```python
import torch

def _softmax(x, axis=-1):
    return torch.softmax(x, dim=axis)
def _gelu(x):
    return torch.nn.functional.gelu(x, approximate="tanh")
def _silu(x):
    return torch.nn.functional.silu(x)
def _sigmoid(x):
    return torch.sigmoid(x)
def _layernorm(x, axis=-1, eps=1e-5):
    m = x.mean(dim=axis, keepdim=True)
    v = x.var(dim=axis, keepdim=True, unbiased=False)
    return (x - m) / torch.sqrt(v + eps)
def _scatter_add(tgt, idx, src, axis=0):
    return tgt.clone().index_add_(axis, idx, src)
def _segment_sum(src, seg, n):
    out = torch.zeros((n,) + src.shape[1:], dtype=src.dtype)
    return out.index_add_(0, seg, src)
def _pad(x, pw):
    flat = tuple(v for pair in reversed(pw) for v in pair)
    return torch.nn.functional.pad(x, flat)

kernel_name = 'concat_heads__compressed_kv_cla__sliding_local_dilated__prompt'

def setup_inputs():

    _w = (lambda a: (lambda t: t.to(torch.bfloat16) if t.is_floating_point() else t)(torch.as_tensor(a)))
    def _A_setup():
        B, H, Sq, Sk, D, M = 1, 32, 2048, 2048, 128, 1024
        Dc = 4 * D
        return {
            "x": _w((lambda *s: torch.randn(*s, dtype=torch.bfloat16) * 0.2)(B, Sq, M)),
            "c_kv": _w((lambda *s: torch.randn(*s, dtype=torch.bfloat16) * 1.6)(B, Sk, Dc)),
            "w_q": _w((lambda *s: torch.randn(*s, dtype=torch.bfloat16) * 3.2)(M, H, D) * (M ** -0.5)),
            "w_uk": _w((lambda *s: torch.randn(*s, dtype=torch.bfloat16) * 3.2)(Dc, H, D) * (Dc ** -0.5)),
            "w_uv": _w((lambda *s: torch.randn(*s, dtype=torch.bfloat16) * 1.6)(Dc, H, D) * (Dc ** -0.5)),
            "w_o": _w((lambda *s: torch.randn(*s, dtype=torch.bfloat16) * 1.6)(H, D, M) * ((H * D) ** -0.5)),
        }
    _A_in = _A_setup()

    def _B_setup():
        B, S, D = 1, 2048, 1024
        return {
            "x": _w((lambda *s: torch.randn(*s, dtype=torch.bfloat16) * 0.2)(B, S, D)),
            "wqkv": _w((lambda *s: torch.randn(*s, dtype=torch.bfloat16) * 0.2)(D, 3 * D)),
            "wo": _w((lambda *s: torch.randn(*s, dtype=torch.bfloat16) * 0.05)(D, D)),
        }
    _B_in = _B_setup()

    return {
        "A_x": _A_in["x"],
        "A_c_kv": _A_in["c_kv"],
        "A_w_q": _A_in["w_q"],
        "A_w_uk": _A_in["w_uk"],
        "A_w_uv": _A_in["w_uv"],
        "A_w_o": _A_in["w_o"],
        "B_x": _B_in["x"],
        "B_wqkv": _B_in["wqkv"],
        "B_wo": _B_in["wo"],
    }

def reference(A_x, A_c_kv, A_w_q, A_w_uk, A_w_uv, A_w_o, B_x, B_wqkv, B_wo):
    def _A_ref(x, c_kv, w_q, w_uk, w_uv, w_o):
        B, Sq, M = x.shape[0], x.shape[1], x.shape[2]
        Sk = c_kv.shape[1]
        H, D = w_q.shape[1], w_q.shape[2]
        q = torch.einsum("bqm,mhd->bhqd", x, w_q)
        k = torch.einsum("bkc,chd->bhkd", c_kv, w_uk)
        v = torch.einsum("bkc,chd->bhkd", c_kv, w_uv)
        scores = torch.einsum("bhqd,bhkd->bhqk", q, k) * (D ** -0.5)
        off = Sk - Sq
        qi = torch.arange(Sq)[:, None]
        kj = torch.arange(Sk)[None, :]
        cmask = kj <= (qi + off)
        scores = torch.where(cmask[None, None], scores, -1e9)
        p = _softmax(scores, axis=-1)
        ctx = torch.einsum("bhqk,bhkd->bhqd", p, v)
        return torch.einsum("bhqd,hdm->bqm", ctx, w_o)

    def _B_ref(x, wqkv, wo):
        B, S, D = x.shape
        H = 32; Dh = D // H
        W, dil = 8, 2
        qkv = (lambda x, *d: x.permute(*d))((x @ wqkv).reshape(B, S, 3, H, Dh), 2, 0, 3, 1, 4)
        q, k, v = qkv[0], qkv[1], qkv[2]
        scale = Dh ** -0.5
        pos = torch.arange(S)
        off = torch.arange(W) * dil
        idx = pos[:, None] - off[None, :]
        mask = idx >= 0
        idx_c = torch.where(mask, idx, 0).reshape(-1)
        kg = k[:, :, idx_c, :].reshape(B, H, S, W, Dh)
        vg = v[:, :, idx_c, :].reshape(B, H, S, W, Dh)
        logits = torch.einsum("bhsd,bhswd->bhsw", q, kg) * scale
        logits = torch.where(mask[None, None, :, :], logits, -1e9)
        attn = _softmax(logits, axis=-1)
        o = torch.einsum("bhsw,bhswd->bhsd", attn, vg)
        return (lambda x, *d: x.permute(*d))(o, 0, 2, 1, 3).reshape(B, S, D) @ wo

    a = _A_ref(A_x, A_c_kv, A_w_q, A_w_uk, A_w_uv, A_w_o)
    b = _B_ref(B_x, B_wqkv, B_wo)
    return torch.concatenate([a, b], axis=-1)
```

```asm
; @launch kernel=k1_proj_kernel grid=(256,1,1) block=(256,1,1) lds=163840
; @launch kernel=k2_attn_kernel grid=(256,1,1) block=(256,1,1) lds=163840
; @launch kernel=k3_oproj_kernel grid=(256,1,1) block=(256,1,1) lds=163840
.amdgcn_target "amdgcn-amd-amdhsa--gfx950"
.text
.globl k1_proj_kernel
.p2align 8
.type k1_proj_kernel,@function
k1_proj_kernel:
  s_cmp_ge_u32 s2, 256
  s_cbranch_scc1 Lk1_end
  s_load_dwordx16 s[64:79], s[0:1], 0
  s_load_dwordx8 s[80:87], s[0:1], 64
  v_lshrrev_b32 v2, 6, v0
  v_and_b32 v1, 63, v0
  v_readfirstlane_b32 s3, v2
  v_lshlrev_b32 v2, 4, v1
  s_waitcnt lgkmcnt(0)
  s_and_b32 s6, s2, 127
  s_and_b32 s4, s6, 1
  s_lshl_b32 s4, s4, 2
  s_bfe_u32 s5, s6, 0x20003
  s_add_u32 s50, s4, s5
  s_bfe_u32 s4, s6, 0x20001
  s_lshl_b32 s4, s4, 2
  s_bfe_u32 s5, s6, 0x20005
  s_add_u32 s51, s4, s5
  s_cmp_lt_u32 s2, 128
  s_cbranch_scc1 Lp1_q
  s_mov_b32 s8, s66
  s_mov_b32 s9, s67
  s_mov_b32 s10, 2097152
  s_mov_b32 s11, 0x00020000
  s_mov_b32 s12, s70
  s_mov_b32 s13, s71
  s_mov_b32 s14, 4194304
  s_mov_b32 s15, 0x00020000
  s_mul_i32 s46, s50, 262144
  s_add_u32 s47, s46, 32768
  s_lshl_b32 s48, s51, 9
  s_add_u32 s49, s48, 262144
  s_lshl_b32 s36, s3, 13
  s_add_u32 s41, s36, 98304
  s_mov_b32 s53, 8
  v_lshrrev_b32 v32, 3, v1
  v_and_b32 v33, 6, v32
  v_and_b32 v34, 7, v1
  v_xor_b32 v33, v33, v34
  v_lshlrev_b32 v33, 4, v33
  s_lshl_b32 s4, s3, 6
  v_mov_b32 v34, v32
  v_add_u32 v34, s4, v34
  v_lshl_add_u32 v34, v34, 10, v33
  v_add_u32 v24, 0, v34
  v_add_u32 v25, 7168, v34
  v_add_u32 v26, 14336, v34
  v_add_u32 v27, 21504, v34
  v_lshrrev_b32 v34, 2, v32
  v_and_b32 v35, 3, v32
  v_lshl_add_u32 v34, v34, 3, v35
  s_lshl_b32 s4, s3, 7
  v_lshl_add_u32 v34, v34, 13, v33
  v_add_u32 v34, s4, v34
  v_add_u32 v28, 0, v34
  v_add_u32 v29, 130048, v34
  v_add_u32 v30, 30720, v34
  v_add_u32 v31, 160768, v34
  s_branch Lp1_go
Lp1_q:
  s_mov_b32 s8, s64
  s_mov_b32 s9, s65
  s_mov_b32 s10, 4194304
  s_mov_b32 s11, 0x00020000
  s_mov_b32 s12, s68
  s_mov_b32 s13, s69
  s_mov_b32 s14, 8388608
  s_mov_b32 s15, 0x00020000
  s_mul_i32 s46, s50, 524288
  s_add_u32 s47, s46, 2048
  s_lshl_b32 s48, s51, 9
  s_add_u32 s49, s48, 262144
  s_lshl_b32 s36, s3, 13
  s_add_u32 s41, s36, 98304
  s_mov_b32 s53, 16
  v_lshrrev_b32 v32, 3, v1
  v_and_b32 v33, 6, v32
  v_and_b32 v34, 7, v1
  v_xor_b32 v33, v33, v34
  v_lshlrev_b32 v33, 4, v33
  s_lshr_b32 s4, s3, 1
  s_lshl_b32 s4, s4, 7
  s_and_b32 s5, s3, 1
  s_lshl_b32 s5, s5, 1
  s_add_u32 s4, s4, s5
  v_lshlrev_b32 v34, 2, v32
  v_add_u32 v34, s4, v34
  v_lshl_add_u32 v34, v34, 11, v33
  v_add_u32 v24, 0, v34
  v_add_u32 v25, 64512, v34
  v_add_u32 v26, 129024, v34
  v_add_u32 v27, 193536, v34
  v_lshrrev_b32 v34, 2, v32
  v_and_b32 v35, 3, v32
  v_lshl_add_u32 v34, v34, 3, v35
  s_lshl_b32 s4, s3, 7
  v_lshl_add_u32 v34, v34, 13, v33
  v_add_u32 v34, s4, v34
  v_add_u32 v28, 0, v34
  v_add_u32 v29, 130048, v34
  v_add_u32 v30, 30720, v34
  v_add_u32 v31, 160768, v34
Lp1_go:
  s_mov_b32 m0, s36
  s_nop 0
  buffer_load_dwordx4 v24, s[8:11], s46 offen offset:0 lds
  buffer_load_dwordx4 v25, s[8:11], s46 offen offset:1024 lds
  buffer_load_dwordx4 v26, s[8:11], s46 offen offset:2048 lds
  buffer_load_dwordx4 v27, s[8:11], s46 offen offset:3072 lds
  s_add_u32 s46, s46, 128
  s_add_u32 m0, s36, 4096
  s_nop 0
  buffer_load_dwordx4 v24, s[8:11], s47 offen offset:0 lds
  buffer_load_dwordx4 v25, s[8:11], s47 offen offset:1024 lds
  buffer_load_dwordx4 v26, s[8:11], s47 offen offset:2048 lds
  buffer_load_dwordx4 v27, s[8:11], s47 offen offset:3072 lds
  s_add_u32 s47, s47, 128
  s_mov_b32 m0, s41
  s_nop 0
  buffer_load_dwordx4 v28, s[12:15], s48 offen offset:0 lds
  buffer_load_dwordx4 v29, s[12:15], s48 offen offset:1024 lds
  buffer_load_dwordx4 v30, s[12:15], s48 offen offset:2048 lds
  buffer_load_dwordx4 v31, s[12:15], s48 offen offset:3072 lds
  s_add_u32 s48, s48, 524288
  s_add_u32 m0, s41, 4096
  s_nop 0
  buffer_load_dwordx4 v28, s[12:15], s49 offen offset:0 lds
  buffer_load_dwordx4 v29, s[12:15], s49 offen offset:1024 lds
  buffer_load_dwordx4 v30, s[12:15], s49 offen offset:2048 lds
  buffer_load_dwordx4 v31, s[12:15], s49 offen offset:3072 lds
  s_add_u32 s49, s49, 524288
  s_add_u32 m0, s36, 32768
  s_nop 0
  buffer_load_dwordx4 v24, s[8:11], s46 offen offset:0 lds
  buffer_load_dwordx4 v25, s[8:11], s46 offen offset:1024 lds
  buffer_load_dwordx4 v26, s[8:11], s46 offen offset:2048 lds
  buffer_load_dwordx4 v27, s[8:11], s46 offen offset:3072 lds
  s_add_u32 s46, s46, 128
  s_add_u32 m0, s36, 36864
  s_nop 0
  buffer_load_dwordx4 v24, s[8:11], s47 offen offset:0 lds
  buffer_load_dwordx4 v25, s[8:11], s47 offen offset:1024 lds
  buffer_load_dwordx4 v26, s[8:11], s47 offen offset:2048 lds
  buffer_load_dwordx4 v27, s[8:11], s47 offen offset:3072 lds
  s_add_u32 s47, s47, 128
  s_add_u32 m0, s41, 32768
  s_nop 0
  buffer_load_dwordx4 v28, s[12:15], s48 offen offset:0 lds
  buffer_load_dwordx4 v29, s[12:15], s48 offen offset:1024 lds
  buffer_load_dwordx4 v30, s[12:15], s48 offen offset:2048 lds
  buffer_load_dwordx4 v31, s[12:15], s48 offen offset:3072 lds
  s_add_u32 s48, s48, 524288
  s_add_u32 m0, s41, 36864
  s_nop 0
  buffer_load_dwordx4 v28, s[12:15], s49 offen offset:0 lds
  buffer_load_dwordx4 v29, s[12:15], s49 offen offset:1024 lds
  buffer_load_dwordx4 v30, s[12:15], s49 offen offset:2048 lds
  buffer_load_dwordx4 v31, s[12:15], s49 offen offset:3072 lds
  s_add_u32 s49, s49, 524288
  s_add_u32 m0, s36, 65536
  s_nop 0
  buffer_load_dwordx4 v24, s[8:11], s46 offen offset:0 lds
  buffer_load_dwordx4 v25, s[8:11], s46 offen offset:1024 lds
  buffer_load_dwordx4 v26, s[8:11], s46 offen offset:2048 lds
  buffer_load_dwordx4 v27, s[8:11], s46 offen offset:3072 lds
  s_add_u32 s46, s46, 128
  s_add_u32 m0, s36, 69632
  s_nop 0
  buffer_load_dwordx4 v24, s[8:11], s47 offen offset:0 lds
  buffer_load_dwordx4 v25, s[8:11], s47 offen offset:1024 lds
  buffer_load_dwordx4 v26, s[8:11], s47 offen offset:2048 lds
  buffer_load_dwordx4 v27, s[8:11], s47 offen offset:3072 lds
  s_add_u32 s47, s47, 128
  s_lshr_b32 s4, s3, 1
  s_lshl_b32 s4, s4, 14
  v_and_b32 v32, 15, v1
  v_lshlrev_b32 v32, 7, v32
  v_lshrrev_b32 v33, 4, v1
  v_and_b32 v34, 6, v1
  v_xor_b32 v33, v33, v34
  v_lshl_add_u32 v32, v33, 4, v32
  v_add_u32 v16, s4, v32
  v_xor_b32 v17, 64, v16
  s_and_b32 s4, s3, 1
  s_lshl_b32 s4, s4, 14
  s_add_u32 s4, s4, 98304
  v_lshrrev_b32 v32, 2, v1
  v_and_b32 v33, 6, v32
  v_lshlrev_b32 v32, 7, v32
  v_and_b32 v34, 1, v1
  v_lshl_add_u32 v32, v34, 3, v32
  v_add_u32 v32, s4, v32
  v_bfe_u32 v34, v1, 1, 1
  v_xor_b32 v33, v33, v34
  v_xor_b32 v34, 0, v33
  v_lshl_add_u32 v18, v34, 4, v32
  v_xor_b32 v34, 2, v33
  v_lshl_add_u32 v19, v34, 4, v32
  v_xor_b32 v34, 4, v33
  v_lshl_add_u32 v20, v34, 4, v32
  v_xor_b32 v34, 6, v33
  v_lshl_add_u32 v21, v34, 4, v32
  s_cmp_lt_u32 s2, 154
  s_cselect_b32 s56, s78, s76
  s_cselect_b32 s57, s79, s77
  s_cselect_b32 s60, 0, 154
  s_mov_b32 s58, 4194304
  s_cselect_b32 s58, 6291456, s58
  s_mov_b32 s59, 0x00020000
  s_sub_u32 s60, s2, s60
  s_lshl_b32 s60, s60, 2
  s_add_u32 s60, s60, s3
  s_mul_i32 s60, s60, 10240
  s_mov_b32 s37, 0
  s_mov_b32 s39, 4294901760
  s_mov_b32 s40, 32768
  s_mov_b32 s42, 0
  s_mov_b32 s44, 4294934528
  s_mov_b32 s45, 32768
  s_mov_b32 s43, s44
  s_waitcnt vmcnt(24)
  s_barrier
  ds_read_b128 a[0:3], v16 offset:0
  ds_read_b64_tr_b16 a[64:65], v18 offset:0
  ds_read_b64_tr_b16 a[66:67], v18 offset:2048
  ds_read_b128 a[4:7], v16 offset:2048
  ds_read_b128 a[8:11], v16 offset:4096
  ds_read_b128 a[12:15], v16 offset:6144
  ds_read_b128 a[16:19], v16 offset:8192
  ds_read_b128 a[20:23], v16 offset:10240
  ds_read_b128 a[24:27], v16 offset:12288
  ds_read_b128 a[28:31], v16 offset:14336
  ds_read_b64_tr_b16 a[68:69], v19 offset:0
  ds_read_b64_tr_b16 a[70:71], v19 offset:2048
  ds_read_b64_tr_b16 a[72:73], v20 offset:0
  ds_read_b64_tr_b16 a[74:75], v20 offset:2048
  ds_read_b64_tr_b16 a[76:77], v21 offset:0
  ds_read_b64_tr_b16 a[78:79], v21 offset:2048
  ds_read_b64_tr_b16 a[80:81], v18 offset:8192
  ds_read_b64_tr_b16 a[82:83], v18 offset:10240
  ds_read_b64_tr_b16 a[84:85], v19 offset:8192
  ds_read_b64_tr_b16 a[86:87], v19 offset:10240
  ds_read_b64_tr_b16 a[88:89], v20 offset:8192
  ds_read_b64_tr_b16 a[90:91], v20 offset:10240
  ds_read_b64_tr_b16 a[92:93], v21 offset:8192
  ds_read_b64_tr_b16 a[94:95], v21 offset:10240
  s_waitcnt lgkmcnt(0)
  v_mfma_f32_16x16x32_bf16 v[64:67], a[64:67], a[0:3], 0
  s_add_u32 s37, s37, 1
  s_cmp_eq_u32 s37, 3
  s_cselect_b32 s37, 0, s37
  s_cselect_b32 s38, s39, s40
  ds_read_b128 a[32:35], v17 offset:0
  v_mfma_f32_16x16x32_bf16 v[96:99], a[64:67], a[4:7], 0
  s_sub_u32 s43, 0, s43
  v_mfma_f32_16x16x32_bf16 v[128:131], a[64:67], a[8:11], 0
  ds_read_b64_tr_b16 a[96:97], v18 offset:4096
  v_mfma_f32_16x16x32_bf16 v[160:163], a[64:67], a[12:15], 0
  v_mfma_f32_16x16x32_bf16 v[192:195], a[64:67], a[16:19], 0
  ds_read_b64_tr_b16 a[98:99], v18 offset:6144
  v_mfma_f32_16x16x32_bf16 v[224:227], a[64:67], a[20:23], 0
  v_mfma_f32_16x16x32_bf16 a[128:131], a[64:67], a[24:27], 0
  ds_read_b128 a[36:39], v17 offset:2048
  v_mfma_f32_16x16x32_bf16 a[160:163], a[64:67], a[28:31], 0
  v_mfma_f32_16x16x32_bf16 v[68:71], a[68:71], a[0:3], 0
  v_mfma_f32_16x16x32_bf16 v[100:103], a[68:71], a[4:7], 0
  ds_read_b128 a[40:43], v17 offset:4096
  v_mfma_f32_16x16x32_bf16 v[132:135], a[68:71], a[8:11], 0
  v_mfma_f32_16x16x32_bf16 v[164:167], a[68:71], a[12:15], 0
  ds_read_b128 a[44:47], v17 offset:6144
  v_mfma_f32_16x16x32_bf16 v[196:199], a[68:71], a[16:19], 0
  v_mfma_f32_16x16x32_bf16 v[228:231], a[68:71], a[20:23], 0
  ds_read_b128 a[48:51], v17 offset:8192
  v_mfma_f32_16x16x32_bf16 a[132:135], a[68:71], a[24:27], 0
  v_mfma_f32_16x16x32_bf16 a[164:167], a[68:71], a[28:31], 0
  ds_read_b128 a[52:55], v17 offset:10240
  v_mfma_f32_16x16x32_bf16 v[72:75], a[72:75], a[0:3], 0
  v_mfma_f32_16x16x32_bf16 v[104:107], a[72:75], a[4:7], 0
  v_mfma_f32_16x16x32_bf16 v[136:139], a[72:75], a[8:11], 0
  ds_read_b128 a[56:59], v17 offset:12288
  v_mfma_f32_16x16x32_bf16 v[168:171], a[72:75], a[12:15], 0
  v_mfma_f32_16x16x32_bf16 v[200:203], a[72:75], a[16:19], 0
  ds_read_b128 a[60:63], v17 offset:14336
  v_mfma_f32_16x16x32_bf16 v[232:235], a[72:75], a[20:23], 0
  v_mfma_f32_16x16x32_bf16 a[136:139], a[72:75], a[24:27], 0
  ds_read_b64_tr_b16 a[100:101], v19 offset:4096
  v_mfma_f32_16x16x32_bf16 a[168:171], a[72:75], a[28:31], 0
  v_mfma_f32_16x16x32_bf16 v[76:79], a[76:79], a[0:3], 0
  ds_read_b64_tr_b16 a[102:103], v19 offset:6144
  v_mfma_f32_16x16x32_bf16 v[108:111], a[76:79], a[4:7], 0
  v_mfma_f32_16x16x32_bf16 v[140:143], a[76:79], a[8:11], 0
  v_mfma_f32_16x16x32_bf16 v[172:175], a[76:79], a[12:15], 0
  ds_read_b64_tr_b16 a[104:105], v20 offset:4096
  v_mfma_f32_16x16x32_bf16 v[204:207], a[76:79], a[16:19], 0
  v_mfma_f32_16x16x32_bf16 v[236:239], a[76:79], a[20:23], 0
  ds_read_b64_tr_b16 a[106:107], v20 offset:6144
  v_mfma_f32_16x16x32_bf16 a[140:143], a[76:79], a[24:27], 0
  v_mfma_f32_16x16x32_bf16 a[172:175], a[76:79], a[28:31], 0
  ds_read_b64_tr_b16 a[108:109], v21 offset:4096
  v_mfma_f32_16x16x32_bf16 v[80:83], a[80:83], a[0:3], 0
  v_mfma_f32_16x16x32_bf16 v[112:115], a[80:83], a[4:7], 0
  ds_read_b64_tr_b16 a[110:111], v21 offset:6144
  v_mfma_f32_16x16x32_bf16 v[144:147], a[80:83], a[8:11], 0
  v_mfma_f32_16x16x32_bf16 v[176:179], a[80:83], a[12:15], 0
  v_mfma_f32_16x16x32_bf16 v[208:211], a[80:83], a[16:19], 0
  ds_read_b64_tr_b16 a[112:113], v18 offset:12288
  v_mfma_f32_16x16x32_bf16 v[240:243], a[80:83], a[20:23], 0
  v_mfma_f32_16x16x32_bf16 a[144:147], a[80:83], a[24:27], 0
  ds_read_b64_tr_b16 a[114:115], v18 offset:14336
  v_mfma_f32_16x16x32_bf16 a[176:179], a[80:83], a[28:31], 0
  v_mfma_f32_16x16x32_bf16 v[84:87], a[84:87], a[0:3], 0
  ds_read_b64_tr_b16 a[116:117], v19 offset:12288
  v_mfma_f32_16x16x32_bf16 v[116:119], a[84:87], a[4:7], 0
  v_mfma_f32_16x16x32_bf16 v[148:151], a[84:87], a[8:11], 0
  ds_read_b64_tr_b16 a[118:119], v19 offset:14336
  v_mfma_f32_16x16x32_bf16 v[180:183], a[84:87], a[12:15], 0
  v_mfma_f32_16x16x32_bf16 v[212:215], a[84:87], a[16:19], 0
  v_mfma_f32_16x16x32_bf16 v[244:247], a[84:87], a[20:23], 0
  ds_read_b64_tr_b16 a[120:121], v20 offset:12288
  v_mfma_f32_16x16x32_bf16 a[148:151], a[84:87], a[24:27], 0
  v_mfma_f32_16x16x32_bf16 a[180:183], a[84:87], a[28:31], 0
  ds_read_b64_tr_b16 a[122:123], v20 offset:14336
  v_mfma_f32_16x16x32_bf16 v[88:91], a[88:91], a[0:3], 0
  v_mfma_f32_16x16x32_bf16 v[120:123], a[88:91], a[4:7], 0
  ds_read_b64_tr_b16 a[124:125], v21 offset:12288
  v_mfma_f32_16x16x32_bf16 v[152:155], a[88:91], a[8:11], 0
  v_mfma_f32_16x16x32_bf16 v[184:187], a[88:91], a[12:15], 0
  ds_read_b64_tr_b16 a[126:127], v21 offset:14336
  v_mfma_f32_16x16x32_bf16 v[216:219], a[88:91], a[16:19], 0
  v_add_u32 v16, s38, v16
  v_add_u32 v17, s38, v17
  v_mfma_f32_16x16x32_bf16 v[248:251], a[88:91], a[20:23], 0
  v_add_u32 v18, s43, v18
  v_add_u32 v19, s43, v19
  v_mfma_f32_16x16x32_bf16 a[152:155], a[88:91], a[24:27], 0
  v_add_u32 v20, s43, v20
  v_add_u32 v21, s43, v21
  v_mfma_f32_16x16x32_bf16 a[184:187], a[88:91], a[28:31], 0
  v_mfma_f32_16x16x32_bf16 v[92:95], a[92:95], a[0:3], 0
  v_mfma_f32_16x16x32_bf16 v[124:127], a[92:95], a[4:7], 0
  v_mfma_f32_16x16x32_bf16 v[156:159], a[92:95], a[8:11], 0
  v_mfma_f32_16x16x32_bf16 v[188:191], a[92:95], a[12:15], 0
  v_mfma_f32_16x16x32_bf16 v[220:223], a[92:95], a[16:19], 0
  v_mfma_f32_16x16x32_bf16 v[252:255], a[92:95], a[20:23], 0
  v_mfma_f32_16x16x32_bf16 a[156:159], a[92:95], a[24:27], 0
  v_mfma_f32_16x16x32_bf16 a[188:191], a[92:95], a[28:31], 0
  s_sub_u32 s35, s53, 3
  .p2align 6
Lp1wx_loop:
  s_waitcnt vmcnt(8) lgkmcnt(0)
  s_barrier
  v_mfma_f32_16x16x32_bf16 v[64:67], a[96:99], a[32:35], v[64:67]
  buffer_load_dwordx4 v[4:7], v2, s[56:59], s60 offen
  ds_read_b128 a[0:3], v16 offset:0
  v_mfma_f32_16x16x32_bf16 v[96:99], a[96:99], a[36:39], v[96:99]
  s_add_u32 s60, s60, 1024
  s_mov_b32 m0, s41
  v_mfma_f32_16x16x32_bf16 v[128:131], a[96:99], a[40:43], v[128:131]
  ds_read_b64_tr_b16 a[64:65], v18 offset:0
  v_mfma_f32_16x16x32_bf16 v[160:163], a[96:99], a[44:47], v[160:163]
  v_mfma_f32_16x16x32_bf16 v[192:195], a[96:99], a[48:51], v[192:195]
  ds_read_b64_tr_b16 a[66:67], v18 offset:2048
  v_mfma_f32_16x16x32_bf16 v[224:227], a[96:99], a[52:55], v[224:227]
  v_mfma_f32_16x16x32_bf16 a[128:131], a[96:99], a[56:59], a[128:131]
  ds_read_b128 a[4:7], v16 offset:2048
  v_mfma_f32_16x16x32_bf16 a[160:163], a[96:99], a[60:63], a[160:163]
  buffer_load_dwordx4 v28, s[12:15], s48 offen offset:0 lds
  v_mfma_f32_16x16x32_bf16 v[68:71], a[100:103], a[32:35], v[68:71]
  v_mfma_f32_16x16x32_bf16 v[100:103], a[100:103], a[36:39], v[100:103]
  ds_read_b128 a[8:11], v16 offset:4096
  v_mfma_f32_16x16x32_bf16 v[132:135], a[100:103], a[40:43], v[132:135]
  v_mfma_f32_16x16x32_bf16 v[164:167], a[100:103], a[44:47], v[164:167]
  ds_read_b128 a[12:15], v16 offset:6144
  v_mfma_f32_16x16x32_bf16 v[196:199], a[100:103], a[48:51], v[196:199]
  v_mfma_f32_16x16x32_bf16 v[228:231], a[100:103], a[52:55], v[228:231]
  ds_read_b128 a[16:19], v16 offset:8192
  v_mfma_f32_16x16x32_bf16 a[132:135], a[100:103], a[56:59], a[132:135]
  buffer_load_dwordx4 v29, s[12:15], s48 offen offset:1024 lds
  v_mfma_f32_16x16x32_bf16 a[164:167], a[100:103], a[60:63], a[164:167]
  ds_read_b128 a[20:23], v16 offset:10240
  v_mfma_f32_16x16x32_bf16 v[72:75], a[104:107], a[32:35], v[72:75]
  v_mfma_f32_16x16x32_bf16 v[104:107], a[104:107], a[36:39], v[104:107]
  v_mfma_f32_16x16x32_bf16 v[136:139], a[104:107], a[40:43], v[136:139]
  ds_read_b128 a[24:27], v16 offset:12288
  v_mfma_f32_16x16x32_bf16 v[168:171], a[104:107], a[44:47], v[168:171]
  v_mfma_f32_16x16x32_bf16 v[200:203], a[104:107], a[48:51], v[200:203]
  ds_read_b128 a[28:31], v16 offset:14336
  v_mfma_f32_16x16x32_bf16 v[232:235], a[104:107], a[52:55], v[232:235]
  buffer_load_dwordx4 v30, s[12:15], s48 offen offset:2048 lds
  v_mfma_f32_16x16x32_bf16 a[136:139], a[104:107], a[56:59], a[136:139]
  ds_read_b64_tr_b16 a[68:69], v19 offset:0
  v_mfma_f32_16x16x32_bf16 a[168:171], a[104:107], a[60:63], a[168:171]
  v_mfma_f32_16x16x32_bf16 v[76:79], a[108:111], a[32:35], v[76:79]
  ds_read_b64_tr_b16 a[70:71], v19 offset:2048
  v_mfma_f32_16x16x32_bf16 v[108:111], a[108:111], a[36:39], v[108:111]
  v_mfma_f32_16x16x32_bf16 v[140:143], a[108:111], a[40:43], v[140:143]
  v_mfma_f32_16x16x32_bf16 v[172:175], a[108:111], a[44:47], v[172:175]
  ds_read_b64_tr_b16 a[72:73], v20 offset:0
  v_mfma_f32_16x16x32_bf16 v[204:207], a[108:111], a[48:51], v[204:207]
  buffer_load_dwordx4 v31, s[12:15], s48 offen offset:3072 lds
  v_mfma_f32_16x16x32_bf16 v[236:239], a[108:111], a[52:55], v[236:239]
  s_add_u32 s48, s48, 524288
  s_add_u32 m0, s41, 4096
  ds_read_b64_tr_b16 a[74:75], v20 offset:2048
  v_mfma_f32_16x16x32_bf16 a[140:143], a[108:111], a[56:59], a[140:143]
  v_mfma_f32_16x16x32_bf16 a[172:175], a[108:111], a[60:63], a[172:175]
  ds_read_b64_tr_b16 a[76:77], v21 offset:0
  v_mfma_f32_16x16x32_bf16 v[80:83], a[112:115], a[32:35], v[80:83]
  v_mfma_f32_16x16x32_bf16 v[112:115], a[112:115], a[36:39], v[112:115]
  ds_read_b64_tr_b16 a[78:79], v21 offset:2048
  v_mfma_f32_16x16x32_bf16 v[144:147], a[112:115], a[40:43], v[144:147]
  v_mfma_f32_16x16x32_bf16 v[176:179], a[112:115], a[44:47], v[176:179]
  buffer_load_dwordx4 v28, s[12:15], s49 offen offset:0 lds
  v_mfma_f32_16x16x32_bf16 v[208:211], a[112:115], a[48:51], v[208:211]
  ds_read_b64_tr_b16 a[80:81], v18 offset:8192
  v_mfma_f32_16x16x32_bf16 v[240:243], a[112:115], a[52:55], v[240:243]
  v_mfma_f32_16x16x32_bf16 a[144:147], a[112:115], a[56:59], a[144:147]
  ds_read_b64_tr_b16 a[82:83], v18 offset:10240
  v_mfma_f32_16x16x32_bf16 a[176:179], a[112:115], a[60:63], a[176:179]
  v_mfma_f32_16x16x32_bf16 v[84:87], a[116:119], a[32:35], v[84:87]
  ds_read_b64_tr_b16 a[84:85], v19 offset:8192
  v_mfma_f32_16x16x32_bf16 v[116:119], a[116:119], a[36:39], v[116:119]
  v_mfma_f32_16x16x32_bf16 v[148:151], a[116:119], a[40:43], v[148:151]
  buffer_load_dwordx4 v29, s[12:15], s49 offen offset:1024 lds
  ds_read_b64_tr_b16 a[86:87], v19 offset:10240
  v_mfma_f32_16x16x32_bf16 v[180:183], a[116:119], a[44:47], v[180:183]
  v_mfma_f32_16x16x32_bf16 v[212:215], a[116:119], a[48:51], v[212:215]
  v_mfma_f32_16x16x32_bf16 v[244:247], a[116:119], a[52:55], v[244:247]
  ds_read_b64_tr_b16 a[88:89], v20 offset:8192
  v_mfma_f32_16x16x32_bf16 a[148:151], a[116:119], a[56:59], a[148:151]
  v_mfma_f32_16x16x32_bf16 a[180:183], a[116:119], a[60:63], a[180:183]
  ds_read_b64_tr_b16 a[90:91], v20 offset:10240
  v_mfma_f32_16x16x32_bf16 v[88:91], a[120:123], a[32:35], v[88:91]
  v_mfma_f32_16x16x32_bf16 v[120:123], a[120:123], a[36:39], v[120:123]
  buffer_load_dwordx4 v30, s[12:15], s49 offen offset:2048 lds
  ds_read_b64_tr_b16 a[92:93], v21 offset:8192
  v_mfma_f32_16x16x32_bf16 v[152:155], a[120:123], a[40:43], v[152:155]
  v_mfma_f32_16x16x32_bf16 v[184:187], a[120:123], a[44:47], v[184:187]
  ds_read_b64_tr_b16 a[94:95], v21 offset:10240
  v_mfma_f32_16x16x32_bf16 v[216:219], a[120:123], a[48:51], v[216:219]
  v_mfma_f32_16x16x32_bf16 v[248:251], a[120:123], a[52:55], v[248:251]
  v_mfma_f32_16x16x32_bf16 a[152:155], a[120:123], a[56:59], a[152:155]
  v_mfma_f32_16x16x32_bf16 a[184:187], a[120:123], a[60:63], a[184:187]
  v_mfma_f32_16x16x32_bf16 v[92:95], a[124:127], a[32:35], v[92:95]
  buffer_load_dwordx4 v31, s[12:15], s49 offen offset:3072 lds
  v_mfma_f32_16x16x32_bf16 v[124:127], a[124:127], a[36:39], v[124:127]
  s_add_u32 s49, s49, 524288
  v_mfma_f32_16x16x32_bf16 v[156:159], a[124:127], a[40:43], v[156:159]
  v_mfma_f32_16x16x32_bf16 v[188:191], a[124:127], a[44:47], v[188:191]
  v_mfma_f32_16x16x32_bf16 v[220:223], a[124:127], a[48:51], v[220:223]
  v_mfma_f32_16x16x32_bf16 v[252:255], a[124:127], a[52:55], v[252:255]
  v_mfma_f32_16x16x32_bf16 a[156:159], a[124:127], a[56:59], a[156:159]
  v_mfma_f32_16x16x32_bf16 a[188:191], a[124:127], a[60:63], a[188:191]
  s_waitcnt lgkmcnt(0)
  v_mfma_f32_16x16x32_bf16 v[64:67], a[64:67], a[0:3], v[64:67]
  s_mov_b32 m0, s36
  ds_read_b128 a[32:35], v17 offset:0
  v_mfma_f32_16x16x32_bf16 v[96:99], a[64:67], a[4:7], v[96:99]
  buffer_load_dwordx4 v24, s[8:11], s46 offen offset:0 lds
  v_mfma_f32_16x16x32_bf16 v[128:131], a[64:67], a[8:11], v[128:131]
  ds_read_b64_tr_b16 a[96:97], v18 offset:4096
  v_mfma_f32_16x16x32_bf16 v[160:163], a[64:67], a[12:15], v[160:163]
  v_mfma_f32_16x16x32_bf16 v[192:195], a[64:67], a[16:19], v[192:195]
  ds_read_b64_tr_b16 a[98:99], v18 offset:6144
  v_mfma_f32_16x16x32_bf16 v[224:227], a[64:67], a[20:23], v[224:227]
  v_mfma_f32_16x16x32_bf16 a[128:131], a[64:67], a[24:27], a[128:131]
  ds_read_b128 a[36:39], v17 offset:2048
  v_mfma_f32_16x16x32_bf16 a[160:163], a[64:67], a[28:31], a[160:163]
  buffer_load_dwordx4 v25, s[8:11], s46 offen offset:1024 lds
  v_mfma_f32_16x16x32_bf16 v[68:71], a[68:71], a[0:3], v[68:71]
  v_mfma_f32_16x16x32_bf16 v[100:103], a[68:71], a[4:7], v[100:103]
  ds_read_b128 a[40:43], v17 offset:4096
  v_mfma_f32_16x16x32_bf16 v[132:135], a[68:71], a[8:11], v[132:135]
  v_mfma_f32_16x16x32_bf16 v[164:167], a[68:71], a[12:15], v[164:167]
  ds_read_b128 a[44:47], v17 offset:6144
  v_mfma_f32_16x16x32_bf16 v[196:199], a[68:71], a[16:19], v[196:199]
  v_mfma_f32_16x16x32_bf16 v[228:231], a[68:71], a[20:23], v[228:231]
  ds_read_b128 a[48:51], v17 offset:8192
  v_mfma_f32_16x16x32_bf16 a[132:135], a[68:71], a[24:27], a[132:135]
  buffer_load_dwordx4 v26, s[8:11], s46 offen offset:2048 lds
  v_mfma_f32_16x16x32_bf16 a[164:167], a[68:71], a[28:31], a[164:167]
  ds_read_b128 a[52:55], v17 offset:10240
  v_mfma_f32_16x16x32_bf16 v[72:75], a[72:75], a[0:3], v[72:75]
  v_mfma_f32_16x16x32_bf16 v[104:107], a[72:75], a[4:7], v[104:107]
  v_mfma_f32_16x16x32_bf16 v[136:139], a[72:75], a[8:11], v[136:139]
  ds_read_b128 a[56:59], v17 offset:12288
  v_mfma_f32_16x16x32_bf16 v[168:171], a[72:75], a[12:15], v[168:171]
  v_mfma_f32_16x16x32_bf16 v[200:203], a[72:75], a[16:19], v[200:203]
  ds_read_b128 a[60:63], v17 offset:14336
  v_mfma_f32_16x16x32_bf16 v[232:235], a[72:75], a[20:23], v[232:235]
  buffer_load_dwordx4 v27, s[8:11], s46 offen offset:3072 lds
  v_mfma_f32_16x16x32_bf16 a[136:139], a[72:75], a[24:27], a[136:139]
  s_add_u32 s46, s46, 128
  s_add_u32 m0, s36, 4096
  ds_read_b64_tr_b16 a[100:101], v19 offset:4096
  v_mfma_f32_16x16x32_bf16 a[168:171], a[72:75], a[28:31], a[168:171]
  v_mfma_f32_16x16x32_bf16 v[76:79], a[76:79], a[0:3], v[76:79]
  ds_read_b64_tr_b16 a[102:103], v19 offset:6144
  v_mfma_f32_16x16x32_bf16 v[108:111], a[76:79], a[4:7], v[108:111]
  v_mfma_f32_16x16x32_bf16 v[140:143], a[76:79], a[8:11], v[140:143]
  v_mfma_f32_16x16x32_bf16 v[172:175], a[76:79], a[12:15], v[172:175]
  ds_read_b64_tr_b16 a[104:105], v20 offset:4096
  v_mfma_f32_16x16x32_bf16 v[204:207], a[76:79], a[16:19], v[204:207]
  buffer_load_dwordx4 v24, s[8:11], s47 offen offset:0 lds
  v_mfma_f32_16x16x32_bf16 v[236:239], a[76:79], a[20:23], v[236:239]
  ds_read_b64_tr_b16 a[106:107], v20 offset:6144
  v_mfma_f32_16x16x32_bf16 a[140:143], a[76:79], a[24:27], a[140:143]
  v_mfma_f32_16x16x32_bf16 a[172:175], a[76:79], a[28:31], a[172:175]
  ds_read_b64_tr_b16 a[108:109], v21 offset:4096
  v_mfma_f32_16x16x32_bf16 v[80:83], a[80:83], a[0:3], v[80:83]
  v_mfma_f32_16x16x32_bf16 v[112:115], a[80:83], a[4:7], v[112:115]
  ds_read_b64_tr_b16 a[110:111], v21 offset:6144
  v_mfma_f32_16x16x32_bf16 v[144:147], a[80:83], a[8:11], v[144:147]
  v_mfma_f32_16x16x32_bf16 v[176:179], a[80:83], a[12:15], v[176:179]
  buffer_load_dwordx4 v25, s[8:11], s47 offen offset:1024 lds
  v_mfma_f32_16x16x32_bf16 v[208:211], a[80:83], a[16:19], v[208:211]
  ds_read_b64_tr_b16 a[112:113], v18 offset:12288
  v_mfma_f32_16x16x32_bf16 v[240:243], a[80:83], a[20:23], v[240:243]
  v_mfma_f32_16x16x32_bf16 a[144:147], a[80:83], a[24:27], a[144:147]
  ds_read_b64_tr_b16 a[114:115], v18 offset:14336
  v_mfma_f32_16x16x32_bf16 a[176:179], a[80:83], a[28:31], a[176:179]
  v_mfma_f32_16x16x32_bf16 v[84:87], a[84:87], a[0:3], v[84:87]
  ds_read_b64_tr_b16 a[116:117], v19 offset:12288
  v_mfma_f32_16x16x32_bf16 v[116:119], a[84:87], a[4:7], v[116:119]
  v_mfma_f32_16x16x32_bf16 v[148:151], a[84:87], a[8:11], v[148:151]
  buffer_load_dwordx4 v26, s[8:11], s47 offen offset:2048 lds
  ds_read_b64_tr_b16 a[118:119], v19 offset:14336
  v_mfma_f32_16x16x32_bf16 v[180:183], a[84:87], a[12:15], v[180:183]
  v_mfma_f32_16x16x32_bf16 v[212:215], a[84:87], a[16:19], v[212:215]
  v_mfma_f32_16x16x32_bf16 v[244:247], a[84:87], a[20:23], v[244:247]
  ds_read_b64_tr_b16 a[120:121], v20 offset:12288
  v_mfma_f32_16x16x32_bf16 a[148:151], a[84:87], a[24:27], a[148:151]
  v_mfma_f32_16x16x32_bf16 a[180:183], a[84:87], a[28:31], a[180:183]
  ds_read_b64_tr_b16 a[122:123], v20 offset:14336
  v_mfma_f32_16x16x32_bf16 v[88:91], a[88:91], a[0:3], v[88:91]
  v_mfma_f32_16x16x32_bf16 v[120:123], a[88:91], a[4:7], v[120:123]
  buffer_load_dwordx4 v27, s[8:11], s47 offen offset:3072 lds
  ds_read_b64_tr_b16 a[124:125], v21 offset:12288
  v_mfma_f32_16x16x32_bf16 v[152:155], a[88:91], a[8:11], v[152:155]
  s_add_u32 s47, s47, 128
  v_mfma_f32_16x16x32_bf16 v[184:187], a[88:91], a[12:15], v[184:187]
  s_add_u32 s36, s36, s38
  s_add_u32 s37, s37, 1
  ds_read_b64_tr_b16 a[126:127], v21 offset:14336
  v_mfma_f32_16x16x32_bf16 v[216:219], a[88:91], a[16:19], v[216:219]
  s_cmp_eq_u32 s37, 3
  s_cselect_b32 s37, 0, s37
  s_cselect_b32 s38, s39, s40
  v_mfma_f32_16x16x32_bf16 v[248:251], a[88:91], a[20:23], v[248:251]
  s_add_u32 s41, s41, s43
  s_sub_u32 s43, 0, s43
  v_mfma_f32_16x16x32_bf16 a[152:155], a[88:91], a[24:27], a[152:155]
  v_add_u32 v16, s38, v16
  v_add_u32 v17, s38, v17
  v_mfma_f32_16x16x32_bf16 a[184:187], a[88:91], a[28:31], a[184:187]
  v_add_u32 v18, s43, v18
  v_add_u32 v19, s43, v19
  v_mfma_f32_16x16x32_bf16 v[92:95], a[92:95], a[0:3], v[92:95]
  v_add_u32 v20, s43, v20
  v_add_u32 v21, s43, v21
  v_mfma_f32_16x16x32_bf16 v[124:127], a[92:95], a[4:7], v[124:127]
  v_mfma_f32_16x16x32_bf16 v[156:159], a[92:95], a[8:11], v[156:159]
  v_mfma_f32_16x16x32_bf16 v[188:191], a[92:95], a[12:15], v[188:191]
  v_mfma_f32_16x16x32_bf16 v[220:223], a[92:95], a[16:19], v[220:223]
  v_mfma_f32_16x16x32_bf16 v[252:255], a[92:95], a[20:23], v[252:255]
  v_mfma_f32_16x16x32_bf16 a[156:159], a[92:95], a[24:27], a[156:159]
  s_sub_u32 s35, s35, 1
  v_mfma_f32_16x16x32_bf16 a[188:191], a[92:95], a[28:31], a[188:191]
  s_cmp_lg_u32 s35, 0
  s_cbranch_scc1 Lp1wx_loop
  s_waitcnt vmcnt(8) lgkmcnt(0)
  s_barrier
  v_mfma_f32_16x16x32_bf16 v[64:67], a[96:99], a[32:35], v[64:67]
  s_mov_b32 m0, s41
  ds_read_b128 a[0:3], v16 offset:0
  v_mfma_f32_16x16x32_bf16 v[96:99], a[96:99], a[36:39], v[96:99]
  buffer_load_dwordx4 v28, s[12:15], s48 offen offset:0 lds
  v_mfma_f32_16x16x32_bf16 v[128:131], a[96:99], a[40:43], v[128:131]
  ds_read_b64_tr_b16 a[64:65], v18 offset:0
  v_mfma_f32_16x16x32_bf16 v[160:163], a[96:99], a[44:47], v[160:163]
  v_mfma_f32_16x16x32_bf16 v[192:195], a[96:99], a[48:51], v[192:195]
  ds_read_b64_tr_b16 a[66:67], v18 offset:2048
  v_mfma_f32_16x16x32_bf16 v[224:227], a[96:99], a[52:55], v[224:227]
  v_mfma_f32_16x16x32_bf16 a[128:131], a[96:99], a[56:59], a[128:131]
  ds_read_b128 a[4:7], v16 offset:2048
  v_mfma_f32_16x16x32_bf16 a[160:163], a[96:99], a[60:63], a[160:163]
  buffer_load_dwordx4 v29, s[12:15], s48 offen offset:1024 lds
  v_mfma_f32_16x16x32_bf16 v[68:71], a[100:103], a[32:35], v[68:71]
  v_mfma_f32_16x16x32_bf16 v[100:103], a[100:103], a[36:39], v[100:103]
  ds_read_b128 a[8:11], v16 offset:4096
  v_mfma_f32_16x16x32_bf16 v[132:135], a[100:103], a[40:43], v[132:135]
  v_mfma_f32_16x16x32_bf16 v[164:167], a[100:103], a[44:47], v[164:167]
  ds_read_b128 a[12:15], v16 offset:6144
  v_mfma_f32_16x16x32_bf16 v[196:199], a[100:103], a[48:51], v[196:199]
  v_mfma_f32_16x16x32_bf16 v[228:231], a[100:103], a[52:55], v[228:231]
  ds_read_b128 a[16:19], v16 offset:8192
  v_mfma_f32_16x16x32_bf16 a[132:135], a[100:103], a[56:59], a[132:135]
  v_mfma_f32_16x16x32_bf16 a[164:167], a[100:103], a[60:63], a[164:167]
  buffer_load_dwordx4 v30, s[12:15], s48 offen offset:2048 lds
  ds_read_b128 a[20:23], v16 offset:10240
  v_mfma_f32_16x16x32_bf16 v[72:75], a[104:107], a[32:35], v[72:75]
  v_mfma_f32_16x16x32_bf16 v[104:107], a[104:107], a[36:39], v[104:107]
  v_mfma_f32_16x16x32_bf16 v[136:139], a[104:107], a[40:43], v[136:139]
  ds_read_b128 a[24:27], v16 offset:12288
  v_mfma_f32_16x16x32_bf16 v[168:171], a[104:107], a[44:47], v[168:171]
  v_mfma_f32_16x16x32_bf16 v[200:203], a[104:107], a[48:51], v[200:203]
  ds_read_b128 a[28:31], v16 offset:14336
  v_mfma_f32_16x16x32_bf16 v[232:235], a[104:107], a[52:55], v[232:235]
  v_mfma_f32_16x16x32_bf16 a[136:139], a[104:107], a[56:59], a[136:139]
  ds_read_b64_tr_b16 a[68:69], v19 offset:0
  v_mfma_f32_16x16x32_bf16 a[168:171], a[104:107], a[60:63], a[168:171]
  buffer_load_dwordx4 v31, s[12:15], s48 offen offset:3072 lds
  v_mfma_f32_16x16x32_bf16 v[76:79], a[108:111], a[32:35], v[76:79]
  s_add_u32 s48, s48, 524288
  s_add_u32 m0, s41, 4096
  ds_read_b64_tr_b16 a[70:71], v19 offset:2048
  v_mfma_f32_16x16x32_bf16 v[108:111], a[108:111], a[36:39], v[108:111]
  v_mfma_f32_16x16x32_bf16 v[140:143], a[108:111], a[40:43], v[140:143]
  v_mfma_f32_16x16x32_bf16 v[172:175], a[108:111], a[44:47], v[172:175]
  ds_read_b64_tr_b16 a[72:73], v20 offset:0
  v_mfma_f32_16x16x32_bf16 v[204:207], a[108:111], a[48:51], v[204:207]
  v_mfma_f32_16x16x32_bf16 v[236:239], a[108:111], a[52:55], v[236:239]
  ds_read_b64_tr_b16 a[74:75], v20 offset:2048
  v_mfma_f32_16x16x32_bf16 a[140:143], a[108:111], a[56:59], a[140:143]
  v_mfma_f32_16x16x32_bf16 a[172:175], a[108:111], a[60:63], a[172:175]
  buffer_load_dwordx4 v28, s[12:15], s49 offen offset:0 lds
  ds_read_b64_tr_b16 a[76:77], v21 offset:0
  v_mfma_f32_16x16x32_bf16 v[80:83], a[112:115], a[32:35], v[80:83]
  v_mfma_f32_16x16x32_bf16 v[112:115], a[112:115], a[36:39], v[112:115]
  ds_read_b64_tr_b16 a[78:79], v21 offset:2048
  v_mfma_f32_16x16x32_bf16 v[144:147], a[112:115], a[40:43], v[144:147]
  v_mfma_f32_16x16x32_bf16 v[176:179], a[112:115], a[44:47], v[176:179]
  v_mfma_f32_16x16x32_bf16 v[208:211], a[112:115], a[48:51], v[208:211]
  ds_read_b64_tr_b16 a[80:81], v18 offset:8192
  v_mfma_f32_16x16x32_bf16 v[240:243], a[112:115], a[52:55], v[240:243]
  v_mfma_f32_16x16x32_bf16 a[144:147], a[112:115], a[56:59], a[144:147]
  ds_read_b64_tr_b16 a[82:83], v18 offset:10240
  v_mfma_f32_16x16x32_bf16 a[176:179], a[112:115], a[60:63], a[176:179]
  buffer_load_dwordx4 v29, s[12:15], s49 offen offset:1024 lds
  v_mfma_f32_16x16x32_bf16 v[84:87], a[116:119], a[32:35], v[84:87]
  ds_read_b64_tr_b16 a[84:85], v19 offset:8192
  v_mfma_f32_16x16x32_bf16 v[116:119], a[116:119], a[36:39], v[116:119]
  v_mfma_f32_16x16x32_bf16 v[148:151], a[116:119], a[40:43], v[148:151]
  ds_read_b64_tr_b16 a[86:87], v19 offset:10240
  v_mfma_f32_16x16x32_bf16 v[180:183], a[116:119], a[44:47], v[180:183]
  v_mfma_f32_16x16x32_bf16 v[212:215], a[116:119], a[48:51], v[212:215]
  v_mfma_f32_16x16x32_bf16 v[244:247], a[116:119], a[52:55], v[244:247]
  ds_read_b64_tr_b16 a[88:89], v20 offset:8192
  v_mfma_f32_16x16x32_bf16 a[148:151], a[116:119], a[56:59], a[148:151]
  v_mfma_f32_16x16x32_bf16 a[180:183], a[116:119], a[60:63], a[180:183]
  buffer_load_dwordx4 v30, s[12:15], s49 offen offset:2048 lds
  ds_read_b64_tr_b16 a[90:91], v20 offset:10240
  v_mfma_f32_16x16x32_bf16 v[88:91], a[120:123], a[32:35], v[88:91]
  v_mfma_f32_16x16x32_bf16 v[120:123], a[120:123], a[36:39], v[120:123]
  ds_read_b64_tr_b16 a[92:93], v21 offset:8192
  v_mfma_f32_16x16x32_bf16 v[152:155], a[120:123], a[40:43], v[152:155]
  v_mfma_f32_16x16x32_bf16 v[184:187], a[120:123], a[44:47], v[184:187]
  ds_read_b64_tr_b16 a[94:95], v21 offset:10240
  v_mfma_f32_16x16x32_bf16 v[216:219], a[120:123], a[48:51], v[216:219]
  v_mfma_f32_16x16x32_bf16 v[248:251], a[120:123], a[52:55], v[248:251]
  v_mfma_f32_16x16x32_bf16 a[152:155], a[120:123], a[56:59], a[152:155]
  v_mfma_f32_16x16x32_bf16 a[184:187], a[120:123], a[60:63], a[184:187]
  buffer_load_dwordx4 v31, s[12:15], s49 offen offset:3072 lds
  v_mfma_f32_16x16x32_bf16 v[92:95], a[124:127], a[32:35], v[92:95]
  s_add_u32 s49, s49, 524288
  v_mfma_f32_16x16x32_bf16 v[124:127], a[124:127], a[36:39], v[124:127]
  v_mfma_f32_16x16x32_bf16 v[156:159], a[124:127], a[40:43], v[156:159]
  v_mfma_f32_16x16x32_bf16 v[188:191], a[124:127], a[44:47], v[188:191]
  v_mfma_f32_16x16x32_bf16 v[220:223], a[124:127], a[48:51], v[220:223]
  v_mfma_f32_16x16x32_bf16 v[252:255], a[124:127], a[52:55], v[252:255]
  v_mfma_f32_16x16x32_bf16 a[156:159], a[124:127], a[56:59], a[156:159]
  v_mfma_f32_16x16x32_bf16 a[188:191], a[124:127], a[60:63], a[188:191]
  s_waitcnt lgkmcnt(0)
  v_mfma_f32_16x16x32_bf16 v[64:67], a[64:67], a[0:3], v[64:67]
  s_add_u32 s36, s36, s38
  s_add_u32 s37, s37, 1
  ds_read_b128 a[32:35], v17 offset:0
  v_mfma_f32_16x16x32_bf16 v[96:99], a[64:67], a[4:7], v[96:99]
  s_cmp_eq_u32 s37, 3
  s_cselect_b32 s37, 0, s37
  s_cselect_b32 s38, s39, s40
  v_mfma_f32_16x16x32_bf16 v[128:131], a[64:67], a[8:11], v[128:131]
  s_add_u32 s41, s41, s43
  s_sub_u32 s43, 0, s43
  ds_read_b64_tr_b16 a[96:97], v18 offset:4096
  v_mfma_f32_16x16x32_bf16 v[160:163], a[64:67], a[12:15], v[160:163]
  v_mfma_f32_16x16x32_bf16 v[192:195], a[64:67], a[16:19], v[192:195]
  ds_read_b64_tr_b16 a[98:99], v18 offset:6144
  v_mfma_f32_16x16x32_bf16 v[224:227], a[64:67], a[20:23], v[224:227]
  v_mfma_f32_16x16x32_bf16 a[128:131], a[64:67], a[24:27], a[128:131]
  ds_read_b128 a[36:39], v17 offset:2048
  v_mfma_f32_16x16x32_bf16 a[160:163], a[64:67], a[28:31], a[160:163]
  v_mfma_f32_16x16x32_bf16 v[68:71], a[68:71], a[0:3], v[68:71]
  v_mfma_f32_16x16x32_bf16 v[100:103], a[68:71], a[4:7], v[100:103]
  ds_read_b128 a[40:43], v17 offset:4096
  v_mfma_f32_16x16x32_bf16 v[132:135], a[68:71], a[8:11], v[132:135]
  v_mfma_f32_16x16x32_bf16 v[164:167], a[68:71], a[12:15], v[164:167]
  ds_read_b128 a[44:47], v17 offset:6144
  v_mfma_f32_16x16x32_bf16 v[196:199], a[68:71], a[16:19], v[196:199]
  v_mfma_f32_16x16x32_bf16 v[228:231], a[68:71], a[20:23], v[228:231]
  ds_read_b128 a[48:51], v17 offset:8192
  v_mfma_f32_16x16x32_bf16 a[132:135], a[68:71], a[24:27], a[132:135]
  v_mfma_f32_16x16x32_bf16 a[164:167], a[68:71], a[28:31], a[164:167]
  ds_read_b128 a[52:55], v17 offset:10240
  v_mfma_f32_16x16x32_bf16 v[72:75], a[72:75], a[0:3], v[72:75]
  v_mfma_f32_16x16x32_bf16 v[104:107], a[72:75], a[4:7], v[104:107]
  v_mfma_f32_16x16x32_bf16 v[136:139], a[72:75], a[8:11], v[136:139]
  ds_read_b128 a[56:59], v17 offset:12288
  v_mfma_f32_16x16x32_bf16 v[168:171], a[72:75], a[12:15], v[168:171]
  v_mfma_f32_16x16x32_bf16 v[200:203], a[72:75], a[16:19], v[200:203]
  ds_read_b128 a[60:63], v17 offset:14336
  v_mfma_f32_16x16x32_bf16 v[232:235], a[72:75], a[20:23], v[232:235]
  v_mfma_f32_16x16x32_bf16 a[136:139], a[72:75], a[24:27], a[136:139]
  ds_read_b64_tr_b16 a[100:101], v19 offset:4096
  v_mfma_f32_16x16x32_bf16 a[168:171], a[72:75], a[28:31], a[168:171]
  v_mfma_f32_16x16x32_bf16 v[76:79], a[76:79], a[0:3], v[76:79]
  ds_read_b64_tr_b16 a[102:103], v19 offset:6144
  v_mfma_f32_16x16x32_bf16 v[108:111], a[76:79], a[4:7], v[108:111]
  v_mfma_f32_16x16x32_bf16 v[140:143], a[76:79], a[8:11], v[140:143]
  v_mfma_f32_16x16x32_bf16 v[172:175], a[76:79], a[12:15], v[172:175]
  ds_read_b64_tr_b16 a[104:105], v20 offset:4096
  v_mfma_f32_16x16x32_bf16 v[204:207], a[76:79], a[16:19], v[204:207]
  v_mfma_f32_16x16x32_bf16 v[236:239], a[76:79], a[20:23], v[236:239]
  ds_read_b64_tr_b16 a[106:107], v20 offset:6144
  v_mfma_f32_16x16x32_bf16 a[140:143], a[76:79], a[24:27], a[140:143]
  v_mfma_f32_16x16x32_bf16 a[172:175], a[76:79], a[28:31], a[172:175]
  ds_read_b64_tr_b16 a[108:109], v21 offset:4096
  v_mfma_f32_16x16x32_bf16 v[80:83], a[80:83], a[0:3], v[80:83]
  v_mfma_f32_16x16x32_bf16 v[112:115], a[80:83], a[4:7], v[112:115]
  ds_read_b64_tr_b16 a[110:111], v21 offset:6144
  v_mfma_f32_16x16x32_bf16 v[144:147], a[80:83], a[8:11], v[144:147]
  v_mfma_f32_16x16x32_bf16 v[176:179], a[80:83], a[12:15], v[176:179]
  v_mfma_f32_16x16x32_bf16 v[208:211], a[80:83], a[16:19], v[208:211]
  ds_read_b64_tr_b16 a[112:113], v18 offset:12288
  v_mfma_f32_16x16x32_bf16 v[240:243], a[80:83], a[20:23], v[240:243]
  v_mfma_f32_16x16x32_bf16 a[144:147], a[80:83], a[24:27], a[144:147]
  ds_read_b64_tr_b16 a[114:115], v18 offset:14336
  v_mfma_f32_16x16x32_bf16 a[176:179], a[80:83], a[28:31], a[176:179]
  v_mfma_f32_16x16x32_bf16 v[84:87], a[84:87], a[0:3], v[84:87]
  ds_read_b64_tr_b16 a[116:117], v19 offset:12288
  v_mfma_f32_16x16x32_bf16 v[116:119], a[84:87], a[4:7], v[116:119]
  v_mfma_f32_16x16x32_bf16 v[148:151], a[84:87], a[8:11], v[148:151]
  ds_read_b64_tr_b16 a[118:119], v19 offset:14336
  v_mfma_f32_16x16x32_bf16 v[180:183], a[84:87], a[12:15], v[180:183]
  v_mfma_f32_16x16x32_bf16 v[212:215], a[84:87], a[16:19], v[212:215]
  v_mfma_f32_16x16x32_bf16 v[244:247], a[84:87], a[20:23], v[244:247]
  ds_read_b64_tr_b16 a[120:121], v20 offset:12288
  v_mfma_f32_16x16x32_bf16 a[148:151], a[84:87], a[24:27], a[148:151]
  v_mfma_f32_16x16x32_bf16 a[180:183], a[84:87], a[28:31], a[180:183]
  ds_read_b64_tr_b16 a[122:123], v20 offset:14336
  v_mfma_f32_16x16x32_bf16 v[88:91], a[88:91], a[0:3], v[88:91]
  v_mfma_f32_16x16x32_bf16 v[120:123], a[88:91], a[4:7], v[120:123]
  ds_read_b64_tr_b16 a[124:125], v21 offset:12288
  v_mfma_f32_16x16x32_bf16 v[152:155], a[88:91], a[8:11], v[152:155]
  v_mfma_f32_16x16x32_bf16 v[184:187], a[88:91], a[12:15], v[184:187]
  ds_read_b64_tr_b16 a[126:127], v21 offset:14336
  v_mfma_f32_16x16x32_bf16 v[216:219], a[88:91], a[16:19], v[216:219]
  v_add_u32 v16, s38, v16
  v_add_u32 v17, s38, v17
  v_mfma_f32_16x16x32_bf16 v[248:251], a[88:91], a[20:23], v[248:251]
  v_add_u32 v18, s43, v18
  v_add_u32 v19, s43, v19
  v_mfma_f32_16x16x32_bf16 a[152:155], a[88:91], a[24:27], a[152:155]
  v_add_u32 v20, s43, v20
  v_add_u32 v21, s43, v21
  v_mfma_f32_16x16x32_bf16 a[184:187], a[88:91], a[28:31], a[184:187]
  v_mfma_f32_16x16x32_bf16 v[92:95], a[92:95], a[0:3], v[92:95]
  v_mfma_f32_16x16x32_bf16 v[124:127], a[92:95], a[4:7], v[124:127]
  v_mfma_f32_16x16x32_bf16 v[156:159], a[92:95], a[8:11], v[156:159]
  v_mfma_f32_16x16x32_bf16 v[188:191], a[92:95], a[12:15], v[188:191]
  v_mfma_f32_16x16x32_bf16 v[220:223], a[92:95], a[16:19], v[220:223]
  v_mfma_f32_16x16x32_bf16 v[252:255], a[92:95], a[20:23], v[252:255]
  v_mfma_f32_16x16x32_bf16 a[156:159], a[92:95], a[24:27], a[156:159]
  v_mfma_f32_16x16x32_bf16 a[188:191], a[92:95], a[28:31], a[188:191]
  s_waitcnt vmcnt(0) lgkmcnt(0)
  s_barrier
  v_mfma_f32_16x16x32_bf16 v[64:67], a[96:99], a[32:35], v[64:67]
  ds_read_b128 a[0:3], v16 offset:0
  v_mfma_f32_16x16x32_bf16 v[96:99], a[96:99], a[36:39], v[96:99]
  v_mfma_f32_16x16x32_bf16 v[128:131], a[96:99], a[40:43], v[128:131]
  ds_read_b64_tr_b16 a[64:65], v18 offset:0
  v_mfma_f32_16x16x32_bf16 v[160:163], a[96:99], a[44:47], v[160:163]
  v_mfma_f32_16x16x32_bf16 v[192:195], a[96:99], a[48:51], v[192:195]
  ds_read_b64_tr_b16 a[66:67], v18 offset:2048
  v_mfma_f32_16x16x32_bf16 v[224:227], a[96:99], a[52:55], v[224:227]
  v_mfma_f32_16x16x32_bf16 a[128:131], a[96:99], a[56:59], a[128:131]
  ds_read_b128 a[4:7], v16 offset:2048
  v_mfma_f32_16x16x32_bf16 a[160:163], a[96:99], a[60:63], a[160:163]
  v_mfma_f32_16x16x32_bf16 v[68:71], a[100:103], a[32:35], v[68:71]
  v_mfma_f32_16x16x32_bf16 v[100:103], a[100:103], a[36:39], v[100:103]
  ds_read_b128 a[8:11], v16 offset:4096
  v_mfma_f32_16x16x32_bf16 v[132:135], a[100:103], a[40:43], v[132:135]
  v_mfma_f32_16x16x32_bf16 v[164:167], a[100:103], a[44:47], v[164:167]
  ds_read_b128 a[12:15], v16 offset:6144
  v_mfma_f32_16x16x32_bf16 v[196:199], a[100:103], a[48:51], v[196:199]
  v_mfma_f32_16x16x32_bf16 v[228:231], a[100:103], a[52:55], v[228:231]
  ds_read_b128 a[16:19], v16 offset:8192
  v_mfma_f32_16x16x32_bf16 a[132:135], a[100:103], a[56:59], a[132:135]
  v_mfma_f32_16x16x32_bf16 a[164:167], a[100:103], a[60:63], a[164:167]
  ds_read_b128 a[20:23], v16 offset:10240
  v_mfma_f32_16x16x32_bf16 v[72:75], a[104:107], a[32:35], v[72:75]
  v_mfma_f32_16x16x32_bf16 v[104:107], a[104:107], a[36:39], v[104:107]
  v_mfma_f32_16x16x32_bf16 v[136:139], a[104:107], a[40:43], v[136:139]
  ds_read_b128 a[24:27], v16 offset:12288
  v_mfma_f32_16x16x32_bf16 v[168:171], a[104:107], a[44:47], v[168:171]
  v_mfma_f32_16x16x32_bf16 v[200:203], a[104:107], a[48:51], v[200:203]
  ds_read_b128 a[28:31], v16 offset:14336
  v_mfma_f32_16x16x32_bf16 v[232:235], a[104:107], a[52:55], v[232:235]
  v_mfma_f32_16x16x32_bf16 a[136:139], a[104:107], a[56:59], a[136:139]
  ds_read_b64_tr_b16 a[68:69], v19 offset:0
  v_mfma_f32_16x16x32_bf16 a[168:171], a[104:107], a[60:63], a[168:171]
  v_mfma_f32_16x16x32_bf16 v[76:79], a[108:111], a[32:35], v[76:79]
  ds_read_b64_tr_b16 a[70:71], v19 offset:2048
  v_mfma_f32_16x16x32_bf16 v[108:111], a[108:111], a[36:39], v[108:111]
  v_mfma_f32_16x16x32_bf16 v[140:143], a[108:111], a[40:43], v[140:143]
  v_mfma_f32_16x16x32_bf16 v[172:175], a[108:111], a[44:47], v[172:175]
  ds_read_b64_tr_b16 a[72:73], v20 offset:0
  v_mfma_f32_16x16x32_bf16 v[204:207], a[108:111], a[48:51], v[204:207]
  v_mfma_f32_16x16x32_bf16 v[236:239], a[108:111], a[52:55], v[236:239]
  ds_read_b64_tr_b16 a[74:75], v20 offset:2048
  v_mfma_f32_16x16x32_bf16 a[140:143], a[108:111], a[56:59], a[140:143]
  v_mfma_f32_16x16x32_bf16 a[172:175], a[108:111], a[60:63], a[172:175]
  ds_read_b64_tr_b16 a[76:77], v21 offset:0
  v_mfma_f32_16x16x32_bf16 v[80:83], a[112:115], a[32:35], v[80:83]
  v_mfma_f32_16x16x32_bf16 v[112:115], a[112:115], a[36:39], v[112:115]
  ds_read_b64_tr_b16 a[78:79], v21 offset:2048
  v_mfma_f32_16x16x32_bf16 v[144:147], a[112:115], a[40:43], v[144:147]
  v_mfma_f32_16x16x32_bf16 v[176:179], a[112:115], a[44:47], v[176:179]
  v_mfma_f32_16x16x32_bf16 v[208:211], a[112:115], a[48:51], v[208:211]
  ds_read_b64_tr_b16 a[80:81], v18 offset:8192
  v_mfma_f32_16x16x32_bf16 v[240:243], a[112:115], a[52:55], v[240:243]
  v_mfma_f32_16x16x32_bf16 a[144:147], a[112:115], a[56:59], a[144:147]
  ds_read_b64_tr_b16 a[82:83], v18 offset:10240
  v_mfma_f32_16x16x32_bf16 a[176:179], a[112:115], a[60:63], a[176:179]
  v_mfma_f32_16x16x32_bf16 v[84:87], a[116:119], a[32:35], v[84:87]
  ds_read_b64_tr_b16 a[84:85], v19 offset:8192
  v_mfma_f32_16x16x32_bf16 v[116:119], a[116:119], a[36:39], v[116:119]
  v_mfma_f32_16x16x32_bf16 v[148:151], a[116:119], a[40:43], v[148:151]
  ds_read_b64_tr_b16 a[86:87], v19 offset:10240
  v_mfma_f32_16x16x32_bf16 v[180:183], a[116:119], a[44:47], v[180:183]
  v_mfma_f32_16x16x32_bf16 v[212:215], a[116:119], a[48:51], v[212:215]
  v_mfma_f32_16x16x32_bf16 v[244:247], a[116:119], a[52:55], v[244:247]
  ds_read_b64_tr_b16 a[88:89], v20 offset:8192
  v_mfma_f32_16x16x32_bf16 a[148:151], a[116:119], a[56:59], a[148:151]
  v_mfma_f32_16x16x32_bf16 a[180:183], a[116:119], a[60:63], a[180:183]
  ds_read_b64_tr_b16 a[90:91], v20 offset:10240
  v_mfma_f32_16x16x32_bf16 v[88:91], a[120:123], a[32:35], v[88:91]
  v_mfma_f32_16x16x32_bf16 v[120:123], a[120:123], a[36:39], v[120:123]
  ds_read_b64_tr_b16 a[92:93], v21 offset:8192
  v_mfma_f32_16x16x32_bf16 v[152:155], a[120:123], a[40:43], v[152:155]
  v_mfma_f32_16x16x32_bf16 v[184:187], a[120:123], a[44:47], v[184:187]
  ds_read_b64_tr_b16 a[94:95], v21 offset:10240
  v_mfma_f32_16x16x32_bf16 v[216:219], a[120:123], a[48:51], v[216:219]
  v_mfma_f32_16x16x32_bf16 v[248:251], a[120:123], a[52:55], v[248:251]
  v_mfma_f32_16x16x32_bf16 a[152:155], a[120:123], a[56:59], a[152:155]
  v_mfma_f32_16x16x32_bf16 a[184:187], a[120:123], a[60:63], a[184:187]
  v_mfma_f32_16x16x32_bf16 v[92:95], a[124:127], a[32:35], v[92:95]
  v_mfma_f32_16x16x32_bf16 v[124:127], a[124:127], a[36:39], v[124:127]
  v_mfma_f32_16x16x32_bf16 v[156:159], a[124:127], a[40:43], v[156:159]
  v_mfma_f32_16x16x32_bf16 v[188:191], a[124:127], a[44:47], v[188:191]
  v_mfma_f32_16x16x32_bf16 v[220:223], a[124:127], a[48:51], v[220:223]
  v_mfma_f32_16x16x32_bf16 v[252:255], a[124:127], a[52:55], v[252:255]
  v_mfma_f32_16x16x32_bf16 a[156:159], a[124:127], a[56:59], a[156:159]
  v_mfma_f32_16x16x32_bf16 a[188:191], a[124:127], a[60:63], a[188:191]
  s_waitcnt lgkmcnt(0)
  v_mfma_f32_16x16x32_bf16 v[64:67], a[64:67], a[0:3], v[64:67]
  ds_read_b128 a[32:35], v17 offset:0
  v_mfma_f32_16x16x32_bf16 v[96:99], a[64:67], a[4:7], v[96:99]
  v_mfma_f32_16x16x32_bf16 v[128:131], a[64:67], a[8:11], v[128:131]
  ds_read_b64_tr_b16 a[96:97], v18 offset:4096
  v_mfma_f32_16x16x32_bf16 v[160:163], a[64:67], a[12:15], v[160:163]
  v_mfma_f32_16x16x32_bf16 v[192:195], a[64:67], a[16:19], v[192:195]
  ds_read_b64_tr_b16 a[98:99], v18 offset:6144
  v_mfma_f32_16x16x32_bf16 v[224:227], a[64:67], a[20:23], v[224:227]
  v_mfma_f32_16x16x32_bf16 a[128:131], a[64:67], a[24:27], a[128:131]
  ds_read_b128 a[36:39], v17 offset:2048
  v_mfma_f32_16x16x32_bf16 a[160:163], a[64:67], a[28:31], a[160:163]
  v_mfma_f32_16x16x32_bf16 v[68:71], a[68:71], a[0:3], v[68:71]
  v_mfma_f32_16x16x32_bf16 v[100:103], a[68:71], a[4:7], v[100:103]
  ds_read_b128 a[40:43], v17 offset:4096
  v_mfma_f32_16x16x32_bf16 v[132:135], a[68:71], a[8:11], v[132:135]
  v_mfma_f32_16x16x32_bf16 v[164:167], a[68:71], a[12:15], v[164:167]
  ds_read_b128 a[44:47], v17 offset:6144
  v_mfma_f32_16x16x32_bf16 v[196:199], a[68:71], a[16:19], v[196:199]
  v_mfma_f32_16x16x32_bf16 v[228:231], a[68:71], a[20:23], v[228:231]
  ds_read_b128 a[48:51], v17 offset:8192
  v_mfma_f32_16x16x32_bf16 a[132:135], a[68:71], a[24:27], a[132:135]
  v_mfma_f32_16x16x32_bf16 a[164:167], a[68:71], a[28:31], a[164:167]
  ds_read_b128 a[52:55], v17 offset:10240
  v_mfma_f32_16x16x32_bf16 v[72:75], a[72:75], a[0:3], v[72:75]
  v_mfma_f32_16x16x32_bf16 v[104:107], a[72:75], a[4:7], v[104:107]
  v_mfma_f32_16x16x32_bf16 v[136:139], a[72:75], a[8:11], v[136:139]
  ds_read_b128 a[56:59], v17 offset:12288
  v_mfma_f32_16x16x32_bf16 v[168:171], a[72:75], a[12:15], v[168:171]
  v_mfma_f32_16x16x32_bf16 v[200:203], a[72:75], a[16:19], v[200:203]
  ds_read_b128 a[60:63], v17 offset:14336
  v_mfma_f32_16x16x32_bf16 v[232:235], a[72:75], a[20:23], v[232:235]
  v_mfma_f32_16x16x32_bf16 a[136:139], a[72:75], a[24:27], a[136:139]
  ds_read_b64_tr_b16 a[100:101], v19 offset:4096
  v_mfma_f32_16x16x32_bf16 a[168:171], a[72:75], a[28:31], a[168:171]
  v_mfma_f32_16x16x32_bf16 v[76:79], a[76:79], a[0:3], v[76:79]
  ds_read_b64_tr_b16 a[102:103], v19 offset:6144
  v_mfma_f32_16x16x32_bf16 v[108:111], a[76:79], a[4:7], v[108:111]
  v_mfma_f32_16x16x32_bf16 v[140:143], a[76:79], a[8:11], v[140:143]
  v_mfma_f32_16x16x32_bf16 v[172:175], a[76:79], a[12:15], v[172:175]
  ds_read_b64_tr_b16 a[104:105], v20 offset:4096
  v_mfma_f32_16x16x32_bf16 v[204:207], a[76:79], a[16:19], v[204:207]
  v_mfma_f32_16x16x32_bf16 v[236:239], a[76:79], a[20:23], v[236:239]
  ds_read_b64_tr_b16 a[106:107], v20 offset:6144
  v_mfma_f32_16x16x32_bf16 a[140:143], a[76:79], a[24:27], a[140:143]
  v_mfma_f32_16x16x32_bf16 a[172:175], a[76:79], a[28:31], a[172:175]
  ds_read_b64_tr_b16 a[108:109], v21 offset:4096
  v_mfma_f32_16x16x32_bf16 v[80:83], a[80:83], a[0:3], v[80:83]
  v_mfma_f32_16x16x32_bf16 v[112:115], a[80:83], a[4:7], v[112:115]
  ds_read_b64_tr_b16 a[110:111], v21 offset:6144
  v_mfma_f32_16x16x32_bf16 v[144:147], a[80:83], a[8:11], v[144:147]
  v_mfma_f32_16x16x32_bf16 v[176:179], a[80:83], a[12:15], v[176:179]
  v_mfma_f32_16x16x32_bf16 v[208:211], a[80:83], a[16:19], v[208:211]
  ds_read_b64_tr_b16 a[112:113], v18 offset:12288
  v_mfma_f32_16x16x32_bf16 v[240:243], a[80:83], a[20:23], v[240:243]
  v_mfma_f32_16x16x32_bf16 a[144:147], a[80:83], a[24:27], a[144:147]
  ds_read_b64_tr_b16 a[114:115], v18 offset:14336
  v_mfma_f32_16x16x32_bf16 a[176:179], a[80:83], a[28:31], a[176:179]
  v_mfma_f32_16x16x32_bf16 v[84:87], a[84:87], a[0:3], v[84:87]
  ds_read_b64_tr_b16 a[116:117], v19 offset:12288
  v_mfma_f32_16x16x32_bf16 v[116:119], a[84:87], a[4:7], v[116:119]
  v_mfma_f32_16x16x32_bf16 v[148:151], a[84:87], a[8:11], v[148:151]
  ds_read_b64_tr_b16 a[118:119], v19 offset:14336
  v_mfma_f32_16x16x32_bf16 v[180:183], a[84:87], a[12:15], v[180:183]
  v_mfma_f32_16x16x32_bf16 v[212:215], a[84:87], a[16:19], v[212:215]
  v_mfma_f32_16x16x32_bf16 v[244:247], a[84:87], a[20:23], v[244:247]
  ds_read_b64_tr_b16 a[120:121], v20 offset:12288
  v_mfma_f32_16x16x32_bf16 a[148:151], a[84:87], a[24:27], a[148:151]
  v_mfma_f32_16x16x32_bf16 a[180:183], a[84:87], a[28:31], a[180:183]
  ds_read_b64_tr_b16 a[122:123], v20 offset:14336
  v_mfma_f32_16x16x32_bf16 v[88:91], a[88:91], a[0:3], v[88:91]
  v_mfma_f32_16x16x32_bf16 v[120:123], a[88:91], a[4:7], v[120:123]
  ds_read_b64_tr_b16 a[124:125], v21 offset:12288
  v_mfma_f32_16x16x32_bf16 v[152:155], a[88:91], a[8:11], v[152:155]
  v_mfma_f32_16x16x32_bf16 v[184:187], a[88:91], a[12:15], v[184:187]
  ds_read_b64_tr_b16 a[126:127], v21 offset:14336
  v_mfma_f32_16x16x32_bf16 v[216:219], a[88:91], a[16:19], v[216:219]
  v_mfma_f32_16x16x32_bf16 v[248:251], a[88:91], a[20:23], v[248:251]
  v_mfma_f32_16x16x32_bf16 a[152:155], a[88:91], a[24:27], a[152:155]
  v_mfma_f32_16x16x32_bf16 a[184:187], a[88:91], a[28:31], a[184:187]
  v_mfma_f32_16x16x32_bf16 v[92:95], a[92:95], a[0:3], v[92:95]
  v_mfma_f32_16x16x32_bf16 v[124:127], a[92:95], a[4:7], v[124:127]
  v_mfma_f32_16x16x32_bf16 v[156:159], a[92:95], a[8:11], v[156:159]
  v_mfma_f32_16x16x32_bf16 v[188:191], a[92:95], a[12:15], v[188:191]
  v_mfma_f32_16x16x32_bf16 v[220:223], a[92:95], a[16:19], v[220:223]
  v_mfma_f32_16x16x32_bf16 v[252:255], a[92:95], a[20:23], v[252:255]
  v_mfma_f32_16x16x32_bf16 a[156:159], a[92:95], a[24:27], a[156:159]
  v_mfma_f32_16x16x32_bf16 a[188:191], a[92:95], a[28:31], a[188:191]
  s_waitcnt lgkmcnt(0)
  s_barrier
  v_mfma_f32_16x16x32_bf16 v[64:67], a[96:99], a[32:35], v[64:67]
  v_mfma_f32_16x16x32_bf16 v[96:99], a[96:99], a[36:39], v[96:99]
  v_mfma_f32_16x16x32_bf16 v[128:131], a[96:99], a[40:43], v[128:131]
  v_mfma_f32_16x16x32_bf16 v[160:163], a[96:99], a[44:47], v[160:163]
  v_mfma_f32_16x16x32_bf16 v[192:195], a[96:99], a[48:51], v[192:195]
  v_mfma_f32_16x16x32_bf16 v[224:227], a[96:99], a[52:55], v[224:227]
  v_mfma_f32_16x16x32_bf16 a[128:131], a[96:99], a[56:59], a[128:131]
  v_mfma_f32_16x16x32_bf16 a[160:163], a[96:99], a[60:63], a[160:163]
  v_mfma_f32_16x16x32_bf16 v[68:71], a[100:103], a[32:35], v[68:71]
  v_mfma_f32_16x16x32_bf16 v[100:103], a[100:103], a[36:39], v[100:103]
  v_mfma_f32_16x16x32_bf16 v[132:135], a[100:103], a[40:43], v[132:135]
  v_mfma_f32_16x16x32_bf16 v[164:167], a[100:103], a[44:47], v[164:167]
  v_mfma_f32_16x16x32_bf16 v[196:199], a[100:103], a[48:51], v[196:199]
  v_mfma_f32_16x16x32_bf16 v[228:231], a[100:103], a[52:55], v[228:231]
  v_mfma_f32_16x16x32_bf16 a[132:135], a[100:103], a[56:59], a[132:135]
  v_mfma_f32_16x16x32_bf16 a[164:167], a[100:103], a[60:63], a[164:167]
  v_mfma_f32_16x16x32_bf16 v[72:75], a[104:107], a[32:35], v[72:75]
  v_mfma_f32_16x16x32_bf16 v[104:107], a[104:107], a[36:39], v[104:107]
  v_mfma_f32_16x16x32_bf16 v[136:139], a[104:107], a[40:43], v[136:139]
  v_mfma_f32_16x16x32_bf16 v[168:171], a[104:107], a[44:47], v[168:171]
  v_mfma_f32_16x16x32_bf16 v[200:203], a[104:107], a[48:51], v[200:203]
  v_mfma_f32_16x16x32_bf16 v[232:235], a[104:107], a[52:55], v[232:235]
  v_mfma_f32_16x16x32_bf16 a[136:139], a[104:107], a[56:59], a[136:139]
  v_mfma_f32_16x16x32_bf16 a[168:171], a[104:107], a[60:63], a[168:171]
  v_mfma_f32_16x16x32_bf16 v[76:79], a[108:111], a[32:35], v[76:79]
  v_mfma_f32_16x16x32_bf16 v[108:111], a[108:111], a[36:39], v[108:111]
  v_mfma_f32_16x16x32_bf16 v[140:143], a[108:111], a[40:43], v[140:143]
  v_mfma_f32_16x16x32_bf16 v[172:175], a[108:111], a[44:47], v[172:175]
  v_mfma_f32_16x16x32_bf16 v[204:207], a[108:111], a[48:51], v[204:207]
  v_mfma_f32_16x16x32_bf16 v[236:239], a[108:111], a[52:55], v[236:239]
  v_mfma_f32_16x16x32_bf16 a[140:143], a[108:111], a[56:59], a[140:143]
  v_mfma_f32_16x16x32_bf16 a[172:175], a[108:111], a[60:63], a[172:175]
  v_mfma_f32_16x16x32_bf16 v[80:83], a[112:115], a[32:35], v[80:83]
  v_mfma_f32_16x16x32_bf16 v[112:115], a[112:115], a[36:39], v[112:115]
  v_mfma_f32_16x16x32_bf16 v[144:147], a[112:115], a[40:43], v[144:147]
  v_mfma_f32_16x16x32_bf16 v[176:179], a[112:115], a[44:47], v[176:179]
  v_mfma_f32_16x16x32_bf16 v[208:211], a[112:115], a[48:51], v[208:211]
  v_mfma_f32_16x16x32_bf16 v[240:243], a[112:115], a[52:55], v[240:243]
  v_mfma_f32_16x16x32_bf16 a[144:147], a[112:115], a[56:59], a[144:147]
  v_mfma_f32_16x16x32_bf16 a[176:179], a[112:115], a[60:63], a[176:179]
  v_mfma_f32_16x16x32_bf16 v[84:87], a[116:119], a[32:35], v[84:87]
  v_mfma_f32_16x16x32_bf16 v[116:119], a[116:119], a[36:39], v[116:119]
  v_mfma_f32_16x16x32_bf16 v[148:151], a[116:119], a[40:43], v[148:151]
  v_mfma_f32_16x16x32_bf16 v[180:183], a[116:119], a[44:47], v[180:183]
  v_mfma_f32_16x16x32_bf16 v[212:215], a[116:119], a[48:51], v[212:215]
  v_mfma_f32_16x16x32_bf16 v[244:247], a[116:119], a[52:55], v[244:247]
  v_mfma_f32_16x16x32_bf16 a[148:151], a[116:119], a[56:59], a[148:151]
  v_mfma_f32_16x16x32_bf16 a[180:183], a[116:119], a[60:63], a[180:183]
  v_mfma_f32_16x16x32_bf16 v[88:91], a[120:123], a[32:35], v[88:91]
  v_mfma_f32_16x16x32_bf16 v[120:123], a[120:123], a[36:39], v[120:123]
  v_mfma_f32_16x16x32_bf16 v[152:155], a[120:123], a[40:43], v[152:155]
  v_mfma_f32_16x16x32_bf16 v[184:187], a[120:123], a[44:47], v[184:187]
  v_mfma_f32_16x16x32_bf16 v[216:219], a[120:123], a[48:51], v[216:219]
  v_mfma_f32_16x16x32_bf16 v[248:251], a[120:123], a[52:55], v[248:251]
  v_mfma_f32_16x16x32_bf16 a[152:155], a[120:123], a[56:59], a[152:155]
  v_mfma_f32_16x16x32_bf16 a[184:187], a[120:123], a[60:63], a[184:187]
  v_mfma_f32_16x16x32_bf16 v[92:95], a[124:127], a[32:35], v[92:95]
  v_mfma_f32_16x16x32_bf16 v[124:127], a[124:127], a[36:39], v[124:127]
  v_mfma_f32_16x16x32_bf16 v[156:159], a[124:127], a[40:43], v[156:159]
  v_mfma_f32_16x16x32_bf16 v[188:191], a[124:127], a[44:47], v[188:191]
  v_mfma_f32_16x16x32_bf16 v[220:223], a[124:127], a[48:51], v[220:223]
  v_mfma_f32_16x16x32_bf16 v[252:255], a[124:127], a[52:55], v[252:255]
  v_mfma_f32_16x16x32_bf16 a[156:159], a[124:127], a[56:59], a[156:159]
  v_mfma_f32_16x16x32_bf16 a[188:191], a[124:127], a[60:63], a[188:191]
  s_cmp_lt_u32 s2, 128
  s_cbranch_scc1 Lp1_qe
  s_mov_b32 s8, s66
  s_mov_b32 s9, s67
  s_mov_b32 s10, 2097152
  s_mov_b32 s11, 0x00020000
  s_mov_b32 s12, s72
  s_mov_b32 s13, s73
  s_mov_b32 s14, 4194304
  s_mov_b32 s15, 0x00020000
  s_mul_i32 s46, s50, 262144
  s_add_u32 s47, s46, 32768
  s_lshl_b32 s48, s51, 9
  s_add_u32 s49, s48, 262144
  s_lshl_b32 s36, s3, 13
  s_add_u32 s41, s36, 98304
  s_mov_b32 s53, 8
  s_mov_b32 m0, s36
  s_nop 0
  buffer_load_dwordx4 v24, s[8:11], s46 offen offset:0 lds
  buffer_load_dwordx4 v25, s[8:11], s46 offen offset:1024 lds
  buffer_load_dwordx4 v26, s[8:11], s46 offen offset:2048 lds
  buffer_load_dwordx4 v27, s[8:11], s46 offen offset:3072 lds
  s_add_u32 s46, s46, 128
  s_add_u32 m0, s36, 4096
  s_nop 0
  buffer_load_dwordx4 v24, s[8:11], s47 offen offset:0 lds
  buffer_load_dwordx4 v25, s[8:11], s47 offen offset:1024 lds
  buffer_load_dwordx4 v26, s[8:11], s47 offen offset:2048 lds
  buffer_load_dwordx4 v27, s[8:11], s47 offen offset:3072 lds
  s_add_u32 s47, s47, 128
  s_mov_b32 m0, s41
  s_nop 0
  buffer_load_dwordx4 v28, s[12:15], s48 offen offset:0 lds
  buffer_load_dwordx4 v29, s[12:15], s48 offen offset:1024 lds
  buffer_load_dwordx4 v30, s[12:15], s48 offen offset:2048 lds
  buffer_load_dwordx4 v31, s[12:15], s48 offen offset:3072 lds
  s_add_u32 s48, s48, 524288
  s_add_u32 m0, s41, 4096
  s_nop 0
  buffer_load_dwordx4 v28, s[12:15], s49 offen offset:0 lds
  buffer_load_dwordx4 v29, s[12:15], s49 offen offset:1024 lds
  buffer_load_dwordx4 v30, s[12:15], s49 offen offset:2048 lds
  buffer_load_dwordx4 v31, s[12:15], s49 offen offset:3072 lds
  s_add_u32 s49, s49, 524288
  s_add_u32 m0, s36, 32768
  s_nop 0
  buffer_load_dwordx4 v24, s[8:11], s46 offen offset:0 lds
  buffer_load_dwordx4 v25, s[8:11], s46 offen offset:1024 lds
  buffer_load_dwordx4 v26, s[8:11], s46 offen offset:2048 lds
  buffer_load_dwordx4 v27, s[8:11], s46 offen offset:3072 lds
  s_add_u32 s46, s46, 128
  s_add_u32 m0, s36, 36864
  s_nop 0
  buffer_load_dwordx4 v24, s[8:11], s47 offen offset:0 lds
  buffer_load_dwordx4 v25, s[8:11], s47 offen offset:1024 lds
  buffer_load_dwordx4 v26, s[8:11], s47 offen offset:2048 lds
  buffer_load_dwordx4 v27, s[8:11], s47 offen offset:3072 lds
  s_add_u32 s47, s47, 128
  s_add_u32 m0, s41, 32768
  s_nop 0
  buffer_load_dwordx4 v28, s[12:15], s48 offen offset:0 lds
  buffer_load_dwordx4 v29, s[12:15], s48 offen offset:1024 lds
  buffer_load_dwordx4 v30, s[12:15], s48 offen offset:2048 lds
  buffer_load_dwordx4 v31, s[12:15], s48 offen offset:3072 lds
  s_add_u32 s48, s48, 524288
  s_add_u32 m0, s41, 36864
  s_nop 0
  buffer_load_dwordx4 v28, s[12:15], s49 offen offset:0 lds
  buffer_load_dwordx4 v29, s[12:15], s49 offen offset:1024 lds
  buffer_load_dwordx4 v30, s[12:15], s49 offen offset:2048 lds
  buffer_load_dwordx4 v31, s[12:15], s49 offen offset:3072 lds
  s_add_u32 s49, s49, 524288
  s_add_u32 m0, s36, 65536
  s_nop 0
  buffer_load_dwordx4 v24, s[8:11], s46 offen offset:0 lds
  buffer_load_dwordx4 v25, s[8:11], s46 offen offset:1024 lds
  buffer_load_dwordx4 v26, s[8:11], s46 offen offset:2048 lds
  buffer_load_dwordx4 v27, s[8:11], s46 offen offset:3072 lds
  s_add_u32 s46, s46, 128
  s_add_u32 m0, s36, 69632
  s_nop 0
  buffer_load_dwordx4 v24, s[8:11], s47 offen offset:0 lds
  buffer_load_dwordx4 v25, s[8:11], s47 offen offset:1024 lds
  buffer_load_dwordx4 v26, s[8:11], s47 offen offset:2048 lds
  buffer_load_dwordx4 v27, s[8:11], s47 offen offset:3072 lds
  s_add_u32 s47, s47, 128
  s_and_b32 s4, s3, 1
  s_lshl_b32 s5, s51, 1
  s_add_u32 s4, s4, s5
  s_lshr_b32 s5, s3, 1
  s_lshl_b32 s6, s50, 1
  s_add_u32 s5, s5, s6
  s_add_u32 s16, s86, 16777216
  s_addc_u32 s17, s87, 0
  s_mov_b32 s18, 33554432
  s_mov_b32 s19, 0x00020000
  s_lshl_b32 s4, s4, 20
  s_lshl_b32 s5, s5, 16
  s_add_u32 s4, s4, s5
  v_cvt_pk_bf16_f32 v64, v64, v65
  v_cvt_pk_bf16_f32 v65, v66, v67
  v_cvt_pk_bf16_f32 v66, v68, v69
  v_cvt_pk_bf16_f32 v67, v70, v71
  buffer_store_dwordx4 v[64:67], v2, s[16:19], s4 offen offset:0
  v_cvt_pk_bf16_f32 v72, v72, v73
  v_cvt_pk_bf16_f32 v73, v74, v75
  v_cvt_pk_bf16_f32 v74, v76, v77
  v_cvt_pk_bf16_f32 v75, v78, v79
  buffer_store_dwordx4 v[72:75], v2, s[16:19], s4 offen offset:1024
  v_cvt_pk_bf16_f32 v80, v80, v81
  v_cvt_pk_bf16_f32 v81, v82, v83
  v_cvt_pk_bf16_f32 v82, v84, v85
  v_cvt_pk_bf16_f32 v83, v86, v87
  buffer_store_dwordx4 v[80:83], v2, s[16:19], s4 offen offset:2048
  v_cvt_pk_bf16_f32 v88, v88, v89
  v_cvt_pk_bf16_f32 v89, v90, v91
  v_cvt_pk_bf16_f32 v90, v92, v93
  v_cvt_pk_bf16_f32 v91, v94, v95
  buffer_store_dwordx4 v[88:91], v2, s[16:19], s4 offen offset:3072
  s_add_u32 s4, s4, 4096
  v_cvt_pk_bf16_f32 v96, v96, v97
  v_cvt_pk_bf16_f32 v97, v98, v99
  v_cvt_pk_bf16_f32 v98, v100, v101
  v_cvt_pk_bf16_f32 v99, v102, v103
  buffer_store_dwordx4 v[96:99], v2, s[16:19], s4 offen offset:0
  v_cvt_pk_bf16_f32 v104, v104, v105
  v_cvt_pk_bf16_f32 v105, v106, v107
  v_cvt_pk_bf16_f32 v106, v108, v109
  v_cvt_pk_bf16_f32 v107, v110, v111
  buffer_store_dwordx4 v[104:107], v2, s[16:19], s4 offen offset:1024
  v_cvt_pk_bf16_f32 v112, v112, v113
  v_cvt_pk_bf16_f32 v113, v114, v115
  v_cvt_pk_bf16_f32 v114, v116, v117
  v_cvt_pk_bf16_f32 v115, v118, v119
  buffer_store_dwordx4 v[112:115], v2, s[16:19], s4 offen offset:2048
  v_cvt_pk_bf16_f32 v120, v120, v121
  v_cvt_pk_bf16_f32 v121, v122, v123
  v_cvt_pk_bf16_f32 v122, v124, v125
  v_cvt_pk_bf16_f32 v123, v126, v127
  buffer_store_dwordx4 v[120:123], v2, s[16:19], s4 offen offset:3072
  s_add_u32 s4, s4, 4096
  v_cvt_pk_bf16_f32 v128, v128, v129
  v_cvt_pk_bf16_f32 v129, v130, v131
  v_cvt_pk_bf16_f32 v130, v132, v133
  v_cvt_pk_bf16_f32 v131, v134, v135
  buffer_store_dwordx4 v[128:131], v2, s[16:19], s4 offen offset:0
  v_cvt_pk_bf16_f32 v136, v136, v137
  v_cvt_pk_bf16_f32 v137, v138, v139
  v_cvt_pk_bf16_f32 v138, v140, v141
  v_cvt_pk_bf16_f32 v139, v142, v143
  buffer_store_dwordx4 v[136:139], v2, s[16:19], s4 offen offset:1024
  v_cvt_pk_bf16_f32 v144, v144, v145
  v_cvt_pk_bf16_f32 v145, v146, v147
  v_cvt_pk_bf16_f32 v146, v148, v149
  v_cvt_pk_bf16_f32 v147, v150, v151
  buffer_store_dwordx4 v[144:147], v2, s[16:19], s4 offen offset:2048
  v_cvt_pk_bf16_f32 v152, v152, v153
  v_cvt_pk_bf16_f32 v153, v154, v155
  v_cvt_pk_bf16_f32 v154, v156, v157
  v_cvt_pk_bf16_f32 v155, v158, v159
  buffer_store_dwordx4 v[152:155], v2, s[16:19], s4 offen offset:3072
  s_add_u32 s4, s4, 4096
  v_cvt_pk_bf16_f32 v160, v160, v161
  v_cvt_pk_bf16_f32 v161, v162, v163
  v_cvt_pk_bf16_f32 v162, v164, v165
  v_cvt_pk_bf16_f32 v163, v166, v167
  buffer_store_dwordx4 v[160:163], v2, s[16:19], s4 offen offset:0
  v_cvt_pk_bf16_f32 v168, v168, v169
  v_cvt_pk_bf16_f32 v169, v170, v171
  v_cvt_pk_bf16_f32 v170, v172, v173
  v_cvt_pk_bf16_f32 v171, v174, v175
  buffer_store_dwordx4 v[168:171], v2, s[16:19], s4 offen offset:1024
  v_cvt_pk_bf16_f32 v176, v176, v177
  v_cvt_pk_bf16_f32 v177, v178, v179
  v_cvt_pk_bf16_f32 v178, v180, v181
  v_cvt_pk_bf16_f32 v179, v182, v183
  buffer_store_dwordx4 v[176:179], v2, s[16:19], s4 offen offset:2048
  v_cvt_pk_bf16_f32 v184, v184, v185
  v_cvt_pk_bf16_f32 v185, v186, v187
  v_cvt_pk_bf16_f32 v186, v188, v189
  v_cvt_pk_bf16_f32 v187, v190, v191
  buffer_store_dwordx4 v[184:187], v2, s[16:19], s4 offen offset:3072
  s_add_u32 s4, s4, 20480
  v_cvt_pk_bf16_f32 v192, v192, v193
  v_cvt_pk_bf16_f32 v193, v194, v195
  v_cvt_pk_bf16_f32 v194, v196, v197
  v_cvt_pk_bf16_f32 v195, v198, v199
  buffer_store_dwordx4 v[192:195], v2, s[16:19], s4 offen offset:0
  v_cvt_pk_bf16_f32 v200, v200, v201
  v_cvt_pk_bf16_f32 v201, v202, v203
  v_cvt_pk_bf16_f32 v202, v204, v205
  v_cvt_pk_bf16_f32 v203, v206, v207
  buffer_store_dwordx4 v[200:203], v2, s[16:19], s4 offen offset:1024
  v_cvt_pk_bf16_f32 v208, v208, v209
  v_cvt_pk_bf16_f32 v209, v210, v211
  v_cvt_pk_bf16_f32 v210, v212, v213
  v_cvt_pk_bf16_f32 v211, v214, v215
  buffer_store_dwordx4 v[208:211], v2, s[16:19], s4 offen offset:2048
  v_cvt_pk_bf16_f32 v216, v216, v217
  v_cvt_pk_bf16_f32 v217, v218, v219
  v_cvt_pk_bf16_f32 v218, v220, v221
  v_cvt_pk_bf16_f32 v219, v222, v223
  buffer_store_dwordx4 v[216:219], v2, s[16:19], s4 offen offset:3072
  s_add_u32 s4, s4, 4096
  v_cvt_pk_bf16_f32 v224, v224, v225
  v_cvt_pk_bf16_f32 v225, v226, v227
  v_cvt_pk_bf16_f32 v226, v228, v229
  v_cvt_pk_bf16_f32 v227, v230, v231
  buffer_store_dwordx4 v[224:227], v2, s[16:19], s4 offen offset:0
  v_cvt_pk_bf16_f32 v232, v232, v233
  v_cvt_pk_bf16_f32 v233, v234, v235
  v_cvt_pk_bf16_f32 v234, v236, v237
  v_cvt_pk_bf16_f32 v235, v238, v239
  buffer_store_dwordx4 v[232:235], v2, s[16:19], s4 offen offset:1024
  v_cvt_pk_bf16_f32 v240, v240, v241
  v_cvt_pk_bf16_f32 v241, v242, v243
  v_cvt_pk_bf16_f32 v242, v244, v245
  v_cvt_pk_bf16_f32 v243, v246, v247
  buffer_store_dwordx4 v[240:243], v2, s[16:19], s4 offen offset:2048
  v_cvt_pk_bf16_f32 v248, v248, v249
  v_cvt_pk_bf16_f32 v249, v250, v251
  v_cvt_pk_bf16_f32 v250, v252, v253
  v_cvt_pk_bf16_f32 v251, v254, v255
  buffer_store_dwordx4 v[248:251], v2, s[16:19], s4 offen offset:3072
  s_add_u32 s4, s4, 4096
  v_accvgpr_read_b32 v32, a128
  v_accvgpr_read_b32 v33, a129
  v_accvgpr_read_b32 v34, a130
  v_accvgpr_read_b32 v35, a131
  v_accvgpr_read_b32 v36, a132
  v_accvgpr_read_b32 v37, a133
  v_accvgpr_read_b32 v38, a134
  v_accvgpr_read_b32 v39, a135
  v_cvt_pk_bf16_f32 v48, v32, v33
  v_cvt_pk_bf16_f32 v49, v34, v35
  v_cvt_pk_bf16_f32 v50, v36, v37
  v_cvt_pk_bf16_f32 v51, v38, v39
  buffer_store_dwordx4 v[48:51], v2, s[16:19], s4 offen offset:0
  v_accvgpr_read_b32 v40, a136
  v_accvgpr_read_b32 v41, a137
  v_accvgpr_read_b32 v42, a138
  v_accvgpr_read_b32 v43, a139
  v_accvgpr_read_b32 v44, a140
  v_accvgpr_read_b32 v45, a141
  v_accvgpr_read_b32 v46, a142
  v_accvgpr_read_b32 v47, a143
  v_cvt_pk_bf16_f32 v52, v40, v41
  v_cvt_pk_bf16_f32 v53, v42, v43
  v_cvt_pk_bf16_f32 v54, v44, v45
  v_cvt_pk_bf16_f32 v55, v46, v47
  buffer_store_dwordx4 v[52:55], v2, s[16:19], s4 offen offset:1024
  v_accvgpr_read_b32 v32, a144
  v_accvgpr_read_b32 v33, a145
  v_accvgpr_read_b32 v34, a146
  v_accvgpr_read_b32 v35, a147
  v_accvgpr_read_b32 v36, a148
  v_accvgpr_read_b32 v37, a149
  v_accvgpr_read_b32 v38, a150
  v_accvgpr_read_b32 v39, a151
  v_cvt_pk_bf16_f32 v56, v32, v33
  v_cvt_pk_bf16_f32 v57, v34, v35
  v_cvt_pk_bf16_f32 v58, v36, v37
  v_cvt_pk_bf16_f32 v59, v38, v39
  buffer_store_dwordx4 v[56:59], v2, s[16:19], s4 offen offset:2048
  v_accvgpr_read_b32 v40, a152
  v_accvgpr_read_b32 v41, a153
  v_accvgpr_read_b32 v42, a154
  v_accvgpr_read_b32 v43, a155
  v_accvgpr_read_b32 v44, a156
  v_accvgpr_read_b32 v45, a157
  v_accvgpr_read_b32 v46, a158
  v_accvgpr_read_b32 v47, a159
  v_cvt_pk_bf16_f32 v60, v40, v41
  v_cvt_pk_bf16_f32 v61, v42, v43
  v_cvt_pk_bf16_f32 v62, v44, v45
  v_cvt_pk_bf16_f32 v63, v46, v47
  buffer_store_dwordx4 v[60:63], v2, s[16:19], s4 offen offset:3072
  s_add_u32 s4, s4, 4096
  v_accvgpr_read_b32 v32, a160
  v_accvgpr_read_b32 v33, a161
  v_accvgpr_read_b32 v34, a162
  v_accvgpr_read_b32 v35, a163
  v_accvgpr_read_b32 v36, a164
  v_accvgpr_read_b32 v37, a165
  v_accvgpr_read_b32 v38, a166
  v_accvgpr_read_b32 v39, a167
  v_cvt_pk_bf16_f32 v48, v32, v33
  v_cvt_pk_bf16_f32 v49, v34, v35
  v_cvt_pk_bf16_f32 v50, v36, v37
  v_cvt_pk_bf16_f32 v51, v38, v39
  buffer_store_dwordx4 v[48:51], v2, s[16:19], s4 offen offset:0
  v_accvgpr_read_b32 v40, a168
  v_accvgpr_read_b32 v41, a169
  v_accvgpr_read_b32 v42, a170
  v_accvgpr_read_b32 v43, a171
  v_accvgpr_read_b32 v44, a172
  v_accvgpr_read_b32 v45, a173
  v_accvgpr_read_b32 v46, a174
  v_accvgpr_read_b32 v47, a175
  v_cvt_pk_bf16_f32 v52, v40, v41
  v_cvt_pk_bf16_f32 v53, v42, v43
  v_cvt_pk_bf16_f32 v54, v44, v45
  v_cvt_pk_bf16_f32 v55, v46, v47
  buffer_store_dwordx4 v[52:55], v2, s[16:19], s4 offen offset:1024
  v_accvgpr_read_b32 v32, a176
  v_accvgpr_read_b32 v33, a177
  v_accvgpr_read_b32 v34, a178
  v_accvgpr_read_b32 v35, a179
  v_accvgpr_read_b32 v36, a180
  v_accvgpr_read_b32 v37, a181
  v_accvgpr_read_b32 v38, a182
  v_accvgpr_read_b32 v39, a183
  v_cvt_pk_bf16_f32 v56, v32, v33
  v_cvt_pk_bf16_f32 v57, v34, v35
  v_cvt_pk_bf16_f32 v58, v36, v37
  v_cvt_pk_bf16_f32 v59, v38, v39
  buffer_store_dwordx4 v[56:59], v2, s[16:19], s4 offen offset:2048
  v_accvgpr_read_b32 v40, a184
  v_accvgpr_read_b32 v41, a185
  v_accvgpr_read_b32 v42, a186
  v_accvgpr_read_b32 v43, a187
  v_accvgpr_read_b32 v44, a188
  v_accvgpr_read_b32 v45, a189
  v_accvgpr_read_b32 v46, a190
  v_accvgpr_read_b32 v47, a191
  v_cvt_pk_bf16_f32 v60, v40, v41
  v_cvt_pk_bf16_f32 v61, v42, v43
  v_cvt_pk_bf16_f32 v62, v44, v45
  v_cvt_pk_bf16_f32 v63, v46, v47
  buffer_store_dwordx4 v[60:63], v2, s[16:19], s4 offen offset:3072
  s_lshr_b32 s4, s3, 1
  s_lshl_b32 s4, s4, 14
  v_and_b32 v32, 15, v1
  v_lshlrev_b32 v32, 7, v32
  v_lshrrev_b32 v33, 4, v1
  v_and_b32 v34, 6, v1
  v_xor_b32 v33, v33, v34
  v_lshl_add_u32 v32, v33, 4, v32
  v_add_u32 v16, s4, v32
  v_xor_b32 v17, 64, v16
  s_and_b32 s4, s3, 1
  s_lshl_b32 s4, s4, 14
  s_add_u32 s4, s4, 98304
  v_lshrrev_b32 v32, 2, v1
  v_and_b32 v33, 6, v32
  v_lshlrev_b32 v32, 7, v32
  v_and_b32 v34, 1, v1
  v_lshl_add_u32 v32, v34, 3, v32
  v_add_u32 v32, s4, v32
  v_bfe_u32 v34, v1, 1, 1
  v_xor_b32 v33, v33, v34
  v_xor_b32 v34, 0, v33
  v_lshl_add_u32 v18, v34, 4, v32
  v_xor_b32 v34, 2, v33
  v_lshl_add_u32 v19, v34, 4, v32
  v_xor_b32 v34, 4, v33
  v_lshl_add_u32 v20, v34, 4, v32
  v_xor_b32 v34, 6, v33
  v_lshl_add_u32 v21, v34, 4, v32
  s_mov_b32 s37, 0
  s_mov_b32 s39, 4294901760
  s_mov_b32 s40, 32768
  s_mov_b32 s42, 0
  s_mov_b32 s44, 4294934528
  s_mov_b32 s45, 32768
  s_mov_b32 s43, s44
  s_waitcnt vmcnt(56)
  s_barrier
  ds_read_b128 a[0:3], v16 offset:0
  ds_read_b64_tr_b16 a[64:65], v18 offset:0
  ds_read_b64_tr_b16 a[66:67], v18 offset:2048
  ds_read_b128 a[4:7], v16 offset:2048
  ds_read_b128 a[8:11], v16 offset:4096
  ds_read_b128 a[12:15], v16 offset:6144
  ds_read_b128 a[16:19], v16 offset:8192
  ds_read_b128 a[20:23], v16 offset:10240
  ds_read_b128 a[24:27], v16 offset:12288
  ds_read_b128 a[28:31], v16 offset:14336
  ds_read_b64_tr_b16 a[68:69], v19 offset:0
  ds_read_b64_tr_b16 a[70:71], v19 offset:2048
  ds_read_b64_tr_b16 a[72:73], v20 offset:0
  ds_read_b64_tr_b16 a[74:75], v20 offset:2048
  ds_read_b64_tr_b16 a[76:77], v21 offset:0
  ds_read_b64_tr_b16 a[78:79], v21 offset:2048
  ds_read_b64_tr_b16 a[80:81], v18 offset:8192
  ds_read_b64_tr_b16 a[82:83], v18 offset:10240
  ds_read_b64_tr_b16 a[84:85], v19 offset:8192
  ds_read_b64_tr_b16 a[86:87], v19 offset:10240
  ds_read_b64_tr_b16 a[88:89], v20 offset:8192
  ds_read_b64_tr_b16 a[90:91], v20 offset:10240
  ds_read_b64_tr_b16 a[92:93], v21 offset:8192
  ds_read_b64_tr_b16 a[94:95], v21 offset:10240
  s_waitcnt lgkmcnt(0)
  v_mfma_f32_16x16x32_bf16 v[64:67], a[0:3], a[64:67], 0
  s_add_u32 s37, s37, 1
  s_cmp_eq_u32 s37, 3
  s_cselect_b32 s37, 0, s37
  s_cselect_b32 s38, s39, s40
  ds_read_b128 a[32:35], v17 offset:0
  v_mfma_f32_16x16x32_bf16 v[96:99], a[4:7], a[64:67], 0
  s_sub_u32 s43, 0, s43
  v_mfma_f32_16x16x32_bf16 v[128:131], a[8:11], a[64:67], 0
  ds_read_b64_tr_b16 a[96:97], v18 offset:4096
  v_mfma_f32_16x16x32_bf16 v[160:163], a[12:15], a[64:67], 0
  v_mfma_f32_16x16x32_bf16 v[192:195], a[16:19], a[64:67], 0
  ds_read_b64_tr_b16 a[98:99], v18 offset:6144
  v_mfma_f32_16x16x32_bf16 v[224:227], a[20:23], a[64:67], 0
  v_mfma_f32_16x16x32_bf16 a[128:131], a[24:27], a[64:67], 0
  ds_read_b128 a[36:39], v17 offset:2048
  v_mfma_f32_16x16x32_bf16 a[160:163], a[28:31], a[64:67], 0
  v_mfma_f32_16x16x32_bf16 v[68:71], a[0:3], a[68:71], 0
  v_mfma_f32_16x16x32_bf16 v[100:103], a[4:7], a[68:71], 0
  ds_read_b128 a[40:43], v17 offset:4096
  v_mfma_f32_16x16x32_bf16 v[132:135], a[8:11], a[68:71], 0
  v_mfma_f32_16x16x32_bf16 v[164:167], a[12:15], a[68:71], 0
  ds_read_b128 a[44:47], v17 offset:6144
  v_mfma_f32_16x16x32_bf16 v[196:199], a[16:19], a[68:71], 0
  v_mfma_f32_16x16x32_bf16 v[228:231], a[20:23], a[68:71], 0
  ds_read_b128 a[48:51], v17 offset:8192
  v_mfma_f32_16x16x32_bf16 a[132:135], a[24:27], a[68:71], 0
  v_mfma_f32_16x16x32_bf16 a[164:167], a[28:31], a[68:71], 0
  ds_read_b128 a[52:55], v17 offset:10240
  v_mfma_f32_16x16x32_bf16 v[72:75], a[0:3], a[72:75], 0
  v_mfma_f32_16x16x32_bf16 v[104:107], a[4:7], a[72:75], 0
  v_mfma_f32_16x16x32_bf16 v[136:139], a[8:11], a[72:75], 0
  ds_read_b128 a[56:59], v17 offset:12288
  v_mfma_f32_16x16x32_bf16 v[168:171], a[12:15], a[72:75], 0
  v_mfma_f32_16x16x32_bf16 v[200:203], a[16:19], a[72:75], 0
  ds_read_b128 a[60:63], v17 offset:14336
  v_mfma_f32_16x16x32_bf16 v[232:235], a[20:23], a[72:75], 0
  v_mfma_f32_16x16x32_bf16 a[136:139], a[24:27], a[72:75], 0
  ds_read_b64_tr_b16 a[100:101], v19 offset:4096
  v_mfma_f32_16x16x32_bf16 a[168:171], a[28:31], a[72:75], 0
  v_mfma_f32_16x16x32_bf16 v[76:79], a[0:3], a[76:79], 0
  ds_read_b64_tr_b16 a[102:103], v19 offset:6144
  v_mfma_f32_16x16x32_bf16 v[108:111], a[4:7], a[76:79], 0
  v_mfma_f32_16x16x32_bf16 v[140:143], a[8:11], a[76:79], 0
  v_mfma_f32_16x16x32_bf16 v[172:175], a[12:15], a[76:79], 0
  ds_read_b64_tr_b16 a[104:105], v20 offset:4096
  v_mfma_f32_16x16x32_bf16 v[204:207], a[16:19], a[76:79], 0
  v_mfma_f32_16x16x32_bf16 v[236:239], a[20:23], a[76:79], 0
  ds_read_b64_tr_b16 a[106:107], v20 offset:6144
  v_mfma_f32_16x16x32_bf16 a[140:143], a[24:27], a[76:79], 0
  v_mfma_f32_16x16x32_bf16 a[172:175], a[28:31], a[76:79], 0
  ds_read_b64_tr_b16 a[108:109], v21 offset:4096
  v_mfma_f32_16x16x32_bf16 v[80:83], a[0:3], a[80:83], 0
  v_mfma_f32_16x16x32_bf16 v[112:115], a[4:7], a[80:83], 0
  ds_read_b64_tr_b16 a[110:111], v21 offset:6144
  v_mfma_f32_16x16x32_bf16 v[144:147], a[8:11], a[80:83], 0
  v_mfma_f32_16x16x32_bf16 v[176:179], a[12:15], a[80:83], 0
  v_mfma_f32_16x16x32_bf16 v[208:211], a[16:19], a[80:83], 0
  ds_read_b64_tr_b16 a[112:113], v18 offset:12288
  v_mfma_f32_16x16x32_bf16 v[240:243], a[20:23], a[80:83], 0
  v_mfma_f32_16x16x32_bf16 a[144:147], a[24:27], a[80:83], 0
  ds_read_b64_tr_b16 a[114:115], v18 offset:14336
  v_mfma_f32_16x16x32_bf16 a[176:179], a[28:31], a[80:83], 0
  v_mfma_f32_16x16x32_bf16 v[84:87], a[0:3], a[84:87], 0
  ds_read_b64_tr_b16 a[116:117], v19 offset:12288
  v_mfma_f32_16x16x32_bf16 v[116:119], a[4:7], a[84:87], 0
  v_mfma_f32_16x16x32_bf16 v[148:151], a[8:11], a[84:87], 0
  ds_read_b64_tr_b16 a[118:119], v19 offset:14336
  v_mfma_f32_16x16x32_bf16 v[180:183], a[12:15], a[84:87], 0
  v_mfma_f32_16x16x32_bf16 v[212:215], a[16:19], a[84:87], 0
  v_mfma_f32_16x16x32_bf16 v[244:247], a[20:23], a[84:87], 0
  ds_read_b64_tr_b16 a[120:121], v20 offset:12288
  v_mfma_f32_16x16x32_bf16 a[148:151], a[24:27], a[84:87], 0
  v_mfma_f32_16x16x32_bf16 a[180:183], a[28:31], a[84:87], 0
  ds_read_b64_tr_b16 a[122:123], v20 offset:14336
  v_mfma_f32_16x16x32_bf16 v[88:91], a[0:3], a[88:91], 0
  v_mfma_f32_16x16x32_bf16 v[120:123], a[4:7], a[88:91], 0
  ds_read_b64_tr_b16 a[124:125], v21 offset:12288
  v_mfma_f32_16x16x32_bf16 v[152:155], a[8:11], a[88:91], 0
  v_mfma_f32_16x16x32_bf16 v[184:187], a[12:15], a[88:91], 0
  ds_read_b64_tr_b16 a[126:127], v21 offset:14336
  v_mfma_f32_16x16x32_bf16 v[216:219], a[16:19], a[88:91], 0
  v_add_u32 v16, s38, v16
  v_add_u32 v17, s38, v17
  v_mfma_f32_16x16x32_bf16 v[248:251], a[20:23], a[88:91], 0
  v_add_u32 v18, s43, v18
  v_add_u32 v19, s43, v19
  v_mfma_f32_16x16x32_bf16 a[152:155], a[24:27], a[88:91], 0
  v_add_u32 v20, s43, v20
  v_add_u32 v21, s43, v21
  v_mfma_f32_16x16x32_bf16 a[184:187], a[28:31], a[88:91], 0
  v_mfma_f32_16x16x32_bf16 v[92:95], a[0:3], a[92:95], 0
  v_mfma_f32_16x16x32_bf16 v[124:127], a[4:7], a[92:95], 0
  v_mfma_f32_16x16x32_bf16 v[156:159], a[8:11], a[92:95], 0
  v_mfma_f32_16x16x32_bf16 v[188:191], a[12:15], a[92:95], 0
  v_mfma_f32_16x16x32_bf16 v[220:223], a[16:19], a[92:95], 0
  v_mfma_f32_16x16x32_bf16 v[252:255], a[20:23], a[92:95], 0
  v_mfma_f32_16x16x32_bf16 a[156:159], a[24:27], a[92:95], 0
  v_mfma_f32_16x16x32_bf16 a[188:191], a[28:31], a[92:95], 0
  s_sub_u32 s35, s53, 3
  .p2align 6
Lp1xw_loop:
  s_waitcnt vmcnt(8) lgkmcnt(0)
  s_barrier
  v_mfma_f32_16x16x32_bf16 v[64:67], a[32:35], a[96:99], v[64:67]
  buffer_load_dwordx4 v[4:7], v2, s[56:59], s60 offen
  ds_read_b128 a[0:3], v16 offset:0
  v_mfma_f32_16x16x32_bf16 v[96:99], a[36:39], a[96:99], v[96:99]
  s_add_u32 s60, s60, 1024
  s_mov_b32 m0, s41
  v_mfma_f32_16x16x32_bf16 v[128:131], a[40:43], a[96:99], v[128:131]
  ds_read_b64_tr_b16 a[64:65], v18 offset:0
  v_mfma_f32_16x16x32_bf16 v[160:163], a[44:47], a[96:99], v[160:163]
  v_mfma_f32_16x16x32_bf16 v[192:195], a[48:51], a[96:99], v[192:195]
  ds_read_b64_tr_b16 a[66:67], v18 offset:2048
  v_mfma_f32_16x16x32_bf16 v[224:227], a[52:55], a[96:99], v[224:227]
  v_mfma_f32_16x16x32_bf16 a[128:131], a[56:59], a[96:99], a[128:131]
  ds_read_b128 a[4:7], v16 offset:2048
  v_mfma_f32_16x16x32_bf16 a[160:163], a[60:63], a[96:99], a[160:163]
  buffer_load_dwordx4 v28, s[12:15], s48 offen offset:0 lds
  v_mfma_f32_16x16x32_bf16 v[68:71], a[32:35], a[100:103], v[68:71]
  v_mfma_f32_16x16x32_bf16 v[100:103], a[36:39], a[100:103], v[100:103]
  ds_read_b128 a[8:11], v16 offset:4096
  v_mfma_f32_16x16x32_bf16 v[132:135], a[40:43], a[100:103], v[132:135]
  v_mfma_f32_16x16x32_bf16 v[164:167], a[44:47], a[100:103], v[164:167]
  ds_read_b128 a[12:15], v16 offset:6144
  v_mfma_f32_16x16x32_bf16 v[196:199], a[48:51], a[100:103], v[196:199]
  v_mfma_f32_16x16x32_bf16 v[228:231], a[52:55], a[100:103], v[228:231]
  ds_read_b128 a[16:19], v16 offset:8192
  v_mfma_f32_16x16x32_bf16 a[132:135], a[56:59], a[100:103], a[132:135]
  buffer_load_dwordx4 v29, s[12:15], s48 offen offset:1024 lds
  v_mfma_f32_16x16x32_bf16 a[164:167], a[60:63], a[100:103], a[164:167]
  ds_read_b128 a[20:23], v16 offset:10240
  v_mfma_f32_16x16x32_bf16 v[72:75], a[32:35], a[104:107], v[72:75]
  v_mfma_f32_16x16x32_bf16 v[104:107], a[36:39], a[104:107], v[104:107]
  v_mfma_f32_16x16x32_bf16 v[136:139], a[40:43], a[104:107], v[136:139]
  ds_read_b128 a[24:27], v16 offset:12288
  v_mfma_f32_16x16x32_bf16 v[168:171], a[44:47], a[104:107], v[168:171]
  v_mfma_f32_16x16x32_bf16 v[200:203], a[48:51], a[104:107], v[200:203]
  ds_read_b128 a[28:31], v16 offset:14336
  v_mfma_f32_16x16x32_bf16 v[232:235], a[52:55], a[104:107], v[232:235]
  buffer_load_dwordx4 v30, s[12:15], s48 offen offset:2048 lds
  v_mfma_f32_16x16x32_bf16 a[136:139], a[56:59], a[104:107], a[136:139]
  ds_read_b64_tr_b16 a[68:69], v19 offset:0
  v_mfma_f32_16x16x32_bf16 a[168:171], a[60:63], a[104:107], a[168:171]
  v_mfma_f32_16x16x32_bf16 v[76:79], a[32:35], a[108:111], v[76:79]
  ds_read_b64_tr_b16 a[70:71], v19 offset:2048
  v_mfma_f32_16x16x32_bf16 v[108:111], a[36:39], a[108:111], v[108:111]
  v_mfma_f32_16x16x32_bf16 v[140:143], a[40:43], a[108:111], v[140:143]
  v_mfma_f32_16x16x32_bf16 v[172:175], a[44:47], a[108:111], v[172:175]
  ds_read_b64_tr_b16 a[72:73], v20 offset:0
  v_mfma_f32_16x16x32_bf16 v[204:207], a[48:51], a[108:111], v[204:207]
  buffer_load_dwordx4 v31, s[12:15], s48 offen offset:3072 lds
  v_mfma_f32_16x16x32_bf16 v[236:239], a[52:55], a[108:111], v[236:239]
  s_add_u32 s48, s48, 524288
  s_add_u32 m0, s41, 4096
  ds_read_b64_tr_b16 a[74:75], v20 offset:2048
  v_mfma_f32_16x16x32_bf16 a[140:143], a[56:59], a[108:111], a[140:143]
  v_mfma_f32_16x16x32_bf16 a[172:175], a[60:63], a[108:111], a[172:175]
  ds_read_b64_tr_b16 a[76:77], v21 offset:0
  v_mfma_f32_16x16x32_bf16 v[80:83], a[32:35], a[112:115], v[80:83]
  v_mfma_f32_16x16x32_bf16 v[112:115], a[36:39], a[112:115], v[112:115]
  ds_read_b64_tr_b16 a[78:79], v21 offset:2048
  v_mfma_f32_16x16x32_bf16 v[144:147], a[40:43], a[112:115], v[144:147]
  v_mfma_f32_16x16x32_bf16 v[176:179], a[44:47], a[112:115], v[176:179]
  buffer_load_dwordx4 v28, s[12:15], s49 offen offset:0 lds
  v_mfma_f32_16x16x32_bf16 v[208:211], a[48:51], a[112:115], v[208:211]
  ds_read_b64_tr_b16 a[80:81], v18 offset:8192
  v_mfma_f32_16x16x32_bf16 v[240:243], a[52:55], a[112:115], v[240:243]
  v_mfma_f32_16x16x32_bf16 a[144:147], a[56:59], a[112:115], a[144:147]
  ds_read_b64_tr_b16 a[82:83], v18 offset:10240
  v_mfma_f32_16x16x32_bf16 a[176:179], a[60:63], a[112:115], a[176:179]
  v_mfma_f32_16x16x32_bf16 v[84:87], a[32:35], a[116:119], v[84:87]
  ds_read_b64_tr_b16 a[84:85], v19 offset:8192
  v_mfma_f32_16x16x32_bf16 v[116:119], a[36:39], a[116:119], v[116:119]
  v_mfma_f32_16x16x32_bf16 v[148:151], a[40:43], a[116:119], v[148:151]
  buffer_load_dwordx4 v29, s[12:15], s49 offen offset:1024 lds
  ds_read_b64_tr_b16 a[86:87], v19 offset:10240
  v_mfma_f32_16x16x32_bf16 v[180:183], a[44:47], a[116:119], v[180:183]
  v_mfma_f32_16x16x32_bf16 v[212:215], a[48:51], a[116:119], v[212:215]
  v_mfma_f32_16x16x32_bf16 v[244:247], a[52:55], a[116:119], v[244:247]
  ds_read_b64_tr_b16 a[88:89], v20 offset:8192
  v_mfma_f32_16x16x32_bf16 a[148:151], a[56:59], a[116:119], a[148:151]
  v_mfma_f32_16x16x32_bf16 a[180:183], a[60:63], a[116:119], a[180:183]
  ds_read_b64_tr_b16 a[90:91], v20 offset:10240
  v_mfma_f32_16x16x32_bf16 v[88:91], a[32:35], a[120:123], v[88:91]
  v_mfma_f32_16x16x32_bf16 v[120:123], a[36:39], a[120:123], v[120:123]
  buffer_load_dwordx4 v30, s[12:15], s49 offen offset:2048 lds
  ds_read_b64_tr_b16 a[92:93], v21 offset:8192
  v_mfma_f32_16x16x32_bf16 v[152:155], a[40:43], a[120:123], v[152:155]
  v_mfma_f32_16x16x32_bf16 v[184:187], a[44:47], a[120:123], v[184:187]
  ds_read_b64_tr_b16 a[94:95], v21 offset:10240
  v_mfma_f32_16x16x32_bf16 v[216:219], a[48:51], a[120:123], v[216:219]
  v_mfma_f32_16x16x32_bf16 v[248:251], a[52:55], a[120:123], v[248:251]
  v_mfma_f32_16x16x32_bf16 a[152:155], a[56:59], a[120:123], a[152:155]
  v_mfma_f32_16x16x32_bf16 a[184:187], a[60:63], a[120:123], a[184:187]
  v_mfma_f32_16x16x32_bf16 v[92:95], a[32:35], a[124:127], v[92:95]
  buffer_load_dwordx4 v31, s[12:15], s49 offen offset:3072 lds
  v_mfma_f32_16x16x32_bf16 v[124:127], a[36:39], a[124:127], v[124:127]
  s_add_u32 s49, s49, 524288
  v_mfma_f32_16x16x32_bf16 v[156:159], a[40:43], a[124:127], v[156:159]
  v_mfma_f32_16x16x32_bf16 v[188:191], a[44:47], a[124:127], v[188:191]
  v_mfma_f32_16x16x32_bf16 v[220:223], a[48:51], a[124:127], v[220:223]
  v_mfma_f32_16x16x32_bf16 v[252:255], a[52:55], a[124:127], v[252:255]
  v_mfma_f32_16x16x32_bf16 a[156:159], a[56:59], a[124:127], a[156:159]
  v_mfma_f32_16x16x32_bf16 a[188:191], a[60:63], a[124:127], a[188:191]
  s_waitcnt lgkmcnt(0)
  v_mfma_f32_16x16x32_bf16 v[64:67], a[0:3], a[64:67], v[64:67]
  s_mov_b32 m0, s36
  ds_read_b128 a[32:35], v17 offset:0
  v_mfma_f32_16x16x32_bf16 v[96:99], a[4:7], a[64:67], v[96:99]
  buffer_load_dwordx4 v24, s[8:11], s46 offen offset:0 lds
  v_mfma_f32_16x16x32_bf16 v[128:131], a[8:11], a[64:67], v[128:131]
  ds_read_b64_tr_b16 a[96:97], v18 offset:4096
  v_mfma_f32_16x16x32_bf16 v[160:163], a[12:15], a[64:67], v[160:163]
  v_mfma_f32_16x16x32_bf16 v[192:195], a[16:19], a[64:67], v[192:195]
  ds_read_b64_tr_b16 a[98:99], v18 offset:6144
  v_mfma_f32_16x16x32_bf16 v[224:227], a[20:23], a[64:67], v[224:227]
  v_mfma_f32_16x16x32_bf16 a[128:131], a[24:27], a[64:67], a[128:131]
  ds_read_b128 a[36:39], v17 offset:2048
  v_mfma_f32_16x16x32_bf16 a[160:163], a[28:31], a[64:67], a[160:163]
  buffer_load_dwordx4 v25, s[8:11], s46 offen offset:1024 lds
  v_mfma_f32_16x16x32_bf16 v[68:71], a[0:3], a[68:71], v[68:71]
  v_mfma_f32_16x16x32_bf16 v[100:103], a[4:7], a[68:71], v[100:103]
  ds_read_b128 a[40:43], v17 offset:4096
  v_mfma_f32_16x16x32_bf16 v[132:135], a[8:11], a[68:71], v[132:135]
  v_mfma_f32_16x16x32_bf16 v[164:167], a[12:15], a[68:71], v[164:167]
  ds_read_b128 a[44:47], v17 offset:6144
  v_mfma_f32_16x16x32_bf16 v[196:199], a[16:19], a[68:71], v[196:199]
  v_mfma_f32_16x16x32_bf16 v[228:231], a[20:23], a[68:71], v[228:231]
  ds_read_b128 a[48:51], v17 offset:8192
  v_mfma_f32_16x16x32_bf16 a[132:135], a[24:27], a[68:71], a[132:135]
  buffer_load_dwordx4 v26, s[8:11], s46 offen offset:2048 lds
  v_mfma_f32_16x16x32_bf16 a[164:167], a[28:31], a[68:71], a[164:167]
  ds_read_b128 a[52:55], v17 offset:10240
  v_mfma_f32_16x16x32_bf16 v[72:75], a[0:3], a[72:75], v[72:75]
  v_mfma_f32_16x16x32_bf16 v[104:107], a[4:7], a[72:75], v[104:107]
  v_mfma_f32_16x16x32_bf16 v[136:139], a[8:11], a[72:75], v[136:139]
  ds_read_b128 a[56:59], v17 offset:12288
  v_mfma_f32_16x16x32_bf16 v[168:171], a[12:15], a[72:75], v[168:171]
  v_mfma_f32_16x16x32_bf16 v[200:203], a[16:19], a[72:75], v[200:203]
  ds_read_b128 a[60:63], v17 offset:14336
  v_mfma_f32_16x16x32_bf16 v[232:235], a[20:23], a[72:75], v[232:235]
  buffer_load_dwordx4 v27, s[8:11], s46 offen offset:3072 lds
  v_mfma_f32_16x16x32_bf16 a[136:139], a[24:27], a[72:75], a[136:139]
  s_add_u32 s46, s46, 128
  s_add_u32 m0, s36, 4096
  ds_read_b64_tr_b16 a[100:101], v19 offset:4096
  v_mfma_f32_16x16x32_bf16 a[168:171], a[28:31], a[72:75], a[168:171]
  v_mfma_f32_16x16x32_bf16 v[76:79], a[0:3], a[76:79], v[76:79]
  ds_read_b64_tr_b16 a[102:103], v19 offset:6144
  v_mfma_f32_16x16x32_bf16 v[108:111], a[4:7], a[76:79], v[108:111]
  v_mfma_f32_16x16x32_bf16 v[140:143], a[8:11], a[76:79], v[140:143]
  v_mfma_f32_16x16x32_bf16 v[172:175], a[12:15], a[76:79], v[172:175]
  ds_read_b64_tr_b16 a[104:105], v20 offset:4096
  v_mfma_f32_16x16x32_bf16 v[204:207], a[16:19], a[76:79], v[204:207]
  buffer_load_dwordx4 v24, s[8:11], s47 offen offset:0 lds
  v_mfma_f32_16x16x32_bf16 v[236:239], a[20:23], a[76:79], v[236:239]
  ds_read_b64_tr_b16 a[106:107], v20 offset:6144
  v_mfma_f32_16x16x32_bf16 a[140:143], a[24:27], a[76:79], a[140:143]
  v_mfma_f32_16x16x32_bf16 a[172:175], a[28:31], a[76:79], a[172:175]
  ds_read_b64_tr_b16 a[108:109], v21 offset:4096
  v_mfma_f32_16x16x32_bf16 v[80:83], a[0:3], a[80:83], v[80:83]
  v_mfma_f32_16x16x32_bf16 v[112:115], a[4:7], a[80:83], v[112:115]
  ds_read_b64_tr_b16 a[110:111], v21 offset:6144
  v_mfma_f32_16x16x32_bf16 v[144:147], a[8:11], a[80:83], v[144:147]
  v_mfma_f32_16x16x32_bf16 v[176:179], a[12:15], a[80:83], v[176:179]
  buffer_load_dwordx4 v25, s[8:11], s47 offen offset:1024 lds
  v_mfma_f32_16x16x32_bf16 v[208:211], a[16:19], a[80:83], v[208:211]
  ds_read_b64_tr_b16 a[112:113], v18 offset:12288
  v_mfma_f32_16x16x32_bf16 v[240:243], a[20:23], a[80:83], v[240:243]
  v_mfma_f32_16x16x32_bf16 a[144:147], a[24:27], a[80:83], a[144:147]
  ds_read_b64_tr_b16 a[114:115], v18 offset:14336
  v_mfma_f32_16x16x32_bf16 a[176:179], a[28:31], a[80:83], a[176:179]
  v_mfma_f32_16x16x32_bf16 v[84:87], a[0:3], a[84:87], v[84:87]
  ds_read_b64_tr_b16 a[116:117], v19 offset:12288
  v_mfma_f32_16x16x32_bf16 v[116:119], a[4:7], a[84:87], v[116:119]
  v_mfma_f32_16x16x32_bf16 v[148:151], a[8:11], a[84:87], v[148:151]
  buffer_load_dwordx4 v26, s[8:11], s47 offen offset:2048 lds
  ds_read_b64_tr_b16 a[118:119], v19 offset:14336
  v_mfma_f32_16x16x32_bf16 v[180:183], a[12:15], a[84:87], v[180:183]
  v_mfma_f32_16x16x32_bf16 v[212:215], a[16:19], a[84:87], v[212:215]
  v_mfma_f32_16x16x32_bf16 v[244:247], a[20:23], a[84:87], v[244:247]
  ds_read_b64_tr_b16 a[120:121], v20 offset:12288
  v_mfma_f32_16x16x32_bf16 a[148:151], a[24:27], a[84:87], a[148:151]
  v_mfma_f32_16x16x32_bf16 a[180:183], a[28:31], a[84:87], a[180:183]
  ds_read_b64_tr_b16 a[122:123], v20 offset:14336
  v_mfma_f32_16x16x32_bf16 v[88:91], a[0:3], a[88:91], v[88:91]
  v_mfma_f32_16x16x32_bf16 v[120:123], a[4:7], a[88:91], v[120:123]
  buffer_load_dwordx4 v27, s[8:11], s47 offen offset:3072 lds
  ds_read_b64_tr_b16 a[124:125], v21 offset:12288
  v_mfma_f32_16x16x32_bf16 v[152:155], a[8:11], a[88:91], v[152:155]
  s_add_u32 s47, s47, 128
  v_mfma_f32_16x16x32_bf16 v[184:187], a[12:15], a[88:91], v[184:187]
  s_add_u32 s36, s36, s38
  s_add_u32 s37, s37, 1
  ds_read_b64_tr_b16 a[126:127], v21 offset:14336
  v_mfma_f32_16x16x32_bf16 v[216:219], a[16:19], a[88:91], v[216:219]
  s_cmp_eq_u32 s37, 3
  s_cselect_b32 s37, 0, s37
  s_cselect_b32 s38, s39, s40
  v_mfma_f32_16x16x32_bf16 v[248:251], a[20:23], a[88:91], v[248:251]
  s_add_u32 s41, s41, s43
  s_sub_u32 s43, 0, s43
  v_mfma_f32_16x16x32_bf16 a[152:155], a[24:27], a[88:91], a[152:155]
  v_add_u32 v16, s38, v16
  v_add_u32 v17, s38, v17
  v_mfma_f32_16x16x32_bf16 a[184:187], a[28:31], a[88:91], a[184:187]
  v_add_u32 v18, s43, v18
  v_add_u32 v19, s43, v19
  v_mfma_f32_16x16x32_bf16 v[92:95], a[0:3], a[92:95], v[92:95]
  v_add_u32 v20, s43, v20
  v_add_u32 v21, s43, v21
  v_mfma_f32_16x16x32_bf16 v[124:127], a[4:7], a[92:95], v[124:127]
  v_mfma_f32_16x16x32_bf16 v[156:159], a[8:11], a[92:95], v[156:159]
  v_mfma_f32_16x16x32_bf16 v[188:191], a[12:15], a[92:95], v[188:191]
  v_mfma_f32_16x16x32_bf16 v[220:223], a[16:19], a[92:95], v[220:223]
  v_mfma_f32_16x16x32_bf16 v[252:255], a[20:23], a[92:95], v[252:255]
  v_mfma_f32_16x16x32_bf16 a[156:159], a[24:27], a[92:95], a[156:159]
  s_sub_u32 s35, s35, 1
  v_mfma_f32_16x16x32_bf16 a[188:191], a[28:31], a[92:95], a[188:191]
  s_cmp_lg_u32 s35, 0
  s_cbranch_scc1 Lp1xw_loop
  s_waitcnt vmcnt(8) lgkmcnt(0)
  s_barrier
  v_mfma_f32_16x16x32_bf16 v[64:67], a[32:35], a[96:99], v[64:67]
  s_mov_b32 m0, s41
  ds_read_b128 a[0:3], v16 offset:0
  v_mfma_f32_16x16x32_bf16 v[96:99], a[36:39], a[96:99], v[96:99]
  buffer_load_dwordx4 v28, s[12:15], s48 offen offset:0 lds
  v_mfma_f32_16x16x32_bf16 v[128:131], a[40:43], a[96:99], v[128:131]
  ds_read_b64_tr_b16 a[64:65], v18 offset:0
  v_mfma_f32_16x16x32_bf16 v[160:163], a[44:47], a[96:99], v[160:163]
  v_mfma_f32_16x16x32_bf16 v[192:195], a[48:51], a[96:99], v[192:195]
  ds_read_b64_tr_b16 a[66:67], v18 offset:2048
  v_mfma_f32_16x16x32_bf16 v[224:227], a[52:55], a[96:99], v[224:227]
  v_mfma_f32_16x16x32_bf16 a[128:131], a[56:59], a[96:99], a[128:131]
  ds_read_b128 a[4:7], v16 offset:2048
  v_mfma_f32_16x16x32_bf16 a[160:163], a[60:63], a[96:99], a[160:163]
  buffer_load_dwordx4 v29, s[12:15], s48 offen offset:1024 lds
  v_mfma_f32_16x16x32_bf16 v[68:71], a[32:35], a[100:103], v[68:71]
  v_mfma_f32_16x16x32_bf16 v[100:103], a[36:39], a[100:103], v[100:103]
  ds_read_b128 a[8:11], v16 offset:4096
  v_mfma_f32_16x16x32_bf16 v[132:135], a[40:43], a[100:103], v[132:135]
  v_mfma_f32_16x16x32_bf16 v[164:167], a[44:47], a[100:103], v[164:167]
  ds_read_b128 a[12:15], v16 offset:6144
  v_mfma_f32_16x16x32_bf16 v[196:199], a[48:51], a[100:103], v[196:199]
  v_mfma_f32_16x16x32_bf16 v[228:231], a[52:55], a[100:103], v[228:231]
  ds_read_b128 a[16:19], v16 offset:8192
  v_mfma_f32_16x16x32_bf16 a[132:135], a[56:59], a[100:103], a[132:135]
  v_mfma_f32_16x16x32_bf16 a[164:167], a[60:63], a[100:103], a[164:167]
  buffer_load_dwordx4 v30, s[12:15], s48 offen offset:2048 lds
  ds_read_b128 a[20:23], v16 offset:10240
  v_mfma_f32_16x16x32_bf16 v[72:75], a[32:35], a[104:107], v[72:75]
  v_mfma_f32_16x16x32_bf16 v[104:107], a[36:39], a[104:107], v[104:107]
  v_mfma_f32_16x16x32_bf16 v[136:139], a[40:43], a[104:107], v[136:139]
  ds_read_b128 a[24:27], v16 offset:12288
  v_mfma_f32_16x16x32_bf16 v[168:171], a[44:47], a[104:107], v[168:171]
  v_mfma_f32_16x16x32_bf16 v[200:203], a[48:51], a[104:107], v[200:203]
  ds_read_b128 a[28:31], v16 offset:14336
  v_mfma_f32_16x16x32_bf16 v[232:235], a[52:55], a[104:107], v[232:235]
  v_mfma_f32_16x16x32_bf16 a[136:139], a[56:59], a[104:107], a[136:139]
  ds_read_b64_tr_b16 a[68:69], v19 offset:0
  v_mfma_f32_16x16x32_bf16 a[168:171], a[60:63], a[104:107], a[168:171]
  buffer_load_dwordx4 v31, s[12:15], s48 offen offset:3072 lds
  v_mfma_f32_16x16x32_bf16 v[76:79], a[32:35], a[108:111], v[76:79]
  s_add_u32 s48, s48, 524288
  s_add_u32 m0, s41, 4096
  ds_read_b64_tr_b16 a[70:71], v19 offset:2048
  v_mfma_f32_16x16x32_bf16 v[108:111], a[36:39], a[108:111], v[108:111]
  v_mfma_f32_16x16x32_bf16 v[140:143], a[40:43], a[108:111], v[140:143]
  v_mfma_f32_16x16x32_bf16 v[172:175], a[44:47], a[108:111], v[172:175]
  ds_read_b64_tr_b16 a[72:73], v20 offset:0
  v_mfma_f32_16x16x32_bf16 v[204:207], a[48:51], a[108:111], v[204:207]
  v_mfma_f32_16x16x32_bf16 v[236:239], a[52:55], a[108:111], v[236:239]
  ds_read_b64_tr_b16 a[74:75], v20 offset:2048
  v_mfma_f32_16x16x32_bf16 a[140:143], a[56:59], a[108:111], a[140:143]
  v_mfma_f32_16x16x32_bf16 a[172:175], a[60:63], a[108:111], a[172:175]
  buffer_load_dwordx4 v28, s[12:15], s49 offen offset:0 lds
  ds_read_b64_tr_b16 a[76:77], v21 offset:0
  v_mfma_f32_16x16x32_bf16 v[80:83], a[32:35], a[112:115], v[80:83]
  v_mfma_f32_16x16x32_bf16 v[112:115], a[36:39], a[112:115], v[112:115]
  ds_read_b64_tr_b16 a[78:79], v21 offset:2048
  v_mfma_f32_16x16x32_bf16 v[144:147], a[40:43], a[112:115], v[144:147]
  v_mfma_f32_16x16x32_bf16 v[176:179], a[44:47], a[112:115], v[176:179]
  v_mfma_f32_16x16x32_bf16 v[208:211], a[48:51], a[112:115], v[208:211]
  ds_read_b64_tr_b16 a[80:81], v18 offset:8192
  v_mfma_f32_16x16x32_bf16 v[240:243], a[52:55], a[112:115], v[240:243]
  v_mfma_f32_16x16x32_bf16 a[144:147], a[56:59], a[112:115], a[144:147]
  ds_read_b64_tr_b16 a[82:83], v18 offset:10240
  v_mfma_f32_16x16x32_bf16 a[176:179], a[60:63], a[112:115], a[176:179]
  buffer_load_dwordx4 v29, s[12:15], s49 offen offset:1024 lds
  v_mfma_f32_16x16x32_bf16 v[84:87], a[32:35], a[116:119], v[84:87]
  ds_read_b64_tr_b16 a[84:85], v19 offset:8192
  v_mfma_f32_16x16x32_bf16 v[116:119], a[36:39], a[116:119], v[116:119]
  v_mfma_f32_16x16x32_bf16 v[148:151], a[40:43], a[116:119], v[148:151]
  ds_read_b64_tr_b16 a[86:87], v19 offset:10240
  v_mfma_f32_16x16x32_bf16 v[180:183], a[44:47], a[116:119], v[180:183]
  v_mfma_f32_16x16x32_bf16 v[212:215], a[48:51], a[116:119], v[212:215]
  v_mfma_f32_16x16x32_bf16 v[244:247], a[52:55], a[116:119], v[244:247]
  ds_read_b64_tr_b16 a[88:89], v20 offset:8192
  v_mfma_f32_16x16x32_bf16 a[148:151], a[56:59], a[116:119], a[148:151]
  v_mfma_f32_16x16x32_bf16 a[180:183], a[60:63], a[116:119], a[180:183]
  buffer_load_dwordx4 v30, s[12:15], s49 offen offset:2048 lds
  ds_read_b64_tr_b16 a[90:91], v20 offset:10240
  v_mfma_f32_16x16x32_bf16 v[88:91], a[32:35], a[120:123], v[88:91]
  v_mfma_f32_16x16x32_bf16 v[120:123], a[36:39], a[120:123], v[120:123]
  ds_read_b64_tr_b16 a[92:93], v21 offset:8192
  v_mfma_f32_16x16x32_bf16 v[152:155], a[40:43], a[120:123], v[152:155]
  v_mfma_f32_16x16x32_bf16 v[184:187], a[44:47], a[120:123], v[184:187]
  ds_read_b64_tr_b16 a[94:95], v21 offset:10240
  v_mfma_f32_16x16x32_bf16 v[216:219], a[48:51], a[120:123], v[216:219]
  v_mfma_f32_16x16x32_bf16 v[248:251], a[52:55], a[120:123], v[248:251]
  v_mfma_f32_16x16x32_bf16 a[152:155], a[56:59], a[120:123], a[152:155]
  v_mfma_f32_16x16x32_bf16 a[184:187], a[60:63], a[120:123], a[184:187]
  buffer_load_dwordx4 v31, s[12:15], s49 offen offset:3072 lds
  v_mfma_f32_16x16x32_bf16 v[92:95], a[32:35], a[124:127], v[92:95]
  s_add_u32 s49, s49, 524288
  v_mfma_f32_16x16x32_bf16 v[124:127], a[36:39], a[124:127], v[124:127]
  v_mfma_f32_16x16x32_bf16 v[156:159], a[40:43], a[124:127], v[156:159]
  v_mfma_f32_16x16x32_bf16 v[188:191], a[44:47], a[124:127], v[188:191]
  v_mfma_f32_16x16x32_bf16 v[220:223], a[48:51], a[124:127], v[220:223]
  v_mfma_f32_16x16x32_bf16 v[252:255], a[52:55], a[124:127], v[252:255]
  v_mfma_f32_16x16x32_bf16 a[156:159], a[56:59], a[124:127], a[156:159]
  v_mfma_f32_16x16x32_bf16 a[188:191], a[60:63], a[124:127], a[188:191]
  s_waitcnt lgkmcnt(0)
  v_mfma_f32_16x16x32_bf16 v[64:67], a[0:3], a[64:67], v[64:67]
  s_add_u32 s36, s36, s38
  s_add_u32 s37, s37, 1
  ds_read_b128 a[32:35], v17 offset:0
  v_mfma_f32_16x16x32_bf16 v[96:99], a[4:7], a[64:67], v[96:99]
  s_cmp_eq_u32 s37, 3
  s_cselect_b32 s37, 0, s37
  s_cselect_b32 s38, s39, s40
  v_mfma_f32_16x16x32_bf16 v[128:131], a[8:11], a[64:67], v[128:131]
  s_add_u32 s41, s41, s43
  s_sub_u32 s43, 0, s43
  ds_read_b64_tr_b16 a[96:97], v18 offset:4096
  v_mfma_f32_16x16x32_bf16 v[160:163], a[12:15], a[64:67], v[160:163]
  v_mfma_f32_16x16x32_bf16 v[192:195], a[16:19], a[64:67], v[192:195]
  ds_read_b64_tr_b16 a[98:99], v18 offset:6144
  v_mfma_f32_16x16x32_bf16 v[224:227], a[20:23], a[64:67], v[224:227]
  v_mfma_f32_16x16x32_bf16 a[128:131], a[24:27], a[64:67], a[128:131]
  ds_read_b128 a[36:39], v17 offset:2048
  v_mfma_f32_16x16x32_bf16 a[160:163], a[28:31], a[64:67], a[160:163]
  v_mfma_f32_16x16x32_bf16 v[68:71], a[0:3], a[68:71], v[68:71]
  v_mfma_f32_16x16x32_bf16 v[100:103], a[4:7], a[68:71], v[100:103]
  ds_read_b128 a[40:43], v17 offset:4096
  v_mfma_f32_16x16x32_bf16 v[132:135], a[8:11], a[68:71], v[132:135]
  v_mfma_f32_16x16x32_bf16 v[164:167], a[12:15], a[68:71], v[164:167]
  ds_read_b128 a[44:47], v17 offset:6144
  v_mfma_f32_16x16x32_bf16 v[196:199], a[16:19], a[68:71], v[196:199]
  v_mfma_f32_16x16x32_bf16 v[228:231], a[20:23], a[68:71], v[228:231]
  ds_read_b128 a[48:51], v17 offset:8192
  v_mfma_f32_16x16x32_bf16 a[132:135], a[24:27], a[68:71], a[132:135]
  v_mfma_f32_16x16x32_bf16 a[164:167], a[28:31], a[68:71], a[164:167]
  ds_read_b128 a[52:55], v17 offset:10240
  v_mfma_f32_16x16x32_bf16 v[72:75], a[0:3], a[72:75], v[72:75]
  v_mfma_f32_16x16x32_bf16 v[104:107], a[4:7], a[72:75], v[104:107]
  v_mfma_f32_16x16x32_bf16 v[136:139], a[8:11], a[72:75], v[136:139]
  ds_read_b128 a[56:59], v17 offset:12288
  v_mfma_f32_16x16x32_bf16 v[168:171], a[12:15], a[72:75], v[168:171]
  v_mfma_f32_16x16x32_bf16 v[200:203], a[16:19], a[72:75], v[200:203]
  ds_read_b128 a[60:63], v17 offset:14336
  v_mfma_f32_16x16x32_bf16 v[232:235], a[20:23], a[72:75], v[232:235]
  v_mfma_f32_16x16x32_bf16 a[136:139], a[24:27], a[72:75], a[136:139]
  ds_read_b64_tr_b16 a[100:101], v19 offset:4096
  v_mfma_f32_16x16x32_bf16 a[168:171], a[28:31], a[72:75], a[168:171]
  v_mfma_f32_16x16x32_bf16 v[76:79], a[0:3], a[76:79], v[76:79]
  ds_read_b64_tr_b16 a[102:103], v19 offset:6144
  v_mfma_f32_16x16x32_bf16 v[108:111], a[4:7], a[76:79], v[108:111]
  v_mfma_f32_16x16x32_bf16 v[140:143], a[8:11], a[76:79], v[140:143]
  v_mfma_f32_16x16x32_bf16 v[172:175], a[12:15], a[76:79], v[172:175]
  ds_read_b64_tr_b16 a[104:105], v20 offset:4096
  v_mfma_f32_16x16x32_bf16 v[204:207], a[16:19], a[76:79], v[204:207]
  v_mfma_f32_16x16x32_bf16 v[236:239], a[20:23], a[76:79], v[236:239]
  ds_read_b64_tr_b16 a[106:107], v20 offset:6144
  v_mfma_f32_16x16x32_bf16 a[140:143], a[24:27], a[76:79], a[140:143]
  v_mfma_f32_16x16x32_bf16 a[172:175], a[28:31], a[76:79], a[172:175]
  ds_read_b64_tr_b16 a[108:109], v21 offset:4096
  v_mfma_f32_16x16x32_bf16 v[80:83], a[0:3], a[80:83], v[80:83]
  v_mfma_f32_16x16x32_bf16 v[112:115], a[4:7], a[80:83], v[112:115]
  ds_read_b64_tr_b16 a[110:111], v21 offset:6144
  v_mfma_f32_16x16x32_bf16 v[144:147], a[8:11], a[80:83], v[144:147]
  v_mfma_f32_16x16x32_bf16 v[176:179], a[12:15], a[80:83], v[176:179]
  v_mfma_f32_16x16x32_bf16 v[208:211], a[16:19], a[80:83], v[208:211]
  ds_read_b64_tr_b16 a[112:113], v18 offset:12288
  v_mfma_f32_16x16x32_bf16 v[240:243], a[20:23], a[80:83], v[240:243]
  v_mfma_f32_16x16x32_bf16 a[144:147], a[24:27], a[80:83], a[144:147]
  ds_read_b64_tr_b16 a[114:115], v18 offset:14336
  v_mfma_f32_16x16x32_bf16 a[176:179], a[28:31], a[80:83], a[176:179]
  v_mfma_f32_16x16x32_bf16 v[84:87], a[0:3], a[84:87], v[84:87]
  ds_read_b64_tr_b16 a[116:117], v19 offset:12288
  v_mfma_f32_16x16x32_bf16 v[116:119], a[4:7], a[84:87], v[116:119]
  v_mfma_f32_16x16x32_bf16 v[148:151], a[8:11], a[84:87], v[148:151]
  ds_read_b64_tr_b16 a[118:119], v19 offset:14336
  v_mfma_f32_16x16x32_bf16 v[180:183], a[12:15], a[84:87], v[180:183]
  v_mfma_f32_16x16x32_bf16 v[212:215], a[16:19], a[84:87], v[212:215]
  v_mfma_f32_16x16x32_bf16 v[244:247], a[20:23], a[84:87], v[244:247]
  ds_read_b64_tr_b16 a[120:121], v20 offset:12288
  v_mfma_f32_16x16x32_bf16 a[148:151], a[24:27], a[84:87], a[148:151]
  v_mfma_f32_16x16x32_bf16 a[180:183], a[28:31], a[84:87], a[180:183]
  ds_read_b64_tr_b16 a[122:123], v20 offset:14336
  v_mfma_f32_16x16x32_bf16 v[88:91], a[0:3], a[88:91], v[88:91]
  v_mfma_f32_16x16x32_bf16 v[120:123], a[4:7], a[88:91], v[120:123]
  ds_read_b64_tr_b16 a[124:125], v21 offset:12288
  v_mfma_f32_16x16x32_bf16 v[152:155], a[8:11], a[88:91], v[152:155]
  v_mfma_f32_16x16x32_bf16 v[184:187], a[12:15], a[88:91], v[184:187]
  ds_read_b64_tr_b16 a[126:127], v21 offset:14336
  v_mfma_f32_16x16x32_bf16 v[216:219], a[16:19], a[88:91], v[216:219]
  v_add_u32 v16, s38, v16
  v_add_u32 v17, s38, v17
  v_mfma_f32_16x16x32_bf16 v[248:251], a[20:23], a[88:91], v[248:251]
  v_add_u32 v18, s43, v18
  v_add_u32 v19, s43, v19
  v_mfma_f32_16x16x32_bf16 a[152:155], a[24:27], a[88:91], a[152:155]
  v_add_u32 v20, s43, v20
  v_add_u32 v21, s43, v21
  v_mfma_f32_16x16x32_bf16 a[184:187], a[28:31], a[88:91], a[184:187]
  v_mfma_f32_16x16x32_bf16 v[92:95], a[0:3], a[92:95], v[92:95]
  v_mfma_f32_16x16x32_bf16 v[124:127], a[4:7], a[92:95], v[124:127]
  v_mfma_f32_16x16x32_bf16 v[156:159], a[8:11], a[92:95], v[156:159]
  v_mfma_f32_16x16x32_bf16 v[188:191], a[12:15], a[92:95], v[188:191]
  v_mfma_f32_16x16x32_bf16 v[220:223], a[16:19], a[92:95], v[220:223]
  v_mfma_f32_16x16x32_bf16 v[252:255], a[20:23], a[92:95], v[252:255]
  v_mfma_f32_16x16x32_bf16 a[156:159], a[24:27], a[92:95], a[156:159]
  v_mfma_f32_16x16x32_bf16 a[188:191], a[28:31], a[92:95], a[188:191]
  s_waitcnt vmcnt(0) lgkmcnt(0)
  s_barrier
  v_mfma_f32_16x16x32_bf16 v[64:67], a[32:35], a[96:99], v[64:67]
  ds_read_b128 a[0:3], v16 offset:0
  v_mfma_f32_16x16x32_bf16 v[96:99], a[36:39], a[96:99], v[96:99]
  v_mfma_f32_16x16x32_bf16 v[128:131], a[40:43], a[96:99], v[128:131]
  ds_read_b64_tr_b16 a[64:65], v18 offset:0
  v_mfma_f32_16x16x32_bf16 v[160:163], a[44:47], a[96:99], v[160:163]
  v_mfma_f32_16x16x32_bf16 v[192:195], a[48:51], a[96:99], v[192:195]
  ds_read_b64_tr_b16 a[66:67], v18 offset:2048
  v_mfma_f32_16x16x32_bf16 v[224:227], a[52:55], a[96:99], v[224:227]
  v_mfma_f32_16x16x32_bf16 a[128:131], a[56:59], a[96:99], a[128:131]
  ds_read_b128 a[4:7], v16 offset:2048
  v_mfma_f32_16x16x32_bf16 a[160:163], a[60:63], a[96:99], a[160:163]
  v_mfma_f32_16x16x32_bf16 v[68:71], a[32:35], a[100:103], v[68:71]
  v_mfma_f32_16x16x32_bf16 v[100:103], a[36:39], a[100:103], v[100:103]
  ds_read_b128 a[8:11], v16 offset:4096
  v_mfma_f32_16x16x32_bf16 v[132:135], a[40:43], a[100:103], v[132:135]
  v_mfma_f32_16x16x32_bf16 v[164:167], a[44:47], a[100:103], v[164:167]
  ds_read_b128 a[12:15], v16 offset:6144
  v_mfma_f32_16x16x32_bf16 v[196:199], a[48:51], a[100:103], v[196:199]
  v_mfma_f32_16x16x32_bf16 v[228:231], a[52:55], a[100:103], v[228:231]
  ds_read_b128 a[16:19], v16 offset:8192
  v_mfma_f32_16x16x32_bf16 a[132:135], a[56:59], a[100:103], a[132:135]
  v_mfma_f32_16x16x32_bf16 a[164:167], a[60:63], a[100:103], a[164:167]
  ds_read_b128 a[20:23], v16 offset:10240
  v_mfma_f32_16x16x32_bf16 v[72:75], a[32:35], a[104:107], v[72:75]
  v_mfma_f32_16x16x32_bf16 v[104:107], a[36:39], a[104:107], v[104:107]
  v_mfma_f32_16x16x32_bf16 v[136:139], a[40:43], a[104:107], v[136:139]
  ds_read_b128 a[24:27], v16 offset:12288
  v_mfma_f32_16x16x32_bf16 v[168:171], a[44:47], a[104:107], v[168:171]
  v_mfma_f32_16x16x32_bf16 v[200:203], a[48:51], a[104:107], v[200:203]
  ds_read_b128 a[28:31], v16 offset:14336
  v_mfma_f32_16x16x32_bf16 v[232:235], a[52:55], a[104:107], v[232:235]
  v_mfma_f32_16x16x32_bf16 a[136:139], a[56:59], a[104:107], a[136:139]
  ds_read_b64_tr_b16 a[68:69], v19 offset:0
  v_mfma_f32_16x16x32_bf16 a[168:171], a[60:63], a[104:107], a[168:171]
  v_mfma_f32_16x16x32_bf16 v[76:79], a[32:35], a[108:111], v[76:79]
  ds_read_b64_tr_b16 a[70:71], v19 offset:2048
  v_mfma_f32_16x16x32_bf16 v[108:111], a[36:39], a[108:111], v[108:111]
  v_mfma_f32_16x16x32_bf16 v[140:143], a[40:43], a[108:111], v[140:143]
  v_mfma_f32_16x16x32_bf16 v[172:175], a[44:47], a[108:111], v[172:175]
  ds_read_b64_tr_b16 a[72:73], v20 offset:0
  v_mfma_f32_16x16x32_bf16 v[204:207], a[48:51], a[108:111], v[204:207]
  v_mfma_f32_16x16x32_bf16 v[236:239], a[52:55], a[108:111], v[236:239]
  ds_read_b64_tr_b16 a[74:75], v20 offset:2048
  v_mfma_f32_16x16x32_bf16 a[140:143], a[56:59], a[108:111], a[140:143]
  v_mfma_f32_16x16x32_bf16 a[172:175], a[60:63], a[108:111], a[172:175]
  ds_read_b64_tr_b16 a[76:77], v21 offset:0
  v_mfma_f32_16x16x32_bf16 v[80:83], a[32:35], a[112:115], v[80:83]
  v_mfma_f32_16x16x32_bf16 v[112:115], a[36:39], a[112:115], v[112:115]
  ds_read_b64_tr_b16 a[78:79], v21 offset:2048
  v_mfma_f32_16x16x32_bf16 v[144:147], a[40:43], a[112:115], v[144:147]
  v_mfma_f32_16x16x32_bf16 v[176:179], a[44:47], a[112:115], v[176:179]
  v_mfma_f32_16x16x32_bf16 v[208:211], a[48:51], a[112:115], v[208:211]
  ds_read_b64_tr_b16 a[80:81], v18 offset:8192
  v_mfma_f32_16x16x32_bf16 v[240:243], a[52:55], a[112:115], v[240:243]
  v_mfma_f32_16x16x32_bf16 a[144:147], a[56:59], a[112:115], a[144:147]
  ds_read_b64_tr_b16 a[82:83], v18 offset:10240
  v_mfma_f32_16x16x32_bf16 a[176:179], a[60:63], a[112:115], a[176:179]
  v_mfma_f32_16x16x32_bf16 v[84:87], a[32:35], a[116:119], v[84:87]
  ds_read_b64_tr_b16 a[84:85], v19 offset:8192
  v_mfma_f32_16x16x32_bf16 v[116:119], a[36:39], a[116:119], v[116:119]
  v_mfma_f32_16x16x32_bf16 v[148:151], a[40:43], a[116:119], v[148:151]
  ds_read_b64_tr_b16 a[86:87], v19 offset:10240
  v_mfma_f32_16x16x32_bf16 v[180:183], a[44:47], a[116:119], v[180:183]
  v_mfma_f32_16x16x32_bf16 v[212:215], a[48:51], a[116:119], v[212:215]
  v_mfma_f32_16x16x32_bf16 v[244:247], a[52:55], a[116:119], v[244:247]
  ds_read_b64_tr_b16 a[88:89], v20 offset:8192
  v_mfma_f32_16x16x32_bf16 a[148:151], a[56:59], a[116:119], a[148:151]
  v_mfma_f32_16x16x32_bf16 a[180:183], a[60:63], a[116:119], a[180:183]
  ds_read_b64_tr_b16 a[90:91], v20 offset:10240
  v_mfma_f32_16x16x32_bf16 v[88:91], a[32:35], a[120:123], v[88:91]
  v_mfma_f32_16x16x32_bf16 v[120:123], a[36:39], a[120:123], v[120:123]
  ds_read_b64_tr_b16 a[92:93], v21 offset:8192
  v_mfma_f32_16x16x32_bf16 v[152:155], a[40:43], a[120:123], v[152:155]
  v_mfma_f32_16x16x32_bf16 v[184:187], a[44:47], a[120:123], v[184:187]
  ds_read_b64_tr_b16 a[94:95], v21 offset:10240
  v_mfma_f32_16x16x32_bf16 v[216:219], a[48:51], a[120:123], v[216:219]
  v_mfma_f32_16x16x32_bf16 v[248:251], a[52:55], a[120:123], v[248:251]
  v_mfma_f32_16x16x32_bf16 a[152:155], a[56:59], a[120:123], a[152:155]
  v_mfma_f32_16x16x32_bf16 a[184:187], a[60:63], a[120:123], a[184:187]
  v_mfma_f32_16x16x32_bf16 v[92:95], a[32:35], a[124:127], v[92:95]
  v_mfma_f32_16x16x32_bf16 v[124:127], a[36:39], a[124:127], v[124:127]
  v_mfma_f32_16x16x32_bf16 v[156:159], a[40:43], a[124:127], v[156:159]
  v_mfma_f32_16x16x32_bf16 v[188:191], a[44:47], a[124:127], v[188:191]
  v_mfma_f32_16x16x32_bf16 v[220:223], a[48:51], a[124:127], v[220:223]
  v_mfma_f32_16x16x32_bf16 v[252:255], a[52:55], a[124:127], v[252:255]
  v_mfma_f32_16x16x32_bf16 a[156:159], a[56:59], a[124:127], a[156:159]
  v_mfma_f32_16x16x32_bf16 a[188:191], a[60:63], a[124:127], a[188:191]
  s_waitcnt lgkmcnt(0)
  v_mfma_f32_16x16x32_bf16 v[64:67], a[0:3], a[64:67], v[64:67]
  ds_read_b128 a[32:35], v17 offset:0
  v_mfma_f32_16x16x32_bf16 v[96:99], a[4:7], a[64:67], v[96:99]
  v_mfma_f32_16x16x32_bf16 v[128:131], a[8:11], a[64:67], v[128:131]
  ds_read_b64_tr_b16 a[96:97], v18 offset:4096
  v_mfma_f32_16x16x32_bf16 v[160:163], a[12:15], a[64:67], v[160:163]
  v_mfma_f32_16x16x32_bf16 v[192:195], a[16:19], a[64:67], v[192:195]
  ds_read_b64_tr_b16 a[98:99], v18 offset:6144
  v_mfma_f32_16x16x32_bf16 v[224:227], a[20:23], a[64:67], v[224:227]
  v_mfma_f32_16x16x32_bf16 a[128:131], a[24:27], a[64:67], a[128:131]
  ds_read_b128 a[36:39], v17 offset:2048
  v_mfma_f32_16x16x32_bf16 a[160:163], a[28:31], a[64:67], a[160:163]
  v_mfma_f32_16x16x32_bf16 v[68:71], a[0:3], a[68:71], v[68:71]
  v_mfma_f32_16x16x32_bf16 v[100:103], a[4:7], a[68:71], v[100:103]
  ds_read_b128 a[40:43], v17 offset:4096
  v_mfma_f32_16x16x32_bf16 v[132:135], a[8:11], a[68:71], v[132:135]
  v_mfma_f32_16x16x32_bf16 v[164:167], a[12:15], a[68:71], v[164:167]
  ds_read_b128 a[44:47], v17 offset:6144
  v_mfma_f32_16x16x32_bf16 v[196:199], a[16:19], a[68:71], v[196:199]
  v_mfma_f32_16x16x32_bf16 v[228:231], a[20:23], a[68:71], v[228:231]
  ds_read_b128 a[48:51], v17 offset:8192
  v_mfma_f32_16x16x32_bf16 a[132:135], a[24:27], a[68:71], a[132:135]
  v_mfma_f32_16x16x32_bf16 a[164:167], a[28:31], a[68:71], a[164:167]
  ds_read_b128 a[52:55], v17 offset:10240
  v_mfma_f32_16x16x32_bf16 v[72:75], a[0:3], a[72:75], v[72:75]
  v_mfma_f32_16x16x32_bf16 v[104:107], a[4:7], a[72:75], v[104:107]
  v_mfma_f32_16x16x32_bf16 v[136:139], a[8:11], a[72:75], v[136:139]
  ds_read_b128 a[56:59], v17 offset:12288
  v_mfma_f32_16x16x32_bf16 v[168:171], a[12:15], a[72:75], v[168:171]
  v_mfma_f32_16x16x32_bf16 v[200:203], a[16:19], a[72:75], v[200:203]
  ds_read_b128 a[60:63], v17 offset:14336
  v_mfma_f32_16x16x32_bf16 v[232:235], a[20:23], a[72:75], v[232:235]
  v_mfma_f32_16x16x32_bf16 a[136:139], a[24:27], a[72:75], a[136:139]
  ds_read_b64_tr_b16 a[100:101], v19 offset:4096
  v_mfma_f32_16x16x32_bf16 a[168:171], a[28:31], a[72:75], a[168:171]
  v_mfma_f32_16x16x32_bf16 v[76:79], a[0:3], a[76:79], v[76:79]
  ds_read_b64_tr_b16 a[102:103], v19 offset:6144
  v_mfma_f32_16x16x32_bf16 v[108:111], a[4:7], a[76:79], v[108:111]
  v_mfma_f32_16x16x32_bf16 v[140:143], a[8:11], a[76:79], v[140:143]
  v_mfma_f32_16x16x32_bf16 v[172:175], a[12:15], a[76:79], v[172:175]
  ds_read_b64_tr_b16 a[104:105], v20 offset:4096
  v_mfma_f32_16x16x32_bf16 v[204:207], a[16:19], a[76:79], v[204:207]
  v_mfma_f32_16x16x32_bf16 v[236:239], a[20:23], a[76:79], v[236:239]
  ds_read_b64_tr_b16 a[106:107], v20 offset:6144
  v_mfma_f32_16x16x32_bf16 a[140:143], a[24:27], a[76:79], a[140:143]
  v_mfma_f32_16x16x32_bf16 a[172:175], a[28:31], a[76:79], a[172:175]
  ds_read_b64_tr_b16 a[108:109], v21 offset:4096
  v_mfma_f32_16x16x32_bf16 v[80:83], a[0:3], a[80:83], v[80:83]
  v_mfma_f32_16x16x32_bf16 v[112:115], a[4:7], a[80:83], v[112:115]
  ds_read_b64_tr_b16 a[110:111], v21 offset:6144
  v_mfma_f32_16x16x32_bf16 v[144:147], a[8:11], a[80:83], v[144:147]
  v_mfma_f32_16x16x32_bf16 v[176:179], a[12:15], a[80:83], v[176:179]
  v_mfma_f32_16x16x32_bf16 v[208:211], a[16:19], a[80:83], v[208:211]
  ds_read_b64_tr_b16 a[112:113], v18 offset:12288
  v_mfma_f32_16x16x32_bf16 v[240:243], a[20:23], a[80:83], v[240:243]
  v_mfma_f32_16x16x32_bf16 a[144:147], a[24:27], a[80:83], a[144:147]
  ds_read_b64_tr_b16 a[114:115], v18 offset:14336
  v_mfma_f32_16x16x32_bf16 a[176:179], a[28:31], a[80:83], a[176:179]
  v_mfma_f32_16x16x32_bf16 v[84:87], a[0:3], a[84:87], v[84:87]
  ds_read_b64_tr_b16 a[116:117], v19 offset:12288
  v_mfma_f32_16x16x32_bf16 v[116:119], a[4:7], a[84:87], v[116:119]
  v_mfma_f32_16x16x32_bf16 v[148:151], a[8:11], a[84:87], v[148:151]
  ds_read_b64_tr_b16 a[118:119], v19 offset:14336
  v_mfma_f32_16x16x32_bf16 v[180:183], a[12:15], a[84:87], v[180:183]
  v_mfma_f32_16x16x32_bf16 v[212:215], a[16:19], a[84:87], v[212:215]
  v_mfma_f32_16x16x32_bf16 v[244:247], a[20:23], a[84:87], v[244:247]
  ds_read_b64_tr_b16 a[120:121], v20 offset:12288
  v_mfma_f32_16x16x32_bf16 a[148:151], a[24:27], a[84:87], a[148:151]
  v_mfma_f32_16x16x32_bf16 a[180:183], a[28:31], a[84:87], a[180:183]
  ds_read_b64_tr_b16 a[122:123], v20 offset:14336
  v_mfma_f32_16x16x32_bf16 v[88:91], a[0:3], a[88:91], v[88:91]
  v_mfma_f32_16x16x32_bf16 v[120:123], a[4:7], a[88:91], v[120:123]
  ds_read_b64_tr_b16 a[124:125], v21 offset:12288
  v_mfma_f32_16x16x32_bf16 v[152:155], a[8:11], a[88:91], v[152:155]
  v_mfma_f32_16x16x32_bf16 v[184:187], a[12:15], a[88:91], v[184:187]
  ds_read_b64_tr_b16 a[126:127], v21 offset:14336
  v_mfma_f32_16x16x32_bf16 v[216:219], a[16:19], a[88:91], v[216:219]
  v_mfma_f32_16x16x32_bf16 v[248:251], a[20:23], a[88:91], v[248:251]
  v_mfma_f32_16x16x32_bf16 a[152:155], a[24:27], a[88:91], a[152:155]
  v_mfma_f32_16x16x32_bf16 a[184:187], a[28:31], a[88:91], a[184:187]
  v_mfma_f32_16x16x32_bf16 v[92:95], a[0:3], a[92:95], v[92:95]
  v_mfma_f32_16x16x32_bf16 v[124:127], a[4:7], a[92:95], v[124:127]
  v_mfma_f32_16x16x32_bf16 v[156:159], a[8:11], a[92:95], v[156:159]
  v_mfma_f32_16x16x32_bf16 v[188:191], a[12:15], a[92:95], v[188:191]
  v_mfma_f32_16x16x32_bf16 v[220:223], a[16:19], a[92:95], v[220:223]
  v_mfma_f32_16x16x32_bf16 v[252:255], a[20:23], a[92:95], v[252:255]
  v_mfma_f32_16x16x32_bf16 a[156:159], a[24:27], a[92:95], a[156:159]
  v_mfma_f32_16x16x32_bf16 a[188:191], a[28:31], a[92:95], a[188:191]
  s_waitcnt lgkmcnt(0)
  s_barrier
  v_mfma_f32_16x16x32_bf16 v[64:67], a[32:35], a[96:99], v[64:67]
  v_mfma_f32_16x16x32_bf16 v[96:99], a[36:39], a[96:99], v[96:99]
  v_mfma_f32_16x16x32_bf16 v[128:131], a[40:43], a[96:99], v[128:131]
  v_mfma_f32_16x16x32_bf16 v[160:163], a[44:47], a[96:99], v[160:163]
  v_mfma_f32_16x16x32_bf16 v[192:195], a[48:51], a[96:99], v[192:195]
  v_mfma_f32_16x16x32_bf16 v[224:227], a[52:55], a[96:99], v[224:227]
  v_mfma_f32_16x16x32_bf16 a[128:131], a[56:59], a[96:99], a[128:131]
  v_mfma_f32_16x16x32_bf16 a[160:163], a[60:63], a[96:99], a[160:163]
  v_mfma_f32_16x16x32_bf16 v[68:71], a[32:35], a[100:103], v[68:71]
  v_mfma_f32_16x16x32_bf16 v[100:103], a[36:39], a[100:103], v[100:103]
  v_mfma_f32_16x16x32_bf16 v[132:135], a[40:43], a[100:103], v[132:135]
  v_mfma_f32_16x16x32_bf16 v[164:167], a[44:47], a[100:103], v[164:167]
  v_mfma_f32_16x16x32_bf16 v[196:199], a[48:51], a[100:103], v[196:199]
  v_mfma_f32_16x16x32_bf16 v[228:231], a[52:55], a[100:103], v[228:231]
  v_mfma_f32_16x16x32_bf16 a[132:135], a[56:59], a[100:103], a[132:135]
  v_mfma_f32_16x16x32_bf16 a[164:167], a[60:63], a[100:103], a[164:167]
  v_mfma_f32_16x16x32_bf16 v[72:75], a[32:35], a[104:107], v[72:75]
  v_mfma_f32_16x16x32_bf16 v[104:107], a[36:39], a[104:107], v[104:107]
  v_mfma_f32_16x16x32_bf16 v[136:139], a[40:43], a[104:107], v[136:139]
  v_mfma_f32_16x16x32_bf16 v[168:171], a[44:47], a[104:107], v[168:171]
  v_mfma_f32_16x16x32_bf16 v[200:203], a[48:51], a[104:107], v[200:203]
  v_mfma_f32_16x16x32_bf16 v[232:235], a[52:55], a[104:107], v[232:235]
  v_mfma_f32_16x16x32_bf16 a[136:139], a[56:59], a[104:107], a[136:139]
  v_mfma_f32_16x16x32_bf16 a[168:171], a[60:63], a[104:107], a[168:171]
  v_mfma_f32_16x16x32_bf16 v[76:79], a[32:35], a[108:111], v[76:79]
  v_mfma_f32_16x16x32_bf16 v[108:111], a[36:39], a[108:111], v[108:111]
  v_mfma_f32_16x16x32_bf16 v[140:143], a[40:43], a[108:111], v[140:143]
  v_mfma_f32_16x16x32_bf16 v[172:175], a[44:47], a[108:111], v[172:175]
  v_mfma_f32_16x16x32_bf16 v[204:207], a[48:51], a[108:111], v[204:207]
  v_mfma_f32_16x16x32_bf16 v[236:239], a[52:55], a[108:111], v[236:239]
  v_mfma_f32_16x16x32_bf16 a[140:143], a[56:59], a[108:111], a[140:143]
  v_mfma_f32_16x16x32_bf16 a[172:175], a[60:63], a[108:111], a[172:175]
  v_mfma_f32_16x16x32_bf16 v[80:83], a[32:35], a[112:115], v[80:83]
  v_mfma_f32_16x16x32_bf16 v[112:115], a[36:39], a[112:115], v[112:115]
  v_mfma_f32_16x16x32_bf16 v[144:147], a[40:43], a[112:115], v[144:147]
  v_mfma_f32_16x16x32_bf16 v[176:179], a[44:47], a[112:115], v[176:179]
  v_mfma_f32_16x16x32_bf16 v[208:211], a[48:51], a[112:115], v[208:211]
  v_mfma_f32_16x16x32_bf16 v[240:243], a[52:55], a[112:115], v[240:243]
  v_mfma_f32_16x16x32_bf16 a[144:147], a[56:59], a[112:115], a[144:147]
  v_mfma_f32_16x16x32_bf16 a[176:179], a[60:63], a[112:115], a[176:179]
  v_mfma_f32_16x16x32_bf16 v[84:87], a[32:35], a[116:119], v[84:87]
  v_mfma_f32_16x16x32_bf16 v[116:119], a[36:39], a[116:119], v[116:119]
  v_mfma_f32_16x16x32_bf16 v[148:151], a[40:43], a[116:119], v[148:151]
  v_mfma_f32_16x16x32_bf16 v[180:183], a[44:47], a[116:119], v[180:183]
  v_mfma_f32_16x16x32_bf16 v[212:215], a[48:51], a[116:119], v[212:215]
  v_mfma_f32_16x16x32_bf16 v[244:247], a[52:55], a[116:119], v[244:247]
  v_mfma_f32_16x16x32_bf16 a[148:151], a[56:59], a[116:119], a[148:151]
  v_mfma_f32_16x16x32_bf16 a[180:183], a[60:63], a[116:119], a[180:183]
  v_mfma_f32_16x16x32_bf16 v[88:91], a[32:35], a[120:123], v[88:91]
  v_mfma_f32_16x16x32_bf16 v[120:123], a[36:39], a[120:123], v[120:123]
  v_mfma_f32_16x16x32_bf16 v[152:155], a[40:43], a[120:123], v[152:155]
  v_mfma_f32_16x16x32_bf16 v[184:187], a[44:47], a[120:123], v[184:187]
  v_mfma_f32_16x16x32_bf16 v[216:219], a[48:51], a[120:123], v[216:219]
  v_mfma_f32_16x16x32_bf16 v[248:251], a[52:55], a[120:123], v[248:251]
  v_mfma_f32_16x16x32_bf16 a[152:155], a[56:59], a[120:123], a[152:155]
  v_mfma_f32_16x16x32_bf16 a[184:187], a[60:63], a[120:123], a[184:187]
  v_mfma_f32_16x16x32_bf16 v[92:95], a[32:35], a[124:127], v[92:95]
  v_mfma_f32_16x16x32_bf16 v[124:127], a[36:39], a[124:127], v[124:127]
  v_mfma_f32_16x16x32_bf16 v[156:159], a[40:43], a[124:127], v[156:159]
  v_mfma_f32_16x16x32_bf16 v[188:191], a[44:47], a[124:127], v[188:191]
  v_mfma_f32_16x16x32_bf16 v[220:223], a[48:51], a[124:127], v[220:223]
  v_mfma_f32_16x16x32_bf16 v[252:255], a[52:55], a[124:127], v[252:255]
  v_mfma_f32_16x16x32_bf16 a[156:159], a[56:59], a[124:127], a[156:159]
  v_mfma_f32_16x16x32_bf16 a[188:191], a[60:63], a[124:127], a[188:191]
  s_and_b32 s4, s2, 1
  s_lshl_b32 s4, s4, 3
  s_bfe_u32 s5, s2, 0x30003
  s_add_u32 s54, s4, s5
  s_bfe_u32 s4, s2, 0x20001
  s_lshl_b32 s4, s4, 2
  s_lshr_b32 s5, s2, 6
  s_add_u32 s55, s4, s5
  s_lshl_b32 s4, s54, 18
  s_add_u32 s8, s76, s4
  s_addc_u32 s9, s77, 0
  s_sub_u32 s8, s8, 32768
  s_subb_u32 s9, s9, 0
  s_mov_b32 s10, 294912
  s_mov_b32 s11, 0x00020000
  s_mov_b32 s12, s78
  s_mov_b32 s13, s79
  s_mov_b32 s14, 6291456
  s_mov_b32 s15, 0x00020000
  s_mov_b32 s46, 0
  s_lshl_b32 s47, s55, 7
  s_lshl_b32 s36, s3, 12
  s_lshl_b32 s4, s3, 11
  s_add_u32 s48, s4, 20480
  s_add_u32 s49, s48, 3072
  s_mul_i32 s4, s3, 3072
  s_sub_u32 s52, 16384, s4
  v_lshrrev_b32 v32, 3, v1
  v_and_b32 v33, 6, v32
  v_and_b32 v34, 7, v1
  v_xor_b32 v33, v33, v34
  v_lshlrev_b32 v33, 4, v33
  s_lshl_b32 s4, s3, 5
  s_add_u32 s4, s4, 16
  v_add_u32 v34, s4, v32
  v_lshl_add_u32 v34, v34, 11, v33
  v_add_u32 v24, 0, v34
  v_add_u32 v25, 15360, v34
  v_add_u32 v26, 30720, v34
  v_add_u32 v27, 46080, v34
  s_lshl_b32 s4, s3, 14
  s_cmp_ge_u32 s3, 2
  s_cselect_b32 s4, 0x40000000, s4
  s_cmp_eq_u32 s54, 0
  s_cselect_b32 s4, 0x40000000, s4
  v_lshl_add_u32 v34, v32, 11, v33
  v_add_u32 v28, s4, v34
  v_lshrrev_b32 v34, 2, v32
  v_and_b32 v35, 3, v32
  v_lshl_add_u32 v34, v34, 3, v35
  v_mul_u32_u24 v34, 6144, v34
  v_add_u32 v34, v34, v33
  s_mul_i32 s6, s3, 6
  s_add_u32 s7, s6, 0
  s_bfe_u32 s4, s7, 0x10002
  s_lshl_b32 s4, s4, 5
  s_and_b32 s5, s7, 1
  s_lshl_b32 s5, s5, 4
  s_add_u32 s4, s4, s5
  s_bfe_u32 s5, s7, 0x10001
  s_lshl_b32 s5, s5, 2
  s_add_u32 s4, s4, s5
  s_mul_i32 s4, s4, 6144
  s_lshr_b32 s5, s7, 3
  s_lshl_b32 s5, s5, 11
  s_add_u32 s4, s4, s5
  s_add_u32 s4, s4, 2048
  v_add_u32 v8, s4, v34
  s_add_u32 s7, s6, 1
  s_bfe_u32 s4, s7, 0x10002
  s_lshl_b32 s4, s4, 5
  s_and_b32 s5, s7, 1
  s_lshl_b32 s5, s5, 4
  s_add_u32 s4, s4, s5
  s_bfe_u32 s5, s7, 0x10001
  s_lshl_b32 s5, s5, 2
  s_add_u32 s4, s4, s5
  s_mul_i32 s4, s4, 6144
  s_lshr_b32 s5, s7, 3
  s_lshl_b32 s5, s5, 11
  s_add_u32 s4, s4, s5
  s_add_u32 s4, s4, 1024
  v_add_u32 v9, s4, v34
  s_add_u32 s7, s6, 2
  s_bfe_u32 s4, s7, 0x10002
  s_lshl_b32 s4, s4, 5
  s_and_b32 s5, s7, 1
  s_lshl_b32 s5, s5, 4
  s_add_u32 s4, s4, s5
  s_bfe_u32 s5, s7, 0x10001
  s_lshl_b32 s5, s5, 2
  s_add_u32 s4, s4, s5
  s_mul_i32 s4, s4, 6144
  s_lshr_b32 s5, s7, 3
  s_lshl_b32 s5, s5, 11
  s_add_u32 s4, s4, s5
  s_add_u32 s4, s4, 0
  v_add_u32 v10, s4, v34
  s_add_u32 s7, s6, 3
  s_bfe_u32 s4, s7, 0x10002
  s_lshl_b32 s4, s4, 5
  s_and_b32 s5, s7, 1
  s_lshl_b32 s5, s5, 4
  s_add_u32 s4, s4, s5
  s_bfe_u32 s5, s7, 0x10001
  s_lshl_b32 s5, s5, 2
  s_add_u32 s4, s4, s5
  s_mul_i32 s4, s4, 6144
  s_lshr_b32 s5, s7, 3
  s_lshl_b32 s5, s5, 11
  s_add_u32 s4, s4, s5
  s_add_u32 s4, s4, 2048
  v_add_u32 v11, s4, v34
  s_add_u32 s7, s6, 4
  s_bfe_u32 s4, s7, 0x10002
  s_lshl_b32 s4, s4, 5
  s_and_b32 s5, s7, 1
  s_lshl_b32 s5, s5, 4
  s_add_u32 s4, s4, s5
  s_bfe_u32 s5, s7, 0x10001
  s_lshl_b32 s5, s5, 2
  s_add_u32 s4, s4, s5
  s_mul_i32 s4, s4, 6144
  s_lshr_b32 s5, s7, 3
  s_lshl_b32 s5, s5, 11
  s_add_u32 s4, s4, s5
  s_add_u32 s4, s4, 1024
  v_add_u32 v12, s4, v34
  s_add_u32 s7, s6, 5
  s_bfe_u32 s4, s7, 0x10002
  s_lshl_b32 s4, s4, 5
  s_and_b32 s5, s7, 1
  s_lshl_b32 s5, s5, 4
  s_add_u32 s4, s4, s5
  s_bfe_u32 s5, s7, 0x10001
  s_lshl_b32 s5, s5, 2
  s_add_u32 s4, s4, s5
  s_mul_i32 s4, s4, 6144
  s_lshr_b32 s5, s7, 3
  s_lshl_b32 s5, s5, 11
  s_add_u32 s4, s4, s5
  s_add_u32 s4, s4, 0
  v_add_u32 v13, s4, v34
  s_sub_u32 s12, s12, 2048
  s_subb_u32 s13, s13, 0
  s_add_u32 s14, s14, 2048
  s_add_u32 m0, s36, s48
  s_nop 0
  buffer_load_dwordx4 v8, s[12:15], s47 offen offset:0 lds
  buffer_load_dwordx4 v9, s[12:15], s47 offen offset:1024 lds
  buffer_load_dwordx4 v10, s[12:15], s47 offen offset:2048 lds
  s_add_u32 m0, s36, s49
  s_nop 0
  buffer_load_dwordx4 v11, s[12:15], s47 offen offset:0 lds
  buffer_load_dwordx4 v12, s[12:15], s47 offen offset:1024 lds
  buffer_load_dwordx4 v13, s[12:15], s47 offen offset:2048 lds
  s_add_u32 s47, s47, 393216
  s_mov_b32 m0, s36
  s_nop 0
  buffer_load_dwordx4 v24, s[8:11], s46 offen offset:0 lds
  buffer_load_dwordx4 v25, s[8:11], s46 offen offset:1024 lds
  buffer_load_dwordx4 v26, s[8:11], s46 offen offset:2048 lds
  buffer_load_dwordx4 v27, s[8:11], s46 offen offset:3072 lds
  s_add_u32 m0, s36, s52
  s_nop 0
  buffer_load_dwordx4 v28, s[8:11], s46 offen offset:0 lds
  s_add_u32 s46, s46, 128
  s_add_u32 m0, s36, s48
  s_add_u32 m0, m0, 45056
  s_nop 0
  buffer_load_dwordx4 v8, s[12:15], s47 offen offset:0 lds
  buffer_load_dwordx4 v9, s[12:15], s47 offen offset:1024 lds
  buffer_load_dwordx4 v10, s[12:15], s47 offen offset:2048 lds
  s_add_u32 m0, s36, s49
  s_add_u32 m0, m0, 45056
  s_nop 0
  buffer_load_dwordx4 v11, s[12:15], s47 offen offset:0 lds
  buffer_load_dwordx4 v12, s[12:15], s47 offen offset:1024 lds
  buffer_load_dwordx4 v13, s[12:15], s47 offen offset:2048 lds
  s_add_u32 s47, s47, 393216
  s_add_u32 m0, s36, 45056
  s_nop 0
  buffer_load_dwordx4 v24, s[8:11], s46 offen offset:0 lds
  buffer_load_dwordx4 v25, s[8:11], s46 offen offset:1024 lds
  buffer_load_dwordx4 v26, s[8:11], s46 offen offset:2048 lds
  buffer_load_dwordx4 v27, s[8:11], s46 offen offset:3072 lds
  s_add_u32 m0, s36, s52
  s_add_u32 m0, m0, 45056
  s_nop 0
  buffer_load_dwordx4 v28, s[8:11], s46 offen offset:0 lds
  s_add_u32 s46, s46, 128
  s_add_u32 m0, s36, s48
  s_add_u32 m0, m0, 90112
  s_nop 0
  buffer_load_dwordx4 v8, s[12:15], s47 offen offset:0 lds
  buffer_load_dwordx4 v9, s[12:15], s47 offen offset:1024 lds
  buffer_load_dwordx4 v10, s[12:15], s47 offen offset:2048 lds
  s_add_u32 m0, s36, s49
  s_add_u32 m0, m0, 90112
  s_nop 0
  buffer_load_dwordx4 v11, s[12:15], s47 offen offset:0 lds
  buffer_load_dwordx4 v12, s[12:15], s47 offen offset:1024 lds
  buffer_load_dwordx4 v13, s[12:15], s47 offen offset:2048 lds
  s_add_u32 s47, s47, 393216
  s_add_u32 m0, s36, 90112
  s_nop 0
  buffer_load_dwordx4 v24, s[8:11], s46 offen offset:0 lds
  buffer_load_dwordx4 v25, s[8:11], s46 offen offset:1024 lds
  buffer_load_dwordx4 v26, s[8:11], s46 offen offset:2048 lds
  buffer_load_dwordx4 v27, s[8:11], s46 offen offset:3072 lds
  s_add_u32 m0, s36, s52
  s_add_u32 m0, m0, 90112
  s_nop 0
  buffer_load_dwordx4 v28, s[8:11], s46 offen offset:0 lds
  s_add_u32 s46, s46, 128
  s_and_b32 s4, s3, 1
  s_lshl_b32 s5, s51, 1
  s_add_u32 s4, s4, s5
  s_lshr_b32 s5, s3, 1
  s_lshl_b32 s6, s50, 1
  s_add_u32 s5, s5, s6
  s_add_u32 s16, s86, 16777216
  s_addc_u32 s17, s87, 0
  s_mov_b32 s18, 33554432
  s_mov_b32 s19, 0x00020000
  s_lshl_b32 s4, s4, 20
  s_lshl_b32 s5, s5, 16
  s_add_u32 s4, s4, s5
  s_add_u32 s4, s4, 0x4000
  v_cvt_pk_bf16_f32 v64, v64, v65
  v_cvt_pk_bf16_f32 v65, v66, v67
  v_cvt_pk_bf16_f32 v66, v96, v97
  v_cvt_pk_bf16_f32 v67, v98, v99
  buffer_store_dwordx4 v[64:67], v2, s[16:19], s4 offen offset:0
  v_cvt_pk_bf16_f32 v68, v68, v69
  v_cvt_pk_bf16_f32 v69, v70, v71
  v_cvt_pk_bf16_f32 v70, v100, v101
  v_cvt_pk_bf16_f32 v71, v102, v103
  buffer_store_dwordx4 v[68:71], v2, s[16:19], s4 offen offset:1024
  v_cvt_pk_bf16_f32 v72, v72, v73
  v_cvt_pk_bf16_f32 v73, v74, v75
  v_cvt_pk_bf16_f32 v74, v104, v105
  v_cvt_pk_bf16_f32 v75, v106, v107
  buffer_store_dwordx4 v[72:75], v2, s[16:19], s4 offen offset:2048
  v_cvt_pk_bf16_f32 v76, v76, v77
  v_cvt_pk_bf16_f32 v77, v78, v79
  v_cvt_pk_bf16_f32 v78, v108, v109
  v_cvt_pk_bf16_f32 v79, v110, v111
  buffer_store_dwordx4 v[76:79], v2, s[16:19], s4 offen offset:3072
  s_add_u32 s4, s4, 4096
  v_cvt_pk_bf16_f32 v80, v80, v81
  v_cvt_pk_bf16_f32 v81, v82, v83
  v_cvt_pk_bf16_f32 v82, v112, v113
  v_cvt_pk_bf16_f32 v83, v114, v115
  buffer_store_dwordx4 v[80:83], v2, s[16:19], s4 offen offset:0
  v_cvt_pk_bf16_f32 v84, v84, v85
  v_cvt_pk_bf16_f32 v85, v86, v87
  v_cvt_pk_bf16_f32 v86, v116, v117
  v_cvt_pk_bf16_f32 v87, v118, v119
  buffer_store_dwordx4 v[84:87], v2, s[16:19], s4 offen offset:1024
  v_cvt_pk_bf16_f32 v88, v88, v89
  v_cvt_pk_bf16_f32 v89, v90, v91
  v_cvt_pk_bf16_f32 v90, v120, v121
  v_cvt_pk_bf16_f32 v91, v122, v123
  buffer_store_dwordx4 v[88:91], v2, s[16:19], s4 offen offset:2048
  v_cvt_pk_bf16_f32 v92, v92, v93
  v_cvt_pk_bf16_f32 v93, v94, v95
  v_cvt_pk_bf16_f32 v94, v124, v125
  v_cvt_pk_bf16_f32 v95, v126, v127
  buffer_store_dwordx4 v[92:95], v2, s[16:19], s4 offen offset:3072
  s_add_u32 s4, s4, 4096
  v_cvt_pk_bf16_f32 v128, v128, v129
  v_cvt_pk_bf16_f32 v129, v130, v131
  v_cvt_pk_bf16_f32 v130, v160, v161
  v_cvt_pk_bf16_f32 v131, v162, v163
  buffer_store_dwordx4 v[128:131], v2, s[16:19], s4 offen offset:0
  v_cvt_pk_bf16_f32 v132, v132, v133
  v_cvt_pk_bf16_f32 v133, v134, v135
  v_cvt_pk_bf16_f32 v134, v164, v165
  v_cvt_pk_bf16_f32 v135, v166, v167
  buffer_store_dwordx4 v[132:135], v2, s[16:19], s4 offen offset:1024
  v_cvt_pk_bf16_f32 v136, v136, v137
  v_cvt_pk_bf16_f32 v137, v138, v139
  v_cvt_pk_bf16_f32 v138, v168, v169
  v_cvt_pk_bf16_f32 v139, v170, v171
  buffer_store_dwordx4 v[136:139], v2, s[16:19], s4 offen offset:2048
  v_cvt_pk_bf16_f32 v140, v140, v141
  v_cvt_pk_bf16_f32 v141, v142, v143
  v_cvt_pk_bf16_f32 v142, v172, v173
  v_cvt_pk_bf16_f32 v143, v174, v175
  buffer_store_dwordx4 v[140:143], v2, s[16:19], s4 offen offset:3072
  s_add_u32 s4, s4, 4096
  v_cvt_pk_bf16_f32 v144, v144, v145
  v_cvt_pk_bf16_f32 v145, v146, v147
  v_cvt_pk_bf16_f32 v146, v176, v177
  v_cvt_pk_bf16_f32 v147, v178, v179
  buffer_store_dwordx4 v[144:147], v2, s[16:19], s4 offen offset:0
  v_cvt_pk_bf16_f32 v148, v148, v149
  v_cvt_pk_bf16_f32 v149, v150, v151
  v_cvt_pk_bf16_f32 v150, v180, v181
  v_cvt_pk_bf16_f32 v151, v182, v183
  buffer_store_dwordx4 v[148:151], v2, s[16:19], s4 offen offset:1024
  v_cvt_pk_bf16_f32 v152, v152, v153
  v_cvt_pk_bf16_f32 v153, v154, v155
  v_cvt_pk_bf16_f32 v154, v184, v185
  v_cvt_pk_bf16_f32 v155, v186, v187
  buffer_store_dwordx4 v[152:155], v2, s[16:19], s4 offen offset:2048
  v_cvt_pk_bf16_f32 v156, v156, v157
  v_cvt_pk_bf16_f32 v157, v158, v159
  v_cvt_pk_bf16_f32 v158, v188, v189
  v_cvt_pk_bf16_f32 v159, v190, v191
  buffer_store_dwordx4 v[156:159], v2, s[16:19], s4 offen offset:3072
  s_add_u32 s4, s4, 20480
  v_cvt_pk_bf16_f32 v192, v192, v193
  v_cvt_pk_bf16_f32 v193, v194, v195
  v_cvt_pk_bf16_f32 v194, v224, v225
  v_cvt_pk_bf16_f32 v195, v226, v227
  buffer_store_dwordx4 v[192:195], v2, s[16:19], s4 offen offset:0
  v_cvt_pk_bf16_f32 v196, v196, v197
  v_cvt_pk_bf16_f32 v197, v198, v199
  v_cvt_pk_bf16_f32 v198, v228, v229
  v_cvt_pk_bf16_f32 v199, v230, v231
  buffer_store_dwordx4 v[196:199], v2, s[16:19], s4 offen offset:1024
  v_cvt_pk_bf16_f32 v200, v200, v201
  v_cvt_pk_bf16_f32 v201, v202, v203
  v_cvt_pk_bf16_f32 v202, v232, v233
  v_cvt_pk_bf16_f32 v203, v234, v235
  buffer_store_dwordx4 v[200:203], v2, s[16:19], s4 offen offset:2048
  v_cvt_pk_bf16_f32 v204, v204, v205
  v_cvt_pk_bf16_f32 v205, v206, v207
  v_cvt_pk_bf16_f32 v206, v236, v237
  v_cvt_pk_bf16_f32 v207, v238, v239
  buffer_store_dwordx4 v[204:207], v2, s[16:19], s4 offen offset:3072
  s_add_u32 s4, s4, 4096
  v_cvt_pk_bf16_f32 v208, v208, v209
  v_cvt_pk_bf16_f32 v209, v210, v211
  v_cvt_pk_bf16_f32 v210, v240, v241
  v_cvt_pk_bf16_f32 v211, v242, v243
  buffer_store_dwordx4 v[208:211], v2, s[16:19], s4 offen offset:0
  v_cvt_pk_bf16_f32 v212, v212, v213
  v_cvt_pk_bf16_f32 v213, v214, v215
  v_cvt_pk_bf16_f32 v214, v244, v245
  v_cvt_pk_bf16_f32 v215, v246, v247
  buffer_store_dwordx4 v[212:215], v2, s[16:19], s4 offen offset:1024
  v_cvt_pk_bf16_f32 v216, v216, v217
  v_cvt_pk_bf16_f32 v217, v218, v219
  v_cvt_pk_bf16_f32 v218, v248, v249
  v_cvt_pk_bf16_f32 v219, v250, v251
  buffer_store_dwordx4 v[216:219], v2, s[16:19], s4 offen offset:2048
  v_cvt_pk_bf16_f32 v220, v220, v221
  v_cvt_pk_bf16_f32 v221, v222, v223
  v_cvt_pk_bf16_f32 v222, v252, v253
  v_cvt_pk_bf16_f32 v223, v254, v255
  buffer_store_dwordx4 v[220:223], v2, s[16:19], s4 offen offset:3072
  s_add_u32 s4, s4, 4096
  v_accvgpr_read_b32 v32, a128
  v_accvgpr_read_b32 v33, a129
  v_accvgpr_read_b32 v34, a130
  v_accvgpr_read_b32 v35, a131
  v_accvgpr_read_b32 v36, a160
  v_accvgpr_read_b32 v37, a161
  v_accvgpr_read_b32 v38, a162
  v_accvgpr_read_b32 v39, a163
  v_cvt_pk_bf16_f32 v48, v32, v33
  v_cvt_pk_bf16_f32 v49, v34, v35
  v_cvt_pk_bf16_f32 v50, v36, v37
  v_cvt_pk_bf16_f32 v51, v38, v39
  buffer_store_dwordx4 v[48:51], v2, s[16:19], s4 offen offset:0
  v_accvgpr_read_b32 v40, a132
  v_accvgpr_read_b32 v41, a133
  v_accvgpr_read_b32 v42, a134
  v_accvgpr_read_b32 v43, a135
  v_accvgpr_read_b32 v44, a164
  v_accvgpr_read_b32 v45, a165
  v_accvgpr_read_b32 v46, a166
  v_accvgpr_read_b32 v47, a167
  v_cvt_pk_bf16_f32 v52, v40, v41
  v_cvt_pk_bf16_f32 v53, v42, v43
  v_cvt_pk_bf16_f32 v54, v44, v45
  v_cvt_pk_bf16_f32 v55, v46, v47
  buffer_store_dwordx4 v[52:55], v2, s[16:19], s4 offen offset:1024
  v_accvgpr_read_b32 v32, a136
  v_accvgpr_read_b32 v33, a137
  v_accvgpr_read_b32 v34, a138
  v_accvgpr_read_b32 v35, a139
  v_accvgpr_read_b32 v36, a168
  v_accvgpr_read_b32 v37, a169
  v_accvgpr_read_b32 v38, a170
  v_accvgpr_read_b32 v39, a171
  v_cvt_pk_bf16_f32 v56, v32, v33
  v_cvt_pk_bf16_f32 v57, v34, v35
  v_cvt_pk_bf16_f32 v58, v36, v37
  v_cvt_pk_bf16_f32 v59, v38, v39
  buffer_store_dwordx4 v[56:59], v2, s[16:19], s4 offen offset:2048
  v_accvgpr_read_b32 v40, a140
  v_accvgpr_read_b32 v41, a141
  v_accvgpr_read_b32 v42, a142
  v_accvgpr_read_b32 v43, a143
  v_accvgpr_read_b32 v44, a172
  v_accvgpr_read_b32 v45, a173
  v_accvgpr_read_b32 v46, a174
  v_accvgpr_read_b32 v47, a175
  v_cvt_pk_bf16_f32 v60, v40, v41
  v_cvt_pk_bf16_f32 v61, v42, v43
  v_cvt_pk_bf16_f32 v62, v44, v45
  v_cvt_pk_bf16_f32 v63, v46, v47
  buffer_store_dwordx4 v[60:63], v2, s[16:19], s4 offen offset:3072
  s_add_u32 s4, s4, 4096
  v_accvgpr_read_b32 v32, a144
  v_accvgpr_read_b32 v33, a145
  v_accvgpr_read_b32 v34, a146
  v_accvgpr_read_b32 v35, a147
  v_accvgpr_read_b32 v36, a176
  v_accvgpr_read_b32 v37, a177
  v_accvgpr_read_b32 v38, a178
  v_accvgpr_read_b32 v39, a179
  v_cvt_pk_bf16_f32 v48, v32, v33
  v_cvt_pk_bf16_f32 v49, v34, v35
  v_cvt_pk_bf16_f32 v50, v36, v37
  v_cvt_pk_bf16_f32 v51, v38, v39
  buffer_store_dwordx4 v[48:51], v2, s[16:19], s4 offen offset:0
  v_accvgpr_read_b32 v40, a148
  v_accvgpr_read_b32 v41, a149
  v_accvgpr_read_b32 v42, a150
  v_accvgpr_read_b32 v43, a151
  v_accvgpr_read_b32 v44, a180
  v_accvgpr_read_b32 v45, a181
  v_accvgpr_read_b32 v46, a182
  v_accvgpr_read_b32 v47, a183
  v_cvt_pk_bf16_f32 v52, v40, v41
  v_cvt_pk_bf16_f32 v53, v42, v43
  v_cvt_pk_bf16_f32 v54, v44, v45
  v_cvt_pk_bf16_f32 v55, v46, v47
  buffer_store_dwordx4 v[52:55], v2, s[16:19], s4 offen offset:1024
  v_accvgpr_read_b32 v32, a152
  v_accvgpr_read_b32 v33, a153
  v_accvgpr_read_b32 v34, a154
  v_accvgpr_read_b32 v35, a155
  v_accvgpr_read_b32 v36, a184
  v_accvgpr_read_b32 v37, a185
  v_accvgpr_read_b32 v38, a186
  v_accvgpr_read_b32 v39, a187
  v_cvt_pk_bf16_f32 v56, v32, v33
  v_cvt_pk_bf16_f32 v57, v34, v35
  v_cvt_pk_bf16_f32 v58, v36, v37
  v_cvt_pk_bf16_f32 v59, v38, v39
  buffer_store_dwordx4 v[56:59], v2, s[16:19], s4 offen offset:2048
  v_accvgpr_read_b32 v40, a156
  v_accvgpr_read_b32 v41, a157
  v_accvgpr_read_b32 v42, a158
  v_accvgpr_read_b32 v43, a159
  v_accvgpr_read_b32 v44, a188
  v_accvgpr_read_b32 v45, a189
  v_accvgpr_read_b32 v46, a190
  v_accvgpr_read_b32 v47, a191
  v_cvt_pk_bf16_f32 v60, v40, v41
  v_cvt_pk_bf16_f32 v61, v42, v43
  v_cvt_pk_bf16_f32 v62, v44, v45
  v_cvt_pk_bf16_f32 v63, v46, v47
  buffer_store_dwordx4 v[60:63], v2, s[16:19], s4 offen offset:3072
  s_branch Lp1_done
Lp1_qe:
  s_and_b32 s4, s2, 1
  s_lshl_b32 s4, s4, 3
  s_bfe_u32 s5, s2, 0x30003
  s_add_u32 s54, s4, s5
  s_bfe_u32 s4, s2, 0x20001
  s_lshl_b32 s4, s4, 2
  s_lshr_b32 s5, s2, 6
  s_add_u32 s55, s4, s5
  s_lshl_b32 s4, s54, 18
  s_add_u32 s8, s76, s4
  s_addc_u32 s9, s77, 0
  s_sub_u32 s8, s8, 32768
  s_subb_u32 s9, s9, 0
  s_mov_b32 s10, 294912
  s_mov_b32 s11, 0x00020000
  s_mov_b32 s12, s78
  s_mov_b32 s13, s79
  s_mov_b32 s14, 6291456
  s_mov_b32 s15, 0x00020000
  s_mov_b32 s46, 0
  s_lshl_b32 s47, s55, 7
  s_lshl_b32 s36, s3, 12
  s_lshl_b32 s4, s3, 11
  s_add_u32 s48, s4, 20480
  s_add_u32 s49, s48, 3072
  s_mul_i32 s4, s3, 3072
  s_sub_u32 s52, 16384, s4
  v_lshrrev_b32 v32, 3, v1
  v_and_b32 v33, 6, v32
  v_and_b32 v34, 7, v1
  v_xor_b32 v33, v33, v34
  v_lshlrev_b32 v33, 4, v33
  s_lshl_b32 s4, s3, 5
  s_add_u32 s4, s4, 16
  v_add_u32 v34, s4, v32
  v_lshl_add_u32 v34, v34, 11, v33
  v_add_u32 v24, 0, v34
  v_add_u32 v25, 15360, v34
  v_add_u32 v26, 30720, v34
  v_add_u32 v27, 46080, v34
  s_lshl_b32 s4, s3, 14
  s_cmp_ge_u32 s3, 2
  s_cselect_b32 s4, 0x40000000, s4
  s_cmp_eq_u32 s54, 0
  s_cselect_b32 s4, 0x40000000, s4
  v_lshl_add_u32 v34, v32, 11, v33
  v_add_u32 v28, s4, v34
  v_lshrrev_b32 v34, 2, v32
  v_and_b32 v35, 3, v32
  v_lshl_add_u32 v34, v34, 3, v35
  v_mul_u32_u24 v34, 6144, v34
  v_add_u32 v34, v34, v33
  s_mul_i32 s6, s3, 6
  s_add_u32 s7, s6, 0
  s_bfe_u32 s4, s7, 0x10002
  s_lshl_b32 s4, s4, 5
  s_and_b32 s5, s7, 1
  s_lshl_b32 s5, s5, 4
  s_add_u32 s4, s4, s5
  s_bfe_u32 s5, s7, 0x10001
  s_lshl_b32 s5, s5, 2
  s_add_u32 s4, s4, s5
  s_mul_i32 s4, s4, 6144
  s_lshr_b32 s5, s7, 3
  s_lshl_b32 s5, s5, 11
  s_add_u32 s4, s4, s5
  s_add_u32 s4, s4, 2048
  v_add_u32 v8, s4, v34
  s_add_u32 s7, s6, 1
  s_bfe_u32 s4, s7, 0x10002
  s_lshl_b32 s4, s4, 5
  s_and_b32 s5, s7, 1
  s_lshl_b32 s5, s5, 4
  s_add_u32 s4, s4, s5
  s_bfe_u32 s5, s7, 0x10001
  s_lshl_b32 s5, s5, 2
  s_add_u32 s4, s4, s5
  s_mul_i32 s4, s4, 6144
  s_lshr_b32 s5, s7, 3
  s_lshl_b32 s5, s5, 11
  s_add_u32 s4, s4, s5
  s_add_u32 s4, s4, 1024
  v_add_u32 v9, s4, v34
  s_add_u32 s7, s6, 2
  s_bfe_u32 s4, s7, 0x10002
  s_lshl_b32 s4, s4, 5
  s_and_b32 s5, s7, 1
  s_lshl_b32 s5, s5, 4
  s_add_u32 s4, s4, s5
  s_bfe_u32 s5, s7, 0x10001
  s_lshl_b32 s5, s5, 2
  s_add_u32 s4, s4, s5
  s_mul_i32 s4, s4, 6144
  s_lshr_b32 s5, s7, 3
  s_lshl_b32 s5, s5, 11
  s_add_u32 s4, s4, s5
  s_add_u32 s4, s4, 0
  v_add_u32 v10, s4, v34
  s_add_u32 s7, s6, 3
  s_bfe_u32 s4, s7, 0x10002
  s_lshl_b32 s4, s4, 5
  s_and_b32 s5, s7, 1
  s_lshl_b32 s5, s5, 4
  s_add_u32 s4, s4, s5
  s_bfe_u32 s5, s7, 0x10001
  s_lshl_b32 s5, s5, 2
  s_add_u32 s4, s4, s5
  s_mul_i32 s4, s4, 6144
  s_lshr_b32 s5, s7, 3
  s_lshl_b32 s5, s5, 11
  s_add_u32 s4, s4, s5
  s_add_u32 s4, s4, 2048
  v_add_u32 v11, s4, v34
  s_add_u32 s7, s6, 4
  s_bfe_u32 s4, s7, 0x10002
  s_lshl_b32 s4, s4, 5
  s_and_b32 s5, s7, 1
  s_lshl_b32 s5, s5, 4
  s_add_u32 s4, s4, s5
  s_bfe_u32 s5, s7, 0x10001
  s_lshl_b32 s5, s5, 2
  s_add_u32 s4, s4, s5
  s_mul_i32 s4, s4, 6144
  s_lshr_b32 s5, s7, 3
  s_lshl_b32 s5, s5, 11
  s_add_u32 s4, s4, s5
  s_add_u32 s4, s4, 1024
  v_add_u32 v12, s4, v34
  s_add_u32 s7, s6, 5
  s_bfe_u32 s4, s7, 0x10002
  s_lshl_b32 s4, s4, 5
  s_and_b32 s5, s7, 1
  s_lshl_b32 s5, s5, 4
  s_add_u32 s4, s4, s5
  s_bfe_u32 s5, s7, 0x10001
  s_lshl_b32 s5, s5, 2
  s_add_u32 s4, s4, s5
  s_mul_i32 s4, s4, 6144
  s_lshr_b32 s5, s7, 3
  s_lshl_b32 s5, s5, 11
  s_add_u32 s4, s4, s5
  s_add_u32 s4, s4, 0
  v_add_u32 v13, s4, v34
  s_sub_u32 s12, s12, 2048
  s_subb_u32 s13, s13, 0
  s_add_u32 s14, s14, 2048
  s_add_u32 m0, s36, s48
  s_nop 0
  buffer_load_dwordx4 v8, s[12:15], s47 offen offset:0 lds
  buffer_load_dwordx4 v9, s[12:15], s47 offen offset:1024 lds
  buffer_load_dwordx4 v10, s[12:15], s47 offen offset:2048 lds
  s_add_u32 m0, s36, s49
  s_nop 0
  buffer_load_dwordx4 v11, s[12:15], s47 offen offset:0 lds
  buffer_load_dwordx4 v12, s[12:15], s47 offen offset:1024 lds
  buffer_load_dwordx4 v13, s[12:15], s47 offen offset:2048 lds
  s_add_u32 s47, s47, 393216
  s_mov_b32 m0, s36
  s_nop 0
  buffer_load_dwordx4 v24, s[8:11], s46 offen offset:0 lds
  buffer_load_dwordx4 v25, s[8:11], s46 offen offset:1024 lds
  buffer_load_dwordx4 v26, s[8:11], s46 offen offset:2048 lds
  buffer_load_dwordx4 v27, s[8:11], s46 offen offset:3072 lds
  s_add_u32 m0, s36, s52
  s_nop 0
  buffer_load_dwordx4 v28, s[8:11], s46 offen offset:0 lds
  s_add_u32 s46, s46, 128
  s_add_u32 m0, s36, s48
  s_add_u32 m0, m0, 45056
  s_nop 0
  buffer_load_dwordx4 v8, s[12:15], s47 offen offset:0 lds
  buffer_load_dwordx4 v9, s[12:15], s47 offen offset:1024 lds
  buffer_load_dwordx4 v10, s[12:15], s47 offen offset:2048 lds
  s_add_u32 m0, s36, s49
  s_add_u32 m0, m0, 45056
  s_nop 0
  buffer_load_dwordx4 v11, s[12:15], s47 offen offset:0 lds
  buffer_load_dwordx4 v12, s[12:15], s47 offen offset:1024 lds
  buffer_load_dwordx4 v13, s[12:15], s47 offen offset:2048 lds
  s_add_u32 s47, s47, 393216
  s_add_u32 m0, s36, 45056
  s_nop 0
  buffer_load_dwordx4 v24, s[8:11], s46 offen offset:0 lds
  buffer_load_dwordx4 v25, s[8:11], s46 offen offset:1024 lds
  buffer_load_dwordx4 v26, s[8:11], s46 offen offset:2048 lds
  buffer_load_dwordx4 v27, s[8:11], s46 offen offset:3072 lds
  s_add_u32 m0, s36, s52
  s_add_u32 m0, m0, 45056
  s_nop 0
  buffer_load_dwordx4 v28, s[8:11], s46 offen offset:0 lds
  s_add_u32 s46, s46, 128
  s_add_u32 m0, s36, s48
  s_add_u32 m0, m0, 90112
  s_nop 0
  buffer_load_dwordx4 v8, s[12:15], s47 offen offset:0 lds
  buffer_load_dwordx4 v9, s[12:15], s47 offen offset:1024 lds
  buffer_load_dwordx4 v10, s[12:15], s47 offen offset:2048 lds
  s_add_u32 m0, s36, s49
  s_add_u32 m0, m0, 90112
  s_nop 0
  buffer_load_dwordx4 v11, s[12:15], s47 offen offset:0 lds
  buffer_load_dwordx4 v12, s[12:15], s47 offen offset:1024 lds
  buffer_load_dwordx4 v13, s[12:15], s47 offen offset:2048 lds
  s_add_u32 s47, s47, 393216
  s_add_u32 m0, s36, 90112
  s_nop 0
  buffer_load_dwordx4 v24, s[8:11], s46 offen offset:0 lds
  buffer_load_dwordx4 v25, s[8:11], s46 offen offset:1024 lds
  buffer_load_dwordx4 v26, s[8:11], s46 offen offset:2048 lds
  buffer_load_dwordx4 v27, s[8:11], s46 offen offset:3072 lds
  s_add_u32 m0, s36, s52
  s_add_u32 m0, m0, 90112
  s_nop 0
  buffer_load_dwordx4 v28, s[8:11], s46 offen offset:0 lds
  s_add_u32 s46, s46, 128
  s_and_b32 s4, s3, 1
  s_lshl_b32 s5, s51, 1
  s_add_u32 s4, s4, s5
  s_lshr_b32 s5, s3, 1
  s_lshl_b32 s6, s50, 1
  s_add_u32 s5, s5, s6
  s_mov_b32 s16, s86
  s_mov_b32 s17, s87
  s_mov_b32 s18, 16777216
  s_mov_b32 s19, 0x00020000
  s_lshl_b32 s4, s4, 15
  s_lshl_b32 s5, s5, 20
  s_mov_b32 s6, 0x3e0293ee
  s_mov_b32 s7, s6
  s_add_u32 s4, s4, s5
  v_pk_mul_f32 v[64:65], v[64:65], s[6:7]
  v_pk_mul_f32 v[66:67], v[66:67], s[6:7]
  v_pk_mul_f32 v[68:69], v[68:69], s[6:7]
  v_pk_mul_f32 v[70:71], v[70:71], s[6:7]
  v_cvt_pk_bf16_f32 v64, v64, v65
  v_cvt_pk_bf16_f32 v65, v66, v67
  v_cvt_pk_bf16_f32 v66, v68, v69
  v_cvt_pk_bf16_f32 v67, v70, v71
  buffer_store_dwordx4 v[64:67], v2, s[16:19], s4 offen offset:0
  v_pk_mul_f32 v[72:73], v[72:73], s[6:7]
  v_pk_mul_f32 v[74:75], v[74:75], s[6:7]
  v_pk_mul_f32 v[76:77], v[76:77], s[6:7]
  v_pk_mul_f32 v[78:79], v[78:79], s[6:7]
  v_cvt_pk_bf16_f32 v72, v72, v73
  v_cvt_pk_bf16_f32 v73, v74, v75
  v_cvt_pk_bf16_f32 v74, v76, v77
  v_cvt_pk_bf16_f32 v75, v78, v79
  buffer_store_dwordx4 v[72:75], v2, s[16:19], s4 offen offset:1024
  v_pk_mul_f32 v[80:81], v[80:81], s[6:7]
  v_pk_mul_f32 v[82:83], v[82:83], s[6:7]
  v_pk_mul_f32 v[84:85], v[84:85], s[6:7]
  v_pk_mul_f32 v[86:87], v[86:87], s[6:7]
  v_cvt_pk_bf16_f32 v80, v80, v81
  v_cvt_pk_bf16_f32 v81, v82, v83
  v_cvt_pk_bf16_f32 v82, v84, v85
  v_cvt_pk_bf16_f32 v83, v86, v87
  buffer_store_dwordx4 v[80:83], v2, s[16:19], s4 offen offset:2048
  v_pk_mul_f32 v[88:89], v[88:89], s[6:7]
  v_pk_mul_f32 v[90:91], v[90:91], s[6:7]
  v_pk_mul_f32 v[92:93], v[92:93], s[6:7]
  v_pk_mul_f32 v[94:95], v[94:95], s[6:7]
  v_cvt_pk_bf16_f32 v88, v88, v89
  v_cvt_pk_bf16_f32 v89, v90, v91
  v_cvt_pk_bf16_f32 v90, v92, v93
  v_cvt_pk_bf16_f32 v91, v94, v95
  buffer_store_dwordx4 v[88:91], v2, s[16:19], s4 offen offset:3072
  s_add_u32 s4, s4, 4096
  v_pk_mul_f32 v[96:97], v[96:97], s[6:7]
  v_pk_mul_f32 v[98:99], v[98:99], s[6:7]
  v_pk_mul_f32 v[100:101], v[100:101], s[6:7]
  v_pk_mul_f32 v[102:103], v[102:103], s[6:7]
  v_cvt_pk_bf16_f32 v96, v96, v97
  v_cvt_pk_bf16_f32 v97, v98, v99
  v_cvt_pk_bf16_f32 v98, v100, v101
  v_cvt_pk_bf16_f32 v99, v102, v103
  buffer_store_dwordx4 v[96:99], v2, s[16:19], s4 offen offset:0
  v_pk_mul_f32 v[104:105], v[104:105], s[6:7]
  v_pk_mul_f32 v[106:107], v[106:107], s[6:7]
  v_pk_mul_f32 v[108:109], v[108:109], s[6:7]
  v_pk_mul_f32 v[110:111], v[110:111], s[6:7]
  v_cvt_pk_bf16_f32 v104, v104, v105
  v_cvt_pk_bf16_f32 v105, v106, v107
  v_cvt_pk_bf16_f32 v106, v108, v109
  v_cvt_pk_bf16_f32 v107, v110, v111
  buffer_store_dwordx4 v[104:107], v2, s[16:19], s4 offen offset:1024
  v_pk_mul_f32 v[112:113], v[112:113], s[6:7]
  v_pk_mul_f32 v[114:115], v[114:115], s[6:7]
  v_pk_mul_f32 v[116:117], v[116:117], s[6:7]
  v_pk_mul_f32 v[118:119], v[118:119], s[6:7]
  v_cvt_pk_bf16_f32 v112, v112, v113
  v_cvt_pk_bf16_f32 v113, v114, v115
  v_cvt_pk_bf16_f32 v114, v116, v117
  v_cvt_pk_bf16_f32 v115, v118, v119
  buffer_store_dwordx4 v[112:115], v2, s[16:19], s4 offen offset:2048
  v_pk_mul_f32 v[120:121], v[120:121], s[6:7]
  v_pk_mul_f32 v[122:123], v[122:123], s[6:7]
  v_pk_mul_f32 v[124:125], v[124:125], s[6:7]
  v_pk_mul_f32 v[126:127], v[126:127], s[6:7]
  v_cvt_pk_bf16_f32 v120, v120, v121
  v_cvt_pk_bf16_f32 v121, v122, v123
  v_cvt_pk_bf16_f32 v122, v124, v125
  v_cvt_pk_bf16_f32 v123, v126, v127
  buffer_store_dwordx4 v[120:123], v2, s[16:19], s4 offen offset:3072
  s_add_u32 s4, s4, 4096
  v_pk_mul_f32 v[128:129], v[128:129], s[6:7]
  v_pk_mul_f32 v[130:131], v[130:131], s[6:7]
  v_pk_mul_f32 v[132:133], v[132:133], s[6:7]
  v_pk_mul_f32 v[134:135], v[134:135], s[6:7]
  v_cvt_pk_bf16_f32 v128, v128, v129
  v_cvt_pk_bf16_f32 v129, v130, v131
  v_cvt_pk_bf16_f32 v130, v132, v133
  v_cvt_pk_bf16_f32 v131, v134, v135
  buffer_store_dwordx4 v[128:131], v2, s[16:19], s4 offen offset:0
  v_pk_mul_f32 v[136:137], v[136:137], s[6:7]
  v_pk_mul_f32 v[138:139], v[138:139], s[6:7]
  v_pk_mul_f32 v[140:141], v[140:141], s[6:7]
  v_pk_mul_f32 v[142:143], v[142:143], s[6:7]
  v_cvt_pk_bf16_f32 v136, v136, v137
  v_cvt_pk_bf16_f32 v137, v138, v139
  v_cvt_pk_bf16_f32 v138, v140, v141
  v_cvt_pk_bf16_f32 v139, v142, v143
  buffer_store_dwordx4 v[136:139], v2, s[16:19], s4 offen offset:1024
  v_pk_mul_f32 v[144:145], v[144:145], s[6:7]
  v_pk_mul_f32 v[146:147], v[146:147], s[6:7]
  v_pk_mul_f32 v[148:149], v[148:149], s[6:7]
  v_pk_mul_f32 v[150:151], v[150:151], s[6:7]
  v_cvt_pk_bf16_f32 v144, v144, v145
  v_cvt_pk_bf16_f32 v145, v146, v147
  v_cvt_pk_bf16_f32 v146, v148, v149
  v_cvt_pk_bf16_f32 v147, v150, v151
  buffer_store_dwordx4 v[144:147], v2, s[16:19], s4 offen offset:2048
  v_pk_mul_f32 v[152:153], v[152:153], s[6:7]
  v_pk_mul_f32 v[154:155], v[154:155], s[6:7]
  v_pk_mul_f32 v[156:157], v[156:157], s[6:7]
  v_pk_mul_f32 v[158:159], v[158:159], s[6:7]
  v_cvt_pk_bf16_f32 v152, v152, v153
  v_cvt_pk_bf16_f32 v153, v154, v155
  v_cvt_pk_bf16_f32 v154, v156, v157
  v_cvt_pk_bf16_f32 v155, v158, v159
  buffer_store_dwordx4 v[152:155], v2, s[16:19], s4 offen offset:3072
  s_add_u32 s4, s4, 4096
  v_pk_mul_f32 v[160:161], v[160:161], s[6:7]
  v_pk_mul_f32 v[162:163], v[162:163], s[6:7]
  v_pk_mul_f32 v[164:165], v[164:165], s[6:7]
  v_pk_mul_f32 v[166:167], v[166:167], s[6:7]
  v_cvt_pk_bf16_f32 v160, v160, v161
  v_cvt_pk_bf16_f32 v161, v162, v163
  v_cvt_pk_bf16_f32 v162, v164, v165
  v_cvt_pk_bf16_f32 v163, v166, v167
  buffer_store_dwordx4 v[160:163], v2, s[16:19], s4 offen offset:0
  v_pk_mul_f32 v[168:169], v[168:169], s[6:7]
  v_pk_mul_f32 v[170:171], v[170:171], s[6:7]
  v_pk_mul_f32 v[172:173], v[172:173], s[6:7]
  v_pk_mul_f32 v[174:175], v[174:175], s[6:7]
  v_cvt_pk_bf16_f32 v168, v168, v169
  v_cvt_pk_bf16_f32 v169, v170, v171
  v_cvt_pk_bf16_f32 v170, v172, v173
  v_cvt_pk_bf16_f32 v171, v174, v175
  buffer_store_dwordx4 v[168:171], v2, s[16:19], s4 offen offset:1024
  v_pk_mul_f32 v[176:177], v[176:177], s[6:7]
  v_pk_mul_f32 v[178:179], v[178:179], s[6:7]
  v_pk_mul_f32 v[180:181], v[180:181], s[6:7]
  v_pk_mul_f32 v[182:183], v[182:183], s[6:7]
  v_cvt_pk_bf16_f32 v176, v176, v177
  v_cvt_pk_bf16_f32 v177, v178, v179
  v_cvt_pk_bf16_f32 v178, v180, v181
  v_cvt_pk_bf16_f32 v179, v182, v183
  buffer_store_dwordx4 v[176:179], v2, s[16:19], s4 offen offset:2048
  v_pk_mul_f32 v[184:185], v[184:185], s[6:7]
  v_pk_mul_f32 v[186:187], v[186:187], s[6:7]
  v_pk_mul_f32 v[188:189], v[188:189], s[6:7]
  v_pk_mul_f32 v[190:191], v[190:191], s[6:7]
  v_cvt_pk_bf16_f32 v184, v184, v185
  v_cvt_pk_bf16_f32 v185, v186, v187
  v_cvt_pk_bf16_f32 v186, v188, v189
  v_cvt_pk_bf16_f32 v187, v190, v191
  buffer_store_dwordx4 v[184:187], v2, s[16:19], s4 offen offset:3072
  s_add_u32 s4, s4, 4096
  v_pk_mul_f32 v[192:193], v[192:193], s[6:7]
  v_pk_mul_f32 v[194:195], v[194:195], s[6:7]
  v_pk_mul_f32 v[196:197], v[196:197], s[6:7]
  v_pk_mul_f32 v[198:199], v[198:199], s[6:7]
  v_cvt_pk_bf16_f32 v192, v192, v193
  v_cvt_pk_bf16_f32 v193, v194, v195
  v_cvt_pk_bf16_f32 v194, v196, v197
  v_cvt_pk_bf16_f32 v195, v198, v199
  buffer_store_dwordx4 v[192:195], v2, s[16:19], s4 offen offset:0
  v_pk_mul_f32 v[200:201], v[200:201], s[6:7]
  v_pk_mul_f32 v[202:203], v[202:203], s[6:7]
  v_pk_mul_f32 v[204:205], v[204:205], s[6:7]
  v_pk_mul_f32 v[206:207], v[206:207], s[6:7]
  v_cvt_pk_bf16_f32 v200, v200, v201
  v_cvt_pk_bf16_f32 v201, v202, v203
  v_cvt_pk_bf16_f32 v202, v204, v205
  v_cvt_pk_bf16_f32 v203, v206, v207
  buffer_store_dwordx4 v[200:203], v2, s[16:19], s4 offen offset:1024
  v_pk_mul_f32 v[208:209], v[208:209], s[6:7]
  v_pk_mul_f32 v[210:211], v[210:211], s[6:7]
  v_pk_mul_f32 v[212:213], v[212:213], s[6:7]
  v_pk_mul_f32 v[214:215], v[214:215], s[6:7]
  v_cvt_pk_bf16_f32 v208, v208, v209
  v_cvt_pk_bf16_f32 v209, v210, v211
  v_cvt_pk_bf16_f32 v210, v212, v213
  v_cvt_pk_bf16_f32 v211, v214, v215
  buffer_store_dwordx4 v[208:211], v2, s[16:19], s4 offen offset:2048
  v_pk_mul_f32 v[216:217], v[216:217], s[6:7]
  v_pk_mul_f32 v[218:219], v[218:219], s[6:7]
  v_pk_mul_f32 v[220:221], v[220:221], s[6:7]
  v_pk_mul_f32 v[222:223], v[222:223], s[6:7]
  v_cvt_pk_bf16_f32 v216, v216, v217
  v_cvt_pk_bf16_f32 v217, v218, v219
  v_cvt_pk_bf16_f32 v218, v220, v221
  v_cvt_pk_bf16_f32 v219, v222, v223
  buffer_store_dwordx4 v[216:219], v2, s[16:19], s4 offen offset:3072
  s_add_u32 s4, s4, 4096
  v_pk_mul_f32 v[224:225], v[224:225], s[6:7]
  v_pk_mul_f32 v[226:227], v[226:227], s[6:7]
  v_pk_mul_f32 v[228:229], v[228:229], s[6:7]
  v_pk_mul_f32 v[230:231], v[230:231], s[6:7]
  v_cvt_pk_bf16_f32 v224, v224, v225
  v_cvt_pk_bf16_f32 v225, v226, v227
  v_cvt_pk_bf16_f32 v226, v228, v229
  v_cvt_pk_bf16_f32 v227, v230, v231
  buffer_store_dwordx4 v[224:227], v2, s[16:19], s4 offen offset:0
  v_pk_mul_f32 v[232:233], v[232:233], s[6:7]
  v_pk_mul_f32 v[234:235], v[234:235], s[6:7]
  v_pk_mul_f32 v[236:237], v[236:237], s[6:7]
  v_pk_mul_f32 v[238:239], v[238:239], s[6:7]
  v_cvt_pk_bf16_f32 v232, v232, v233
  v_cvt_pk_bf16_f32 v233, v234, v235
  v_cvt_pk_bf16_f32 v234, v236, v237
  v_cvt_pk_bf16_f32 v235, v238, v239
  buffer_store_dwordx4 v[232:235], v2, s[16:19], s4 offen offset:1024
  v_pk_mul_f32 v[240:241], v[240:241], s[6:7]
  v_pk_mul_f32 v[242:243], v[242:243], s[6:7]
  v_pk_mul_f32 v[244:245], v[244:245], s[6:7]
  v_pk_mul_f32 v[246:247], v[246:247], s[6:7]
  v_cvt_pk_bf16_f32 v240, v240, v241
  v_cvt_pk_bf16_f32 v241, v242, v243
  v_cvt_pk_bf16_f32 v242, v244, v245
  v_cvt_pk_bf16_f32 v243, v246, v247
  buffer_store_dwordx4 v[240:243], v2, s[16:19], s4 offen offset:2048
  v_pk_mul_f32 v[248:249], v[248:249], s[6:7]
  v_pk_mul_f32 v[250:251], v[250:251], s[6:7]
  v_pk_mul_f32 v[252:253], v[252:253], s[6:7]
  v_pk_mul_f32 v[254:255], v[254:255], s[6:7]
  v_cvt_pk_bf16_f32 v248, v248, v249
  v_cvt_pk_bf16_f32 v249, v250, v251
  v_cvt_pk_bf16_f32 v250, v252, v253
  v_cvt_pk_bf16_f32 v251, v254, v255
  buffer_store_dwordx4 v[248:251], v2, s[16:19], s4 offen offset:3072
  s_add_u32 s4, s4, 4096
  v_accvgpr_read_b32 v32, a128
  v_accvgpr_read_b32 v33, a129
  v_accvgpr_read_b32 v34, a130
  v_accvgpr_read_b32 v35, a131
  v_accvgpr_read_b32 v36, a132
  v_accvgpr_read_b32 v37, a133
  v_accvgpr_read_b32 v38, a134
  v_accvgpr_read_b32 v39, a135
  v_pk_mul_f32 v[32:33], v[32:33], s[6:7]
  v_pk_mul_f32 v[34:35], v[34:35], s[6:7]
  v_pk_mul_f32 v[36:37], v[36:37], s[6:7]
  v_pk_mul_f32 v[38:39], v[38:39], s[6:7]
  v_cvt_pk_bf16_f32 v48, v32, v33
  v_cvt_pk_bf16_f32 v49, v34, v35
  v_cvt_pk_bf16_f32 v50, v36, v37
  v_cvt_pk_bf16_f32 v51, v38, v39
  buffer_store_dwordx4 v[48:51], v2, s[16:19], s4 offen offset:0
  v_accvgpr_read_b32 v40, a136
  v_accvgpr_read_b32 v41, a137
  v_accvgpr_read_b32 v42, a138
  v_accvgpr_read_b32 v43, a139
  v_accvgpr_read_b32 v44, a140
  v_accvgpr_read_b32 v45, a141
  v_accvgpr_read_b32 v46, a142
  v_accvgpr_read_b32 v47, a143
  v_pk_mul_f32 v[40:41], v[40:41], s[6:7]
  v_pk_mul_f32 v[42:43], v[42:43], s[6:7]
  v_pk_mul_f32 v[44:45], v[44:45], s[6:7]
  v_pk_mul_f32 v[46:47], v[46:47], s[6:7]
  v_cvt_pk_bf16_f32 v52, v40, v41
  v_cvt_pk_bf16_f32 v53, v42, v43
  v_cvt_pk_bf16_f32 v54, v44, v45
  v_cvt_pk_bf16_f32 v55, v46, v47
  buffer_store_dwordx4 v[52:55], v2, s[16:19], s4 offen offset:1024
  v_accvgpr_read_b32 v32, a144
  v_accvgpr_read_b32 v33, a145
  v_accvgpr_read_b32 v34, a146
  v_accvgpr_read_b32 v35, a147
  v_accvgpr_read_b32 v36, a148
  v_accvgpr_read_b32 v37, a149
  v_accvgpr_read_b32 v38, a150
  v_accvgpr_read_b32 v39, a151
  v_pk_mul_f32 v[32:33], v[32:33], s[6:7]
  v_pk_mul_f32 v[34:35], v[34:35], s[6:7]
  v_pk_mul_f32 v[36:37], v[36:37], s[6:7]
  v_pk_mul_f32 v[38:39], v[38:39], s[6:7]
  v_cvt_pk_bf16_f32 v56, v32, v33
  v_cvt_pk_bf16_f32 v57, v34, v35
  v_cvt_pk_bf16_f32 v58, v36, v37
  v_cvt_pk_bf16_f32 v59, v38, v39
  buffer_store_dwordx4 v[56:59], v2, s[16:19], s4 offen offset:2048
  v_accvgpr_read_b32 v40, a152
  v_accvgpr_read_b32 v41, a153
  v_accvgpr_read_b32 v42, a154
  v_accvgpr_read_b32 v43, a155
  v_accvgpr_read_b32 v44, a156
  v_accvgpr_read_b32 v45, a157
  v_accvgpr_read_b32 v46, a158
  v_accvgpr_read_b32 v47, a159
  v_pk_mul_f32 v[40:41], v[40:41], s[6:7]
  v_pk_mul_f32 v[42:43], v[42:43], s[6:7]
  v_pk_mul_f32 v[44:45], v[44:45], s[6:7]
  v_pk_mul_f32 v[46:47], v[46:47], s[6:7]
  v_cvt_pk_bf16_f32 v60, v40, v41
  v_cvt_pk_bf16_f32 v61, v42, v43
  v_cvt_pk_bf16_f32 v62, v44, v45
  v_cvt_pk_bf16_f32 v63, v46, v47
  buffer_store_dwordx4 v[60:63], v2, s[16:19], s4 offen offset:3072
  s_add_u32 s4, s4, 4096
  v_accvgpr_read_b32 v32, a160
  v_accvgpr_read_b32 v33, a161
  v_accvgpr_read_b32 v34, a162
  v_accvgpr_read_b32 v35, a163
  v_accvgpr_read_b32 v36, a164
  v_accvgpr_read_b32 v37, a165
  v_accvgpr_read_b32 v38, a166
  v_accvgpr_read_b32 v39, a167
  v_pk_mul_f32 v[32:33], v[32:33], s[6:7]
  v_pk_mul_f32 v[34:35], v[34:35], s[6:7]
  v_pk_mul_f32 v[36:37], v[36:37], s[6:7]
  v_pk_mul_f32 v[38:39], v[38:39], s[6:7]
  v_cvt_pk_bf16_f32 v48, v32, v33
  v_cvt_pk_bf16_f32 v49, v34, v35
  v_cvt_pk_bf16_f32 v50, v36, v37
  v_cvt_pk_bf16_f32 v51, v38, v39
  buffer_store_dwordx4 v[48:51], v2, s[16:19], s4 offen offset:0
  v_accvgpr_read_b32 v40, a168
  v_accvgpr_read_b32 v41, a169
  v_accvgpr_read_b32 v42, a170
  v_accvgpr_read_b32 v43, a171
  v_accvgpr_read_b32 v44, a172
  v_accvgpr_read_b32 v45, a173
  v_accvgpr_read_b32 v46, a174
  v_accvgpr_read_b32 v47, a175
  v_pk_mul_f32 v[40:41], v[40:41], s[6:7]
  v_pk_mul_f32 v[42:43], v[42:43], s[6:7]
  v_pk_mul_f32 v[44:45], v[44:45], s[6:7]
  v_pk_mul_f32 v[46:47], v[46:47], s[6:7]
  v_cvt_pk_bf16_f32 v52, v40, v41
  v_cvt_pk_bf16_f32 v53, v42, v43
  v_cvt_pk_bf16_f32 v54, v44, v45
  v_cvt_pk_bf16_f32 v55, v46, v47
  buffer_store_dwordx4 v[52:55], v2, s[16:19], s4 offen offset:1024
  v_accvgpr_read_b32 v32, a176
  v_accvgpr_read_b32 v33, a177
  v_accvgpr_read_b32 v34, a178
  v_accvgpr_read_b32 v35, a179
  v_accvgpr_read_b32 v36, a180
  v_accvgpr_read_b32 v37, a181
  v_accvgpr_read_b32 v38, a182
  v_accvgpr_read_b32 v39, a183
  v_pk_mul_f32 v[32:33], v[32:33], s[6:7]
  v_pk_mul_f32 v[34:35], v[34:35], s[6:7]
  v_pk_mul_f32 v[36:37], v[36:37], s[6:7]
  v_pk_mul_f32 v[38:39], v[38:39], s[6:7]
  v_cvt_pk_bf16_f32 v56, v32, v33
  v_cvt_pk_bf16_f32 v57, v34, v35
  v_cvt_pk_bf16_f32 v58, v36, v37
  v_cvt_pk_bf16_f32 v59, v38, v39
  buffer_store_dwordx4 v[56:59], v2, s[16:19], s4 offen offset:2048
  v_accvgpr_read_b32 v40, a184
  v_accvgpr_read_b32 v41, a185
  v_accvgpr_read_b32 v42, a186
  v_accvgpr_read_b32 v43, a187
  v_accvgpr_read_b32 v44, a188
  v_accvgpr_read_b32 v45, a189
  v_accvgpr_read_b32 v46, a190
  v_accvgpr_read_b32 v47, a191
  v_pk_mul_f32 v[40:41], v[40:41], s[6:7]
  v_pk_mul_f32 v[42:43], v[42:43], s[6:7]
  v_pk_mul_f32 v[44:45], v[44:45], s[6:7]
  v_pk_mul_f32 v[46:47], v[46:47], s[6:7]
  v_cvt_pk_bf16_f32 v60, v40, v41
  v_cvt_pk_bf16_f32 v61, v42, v43
  v_cvt_pk_bf16_f32 v62, v44, v45
  v_cvt_pk_bf16_f32 v63, v46, v47
  buffer_store_dwordx4 v[60:63], v2, s[16:19], s4 offen offset:3072
Lp1_done:
  s_lshr_b32 s4, s3, 1
  s_lshl_b32 s4, s4, 13
  v_and_b32 v32, 15, v1
  v_lshlrev_b32 v32, 7, v32
  v_lshrrev_b32 v33, 4, v1
  v_and_b32 v34, 6, v1
  v_xor_b32 v33, v33, v34
  v_lshl_add_u32 v32, v33, 4, v32
  v_add_u32 v16, s4, v32
  v_xor_b32 v17, 64, v16
  v_and_b32 v32, 15, v1
  v_lshlrev_b32 v32, 7, v32
  v_lshrrev_b32 v33, 4, v1
  v_and_b32 v34, 6, v1
  v_xor_b32 v33, v33, v34
  v_lshl_add_u32 v32, v33, 4, v32
  v_add_u32 v18, 16384, v32
  v_xor_b32 v19, 64, v18
  v_lshrrev_b32 v32, 2, v1
  v_and_b32 v33, 6, v32
  v_lshlrev_b32 v32, 7, v32
  v_and_b32 v34, 1, v1
  v_lshl_add_u32 v32, v34, 3, v32
  v_add_u32 v32, 0, v32
  v_bfe_u32 v34, v1, 1, 1
  v_xor_b32 v33, v33, v34
  v_xor_b32 v34, 0, v33
  v_lshl_add_u32 v20, v34, 4, v32
  v_xor_b32 v34, 2, v33
  v_lshl_add_u32 v21, v34, 4, v32
  s_and_b32 s4, s3, 1
  s_lshl_b32 s4, s4, 6
  v_xor_b32 v20, s4, v20
  v_xor_b32 v21, s4, v21
  s_cmp_ge_u32 s3, 2
  s_cbranch_scc1 Lp2_r1
  s_mov_b32 s37, 0
  s_mov_b32 s39, 4294877184
  s_mov_b32 s40, 45056
  s_waitcnt vmcnt(54)
  s_barrier
  ds_read_b128 a[0:3], v16 offset:0
  ds_read_b64_tr_b16 a[40:41], v20 offset:20480
  ds_read_b64_tr_b16 a[42:43], v20 offset:22528
  ds_read_b128 a[4:7], v16 offset:2048
  ds_read_b128 a[8:11], v16 offset:4096
  ds_read_b128 a[12:15], v16 offset:6144
  ds_read_b64_tr_b16 a[44:45], v21 offset:20480
  ds_read_b64_tr_b16 a[46:47], v21 offset:22528
  ds_read_b64_tr_b16 a[48:49], v20 offset:28672
  ds_read_b64_tr_b16 a[50:51], v20 offset:30720
  ds_read_b128 a[16:19], v18 offset:0
  ds_read_b64_tr_b16 a[52:53], v21 offset:28672
  ds_read_b64_tr_b16 a[54:55], v21 offset:30720
  ds_read_b64_tr_b16 a[56:57], v20 offset:36864
  ds_read_b64_tr_b16 a[58:59], v20 offset:38912
  ds_read_b64_tr_b16 a[60:61], v21 offset:36864
  ds_read_b64_tr_b16 a[62:63], v21 offset:38912
  s_waitcnt lgkmcnt(0)
  v_mfma_f32_16x16x32_bf16 v[128:131], a[40:43], a[0:3], 0
  s_add_u32 s37, s37, 1
  s_cmp_eq_u32 s37, 3
  s_cselect_b32 s37, 0, s37
  s_cselect_b32 s38, s39, s40
  ds_read_b128 a[20:23], v17 offset:0
  v_mfma_f32_16x16x32_bf16 v[136:139], a[40:43], a[4:7], 0
  ds_read_b64_tr_b16 a[64:65], v20 offset:24576
  v_mfma_f32_16x16x32_bf16 v[144:147], a[40:43], a[8:11], 0
  ds_read_b64_tr_b16 a[66:67], v20 offset:26624
  v_mfma_f32_16x16x32_bf16 v[152:155], a[40:43], a[12:15], 0
  ds_read_b128 a[24:27], v17 offset:2048
  v_mfma_f32_16x16x32_bf16 v[132:135], a[44:47], a[0:3], 0
  ds_read_b128 a[28:31], v17 offset:4096
  v_mfma_f32_16x16x32_bf16 v[140:143], a[44:47], a[4:7], 0
  ds_read_b128 a[32:35], v17 offset:6144
  v_mfma_f32_16x16x32_bf16 v[148:151], a[44:47], a[8:11], 0
  ds_read_b64_tr_b16 a[68:69], v21 offset:24576
  v_mfma_f32_16x16x32_bf16 v[156:159], a[44:47], a[12:15], 0
  ds_read_b64_tr_b16 a[70:71], v21 offset:26624
  v_mfma_f32_16x16x32_bf16 v[160:163], a[48:51], a[0:3], 0
  ds_read_b64_tr_b16 a[72:73], v20 offset:32768
  v_mfma_f32_16x16x32_bf16 v[168:171], a[48:51], a[4:7], 0
  ds_read_b64_tr_b16 a[74:75], v20 offset:34816
  v_mfma_f32_16x16x32_bf16 v[176:179], a[48:51], a[8:11], 0
  ds_read_b128 a[36:39], v19 offset:0
  v_mfma_f32_16x16x32_bf16 v[184:187], a[48:51], a[12:15], 0
  ds_read_b64_tr_b16 a[76:77], v21 offset:32768
  v_mfma_f32_16x16x32_bf16 v[224:227], a[48:51], a[16:19], 0
  ds_read_b64_tr_b16 a[78:79], v21 offset:34816
  v_mfma_f32_16x16x32_bf16 v[164:167], a[52:55], a[0:3], 0
  ds_read_b64_tr_b16 a[80:81], v20 offset:40960
  v_mfma_f32_16x16x32_bf16 v[172:175], a[52:55], a[4:7], 0
  ds_read_b64_tr_b16 a[82:83], v20 offset:43008
  v_mfma_f32_16x16x32_bf16 v[180:183], a[52:55], a[8:11], 0
  ds_read_b64_tr_b16 a[84:85], v21 offset:40960
  v_mfma_f32_16x16x32_bf16 v[188:191], a[52:55], a[12:15], 0
  ds_read_b64_tr_b16 a[86:87], v21 offset:43008
  v_mfma_f32_16x16x32_bf16 v[228:231], a[52:55], a[16:19], 0
  v_add_u32 v16, s38, v16
  v_add_u32 v17, s38, v17
  v_mfma_f32_16x16x32_bf16 v[192:195], a[0:3], a[56:59], 0
  v_add_u32 v18, s38, v18
  v_add_u32 v19, s38, v19
  v_mfma_f32_16x16x32_bf16 v[200:203], a[4:7], a[56:59], 0
  v_add_u32 v20, s38, v20
  v_add_u32 v21, s38, v21
  v_mfma_f32_16x16x32_bf16 v[208:211], a[8:11], a[56:59], 0
  v_mfma_f32_16x16x32_bf16 v[216:219], a[12:15], a[56:59], 0
  v_mfma_f32_16x16x32_bf16 v[196:199], a[0:3], a[60:63], 0
  v_mfma_f32_16x16x32_bf16 v[204:207], a[4:7], a[60:63], 0
  v_mfma_f32_16x16x32_bf16 v[212:215], a[8:11], a[60:63], 0
  v_mfma_f32_16x16x32_bf16 v[220:223], a[12:15], a[60:63], 0
  s_mov_b32 s35, 13
  .p2align 6
Lp2r0_loop:
  s_waitcnt vmcnt(11) lgkmcnt(0)
  s_barrier
  v_mfma_f32_16x16x32_bf16 v[128:131], a[64:67], a[20:23], v[128:131]
  s_add_u32 m0, s36, s48
  ds_read_b128 a[0:3], v16 offset:0
  v_mfma_f32_16x16x32_bf16 v[136:139], a[64:67], a[24:27], v[136:139]
  buffer_load_dwordx4 v8, s[12:15], s47 offen offset:0 lds
  ds_read_b64_tr_b16 a[40:41], v20 offset:20480
  v_mfma_f32_16x16x32_bf16 v[144:147], a[64:67], a[28:31], v[144:147]
  ds_read_b64_tr_b16 a[42:43], v20 offset:22528
  v_mfma_f32_16x16x32_bf16 v[152:155], a[64:67], a[32:35], v[152:155]
  ds_read_b128 a[4:7], v16 offset:2048
  v_mfma_f32_16x16x32_bf16 v[132:135], a[68:71], a[20:23], v[132:135]
  buffer_load_dwordx4 v9, s[12:15], s47 offen offset:1024 lds
  ds_read_b128 a[8:11], v16 offset:4096
  v_mfma_f32_16x16x32_bf16 v[140:143], a[68:71], a[24:27], v[140:143]
  ds_read_b128 a[12:15], v16 offset:6144
  v_mfma_f32_16x16x32_bf16 v[148:151], a[68:71], a[28:31], v[148:151]
  ds_read_b64_tr_b16 a[44:45], v21 offset:20480
  v_mfma_f32_16x16x32_bf16 v[156:159], a[68:71], a[32:35], v[156:159]
  ds_read_b64_tr_b16 a[46:47], v21 offset:22528
  v_mfma_f32_16x16x32_bf16 v[160:163], a[72:75], a[20:23], v[160:163]
  buffer_load_dwordx4 v10, s[12:15], s47 offen offset:2048 lds
  ds_read_b64_tr_b16 a[48:49], v20 offset:28672
  v_mfma_f32_16x16x32_bf16 v[168:171], a[72:75], a[24:27], v[168:171]
  s_add_u32 m0, s36, s49
  ds_read_b64_tr_b16 a[50:51], v20 offset:30720
  v_mfma_f32_16x16x32_bf16 v[176:179], a[72:75], a[28:31], v[176:179]
  ds_read_b128 a[16:19], v18 offset:0
  v_mfma_f32_16x16x32_bf16 v[184:187], a[72:75], a[32:35], v[184:187]
  ds_read_b64_tr_b16 a[52:53], v21 offset:28672
  v_mfma_f32_16x16x32_bf16 v[224:227], a[72:75], a[36:39], v[224:227]
  buffer_load_dwordx4 v11, s[12:15], s47 offen offset:0 lds
  ds_read_b64_tr_b16 a[54:55], v21 offset:30720
  v_mfma_f32_16x16x32_bf16 v[164:167], a[76:79], a[20:23], v[164:167]
  ds_read_b64_tr_b16 a[56:57], v20 offset:36864
  v_mfma_f32_16x16x32_bf16 v[172:175], a[76:79], a[24:27], v[172:175]
  ds_read_b64_tr_b16 a[58:59], v20 offset:38912
  v_mfma_f32_16x16x32_bf16 v[180:183], a[76:79], a[28:31], v[180:183]
  ds_read_b64_tr_b16 a[60:61], v21 offset:36864
  v_mfma_f32_16x16x32_bf16 v[188:191], a[76:79], a[32:35], v[188:191]
  buffer_load_dwordx4 v12, s[12:15], s47 offen offset:1024 lds
  ds_read_b64_tr_b16 a[62:63], v21 offset:38912
  v_mfma_f32_16x16x32_bf16 v[228:231], a[76:79], a[36:39], v[228:231]
  v_mfma_f32_16x16x32_bf16 v[192:195], a[20:23], a[80:83], v[192:195]
  v_mfma_f32_16x16x32_bf16 v[200:203], a[24:27], a[80:83], v[200:203]
  v_mfma_f32_16x16x32_bf16 v[208:211], a[28:31], a[80:83], v[208:211]
  buffer_load_dwordx4 v13, s[12:15], s47 offen offset:2048 lds
  v_mfma_f32_16x16x32_bf16 v[216:219], a[32:35], a[80:83], v[216:219]
  s_add_u32 s47, s47, 393216
  v_mfma_f32_16x16x32_bf16 v[196:199], a[20:23], a[84:87], v[196:199]
  v_mfma_f32_16x16x32_bf16 v[204:207], a[24:27], a[84:87], v[204:207]
  v_mfma_f32_16x16x32_bf16 v[212:215], a[28:31], a[84:87], v[212:215]
  v_mfma_f32_16x16x32_bf16 v[220:223], a[32:35], a[84:87], v[220:223]
  s_waitcnt lgkmcnt(0)
  v_mfma_f32_16x16x32_bf16 v[128:131], a[40:43], a[0:3], v[128:131]
  s_mov_b32 m0, s36
  ds_read_b128 a[20:23], v17 offset:0
  v_mfma_f32_16x16x32_bf16 v[136:139], a[40:43], a[4:7], v[136:139]
  buffer_load_dwordx4 v24, s[8:11], s46 offen offset:0 lds
  ds_read_b64_tr_b16 a[64:65], v20 offset:24576
  v_mfma_f32_16x16x32_bf16 v[144:147], a[40:43], a[8:11], v[144:147]
  ds_read_b64_tr_b16 a[66:67], v20 offset:26624
  v_mfma_f32_16x16x32_bf16 v[152:155], a[40:43], a[12:15], v[152:155]
  buffer_load_dwordx4 v25, s[8:11], s46 offen offset:1024 lds
  ds_read_b128 a[24:27], v17 offset:2048
  v_mfma_f32_16x16x32_bf16 v[132:135], a[44:47], a[0:3], v[132:135]
  ds_read_b128 a[28:31], v17 offset:4096
  v_mfma_f32_16x16x32_bf16 v[140:143], a[44:47], a[4:7], v[140:143]
  ds_read_b128 a[32:35], v17 offset:6144
  v_mfma_f32_16x16x32_bf16 v[148:151], a[44:47], a[8:11], v[148:151]
  ds_read_b64_tr_b16 a[68:69], v21 offset:24576
  v_mfma_f32_16x16x32_bf16 v[156:159], a[44:47], a[12:15], v[156:159]
  buffer_load_dwordx4 v26, s[8:11], s46 offen offset:2048 lds
  ds_read_b64_tr_b16 a[70:71], v21 offset:26624
  v_mfma_f32_16x16x32_bf16 v[160:163], a[48:51], a[0:3], v[160:163]
  ds_read_b64_tr_b16 a[72:73], v20 offset:32768
  v_mfma_f32_16x16x32_bf16 v[168:171], a[48:51], a[4:7], v[168:171]
  ds_read_b64_tr_b16 a[74:75], v20 offset:34816
  v_mfma_f32_16x16x32_bf16 v[176:179], a[48:51], a[8:11], v[176:179]
  ds_read_b128 a[36:39], v19 offset:0
  v_mfma_f32_16x16x32_bf16 v[184:187], a[48:51], a[12:15], v[184:187]
  buffer_load_dwordx4 v27, s[8:11], s46 offen offset:3072 lds
  ds_read_b64_tr_b16 a[76:77], v21 offset:32768
  v_mfma_f32_16x16x32_bf16 v[224:227], a[48:51], a[16:19], v[224:227]
  s_add_u32 m0, s36, s52
  ds_read_b64_tr_b16 a[78:79], v21 offset:34816
  v_mfma_f32_16x16x32_bf16 v[164:167], a[52:55], a[0:3], v[164:167]
  ds_read_b64_tr_b16 a[80:81], v20 offset:40960
  v_mfma_f32_16x16x32_bf16 v[172:175], a[52:55], a[4:7], v[172:175]
  ds_read_b64_tr_b16 a[82:83], v20 offset:43008
  v_mfma_f32_16x16x32_bf16 v[180:183], a[52:55], a[8:11], v[180:183]
  buffer_load_dwordx4 v28, s[8:11], s46 offen offset:0 lds
  ds_read_b64_tr_b16 a[84:85], v21 offset:40960
  v_mfma_f32_16x16x32_bf16 v[188:191], a[52:55], a[12:15], v[188:191]
  s_add_u32 s46, s46, 128
  ds_read_b64_tr_b16 a[86:87], v21 offset:43008
  v_mfma_f32_16x16x32_bf16 v[228:231], a[52:55], a[16:19], v[228:231]
  s_add_u32 s36, s36, s38
  s_add_u32 s37, s37, 1
  s_cmp_eq_u32 s37, 3
  s_cselect_b32 s37, 0, s37
  s_cselect_b32 s38, s39, s40
  v_mfma_f32_16x16x32_bf16 v[192:195], a[0:3], a[56:59], v[192:195]
  v_add_u32 v16, s38, v16
  v_add_u32 v17, s38, v17
  v_mfma_f32_16x16x32_bf16 v[200:203], a[4:7], a[56:59], v[200:203]
  v_add_u32 v18, s38, v18
  v_add_u32 v19, s38, v19
  v_mfma_f32_16x16x32_bf16 v[208:211], a[8:11], a[56:59], v[208:211]
  v_add_u32 v20, s38, v20
  v_add_u32 v21, s38, v21
  v_mfma_f32_16x16x32_bf16 v[216:219], a[12:15], a[56:59], v[216:219]
  v_mfma_f32_16x16x32_bf16 v[196:199], a[0:3], a[60:63], v[196:199]
  v_mfma_f32_16x16x32_bf16 v[204:207], a[4:7], a[60:63], v[204:207]
  v_mfma_f32_16x16x32_bf16 v[212:215], a[8:11], a[60:63], v[212:215]
  s_sub_u32 s35, s35, 1
  v_mfma_f32_16x16x32_bf16 v[220:223], a[12:15], a[60:63], v[220:223]
  s_cmp_lg_u32 s35, 0
  s_cbranch_scc1 Lp2r0_loop
  s_waitcnt vmcnt(11) lgkmcnt(0)
  s_barrier
  v_mfma_f32_16x16x32_bf16 v[128:131], a[64:67], a[20:23], v[128:131]
  ds_read_b128 a[0:3], v16 offset:0
  v_mfma_f32_16x16x32_bf16 v[136:139], a[64:67], a[24:27], v[136:139]
  ds_read_b64_tr_b16 a[40:41], v20 offset:20480
  v_mfma_f32_16x16x32_bf16 v[144:147], a[64:67], a[28:31], v[144:147]
  ds_read_b64_tr_b16 a[42:43], v20 offset:22528
  v_mfma_f32_16x16x32_bf16 v[152:155], a[64:67], a[32:35], v[152:155]
  ds_read_b128 a[4:7], v16 offset:2048
  v_mfma_f32_16x16x32_bf16 v[132:135], a[68:71], a[20:23], v[132:135]
  ds_read_b128 a[8:11], v16 offset:4096
  v_mfma_f32_16x16x32_bf16 v[140:143], a[68:71], a[24:27], v[140:143]
  ds_read_b128 a[12:15], v16 offset:6144
  v_mfma_f32_16x16x32_bf16 v[148:151], a[68:71], a[28:31], v[148:151]
  ds_read_b64_tr_b16 a[44:45], v21 offset:20480
  v_mfma_f32_16x16x32_bf16 v[156:159], a[68:71], a[32:35], v[156:159]
  ds_read_b64_tr_b16 a[46:47], v21 offset:22528
  v_mfma_f32_16x16x32_bf16 v[160:163], a[72:75], a[20:23], v[160:163]
  ds_read_b64_tr_b16 a[48:49], v20 offset:28672
  v_mfma_f32_16x16x32_bf16 v[168:171], a[72:75], a[24:27], v[168:171]
  ds_read_b64_tr_b16 a[50:51], v20 offset:30720
  v_mfma_f32_16x16x32_bf16 v[176:179], a[72:75], a[28:31], v[176:179]
  ds_read_b128 a[16:19], v18 offset:0
  v_mfma_f32_16x16x32_bf16 v[184:187], a[72:75], a[32:35], v[184:187]
  ds_read_b64_tr_b16 a[52:53], v21 offset:28672
  v_mfma_f32_16x16x32_bf16 v[224:227], a[72:75], a[36:39], v[224:227]
  ds_read_b64_tr_b16 a[54:55], v21 offset:30720
  v_mfma_f32_16x16x32_bf16 v[164:167], a[76:79], a[20:23], v[164:167]
  ds_read_b64_tr_b16 a[56:57], v20 offset:36864
  v_mfma_f32_16x16x32_bf16 v[172:175], a[76:79], a[24:27], v[172:175]
  ds_read_b64_tr_b16 a[58:59], v20 offset:38912
  v_mfma_f32_16x16x32_bf16 v[180:183], a[76:79], a[28:31], v[180:183]
  ds_read_b64_tr_b16 a[60:61], v21 offset:36864
  v_mfma_f32_16x16x32_bf16 v[188:191], a[76:79], a[32:35], v[188:191]
  ds_read_b64_tr_b16 a[62:63], v21 offset:38912
  v_mfma_f32_16x16x32_bf16 v[228:231], a[76:79], a[36:39], v[228:231]
  v_mfma_f32_16x16x32_bf16 v[192:195], a[20:23], a[80:83], v[192:195]
  v_mfma_f32_16x16x32_bf16 v[200:203], a[24:27], a[80:83], v[200:203]
  v_mfma_f32_16x16x32_bf16 v[208:211], a[28:31], a[80:83], v[208:211]
  v_mfma_f32_16x16x32_bf16 v[216:219], a[32:35], a[80:83], v[216:219]
  v_mfma_f32_16x16x32_bf16 v[196:199], a[20:23], a[84:87], v[196:199]
  v_mfma_f32_16x16x32_bf16 v[204:207], a[24:27], a[84:87], v[204:207]
  v_mfma_f32_16x16x32_bf16 v[212:215], a[28:31], a[84:87], v[212:215]
  v_mfma_f32_16x16x32_bf16 v[220:223], a[32:35], a[84:87], v[220:223]
  s_waitcnt lgkmcnt(0)
  v_mfma_f32_16x16x32_bf16 v[128:131], a[40:43], a[0:3], v[128:131]
  s_add_u32 s37, s37, 1
  s_cmp_eq_u32 s37, 3
  s_cselect_b32 s37, 0, s37
  s_cselect_b32 s38, s39, s40
  ds_read_b128 a[20:23], v17 offset:0
  v_mfma_f32_16x16x32_bf16 v[136:139], a[40:43], a[4:7], v[136:139]
  ds_read_b64_tr_b16 a[64:65], v20 offset:24576
  v_mfma_f32_16x16x32_bf16 v[144:147], a[40:43], a[8:11], v[144:147]
  ds_read_b64_tr_b16 a[66:67], v20 offset:26624
  v_mfma_f32_16x16x32_bf16 v[152:155], a[40:43], a[12:15], v[152:155]
  ds_read_b128 a[24:27], v17 offset:2048
  v_mfma_f32_16x16x32_bf16 v[132:135], a[44:47], a[0:3], v[132:135]
  ds_read_b128 a[28:31], v17 offset:4096
  v_mfma_f32_16x16x32_bf16 v[140:143], a[44:47], a[4:7], v[140:143]
  ds_read_b128 a[32:35], v17 offset:6144
  v_mfma_f32_16x16x32_bf16 v[148:151], a[44:47], a[8:11], v[148:151]
  ds_read_b64_tr_b16 a[68:69], v21 offset:24576
  v_mfma_f32_16x16x32_bf16 v[156:159], a[44:47], a[12:15], v[156:159]
  ds_read_b64_tr_b16 a[70:71], v21 offset:26624
  v_mfma_f32_16x16x32_bf16 v[160:163], a[48:51], a[0:3], v[160:163]
  ds_read_b64_tr_b16 a[72:73], v20 offset:32768
  v_mfma_f32_16x16x32_bf16 v[168:171], a[48:51], a[4:7], v[168:171]
  ds_read_b64_tr_b16 a[74:75], v20 offset:34816
  v_mfma_f32_16x16x32_bf16 v[176:179], a[48:51], a[8:11], v[176:179]
  ds_read_b128 a[36:39], v19 offset:0
  v_mfma_f32_16x16x32_bf16 v[184:187], a[48:51], a[12:15], v[184:187]
  ds_read_b64_tr_b16 a[76:77], v21 offset:32768
  v_mfma_f32_16x16x32_bf16 v[224:227], a[48:51], a[16:19], v[224:227]
  ds_read_b64_tr_b16 a[78:79], v21 offset:34816
  v_mfma_f32_16x16x32_bf16 v[164:167], a[52:55], a[0:3], v[164:167]
  ds_read_b64_tr_b16 a[80:81], v20 offset:40960
  v_mfma_f32_16x16x32_bf16 v[172:175], a[52:55], a[4:7], v[172:175]
  ds_read_b64_tr_b16 a[82:83], v20 offset:43008
  v_mfma_f32_16x16x32_bf16 v[180:183], a[52:55], a[8:11], v[180:183]
  ds_read_b64_tr_b16 a[84:85], v21 offset:40960
  v_mfma_f32_16x16x32_bf16 v[188:191], a[52:55], a[12:15], v[188:191]
  ds_read_b64_tr_b16 a[86:87], v21 offset:43008
  v_mfma_f32_16x16x32_bf16 v[228:231], a[52:55], a[16:19], v[228:231]
  v_add_u32 v16, s38, v16
  v_add_u32 v17, s38, v17
  v_mfma_f32_16x16x32_bf16 v[192:195], a[0:3], a[56:59], v[192:195]
  v_add_u32 v18, s38, v18
  v_add_u32 v19, s38, v19
  v_mfma_f32_16x16x32_bf16 v[200:203], a[4:7], a[56:59], v[200:203]
  v_add_u32 v20, s38, v20
  v_add_u32 v21, s38, v21
  v_mfma_f32_16x16x32_bf16 v[208:211], a[8:11], a[56:59], v[208:211]
  v_mfma_f32_16x16x32_bf16 v[216:219], a[12:15], a[56:59], v[216:219]
  v_mfma_f32_16x16x32_bf16 v[196:199], a[0:3], a[60:63], v[196:199]
  v_mfma_f32_16x16x32_bf16 v[204:207], a[4:7], a[60:63], v[204:207]
  v_mfma_f32_16x16x32_bf16 v[212:215], a[8:11], a[60:63], v[212:215]
  v_mfma_f32_16x16x32_bf16 v[220:223], a[12:15], a[60:63], v[220:223]
  s_waitcnt vmcnt(0) lgkmcnt(0)
  s_barrier
  v_mfma_f32_16x16x32_bf16 v[128:131], a[64:67], a[20:23], v[128:131]
  ds_read_b128 a[0:3], v16 offset:0
  v_mfma_f32_16x16x32_bf16 v[136:139], a[64:67], a[24:27], v[136:139]
  ds_read_b64_tr_b16 a[40:41], v20 offset:20480
  v_mfma_f32_16x16x32_bf16 v[144:147], a[64:67], a[28:31], v[144:147]
  ds_read_b64_tr_b16 a[42:43], v20 offset:22528
  v_mfma_f32_16x16x32_bf16 v[152:155], a[64:67], a[32:35], v[152:155]
  ds_read_b128 a[4:7], v16 offset:2048
  v_mfma_f32_16x16x32_bf16 v[132:135], a[68:71], a[20:23], v[132:135]
  ds_read_b128 a[8:11], v16 offset:4096
  v_mfma_f32_16x16x32_bf16 v[140:143], a[68:71], a[24:27], v[140:143]
  ds_read_b128 a[12:15], v16 offset:6144
  v_mfma_f32_16x16x32_bf16 v[148:151], a[68:71], a[28:31], v[148:151]
  ds_read_b64_tr_b16 a[44:45], v21 offset:20480
  v_mfma_f32_16x16x32_bf16 v[156:159], a[68:71], a[32:35], v[156:159]
  ds_read_b64_tr_b16 a[46:47], v21 offset:22528
  v_mfma_f32_16x16x32_bf16 v[160:163], a[72:75], a[20:23], v[160:163]
  ds_read_b64_tr_b16 a[48:49], v20 offset:28672
  v_mfma_f32_16x16x32_bf16 v[168:171], a[72:75], a[24:27], v[168:171]
  ds_read_b64_tr_b16 a[50:51], v20 offset:30720
  v_mfma_f32_16x16x32_bf16 v[176:179], a[72:75], a[28:31], v[176:179]
  ds_read_b128 a[16:19], v18 offset:0
  v_mfma_f32_16x16x32_bf16 v[184:187], a[72:75], a[32:35], v[184:187]
  ds_read_b64_tr_b16 a[52:53], v21 offset:28672
  v_mfma_f32_16x16x32_bf16 v[224:227], a[72:75], a[36:39], v[224:227]
  ds_read_b64_tr_b16 a[54:55], v21 offset:30720
  v_mfma_f32_16x16x32_bf16 v[164:167], a[76:79], a[20:23], v[164:167]
  ds_read_b64_tr_b16 a[56:57], v20 offset:36864
  v_mfma_f32_16x16x32_bf16 v[172:175], a[76:79], a[24:27], v[172:175]
  ds_read_b64_tr_b16 a[58:59], v20 offset:38912
  v_mfma_f32_16x16x32_bf16 v[180:183], a[76:79], a[28:31], v[180:183]
  ds_read_b64_tr_b16 a[60:61], v21 offset:36864
  v_mfma_f32_16x16x32_bf16 v[188:191], a[76:79], a[32:35], v[188:191]
  ds_read_b64_tr_b16 a[62:63], v21 offset:38912
  v_mfma_f32_16x16x32_bf16 v[228:231], a[76:79], a[36:39], v[228:231]
  v_mfma_f32_16x16x32_bf16 v[192:195], a[20:23], a[80:83], v[192:195]
  v_mfma_f32_16x16x32_bf16 v[200:203], a[24:27], a[80:83], v[200:203]
  v_mfma_f32_16x16x32_bf16 v[208:211], a[28:31], a[80:83], v[208:211]
  v_mfma_f32_16x16x32_bf16 v[216:219], a[32:35], a[80:83], v[216:219]
  v_mfma_f32_16x16x32_bf16 v[196:199], a[20:23], a[84:87], v[196:199]
  v_mfma_f32_16x16x32_bf16 v[204:207], a[24:27], a[84:87], v[204:207]
  v_mfma_f32_16x16x32_bf16 v[212:215], a[28:31], a[84:87], v[212:215]
  v_mfma_f32_16x16x32_bf16 v[220:223], a[32:35], a[84:87], v[220:223]
  s_waitcnt lgkmcnt(0)
  v_mfma_f32_16x16x32_bf16 v[128:131], a[40:43], a[0:3], v[128:131]
  ds_read_b128 a[20:23], v17 offset:0
  v_mfma_f32_16x16x32_bf16 v[136:139], a[40:43], a[4:7], v[136:139]
  ds_read_b64_tr_b16 a[64:65], v20 offset:24576
  v_mfma_f32_16x16x32_bf16 v[144:147], a[40:43], a[8:11], v[144:147]
  ds_read_b64_tr_b16 a[66:67], v20 offset:26624
  v_mfma_f32_16x16x32_bf16 v[152:155], a[40:43], a[12:15], v[152:155]
  ds_read_b128 a[24:27], v17 offset:2048
  v_mfma_f32_16x16x32_bf16 v[132:135], a[44:47], a[0:3], v[132:135]
  ds_read_b128 a[28:31], v17 offset:4096
  v_mfma_f32_16x16x32_bf16 v[140:143], a[44:47], a[4:7], v[140:143]
  ds_read_b128 a[32:35], v17 offset:6144
  v_mfma_f32_16x16x32_bf16 v[148:151], a[44:47], a[8:11], v[148:151]
  ds_read_b64_tr_b16 a[68:69], v21 offset:24576
  v_mfma_f32_16x16x32_bf16 v[156:159], a[44:47], a[12:15], v[156:159]
  ds_read_b64_tr_b16 a[70:71], v21 offset:26624
  v_mfma_f32_16x16x32_bf16 v[160:163], a[48:51], a[0:3], v[160:163]
  ds_read_b64_tr_b16 a[72:73], v20 offset:32768
  v_mfma_f32_16x16x32_bf16 v[168:171], a[48:51], a[4:7], v[168:171]
  ds_read_b64_tr_b16 a[74:75], v20 offset:34816
  v_mfma_f32_16x16x32_bf16 v[176:179], a[48:51], a[8:11], v[176:179]
  ds_read_b128 a[36:39], v19 offset:0
  v_mfma_f32_16x16x32_bf16 v[184:187], a[48:51], a[12:15], v[184:187]
  ds_read_b64_tr_b16 a[76:77], v21 offset:32768
  v_mfma_f32_16x16x32_bf16 v[224:227], a[48:51], a[16:19], v[224:227]
  ds_read_b64_tr_b16 a[78:79], v21 offset:34816
  v_mfma_f32_16x16x32_bf16 v[164:167], a[52:55], a[0:3], v[164:167]
  ds_read_b64_tr_b16 a[80:81], v20 offset:40960
  v_mfma_f32_16x16x32_bf16 v[172:175], a[52:55], a[4:7], v[172:175]
  ds_read_b64_tr_b16 a[82:83], v20 offset:43008
  v_mfma_f32_16x16x32_bf16 v[180:183], a[52:55], a[8:11], v[180:183]
  ds_read_b64_tr_b16 a[84:85], v21 offset:40960
  v_mfma_f32_16x16x32_bf16 v[188:191], a[52:55], a[12:15], v[188:191]
  ds_read_b64_tr_b16 a[86:87], v21 offset:43008
  v_mfma_f32_16x16x32_bf16 v[228:231], a[52:55], a[16:19], v[228:231]
  v_mfma_f32_16x16x32_bf16 v[192:195], a[0:3], a[56:59], v[192:195]
  v_mfma_f32_16x16x32_bf16 v[200:203], a[4:7], a[56:59], v[200:203]
  v_mfma_f32_16x16x32_bf16 v[208:211], a[8:11], a[56:59], v[208:211]
  v_mfma_f32_16x16x32_bf16 v[216:219], a[12:15], a[56:59], v[216:219]
  v_mfma_f32_16x16x32_bf16 v[196:199], a[0:3], a[60:63], v[196:199]
  v_mfma_f32_16x16x32_bf16 v[204:207], a[4:7], a[60:63], v[204:207]
  v_mfma_f32_16x16x32_bf16 v[212:215], a[8:11], a[60:63], v[212:215]
  v_mfma_f32_16x16x32_bf16 v[220:223], a[12:15], a[60:63], v[220:223]
  s_waitcnt lgkmcnt(0)
  v_mfma_f32_16x16x32_bf16 v[128:131], a[64:67], a[20:23], v[128:131]
  v_mfma_f32_16x16x32_bf16 v[136:139], a[64:67], a[24:27], v[136:139]
  v_mfma_f32_16x16x32_bf16 v[144:147], a[64:67], a[28:31], v[144:147]
  v_mfma_f32_16x16x32_bf16 v[152:155], a[64:67], a[32:35], v[152:155]
  v_mfma_f32_16x16x32_bf16 v[132:135], a[68:71], a[20:23], v[132:135]
  v_mfma_f32_16x16x32_bf16 v[140:143], a[68:71], a[24:27], v[140:143]
  v_mfma_f32_16x16x32_bf16 v[148:151], a[68:71], a[28:31], v[148:151]
  v_mfma_f32_16x16x32_bf16 v[156:159], a[68:71], a[32:35], v[156:159]
  v_mfma_f32_16x16x32_bf16 v[160:163], a[72:75], a[20:23], v[160:163]
  v_mfma_f32_16x16x32_bf16 v[168:171], a[72:75], a[24:27], v[168:171]
  v_mfma_f32_16x16x32_bf16 v[176:179], a[72:75], a[28:31], v[176:179]
  v_mfma_f32_16x16x32_bf16 v[184:187], a[72:75], a[32:35], v[184:187]
  v_mfma_f32_16x16x32_bf16 v[224:227], a[72:75], a[36:39], v[224:227]
  v_mfma_f32_16x16x32_bf16 v[164:167], a[76:79], a[20:23], v[164:167]
  v_mfma_f32_16x16x32_bf16 v[172:175], a[76:79], a[24:27], v[172:175]
  v_mfma_f32_16x16x32_bf16 v[180:183], a[76:79], a[28:31], v[180:183]
  v_mfma_f32_16x16x32_bf16 v[188:191], a[76:79], a[32:35], v[188:191]
  v_mfma_f32_16x16x32_bf16 v[228:231], a[76:79], a[36:39], v[228:231]
  v_mfma_f32_16x16x32_bf16 v[192:195], a[20:23], a[80:83], v[192:195]
  v_mfma_f32_16x16x32_bf16 v[200:203], a[24:27], a[80:83], v[200:203]
  v_mfma_f32_16x16x32_bf16 v[208:211], a[28:31], a[80:83], v[208:211]
  v_mfma_f32_16x16x32_bf16 v[216:219], a[32:35], a[80:83], v[216:219]
  v_mfma_f32_16x16x32_bf16 v[196:199], a[20:23], a[84:87], v[196:199]
  v_mfma_f32_16x16x32_bf16 v[204:207], a[24:27], a[84:87], v[204:207]
  v_mfma_f32_16x16x32_bf16 v[212:215], a[28:31], a[84:87], v[212:215]
  v_mfma_f32_16x16x32_bf16 v[220:223], a[32:35], a[84:87], v[220:223]
  s_and_b32 s4, s3, 1
  s_mul_i32 s4, s4, 3072
  s_add_u32 s4, s4, 135168
  v_add_u32 v116, s4, v2
  v_cvt_pk_bf16_f32 v80, v184, v185
  v_cvt_pk_bf16_f32 v81, v186, v187
  v_cvt_pk_bf16_f32 v92, v216, v217
  v_cvt_pk_bf16_f32 v93, v218, v219
  v_cvt_pk_bf16_f32 v82, v188, v189
  v_cvt_pk_bf16_f32 v83, v190, v191
  v_cvt_pk_bf16_f32 v102, v220, v221
  v_cvt_pk_bf16_f32 v103, v222, v223
  ds_write_b128 v116, v[80:83]
  ds_write_b64 v116, v[92:93] offset:1024
  ds_write_b64 v116, v[102:103] offset:1032
  v_and_b32 v117, 15, v1
  v_lshrrev_b32 v118, 4, v1
  v_lshlrev_b32 v118, 2, v118
  v_sub_u32 v117, v117, v118
  v_mov_b32 v118, 0xf149f2ca
  v_subrev_u32 v119, 0, v117
  v_and_b32 v104, 0x80000001, v119
  v_cmp_ne_u32 vcc, 0, v104
  s_nop 1
  v_cndmask_b32 v104, 0, v118, vcc
  v_add_u32 v119, 1, v119
  v_and_b32 v108, 0x80000001, v119
  v_cmp_ne_u32 vcc, 0x80000001, v108
  s_nop 1
  v_cndmask_b32 v108, 0, v118, vcc
  v_subrev_u32 v119, 1, v117
  v_and_b32 v105, 0x80000001, v119
  v_cmp_ne_u32 vcc, 0, v105
  s_nop 1
  v_cndmask_b32 v105, 0, v118, vcc
  v_add_u32 v119, 1, v119
  v_and_b32 v109, 0x80000001, v119
  v_cmp_ne_u32 vcc, 0x80000001, v109
  s_nop 1
  v_cndmask_b32 v109, 0, v118, vcc
  v_subrev_u32 v119, 2, v117
  v_and_b32 v106, 0x80000001, v119
  v_cmp_ne_u32 vcc, 0, v106
  s_nop 1
  v_cndmask_b32 v106, 0, v118, vcc
  v_add_u32 v119, 1, v119
  v_and_b32 v110, 0x80000001, v119
  v_cmp_ne_u32 vcc, 0x80000001, v110
  s_nop 1
  v_cndmask_b32 v110, 0, v118, vcc
  v_subrev_u32 v119, 3, v117
  v_and_b32 v107, 0x80000001, v119
  v_cmp_ne_u32 vcc, 0, v107
  s_nop 1
  v_cndmask_b32 v107, 0, v118, vcc
  v_add_u32 v119, 1, v119
  v_and_b32 v111, 0x80000001, v119
  v_cmp_ne_u32 vcc, 0x80000001, v111
  s_nop 1
  v_cndmask_b32 v111, 0, v118, vcc
  s_cmp_eq_u32 s54, 0
  s_cselect_b64 vcc, -1, 0
  v_cndmask_b32 v112, v108, v118, vcc
  v_cndmask_b32 v113, v109, v118, vcc
  v_cndmask_b32 v114, v110, v118, vcc
  v_cndmask_b32 v115, v111, v118, vcc
  s_mov_b32 s6, 0x3e8293ee
  s_mov_b32 s7, s6
  v_pk_mul_f32 v[128:129], v[128:129], s[6:7]
  v_pk_mul_f32 v[130:131], v[130:131], s[6:7]
  v_pk_mul_f32 v[132:133], v[132:133], s[6:7]
  v_pk_mul_f32 v[134:135], v[134:135], s[6:7]
  v_cvt_pk_bf16_f32 v48, v128, v129
  v_cvt_pk_bf16_f32 v49, v130, v131
  v_cvt_pk_bf16_f32 v50, v132, v133
  v_cvt_pk_bf16_f32 v51, v134, v135
  v_pk_mul_f32 v[136:137], v[136:137], s[6:7]
  v_pk_mul_f32 v[138:139], v[138:139], s[6:7]
  v_pk_mul_f32 v[140:141], v[140:141], s[6:7]
  v_pk_mul_f32 v[142:143], v[142:143], s[6:7]
  v_cvt_pk_bf16_f32 v52, v136, v137
  v_cvt_pk_bf16_f32 v53, v138, v139
  v_cvt_pk_bf16_f32 v54, v140, v141
  v_cvt_pk_bf16_f32 v55, v142, v143
  v_pk_mul_f32 v[144:145], v[144:145], s[6:7]
  v_pk_mul_f32 v[146:147], v[146:147], s[6:7]
  v_pk_mul_f32 v[148:149], v[148:149], s[6:7]
  v_pk_mul_f32 v[150:151], v[150:151], s[6:7]
  v_cvt_pk_bf16_f32 v56, v144, v145
  v_cvt_pk_bf16_f32 v57, v146, v147
  v_cvt_pk_bf16_f32 v58, v148, v149
  v_cvt_pk_bf16_f32 v59, v150, v151
  v_pk_mul_f32 v[152:153], v[152:153], s[6:7]
  v_pk_mul_f32 v[154:155], v[154:155], s[6:7]
  v_pk_mul_f32 v[156:157], v[156:157], s[6:7]
  v_pk_mul_f32 v[158:159], v[158:159], s[6:7]
  v_cvt_pk_bf16_f32 v60, v152, v153
  v_cvt_pk_bf16_f32 v61, v154, v155
  v_cvt_pk_bf16_f32 v62, v156, v157
  v_cvt_pk_bf16_f32 v63, v158, v159
  v_cvt_pk_bf16_f32 v68, v160, v161
  v_cvt_pk_bf16_f32 v69, v162, v163
  v_cvt_pk_bf16_f32 v86, v192, v193
  v_cvt_pk_bf16_f32 v87, v194, v195
  v_cvt_pk_bf16_f32 v70, v164, v165
  v_cvt_pk_bf16_f32 v71, v166, v167
  v_cvt_pk_bf16_f32 v96, v196, v197
  v_cvt_pk_bf16_f32 v97, v198, v199
  v_cvt_pk_bf16_f32 v72, v168, v169
  v_cvt_pk_bf16_f32 v73, v170, v171
  v_cvt_pk_bf16_f32 v88, v200, v201
  v_cvt_pk_bf16_f32 v89, v202, v203
  v_cvt_pk_bf16_f32 v74, v172, v173
  v_cvt_pk_bf16_f32 v75, v174, v175
  v_cvt_pk_bf16_f32 v98, v204, v205
  v_cvt_pk_bf16_f32 v99, v206, v207
  v_cvt_pk_bf16_f32 v76, v176, v177
  v_cvt_pk_bf16_f32 v77, v178, v179
  v_cvt_pk_bf16_f32 v90, v208, v209
  v_cvt_pk_bf16_f32 v91, v210, v211
  v_cvt_pk_bf16_f32 v78, v180, v181
  v_cvt_pk_bf16_f32 v79, v182, v183
  v_cvt_pk_bf16_f32 v100, v212, v213
  v_cvt_pk_bf16_f32 v101, v214, v215
  v_cvt_pk_bf16_f32 v64, v224, v225
  v_cvt_pk_bf16_f32 v65, v226, v227
  v_cvt_pk_bf16_f32 v66, v228, v229
  v_cvt_pk_bf16_f32 v67, v230, v231
  v_mov_b32 v120, 0x3f803f80
  v_mov_b32 v121, v120
  v_mov_b32 v122, v120
  v_mov_b32 v123, v120
  s_waitcnt lgkmcnt(0)
  s_barrier
  ds_read_b64 v[84:85], v116 offset:2048
  ds_read_b64 v[94:95], v116 offset:2056
  v_mfma_f32_16x16x32_bf16 v[40:43], v[76:79], v[60:63], v[108:111]
  v_mfma_f32_16x16x32_bf16 v[44:47], v[80:83], v[60:63], v[104:107]
  v_mfma_f32_16x16x32_bf16 v[32:35], v[72:75], v[56:59], v[108:111]
  v_mfma_f32_16x16x32_bf16 v[36:39], v[76:79], v[56:59], v[104:107]
  v_mfma_f32_16x16x32_bf16 v[24:27], v[68:71], v[52:55], v[108:111]
  v_mfma_f32_16x16x32_bf16 v[28:31], v[72:75], v[52:55], v[104:107]
  s_waitcnt lgkmcnt(0)
  v_mfma_f32_16x16x32_bf16 v[16:19], v[64:67], v[48:51], v[112:115]
  v_mfma_f32_16x16x32_bf16 v[20:23], v[68:71], v[48:51], v[104:107]
  v_max3_f32 v134, v40, v41, v42
  v_max3_f32 v135, v43, v44, v45
  v_max3_f32 v134, v134, v46, v47
  v_max_f32 v134, v134, v135
  v_max3_f32 v132, v32, v33, v34
  v_max3_f32 v133, v35, v36, v37
  v_max3_f32 v132, v132, v38, v39
  v_max_f32 v132, v132, v133
  v_max3_f32 v130, v24, v25, v26
  v_max3_f32 v131, v27, v28, v29
  v_max3_f32 v130, v130, v30, v31
  v_max_f32 v130, v130, v131
  v_max3_f32 v128, v16, v17, v18
  v_max3_f32 v129, v19, v20, v21
  v_max3_f32 v128, v128, v22, v23
  v_max_f32 v128, v128, v129
  v_mov_b32 v135, v134
  v_mov_b32 v133, v132
  v_mov_b32 v131, v130
  v_mov_b32 v129, v128
  v_permlane32_swap_b32 v134, v135
  v_permlane32_swap_b32 v132, v133
  v_permlane32_swap_b32 v130, v131
  v_permlane32_swap_b32 v128, v129
  v_max_f32 v134, v134, v135
  v_max_f32 v132, v132, v133
  v_max_f32 v130, v130, v131
  v_max_f32 v128, v128, v129
  v_mov_b32 v135, v134
  v_mov_b32 v133, v132
  v_mov_b32 v131, v130
  v_mov_b32 v129, v128
  v_permlane16_swap_b32 v134, v135
  v_permlane16_swap_b32 v132, v133
  v_permlane16_swap_b32 v130, v131
  v_permlane16_swap_b32 v128, v129
  v_max_f32 v134, v134, v135
  v_max_f32 v132, v132, v133
  v_max_f32 v130, v130, v131
  v_max_f32 v128, v128, v129
  v_sub_f32 v40, v40, v134
  v_sub_f32 v41, v41, v134
  v_sub_f32 v42, v42, v134
  v_sub_f32 v43, v43, v134
  v_sub_f32 v44, v44, v134
  v_sub_f32 v45, v45, v134
  v_sub_f32 v46, v46, v134
  v_sub_f32 v47, v47, v134
  v_exp_f32 v40, v40
  v_exp_f32 v41, v41
  v_exp_f32 v42, v42
  v_exp_f32 v43, v43
  v_exp_f32 v44, v44
  v_exp_f32 v45, v45
  v_exp_f32 v46, v46
  v_exp_f32 v47, v47
  v_sub_f32 v32, v32, v132
  v_sub_f32 v33, v33, v132
  v_sub_f32 v34, v34, v132
  v_sub_f32 v35, v35, v132
  v_sub_f32 v36, v36, v132
  v_sub_f32 v37, v37, v132
  v_sub_f32 v38, v38, v132
  v_sub_f32 v39, v39, v132
  v_exp_f32 v32, v32
  v_exp_f32 v33, v33
  v_exp_f32 v34, v34
  v_exp_f32 v35, v35
  v_exp_f32 v36, v36
  v_exp_f32 v37, v37
  v_exp_f32 v38, v38
  v_exp_f32 v39, v39
  v_sub_f32 v24, v24, v130
  v_sub_f32 v25, v25, v130
  v_sub_f32 v26, v26, v130
  v_sub_f32 v27, v27, v130
  v_sub_f32 v28, v28, v130
  v_sub_f32 v29, v29, v130
  v_sub_f32 v30, v30, v130
  v_sub_f32 v31, v31, v130
  v_exp_f32 v24, v24
  v_exp_f32 v25, v25
  v_exp_f32 v26, v26
  v_exp_f32 v27, v27
  v_exp_f32 v28, v28
  v_exp_f32 v29, v29
  v_exp_f32 v30, v30
  v_exp_f32 v31, v31
  v_sub_f32 v16, v16, v128
  v_sub_f32 v17, v17, v128
  v_sub_f32 v18, v18, v128
  v_sub_f32 v19, v19, v128
  v_sub_f32 v20, v20, v128
  v_sub_f32 v21, v21, v128
  v_sub_f32 v22, v22, v128
  v_sub_f32 v23, v23, v128
  v_exp_f32 v16, v16
  v_exp_f32 v17, v17
  v_exp_f32 v18, v18
  v_exp_f32 v19, v19
  v_exp_f32 v20, v20
  v_exp_f32 v21, v21
  v_exp_f32 v22, v22
  v_exp_f32 v23, v23
  v_cvt_pk_bf16_f32 v148, v40, v41
  v_cvt_pk_bf16_f32 v149, v42, v43
  v_cvt_pk_bf16_f32 v150, v44, v45
  v_cvt_pk_bf16_f32 v151, v46, v47
  v_cvt_pk_bf16_f32 v144, v32, v33
  v_cvt_pk_bf16_f32 v145, v34, v35
  v_cvt_pk_bf16_f32 v146, v36, v37
  v_cvt_pk_bf16_f32 v147, v38, v39
  v_cvt_pk_bf16_f32 v140, v24, v25
  v_cvt_pk_bf16_f32 v141, v26, v27
  v_cvt_pk_bf16_f32 v142, v28, v29
  v_cvt_pk_bf16_f32 v143, v30, v31
  v_cvt_pk_bf16_f32 v136, v16, v17
  v_cvt_pk_bf16_f32 v137, v18, v19
  v_cvt_pk_bf16_f32 v138, v20, v21
  v_cvt_pk_bf16_f32 v139, v22, v23
  v_mfma_f32_16x16x32_bf16 v[164:167], v[120:123], v[148:151], 0
  v_mfma_f32_16x16x32_bf16 v[192:195], v[90:93], v[148:151], 0
  v_mfma_f32_16x16x32_bf16 v[196:199], v[100:103], v[148:151], 0
  v_mfma_f32_16x16x32_bf16 v[160:163], v[120:123], v[144:147], 0
  v_mfma_f32_16x16x32_bf16 v[184:187], v[88:91], v[144:147], 0
  v_mfma_f32_16x16x32_bf16 v[188:191], v[98:101], v[144:147], 0
  v_mfma_f32_16x16x32_bf16 v[156:159], v[120:123], v[140:143], 0
  v_mfma_f32_16x16x32_bf16 v[176:179], v[86:89], v[140:143], 0
  v_mfma_f32_16x16x32_bf16 v[180:183], v[96:99], v[140:143], 0
  v_mfma_f32_16x16x32_bf16 v[152:155], v[120:123], v[136:139], 0
  v_mfma_f32_16x16x32_bf16 v[168:171], v[84:87], v[136:139], 0
  v_mfma_f32_16x16x32_bf16 v[172:175], v[94:97], v[136:139], 0
  s_add_u32 s16, s86, 83886080
  s_addc_u32 s17, s87, 0
  s_mov_b32 s18, 4194304
  s_mov_b32 s19, 0x00020000
  s_lshl_b32 s4, s54, 18
  s_lshl_b32 s5, s55, 14
  s_add_u32 s4, s4, s5
  s_and_b32 s5, s3, 1
  s_lshl_b32 s5, s5, 13
  s_add_u32 s4, s4, s5
  v_rcp_f32 v164, v164
  v_rcp_f32 v160, v160
  v_rcp_f32 v156, v156
  v_rcp_f32 v152, v152
  v_mov_b32 v165, v164
  v_mov_b32 v161, v160
  v_mov_b32 v157, v156
  v_mov_b32 v153, v152
  v_pk_mul_f32 v[192:193], v[192:193], v[164:165]
  v_pk_mul_f32 v[194:195], v[194:195], v[164:165]
  v_pk_mul_f32 v[196:197], v[196:197], v[164:165]
  v_pk_mul_f32 v[198:199], v[198:199], v[164:165]
  v_cvt_pk_bf16_f32 v192, v192, v193
  v_cvt_pk_bf16_f32 v193, v194, v195
  v_cvt_pk_bf16_f32 v194, v196, v197
  v_cvt_pk_bf16_f32 v195, v198, v199
  buffer_store_dwordx4 v[192:195], v2, s[16:19], s4 offen offset:3072
  v_pk_mul_f32 v[184:185], v[184:185], v[160:161]
  v_pk_mul_f32 v[186:187], v[186:187], v[160:161]
  v_pk_mul_f32 v[188:189], v[188:189], v[160:161]
  v_pk_mul_f32 v[190:191], v[190:191], v[160:161]
  v_cvt_pk_bf16_f32 v184, v184, v185
  v_cvt_pk_bf16_f32 v185, v186, v187
  v_cvt_pk_bf16_f32 v186, v188, v189
  v_cvt_pk_bf16_f32 v187, v190, v191
  buffer_store_dwordx4 v[184:187], v2, s[16:19], s4 offen offset:2048
  v_pk_mul_f32 v[176:177], v[176:177], v[156:157]
  v_pk_mul_f32 v[178:179], v[178:179], v[156:157]
  v_pk_mul_f32 v[180:181], v[180:181], v[156:157]
  v_pk_mul_f32 v[182:183], v[182:183], v[156:157]
  v_cvt_pk_bf16_f32 v176, v176, v177
  v_cvt_pk_bf16_f32 v177, v178, v179
  v_cvt_pk_bf16_f32 v178, v180, v181
  v_cvt_pk_bf16_f32 v179, v182, v183
  buffer_store_dwordx4 v[176:179], v2, s[16:19], s4 offen offset:1024
  v_pk_mul_f32 v[168:169], v[168:169], v[152:153]
  v_pk_mul_f32 v[170:171], v[170:171], v[152:153]
  v_pk_mul_f32 v[172:173], v[172:173], v[152:153]
  v_pk_mul_f32 v[174:175], v[174:175], v[152:153]
  v_cvt_pk_bf16_f32 v168, v168, v169
  v_cvt_pk_bf16_f32 v169, v170, v171
  v_cvt_pk_bf16_f32 v170, v172, v173
  v_cvt_pk_bf16_f32 v171, v174, v175
  buffer_store_dwordx4 v[168:171], v2, s[16:19], s4 offen offset:0
  s_branch Lp2_done
Lp2_r1:
  s_mov_b32 s37, 0
  s_mov_b32 s39, 4294877184
  s_mov_b32 s40, 45056
  s_waitcnt vmcnt(54)
  s_barrier
  ds_read_b128 a[0:3], v16 offset:0
  ds_read_b64_tr_b16 a[40:41], v20 offset:20480
  ds_read_b64_tr_b16 a[42:43], v20 offset:22528
  ds_read_b128 a[4:7], v16 offset:2048
  ds_read_b128 a[8:11], v16 offset:4096
  ds_read_b128 a[12:15], v16 offset:6144
  ds_read_b64_tr_b16 a[44:45], v21 offset:20480
  ds_read_b64_tr_b16 a[46:47], v21 offset:22528
  ds_read_b64_tr_b16 a[48:49], v20 offset:28672
  ds_read_b64_tr_b16 a[50:51], v20 offset:30720
  ds_read_b64_tr_b16 a[52:53], v21 offset:28672
  ds_read_b64_tr_b16 a[54:55], v21 offset:30720
  ds_read_b64_tr_b16 a[56:57], v20 offset:36864
  ds_read_b64_tr_b16 a[58:59], v20 offset:38912
  ds_read_b128 a[16:19], v18 offset:0
  ds_read_b64_tr_b16 a[60:61], v21 offset:36864
  ds_read_b64_tr_b16 a[62:63], v21 offset:38912
  s_waitcnt lgkmcnt(0)
  v_mfma_f32_16x16x32_bf16 v[128:131], a[40:43], a[0:3], 0
  s_add_u32 s37, s37, 1
  s_cmp_eq_u32 s37, 3
  s_cselect_b32 s37, 0, s37
  s_cselect_b32 s38, s39, s40
  ds_read_b128 a[20:23], v17 offset:0
  v_mfma_f32_16x16x32_bf16 v[136:139], a[40:43], a[4:7], 0
  ds_read_b64_tr_b16 a[64:65], v20 offset:24576
  v_mfma_f32_16x16x32_bf16 v[144:147], a[40:43], a[8:11], 0
  ds_read_b64_tr_b16 a[66:67], v20 offset:26624
  v_mfma_f32_16x16x32_bf16 v[152:155], a[40:43], a[12:15], 0
  ds_read_b128 a[24:27], v17 offset:2048
  v_mfma_f32_16x16x32_bf16 v[132:135], a[44:47], a[0:3], 0
  ds_read_b128 a[28:31], v17 offset:4096
  v_mfma_f32_16x16x32_bf16 v[140:143], a[44:47], a[4:7], 0
  ds_read_b128 a[32:35], v17 offset:6144
  v_mfma_f32_16x16x32_bf16 v[148:151], a[44:47], a[8:11], 0
  ds_read_b64_tr_b16 a[68:69], v21 offset:24576
  v_mfma_f32_16x16x32_bf16 v[156:159], a[44:47], a[12:15], 0
  ds_read_b64_tr_b16 a[70:71], v21 offset:26624
  v_mfma_f32_16x16x32_bf16 v[160:163], a[48:51], a[0:3], 0
  ds_read_b64_tr_b16 a[72:73], v20 offset:32768
  v_mfma_f32_16x16x32_bf16 v[168:171], a[48:51], a[4:7], 0
  ds_read_b64_tr_b16 a[74:75], v20 offset:34816
  v_mfma_f32_16x16x32_bf16 v[176:179], a[48:51], a[8:11], 0
  ds_read_b64_tr_b16 a[76:77], v21 offset:32768
  v_mfma_f32_16x16x32_bf16 v[184:187], a[48:51], a[12:15], 0
  ds_read_b64_tr_b16 a[78:79], v21 offset:34816
  v_mfma_f32_16x16x32_bf16 v[164:167], a[52:55], a[0:3], 0
  ds_read_b64_tr_b16 a[80:81], v20 offset:40960
  v_mfma_f32_16x16x32_bf16 v[172:175], a[52:55], a[4:7], 0
  ds_read_b64_tr_b16 a[82:83], v20 offset:43008
  v_mfma_f32_16x16x32_bf16 v[180:183], a[52:55], a[8:11], 0
  ds_read_b128 a[36:39], v19 offset:0
  v_mfma_f32_16x16x32_bf16 v[188:191], a[52:55], a[12:15], 0
  ds_read_b64_tr_b16 a[84:85], v21 offset:40960
  v_mfma_f32_16x16x32_bf16 v[192:195], a[0:3], a[56:59], 0
  ds_read_b64_tr_b16 a[86:87], v21 offset:43008
  v_mfma_f32_16x16x32_bf16 v[200:203], a[4:7], a[56:59], 0
  v_add_u32 v16, s38, v16
  v_add_u32 v17, s38, v17
  v_mfma_f32_16x16x32_bf16 v[208:211], a[8:11], a[56:59], 0
  v_add_u32 v18, s38, v18
  v_add_u32 v19, s38, v19
  v_mfma_f32_16x16x32_bf16 v[216:219], a[12:15], a[56:59], 0
  v_add_u32 v20, s38, v20
  v_add_u32 v21, s38, v21
  v_mfma_f32_16x16x32_bf16 v[224:227], a[16:19], a[56:59], 0
  v_mfma_f32_16x16x32_bf16 v[196:199], a[0:3], a[60:63], 0
  v_mfma_f32_16x16x32_bf16 v[204:207], a[4:7], a[60:63], 0
  v_mfma_f32_16x16x32_bf16 v[212:215], a[8:11], a[60:63], 0
  v_mfma_f32_16x16x32_bf16 v[220:223], a[12:15], a[60:63], 0
  v_mfma_f32_16x16x32_bf16 v[228:231], a[16:19], a[60:63], 0
  s_mov_b32 s35, 13
  .p2align 6
Lp2r1_loop:
  s_waitcnt vmcnt(11) lgkmcnt(0)
  s_barrier
  v_mfma_f32_16x16x32_bf16 v[128:131], a[64:67], a[20:23], v[128:131]
  s_add_u32 m0, s36, s48
  ds_read_b128 a[0:3], v16 offset:0
  v_mfma_f32_16x16x32_bf16 v[136:139], a[64:67], a[24:27], v[136:139]
  buffer_load_dwordx4 v8, s[12:15], s47 offen offset:0 lds
  ds_read_b64_tr_b16 a[40:41], v20 offset:20480
  v_mfma_f32_16x16x32_bf16 v[144:147], a[64:67], a[28:31], v[144:147]
  ds_read_b64_tr_b16 a[42:43], v20 offset:22528
  v_mfma_f32_16x16x32_bf16 v[152:155], a[64:67], a[32:35], v[152:155]
  ds_read_b128 a[4:7], v16 offset:2048
  v_mfma_f32_16x16x32_bf16 v[132:135], a[68:71], a[20:23], v[132:135]
  buffer_load_dwordx4 v9, s[12:15], s47 offen offset:1024 lds
  ds_read_b128 a[8:11], v16 offset:4096
  v_mfma_f32_16x16x32_bf16 v[140:143], a[68:71], a[24:27], v[140:143]
  ds_read_b128 a[12:15], v16 offset:6144
  v_mfma_f32_16x16x32_bf16 v[148:151], a[68:71], a[28:31], v[148:151]
  ds_read_b64_tr_b16 a[44:45], v21 offset:20480
  v_mfma_f32_16x16x32_bf16 v[156:159], a[68:71], a[32:35], v[156:159]
  ds_read_b64_tr_b16 a[46:47], v21 offset:22528
  v_mfma_f32_16x16x32_bf16 v[160:163], a[72:75], a[20:23], v[160:163]
  buffer_load_dwordx4 v10, s[12:15], s47 offen offset:2048 lds
  ds_read_b64_tr_b16 a[48:49], v20 offset:28672
  v_mfma_f32_16x16x32_bf16 v[168:171], a[72:75], a[24:27], v[168:171]
  s_add_u32 m0, s36, s49
  ds_read_b64_tr_b16 a[50:51], v20 offset:30720
  v_mfma_f32_16x16x32_bf16 v[176:179], a[72:75], a[28:31], v[176:179]
  ds_read_b64_tr_b16 a[52:53], v21 offset:28672
  v_mfma_f32_16x16x32_bf16 v[184:187], a[72:75], a[32:35], v[184:187]
  ds_read_b64_tr_b16 a[54:55], v21 offset:30720
  v_mfma_f32_16x16x32_bf16 v[164:167], a[76:79], a[20:23], v[164:167]
  buffer_load_dwordx4 v11, s[12:15], s47 offen offset:0 lds
  ds_read_b64_tr_b16 a[56:57], v20 offset:36864
  v_mfma_f32_16x16x32_bf16 v[172:175], a[76:79], a[24:27], v[172:175]
  ds_read_b64_tr_b16 a[58:59], v20 offset:38912
  v_mfma_f32_16x16x32_bf16 v[180:183], a[76:79], a[28:31], v[180:183]
  ds_read_b128 a[16:19], v18 offset:0
  v_mfma_f32_16x16x32_bf16 v[188:191], a[76:79], a[32:35], v[188:191]
  ds_read_b64_tr_b16 a[60:61], v21 offset:36864
  v_mfma_f32_16x16x32_bf16 v[192:195], a[20:23], a[80:83], v[192:195]
  buffer_load_dwordx4 v12, s[12:15], s47 offen offset:1024 lds
  ds_read_b64_tr_b16 a[62:63], v21 offset:38912
  v_mfma_f32_16x16x32_bf16 v[200:203], a[24:27], a[80:83], v[200:203]
  v_mfma_f32_16x16x32_bf16 v[208:211], a[28:31], a[80:83], v[208:211]
  v_mfma_f32_16x16x32_bf16 v[216:219], a[32:35], a[80:83], v[216:219]
  v_mfma_f32_16x16x32_bf16 v[224:227], a[36:39], a[80:83], v[224:227]
  buffer_load_dwordx4 v13, s[12:15], s47 offen offset:2048 lds
  v_mfma_f32_16x16x32_bf16 v[196:199], a[20:23], a[84:87], v[196:199]
  s_add_u32 s47, s47, 393216
  v_mfma_f32_16x16x32_bf16 v[204:207], a[24:27], a[84:87], v[204:207]
  v_mfma_f32_16x16x32_bf16 v[212:215], a[28:31], a[84:87], v[212:215]
  v_mfma_f32_16x16x32_bf16 v[220:223], a[32:35], a[84:87], v[220:223]
  v_mfma_f32_16x16x32_bf16 v[228:231], a[36:39], a[84:87], v[228:231]
  s_waitcnt lgkmcnt(0)
  v_mfma_f32_16x16x32_bf16 v[128:131], a[40:43], a[0:3], v[128:131]
  s_mov_b32 m0, s36
  ds_read_b128 a[20:23], v17 offset:0
  v_mfma_f32_16x16x32_bf16 v[136:139], a[40:43], a[4:7], v[136:139]
  buffer_load_dwordx4 v24, s[8:11], s46 offen offset:0 lds
  ds_read_b64_tr_b16 a[64:65], v20 offset:24576
  v_mfma_f32_16x16x32_bf16 v[144:147], a[40:43], a[8:11], v[144:147]
  ds_read_b64_tr_b16 a[66:67], v20 offset:26624
  v_mfma_f32_16x16x32_bf16 v[152:155], a[40:43], a[12:15], v[152:155]
  buffer_load_dwordx4 v25, s[8:11], s46 offen offset:1024 lds
  ds_read_b128 a[24:27], v17 offset:2048
  v_mfma_f32_16x16x32_bf16 v[132:135], a[44:47], a[0:3], v[132:135]
  ds_read_b128 a[28:31], v17 offset:4096
  v_mfma_f32_16x16x32_bf16 v[140:143], a[44:47], a[4:7], v[140:143]
  ds_read_b128 a[32:35], v17 offset:6144
  v_mfma_f32_16x16x32_bf16 v[148:151], a[44:47], a[8:11], v[148:151]
  ds_read_b64_tr_b16 a[68:69], v21 offset:24576
  v_mfma_f32_16x16x32_bf16 v[156:159], a[44:47], a[12:15], v[156:159]
  buffer_load_dwordx4 v26, s[8:11], s46 offen offset:2048 lds
  ds_read_b64_tr_b16 a[70:71], v21 offset:26624
  v_mfma_f32_16x16x32_bf16 v[160:163], a[48:51], a[0:3], v[160:163]
  ds_read_b64_tr_b16 a[72:73], v20 offset:32768
  v_mfma_f32_16x16x32_bf16 v[168:171], a[48:51], a[4:7], v[168:171]
  ds_read_b64_tr_b16 a[74:75], v20 offset:34816
  v_mfma_f32_16x16x32_bf16 v[176:179], a[48:51], a[8:11], v[176:179]
  ds_read_b64_tr_b16 a[76:77], v21 offset:32768
  v_mfma_f32_16x16x32_bf16 v[184:187], a[48:51], a[12:15], v[184:187]
  buffer_load_dwordx4 v27, s[8:11], s46 offen offset:3072 lds
  ds_read_b64_tr_b16 a[78:79], v21 offset:34816
  v_mfma_f32_16x16x32_bf16 v[164:167], a[52:55], a[0:3], v[164:167]
  s_add_u32 m0, s36, s52
  ds_read_b64_tr_b16 a[80:81], v20 offset:40960
  v_mfma_f32_16x16x32_bf16 v[172:175], a[52:55], a[4:7], v[172:175]
  ds_read_b64_tr_b16 a[82:83], v20 offset:43008
  v_mfma_f32_16x16x32_bf16 v[180:183], a[52:55], a[8:11], v[180:183]
  ds_read_b128 a[36:39], v19 offset:0
  v_mfma_f32_16x16x32_bf16 v[188:191], a[52:55], a[12:15], v[188:191]
  buffer_load_dwordx4 v28, s[8:11], s46 offen offset:0 lds
  ds_read_b64_tr_b16 a[84:85], v21 offset:40960
  v_mfma_f32_16x16x32_bf16 v[192:195], a[0:3], a[56:59], v[192:195]
  s_add_u32 s46, s46, 128
  ds_read_b64_tr_b16 a[86:87], v21 offset:43008
  v_mfma_f32_16x16x32_bf16 v[200:203], a[4:7], a[56:59], v[200:203]
  s_add_u32 s36, s36, s38
  s_add_u32 s37, s37, 1
  s_cmp_eq_u32 s37, 3
  s_cselect_b32 s37, 0, s37
  s_cselect_b32 s38, s39, s40
  v_mfma_f32_16x16x32_bf16 v[208:211], a[8:11], a[56:59], v[208:211]
  v_add_u32 v16, s38, v16
  v_add_u32 v17, s38, v17
  v_mfma_f32_16x16x32_bf16 v[216:219], a[12:15], a[56:59], v[216:219]
  v_add_u32 v18, s38, v18
  v_add_u32 v19, s38, v19
  v_mfma_f32_16x16x32_bf16 v[224:227], a[16:19], a[56:59], v[224:227]
  v_add_u32 v20, s38, v20
  v_add_u32 v21, s38, v21
  v_mfma_f32_16x16x32_bf16 v[196:199], a[0:3], a[60:63], v[196:199]
  v_mfma_f32_16x16x32_bf16 v[204:207], a[4:7], a[60:63], v[204:207]
  v_mfma_f32_16x16x32_bf16 v[212:215], a[8:11], a[60:63], v[212:215]
  v_mfma_f32_16x16x32_bf16 v[220:223], a[12:15], a[60:63], v[220:223]
  s_sub_u32 s35, s35, 1
  v_mfma_f32_16x16x32_bf16 v[228:231], a[16:19], a[60:63], v[228:231]
  s_cmp_lg_u32 s35, 0
  s_cbranch_scc1 Lp2r1_loop
  s_waitcnt vmcnt(11) lgkmcnt(0)
  s_barrier
  v_mfma_f32_16x16x32_bf16 v[128:131], a[64:67], a[20:23], v[128:131]
  ds_read_b128 a[0:3], v16 offset:0
  v_mfma_f32_16x16x32_bf16 v[136:139], a[64:67], a[24:27], v[136:139]
  ds_read_b64_tr_b16 a[40:41], v20 offset:20480
  v_mfma_f32_16x16x32_bf16 v[144:147], a[64:67], a[28:31], v[144:147]
  ds_read_b64_tr_b16 a[42:43], v20 offset:22528
  v_mfma_f32_16x16x32_bf16 v[152:155], a[64:67], a[32:35], v[152:155]
  ds_read_b128 a[4:7], v16 offset:2048
  v_mfma_f32_16x16x32_bf16 v[132:135], a[68:71], a[20:23], v[132:135]
  ds_read_b128 a[8:11], v16 offset:4096
  v_mfma_f32_16x16x32_bf16 v[140:143], a[68:71], a[24:27], v[140:143]
  ds_read_b128 a[12:15], v16 offset:6144
  v_mfma_f32_16x16x32_bf16 v[148:151], a[68:71], a[28:31], v[148:151]
  ds_read_b64_tr_b16 a[44:45], v21 offset:20480
  v_mfma_f32_16x16x32_bf16 v[156:159], a[68:71], a[32:35], v[156:159]
  ds_read_b64_tr_b16 a[46:47], v21 offset:22528
  v_mfma_f32_16x16x32_bf16 v[160:163], a[72:75], a[20:23], v[160:163]
  ds_read_b64_tr_b16 a[48:49], v20 offset:28672
  v_mfma_f32_16x16x32_bf16 v[168:171], a[72:75], a[24:27], v[168:171]
  ds_read_b64_tr_b16 a[50:51], v20 offset:30720
  v_mfma_f32_16x16x32_bf16 v[176:179], a[72:75], a[28:31], v[176:179]
  ds_read_b64_tr_b16 a[52:53], v21 offset:28672
  v_mfma_f32_16x16x32_bf16 v[184:187], a[72:75], a[32:35], v[184:187]
  ds_read_b64_tr_b16 a[54:55], v21 offset:30720
  v_mfma_f32_16x16x32_bf16 v[164:167], a[76:79], a[20:23], v[164:167]
  ds_read_b64_tr_b16 a[56:57], v20 offset:36864
  v_mfma_f32_16x16x32_bf16 v[172:175], a[76:79], a[24:27], v[172:175]
  ds_read_b64_tr_b16 a[58:59], v20 offset:38912
  v_mfma_f32_16x16x32_bf16 v[180:183], a[76:79], a[28:31], v[180:183]
  ds_read_b128 a[16:19], v18 offset:0
  v_mfma_f32_16x16x32_bf16 v[188:191], a[76:79], a[32:35], v[188:191]
  ds_read_b64_tr_b16 a[60:61], v21 offset:36864
  v_mfma_f32_16x16x32_bf16 v[192:195], a[20:23], a[80:83], v[192:195]
  ds_read_b64_tr_b16 a[62:63], v21 offset:38912
  v_mfma_f32_16x16x32_bf16 v[200:203], a[24:27], a[80:83], v[200:203]
  v_mfma_f32_16x16x32_bf16 v[208:211], a[28:31], a[80:83], v[208:211]
  v_mfma_f32_16x16x32_bf16 v[216:219], a[32:35], a[80:83], v[216:219]
  v_mfma_f32_16x16x32_bf16 v[224:227], a[36:39], a[80:83], v[224:227]
  v_mfma_f32_16x16x32_bf16 v[196:199], a[20:23], a[84:87], v[196:199]
  v_mfma_f32_16x16x32_bf16 v[204:207], a[24:27], a[84:87], v[204:207]
  v_mfma_f32_16x16x32_bf16 v[212:215], a[28:31], a[84:87], v[212:215]
  v_mfma_f32_16x16x32_bf16 v[220:223], a[32:35], a[84:87], v[220:223]
  v_mfma_f32_16x16x32_bf16 v[228:231], a[36:39], a[84:87], v[228:231]
  s_waitcnt lgkmcnt(0)
  v_mfma_f32_16x16x32_bf16 v[128:131], a[40:43], a[0:3], v[128:131]
  s_add_u32 s37, s37, 1
  s_cmp_eq_u32 s37, 3
  s_cselect_b32 s37, 0, s37
  s_cselect_b32 s38, s39, s40
  ds_read_b128 a[20:23], v17 offset:0
  v_mfma_f32_16x16x32_bf16 v[136:139], a[40:43], a[4:7], v[136:139]
  ds_read_b64_tr_b16 a[64:65], v20 offset:24576
  v_mfma_f32_16x16x32_bf16 v[144:147], a[40:43], a[8:11], v[144:147]
  ds_read_b64_tr_b16 a[66:67], v20 offset:26624
  v_mfma_f32_16x16x32_bf16 v[152:155], a[40:43], a[12:15], v[152:155]
  ds_read_b128 a[24:27], v17 offset:2048
  v_mfma_f32_16x16x32_bf16 v[132:135], a[44:47], a[0:3], v[132:135]
  ds_read_b128 a[28:31], v17 offset:4096
  v_mfma_f32_16x16x32_bf16 v[140:143], a[44:47], a[4:7], v[140:143]
  ds_read_b128 a[32:35], v17 offset:6144
  v_mfma_f32_16x16x32_bf16 v[148:151], a[44:47], a[8:11], v[148:151]
  ds_read_b64_tr_b16 a[68:69], v21 offset:24576
  v_mfma_f32_16x16x32_bf16 v[156:159], a[44:47], a[12:15], v[156:159]
  ds_read_b64_tr_b16 a[70:71], v21 offset:26624
  v_mfma_f32_16x16x32_bf16 v[160:163], a[48:51], a[0:3], v[160:163]
  ds_read_b64_tr_b16 a[72:73], v20 offset:32768
  v_mfma_f32_16x16x32_bf16 v[168:171], a[48:51], a[4:7], v[168:171]
  ds_read_b64_tr_b16 a[74:75], v20 offset:34816
  v_mfma_f32_16x16x32_bf16 v[176:179], a[48:51], a[8:11], v[176:179]
  ds_read_b64_tr_b16 a[76:77], v21 offset:32768
  v_mfma_f32_16x16x32_bf16 v[184:187], a[48:51], a[12:15], v[184:187]
  ds_read_b64_tr_b16 a[78:79], v21 offset:34816
  v_mfma_f32_16x16x32_bf16 v[164:167], a[52:55], a[0:3], v[164:167]
  ds_read_b64_tr_b16 a[80:81], v20 offset:40960
  v_mfma_f32_16x16x32_bf16 v[172:175], a[52:55], a[4:7], v[172:175]
  ds_read_b64_tr_b16 a[82:83], v20 offset:43008
  v_mfma_f32_16x16x32_bf16 v[180:183], a[52:55], a[8:11], v[180:183]
  ds_read_b128 a[36:39], v19 offset:0
  v_mfma_f32_16x16x32_bf16 v[188:191], a[52:55], a[12:15], v[188:191]
  ds_read_b64_tr_b16 a[84:85], v21 offset:40960
  v_mfma_f32_16x16x32_bf16 v[192:195], a[0:3], a[56:59], v[192:195]
  ds_read_b64_tr_b16 a[86:87], v21 offset:43008
  v_mfma_f32_16x16x32_bf16 v[200:203], a[4:7], a[56:59], v[200:203]
  v_add_u32 v16, s38, v16
  v_add_u32 v17, s38, v17
  v_mfma_f32_16x16x32_bf16 v[208:211], a[8:11], a[56:59], v[208:211]
  v_add_u32 v18, s38, v18
  v_add_u32 v19, s38, v19
  v_mfma_f32_16x16x32_bf16 v[216:219], a[12:15], a[56:59], v[216:219]
  v_add_u32 v20, s38, v20
  v_add_u32 v21, s38, v21
  v_mfma_f32_16x16x32_bf16 v[224:227], a[16:19], a[56:59], v[224:227]
  v_mfma_f32_16x16x32_bf16 v[196:199], a[0:3], a[60:63], v[196:199]
  v_mfma_f32_16x16x32_bf16 v[204:207], a[4:7], a[60:63], v[204:207]
  v_mfma_f32_16x16x32_bf16 v[212:215], a[8:11], a[60:63], v[212:215]
  v_mfma_f32_16x16x32_bf16 v[220:223], a[12:15], a[60:63], v[220:223]
  v_mfma_f32_16x16x32_bf16 v[228:231], a[16:19], a[60:63], v[228:231]
  s_waitcnt vmcnt(0) lgkmcnt(0)
  s_barrier
  v_mfma_f32_16x16x32_bf16 v[128:131], a[64:67], a[20:23], v[128:131]
  ds_read_b128 a[0:3], v16 offset:0
  v_mfma_f32_16x16x32_bf16 v[136:139], a[64:67], a[24:27], v[136:139]
  ds_read_b64_tr_b16 a[40:41], v20 offset:20480
  v_mfma_f32_16x16x32_bf16 v[144:147], a[64:67], a[28:31], v[144:147]
  ds_read_b64_tr_b16 a[42:43], v20 offset:22528
  v_mfma_f32_16x16x32_bf16 v[152:155], a[64:67], a[32:35], v[152:155]
  ds_read_b128 a[4:7], v16 offset:2048
  v_mfma_f32_16x16x32_bf16 v[132:135], a[68:71], a[20:23], v[132:135]
  ds_read_b128 a[8:11], v16 offset:4096
  v_mfma_f32_16x16x32_bf16 v[140:143], a[68:71], a[24:27], v[140:143]
  ds_read_b128 a[12:15], v16 offset:6144
  v_mfma_f32_16x16x32_bf16 v[148:151], a[68:71], a[28:31], v[148:151]
  ds_read_b64_tr_b16 a[44:45], v21 offset:20480
  v_mfma_f32_16x16x32_bf16 v[156:159], a[68:71], a[32:35], v[156:159]
  ds_read_b64_tr_b16 a[46:47], v21 offset:22528
  v_mfma_f32_16x16x32_bf16 v[160:163], a[72:75], a[20:23], v[160:163]
  ds_read_b64_tr_b16 a[48:49], v20 offset:28672
  v_mfma_f32_16x16x32_bf16 v[168:171], a[72:75], a[24:27], v[168:171]
  ds_read_b64_tr_b16 a[50:51], v20 offset:30720
  v_mfma_f32_16x16x32_bf16 v[176:179], a[72:75], a[28:31], v[176:179]
  ds_read_b64_tr_b16 a[52:53], v21 offset:28672
  v_mfma_f32_16x16x32_bf16 v[184:187], a[72:75], a[32:35], v[184:187]
  ds_read_b64_tr_b16 a[54:55], v21 offset:30720
  v_mfma_f32_16x16x32_bf16 v[164:167], a[76:79], a[20:23], v[164:167]
  ds_read_b64_tr_b16 a[56:57], v20 offset:36864
  v_mfma_f32_16x16x32_bf16 v[172:175], a[76:79], a[24:27], v[172:175]
  ds_read_b64_tr_b16 a[58:59], v20 offset:38912
  v_mfma_f32_16x16x32_bf16 v[180:183], a[76:79], a[28:31], v[180:183]
  ds_read_b128 a[16:19], v18 offset:0
  v_mfma_f32_16x16x32_bf16 v[188:191], a[76:79], a[32:35], v[188:191]
  ds_read_b64_tr_b16 a[60:61], v21 offset:36864
  v_mfma_f32_16x16x32_bf16 v[192:195], a[20:23], a[80:83], v[192:195]
  ds_read_b64_tr_b16 a[62:63], v21 offset:38912
  v_mfma_f32_16x16x32_bf16 v[200:203], a[24:27], a[80:83], v[200:203]
  v_mfma_f32_16x16x32_bf16 v[208:211], a[28:31], a[80:83], v[208:211]
  v_mfma_f32_16x16x32_bf16 v[216:219], a[32:35], a[80:83], v[216:219]
  v_mfma_f32_16x16x32_bf16 v[224:227], a[36:39], a[80:83], v[224:227]
  v_mfma_f32_16x16x32_bf16 v[196:199], a[20:23], a[84:87], v[196:199]
  v_mfma_f32_16x16x32_bf16 v[204:207], a[24:27], a[84:87], v[204:207]
  v_mfma_f32_16x16x32_bf16 v[212:215], a[28:31], a[84:87], v[212:215]
  v_mfma_f32_16x16x32_bf16 v[220:223], a[32:35], a[84:87], v[220:223]
  v_mfma_f32_16x16x32_bf16 v[228:231], a[36:39], a[84:87], v[228:231]
  s_waitcnt lgkmcnt(0)
  v_mfma_f32_16x16x32_bf16 v[128:131], a[40:43], a[0:3], v[128:131]
  ds_read_b128 a[20:23], v17 offset:0
  v_mfma_f32_16x16x32_bf16 v[136:139], a[40:43], a[4:7], v[136:139]
  ds_read_b64_tr_b16 a[64:65], v20 offset:24576
  v_mfma_f32_16x16x32_bf16 v[144:147], a[40:43], a[8:11], v[144:147]
  ds_read_b64_tr_b16 a[66:67], v20 offset:26624
  v_mfma_f32_16x16x32_bf16 v[152:155], a[40:43], a[12:15], v[152:155]
  ds_read_b128 a[24:27], v17 offset:2048
  v_mfma_f32_16x16x32_bf16 v[132:135], a[44:47], a[0:3], v[132:135]
  ds_read_b128 a[28:31], v17 offset:4096
  v_mfma_f32_16x16x32_bf16 v[140:143], a[44:47], a[4:7], v[140:143]
  ds_read_b128 a[32:35], v17 offset:6144
  v_mfma_f32_16x16x32_bf16 v[148:151], a[44:47], a[8:11], v[148:151]
  ds_read_b64_tr_b16 a[68:69], v21 offset:24576
  v_mfma_f32_16x16x32_bf16 v[156:159], a[44:47], a[12:15], v[156:159]
  ds_read_b64_tr_b16 a[70:71], v21 offset:26624
  v_mfma_f32_16x16x32_bf16 v[160:163], a[48:51], a[0:3], v[160:163]
  ds_read_b64_tr_b16 a[72:73], v20 offset:32768
  v_mfma_f32_16x16x32_bf16 v[168:171], a[48:51], a[4:7], v[168:171]
  ds_read_b64_tr_b16 a[74:75], v20 offset:34816
  v_mfma_f32_16x16x32_bf16 v[176:179], a[48:51], a[8:11], v[176:179]
  ds_read_b64_tr_b16 a[76:77], v21 offset:32768
  v_mfma_f32_16x16x32_bf16 v[184:187], a[48:51], a[12:15], v[184:187]
  ds_read_b64_tr_b16 a[78:79], v21 offset:34816
  v_mfma_f32_16x16x32_bf16 v[164:167], a[52:55], a[0:3], v[164:167]
  ds_read_b64_tr_b16 a[80:81], v20 offset:40960
  v_mfma_f32_16x16x32_bf16 v[172:175], a[52:55], a[4:7], v[172:175]
  ds_read_b64_tr_b16 a[82:83], v20 offset:43008
  v_mfma_f32_16x16x32_bf16 v[180:183], a[52:55], a[8:11], v[180:183]
  ds_read_b128 a[36:39], v19 offset:0
  v_mfma_f32_16x16x32_bf16 v[188:191], a[52:55], a[12:15], v[188:191]
  ds_read_b64_tr_b16 a[84:85], v21 offset:40960
  v_mfma_f32_16x16x32_bf16 v[192:195], a[0:3], a[56:59], v[192:195]
  ds_read_b64_tr_b16 a[86:87], v21 offset:43008
  v_mfma_f32_16x16x32_bf16 v[200:203], a[4:7], a[56:59], v[200:203]
  v_mfma_f32_16x16x32_bf16 v[208:211], a[8:11], a[56:59], v[208:211]
  v_mfma_f32_16x16x32_bf16 v[216:219], a[12:15], a[56:59], v[216:219]
  v_mfma_f32_16x16x32_bf16 v[224:227], a[16:19], a[56:59], v[224:227]
  v_mfma_f32_16x16x32_bf16 v[196:199], a[0:3], a[60:63], v[196:199]
  v_mfma_f32_16x16x32_bf16 v[204:207], a[4:7], a[60:63], v[204:207]
  v_mfma_f32_16x16x32_bf16 v[212:215], a[8:11], a[60:63], v[212:215]
  v_mfma_f32_16x16x32_bf16 v[220:223], a[12:15], a[60:63], v[220:223]
  v_mfma_f32_16x16x32_bf16 v[228:231], a[16:19], a[60:63], v[228:231]
  s_waitcnt lgkmcnt(0)
  v_mfma_f32_16x16x32_bf16 v[128:131], a[64:67], a[20:23], v[128:131]
  v_mfma_f32_16x16x32_bf16 v[136:139], a[64:67], a[24:27], v[136:139]
  v_mfma_f32_16x16x32_bf16 v[144:147], a[64:67], a[28:31], v[144:147]
  v_mfma_f32_16x16x32_bf16 v[152:155], a[64:67], a[32:35], v[152:155]
  v_mfma_f32_16x16x32_bf16 v[132:135], a[68:71], a[20:23], v[132:135]
  v_mfma_f32_16x16x32_bf16 v[140:143], a[68:71], a[24:27], v[140:143]
  v_mfma_f32_16x16x32_bf16 v[148:151], a[68:71], a[28:31], v[148:151]
  v_mfma_f32_16x16x32_bf16 v[156:159], a[68:71], a[32:35], v[156:159]
  v_mfma_f32_16x16x32_bf16 v[160:163], a[72:75], a[20:23], v[160:163]
  v_mfma_f32_16x16x32_bf16 v[168:171], a[72:75], a[24:27], v[168:171]
  v_mfma_f32_16x16x32_bf16 v[176:179], a[72:75], a[28:31], v[176:179]
  v_mfma_f32_16x16x32_bf16 v[184:187], a[72:75], a[32:35], v[184:187]
  v_mfma_f32_16x16x32_bf16 v[164:167], a[76:79], a[20:23], v[164:167]
  v_mfma_f32_16x16x32_bf16 v[172:175], a[76:79], a[24:27], v[172:175]
  v_mfma_f32_16x16x32_bf16 v[180:183], a[76:79], a[28:31], v[180:183]
  v_mfma_f32_16x16x32_bf16 v[188:191], a[76:79], a[32:35], v[188:191]
  v_mfma_f32_16x16x32_bf16 v[192:195], a[20:23], a[80:83], v[192:195]
  v_mfma_f32_16x16x32_bf16 v[200:203], a[24:27], a[80:83], v[200:203]
  v_mfma_f32_16x16x32_bf16 v[208:211], a[28:31], a[80:83], v[208:211]
  v_mfma_f32_16x16x32_bf16 v[216:219], a[32:35], a[80:83], v[216:219]
  v_mfma_f32_16x16x32_bf16 v[224:227], a[36:39], a[80:83], v[224:227]
  v_mfma_f32_16x16x32_bf16 v[196:199], a[20:23], a[84:87], v[196:199]
  v_mfma_f32_16x16x32_bf16 v[204:207], a[24:27], a[84:87], v[204:207]
  v_mfma_f32_16x16x32_bf16 v[212:215], a[28:31], a[84:87], v[212:215]
  v_mfma_f32_16x16x32_bf16 v[220:223], a[32:35], a[84:87], v[220:223]
  v_mfma_f32_16x16x32_bf16 v[228:231], a[36:39], a[84:87], v[228:231]
  s_and_b32 s4, s3, 1
  s_mul_i32 s4, s4, 3072
  s_add_u32 s4, s4, 135168
  v_add_u32 v116, s4, v2
  v_cvt_pk_bf16_f32 v120, v224, v225
  v_cvt_pk_bf16_f32 v121, v226, v227
  s_nop 1
  v_cvt_pk_bf16_f32 v122, v228, v229
  v_cvt_pk_bf16_f32 v123, v230, v231
  ds_write_b128 v116, v[120:123] offset:2048
  v_and_b32 v117, 15, v1
  v_lshrrev_b32 v118, 4, v1
  v_lshlrev_b32 v118, 2, v118
  v_sub_u32 v117, v117, v118
  v_mov_b32 v118, 0xf149f2ca
  v_subrev_u32 v119, 0, v117
  v_and_b32 v104, 0x80000001, v119
  v_cmp_ne_u32 vcc, 0, v104
  s_nop 1
  v_cndmask_b32 v104, 0, v118, vcc
  v_add_u32 v119, 1, v119
  v_and_b32 v108, 0x80000001, v119
  v_cmp_ne_u32 vcc, 0x80000001, v108
  s_nop 1
  v_cndmask_b32 v108, 0, v118, vcc
  v_subrev_u32 v119, 1, v117
  v_and_b32 v105, 0x80000001, v119
  v_cmp_ne_u32 vcc, 0, v105
  s_nop 1
  v_cndmask_b32 v105, 0, v118, vcc
  v_add_u32 v119, 1, v119
  v_and_b32 v109, 0x80000001, v119
  v_cmp_ne_u32 vcc, 0x80000001, v109
  s_nop 1
  v_cndmask_b32 v109, 0, v118, vcc
  v_subrev_u32 v119, 2, v117
  v_and_b32 v106, 0x80000001, v119
  v_cmp_ne_u32 vcc, 0, v106
  s_nop 1
  v_cndmask_b32 v106, 0, v118, vcc
  v_add_u32 v119, 1, v119
  v_and_b32 v110, 0x80000001, v119
  v_cmp_ne_u32 vcc, 0x80000001, v110
  s_nop 1
  v_cndmask_b32 v110, 0, v118, vcc
  v_subrev_u32 v119, 3, v117
  v_and_b32 v107, 0x80000001, v119
  v_cmp_ne_u32 vcc, 0, v107
  s_nop 1
  v_cndmask_b32 v107, 0, v118, vcc
  v_add_u32 v119, 1, v119
  v_and_b32 v111, 0x80000001, v119
  v_cmp_ne_u32 vcc, 0x80000001, v111
  s_nop 1
  v_cndmask_b32 v111, 0, v118, vcc
  s_mov_b32 s6, 0x3e8293ee
  s_mov_b32 s7, s6
  v_pk_mul_f32 v[128:129], v[128:129], s[6:7]
  v_pk_mul_f32 v[130:131], v[130:131], s[6:7]
  v_pk_mul_f32 v[132:133], v[132:133], s[6:7]
  v_pk_mul_f32 v[134:135], v[134:135], s[6:7]
  v_cvt_pk_bf16_f32 v48, v128, v129
  v_cvt_pk_bf16_f32 v49, v130, v131
  v_cvt_pk_bf16_f32 v50, v132, v133
  v_cvt_pk_bf16_f32 v51, v134, v135
  v_pk_mul_f32 v[136:137], v[136:137], s[6:7]
  v_pk_mul_f32 v[138:139], v[138:139], s[6:7]
  v_pk_mul_f32 v[140:141], v[140:141], s[6:7]
  v_pk_mul_f32 v[142:143], v[142:143], s[6:7]
  v_cvt_pk_bf16_f32 v52, v136, v137
  v_cvt_pk_bf16_f32 v53, v138, v139
  v_cvt_pk_bf16_f32 v54, v140, v141
  v_cvt_pk_bf16_f32 v55, v142, v143
  v_pk_mul_f32 v[144:145], v[144:145], s[6:7]
  v_pk_mul_f32 v[146:147], v[146:147], s[6:7]
  v_pk_mul_f32 v[148:149], v[148:149], s[6:7]
  v_pk_mul_f32 v[150:151], v[150:151], s[6:7]
  v_cvt_pk_bf16_f32 v56, v144, v145
  v_cvt_pk_bf16_f32 v57, v146, v147
  v_cvt_pk_bf16_f32 v58, v148, v149
  v_cvt_pk_bf16_f32 v59, v150, v151
  v_pk_mul_f32 v[152:153], v[152:153], s[6:7]
  v_pk_mul_f32 v[154:155], v[154:155], s[6:7]
  v_pk_mul_f32 v[156:157], v[156:157], s[6:7]
  v_pk_mul_f32 v[158:159], v[158:159], s[6:7]
  v_cvt_pk_bf16_f32 v60, v152, v153
  v_cvt_pk_bf16_f32 v61, v154, v155
  v_cvt_pk_bf16_f32 v62, v156, v157
  v_cvt_pk_bf16_f32 v63, v158, v159
  v_cvt_pk_bf16_f32 v68, v160, v161
  v_cvt_pk_bf16_f32 v69, v162, v163
  v_cvt_pk_bf16_f32 v86, v192, v193
  v_cvt_pk_bf16_f32 v87, v194, v195
  v_cvt_pk_bf16_f32 v70, v164, v165
  v_cvt_pk_bf16_f32 v71, v166, v167
  v_cvt_pk_bf16_f32 v96, v196, v197
  v_cvt_pk_bf16_f32 v97, v198, v199
  v_cvt_pk_bf16_f32 v72, v168, v169
  v_cvt_pk_bf16_f32 v73, v170, v171
  v_cvt_pk_bf16_f32 v88, v200, v201
  v_cvt_pk_bf16_f32 v89, v202, v203
  v_cvt_pk_bf16_f32 v74, v172, v173
  v_cvt_pk_bf16_f32 v75, v174, v175
  v_cvt_pk_bf16_f32 v98, v204, v205
  v_cvt_pk_bf16_f32 v99, v206, v207
  v_cvt_pk_bf16_f32 v76, v176, v177
  v_cvt_pk_bf16_f32 v77, v178, v179
  v_cvt_pk_bf16_f32 v90, v208, v209
  v_cvt_pk_bf16_f32 v91, v210, v211
  v_cvt_pk_bf16_f32 v78, v180, v181
  v_cvt_pk_bf16_f32 v79, v182, v183
  v_cvt_pk_bf16_f32 v100, v212, v213
  v_cvt_pk_bf16_f32 v101, v214, v215
  v_cvt_pk_bf16_f32 v80, v184, v185
  v_cvt_pk_bf16_f32 v81, v186, v187
  v_cvt_pk_bf16_f32 v92, v216, v217
  v_cvt_pk_bf16_f32 v93, v218, v219
  v_cvt_pk_bf16_f32 v82, v188, v189
  v_cvt_pk_bf16_f32 v83, v190, v191
  v_cvt_pk_bf16_f32 v102, v220, v221
  v_cvt_pk_bf16_f32 v103, v222, v223
  v_mov_b32 v120, 0x3f803f80
  v_mov_b32 v121, v120
  v_mov_b32 v122, v120
  v_mov_b32 v123, v120
  s_waitcnt lgkmcnt(0)
  s_barrier
  ds_read_b128 v[64:67], v116
  ds_read_b64 v[84:85], v116 offset:1024
  ds_read_b64 v[94:95], v116 offset:1032
  v_mfma_f32_16x16x32_bf16 v[40:43], v[76:79], v[60:63], v[108:111]
  v_mfma_f32_16x16x32_bf16 v[44:47], v[80:83], v[60:63], v[104:107]
  v_mfma_f32_16x16x32_bf16 v[32:35], v[72:75], v[56:59], v[108:111]
  v_mfma_f32_16x16x32_bf16 v[36:39], v[76:79], v[56:59], v[104:107]
  v_mfma_f32_16x16x32_bf16 v[24:27], v[68:71], v[52:55], v[108:111]
  v_mfma_f32_16x16x32_bf16 v[28:31], v[72:75], v[52:55], v[104:107]
  s_waitcnt lgkmcnt(0)
  v_mfma_f32_16x16x32_bf16 v[16:19], v[64:67], v[48:51], v[108:111]
  v_mfma_f32_16x16x32_bf16 v[20:23], v[68:71], v[48:51], v[104:107]
  v_max3_f32 v134, v40, v41, v42
  v_max3_f32 v135, v43, v44, v45
  v_max3_f32 v134, v134, v46, v47
  v_max_f32 v134, v134, v135
  v_max3_f32 v132, v32, v33, v34
  v_max3_f32 v133, v35, v36, v37
  v_max3_f32 v132, v132, v38, v39
  v_max_f32 v132, v132, v133
  v_max3_f32 v130, v24, v25, v26
  v_max3_f32 v131, v27, v28, v29
  v_max3_f32 v130, v130, v30, v31
  v_max_f32 v130, v130, v131
  v_max3_f32 v128, v16, v17, v18
  v_max3_f32 v129, v19, v20, v21
  v_max3_f32 v128, v128, v22, v23
  v_max_f32 v128, v128, v129
  v_mov_b32 v135, v134
  v_mov_b32 v133, v132
  v_mov_b32 v131, v130
  v_mov_b32 v129, v128
  v_permlane32_swap_b32 v134, v135
  v_permlane32_swap_b32 v132, v133
  v_permlane32_swap_b32 v130, v131
  v_permlane32_swap_b32 v128, v129
  v_max_f32 v134, v134, v135
  v_max_f32 v132, v132, v133
  v_max_f32 v130, v130, v131
  v_max_f32 v128, v128, v129
  v_mov_b32 v135, v134
  v_mov_b32 v133, v132
  v_mov_b32 v131, v130
  v_mov_b32 v129, v128
  v_permlane16_swap_b32 v134, v135
  v_permlane16_swap_b32 v132, v133
  v_permlane16_swap_b32 v130, v131
  v_permlane16_swap_b32 v128, v129
  v_max_f32 v134, v134, v135
  v_max_f32 v132, v132, v133
  v_max_f32 v130, v130, v131
  v_max_f32 v128, v128, v129
  v_sub_f32 v40, v40, v134
  v_sub_f32 v41, v41, v134
  v_sub_f32 v42, v42, v134
  v_sub_f32 v43, v43, v134
  v_sub_f32 v44, v44, v134
  v_sub_f32 v45, v45, v134
  v_sub_f32 v46, v46, v134
  v_sub_f32 v47, v47, v134
  v_exp_f32 v40, v40
  v_exp_f32 v41, v41
  v_exp_f32 v42, v42
  v_exp_f32 v43, v43
  v_exp_f32 v44, v44
  v_exp_f32 v45, v45
  v_exp_f32 v46, v46
  v_exp_f32 v47, v47
  v_sub_f32 v32, v32, v132
  v_sub_f32 v33, v33, v132
  v_sub_f32 v34, v34, v132
  v_sub_f32 v35, v35, v132
  v_sub_f32 v36, v36, v132
  v_sub_f32 v37, v37, v132
  v_sub_f32 v38, v38, v132
  v_sub_f32 v39, v39, v132
  v_exp_f32 v32, v32
  v_exp_f32 v33, v33
  v_exp_f32 v34, v34
  v_exp_f32 v35, v35
  v_exp_f32 v36, v36
  v_exp_f32 v37, v37
  v_exp_f32 v38, v38
  v_exp_f32 v39, v39
  v_sub_f32 v24, v24, v130
  v_sub_f32 v25, v25, v130
  v_sub_f32 v26, v26, v130
  v_sub_f32 v27, v27, v130
  v_sub_f32 v28, v28, v130
  v_sub_f32 v29, v29, v130
  v_sub_f32 v30, v30, v130
  v_sub_f32 v31, v31, v130
  v_exp_f32 v24, v24
  v_exp_f32 v25, v25
  v_exp_f32 v26, v26
  v_exp_f32 v27, v27
  v_exp_f32 v28, v28
  v_exp_f32 v29, v29
  v_exp_f32 v30, v30
  v_exp_f32 v31, v31
  v_sub_f32 v16, v16, v128
  v_sub_f32 v17, v17, v128
  v_sub_f32 v18, v18, v128
  v_sub_f32 v19, v19, v128
  v_sub_f32 v20, v20, v128
  v_sub_f32 v21, v21, v128
  v_sub_f32 v22, v22, v128
  v_sub_f32 v23, v23, v128
  v_exp_f32 v16, v16
  v_exp_f32 v17, v17
  v_exp_f32 v18, v18
  v_exp_f32 v19, v19
  v_exp_f32 v20, v20
  v_exp_f32 v21, v21
  v_exp_f32 v22, v22
  v_exp_f32 v23, v23
  v_cvt_pk_bf16_f32 v148, v40, v41
  v_cvt_pk_bf16_f32 v149, v42, v43
  v_cvt_pk_bf16_f32 v150, v44, v45
  v_cvt_pk_bf16_f32 v151, v46, v47
  v_cvt_pk_bf16_f32 v144, v32, v33
  v_cvt_pk_bf16_f32 v145, v34, v35
  v_cvt_pk_bf16_f32 v146, v36, v37
  v_cvt_pk_bf16_f32 v147, v38, v39
  v_cvt_pk_bf16_f32 v140, v24, v25
  v_cvt_pk_bf16_f32 v141, v26, v27
  v_cvt_pk_bf16_f32 v142, v28, v29
  v_cvt_pk_bf16_f32 v143, v30, v31
  v_cvt_pk_bf16_f32 v136, v16, v17
  v_cvt_pk_bf16_f32 v137, v18, v19
  v_cvt_pk_bf16_f32 v138, v20, v21
  v_cvt_pk_bf16_f32 v139, v22, v23
  v_mfma_f32_16x16x32_bf16 v[164:167], v[120:123], v[148:151], 0
  v_mfma_f32_16x16x32_bf16 v[192:195], v[90:93], v[148:151], 0
  v_mfma_f32_16x16x32_bf16 v[196:199], v[100:103], v[148:151], 0
  v_mfma_f32_16x16x32_bf16 v[160:163], v[120:123], v[144:147], 0
  v_mfma_f32_16x16x32_bf16 v[184:187], v[88:91], v[144:147], 0
  v_mfma_f32_16x16x32_bf16 v[188:191], v[98:101], v[144:147], 0
  v_mfma_f32_16x16x32_bf16 v[156:159], v[120:123], v[140:143], 0
  v_mfma_f32_16x16x32_bf16 v[176:179], v[86:89], v[140:143], 0
  v_mfma_f32_16x16x32_bf16 v[180:183], v[96:99], v[140:143], 0
  v_mfma_f32_16x16x32_bf16 v[152:155], v[120:123], v[136:139], 0
  v_mfma_f32_16x16x32_bf16 v[168:171], v[84:87], v[136:139], 0
  v_mfma_f32_16x16x32_bf16 v[172:175], v[94:97], v[136:139], 0
  s_add_u32 s16, s86, 83886080
  s_addc_u32 s17, s87, 0
  s_mov_b32 s18, 4194304
  s_mov_b32 s19, 0x00020000
  s_lshl_b32 s4, s54, 18
  s_lshl_b32 s5, s55, 14
  s_add_u32 s4, s4, s5
  s_and_b32 s5, s3, 1
  s_lshl_b32 s5, s5, 13
  s_add_u32 s4, s4, s5
  s_add_u32 s4, s4, 4096
  v_rcp_f32 v164, v164
  v_rcp_f32 v160, v160
  v_rcp_f32 v156, v156
  v_rcp_f32 v152, v152
  v_mov_b32 v165, v164
  v_mov_b32 v161, v160
  v_mov_b32 v157, v156
  v_mov_b32 v153, v152
  v_pk_mul_f32 v[192:193], v[192:193], v[164:165]
  v_pk_mul_f32 v[194:195], v[194:195], v[164:165]
  v_pk_mul_f32 v[196:197], v[196:197], v[164:165]
  v_pk_mul_f32 v[198:199], v[198:199], v[164:165]
  v_cvt_pk_bf16_f32 v192, v192, v193
  v_cvt_pk_bf16_f32 v193, v194, v195
  v_cvt_pk_bf16_f32 v194, v196, v197
  v_cvt_pk_bf16_f32 v195, v198, v199
  buffer_store_dwordx4 v[192:195], v2, s[16:19], s4 offen offset:3072
  v_pk_mul_f32 v[184:185], v[184:185], v[160:161]
  v_pk_mul_f32 v[186:187], v[186:187], v[160:161]
  v_pk_mul_f32 v[188:189], v[188:189], v[160:161]
  v_pk_mul_f32 v[190:191], v[190:191], v[160:161]
  v_cvt_pk_bf16_f32 v184, v184, v185
  v_cvt_pk_bf16_f32 v185, v186, v187
  v_cvt_pk_bf16_f32 v186, v188, v189
  v_cvt_pk_bf16_f32 v187, v190, v191
  buffer_store_dwordx4 v[184:187], v2, s[16:19], s4 offen offset:2048
  v_pk_mul_f32 v[176:177], v[176:177], v[156:157]
  v_pk_mul_f32 v[178:179], v[178:179], v[156:157]
  v_pk_mul_f32 v[180:181], v[180:181], v[156:157]
  v_pk_mul_f32 v[182:183], v[182:183], v[156:157]
  v_cvt_pk_bf16_f32 v176, v176, v177
  v_cvt_pk_bf16_f32 v177, v178, v179
  v_cvt_pk_bf16_f32 v178, v180, v181
  v_cvt_pk_bf16_f32 v179, v182, v183
  buffer_store_dwordx4 v[176:179], v2, s[16:19], s4 offen offset:1024
  v_pk_mul_f32 v[168:169], v[168:169], v[152:153]
  v_pk_mul_f32 v[170:171], v[170:171], v[152:153]
  v_pk_mul_f32 v[172:173], v[172:173], v[152:153]
  v_pk_mul_f32 v[174:175], v[174:175], v[152:153]
  v_cvt_pk_bf16_f32 v168, v168, v169
  v_cvt_pk_bf16_f32 v169, v170, v171
  v_cvt_pk_bf16_f32 v170, v172, v173
  v_cvt_pk_bf16_f32 v171, v174, v175
  buffer_store_dwordx4 v[168:171], v2, s[16:19], s4 offen offset:0
Lp2_done:
  s_waitcnt vmcnt(0)
Lk1_end:
  s_endpgm
.globl k2_attn_kernel
.p2align 8
.type k2_attn_kernel,@function
k2_attn_kernel:
  s_cmp_ge_u32 s2, 256
  s_cbranch_scc1 Lk2_end
  s_load_dwordx16 s[64:79], s[0:1], 0
  s_load_dwordx8 s[80:87], s[0:1], 64
  v_lshrrev_b32 v2, 6, v0
  v_and_b32 v1, 63, v0
  v_readfirstlane_b32 s3, v2
  v_lshlrev_b32 v2, 4, v1
  s_and_b32 s24, s2, 7
  s_lshr_b32 s4, s2, 6
  s_lshl_b32 s4, s4, 3
  s_add_u32 s24, s24, s4
  s_lshr_b32 s25, s2, 3
  s_and_b32 s25, s25, 7
  s_waitcnt lgkmcnt(0)
  s_lshl_b32 s4, s24, 20
  s_lshl_b32 s5, s25, 16
  s_sub_u32 s5, 1048576, s5
  s_add_u32 s20, s86, 16777216
  s_addc_u32 s21, s87, 0
  s_add_u32 s20, s20, s4
  s_addc_u32 s21, s21, 0
  s_mov_b32 s22, s5
  s_mov_b32 s23, 0x00020000
  s_lshl_b32 s26, s3, 12
  s_add_u32 s27, s26, 0x10000
  s_mov_b32 s28, s26
  s_add_u32 s29, s26, 0x4000
  s_mov_b32 s8, s86
  s_mov_b32 s9, s87
  s_mov_b32 s10, 16777216
  s_mov_b32 s11, 0x00020000
  s_lshl_b32 s4, s24, 15
  s_lshl_b32 s5, s3, 13
  s_add_u32 s4, s4, s5
  s_lshl_b32 s5, s25, 20
  s_add_u32 s6, s4, s5
  s_sub_u32 s7, s4, s5
  s_add_u32 s7, s7, 15728640
  s_mov_b32 m0, s26
  s_nop 0
  buffer_load_dwordx4 v2, s[20:23], s28 offen offset:0 lds
  buffer_load_dwordx4 v2, s[20:23], s28 offen offset:1024 lds
  buffer_load_dwordx4 v2, s[20:23], s28 offen offset:2048 lds
  buffer_load_dwordx4 v2, s[20:23], s28 offen offset:3072 lds
  s_xor_b32 s26, s26, 0x4000
  s_add_u32 s28, s28, 0x8000
  s_add_u32 s5, s6, 0
  buffer_load_dwordx4 a[128:131], v2, s[8:11], s5 offen offset:0
  buffer_load_dwordx4 a[132:135], v2, s[8:11], s5 offen offset:1024
  buffer_load_dwordx4 a[136:139], v2, s[8:11], s5 offen offset:2048
  buffer_load_dwordx4 a[140:143], v2, s[8:11], s5 offen offset:3072
  s_add_u32 s5, s6, 4096
  buffer_load_dwordx4 a[144:147], v2, s[8:11], s5 offen offset:0
  buffer_load_dwordx4 a[148:151], v2, s[8:11], s5 offen offset:1024
  buffer_load_dwordx4 a[152:155], v2, s[8:11], s5 offen offset:2048
  buffer_load_dwordx4 a[156:159], v2, s[8:11], s5 offen offset:3072
  s_add_u32 s5, s7, 0
  buffer_load_dwordx4 a[160:163], v2, s[8:11], s5 offen offset:0
  buffer_load_dwordx4 a[164:167], v2, s[8:11], s5 offen offset:1024
  buffer_load_dwordx4 a[168:171], v2, s[8:11], s5 offen offset:2048
  buffer_load_dwordx4 a[172:175], v2, s[8:11], s5 offen offset:3072
  s_add_u32 s5, s7, 4096
  buffer_load_dwordx4 a[176:179], v2, s[8:11], s5 offen offset:0
  buffer_load_dwordx4 a[180:183], v2, s[8:11], s5 offen offset:1024
  buffer_load_dwordx4 a[184:187], v2, s[8:11], s5 offen offset:2048
  buffer_load_dwordx4 a[188:191], v2, s[8:11], s5 offen offset:3072
  s_mov_b32 m0, s26
  s_nop 0
  buffer_load_dwordx4 v2, s[20:23], s28 offen offset:0 lds
  buffer_load_dwordx4 v2, s[20:23], s28 offen offset:1024 lds
  buffer_load_dwordx4 v2, s[20:23], s28 offen offset:2048 lds
  buffer_load_dwordx4 v2, s[20:23], s28 offen offset:3072 lds
  s_xor_b32 s26, s26, 0x8000
  s_add_u32 s28, s28, 0x8000
  s_mov_b32 m0, s27
  s_nop 0
  buffer_load_dwordx4 v2, s[20:23], s29 offen offset:0 lds
  buffer_load_dwordx4 v2, s[20:23], s29 offen offset:1024 lds
  buffer_load_dwordx4 v2, s[20:23], s29 offen offset:2048 lds
  buffer_load_dwordx4 v2, s[20:23], s29 offen offset:3072 lds
  s_xor_b32 s27, s27, 0x4000
  s_add_u32 s29, s29, 0x8000
  s_lshl_b32 s4, s2, 2
  s_add_u32 s4, s4, s3
  s_lshl_b32 s6, s4, 13
  s_lshl_b32 s7, s4, 11
  s_mov_b32 s8, s74
  s_mov_b32 s9, s75
  s_mov_b32 s10, 8388608
  s_mov_b32 s11, 0x00020000
  s_mov_b32 s12, s80
  s_mov_b32 s13, s81
  s_mov_b32 s14, 2097152
  s_mov_b32 s15, 0x00020000
  s_add_u32 s16, s86, 67108864
  s_addc_u32 s17, s87, 0
  s_mov_b32 s18, 16777216
  s_mov_b32 s19, 0x00020000
  v_mov_b32 v3, v2
  v_add_u32 v4, 0x10000, v2
  v_mov_b32 v5, 0xf149f2ca
  s_mov_b32 s89, 0
  v_mov_b32 v6, 0x3f803f80
  v_accvgpr_write_b32 a208, v6
  v_accvgpr_write_b32 a209, v6
  v_accvgpr_write_b32 a210, v6
  v_accvgpr_write_b32 a211, v6
  v_accvgpr_write_b32 a192, 0
  v_accvgpr_write_b32 a193, 0
  v_accvgpr_write_b32 a194, 0
  v_accvgpr_write_b32 a195, 0
  v_accvgpr_write_b32 a196, 0
  v_accvgpr_write_b32 a197, 0
  v_accvgpr_write_b32 a198, 0
  v_accvgpr_write_b32 a199, 0
  v_accvgpr_write_b32 a200, 0
  v_accvgpr_write_b32 a201, 0
  v_accvgpr_write_b32 a202, 0
  v_accvgpr_write_b32 a203, 0
  v_accvgpr_write_b32 a204, 0
  v_accvgpr_write_b32 a205, 0
  v_accvgpr_write_b32 a206, 0
  v_accvgpr_write_b32 a207, 0
  v_mov_b32 v128, 0
  v_mov_b32 v129, 0
  v_mov_b32 v130, 0
  v_mov_b32 v131, 0
  v_mov_b32 v132, 0
  v_mov_b32 v133, 0
  v_mov_b32 v134, 0
  v_mov_b32 v135, 0
  v_mov_b32 v136, 0
  v_mov_b32 v137, 0
  v_mov_b32 v138, 0
  v_mov_b32 v139, 0
  v_mov_b32 v140, 0
  v_mov_b32 v141, 0
  v_mov_b32 v142, 0
  v_mov_b32 v143, 0
  v_mov_b32 v144, 0
  v_mov_b32 v145, 0
  v_mov_b32 v146, 0
  v_mov_b32 v147, 0
  v_mov_b32 v148, 0
  v_mov_b32 v149, 0
  v_mov_b32 v150, 0
  v_mov_b32 v151, 0
  v_mov_b32 v152, 0
  v_mov_b32 v153, 0
  v_mov_b32 v154, 0
  v_mov_b32 v155, 0
  v_mov_b32 v156, 0
  v_mov_b32 v157, 0
  v_mov_b32 v158, 0
  v_mov_b32 v159, 0
  v_mov_b32 v160, 0
  v_mov_b32 v161, 0
  v_mov_b32 v162, 0
  v_mov_b32 v163, 0
  v_mov_b32 v164, 0
  v_mov_b32 v165, 0
  v_mov_b32 v166, 0
  v_mov_b32 v167, 0
  v_mov_b32 v168, 0
  v_mov_b32 v169, 0
  v_mov_b32 v170, 0
  v_mov_b32 v171, 0
  v_mov_b32 v172, 0
  v_mov_b32 v173, 0
  v_mov_b32 v174, 0
  v_mov_b32 v175, 0
  v_mov_b32 v176, 0
  v_mov_b32 v177, 0
  v_mov_b32 v178, 0
  v_mov_b32 v179, 0
  v_mov_b32 v180, 0
  v_mov_b32 v181, 0
  v_mov_b32 v182, 0
  v_mov_b32 v183, 0
  v_mov_b32 v184, 0
  v_mov_b32 v185, 0
  v_mov_b32 v186, 0
  v_mov_b32 v187, 0
  v_mov_b32 v188, 0
  v_mov_b32 v189, 0
  v_mov_b32 v190, 0
  v_mov_b32 v191, 0
  v_mov_b32 v192, 0
  v_mov_b32 v193, 0
  v_mov_b32 v194, 0
  v_mov_b32 v195, 0
  v_mov_b32 v196, 0
  v_mov_b32 v197, 0
  v_mov_b32 v198, 0
  v_mov_b32 v199, 0
  v_mov_b32 v200, 0
  v_mov_b32 v201, 0
  v_mov_b32 v202, 0
  v_mov_b32 v203, 0
  v_mov_b32 v204, 0
  v_mov_b32 v205, 0
  v_mov_b32 v206, 0
  v_mov_b32 v207, 0
  v_mov_b32 v208, 0
  v_mov_b32 v209, 0
  v_mov_b32 v210, 0
  v_mov_b32 v211, 0
  v_mov_b32 v212, 0
  v_mov_b32 v213, 0
  v_mov_b32 v214, 0
  v_mov_b32 v215, 0
  v_mov_b32 v216, 0
  v_mov_b32 v217, 0
  v_mov_b32 v218, 0
  v_mov_b32 v219, 0
  v_mov_b32 v220, 0
  v_mov_b32 v221, 0
  v_mov_b32 v222, 0
  v_mov_b32 v223, 0
  v_mov_b32 v224, 0
  v_mov_b32 v225, 0
  v_mov_b32 v226, 0
  v_mov_b32 v227, 0
  v_mov_b32 v228, 0
  v_mov_b32 v229, 0
  v_mov_b32 v230, 0
  v_mov_b32 v231, 0
  v_mov_b32 v232, 0
  v_mov_b32 v233, 0
  v_mov_b32 v234, 0
  v_mov_b32 v235, 0
  v_mov_b32 v236, 0
  v_mov_b32 v237, 0
  v_mov_b32 v238, 0
  v_mov_b32 v239, 0
  v_mov_b32 v240, 0
  v_mov_b32 v241, 0
  v_mov_b32 v242, 0
  v_mov_b32 v243, 0
  v_mov_b32 v244, 0
  v_mov_b32 v245, 0
  v_mov_b32 v246, 0
  v_mov_b32 v247, 0
  v_mov_b32 v248, 0
  v_mov_b32 v249, 0
  v_mov_b32 v250, 0
  v_mov_b32 v251, 0
  v_mov_b32 v252, 0
  v_mov_b32 v253, 0
  v_mov_b32 v254, 0
  v_mov_b32 v255, 0
  v_and_b32 v6, 15, v1
  v_lshrrev_b32 v7, 4, v1
  v_sub_u32 v6, v6, v7
  v_lshlrev_b32 v6, 2, v6
  v_add_u32 v6, s3, v6
  v_cmp_gt_i32 s[32:33], 0, v6
  v_cmp_gt_i32 s[34:35], 1, v6
  v_cmp_gt_i32 s[36:37], 2, v6
  v_cmp_gt_i32 s[38:39], 3, v6
  v_cmp_gt_i32 s[40:41], 16, v6
  v_cmp_gt_i32 s[42:43], 17, v6
  v_cmp_gt_i32 s[44:45], 18, v6
  v_cmp_gt_i32 s[46:47], 19, v6
  v_cmp_gt_i32 s[48:49], 32, v6
  v_cmp_gt_i32 s[50:51], 33, v6
  v_cmp_gt_i32 s[52:53], 34, v6
  v_cmp_gt_i32 s[54:55], 35, v6
  v_cmp_gt_i32 s[56:57], 48, v6
  v_cmp_gt_i32 s[58:59], 49, v6
  v_cmp_gt_i32 s[60:61], 50, v6
  v_cmp_gt_i32 s[62:63], 51, v6
  s_mov_b32 s30, 0x8000
  s_mov_b32 s31, 0x4000
  s_waitcnt vmcnt(8)
  s_barrier
  ds_read_b128 a[32:35], v3 offset:0
  ds_read_b128 a[36:39], v3 offset:1024
  ds_read_b128 a[40:43], v3 offset:2048
  ds_read_b128 a[44:47], v3 offset:3072
  ds_read_b128 a[48:51], v3 offset:4096
  ds_read_b128 a[52:55], v3 offset:5120
  ds_read_b128 a[56:59], v3 offset:6144
  ds_read_b128 a[60:63], v3 offset:7168
  s_waitcnt lgkmcnt(6)
  v_mfma_f32_16x16x32_bf16 v[64:67], a[32:35], a[128:131], 0
  v_mfma_f32_16x16x32_bf16 v[72:75], a[32:35], a[144:147], 0
  v_mfma_f32_16x16x32_bf16 v[80:83], a[32:35], a[160:163], 0
  v_mfma_f32_16x16x32_bf16 v[88:91], a[32:35], a[176:179], 0
  ds_read_b128 a[0:3], v3 offset:8192
  v_mfma_f32_16x16x32_bf16 v[64:67], a[36:39], a[132:135], v[64:67]
  v_mfma_f32_16x16x32_bf16 v[72:75], a[36:39], a[148:151], v[72:75]
  v_mfma_f32_16x16x32_bf16 v[80:83], a[36:39], a[164:167], v[80:83]
  v_mfma_f32_16x16x32_bf16 v[88:91], a[36:39], a[180:183], v[88:91]
  ds_read_b128 a[4:7], v3 offset:9216
  s_waitcnt lgkmcnt(6)
  v_mfma_f32_16x16x32_bf16 v[64:67], a[40:43], a[136:139], v[64:67]
  v_mfma_f32_16x16x32_bf16 v[72:75], a[40:43], a[152:155], v[72:75]
  v_mfma_f32_16x16x32_bf16 v[80:83], a[40:43], a[168:171], v[80:83]
  v_mfma_f32_16x16x32_bf16 v[88:91], a[40:43], a[184:187], v[88:91]
  ds_read_b128 a[8:11], v3 offset:10240
  v_mfma_f32_16x16x32_bf16 v[64:67], a[44:47], a[140:143], v[64:67]
  v_mfma_f32_16x16x32_bf16 v[72:75], a[44:47], a[156:159], v[72:75]
  v_mfma_f32_16x16x32_bf16 v[80:83], a[44:47], a[172:175], v[80:83]
  v_mfma_f32_16x16x32_bf16 v[88:91], a[44:47], a[188:191], v[88:91]
  ds_read_b128 a[12:15], v3 offset:11264
  s_waitcnt lgkmcnt(6)
  v_mfma_f32_16x16x32_bf16 v[68:71], a[48:51], a[128:131], 0
  v_mfma_f32_16x16x32_bf16 v[76:79], a[48:51], a[144:147], 0
  v_mfma_f32_16x16x32_bf16 v[84:87], a[48:51], a[160:163], 0
  v_mfma_f32_16x16x32_bf16 v[92:95], a[48:51], a[176:179], 0
  ds_read_b128 a[16:19], v3 offset:12288
  v_mfma_f32_16x16x32_bf16 v[68:71], a[52:55], a[132:135], v[68:71]
  v_mfma_f32_16x16x32_bf16 v[76:79], a[52:55], a[148:151], v[76:79]
  v_mfma_f32_16x16x32_bf16 v[84:87], a[52:55], a[164:167], v[84:87]
  v_mfma_f32_16x16x32_bf16 v[92:95], a[52:55], a[180:183], v[92:95]
  ds_read_b128 a[20:23], v3 offset:13312
  s_waitcnt lgkmcnt(6)
  v_mfma_f32_16x16x32_bf16 v[68:71], a[56:59], a[136:139], v[68:71]
  v_mfma_f32_16x16x32_bf16 v[76:79], a[56:59], a[152:155], v[76:79]
  v_mfma_f32_16x16x32_bf16 v[84:87], a[56:59], a[168:171], v[84:87]
  v_mfma_f32_16x16x32_bf16 v[92:95], a[56:59], a[184:187], v[92:95]
  ds_read_b128 a[24:27], v3 offset:14336
  v_mfma_f32_16x16x32_bf16 v[68:71], a[60:63], a[140:143], v[68:71]
  v_mfma_f32_16x16x32_bf16 v[76:79], a[60:63], a[156:159], v[76:79]
  v_mfma_f32_16x16x32_bf16 v[84:87], a[60:63], a[172:175], v[84:87]
  v_mfma_f32_16x16x32_bf16 v[92:95], a[60:63], a[188:191], v[92:95]
  ds_read_b128 a[28:31], v3 offset:15360
  s_cmp_lg_u32 s25, 0
  s_nop 0
  s_cbranch_scc1 La_nomask0
  v_cndmask_b32 v64, v64, v5, s[32:33]
  v_cndmask_b32 v65, v65, v5, s[34:35]
  v_cndmask_b32 v66, v66, v5, s[36:37]
  v_cndmask_b32 v67, v67, v5, s[38:39]
  v_cndmask_b32 v68, v68, v5, s[40:41]
  v_cndmask_b32 v69, v69, v5, s[42:43]
  v_cndmask_b32 v70, v70, v5, s[44:45]
  v_cndmask_b32 v71, v71, v5, s[46:47]
La_nomask0:
  v_max3_f32 v6, v64, v65, v66
  v_max3_f32 v7, v67, v68, v69
  v_max3_f32 v6, v6, v70, v71
  v_max_f32 v6, v6, v7
  v_max3_f32 v8, v72, v73, v74
  v_max3_f32 v9, v75, v76, v77
  v_max3_f32 v8, v8, v78, v79
  v_max_f32 v8, v8, v9
  v_max3_f32 v10, v80, v81, v82
  v_max3_f32 v11, v83, v84, v85
  v_max3_f32 v10, v10, v86, v87
  v_max_f32 v10, v10, v11
  v_max3_f32 v12, v88, v89, v90
  v_max3_f32 v13, v91, v92, v93
  v_max3_f32 v12, v12, v94, v95
  v_max_f32 v12, v12, v13
  v_mov_b32 v7, v6
  v_mov_b32 v9, v8
  v_mov_b32 v11, v10
  v_mov_b32 v13, v12
  v_permlane32_swap_b32 v6, v7
  v_permlane32_swap_b32 v8, v9
  v_permlane32_swap_b32 v10, v11
  v_permlane32_swap_b32 v12, v13
  v_max_f32 v6, v6, v7
  v_max_f32 v8, v8, v9
  v_max_f32 v10, v10, v11
  v_max_f32 v12, v12, v13
  v_mov_b32 v7, v6
  v_mov_b32 v9, v8
  v_mov_b32 v11, v10
  v_mov_b32 v13, v12
  v_permlane16_swap_b32 v6, v7
  v_permlane16_swap_b32 v8, v9
  v_permlane16_swap_b32 v10, v11
  v_permlane16_swap_b32 v12, v13
  v_max_f32 v6, v6, v7
  v_max_f32 v8, v8, v9
  v_max_f32 v10, v10, v11
  v_max_f32 v12, v12, v13
  v_sub_f32 v16, 0, v6
  v_sub_f32 v17, 0, v6
  v_sub_f32 v18, 0, v6
  v_sub_f32 v19, 0, v6
  v_sub_f32 v20, 0, v8
  v_sub_f32 v21, 0, v8
  v_sub_f32 v22, 0, v8
  v_sub_f32 v23, 0, v8
  v_sub_f32 v24, 0, v10
  v_sub_f32 v25, 0, v10
  v_sub_f32 v26, 0, v10
  v_sub_f32 v27, 0, v10
  v_sub_f32 v28, 0, v12
  v_sub_f32 v29, 0, v12
  v_sub_f32 v30, 0, v12
  v_sub_f32 v31, 0, v12
  v_pk_add_f32 v[64:65], v[64:65], v[16:17]
  v_pk_add_f32 v[66:67], v[66:67], v[16:17]
  v_pk_add_f32 v[68:69], v[68:69], v[16:17]
  v_pk_add_f32 v[70:71], v[70:71], v[16:17]
  v_pk_add_f32 v[72:73], v[72:73], v[20:21]
  v_pk_add_f32 v[74:75], v[74:75], v[20:21]
  v_pk_add_f32 v[76:77], v[76:77], v[20:21]
  v_pk_add_f32 v[78:79], v[78:79], v[20:21]
  v_pk_add_f32 v[80:81], v[80:81], v[24:25]
  v_pk_add_f32 v[82:83], v[82:83], v[24:25]
  v_pk_add_f32 v[84:85], v[84:85], v[24:25]
  v_pk_add_f32 v[86:87], v[86:87], v[24:25]
  v_pk_add_f32 v[88:89], v[88:89], v[28:29]
  v_pk_add_f32 v[90:91], v[90:91], v[28:29]
  v_pk_add_f32 v[92:93], v[92:93], v[28:29]
  v_pk_add_f32 v[94:95], v[94:95], v[28:29]
  s_lshl_b32 s88, s25, 1
  s_waitcnt vmcnt(0)
  s_barrier
  s_waitcnt lgkmcnt(4)
  v_mfma_f32_16x16x32_bf16 v[96:99], a[0:3], a[128:131], v[16:19]
  s_mov_b32 m0, s26
  v_exp_f32 v64, v64
  v_mfma_f32_16x16x32_bf16 v[104:107], a[0:3], a[144:147], v[20:23]
  buffer_load_dwordx4 v2, s[20:23], s28 offen offset:0 lds
  v_exp_f32 v65, v65
  v_mfma_f32_16x16x32_bf16 v[112:115], a[0:3], a[160:163], v[24:27]
  buffer_load_dwordx4 v2, s[20:23], s28 offen offset:1024 lds
  v_exp_f32 v66, v66
  v_mfma_f32_16x16x32_bf16 v[120:123], a[0:3], a[176:179], v[28:31]
  buffer_load_dwordx4 v2, s[20:23], s28 offen offset:2048 lds
  v_exp_f32 v67, v67
  v_mfma_f32_16x16x32_bf16 v[96:99], a[4:7], a[132:135], v[96:99]
  v_exp_f32 v68, v68
  v_cvt_pk_bf16_f32 v32, v64, v65
  v_mfma_f32_16x16x32_bf16 v[104:107], a[4:7], a[148:151], v[104:107]
  buffer_load_dwordx4 v2, s[20:23], s28 offen offset:3072 lds
  v_exp_f32 v69, v69
  v_mfma_f32_16x16x32_bf16 v[112:115], a[4:7], a[164:167], v[112:115]
  s_xor_b32 s26, s26, 0x4000
  v_exp_f32 v70, v70
  v_cvt_pk_bf16_f32 v33, v66, v67
  v_mfma_f32_16x16x32_bf16 v[120:123], a[4:7], a[180:183], v[120:123]
  s_add_u32 s28, s28, 0x8000
  v_exp_f32 v71, v71
  v_cvt_pk_bf16_f32 v34, v68, v69
  v_mfma_f32_16x16x32_bf16 v[96:99], a[8:11], a[136:139], v[96:99]
  s_mov_b32 m0, s27
  v_exp_f32 v72, v72
  v_cvt_pk_bf16_f32 v35, v70, v71
  v_mfma_f32_16x16x32_bf16 v[104:107], a[8:11], a[152:155], v[104:107]
  buffer_load_dwordx4 v2, s[20:23], s29 offen offset:0 lds
  v_exp_f32 v73, v73
  v_mfma_f32_16x16x32_bf16 v[112:115], a[8:11], a[168:171], v[112:115]
  buffer_load_dwordx4 v2, s[20:23], s29 offen offset:1024 lds
  v_exp_f32 v74, v74
  v_mfma_f32_16x16x32_bf16 v[120:123], a[8:11], a[184:187], v[120:123]
  buffer_load_dwordx4 v2, s[20:23], s29 offen offset:2048 lds
  v_exp_f32 v75, v75
  v_mfma_f32_16x16x32_bf16 v[96:99], a[12:15], a[140:143], v[96:99]
  v_exp_f32 v76, v76
  v_cvt_pk_bf16_f32 v36, v72, v73
  v_mfma_f32_16x16x32_bf16 v[104:107], a[12:15], a[156:159], v[104:107]
  buffer_load_dwordx4 v2, s[20:23], s29 offen offset:3072 lds
  v_exp_f32 v77, v77
  v_mfma_f32_16x16x32_bf16 v[112:115], a[12:15], a[172:175], v[112:115]
  s_xor_b32 s27, s27, 0x8000
  v_exp_f32 v78, v78
  v_cvt_pk_bf16_f32 v37, v74, v75
  v_mfma_f32_16x16x32_bf16 v[120:123], a[12:15], a[188:191], v[120:123]
  s_waitcnt lgkmcnt(0)
  v_exp_f32 v79, v79
  v_cvt_pk_bf16_f32 v38, v76, v77
  v_mfma_f32_16x16x32_bf16 v[100:103], a[16:19], a[128:131], v[16:19]
  s_add_u32 s29, s29, 0x8000
  v_exp_f32 v80, v80
  v_cvt_pk_bf16_f32 v39, v78, v79
  v_mfma_f32_16x16x32_bf16 v[108:111], a[16:19], a[144:147], v[20:23]
  s_mov_b32 m0, s26
  v_exp_f32 v81, v81
  v_xor_b32 v3, 0x4000, v3
  v_mfma_f32_16x16x32_bf16 v[116:119], a[16:19], a[160:163], v[24:27]
  buffer_load_dwordx4 v2, s[20:23], s28 offen offset:0 lds
  v_exp_f32 v82, v82
  v_mfma_f32_16x16x32_bf16 v[124:127], a[16:19], a[176:179], v[28:31]
  buffer_load_dwordx4 v2, s[20:23], s28 offen offset:1024 lds
  v_exp_f32 v83, v83
  v_mfma_f32_16x16x32_bf16 v[100:103], a[20:23], a[132:135], v[100:103]
  buffer_load_dwordx4 v2, s[20:23], s28 offen offset:2048 lds
  v_exp_f32 v84, v84
  v_cvt_pk_bf16_f32 v41, v82, v83
  v_mfma_f32_16x16x32_bf16 v[108:111], a[20:23], a[148:151], v[108:111]
  buffer_load_dwordx4 v2, s[20:23], s28 offen offset:3072 lds
  v_exp_f32 v85, v85
  v_mfma_f32_16x16x32_bf16 v[116:119], a[20:23], a[164:167], v[116:119]
  s_xor_b32 s26, s26, 0x8000
  ds_read_b128 a[32:35], v3 offset:0
  v_exp_f32 v86, v86
  v_cvt_pk_bf16_f32 v42, v84, v85
  v_mfma_f32_16x16x32_bf16 v[124:127], a[20:23], a[180:183], v[124:127]
  s_add_u32 s28, s28, 0x8000
  v_exp_f32 v87, v87
  v_cvt_pk_bf16_f32 v40, v80, v81
  v_mfma_f32_16x16x32_bf16 v[100:103], a[24:27], a[136:139], v[100:103]
  s_mov_b32 m0, s27
  ds_read_b128 a[36:39], v3 offset:1024
  v_exp_f32 v88, v88
  v_cvt_pk_bf16_f32 v43, v86, v87
  v_mfma_f32_16x16x32_bf16 v[108:111], a[24:27], a[152:155], v[108:111]
  buffer_load_dwordx4 v2, s[20:23], s29 offen offset:0 lds
  v_exp_f32 v89, v89
  v_mfma_f32_16x16x32_bf16 v[116:119], a[24:27], a[168:171], v[116:119]
  buffer_load_dwordx4 v2, s[20:23], s29 offen offset:1024 lds
  v_exp_f32 v90, v90
  v_cvt_pk_bf16_f32 v44, v88, v89
  v_mfma_f32_16x16x32_bf16 v[124:127], a[24:27], a[184:187], v[124:127]
  buffer_load_dwordx4 v2, s[20:23], s29 offen offset:2048 lds
  v_exp_f32 v91, v91
  v_mfma_f32_16x16x32_bf16 v[100:103], a[28:31], a[140:143], v[100:103]
  buffer_load_dwordx4 v2, s[20:23], s29 offen offset:3072 lds
  v_exp_f32 v92, v92
  v_cvt_pk_bf16_f32 v45, v90, v91
  v_mfma_f32_16x16x32_bf16 v[108:111], a[28:31], a[156:159], v[108:111]
  s_xor_b32 s27, s27, 0x4000
  ds_read_b128 a[40:43], v3 offset:2048
  v_exp_f32 v93, v93
  v_mfma_f32_16x16x32_bf16 v[116:119], a[28:31], a[172:175], v[116:119]
  s_add_u32 s29, s29, 0x8000
  ds_read_b128 a[44:47], v3 offset:3072
  v_exp_f32 v94, v94
  v_cvt_pk_bf16_f32 v46, v92, v93
  v_mfma_f32_16x16x32_bf16 v[124:127], a[28:31], a[188:191], v[124:127]
  ds_read_b128 a[48:51], v3 offset:4096
  ds_read_b128 a[52:55], v3 offset:5120
  ds_read_b128 a[56:59], v3 offset:6144
  ds_read_b128 a[60:63], v3 offset:7168
  ds_read_b128 a[0:3], v4 offset:0
  ds_read_b128 a[4:7], v4 offset:1024
  ds_read_b128 a[8:11], v4 offset:2048
  v_exp_f32 v95, v95
  s_nop 0
  v_cvt_pk_bf16_f32 v47, v94, v95
  s_cmp_eq_u32 s25, 0
  s_cbranch_scc1 La_d1
  .p2align 6
La_lo:
  s_waitcnt lgkmcnt(7)
  v_mfma_f32_16x16x32_bf16 v[64:67], a[32:35], a[128:131], v[16:19]
  v_exp_f32 v96, v96
  v_mfma_f32_16x16x32_bf16 v[72:75], a[32:35], a[144:147], v[20:23]
  ds_read_b128 a[12:15], v4 offset:3072
  v_mfma_f32_16x16x32_bf16 v[80:83], a[32:35], a[160:163], v[24:27]
  v_exp_f32 v97, v97
  v_mfma_f32_16x16x32_bf16 v[88:91], a[32:35], a[176:179], v[28:31]
  v_cvt_pk_bf16_f32 v48, v96, v97
  v_mfma_f32_16x16x32_bf16 v[64:67], a[36:39], a[132:135], v[64:67]
  v_exp_f32 v98, v98
  v_mfma_f32_16x16x32_bf16 v[72:75], a[36:39], a[148:151], v[72:75]
  ds_read_b128 a[16:19], v4 offset:4096
  v_mfma_f32_16x16x32_bf16 v[80:83], a[36:39], a[164:167], v[80:83]
  v_exp_f32 v99, v99
  v_mfma_f32_16x16x32_bf16 v[88:91], a[36:39], a[180:183], v[88:91]
  v_cvt_pk_bf16_f32 v49, v98, v99
  v_mfma_f32_16x16x32_bf16 v[64:67], a[40:43], a[136:139], v[64:67]
  v_exp_f32 v100, v100
  v_mfma_f32_16x16x32_bf16 v[72:75], a[40:43], a[152:155], v[72:75]
  ds_read_b128 a[20:23], v4 offset:5120
  v_mfma_f32_16x16x32_bf16 v[80:83], a[40:43], a[168:171], v[80:83]
  v_exp_f32 v101, v101
  v_mfma_f32_16x16x32_bf16 v[88:91], a[40:43], a[184:187], v[88:91]
  v_cvt_pk_bf16_f32 v50, v100, v101
  v_mfma_f32_16x16x32_bf16 v[64:67], a[44:47], a[140:143], v[64:67]
  v_exp_f32 v102, v102
  v_mfma_f32_16x16x32_bf16 v[72:75], a[44:47], a[156:159], v[72:75]
  ds_read_b128 a[24:27], v4 offset:6144
  v_mfma_f32_16x16x32_bf16 v[80:83], a[44:47], a[172:175], v[80:83]
  v_exp_f32 v103, v103
  v_mfma_f32_16x16x32_bf16 v[88:91], a[44:47], a[188:191], v[88:91]
  s_waitcnt lgkmcnt(7)
  v_cvt_pk_bf16_f32 v51, v102, v103
  v_mfma_f32_16x16x32_bf16 v[68:71], a[48:51], a[128:131], v[16:19]
  v_exp_f32 v104, v104
  v_mfma_f32_16x16x32_bf16 v[76:79], a[48:51], a[144:147], v[20:23]
  ds_read_b128 a[28:31], v4 offset:7168
  v_mfma_f32_16x16x32_bf16 v[84:87], a[48:51], a[160:163], v[24:27]
  v_exp_f32 v105, v105
  v_mfma_f32_16x16x32_bf16 v[92:95], a[48:51], a[176:179], v[28:31]
  v_cvt_pk_bf16_f32 v52, v104, v105
  v_mfma_f32_16x16x32_bf16 v[68:71], a[52:55], a[132:135], v[68:71]
  v_exp_f32 v106, v106
  v_mfma_f32_16x16x32_bf16 v[76:79], a[52:55], a[148:151], v[76:79]
  ds_read_b128 a[32:35], v3 offset:8192
  v_mfma_f32_16x16x32_bf16 v[84:87], a[52:55], a[164:167], v[84:87]
  v_exp_f32 v107, v107
  v_mfma_f32_16x16x32_bf16 v[92:95], a[52:55], a[180:183], v[92:95]
  v_cvt_pk_bf16_f32 v53, v106, v107
  v_mfma_f32_16x16x32_bf16 v[68:71], a[56:59], a[136:139], v[68:71]
  v_exp_f32 v108, v108
  v_mfma_f32_16x16x32_bf16 v[76:79], a[56:59], a[152:155], v[76:79]
  ds_read_b128 a[36:39], v3 offset:9216
  v_mfma_f32_16x16x32_bf16 v[84:87], a[56:59], a[168:171], v[84:87]
  v_exp_f32 v109, v109
  v_mfma_f32_16x16x32_bf16 v[92:95], a[56:59], a[184:187], v[92:95]
  v_cvt_pk_bf16_f32 v54, v108, v109
  v_mfma_f32_16x16x32_bf16 v[68:71], a[60:63], a[140:143], v[68:71]
  v_exp_f32 v110, v110
  v_mfma_f32_16x16x32_bf16 v[76:79], a[60:63], a[156:159], v[76:79]
  ds_read_b128 a[40:43], v3 offset:10240
  v_mfma_f32_16x16x32_bf16 v[84:87], a[60:63], a[172:175], v[84:87]
  v_exp_f32 v111, v111
  v_mfma_f32_16x16x32_bf16 v[92:95], a[60:63], a[188:191], v[92:95]
  s_waitcnt lgkmcnt(7)
  v_cvt_pk_bf16_f32 v55, v110, v111
  v_mfma_f32_16x16x32_bf16 v[128:131], a[0:3], v[32:35], v[128:131]
  ds_read_b128 a[44:47], v3 offset:11264
  v_mfma_f32_16x16x32_bf16 v[160:163], a[0:3], v[36:39], v[160:163]
  v_exp_f32 v112, v112
  v_mfma_f32_16x16x32_bf16 v[192:195], a[0:3], v[40:43], v[192:195]
  s_sub_u32 s88, s88, 1
  v_mfma_f32_16x16x32_bf16 v[224:227], a[0:3], v[44:47], v[224:227]
  v_exp_f32 v113, v113
  v_mfma_f32_16x16x32_bf16 a[192:195], a[208:211], v[32:35], a[192:195]
  v_cvt_pk_bf16_f32 v56, v112, v113
  v_mfma_f32_16x16x32_bf16 v[132:135], a[4:7], v[32:35], v[132:135]
  v_exp_f32 v114, v114
  v_mfma_f32_16x16x32_bf16 v[164:167], a[4:7], v[36:39], v[164:167]
  ds_read_b128 a[48:51], v3 offset:12288
  v_mfma_f32_16x16x32_bf16 v[196:199], a[4:7], v[40:43], v[196:199]
  v_exp_f32 v115, v115
  v_mfma_f32_16x16x32_bf16 v[228:231], a[4:7], v[44:47], v[228:231]
  v_cvt_pk_bf16_f32 v57, v114, v115
  v_mfma_f32_16x16x32_bf16 a[196:199], a[208:211], v[36:39], a[196:199]
  v_exp_f32 v116, v116
  v_mfma_f32_16x16x32_bf16 v[136:139], a[8:11], v[32:35], v[136:139]
  ds_read_b128 a[52:55], v3 offset:13312
  v_mfma_f32_16x16x32_bf16 v[168:171], a[8:11], v[36:39], v[168:171]
  v_exp_f32 v117, v117
  v_mfma_f32_16x16x32_bf16 v[200:203], a[8:11], v[40:43], v[200:203]
  v_cvt_pk_bf16_f32 v58, v116, v117
  v_mfma_f32_16x16x32_bf16 v[232:235], a[8:11], v[44:47], v[232:235]
  v_exp_f32 v118, v118
  v_mfma_f32_16x16x32_bf16 a[200:203], a[208:211], v[40:43], a[200:203]
  v_mfma_f32_16x16x32_bf16 v[140:143], a[12:15], v[32:35], v[140:143]
  v_exp_f32 v119, v119
  v_mfma_f32_16x16x32_bf16 v[172:175], a[12:15], v[36:39], v[172:175]
  ds_read_b128 a[56:59], v3 offset:14336
  v_cvt_pk_bf16_f32 v59, v118, v119
  v_mfma_f32_16x16x32_bf16 v[204:207], a[12:15], v[40:43], v[204:207]
  v_exp_f32 v120, v120
  v_mfma_f32_16x16x32_bf16 v[236:239], a[12:15], v[44:47], v[236:239]
  v_mfma_f32_16x16x32_bf16 a[204:207], a[208:211], v[44:47], a[204:207]
  s_waitcnt lgkmcnt(7)
  v_exp_f32 v121, v121
  v_mfma_f32_16x16x32_bf16 v[144:147], a[16:19], v[32:35], v[144:147]
  ds_read_b128 a[60:63], v3 offset:15360
  v_cvt_pk_bf16_f32 v60, v120, v121
  v_mfma_f32_16x16x32_bf16 v[176:179], a[16:19], v[36:39], v[176:179]
  v_exp_f32 v122, v122
  v_mfma_f32_16x16x32_bf16 v[208:211], a[16:19], v[40:43], v[208:211]
  v_mfma_f32_16x16x32_bf16 v[240:243], a[16:19], v[44:47], v[240:243]
  v_exp_f32 v123, v123
  v_mfma_f32_16x16x32_bf16 v[148:151], a[20:23], v[32:35], v[148:151]
  ds_read_b128 a[0:3], v4 offset:8192
  v_cvt_pk_bf16_f32 v61, v122, v123
  v_mfma_f32_16x16x32_bf16 v[180:183], a[20:23], v[36:39], v[180:183]
  v_exp_f32 v124, v124
  v_mfma_f32_16x16x32_bf16 v[212:215], a[20:23], v[40:43], v[212:215]
  v_mfma_f32_16x16x32_bf16 v[244:247], a[20:23], v[44:47], v[244:247]
  v_exp_f32 v125, v125
  v_mfma_f32_16x16x32_bf16 v[152:155], a[24:27], v[32:35], v[152:155]
  ds_read_b128 a[4:7], v4 offset:9216
  v_cvt_pk_bf16_f32 v62, v124, v125
  v_mfma_f32_16x16x32_bf16 v[184:187], a[24:27], v[36:39], v[184:187]
  v_exp_f32 v126, v126
  v_mfma_f32_16x16x32_bf16 v[216:219], a[24:27], v[40:43], v[216:219]
  v_mfma_f32_16x16x32_bf16 v[248:251], a[24:27], v[44:47], v[248:251]
  v_exp_f32 v127, v127
  v_mfma_f32_16x16x32_bf16 v[156:159], a[28:31], v[32:35], v[156:159]
  ds_read_b128 a[8:11], v4 offset:10240
  v_cvt_pk_bf16_f32 v63, v126, v127
  v_mfma_f32_16x16x32_bf16 v[188:191], a[28:31], v[36:39], v[188:191]
  v_mfma_f32_16x16x32_bf16 v[220:223], a[28:31], v[40:43], v[220:223]
  v_mfma_f32_16x16x32_bf16 v[252:255], a[28:31], v[44:47], v[252:255]
  s_cmp_eq_u32 s88, 0
  s_cbranch_scc1 La_d0
  s_waitcnt vmcnt(8)
  s_barrier
  s_waitcnt lgkmcnt(7)
  v_mfma_f32_16x16x32_bf16 v[96:99], a[32:35], a[128:131], v[16:19]
  s_mov_b32 m0, s26
  v_exp_f32 v64, v64
  v_mfma_f32_16x16x32_bf16 v[104:107], a[32:35], a[144:147], v[20:23]
  buffer_load_dwordx4 v2, s[20:23], s28 offen offset:0 lds
  ds_read_b128 a[12:15], v4 offset:11264
  v_mfma_f32_16x16x32_bf16 v[112:115], a[32:35], a[160:163], v[24:27]
  v_exp_f32 v65, v65
  v_mfma_f32_16x16x32_bf16 v[120:123], a[32:35], a[176:179], v[28:31]
  v_cvt_pk_bf16_f32 v32, v64, v65
  v_mfma_f32_16x16x32_bf16 v[96:99], a[36:39], a[132:135], v[96:99]
  v_exp_f32 v66, v66
  v_mfma_f32_16x16x32_bf16 v[104:107], a[36:39], a[148:151], v[104:107]
  ds_read_b128 a[16:19], v4 offset:12288
  v_mfma_f32_16x16x32_bf16 v[112:115], a[36:39], a[164:167], v[112:115]
  v_exp_f32 v67, v67
  v_mfma_f32_16x16x32_bf16 v[120:123], a[36:39], a[180:183], v[120:123]
  v_cvt_pk_bf16_f32 v33, v66, v67
  v_mfma_f32_16x16x32_bf16 v[96:99], a[40:43], a[136:139], v[96:99]
  v_exp_f32 v68, v68
  v_mfma_f32_16x16x32_bf16 v[104:107], a[40:43], a[152:155], v[104:107]
  buffer_load_dwordx4 v2, s[20:23], s28 offen offset:1024 lds
  ds_read_b128 a[20:23], v4 offset:13312
  v_mfma_f32_16x16x32_bf16 v[112:115], a[40:43], a[168:171], v[112:115]
  v_exp_f32 v69, v69
  v_mfma_f32_16x16x32_bf16 v[120:123], a[40:43], a[184:187], v[120:123]
  v_cvt_pk_bf16_f32 v34, v68, v69
  v_mfma_f32_16x16x32_bf16 v[96:99], a[44:47], a[140:143], v[96:99]
  v_exp_f32 v70, v70
  v_mfma_f32_16x16x32_bf16 v[104:107], a[44:47], a[156:159], v[104:107]
  ds_read_b128 a[24:27], v4 offset:14336
  v_mfma_f32_16x16x32_bf16 v[112:115], a[44:47], a[172:175], v[112:115]
  v_exp_f32 v71, v71
  v_mfma_f32_16x16x32_bf16 v[120:123], a[44:47], a[188:191], v[120:123]
  s_waitcnt lgkmcnt(7)
  v_cvt_pk_bf16_f32 v35, v70, v71
  v_mfma_f32_16x16x32_bf16 v[100:103], a[48:51], a[128:131], v[16:19]
  v_exp_f32 v72, v72
  v_mfma_f32_16x16x32_bf16 v[108:111], a[48:51], a[144:147], v[20:23]
  buffer_load_dwordx4 v2, s[20:23], s28 offen offset:2048 lds
  ds_read_b128 a[28:31], v4 offset:15360
  v_mfma_f32_16x16x32_bf16 v[116:119], a[48:51], a[160:163], v[24:27]
  v_exp_f32 v73, v73
  v_mfma_f32_16x16x32_bf16 v[124:127], a[48:51], a[176:179], v[28:31]
  v_xor_b32 v3, s30, v3
  v_cvt_pk_bf16_f32 v36, v72, v73
  v_mfma_f32_16x16x32_bf16 v[100:103], a[52:55], a[132:135], v[100:103]
  v_exp_f32 v74, v74
  v_mfma_f32_16x16x32_bf16 v[108:111], a[52:55], a[148:151], v[108:111]
  ds_read_b128 a[32:35], v3 offset:0
  v_mfma_f32_16x16x32_bf16 v[116:119], a[52:55], a[164:167], v[116:119]
  v_exp_f32 v75, v75
  v_mfma_f32_16x16x32_bf16 v[124:127], a[52:55], a[180:183], v[124:127]
  v_cvt_pk_bf16_f32 v37, v74, v75
  v_mfma_f32_16x16x32_bf16 v[100:103], a[56:59], a[136:139], v[100:103]
  v_exp_f32 v76, v76
  v_mfma_f32_16x16x32_bf16 v[108:111], a[56:59], a[152:155], v[108:111]
  buffer_load_dwordx4 v2, s[20:23], s28 offen offset:3072 lds
  ds_read_b128 a[36:39], v3 offset:1024
  v_mfma_f32_16x16x32_bf16 v[116:119], a[56:59], a[168:171], v[116:119]
  s_xor_b32 s26, s26, s31
  v_exp_f32 v77, v77
  v_mfma_f32_16x16x32_bf16 v[124:127], a[56:59], a[184:187], v[124:127]
  s_add_u32 s28, s28, 0x8000
  s_mov_b32 m0, s27
  v_cvt_pk_bf16_f32 v38, v76, v77
  v_mfma_f32_16x16x32_bf16 v[100:103], a[60:63], a[140:143], v[100:103]
  v_exp_f32 v78, v78
  v_mfma_f32_16x16x32_bf16 v[108:111], a[60:63], a[156:159], v[108:111]
  ds_read_b128 a[40:43], v3 offset:2048
  v_mfma_f32_16x16x32_bf16 v[116:119], a[60:63], a[172:175], v[116:119]
  v_exp_f32 v79, v79
  v_mfma_f32_16x16x32_bf16 v[124:127], a[60:63], a[188:191], v[124:127]
  s_waitcnt lgkmcnt(7)
  v_cvt_pk_bf16_f32 v39, v78, v79
  v_mfma_f32_16x16x32_bf16 v[128:131], a[0:3], v[48:51], v[128:131]
  ds_read_b128 a[44:47], v3 offset:3072
  v_mfma_f32_16x16x32_bf16 v[160:163], a[0:3], v[52:55], v[160:163]
  v_exp_f32 v80, v80
  v_mfma_f32_16x16x32_bf16 v[192:195], a[0:3], v[56:59], v[192:195]
  buffer_load_dwordx4 v2, s[20:23], s29 offen offset:0 lds
  v_mfma_f32_16x16x32_bf16 v[224:227], a[0:3], v[60:63], v[224:227]
  v_exp_f32 v81, v81
  v_mfma_f32_16x16x32_bf16 a[192:195], a[208:211], v[48:51], a[192:195]
  v_cvt_pk_bf16_f32 v40, v80, v81
  v_mfma_f32_16x16x32_bf16 v[132:135], a[4:7], v[48:51], v[132:135]
  v_exp_f32 v82, v82
  v_mfma_f32_16x16x32_bf16 v[164:167], a[4:7], v[52:55], v[164:167]
  ds_read_b128 a[48:51], v3 offset:4096
  v_mfma_f32_16x16x32_bf16 v[196:199], a[4:7], v[56:59], v[196:199]
  v_exp_f32 v83, v83
  v_mfma_f32_16x16x32_bf16 v[228:231], a[4:7], v[60:63], v[228:231]
  v_cvt_pk_bf16_f32 v41, v82, v83
  v_mfma_f32_16x16x32_bf16 a[196:199], a[208:211], v[52:55], a[196:199]
  v_exp_f32 v84, v84
  v_mfma_f32_16x16x32_bf16 v[136:139], a[8:11], v[48:51], v[136:139]
  buffer_load_dwordx4 v2, s[20:23], s29 offen offset:1024 lds
  ds_read_b128 a[52:55], v3 offset:5120
  v_mfma_f32_16x16x32_bf16 v[168:171], a[8:11], v[52:55], v[168:171]
  v_exp_f32 v85, v85
  v_mfma_f32_16x16x32_bf16 v[200:203], a[8:11], v[56:59], v[200:203]
  v_cvt_pk_bf16_f32 v42, v84, v85
  v_mfma_f32_16x16x32_bf16 v[232:235], a[8:11], v[60:63], v[232:235]
  v_exp_f32 v86, v86
  v_mfma_f32_16x16x32_bf16 a[200:203], a[208:211], v[56:59], a[200:203]
  v_mfma_f32_16x16x32_bf16 v[140:143], a[12:15], v[48:51], v[140:143]
  v_exp_f32 v87, v87
  v_mfma_f32_16x16x32_bf16 v[172:175], a[12:15], v[52:55], v[172:175]
  ds_read_b128 a[56:59], v3 offset:6144
  v_cvt_pk_bf16_f32 v43, v86, v87
  v_mfma_f32_16x16x32_bf16 v[204:207], a[12:15], v[56:59], v[204:207]
  v_exp_f32 v88, v88
  v_mfma_f32_16x16x32_bf16 v[236:239], a[12:15], v[60:63], v[236:239]
  buffer_load_dwordx4 v2, s[20:23], s29 offen offset:2048 lds
  v_mfma_f32_16x16x32_bf16 a[204:207], a[208:211], v[60:63], a[204:207]
  s_waitcnt lgkmcnt(7)
  v_exp_f32 v89, v89
  v_mfma_f32_16x16x32_bf16 v[144:147], a[16:19], v[48:51], v[144:147]
  ds_read_b128 a[60:63], v3 offset:7168
  v_cvt_pk_bf16_f32 v44, v88, v89
  v_mfma_f32_16x16x32_bf16 v[176:179], a[16:19], v[52:55], v[176:179]
  v_exp_f32 v90, v90
  v_mfma_f32_16x16x32_bf16 v[208:211], a[16:19], v[56:59], v[208:211]
  v_mfma_f32_16x16x32_bf16 v[240:243], a[16:19], v[60:63], v[240:243]
  v_exp_f32 v91, v91
  v_mfma_f32_16x16x32_bf16 v[148:151], a[20:23], v[48:51], v[148:151]
  v_xor_b32 v4, s31, v4
  v_cvt_pk_bf16_f32 v45, v90, v91
  v_mfma_f32_16x16x32_bf16 v[180:183], a[20:23], v[52:55], v[180:183]
  v_exp_f32 v92, v92
  v_mfma_f32_16x16x32_bf16 v[212:215], a[20:23], v[56:59], v[212:215]
  buffer_load_dwordx4 v2, s[20:23], s29 offen offset:3072 lds
  ds_read_b128 a[0:3], v4 offset:0
  v_mfma_f32_16x16x32_bf16 v[244:247], a[20:23], v[60:63], v[244:247]
  s_xor_b32 s27, s27, s30
  v_exp_f32 v93, v93
  v_mfma_f32_16x16x32_bf16 v[152:155], a[24:27], v[48:51], v[152:155]
  s_add_u32 s29, s29, 0x8000
  ds_read_b128 a[4:7], v4 offset:1024
  v_cvt_pk_bf16_f32 v46, v92, v93
  v_mfma_f32_16x16x32_bf16 v[184:187], a[24:27], v[52:55], v[184:187]
  v_exp_f32 v94, v94
  v_mfma_f32_16x16x32_bf16 v[216:219], a[24:27], v[56:59], v[216:219]
  v_mfma_f32_16x16x32_bf16 v[248:251], a[24:27], v[60:63], v[248:251]
  v_exp_f32 v95, v95
  v_mfma_f32_16x16x32_bf16 v[156:159], a[28:31], v[48:51], v[156:159]
  ds_read_b128 a[8:11], v4 offset:2048
  v_cvt_pk_bf16_f32 v47, v94, v95
  v_mfma_f32_16x16x32_bf16 v[188:191], a[28:31], v[52:55], v[188:191]
  v_mfma_f32_16x16x32_bf16 v[220:223], a[28:31], v[56:59], v[220:223]
  v_mfma_f32_16x16x32_bf16 v[252:255], a[28:31], v[60:63], v[252:255]
  s_xor_b32 s30, s30, 0xc000
  s_xor_b32 s31, s31, 0xc000
  s_branch La_lo
La_d0:
  s_waitcnt vmcnt(8)
  s_barrier
  s_waitcnt lgkmcnt(7)
  v_mfma_f32_16x16x32_bf16 v[96:99], a[32:35], a[128:131], v[16:19]
  s_mov_b32 m0, s26
  ds_read_b128 a[12:15], v4 offset:11264
  v_cndmask_b32 v64, v64, v5, s[32:33]
  v_mfma_f32_16x16x32_bf16 v[104:107], a[32:35], a[144:147], v[20:23]
  v_exp_f32 v64, v64
  v_mfma_f32_16x16x32_bf16 v[112:115], a[32:35], a[160:163], v[24:27]
  v_cndmask_b32 v65, v65, v5, s[34:35]
  v_exp_f32 v65, v65
  v_mfma_f32_16x16x32_bf16 v[120:123], a[32:35], a[176:179], v[28:31]
  buffer_load_dwordx4 v2, s[20:23], s28 offen offset:0 lds
  v_cndmask_b32 v66, v66, v5, s[36:37]
  v_mfma_f32_16x16x32_bf16 v[96:99], a[36:39], a[132:135], v[96:99]
  v_exp_f32 v66, v66
  v_mfma_f32_16x16x32_bf16 v[104:107], a[36:39], a[148:151], v[104:107]
  ds_read_b128 a[16:19], v4 offset:12288
  v_cndmask_b32 v67, v67, v5, s[38:39]
  v_mfma_f32_16x16x32_bf16 v[112:115], a[36:39], a[164:167], v[112:115]
  v_exp_f32 v67, v67
  v_mfma_f32_16x16x32_bf16 v[120:123], a[36:39], a[180:183], v[120:123]
  v_cndmask_b32 v68, v68, v5, s[40:41]
  v_cndmask_b32 v69, v69, v5, s[42:43]
  v_mfma_f32_16x16x32_bf16 v[96:99], a[40:43], a[136:139], v[96:99]
  v_exp_f32 v68, v68
  v_mfma_f32_16x16x32_bf16 v[104:107], a[40:43], a[152:155], v[104:107]
  buffer_load_dwordx4 v2, s[20:23], s28 offen offset:1024 lds
  ds_read_b128 a[20:23], v4 offset:13312
  v_mfma_f32_16x16x32_bf16 v[112:115], a[40:43], a[168:171], v[112:115]
  v_exp_f32 v69, v69
  v_mfma_f32_16x16x32_bf16 v[120:123], a[40:43], a[184:187], v[120:123]
  v_cndmask_b32 v70, v70, v5, s[44:45]
  v_cvt_pk_bf16_f32 v32, v64, v65
  v_mfma_f32_16x16x32_bf16 v[96:99], a[44:47], a[140:143], v[96:99]
  v_exp_f32 v70, v70
  v_mfma_f32_16x16x32_bf16 v[104:107], a[44:47], a[156:159], v[104:107]
  ds_read_b128 a[24:27], v4 offset:14336
  v_cndmask_b32 v71, v71, v5, s[46:47]
  v_mfma_f32_16x16x32_bf16 v[112:115], a[44:47], a[172:175], v[112:115]
  v_exp_f32 v71, v71
  v_mfma_f32_16x16x32_bf16 v[120:123], a[44:47], a[188:191], v[120:123]
  s_waitcnt lgkmcnt(7)
  v_cvt_pk_bf16_f32 v33, v66, v67
  v_cvt_pk_bf16_f32 v34, v68, v69
  v_mfma_f32_16x16x32_bf16 v[100:103], a[48:51], a[128:131], v[16:19]
  v_exp_f32 v72, v72
  v_mfma_f32_16x16x32_bf16 v[108:111], a[48:51], a[144:147], v[20:23]
  buffer_load_dwordx4 v2, s[20:23], s28 offen offset:2048 lds
  ds_read_b128 a[28:31], v4 offset:15360
  v_mfma_f32_16x16x32_bf16 v[116:119], a[48:51], a[160:163], v[24:27]
  v_exp_f32 v73, v73
  v_mfma_f32_16x16x32_bf16 v[124:127], a[48:51], a[176:179], v[28:31]
  v_xor_b32 v3, 0x4000, v3
  v_cvt_pk_bf16_f32 v35, v70, v71
  v_mfma_f32_16x16x32_bf16 v[100:103], a[52:55], a[132:135], v[100:103]
  v_exp_f32 v74, v74
  v_mfma_f32_16x16x32_bf16 v[108:111], a[52:55], a[148:151], v[108:111]
  ds_read_b128 a[32:35], v3 offset:0
  v_cvt_pk_bf16_f32 v36, v72, v73
  v_mfma_f32_16x16x32_bf16 v[116:119], a[52:55], a[164:167], v[116:119]
  v_exp_f32 v75, v75
  v_mfma_f32_16x16x32_bf16 v[124:127], a[52:55], a[180:183], v[124:127]
  v_cvt_pk_bf16_f32 v37, v74, v75
  v_mfma_f32_16x16x32_bf16 v[100:103], a[56:59], a[136:139], v[100:103]
  v_exp_f32 v76, v76
  v_mfma_f32_16x16x32_bf16 v[108:111], a[56:59], a[152:155], v[108:111]
  buffer_load_dwordx4 v2, s[20:23], s28 offen offset:3072 lds
  ds_read_b128 a[36:39], v3 offset:1024
  v_mfma_f32_16x16x32_bf16 v[116:119], a[56:59], a[168:171], v[116:119]
  s_xor_b32 s26, s26, 0x8000
  v_exp_f32 v77, v77
  v_mfma_f32_16x16x32_bf16 v[124:127], a[56:59], a[184:187], v[124:127]
  s_add_u32 s28, s28, 0x8000
  s_mov_b32 m0, s27
  v_cvt_pk_bf16_f32 v38, v76, v77
  v_mfma_f32_16x16x32_bf16 v[100:103], a[60:63], a[140:143], v[100:103]
  v_exp_f32 v78, v78
  v_mfma_f32_16x16x32_bf16 v[108:111], a[60:63], a[156:159], v[108:111]
  ds_read_b128 a[40:43], v3 offset:2048
  v_mfma_f32_16x16x32_bf16 v[116:119], a[60:63], a[172:175], v[116:119]
  v_exp_f32 v79, v79
  v_mfma_f32_16x16x32_bf16 v[124:127], a[60:63], a[188:191], v[124:127]
  s_waitcnt lgkmcnt(7)
  v_cvt_pk_bf16_f32 v39, v78, v79
  v_mfma_f32_16x16x32_bf16 v[128:131], a[0:3], v[48:51], v[128:131]
  ds_read_b128 a[44:47], v3 offset:3072
  v_mfma_f32_16x16x32_bf16 v[160:163], a[0:3], v[52:55], v[160:163]
  v_exp_f32 v80, v80
  v_mfma_f32_16x16x32_bf16 v[192:195], a[0:3], v[56:59], v[192:195]
  buffer_load_dwordx4 v2, s[20:23], s29 offen offset:0 lds
  v_mfma_f32_16x16x32_bf16 v[224:227], a[0:3], v[60:63], v[224:227]
  v_exp_f32 v81, v81
  v_mfma_f32_16x16x32_bf16 a[192:195], a[208:211], v[48:51], a[192:195]
  v_cvt_pk_bf16_f32 v40, v80, v81
  v_mfma_f32_16x16x32_bf16 v[132:135], a[4:7], v[48:51], v[132:135]
  v_exp_f32 v82, v82
  v_mfma_f32_16x16x32_bf16 v[164:167], a[4:7], v[52:55], v[164:167]
  ds_read_b128 a[48:51], v3 offset:4096
  v_mfma_f32_16x16x32_bf16 v[196:199], a[4:7], v[56:59], v[196:199]
  v_exp_f32 v83, v83
  v_mfma_f32_16x16x32_bf16 v[228:231], a[4:7], v[60:63], v[228:231]
  v_cvt_pk_bf16_f32 v41, v82, v83
  v_mfma_f32_16x16x32_bf16 a[196:199], a[208:211], v[52:55], a[196:199]
  v_exp_f32 v84, v84
  v_mfma_f32_16x16x32_bf16 v[136:139], a[8:11], v[48:51], v[136:139]
  buffer_load_dwordx4 v2, s[20:23], s29 offen offset:1024 lds
  ds_read_b128 a[52:55], v3 offset:5120
  v_mfma_f32_16x16x32_bf16 v[168:171], a[8:11], v[52:55], v[168:171]
  v_exp_f32 v85, v85
  v_mfma_f32_16x16x32_bf16 v[200:203], a[8:11], v[56:59], v[200:203]
  v_cvt_pk_bf16_f32 v42, v84, v85
  v_mfma_f32_16x16x32_bf16 v[232:235], a[8:11], v[60:63], v[232:235]
  v_exp_f32 v86, v86
  v_mfma_f32_16x16x32_bf16 a[200:203], a[208:211], v[56:59], a[200:203]
  v_mfma_f32_16x16x32_bf16 v[140:143], a[12:15], v[48:51], v[140:143]
  v_exp_f32 v87, v87
  v_mfma_f32_16x16x32_bf16 v[172:175], a[12:15], v[52:55], v[172:175]
  ds_read_b128 a[56:59], v3 offset:6144
  v_cvt_pk_bf16_f32 v43, v86, v87
  v_mfma_f32_16x16x32_bf16 v[204:207], a[12:15], v[56:59], v[204:207]
  v_exp_f32 v88, v88
  v_mfma_f32_16x16x32_bf16 v[236:239], a[12:15], v[60:63], v[236:239]
  buffer_load_dwordx4 v2, s[20:23], s29 offen offset:2048 lds
  v_mfma_f32_16x16x32_bf16 a[204:207], a[208:211], v[60:63], a[204:207]
  s_waitcnt lgkmcnt(7)
  v_exp_f32 v89, v89
  v_mfma_f32_16x16x32_bf16 v[144:147], a[16:19], v[48:51], v[144:147]
  ds_read_b128 a[60:63], v3 offset:7168
  v_cvt_pk_bf16_f32 v44, v88, v89
  v_mfma_f32_16x16x32_bf16 v[176:179], a[16:19], v[52:55], v[176:179]
  v_exp_f32 v90, v90
  v_mfma_f32_16x16x32_bf16 v[208:211], a[16:19], v[56:59], v[208:211]
  v_mfma_f32_16x16x32_bf16 v[240:243], a[16:19], v[60:63], v[240:243]
  v_exp_f32 v91, v91
  v_mfma_f32_16x16x32_bf16 v[148:151], a[20:23], v[48:51], v[148:151]
  v_xor_b32 v4, 0x8000, v4
  v_cvt_pk_bf16_f32 v45, v90, v91
  v_mfma_f32_16x16x32_bf16 v[180:183], a[20:23], v[52:55], v[180:183]
  v_exp_f32 v92, v92
  v_mfma_f32_16x16x32_bf16 v[212:215], a[20:23], v[56:59], v[212:215]
  buffer_load_dwordx4 v2, s[20:23], s29 offen offset:3072 lds
  ds_read_b128 a[0:3], v4 offset:0
  v_mfma_f32_16x16x32_bf16 v[244:247], a[20:23], v[60:63], v[244:247]
  s_xor_b32 s27, s27, 0x4000
  v_exp_f32 v93, v93
  v_mfma_f32_16x16x32_bf16 v[152:155], a[24:27], v[48:51], v[152:155]
  s_add_u32 s29, s29, 0x8000
  ds_read_b128 a[4:7], v4 offset:1024
  v_cvt_pk_bf16_f32 v46, v92, v93
  v_mfma_f32_16x16x32_bf16 v[184:187], a[24:27], v[52:55], v[184:187]
  v_exp_f32 v94, v94
  v_mfma_f32_16x16x32_bf16 v[216:219], a[24:27], v[56:59], v[216:219]
  v_mfma_f32_16x16x32_bf16 v[248:251], a[24:27], v[60:63], v[248:251]
  v_exp_f32 v95, v95
  v_mfma_f32_16x16x32_bf16 v[156:159], a[28:31], v[48:51], v[156:159]
  ds_read_b128 a[8:11], v4 offset:2048
  v_cvt_pk_bf16_f32 v47, v94, v95
  v_mfma_f32_16x16x32_bf16 v[188:191], a[28:31], v[52:55], v[188:191]
  v_mfma_f32_16x16x32_bf16 v[220:223], a[28:31], v[56:59], v[220:223]
  v_mfma_f32_16x16x32_bf16 v[252:255], a[28:31], v[60:63], v[252:255]
La_d1:
  s_waitcnt lgkmcnt(7)
  v_mfma_f32_16x16x32_bf16 v[72:75], a[32:35], a[144:147], v[20:23]
  buffer_load_dwordx4 a[64:67], v2, s[8:11], s6 offen offset:0
  ds_read_b128 a[12:15], v4 offset:3072
  v_mfma_f32_16x16x32_bf16 v[80:83], a[32:35], a[160:163], v[24:27]
  v_cndmask_b32 v96, v96, v5, s[48:49]
  v_exp_f32 v96, v96
  v_mfma_f32_16x16x32_bf16 v[88:91], a[32:35], a[176:179], v[28:31]
  v_cndmask_b32 v97, v97, v5, s[50:51]
  v_exp_f32 v97, v97
  v_mfma_f32_16x16x32_bf16 v[72:75], a[36:39], a[148:151], v[72:75]
  v_cndmask_b32 v98, v98, v5, s[52:53]
  v_exp_f32 v98, v98
  v_mfma_f32_16x16x32_bf16 v[80:83], a[36:39], a[164:167], v[80:83]
  ds_read_b128 a[16:19], v4 offset:4096
  v_cndmask_b32 v99, v99, v5, s[54:55]
  v_mfma_f32_16x16x32_bf16 v[88:91], a[36:39], a[180:183], v[88:91]
  v_exp_f32 v99, v99
  v_mfma_f32_16x16x32_bf16 v[72:75], a[40:43], a[152:155], v[72:75]
  buffer_load_dwordx4 a[64:67], v2, s[8:11], s6 offen offset:1024
  ds_read_b128 a[20:23], v4 offset:5120
  v_mfma_f32_16x16x32_bf16 v[80:83], a[40:43], a[168:171], v[80:83]
  v_cndmask_b32 v100, v100, v5, s[56:57]
  v_exp_f32 v100, v100
  v_mfma_f32_16x16x32_bf16 v[88:91], a[40:43], a[184:187], v[88:91]
  v_cndmask_b32 v101, v101, v5, s[58:59]
  v_cndmask_b32 v102, v102, v5, s[60:61]
  v_mfma_f32_16x16x32_bf16 v[72:75], a[44:47], a[156:159], v[72:75]
  v_exp_f32 v101, v101
  v_mfma_f32_16x16x32_bf16 v[80:83], a[44:47], a[172:175], v[80:83]
  v_exp_f32 v102, v102
  v_mfma_f32_16x16x32_bf16 v[88:91], a[44:47], a[188:191], v[88:91]
  s_waitcnt lgkmcnt(6)
  buffer_load_dwordx4 a[64:67], v2, s[8:11], s6 offen offset:2048
  ds_read_b128 a[24:27], v4 offset:6144
  v_mfma_f32_16x16x32_bf16 v[76:79], a[48:51], a[144:147], v[20:23]
  v_cndmask_b32 v103, v103, v5, s[62:63]
  v_exp_f32 v103, v103
  v_mfma_f32_16x16x32_bf16 v[84:87], a[48:51], a[160:163], v[24:27]
  ds_read_b128 a[28:31], v4 offset:7168
  v_cvt_pk_bf16_f32 v48, v96, v97
  v_mfma_f32_16x16x32_bf16 v[92:95], a[48:51], a[176:179], v[28:31]
  v_exp_f32 v104, v104
  v_mfma_f32_16x16x32_bf16 v[76:79], a[52:55], a[148:151], v[76:79]
  ds_read_b128 a[32:35], v3 offset:8192
  v_cvt_pk_bf16_f32 v49, v98, v99
  v_mfma_f32_16x16x32_bf16 v[84:87], a[52:55], a[164:167], v[84:87]
  v_exp_f32 v105, v105
  v_mfma_f32_16x16x32_bf16 v[92:95], a[52:55], a[180:183], v[92:95]
  buffer_load_dwordx4 a[64:67], v2, s[8:11], s6 offen offset:3072
  v_cvt_pk_bf16_f32 v50, v100, v101
  v_mfma_f32_16x16x32_bf16 v[76:79], a[56:59], a[152:155], v[76:79]
  s_add_u32 s6, s6, 4096
  v_exp_f32 v106, v106
  v_mfma_f32_16x16x32_bf16 v[84:87], a[56:59], a[168:171], v[84:87]
  v_exp_f32 v107, v107
  v_mfma_f32_16x16x32_bf16 v[92:95], a[56:59], a[184:187], v[92:95]
  ds_read_b128 a[36:39], v3 offset:9216
  v_cvt_pk_bf16_f32 v51, v102, v103
  v_mfma_f32_16x16x32_bf16 v[76:79], a[60:63], a[156:159], v[76:79]
  v_exp_f32 v108, v108
  v_mfma_f32_16x16x32_bf16 v[84:87], a[60:63], a[172:175], v[84:87]
  ds_read_b128 a[40:43], v3 offset:10240
  v_cvt_pk_bf16_f32 v52, v104, v105
  v_mfma_f32_16x16x32_bf16 v[92:95], a[60:63], a[188:191], v[92:95]
  s_waitcnt lgkmcnt(7)
  v_exp_f32 v109, v109
  v_mfma_f32_16x16x32_bf16 v[128:131], a[0:3], v[32:35], v[128:131]
  buffer_load_dwordx4 a[64:67], v2, s[8:11], s6 offen offset:0
  ds_read_b128 a[44:47], v3 offset:11264
  v_mfma_f32_16x16x32_bf16 v[160:163], a[0:3], v[36:39], v[160:163]
  v_exp_f32 v110, v110
  v_mfma_f32_16x16x32_bf16 v[192:195], a[0:3], v[40:43], v[192:195]
  v_cvt_pk_bf16_f32 v53, v106, v107
  v_cvt_pk_bf16_f32 v54, v108, v109
  v_mfma_f32_16x16x32_bf16 v[224:227], a[0:3], v[44:47], v[224:227]
  v_exp_f32 v111, v111
  v_mfma_f32_16x16x32_bf16 a[192:195], a[208:211], v[32:35], a[192:195]
  v_cvt_pk_bf16_f32 v55, v110, v111
  v_mfma_f32_16x16x32_bf16 v[132:135], a[4:7], v[32:35], v[132:135]
  v_exp_f32 v112, v112
  v_mfma_f32_16x16x32_bf16 v[164:167], a[4:7], v[36:39], v[164:167]
  v_exp_f32 v113, v113
  v_mfma_f32_16x16x32_bf16 v[196:199], a[4:7], v[40:43], v[196:199]
  buffer_load_dwordx4 a[64:67], v2, s[8:11], s6 offen offset:1024
  ds_read_b128 a[48:51], v3 offset:12288
  v_mfma_f32_16x16x32_bf16 v[228:231], a[4:7], v[44:47], v[228:231]
  v_exp_f32 v114, v114
  v_mfma_f32_16x16x32_bf16 a[196:199], a[208:211], v[36:39], a[196:199]
  v_cvt_pk_bf16_f32 v56, v112, v113
  v_mfma_f32_16x16x32_bf16 v[136:139], a[8:11], v[32:35], v[136:139]
  v_exp_f32 v115, v115
  v_mfma_f32_16x16x32_bf16 v[168:171], a[8:11], v[36:39], v[168:171]
  buffer_load_dwordx4 a[64:67], v2, s[8:11], s6 offen offset:2048
  ds_read_b128 a[52:55], v3 offset:13312
  v_mfma_f32_16x16x32_bf16 v[200:203], a[8:11], v[40:43], v[200:203]
  v_exp_f32 v116, v116
  v_mfma_f32_16x16x32_bf16 v[232:235], a[8:11], v[44:47], v[232:235]
  v_cvt_pk_bf16_f32 v57, v114, v115
  v_mfma_f32_16x16x32_bf16 a[200:203], a[208:211], v[40:43], a[200:203]
  v_exp_f32 v117, v117
  v_mfma_f32_16x16x32_bf16 v[140:143], a[12:15], v[32:35], v[140:143]
  v_exp_f32 v118, v118
  v_mfma_f32_16x16x32_bf16 v[172:175], a[12:15], v[36:39], v[172:175]
  buffer_load_dwordx4 a[64:67], v2, s[8:11], s6 offen offset:3072
  ds_read_b128 a[56:59], v3 offset:14336
  v_mfma_f32_16x16x32_bf16 v[204:207], a[12:15], v[40:43], v[204:207]
  v_exp_f32 v119, v119
  v_mfma_f32_16x16x32_bf16 v[236:239], a[12:15], v[44:47], v[236:239]
  v_cvt_pk_bf16_f32 v58, v116, v117
  v_cvt_pk_bf16_f32 v59, v118, v119
  v_mfma_f32_16x16x32_bf16 a[204:207], a[208:211], v[44:47], a[204:207]
  s_waitcnt lgkmcnt(7)
  v_exp_f32 v120, v120
  v_mfma_f32_16x16x32_bf16 v[144:147], a[16:19], v[32:35], v[144:147]
  ds_read_b128 a[60:63], v3 offset:15360
  v_mfma_f32_16x16x32_bf16 v[176:179], a[16:19], v[36:39], v[176:179]
  v_exp_f32 v121, v121
  v_mfma_f32_16x16x32_bf16 v[208:211], a[16:19], v[40:43], v[208:211]
  buffer_load_dwordx4 a[64:67], v2, s[12:15], s7 offen offset:0
  v_cvt_pk_bf16_f32 v60, v120, v121
  v_mfma_f32_16x16x32_bf16 v[240:243], a[16:19], v[44:47], v[240:243]
  v_exp_f32 v122, v122
  v_mfma_f32_16x16x32_bf16 v[148:151], a[20:23], v[32:35], v[148:151]
  v_exp_f32 v123, v123
  v_mfma_f32_16x16x32_bf16 v[180:183], a[20:23], v[36:39], v[180:183]
  ds_read_b128 a[0:3], v4 offset:8192
  v_cvt_pk_bf16_f32 v61, v122, v123
  v_mfma_f32_16x16x32_bf16 v[212:215], a[20:23], v[40:43], v[212:215]
  v_exp_f32 v124, v124
  v_mfma_f32_16x16x32_bf16 v[244:247], a[20:23], v[44:47], v[244:247]
  v_mfma_f32_16x16x32_bf16 v[152:155], a[24:27], v[32:35], v[152:155]
  v_exp_f32 v125, v125
  v_mfma_f32_16x16x32_bf16 v[184:187], a[24:27], v[36:39], v[184:187]
  buffer_load_dwordx4 a[64:67], v2, s[12:15], s7 offen offset:1024
  ds_read_b128 a[4:7], v4 offset:9216
  v_mfma_f32_16x16x32_bf16 v[216:219], a[24:27], v[40:43], v[216:219]
  v_exp_f32 v126, v126
  v_mfma_f32_16x16x32_bf16 v[248:251], a[24:27], v[44:47], v[248:251]
  v_cvt_pk_bf16_f32 v62, v124, v125
  v_mfma_f32_16x16x32_bf16 v[156:159], a[28:31], v[32:35], v[156:159]
  v_exp_f32 v127, v127
  v_mfma_f32_16x16x32_bf16 v[188:191], a[28:31], v[36:39], v[188:191]
  ds_read_b128 a[8:11], v4 offset:10240
  v_cvt_pk_bf16_f32 v63, v126, v127
  v_mfma_f32_16x16x32_bf16 v[220:223], a[28:31], v[40:43], v[220:223]
  v_mfma_f32_16x16x32_bf16 v[252:255], a[28:31], v[44:47], v[252:255]
  s_waitcnt vmcnt(22)
  s_barrier
  s_waitcnt lgkmcnt(7)
  v_mfma_f32_16x16x32_bf16 v[104:107], a[32:35], a[144:147], v[20:23]
  s_mov_b32 m0, s26
  ds_read_b128 a[12:15], v4 offset:11264
  v_cndmask_b32 v72, v72, v5, s[32:33]
  v_mfma_f32_16x16x32_bf16 v[112:115], a[32:35], a[160:163], v[24:27]
  v_exp_f32 v72, v72
  v_mfma_f32_16x16x32_bf16 v[120:123], a[32:35], a[176:179], v[28:31]
  v_cndmask_b32 v73, v73, v5, s[34:35]
  v_exp_f32 v73, v73
  v_mfma_f32_16x16x32_bf16 v[104:107], a[36:39], a[148:151], v[104:107]
  buffer_load_dwordx4 v2, s[20:23], s28 offen offset:0 lds
  ds_read_b128 a[16:19], v4 offset:12288
  v_mfma_f32_16x16x32_bf16 v[112:115], a[36:39], a[164:167], v[112:115]
  v_cndmask_b32 v74, v74, v5, s[36:37]
  v_exp_f32 v74, v74
  v_mfma_f32_16x16x32_bf16 v[120:123], a[36:39], a[180:183], v[120:123]
  v_cvt_pk_bf16_f32 v36, v72, v73
  v_mfma_f32_16x16x32_bf16 v[104:107], a[40:43], a[152:155], v[104:107]
  ds_read_b128 a[20:23], v4 offset:13312
  v_cndmask_b32 v75, v75, v5, s[38:39]
  v_mfma_f32_16x16x32_bf16 v[112:115], a[40:43], a[168:171], v[112:115]
  v_exp_f32 v75, v75
  v_mfma_f32_16x16x32_bf16 v[120:123], a[40:43], a[184:187], v[120:123]
  buffer_load_dwordx4 v2, s[20:23], s28 offen offset:1024 lds
  v_cndmask_b32 v76, v76, v5, s[40:41]
  v_mfma_f32_16x16x32_bf16 v[104:107], a[44:47], a[156:159], v[104:107]
  v_exp_f32 v76, v76
  v_mfma_f32_16x16x32_bf16 v[112:115], a[44:47], a[172:175], v[112:115]
  ds_read_b128 a[24:27], v4 offset:14336
  v_cndmask_b32 v79, v79, v5, s[46:47]
  v_mfma_f32_16x16x32_bf16 v[120:123], a[44:47], a[188:191], v[120:123]
  s_waitcnt lgkmcnt(7)
  v_cndmask_b32 v77, v77, v5, s[42:43]
  v_cndmask_b32 v78, v78, v5, s[44:45]
  v_mfma_f32_16x16x32_bf16 v[108:111], a[48:51], a[144:147], v[20:23]
  v_exp_f32 v77, v77
  v_mfma_f32_16x16x32_bf16 v[116:119], a[48:51], a[160:163], v[24:27]
  ds_read_b128 a[28:31], v4 offset:15360
  v_xor_b32 v4, 0x4000, v4
  v_mfma_f32_16x16x32_bf16 v[124:127], a[48:51], a[176:179], v[28:31]
  v_exp_f32 v78, v78
  v_mfma_f32_16x16x32_bf16 v[108:111], a[52:55], a[148:151], v[108:111]
  buffer_load_dwordx4 v2, s[20:23], s28 offen offset:2048 lds
  v_xor_b32 v3, 0x8000, v3
  v_mfma_f32_16x16x32_bf16 v[116:119], a[52:55], a[164:167], v[116:119]
  v_exp_f32 v79, v79
  v_mfma_f32_16x16x32_bf16 v[124:127], a[52:55], a[180:183], v[124:127]
  ds_read_b128 a[32:35], v3 offset:0
  v_cvt_pk_bf16_f32 v37, v74, v75
  v_mfma_f32_16x16x32_bf16 v[108:111], a[56:59], a[152:155], v[108:111]
  ds_read_b128 a[36:39], v3 offset:1024
  v_cvt_pk_bf16_f32 v38, v76, v77
  v_mfma_f32_16x16x32_bf16 v[116:119], a[56:59], a[168:171], v[116:119]
  v_exp_f32 v80, v80
  v_mfma_f32_16x16x32_bf16 v[124:127], a[56:59], a[184:187], v[124:127]
  v_cvt_pk_bf16_f32 v39, v78, v79
  v_mfma_f32_16x16x32_bf16 v[108:111], a[60:63], a[156:159], v[108:111]
  v_exp_f32 v81, v81
  v_mfma_f32_16x16x32_bf16 v[116:119], a[60:63], a[172:175], v[116:119]
  buffer_load_dwordx4 v2, s[20:23], s28 offen offset:3072 lds
  ds_read_b128 a[40:43], v3 offset:2048
  v_mfma_f32_16x16x32_bf16 v[124:127], a[60:63], a[188:191], v[124:127]
  s_waitcnt lgkmcnt(7)
  s_xor_b32 s26, s26, 0x4000
  s_add_u32 s28, s28, 0x8000
  v_mfma_f32_16x16x32_bf16 v[128:131], a[0:3], v[48:51], v[128:131]
  s_mov_b32 m0, s27
  v_exp_f32 v82, v82
  v_mfma_f32_16x16x32_bf16 v[160:163], a[0:3], v[52:55], v[160:163]
  ds_read_b128 a[44:47], v3 offset:3072
  v_cvt_pk_bf16_f32 v40, v80, v81
  v_mfma_f32_16x16x32_bf16 v[192:195], a[0:3], v[56:59], v[192:195]
  v_exp_f32 v83, v83
  v_mfma_f32_16x16x32_bf16 v[224:227], a[0:3], v[60:63], v[224:227]
  v_cvt_pk_bf16_f32 v41, v82, v83
  v_mfma_f32_16x16x32_bf16 a[192:195], a[208:211], v[48:51], a[192:195]
  v_mfma_f32_16x16x32_bf16 v[132:135], a[4:7], v[48:51], v[132:135]
  v_exp_f32 v84, v84
  v_mfma_f32_16x16x32_bf16 v[164:167], a[4:7], v[52:55], v[164:167]
  buffer_load_dwordx4 v2, s[20:23], s29 offen offset:0 lds
  ds_read_b128 a[48:51], v3 offset:4096
  v_mfma_f32_16x16x32_bf16 v[196:199], a[4:7], v[56:59], v[196:199]
  v_exp_f32 v85, v85
  v_mfma_f32_16x16x32_bf16 v[228:231], a[4:7], v[60:63], v[228:231]
  v_cvt_pk_bf16_f32 v42, v84, v85
  v_mfma_f32_16x16x32_bf16 a[196:199], a[208:211], v[52:55], a[196:199]
  v_exp_f32 v86, v86
  v_mfma_f32_16x16x32_bf16 v[136:139], a[8:11], v[48:51], v[136:139]
  ds_read_b128 a[52:55], v3 offset:5120
  v_mfma_f32_16x16x32_bf16 v[168:171], a[8:11], v[52:55], v[168:171]
  v_mfma_f32_16x16x32_bf16 v[200:203], a[8:11], v[56:59], v[200:203]
  v_exp_f32 v87, v87
  v_mfma_f32_16x16x32_bf16 v[232:235], a[8:11], v[60:63], v[232:235]
  buffer_load_dwordx4 v2, s[20:23], s29 offen offset:1024 lds
  v_cvt_pk_bf16_f32 v43, v86, v87
  v_mfma_f32_16x16x32_bf16 a[200:203], a[208:211], v[56:59], a[200:203]
  v_exp_f32 v88, v88
  v_mfma_f32_16x16x32_bf16 v[140:143], a[12:15], v[48:51], v[140:143]
  ds_read_b128 a[56:59], v3 offset:6144
  v_mfma_f32_16x16x32_bf16 v[172:175], a[12:15], v[52:55], v[172:175]
  v_mfma_f32_16x16x32_bf16 v[204:207], a[12:15], v[56:59], v[204:207]
  v_exp_f32 v89, v89
  v_mfma_f32_16x16x32_bf16 v[236:239], a[12:15], v[60:63], v[236:239]
  v_cvt_pk_bf16_f32 v44, v88, v89
  v_mfma_f32_16x16x32_bf16 a[204:207], a[208:211], v[60:63], a[204:207]
  s_waitcnt lgkmcnt(7)
  v_exp_f32 v90, v90
  v_mfma_f32_16x16x32_bf16 v[144:147], a[16:19], v[48:51], v[144:147]
  buffer_load_dwordx4 v2, s[20:23], s29 offen offset:2048 lds
  ds_read_b128 a[60:63], v3 offset:7168
  v_mfma_f32_16x16x32_bf16 v[176:179], a[16:19], v[52:55], v[176:179]
  v_exp_f32 v91, v91
  v_mfma_f32_16x16x32_bf16 v[208:211], a[16:19], v[56:59], v[208:211]
  v_cvt_pk_bf16_f32 v45, v90, v91
  v_mfma_f32_16x16x32_bf16 v[240:243], a[16:19], v[60:63], v[240:243]
  v_mfma_f32_16x16x32_bf16 v[148:151], a[20:23], v[48:51], v[148:151]
  v_exp_f32 v92, v92
  v_mfma_f32_16x16x32_bf16 v[180:183], a[20:23], v[52:55], v[180:183]
  ds_read_b128 a[0:3], v3 offset:8192
  v_mfma_f32_16x16x32_bf16 v[212:215], a[20:23], v[56:59], v[212:215]
  v_exp_f32 v93, v93
  v_mfma_f32_16x16x32_bf16 v[244:247], a[20:23], v[60:63], v[244:247]
  buffer_load_dwordx4 v2, s[20:23], s29 offen offset:3072 lds
  v_cvt_pk_bf16_f32 v46, v92, v93
  v_mfma_f32_16x16x32_bf16 v[152:155], a[24:27], v[48:51], v[152:155]
  s_xor_b32 s27, s27, 0x8000
  s_add_u32 s29, s29, 0x8000
  ds_read_b128 a[4:7], v3 offset:9216
  v_mfma_f32_16x16x32_bf16 v[184:187], a[24:27], v[52:55], v[184:187]
  v_exp_f32 v94, v94
  v_mfma_f32_16x16x32_bf16 v[216:219], a[24:27], v[56:59], v[216:219]
  v_mfma_f32_16x16x32_bf16 v[248:251], a[24:27], v[60:63], v[248:251]
  v_exp_f32 v95, v95
  v_mfma_f32_16x16x32_bf16 v[156:159], a[28:31], v[48:51], v[156:159]
  ds_read_b128 a[8:11], v3 offset:10240
  v_cvt_pk_bf16_f32 v47, v94, v95
  v_mfma_f32_16x16x32_bf16 v[188:191], a[28:31], v[52:55], v[188:191]
  v_mfma_f32_16x16x32_bf16 v[220:223], a[28:31], v[56:59], v[220:223]
  v_mfma_f32_16x16x32_bf16 v[252:255], a[28:31], v[60:63], v[252:255]
  s_waitcnt vmcnt(22)
  s_barrier
  s_waitcnt lgkmcnt(3)
  v_mfma_f32_16x16x32_bf16 v[64:67], a[32:35], a[160:163], v[24:27]
  s_mov_b32 m0, s26
  ds_read_b128 a[12:15], v3 offset:11264
  v_cndmask_b32 v104, v104, v5, s[48:49]
  v_mfma_f32_16x16x32_bf16 v[72:75], a[32:35], a[176:179], v[28:31]
  v_exp_f32 v104, v104
  v_mfma_f32_16x16x32_bf16 v[64:67], a[36:39], a[164:167], v[64:67]
  v_cndmask_b32 v105, v105, v5, s[50:51]
  v_exp_f32 v105, v105
  v_mfma_f32_16x16x32_bf16 v[72:75], a[36:39], a[180:183], v[72:75]
  buffer_load_dwordx4 v2, s[20:23], s28 offen offset:0 lds
  ds_read_b128 a[16:19], v3 offset:12288
  v_mfma_f32_16x16x32_bf16 v[64:67], a[40:43], a[168:171], v[64:67]
  v_cndmask_b32 v106, v106, v5, s[52:53]
  v_exp_f32 v106, v106
  v_mfma_f32_16x16x32_bf16 v[72:75], a[40:43], a[184:187], v[72:75]
  ds_read_b128 a[20:23], v3 offset:13312
  v_cndmask_b32 v108, v108, v5, s[56:57]
  v_mfma_f32_16x16x32_bf16 v[64:67], a[44:47], a[172:175], v[64:67]
  ds_read_b128 a[24:27], v3 offset:14336
  v_cndmask_b32 v107, v107, v5, s[54:55]
  v_mfma_f32_16x16x32_bf16 v[72:75], a[44:47], a[188:191], v[72:75]
  v_exp_f32 v107, v107
  v_mfma_f32_16x16x32_bf16 v[68:71], a[48:51], a[160:163], v[24:27]
  buffer_load_dwordx4 v2, s[20:23], s28 offen offset:1024 lds
  ds_read_b128 a[28:31], v3 offset:15360
  v_mfma_f32_16x16x32_bf16 v[76:79], a[48:51], a[176:179], v[28:31]
  v_exp_f32 v108, v108
  v_mfma_f32_16x16x32_bf16 v[68:71], a[52:55], a[164:167], v[68:71]
  ds_read_b128 a[32:35], v4 offset:0
  v_cndmask_b32 v109, v109, v5, s[58:59]
  v_mfma_f32_16x16x32_bf16 v[76:79], a[52:55], a[180:183], v[76:79]
  v_exp_f32 v109, v109
  v_mfma_f32_16x16x32_bf16 v[68:71], a[56:59], a[168:171], v[68:71]
  ds_read_b128 a[36:39], v4 offset:1024
  v_cvt_pk_bf16_f32 v52, v104, v105
  v_mfma_f32_16x16x32_bf16 v[76:79], a[56:59], a[184:187], v[76:79]
  v_cndmask_b32 v110, v110, v5, s[60:61]
  v_cndmask_b32 v111, v111, v5, s[62:63]
  v_mfma_f32_16x16x32_bf16 v[68:71], a[60:63], a[172:175], v[68:71]
  v_exp_f32 v110, v110
  v_mfma_f32_16x16x32_bf16 v[76:79], a[60:63], a[188:191], v[76:79]
  s_waitcnt lgkmcnt(2)
  buffer_load_dwordx4 v2, s[20:23], s28 offen offset:2048 lds
  ds_read_b128 a[40:43], v4 offset:2048
  v_mfma_f32_16x16x32_bf16 v[80:83], a[0:3], a[160:163], v[24:27]
  v_exp_f32 v111, v111
  v_mfma_f32_16x16x32_bf16 v[88:91], a[0:3], a[176:179], v[28:31]
  ds_read_b128 a[44:47], v4 offset:3072
  v_cvt_pk_bf16_f32 v53, v106, v107
  v_mfma_f32_16x16x32_bf16 v[80:83], a[4:7], a[164:167], v[80:83]
  ds_read_b128 a[48:51], v4 offset:4096
  v_cvt_pk_bf16_f32 v54, v108, v109
  v_mfma_f32_16x16x32_bf16 v[88:91], a[4:7], a[180:183], v[88:91]
  v_exp_f32 v112, v112
  v_mfma_f32_16x16x32_bf16 v[80:83], a[8:11], a[168:171], v[80:83]
  ds_read_b128 a[52:55], v4 offset:5120
  v_cvt_pk_bf16_f32 v55, v110, v111
  v_mfma_f32_16x16x32_bf16 v[88:91], a[8:11], a[184:187], v[88:91]
  v_exp_f32 v113, v113
  v_mfma_f32_16x16x32_bf16 v[80:83], a[12:15], a[172:175], v[80:83]
  buffer_load_dwordx4 v2, s[20:23], s28 offen offset:3072 lds
  ds_read_b128 a[56:59], v4 offset:6144
  v_mfma_f32_16x16x32_bf16 v[88:91], a[12:15], a[188:191], v[88:91]
  s_xor_b32 s26, s26, 0x8000
  v_exp_f32 v114, v114
  v_mfma_f32_16x16x32_bf16 v[84:87], a[16:19], a[160:163], v[24:27]
  s_add_u32 s28, s28, 0x8000
  s_mov_b32 m0, s27
  ds_read_b128 a[60:63], v4 offset:7168
  v_mfma_f32_16x16x32_bf16 v[92:95], a[16:19], a[176:179], v[28:31]
  v_xor_b32 v3, 0x4000, v3
  v_cvt_pk_bf16_f32 v56, v112, v113
  v_mfma_f32_16x16x32_bf16 v[84:87], a[20:23], a[164:167], v[84:87]
  v_exp_f32 v115, v115
  v_mfma_f32_16x16x32_bf16 v[92:95], a[20:23], a[180:183], v[92:95]
  ds_read_b128 a[0:3], v3 offset:0
  v_cvt_pk_bf16_f32 v57, v114, v115
  v_mfma_f32_16x16x32_bf16 v[84:87], a[24:27], a[168:171], v[84:87]
  v_exp_f32 v116, v116
  v_mfma_f32_16x16x32_bf16 v[92:95], a[24:27], a[184:187], v[92:95]
  buffer_load_dwordx4 v2, s[20:23], s29 offen offset:0 lds
  ds_read_b128 a[4:7], v3 offset:1024
  v_mfma_f32_16x16x32_bf16 v[84:87], a[28:31], a[172:175], v[84:87]
  v_exp_f32 v117, v117
  v_mfma_f32_16x16x32_bf16 v[92:95], a[28:31], a[188:191], v[92:95]
  s_waitcnt lgkmcnt(6)
  ds_read_b128 a[8:11], v3 offset:2048
  v_cvt_pk_bf16_f32 v58, v116, v117
  v_mfma_f32_16x16x32_bf16 v[160:163], a[32:35], v[36:39], v[160:163]
  ds_read_b128 a[12:15], v3 offset:3072
  v_mfma_f32_16x16x32_bf16 v[192:195], a[32:35], v[40:43], v[192:195]
  v_exp_f32 v118, v118
  v_mfma_f32_16x16x32_bf16 v[224:227], a[32:35], v[44:47], v[224:227]
  v_mfma_f32_16x16x32_bf16 a[196:199], a[208:211], v[36:39], a[196:199]
  v_exp_f32 v119, v119
  v_mfma_f32_16x16x32_bf16 v[164:167], a[36:39], v[36:39], v[164:167]
  buffer_load_dwordx4 v2, s[20:23], s29 offen offset:1024 lds
  ds_read_b128 a[16:19], v3 offset:4096
  v_mfma_f32_16x16x32_bf16 v[196:199], a[36:39], v[40:43], v[196:199]
  v_cvt_pk_bf16_f32 v59, v118, v119
  v_mfma_f32_16x16x32_bf16 v[228:231], a[36:39], v[44:47], v[228:231]
  v_exp_f32 v120, v120
  v_mfma_f32_16x16x32_bf16 a[200:203], a[208:211], v[40:43], a[200:203]
  v_mfma_f32_16x16x32_bf16 v[168:171], a[40:43], v[36:39], v[168:171]
  v_exp_f32 v121, v121
  v_mfma_f32_16x16x32_bf16 v[200:203], a[40:43], v[40:43], v[200:203]
  ds_read_b128 a[20:23], v3 offset:5120
  v_cvt_pk_bf16_f32 v60, v120, v121
  v_mfma_f32_16x16x32_bf16 v[232:235], a[40:43], v[44:47], v[232:235]
  v_exp_f32 v122, v122
  v_mfma_f32_16x16x32_bf16 a[204:207], a[208:211], v[44:47], a[204:207]
  buffer_load_dwordx4 v2, s[20:23], s29 offen offset:2048 lds
  v_mfma_f32_16x16x32_bf16 v[172:175], a[44:47], v[36:39], v[172:175]
  ds_read_b128 a[24:27], v3 offset:6144
  v_mfma_f32_16x16x32_bf16 v[204:207], a[44:47], v[40:43], v[204:207]
  v_exp_f32 v123, v123
  v_mfma_f32_16x16x32_bf16 v[236:239], a[44:47], v[44:47], v[236:239]
  s_waitcnt lgkmcnt(7)
  v_cvt_pk_bf16_f32 v61, v122, v123
  v_mfma_f32_16x16x32_bf16 v[176:179], a[48:51], v[36:39], v[176:179]
  v_exp_f32 v124, v124
  v_mfma_f32_16x16x32_bf16 v[208:211], a[48:51], v[40:43], v[208:211]
  ds_read_b128 a[28:31], v3 offset:7168
  v_mfma_f32_16x16x32_bf16 v[240:243], a[48:51], v[44:47], v[240:243]
  v_exp_f32 v125, v125
  v_mfma_f32_16x16x32_bf16 v[180:183], a[52:55], v[36:39], v[180:183]
  buffer_load_dwordx4 v2, s[20:23], s29 offen offset:3072 lds
  ds_read_b128 a[32:35], v3 offset:8192
  v_mfma_f32_16x16x32_bf16 v[212:215], a[52:55], v[40:43], v[212:215]
  s_xor_b32 s27, s27, 0x4000
  s_add_u32 s29, s29, 0x8000
  v_cvt_pk_bf16_f32 v62, v124, v125
  v_mfma_f32_16x16x32_bf16 v[244:247], a[52:55], v[44:47], v[244:247]
  v_exp_f32 v126, v126
  v_mfma_f32_16x16x32_bf16 v[184:187], a[56:59], v[36:39], v[184:187]
  ds_read_b128 a[36:39], v3 offset:9216
  v_mfma_f32_16x16x32_bf16 v[216:219], a[56:59], v[40:43], v[216:219]
  v_exp_f32 v127, v127
  v_mfma_f32_16x16x32_bf16 v[248:251], a[56:59], v[44:47], v[248:251]
  v_cvt_pk_bf16_f32 v63, v126, v127
  v_mfma_f32_16x16x32_bf16 v[188:191], a[60:63], v[36:39], v[188:191]
  ds_read_b128 a[40:43], v3 offset:10240
  v_mfma_f32_16x16x32_bf16 v[220:223], a[60:63], v[40:43], v[220:223]
  v_mfma_f32_16x16x32_bf16 v[252:255], a[60:63], v[44:47], v[252:255]
  s_cmp_eq_u32 s25, 7
  s_cbranch_scc1 La_t7
  s_waitcnt vmcnt(12)
  s_barrier
  s_waitcnt lgkmcnt(3)
  v_mfma_f32_16x16x32_bf16 v[96:99], a[0:3], a[160:163], v[24:27]
  s_mov_b32 m0, s26
  v_exp_f32 v64, v64
  v_mfma_f32_16x16x32_bf16 v[104:107], a[0:3], a[176:179], v[28:31]
  v_exp_f32 v65, v65
  v_mfma_f32_16x16x32_bf16 v[96:99], a[4:7], a[164:167], v[96:99]
  buffer_load_dwordx4 v2, s[20:23], s28 offen offset:0 lds
  ds_read_b128 a[44:47], v3 offset:11264
  v_mfma_f32_16x16x32_bf16 v[104:107], a[4:7], a[180:183], v[104:107]
  v_exp_f32 v66, v66
  v_mfma_f32_16x16x32_bf16 v[96:99], a[8:11], a[168:171], v[96:99]
  ds_read_b128 a[48:51], v3 offset:12288
  ds_read_b128 a[52:55], v3 offset:13312
  v_mfma_f32_16x16x32_bf16 v[104:107], a[8:11], a[184:187], v[104:107]
  v_exp_f32 v67, v67
  v_mfma_f32_16x16x32_bf16 v[96:99], a[12:15], a[172:175], v[96:99]
  ds_read_b128 a[56:59], v3 offset:14336
  v_cvt_pk_bf16_f32 v32, v64, v65
  v_mfma_f32_16x16x32_bf16 v[104:107], a[12:15], a[188:191], v[104:107]
  v_exp_f32 v68, v68
  v_mfma_f32_16x16x32_bf16 v[100:103], a[16:19], a[160:163], v[24:27]
  v_exp_f32 v69, v69
  v_mfma_f32_16x16x32_bf16 v[108:111], a[16:19], a[176:179], v[28:31]
  ds_read_b128 a[60:63], v3 offset:15360
  v_cvt_pk_bf16_f32 v33, v66, v67
  v_mfma_f32_16x16x32_bf16 v[100:103], a[20:23], a[164:167], v[100:103]
  v_exp_f32 v70, v70
  v_mfma_f32_16x16x32_bf16 v[108:111], a[20:23], a[180:183], v[108:111]
  ds_read_b128 a[0:3], v4 offset:8192
  v_cvt_pk_bf16_f32 v34, v68, v69
  v_mfma_f32_16x16x32_bf16 v[100:103], a[24:27], a[168:171], v[100:103]
  v_exp_f32 v71, v71
  v_mfma_f32_16x16x32_bf16 v[108:111], a[24:27], a[184:187], v[108:111]
  ds_read_b128 a[4:7], v4 offset:9216
  v_cvt_pk_bf16_f32 v35, v70, v71
  v_mfma_f32_16x16x32_bf16 v[100:103], a[28:31], a[172:175], v[100:103]
  v_exp_f32 v72, v72
  v_mfma_f32_16x16x32_bf16 v[108:111], a[28:31], a[188:191], v[108:111]
  s_waitcnt lgkmcnt(2)
  buffer_load_dwordx4 v2, s[20:23], s28 offen offset:1024 lds
  ds_read_b128 a[8:11], v4 offset:10240
  v_mfma_f32_16x16x32_bf16 v[112:115], a[32:35], a[160:163], v[24:27]
  v_exp_f32 v73, v73
  v_mfma_f32_16x16x32_bf16 v[120:123], a[32:35], a[176:179], v[28:31]
  v_exp_f32 v74, v74
  v_mfma_f32_16x16x32_bf16 v[112:115], a[36:39], a[164:167], v[112:115]
  ds_read_b128 a[12:15], v4 offset:11264
  ds_read_b128 a[16:19], v4 offset:12288
  v_mfma_f32_16x16x32_bf16 v[120:123], a[36:39], a[180:183], v[120:123]
  v_exp_f32 v75, v75
  v_mfma_f32_16x16x32_bf16 v[112:115], a[40:43], a[168:171], v[112:115]
  ds_read_b128 a[20:23], v4 offset:13312
  v_cvt_pk_bf16_f32 v36, v72, v73
  v_mfma_f32_16x16x32_bf16 v[120:123], a[40:43], a[184:187], v[120:123]
  v_exp_f32 v76, v76
  v_mfma_f32_16x16x32_bf16 v[112:115], a[44:47], a[172:175], v[112:115]
  ds_read_b128 a[24:27], v4 offset:14336
  v_cvt_pk_bf16_f32 v37, v74, v75
  v_mfma_f32_16x16x32_bf16 v[120:123], a[44:47], a[188:191], v[120:123]
  v_exp_f32 v77, v77
  v_mfma_f32_16x16x32_bf16 v[116:119], a[48:51], a[160:163], v[24:27]
  v_exp_f32 v78, v78
  v_mfma_f32_16x16x32_bf16 v[124:127], a[48:51], a[176:179], v[28:31]
  ds_read_b128 a[28:31], v4 offset:15360
  v_xor_b32 v4, 0x8000, v4
  v_mfma_f32_16x16x32_bf16 v[116:119], a[52:55], a[164:167], v[116:119]
  v_exp_f32 v79, v79
  v_mfma_f32_16x16x32_bf16 v[124:127], a[52:55], a[180:183], v[124:127]
  v_xor_b32 v3, 0x8000, v3
  v_cvt_pk_bf16_f32 v38, v76, v77
  v_mfma_f32_16x16x32_bf16 v[116:119], a[56:59], a[168:171], v[116:119]
  v_exp_f32 v80, v80
  v_mfma_f32_16x16x32_bf16 v[124:127], a[56:59], a[184:187], v[124:127]
  buffer_load_dwordx4 v2, s[20:23], s28 offen offset:2048 lds
  ds_read_b128 a[32:35], v3 offset:0
  v_mfma_f32_16x16x32_bf16 v[116:119], a[60:63], a[172:175], v[116:119]
  v_exp_f32 v81, v81
  v_mfma_f32_16x16x32_bf16 v[124:127], a[60:63], a[188:191], v[124:127]
  s_waitcnt lgkmcnt(5)
  ds_read_b128 a[36:39], v3 offset:1024
  ds_read_b128 a[40:43], v3 offset:2048
  v_mfma_f32_16x16x32_bf16 v[160:163], a[0:3], v[52:55], v[160:163]
  v_exp_f32 v82, v82
  v_mfma_f32_16x16x32_bf16 v[192:195], a[0:3], v[56:59], v[192:195]
  v_exp_f32 v83, v83
  v_mfma_f32_16x16x32_bf16 v[224:227], a[0:3], v[60:63], v[224:227]
  ds_read_b128 a[44:47], v3 offset:3072
  v_cvt_pk_bf16_f32 v39, v78, v79
  v_mfma_f32_16x16x32_bf16 a[196:199], a[208:211], v[52:55], a[196:199]
  v_exp_f32 v84, v84
  v_mfma_f32_16x16x32_bf16 v[164:167], a[4:7], v[52:55], v[164:167]
  ds_read_b128 a[48:51], v3 offset:4096
  v_cvt_pk_bf16_f32 v40, v80, v81
  v_mfma_f32_16x16x32_bf16 v[196:199], a[4:7], v[56:59], v[196:199]
  v_exp_f32 v85, v85
  v_mfma_f32_16x16x32_bf16 v[228:231], a[4:7], v[60:63], v[228:231]
  v_cvt_pk_bf16_f32 v41, v82, v83
  v_cvt_pk_bf16_f32 v42, v84, v85
  v_mfma_f32_16x16x32_bf16 a[200:203], a[208:211], v[56:59], a[200:203]
  v_exp_f32 v86, v86
  v_mfma_f32_16x16x32_bf16 v[168:171], a[8:11], v[52:55], v[168:171]
  v_exp_f32 v87, v87
  v_mfma_f32_16x16x32_bf16 v[200:203], a[8:11], v[56:59], v[200:203]
  ds_read_b128 a[52:55], v3 offset:5120
  v_cvt_pk_bf16_f32 v43, v86, v87
  v_mfma_f32_16x16x32_bf16 v[232:235], a[8:11], v[60:63], v[232:235]
  v_exp_f32 v88, v88
  v_mfma_f32_16x16x32_bf16 a[204:207], a[208:211], v[60:63], a[204:207]
  buffer_load_dwordx4 v2, s[20:23], s28 offen offset:3072 lds
  v_mfma_f32_16x16x32_bf16 v[172:175], a[12:15], v[52:55], v[172:175]
  s_xor_b32 s26, s26, 0x4000
  v_exp_f32 v89, v89
  v_mfma_f32_16x16x32_bf16 v[204:207], a[12:15], v[56:59], v[204:207]
  s_add_u32 s28, s28, 0x8000
  ds_read_b128 a[56:59], v3 offset:6144
  v_cvt_pk_bf16_f32 v44, v88, v89
  v_mfma_f32_16x16x32_bf16 v[236:239], a[12:15], v[60:63], v[236:239]
  s_waitcnt lgkmcnt(7)
  v_exp_f32 v90, v90
  v_mfma_f32_16x16x32_bf16 v[176:179], a[16:19], v[52:55], v[176:179]
  ds_read_b128 a[60:63], v3 offset:7168
  v_mfma_f32_16x16x32_bf16 v[208:211], a[16:19], v[56:59], v[208:211]
  v_exp_f32 v91, v91
  v_mfma_f32_16x16x32_bf16 v[240:243], a[16:19], v[60:63], v[240:243]
  v_exp_f32 v92, v92
  v_mfma_f32_16x16x32_bf16 v[180:183], a[20:23], v[52:55], v[180:183]
  ds_read_b128 a[0:3], v3 offset:8192
  v_cvt_pk_bf16_f32 v45, v90, v91
  v_mfma_f32_16x16x32_bf16 v[212:215], a[20:23], v[56:59], v[212:215]
  v_exp_f32 v93, v93
  v_mfma_f32_16x16x32_bf16 v[244:247], a[20:23], v[60:63], v[244:247]
  v_cvt_pk_bf16_f32 v46, v92, v93
  v_mfma_f32_16x16x32_bf16 v[184:187], a[24:27], v[52:55], v[184:187]
  v_exp_f32 v94, v94
  v_mfma_f32_16x16x32_bf16 v[216:219], a[24:27], v[56:59], v[216:219]
  ds_read_b128 a[4:7], v3 offset:9216
  v_mfma_f32_16x16x32_bf16 v[248:251], a[24:27], v[60:63], v[248:251]
  v_exp_f32 v95, v95
  v_mfma_f32_16x16x32_bf16 v[188:191], a[28:31], v[52:55], v[188:191]
  ds_read_b128 a[8:11], v3 offset:10240
  v_cvt_pk_bf16_f32 v47, v94, v95
  v_mfma_f32_16x16x32_bf16 v[220:223], a[28:31], v[56:59], v[220:223]
  v_mfma_f32_16x16x32_bf16 v[252:255], a[28:31], v[60:63], v[252:255]
  s_lshl_b32 s4, s25, 20
  s_lshl_b32 s5, s24, 15
  s_add_u32 s4, s4, s5
  s_lshl_b32 s5, s3, 11
  s_add_u32 s4, s4, s5
  v_accvgpr_read_b32 v6, a192
  v_accvgpr_read_b32 v8, a196
  s_mov_b32 s5, 0x5f800000
  v_cmp_ngt_f32 vcc, s5, v6
  v_rcp_f32 v6, v6
  s_or_b32 s89, s89, vcc_lo
  s_or_b32 s89, s89, vcc_hi
  v_mov_b32 v7, v6
  v_cmp_ngt_f32 vcc, s5, v8
  v_rcp_f32 v8, v8
  s_or_b32 s89, s89, vcc_lo
  s_or_b32 s89, s89, vcc_hi
  v_mov_b32 v9, v8
  v_pk_mul_f32 v[128:129], v[128:129], v[6:7]
  v_pk_mul_f32 v[130:131], v[130:131], v[6:7]
  v_pk_mul_f32 v[132:133], v[132:133], v[6:7]
  v_pk_mul_f32 v[134:135], v[134:135], v[6:7]
  v_cvt_pk_bf16_f32 v128, v128, v129
  v_cvt_pk_bf16_f32 v129, v130, v131
  v_cvt_pk_bf16_f32 v130, v132, v133
  v_cvt_pk_bf16_f32 v131, v134, v135
  buffer_store_dwordx4 v[128:131], v2, s[16:19], s4 offen offset:0
  v_pk_mul_f32 v[160:161], v[160:161], v[8:9]
  v_pk_mul_f32 v[162:163], v[162:163], v[8:9]
  v_pk_mul_f32 v[164:165], v[164:165], v[8:9]
  v_pk_mul_f32 v[166:167], v[166:167], v[8:9]
  v_cvt_pk_bf16_f32 v160, v160, v161
  v_cvt_pk_bf16_f32 v161, v162, v163
  v_cvt_pk_bf16_f32 v162, v164, v165
  v_cvt_pk_bf16_f32 v163, v166, v167
  buffer_store_dwordx4 v[160:163], v2, s[16:19], s4 offen offset:1024
  s_add_u32 s4, s4, 8192
  v_pk_mul_f32 v[136:137], v[136:137], v[6:7]
  v_pk_mul_f32 v[138:139], v[138:139], v[6:7]
  v_pk_mul_f32 v[140:141], v[140:141], v[6:7]
  v_pk_mul_f32 v[142:143], v[142:143], v[6:7]
  v_cvt_pk_bf16_f32 v136, v136, v137
  v_cvt_pk_bf16_f32 v137, v138, v139
  v_cvt_pk_bf16_f32 v138, v140, v141
  v_cvt_pk_bf16_f32 v139, v142, v143
  buffer_store_dwordx4 v[136:139], v2, s[16:19], s4 offen offset:0
  v_pk_mul_f32 v[168:169], v[168:169], v[8:9]
  v_pk_mul_f32 v[170:171], v[170:171], v[8:9]
  v_pk_mul_f32 v[172:173], v[172:173], v[8:9]
  v_pk_mul_f32 v[174:175], v[174:175], v[8:9]
  v_cvt_pk_bf16_f32 v168, v168, v169
  v_cvt_pk_bf16_f32 v169, v170, v171
  v_cvt_pk_bf16_f32 v170, v172, v173
  v_cvt_pk_bf16_f32 v171, v174, v175
  buffer_store_dwordx4 v[168:171], v2, s[16:19], s4 offen offset:1024
  s_add_u32 s4, s4, 8192
  v_pk_mul_f32 v[144:145], v[144:145], v[6:7]
  v_pk_mul_f32 v[146:147], v[146:147], v[6:7]
  v_pk_mul_f32 v[148:149], v[148:149], v[6:7]
  v_pk_mul_f32 v[150:151], v[150:151], v[6:7]
  v_cvt_pk_bf16_f32 v144, v144, v145
  v_cvt_pk_bf16_f32 v145, v146, v147
  v_cvt_pk_bf16_f32 v146, v148, v149
  v_cvt_pk_bf16_f32 v147, v150, v151
  buffer_store_dwordx4 v[144:147], v2, s[16:19], s4 offen offset:0
  v_pk_mul_f32 v[176:177], v[176:177], v[8:9]
  v_pk_mul_f32 v[178:179], v[178:179], v[8:9]
  v_pk_mul_f32 v[180:181], v[180:181], v[8:9]
  v_pk_mul_f32 v[182:183], v[182:183], v[8:9]
  v_cvt_pk_bf16_f32 v176, v176, v177
  v_cvt_pk_bf16_f32 v177, v178, v179
  v_cvt_pk_bf16_f32 v178, v180, v181
  v_cvt_pk_bf16_f32 v179, v182, v183
  buffer_store_dwordx4 v[176:179], v2, s[16:19], s4 offen offset:1024
  s_add_u32 s4, s4, 8192
  v_pk_mul_f32 v[152:153], v[152:153], v[6:7]
  v_pk_mul_f32 v[154:155], v[154:155], v[6:7]
  v_pk_mul_f32 v[156:157], v[156:157], v[6:7]
  v_pk_mul_f32 v[158:159], v[158:159], v[6:7]
  v_cvt_pk_bf16_f32 v152, v152, v153
  v_cvt_pk_bf16_f32 v153, v154, v155
  v_cvt_pk_bf16_f32 v154, v156, v157
  v_cvt_pk_bf16_f32 v155, v158, v159
  buffer_store_dwordx4 v[152:155], v2, s[16:19], s4 offen offset:0
  v_pk_mul_f32 v[184:185], v[184:185], v[8:9]
  v_pk_mul_f32 v[186:187], v[186:187], v[8:9]
  v_pk_mul_f32 v[188:189], v[188:189], v[8:9]
  v_pk_mul_f32 v[190:191], v[190:191], v[8:9]
  v_cvt_pk_bf16_f32 v184, v184, v185
  v_cvt_pk_bf16_f32 v185, v186, v187
  v_cvt_pk_bf16_f32 v186, v188, v189
  v_cvt_pk_bf16_f32 v187, v190, v191
  buffer_store_dwordx4 v[184:187], v2, s[16:19], s4 offen offset:1024
  s_lshl_b32 s88, s25, 1
  s_sub_u32 s88, 14, s88
  .p2align 6
La_so:
  s_waitcnt vmcnt(12)
  s_barrier
  s_waitcnt lgkmcnt(3)
  v_mfma_f32_16x16x32_bf16 v[64:67], a[32:35], a[160:163], v[24:27]
  s_mov_b32 m0, s26
  v_exp_f32 v96, v96
  v_mfma_f32_16x16x32_bf16 v[72:75], a[32:35], a[176:179], v[28:31]
  buffer_load_dwordx4 v2, s[20:23], s28 offen offset:0 lds
  ds_read_b128 a[12:15], v3 offset:11264
  v_mfma_f32_16x16x32_bf16 v[64:67], a[36:39], a[164:167], v[64:67]
  v_exp_f32 v97, v97
  v_mfma_f32_16x16x32_bf16 v[72:75], a[36:39], a[180:183], v[72:75]
  ds_read_b128 a[16:19], v3 offset:12288
  v_cvt_pk_bf16_f32 v48, v96, v97
  v_mfma_f32_16x16x32_bf16 v[64:67], a[40:43], a[168:171], v[64:67]
  v_exp_f32 v98, v98
  v_mfma_f32_16x16x32_bf16 v[72:75], a[40:43], a[184:187], v[72:75]
  ds_read_b128 a[20:23], v3 offset:13312
  v_mfma_f32_16x16x32_bf16 v[64:67], a[44:47], a[172:175], v[64:67]
  v_exp_f32 v99, v99
  v_mfma_f32_16x16x32_bf16 v[72:75], a[44:47], a[188:191], v[72:75]
  ds_read_b128 a[24:27], v3 offset:14336
  v_cvt_pk_bf16_f32 v49, v98, v99
  v_mfma_f32_16x16x32_bf16 v[68:71], a[48:51], a[160:163], v[24:27]
  v_exp_f32 v100, v100
  v_mfma_f32_16x16x32_bf16 v[76:79], a[48:51], a[176:179], v[28:31]
  buffer_load_dwordx4 v2, s[20:23], s28 offen offset:1024 lds
  ds_read_b128 a[28:31], v3 offset:15360
  v_mfma_f32_16x16x32_bf16 v[68:71], a[52:55], a[164:167], v[68:71]
  v_exp_f32 v101, v101
  v_mfma_f32_16x16x32_bf16 v[76:79], a[52:55], a[180:183], v[76:79]
  ds_read_b128 a[32:35], v4 offset:0
  v_cvt_pk_bf16_f32 v50, v100, v101
  v_mfma_f32_16x16x32_bf16 v[68:71], a[56:59], a[168:171], v[68:71]
  v_exp_f32 v102, v102
  v_mfma_f32_16x16x32_bf16 v[76:79], a[56:59], a[184:187], v[76:79]
  ds_read_b128 a[36:39], v4 offset:1024
  v_mfma_f32_16x16x32_bf16 v[68:71], a[60:63], a[172:175], v[68:71]
  v_exp_f32 v103, v103
  v_mfma_f32_16x16x32_bf16 v[76:79], a[60:63], a[188:191], v[76:79]
  s_waitcnt lgkmcnt(2)
  ds_read_b128 a[40:43], v4 offset:2048
  v_cvt_pk_bf16_f32 v51, v102, v103
  v_mfma_f32_16x16x32_bf16 v[80:83], a[0:3], a[160:163], v[24:27]
  v_exp_f32 v104, v104
  v_mfma_f32_16x16x32_bf16 v[88:91], a[0:3], a[176:179], v[28:31]
  buffer_load_dwordx4 v2, s[20:23], s28 offen offset:2048 lds
  ds_read_b128 a[44:47], v4 offset:3072
  v_mfma_f32_16x16x32_bf16 v[80:83], a[4:7], a[164:167], v[80:83]
  v_exp_f32 v105, v105
  v_mfma_f32_16x16x32_bf16 v[88:91], a[4:7], a[180:183], v[88:91]
  ds_read_b128 a[48:51], v4 offset:4096
  v_cvt_pk_bf16_f32 v52, v104, v105
  v_mfma_f32_16x16x32_bf16 v[80:83], a[8:11], a[168:171], v[80:83]
  v_exp_f32 v106, v106
  v_mfma_f32_16x16x32_bf16 v[88:91], a[8:11], a[184:187], v[88:91]
  ds_read_b128 a[52:55], v4 offset:5120
  v_mfma_f32_16x16x32_bf16 v[80:83], a[12:15], a[172:175], v[80:83]
  v_exp_f32 v107, v107
  v_mfma_f32_16x16x32_bf16 v[88:91], a[12:15], a[188:191], v[88:91]
  ds_read_b128 a[56:59], v4 offset:6144
  v_cvt_pk_bf16_f32 v53, v106, v107
  v_mfma_f32_16x16x32_bf16 v[84:87], a[16:19], a[160:163], v[24:27]
  v_exp_f32 v108, v108
  v_mfma_f32_16x16x32_bf16 v[92:95], a[16:19], a[176:179], v[28:31]
  buffer_load_dwordx4 v2, s[20:23], s28 offen offset:3072 lds
  ds_read_b128 a[60:63], v4 offset:7168
  v_mfma_f32_16x16x32_bf16 v[84:87], a[20:23], a[164:167], v[84:87]
  s_xor_b32 s26, s26, 0x8000
  v_exp_f32 v109, v109
  v_mfma_f32_16x16x32_bf16 v[92:95], a[20:23], a[180:183], v[92:95]
  s_add_u32 s28, s28, 0x8000
  s_mov_b32 m0, s27
  ds_read_b128 a[0:3], v4 offset:8192
  v_mfma_f32_16x16x32_bf16 v[84:87], a[24:27], a[168:171], v[84:87]
  v_exp_f32 v110, v110
  v_mfma_f32_16x16x32_bf16 v[92:95], a[24:27], a[184:187], v[92:95]
  ds_read_b128 a[4:7], v4 offset:9216
  v_cvt_pk_bf16_f32 v54, v108, v109
  v_mfma_f32_16x16x32_bf16 v[84:87], a[28:31], a[172:175], v[84:87]
  v_exp_f32 v111, v111
  v_mfma_f32_16x16x32_bf16 v[92:95], a[28:31], a[188:191], v[92:95]
  s_waitcnt lgkmcnt(2)
  ds_read_b128 a[8:11], v4 offset:10240
  v_cvt_pk_bf16_f32 v55, v110, v111
  v_mfma_f32_16x16x32_bf16 v[192:195], a[32:35], v[32:35], v[192:195]
  ds_read_b128 a[12:15], v4 offset:11264
  v_mfma_f32_16x16x32_bf16 v[224:227], a[32:35], v[36:39], v[224:227]
  v_exp_f32 v112, v112
  v_mfma_f32_16x16x32_bf16 a[200:203], a[208:211], v[32:35], a[200:203]
  s_sub_u32 s88, s88, 1
  buffer_load_dwordx4 v2, s[20:23], s29 offen offset:0 lds
  v_mfma_f32_16x16x32_bf16 v[196:199], a[36:39], v[32:35], v[196:199]
  v_exp_f32 v113, v113
  v_mfma_f32_16x16x32_bf16 v[228:231], a[36:39], v[36:39], v[228:231]
  ds_read_b128 a[16:19], v4 offset:12288
  v_cvt_pk_bf16_f32 v56, v112, v113
  v_mfma_f32_16x16x32_bf16 a[204:207], a[208:211], v[36:39], a[204:207]
  v_exp_f32 v114, v114
  v_mfma_f32_16x16x32_bf16 v[200:203], a[40:43], v[32:35], v[200:203]
  ds_read_b128 a[20:23], v4 offset:13312
  v_mfma_f32_16x16x32_bf16 v[232:235], a[40:43], v[36:39], v[232:235]
  v_exp_f32 v115, v115
  v_mfma_f32_16x16x32_bf16 v[204:207], a[44:47], v[32:35], v[204:207]
  ds_read_b128 a[24:27], v4 offset:14336
  v_cvt_pk_bf16_f32 v57, v114, v115
  v_mfma_f32_16x16x32_bf16 v[236:239], a[44:47], v[36:39], v[236:239]
  v_exp_f32 v116, v116
  v_mfma_f32_16x16x32_bf16 v[208:211], a[48:51], v[32:35], v[208:211]
  buffer_load_dwordx4 v2, s[20:23], s29 offen offset:1024 lds
  ds_read_b128 a[28:31], v4 offset:15360
  v_mfma_f32_16x16x32_bf16 v[240:243], a[48:51], v[36:39], v[240:243]
  v_exp_f32 v117, v117
  v_mfma_f32_16x16x32_bf16 v[212:215], a[52:55], v[32:35], v[212:215]
  v_xor_b32 v4, 0x4000, v4
  v_xor_b32 v3, 0x4000, v3
  v_mfma_f32_16x16x32_bf16 v[244:247], a[52:55], v[36:39], v[244:247]
  v_exp_f32 v118, v118
  v_mfma_f32_16x16x32_bf16 v[216:219], a[56:59], v[32:35], v[216:219]
  ds_read_b128 a[32:35], v3 offset:0
  ds_read_b128 a[36:39], v3 offset:1024
  v_mfma_f32_16x16x32_bf16 v[248:251], a[56:59], v[36:39], v[248:251]
  v_exp_f32 v119, v119
  v_mfma_f32_16x16x32_bf16 v[220:223], a[60:63], v[32:35], v[220:223]
  ds_read_b128 a[40:43], v3 offset:2048
  v_cvt_pk_bf16_f32 v58, v116, v117
  v_mfma_f32_16x16x32_bf16 v[252:255], a[60:63], v[36:39], v[252:255]
  s_waitcnt lgkmcnt(3)
  v_exp_f32 v120, v120
  v_mfma_f32_16x16x32_bf16 v[192:195], a[0:3], v[40:43], v[192:195]
  buffer_load_dwordx4 v2, s[20:23], s29 offen offset:2048 lds
  ds_read_b128 a[44:47], v3 offset:3072
  v_mfma_f32_16x16x32_bf16 v[224:227], a[0:3], v[44:47], v[224:227]
  v_exp_f32 v121, v121
  v_mfma_f32_16x16x32_bf16 a[200:203], a[208:211], v[40:43], a[200:203]
  v_cvt_pk_bf16_f32 v59, v118, v119
  v_cvt_pk_bf16_f32 v60, v120, v121
  v_mfma_f32_16x16x32_bf16 v[196:199], a[4:7], v[40:43], v[196:199]
  v_exp_f32 v122, v122
  v_mfma_f32_16x16x32_bf16 v[228:231], a[4:7], v[44:47], v[228:231]
  ds_read_b128 a[48:51], v3 offset:4096
  v_mfma_f32_16x16x32_bf16 a[204:207], a[208:211], v[44:47], a[204:207]
  v_exp_f32 v123, v123
  v_mfma_f32_16x16x32_bf16 v[200:203], a[8:11], v[40:43], v[200:203]
  ds_read_b128 a[52:55], v3 offset:5120
  v_cvt_pk_bf16_f32 v61, v122, v123
  v_mfma_f32_16x16x32_bf16 v[232:235], a[8:11], v[44:47], v[232:235]
  v_exp_f32 v124, v124
  v_mfma_f32_16x16x32_bf16 v[204:207], a[12:15], v[40:43], v[204:207]
  buffer_load_dwordx4 v2, s[20:23], s29 offen offset:3072 lds
  ds_read_b128 a[56:59], v3 offset:6144
  v_mfma_f32_16x16x32_bf16 v[236:239], a[12:15], v[44:47], v[236:239]
  s_xor_b32 s27, s27, 0x8000
  v_exp_f32 v125, v125
  v_mfma_f32_16x16x32_bf16 v[208:211], a[16:19], v[40:43], v[208:211]
  s_add_u32 s29, s29, 0x8000
  ds_read_b128 a[60:63], v3 offset:7168
  v_cvt_pk_bf16_f32 v62, v124, v125
  v_mfma_f32_16x16x32_bf16 v[240:243], a[16:19], v[44:47], v[240:243]
  v_exp_f32 v126, v126
  v_mfma_f32_16x16x32_bf16 v[212:215], a[20:23], v[40:43], v[212:215]
  ds_read_b128 a[0:3], v3 offset:8192
  v_mfma_f32_16x16x32_bf16 v[244:247], a[20:23], v[44:47], v[244:247]
  v_exp_f32 v127, v127
  v_mfma_f32_16x16x32_bf16 v[216:219], a[24:27], v[40:43], v[216:219]
  ds_read_b128 a[4:7], v3 offset:9216
  v_cvt_pk_bf16_f32 v63, v126, v127
  v_mfma_f32_16x16x32_bf16 v[248:251], a[24:27], v[44:47], v[248:251]
  v_mfma_f32_16x16x32_bf16 v[220:223], a[28:31], v[40:43], v[220:223]
  ds_read_b128 a[8:11], v3 offset:10240
  v_mfma_f32_16x16x32_bf16 v[252:255], a[28:31], v[44:47], v[252:255]
  s_cmp_eq_u32 s88, 0
  s_cbranch_scc1 La_e0
  s_waitcnt vmcnt(12)
  s_barrier
  s_waitcnt lgkmcnt(3)
  v_mfma_f32_16x16x32_bf16 v[96:99], a[32:35], a[160:163], v[24:27]
  s_mov_b32 m0, s26
  v_exp_f32 v64, v64
  v_mfma_f32_16x16x32_bf16 v[104:107], a[32:35], a[176:179], v[28:31]
  buffer_load_dwordx4 v2, s[20:23], s28 offen offset:0 lds
  ds_read_b128 a[12:15], v3 offset:11264
  v_mfma_f32_16x16x32_bf16 v[96:99], a[36:39], a[164:167], v[96:99]
  v_exp_f32 v65, v65
  v_mfma_f32_16x16x32_bf16 v[104:107], a[36:39], a[180:183], v[104:107]
  ds_read_b128 a[16:19], v3 offset:12288
  v_cvt_pk_bf16_f32 v32, v64, v65
  v_mfma_f32_16x16x32_bf16 v[96:99], a[40:43], a[168:171], v[96:99]
  v_exp_f32 v66, v66
  v_mfma_f32_16x16x32_bf16 v[104:107], a[40:43], a[184:187], v[104:107]
  ds_read_b128 a[20:23], v3 offset:13312
  v_mfma_f32_16x16x32_bf16 v[96:99], a[44:47], a[172:175], v[96:99]
  v_exp_f32 v67, v67
  v_mfma_f32_16x16x32_bf16 v[104:107], a[44:47], a[188:191], v[104:107]
  ds_read_b128 a[24:27], v3 offset:14336
  v_cvt_pk_bf16_f32 v33, v66, v67
  v_mfma_f32_16x16x32_bf16 v[100:103], a[48:51], a[160:163], v[24:27]
  v_exp_f32 v68, v68
  v_mfma_f32_16x16x32_bf16 v[108:111], a[48:51], a[176:179], v[28:31]
  buffer_load_dwordx4 v2, s[20:23], s28 offen offset:1024 lds
  ds_read_b128 a[28:31], v3 offset:15360
  v_mfma_f32_16x16x32_bf16 v[100:103], a[52:55], a[164:167], v[100:103]
  v_exp_f32 v69, v69
  v_mfma_f32_16x16x32_bf16 v[108:111], a[52:55], a[180:183], v[108:111]
  ds_read_b128 a[32:35], v4 offset:0
  v_cvt_pk_bf16_f32 v34, v68, v69
  v_mfma_f32_16x16x32_bf16 v[100:103], a[56:59], a[168:171], v[100:103]
  v_exp_f32 v70, v70
  v_mfma_f32_16x16x32_bf16 v[108:111], a[56:59], a[184:187], v[108:111]
  ds_read_b128 a[36:39], v4 offset:1024
  v_mfma_f32_16x16x32_bf16 v[100:103], a[60:63], a[172:175], v[100:103]
  v_exp_f32 v71, v71
  v_mfma_f32_16x16x32_bf16 v[108:111], a[60:63], a[188:191], v[108:111]
  s_waitcnt lgkmcnt(2)
  ds_read_b128 a[40:43], v4 offset:2048
  v_cvt_pk_bf16_f32 v35, v70, v71
  v_mfma_f32_16x16x32_bf16 v[112:115], a[0:3], a[160:163], v[24:27]
  v_exp_f32 v72, v72
  v_mfma_f32_16x16x32_bf16 v[120:123], a[0:3], a[176:179], v[28:31]
  buffer_load_dwordx4 v2, s[20:23], s28 offen offset:2048 lds
  ds_read_b128 a[44:47], v4 offset:3072
  v_mfma_f32_16x16x32_bf16 v[112:115], a[4:7], a[164:167], v[112:115]
  v_exp_f32 v73, v73
  v_mfma_f32_16x16x32_bf16 v[120:123], a[4:7], a[180:183], v[120:123]
  ds_read_b128 a[48:51], v4 offset:4096
  v_cvt_pk_bf16_f32 v36, v72, v73
  v_mfma_f32_16x16x32_bf16 v[112:115], a[8:11], a[168:171], v[112:115]
  v_exp_f32 v74, v74
  v_mfma_f32_16x16x32_bf16 v[120:123], a[8:11], a[184:187], v[120:123]
  ds_read_b128 a[52:55], v4 offset:5120
  v_mfma_f32_16x16x32_bf16 v[112:115], a[12:15], a[172:175], v[112:115]
  v_exp_f32 v75, v75
  v_mfma_f32_16x16x32_bf16 v[120:123], a[12:15], a[188:191], v[120:123]
  ds_read_b128 a[56:59], v4 offset:6144
  v_cvt_pk_bf16_f32 v37, v74, v75
  v_mfma_f32_16x16x32_bf16 v[116:119], a[16:19], a[160:163], v[24:27]
  v_exp_f32 v76, v76
  v_mfma_f32_16x16x32_bf16 v[124:127], a[16:19], a[176:179], v[28:31]
  buffer_load_dwordx4 v2, s[20:23], s28 offen offset:3072 lds
  ds_read_b128 a[60:63], v4 offset:7168
  v_mfma_f32_16x16x32_bf16 v[116:119], a[20:23], a[164:167], v[116:119]
  s_xor_b32 s26, s26, 0x4000
  v_exp_f32 v77, v77
  v_mfma_f32_16x16x32_bf16 v[124:127], a[20:23], a[180:183], v[124:127]
  s_add_u32 s28, s28, 0x8000
  s_mov_b32 m0, s27
  ds_read_b128 a[0:3], v4 offset:8192
  v_mfma_f32_16x16x32_bf16 v[116:119], a[24:27], a[168:171], v[116:119]
  v_exp_f32 v78, v78
  v_mfma_f32_16x16x32_bf16 v[124:127], a[24:27], a[184:187], v[124:127]
  ds_read_b128 a[4:7], v4 offset:9216
  v_cvt_pk_bf16_f32 v38, v76, v77
  v_mfma_f32_16x16x32_bf16 v[116:119], a[28:31], a[172:175], v[116:119]
  v_exp_f32 v79, v79
  v_mfma_f32_16x16x32_bf16 v[124:127], a[28:31], a[188:191], v[124:127]
  s_waitcnt lgkmcnt(2)
  ds_read_b128 a[8:11], v4 offset:10240
  v_cvt_pk_bf16_f32 v39, v78, v79
  v_mfma_f32_16x16x32_bf16 v[192:195], a[32:35], v[48:51], v[192:195]
  ds_read_b128 a[12:15], v4 offset:11264
  v_mfma_f32_16x16x32_bf16 v[224:227], a[32:35], v[52:55], v[224:227]
  v_exp_f32 v80, v80
  v_mfma_f32_16x16x32_bf16 a[200:203], a[208:211], v[48:51], a[200:203]
  buffer_load_dwordx4 v2, s[20:23], s29 offen offset:0 lds
  v_mfma_f32_16x16x32_bf16 v[196:199], a[36:39], v[48:51], v[196:199]
  v_exp_f32 v81, v81
  v_mfma_f32_16x16x32_bf16 v[228:231], a[36:39], v[52:55], v[228:231]
  ds_read_b128 a[16:19], v4 offset:12288
  v_cvt_pk_bf16_f32 v40, v80, v81
  v_mfma_f32_16x16x32_bf16 a[204:207], a[208:211], v[52:55], a[204:207]
  v_exp_f32 v82, v82
  v_mfma_f32_16x16x32_bf16 v[200:203], a[40:43], v[48:51], v[200:203]
  ds_read_b128 a[20:23], v4 offset:13312
  v_mfma_f32_16x16x32_bf16 v[232:235], a[40:43], v[52:55], v[232:235]
  v_exp_f32 v83, v83
  v_mfma_f32_16x16x32_bf16 v[204:207], a[44:47], v[48:51], v[204:207]
  ds_read_b128 a[24:27], v4 offset:14336
  v_cvt_pk_bf16_f32 v41, v82, v83
  v_mfma_f32_16x16x32_bf16 v[236:239], a[44:47], v[52:55], v[236:239]
  v_exp_f32 v84, v84
  v_mfma_f32_16x16x32_bf16 v[208:211], a[48:51], v[48:51], v[208:211]
  buffer_load_dwordx4 v2, s[20:23], s29 offen offset:1024 lds
  ds_read_b128 a[28:31], v4 offset:15360
  v_mfma_f32_16x16x32_bf16 v[240:243], a[48:51], v[52:55], v[240:243]
  v_exp_f32 v85, v85
  v_mfma_f32_16x16x32_bf16 v[212:215], a[52:55], v[48:51], v[212:215]
  v_xor_b32 v4, 0x8000, v4
  v_xor_b32 v3, 0x8000, v3
  v_mfma_f32_16x16x32_bf16 v[244:247], a[52:55], v[52:55], v[244:247]
  v_exp_f32 v86, v86
  v_mfma_f32_16x16x32_bf16 v[216:219], a[56:59], v[48:51], v[216:219]
  ds_read_b128 a[32:35], v3 offset:0
  ds_read_b128 a[36:39], v3 offset:1024
  v_mfma_f32_16x16x32_bf16 v[248:251], a[56:59], v[52:55], v[248:251]
  v_exp_f32 v87, v87
  v_mfma_f32_16x16x32_bf16 v[220:223], a[60:63], v[48:51], v[220:223]
  ds_read_b128 a[40:43], v3 offset:2048
  v_cvt_pk_bf16_f32 v42, v84, v85
  v_mfma_f32_16x16x32_bf16 v[252:255], a[60:63], v[52:55], v[252:255]
  s_waitcnt lgkmcnt(3)
  v_exp_f32 v88, v88
  v_mfma_f32_16x16x32_bf16 v[192:195], a[0:3], v[56:59], v[192:195]
  buffer_load_dwordx4 v2, s[20:23], s29 offen offset:2048 lds
  ds_read_b128 a[44:47], v3 offset:3072
  v_mfma_f32_16x16x32_bf16 v[224:227], a[0:3], v[60:63], v[224:227]
  v_exp_f32 v89, v89
  v_mfma_f32_16x16x32_bf16 a[200:203], a[208:211], v[56:59], a[200:203]
  v_cvt_pk_bf16_f32 v43, v86, v87
  v_cvt_pk_bf16_f32 v44, v88, v89
  v_mfma_f32_16x16x32_bf16 v[196:199], a[4:7], v[56:59], v[196:199]
  v_exp_f32 v90, v90
  v_mfma_f32_16x16x32_bf16 v[228:231], a[4:7], v[60:63], v[228:231]
  ds_read_b128 a[48:51], v3 offset:4096
  v_mfma_f32_16x16x32_bf16 a[204:207], a[208:211], v[60:63], a[204:207]
  v_exp_f32 v91, v91
  v_mfma_f32_16x16x32_bf16 v[200:203], a[8:11], v[56:59], v[200:203]
  ds_read_b128 a[52:55], v3 offset:5120
  v_cvt_pk_bf16_f32 v45, v90, v91
  v_mfma_f32_16x16x32_bf16 v[232:235], a[8:11], v[60:63], v[232:235]
  v_exp_f32 v92, v92
  v_mfma_f32_16x16x32_bf16 v[204:207], a[12:15], v[56:59], v[204:207]
  buffer_load_dwordx4 v2, s[20:23], s29 offen offset:3072 lds
  ds_read_b128 a[56:59], v3 offset:6144
  v_mfma_f32_16x16x32_bf16 v[236:239], a[12:15], v[60:63], v[236:239]
  s_xor_b32 s27, s27, 0x4000
  v_exp_f32 v93, v93
  v_mfma_f32_16x16x32_bf16 v[208:211], a[16:19], v[56:59], v[208:211]
  s_add_u32 s29, s29, 0x8000
  ds_read_b128 a[60:63], v3 offset:7168
  v_cvt_pk_bf16_f32 v46, v92, v93
  v_mfma_f32_16x16x32_bf16 v[240:243], a[16:19], v[60:63], v[240:243]
  v_exp_f32 v94, v94
  v_mfma_f32_16x16x32_bf16 v[212:215], a[20:23], v[56:59], v[212:215]
  ds_read_b128 a[0:3], v3 offset:8192
  v_mfma_f32_16x16x32_bf16 v[244:247], a[20:23], v[60:63], v[244:247]
  v_exp_f32 v95, v95
  v_mfma_f32_16x16x32_bf16 v[216:219], a[24:27], v[56:59], v[216:219]
  ds_read_b128 a[4:7], v3 offset:9216
  v_cvt_pk_bf16_f32 v47, v94, v95
  v_mfma_f32_16x16x32_bf16 v[248:251], a[24:27], v[60:63], v[248:251]
  v_mfma_f32_16x16x32_bf16 v[220:223], a[28:31], v[56:59], v[220:223]
  ds_read_b128 a[8:11], v3 offset:10240
  v_mfma_f32_16x16x32_bf16 v[252:255], a[28:31], v[60:63], v[252:255]
  s_branch La_so
La_t7:
  s_waitcnt vmcnt(26)
  s_barrier
  s_waitcnt lgkmcnt(7)
  v_mfma_f32_16x16x32_bf16 v[104:107], a[0:3], a[176:179], v[28:31]
  ds_read_b128 a[44:47], v3 offset:11264
  v_cndmask_b32 v64, v64, v5, s[32:33]
  v_mfma_f32_16x16x32_bf16 v[104:107], a[4:7], a[180:183], v[104:107]
  v_exp_f32 v64, v64
  v_mfma_f32_16x16x32_bf16 v[104:107], a[8:11], a[184:187], v[104:107]
  v_cndmask_b32 v65, v65, v5, s[34:35]
  v_exp_f32 v65, v65
  v_mfma_f32_16x16x32_bf16 v[104:107], a[12:15], a[188:191], v[104:107]
  s_waitcnt lgkmcnt(4)
  v_cndmask_b32 v66, v66, v5, s[36:37]
  v_exp_f32 v66, v66
  v_mfma_f32_16x16x32_bf16 v[108:111], a[16:19], a[176:179], v[28:31]
  v_cndmask_b32 v67, v67, v5, s[38:39]
  v_exp_f32 v67, v67
  v_mfma_f32_16x16x32_bf16 v[108:111], a[20:23], a[180:183], v[108:111]
  v_cndmask_b32 v68, v68, v5, s[40:41]
  v_exp_f32 v68, v68
  v_mfma_f32_16x16x32_bf16 v[108:111], a[24:27], a[184:187], v[108:111]
  v_cndmask_b32 v69, v69, v5, s[42:43]
  v_exp_f32 v69, v69
  v_mfma_f32_16x16x32_bf16 v[108:111], a[28:31], a[188:191], v[108:111]
  s_waitcnt lgkmcnt(0)
  v_cndmask_b32 v70, v70, v5, s[44:45]
  v_exp_f32 v70, v70
  v_mfma_f32_16x16x32_bf16 v[120:123], a[32:35], a[176:179], v[28:31]
  v_cndmask_b32 v71, v71, v5, s[46:47]
  v_exp_f32 v71, v71
  v_mfma_f32_16x16x32_bf16 v[120:123], a[36:39], a[180:183], v[120:123]
  ds_read_b128 a[48:51], v3 offset:12288
  ds_read_b128 a[52:55], v3 offset:13312
  ds_read_b128 a[56:59], v3 offset:14336
  v_mfma_f32_16x16x32_bf16 v[120:123], a[40:43], a[184:187], v[120:123]
  ds_read_b128 a[60:63], v3 offset:15360
  v_exp_f32 v72, v72
  v_mfma_f32_16x16x32_bf16 v[120:123], a[44:47], a[188:191], v[120:123]
  s_waitcnt lgkmcnt(0)
  v_exp_f32 v73, v73
  v_cvt_pk_bf16_f32 v33, v66, v67
  v_mfma_f32_16x16x32_bf16 v[124:127], a[48:51], a[176:179], v[28:31]
  v_exp_f32 v74, v74
  v_cvt_pk_bf16_f32 v34, v68, v69
  v_mfma_f32_16x16x32_bf16 v[124:127], a[52:55], a[180:183], v[124:127]
  ds_read_b128 a[0:3], v4 offset:8192
  ds_read_b128 a[4:7], v4 offset:9216
  ds_read_b128 a[8:11], v4 offset:10240
  v_mfma_f32_16x16x32_bf16 v[124:127], a[56:59], a[184:187], v[124:127]
  ds_read_b128 a[12:15], v4 offset:11264
  v_exp_f32 v75, v75
  v_mfma_f32_16x16x32_bf16 v[124:127], a[60:63], a[188:191], v[124:127]
  s_waitcnt lgkmcnt(0)
  v_exp_f32 v76, v76
  v_cvt_pk_bf16_f32 v35, v70, v71
  v_mfma_f32_16x16x32_bf16 v[160:163], a[0:3], v[52:55], v[160:163]
  v_exp_f32 v77, v77
  v_cvt_pk_bf16_f32 v36, v72, v73
  v_mfma_f32_16x16x32_bf16 v[192:195], a[0:3], v[56:59], v[192:195]
  v_exp_f32 v78, v78
  v_cvt_pk_bf16_f32 v37, v74, v75
  v_mfma_f32_16x16x32_bf16 v[224:227], a[0:3], v[60:63], v[224:227]
  ds_read_b128 a[16:19], v4 offset:12288
  ds_read_b128 a[20:23], v4 offset:13312
  v_cvt_pk_bf16_f32 v38, v76, v77
  v_mfma_f32_16x16x32_bf16 a[196:199], a[208:211], v[52:55], a[196:199]
  v_exp_f32 v79, v79
  v_mfma_f32_16x16x32_bf16 v[164:167], a[4:7], v[52:55], v[164:167]
  v_cndmask_b32 v80, v80, v5, s[48:49]
  v_exp_f32 v80, v80
  v_cvt_pk_bf16_f32 v39, v78, v79
  v_mfma_f32_16x16x32_bf16 v[196:199], a[4:7], v[56:59], v[196:199]
  v_cndmask_b32 v81, v81, v5, s[50:51]
  v_exp_f32 v81, v81
  v_mfma_f32_16x16x32_bf16 v[228:231], a[4:7], v[60:63], v[228:231]
  ds_read_b128 a[24:27], v4 offset:14336
  ds_read_b128 a[28:31], v4 offset:15360
  v_cvt_pk_bf16_f32 v40, v80, v81
  v_mfma_f32_16x16x32_bf16 a[200:203], a[208:211], v[56:59], a[200:203]
  v_cndmask_b32 v82, v82, v5, s[52:53]
  v_exp_f32 v82, v82
  v_mfma_f32_16x16x32_bf16 v[168:171], a[8:11], v[52:55], v[168:171]
  v_cndmask_b32 v83, v83, v5, s[54:55]
  v_exp_f32 v83, v83
  v_mfma_f32_16x16x32_bf16 v[200:203], a[8:11], v[56:59], v[200:203]
  v_cndmask_b32 v84, v84, v5, s[56:57]
  v_exp_f32 v84, v84
  v_mfma_f32_16x16x32_bf16 v[232:235], a[8:11], v[60:63], v[232:235]
  v_cndmask_b32 v85, v85, v5, s[58:59]
  v_exp_f32 v85, v85
  v_mfma_f32_16x16x32_bf16 a[204:207], a[208:211], v[60:63], a[204:207]
  v_xor_b32 v4, 0x8000, v4
  v_cvt_pk_bf16_f32 v32, v64, v65
  v_cvt_pk_bf16_f32 v41, v82, v83
  v_mfma_f32_16x16x32_bf16 v[172:175], a[12:15], v[52:55], v[172:175]
  v_cndmask_b32 v86, v86, v5, s[60:61]
  v_exp_f32 v86, v86
  v_mfma_f32_16x16x32_bf16 v[204:207], a[12:15], v[56:59], v[204:207]
  v_cndmask_b32 v87, v87, v5, s[62:63]
  v_exp_f32 v87, v87
  v_mfma_f32_16x16x32_bf16 v[236:239], a[12:15], v[60:63], v[236:239]
  s_waitcnt lgkmcnt(0)
  v_exp_f32 v88, v88
  v_cvt_pk_bf16_f32 v42, v84, v85
  v_mfma_f32_16x16x32_bf16 v[176:179], a[16:19], v[52:55], v[176:179]
  ds_read_b128 a[32:35], v4 offset:0
  ds_read_b128 a[36:39], v4 offset:1024
  v_cvt_pk_bf16_f32 v43, v86, v87
  v_mfma_f32_16x16x32_bf16 v[208:211], a[16:19], v[56:59], v[208:211]
  v_exp_f32 v89, v89
  v_mfma_f32_16x16x32_bf16 v[240:243], a[16:19], v[60:63], v[240:243]
  v_exp_f32 v90, v90
  v_cvt_pk_bf16_f32 v44, v88, v89
  v_mfma_f32_16x16x32_bf16 v[180:183], a[20:23], v[52:55], v[180:183]
  v_exp_f32 v91, v91
  v_mfma_f32_16x16x32_bf16 v[212:215], a[20:23], v[56:59], v[212:215]
  v_exp_f32 v92, v92
  v_cvt_pk_bf16_f32 v45, v90, v91
  v_mfma_f32_16x16x32_bf16 v[244:247], a[20:23], v[60:63], v[244:247]
  ds_read_b128 a[40:43], v4 offset:2048
  ds_read_b128 a[44:47], v4 offset:3072
  v_mfma_f32_16x16x32_bf16 v[184:187], a[24:27], v[52:55], v[184:187]
  v_exp_f32 v93, v93
  v_mfma_f32_16x16x32_bf16 v[216:219], a[24:27], v[56:59], v[216:219]
  v_exp_f32 v94, v94
  v_cvt_pk_bf16_f32 v46, v92, v93
  v_mfma_f32_16x16x32_bf16 v[248:251], a[24:27], v[60:63], v[248:251]
  v_exp_f32 v95, v95
  v_mfma_f32_16x16x32_bf16 v[188:191], a[28:31], v[52:55], v[188:191]
  ds_read_b128 a[48:51], v4 offset:4096
  ds_read_b128 a[52:55], v4 offset:5120
  v_cvt_pk_bf16_f32 v47, v94, v95
  v_mfma_f32_16x16x32_bf16 v[220:223], a[28:31], v[56:59], v[220:223]
  ds_read_b128 a[56:59], v4 offset:6144
  ds_read_b128 a[60:63], v4 offset:7168
  v_mfma_f32_16x16x32_bf16 v[252:255], a[28:31], v[60:63], v[252:255]
  ds_read_b128 a[0:3], v4 offset:8192
  ds_read_b128 a[4:7], v4 offset:9216
  ds_read_b128 a[8:11], v4 offset:10240
  s_lshl_b32 s4, s25, 20
  s_lshl_b32 s5, s24, 15
  s_add_u32 s4, s4, s5
  s_lshl_b32 s5, s3, 11
  s_add_u32 s4, s4, s5
  v_accvgpr_read_b32 v6, a192
  v_accvgpr_read_b32 v8, a196
  s_mov_b32 s5, 0x5f800000
  v_cmp_ngt_f32 vcc, s5, v6
  v_rcp_f32 v6, v6
  s_or_b32 s89, s89, vcc_lo
  s_or_b32 s89, s89, vcc_hi
  v_mov_b32 v7, v6
  v_cmp_ngt_f32 vcc, s5, v8
  v_rcp_f32 v8, v8
  s_or_b32 s89, s89, vcc_lo
  s_or_b32 s89, s89, vcc_hi
  v_mov_b32 v9, v8
  v_pk_mul_f32 v[128:129], v[128:129], v[6:7]
  v_pk_mul_f32 v[130:131], v[130:131], v[6:7]
  v_pk_mul_f32 v[132:133], v[132:133], v[6:7]
  v_pk_mul_f32 v[134:135], v[134:135], v[6:7]
  v_cvt_pk_bf16_f32 v128, v128, v129
  v_cvt_pk_bf16_f32 v129, v130, v131
  v_cvt_pk_bf16_f32 v130, v132, v133
  v_cvt_pk_bf16_f32 v131, v134, v135
  buffer_store_dwordx4 v[128:131], v2, s[16:19], s4 offen offset:0
  v_pk_mul_f32 v[160:161], v[160:161], v[8:9]
  v_pk_mul_f32 v[162:163], v[162:163], v[8:9]
  v_pk_mul_f32 v[164:165], v[164:165], v[8:9]
  v_pk_mul_f32 v[166:167], v[166:167], v[8:9]
  v_cvt_pk_bf16_f32 v160, v160, v161
  v_cvt_pk_bf16_f32 v161, v162, v163
  v_cvt_pk_bf16_f32 v162, v164, v165
  v_cvt_pk_bf16_f32 v163, v166, v167
  buffer_store_dwordx4 v[160:163], v2, s[16:19], s4 offen offset:1024
  s_add_u32 s4, s4, 8192
  v_pk_mul_f32 v[136:137], v[136:137], v[6:7]
  v_pk_mul_f32 v[138:139], v[138:139], v[6:7]
  v_pk_mul_f32 v[140:141], v[140:141], v[6:7]
  v_pk_mul_f32 v[142:143], v[142:143], v[6:7]
  v_cvt_pk_bf16_f32 v136, v136, v137
  v_cvt_pk_bf16_f32 v137, v138, v139
  v_cvt_pk_bf16_f32 v138, v140, v141
  v_cvt_pk_bf16_f32 v139, v142, v143
  buffer_store_dwordx4 v[136:139], v2, s[16:19], s4 offen offset:0
  v_pk_mul_f32 v[168:169], v[168:169], v[8:9]
  v_pk_mul_f32 v[170:171], v[170:171], v[8:9]
  v_pk_mul_f32 v[172:173], v[172:173], v[8:9]
  v_pk_mul_f32 v[174:175], v[174:175], v[8:9]
  v_cvt_pk_bf16_f32 v168, v168, v169
  v_cvt_pk_bf16_f32 v169, v170, v171
  v_cvt_pk_bf16_f32 v170, v172, v173
  v_cvt_pk_bf16_f32 v171, v174, v175
  buffer_store_dwordx4 v[168:171], v2, s[16:19], s4 offen offset:1024
  s_add_u32 s4, s4, 8192
  v_pk_mul_f32 v[144:145], v[144:145], v[6:7]
  v_pk_mul_f32 v[146:147], v[146:147], v[6:7]
  v_pk_mul_f32 v[148:149], v[148:149], v[6:7]
  v_pk_mul_f32 v[150:151], v[150:151], v[6:7]
  v_cvt_pk_bf16_f32 v144, v144, v145
  v_cvt_pk_bf16_f32 v145, v146, v147
  v_cvt_pk_bf16_f32 v146, v148, v149
  v_cvt_pk_bf16_f32 v147, v150, v151
  buffer_store_dwordx4 v[144:147], v2, s[16:19], s4 offen offset:0
  v_pk_mul_f32 v[176:177], v[176:177], v[8:9]
  v_pk_mul_f32 v[178:179], v[178:179], v[8:9]
  v_pk_mul_f32 v[180:181], v[180:181], v[8:9]
  v_pk_mul_f32 v[182:183], v[182:183], v[8:9]
  v_cvt_pk_bf16_f32 v176, v176, v177
  v_cvt_pk_bf16_f32 v177, v178, v179
  v_cvt_pk_bf16_f32 v178, v180, v181
  v_cvt_pk_bf16_f32 v179, v182, v183
  buffer_store_dwordx4 v[176:179], v2, s[16:19], s4 offen offset:1024
  s_add_u32 s4, s4, 8192
  v_pk_mul_f32 v[152:153], v[152:153], v[6:7]
  v_pk_mul_f32 v[154:155], v[154:155], v[6:7]
  v_pk_mul_f32 v[156:157], v[156:157], v[6:7]
  v_pk_mul_f32 v[158:159], v[158:159], v[6:7]
  v_cvt_pk_bf16_f32 v152, v152, v153
  v_cvt_pk_bf16_f32 v153, v154, v155
  v_cvt_pk_bf16_f32 v154, v156, v157
  v_cvt_pk_bf16_f32 v155, v158, v159
  buffer_store_dwordx4 v[152:155], v2, s[16:19], s4 offen offset:0
  v_pk_mul_f32 v[184:185], v[184:185], v[8:9]
  v_pk_mul_f32 v[186:187], v[186:187], v[8:9]
  v_pk_mul_f32 v[188:189], v[188:189], v[8:9]
  v_pk_mul_f32 v[190:191], v[190:191], v[8:9]
  v_cvt_pk_bf16_f32 v184, v184, v185
  v_cvt_pk_bf16_f32 v185, v186, v187
  v_cvt_pk_bf16_f32 v186, v188, v189
  v_cvt_pk_bf16_f32 v187, v190, v191
  buffer_store_dwordx4 v[184:187], v2, s[16:19], s4 offen offset:1024
  s_branch La_e1
La_e0:
  s_waitcnt vmcnt(8)
  s_barrier
  s_waitcnt lgkmcnt(7)
  v_mfma_f32_16x16x32_bf16 v[104:107], a[32:35], a[176:179], v[28:31]
  ds_read_b128 a[12:15], v3 offset:11264
  v_cndmask_b32 v64, v64, v5, s[32:33]
  v_mfma_f32_16x16x32_bf16 v[104:107], a[36:39], a[180:183], v[104:107]
  v_exp_f32 v64, v64
  v_mfma_f32_16x16x32_bf16 v[104:107], a[40:43], a[184:187], v[104:107]
  v_cndmask_b32 v65, v65, v5, s[34:35]
  v_exp_f32 v65, v65
  v_mfma_f32_16x16x32_bf16 v[104:107], a[44:47], a[188:191], v[104:107]
  s_waitcnt lgkmcnt(4)
  v_cndmask_b32 v66, v66, v5, s[36:37]
  v_exp_f32 v66, v66
  v_mfma_f32_16x16x32_bf16 v[108:111], a[48:51], a[176:179], v[28:31]
  v_cndmask_b32 v67, v67, v5, s[38:39]
  v_exp_f32 v67, v67
  v_mfma_f32_16x16x32_bf16 v[108:111], a[52:55], a[180:183], v[108:111]
  ds_read_b128 a[16:19], v3 offset:12288
  ds_read_b128 a[20:23], v3 offset:13312
  v_mfma_f32_16x16x32_bf16 v[108:111], a[56:59], a[184:187], v[108:111]
  v_cndmask_b32 v68, v68, v5, s[40:41]
  v_exp_f32 v68, v68
  v_mfma_f32_16x16x32_bf16 v[108:111], a[60:63], a[188:191], v[108:111]
  s_waitcnt lgkmcnt(2)
  v_cndmask_b32 v69, v69, v5, s[42:43]
  v_exp_f32 v69, v69
  v_mfma_f32_16x16x32_bf16 v[120:123], a[0:3], a[176:179], v[28:31]
  ds_read_b128 a[24:27], v3 offset:14336
  ds_read_b128 a[28:31], v3 offset:15360
  v_mfma_f32_16x16x32_bf16 v[120:123], a[4:7], a[180:183], v[120:123]
  v_cndmask_b32 v70, v70, v5, s[44:45]
  v_exp_f32 v70, v70
  v_mfma_f32_16x16x32_bf16 v[120:123], a[8:11], a[184:187], v[120:123]
  v_cndmask_b32 v71, v71, v5, s[46:47]
  v_exp_f32 v71, v71
  v_mfma_f32_16x16x32_bf16 v[120:123], a[12:15], a[188:191], v[120:123]
  s_waitcnt lgkmcnt(0)
  ds_read_b128 a[32:35], v4 offset:0
  ds_read_b128 a[36:39], v4 offset:1024
  v_mfma_f32_16x16x32_bf16 v[124:127], a[16:19], a[176:179], v[28:31]
  v_exp_f32 v72, v72
  v_mfma_f32_16x16x32_bf16 v[124:127], a[20:23], a[180:183], v[124:127]
  ds_read_b128 a[40:43], v4 offset:2048
  ds_read_b128 a[44:47], v4 offset:3072
  ds_read_b128 a[48:51], v4 offset:4096
  v_mfma_f32_16x16x32_bf16 v[124:127], a[24:27], a[184:187], v[124:127]
  ds_read_b128 a[52:55], v4 offset:5120
  ds_read_b128 a[56:59], v4 offset:6144
  ds_read_b128 a[60:63], v4 offset:7168
  v_exp_f32 v73, v73
  v_mfma_f32_16x16x32_bf16 v[124:127], a[28:31], a[188:191], v[124:127]
  s_waitcnt lgkmcnt(0)
  v_exp_f32 v74, v74
  v_mfma_f32_16x16x32_bf16 v[192:195], a[32:35], v[48:51], v[192:195]
  ds_read_b128 a[0:3], v4 offset:8192
  ds_read_b128 a[4:7], v4 offset:9216
  v_mfma_f32_16x16x32_bf16 v[224:227], a[32:35], v[52:55], v[224:227]
  v_exp_f32 v75, v75
  v_mfma_f32_16x16x32_bf16 a[200:203], a[208:211], v[48:51], a[200:203]
  v_exp_f32 v76, v76
  v_mfma_f32_16x16x32_bf16 v[196:199], a[36:39], v[48:51], v[196:199]
  ds_read_b128 a[8:11], v4 offset:10240
  ds_read_b128 a[12:15], v4 offset:11264
  v_mfma_f32_16x16x32_bf16 v[228:231], a[36:39], v[52:55], v[228:231]
  v_exp_f32 v77, v77
  v_mfma_f32_16x16x32_bf16 a[204:207], a[208:211], v[52:55], a[204:207]
  v_exp_f32 v78, v78
  v_mfma_f32_16x16x32_bf16 v[200:203], a[40:43], v[48:51], v[200:203]
  ds_read_b128 a[16:19], v4 offset:12288
  ds_read_b128 a[20:23], v4 offset:13312
  v_mfma_f32_16x16x32_bf16 v[232:235], a[40:43], v[52:55], v[232:235]
  v_exp_f32 v79, v79
  v_mfma_f32_16x16x32_bf16 v[204:207], a[44:47], v[48:51], v[204:207]
  ds_read_b128 a[24:27], v4 offset:14336
  v_cvt_pk_bf16_f32 v32, v64, v65
  v_mfma_f32_16x16x32_bf16 v[236:239], a[44:47], v[52:55], v[236:239]
  v_cndmask_b32 v80, v80, v5, s[48:49]
  v_exp_f32 v80, v80
  v_mfma_f32_16x16x32_bf16 v[208:211], a[48:51], v[48:51], v[208:211]
  v_cndmask_b32 v81, v81, v5, s[50:51]
  v_exp_f32 v81, v81
  v_mfma_f32_16x16x32_bf16 v[240:243], a[48:51], v[52:55], v[240:243]
  ds_read_b128 a[28:31], v4 offset:15360
  v_xor_b32 v4, 0x8000, v4
  v_mfma_f32_16x16x32_bf16 v[212:215], a[52:55], v[48:51], v[212:215]
  v_cndmask_b32 v82, v82, v5, s[52:53]
  v_exp_f32 v82, v82
  v_mfma_f32_16x16x32_bf16 v[244:247], a[52:55], v[52:55], v[244:247]
  v_cndmask_b32 v83, v83, v5, s[54:55]
  v_exp_f32 v83, v83
  v_mfma_f32_16x16x32_bf16 v[216:219], a[56:59], v[48:51], v[216:219]
  ds_read_b128 a[32:35], v4 offset:0
  ds_read_b128 a[36:39], v4 offset:1024
  v_mfma_f32_16x16x32_bf16 v[248:251], a[56:59], v[52:55], v[248:251]
  v_cndmask_b32 v84, v84, v5, s[56:57]
  v_exp_f32 v84, v84
  v_mfma_f32_16x16x32_bf16 v[220:223], a[60:63], v[48:51], v[220:223]
  v_cndmask_b32 v85, v85, v5, s[58:59]
  v_exp_f32 v85, v85
  v_mfma_f32_16x16x32_bf16 v[252:255], a[60:63], v[52:55], v[252:255]
  s_waitcnt lgkmcnt(2)
  ds_read_b128 a[40:43], v4 offset:2048
  v_cvt_pk_bf16_f32 v33, v66, v67
  v_cvt_pk_bf16_f32 v42, v84, v85
  v_mfma_f32_16x16x32_bf16 v[192:195], a[0:3], v[56:59], v[192:195]
  v_cndmask_b32 v86, v86, v5, s[60:61]
  v_exp_f32 v86, v86
  v_mfma_f32_16x16x32_bf16 v[224:227], a[0:3], v[60:63], v[224:227]
  v_cndmask_b32 v87, v87, v5, s[62:63]
  v_exp_f32 v87, v87
  v_mfma_f32_16x16x32_bf16 a[200:203], a[208:211], v[56:59], a[200:203]
  ds_read_b128 a[44:47], v4 offset:3072
  v_cvt_pk_bf16_f32 v34, v68, v69
  v_cvt_pk_bf16_f32 v43, v86, v87
  v_mfma_f32_16x16x32_bf16 v[196:199], a[4:7], v[56:59], v[196:199]
  v_exp_f32 v88, v88
  v_mfma_f32_16x16x32_bf16 v[228:231], a[4:7], v[60:63], v[228:231]
  ds_read_b128 a[48:51], v4 offset:4096
  v_cvt_pk_bf16_f32 v35, v70, v71
  v_mfma_f32_16x16x32_bf16 a[204:207], a[208:211], v[60:63], a[204:207]
  v_exp_f32 v89, v89
  v_mfma_f32_16x16x32_bf16 v[200:203], a[8:11], v[56:59], v[200:203]
  v_exp_f32 v90, v90
  v_cvt_pk_bf16_f32 v44, v88, v89
  v_mfma_f32_16x16x32_bf16 v[232:235], a[8:11], v[60:63], v[232:235]
  ds_read_b128 a[52:55], v4 offset:5120
  v_cvt_pk_bf16_f32 v36, v72, v73
  v_mfma_f32_16x16x32_bf16 v[204:207], a[12:15], v[56:59], v[204:207]
  v_exp_f32 v91, v91
  v_mfma_f32_16x16x32_bf16 v[236:239], a[12:15], v[60:63], v[236:239]
  v_exp_f32 v92, v92
  v_cvt_pk_bf16_f32 v45, v90, v91
  v_mfma_f32_16x16x32_bf16 v[208:211], a[16:19], v[56:59], v[208:211]
  ds_read_b128 a[56:59], v4 offset:6144
  ds_read_b128 a[60:63], v4 offset:7168
  v_mfma_f32_16x16x32_bf16 v[240:243], a[16:19], v[60:63], v[240:243]
  v_exp_f32 v93, v93
  v_mfma_f32_16x16x32_bf16 v[212:215], a[20:23], v[56:59], v[212:215]
  v_exp_f32 v94, v94
  v_cvt_pk_bf16_f32 v46, v92, v93
  v_mfma_f32_16x16x32_bf16 v[244:247], a[20:23], v[60:63], v[244:247]
  ds_read_b128 a[0:3], v4 offset:8192
  v_cvt_pk_bf16_f32 v37, v74, v75
  v_mfma_f32_16x16x32_bf16 v[216:219], a[24:27], v[56:59], v[216:219]
  v_exp_f32 v95, v95
  v_mfma_f32_16x16x32_bf16 v[248:251], a[24:27], v[60:63], v[248:251]
  ds_read_b128 a[4:7], v4 offset:9216
  v_cvt_pk_bf16_f32 v38, v76, v77
  v_cvt_pk_bf16_f32 v47, v94, v95
  v_mfma_f32_16x16x32_bf16 v[220:223], a[28:31], v[56:59], v[220:223]
  ds_read_b128 a[8:11], v4 offset:10240
  v_cvt_pk_bf16_f32 v39, v78, v79
  v_mfma_f32_16x16x32_bf16 v[252:255], a[28:31], v[60:63], v[252:255]
  v_cvt_pk_bf16_f32 v40, v80, v81
  v_cvt_pk_bf16_f32 v41, v82, v83
La_e1:
  s_waitcnt vmcnt(0)
  s_barrier
  s_waitcnt lgkmcnt(3)
  v_mfma_f32_16x16x32_bf16 v[192:195], a[32:35], v[32:35], v[192:195]
  ds_read_b128 a[12:15], v4 offset:11264
  v_cndmask_b32 v104, v104, v5, s[32:33]
  v_mfma_f32_16x16x32_bf16 v[224:227], a[32:35], v[36:39], v[224:227]
  v_exp_f32 v104, v104
  v_mfma_f32_16x16x32_bf16 a[200:203], a[208:211], v[32:35], a[200:203]
  v_cndmask_b32 v105, v105, v5, s[34:35]
  v_exp_f32 v105, v105
  v_mfma_f32_16x16x32_bf16 v[196:199], a[36:39], v[32:35], v[196:199]
  ds_read_b128 a[16:19], v4 offset:12288
  v_cndmask_b32 v106, v106, v5, s[36:37]
  v_mfma_f32_16x16x32_bf16 v[228:231], a[36:39], v[36:39], v[228:231]
  v_exp_f32 v106, v106
  v_mfma_f32_16x16x32_bf16 a[204:207], a[208:211], v[36:39], a[204:207]
  v_cndmask_b32 v107, v107, v5, s[38:39]
  v_cndmask_b32 v110, v110, v5, s[44:45]
  v_mfma_f32_16x16x32_bf16 v[200:203], a[40:43], v[32:35], v[200:203]
  v_exp_f32 v107, v107
  v_mfma_f32_16x16x32_bf16 v[232:235], a[40:43], v[36:39], v[232:235]
  ds_read_b128 a[20:23], v4 offset:13312
  v_cndmask_b32 v108, v108, v5, s[40:41]
  v_mfma_f32_16x16x32_bf16 v[204:207], a[44:47], v[32:35], v[204:207]
  v_exp_f32 v108, v108
  v_mfma_f32_16x16x32_bf16 v[236:239], a[44:47], v[36:39], v[236:239]
  ds_read_b128 a[24:27], v4 offset:14336
  v_cndmask_b32 v109, v109, v5, s[42:43]
  v_mfma_f32_16x16x32_bf16 v[208:211], a[48:51], v[32:35], v[208:211]
  v_exp_f32 v109, v109
  v_mfma_f32_16x16x32_bf16 v[240:243], a[48:51], v[36:39], v[240:243]
  ds_read_b128 a[28:31], v4 offset:15360
  v_xor_b32 v4, 0x4000, v4
  v_mfma_f32_16x16x32_bf16 v[212:215], a[52:55], v[32:35], v[212:215]
  v_exp_f32 v110, v110
  v_mfma_f32_16x16x32_bf16 v[244:247], a[52:55], v[36:39], v[244:247]
  ds_read_b128 a[32:35], v4 offset:0
  v_cndmask_b32 v111, v111, v5, s[46:47]
  v_mfma_f32_16x16x32_bf16 v[216:219], a[56:59], v[32:35], v[216:219]
  v_exp_f32 v111, v111
  v_mfma_f32_16x16x32_bf16 v[248:251], a[56:59], v[36:39], v[248:251]
  ds_read_b128 a[36:39], v4 offset:1024
  v_cvt_pk_bf16_f32 v52, v104, v105
  v_mfma_f32_16x16x32_bf16 v[220:223], a[60:63], v[32:35], v[220:223]
  ds_read_b128 a[40:43], v4 offset:2048
  v_cvt_pk_bf16_f32 v53, v106, v107
  v_mfma_f32_16x16x32_bf16 v[252:255], a[60:63], v[36:39], v[252:255]
  s_waitcnt lgkmcnt(3)
  v_cndmask_b32 v120, v120, v5, s[48:49]
  v_exp_f32 v120, v120
  v_mfma_f32_16x16x32_bf16 v[192:195], a[0:3], v[40:43], v[192:195]
  ds_read_b128 a[44:47], v4 offset:3072
  v_cvt_pk_bf16_f32 v54, v108, v109
  v_mfma_f32_16x16x32_bf16 v[224:227], a[0:3], v[44:47], v[224:227]
  v_cndmask_b32 v121, v121, v5, s[50:51]
  v_exp_f32 v121, v121
  v_mfma_f32_16x16x32_bf16 a[200:203], a[208:211], v[40:43], a[200:203]
  v_cvt_pk_bf16_f32 v55, v110, v111
  v_cndmask_b32 v122, v122, v5, s[52:53]
  v_mfma_f32_16x16x32_bf16 v[196:199], a[4:7], v[40:43], v[196:199]
  v_exp_f32 v122, v122
  v_mfma_f32_16x16x32_bf16 v[228:231], a[4:7], v[44:47], v[228:231]
  ds_read_b128 a[48:51], v4 offset:4096
  v_cndmask_b32 v123, v123, v5, s[54:55]
  v_mfma_f32_16x16x32_bf16 a[204:207], a[208:211], v[44:47], a[204:207]
  v_exp_f32 v123, v123
  v_mfma_f32_16x16x32_bf16 v[200:203], a[8:11], v[40:43], v[200:203]
  ds_read_b128 a[52:55], v4 offset:5120
  v_cndmask_b32 v124, v124, v5, s[56:57]
  v_mfma_f32_16x16x32_bf16 v[232:235], a[8:11], v[44:47], v[232:235]
  v_exp_f32 v124, v124
  v_mfma_f32_16x16x32_bf16 v[204:207], a[12:15], v[40:43], v[204:207]
  ds_read_b128 a[56:59], v4 offset:6144
  v_cndmask_b32 v125, v125, v5, s[58:59]
  v_mfma_f32_16x16x32_bf16 v[236:239], a[12:15], v[44:47], v[236:239]
  v_exp_f32 v125, v125
  v_mfma_f32_16x16x32_bf16 v[208:211], a[16:19], v[40:43], v[208:211]
  ds_read_b128 a[60:63], v4 offset:7168
  v_cndmask_b32 v126, v126, v5, s[60:61]
  v_mfma_f32_16x16x32_bf16 v[240:243], a[16:19], v[44:47], v[240:243]
  v_exp_f32 v126, v126
  v_mfma_f32_16x16x32_bf16 v[212:215], a[20:23], v[40:43], v[212:215]
  ds_read_b128 a[0:3], v4 offset:8192
  v_cndmask_b32 v127, v127, v5, s[62:63]
  v_mfma_f32_16x16x32_bf16 v[244:247], a[20:23], v[44:47], v[244:247]
  v_exp_f32 v127, v127
  v_mfma_f32_16x16x32_bf16 v[216:219], a[24:27], v[40:43], v[216:219]
  ds_read_b128 a[4:7], v4 offset:9216
  v_cvt_pk_bf16_f32 v60, v120, v121
  v_mfma_f32_16x16x32_bf16 v[248:251], a[24:27], v[44:47], v[248:251]
  v_cvt_pk_bf16_f32 v61, v122, v123
  v_cvt_pk_bf16_f32 v62, v124, v125
  v_mfma_f32_16x16x32_bf16 v[220:223], a[28:31], v[40:43], v[220:223]
  ds_read_b128 a[8:11], v4 offset:10240
  v_cvt_pk_bf16_f32 v63, v126, v127
  v_mfma_f32_16x16x32_bf16 v[252:255], a[28:31], v[44:47], v[252:255]
  s_waitcnt lgkmcnt(7)
  v_mfma_f32_16x16x32_bf16 v[224:227], a[32:35], v[52:55], v[224:227]
  ds_read_b128 a[12:15], v4 offset:11264
  v_mfma_f32_16x16x32_bf16 a[204:207], a[208:211], v[52:55], a[204:207]
  v_mfma_f32_16x16x32_bf16 v[228:231], a[36:39], v[52:55], v[228:231]
  ds_read_b128 a[16:19], v4 offset:12288
  v_mfma_f32_16x16x32_bf16 v[232:235], a[40:43], v[52:55], v[232:235]
  ds_read_b128 a[20:23], v4 offset:13312
  v_mfma_f32_16x16x32_bf16 v[236:239], a[44:47], v[52:55], v[236:239]
  s_waitcnt lgkmcnt(6)
  ds_read_b128 a[24:27], v4 offset:14336
  v_mfma_f32_16x16x32_bf16 v[240:243], a[48:51], v[52:55], v[240:243]
  ds_read_b128 a[28:31], v4 offset:15360
  v_mfma_f32_16x16x32_bf16 v[244:247], a[52:55], v[52:55], v[244:247]
  v_mfma_f32_16x16x32_bf16 v[248:251], a[56:59], v[52:55], v[248:251]
  v_mfma_f32_16x16x32_bf16 v[252:255], a[60:63], v[52:55], v[252:255]
  s_waitcnt lgkmcnt(4)
  v_mfma_f32_16x16x32_bf16 v[224:227], a[0:3], v[60:63], v[224:227]
  v_mfma_f32_16x16x32_bf16 a[204:207], a[208:211], v[60:63], a[204:207]
  v_mfma_f32_16x16x32_bf16 v[228:231], a[4:7], v[60:63], v[228:231]
  v_mfma_f32_16x16x32_bf16 v[232:235], a[8:11], v[60:63], v[232:235]
  v_mfma_f32_16x16x32_bf16 v[236:239], a[12:15], v[60:63], v[236:239]
  s_waitcnt lgkmcnt(0)
  v_mfma_f32_16x16x32_bf16 v[240:243], a[16:19], v[60:63], v[240:243]
  v_mfma_f32_16x16x32_bf16 v[244:247], a[20:23], v[60:63], v[244:247]
  v_mfma_f32_16x16x32_bf16 v[248:251], a[24:27], v[60:63], v[248:251]
  v_mfma_f32_16x16x32_bf16 v[252:255], a[28:31], v[60:63], v[252:255]
  s_sub_u32 s88, 15, s25
  s_lshl_b32 s4, s88, 20
  s_lshl_b32 s5, s24, 15
  s_add_u32 s4, s4, s5
  s_lshl_b32 s5, s3, 11
  s_add_u32 s4, s4, s5
  v_accvgpr_read_b32 v6, a200
  v_accvgpr_read_b32 v8, a204
  s_mov_b32 s5, 0x5f800000
  v_cmp_ngt_f32 vcc, s5, v6
  v_rcp_f32 v6, v6
  s_or_b32 s89, s89, vcc_lo
  s_or_b32 s89, s89, vcc_hi
  v_mov_b32 v7, v6
  v_cmp_ngt_f32 vcc, s5, v8
  v_rcp_f32 v8, v8
  s_or_b32 s89, s89, vcc_lo
  s_or_b32 s89, s89, vcc_hi
  v_mov_b32 v9, v8
  v_pk_mul_f32 v[192:193], v[192:193], v[6:7]
  v_pk_mul_f32 v[194:195], v[194:195], v[6:7]
  v_pk_mul_f32 v[196:197], v[196:197], v[6:7]
  v_pk_mul_f32 v[198:199], v[198:199], v[6:7]
  v_cvt_pk_bf16_f32 v192, v192, v193
  v_cvt_pk_bf16_f32 v193, v194, v195
  v_cvt_pk_bf16_f32 v194, v196, v197
  v_cvt_pk_bf16_f32 v195, v198, v199
  buffer_store_dwordx4 v[192:195], v2, s[16:19], s4 offen offset:0
  v_pk_mul_f32 v[224:225], v[224:225], v[8:9]
  v_pk_mul_f32 v[226:227], v[226:227], v[8:9]
  v_pk_mul_f32 v[228:229], v[228:229], v[8:9]
  v_pk_mul_f32 v[230:231], v[230:231], v[8:9]
  v_cvt_pk_bf16_f32 v224, v224, v225
  v_cvt_pk_bf16_f32 v225, v226, v227
  v_cvt_pk_bf16_f32 v226, v228, v229
  v_cvt_pk_bf16_f32 v227, v230, v231
  buffer_store_dwordx4 v[224:227], v2, s[16:19], s4 offen offset:1024
  s_add_u32 s4, s4, 8192
  v_pk_mul_f32 v[200:201], v[200:201], v[6:7]
  v_pk_mul_f32 v[202:203], v[202:203], v[6:7]
  v_pk_mul_f32 v[204:205], v[204:205], v[6:7]
  v_pk_mul_f32 v[206:207], v[206:207], v[6:7]
  v_cvt_pk_bf16_f32 v200, v200, v201
  v_cvt_pk_bf16_f32 v201, v202, v203
  v_cvt_pk_bf16_f32 v202, v204, v205
  v_cvt_pk_bf16_f32 v203, v206, v207
  buffer_store_dwordx4 v[200:203], v2, s[16:19], s4 offen offset:0
  v_pk_mul_f32 v[232:233], v[232:233], v[8:9]
  v_pk_mul_f32 v[234:235], v[234:235], v[8:9]
  v_pk_mul_f32 v[236:237], v[236:237], v[8:9]
  v_pk_mul_f32 v[238:239], v[238:239], v[8:9]
  v_cvt_pk_bf16_f32 v232, v232, v233
  v_cvt_pk_bf16_f32 v233, v234, v235
  v_cvt_pk_bf16_f32 v234, v236, v237
  v_cvt_pk_bf16_f32 v235, v238, v239
  buffer_store_dwordx4 v[232:235], v2, s[16:19], s4 offen offset:1024
  s_add_u32 s4, s4, 8192
  v_pk_mul_f32 v[208:209], v[208:209], v[6:7]
  v_pk_mul_f32 v[210:211], v[210:211], v[6:7]
  v_pk_mul_f32 v[212:213], v[212:213], v[6:7]
  v_pk_mul_f32 v[214:215], v[214:215], v[6:7]
  v_cvt_pk_bf16_f32 v208, v208, v209
  v_cvt_pk_bf16_f32 v209, v210, v211
  v_cvt_pk_bf16_f32 v210, v212, v213
  v_cvt_pk_bf16_f32 v211, v214, v215
  buffer_store_dwordx4 v[208:211], v2, s[16:19], s4 offen offset:0
  v_pk_mul_f32 v[240:241], v[240:241], v[8:9]
  v_pk_mul_f32 v[242:243], v[242:243], v[8:9]
  v_pk_mul_f32 v[244:245], v[244:245], v[8:9]
  v_pk_mul_f32 v[246:247], v[246:247], v[8:9]
  v_cvt_pk_bf16_f32 v240, v240, v241
  v_cvt_pk_bf16_f32 v241, v242, v243
  v_cvt_pk_bf16_f32 v242, v244, v245
  v_cvt_pk_bf16_f32 v243, v246, v247
  buffer_store_dwordx4 v[240:243], v2, s[16:19], s4 offen offset:1024
  s_add_u32 s4, s4, 8192
  v_pk_mul_f32 v[216:217], v[216:217], v[6:7]
  v_pk_mul_f32 v[218:219], v[218:219], v[6:7]
  v_pk_mul_f32 v[220:221], v[220:221], v[6:7]
  v_pk_mul_f32 v[222:223], v[222:223], v[6:7]
  v_cvt_pk_bf16_f32 v216, v216, v217
  v_cvt_pk_bf16_f32 v217, v218, v219
  v_cvt_pk_bf16_f32 v218, v220, v221
  v_cvt_pk_bf16_f32 v219, v222, v223
  buffer_store_dwordx4 v[216:219], v2, s[16:19], s4 offen offset:0
  v_pk_mul_f32 v[248:249], v[248:249], v[8:9]
  v_pk_mul_f32 v[250:251], v[250:251], v[8:9]
  v_pk_mul_f32 v[252:253], v[252:253], v[8:9]
  v_pk_mul_f32 v[254:255], v[254:255], v[8:9]
  v_cvt_pk_bf16_f32 v248, v248, v249
  v_cvt_pk_bf16_f32 v249, v250, v251
  v_cvt_pk_bf16_f32 v250, v252, v253
  v_cvt_pk_bf16_f32 v251, v254, v255
  buffer_store_dwordx4 v[248:251], v2, s[16:19], s4 offen offset:1024
  s_cmp_eq_u32 s89, 0
  s_cbranch_scc1 La_done
  s_waitcnt vmcnt(0)
  s_sub_u32 s6, 15, s25
La_sl_blk:
  v_mov_b32 v192, 0
  v_mov_b32 v193, 0
  v_mov_b32 v194, 0
  v_mov_b32 v195, 0
  v_mov_b32 v196, 0
  v_mov_b32 v197, 0
  v_mov_b32 v198, 0
  v_mov_b32 v199, 0
  v_mov_b32 v200, 0
  v_mov_b32 v201, 0
  v_mov_b32 v202, 0
  v_mov_b32 v203, 0
  v_mov_b32 v204, 0
  v_mov_b32 v205, 0
  v_mov_b32 v206, 0
  v_mov_b32 v207, 0
  v_mov_b32 v208, 0
  v_mov_b32 v209, 0
  v_mov_b32 v210, 0
  v_mov_b32 v211, 0
  v_mov_b32 v212, 0
  v_mov_b32 v213, 0
  v_mov_b32 v214, 0
  v_mov_b32 v215, 0
  v_mov_b32 v216, 0
  v_mov_b32 v217, 0
  v_mov_b32 v218, 0
  v_mov_b32 v219, 0
  v_mov_b32 v220, 0
  v_mov_b32 v221, 0
  v_mov_b32 v222, 0
  v_mov_b32 v223, 0
  v_mov_b32 v224, 0
  v_mov_b32 v225, 0
  v_mov_b32 v226, 0
  v_mov_b32 v227, 0
  v_mov_b32 v228, 0
  v_mov_b32 v229, 0
  v_mov_b32 v230, 0
  v_mov_b32 v231, 0
  v_mov_b32 v232, 0
  v_mov_b32 v233, 0
  v_mov_b32 v234, 0
  v_mov_b32 v235, 0
  v_mov_b32 v236, 0
  v_mov_b32 v237, 0
  v_mov_b32 v238, 0
  v_mov_b32 v239, 0
  v_mov_b32 v240, 0
  v_mov_b32 v241, 0
  v_mov_b32 v242, 0
  v_mov_b32 v243, 0
  v_mov_b32 v244, 0
  v_mov_b32 v245, 0
  v_mov_b32 v246, 0
  v_mov_b32 v247, 0
  v_mov_b32 v248, 0
  v_mov_b32 v249, 0
  v_mov_b32 v250, 0
  v_mov_b32 v251, 0
  v_mov_b32 v252, 0
  v_mov_b32 v253, 0
  v_mov_b32 v254, 0
  v_mov_b32 v255, 0
  v_mov_b32 v24, 0
  v_mov_b32 v25, 0
  v_mov_b32 v26, 0
  v_mov_b32 v27, 0
  v_mov_b32 v28, 0
  v_mov_b32 v29, 0
  v_mov_b32 v30, 0
  v_mov_b32 v31, 0
  v_mov_b32 v16, v5
  v_mov_b32 v17, v5
  v_and_b32 v20, 15, v1
  v_lshrrev_b32 v21, 4, v1
  v_sub_u32 v20, v20, v21
  v_lshlrev_b32 v20, 2, v20
  s_lshl_b32 s4, s6, 7
  s_add_u32 s4, s4, s3
  v_add_u32 v20, s4, v20
  v_add_u32 v21, 64, v20
  s_add_u32 s7, s6, 1
  s_lshl_b32 s7, s7, 2
  s_mov_b32 s90, 0
La_sl_loop:
  s_add_u32 s4, s90, 0
  buffer_load_dwordx4 a[0:3], v2, s[20:23], s4 offen offset:0
  buffer_load_dwordx4 a[4:7], v2, s[20:23], s4 offen offset:1024
  buffer_load_dwordx4 a[8:11], v2, s[20:23], s4 offen offset:2048
  buffer_load_dwordx4 a[12:15], v2, s[20:23], s4 offen offset:3072
  s_add_u32 s4, s90, 4096
  buffer_load_dwordx4 a[16:19], v2, s[20:23], s4 offen offset:0
  buffer_load_dwordx4 a[20:23], v2, s[20:23], s4 offen offset:1024
  buffer_load_dwordx4 a[24:27], v2, s[20:23], s4 offen offset:2048
  buffer_load_dwordx4 a[28:31], v2, s[20:23], s4 offen offset:3072
  s_add_u32 s4, s90, 16384
  buffer_load_dwordx4 a[32:35], v2, s[20:23], s4 offen offset:0
  buffer_load_dwordx4 a[36:39], v2, s[20:23], s4 offen offset:1024
  buffer_load_dwordx4 a[40:43], v2, s[20:23], s4 offen offset:2048
  buffer_load_dwordx4 a[44:47], v2, s[20:23], s4 offen offset:3072
  s_add_u32 s4, s90, 20480
  buffer_load_dwordx4 a[48:51], v2, s[20:23], s4 offen offset:0
  buffer_load_dwordx4 a[52:55], v2, s[20:23], s4 offen offset:1024
  buffer_load_dwordx4 a[56:59], v2, s[20:23], s4 offen offset:2048
  buffer_load_dwordx4 a[60:63], v2, s[20:23], s4 offen offset:3072
  s_waitcnt vmcnt(0)
  v_mfma_f32_16x16x32_bf16 v[64:67], a[0:3], a[160:163], 0
  v_mfma_f32_16x16x32_bf16 v[72:75], a[0:3], a[176:179], 0
  v_mfma_f32_16x16x32_bf16 v[64:67], a[4:7], a[164:167], v[64:67]
  v_mfma_f32_16x16x32_bf16 v[72:75], a[4:7], a[180:183], v[72:75]
  v_mfma_f32_16x16x32_bf16 v[64:67], a[8:11], a[168:171], v[64:67]
  v_mfma_f32_16x16x32_bf16 v[72:75], a[8:11], a[184:187], v[72:75]
  v_mfma_f32_16x16x32_bf16 v[64:67], a[12:15], a[172:175], v[64:67]
  v_mfma_f32_16x16x32_bf16 v[72:75], a[12:15], a[188:191], v[72:75]
  v_mfma_f32_16x16x32_bf16 v[68:71], a[16:19], a[160:163], 0
  v_mfma_f32_16x16x32_bf16 v[76:79], a[16:19], a[176:179], 0
  v_mfma_f32_16x16x32_bf16 v[68:71], a[20:23], a[164:167], v[68:71]
  v_mfma_f32_16x16x32_bf16 v[76:79], a[20:23], a[180:183], v[76:79]
  v_mfma_f32_16x16x32_bf16 v[68:71], a[24:27], a[168:171], v[68:71]
  v_mfma_f32_16x16x32_bf16 v[76:79], a[24:27], a[184:187], v[76:79]
  v_mfma_f32_16x16x32_bf16 v[68:71], a[28:31], a[172:175], v[68:71]
  v_mfma_f32_16x16x32_bf16 v[76:79], a[28:31], a[188:191], v[76:79]
  v_cmp_gt_i32 vcc, 0, v20
  s_nop 1
  v_cndmask_b32 v64, v64, v5, vcc
  v_cmp_gt_i32 vcc, 1, v20
  s_nop 1
  v_cndmask_b32 v65, v65, v5, vcc
  v_cmp_gt_i32 vcc, 2, v20
  s_nop 1
  v_cndmask_b32 v66, v66, v5, vcc
  v_cmp_gt_i32 vcc, 3, v20
  s_nop 1
  v_cndmask_b32 v67, v67, v5, vcc
  v_cmp_gt_i32 vcc, 16, v20
  s_nop 1
  v_cndmask_b32 v68, v68, v5, vcc
  v_cmp_gt_i32 vcc, 17, v20
  s_nop 1
  v_cndmask_b32 v69, v69, v5, vcc
  v_cmp_gt_i32 vcc, 18, v20
  s_nop 1
  v_cndmask_b32 v70, v70, v5, vcc
  v_cmp_gt_i32 vcc, 19, v20
  s_nop 1
  v_cndmask_b32 v71, v71, v5, vcc
  v_subrev_u32 v20, 32, v20
  v_max3_f32 v6, v64, v65, v66
  v_max3_f32 v7, v67, v68, v69
  v_max3_f32 v6, v6, v70, v71
  v_max_f32 v6, v6, v7
  v_cmp_gt_i32 vcc, 0, v21
  s_nop 1
  v_cndmask_b32 v72, v72, v5, vcc
  v_cmp_gt_i32 vcc, 1, v21
  s_nop 1
  v_cndmask_b32 v73, v73, v5, vcc
  v_cmp_gt_i32 vcc, 2, v21
  s_nop 1
  v_cndmask_b32 v74, v74, v5, vcc
  v_cmp_gt_i32 vcc, 3, v21
  s_nop 1
  v_cndmask_b32 v75, v75, v5, vcc
  v_cmp_gt_i32 vcc, 16, v21
  s_nop 1
  v_cndmask_b32 v76, v76, v5, vcc
  v_cmp_gt_i32 vcc, 17, v21
  s_nop 1
  v_cndmask_b32 v77, v77, v5, vcc
  v_cmp_gt_i32 vcc, 18, v21
  s_nop 1
  v_cndmask_b32 v78, v78, v5, vcc
  v_cmp_gt_i32 vcc, 19, v21
  s_nop 1
  v_cndmask_b32 v79, v79, v5, vcc
  v_subrev_u32 v21, 32, v21
  v_max3_f32 v8, v72, v73, v74
  v_max3_f32 v9, v75, v76, v77
  v_max3_f32 v8, v8, v78, v79
  v_max_f32 v8, v8, v9
  v_mov_b32 v7, v6
  v_mov_b32 v9, v8
  s_nop 0
  v_permlane32_swap_b32 v6, v7
  v_permlane32_swap_b32 v8, v9
  v_max_f32 v6, v6, v7
  v_max_f32 v8, v8, v9
  v_mov_b32 v7, v6
  v_mov_b32 v9, v8
  s_nop 0
  v_permlane16_swap_b32 v6, v7
  v_permlane16_swap_b32 v8, v9
  v_max_f32 v6, v6, v7
  v_max_f32 v8, v8, v9
  v_max_f32 v6, v6, v16
  v_sub_f32 v7, v16, v6
  v_exp_f32 v7, v7
  v_mov_b32 v16, v6
  v_sub_f32 v64, v64, v16
  v_sub_f32 v65, v65, v16
  v_sub_f32 v66, v66, v16
  v_sub_f32 v67, v67, v16
  v_sub_f32 v68, v68, v16
  v_sub_f32 v69, v69, v16
  v_sub_f32 v70, v70, v16
  v_sub_f32 v71, v71, v16
  v_exp_f32 v64, v64
  v_exp_f32 v65, v65
  v_exp_f32 v66, v66
  v_exp_f32 v67, v67
  v_exp_f32 v68, v68
  v_exp_f32 v69, v69
  v_exp_f32 v70, v70
  v_exp_f32 v71, v71
  v_mul_f32 v24, v24, v7
  v_mul_f32 v25, v25, v7
  v_mul_f32 v26, v26, v7
  v_mul_f32 v27, v27, v7
  v_mul_f32 v192, v192, v7
  v_mul_f32 v193, v193, v7
  v_mul_f32 v194, v194, v7
  v_mul_f32 v195, v195, v7
  v_mul_f32 v196, v196, v7
  v_mul_f32 v197, v197, v7
  v_mul_f32 v198, v198, v7
  v_mul_f32 v199, v199, v7
  v_mul_f32 v200, v200, v7
  v_mul_f32 v201, v201, v7
  v_mul_f32 v202, v202, v7
  v_mul_f32 v203, v203, v7
  v_mul_f32 v204, v204, v7
  v_mul_f32 v205, v205, v7
  v_mul_f32 v206, v206, v7
  v_mul_f32 v207, v207, v7
  v_mul_f32 v208, v208, v7
  v_mul_f32 v209, v209, v7
  v_mul_f32 v210, v210, v7
  v_mul_f32 v211, v211, v7
  v_mul_f32 v212, v212, v7
  v_mul_f32 v213, v213, v7
  v_mul_f32 v214, v214, v7
  v_mul_f32 v215, v215, v7
  v_mul_f32 v216, v216, v7
  v_mul_f32 v217, v217, v7
  v_mul_f32 v218, v218, v7
  v_mul_f32 v219, v219, v7
  v_mul_f32 v220, v220, v7
  v_mul_f32 v221, v221, v7
  v_mul_f32 v222, v222, v7
  v_mul_f32 v223, v223, v7
  v_cvt_pk_bf16_f32 v32, v64, v65
  v_cvt_pk_bf16_f32 v33, v66, v67
  v_cvt_pk_bf16_f32 v34, v68, v69
  v_cvt_pk_bf16_f32 v35, v70, v71
  v_max_f32 v8, v8, v17
  v_sub_f32 v9, v17, v8
  v_exp_f32 v9, v9
  v_mov_b32 v17, v8
  v_sub_f32 v72, v72, v17
  v_sub_f32 v73, v73, v17
  v_sub_f32 v74, v74, v17
  v_sub_f32 v75, v75, v17
  v_sub_f32 v76, v76, v17
  v_sub_f32 v77, v77, v17
  v_sub_f32 v78, v78, v17
  v_sub_f32 v79, v79, v17
  v_exp_f32 v72, v72
  v_exp_f32 v73, v73
  v_exp_f32 v74, v74
  v_exp_f32 v75, v75
  v_exp_f32 v76, v76
  v_exp_f32 v77, v77
  v_exp_f32 v78, v78
  v_exp_f32 v79, v79
  v_mul_f32 v28, v28, v9
  v_mul_f32 v29, v29, v9
  v_mul_f32 v30, v30, v9
  v_mul_f32 v31, v31, v9
  v_mul_f32 v224, v224, v9
  v_mul_f32 v225, v225, v9
  v_mul_f32 v226, v226, v9
  v_mul_f32 v227, v227, v9
  v_mul_f32 v228, v228, v9
  v_mul_f32 v229, v229, v9
  v_mul_f32 v230, v230, v9
  v_mul_f32 v231, v231, v9
  v_mul_f32 v232, v232, v9
  v_mul_f32 v233, v233, v9
  v_mul_f32 v234, v234, v9
  v_mul_f32 v235, v235, v9
  v_mul_f32 v236, v236, v9
  v_mul_f32 v237, v237, v9
  v_mul_f32 v238, v238, v9
  v_mul_f32 v239, v239, v9
  v_mul_f32 v240, v240, v9
  v_mul_f32 v241, v241, v9
  v_mul_f32 v242, v242, v9
  v_mul_f32 v243, v243, v9
  v_mul_f32 v244, v244, v9
  v_mul_f32 v245, v245, v9
  v_mul_f32 v246, v246, v9
  v_mul_f32 v247, v247, v9
  v_mul_f32 v248, v248, v9
  v_mul_f32 v249, v249, v9
  v_mul_f32 v250, v250, v9
  v_mul_f32 v251, v251, v9
  v_mul_f32 v252, v252, v9
  v_mul_f32 v253, v253, v9
  v_mul_f32 v254, v254, v9
  v_mul_f32 v255, v255, v9
  v_cvt_pk_bf16_f32 v36, v72, v73
  v_cvt_pk_bf16_f32 v37, v74, v75
  v_cvt_pk_bf16_f32 v38, v76, v77
  v_cvt_pk_bf16_f32 v39, v78, v79
  v_mfma_f32_16x16x32_bf16 v[24:27], a[208:211], v[32:35], v[24:27]
  v_mfma_f32_16x16x32_bf16 v[192:195], a[32:35], v[32:35], v[192:195]
  v_mfma_f32_16x16x32_bf16 v[196:199], a[36:39], v[32:35], v[196:199]
  v_mfma_f32_16x16x32_bf16 v[200:203], a[40:43], v[32:35], v[200:203]
  v_mfma_f32_16x16x32_bf16 v[204:207], a[44:47], v[32:35], v[204:207]
  v_mfma_f32_16x16x32_bf16 v[208:211], a[48:51], v[32:35], v[208:211]
  v_mfma_f32_16x16x32_bf16 v[212:215], a[52:55], v[32:35], v[212:215]
  v_mfma_f32_16x16x32_bf16 v[216:219], a[56:59], v[32:35], v[216:219]
  v_mfma_f32_16x16x32_bf16 v[220:223], a[60:63], v[32:35], v[220:223]
  v_mfma_f32_16x16x32_bf16 v[28:31], a[208:211], v[36:39], v[28:31]
  v_mfma_f32_16x16x32_bf16 v[224:227], a[32:35], v[36:39], v[224:227]
  v_mfma_f32_16x16x32_bf16 v[228:231], a[36:39], v[36:39], v[228:231]
  v_mfma_f32_16x16x32_bf16 v[232:235], a[40:43], v[36:39], v[232:235]
  v_mfma_f32_16x16x32_bf16 v[236:239], a[44:47], v[36:39], v[236:239]
  v_mfma_f32_16x16x32_bf16 v[240:243], a[48:51], v[36:39], v[240:243]
  v_mfma_f32_16x16x32_bf16 v[244:247], a[52:55], v[36:39], v[244:247]
  v_mfma_f32_16x16x32_bf16 v[248:251], a[56:59], v[36:39], v[248:251]
  v_mfma_f32_16x16x32_bf16 v[252:255], a[60:63], v[36:39], v[252:255]
  s_add_u32 s90, s90, 8192
  s_and_b32 s4, s90, 0x4000
  s_add_u32 s90, s90, s4
  s_sub_u32 s7, s7, 1
  s_cmp_lg_u32 s7, 0
  s_cbranch_scc1 La_sl_loop
  s_lshl_b32 s4, s6, 20
  s_lshl_b32 s5, s24, 15
  s_add_u32 s4, s4, s5
  s_lshl_b32 s5, s3, 11
  s_add_u32 s4, s4, s5
  v_rcp_f32 v6, v24
  s_nop 0
  v_mov_b32 v7, v6
  v_rcp_f32 v8, v28
  s_nop 0
  v_mov_b32 v9, v8
  v_pk_mul_f32 v[192:193], v[192:193], v[6:7]
  v_pk_mul_f32 v[194:195], v[194:195], v[6:7]
  v_pk_mul_f32 v[196:197], v[196:197], v[6:7]
  v_pk_mul_f32 v[198:199], v[198:199], v[6:7]
  v_cvt_pk_bf16_f32 v192, v192, v193
  v_cvt_pk_bf16_f32 v193, v194, v195
  v_cvt_pk_bf16_f32 v194, v196, v197
  v_cvt_pk_bf16_f32 v195, v198, v199
  buffer_store_dwordx4 v[192:195], v2, s[16:19], s4 offen offset:0
  v_pk_mul_f32 v[224:225], v[224:225], v[8:9]
  v_pk_mul_f32 v[226:227], v[226:227], v[8:9]
  v_pk_mul_f32 v[228:229], v[228:229], v[8:9]
  v_pk_mul_f32 v[230:231], v[230:231], v[8:9]
  v_cvt_pk_bf16_f32 v224, v224, v225
  v_cvt_pk_bf16_f32 v225, v226, v227
  v_cvt_pk_bf16_f32 v226, v228, v229
  v_cvt_pk_bf16_f32 v227, v230, v231
  buffer_store_dwordx4 v[224:227], v2, s[16:19], s4 offen offset:1024
  s_add_u32 s4, s4, 8192
  v_pk_mul_f32 v[200:201], v[200:201], v[6:7]
  v_pk_mul_f32 v[202:203], v[202:203], v[6:7]
  v_pk_mul_f32 v[204:205], v[204:205], v[6:7]
  v_pk_mul_f32 v[206:207], v[206:207], v[6:7]
  v_cvt_pk_bf16_f32 v200, v200, v201
  v_cvt_pk_bf16_f32 v201, v202, v203
  v_cvt_pk_bf16_f32 v202, v204, v205
  v_cvt_pk_bf16_f32 v203, v206, v207
  buffer_store_dwordx4 v[200:203], v2, s[16:19], s4 offen offset:0
  v_pk_mul_f32 v[232:233], v[232:233], v[8:9]
  v_pk_mul_f32 v[234:235], v[234:235], v[8:9]
  v_pk_mul_f32 v[236:237], v[236:237], v[8:9]
  v_pk_mul_f32 v[238:239], v[238:239], v[8:9]
  v_cvt_pk_bf16_f32 v232, v232, v233
  v_cvt_pk_bf16_f32 v233, v234, v235
  v_cvt_pk_bf16_f32 v234, v236, v237
  v_cvt_pk_bf16_f32 v235, v238, v239
  buffer_store_dwordx4 v[232:235], v2, s[16:19], s4 offen offset:1024
  s_add_u32 s4, s4, 8192
  v_pk_mul_f32 v[208:209], v[208:209], v[6:7]
  v_pk_mul_f32 v[210:211], v[210:211], v[6:7]
  v_pk_mul_f32 v[212:213], v[212:213], v[6:7]
  v_pk_mul_f32 v[214:215], v[214:215], v[6:7]
  v_cvt_pk_bf16_f32 v208, v208, v209
  v_cvt_pk_bf16_f32 v209, v210, v211
  v_cvt_pk_bf16_f32 v210, v212, v213
  v_cvt_pk_bf16_f32 v211, v214, v215
  buffer_store_dwordx4 v[208:211], v2, s[16:19], s4 offen offset:0
  v_pk_mul_f32 v[240:241], v[240:241], v[8:9]
  v_pk_mul_f32 v[242:243], v[242:243], v[8:9]
  v_pk_mul_f32 v[244:245], v[244:245], v[8:9]
  v_pk_mul_f32 v[246:247], v[246:247], v[8:9]
  v_cvt_pk_bf16_f32 v240, v240, v241
  v_cvt_pk_bf16_f32 v241, v242, v243
  v_cvt_pk_bf16_f32 v242, v244, v245
  v_cvt_pk_bf16_f32 v243, v246, v247
  buffer_store_dwordx4 v[240:243], v2, s[16:19], s4 offen offset:1024
  s_add_u32 s4, s4, 8192
  v_pk_mul_f32 v[216:217], v[216:217], v[6:7]
  v_pk_mul_f32 v[218:219], v[218:219], v[6:7]
  v_pk_mul_f32 v[220:221], v[220:221], v[6:7]
  v_pk_mul_f32 v[222:223], v[222:223], v[6:7]
  v_cvt_pk_bf16_f32 v216, v216, v217
  v_cvt_pk_bf16_f32 v217, v218, v219
  v_cvt_pk_bf16_f32 v218, v220, v221
  v_cvt_pk_bf16_f32 v219, v222, v223
  buffer_store_dwordx4 v[216:219], v2, s[16:19], s4 offen offset:0
  v_pk_mul_f32 v[248:249], v[248:249], v[8:9]
  v_pk_mul_f32 v[250:251], v[250:251], v[8:9]
  v_pk_mul_f32 v[252:253], v[252:253], v[8:9]
  v_pk_mul_f32 v[254:255], v[254:255], v[8:9]
  v_cvt_pk_bf16_f32 v248, v248, v249
  v_cvt_pk_bf16_f32 v249, v250, v251
  v_cvt_pk_bf16_f32 v250, v252, v253
  v_cvt_pk_bf16_f32 v251, v254, v255
  buffer_store_dwordx4 v[248:251], v2, s[16:19], s4 offen offset:1024
  s_cmp_eq_u32 s6, s25
  s_cbranch_scc1 La_done
  v_accvgpr_read_b32 v64, a128
  v_accvgpr_read_b32 v65, a129
  v_accvgpr_read_b32 v66, a130
  v_accvgpr_read_b32 v67, a131
  v_accvgpr_read_b32 v68, a132
  v_accvgpr_read_b32 v69, a133
  v_accvgpr_read_b32 v70, a134
  v_accvgpr_read_b32 v71, a135
  v_accvgpr_read_b32 v72, a136
  v_accvgpr_read_b32 v73, a137
  v_accvgpr_read_b32 v74, a138
  v_accvgpr_read_b32 v75, a139
  v_accvgpr_read_b32 v76, a140
  v_accvgpr_read_b32 v77, a141
  v_accvgpr_read_b32 v78, a142
  v_accvgpr_read_b32 v79, a143
  v_accvgpr_read_b32 v80, a144
  v_accvgpr_read_b32 v81, a145
  v_accvgpr_read_b32 v82, a146
  v_accvgpr_read_b32 v83, a147
  v_accvgpr_read_b32 v84, a148
  v_accvgpr_read_b32 v85, a149
  v_accvgpr_read_b32 v86, a150
  v_accvgpr_read_b32 v87, a151
  v_accvgpr_read_b32 v88, a152
  v_accvgpr_read_b32 v89, a153
  v_accvgpr_read_b32 v90, a154
  v_accvgpr_read_b32 v91, a155
  v_accvgpr_read_b32 v92, a156
  v_accvgpr_read_b32 v93, a157
  v_accvgpr_read_b32 v94, a158
  v_accvgpr_read_b32 v95, a159
  v_accvgpr_write_b32 a160, v64
  v_accvgpr_write_b32 a161, v65
  v_accvgpr_write_b32 a162, v66
  v_accvgpr_write_b32 a163, v67
  v_accvgpr_write_b32 a164, v68
  v_accvgpr_write_b32 a165, v69
  v_accvgpr_write_b32 a166, v70
  v_accvgpr_write_b32 a167, v71
  v_accvgpr_write_b32 a168, v72
  v_accvgpr_write_b32 a169, v73
  v_accvgpr_write_b32 a170, v74
  v_accvgpr_write_b32 a171, v75
  v_accvgpr_write_b32 a172, v76
  v_accvgpr_write_b32 a173, v77
  v_accvgpr_write_b32 a174, v78
  v_accvgpr_write_b32 a175, v79
  v_accvgpr_write_b32 a176, v80
  v_accvgpr_write_b32 a177, v81
  v_accvgpr_write_b32 a178, v82
  v_accvgpr_write_b32 a179, v83
  v_accvgpr_write_b32 a180, v84
  v_accvgpr_write_b32 a181, v85
  v_accvgpr_write_b32 a182, v86
  v_accvgpr_write_b32 a183, v87
  v_accvgpr_write_b32 a184, v88
  v_accvgpr_write_b32 a185, v89
  v_accvgpr_write_b32 a186, v90
  v_accvgpr_write_b32 a187, v91
  v_accvgpr_write_b32 a188, v92
  v_accvgpr_write_b32 a189, v93
  v_accvgpr_write_b32 a190, v94
  v_accvgpr_write_b32 a191, v95
  s_mov_b32 s6, s25
  s_branch La_sl_blk
La_done:
  s_waitcnt vmcnt(0)
Lk2_end:
  s_endpgm
.globl k3_oproj_kernel
.p2align 8
.type k3_oproj_kernel,@function
k3_oproj_kernel:
  s_cmp_ge_u32 s2, 256
  s_cbranch_scc1 Lk3_end
  s_load_dwordx16 s[64:79], s[0:1], 0
  s_load_dwordx8 s[80:87], s[0:1], 64
  v_lshrrev_b32 v2, 6, v0
  v_and_b32 v1, 63, v0
  v_readfirstlane_b32 s3, v2
  v_lshlrev_b32 v2, 4, v1
  s_and_b32 s4, s2, 3
  s_lshl_b32 s4, s4, 2
  s_bfe_u32 s5, s2, 0x20003
  s_add_u32 s54, s4, s5
  s_bfe_u32 s4, s2, 0x10002
  s_lshl_b32 s4, s4, 3
  s_lshr_b32 s5, s2, 5
  s_add_u32 s55, s4, s5
  v_lshrrev_b32 v32, 3, v1
  v_and_b32 v33, 6, v32
  v_and_b32 v34, 7, v1
  v_xor_b32 v33, v33, v34
  v_lshlrev_b32 v33, 4, v33
  s_lshl_b32 s4, s3, 4
  v_add_u32 v34, s4, v32
  v_lshl_add_u32 v24, v34, 11, v33
  v_add_u32 v25, 15360, v24
  s_lshl_b32 s4, s3, 11
  s_sub_u32 s48, 16384, s4
  s_waitcnt lgkmcnt(0)
  s_add_u32 s8, s86, 83886080
  s_addc_u32 s9, s87, 0
  s_mov_b32 s10, 4194304
  s_mov_b32 s11, 0x00020000
  s_mov_b32 s12, s80
  s_mov_b32 s13, s81
  s_mov_b32 s14, 2097152
  s_mov_b32 s15, 0x00020000
  s_lshl_b32 s36, s3, 12
  s_lshl_b32 s46, s54, 18
  s_add_u32 s46, s46, s36
  s_lshl_b32 s47, s55, 7
  s_add_u32 m0, s36, s48
  s_nop 0
  buffer_load_dwordx4 v24, s[12:15], s47 offen offset:0 lds
  buffer_load_dwordx4 v25, s[12:15], s47 offen offset:1024 lds
  s_add_u32 s47, s47, 131072
  s_mov_b32 m0, s36
  s_nop 0
  buffer_load_dwordx4 v2, s[8:11], s46 offen offset:0 lds
  buffer_load_dwordx4 v2, s[8:11], s46 offen offset:1024 lds
  buffer_load_dwordx4 v2, s[8:11], s46 offen offset:2048 lds
  buffer_load_dwordx4 v2, s[8:11], s46 offen offset:3072 lds
  s_add_u32 s46, s46, 16384
  s_add_u32 m0, s36, s48
  s_add_u32 m0, m0, 24576
  s_nop 0
  buffer_load_dwordx4 v24, s[12:15], s47 offen offset:0 lds
  buffer_load_dwordx4 v25, s[12:15], s47 offen offset:1024 lds
  s_add_u32 s47, s47, 131072
  s_add_u32 m0, s36, 24576
  s_nop 0
  buffer_load_dwordx4 v2, s[8:11], s46 offen offset:0 lds
  buffer_load_dwordx4 v2, s[8:11], s46 offen offset:1024 lds
  buffer_load_dwordx4 v2, s[8:11], s46 offen offset:2048 lds
  buffer_load_dwordx4 v2, s[8:11], s46 offen offset:3072 lds
  s_add_u32 s46, s46, 16384
  s_add_u32 m0, s36, s48
  s_add_u32 m0, m0, 49152
  s_nop 0
  buffer_load_dwordx4 v24, s[12:15], s47 offen offset:0 lds
  buffer_load_dwordx4 v25, s[12:15], s47 offen offset:1024 lds
  s_add_u32 s47, s47, 131072
  s_add_u32 m0, s36, 49152
  s_nop 0
  buffer_load_dwordx4 v2, s[8:11], s46 offen offset:0 lds
  buffer_load_dwordx4 v2, s[8:11], s46 offen offset:1024 lds
  buffer_load_dwordx4 v2, s[8:11], s46 offen offset:2048 lds
  buffer_load_dwordx4 v2, s[8:11], s46 offen offset:3072 lds
  s_add_u32 s46, s46, 16384
  s_add_u32 m0, s36, s48
  s_add_u32 m0, m0, 73728
  s_nop 0
  buffer_load_dwordx4 v24, s[12:15], s47 offen offset:0 lds
  buffer_load_dwordx4 v25, s[12:15], s47 offen offset:1024 lds
  s_add_u32 s47, s47, 131072
  s_add_u32 m0, s36, 73728
  s_nop 0
  buffer_load_dwordx4 v2, s[8:11], s46 offen offset:0 lds
  buffer_load_dwordx4 v2, s[8:11], s46 offen offset:1024 lds
  buffer_load_dwordx4 v2, s[8:11], s46 offen offset:2048 lds
  buffer_load_dwordx4 v2, s[8:11], s46 offen offset:3072 lds
  s_add_u32 s46, s46, 16384
  s_add_u32 m0, s36, s48
  s_add_u32 m0, m0, 98304
  s_nop 0
  buffer_load_dwordx4 v24, s[12:15], s47 offen offset:0 lds
  buffer_load_dwordx4 v25, s[12:15], s47 offen offset:1024 lds
  s_add_u32 s47, s47, 131072
  s_add_u32 m0, s36, 98304
  s_nop 0
  buffer_load_dwordx4 v2, s[8:11], s46 offen offset:0 lds
  buffer_load_dwordx4 v2, s[8:11], s46 offen offset:1024 lds
  buffer_load_dwordx4 v2, s[8:11], s46 offen offset:2048 lds
  buffer_load_dwordx4 v2, s[8:11], s46 offen offset:3072 lds
  s_add_u32 s46, s46, 16384
  s_lshr_b32 s4, s3, 1
  s_lshl_b32 s4, s4, 12
  v_add_u32 v16, s4, v2
  v_lshrrev_b32 v32, 2, v1
  v_and_b32 v33, 6, v32
  v_lshlrev_b32 v32, 7, v32
  v_and_b32 v34, 1, v1
  v_lshl_add_u32 v32, v34, 3, v32
  v_add_u32 v32, 0, v32
  v_bfe_u32 v34, v1, 1, 1
  v_xor_b32 v33, v33, v34
  v_xor_b32 v34, 0, v33
  v_lshl_add_u32 v20, v34, 4, v32
  v_xor_b32 v34, 2, v33
  v_lshl_add_u32 v21, v34, 4, v32
  s_and_b32 s4, s3, 1
  s_lshl_b32 s4, s4, 6
  v_xor_b32 v20, s4, v20
  v_xor_b32 v21, s4, v21
  s_mov_b32 s37, 0
  s_mov_b32 s39, 4294868992
  s_mov_b32 s40, 24576
  s_waitcnt vmcnt(24)
  s_barrier
  ds_read_b128 a[0:3], v16 offset:0
  ds_read_b64_tr_b16 a[32:33], v20 offset:16384
  ds_read_b64_tr_b16 a[34:35], v20 offset:18432
  ds_read_b128 a[4:7], v16 offset:1024
  ds_read_b128 a[8:11], v16 offset:2048
  ds_read_b128 a[12:15], v16 offset:3072
  ds_read_b64_tr_b16 a[36:37], v21 offset:16384
  ds_read_b64_tr_b16 a[38:39], v21 offset:18432
  s_waitcnt lgkmcnt(0)
  v_mfma_f32_16x16x32_bf16 v[64:67], a[32:35], a[0:3], 0
  s_add_u32 s37, s37, 1
  ds_read_b128 a[16:19], v16 offset:8192
  ds_read_b64_tr_b16 a[40:41], v20 offset:20480
  v_mfma_f32_16x16x32_bf16 v[72:75], a[32:35], a[4:7], 0
  s_cmp_eq_u32 s37, 5
  s_cselect_b32 s37, 0, s37
  s_cselect_b32 s38, s39, s40
  ds_read_b64_tr_b16 a[42:43], v20 offset:22528
  v_mfma_f32_16x16x32_bf16 v[80:83], a[32:35], a[8:11], 0
  ds_read_b128 a[20:23], v16 offset:9216
  v_mfma_f32_16x16x32_bf16 v[88:91], a[32:35], a[12:15], 0
  ds_read_b128 a[24:27], v16 offset:10240
  ds_read_b128 a[28:31], v16 offset:11264
  v_mfma_f32_16x16x32_bf16 v[68:71], a[36:39], a[0:3], 0
  ds_read_b64_tr_b16 a[44:45], v21 offset:20480
  v_mfma_f32_16x16x32_bf16 v[76:79], a[36:39], a[4:7], 0
  ds_read_b64_tr_b16 a[46:47], v21 offset:22528
  v_mfma_f32_16x16x32_bf16 v[84:87], a[36:39], a[8:11], 0
  v_add_u32 v16, s38, v16
  v_add_u32 v20, s38, v20
  v_mfma_f32_16x16x32_bf16 v[92:95], a[36:39], a[12:15], 0
  v_add_u32 v21, s38, v21
  s_mov_b32 s35, 11
  .p2align 6
Lp6_loop:
  s_waitcnt vmcnt(18) lgkmcnt(0)
  s_barrier
  v_mfma_f32_16x16x32_bf16 v[64:67], a[40:43], a[16:19], v[64:67]
  s_add_u32 m0, s36, s48
  ds_read_b128 a[0:3], v16 offset:0
  ds_read_b64_tr_b16 a[32:33], v20 offset:16384
  v_mfma_f32_16x16x32_bf16 v[72:75], a[40:43], a[20:23], v[72:75]
  buffer_load_dwordx4 v24, s[12:15], s47 offen offset:0 lds
  ds_read_b64_tr_b16 a[34:35], v20 offset:18432
  v_mfma_f32_16x16x32_bf16 v[80:83], a[40:43], a[24:27], v[80:83]
  buffer_load_dwordx4 v25, s[12:15], s47 offen offset:1024 lds
  ds_read_b128 a[4:7], v16 offset:1024
  v_mfma_f32_16x16x32_bf16 v[88:91], a[40:43], a[28:31], v[88:91]
  s_add_u32 s47, s47, 131072
  s_mov_b32 m0, s36
  ds_read_b128 a[8:11], v16 offset:2048
  v_mfma_f32_16x16x32_bf16 v[68:71], a[44:47], a[16:19], v[68:71]
  buffer_load_dwordx4 v2, s[8:11], s46 offen offset:0 lds
  ds_read_b128 a[12:15], v16 offset:3072
  v_mfma_f32_16x16x32_bf16 v[76:79], a[44:47], a[20:23], v[76:79]
  ds_read_b64_tr_b16 a[36:37], v21 offset:16384
  ds_read_b64_tr_b16 a[38:39], v21 offset:18432
  v_mfma_f32_16x16x32_bf16 v[84:87], a[44:47], a[24:27], v[84:87]
  v_mfma_f32_16x16x32_bf16 v[92:95], a[44:47], a[28:31], v[92:95]
  s_waitcnt lgkmcnt(0)
  v_mfma_f32_16x16x32_bf16 v[64:67], a[32:35], a[0:3], v[64:67]
  buffer_load_dwordx4 v2, s[8:11], s46 offen offset:1024 lds
  ds_read_b128 a[16:19], v16 offset:8192
  v_mfma_f32_16x16x32_bf16 v[72:75], a[32:35], a[4:7], v[72:75]
  ds_read_b64_tr_b16 a[40:41], v20 offset:20480
  ds_read_b64_tr_b16 a[42:43], v20 offset:22528
  v_mfma_f32_16x16x32_bf16 v[80:83], a[32:35], a[8:11], v[80:83]
  buffer_load_dwordx4 v2, s[8:11], s46 offen offset:2048 lds
  ds_read_b128 a[20:23], v16 offset:9216
  v_mfma_f32_16x16x32_bf16 v[88:91], a[32:35], a[12:15], v[88:91]
  ds_read_b128 a[24:27], v16 offset:10240
  ds_read_b128 a[28:31], v16 offset:11264
  v_mfma_f32_16x16x32_bf16 v[68:71], a[36:39], a[0:3], v[68:71]
  buffer_load_dwordx4 v2, s[8:11], s46 offen offset:3072 lds
  ds_read_b64_tr_b16 a[44:45], v21 offset:20480
  v_mfma_f32_16x16x32_bf16 v[76:79], a[36:39], a[4:7], v[76:79]
  s_add_u32 s46, s46, 16384
  ds_read_b64_tr_b16 a[46:47], v21 offset:22528
  v_mfma_f32_16x16x32_bf16 v[84:87], a[36:39], a[8:11], v[84:87]
  s_add_u32 s36, s36, s38
  s_add_u32 s37, s37, 1
  s_cmp_eq_u32 s37, 5
  s_cselect_b32 s37, 0, s37
  s_cselect_b32 s38, s39, s40
  v_mfma_f32_16x16x32_bf16 v[92:95], a[36:39], a[12:15], v[92:95]
  s_sub_u32 s35, s35, 1
  v_add_u32 v16, s38, v16
  v_add_u32 v20, s38, v20
  v_add_u32 v21, s38, v21
  s_cmp_lg_u32 s35, 0
  s_cbranch_scc1 Lp6_loop
  s_waitcnt vmcnt(18) lgkmcnt(0)
  s_barrier
  v_mfma_f32_16x16x32_bf16 v[64:67], a[40:43], a[16:19], v[64:67]
  ds_read_b128 a[0:3], v16 offset:0
  ds_read_b64_tr_b16 a[32:33], v20 offset:16384
  v_mfma_f32_16x16x32_bf16 v[72:75], a[40:43], a[20:23], v[72:75]
  ds_read_b64_tr_b16 a[34:35], v20 offset:18432
  v_mfma_f32_16x16x32_bf16 v[80:83], a[40:43], a[24:27], v[80:83]
  ds_read_b128 a[4:7], v16 offset:1024
  v_mfma_f32_16x16x32_bf16 v[88:91], a[40:43], a[28:31], v[88:91]
  ds_read_b128 a[8:11], v16 offset:2048
  ds_read_b128 a[12:15], v16 offset:3072
  v_mfma_f32_16x16x32_bf16 v[68:71], a[44:47], a[16:19], v[68:71]
  ds_read_b64_tr_b16 a[36:37], v21 offset:16384
  v_mfma_f32_16x16x32_bf16 v[76:79], a[44:47], a[20:23], v[76:79]
  ds_read_b64_tr_b16 a[38:39], v21 offset:18432
  v_mfma_f32_16x16x32_bf16 v[84:87], a[44:47], a[24:27], v[84:87]
  v_mfma_f32_16x16x32_bf16 v[92:95], a[44:47], a[28:31], v[92:95]
  s_waitcnt lgkmcnt(0)
  v_mfma_f32_16x16x32_bf16 v[64:67], a[32:35], a[0:3], v[64:67]
  s_add_u32 s37, s37, 1
  ds_read_b128 a[16:19], v16 offset:8192
  ds_read_b64_tr_b16 a[40:41], v20 offset:20480
  v_mfma_f32_16x16x32_bf16 v[72:75], a[32:35], a[4:7], v[72:75]
  s_cmp_eq_u32 s37, 5
  s_cselect_b32 s37, 0, s37
  s_cselect_b32 s38, s39, s40
  ds_read_b64_tr_b16 a[42:43], v20 offset:22528
  v_mfma_f32_16x16x32_bf16 v[80:83], a[32:35], a[8:11], v[80:83]
  ds_read_b128 a[20:23], v16 offset:9216
  v_mfma_f32_16x16x32_bf16 v[88:91], a[32:35], a[12:15], v[88:91]
  ds_read_b128 a[24:27], v16 offset:10240
  ds_read_b128 a[28:31], v16 offset:11264
  v_mfma_f32_16x16x32_bf16 v[68:71], a[36:39], a[0:3], v[68:71]
  ds_read_b64_tr_b16 a[44:45], v21 offset:20480
  v_mfma_f32_16x16x32_bf16 v[76:79], a[36:39], a[4:7], v[76:79]
  ds_read_b64_tr_b16 a[46:47], v21 offset:22528
  v_mfma_f32_16x16x32_bf16 v[84:87], a[36:39], a[8:11], v[84:87]
  v_add_u32 v16, s38, v16
  v_add_u32 v20, s38, v20
  v_mfma_f32_16x16x32_bf16 v[92:95], a[36:39], a[12:15], v[92:95]
  v_add_u32 v21, s38, v21
  s_waitcnt vmcnt(12) lgkmcnt(0)
  s_barrier
  v_mfma_f32_16x16x32_bf16 v[64:67], a[40:43], a[16:19], v[64:67]
  ds_read_b128 a[0:3], v16 offset:0
  ds_read_b64_tr_b16 a[32:33], v20 offset:16384
  v_mfma_f32_16x16x32_bf16 v[72:75], a[40:43], a[20:23], v[72:75]
  ds_read_b64_tr_b16 a[34:35], v20 offset:18432
  v_mfma_f32_16x16x32_bf16 v[80:83], a[40:43], a[24:27], v[80:83]
  ds_read_b128 a[4:7], v16 offset:1024
  v_mfma_f32_16x16x32_bf16 v[88:91], a[40:43], a[28:31], v[88:91]
  ds_read_b128 a[8:11], v16 offset:2048
  ds_read_b128 a[12:15], v16 offset:3072
  v_mfma_f32_16x16x32_bf16 v[68:71], a[44:47], a[16:19], v[68:71]
  ds_read_b64_tr_b16 a[36:37], v21 offset:16384
  v_mfma_f32_16x16x32_bf16 v[76:79], a[44:47], a[20:23], v[76:79]
  ds_read_b64_tr_b16 a[38:39], v21 offset:18432
  v_mfma_f32_16x16x32_bf16 v[84:87], a[44:47], a[24:27], v[84:87]
  v_mfma_f32_16x16x32_bf16 v[92:95], a[44:47], a[28:31], v[92:95]
  s_waitcnt lgkmcnt(0)
  v_mfma_f32_16x16x32_bf16 v[64:67], a[32:35], a[0:3], v[64:67]
  s_add_u32 s37, s37, 1
  ds_read_b128 a[16:19], v16 offset:8192
  ds_read_b64_tr_b16 a[40:41], v20 offset:20480
  v_mfma_f32_16x16x32_bf16 v[72:75], a[32:35], a[4:7], v[72:75]
  s_cmp_eq_u32 s37, 5
  s_cselect_b32 s37, 0, s37
  s_cselect_b32 s38, s39, s40
  ds_read_b64_tr_b16 a[42:43], v20 offset:22528
  v_mfma_f32_16x16x32_bf16 v[80:83], a[32:35], a[8:11], v[80:83]
  ds_read_b128 a[20:23], v16 offset:9216
  v_mfma_f32_16x16x32_bf16 v[88:91], a[32:35], a[12:15], v[88:91]
  ds_read_b128 a[24:27], v16 offset:10240
  ds_read_b128 a[28:31], v16 offset:11264
  v_mfma_f32_16x16x32_bf16 v[68:71], a[36:39], a[0:3], v[68:71]
  ds_read_b64_tr_b16 a[44:45], v21 offset:20480
  v_mfma_f32_16x16x32_bf16 v[76:79], a[36:39], a[4:7], v[76:79]
  ds_read_b64_tr_b16 a[46:47], v21 offset:22528
  v_mfma_f32_16x16x32_bf16 v[84:87], a[36:39], a[8:11], v[84:87]
  v_add_u32 v16, s38, v16
  v_add_u32 v20, s38, v20
  v_mfma_f32_16x16x32_bf16 v[92:95], a[36:39], a[12:15], v[92:95]
  v_add_u32 v21, s38, v21
  s_waitcnt vmcnt(6) lgkmcnt(0)
  s_barrier
  v_mfma_f32_16x16x32_bf16 v[64:67], a[40:43], a[16:19], v[64:67]
  ds_read_b128 a[0:3], v16 offset:0
  ds_read_b64_tr_b16 a[32:33], v20 offset:16384
  v_mfma_f32_16x16x32_bf16 v[72:75], a[40:43], a[20:23], v[72:75]
  ds_read_b64_tr_b16 a[34:35], v20 offset:18432
  v_mfma_f32_16x16x32_bf16 v[80:83], a[40:43], a[24:27], v[80:83]
  ds_read_b128 a[4:7], v16 offset:1024
  v_mfma_f32_16x16x32_bf16 v[88:91], a[40:43], a[28:31], v[88:91]
  ds_read_b128 a[8:11], v16 offset:2048
  ds_read_b128 a[12:15], v16 offset:3072
  v_mfma_f32_16x16x32_bf16 v[68:71], a[44:47], a[16:19], v[68:71]
  ds_read_b64_tr_b16 a[36:37], v21 offset:16384
  v_mfma_f32_16x16x32_bf16 v[76:79], a[44:47], a[20:23], v[76:79]
  ds_read_b64_tr_b16 a[38:39], v21 offset:18432
  v_mfma_f32_16x16x32_bf16 v[84:87], a[44:47], a[24:27], v[84:87]
  v_mfma_f32_16x16x32_bf16 v[92:95], a[44:47], a[28:31], v[92:95]
  s_waitcnt lgkmcnt(0)
  v_mfma_f32_16x16x32_bf16 v[64:67], a[32:35], a[0:3], v[64:67]
  s_add_u32 s37, s37, 1
  ds_read_b128 a[16:19], v16 offset:8192
  ds_read_b64_tr_b16 a[40:41], v20 offset:20480
  v_mfma_f32_16x16x32_bf16 v[72:75], a[32:35], a[4:7], v[72:75]
  s_cmp_eq_u32 s37, 5
  s_cselect_b32 s37, 0, s37
  s_cselect_b32 s38, s39, s40
  ds_read_b64_tr_b16 a[42:43], v20 offset:22528
  v_mfma_f32_16x16x32_bf16 v[80:83], a[32:35], a[8:11], v[80:83]
  ds_read_b128 a[20:23], v16 offset:9216
  v_mfma_f32_16x16x32_bf16 v[88:91], a[32:35], a[12:15], v[88:91]
  ds_read_b128 a[24:27], v16 offset:10240
  ds_read_b128 a[28:31], v16 offset:11264
  v_mfma_f32_16x16x32_bf16 v[68:71], a[36:39], a[0:3], v[68:71]
  ds_read_b64_tr_b16 a[44:45], v21 offset:20480
  v_mfma_f32_16x16x32_bf16 v[76:79], a[36:39], a[4:7], v[76:79]
  ds_read_b64_tr_b16 a[46:47], v21 offset:22528
  v_mfma_f32_16x16x32_bf16 v[84:87], a[36:39], a[8:11], v[84:87]
  v_add_u32 v16, s38, v16
  v_add_u32 v20, s38, v20
  v_mfma_f32_16x16x32_bf16 v[92:95], a[36:39], a[12:15], v[92:95]
  v_add_u32 v21, s38, v21
  s_waitcnt vmcnt(0) lgkmcnt(0)
  s_barrier
  v_mfma_f32_16x16x32_bf16 v[64:67], a[40:43], a[16:19], v[64:67]
  ds_read_b128 a[0:3], v16 offset:0
  ds_read_b64_tr_b16 a[32:33], v20 offset:16384
  v_mfma_f32_16x16x32_bf16 v[72:75], a[40:43], a[20:23], v[72:75]
  ds_read_b64_tr_b16 a[34:35], v20 offset:18432
  v_mfma_f32_16x16x32_bf16 v[80:83], a[40:43], a[24:27], v[80:83]
  ds_read_b128 a[4:7], v16 offset:1024
  v_mfma_f32_16x16x32_bf16 v[88:91], a[40:43], a[28:31], v[88:91]
  ds_read_b128 a[8:11], v16 offset:2048
  ds_read_b128 a[12:15], v16 offset:3072
  v_mfma_f32_16x16x32_bf16 v[68:71], a[44:47], a[16:19], v[68:71]
  ds_read_b64_tr_b16 a[36:37], v21 offset:16384
  v_mfma_f32_16x16x32_bf16 v[76:79], a[44:47], a[20:23], v[76:79]
  ds_read_b64_tr_b16 a[38:39], v21 offset:18432
  v_mfma_f32_16x16x32_bf16 v[84:87], a[44:47], a[24:27], v[84:87]
  v_mfma_f32_16x16x32_bf16 v[92:95], a[44:47], a[28:31], v[92:95]
  s_waitcnt lgkmcnt(0)
  v_mfma_f32_16x16x32_bf16 v[64:67], a[32:35], a[0:3], v[64:67]
  ds_read_b128 a[16:19], v16 offset:8192
  ds_read_b64_tr_b16 a[40:41], v20 offset:20480
  v_mfma_f32_16x16x32_bf16 v[72:75], a[32:35], a[4:7], v[72:75]
  ds_read_b64_tr_b16 a[42:43], v20 offset:22528
  v_mfma_f32_16x16x32_bf16 v[80:83], a[32:35], a[8:11], v[80:83]
  ds_read_b128 a[20:23], v16 offset:9216
  v_mfma_f32_16x16x32_bf16 v[88:91], a[32:35], a[12:15], v[88:91]
  ds_read_b128 a[24:27], v16 offset:10240
  ds_read_b128 a[28:31], v16 offset:11264
  v_mfma_f32_16x16x32_bf16 v[68:71], a[36:39], a[0:3], v[68:71]
  ds_read_b64_tr_b16 a[44:45], v21 offset:20480
  v_mfma_f32_16x16x32_bf16 v[76:79], a[36:39], a[4:7], v[76:79]
  ds_read_b64_tr_b16 a[46:47], v21 offset:22528
  v_mfma_f32_16x16x32_bf16 v[84:87], a[36:39], a[8:11], v[84:87]
  v_mfma_f32_16x16x32_bf16 v[92:95], a[36:39], a[12:15], v[92:95]
  s_waitcnt lgkmcnt(0)
  s_barrier
  v_mfma_f32_16x16x32_bf16 v[64:67], a[40:43], a[16:19], v[64:67]
  v_mfma_f32_16x16x32_bf16 v[72:75], a[40:43], a[20:23], v[72:75]
  v_mfma_f32_16x16x32_bf16 v[80:83], a[40:43], a[24:27], v[80:83]
  v_mfma_f32_16x16x32_bf16 v[88:91], a[40:43], a[28:31], v[88:91]
  v_mfma_f32_16x16x32_bf16 v[68:71], a[44:47], a[16:19], v[68:71]
  v_mfma_f32_16x16x32_bf16 v[76:79], a[44:47], a[20:23], v[76:79]
  v_mfma_f32_16x16x32_bf16 v[84:87], a[44:47], a[24:27], v[84:87]
  v_mfma_f32_16x16x32_bf16 v[92:95], a[44:47], a[28:31], v[92:95]
  s_add_u32 s8, s86, 67108864
  s_addc_u32 s9, s87, 0
  s_mov_b32 s10, 16777216
  s_mov_b32 s11, 0x00020000
  s_mov_b32 s12, s74
  s_mov_b32 s13, s75
  s_mov_b32 s14, 8388608
  s_mov_b32 s15, 0x00020000
  s_lshl_b32 s36, s3, 12
  s_lshl_b32 s46, s54, 20
  s_add_u32 s46, s46, s36
  s_lshl_b32 s47, s55, 7
  s_add_u32 m0, s36, s48
  s_nop 0
  buffer_load_dwordx4 v24, s[12:15], s47 offen offset:0 lds
  buffer_load_dwordx4 v25, s[12:15], s47 offen offset:1024 lds
  s_add_u32 s47, s47, 131072
  s_mov_b32 m0, s36
  s_nop 0
  buffer_load_dwordx4 v2, s[8:11], s46 offen offset:0 lds
  buffer_load_dwordx4 v2, s[8:11], s46 offen offset:1024 lds
  buffer_load_dwordx4 v2, s[8:11], s46 offen offset:2048 lds
  buffer_load_dwordx4 v2, s[8:11], s46 offen offset:3072 lds
  s_add_u32 s46, s46, 16384
  s_add_u32 m0, s36, s48
  s_add_u32 m0, m0, 24576
  s_nop 0
  buffer_load_dwordx4 v24, s[12:15], s47 offen offset:0 lds
  buffer_load_dwordx4 v25, s[12:15], s47 offen offset:1024 lds
  s_add_u32 s47, s47, 131072
  s_add_u32 m0, s36, 24576
  s_nop 0
  buffer_load_dwordx4 v2, s[8:11], s46 offen offset:0 lds
  buffer_load_dwordx4 v2, s[8:11], s46 offen offset:1024 lds
  buffer_load_dwordx4 v2, s[8:11], s46 offen offset:2048 lds
  buffer_load_dwordx4 v2, s[8:11], s46 offen offset:3072 lds
  s_add_u32 s46, s46, 16384
  s_add_u32 m0, s36, s48
  s_add_u32 m0, m0, 49152
  s_nop 0
  buffer_load_dwordx4 v24, s[12:15], s47 offen offset:0 lds
  buffer_load_dwordx4 v25, s[12:15], s47 offen offset:1024 lds
  s_add_u32 s47, s47, 131072
  s_add_u32 m0, s36, 49152
  s_nop 0
  buffer_load_dwordx4 v2, s[8:11], s46 offen offset:0 lds
  buffer_load_dwordx4 v2, s[8:11], s46 offen offset:1024 lds
  buffer_load_dwordx4 v2, s[8:11], s46 offen offset:2048 lds
  buffer_load_dwordx4 v2, s[8:11], s46 offen offset:3072 lds
  s_add_u32 s46, s46, 16384
  s_add_u32 m0, s36, s48
  s_add_u32 m0, m0, 73728
  s_nop 0
  buffer_load_dwordx4 v24, s[12:15], s47 offen offset:0 lds
  buffer_load_dwordx4 v25, s[12:15], s47 offen offset:1024 lds
  s_add_u32 s47, s47, 131072
  s_add_u32 m0, s36, 73728
  s_nop 0
  buffer_load_dwordx4 v2, s[8:11], s46 offen offset:0 lds
  buffer_load_dwordx4 v2, s[8:11], s46 offen offset:1024 lds
  buffer_load_dwordx4 v2, s[8:11], s46 offen offset:2048 lds
  buffer_load_dwordx4 v2, s[8:11], s46 offen offset:3072 lds
  s_add_u32 s46, s46, 16384
  s_add_u32 m0, s36, s48
  s_add_u32 m0, m0, 98304
  s_nop 0
  buffer_load_dwordx4 v24, s[12:15], s47 offen offset:0 lds
  buffer_load_dwordx4 v25, s[12:15], s47 offen offset:1024 lds
  s_add_u32 s47, s47, 131072
  s_add_u32 m0, s36, 98304
  s_nop 0
  buffer_load_dwordx4 v2, s[8:11], s46 offen offset:0 lds
  buffer_load_dwordx4 v2, s[8:11], s46 offen offset:1024 lds
  buffer_load_dwordx4 v2, s[8:11], s46 offen offset:2048 lds
  buffer_load_dwordx4 v2, s[8:11], s46 offen offset:3072 lds
  s_add_u32 s46, s46, 16384
  s_mov_b32 s16, s82
  s_mov_b32 s17, s83
  s_mov_b32 s18, 8388608
  s_mov_b32 s19, 0x00020000
  v_and_b32 v32, 15, v1
  v_lshlrev_b32 v32, 12, v32
  v_bfe_u32 v33, v1, 4, 1
  v_lshrrev_b32 v34, 5, v1
  v_lshl_or_b32 v33, v33, 1, v34
  v_lshl_add_u32 v32, v33, 4, v32
  s_lshl_b32 s4, s54, 19
  s_lshl_b32 s5, s55, 7
  s_add_u32 s4, s4, s5
  s_and_b32 s5, s3, 1
  s_lshl_b32 s5, s5, 6
  s_add_u32 s4, s4, s5
  s_lshr_b32 s5, s3, 1
  s_lshl_b32 s5, s5, 18
  s_add_u32 s4, s4, s5
  s_add_u32 s4, s4, 2048
  v_cvt_pk_bf16_f32 v36, v64, v65
  v_cvt_pk_bf16_f32 v37, v66, v67
  v_cvt_pk_bf16_f32 v38, v68, v69
  v_cvt_pk_bf16_f32 v39, v70, v71
  v_cvt_pk_bf16_f32 v40, v72, v73
  v_cvt_pk_bf16_f32 v41, v74, v75
  v_cvt_pk_bf16_f32 v42, v76, v77
  v_cvt_pk_bf16_f32 v43, v78, v79
  v_cvt_pk_bf16_f32 v44, v80, v81
  v_cvt_pk_bf16_f32 v45, v82, v83
  v_cvt_pk_bf16_f32 v46, v84, v85
  v_cvt_pk_bf16_f32 v47, v86, v87
  v_cvt_pk_bf16_f32 v48, v88, v89
  v_cvt_pk_bf16_f32 v49, v90, v91
  v_cvt_pk_bf16_f32 v50, v92, v93
  v_cvt_pk_bf16_f32 v51, v94, v95
  v_permlane16_swap_b32 v36, v38
  v_permlane16_swap_b32 v37, v39
  s_add_u32 s5, s4, 0
  buffer_store_dwordx4 v[36:39], v32, s[16:19], s5 offen
  v_permlane16_swap_b32 v40, v42
  v_permlane16_swap_b32 v41, v43
  s_add_u32 s5, s4, 65536
  buffer_store_dwordx4 v[40:43], v32, s[16:19], s5 offen
  v_permlane16_swap_b32 v44, v46
  v_permlane16_swap_b32 v45, v47
  s_add_u32 s5, s4, 131072
  buffer_store_dwordx4 v[44:47], v32, s[16:19], s5 offen
  v_permlane16_swap_b32 v48, v50
  v_permlane16_swap_b32 v49, v51
  s_add_u32 s5, s4, 196608
  buffer_store_dwordx4 v[48:51], v32, s[16:19], s5 offen
  s_lshr_b32 s4, s3, 1
  s_lshl_b32 s4, s4, 12
  v_add_u32 v16, s4, v2
  v_lshrrev_b32 v32, 2, v1
  v_and_b32 v33, 6, v32
  v_lshlrev_b32 v32, 7, v32
  v_and_b32 v34, 1, v1
  v_lshl_add_u32 v32, v34, 3, v32
  v_add_u32 v32, 0, v32
  v_bfe_u32 v34, v1, 1, 1
  v_xor_b32 v33, v33, v34
  v_xor_b32 v34, 0, v33
  v_lshl_add_u32 v20, v34, 4, v32
  v_xor_b32 v34, 2, v33
  v_lshl_add_u32 v21, v34, 4, v32
  s_and_b32 s4, s3, 1
  s_lshl_b32 s4, s4, 6
  v_xor_b32 v20, s4, v20
  v_xor_b32 v21, s4, v21
  s_mov_b32 s37, 0
  s_mov_b32 s39, 4294868992
  s_mov_b32 s40, 24576
  s_waitcnt vmcnt(28)
  s_barrier
  ds_read_b128 a[0:3], v16 offset:0
  ds_read_b64_tr_b16 a[32:33], v20 offset:16384
  ds_read_b64_tr_b16 a[34:35], v20 offset:18432
  ds_read_b128 a[4:7], v16 offset:1024
  ds_read_b128 a[8:11], v16 offset:2048
  ds_read_b128 a[12:15], v16 offset:3072
  ds_read_b64_tr_b16 a[36:37], v21 offset:16384
  ds_read_b64_tr_b16 a[38:39], v21 offset:18432
  s_waitcnt lgkmcnt(0)
  v_mfma_f32_16x16x32_bf16 v[64:67], a[32:35], a[0:3], 0
  s_add_u32 s37, s37, 1
  ds_read_b128 a[16:19], v16 offset:8192
  ds_read_b64_tr_b16 a[40:41], v20 offset:20480
  v_mfma_f32_16x16x32_bf16 v[72:75], a[32:35], a[4:7], 0
  s_cmp_eq_u32 s37, 5
  s_cselect_b32 s37, 0, s37
  s_cselect_b32 s38, s39, s40
  ds_read_b64_tr_b16 a[42:43], v20 offset:22528
  v_mfma_f32_16x16x32_bf16 v[80:83], a[32:35], a[8:11], 0
  ds_read_b128 a[20:23], v16 offset:9216
  v_mfma_f32_16x16x32_bf16 v[88:91], a[32:35], a[12:15], 0
  ds_read_b128 a[24:27], v16 offset:10240
  ds_read_b128 a[28:31], v16 offset:11264
  v_mfma_f32_16x16x32_bf16 v[68:71], a[36:39], a[0:3], 0
  ds_read_b64_tr_b16 a[44:45], v21 offset:20480
  v_mfma_f32_16x16x32_bf16 v[76:79], a[36:39], a[4:7], 0
  ds_read_b64_tr_b16 a[46:47], v21 offset:22528
  v_mfma_f32_16x16x32_bf16 v[84:87], a[36:39], a[8:11], 0
  v_add_u32 v16, s38, v16
  v_add_u32 v20, s38, v20
  v_mfma_f32_16x16x32_bf16 v[92:95], a[36:39], a[12:15], 0
  v_add_u32 v21, s38, v21
  s_mov_b32 s35, 59
  .p2align 6
Lp7_loop:
  s_waitcnt vmcnt(18) lgkmcnt(0)
  s_barrier
  v_mfma_f32_16x16x32_bf16 v[64:67], a[40:43], a[16:19], v[64:67]
  s_add_u32 m0, s36, s48
  ds_read_b128 a[0:3], v16 offset:0
  ds_read_b64_tr_b16 a[32:33], v20 offset:16384
  v_mfma_f32_16x16x32_bf16 v[72:75], a[40:43], a[20:23], v[72:75]
  buffer_load_dwordx4 v24, s[12:15], s47 offen offset:0 lds
  ds_read_b64_tr_b16 a[34:35], v20 offset:18432
  v_mfma_f32_16x16x32_bf16 v[80:83], a[40:43], a[24:27], v[80:83]
  buffer_load_dwordx4 v25, s[12:15], s47 offen offset:1024 lds
  ds_read_b128 a[4:7], v16 offset:1024
  v_mfma_f32_16x16x32_bf16 v[88:91], a[40:43], a[28:31], v[88:91]
  s_add_u32 s47, s47, 131072
  s_mov_b32 m0, s36
  ds_read_b128 a[8:11], v16 offset:2048
  v_mfma_f32_16x16x32_bf16 v[68:71], a[44:47], a[16:19], v[68:71]
  buffer_load_dwordx4 v2, s[8:11], s46 offen offset:0 lds
  ds_read_b128 a[12:15], v16 offset:3072
  v_mfma_f32_16x16x32_bf16 v[76:79], a[44:47], a[20:23], v[76:79]
  ds_read_b64_tr_b16 a[36:37], v21 offset:16384
  ds_read_b64_tr_b16 a[38:39], v21 offset:18432
  v_mfma_f32_16x16x32_bf16 v[84:87], a[44:47], a[24:27], v[84:87]
  v_mfma_f32_16x16x32_bf16 v[92:95], a[44:47], a[28:31], v[92:95]
  s_waitcnt lgkmcnt(0)
  v_mfma_f32_16x16x32_bf16 v[64:67], a[32:35], a[0:3], v[64:67]
  buffer_load_dwordx4 v2, s[8:11], s46 offen offset:1024 lds
  ds_read_b128 a[16:19], v16 offset:8192
  v_mfma_f32_16x16x32_bf16 v[72:75], a[32:35], a[4:7], v[72:75]
  ds_read_b64_tr_b16 a[40:41], v20 offset:20480
  ds_read_b64_tr_b16 a[42:43], v20 offset:22528
  v_mfma_f32_16x16x32_bf16 v[80:83], a[32:35], a[8:11], v[80:83]
  buffer_load_dwordx4 v2, s[8:11], s46 offen offset:2048 lds
  ds_read_b128 a[20:23], v16 offset:9216
  v_mfma_f32_16x16x32_bf16 v[88:91], a[32:35], a[12:15], v[88:91]
  ds_read_b128 a[24:27], v16 offset:10240
  ds_read_b128 a[28:31], v16 offset:11264
  v_mfma_f32_16x16x32_bf16 v[68:71], a[36:39], a[0:3], v[68:71]
  buffer_load_dwordx4 v2, s[8:11], s46 offen offset:3072 lds
  ds_read_b64_tr_b16 a[44:45], v21 offset:20480
  v_mfma_f32_16x16x32_bf16 v[76:79], a[36:39], a[4:7], v[76:79]
  s_add_u32 s46, s46, 16384
  ds_read_b64_tr_b16 a[46:47], v21 offset:22528
  v_mfma_f32_16x16x32_bf16 v[84:87], a[36:39], a[8:11], v[84:87]
  s_add_u32 s36, s36, s38
  s_add_u32 s37, s37, 1
  s_cmp_eq_u32 s37, 5
  s_cselect_b32 s37, 0, s37
  s_cselect_b32 s38, s39, s40
  v_mfma_f32_16x16x32_bf16 v[92:95], a[36:39], a[12:15], v[92:95]
  s_sub_u32 s35, s35, 1
  v_add_u32 v16, s38, v16
  v_add_u32 v20, s38, v20
  v_add_u32 v21, s38, v21
  s_cmp_lg_u32 s35, 0
  s_cbranch_scc1 Lp7_loop
  s_waitcnt vmcnt(18) lgkmcnt(0)
  s_barrier
  v_mfma_f32_16x16x32_bf16 v[64:67], a[40:43], a[16:19], v[64:67]
  ds_read_b128 a[0:3], v16 offset:0
  ds_read_b64_tr_b16 a[32:33], v20 offset:16384
  v_mfma_f32_16x16x32_bf16 v[72:75], a[40:43], a[20:23], v[72:75]
  ds_read_b64_tr_b16 a[34:35], v20 offset:18432
  v_mfma_f32_16x16x32_bf16 v[80:83], a[40:43], a[24:27], v[80:83]
  ds_read_b128 a[4:7], v16 offset:1024
  v_mfma_f32_16x16x32_bf16 v[88:91], a[40:43], a[28:31], v[88:91]
  ds_read_b128 a[8:11], v16 offset:2048
  ds_read_b128 a[12:15], v16 offset:3072
  v_mfma_f32_16x16x32_bf16 v[68:71], a[44:47], a[16:19], v[68:71]
  ds_read_b64_tr_b16 a[36:37], v21 offset:16384
  v_mfma_f32_16x16x32_bf16 v[76:79], a[44:47], a[20:23], v[76:79]
  ds_read_b64_tr_b16 a[38:39], v21 offset:18432
  v_mfma_f32_16x16x32_bf16 v[84:87], a[44:47], a[24:27], v[84:87]
  v_mfma_f32_16x16x32_bf16 v[92:95], a[44:47], a[28:31], v[92:95]
  s_waitcnt lgkmcnt(0)
  v_mfma_f32_16x16x32_bf16 v[64:67], a[32:35], a[0:3], v[64:67]
  s_add_u32 s37, s37, 1
  ds_read_b128 a[16:19], v16 offset:8192
  ds_read_b64_tr_b16 a[40:41], v20 offset:20480
  v_mfma_f32_16x16x32_bf16 v[72:75], a[32:35], a[4:7], v[72:75]
  s_cmp_eq_u32 s37, 5
  s_cselect_b32 s37, 0, s37
  s_cselect_b32 s38, s39, s40
  ds_read_b64_tr_b16 a[42:43], v20 offset:22528
  v_mfma_f32_16x16x32_bf16 v[80:83], a[32:35], a[8:11], v[80:83]
  ds_read_b128 a[20:23], v16 offset:9216
  v_mfma_f32_16x16x32_bf16 v[88:91], a[32:35], a[12:15], v[88:91]
  ds_read_b128 a[24:27], v16 offset:10240
  ds_read_b128 a[28:31], v16 offset:11264
  v_mfma_f32_16x16x32_bf16 v[68:71], a[36:39], a[0:3], v[68:71]
  ds_read_b64_tr_b16 a[44:45], v21 offset:20480
  v_mfma_f32_16x16x32_bf16 v[76:79], a[36:39], a[4:7], v[76:79]
  ds_read_b64_tr_b16 a[46:47], v21 offset:22528
  v_mfma_f32_16x16x32_bf16 v[84:87], a[36:39], a[8:11], v[84:87]
  v_add_u32 v16, s38, v16
  v_add_u32 v20, s38, v20
  v_mfma_f32_16x16x32_bf16 v[92:95], a[36:39], a[12:15], v[92:95]
  v_add_u32 v21, s38, v21
  s_waitcnt vmcnt(12) lgkmcnt(0)
  s_barrier
  v_mfma_f32_16x16x32_bf16 v[64:67], a[40:43], a[16:19], v[64:67]
  ds_read_b128 a[0:3], v16 offset:0
  ds_read_b64_tr_b16 a[32:33], v20 offset:16384
  v_mfma_f32_16x16x32_bf16 v[72:75], a[40:43], a[20:23], v[72:75]
  ds_read_b64_tr_b16 a[34:35], v20 offset:18432
  v_mfma_f32_16x16x32_bf16 v[80:83], a[40:43], a[24:27], v[80:83]
  ds_read_b128 a[4:7], v16 offset:1024
  v_mfma_f32_16x16x32_bf16 v[88:91], a[40:43], a[28:31], v[88:91]
  ds_read_b128 a[8:11], v16 offset:2048
  ds_read_b128 a[12:15], v16 offset:3072
  v_mfma_f32_16x16x32_bf16 v[68:71], a[44:47], a[16:19], v[68:71]
  ds_read_b64_tr_b16 a[36:37], v21 offset:16384
  v_mfma_f32_16x16x32_bf16 v[76:79], a[44:47], a[20:23], v[76:79]
  ds_read_b64_tr_b16 a[38:39], v21 offset:18432
  v_mfma_f32_16x16x32_bf16 v[84:87], a[44:47], a[24:27], v[84:87]
  v_mfma_f32_16x16x32_bf16 v[92:95], a[44:47], a[28:31], v[92:95]
  s_waitcnt lgkmcnt(0)
  v_mfma_f32_16x16x32_bf16 v[64:67], a[32:35], a[0:3], v[64:67]
  s_add_u32 s37, s37, 1
  ds_read_b128 a[16:19], v16 offset:8192
  ds_read_b64_tr_b16 a[40:41], v20 offset:20480
  v_mfma_f32_16x16x32_bf16 v[72:75], a[32:35], a[4:7], v[72:75]
  s_cmp_eq_u32 s37, 5
  s_cselect_b32 s37, 0, s37
  s_cselect_b32 s38, s39, s40
  ds_read_b64_tr_b16 a[42:43], v20 offset:22528
  v_mfma_f32_16x16x32_bf16 v[80:83], a[32:35], a[8:11], v[80:83]
  ds_read_b128 a[20:23], v16 offset:9216
  v_mfma_f32_16x16x32_bf16 v[88:91], a[32:35], a[12:15], v[88:91]
  ds_read_b128 a[24:27], v16 offset:10240
  ds_read_b128 a[28:31], v16 offset:11264
  v_mfma_f32_16x16x32_bf16 v[68:71], a[36:39], a[0:3], v[68:71]
  ds_read_b64_tr_b16 a[44:45], v21 offset:20480
  v_mfma_f32_16x16x32_bf16 v[76:79], a[36:39], a[4:7], v[76:79]
  ds_read_b64_tr_b16 a[46:47], v21 offset:22528
  v_mfma_f32_16x16x32_bf16 v[84:87], a[36:39], a[8:11], v[84:87]
  v_add_u32 v16, s38, v16
  v_add_u32 v20, s38, v20
  v_mfma_f32_16x16x32_bf16 v[92:95], a[36:39], a[12:15], v[92:95]
  v_add_u32 v21, s38, v21
  s_waitcnt vmcnt(6) lgkmcnt(0)
  s_barrier
  v_mfma_f32_16x16x32_bf16 v[64:67], a[40:43], a[16:19], v[64:67]
  ds_read_b128 a[0:3], v16 offset:0
  ds_read_b64_tr_b16 a[32:33], v20 offset:16384
  v_mfma_f32_16x16x32_bf16 v[72:75], a[40:43], a[20:23], v[72:75]
  ds_read_b64_tr_b16 a[34:35], v20 offset:18432
  v_mfma_f32_16x16x32_bf16 v[80:83], a[40:43], a[24:27], v[80:83]
  ds_read_b128 a[4:7], v16 offset:1024
  v_mfma_f32_16x16x32_bf16 v[88:91], a[40:43], a[28:31], v[88:91]
  ds_read_b128 a[8:11], v16 offset:2048
  ds_read_b128 a[12:15], v16 offset:3072
  v_mfma_f32_16x16x32_bf16 v[68:71], a[44:47], a[16:19], v[68:71]
  ds_read_b64_tr_b16 a[36:37], v21 offset:16384
  v_mfma_f32_16x16x32_bf16 v[76:79], a[44:47], a[20:23], v[76:79]
  ds_read_b64_tr_b16 a[38:39], v21 offset:18432
  v_mfma_f32_16x16x32_bf16 v[84:87], a[44:47], a[24:27], v[84:87]
  v_mfma_f32_16x16x32_bf16 v[92:95], a[44:47], a[28:31], v[92:95]
  s_waitcnt lgkmcnt(0)
  v_mfma_f32_16x16x32_bf16 v[64:67], a[32:35], a[0:3], v[64:67]
  s_add_u32 s37, s37, 1
  ds_read_b128 a[16:19], v16 offset:8192
  ds_read_b64_tr_b16 a[40:41], v20 offset:20480
  v_mfma_f32_16x16x32_bf16 v[72:75], a[32:35], a[4:7], v[72:75]
  s_cmp_eq_u32 s37, 5
  s_cselect_b32 s37, 0, s37
  s_cselect_b32 s38, s39, s40
  ds_read_b64_tr_b16 a[42:43], v20 offset:22528
  v_mfma_f32_16x16x32_bf16 v[80:83], a[32:35], a[8:11], v[80:83]
  ds_read_b128 a[20:23], v16 offset:9216
  v_mfma_f32_16x16x32_bf16 v[88:91], a[32:35], a[12:15], v[88:91]
  ds_read_b128 a[24:27], v16 offset:10240
  ds_read_b128 a[28:31], v16 offset:11264
  v_mfma_f32_16x16x32_bf16 v[68:71], a[36:39], a[0:3], v[68:71]
  ds_read_b64_tr_b16 a[44:45], v21 offset:20480
  v_mfma_f32_16x16x32_bf16 v[76:79], a[36:39], a[4:7], v[76:79]
  ds_read_b64_tr_b16 a[46:47], v21 offset:22528
  v_mfma_f32_16x16x32_bf16 v[84:87], a[36:39], a[8:11], v[84:87]
  v_add_u32 v16, s38, v16
  v_add_u32 v20, s38, v20
  v_mfma_f32_16x16x32_bf16 v[92:95], a[36:39], a[12:15], v[92:95]
  v_add_u32 v21, s38, v21
  s_waitcnt vmcnt(0) lgkmcnt(0)
  s_barrier
  v_mfma_f32_16x16x32_bf16 v[64:67], a[40:43], a[16:19], v[64:67]
  ds_read_b128 a[0:3], v16 offset:0
  ds_read_b64_tr_b16 a[32:33], v20 offset:16384
  v_mfma_f32_16x16x32_bf16 v[72:75], a[40:43], a[20:23], v[72:75]
  ds_read_b64_tr_b16 a[34:35], v20 offset:18432
  v_mfma_f32_16x16x32_bf16 v[80:83], a[40:43], a[24:27], v[80:83]
  ds_read_b128 a[4:7], v16 offset:1024
  v_mfma_f32_16x16x32_bf16 v[88:91], a[40:43], a[28:31], v[88:91]
  ds_read_b128 a[8:11], v16 offset:2048
  ds_read_b128 a[12:15], v16 offset:3072
  v_mfma_f32_16x16x32_bf16 v[68:71], a[44:47], a[16:19], v[68:71]
  ds_read_b64_tr_b16 a[36:37], v21 offset:16384
  v_mfma_f32_16x16x32_bf16 v[76:79], a[44:47], a[20:23], v[76:79]
  ds_read_b64_tr_b16 a[38:39], v21 offset:18432
  v_mfma_f32_16x16x32_bf16 v[84:87], a[44:47], a[24:27], v[84:87]
  v_mfma_f32_16x16x32_bf16 v[92:95], a[44:47], a[28:31], v[92:95]
  s_waitcnt lgkmcnt(0)
  v_mfma_f32_16x16x32_bf16 v[64:67], a[32:35], a[0:3], v[64:67]
  ds_read_b128 a[16:19], v16 offset:8192
  ds_read_b64_tr_b16 a[40:41], v20 offset:20480
  v_mfma_f32_16x16x32_bf16 v[72:75], a[32:35], a[4:7], v[72:75]
  ds_read_b64_tr_b16 a[42:43], v20 offset:22528
  v_mfma_f32_16x16x32_bf16 v[80:83], a[32:35], a[8:11], v[80:83]
  ds_read_b128 a[20:23], v16 offset:9216
  v_mfma_f32_16x16x32_bf16 v[88:91], a[32:35], a[12:15], v[88:91]
  ds_read_b128 a[24:27], v16 offset:10240
  ds_read_b128 a[28:31], v16 offset:11264
  v_mfma_f32_16x16x32_bf16 v[68:71], a[36:39], a[0:3], v[68:71]
  ds_read_b64_tr_b16 a[44:45], v21 offset:20480
  v_mfma_f32_16x16x32_bf16 v[76:79], a[36:39], a[4:7], v[76:79]
  ds_read_b64_tr_b16 a[46:47], v21 offset:22528
  v_mfma_f32_16x16x32_bf16 v[84:87], a[36:39], a[8:11], v[84:87]
  v_mfma_f32_16x16x32_bf16 v[92:95], a[36:39], a[12:15], v[92:95]
  s_waitcnt lgkmcnt(0)
  v_mfma_f32_16x16x32_bf16 v[64:67], a[40:43], a[16:19], v[64:67]
  v_mfma_f32_16x16x32_bf16 v[72:75], a[40:43], a[20:23], v[72:75]
  v_mfma_f32_16x16x32_bf16 v[80:83], a[40:43], a[24:27], v[80:83]
  v_mfma_f32_16x16x32_bf16 v[88:91], a[40:43], a[28:31], v[88:91]
  v_mfma_f32_16x16x32_bf16 v[68:71], a[44:47], a[16:19], v[68:71]
  v_mfma_f32_16x16x32_bf16 v[76:79], a[44:47], a[20:23], v[76:79]
  v_mfma_f32_16x16x32_bf16 v[84:87], a[44:47], a[24:27], v[84:87]
  v_mfma_f32_16x16x32_bf16 v[92:95], a[44:47], a[28:31], v[92:95]
  s_mov_b32 s16, s82
  s_mov_b32 s17, s83
  s_mov_b32 s18, 8388608
  s_mov_b32 s19, 0x00020000
  v_and_b32 v32, 15, v1
  v_lshlrev_b32 v32, 14, v32
  v_bfe_u32 v33, v1, 4, 1
  v_lshrrev_b32 v34, 5, v1
  v_lshl_or_b32 v33, v33, 1, v34
  v_lshl_add_u32 v32, v33, 4, v32
  s_lshl_b32 s4, s54, 19
  s_lshl_b32 s5, s55, 7
  s_add_u32 s4, s4, s5
  s_and_b32 s5, s3, 1
  s_lshl_b32 s5, s5, 6
  s_add_u32 s4, s4, s5
  s_lshr_b32 s5, s3, 1
  s_lshl_b32 s5, s5, 13
  s_add_u32 s4, s4, s5
  v_cvt_pk_bf16_f32 v36, v64, v65
  v_cvt_pk_bf16_f32 v37, v66, v67
  v_cvt_pk_bf16_f32 v38, v68, v69
  v_cvt_pk_bf16_f32 v39, v70, v71
  v_cvt_pk_bf16_f32 v40, v72, v73
  v_cvt_pk_bf16_f32 v41, v74, v75
  v_cvt_pk_bf16_f32 v42, v76, v77
  v_cvt_pk_bf16_f32 v43, v78, v79
  v_cvt_pk_bf16_f32 v44, v80, v81
  v_cvt_pk_bf16_f32 v45, v82, v83
  v_cvt_pk_bf16_f32 v46, v84, v85
  v_cvt_pk_bf16_f32 v47, v86, v87
  v_cvt_pk_bf16_f32 v48, v88, v89
  v_cvt_pk_bf16_f32 v49, v90, v91
  v_cvt_pk_bf16_f32 v50, v92, v93
  v_cvt_pk_bf16_f32 v51, v94, v95
  v_permlane16_swap_b32 v36, v38
  v_permlane16_swap_b32 v37, v39
  s_add_u32 s5, s4, 0
  buffer_store_dwordx4 v[36:39], v32, s[16:19], s5 offen
  v_permlane16_swap_b32 v40, v42
  v_permlane16_swap_b32 v41, v43
  s_add_u32 s5, s4, 262144
  buffer_store_dwordx4 v[40:43], v32, s[16:19], s5 offen
  v_permlane16_swap_b32 v44, v46
  v_permlane16_swap_b32 v45, v47
  s_add_u32 s5, s4, 4096
  buffer_store_dwordx4 v[44:47], v32, s[16:19], s5 offen
  v_permlane16_swap_b32 v48, v50
  v_permlane16_swap_b32 v49, v51
  s_add_u32 s5, s4, 266240
  buffer_store_dwordx4 v[48:51], v32, s[16:19], s5 offen
  s_waitcnt vmcnt(0)
Lk3_end:
  s_endpgm
.section .rodata,"a"
.p2align 6
.amdhsa_kernel k1_proj_kernel
  .amdhsa_next_free_vgpr 512
  .amdhsa_next_free_sgpr 102
  .amdhsa_accum_offset 256
  .amdhsa_group_segment_fixed_size 0
  .amdhsa_kernarg_size 96
  .amdhsa_user_sgpr_count 2
  .amdhsa_user_sgpr_kernarg_segment_ptr 1
  .amdhsa_system_sgpr_workgroup_id_x 1
.end_amdhsa_kernel
.p2align 6
.amdhsa_kernel k2_attn_kernel
  .amdhsa_next_free_vgpr 512
  .amdhsa_next_free_sgpr 102
  .amdhsa_accum_offset 256
  .amdhsa_group_segment_fixed_size 0
  .amdhsa_kernarg_size 96
  .amdhsa_user_sgpr_count 2
  .amdhsa_user_sgpr_kernarg_segment_ptr 1
  .amdhsa_system_sgpr_workgroup_id_x 1
.end_amdhsa_kernel
.p2align 6
.amdhsa_kernel k3_oproj_kernel
  .amdhsa_next_free_vgpr 512
  .amdhsa_next_free_sgpr 102
  .amdhsa_accum_offset 256
  .amdhsa_group_segment_fixed_size 0
  .amdhsa_kernarg_size 96
  .amdhsa_user_sgpr_count 2
  .amdhsa_user_sgpr_kernarg_segment_ptr 1
  .amdhsa_system_sgpr_workgroup_id_x 1
.end_amdhsa_kernel
```

```asm
; @launch grid=(256,1,1) block=(256,1,1) lds=163840
.amdgcn_target "amdgcn-amd-amdhsa--gfx950"
.text
.globl concat_heads__compressed_kv_cla__sliding_local_dilated__prompt_kernel
.p2align 8
.type concat_heads__compressed_kv_cla__sliding_local_dilated__prompt_kernel,@function
concat_heads__compressed_kv_cla__sliding_local_dilated__prompt_kernel:
  s_cmp_ge_u32 s2, 256
  s_cbranch_scc1 Lend
  s_load_dwordx16 s[64:79], s[0:1], 0
  s_load_dwordx8 s[80:87], s[0:1], 64
  v_lshrrev_b32 v2, 6, v0
  v_and_b32 v1, 63, v0
  v_readfirstlane_b32 s3, v2
  v_lshlrev_b32 v2, 4, v1
  s_and_b32 s4, s2, 1
  s_lshl_b32 s4, s4, 2
  s_bfe_u32 s5, s2, 0x20003
  s_add_u32 s61, s4, s5
  s_bfe_u32 s4, s2, 0x20001
  s_lshl_b32 s4, s4, 2
  s_bfe_u32 s5, s2, 0x20005
  s_add_u32 s62, s4, s5
  s_lshl_b32 s36, s3, 13
  s_add_u32 s41, s36, 98304
  v_lshrrev_b32 v32, 3, v1
  v_and_b32 v33, 6, v32
  v_and_b32 v34, 7, v1
  v_xor_b32 v33, v33, v34
  v_lshlrev_b32 v33, 4, v33
  v_lshrrev_b32 v34, 2, v32
  v_and_b32 v35, 3, v32
  v_lshl_add_u32 v34, v34, 3, v35
  s_lshl_b32 s4, s3, 7
  v_lshl_add_u32 v34, v34, 13, v33
  v_add_u32 v34, s4, v34
  v_add_u32 v56, 0, v34
  v_add_u32 v57, 130048, v34
  v_add_u32 v58, 30720, v34
  v_add_u32 v59, 160768, v34
  v_add_u32 v60, 262144, v34
  v_add_u32 v61, 392192, v34
  v_add_u32 v62, 292864, v34
  v_add_u32 v63, 422912, v34
  s_waitcnt lgkmcnt(0)
  s_bfe_u32 s6, s2, 0x20001
  s_lshl_b32 s6, s6, 1
  s_and_b32 s7, s2, 1
  s_add_u32 s6, s6, s7
  s_cmp_lt_u32 s2, 128
  s_cbranch_scc1 Lp1_q
  s_mov_b32 s8, s66
  s_mov_b32 s9, s67
  s_mov_b32 s10, 2097152
  s_mov_b32 s11, 0x00020000
  s_mov_b32 s12, s70
  s_mov_b32 s13, s71
  s_mov_b32 s14, 4194304
  s_mov_b32 s15, 0x00020000
  s_mov_b32 s54, s72
  s_mov_b32 s55, s73
  s_mov_b32 s51, 8
  s_mov_b32 s52, 1024
  s_mov_b32 s53, 4194304
  s_mul_i32 s46, s61, 262144
  s_lshl_b32 s4, s3, 6
  v_add_u32 v34, s4, v32
  v_lshl_add_u32 v34, v34, 10, v33
  v_add_u32 v48, 0, v34
  v_add_u32 v49, 7168, v34
  v_add_u32 v50, 14336, v34
  v_add_u32 v51, 21504, v34
  v_add_u32 v52, 32768, v34
  v_add_u32 v53, 39936, v34
  v_add_u32 v54, 47104, v34
  v_add_u32 v55, 54272, v34
  s_branch Lp1_go
Lp1_q:
  s_mov_b32 s8, s64
  s_mov_b32 s9, s65
  s_mov_b32 s10, 4194304
  s_mov_b32 s11, 0x00020000
  s_mov_b32 s12, s68
  s_mov_b32 s13, s69
  s_mov_b32 s14, 8388608
  s_mov_b32 s15, 0x00020000
  s_mov_b32 s54, s68
  s_mov_b32 s55, s69
  s_lshl_b32 s6, s6, 1
  s_mov_b32 s51, 16
  s_mov_b32 s52, 2048
  s_mov_b32 s53, 8388608
  s_mul_i32 s46, s61, 524288
  s_lshr_b32 s4, s3, 1
  s_lshl_b32 s4, s4, 7
  s_and_b32 s5, s3, 1
  s_lshl_b32 s5, s5, 1
  s_add_u32 s4, s4, s5
  v_lshlrev_b32 v34, 2, v32
  v_add_u32 v34, s4, v34
  v_lshl_add_u32 v34, v34, 11, v33
  v_add_u32 v48, 0, v34
  v_add_u32 v49, 64512, v34
  v_add_u32 v50, 129024, v34
  v_add_u32 v51, 193536, v34
  v_add_u32 v52, 2048, v34
  v_add_u32 v53, 66560, v34
  v_add_u32 v54, 131072, v34
  v_add_u32 v55, 195584, v34
Lp1_go:
  s_sub_u32 s48, s51, s6
  s_mov_b32 s49, s48
  s_mov_b32 s50, 8
  s_lshl_b32 s4, s6, 7
  s_add_u32 s46, s46, s4
  s_lshl_b32 s47, s62, 9
  s_lshl_b32 s4, s6, 19
  s_add_u32 s47, s47, s4
  s_add_u32 s96, s86, 125829120
  s_addc_u32 s97, s87, 0
  s_mov_b32 s98, 262144
  s_mov_b32 s99, 0x00020000
  s_or_b32 s4, s2, s3
  s_cbranch_scc1 Ltag_1
  s_mov_b32 s4, 196608
  buffer_load_dwordx2 v[4:5], off, s[96:99], s4 sc1
Ltag_1:
  s_mov_b32 m0, s36
  s_nop 0
  buffer_load_dwordx4 v48, s[8:11], s46 offen offset:0 lds
  buffer_load_dwordx4 v49, s[8:11], s46 offen offset:1024 lds
  buffer_load_dwordx4 v50, s[8:11], s46 offen offset:2048 lds
  buffer_load_dwordx4 v51, s[8:11], s46 offen offset:3072 lds
  s_add_u32 m0, s36, 4096
  s_nop 0
  buffer_load_dwordx4 v52, s[8:11], s46 offen offset:0 lds
  buffer_load_dwordx4 v53, s[8:11], s46 offen offset:1024 lds
  buffer_load_dwordx4 v54, s[8:11], s46 offen offset:2048 lds
  buffer_load_dwordx4 v55, s[8:11], s46 offen offset:3072 lds
  s_add_u32 s46, s46, 128
  s_sub_u32 s48, s48, 1
  s_cmp_eq_u32 s48, 0
  s_cselect_b32 s34, s52, 0
  s_cselect_b32 s48, s51, s48
  s_sub_u32 s46, s46, s34
  s_mov_b32 m0, s41
  s_nop 0
  buffer_load_dwordx4 v56, s[12:15], s47 offen offset:0 lds
  buffer_load_dwordx4 v57, s[12:15], s47 offen offset:1024 lds
  buffer_load_dwordx4 v58, s[12:15], s47 offen offset:2048 lds
  buffer_load_dwordx4 v59, s[12:15], s47 offen offset:3072 lds
  s_add_u32 m0, s41, 4096
  s_nop 0
  buffer_load_dwordx4 v60, s[12:15], s47 offen offset:0 lds
  buffer_load_dwordx4 v61, s[12:15], s47 offen offset:1024 lds
  buffer_load_dwordx4 v62, s[12:15], s47 offen offset:2048 lds
  buffer_load_dwordx4 v63, s[12:15], s47 offen offset:3072 lds
  s_add_u32 s47, s47, 524288
  s_sub_u32 s49, s49, 1
  s_cmp_eq_u32 s49, 0
  s_cselect_b32 s34, s53, 0
  s_cselect_b32 s49, s51, s49
  s_sub_u32 s47, s47, s34
  s_sub_u32 s50, s50, 1
  s_cmp_eq_u32 s50, 0
  s_cselect_b32 s12, s54, s12
  s_cselect_b32 s13, s55, s13
  s_add_u32 m0, s36, 32768
  s_nop 0
  buffer_load_dwordx4 v48, s[8:11], s46 offen offset:0 lds
  buffer_load_dwordx4 v49, s[8:11], s46 offen offset:1024 lds
  buffer_load_dwordx4 v50, s[8:11], s46 offen offset:2048 lds
  buffer_load_dwordx4 v51, s[8:11], s46 offen offset:3072 lds
  s_add_u32 m0, s36, 36864
  s_nop 0
  buffer_load_dwordx4 v52, s[8:11], s46 offen offset:0 lds
  buffer_load_dwordx4 v53, s[8:11], s46 offen offset:1024 lds
  buffer_load_dwordx4 v54, s[8:11], s46 offen offset:2048 lds
  buffer_load_dwordx4 v55, s[8:11], s46 offen offset:3072 lds
  s_add_u32 s46, s46, 128
  s_sub_u32 s48, s48, 1
  s_cmp_eq_u32 s48, 0
  s_cselect_b32 s34, s52, 0
  s_cselect_b32 s48, s51, s48
  s_sub_u32 s46, s46, s34
  s_add_u32 m0, s41, 32768
  s_nop 0
  buffer_load_dwordx4 v56, s[12:15], s47 offen offset:0 lds
  buffer_load_dwordx4 v57, s[12:15], s47 offen offset:1024 lds
  buffer_load_dwordx4 v58, s[12:15], s47 offen offset:2048 lds
  buffer_load_dwordx4 v59, s[12:15], s47 offen offset:3072 lds
  s_add_u32 m0, s41, 36864
  s_nop 0
  buffer_load_dwordx4 v60, s[12:15], s47 offen offset:0 lds
  buffer_load_dwordx4 v61, s[12:15], s47 offen offset:1024 lds
  buffer_load_dwordx4 v62, s[12:15], s47 offen offset:2048 lds
  buffer_load_dwordx4 v63, s[12:15], s47 offen offset:3072 lds
  s_add_u32 s47, s47, 524288
  s_sub_u32 s49, s49, 1
  s_cmp_eq_u32 s49, 0
  s_cselect_b32 s34, s53, 0
  s_cselect_b32 s49, s51, s49
  s_sub_u32 s47, s47, s34
  s_sub_u32 s50, s50, 1
  s_cmp_eq_u32 s50, 0
  s_cselect_b32 s12, s54, s12
  s_cselect_b32 s13, s55, s13
  s_add_u32 m0, s36, 65536
  s_nop 0
  buffer_load_dwordx4 v48, s[8:11], s46 offen offset:0 lds
  buffer_load_dwordx4 v49, s[8:11], s46 offen offset:1024 lds
  buffer_load_dwordx4 v50, s[8:11], s46 offen offset:2048 lds
  buffer_load_dwordx4 v51, s[8:11], s46 offen offset:3072 lds
  s_add_u32 m0, s36, 69632
  s_nop 0
  buffer_load_dwordx4 v52, s[8:11], s46 offen offset:0 lds
  buffer_load_dwordx4 v53, s[8:11], s46 offen offset:1024 lds
  buffer_load_dwordx4 v54, s[8:11], s46 offen offset:2048 lds
  buffer_load_dwordx4 v55, s[8:11], s46 offen offset:3072 lds
  s_add_u32 s46, s46, 128
  s_sub_u32 s48, s48, 1
  s_cmp_eq_u32 s48, 0
  s_cselect_b32 s34, s52, 0
  s_cselect_b32 s48, s51, s48
  s_sub_u32 s46, s46, s34
  s_or_b32 s4, s2, s3
  s_cbranch_scc1 Ltag_2
  s_mov_b32 s4, 196608
  s_mov_b32 s16, s84
  s_mov_b32 s17, s85
  s_mov_b32 s18, 256
  s_mov_b32 s19, 0x00020000
  s_waitcnt vmcnt(40)
  v_add_u32 v4, 1, v4
  v_or_b32 v5, 0x80000000, v5
  buffer_store_dwordx2 v[4:5], off, s[96:99], s4 sc1
  buffer_store_dwordx2 v[4:5], off, s[16:19], 0 sc1
Ltag_2:
  s_lshr_b32 s4, s3, 1
  s_lshl_b32 s4, s4, 14
  v_and_b32 v32, 15, v1
  v_lshlrev_b32 v32, 7, v32
  v_lshrrev_b32 v33, 4, v1
  v_and_b32 v34, 6, v1
  v_xor_b32 v33, v33, v34
  v_lshl_add_u32 v32, v33, 4, v32
  v_add_u32 v16, s4, v32
  v_xor_b32 v17, 64, v16
  s_and_b32 s4, s3, 1
  s_lshl_b32 s4, s4, 14
  s_add_u32 s4, s4, 98304
  v_lshrrev_b32 v32, 2, v1
  v_and_b32 v33, 6, v32
  v_lshlrev_b32 v32, 7, v32
  v_and_b32 v34, 1, v1
  v_lshl_add_u32 v32, v34, 3, v32
  v_add_u32 v32, s4, v32
  v_bfe_u32 v34, v1, 1, 1
  v_xor_b32 v33, v33, v34
  v_xor_b32 v34, 0, v33
  v_lshl_add_u32 v18, v34, 4, v32
  v_xor_b32 v34, 2, v33
  v_lshl_add_u32 v19, v34, 4, v32
  v_xor_b32 v34, 4, v33
  v_lshl_add_u32 v20, v34, 4, v32
  v_xor_b32 v34, 6, v33
  v_lshl_add_u32 v21, v34, 4, v32
  s_cmp_lt_u32 s2, 154
  s_cselect_b32 s56, s78, s76
  s_cselect_b32 s57, s79, s77
  s_cselect_b32 s60, 0, 154
  s_mov_b32 s58, 4194304
  s_cselect_b32 s58, 6291456, s58
  s_mov_b32 s59, 0x00020000
  s_sub_u32 s60, s2, s60
  s_lshl_b32 s60, s60, 2
  s_add_u32 s60, s60, s3
  s_mul_i32 s60, s60, 10240
  s_and_b32 s4, s2, 1
  s_lshl_b32 s4, s4, 3
  s_bfe_u32 s5, s2, 0x30003
  s_add_u32 s32, s4, s5
  s_bfe_u32 s4, s2, 0x20001
  s_lshl_b32 s4, s4, 2
  s_lshr_b32 s5, s2, 6
  s_add_u32 s33, s4, s5
  s_mov_b32 s20, s78
  s_mov_b32 s21, s79
  s_mov_b32 s22, 6291456
  s_mov_b32 s23, 0x00020000
  s_mov_b32 s24, 0
  s_lshl_b32 s25, s33, 7
  s_lshl_b32 s88, s3, 12
  s_add_u32 s88, s88, 32768
  s_lshl_b32 s4, s3, 11
  s_add_u32 s26, s4, 18432
  s_add_u32 s27, s26, 3072
  s_mul_i32 s4, s3, 3072
  s_sub_u32 s28, 16384, s4
  v_lshrrev_b32 v32, 3, v1
  v_and_b32 v33, 6, v32
  v_and_b32 v34, 7, v1
  v_xor_b32 v33, v33, v34
  v_lshlrev_b32 v33, 4, v33
  s_lshl_b32 s4, s3, 5
  s_add_u32 s4, s4, 16
  v_add_u32 v34, s4, v32
  v_lshl_add_u32 v34, v34, 11, v33
  v_add_u32 v36, 0, v34
  v_add_u32 v37, 15360, v34
  v_add_u32 v38, 30720, v34
  v_add_u32 v39, 46080, v34
  s_lshl_b32 s4, s3, 14
  s_cmp_eq_u32 s32, 0
  s_cselect_b32 s4, 0x40000000, s4
  v_lshl_add_u32 v34, v32, 11, v33
  v_add_u32 v40, s4, v34
  v_lshrrev_b32 v34, 2, v32
  v_and_b32 v35, 3, v32
  v_lshl_add_u32 v34, v34, 3, v35
  v_mul_u32_u24 v34, 6144, v34
  v_add_u32 v34, v34, v33
  s_mul_i32 s6, s3, 6
  s_add_u32 s7, s6, 0
  s_bfe_u32 s4, s7, 0x10002
  s_lshl_b32 s4, s4, 5
  s_and_b32 s5, s7, 1
  s_lshl_b32 s5, s5, 4
  s_add_u32 s4, s4, s5
  s_bfe_u32 s5, s7, 0x10001
  s_lshl_b32 s5, s5, 2
  s_add_u32 s4, s4, s5
  s_mul_i32 s4, s4, 6144
  s_lshr_b32 s5, s7, 3
  s_lshl_b32 s5, s5, 11
  s_add_u32 s4, s4, s5
  s_add_u32 s4, s4, 2048
  v_add_u32 v8, s4, v34
  s_add_u32 s7, s6, 1
  s_bfe_u32 s4, s7, 0x10002
  s_lshl_b32 s4, s4, 5
  s_and_b32 s5, s7, 1
  s_lshl_b32 s5, s5, 4
  s_add_u32 s4, s4, s5
  s_bfe_u32 s5, s7, 0x10001
  s_lshl_b32 s5, s5, 2
  s_add_u32 s4, s4, s5
  s_mul_i32 s4, s4, 6144
  s_lshr_b32 s5, s7, 3
  s_lshl_b32 s5, s5, 11
  s_add_u32 s4, s4, s5
  s_add_u32 s4, s4, 1024
  v_add_u32 v9, s4, v34
  s_add_u32 s7, s6, 2
  s_bfe_u32 s4, s7, 0x10002
  s_lshl_b32 s4, s4, 5
  s_and_b32 s5, s7, 1
  s_lshl_b32 s5, s5, 4
  s_add_u32 s4, s4, s5
  s_bfe_u32 s5, s7, 0x10001
  s_lshl_b32 s5, s5, 2
  s_add_u32 s4, s4, s5
  s_mul_i32 s4, s4, 6144
  s_lshr_b32 s5, s7, 3
  s_lshl_b32 s5, s5, 11
  s_add_u32 s4, s4, s5
  s_add_u32 s4, s4, 0
  v_add_u32 v10, s4, v34
  s_add_u32 s7, s6, 3
  s_bfe_u32 s4, s7, 0x10002
  s_lshl_b32 s4, s4, 5
  s_and_b32 s5, s7, 1
  s_lshl_b32 s5, s5, 4
  s_add_u32 s4, s4, s5
  s_bfe_u32 s5, s7, 0x10001
  s_lshl_b32 s5, s5, 2
  s_add_u32 s4, s4, s5
  s_mul_i32 s4, s4, 6144
  s_lshr_b32 s5, s7, 3
  s_lshl_b32 s5, s5, 11
  s_add_u32 s4, s4, s5
  s_add_u32 s4, s4, 2048
  v_add_u32 v11, s4, v34
  s_add_u32 s7, s6, 4
  s_bfe_u32 s4, s7, 0x10002
  s_lshl_b32 s4, s4, 5
  s_and_b32 s5, s7, 1
  s_lshl_b32 s5, s5, 4
  s_add_u32 s4, s4, s5
  s_bfe_u32 s5, s7, 0x10001
  s_lshl_b32 s5, s5, 2
  s_add_u32 s4, s4, s5
  s_mul_i32 s4, s4, 6144
  s_lshr_b32 s5, s7, 3
  s_lshl_b32 s5, s5, 11
  s_add_u32 s4, s4, s5
  s_add_u32 s4, s4, 1024
  v_add_u32 v12, s4, v34
  s_add_u32 s7, s6, 5
  s_bfe_u32 s4, s7, 0x10002
  s_lshl_b32 s4, s4, 5
  s_and_b32 s5, s7, 1
  s_lshl_b32 s5, s5, 4
  s_add_u32 s4, s4, s5
  s_bfe_u32 s5, s7, 0x10001
  s_lshl_b32 s5, s5, 2
  s_add_u32 s4, s4, s5
  s_mul_i32 s4, s4, 6144
  s_lshr_b32 s5, s7, 3
  s_lshl_b32 s5, s5, 11
  s_add_u32 s4, s4, s5
  s_add_u32 s4, s4, 0
  v_add_u32 v13, s4, v34
  s_sub_u32 s20, s20, 2048
  s_subb_u32 s21, s21, 0
  s_add_u32 s22, s22, 2048
  s_lshr_b32 s4, s3, 1
  s_lshl_b32 s4, s4, 13
  s_add_u32 s4, s4, 32768
  v_and_b32 v32, 15, v1
  v_lshlrev_b32 v32, 7, v32
  v_lshrrev_b32 v33, 4, v1
  v_and_b32 v34, 6, v1
  v_xor_b32 v33, v33, v34
  v_lshl_add_u32 v32, v33, 4, v32
  v_add_u32 v22, s4, v32
  v_xor_b32 v23, 64, v22
  v_and_b32 v32, 15, v1
  v_lshlrev_b32 v32, 7, v32
  v_lshrrev_b32 v33, 4, v1
  v_and_b32 v34, 6, v1
  v_xor_b32 v33, v33, v34
  v_lshl_add_u32 v32, v33, 4, v32
  v_add_u32 v24, 49152, v32
  v_xor_b32 v25, 64, v24
  v_lshrrev_b32 v32, 2, v1
  v_and_b32 v33, 6, v32
  v_lshlrev_b32 v32, 7, v32
  v_and_b32 v34, 1, v1
  v_lshl_add_u32 v32, v34, 3, v32
  v_add_u32 v32, 32768, v32
  v_bfe_u32 v34, v1, 1, 1
  v_xor_b32 v33, v33, v34
  v_xor_b32 v34, 0, v33
  v_lshl_add_u32 v26, v34, 4, v32
  v_xor_b32 v34, 2, v33
  v_lshl_add_u32 v27, v34, 4, v32
  s_and_b32 s4, s3, 1
  s_lshl_b32 s4, s4, 6
  v_xor_b32 v26, s4, v26
  v_xor_b32 v27, s4, v27
  v_lshrrev_b32 v28, 3, v1
  v_and_b32 v29, 6, v28
  v_and_b32 v30, 7, v1
  v_xor_b32 v29, v29, v30
  v_lshlrev_b32 v29, 4, v29
  s_and_b32 s4, s3, 1
  s_lshl_b32 s4, s4, 16
  s_lshr_b32 s5, s3, 1
  s_lshl_b32 s5, s5, 7
  s_add_u32 s4, s4, s5
  v_lshl_add_u32 v28, v28, 11, v29
  v_add_u32 v28, s4, v28
  v_add_u32 v29, 0, v28
  v_accvgpr_write_b32 a212, v29
  v_add_u32 v29, 15360, v28
  v_accvgpr_write_b32 a213, v29
  v_add_u32 v29, 30720, v28
  v_accvgpr_write_b32 a214, v29
  v_add_u32 v29, 46080, v28
  v_accvgpr_write_b32 a215, v29
  s_mov_b32 s37, 0
  s_mov_b32 s39, 4294901760
  s_mov_b32 s40, 32768
  s_mov_b32 s42, 0
  s_mov_b32 s44, 4294934528
  s_mov_b32 s45, 32768
  s_mov_b32 s43, s44
  s_waitcnt vmcnt(24)
  s_barrier
  ds_read_b128 a[0:3], v16 offset:0
  ds_read_b64_tr_b16 a[64:65], v18 offset:0
  ds_read_b64_tr_b16 a[66:67], v18 offset:2048
  ds_read_b128 a[4:7], v16 offset:2048
  ds_read_b128 a[8:11], v16 offset:4096
  ds_read_b128 a[12:15], v16 offset:6144
  ds_read_b128 a[16:19], v16 offset:8192
  ds_read_b128 a[20:23], v16 offset:10240
  ds_read_b128 a[24:27], v16 offset:12288
  ds_read_b128 a[28:31], v16 offset:14336
  ds_read_b64_tr_b16 a[68:69], v19 offset:0
  ds_read_b64_tr_b16 a[70:71], v19 offset:2048
  ds_read_b64_tr_b16 a[72:73], v20 offset:0
  ds_read_b64_tr_b16 a[74:75], v20 offset:2048
  ds_read_b64_tr_b16 a[76:77], v21 offset:0
  ds_read_b64_tr_b16 a[78:79], v21 offset:2048
  ds_read_b64_tr_b16 a[80:81], v18 offset:8192
  ds_read_b64_tr_b16 a[82:83], v18 offset:10240
  ds_read_b64_tr_b16 a[84:85], v19 offset:8192
  ds_read_b64_tr_b16 a[86:87], v19 offset:10240
  ds_read_b64_tr_b16 a[88:89], v20 offset:8192
  ds_read_b64_tr_b16 a[90:91], v20 offset:10240
  ds_read_b64_tr_b16 a[92:93], v21 offset:8192
  ds_read_b64_tr_b16 a[94:95], v21 offset:10240
  s_waitcnt lgkmcnt(0)
  v_mfma_f32_16x16x32_bf16 v[64:67], a[64:67], a[0:3], 0
  s_add_u32 s37, s37, 1
  s_cmp_eq_u32 s37, 3
  s_cselect_b32 s37, 0, s37
  s_cselect_b32 s38, s39, s40
  ds_read_b128 a[32:35], v17 offset:0
  v_mfma_f32_16x16x32_bf16 v[96:99], a[64:67], a[4:7], 0
  s_sub_u32 s43, 0, s43
  v_mfma_f32_16x16x32_bf16 v[128:131], a[64:67], a[8:11], 0
  ds_read_b64_tr_b16 a[96:97], v18 offset:4096
  v_mfma_f32_16x16x32_bf16 v[160:163], a[64:67], a[12:15], 0
  v_mfma_f32_16x16x32_bf16 v[192:195], a[64:67], a[16:19], 0
  ds_read_b64_tr_b16 a[98:99], v18 offset:6144
  v_mfma_f32_16x16x32_bf16 v[224:227], a[64:67], a[20:23], 0
  v_mfma_f32_16x16x32_bf16 a[128:131], a[64:67], a[24:27], 0
  ds_read_b128 a[36:39], v17 offset:2048
  v_mfma_f32_16x16x32_bf16 a[160:163], a[64:67], a[28:31], 0
  v_mfma_f32_16x16x32_bf16 v[68:71], a[68:71], a[0:3], 0
  v_mfma_f32_16x16x32_bf16 v[100:103], a[68:71], a[4:7], 0
  ds_read_b128 a[40:43], v17 offset:4096
  v_mfma_f32_16x16x32_bf16 v[132:135], a[68:71], a[8:11], 0
  v_mfma_f32_16x16x32_bf16 v[164:167], a[68:71], a[12:15], 0
  ds_read_b128 a[44:47], v17 offset:6144
  v_mfma_f32_16x16x32_bf16 v[196:199], a[68:71], a[16:19], 0
  v_mfma_f32_16x16x32_bf16 v[228:231], a[68:71], a[20:23], 0
  ds_read_b128 a[48:51], v17 offset:8192
  v_mfma_f32_16x16x32_bf16 a[132:135], a[68:71], a[24:27], 0
  v_mfma_f32_16x16x32_bf16 a[164:167], a[68:71], a[28:31], 0
  ds_read_b128 a[52:55], v17 offset:10240
  v_mfma_f32_16x16x32_bf16 v[72:75], a[72:75], a[0:3], 0
  v_mfma_f32_16x16x32_bf16 v[104:107], a[72:75], a[4:7], 0
  v_mfma_f32_16x16x32_bf16 v[136:139], a[72:75], a[8:11], 0
  ds_read_b128 a[56:59], v17 offset:12288
  v_mfma_f32_16x16x32_bf16 v[168:171], a[72:75], a[12:15], 0
  v_mfma_f32_16x16x32_bf16 v[200:203], a[72:75], a[16:19], 0
  ds_read_b128 a[60:63], v17 offset:14336
  v_mfma_f32_16x16x32_bf16 v[232:235], a[72:75], a[20:23], 0
  v_mfma_f32_16x16x32_bf16 a[136:139], a[72:75], a[24:27], 0
  ds_read_b64_tr_b16 a[100:101], v19 offset:4096
  v_mfma_f32_16x16x32_bf16 a[168:171], a[72:75], a[28:31], 0
  v_mfma_f32_16x16x32_bf16 v[76:79], a[76:79], a[0:3], 0
  ds_read_b64_tr_b16 a[102:103], v19 offset:6144
  v_mfma_f32_16x16x32_bf16 v[108:111], a[76:79], a[4:7], 0
  v_mfma_f32_16x16x32_bf16 v[140:143], a[76:79], a[8:11], 0
  v_mfma_f32_16x16x32_bf16 v[172:175], a[76:79], a[12:15], 0
  ds_read_b64_tr_b16 a[104:105], v20 offset:4096
  v_mfma_f32_16x16x32_bf16 v[204:207], a[76:79], a[16:19], 0
  v_mfma_f32_16x16x32_bf16 v[236:239], a[76:79], a[20:23], 0
  ds_read_b64_tr_b16 a[106:107], v20 offset:6144
  v_mfma_f32_16x16x32_bf16 a[140:143], a[76:79], a[24:27], 0
  v_mfma_f32_16x16x32_bf16 a[172:175], a[76:79], a[28:31], 0
  ds_read_b64_tr_b16 a[108:109], v21 offset:4096
  v_mfma_f32_16x16x32_bf16 v[80:83], a[80:83], a[0:3], 0
  v_mfma_f32_16x16x32_bf16 v[112:115], a[80:83], a[4:7], 0
  ds_read_b64_tr_b16 a[110:111], v21 offset:6144
  v_mfma_f32_16x16x32_bf16 v[144:147], a[80:83], a[8:11], 0
  v_mfma_f32_16x16x32_bf16 v[176:179], a[80:83], a[12:15], 0
  v_mfma_f32_16x16x32_bf16 v[208:211], a[80:83], a[16:19], 0
  ds_read_b64_tr_b16 a[112:113], v18 offset:12288
  v_mfma_f32_16x16x32_bf16 v[240:243], a[80:83], a[20:23], 0
  v_mfma_f32_16x16x32_bf16 a[144:147], a[80:83], a[24:27], 0
  ds_read_b64_tr_b16 a[114:115], v18 offset:14336
  v_mfma_f32_16x16x32_bf16 a[176:179], a[80:83], a[28:31], 0
  v_mfma_f32_16x16x32_bf16 v[84:87], a[84:87], a[0:3], 0
  ds_read_b64_tr_b16 a[116:117], v19 offset:12288
  v_mfma_f32_16x16x32_bf16 v[116:119], a[84:87], a[4:7], 0
  v_mfma_f32_16x16x32_bf16 v[148:151], a[84:87], a[8:11], 0
  ds_read_b64_tr_b16 a[118:119], v19 offset:14336
  v_mfma_f32_16x16x32_bf16 v[180:183], a[84:87], a[12:15], 0
  v_mfma_f32_16x16x32_bf16 v[212:215], a[84:87], a[16:19], 0
  v_mfma_f32_16x16x32_bf16 v[244:247], a[84:87], a[20:23], 0
  ds_read_b64_tr_b16 a[120:121], v20 offset:12288
  v_mfma_f32_16x16x32_bf16 a[148:151], a[84:87], a[24:27], 0
  v_mfma_f32_16x16x32_bf16 a[180:183], a[84:87], a[28:31], 0
  ds_read_b64_tr_b16 a[122:123], v20 offset:14336
  v_mfma_f32_16x16x32_bf16 v[88:91], a[88:91], a[0:3], 0
  v_mfma_f32_16x16x32_bf16 v[120:123], a[88:91], a[4:7], 0
  ds_read_b64_tr_b16 a[124:125], v21 offset:12288
  v_mfma_f32_16x16x32_bf16 v[152:155], a[88:91], a[8:11], 0
  v_mfma_f32_16x16x32_bf16 v[184:187], a[88:91], a[12:15], 0
  ds_read_b64_tr_b16 a[126:127], v21 offset:14336
  v_mfma_f32_16x16x32_bf16 v[216:219], a[88:91], a[16:19], 0
  v_add_u32 v16, s38, v16
  v_add_u32 v17, s38, v17
  v_mfma_f32_16x16x32_bf16 v[248:251], a[88:91], a[20:23], 0
  v_add_u32 v18, s43, v18
  v_add_u32 v19, s43, v19
  v_mfma_f32_16x16x32_bf16 a[152:155], a[88:91], a[24:27], 0
  v_add_u32 v20, s43, v20
  v_add_u32 v21, s43, v21
  v_mfma_f32_16x16x32_bf16 a[184:187], a[88:91], a[28:31], 0
  v_mfma_f32_16x16x32_bf16 v[92:95], a[92:95], a[0:3], 0
  v_mfma_f32_16x16x32_bf16 v[124:127], a[92:95], a[4:7], 0
  v_mfma_f32_16x16x32_bf16 v[156:159], a[92:95], a[8:11], 0
  v_mfma_f32_16x16x32_bf16 v[188:191], a[92:95], a[12:15], 0
  v_mfma_f32_16x16x32_bf16 v[220:223], a[92:95], a[16:19], 0
  v_mfma_f32_16x16x32_bf16 v[252:255], a[92:95], a[20:23], 0
  v_mfma_f32_16x16x32_bf16 a[156:159], a[92:95], a[24:27], 0
  v_mfma_f32_16x16x32_bf16 a[188:191], a[92:95], a[28:31], 0
  s_cmp_lt_u32 s2, 128
  s_cselect_b32 s35, 13, 7
  .p2align 6
Lp1wx_loop:
  s_waitcnt vmcnt(8) lgkmcnt(0)
  s_barrier
  v_mfma_f32_16x16x32_bf16 v[64:67], a[96:99], a[32:35], v[64:67]
  buffer_load_dwordx4 v[4:7], v2, s[56:59], s60 offen
  ds_read_b128 a[0:3], v16 offset:0
  v_mfma_f32_16x16x32_bf16 v[96:99], a[96:99], a[36:39], v[96:99]
  s_add_u32 s60, s60, 1024
  s_mov_b32 m0, s41
  v_mfma_f32_16x16x32_bf16 v[128:131], a[96:99], a[40:43], v[128:131]
  ds_read_b64_tr_b16 a[64:65], v18 offset:0
  v_mfma_f32_16x16x32_bf16 v[160:163], a[96:99], a[44:47], v[160:163]
  v_mfma_f32_16x16x32_bf16 v[192:195], a[96:99], a[48:51], v[192:195]
  ds_read_b64_tr_b16 a[66:67], v18 offset:2048
  v_mfma_f32_16x16x32_bf16 v[224:227], a[96:99], a[52:55], v[224:227]
  v_mfma_f32_16x16x32_bf16 a[128:131], a[96:99], a[56:59], a[128:131]
  ds_read_b128 a[4:7], v16 offset:2048
  v_mfma_f32_16x16x32_bf16 a[160:163], a[96:99], a[60:63], a[160:163]
  buffer_load_dwordx4 v56, s[12:15], s47 offen offset:0 lds
  v_mfma_f32_16x16x32_bf16 v[68:71], a[100:103], a[32:35], v[68:71]
  v_mfma_f32_16x16x32_bf16 v[100:103], a[100:103], a[36:39], v[100:103]
  ds_read_b128 a[8:11], v16 offset:4096
  v_mfma_f32_16x16x32_bf16 v[132:135], a[100:103], a[40:43], v[132:135]
  v_mfma_f32_16x16x32_bf16 v[164:167], a[100:103], a[44:47], v[164:167]
  ds_read_b128 a[12:15], v16 offset:6144
  v_mfma_f32_16x16x32_bf16 v[196:199], a[100:103], a[48:51], v[196:199]
  v_mfma_f32_16x16x32_bf16 v[228:231], a[100:103], a[52:55], v[228:231]
  ds_read_b128 a[16:19], v16 offset:8192
  v_mfma_f32_16x16x32_bf16 a[132:135], a[100:103], a[56:59], a[132:135]
  buffer_load_dwordx4 v57, s[12:15], s47 offen offset:1024 lds
  v_mfma_f32_16x16x32_bf16 a[164:167], a[100:103], a[60:63], a[164:167]
  ds_read_b128 a[20:23], v16 offset:10240
  v_mfma_f32_16x16x32_bf16 v[72:75], a[104:107], a[32:35], v[72:75]
  v_mfma_f32_16x16x32_bf16 v[104:107], a[104:107], a[36:39], v[104:107]
  v_mfma_f32_16x16x32_bf16 v[136:139], a[104:107], a[40:43], v[136:139]
  ds_read_b128 a[24:27], v16 offset:12288
  v_mfma_f32_16x16x32_bf16 v[168:171], a[104:107], a[44:47], v[168:171]
  v_mfma_f32_16x16x32_bf16 v[200:203], a[104:107], a[48:51], v[200:203]
  ds_read_b128 a[28:31], v16 offset:14336
  v_mfma_f32_16x16x32_bf16 v[232:235], a[104:107], a[52:55], v[232:235]
  buffer_load_dwordx4 v58, s[12:15], s47 offen offset:2048 lds
  v_mfma_f32_16x16x32_bf16 a[136:139], a[104:107], a[56:59], a[136:139]
  ds_read_b64_tr_b16 a[68:69], v19 offset:0
  v_mfma_f32_16x16x32_bf16 a[168:171], a[104:107], a[60:63], a[168:171]
  v_mfma_f32_16x16x32_bf16 v[76:79], a[108:111], a[32:35], v[76:79]
  ds_read_b64_tr_b16 a[70:71], v19 offset:2048
  v_mfma_f32_16x16x32_bf16 v[108:111], a[108:111], a[36:39], v[108:111]
  v_mfma_f32_16x16x32_bf16 v[140:143], a[108:111], a[40:43], v[140:143]
  v_mfma_f32_16x16x32_bf16 v[172:175], a[108:111], a[44:47], v[172:175]
  ds_read_b64_tr_b16 a[72:73], v20 offset:0
  v_mfma_f32_16x16x32_bf16 v[204:207], a[108:111], a[48:51], v[204:207]
  buffer_load_dwordx4 v59, s[12:15], s47 offen offset:3072 lds
  v_mfma_f32_16x16x32_bf16 v[236:239], a[108:111], a[52:55], v[236:239]
  s_add_u32 m0, s41, 4096
  ds_read_b64_tr_b16 a[74:75], v20 offset:2048
  v_mfma_f32_16x16x32_bf16 a[140:143], a[108:111], a[56:59], a[140:143]
  v_mfma_f32_16x16x32_bf16 a[172:175], a[108:111], a[60:63], a[172:175]
  ds_read_b64_tr_b16 a[76:77], v21 offset:0
  v_mfma_f32_16x16x32_bf16 v[80:83], a[112:115], a[32:35], v[80:83]
  v_mfma_f32_16x16x32_bf16 v[112:115], a[112:115], a[36:39], v[112:115]
  ds_read_b64_tr_b16 a[78:79], v21 offset:2048
  v_mfma_f32_16x16x32_bf16 v[144:147], a[112:115], a[40:43], v[144:147]
  v_mfma_f32_16x16x32_bf16 v[176:179], a[112:115], a[44:47], v[176:179]
  buffer_load_dwordx4 v60, s[12:15], s47 offen offset:0 lds
  v_mfma_f32_16x16x32_bf16 v[208:211], a[112:115], a[48:51], v[208:211]
  ds_read_b64_tr_b16 a[80:81], v18 offset:8192
  v_mfma_f32_16x16x32_bf16 v[240:243], a[112:115], a[52:55], v[240:243]
  v_mfma_f32_16x16x32_bf16 a[144:147], a[112:115], a[56:59], a[144:147]
  ds_read_b64_tr_b16 a[82:83], v18 offset:10240
  v_mfma_f32_16x16x32_bf16 a[176:179], a[112:115], a[60:63], a[176:179]
  v_mfma_f32_16x16x32_bf16 v[84:87], a[116:119], a[32:35], v[84:87]
  ds_read_b64_tr_b16 a[84:85], v19 offset:8192
  v_mfma_f32_16x16x32_bf16 v[116:119], a[116:119], a[36:39], v[116:119]
  v_mfma_f32_16x16x32_bf16 v[148:151], a[116:119], a[40:43], v[148:151]
  buffer_load_dwordx4 v61, s[12:15], s47 offen offset:1024 lds
  ds_read_b64_tr_b16 a[86:87], v19 offset:10240
  v_mfma_f32_16x16x32_bf16 v[180:183], a[116:119], a[44:47], v[180:183]
  v_mfma_f32_16x16x32_bf16 v[212:215], a[116:119], a[48:51], v[212:215]
  v_mfma_f32_16x16x32_bf16 v[244:247], a[116:119], a[52:55], v[244:247]
  ds_read_b64_tr_b16 a[88:89], v20 offset:8192
  v_mfma_f32_16x16x32_bf16 a[148:151], a[116:119], a[56:59], a[148:151]
  v_mfma_f32_16x16x32_bf16 a[180:183], a[116:119], a[60:63], a[180:183]
  ds_read_b64_tr_b16 a[90:91], v20 offset:10240
  v_mfma_f32_16x16x32_bf16 v[88:91], a[120:123], a[32:35], v[88:91]
  v_mfma_f32_16x16x32_bf16 v[120:123], a[120:123], a[36:39], v[120:123]
  buffer_load_dwordx4 v62, s[12:15], s47 offen offset:2048 lds
  ds_read_b64_tr_b16 a[92:93], v21 offset:8192
  v_mfma_f32_16x16x32_bf16 v[152:155], a[120:123], a[40:43], v[152:155]
  v_mfma_f32_16x16x32_bf16 v[184:187], a[120:123], a[44:47], v[184:187]
  ds_read_b64_tr_b16 a[94:95], v21 offset:10240
  v_mfma_f32_16x16x32_bf16 v[216:219], a[120:123], a[48:51], v[216:219]
  v_mfma_f32_16x16x32_bf16 v[248:251], a[120:123], a[52:55], v[248:251]
  v_mfma_f32_16x16x32_bf16 a[152:155], a[120:123], a[56:59], a[152:155]
  v_mfma_f32_16x16x32_bf16 a[184:187], a[120:123], a[60:63], a[184:187]
  v_mfma_f32_16x16x32_bf16 v[92:95], a[124:127], a[32:35], v[92:95]
  buffer_load_dwordx4 v63, s[12:15], s47 offen offset:3072 lds
  v_mfma_f32_16x16x32_bf16 v[124:127], a[124:127], a[36:39], v[124:127]
  s_add_u32 s47, s47, 524288
  s_sub_u32 s49, s49, 1
  s_cmp_eq_u32 s49, 0
  s_cselect_b32 s34, s53, 0
  s_cselect_b32 s49, s51, s49
  v_mfma_f32_16x16x32_bf16 v[156:159], a[124:127], a[40:43], v[156:159]
  s_sub_u32 s47, s47, s34
  s_sub_u32 s50, s50, 1
  s_cmp_eq_u32 s50, 0
  s_cselect_b32 s12, s54, s12
  s_cselect_b32 s13, s55, s13
  v_mfma_f32_16x16x32_bf16 v[188:191], a[124:127], a[44:47], v[188:191]
  v_mfma_f32_16x16x32_bf16 v[220:223], a[124:127], a[48:51], v[220:223]
  v_mfma_f32_16x16x32_bf16 v[252:255], a[124:127], a[52:55], v[252:255]
  v_mfma_f32_16x16x32_bf16 a[156:159], a[124:127], a[56:59], a[156:159]
  v_mfma_f32_16x16x32_bf16 a[188:191], a[124:127], a[60:63], a[188:191]
  s_waitcnt lgkmcnt(0)
  v_mfma_f32_16x16x32_bf16 v[64:67], a[64:67], a[0:3], v[64:67]
  s_mov_b32 m0, s36
  ds_read_b128 a[32:35], v17 offset:0
  v_mfma_f32_16x16x32_bf16 v[96:99], a[64:67], a[4:7], v[96:99]
  buffer_load_dwordx4 v48, s[8:11], s46 offen offset:0 lds
  v_mfma_f32_16x16x32_bf16 v[128:131], a[64:67], a[8:11], v[128:131]
  ds_read_b64_tr_b16 a[96:97], v18 offset:4096
  v_mfma_f32_16x16x32_bf16 v[160:163], a[64:67], a[12:15], v[160:163]
  v_mfma_f32_16x16x32_bf16 v[192:195], a[64:67], a[16:19], v[192:195]
  ds_read_b64_tr_b16 a[98:99], v18 offset:6144
  v_mfma_f32_16x16x32_bf16 v[224:227], a[64:67], a[20:23], v[224:227]
  v_mfma_f32_16x16x32_bf16 a[128:131], a[64:67], a[24:27], a[128:131]
  ds_read_b128 a[36:39], v17 offset:2048
  v_mfma_f32_16x16x32_bf16 a[160:163], a[64:67], a[28:31], a[160:163]
  buffer_load_dwordx4 v49, s[8:11], s46 offen offset:1024 lds
  v_mfma_f32_16x16x32_bf16 v[68:71], a[68:71], a[0:3], v[68:71]
  v_mfma_f32_16x16x32_bf16 v[100:103], a[68:71], a[4:7], v[100:103]
  ds_read_b128 a[40:43], v17 offset:4096
  v_mfma_f32_16x16x32_bf16 v[132:135], a[68:71], a[8:11], v[132:135]
  v_mfma_f32_16x16x32_bf16 v[164:167], a[68:71], a[12:15], v[164:167]
  ds_read_b128 a[44:47], v17 offset:6144
  v_mfma_f32_16x16x32_bf16 v[196:199], a[68:71], a[16:19], v[196:199]
  v_mfma_f32_16x16x32_bf16 v[228:231], a[68:71], a[20:23], v[228:231]
  ds_read_b128 a[48:51], v17 offset:8192
  v_mfma_f32_16x16x32_bf16 a[132:135], a[68:71], a[24:27], a[132:135]
  buffer_load_dwordx4 v50, s[8:11], s46 offen offset:2048 lds
  v_mfma_f32_16x16x32_bf16 a[164:167], a[68:71], a[28:31], a[164:167]
  ds_read_b128 a[52:55], v17 offset:10240
  v_mfma_f32_16x16x32_bf16 v[72:75], a[72:75], a[0:3], v[72:75]
  v_mfma_f32_16x16x32_bf16 v[104:107], a[72:75], a[4:7], v[104:107]
  v_mfma_f32_16x16x32_bf16 v[136:139], a[72:75], a[8:11], v[136:139]
  ds_read_b128 a[56:59], v17 offset:12288
  v_mfma_f32_16x16x32_bf16 v[168:171], a[72:75], a[12:15], v[168:171]
  v_mfma_f32_16x16x32_bf16 v[200:203], a[72:75], a[16:19], v[200:203]
  ds_read_b128 a[60:63], v17 offset:14336
  v_mfma_f32_16x16x32_bf16 v[232:235], a[72:75], a[20:23], v[232:235]
  buffer_load_dwordx4 v51, s[8:11], s46 offen offset:3072 lds
  v_mfma_f32_16x16x32_bf16 a[136:139], a[72:75], a[24:27], a[136:139]
  s_add_u32 m0, s36, 4096
  ds_read_b64_tr_b16 a[100:101], v19 offset:4096
  v_mfma_f32_16x16x32_bf16 a[168:171], a[72:75], a[28:31], a[168:171]
  v_mfma_f32_16x16x32_bf16 v[76:79], a[76:79], a[0:3], v[76:79]
  ds_read_b64_tr_b16 a[102:103], v19 offset:6144
  v_mfma_f32_16x16x32_bf16 v[108:111], a[76:79], a[4:7], v[108:111]
  v_mfma_f32_16x16x32_bf16 v[140:143], a[76:79], a[8:11], v[140:143]
  v_mfma_f32_16x16x32_bf16 v[172:175], a[76:79], a[12:15], v[172:175]
  ds_read_b64_tr_b16 a[104:105], v20 offset:4096
  v_mfma_f32_16x16x32_bf16 v[204:207], a[76:79], a[16:19], v[204:207]
  buffer_load_dwordx4 v52, s[8:11], s46 offen offset:0 lds
  v_mfma_f32_16x16x32_bf16 v[236:239], a[76:79], a[20:23], v[236:239]
  ds_read_b64_tr_b16 a[106:107], v20 offset:6144
  v_mfma_f32_16x16x32_bf16 a[140:143], a[76:79], a[24:27], a[140:143]
  v_mfma_f32_16x16x32_bf16 a[172:175], a[76:79], a[28:31], a[172:175]
  ds_read_b64_tr_b16 a[108:109], v21 offset:4096
  v_mfma_f32_16x16x32_bf16 v[80:83], a[80:83], a[0:3], v[80:83]
  v_mfma_f32_16x16x32_bf16 v[112:115], a[80:83], a[4:7], v[112:115]
  ds_read_b64_tr_b16 a[110:111], v21 offset:6144
  v_mfma_f32_16x16x32_bf16 v[144:147], a[80:83], a[8:11], v[144:147]
  v_mfma_f32_16x16x32_bf16 v[176:179], a[80:83], a[12:15], v[176:179]
  buffer_load_dwordx4 v53, s[8:11], s46 offen offset:1024 lds
  v_mfma_f32_16x16x32_bf16 v[208:211], a[80:83], a[16:19], v[208:211]
  ds_read_b64_tr_b16 a[112:113], v18 offset:12288
  v_mfma_f32_16x16x32_bf16 v[240:243], a[80:83], a[20:23], v[240:243]
  v_mfma_f32_16x16x32_bf16 a[144:147], a[80:83], a[24:27], a[144:147]
  ds_read_b64_tr_b16 a[114:115], v18 offset:14336
  v_mfma_f32_16x16x32_bf16 a[176:179], a[80:83], a[28:31], a[176:179]
  v_mfma_f32_16x16x32_bf16 v[84:87], a[84:87], a[0:3], v[84:87]
  ds_read_b64_tr_b16 a[116:117], v19 offset:12288
  v_mfma_f32_16x16x32_bf16 v[116:119], a[84:87], a[4:7], v[116:119]
  v_mfma_f32_16x16x32_bf16 v[148:151], a[84:87], a[8:11], v[148:151]
  buffer_load_dwordx4 v54, s[8:11], s46 offen offset:2048 lds
  ds_read_b64_tr_b16 a[118:119], v19 offset:14336
  v_mfma_f32_16x16x32_bf16 v[180:183], a[84:87], a[12:15], v[180:183]
  v_mfma_f32_16x16x32_bf16 v[212:215], a[84:87], a[16:19], v[212:215]
  v_mfma_f32_16x16x32_bf16 v[244:247], a[84:87], a[20:23], v[244:247]
  ds_read_b64_tr_b16 a[120:121], v20 offset:12288
  v_mfma_f32_16x16x32_bf16 a[148:151], a[84:87], a[24:27], a[148:151]
  v_mfma_f32_16x16x32_bf16 a[180:183], a[84:87], a[28:31], a[180:183]
  ds_read_b64_tr_b16 a[122:123], v20 offset:14336
  v_mfma_f32_16x16x32_bf16 v[88:91], a[88:91], a[0:3], v[88:91]
  v_mfma_f32_16x16x32_bf16 v[120:123], a[88:91], a[4:7], v[120:123]
  buffer_load_dwordx4 v55, s[8:11], s46 offen offset:3072 lds
  ds_read_b64_tr_b16 a[124:125], v21 offset:12288
  v_mfma_f32_16x16x32_bf16 v[152:155], a[88:91], a[8:11], v[152:155]
  s_add_u32 s46, s46, 128
  s_sub_u32 s48, s48, 1
  s_cmp_eq_u32 s48, 0
  s_cselect_b32 s34, s52, 0
  s_cselect_b32 s48, s51, s48
  v_mfma_f32_16x16x32_bf16 v[184:187], a[88:91], a[12:15], v[184:187]
  s_sub_u32 s46, s46, s34
  ds_read_b64_tr_b16 a[126:127], v21 offset:14336
  v_mfma_f32_16x16x32_bf16 v[216:219], a[88:91], a[16:19], v[216:219]
  s_add_u32 s36, s36, s38
  s_add_u32 s37, s37, 1
  s_cmp_eq_u32 s37, 3
  s_cselect_b32 s37, 0, s37
  s_cselect_b32 s38, s39, s40
  v_mfma_f32_16x16x32_bf16 v[248:251], a[88:91], a[20:23], v[248:251]
  s_add_u32 s41, s41, s43
  s_sub_u32 s43, 0, s43
  v_mfma_f32_16x16x32_bf16 a[152:155], a[88:91], a[24:27], a[152:155]
  v_add_u32 v16, s38, v16
  v_add_u32 v17, s38, v17
  v_mfma_f32_16x16x32_bf16 a[184:187], a[88:91], a[28:31], a[184:187]
  v_add_u32 v18, s43, v18
  v_add_u32 v19, s43, v19
  v_mfma_f32_16x16x32_bf16 v[92:95], a[92:95], a[0:3], v[92:95]
  v_add_u32 v20, s43, v20
  v_add_u32 v21, s43, v21
  v_mfma_f32_16x16x32_bf16 v[124:127], a[92:95], a[4:7], v[124:127]
  v_mfma_f32_16x16x32_bf16 v[156:159], a[92:95], a[8:11], v[156:159]
  v_mfma_f32_16x16x32_bf16 v[188:191], a[92:95], a[12:15], v[188:191]
  v_mfma_f32_16x16x32_bf16 v[220:223], a[92:95], a[16:19], v[220:223]
  v_mfma_f32_16x16x32_bf16 v[252:255], a[92:95], a[20:23], v[252:255]
  v_mfma_f32_16x16x32_bf16 a[156:159], a[92:95], a[24:27], a[156:159]
  s_sub_u32 s35, s35, 1
  v_mfma_f32_16x16x32_bf16 a[188:191], a[92:95], a[28:31], a[188:191]
  s_cmp_lg_u32 s35, 0
  s_cbranch_scc1 Lp1wx_loop
  s_cmp_lt_u32 s2, 128
  s_cbranch_scc1 Lp1_qt
  s_waitcnt vmcnt(8) lgkmcnt(0)
  s_barrier
  v_mfma_f32_16x16x32_bf16 v[64:67], a[96:99], a[32:35], v[64:67]
  s_mov_b32 m0, s41
  ds_read_b128 a[0:3], v16 offset:0
  v_mfma_f32_16x16x32_bf16 v[96:99], a[96:99], a[36:39], v[96:99]
  buffer_load_dwordx4 v56, s[12:15], s47 offen offset:0 lds
  v_mfma_f32_16x16x32_bf16 v[128:131], a[96:99], a[40:43], v[128:131]
  ds_read_b64_tr_b16 a[64:65], v18 offset:0
  v_mfma_f32_16x16x32_bf16 v[160:163], a[96:99], a[44:47], v[160:163]
  buffer_load_dwordx4 v57, s[12:15], s47 offen offset:1024 lds
  v_mfma_f32_16x16x32_bf16 v[192:195], a[96:99], a[48:51], v[192:195]
  ds_read_b64_tr_b16 a[66:67], v18 offset:2048
  v_mfma_f32_16x16x32_bf16 v[224:227], a[96:99], a[52:55], v[224:227]
  v_mfma_f32_16x16x32_bf16 a[128:131], a[96:99], a[56:59], a[128:131]
  ds_read_b128 a[4:7], v16 offset:2048
  v_mfma_f32_16x16x32_bf16 a[160:163], a[96:99], a[60:63], a[160:163]
  buffer_load_dwordx4 v58, s[12:15], s47 offen offset:2048 lds
  v_mfma_f32_16x16x32_bf16 v[68:71], a[100:103], a[32:35], v[68:71]
  v_mfma_f32_16x16x32_bf16 v[100:103], a[100:103], a[36:39], v[100:103]
  ds_read_b128 a[8:11], v16 offset:4096
  v_mfma_f32_16x16x32_bf16 v[132:135], a[100:103], a[40:43], v[132:135]
  v_mfma_f32_16x16x32_bf16 v[164:167], a[100:103], a[44:47], v[164:167]
  buffer_load_dwordx4 v59, s[12:15], s47 offen offset:3072 lds
  ds_read_b128 a[12:15], v16 offset:6144
  v_mfma_f32_16x16x32_bf16 v[196:199], a[100:103], a[48:51], v[196:199]
  s_add_u32 m0, s41, 4096
  v_mfma_f32_16x16x32_bf16 v[228:231], a[100:103], a[52:55], v[228:231]
  ds_read_b128 a[16:19], v16 offset:8192
  v_mfma_f32_16x16x32_bf16 a[132:135], a[100:103], a[56:59], a[132:135]
  v_mfma_f32_16x16x32_bf16 a[164:167], a[100:103], a[60:63], a[164:167]
  buffer_load_dwordx4 v60, s[12:15], s47 offen offset:0 lds
  ds_read_b128 a[20:23], v16 offset:10240
  v_mfma_f32_16x16x32_bf16 v[72:75], a[104:107], a[32:35], v[72:75]
  v_mfma_f32_16x16x32_bf16 v[104:107], a[104:107], a[36:39], v[104:107]
  v_mfma_f32_16x16x32_bf16 v[136:139], a[104:107], a[40:43], v[136:139]
  ds_read_b128 a[24:27], v16 offset:12288
  v_mfma_f32_16x16x32_bf16 v[168:171], a[104:107], a[44:47], v[168:171]
  buffer_load_dwordx4 v61, s[12:15], s47 offen offset:1024 lds
  v_mfma_f32_16x16x32_bf16 v[200:203], a[104:107], a[48:51], v[200:203]
  ds_read_b128 a[28:31], v16 offset:14336
  v_mfma_f32_16x16x32_bf16 v[232:235], a[104:107], a[52:55], v[232:235]
  v_mfma_f32_16x16x32_bf16 a[136:139], a[104:107], a[56:59], a[136:139]
  ds_read_b64_tr_b16 a[68:69], v19 offset:0
  v_mfma_f32_16x16x32_bf16 a[168:171], a[104:107], a[60:63], a[168:171]
  buffer_load_dwordx4 v62, s[12:15], s47 offen offset:2048 lds
  v_mfma_f32_16x16x32_bf16 v[76:79], a[108:111], a[32:35], v[76:79]
  ds_read_b64_tr_b16 a[70:71], v19 offset:2048
  v_mfma_f32_16x16x32_bf16 v[108:111], a[108:111], a[36:39], v[108:111]
  v_mfma_f32_16x16x32_bf16 v[140:143], a[108:111], a[40:43], v[140:143]
  v_mfma_f32_16x16x32_bf16 v[172:175], a[108:111], a[44:47], v[172:175]
  buffer_load_dwordx4 v63, s[12:15], s47 offen offset:3072 lds
  ds_read_b64_tr_b16 a[72:73], v20 offset:0
  v_mfma_f32_16x16x32_bf16 v[204:207], a[108:111], a[48:51], v[204:207]
  s_add_u32 s47, s47, 524288
  s_sub_u32 s49, s49, 1
  s_cmp_eq_u32 s49, 0
  s_cselect_b32 s34, s53, 0
  s_cselect_b32 s49, s51, s49
  v_mfma_f32_16x16x32_bf16 v[236:239], a[108:111], a[52:55], v[236:239]
  s_sub_u32 s47, s47, s34
  s_sub_u32 s50, s50, 1
  s_cmp_eq_u32 s50, 0
  s_cselect_b32 s12, s54, s12
  s_cselect_b32 s13, s55, s13
  v_mfma_f32_16x16x32_bf16 a[140:143], a[108:111], a[56:59], a[140:143]
  s_mov_b32 m0, s36
  ds_read_b64_tr_b16 a[74:75], v20 offset:2048
  v_mfma_f32_16x16x32_bf16 a[172:175], a[108:111], a[60:63], a[172:175]
  buffer_load_dwordx4 v48, s[8:11], s46 offen offset:0 lds
  ds_read_b64_tr_b16 a[76:77], v21 offset:0
  v_mfma_f32_16x16x32_bf16 v[80:83], a[112:115], a[32:35], v[80:83]
  v_mfma_f32_16x16x32_bf16 v[112:115], a[112:115], a[36:39], v[112:115]
  ds_read_b64_tr_b16 a[78:79], v21 offset:2048
  v_mfma_f32_16x16x32_bf16 v[144:147], a[112:115], a[40:43], v[144:147]
  v_mfma_f32_16x16x32_bf16 v[176:179], a[112:115], a[44:47], v[176:179]
  buffer_load_dwordx4 v49, s[8:11], s46 offen offset:1024 lds
  v_mfma_f32_16x16x32_bf16 v[208:211], a[112:115], a[48:51], v[208:211]
  ds_read_b64_tr_b16 a[80:81], v18 offset:8192
  v_mfma_f32_16x16x32_bf16 v[240:243], a[112:115], a[52:55], v[240:243]
  v_mfma_f32_16x16x32_bf16 a[144:147], a[112:115], a[56:59], a[144:147]
  ds_read_b64_tr_b16 a[82:83], v18 offset:10240
  v_mfma_f32_16x16x32_bf16 a[176:179], a[112:115], a[60:63], a[176:179]
  buffer_load_dwordx4 v50, s[8:11], s46 offen offset:2048 lds
  v_mfma_f32_16x16x32_bf16 v[84:87], a[116:119], a[32:35], v[84:87]
  ds_read_b64_tr_b16 a[84:85], v19 offset:8192
  v_mfma_f32_16x16x32_bf16 v[116:119], a[116:119], a[36:39], v[116:119]
  v_mfma_f32_16x16x32_bf16 v[148:151], a[116:119], a[40:43], v[148:151]
  ds_read_b64_tr_b16 a[86:87], v19 offset:10240
  v_mfma_f32_16x16x32_bf16 v[180:183], a[116:119], a[44:47], v[180:183]
  buffer_load_dwordx4 v51, s[8:11], s46 offen offset:3072 lds
  v_mfma_f32_16x16x32_bf16 v[212:215], a[116:119], a[48:51], v[212:215]
  s_add_u32 m0, s36, 4096
  v_mfma_f32_16x16x32_bf16 v[244:247], a[116:119], a[52:55], v[244:247]
  ds_read_b64_tr_b16 a[88:89], v20 offset:8192
  v_mfma_f32_16x16x32_bf16 a[148:151], a[116:119], a[56:59], a[148:151]
  v_mfma_f32_16x16x32_bf16 a[180:183], a[116:119], a[60:63], a[180:183]
  buffer_load_dwordx4 v52, s[8:11], s46 offen offset:0 lds
  ds_read_b64_tr_b16 a[90:91], v20 offset:10240
  v_mfma_f32_16x16x32_bf16 v[88:91], a[120:123], a[32:35], v[88:91]
  v_mfma_f32_16x16x32_bf16 v[120:123], a[120:123], a[36:39], v[120:123]
  ds_read_b64_tr_b16 a[92:93], v21 offset:8192
  v_mfma_f32_16x16x32_bf16 v[152:155], a[120:123], a[40:43], v[152:155]
  v_mfma_f32_16x16x32_bf16 v[184:187], a[120:123], a[44:47], v[184:187]
  buffer_load_dwordx4 v53, s[8:11], s46 offen offset:1024 lds
  ds_read_b64_tr_b16 a[94:95], v21 offset:10240
  v_mfma_f32_16x16x32_bf16 v[216:219], a[120:123], a[48:51], v[216:219]
  v_mfma_f32_16x16x32_bf16 v[248:251], a[120:123], a[52:55], v[248:251]
  v_mfma_f32_16x16x32_bf16 a[152:155], a[120:123], a[56:59], a[152:155]
  v_mfma_f32_16x16x32_bf16 a[184:187], a[120:123], a[60:63], a[184:187]
  buffer_load_dwordx4 v54, s[8:11], s46 offen offset:2048 lds
  v_mfma_f32_16x16x32_bf16 v[92:95], a[124:127], a[32:35], v[92:95]
  v_mfma_f32_16x16x32_bf16 v[124:127], a[124:127], a[36:39], v[124:127]
  v_mfma_f32_16x16x32_bf16 v[156:159], a[124:127], a[40:43], v[156:159]
  v_mfma_f32_16x16x32_bf16 v[188:191], a[124:127], a[44:47], v[188:191]
  buffer_load_dwordx4 v55, s[8:11], s46 offen offset:3072 lds
  v_mfma_f32_16x16x32_bf16 v[220:223], a[124:127], a[48:51], v[220:223]
  s_add_u32 s46, s46, 128
  s_sub_u32 s48, s48, 1
  s_cmp_eq_u32 s48, 0
  s_cselect_b32 s34, s52, 0
  s_cselect_b32 s48, s51, s48
  v_mfma_f32_16x16x32_bf16 v[252:255], a[124:127], a[52:55], v[252:255]
  s_sub_u32 s46, s46, s34
  v_mfma_f32_16x16x32_bf16 a[156:159], a[124:127], a[56:59], a[156:159]
  v_mfma_f32_16x16x32_bf16 a[188:191], a[124:127], a[60:63], a[188:191]
  s_and_b32 s4, s3, 1
  s_lshl_b32 s5, s62, 1
  s_add_u32 s4, s4, s5
  s_lshr_b32 s5, s3, 1
  s_lshl_b32 s6, s61, 1
  s_add_u32 s5, s5, s6
  s_add_u32 s16, s86, 16777216
  s_addc_u32 s17, s87, 0
  s_mov_b32 s18, 33554432
  s_mov_b32 s19, 0x00020000
  s_lshl_b32 s4, s4, 20
  s_lshl_b32 s5, s5, 16
  s_add_u32 s4, s4, s5
  v_cvt_pk_bf16_f32 v64, v64, v65
  v_cvt_pk_bf16_f32 v65, v66, v67
  v_cvt_pk_bf16_f32 v66, v68, v69
  v_cvt_pk_bf16_f32 v67, v70, v71
  buffer_store_dwordx4 v[64:67], v2, s[16:19], s4 offen offset:0 sc1
  v_cvt_pk_bf16_f32 v72, v72, v73
  v_cvt_pk_bf16_f32 v73, v74, v75
  v_cvt_pk_bf16_f32 v74, v76, v77
  v_cvt_pk_bf16_f32 v75, v78, v79
  buffer_store_dwordx4 v[72:75], v2, s[16:19], s4 offen offset:1024 sc1
  v_cvt_pk_bf16_f32 v80, v80, v81
  v_cvt_pk_bf16_f32 v81, v82, v83
  v_cvt_pk_bf16_f32 v82, v84, v85
  v_cvt_pk_bf16_f32 v83, v86, v87
  buffer_store_dwordx4 v[80:83], v2, s[16:19], s4 offen offset:2048 sc1
  v_cvt_pk_bf16_f32 v88, v88, v89
  v_cvt_pk_bf16_f32 v89, v90, v91
  v_cvt_pk_bf16_f32 v90, v92, v93
  v_cvt_pk_bf16_f32 v91, v94, v95
  buffer_store_dwordx4 v[88:91], v2, s[16:19], s4 offen offset:3072 sc1
  s_add_u32 s4, s4, 4096
  v_cvt_pk_bf16_f32 v96, v96, v97
  v_cvt_pk_bf16_f32 v97, v98, v99
  v_cvt_pk_bf16_f32 v98, v100, v101
  v_cvt_pk_bf16_f32 v99, v102, v103
  buffer_store_dwordx4 v[96:99], v2, s[16:19], s4 offen offset:0 sc1
  v_cvt_pk_bf16_f32 v104, v104, v105
  v_cvt_pk_bf16_f32 v105, v106, v107
  v_cvt_pk_bf16_f32 v106, v108, v109
  v_cvt_pk_bf16_f32 v107, v110, v111
  buffer_store_dwordx4 v[104:107], v2, s[16:19], s4 offen offset:1024 sc1
  v_cvt_pk_bf16_f32 v112, v112, v113
  v_cvt_pk_bf16_f32 v113, v114, v115
  v_cvt_pk_bf16_f32 v114, v116, v117
  v_cvt_pk_bf16_f32 v115, v118, v119
  buffer_store_dwordx4 v[112:115], v2, s[16:19], s4 offen offset:2048 sc1
  v_cvt_pk_bf16_f32 v120, v120, v121
  v_cvt_pk_bf16_f32 v121, v122, v123
  v_cvt_pk_bf16_f32 v122, v124, v125
  v_cvt_pk_bf16_f32 v123, v126, v127
  buffer_store_dwordx4 v[120:123], v2, s[16:19], s4 offen offset:3072 sc1
  s_add_u32 s4, s4, 4096
  v_cvt_pk_bf16_f32 v128, v128, v129
  v_cvt_pk_bf16_f32 v129, v130, v131
  v_cvt_pk_bf16_f32 v130, v132, v133
  v_cvt_pk_bf16_f32 v131, v134, v135
  buffer_store_dwordx4 v[128:131], v2, s[16:19], s4 offen offset:0 sc1
  v_cvt_pk_bf16_f32 v136, v136, v137
  v_cvt_pk_bf16_f32 v137, v138, v139
  v_cvt_pk_bf16_f32 v138, v140, v141
  v_cvt_pk_bf16_f32 v139, v142, v143
  buffer_store_dwordx4 v[136:139], v2, s[16:19], s4 offen offset:1024 sc1
  v_cvt_pk_bf16_f32 v144, v144, v145
  v_cvt_pk_bf16_f32 v145, v146, v147
  v_cvt_pk_bf16_f32 v146, v148, v149
  v_cvt_pk_bf16_f32 v147, v150, v151
  buffer_store_dwordx4 v[144:147], v2, s[16:19], s4 offen offset:2048 sc1
  v_cvt_pk_bf16_f32 v152, v152, v153
  v_cvt_pk_bf16_f32 v153, v154, v155
  v_cvt_pk_bf16_f32 v154, v156, v157
  v_cvt_pk_bf16_f32 v155, v158, v159
  buffer_store_dwordx4 v[152:155], v2, s[16:19], s4 offen offset:3072 sc1
  s_add_u32 s4, s4, 4096
  v_cvt_pk_bf16_f32 v160, v160, v161
  v_cvt_pk_bf16_f32 v161, v162, v163
  v_cvt_pk_bf16_f32 v162, v164, v165
  v_cvt_pk_bf16_f32 v163, v166, v167
  buffer_store_dwordx4 v[160:163], v2, s[16:19], s4 offen offset:0 sc1
  v_cvt_pk_bf16_f32 v168, v168, v169
  v_cvt_pk_bf16_f32 v169, v170, v171
  v_cvt_pk_bf16_f32 v170, v172, v173
  v_cvt_pk_bf16_f32 v171, v174, v175
  buffer_store_dwordx4 v[168:171], v2, s[16:19], s4 offen offset:1024 sc1
  v_cvt_pk_bf16_f32 v176, v176, v177
  v_cvt_pk_bf16_f32 v177, v178, v179
  v_cvt_pk_bf16_f32 v178, v180, v181
  v_cvt_pk_bf16_f32 v179, v182, v183
  buffer_store_dwordx4 v[176:179], v2, s[16:19], s4 offen offset:2048 sc1
  v_cvt_pk_bf16_f32 v184, v184, v185
  v_cvt_pk_bf16_f32 v185, v186, v187
  v_cvt_pk_bf16_f32 v186, v188, v189
  v_cvt_pk_bf16_f32 v187, v190, v191
  buffer_store_dwordx4 v[184:187], v2, s[16:19], s4 offen offset:3072 sc1
  s_add_u32 s4, s4, 20480
  v_cvt_pk_bf16_f32 v192, v192, v193
  v_cvt_pk_bf16_f32 v193, v194, v195
  v_cvt_pk_bf16_f32 v194, v196, v197
  v_cvt_pk_bf16_f32 v195, v198, v199
  buffer_store_dwordx4 v[192:195], v2, s[16:19], s4 offen offset:0 sc1
  v_cvt_pk_bf16_f32 v200, v200, v201
  v_cvt_pk_bf16_f32 v201, v202, v203
  v_cvt_pk_bf16_f32 v202, v204, v205
  v_cvt_pk_bf16_f32 v203, v206, v207
  buffer_store_dwordx4 v[200:203], v2, s[16:19], s4 offen offset:1024 sc1
  v_cvt_pk_bf16_f32 v208, v208, v209
  v_cvt_pk_bf16_f32 v209, v210, v211
  v_cvt_pk_bf16_f32 v210, v212, v213
  v_cvt_pk_bf16_f32 v211, v214, v215
  buffer_store_dwordx4 v[208:211], v2, s[16:19], s4 offen offset:2048 sc1
  v_cvt_pk_bf16_f32 v216, v216, v217
  v_cvt_pk_bf16_f32 v217, v218, v219
  v_cvt_pk_bf16_f32 v218, v220, v221
  v_cvt_pk_bf16_f32 v219, v222, v223
  buffer_store_dwordx4 v[216:219], v2, s[16:19], s4 offen offset:3072 sc1
  s_add_u32 s4, s4, 4096
  v_cvt_pk_bf16_f32 v224, v224, v225
  v_cvt_pk_bf16_f32 v225, v226, v227
  v_cvt_pk_bf16_f32 v226, v228, v229
  v_cvt_pk_bf16_f32 v227, v230, v231
  buffer_store_dwordx4 v[224:227], v2, s[16:19], s4 offen offset:0 sc1
  v_cvt_pk_bf16_f32 v232, v232, v233
  v_cvt_pk_bf16_f32 v233, v234, v235
  v_cvt_pk_bf16_f32 v234, v236, v237
  v_cvt_pk_bf16_f32 v235, v238, v239
  buffer_store_dwordx4 v[232:235], v2, s[16:19], s4 offen offset:1024 sc1
  v_cvt_pk_bf16_f32 v240, v240, v241
  v_cvt_pk_bf16_f32 v241, v242, v243
  v_cvt_pk_bf16_f32 v242, v244, v245
  v_cvt_pk_bf16_f32 v243, v246, v247
  buffer_store_dwordx4 v[240:243], v2, s[16:19], s4 offen offset:2048 sc1
  v_cvt_pk_bf16_f32 v248, v248, v249
  v_cvt_pk_bf16_f32 v249, v250, v251
  v_cvt_pk_bf16_f32 v250, v252, v253
  v_cvt_pk_bf16_f32 v251, v254, v255
  buffer_store_dwordx4 v[248:251], v2, s[16:19], s4 offen offset:3072 sc1
  s_add_u32 s4, s4, 4096
  v_accvgpr_read_b32 v64, a128
  v_accvgpr_read_b32 v65, a129
  v_accvgpr_read_b32 v66, a130
  v_accvgpr_read_b32 v67, a131
  v_accvgpr_read_b32 v68, a132
  v_accvgpr_read_b32 v69, a133
  v_accvgpr_read_b32 v70, a134
  v_accvgpr_read_b32 v71, a135
  v_cvt_pk_bf16_f32 v64, v64, v65
  v_cvt_pk_bf16_f32 v65, v66, v67
  v_cvt_pk_bf16_f32 v66, v68, v69
  v_cvt_pk_bf16_f32 v67, v70, v71
  buffer_store_dwordx4 v[64:67], v2, s[16:19], s4 offen offset:0 sc1
  v_accvgpr_read_b32 v72, a136
  v_accvgpr_read_b32 v73, a137
  v_accvgpr_read_b32 v74, a138
  v_accvgpr_read_b32 v75, a139
  v_accvgpr_read_b32 v76, a140
  v_accvgpr_read_b32 v77, a141
  v_accvgpr_read_b32 v78, a142
  v_accvgpr_read_b32 v79, a143
  v_cvt_pk_bf16_f32 v72, v72, v73
  v_cvt_pk_bf16_f32 v73, v74, v75
  v_cvt_pk_bf16_f32 v74, v76, v77
  v_cvt_pk_bf16_f32 v75, v78, v79
  buffer_store_dwordx4 v[72:75], v2, s[16:19], s4 offen offset:1024 sc1
  v_accvgpr_read_b32 v80, a144
  v_accvgpr_read_b32 v81, a145
  v_accvgpr_read_b32 v82, a146
  v_accvgpr_read_b32 v83, a147
  v_accvgpr_read_b32 v84, a148
  v_accvgpr_read_b32 v85, a149
  v_accvgpr_read_b32 v86, a150
  v_accvgpr_read_b32 v87, a151
  v_cvt_pk_bf16_f32 v80, v80, v81
  v_cvt_pk_bf16_f32 v81, v82, v83
  v_cvt_pk_bf16_f32 v82, v84, v85
  v_cvt_pk_bf16_f32 v83, v86, v87
  buffer_store_dwordx4 v[80:83], v2, s[16:19], s4 offen offset:2048 sc1
  v_accvgpr_read_b32 v88, a152
  v_accvgpr_read_b32 v89, a153
  v_accvgpr_read_b32 v90, a154
  v_accvgpr_read_b32 v91, a155
  v_accvgpr_read_b32 v92, a156
  v_accvgpr_read_b32 v93, a157
  v_accvgpr_read_b32 v94, a158
  v_accvgpr_read_b32 v95, a159
  v_cvt_pk_bf16_f32 v88, v88, v89
  v_cvt_pk_bf16_f32 v89, v90, v91
  v_cvt_pk_bf16_f32 v90, v92, v93
  v_cvt_pk_bf16_f32 v91, v94, v95
  buffer_store_dwordx4 v[88:91], v2, s[16:19], s4 offen offset:3072 sc1
  s_add_u32 s4, s4, 4096
  v_accvgpr_read_b32 v96, a160
  v_accvgpr_read_b32 v97, a161
  v_accvgpr_read_b32 v98, a162
  v_accvgpr_read_b32 v99, a163
  v_accvgpr_read_b32 v100, a164
  v_accvgpr_read_b32 v101, a165
  v_accvgpr_read_b32 v102, a166
  v_accvgpr_read_b32 v103, a167
  v_cvt_pk_bf16_f32 v96, v96, v97
  v_cvt_pk_bf16_f32 v97, v98, v99
  v_cvt_pk_bf16_f32 v98, v100, v101
  v_cvt_pk_bf16_f32 v99, v102, v103
  buffer_store_dwordx4 v[96:99], v2, s[16:19], s4 offen offset:0 sc1
  v_accvgpr_read_b32 v104, a168
  v_accvgpr_read_b32 v105, a169
  v_accvgpr_read_b32 v106, a170
  v_accvgpr_read_b32 v107, a171
  v_accvgpr_read_b32 v108, a172
  v_accvgpr_read_b32 v109, a173
  v_accvgpr_read_b32 v110, a174
  v_accvgpr_read_b32 v111, a175
  v_cvt_pk_bf16_f32 v104, v104, v105
  v_cvt_pk_bf16_f32 v105, v106, v107
  v_cvt_pk_bf16_f32 v106, v108, v109
  v_cvt_pk_bf16_f32 v107, v110, v111
  buffer_store_dwordx4 v[104:107], v2, s[16:19], s4 offen offset:1024 sc1
  v_accvgpr_read_b32 v112, a176
  v_accvgpr_read_b32 v113, a177
  v_accvgpr_read_b32 v114, a178
  v_accvgpr_read_b32 v115, a179
  v_accvgpr_read_b32 v116, a180
  v_accvgpr_read_b32 v117, a181
  v_accvgpr_read_b32 v118, a182
  v_accvgpr_read_b32 v119, a183
  v_cvt_pk_bf16_f32 v112, v112, v113
  v_cvt_pk_bf16_f32 v113, v114, v115
  v_cvt_pk_bf16_f32 v114, v116, v117
  v_cvt_pk_bf16_f32 v115, v118, v119
  buffer_store_dwordx4 v[112:115], v2, s[16:19], s4 offen offset:2048 sc1
  v_accvgpr_read_b32 v120, a184
  v_accvgpr_read_b32 v121, a185
  v_accvgpr_read_b32 v122, a186
  v_accvgpr_read_b32 v123, a187
  v_accvgpr_read_b32 v124, a188
  v_accvgpr_read_b32 v125, a189
  v_accvgpr_read_b32 v126, a190
  v_accvgpr_read_b32 v127, a191
  v_cvt_pk_bf16_f32 v120, v120, v121
  v_cvt_pk_bf16_f32 v121, v122, v123
  v_cvt_pk_bf16_f32 v122, v124, v125
  v_cvt_pk_bf16_f32 v123, v126, v127
  buffer_store_dwordx4 v[120:123], v2, s[16:19], s4 offen offset:3072 sc1
  s_waitcnt lgkmcnt(0)
  v_mfma_f32_16x16x32_bf16 v[64:67], a[0:3], a[64:67], 0
  s_add_u32 s36, s36, s38
  s_add_u32 s37, s37, 1
  ds_read_b128 a[32:35], v17 offset:0
  v_mfma_f32_16x16x32_bf16 v[96:99], a[4:7], a[64:67], 0
  s_cmp_eq_u32 s37, 3
  s_cselect_b32 s37, 0, s37
  s_cselect_b32 s38, s39, s40
  v_mfma_f32_16x16x32_bf16 v[128:131], a[8:11], a[64:67], 0
  s_add_u32 s41, s41, s43
  s_sub_u32 s43, 0, s43
  ds_read_b64_tr_b16 a[96:97], v18 offset:4096
  v_mfma_f32_16x16x32_bf16 v[160:163], a[12:15], a[64:67], 0
  v_mfma_f32_16x16x32_bf16 v[192:195], a[16:19], a[64:67], 0
  ds_read_b64_tr_b16 a[98:99], v18 offset:6144
  v_mfma_f32_16x16x32_bf16 v[224:227], a[20:23], a[64:67], 0
  v_mfma_f32_16x16x32_bf16 a[128:131], a[24:27], a[64:67], 0
  ds_read_b128 a[36:39], v17 offset:2048
  v_mfma_f32_16x16x32_bf16 a[160:163], a[28:31], a[64:67], 0
  v_mfma_f32_16x16x32_bf16 v[68:71], a[0:3], a[68:71], 0
  v_mfma_f32_16x16x32_bf16 v[100:103], a[4:7], a[68:71], 0
  ds_read_b128 a[40:43], v17 offset:4096
  v_mfma_f32_16x16x32_bf16 v[132:135], a[8:11], a[68:71], 0
  v_mfma_f32_16x16x32_bf16 v[164:167], a[12:15], a[68:71], 0
  ds_read_b128 a[44:47], v17 offset:6144
  v_mfma_f32_16x16x32_bf16 v[196:199], a[16:19], a[68:71], 0
  v_mfma_f32_16x16x32_bf16 v[228:231], a[20:23], a[68:71], 0
  ds_read_b128 a[48:51], v17 offset:8192
  v_mfma_f32_16x16x32_bf16 a[132:135], a[24:27], a[68:71], 0
  v_mfma_f32_16x16x32_bf16 a[164:167], a[28:31], a[68:71], 0
  ds_read_b128 a[52:55], v17 offset:10240
  v_mfma_f32_16x16x32_bf16 v[72:75], a[0:3], a[72:75], 0
  v_mfma_f32_16x16x32_bf16 v[104:107], a[4:7], a[72:75], 0
  v_mfma_f32_16x16x32_bf16 v[136:139], a[8:11], a[72:75], 0
  ds_read_b128 a[56:59], v17 offset:12288
  v_mfma_f32_16x16x32_bf16 v[168:171], a[12:15], a[72:75], 0
  v_mfma_f32_16x16x32_bf16 v[200:203], a[16:19], a[72:75], 0
  ds_read_b128 a[60:63], v17 offset:14336
  v_mfma_f32_16x16x32_bf16 v[232:235], a[20:23], a[72:75], 0
  v_mfma_f32_16x16x32_bf16 a[136:139], a[24:27], a[72:75], 0
  ds_read_b64_tr_b16 a[100:101], v19 offset:4096
  v_mfma_f32_16x16x32_bf16 a[168:171], a[28:31], a[72:75], 0
  v_mfma_f32_16x16x32_bf16 v[76:79], a[0:3], a[76:79], 0
  ds_read_b64_tr_b16 a[102:103], v19 offset:6144
  v_mfma_f32_16x16x32_bf16 v[108:111], a[4:7], a[76:79], 0
  v_mfma_f32_16x16x32_bf16 v[140:143], a[8:11], a[76:79], 0
  v_mfma_f32_16x16x32_bf16 v[172:175], a[12:15], a[76:79], 0
  ds_read_b64_tr_b16 a[104:105], v20 offset:4096
  v_mfma_f32_16x16x32_bf16 v[204:207], a[16:19], a[76:79], 0
  v_mfma_f32_16x16x32_bf16 v[236:239], a[20:23], a[76:79], 0
  ds_read_b64_tr_b16 a[106:107], v20 offset:6144
  v_mfma_f32_16x16x32_bf16 a[140:143], a[24:27], a[76:79], 0
  v_mfma_f32_16x16x32_bf16 a[172:175], a[28:31], a[76:79], 0
  ds_read_b64_tr_b16 a[108:109], v21 offset:4096
  v_mfma_f32_16x16x32_bf16 v[80:83], a[0:3], a[80:83], 0
  v_mfma_f32_16x16x32_bf16 v[112:115], a[4:7], a[80:83], 0
  ds_read_b64_tr_b16 a[110:111], v21 offset:6144
  v_mfma_f32_16x16x32_bf16 v[144:147], a[8:11], a[80:83], 0
  v_mfma_f32_16x16x32_bf16 v[176:179], a[12:15], a[80:83], 0
  v_mfma_f32_16x16x32_bf16 v[208:211], a[16:19], a[80:83], 0
  ds_read_b64_tr_b16 a[112:113], v18 offset:12288
  v_mfma_f32_16x16x32_bf16 v[240:243], a[20:23], a[80:83], 0
  v_mfma_f32_16x16x32_bf16 a[144:147], a[24:27], a[80:83], 0
  ds_read_b64_tr_b16 a[114:115], v18 offset:14336
  v_mfma_f32_16x16x32_bf16 a[176:179], a[28:31], a[80:83], 0
  v_mfma_f32_16x16x32_bf16 v[84:87], a[0:3], a[84:87], 0
  ds_read_b64_tr_b16 a[116:117], v19 offset:12288
  v_mfma_f32_16x16x32_bf16 v[116:119], a[4:7], a[84:87], 0
  v_mfma_f32_16x16x32_bf16 v[148:151], a[8:11], a[84:87], 0
  ds_read_b64_tr_b16 a[118:119], v19 offset:14336
  v_mfma_f32_16x16x32_bf16 v[180:183], a[12:15], a[84:87], 0
  v_mfma_f32_16x16x32_bf16 v[212:215], a[16:19], a[84:87], 0
  v_mfma_f32_16x16x32_bf16 v[244:247], a[20:23], a[84:87], 0
  ds_read_b64_tr_b16 a[120:121], v20 offset:12288
  v_mfma_f32_16x16x32_bf16 a[148:151], a[24:27], a[84:87], 0
  v_mfma_f32_16x16x32_bf16 a[180:183], a[28:31], a[84:87], 0
  ds_read_b64_tr_b16 a[122:123], v20 offset:14336
  v_mfma_f32_16x16x32_bf16 v[88:91], a[0:3], a[88:91], 0
  v_mfma_f32_16x16x32_bf16 v[120:123], a[4:7], a[88:91], 0
  ds_read_b64_tr_b16 a[124:125], v21 offset:12288
  v_mfma_f32_16x16x32_bf16 v[152:155], a[8:11], a[88:91], 0
  v_mfma_f32_16x16x32_bf16 v[184:187], a[12:15], a[88:91], 0
  ds_read_b64_tr_b16 a[126:127], v21 offset:14336
  v_mfma_f32_16x16x32_bf16 v[216:219], a[16:19], a[88:91], 0
  v_add_u32 v16, s38, v16
  v_add_u32 v17, s38, v17
  v_mfma_f32_16x16x32_bf16 v[248:251], a[20:23], a[88:91], 0
  v_add_u32 v18, s43, v18
  v_add_u32 v19, s43, v19
  v_mfma_f32_16x16x32_bf16 a[152:155], a[24:27], a[88:91], 0
  v_add_u32 v20, s43, v20
  v_add_u32 v21, s43, v21
  v_mfma_f32_16x16x32_bf16 a[184:187], a[28:31], a[88:91], 0
  v_mfma_f32_16x16x32_bf16 v[92:95], a[0:3], a[92:95], 0
  v_mfma_f32_16x16x32_bf16 v[124:127], a[4:7], a[92:95], 0
  v_mfma_f32_16x16x32_bf16 v[156:159], a[8:11], a[92:95], 0
  v_mfma_f32_16x16x32_bf16 v[188:191], a[12:15], a[92:95], 0
  v_mfma_f32_16x16x32_bf16 v[220:223], a[16:19], a[92:95], 0
  v_mfma_f32_16x16x32_bf16 v[252:255], a[20:23], a[92:95], 0
  v_mfma_f32_16x16x32_bf16 a[156:159], a[24:27], a[92:95], 0
  v_mfma_f32_16x16x32_bf16 a[188:191], a[28:31], a[92:95], 0
  s_waitcnt vmcnt(40) lgkmcnt(0)
  s_barrier
  v_mfma_f32_16x16x32_bf16 v[64:67], a[32:35], a[96:99], v[64:67]
  buffer_load_dwordx4 v[4:7], v2, s[56:59], s60 offen
  ds_read_b128 a[0:3], v16 offset:0
  v_mfma_f32_16x16x32_bf16 v[96:99], a[36:39], a[96:99], v[96:99]
  s_add_u32 s60, s60, 1024
  s_mov_b32 m0, s41
  v_mfma_f32_16x16x32_bf16 v[128:131], a[40:43], a[96:99], v[128:131]
  ds_read_b64_tr_b16 a[64:65], v18 offset:0
  v_mfma_f32_16x16x32_bf16 v[160:163], a[44:47], a[96:99], v[160:163]
  v_mfma_f32_16x16x32_bf16 v[192:195], a[48:51], a[96:99], v[192:195]
  ds_read_b64_tr_b16 a[66:67], v18 offset:2048
  v_mfma_f32_16x16x32_bf16 v[224:227], a[52:55], a[96:99], v[224:227]
  v_mfma_f32_16x16x32_bf16 a[128:131], a[56:59], a[96:99], a[128:131]
  ds_read_b128 a[4:7], v16 offset:2048
  v_mfma_f32_16x16x32_bf16 a[160:163], a[60:63], a[96:99], a[160:163]
  buffer_load_dwordx4 v56, s[12:15], s47 offen offset:0 lds
  v_mfma_f32_16x16x32_bf16 v[68:71], a[32:35], a[100:103], v[68:71]
  v_mfma_f32_16x16x32_bf16 v[100:103], a[36:39], a[100:103], v[100:103]
  ds_read_b128 a[8:11], v16 offset:4096
  v_mfma_f32_16x16x32_bf16 v[132:135], a[40:43], a[100:103], v[132:135]
  v_mfma_f32_16x16x32_bf16 v[164:167], a[44:47], a[100:103], v[164:167]
  ds_read_b128 a[12:15], v16 offset:6144
  v_mfma_f32_16x16x32_bf16 v[196:199], a[48:51], a[100:103], v[196:199]
  v_mfma_f32_16x16x32_bf16 v[228:231], a[52:55], a[100:103], v[228:231]
  ds_read_b128 a[16:19], v16 offset:8192
  v_mfma_f32_16x16x32_bf16 a[132:135], a[56:59], a[100:103], a[132:135]
  buffer_load_dwordx4 v57, s[12:15], s47 offen offset:1024 lds
  v_mfma_f32_16x16x32_bf16 a[164:167], a[60:63], a[100:103], a[164:167]
  ds_read_b128 a[20:23], v16 offset:10240
  v_mfma_f32_16x16x32_bf16 v[72:75], a[32:35], a[104:107], v[72:75]
  v_mfma_f32_16x16x32_bf16 v[104:107], a[36:39], a[104:107], v[104:107]
  v_mfma_f32_16x16x32_bf16 v[136:139], a[40:43], a[104:107], v[136:139]
  ds_read_b128 a[24:27], v16 offset:12288
  v_mfma_f32_16x16x32_bf16 v[168:171], a[44:47], a[104:107], v[168:171]
  v_mfma_f32_16x16x32_bf16 v[200:203], a[48:51], a[104:107], v[200:203]
  ds_read_b128 a[28:31], v16 offset:14336
  v_mfma_f32_16x16x32_bf16 v[232:235], a[52:55], a[104:107], v[232:235]
  buffer_load_dwordx4 v58, s[12:15], s47 offen offset:2048 lds
  v_mfma_f32_16x16x32_bf16 a[136:139], a[56:59], a[104:107], a[136:139]
  ds_read_b64_tr_b16 a[68:69], v19 offset:0
  v_mfma_f32_16x16x32_bf16 a[168:171], a[60:63], a[104:107], a[168:171]
  v_mfma_f32_16x16x32_bf16 v[76:79], a[32:35], a[108:111], v[76:79]
  ds_read_b64_tr_b16 a[70:71], v19 offset:2048
  v_mfma_f32_16x16x32_bf16 v[108:111], a[36:39], a[108:111], v[108:111]
  v_mfma_f32_16x16x32_bf16 v[140:143], a[40:43], a[108:111], v[140:143]
  v_mfma_f32_16x16x32_bf16 v[172:175], a[44:47], a[108:111], v[172:175]
  ds_read_b64_tr_b16 a[72:73], v20 offset:0
  v_mfma_f32_16x16x32_bf16 v[204:207], a[48:51], a[108:111], v[204:207]
  buffer_load_dwordx4 v59, s[12:15], s47 offen offset:3072 lds
  v_mfma_f32_16x16x32_bf16 v[236:239], a[52:55], a[108:111], v[236:239]
  s_add_u32 m0, s41, 4096
  ds_read_b64_tr_b16 a[74:75], v20 offset:2048
  v_mfma_f32_16x16x32_bf16 a[140:143], a[56:59], a[108:111], a[140:143]
  v_mfma_f32_16x16x32_bf16 a[172:175], a[60:63], a[108:111], a[172:175]
  ds_read_b64_tr_b16 a[76:77], v21 offset:0
  v_mfma_f32_16x16x32_bf16 v[80:83], a[32:35], a[112:115], v[80:83]
  v_mfma_f32_16x16x32_bf16 v[112:115], a[36:39], a[112:115], v[112:115]
  ds_read_b64_tr_b16 a[78:79], v21 offset:2048
  v_mfma_f32_16x16x32_bf16 v[144:147], a[40:43], a[112:115], v[144:147]
  v_mfma_f32_16x16x32_bf16 v[176:179], a[44:47], a[112:115], v[176:179]
  buffer_load_dwordx4 v60, s[12:15], s47 offen offset:0 lds
  v_mfma_f32_16x16x32_bf16 v[208:211], a[48:51], a[112:115], v[208:211]
  ds_read_b64_tr_b16 a[80:81], v18 offset:8192
  v_mfma_f32_16x16x32_bf16 v[240:243], a[52:55], a[112:115], v[240:243]
  v_mfma_f32_16x16x32_bf16 a[144:147], a[56:59], a[112:115], a[144:147]
  ds_read_b64_tr_b16 a[82:83], v18 offset:10240
  v_mfma_f32_16x16x32_bf16 a[176:179], a[60:63], a[112:115], a[176:179]
  v_mfma_f32_16x16x32_bf16 v[84:87], a[32:35], a[116:119], v[84:87]
  ds_read_b64_tr_b16 a[84:85], v19 offset:8192
  v_mfma_f32_16x16x32_bf16 v[116:119], a[36:39], a[116:119], v[116:119]
  v_mfma_f32_16x16x32_bf16 v[148:151], a[40:43], a[116:119], v[148:151]
  buffer_load_dwordx4 v61, s[12:15], s47 offen offset:1024 lds
  ds_read_b64_tr_b16 a[86:87], v19 offset:10240
  v_mfma_f32_16x16x32_bf16 v[180:183], a[44:47], a[116:119], v[180:183]
  v_mfma_f32_16x16x32_bf16 v[212:215], a[48:51], a[116:119], v[212:215]
  v_mfma_f32_16x16x32_bf16 v[244:247], a[52:55], a[116:119], v[244:247]
  ds_read_b64_tr_b16 a[88:89], v20 offset:8192
  v_mfma_f32_16x16x32_bf16 a[148:151], a[56:59], a[116:119], a[148:151]
  v_mfma_f32_16x16x32_bf16 a[180:183], a[60:63], a[116:119], a[180:183]
  ds_read_b64_tr_b16 a[90:91], v20 offset:10240
  v_mfma_f32_16x16x32_bf16 v[88:91], a[32:35], a[120:123], v[88:91]
  v_mfma_f32_16x16x32_bf16 v[120:123], a[36:39], a[120:123], v[120:123]
  buffer_load_dwordx4 v62, s[12:15], s47 offen offset:2048 lds
  ds_read_b64_tr_b16 a[92:93], v21 offset:8192
  v_mfma_f32_16x16x32_bf16 v[152:155], a[40:43], a[120:123], v[152:155]
  v_mfma_f32_16x16x32_bf16 v[184:187], a[44:47], a[120:123], v[184:187]
  ds_read_b64_tr_b16 a[94:95], v21 offset:10240
  v_mfma_f32_16x16x32_bf16 v[216:219], a[48:51], a[120:123], v[216:219]
  v_mfma_f32_16x16x32_bf16 v[248:251], a[52:55], a[120:123], v[248:251]
  v_mfma_f32_16x16x32_bf16 a[152:155], a[56:59], a[120:123], a[152:155]
  v_mfma_f32_16x16x32_bf16 a[184:187], a[60:63], a[120:123], a[184:187]
  v_mfma_f32_16x16x32_bf16 v[92:95], a[32:35], a[124:127], v[92:95]
  buffer_load_dwordx4 v63, s[12:15], s47 offen offset:3072 lds
  v_mfma_f32_16x16x32_bf16 v[124:127], a[36:39], a[124:127], v[124:127]
  s_add_u32 s47, s47, 524288
  s_sub_u32 s49, s49, 1
  s_cmp_eq_u32 s49, 0
  s_cselect_b32 s34, s53, 0
  s_cselect_b32 s49, s51, s49
  v_mfma_f32_16x16x32_bf16 v[156:159], a[40:43], a[124:127], v[156:159]
  s_sub_u32 s47, s47, s34
  s_sub_u32 s50, s50, 1
  s_cmp_eq_u32 s50, 0
  s_cselect_b32 s12, s54, s12
  s_cselect_b32 s13, s55, s13
  v_mfma_f32_16x16x32_bf16 v[188:191], a[44:47], a[124:127], v[188:191]
  v_mfma_f32_16x16x32_bf16 v[220:223], a[48:51], a[124:127], v[220:223]
  v_mfma_f32_16x16x32_bf16 v[252:255], a[52:55], a[124:127], v[252:255]
  v_mfma_f32_16x16x32_bf16 a[156:159], a[56:59], a[124:127], a[156:159]
  v_mfma_f32_16x16x32_bf16 a[188:191], a[60:63], a[124:127], a[188:191]
  s_waitcnt lgkmcnt(0)
  v_mfma_f32_16x16x32_bf16 v[64:67], a[0:3], a[64:67], v[64:67]
  s_mov_b32 m0, s36
  ds_read_b128 a[32:35], v17 offset:0
  v_mfma_f32_16x16x32_bf16 v[96:99], a[4:7], a[64:67], v[96:99]
  buffer_load_dwordx4 v48, s[8:11], s46 offen offset:0 lds
  v_mfma_f32_16x16x32_bf16 v[128:131], a[8:11], a[64:67], v[128:131]
  ds_read_b64_tr_b16 a[96:97], v18 offset:4096
  v_mfma_f32_16x16x32_bf16 v[160:163], a[12:15], a[64:67], v[160:163]
  v_mfma_f32_16x16x32_bf16 v[192:195], a[16:19], a[64:67], v[192:195]
  ds_read_b64_tr_b16 a[98:99], v18 offset:6144
  v_mfma_f32_16x16x32_bf16 v[224:227], a[20:23], a[64:67], v[224:227]
  v_mfma_f32_16x16x32_bf16 a[128:131], a[24:27], a[64:67], a[128:131]
  ds_read_b128 a[36:39], v17 offset:2048
  v_mfma_f32_16x16x32_bf16 a[160:163], a[28:31], a[64:67], a[160:163]
  buffer_load_dwordx4 v49, s[8:11], s46 offen offset:1024 lds
  v_mfma_f32_16x16x32_bf16 v[68:71], a[0:3], a[68:71], v[68:71]
  v_mfma_f32_16x16x32_bf16 v[100:103], a[4:7], a[68:71], v[100:103]
  ds_read_b128 a[40:43], v17 offset:4096
  v_mfma_f32_16x16x32_bf16 v[132:135], a[8:11], a[68:71], v[132:135]
  v_mfma_f32_16x16x32_bf16 v[164:167], a[12:15], a[68:71], v[164:167]
  ds_read_b128 a[44:47], v17 offset:6144
  v_mfma_f32_16x16x32_bf16 v[196:199], a[16:19], a[68:71], v[196:199]
  v_mfma_f32_16x16x32_bf16 v[228:231], a[20:23], a[68:71], v[228:231]
  ds_read_b128 a[48:51], v17 offset:8192
  v_mfma_f32_16x16x32_bf16 a[132:135], a[24:27], a[68:71], a[132:135]
  buffer_load_dwordx4 v50, s[8:11], s46 offen offset:2048 lds
  v_mfma_f32_16x16x32_bf16 a[164:167], a[28:31], a[68:71], a[164:167]
  ds_read_b128 a[52:55], v17 offset:10240
  v_mfma_f32_16x16x32_bf16 v[72:75], a[0:3], a[72:75], v[72:75]
  v_mfma_f32_16x16x32_bf16 v[104:107], a[4:7], a[72:75], v[104:107]
  v_mfma_f32_16x16x32_bf16 v[136:139], a[8:11], a[72:75], v[136:139]
  ds_read_b128 a[56:59], v17 offset:12288
  v_mfma_f32_16x16x32_bf16 v[168:171], a[12:15], a[72:75], v[168:171]
  v_mfma_f32_16x16x32_bf16 v[200:203], a[16:19], a[72:75], v[200:203]
  ds_read_b128 a[60:63], v17 offset:14336
  v_mfma_f32_16x16x32_bf16 v[232:235], a[20:23], a[72:75], v[232:235]
  buffer_load_dwordx4 v51, s[8:11], s46 offen offset:3072 lds
  v_mfma_f32_16x16x32_bf16 a[136:139], a[24:27], a[72:75], a[136:139]
  s_add_u32 m0, s36, 4096
  ds_read_b64_tr_b16 a[100:101], v19 offset:4096
  v_mfma_f32_16x16x32_bf16 a[168:171], a[28:31], a[72:75], a[168:171]
  v_mfma_f32_16x16x32_bf16 v[76:79], a[0:3], a[76:79], v[76:79]
  ds_read_b64_tr_b16 a[102:103], v19 offset:6144
  v_mfma_f32_16x16x32_bf16 v[108:111], a[4:7], a[76:79], v[108:111]
  v_mfma_f32_16x16x32_bf16 v[140:143], a[8:11], a[76:79], v[140:143]
  v_mfma_f32_16x16x32_bf16 v[172:175], a[12:15], a[76:79], v[172:175]
  ds_read_b64_tr_b16 a[104:105], v20 offset:4096
  v_mfma_f32_16x16x32_bf16 v[204:207], a[16:19], a[76:79], v[204:207]
  buffer_load_dwordx4 v52, s[8:11], s46 offen offset:0 lds
  v_mfma_f32_16x16x32_bf16 v[236:239], a[20:23], a[76:79], v[236:239]
  ds_read_b64_tr_b16 a[106:107], v20 offset:6144
  v_mfma_f32_16x16x32_bf16 a[140:143], a[24:27], a[76:79], a[140:143]
  v_mfma_f32_16x16x32_bf16 a[172:175], a[28:31], a[76:79], a[172:175]
  ds_read_b64_tr_b16 a[108:109], v21 offset:4096
  v_mfma_f32_16x16x32_bf16 v[80:83], a[0:3], a[80:83], v[80:83]
  v_mfma_f32_16x16x32_bf16 v[112:115], a[4:7], a[80:83], v[112:115]
  ds_read_b64_tr_b16 a[110:111], v21 offset:6144
  v_mfma_f32_16x16x32_bf16 v[144:147], a[8:11], a[80:83], v[144:147]
  v_mfma_f32_16x16x32_bf16 v[176:179], a[12:15], a[80:83], v[176:179]
  buffer_load_dwordx4 v53, s[8:11], s46 offen offset:1024 lds
  v_mfma_f32_16x16x32_bf16 v[208:211], a[16:19], a[80:83], v[208:211]
  ds_read_b64_tr_b16 a[112:113], v18 offset:12288
  v_mfma_f32_16x16x32_bf16 v[240:243], a[20:23], a[80:83], v[240:243]
  v_mfma_f32_16x16x32_bf16 a[144:147], a[24:27], a[80:83], a[144:147]
  ds_read_b64_tr_b16 a[114:115], v18 offset:14336
  v_mfma_f32_16x16x32_bf16 a[176:179], a[28:31], a[80:83], a[176:179]
  v_mfma_f32_16x16x32_bf16 v[84:87], a[0:3], a[84:87], v[84:87]
  ds_read_b64_tr_b16 a[116:117], v19 offset:12288
  v_mfma_f32_16x16x32_bf16 v[116:119], a[4:7], a[84:87], v[116:119]
  v_mfma_f32_16x16x32_bf16 v[148:151], a[8:11], a[84:87], v[148:151]
  buffer_load_dwordx4 v54, s[8:11], s46 offen offset:2048 lds
  ds_read_b64_tr_b16 a[118:119], v19 offset:14336
  v_mfma_f32_16x16x32_bf16 v[180:183], a[12:15], a[84:87], v[180:183]
  v_mfma_f32_16x16x32_bf16 v[212:215], a[16:19], a[84:87], v[212:215]
  v_mfma_f32_16x16x32_bf16 v[244:247], a[20:23], a[84:87], v[244:247]
  ds_read_b64_tr_b16 a[120:121], v20 offset:12288
  v_mfma_f32_16x16x32_bf16 a[148:151], a[24:27], a[84:87], a[148:151]
  v_mfma_f32_16x16x32_bf16 a[180:183], a[28:31], a[84:87], a[180:183]
  ds_read_b64_tr_b16 a[122:123], v20 offset:14336
  v_mfma_f32_16x16x32_bf16 v[88:91], a[0:3], a[88:91], v[88:91]
  v_mfma_f32_16x16x32_bf16 v[120:123], a[4:7], a[88:91], v[120:123]
  buffer_load_dwordx4 v55, s[8:11], s46 offen offset:3072 lds
  ds_read_b64_tr_b16 a[124:125], v21 offset:12288
  v_mfma_f32_16x16x32_bf16 v[152:155], a[8:11], a[88:91], v[152:155]
  s_add_u32 s46, s46, 128
  s_sub_u32 s48, s48, 1
  s_cmp_eq_u32 s48, 0
  s_cselect_b32 s34, s52, 0
  s_cselect_b32 s48, s51, s48
  v_mfma_f32_16x16x32_bf16 v[184:187], a[12:15], a[88:91], v[184:187]
  s_sub_u32 s46, s46, s34
  ds_read_b64_tr_b16 a[126:127], v21 offset:14336
  v_mfma_f32_16x16x32_bf16 v[216:219], a[16:19], a[88:91], v[216:219]
  s_add_u32 s36, s36, s38
  s_add_u32 s37, s37, 1
  s_cmp_eq_u32 s37, 3
  s_cselect_b32 s37, 0, s37
  s_cselect_b32 s38, s39, s40
  v_mfma_f32_16x16x32_bf16 v[248:251], a[20:23], a[88:91], v[248:251]
  s_add_u32 s41, s41, s43
  s_sub_u32 s43, 0, s43
  v_mfma_f32_16x16x32_bf16 a[152:155], a[24:27], a[88:91], a[152:155]
  v_add_u32 v16, s38, v16
  v_add_u32 v17, s38, v17
  v_mfma_f32_16x16x32_bf16 a[184:187], a[28:31], a[88:91], a[184:187]
  v_add_u32 v18, s43, v18
  v_add_u32 v19, s43, v19
  v_mfma_f32_16x16x32_bf16 v[92:95], a[0:3], a[92:95], v[92:95]
  v_add_u32 v20, s43, v20
  v_add_u32 v21, s43, v21
  v_mfma_f32_16x16x32_bf16 v[124:127], a[4:7], a[92:95], v[124:127]
  v_mfma_f32_16x16x32_bf16 v[156:159], a[8:11], a[92:95], v[156:159]
  v_mfma_f32_16x16x32_bf16 v[188:191], a[12:15], a[92:95], v[188:191]
  v_mfma_f32_16x16x32_bf16 v[220:223], a[16:19], a[92:95], v[220:223]
  v_mfma_f32_16x16x32_bf16 v[252:255], a[20:23], a[92:95], v[252:255]
  v_mfma_f32_16x16x32_bf16 a[156:159], a[24:27], a[92:95], a[156:159]
  v_mfma_f32_16x16x32_bf16 a[188:191], a[28:31], a[92:95], a[188:191]
  s_mov_b32 s35, 4
  .p2align 6
Lp1xw_loop:
  s_waitcnt vmcnt(8) lgkmcnt(0)
  s_barrier
  v_mfma_f32_16x16x32_bf16 v[64:67], a[32:35], a[96:99], v[64:67]
  buffer_load_dwordx4 v[4:7], v2, s[56:59], s60 offen
  ds_read_b128 a[0:3], v16 offset:0
  v_mfma_f32_16x16x32_bf16 v[96:99], a[36:39], a[96:99], v[96:99]
  s_add_u32 s60, s60, 1024
  s_mov_b32 m0, s41
  v_mfma_f32_16x16x32_bf16 v[128:131], a[40:43], a[96:99], v[128:131]
  ds_read_b64_tr_b16 a[64:65], v18 offset:0
  v_mfma_f32_16x16x32_bf16 v[160:163], a[44:47], a[96:99], v[160:163]
  v_mfma_f32_16x16x32_bf16 v[192:195], a[48:51], a[96:99], v[192:195]
  ds_read_b64_tr_b16 a[66:67], v18 offset:2048
  v_mfma_f32_16x16x32_bf16 v[224:227], a[52:55], a[96:99], v[224:227]
  v_mfma_f32_16x16x32_bf16 a[128:131], a[56:59], a[96:99], a[128:131]
  ds_read_b128 a[4:7], v16 offset:2048
  v_mfma_f32_16x16x32_bf16 a[160:163], a[60:63], a[96:99], a[160:163]
  buffer_load_dwordx4 v56, s[12:15], s47 offen offset:0 lds
  v_mfma_f32_16x16x32_bf16 v[68:71], a[32:35], a[100:103], v[68:71]
  v_mfma_f32_16x16x32_bf16 v[100:103], a[36:39], a[100:103], v[100:103]
  ds_read_b128 a[8:11], v16 offset:4096
  v_mfma_f32_16x16x32_bf16 v[132:135], a[40:43], a[100:103], v[132:135]
  v_mfma_f32_16x16x32_bf16 v[164:167], a[44:47], a[100:103], v[164:167]
  ds_read_b128 a[12:15], v16 offset:6144
  v_mfma_f32_16x16x32_bf16 v[196:199], a[48:51], a[100:103], v[196:199]
  v_mfma_f32_16x16x32_bf16 v[228:231], a[52:55], a[100:103], v[228:231]
  ds_read_b128 a[16:19], v16 offset:8192
  v_mfma_f32_16x16x32_bf16 a[132:135], a[56:59], a[100:103], a[132:135]
  buffer_load_dwordx4 v57, s[12:15], s47 offen offset:1024 lds
  v_mfma_f32_16x16x32_bf16 a[164:167], a[60:63], a[100:103], a[164:167]
  ds_read_b128 a[20:23], v16 offset:10240
  v_mfma_f32_16x16x32_bf16 v[72:75], a[32:35], a[104:107], v[72:75]
  v_mfma_f32_16x16x32_bf16 v[104:107], a[36:39], a[104:107], v[104:107]
  v_mfma_f32_16x16x32_bf16 v[136:139], a[40:43], a[104:107], v[136:139]
  ds_read_b128 a[24:27], v16 offset:12288
  v_mfma_f32_16x16x32_bf16 v[168:171], a[44:47], a[104:107], v[168:171]
  v_mfma_f32_16x16x32_bf16 v[200:203], a[48:51], a[104:107], v[200:203]
  ds_read_b128 a[28:31], v16 offset:14336
  v_mfma_f32_16x16x32_bf16 v[232:235], a[52:55], a[104:107], v[232:235]
  buffer_load_dwordx4 v58, s[12:15], s47 offen offset:2048 lds
  v_mfma_f32_16x16x32_bf16 a[136:139], a[56:59], a[104:107], a[136:139]
  ds_read_b64_tr_b16 a[68:69], v19 offset:0
  v_mfma_f32_16x16x32_bf16 a[168:171], a[60:63], a[104:107], a[168:171]
  v_mfma_f32_16x16x32_bf16 v[76:79], a[32:35], a[108:111], v[76:79]
  ds_read_b64_tr_b16 a[70:71], v19 offset:2048
  v_mfma_f32_16x16x32_bf16 v[108:111], a[36:39], a[108:111], v[108:111]
  v_mfma_f32_16x16x32_bf16 v[140:143], a[40:43], a[108:111], v[140:143]
  v_mfma_f32_16x16x32_bf16 v[172:175], a[44:47], a[108:111], v[172:175]
  ds_read_b64_tr_b16 a[72:73], v20 offset:0
  v_mfma_f32_16x16x32_bf16 v[204:207], a[48:51], a[108:111], v[204:207]
  buffer_load_dwordx4 v59, s[12:15], s47 offen offset:3072 lds
  v_mfma_f32_16x16x32_bf16 v[236:239], a[52:55], a[108:111], v[236:239]
  s_add_u32 m0, s41, 4096
  ds_read_b64_tr_b16 a[74:75], v20 offset:2048
  v_mfma_f32_16x16x32_bf16 a[140:143], a[56:59], a[108:111], a[140:143]
  v_mfma_f32_16x16x32_bf16 a[172:175], a[60:63], a[108:111], a[172:175]
  ds_read_b64_tr_b16 a[76:77], v21 offset:0
  v_mfma_f32_16x16x32_bf16 v[80:83], a[32:35], a[112:115], v[80:83]
  v_mfma_f32_16x16x32_bf16 v[112:115], a[36:39], a[112:115], v[112:115]
  ds_read_b64_tr_b16 a[78:79], v21 offset:2048
  v_mfma_f32_16x16x32_bf16 v[144:147], a[40:43], a[112:115], v[144:147]
  v_mfma_f32_16x16x32_bf16 v[176:179], a[44:47], a[112:115], v[176:179]
  buffer_load_dwordx4 v60, s[12:15], s47 offen offset:0 lds
  v_mfma_f32_16x16x32_bf16 v[208:211], a[48:51], a[112:115], v[208:211]
  ds_read_b64_tr_b16 a[80:81], v18 offset:8192
  v_mfma_f32_16x16x32_bf16 v[240:243], a[52:55], a[112:115], v[240:243]
  v_mfma_f32_16x16x32_bf16 a[144:147], a[56:59], a[112:115], a[144:147]
  ds_read_b64_tr_b16 a[82:83], v18 offset:10240
  v_mfma_f32_16x16x32_bf16 a[176:179], a[60:63], a[112:115], a[176:179]
  v_mfma_f32_16x16x32_bf16 v[84:87], a[32:35], a[116:119], v[84:87]
  ds_read_b64_tr_b16 a[84:85], v19 offset:8192
  v_mfma_f32_16x16x32_bf16 v[116:119], a[36:39], a[116:119], v[116:119]
  v_mfma_f32_16x16x32_bf16 v[148:151], a[40:43], a[116:119], v[148:151]
  buffer_load_dwordx4 v61, s[12:15], s47 offen offset:1024 lds
  ds_read_b64_tr_b16 a[86:87], v19 offset:10240
  v_mfma_f32_16x16x32_bf16 v[180:183], a[44:47], a[116:119], v[180:183]
  v_mfma_f32_16x16x32_bf16 v[212:215], a[48:51], a[116:119], v[212:215]
  v_mfma_f32_16x16x32_bf16 v[244:247], a[52:55], a[116:119], v[244:247]
  ds_read_b64_tr_b16 a[88:89], v20 offset:8192
  v_mfma_f32_16x16x32_bf16 a[148:151], a[56:59], a[116:119], a[148:151]
  v_mfma_f32_16x16x32_bf16 a[180:183], a[60:63], a[116:119], a[180:183]
  ds_read_b64_tr_b16 a[90:91], v20 offset:10240
  v_mfma_f32_16x16x32_bf16 v[88:91], a[32:35], a[120:123], v[88:91]
  v_mfma_f32_16x16x32_bf16 v[120:123], a[36:39], a[120:123], v[120:123]
  buffer_load_dwordx4 v62, s[12:15], s47 offen offset:2048 lds
  ds_read_b64_tr_b16 a[92:93], v21 offset:8192
  v_mfma_f32_16x16x32_bf16 v[152:155], a[40:43], a[120:123], v[152:155]
  v_mfma_f32_16x16x32_bf16 v[184:187], a[44:47], a[120:123], v[184:187]
  ds_read_b64_tr_b16 a[94:95], v21 offset:10240
  v_mfma_f32_16x16x32_bf16 v[216:219], a[48:51], a[120:123], v[216:219]
  v_mfma_f32_16x16x32_bf16 v[248:251], a[52:55], a[120:123], v[248:251]
  v_mfma_f32_16x16x32_bf16 a[152:155], a[56:59], a[120:123], a[152:155]
  v_mfma_f32_16x16x32_bf16 a[184:187], a[60:63], a[120:123], a[184:187]
  v_mfma_f32_16x16x32_bf16 v[92:95], a[32:35], a[124:127], v[92:95]
  buffer_load_dwordx4 v63, s[12:15], s47 offen offset:3072 lds
  v_mfma_f32_16x16x32_bf16 v[124:127], a[36:39], a[124:127], v[124:127]
  s_add_u32 s47, s47, 524288
  s_sub_u32 s49, s49, 1
  s_cmp_eq_u32 s49, 0
  s_cselect_b32 s34, s53, 0
  s_cselect_b32 s49, s51, s49
  v_mfma_f32_16x16x32_bf16 v[156:159], a[40:43], a[124:127], v[156:159]
  s_sub_u32 s47, s47, s34
  s_sub_u32 s50, s50, 1
  s_cmp_eq_u32 s50, 0
  s_cselect_b32 s12, s54, s12
  s_cselect_b32 s13, s55, s13
  v_mfma_f32_16x16x32_bf16 v[188:191], a[44:47], a[124:127], v[188:191]
  v_mfma_f32_16x16x32_bf16 v[220:223], a[48:51], a[124:127], v[220:223]
  v_mfma_f32_16x16x32_bf16 v[252:255], a[52:55], a[124:127], v[252:255]
  v_mfma_f32_16x16x32_bf16 a[156:159], a[56:59], a[124:127], a[156:159]
  v_mfma_f32_16x16x32_bf16 a[188:191], a[60:63], a[124:127], a[188:191]
  s_waitcnt lgkmcnt(0)
  v_mfma_f32_16x16x32_bf16 v[64:67], a[0:3], a[64:67], v[64:67]
  s_mov_b32 m0, s36
  ds_read_b128 a[32:35], v17 offset:0
  v_mfma_f32_16x16x32_bf16 v[96:99], a[4:7], a[64:67], v[96:99]
  buffer_load_dwordx4 v48, s[8:11], s46 offen offset:0 lds
  v_mfma_f32_16x16x32_bf16 v[128:131], a[8:11], a[64:67], v[128:131]
  ds_read_b64_tr_b16 a[96:97], v18 offset:4096
  v_mfma_f32_16x16x32_bf16 v[160:163], a[12:15], a[64:67], v[160:163]
  v_mfma_f32_16x16x32_bf16 v[192:195], a[16:19], a[64:67], v[192:195]
  ds_read_b64_tr_b16 a[98:99], v18 offset:6144
  v_mfma_f32_16x16x32_bf16 v[224:227], a[20:23], a[64:67], v[224:227]
  v_mfma_f32_16x16x32_bf16 a[128:131], a[24:27], a[64:67], a[128:131]
  ds_read_b128 a[36:39], v17 offset:2048
  v_mfma_f32_16x16x32_bf16 a[160:163], a[28:31], a[64:67], a[160:163]
  buffer_load_dwordx4 v49, s[8:11], s46 offen offset:1024 lds
  v_mfma_f32_16x16x32_bf16 v[68:71], a[0:3], a[68:71], v[68:71]
  v_mfma_f32_16x16x32_bf16 v[100:103], a[4:7], a[68:71], v[100:103]
  ds_read_b128 a[40:43], v17 offset:4096
  v_mfma_f32_16x16x32_bf16 v[132:135], a[8:11], a[68:71], v[132:135]
  v_mfma_f32_16x16x32_bf16 v[164:167], a[12:15], a[68:71], v[164:167]
  ds_read_b128 a[44:47], v17 offset:6144
  v_mfma_f32_16x16x32_bf16 v[196:199], a[16:19], a[68:71], v[196:199]
  v_mfma_f32_16x16x32_bf16 v[228:231], a[20:23], a[68:71], v[228:231]
  ds_read_b128 a[48:51], v17 offset:8192
  v_mfma_f32_16x16x32_bf16 a[132:135], a[24:27], a[68:71], a[132:135]
  buffer_load_dwordx4 v50, s[8:11], s46 offen offset:2048 lds
  v_mfma_f32_16x16x32_bf16 a[164:167], a[28:31], a[68:71], a[164:167]
  ds_read_b128 a[52:55], v17 offset:10240
  v_mfma_f32_16x16x32_bf16 v[72:75], a[0:3], a[72:75], v[72:75]
  v_mfma_f32_16x16x32_bf16 v[104:107], a[4:7], a[72:75], v[104:107]
  v_mfma_f32_16x16x32_bf16 v[136:139], a[8:11], a[72:75], v[136:139]
  ds_read_b128 a[56:59], v17 offset:12288
  v_mfma_f32_16x16x32_bf16 v[168:171], a[12:15], a[72:75], v[168:171]
  v_mfma_f32_16x16x32_bf16 v[200:203], a[16:19], a[72:75], v[200:203]
  ds_read_b128 a[60:63], v17 offset:14336
  v_mfma_f32_16x16x32_bf16 v[232:235], a[20:23], a[72:75], v[232:235]
  buffer_load_dwordx4 v51, s[8:11], s46 offen offset:3072 lds
  v_mfma_f32_16x16x32_bf16 a[136:139], a[24:27], a[72:75], a[136:139]
  s_add_u32 m0, s36, 4096
  ds_read_b64_tr_b16 a[100:101], v19 offset:4096
  v_mfma_f32_16x16x32_bf16 a[168:171], a[28:31], a[72:75], a[168:171]
  v_mfma_f32_16x16x32_bf16 v[76:79], a[0:3], a[76:79], v[76:79]
  ds_read_b64_tr_b16 a[102:103], v19 offset:6144
  v_mfma_f32_16x16x32_bf16 v[108:111], a[4:7], a[76:79], v[108:111]
  v_mfma_f32_16x16x32_bf16 v[140:143], a[8:11], a[76:79], v[140:143]
  v_mfma_f32_16x16x32_bf16 v[172:175], a[12:15], a[76:79], v[172:175]
  ds_read_b64_tr_b16 a[104:105], v20 offset:4096
  v_mfma_f32_16x16x32_bf16 v[204:207], a[16:19], a[76:79], v[204:207]
  buffer_load_dwordx4 v52, s[8:11], s46 offen offset:0 lds
  v_mfma_f32_16x16x32_bf16 v[236:239], a[20:23], a[76:79], v[236:239]
  ds_read_b64_tr_b16 a[106:107], v20 offset:6144
  v_mfma_f32_16x16x32_bf16 a[140:143], a[24:27], a[76:79], a[140:143]
  v_mfma_f32_16x16x32_bf16 a[172:175], a[28:31], a[76:79], a[172:175]
  ds_read_b64_tr_b16 a[108:109], v21 offset:4096
  v_mfma_f32_16x16x32_bf16 v[80:83], a[0:3], a[80:83], v[80:83]
  v_mfma_f32_16x16x32_bf16 v[112:115], a[4:7], a[80:83], v[112:115]
  ds_read_b64_tr_b16 a[110:111], v21 offset:6144
  v_mfma_f32_16x16x32_bf16 v[144:147], a[8:11], a[80:83], v[144:147]
  v_mfma_f32_16x16x32_bf16 v[176:179], a[12:15], a[80:83], v[176:179]
  buffer_load_dwordx4 v53, s[8:11], s46 offen offset:1024 lds
  v_mfma_f32_16x16x32_bf16 v[208:211], a[16:19], a[80:83], v[208:211]
  ds_read_b64_tr_b16 a[112:113], v18 offset:12288
  v_mfma_f32_16x16x32_bf16 v[240:243], a[20:23], a[80:83], v[240:243]
  v_mfma_f32_16x16x32_bf16 a[144:147], a[24:27], a[80:83], a[144:147]
  ds_read_b64_tr_b16 a[114:115], v18 offset:14336
  v_mfma_f32_16x16x32_bf16 a[176:179], a[28:31], a[80:83], a[176:179]
  v_mfma_f32_16x16x32_bf16 v[84:87], a[0:3], a[84:87], v[84:87]
  ds_read_b64_tr_b16 a[116:117], v19 offset:12288
  v_mfma_f32_16x16x32_bf16 v[116:119], a[4:7], a[84:87], v[116:119]
  v_mfma_f32_16x16x32_bf16 v[148:151], a[8:11], a[84:87], v[148:151]
  buffer_load_dwordx4 v54, s[8:11], s46 offen offset:2048 lds
  ds_read_b64_tr_b16 a[118:119], v19 offset:14336
  v_mfma_f32_16x16x32_bf16 v[180:183], a[12:15], a[84:87], v[180:183]
  v_mfma_f32_16x16x32_bf16 v[212:215], a[16:19], a[84:87], v[212:215]
  v_mfma_f32_16x16x32_bf16 v[244:247], a[20:23], a[84:87], v[244:247]
  ds_read_b64_tr_b16 a[120:121], v20 offset:12288
  v_mfma_f32_16x16x32_bf16 a[148:151], a[24:27], a[84:87], a[148:151]
  v_mfma_f32_16x16x32_bf16 a[180:183], a[28:31], a[84:87], a[180:183]
  ds_read_b64_tr_b16 a[122:123], v20 offset:14336
  v_mfma_f32_16x16x32_bf16 v[88:91], a[0:3], a[88:91], v[88:91]
  v_mfma_f32_16x16x32_bf16 v[120:123], a[4:7], a[88:91], v[120:123]
  buffer_load_dwordx4 v55, s[8:11], s46 offen offset:3072 lds
  ds_read_b64_tr_b16 a[124:125], v21 offset:12288
  v_mfma_f32_16x16x32_bf16 v[152:155], a[8:11], a[88:91], v[152:155]
  s_add_u32 s46, s46, 128
  s_sub_u32 s48, s48, 1
  s_cmp_eq_u32 s48, 0
  s_cselect_b32 s34, s52, 0
  s_cselect_b32 s48, s51, s48
  v_mfma_f32_16x16x32_bf16 v[184:187], a[12:15], a[88:91], v[184:187]
  s_sub_u32 s46, s46, s34
  ds_read_b64_tr_b16 a[126:127], v21 offset:14336
  v_mfma_f32_16x16x32_bf16 v[216:219], a[16:19], a[88:91], v[216:219]
  s_add_u32 s36, s36, s38
  s_add_u32 s37, s37, 1
  s_cmp_eq_u32 s37, 3
  s_cselect_b32 s37, 0, s37
  s_cselect_b32 s38, s39, s40
  v_mfma_f32_16x16x32_bf16 v[248:251], a[20:23], a[88:91], v[248:251]
  s_add_u32 s41, s41, s43
  s_sub_u32 s43, 0, s43
  v_mfma_f32_16x16x32_bf16 a[152:155], a[24:27], a[88:91], a[152:155]
  v_add_u32 v16, s38, v16
  v_add_u32 v17, s38, v17
  v_mfma_f32_16x16x32_bf16 a[184:187], a[28:31], a[88:91], a[184:187]
  v_add_u32 v18, s43, v18
  v_add_u32 v19, s43, v19
  v_mfma_f32_16x16x32_bf16 v[92:95], a[0:3], a[92:95], v[92:95]
  v_add_u32 v20, s43, v20
  v_add_u32 v21, s43, v21
  v_mfma_f32_16x16x32_bf16 v[124:127], a[4:7], a[92:95], v[124:127]
  v_mfma_f32_16x16x32_bf16 v[156:159], a[8:11], a[92:95], v[156:159]
  v_mfma_f32_16x16x32_bf16 v[188:191], a[12:15], a[92:95], v[188:191]
  v_mfma_f32_16x16x32_bf16 v[220:223], a[16:19], a[92:95], v[220:223]
  v_mfma_f32_16x16x32_bf16 v[252:255], a[20:23], a[92:95], v[252:255]
  v_mfma_f32_16x16x32_bf16 a[156:159], a[24:27], a[92:95], a[156:159]
  s_sub_u32 s35, s35, 1
  v_mfma_f32_16x16x32_bf16 a[188:191], a[28:31], a[92:95], a[188:191]
  s_cmp_lg_u32 s35, 0
  s_cbranch_scc1 Lp1xw_loop
  s_waitcnt vmcnt(8) lgkmcnt(0)
  s_barrier
  v_mfma_f32_16x16x32_bf16 v[64:67], a[32:35], a[96:99], v[64:67]
  s_mov_b32 m0, s41
  ds_read_b128 a[0:3], v16 offset:0
  v_mfma_f32_16x16x32_bf16 v[96:99], a[36:39], a[96:99], v[96:99]
  buffer_load_dwordx4 v56, s[12:15], s47 offen offset:0 lds
  v_mfma_f32_16x16x32_bf16 v[128:131], a[40:43], a[96:99], v[128:131]
  ds_read_b64_tr_b16 a[64:65], v18 offset:0
  v_mfma_f32_16x16x32_bf16 v[160:163], a[44:47], a[96:99], v[160:163]
  v_mfma_f32_16x16x32_bf16 v[192:195], a[48:51], a[96:99], v[192:195]
  ds_read_b64_tr_b16 a[66:67], v18 offset:2048
  v_mfma_f32_16x16x32_bf16 v[224:227], a[52:55], a[96:99], v[224:227]
  v_mfma_f32_16x16x32_bf16 a[128:131], a[56:59], a[96:99], a[128:131]
  ds_read_b128 a[4:7], v16 offset:2048
  v_mfma_f32_16x16x32_bf16 a[160:163], a[60:63], a[96:99], a[160:163]
  v_mfma_f32_16x16x32_bf16 v[68:71], a[32:35], a[100:103], v[68:71]
  v_mfma_f32_16x16x32_bf16 v[100:103], a[36:39], a[100:103], v[100:103]
  ds_read_b128 a[8:11], v16 offset:4096
  v_mfma_f32_16x16x32_bf16 v[132:135], a[40:43], a[100:103], v[132:135]
  buffer_load_dwordx4 v57, s[12:15], s47 offen offset:1024 lds
  v_mfma_f32_16x16x32_bf16 v[164:167], a[44:47], a[100:103], v[164:167]
  ds_read_b128 a[12:15], v16 offset:6144
  v_mfma_f32_16x16x32_bf16 v[196:199], a[48:51], a[100:103], v[196:199]
  v_mfma_f32_16x16x32_bf16 v[228:231], a[52:55], a[100:103], v[228:231]
  ds_read_b128 a[16:19], v16 offset:8192
  v_mfma_f32_16x16x32_bf16 a[132:135], a[56:59], a[100:103], a[132:135]
  v_mfma_f32_16x16x32_bf16 a[164:167], a[60:63], a[100:103], a[164:167]
  ds_read_b128 a[20:23], v16 offset:10240
  v_mfma_f32_16x16x32_bf16 v[72:75], a[32:35], a[104:107], v[72:75]
  v_mfma_f32_16x16x32_bf16 v[104:107], a[36:39], a[104:107], v[104:107]
  v_mfma_f32_16x16x32_bf16 v[136:139], a[40:43], a[104:107], v[136:139]
  ds_read_b128 a[24:27], v16 offset:12288
  v_mfma_f32_16x16x32_bf16 v[168:171], a[44:47], a[104:107], v[168:171]
  v_mfma_f32_16x16x32_bf16 v[200:203], a[48:51], a[104:107], v[200:203]
  ds_read_b128 a[28:31], v16 offset:14336
  v_mfma_f32_16x16x32_bf16 v[232:235], a[52:55], a[104:107], v[232:235]
  buffer_load_dwordx4 v58, s[12:15], s47 offen offset:2048 lds
  v_mfma_f32_16x16x32_bf16 a[136:139], a[56:59], a[104:107], a[136:139]
  ds_read_b64_tr_b16 a[68:69], v19 offset:0
  v_mfma_f32_16x16x32_bf16 a[168:171], a[60:63], a[104:107], a[168:171]
  v_mfma_f32_16x16x32_bf16 v[76:79], a[32:35], a[108:111], v[76:79]
  ds_read_b64_tr_b16 a[70:71], v19 offset:2048
  v_mfma_f32_16x16x32_bf16 v[108:111], a[36:39], a[108:111], v[108:111]
  v_mfma_f32_16x16x32_bf16 v[140:143], a[40:43], a[108:111], v[140:143]
  v_mfma_f32_16x16x32_bf16 v[172:175], a[44:47], a[108:111], v[172:175]
  ds_read_b64_tr_b16 a[72:73], v20 offset:0
  v_mfma_f32_16x16x32_bf16 v[204:207], a[48:51], a[108:111], v[204:207]
  v_mfma_f32_16x16x32_bf16 v[236:239], a[52:55], a[108:111], v[236:239]
  ds_read_b64_tr_b16 a[74:75], v20 offset:2048
  v_mfma_f32_16x16x32_bf16 a[140:143], a[56:59], a[108:111], a[140:143]
  v_mfma_f32_16x16x32_bf16 a[172:175], a[60:63], a[108:111], a[172:175]
  buffer_load_dwordx4 v59, s[12:15], s47 offen offset:3072 lds
  ds_read_b64_tr_b16 a[76:77], v21 offset:0
  v_mfma_f32_16x16x32_bf16 v[80:83], a[32:35], a[112:115], v[80:83]
  s_add_u32 m0, s41, 4096
  v_mfma_f32_16x16x32_bf16 v[112:115], a[36:39], a[112:115], v[112:115]
  ds_read_b64_tr_b16 a[78:79], v21 offset:2048
  v_mfma_f32_16x16x32_bf16 v[144:147], a[40:43], a[112:115], v[144:147]
  v_mfma_f32_16x16x32_bf16 v[176:179], a[44:47], a[112:115], v[176:179]
  v_mfma_f32_16x16x32_bf16 v[208:211], a[48:51], a[112:115], v[208:211]
  ds_read_b64_tr_b16 a[80:81], v18 offset:8192
  v_mfma_f32_16x16x32_bf16 v[240:243], a[52:55], a[112:115], v[240:243]
  v_mfma_f32_16x16x32_bf16 a[144:147], a[56:59], a[112:115], a[144:147]
  ds_read_b64_tr_b16 a[82:83], v18 offset:10240
  v_mfma_f32_16x16x32_bf16 a[176:179], a[60:63], a[112:115], a[176:179]
  v_mfma_f32_16x16x32_bf16 v[84:87], a[32:35], a[116:119], v[84:87]
  ds_read_b64_tr_b16 a[84:85], v19 offset:8192
  v_mfma_f32_16x16x32_bf16 v[116:119], a[36:39], a[116:119], v[116:119]
  v_mfma_f32_16x16x32_bf16 v[148:151], a[40:43], a[116:119], v[148:151]
  buffer_load_dwordx4 v60, s[12:15], s47 offen offset:0 lds
  ds_read_b64_tr_b16 a[86:87], v19 offset:10240
  v_mfma_f32_16x16x32_bf16 v[180:183], a[44:47], a[116:119], v[180:183]
  v_mfma_f32_16x16x32_bf16 v[212:215], a[48:51], a[116:119], v[212:215]
  v_mfma_f32_16x16x32_bf16 v[244:247], a[52:55], a[116:119], v[244:247]
  ds_read_b64_tr_b16 a[88:89], v20 offset:8192
  v_mfma_f32_16x16x32_bf16 a[148:151], a[56:59], a[116:119], a[148:151]
  v_mfma_f32_16x16x32_bf16 a[180:183], a[60:63], a[116:119], a[180:183]
  ds_read_b64_tr_b16 a[90:91], v20 offset:10240
  v_mfma_f32_16x16x32_bf16 v[88:91], a[32:35], a[120:123], v[88:91]
  v_mfma_f32_16x16x32_bf16 v[120:123], a[36:39], a[120:123], v[120:123]
  ds_read_b64_tr_b16 a[92:93], v21 offset:8192
  v_mfma_f32_16x16x32_bf16 v[152:155], a[40:43], a[120:123], v[152:155]
  v_mfma_f32_16x16x32_bf16 v[184:187], a[44:47], a[120:123], v[184:187]
  ds_read_b64_tr_b16 a[94:95], v21 offset:10240
  v_mfma_f32_16x16x32_bf16 v[216:219], a[48:51], a[120:123], v[216:219]
  buffer_load_dwordx4 v61, s[12:15], s47 offen offset:1024 lds
  v_mfma_f32_16x16x32_bf16 v[248:251], a[52:55], a[120:123], v[248:251]
  v_mfma_f32_16x16x32_bf16 a[152:155], a[56:59], a[120:123], a[152:155]
  v_mfma_f32_16x16x32_bf16 a[184:187], a[60:63], a[120:123], a[184:187]
  v_mfma_f32_16x16x32_bf16 v[92:95], a[32:35], a[124:127], v[92:95]
  v_mfma_f32_16x16x32_bf16 v[124:127], a[36:39], a[124:127], v[124:127]
  v_mfma_f32_16x16x32_bf16 v[156:159], a[40:43], a[124:127], v[156:159]
  v_mfma_f32_16x16x32_bf16 v[188:191], a[44:47], a[124:127], v[188:191]
  v_mfma_f32_16x16x32_bf16 v[220:223], a[48:51], a[124:127], v[220:223]
  v_mfma_f32_16x16x32_bf16 v[252:255], a[52:55], a[124:127], v[252:255]
  v_mfma_f32_16x16x32_bf16 a[156:159], a[56:59], a[124:127], a[156:159]
  v_mfma_f32_16x16x32_bf16 a[188:191], a[60:63], a[124:127], a[188:191]
  s_waitcnt lgkmcnt(0)
  v_mfma_f32_16x16x32_bf16 v[64:67], a[0:3], a[64:67], v[64:67]
  buffer_load_dwordx4 v62, s[12:15], s47 offen offset:2048 lds
  ds_read_b128 a[32:35], v17 offset:0
  v_mfma_f32_16x16x32_bf16 v[96:99], a[4:7], a[64:67], v[96:99]
  v_mfma_f32_16x16x32_bf16 v[128:131], a[8:11], a[64:67], v[128:131]
  ds_read_b64_tr_b16 a[96:97], v18 offset:4096
  v_mfma_f32_16x16x32_bf16 v[160:163], a[12:15], a[64:67], v[160:163]
  v_mfma_f32_16x16x32_bf16 v[192:195], a[16:19], a[64:67], v[192:195]
  ds_read_b64_tr_b16 a[98:99], v18 offset:6144
  v_mfma_f32_16x16x32_bf16 v[224:227], a[20:23], a[64:67], v[224:227]
  v_mfma_f32_16x16x32_bf16 a[128:131], a[24:27], a[64:67], a[128:131]
  ds_read_b128 a[36:39], v17 offset:2048
  v_mfma_f32_16x16x32_bf16 a[160:163], a[28:31], a[64:67], a[160:163]
  v_mfma_f32_16x16x32_bf16 v[68:71], a[0:3], a[68:71], v[68:71]
  v_mfma_f32_16x16x32_bf16 v[100:103], a[4:7], a[68:71], v[100:103]
  buffer_load_dwordx4 v63, s[12:15], s47 offen offset:3072 lds
  ds_read_b128 a[40:43], v17 offset:4096
  v_mfma_f32_16x16x32_bf16 v[132:135], a[8:11], a[68:71], v[132:135]
  s_add_u32 s47, s47, 524288
  s_sub_u32 s49, s49, 1
  s_cmp_eq_u32 s49, 0
  s_cselect_b32 s34, s53, 0
  s_cselect_b32 s49, s51, s49
  v_mfma_f32_16x16x32_bf16 v[164:167], a[12:15], a[68:71], v[164:167]
  s_sub_u32 s47, s47, s34
  s_sub_u32 s50, s50, 1
  s_cmp_eq_u32 s50, 0
  s_cselect_b32 s12, s54, s12
  s_cselect_b32 s13, s55, s13
  v_mfma_f32_16x16x32_bf16 v[196:199], a[16:19], a[68:71], v[196:199]
  s_lshl_b32 s10, s32, 18
  s_add_u32 s8, s76, s10
  s_addc_u32 s9, s77, 0
  v_mfma_f32_16x16x32_bf16 v[228:231], a[20:23], a[68:71], v[228:231]
  s_sub_u32 s8, s8, 32768
  s_subb_u32 s9, s9, 0
  s_mov_b32 s10, 294912
  v_mfma_f32_16x16x32_bf16 a[132:135], a[24:27], a[68:71], a[132:135]
  s_mov_b32 s11, 0x00020000
  s_cmp_ge_u32 s3, 2
  s_cbranch_scc1 Lh_3
  s_add_u32 m0, s88, s28
  s_nop 0
  buffer_load_dwordx4 v40, s[8:11], s24 offen offset:0 lds
Lh_3:
  v_mfma_f32_16x16x32_bf16 a[164:167], a[28:31], a[68:71], a[164:167]
  s_mov_b32 m0, s88
  ds_read_b128 a[44:47], v17 offset:6144
  ds_read_b128 a[48:51], v17 offset:8192
  v_mfma_f32_16x16x32_bf16 v[72:75], a[0:3], a[72:75], v[72:75]
  ds_read_b128 a[52:55], v17 offset:10240
  v_mfma_f32_16x16x32_bf16 v[104:107], a[4:7], a[72:75], v[104:107]
  v_mfma_f32_16x16x32_bf16 v[136:139], a[8:11], a[72:75], v[136:139]
  ds_read_b128 a[56:59], v17 offset:12288
  v_mfma_f32_16x16x32_bf16 v[168:171], a[12:15], a[72:75], v[168:171]
  buffer_load_dwordx4 v36, s[8:11], s24 offen offset:0 lds
  v_mfma_f32_16x16x32_bf16 v[200:203], a[16:19], a[72:75], v[200:203]
  ds_read_b128 a[60:63], v17 offset:14336
  v_mfma_f32_16x16x32_bf16 v[232:235], a[20:23], a[72:75], v[232:235]
  v_mfma_f32_16x16x32_bf16 a[136:139], a[24:27], a[72:75], a[136:139]
  ds_read_b64_tr_b16 a[100:101], v19 offset:4096
  v_mfma_f32_16x16x32_bf16 a[168:171], a[28:31], a[72:75], a[168:171]
  v_mfma_f32_16x16x32_bf16 v[76:79], a[0:3], a[76:79], v[76:79]
  ds_read_b64_tr_b16 a[102:103], v19 offset:6144
  v_mfma_f32_16x16x32_bf16 v[108:111], a[4:7], a[76:79], v[108:111]
  v_mfma_f32_16x16x32_bf16 v[140:143], a[8:11], a[76:79], v[140:143]
  v_mfma_f32_16x16x32_bf16 v[172:175], a[12:15], a[76:79], v[172:175]
  ds_read_b64_tr_b16 a[104:105], v20 offset:4096
  v_mfma_f32_16x16x32_bf16 v[204:207], a[16:19], a[76:79], v[204:207]
  buffer_load_dwordx4 v37, s[8:11], s24 offen offset:1024 lds
  v_mfma_f32_16x16x32_bf16 v[236:239], a[20:23], a[76:79], v[236:239]
  ds_read_b64_tr_b16 a[106:107], v20 offset:6144
  v_mfma_f32_16x16x32_bf16 a[140:143], a[24:27], a[76:79], a[140:143]
  v_mfma_f32_16x16x32_bf16 a[172:175], a[28:31], a[76:79], a[172:175]
  ds_read_b64_tr_b16 a[108:109], v21 offset:4096
  v_mfma_f32_16x16x32_bf16 v[80:83], a[0:3], a[80:83], v[80:83]
  v_mfma_f32_16x16x32_bf16 v[112:115], a[4:7], a[80:83], v[112:115]
  ds_read_b64_tr_b16 a[110:111], v21 offset:6144
  v_mfma_f32_16x16x32_bf16 v[144:147], a[8:11], a[80:83], v[144:147]
  v_mfma_f32_16x16x32_bf16 v[176:179], a[12:15], a[80:83], v[176:179]
  v_mfma_f32_16x16x32_bf16 v[208:211], a[16:19], a[80:83], v[208:211]
  ds_read_b64_tr_b16 a[112:113], v18 offset:12288
  v_mfma_f32_16x16x32_bf16 v[240:243], a[20:23], a[80:83], v[240:243]
  v_mfma_f32_16x16x32_bf16 a[144:147], a[24:27], a[80:83], a[144:147]
  buffer_load_dwordx4 v38, s[8:11], s24 offen offset:2048 lds
  ds_read_b64_tr_b16 a[114:115], v18 offset:14336
  v_mfma_f32_16x16x32_bf16 a[176:179], a[28:31], a[80:83], a[176:179]
  v_mfma_f32_16x16x32_bf16 v[84:87], a[0:3], a[84:87], v[84:87]
  ds_read_b64_tr_b16 a[116:117], v19 offset:12288
  v_mfma_f32_16x16x32_bf16 v[116:119], a[4:7], a[84:87], v[116:119]
  v_mfma_f32_16x16x32_bf16 v[148:151], a[8:11], a[84:87], v[148:151]
  ds_read_b64_tr_b16 a[118:119], v19 offset:14336
  v_mfma_f32_16x16x32_bf16 v[180:183], a[12:15], a[84:87], v[180:183]
  v_mfma_f32_16x16x32_bf16 v[212:215], a[16:19], a[84:87], v[212:215]
  v_mfma_f32_16x16x32_bf16 v[244:247], a[20:23], a[84:87], v[244:247]
  ds_read_b64_tr_b16 a[120:121], v20 offset:12288
  v_mfma_f32_16x16x32_bf16 a[148:151], a[24:27], a[84:87], a[148:151]
  v_mfma_f32_16x16x32_bf16 a[180:183], a[28:31], a[84:87], a[180:183]
  buffer_load_dwordx4 v39, s[8:11], s24 offen offset:3072 lds
  ds_read_b64_tr_b16 a[122:123], v20 offset:14336
  v_mfma_f32_16x16x32_bf16 v[88:91], a[0:3], a[88:91], v[88:91]
  s_add_u32 s24, s24, 128
  v_mfma_f32_16x16x32_bf16 v[120:123], a[4:7], a[88:91], v[120:123]
  s_add_u32 s36, s36, s38
  s_add_u32 s37, s37, 1
  ds_read_b64_tr_b16 a[124:125], v21 offset:12288
  v_mfma_f32_16x16x32_bf16 v[152:155], a[8:11], a[88:91], v[152:155]
  s_cmp_eq_u32 s37, 3
  s_cselect_b32 s37, 0, s37
  s_cselect_b32 s38, s39, s40
  v_mfma_f32_16x16x32_bf16 v[184:187], a[12:15], a[88:91], v[184:187]
  s_add_u32 s41, s41, s43
  s_sub_u32 s43, 0, s43
  ds_read_b64_tr_b16 a[126:127], v21 offset:14336
  v_mfma_f32_16x16x32_bf16 v[216:219], a[16:19], a[88:91], v[216:219]
  v_add_u32 v16, s38, v16
  v_add_u32 v17, s38, v17
  v_mfma_f32_16x16x32_bf16 v[248:251], a[20:23], a[88:91], v[248:251]
  v_add_u32 v18, s43, v18
  v_add_u32 v19, s43, v19
  v_mfma_f32_16x16x32_bf16 a[152:155], a[24:27], a[88:91], a[152:155]
  v_add_u32 v20, s43, v20
  v_add_u32 v21, s43, v21
  v_mfma_f32_16x16x32_bf16 a[184:187], a[28:31], a[88:91], a[184:187]
  v_mfma_f32_16x16x32_bf16 v[92:95], a[0:3], a[92:95], v[92:95]
  v_mfma_f32_16x16x32_bf16 v[124:127], a[4:7], a[92:95], v[124:127]
  v_mfma_f32_16x16x32_bf16 v[156:159], a[8:11], a[92:95], v[156:159]
  v_mfma_f32_16x16x32_bf16 v[188:191], a[12:15], a[92:95], v[188:191]
  v_mfma_f32_16x16x32_bf16 v[220:223], a[16:19], a[92:95], v[220:223]
  v_mfma_f32_16x16x32_bf16 v[252:255], a[20:23], a[92:95], v[252:255]
  v_mfma_f32_16x16x32_bf16 a[156:159], a[24:27], a[92:95], a[156:159]
  v_mfma_f32_16x16x32_bf16 a[188:191], a[28:31], a[92:95], a[188:191]
  s_waitcnt vmcnt(4) lgkmcnt(0)
  s_barrier
  v_mfma_f32_16x16x32_bf16 v[64:67], a[32:35], a[96:99], v[64:67]
  s_add_u32 m0, s88, s26
  ds_read_b128 a[0:3], v16 offset:0
  v_mfma_f32_16x16x32_bf16 v[96:99], a[36:39], a[96:99], v[96:99]
  buffer_load_dwordx4 v8, s[20:23], s25 offen offset:0 lds
  v_mfma_f32_16x16x32_bf16 v[128:131], a[40:43], a[96:99], v[128:131]
  ds_read_b64_tr_b16 a[64:65], v18 offset:0
  v_mfma_f32_16x16x32_bf16 v[160:163], a[44:47], a[96:99], v[160:163]
  v_mfma_f32_16x16x32_bf16 v[192:195], a[48:51], a[96:99], v[192:195]
  ds_read_b64_tr_b16 a[66:67], v18 offset:2048
  v_mfma_f32_16x16x32_bf16 v[224:227], a[52:55], a[96:99], v[224:227]
  v_mfma_f32_16x16x32_bf16 a[128:131], a[56:59], a[96:99], a[128:131]
  ds_read_b128 a[4:7], v16 offset:2048
  v_mfma_f32_16x16x32_bf16 a[160:163], a[60:63], a[96:99], a[160:163]
  buffer_load_dwordx4 v9, s[20:23], s25 offen offset:1024 lds
  v_mfma_f32_16x16x32_bf16 v[68:71], a[32:35], a[100:103], v[68:71]
  v_mfma_f32_16x16x32_bf16 v[100:103], a[36:39], a[100:103], v[100:103]
  ds_read_b128 a[8:11], v16 offset:4096
  v_mfma_f32_16x16x32_bf16 v[132:135], a[40:43], a[100:103], v[132:135]
  v_mfma_f32_16x16x32_bf16 v[164:167], a[44:47], a[100:103], v[164:167]
  ds_read_b128 a[12:15], v16 offset:6144
  v_mfma_f32_16x16x32_bf16 v[196:199], a[48:51], a[100:103], v[196:199]
  v_mfma_f32_16x16x32_bf16 v[228:231], a[52:55], a[100:103], v[228:231]
  ds_read_b128 a[16:19], v16 offset:8192
  v_mfma_f32_16x16x32_bf16 a[132:135], a[56:59], a[100:103], a[132:135]
  v_mfma_f32_16x16x32_bf16 a[164:167], a[60:63], a[100:103], a[164:167]
  buffer_load_dwordx4 v10, s[20:23], s25 offen offset:2048 lds
  ds_read_b128 a[20:23], v16 offset:10240
  v_mfma_f32_16x16x32_bf16 v[72:75], a[32:35], a[104:107], v[72:75]
  s_add_u32 m0, s88, s27
  v_mfma_f32_16x16x32_bf16 v[104:107], a[36:39], a[104:107], v[104:107]
  v_mfma_f32_16x16x32_bf16 v[136:139], a[40:43], a[104:107], v[136:139]
  ds_read_b128 a[24:27], v16 offset:12288
  v_mfma_f32_16x16x32_bf16 v[168:171], a[44:47], a[104:107], v[168:171]
  v_mfma_f32_16x16x32_bf16 v[200:203], a[48:51], a[104:107], v[200:203]
  ds_read_b128 a[28:31], v16 offset:14336
  v_mfma_f32_16x16x32_bf16 v[232:235], a[52:55], a[104:107], v[232:235]
  v_mfma_f32_16x16x32_bf16 a[136:139], a[56:59], a[104:107], a[136:139]
  ds_read_b64_tr_b16 a[68:69], v19 offset:0
  v_mfma_f32_16x16x32_bf16 a[168:171], a[60:63], a[104:107], a[168:171]
  buffer_load_dwordx4 v11, s[20:23], s25 offen offset:0 lds
  v_mfma_f32_16x16x32_bf16 v[76:79], a[32:35], a[108:111], v[76:79]
  ds_read_b64_tr_b16 a[70:71], v19 offset:2048
  v_mfma_f32_16x16x32_bf16 v[108:111], a[36:39], a[108:111], v[108:111]
  v_mfma_f32_16x16x32_bf16 v[140:143], a[40:43], a[108:111], v[140:143]
  v_mfma_f32_16x16x32_bf16 v[172:175], a[44:47], a[108:111], v[172:175]
  ds_read_b64_tr_b16 a[72:73], v20 offset:0
  v_mfma_f32_16x16x32_bf16 v[204:207], a[48:51], a[108:111], v[204:207]
  v_mfma_f32_16x16x32_bf16 v[236:239], a[52:55], a[108:111], v[236:239]
  ds_read_b64_tr_b16 a[74:75], v20 offset:2048
  v_mfma_f32_16x16x32_bf16 a[140:143], a[56:59], a[108:111], a[140:143]
  v_mfma_f32_16x16x32_bf16 a[172:175], a[60:63], a[108:111], a[172:175]
  buffer_load_dwordx4 v12, s[20:23], s25 offen offset:1024 lds
  ds_read_b64_tr_b16 a[76:77], v21 offset:0
  v_mfma_f32_16x16x32_bf16 v[80:83], a[32:35], a[112:115], v[80:83]
  v_mfma_f32_16x16x32_bf16 v[112:115], a[36:39], a[112:115], v[112:115]
  ds_read_b64_tr_b16 a[78:79], v21 offset:2048
  v_mfma_f32_16x16x32_bf16 v[144:147], a[40:43], a[112:115], v[144:147]
  v_mfma_f32_16x16x32_bf16 v[176:179], a[44:47], a[112:115], v[176:179]
  v_mfma_f32_16x16x32_bf16 v[208:211], a[48:51], a[112:115], v[208:211]
  ds_read_b64_tr_b16 a[80:81], v18 offset:8192
  v_mfma_f32_16x16x32_bf16 v[240:243], a[52:55], a[112:115], v[240:243]
  v_mfma_f32_16x16x32_bf16 a[144:147], a[56:59], a[112:115], a[144:147]
  ds_read_b64_tr_b16 a[82:83], v18 offset:10240
  v_mfma_f32_16x16x32_bf16 a[176:179], a[60:63], a[112:115], a[176:179]
  buffer_load_dwordx4 v13, s[20:23], s25 offen offset:2048 lds
  v_mfma_f32_16x16x32_bf16 v[84:87], a[32:35], a[116:119], v[84:87]
  s_add_u32 s25, s25, 393216
  s_cmp_ge_u32 s3, 2
  s_cbranch_scc1 Lh_4
  s_add_u32 m0, s88, s28
  s_add_u32 m0, m0, 43008
  s_nop 0
  buffer_load_dwordx4 v40, s[8:11], s24 offen offset:0 lds
Lh_4:
  v_mfma_f32_16x16x32_bf16 v[116:119], a[36:39], a[116:119], v[116:119]
  s_add_u32 m0, s88, 43008
  ds_read_b64_tr_b16 a[84:85], v19 offset:8192
  v_mfma_f32_16x16x32_bf16 v[148:151], a[40:43], a[116:119], v[148:151]
  ds_read_b64_tr_b16 a[86:87], v19 offset:10240
  v_mfma_f32_16x16x32_bf16 v[180:183], a[44:47], a[116:119], v[180:183]
  v_mfma_f32_16x16x32_bf16 v[212:215], a[48:51], a[116:119], v[212:215]
  v_mfma_f32_16x16x32_bf16 v[244:247], a[52:55], a[116:119], v[244:247]
  ds_read_b64_tr_b16 a[88:89], v20 offset:8192
  v_mfma_f32_16x16x32_bf16 a[148:151], a[56:59], a[116:119], a[148:151]
  v_mfma_f32_16x16x32_bf16 a[180:183], a[60:63], a[116:119], a[180:183]
  buffer_load_dwordx4 v36, s[8:11], s24 offen offset:0 lds
  ds_read_b64_tr_b16 a[90:91], v20 offset:10240
  v_mfma_f32_16x16x32_bf16 v[88:91], a[32:35], a[120:123], v[88:91]
  v_mfma_f32_16x16x32_bf16 v[120:123], a[36:39], a[120:123], v[120:123]
  ds_read_b64_tr_b16 a[92:93], v21 offset:8192
  v_mfma_f32_16x16x32_bf16 v[152:155], a[40:43], a[120:123], v[152:155]
  v_mfma_f32_16x16x32_bf16 v[184:187], a[44:47], a[120:123], v[184:187]
  ds_read_b64_tr_b16 a[94:95], v21 offset:10240
  v_mfma_f32_16x16x32_bf16 v[216:219], a[48:51], a[120:123], v[216:219]
  v_mfma_f32_16x16x32_bf16 v[248:251], a[52:55], a[120:123], v[248:251]
  v_mfma_f32_16x16x32_bf16 a[152:155], a[56:59], a[120:123], a[152:155]
  v_mfma_f32_16x16x32_bf16 a[184:187], a[60:63], a[120:123], a[184:187]
  buffer_load_dwordx4 v37, s[8:11], s24 offen offset:1024 lds
  v_mfma_f32_16x16x32_bf16 v[92:95], a[32:35], a[124:127], v[92:95]
  v_mfma_f32_16x16x32_bf16 v[124:127], a[36:39], a[124:127], v[124:127]
  v_mfma_f32_16x16x32_bf16 v[156:159], a[40:43], a[124:127], v[156:159]
  v_mfma_f32_16x16x32_bf16 v[188:191], a[44:47], a[124:127], v[188:191]
  v_mfma_f32_16x16x32_bf16 v[220:223], a[48:51], a[124:127], v[220:223]
  v_mfma_f32_16x16x32_bf16 v[252:255], a[52:55], a[124:127], v[252:255]
  v_mfma_f32_16x16x32_bf16 a[156:159], a[56:59], a[124:127], a[156:159]
  v_mfma_f32_16x16x32_bf16 a[188:191], a[60:63], a[124:127], a[188:191]
  s_waitcnt lgkmcnt(0)
  v_mfma_f32_16x16x32_bf16 v[64:67], a[0:3], a[64:67], v[64:67]
  buffer_load_dwordx4 v38, s[8:11], s24 offen offset:2048 lds
  ds_read_b128 a[32:35], v17 offset:0
  v_mfma_f32_16x16x32_bf16 v[96:99], a[4:7], a[64:67], v[96:99]
  v_mfma_f32_16x16x32_bf16 v[128:131], a[8:11], a[64:67], v[128:131]
  ds_read_b64_tr_b16 a[96:97], v18 offset:4096
  v_mfma_f32_16x16x32_bf16 v[160:163], a[12:15], a[64:67], v[160:163]
  v_mfma_f32_16x16x32_bf16 v[192:195], a[16:19], a[64:67], v[192:195]
  ds_read_b64_tr_b16 a[98:99], v18 offset:6144
  v_mfma_f32_16x16x32_bf16 v[224:227], a[20:23], a[64:67], v[224:227]
  v_mfma_f32_16x16x32_bf16 a[128:131], a[24:27], a[64:67], a[128:131]
  ds_read_b128 a[36:39], v17 offset:2048
  v_mfma_f32_16x16x32_bf16 a[160:163], a[28:31], a[64:67], a[160:163]
  buffer_load_dwordx4 v39, s[8:11], s24 offen offset:3072 lds
  v_mfma_f32_16x16x32_bf16 v[68:71], a[0:3], a[68:71], v[68:71]
  s_add_u32 s24, s24, 128
  s_add_u32 m0, s88, s26
  s_add_u32 m0, m0, 43008
  v_mfma_f32_16x16x32_bf16 v[100:103], a[4:7], a[68:71], v[100:103]
  ds_read_b128 a[40:43], v17 offset:4096
  v_mfma_f32_16x16x32_bf16 v[132:135], a[8:11], a[68:71], v[132:135]
  v_mfma_f32_16x16x32_bf16 v[164:167], a[12:15], a[68:71], v[164:167]
  ds_read_b128 a[44:47], v17 offset:6144
  v_mfma_f32_16x16x32_bf16 v[196:199], a[16:19], a[68:71], v[196:199]
  v_mfma_f32_16x16x32_bf16 v[228:231], a[20:23], a[68:71], v[228:231]
  ds_read_b128 a[48:51], v17 offset:8192
  v_mfma_f32_16x16x32_bf16 a[132:135], a[24:27], a[68:71], a[132:135]
  v_mfma_f32_16x16x32_bf16 a[164:167], a[28:31], a[68:71], a[164:167]
  buffer_load_dwordx4 v8, s[20:23], s25 offen offset:0 lds
  ds_read_b128 a[52:55], v17 offset:10240
  v_mfma_f32_16x16x32_bf16 v[72:75], a[0:3], a[72:75], v[72:75]
  v_mfma_f32_16x16x32_bf16 v[104:107], a[4:7], a[72:75], v[104:107]
  v_mfma_f32_16x16x32_bf16 v[136:139], a[8:11], a[72:75], v[136:139]
  ds_read_b128 a[56:59], v17 offset:12288
  v_mfma_f32_16x16x32_bf16 v[168:171], a[12:15], a[72:75], v[168:171]
  v_mfma_f32_16x16x32_bf16 v[200:203], a[16:19], a[72:75], v[200:203]
  ds_read_b128 a[60:63], v17 offset:14336
  v_mfma_f32_16x16x32_bf16 v[232:235], a[20:23], a[72:75], v[232:235]
  v_mfma_f32_16x16x32_bf16 a[136:139], a[24:27], a[72:75], a[136:139]
  ds_read_b64_tr_b16 a[100:101], v19 offset:4096
  v_mfma_f32_16x16x32_bf16 a[168:171], a[28:31], a[72:75], a[168:171]
  buffer_load_dwordx4 v9, s[20:23], s25 offen offset:1024 lds
  v_mfma_f32_16x16x32_bf16 v[76:79], a[0:3], a[76:79], v[76:79]
  ds_read_b64_tr_b16 a[102:103], v19 offset:6144
  v_mfma_f32_16x16x32_bf16 v[108:111], a[4:7], a[76:79], v[108:111]
  v_mfma_f32_16x16x32_bf16 v[140:143], a[8:11], a[76:79], v[140:143]
  v_mfma_f32_16x16x32_bf16 v[172:175], a[12:15], a[76:79], v[172:175]
  ds_read_b64_tr_b16 a[104:105], v20 offset:4096
  v_mfma_f32_16x16x32_bf16 v[204:207], a[16:19], a[76:79], v[204:207]
  v_mfma_f32_16x16x32_bf16 v[236:239], a[20:23], a[76:79], v[236:239]
  ds_read_b64_tr_b16 a[106:107], v20 offset:6144
  v_mfma_f32_16x16x32_bf16 a[140:143], a[24:27], a[76:79], a[140:143]
  v_mfma_f32_16x16x32_bf16 a[172:175], a[28:31], a[76:79], a[172:175]
  buffer_load_dwordx4 v10, s[20:23], s25 offen offset:2048 lds
  ds_read_b64_tr_b16 a[108:109], v21 offset:4096
  v_mfma_f32_16x16x32_bf16 v[80:83], a[0:3], a[80:83], v[80:83]
  s_add_u32 m0, s88, s27
  s_add_u32 m0, m0, 43008
  v_mfma_f32_16x16x32_bf16 v[112:115], a[4:7], a[80:83], v[112:115]
  ds_read_b64_tr_b16 a[110:111], v21 offset:6144
  v_mfma_f32_16x16x32_bf16 v[144:147], a[8:11], a[80:83], v[144:147]
  v_mfma_f32_16x16x32_bf16 v[176:179], a[12:15], a[80:83], v[176:179]
  v_mfma_f32_16x16x32_bf16 v[208:211], a[16:19], a[80:83], v[208:211]
  ds_read_b64_tr_b16 a[112:113], v18 offset:12288
  v_mfma_f32_16x16x32_bf16 v[240:243], a[20:23], a[80:83], v[240:243]
  v_mfma_f32_16x16x32_bf16 a[144:147], a[24:27], a[80:83], a[144:147]
  ds_read_b64_tr_b16 a[114:115], v18 offset:14336
  v_mfma_f32_16x16x32_bf16 a[176:179], a[28:31], a[80:83], a[176:179]
  buffer_load_dwordx4 v11, s[20:23], s25 offen offset:0 lds
  v_mfma_f32_16x16x32_bf16 v[84:87], a[0:3], a[84:87], v[84:87]
  ds_read_b64_tr_b16 a[116:117], v19 offset:12288
  v_mfma_f32_16x16x32_bf16 v[116:119], a[4:7], a[84:87], v[116:119]
  v_mfma_f32_16x16x32_bf16 v[148:151], a[8:11], a[84:87], v[148:151]
  ds_read_b64_tr_b16 a[118:119], v19 offset:14336
  v_mfma_f32_16x16x32_bf16 v[180:183], a[12:15], a[84:87], v[180:183]
  v_mfma_f32_16x16x32_bf16 v[212:215], a[16:19], a[84:87], v[212:215]
  v_mfma_f32_16x16x32_bf16 v[244:247], a[20:23], a[84:87], v[244:247]
  ds_read_b64_tr_b16 a[120:121], v20 offset:12288
  v_mfma_f32_16x16x32_bf16 a[148:151], a[24:27], a[84:87], a[148:151]
  v_mfma_f32_16x16x32_bf16 a[180:183], a[28:31], a[84:87], a[180:183]
  buffer_load_dwordx4 v12, s[20:23], s25 offen offset:1024 lds
  ds_read_b64_tr_b16 a[122:123], v20 offset:14336
  v_mfma_f32_16x16x32_bf16 v[88:91], a[0:3], a[88:91], v[88:91]
  v_mfma_f32_16x16x32_bf16 v[120:123], a[4:7], a[88:91], v[120:123]
  ds_read_b64_tr_b16 a[124:125], v21 offset:12288
  v_mfma_f32_16x16x32_bf16 v[152:155], a[8:11], a[88:91], v[152:155]
  v_mfma_f32_16x16x32_bf16 v[184:187], a[12:15], a[88:91], v[184:187]
  ds_read_b64_tr_b16 a[126:127], v21 offset:14336
  v_mfma_f32_16x16x32_bf16 v[216:219], a[16:19], a[88:91], v[216:219]
  v_mfma_f32_16x16x32_bf16 v[248:251], a[20:23], a[88:91], v[248:251]
  v_mfma_f32_16x16x32_bf16 a[152:155], a[24:27], a[88:91], a[152:155]
  v_mfma_f32_16x16x32_bf16 a[184:187], a[28:31], a[88:91], a[184:187]
  buffer_load_dwordx4 v13, s[20:23], s25 offen offset:2048 lds
  v_mfma_f32_16x16x32_bf16 v[92:95], a[0:3], a[92:95], v[92:95]
  s_add_u32 s25, s25, 393216
  v_mfma_f32_16x16x32_bf16 v[124:127], a[4:7], a[92:95], v[124:127]
  v_mfma_f32_16x16x32_bf16 v[156:159], a[8:11], a[92:95], v[156:159]
  v_mfma_f32_16x16x32_bf16 v[188:191], a[12:15], a[92:95], v[188:191]
  v_mfma_f32_16x16x32_bf16 v[220:223], a[16:19], a[92:95], v[220:223]
  v_mfma_f32_16x16x32_bf16 v[252:255], a[20:23], a[92:95], v[252:255]
  v_mfma_f32_16x16x32_bf16 a[156:159], a[24:27], a[92:95], a[156:159]
  v_mfma_f32_16x16x32_bf16 a[188:191], a[28:31], a[92:95], a[188:191]
  s_mov_b32 s16, s84
  s_mov_b32 s17, s85
  s_mov_b32 s18, 256
  s_mov_b32 s19, 0x00020000
  buffer_load_dwordx2 v[30:31], off, s[16:19], 0 sc1
  s_waitcnt lgkmcnt(0)
  s_barrier
  v_mfma_f32_16x16x32_bf16 v[64:67], a[32:35], a[96:99], v[64:67]
  s_cmp_ge_u32 s3, 2
  s_cbranch_scc1 Lh_5
  s_add_u32 m0, s88, s28
  s_add_u32 m0, m0, 86016
  s_nop 0
  buffer_load_dwordx4 v40, s[8:11], s24 offen offset:0 lds
Lh_5:
  v_mfma_f32_16x16x32_bf16 v[96:99], a[36:39], a[96:99], v[96:99]
  s_add_u32 m0, s88, 86016
  v_mfma_f32_16x16x32_bf16 v[128:131], a[40:43], a[96:99], v[128:131]
  buffer_load_dwordx4 v36, s[8:11], s24 offen offset:0 lds
  v_mfma_f32_16x16x32_bf16 v[160:163], a[44:47], a[96:99], v[160:163]
  v_mfma_f32_16x16x32_bf16 v[192:195], a[48:51], a[96:99], v[192:195]
  v_mfma_f32_16x16x32_bf16 v[224:227], a[52:55], a[96:99], v[224:227]
  v_mfma_f32_16x16x32_bf16 a[128:131], a[56:59], a[96:99], a[128:131]
  buffer_load_dwordx4 v37, s[8:11], s24 offen offset:1024 lds
  v_mfma_f32_16x16x32_bf16 a[160:163], a[60:63], a[96:99], a[160:163]
  v_mfma_f32_16x16x32_bf16 v[68:71], a[32:35], a[100:103], v[68:71]
  v_mfma_f32_16x16x32_bf16 v[100:103], a[36:39], a[100:103], v[100:103]
  v_mfma_f32_16x16x32_bf16 v[132:135], a[40:43], a[100:103], v[132:135]
  v_mfma_f32_16x16x32_bf16 v[164:167], a[44:47], a[100:103], v[164:167]
  v_mfma_f32_16x16x32_bf16 v[196:199], a[48:51], a[100:103], v[196:199]
  buffer_load_dwordx4 v38, s[8:11], s24 offen offset:2048 lds
  v_mfma_f32_16x16x32_bf16 v[228:231], a[52:55], a[100:103], v[228:231]
  v_mfma_f32_16x16x32_bf16 a[132:135], a[56:59], a[100:103], a[132:135]
  v_mfma_f32_16x16x32_bf16 a[164:167], a[60:63], a[100:103], a[164:167]
  v_mfma_f32_16x16x32_bf16 v[72:75], a[32:35], a[104:107], v[72:75]
  v_mfma_f32_16x16x32_bf16 v[104:107], a[36:39], a[104:107], v[104:107]
  v_mfma_f32_16x16x32_bf16 v[136:139], a[40:43], a[104:107], v[136:139]
  buffer_load_dwordx4 v39, s[8:11], s24 offen offset:3072 lds
  v_mfma_f32_16x16x32_bf16 v[168:171], a[44:47], a[104:107], v[168:171]
  s_add_u32 s24, s24, 128
  s_add_u32 m0, s88, s26
  s_add_u32 m0, m0, 86016
  v_mfma_f32_16x16x32_bf16 v[200:203], a[48:51], a[104:107], v[200:203]
  v_mfma_f32_16x16x32_bf16 v[232:235], a[52:55], a[104:107], v[232:235]
  v_mfma_f32_16x16x32_bf16 a[136:139], a[56:59], a[104:107], a[136:139]
  v_mfma_f32_16x16x32_bf16 a[168:171], a[60:63], a[104:107], a[168:171]
  v_mfma_f32_16x16x32_bf16 v[76:79], a[32:35], a[108:111], v[76:79]
  v_mfma_f32_16x16x32_bf16 v[108:111], a[36:39], a[108:111], v[108:111]
  buffer_load_dwordx4 v8, s[20:23], s25 offen offset:0 lds
  v_mfma_f32_16x16x32_bf16 v[140:143], a[40:43], a[108:111], v[140:143]
  v_mfma_f32_16x16x32_bf16 v[172:175], a[44:47], a[108:111], v[172:175]
  v_mfma_f32_16x16x32_bf16 v[204:207], a[48:51], a[108:111], v[204:207]
  v_mfma_f32_16x16x32_bf16 v[236:239], a[52:55], a[108:111], v[236:239]
  v_mfma_f32_16x16x32_bf16 a[140:143], a[56:59], a[108:111], a[140:143]
  v_mfma_f32_16x16x32_bf16 a[172:175], a[60:63], a[108:111], a[172:175]
  buffer_load_dwordx4 v9, s[20:23], s25 offen offset:1024 lds
  v_mfma_f32_16x16x32_bf16 v[80:83], a[32:35], a[112:115], v[80:83]
  v_mfma_f32_16x16x32_bf16 v[112:115], a[36:39], a[112:115], v[112:115]
  v_mfma_f32_16x16x32_bf16 v[144:147], a[40:43], a[112:115], v[144:147]
  v_mfma_f32_16x16x32_bf16 v[176:179], a[44:47], a[112:115], v[176:179]
  v_mfma_f32_16x16x32_bf16 v[208:211], a[48:51], a[112:115], v[208:211]
  v_mfma_f32_16x16x32_bf16 v[240:243], a[52:55], a[112:115], v[240:243]
  buffer_load_dwordx4 v10, s[20:23], s25 offen offset:2048 lds
  v_mfma_f32_16x16x32_bf16 a[144:147], a[56:59], a[112:115], a[144:147]
  s_add_u32 m0, s88, s27
  s_add_u32 m0, m0, 86016
  v_mfma_f32_16x16x32_bf16 a[176:179], a[60:63], a[112:115], a[176:179]
  v_mfma_f32_16x16x32_bf16 v[84:87], a[32:35], a[116:119], v[84:87]
  v_mfma_f32_16x16x32_bf16 v[116:119], a[36:39], a[116:119], v[116:119]
  v_mfma_f32_16x16x32_bf16 v[148:151], a[40:43], a[116:119], v[148:151]
  v_mfma_f32_16x16x32_bf16 v[180:183], a[44:47], a[116:119], v[180:183]
  v_mfma_f32_16x16x32_bf16 v[212:215], a[48:51], a[116:119], v[212:215]
  buffer_load_dwordx4 v11, s[20:23], s25 offen offset:0 lds
  v_mfma_f32_16x16x32_bf16 v[244:247], a[52:55], a[116:119], v[244:247]
  v_mfma_f32_16x16x32_bf16 a[148:151], a[56:59], a[116:119], a[148:151]
  v_mfma_f32_16x16x32_bf16 a[180:183], a[60:63], a[116:119], a[180:183]
  v_mfma_f32_16x16x32_bf16 v[88:91], a[32:35], a[120:123], v[88:91]
  v_mfma_f32_16x16x32_bf16 v[120:123], a[36:39], a[120:123], v[120:123]
  v_mfma_f32_16x16x32_bf16 v[152:155], a[40:43], a[120:123], v[152:155]
  buffer_load_dwordx4 v12, s[20:23], s25 offen offset:1024 lds
  v_mfma_f32_16x16x32_bf16 v[184:187], a[44:47], a[120:123], v[184:187]
  v_mfma_f32_16x16x32_bf16 v[216:219], a[48:51], a[120:123], v[216:219]
  v_mfma_f32_16x16x32_bf16 v[248:251], a[52:55], a[120:123], v[248:251]
  v_mfma_f32_16x16x32_bf16 a[152:155], a[56:59], a[120:123], a[152:155]
  v_mfma_f32_16x16x32_bf16 a[184:187], a[60:63], a[120:123], a[184:187]
  v_mfma_f32_16x16x32_bf16 v[92:95], a[32:35], a[124:127], v[92:95]
  buffer_load_dwordx4 v13, s[20:23], s25 offen offset:2048 lds
  v_mfma_f32_16x16x32_bf16 v[124:127], a[36:39], a[124:127], v[124:127]
  s_add_u32 s25, s25, 393216
  v_mfma_f32_16x16x32_bf16 v[156:159], a[40:43], a[124:127], v[156:159]
  v_mfma_f32_16x16x32_bf16 v[188:191], a[44:47], a[124:127], v[188:191]
  v_mfma_f32_16x16x32_bf16 v[220:223], a[48:51], a[124:127], v[220:223]
  v_mfma_f32_16x16x32_bf16 v[252:255], a[52:55], a[124:127], v[252:255]
  v_mfma_f32_16x16x32_bf16 a[156:159], a[56:59], a[124:127], a[156:159]
  v_mfma_f32_16x16x32_bf16 a[188:191], a[60:63], a[124:127], a[188:191]
  s_and_b32 s4, s3, 1
  s_lshl_b32 s5, s62, 1
  s_add_u32 s4, s4, s5
  s_lshr_b32 s5, s3, 1
  s_lshl_b32 s6, s61, 1
  s_add_u32 s5, s5, s6
  s_add_u32 s16, s86, 16777216
  s_addc_u32 s17, s87, 0
  s_mov_b32 s18, 33554432
  s_mov_b32 s19, 0x00020000
  s_lshl_b32 s4, s4, 20
  s_lshl_b32 s5, s5, 16
  s_add_u32 s4, s4, s5
  s_add_u32 s4, s4, 0x4000
  v_cvt_pk_bf16_f32 v64, v64, v65
  v_cvt_pk_bf16_f32 v65, v66, v67
  v_cvt_pk_bf16_f32 v66, v96, v97
  v_cvt_pk_bf16_f32 v67, v98, v99
  buffer_store_dwordx4 v[64:67], v2, s[16:19], s4 offen offset:0 sc1
  v_cvt_pk_bf16_f32 v68, v68, v69
  v_cvt_pk_bf16_f32 v69, v70, v71
  v_cvt_pk_bf16_f32 v70, v100, v101
  v_cvt_pk_bf16_f32 v71, v102, v103
  buffer_store_dwordx4 v[68:71], v2, s[16:19], s4 offen offset:1024 sc1
  v_cvt_pk_bf16_f32 v72, v72, v73
  v_cvt_pk_bf16_f32 v73, v74, v75
  v_cvt_pk_bf16_f32 v74, v104, v105
  v_cvt_pk_bf16_f32 v75, v106, v107
  buffer_store_dwordx4 v[72:75], v2, s[16:19], s4 offen offset:2048 sc1
  v_cvt_pk_bf16_f32 v76, v76, v77
  v_cvt_pk_bf16_f32 v77, v78, v79
  v_cvt_pk_bf16_f32 v78, v108, v109
  v_cvt_pk_bf16_f32 v79, v110, v111
  buffer_store_dwordx4 v[76:79], v2, s[16:19], s4 offen offset:3072 sc1
  s_add_u32 s4, s4, 4096
  v_cvt_pk_bf16_f32 v80, v80, v81
  v_cvt_pk_bf16_f32 v81, v82, v83
  v_cvt_pk_bf16_f32 v82, v112, v113
  v_cvt_pk_bf16_f32 v83, v114, v115
  buffer_store_dwordx4 v[80:83], v2, s[16:19], s4 offen offset:0 sc1
  v_cvt_pk_bf16_f32 v84, v84, v85
  v_cvt_pk_bf16_f32 v85, v86, v87
  v_cvt_pk_bf16_f32 v86, v116, v117
  v_cvt_pk_bf16_f32 v87, v118, v119
  buffer_store_dwordx4 v[84:87], v2, s[16:19], s4 offen offset:1024 sc1
  v_cvt_pk_bf16_f32 v88, v88, v89
  v_cvt_pk_bf16_f32 v89, v90, v91
  v_cvt_pk_bf16_f32 v90, v120, v121
  v_cvt_pk_bf16_f32 v91, v122, v123
  buffer_store_dwordx4 v[88:91], v2, s[16:19], s4 offen offset:2048 sc1
  v_cvt_pk_bf16_f32 v92, v92, v93
  v_cvt_pk_bf16_f32 v93, v94, v95
  v_cvt_pk_bf16_f32 v94, v124, v125
  v_cvt_pk_bf16_f32 v95, v126, v127
  buffer_store_dwordx4 v[92:95], v2, s[16:19], s4 offen offset:3072 sc1
  s_add_u32 s4, s4, 4096
  v_cvt_pk_bf16_f32 v128, v128, v129
  v_cvt_pk_bf16_f32 v129, v130, v131
  v_cvt_pk_bf16_f32 v130, v160, v161
  v_cvt_pk_bf16_f32 v131, v162, v163
  buffer_store_dwordx4 v[128:131], v2, s[16:19], s4 offen offset:0 sc1
  v_cvt_pk_bf16_f32 v132, v132, v133
  v_cvt_pk_bf16_f32 v133, v134, v135
  v_cvt_pk_bf16_f32 v134, v164, v165
  v_cvt_pk_bf16_f32 v135, v166, v167
  buffer_store_dwordx4 v[132:135], v2, s[16:19], s4 offen offset:1024 sc1
  v_cvt_pk_bf16_f32 v136, v136, v137
  v_cvt_pk_bf16_f32 v137, v138, v139
  v_cvt_pk_bf16_f32 v138, v168, v169
  v_cvt_pk_bf16_f32 v139, v170, v171
  buffer_store_dwordx4 v[136:139], v2, s[16:19], s4 offen offset:2048 sc1
  v_cvt_pk_bf16_f32 v140, v140, v141
  v_cvt_pk_bf16_f32 v141, v142, v143
  v_cvt_pk_bf16_f32 v142, v172, v173
  v_cvt_pk_bf16_f32 v143, v174, v175
  buffer_store_dwordx4 v[140:143], v2, s[16:19], s4 offen offset:3072 sc1
  s_add_u32 s4, s4, 4096
  v_cvt_pk_bf16_f32 v144, v144, v145
  v_cvt_pk_bf16_f32 v145, v146, v147
  v_cvt_pk_bf16_f32 v146, v176, v177
  v_cvt_pk_bf16_f32 v147, v178, v179
  buffer_store_dwordx4 v[144:147], v2, s[16:19], s4 offen offset:0 sc1
  v_cvt_pk_bf16_f32 v148, v148, v149
  v_cvt_pk_bf16_f32 v149, v150, v151
  v_cvt_pk_bf16_f32 v150, v180, v181
  v_cvt_pk_bf16_f32 v151, v182, v183
  buffer_store_dwordx4 v[148:151], v2, s[16:19], s4 offen offset:1024 sc1
  v_cvt_pk_bf16_f32 v152, v152, v153
  v_cvt_pk_bf16_f32 v153, v154, v155
  v_cvt_pk_bf16_f32 v154, v184, v185
  v_cvt_pk_bf16_f32 v155, v186, v187
  buffer_store_dwordx4 v[152:155], v2, s[16:19], s4 offen offset:2048 sc1
  v_cvt_pk_bf16_f32 v156, v156, v157
  v_cvt_pk_bf16_f32 v157, v158, v159
  v_cvt_pk_bf16_f32 v158, v188, v189
  v_cvt_pk_bf16_f32 v159, v190, v191
  buffer_store_dwordx4 v[156:159], v2, s[16:19], s4 offen offset:3072 sc1
  s_add_u32 s4, s4, 20480
  v_cvt_pk_bf16_f32 v192, v192, v193
  v_cvt_pk_bf16_f32 v193, v194, v195
  v_cvt_pk_bf16_f32 v194, v224, v225
  v_cvt_pk_bf16_f32 v195, v226, v227
  buffer_store_dwordx4 v[192:195], v2, s[16:19], s4 offen offset:0 sc1
  v_cvt_pk_bf16_f32 v196, v196, v197
  v_cvt_pk_bf16_f32 v197, v198, v199
  v_cvt_pk_bf16_f32 v198, v228, v229
  v_cvt_pk_bf16_f32 v199, v230, v231
  buffer_store_dwordx4 v[196:199], v2, s[16:19], s4 offen offset:1024 sc1
  v_cvt_pk_bf16_f32 v200, v200, v201
  v_cvt_pk_bf16_f32 v201, v202, v203
  v_cvt_pk_bf16_f32 v202, v232, v233
  v_cvt_pk_bf16_f32 v203, v234, v235
  buffer_store_dwordx4 v[200:203], v2, s[16:19], s4 offen offset:2048 sc1
  v_cvt_pk_bf16_f32 v204, v204, v205
  v_cvt_pk_bf16_f32 v205, v206, v207
  v_cvt_pk_bf16_f32 v206, v236, v237
  v_cvt_pk_bf16_f32 v207, v238, v239
  buffer_store_dwordx4 v[204:207], v2, s[16:19], s4 offen offset:3072 sc1
  s_add_u32 s4, s4, 4096
  v_cvt_pk_bf16_f32 v208, v208, v209
  v_cvt_pk_bf16_f32 v209, v210, v211
  v_cvt_pk_bf16_f32 v210, v240, v241
  v_cvt_pk_bf16_f32 v211, v242, v243
  buffer_store_dwordx4 v[208:211], v2, s[16:19], s4 offen offset:0 sc1
  v_cvt_pk_bf16_f32 v212, v212, v213
  v_cvt_pk_bf16_f32 v213, v214, v215
  v_cvt_pk_bf16_f32 v214, v244, v245
  v_cvt_pk_bf16_f32 v215, v246, v247
  buffer_store_dwordx4 v[212:215], v2, s[16:19], s4 offen offset:1024 sc1
  v_cvt_pk_bf16_f32 v216, v216, v217
  v_cvt_pk_bf16_f32 v217, v218, v219
  v_cvt_pk_bf16_f32 v218, v248, v249
  v_cvt_pk_bf16_f32 v219, v250, v251
  buffer_store_dwordx4 v[216:219], v2, s[16:19], s4 offen offset:2048 sc1
  v_cvt_pk_bf16_f32 v220, v220, v221
  v_cvt_pk_bf16_f32 v221, v222, v223
  v_cvt_pk_bf16_f32 v222, v252, v253
  v_cvt_pk_bf16_f32 v223, v254, v255
  buffer_store_dwordx4 v[220:223], v2, s[16:19], s4 offen offset:3072 sc1
  s_add_u32 s4, s4, 4096
  v_accvgpr_read_b32 v64, a128
  v_accvgpr_read_b32 v65, a129
  v_accvgpr_read_b32 v66, a130
  v_accvgpr_read_b32 v67, a131
  v_accvgpr_read_b32 v68, a160
  v_accvgpr_read_b32 v69, a161
  v_accvgpr_read_b32 v70, a162
  v_accvgpr_read_b32 v71, a163
  v_cvt_pk_bf16_f32 v64, v64, v65
  v_cvt_pk_bf16_f32 v65, v66, v67
  v_cvt_pk_bf16_f32 v66, v68, v69
  v_cvt_pk_bf16_f32 v67, v70, v71
  buffer_store_dwordx4 v[64:67], v2, s[16:19], s4 offen offset:0 sc1
  v_accvgpr_read_b32 v72, a132
  v_accvgpr_read_b32 v73, a133
  v_accvgpr_read_b32 v74, a134
  v_accvgpr_read_b32 v75, a135
  v_accvgpr_read_b32 v76, a164
  v_accvgpr_read_b32 v77, a165
  v_accvgpr_read_b32 v78, a166
  v_accvgpr_read_b32 v79, a167
  v_cvt_pk_bf16_f32 v72, v72, v73
  v_cvt_pk_bf16_f32 v73, v74, v75
  v_cvt_pk_bf16_f32 v74, v76, v77
  v_cvt_pk_bf16_f32 v75, v78, v79
  buffer_store_dwordx4 v[72:75], v2, s[16:19], s4 offen offset:1024 sc1
  v_accvgpr_read_b32 v80, a136
  v_accvgpr_read_b32 v81, a137
  v_accvgpr_read_b32 v82, a138
  v_accvgpr_read_b32 v83, a139
  v_accvgpr_read_b32 v84, a168
  v_accvgpr_read_b32 v85, a169
  v_accvgpr_read_b32 v86, a170
  v_accvgpr_read_b32 v87, a171
  v_cvt_pk_bf16_f32 v80, v80, v81
  v_cvt_pk_bf16_f32 v81, v82, v83
  v_cvt_pk_bf16_f32 v82, v84, v85
  v_cvt_pk_bf16_f32 v83, v86, v87
  buffer_store_dwordx4 v[80:83], v2, s[16:19], s4 offen offset:2048 sc1
  v_accvgpr_read_b32 v88, a140
  v_accvgpr_read_b32 v89, a141
  v_accvgpr_read_b32 v90, a142
  v_accvgpr_read_b32 v91, a143
  v_accvgpr_read_b32 v92, a172
  v_accvgpr_read_b32 v93, a173
  v_accvgpr_read_b32 v94, a174
  v_accvgpr_read_b32 v95, a175
  v_cvt_pk_bf16_f32 v88, v88, v89
  v_cvt_pk_bf16_f32 v89, v90, v91
  v_cvt_pk_bf16_f32 v90, v92, v93
  v_cvt_pk_bf16_f32 v91, v94, v95
  buffer_store_dwordx4 v[88:91], v2, s[16:19], s4 offen offset:3072 sc1
  s_add_u32 s4, s4, 4096
  v_accvgpr_read_b32 v96, a144
  v_accvgpr_read_b32 v97, a145
  v_accvgpr_read_b32 v98, a146
  v_accvgpr_read_b32 v99, a147
  v_accvgpr_read_b32 v100, a176
  v_accvgpr_read_b32 v101, a177
  v_accvgpr_read_b32 v102, a178
  v_accvgpr_read_b32 v103, a179
  v_cvt_pk_bf16_f32 v96, v96, v97
  v_cvt_pk_bf16_f32 v97, v98, v99
  v_cvt_pk_bf16_f32 v98, v100, v101
  v_cvt_pk_bf16_f32 v99, v102, v103
  buffer_store_dwordx4 v[96:99], v2, s[16:19], s4 offen offset:0 sc1
  v_accvgpr_read_b32 v104, a148
  v_accvgpr_read_b32 v105, a149
  v_accvgpr_read_b32 v106, a150
  v_accvgpr_read_b32 v107, a151
  v_accvgpr_read_b32 v108, a180
  v_accvgpr_read_b32 v109, a181
  v_accvgpr_read_b32 v110, a182
  v_accvgpr_read_b32 v111, a183
  v_cvt_pk_bf16_f32 v104, v104, v105
  v_cvt_pk_bf16_f32 v105, v106, v107
  v_cvt_pk_bf16_f32 v106, v108, v109
  v_cvt_pk_bf16_f32 v107, v110, v111
  buffer_store_dwordx4 v[104:107], v2, s[16:19], s4 offen offset:1024 sc1
  v_accvgpr_read_b32 v112, a152
  v_accvgpr_read_b32 v113, a153
  v_accvgpr_read_b32 v114, a154
  v_accvgpr_read_b32 v115, a155
  v_accvgpr_read_b32 v116, a184
  v_accvgpr_read_b32 v117, a185
  v_accvgpr_read_b32 v118, a186
  v_accvgpr_read_b32 v119, a187
  v_cvt_pk_bf16_f32 v112, v112, v113
  v_cvt_pk_bf16_f32 v113, v114, v115
  v_cvt_pk_bf16_f32 v114, v116, v117
  v_cvt_pk_bf16_f32 v115, v118, v119
  buffer_store_dwordx4 v[112:115], v2, s[16:19], s4 offen offset:2048 sc1
  v_accvgpr_read_b32 v120, a156
  v_accvgpr_read_b32 v121, a157
  v_accvgpr_read_b32 v122, a158
  v_accvgpr_read_b32 v123, a159
  v_accvgpr_read_b32 v124, a188
  v_accvgpr_read_b32 v125, a189
  v_accvgpr_read_b32 v126, a190
  v_accvgpr_read_b32 v127, a191
  v_cvt_pk_bf16_f32 v120, v120, v121
  v_cvt_pk_bf16_f32 v121, v122, v123
  v_cvt_pk_bf16_f32 v122, v124, v125
  v_cvt_pk_bf16_f32 v123, v126, v127
  buffer_store_dwordx4 v[120:123], v2, s[16:19], s4 offen offset:3072 sc1
  s_branch Lp2
Lp1_qt:
  s_waitcnt vmcnt(8) lgkmcnt(0)
  s_barrier
  v_mfma_f32_16x16x32_bf16 v[64:67], a[96:99], a[32:35], v[64:67]
  s_mov_b32 m0, s41
  ds_read_b128 a[0:3], v16 offset:0
  v_mfma_f32_16x16x32_bf16 v[96:99], a[96:99], a[36:39], v[96:99]
  buffer_load_dwordx4 v56, s[12:15], s47 offen offset:0 lds
  v_mfma_f32_16x16x32_bf16 v[128:131], a[96:99], a[40:43], v[128:131]
  ds_read_b64_tr_b16 a[64:65], v18 offset:0
  v_mfma_f32_16x16x32_bf16 v[160:163], a[96:99], a[44:47], v[160:163]
  v_mfma_f32_16x16x32_bf16 v[192:195], a[96:99], a[48:51], v[192:195]
  ds_read_b64_tr_b16 a[66:67], v18 offset:2048
  v_mfma_f32_16x16x32_bf16 v[224:227], a[96:99], a[52:55], v[224:227]
  v_mfma_f32_16x16x32_bf16 a[128:131], a[96:99], a[56:59], a[128:131]
  ds_read_b128 a[4:7], v16 offset:2048
  v_mfma_f32_16x16x32_bf16 a[160:163], a[96:99], a[60:63], a[160:163]
  v_mfma_f32_16x16x32_bf16 v[68:71], a[100:103], a[32:35], v[68:71]
  v_mfma_f32_16x16x32_bf16 v[100:103], a[100:103], a[36:39], v[100:103]
  ds_read_b128 a[8:11], v16 offset:4096
  v_mfma_f32_16x16x32_bf16 v[132:135], a[100:103], a[40:43], v[132:135]
  buffer_load_dwordx4 v57, s[12:15], s47 offen offset:1024 lds
  v_mfma_f32_16x16x32_bf16 v[164:167], a[100:103], a[44:47], v[164:167]
  ds_read_b128 a[12:15], v16 offset:6144
  v_mfma_f32_16x16x32_bf16 v[196:199], a[100:103], a[48:51], v[196:199]
  v_mfma_f32_16x16x32_bf16 v[228:231], a[100:103], a[52:55], v[228:231]
  ds_read_b128 a[16:19], v16 offset:8192
  v_mfma_f32_16x16x32_bf16 a[132:135], a[100:103], a[56:59], a[132:135]
  v_mfma_f32_16x16x32_bf16 a[164:167], a[100:103], a[60:63], a[164:167]
  ds_read_b128 a[20:23], v16 offset:10240
  v_mfma_f32_16x16x32_bf16 v[72:75], a[104:107], a[32:35], v[72:75]
  v_mfma_f32_16x16x32_bf16 v[104:107], a[104:107], a[36:39], v[104:107]
  v_mfma_f32_16x16x32_bf16 v[136:139], a[104:107], a[40:43], v[136:139]
  ds_read_b128 a[24:27], v16 offset:12288
  v_mfma_f32_16x16x32_bf16 v[168:171], a[104:107], a[44:47], v[168:171]
  v_mfma_f32_16x16x32_bf16 v[200:203], a[104:107], a[48:51], v[200:203]
  ds_read_b128 a[28:31], v16 offset:14336
  v_mfma_f32_16x16x32_bf16 v[232:235], a[104:107], a[52:55], v[232:235]
  buffer_load_dwordx4 v58, s[12:15], s47 offen offset:2048 lds
  v_mfma_f32_16x16x32_bf16 a[136:139], a[104:107], a[56:59], a[136:139]
  ds_read_b64_tr_b16 a[68:69], v19 offset:0
  v_mfma_f32_16x16x32_bf16 a[168:171], a[104:107], a[60:63], a[168:171]
  v_mfma_f32_16x16x32_bf16 v[76:79], a[108:111], a[32:35], v[76:79]
  ds_read_b64_tr_b16 a[70:71], v19 offset:2048
  v_mfma_f32_16x16x32_bf16 v[108:111], a[108:111], a[36:39], v[108:111]
  v_mfma_f32_16x16x32_bf16 v[140:143], a[108:111], a[40:43], v[140:143]
  v_mfma_f32_16x16x32_bf16 v[172:175], a[108:111], a[44:47], v[172:175]
  ds_read_b64_tr_b16 a[72:73], v20 offset:0
  v_mfma_f32_16x16x32_bf16 v[204:207], a[108:111], a[48:51], v[204:207]
  v_mfma_f32_16x16x32_bf16 v[236:239], a[108:111], a[52:55], v[236:239]
  ds_read_b64_tr_b16 a[74:75], v20 offset:2048
  v_mfma_f32_16x16x32_bf16 a[140:143], a[108:111], a[56:59], a[140:143]
  v_mfma_f32_16x16x32_bf16 a[172:175], a[108:111], a[60:63], a[172:175]
  buffer_load_dwordx4 v59, s[12:15], s47 offen offset:3072 lds
  ds_read_b64_tr_b16 a[76:77], v21 offset:0
  v_mfma_f32_16x16x32_bf16 v[80:83], a[112:115], a[32:35], v[80:83]
  s_add_u32 m0, s41, 4096
  v_mfma_f32_16x16x32_bf16 v[112:115], a[112:115], a[36:39], v[112:115]
  ds_read_b64_tr_b16 a[78:79], v21 offset:2048
  v_mfma_f32_16x16x32_bf16 v[144:147], a[112:115], a[40:43], v[144:147]
  v_mfma_f32_16x16x32_bf16 v[176:179], a[112:115], a[44:47], v[176:179]
  v_mfma_f32_16x16x32_bf16 v[208:211], a[112:115], a[48:51], v[208:211]
  ds_read_b64_tr_b16 a[80:81], v18 offset:8192
  v_mfma_f32_16x16x32_bf16 v[240:243], a[112:115], a[52:55], v[240:243]
  v_mfma_f32_16x16x32_bf16 a[144:147], a[112:115], a[56:59], a[144:147]
  ds_read_b64_tr_b16 a[82:83], v18 offset:10240
  v_mfma_f32_16x16x32_bf16 a[176:179], a[112:115], a[60:63], a[176:179]
  v_mfma_f32_16x16x32_bf16 v[84:87], a[116:119], a[32:35], v[84:87]
  ds_read_b64_tr_b16 a[84:85], v19 offset:8192
  v_mfma_f32_16x16x32_bf16 v[116:119], a[116:119], a[36:39], v[116:119]
  v_mfma_f32_16x16x32_bf16 v[148:151], a[116:119], a[40:43], v[148:151]
  buffer_load_dwordx4 v60, s[12:15], s47 offen offset:0 lds
  ds_read_b64_tr_b16 a[86:87], v19 offset:10240
  v_mfma_f32_16x16x32_bf16 v[180:183], a[116:119], a[44:47], v[180:183]
  v_mfma_f32_16x16x32_bf16 v[212:215], a[116:119], a[48:51], v[212:215]
  v_mfma_f32_16x16x32_bf16 v[244:247], a[116:119], a[52:55], v[244:247]
  ds_read_b64_tr_b16 a[88:89], v20 offset:8192
  v_mfma_f32_16x16x32_bf16 a[148:151], a[116:119], a[56:59], a[148:151]
  v_mfma_f32_16x16x32_bf16 a[180:183], a[116:119], a[60:63], a[180:183]
  ds_read_b64_tr_b16 a[90:91], v20 offset:10240
  v_mfma_f32_16x16x32_bf16 v[88:91], a[120:123], a[32:35], v[88:91]
  v_mfma_f32_16x16x32_bf16 v[120:123], a[120:123], a[36:39], v[120:123]
  ds_read_b64_tr_b16 a[92:93], v21 offset:8192
  v_mfma_f32_16x16x32_bf16 v[152:155], a[120:123], a[40:43], v[152:155]
  v_mfma_f32_16x16x32_bf16 v[184:187], a[120:123], a[44:47], v[184:187]
  ds_read_b64_tr_b16 a[94:95], v21 offset:10240
  v_mfma_f32_16x16x32_bf16 v[216:219], a[120:123], a[48:51], v[216:219]
  buffer_load_dwordx4 v61, s[12:15], s47 offen offset:1024 lds
  v_mfma_f32_16x16x32_bf16 v[248:251], a[120:123], a[52:55], v[248:251]
  v_mfma_f32_16x16x32_bf16 a[152:155], a[120:123], a[56:59], a[152:155]
  v_mfma_f32_16x16x32_bf16 a[184:187], a[120:123], a[60:63], a[184:187]
  v_mfma_f32_16x16x32_bf16 v[92:95], a[124:127], a[32:35], v[92:95]
  v_mfma_f32_16x16x32_bf16 v[124:127], a[124:127], a[36:39], v[124:127]
  v_mfma_f32_16x16x32_bf16 v[156:159], a[124:127], a[40:43], v[156:159]
  v_mfma_f32_16x16x32_bf16 v[188:191], a[124:127], a[44:47], v[188:191]
  v_mfma_f32_16x16x32_bf16 v[220:223], a[124:127], a[48:51], v[220:223]
  v_mfma_f32_16x16x32_bf16 v[252:255], a[124:127], a[52:55], v[252:255]
  v_mfma_f32_16x16x32_bf16 a[156:159], a[124:127], a[56:59], a[156:159]
  v_mfma_f32_16x16x32_bf16 a[188:191], a[124:127], a[60:63], a[188:191]
  s_waitcnt lgkmcnt(0)
  v_mfma_f32_16x16x32_bf16 v[64:67], a[64:67], a[0:3], v[64:67]
  buffer_load_dwordx4 v62, s[12:15], s47 offen offset:2048 lds
  ds_read_b128 a[32:35], v17 offset:0
  v_mfma_f32_16x16x32_bf16 v[96:99], a[64:67], a[4:7], v[96:99]
  v_mfma_f32_16x16x32_bf16 v[128:131], a[64:67], a[8:11], v[128:131]
  ds_read_b64_tr_b16 a[96:97], v18 offset:4096
  v_mfma_f32_16x16x32_bf16 v[160:163], a[64:67], a[12:15], v[160:163]
  v_mfma_f32_16x16x32_bf16 v[192:195], a[64:67], a[16:19], v[192:195]
  ds_read_b64_tr_b16 a[98:99], v18 offset:6144
  v_mfma_f32_16x16x32_bf16 v[224:227], a[64:67], a[20:23], v[224:227]
  v_mfma_f32_16x16x32_bf16 a[128:131], a[64:67], a[24:27], a[128:131]
  ds_read_b128 a[36:39], v17 offset:2048
  v_mfma_f32_16x16x32_bf16 a[160:163], a[64:67], a[28:31], a[160:163]
  v_mfma_f32_16x16x32_bf16 v[68:71], a[68:71], a[0:3], v[68:71]
  v_mfma_f32_16x16x32_bf16 v[100:103], a[68:71], a[4:7], v[100:103]
  buffer_load_dwordx4 v63, s[12:15], s47 offen offset:3072 lds
  ds_read_b128 a[40:43], v17 offset:4096
  v_mfma_f32_16x16x32_bf16 v[132:135], a[68:71], a[8:11], v[132:135]
  s_add_u32 s47, s47, 524288
  s_sub_u32 s49, s49, 1
  s_cmp_eq_u32 s49, 0
  s_cselect_b32 s34, s53, 0
  s_cselect_b32 s49, s51, s49
  v_mfma_f32_16x16x32_bf16 v[164:167], a[68:71], a[12:15], v[164:167]
  s_sub_u32 s47, s47, s34
  s_sub_u32 s50, s50, 1
  s_cmp_eq_u32 s50, 0
  s_cselect_b32 s12, s54, s12
  s_cselect_b32 s13, s55, s13
  v_mfma_f32_16x16x32_bf16 v[196:199], a[68:71], a[16:19], v[196:199]
  s_lshl_b32 s10, s32, 18
  s_add_u32 s8, s76, s10
  s_addc_u32 s9, s77, 0
  v_mfma_f32_16x16x32_bf16 v[228:231], a[68:71], a[20:23], v[228:231]
  s_sub_u32 s8, s8, 32768
  s_subb_u32 s9, s9, 0
  s_mov_b32 s10, 294912
  v_mfma_f32_16x16x32_bf16 a[132:135], a[68:71], a[24:27], a[132:135]
  s_mov_b32 s11, 0x00020000
  s_cmp_ge_u32 s3, 2
  s_cbranch_scc1 Lh_6
  s_add_u32 m0, s88, s28
  s_nop 0
  buffer_load_dwordx4 v40, s[8:11], s24 offen offset:0 lds
Lh_6:
  v_mfma_f32_16x16x32_bf16 a[164:167], a[68:71], a[28:31], a[164:167]
  s_mov_b32 m0, s88
  ds_read_b128 a[44:47], v17 offset:6144
  ds_read_b128 a[48:51], v17 offset:8192
  v_mfma_f32_16x16x32_bf16 v[72:75], a[72:75], a[0:3], v[72:75]
  ds_read_b128 a[52:55], v17 offset:10240
  v_mfma_f32_16x16x32_bf16 v[104:107], a[72:75], a[4:7], v[104:107]
  v_mfma_f32_16x16x32_bf16 v[136:139], a[72:75], a[8:11], v[136:139]
  ds_read_b128 a[56:59], v17 offset:12288
  v_mfma_f32_16x16x32_bf16 v[168:171], a[72:75], a[12:15], v[168:171]
  buffer_load_dwordx4 v36, s[8:11], s24 offen offset:0 lds
  v_mfma_f32_16x16x32_bf16 v[200:203], a[72:75], a[16:19], v[200:203]
  ds_read_b128 a[60:63], v17 offset:14336
  v_mfma_f32_16x16x32_bf16 v[232:235], a[72:75], a[20:23], v[232:235]
  v_mfma_f32_16x16x32_bf16 a[136:139], a[72:75], a[24:27], a[136:139]
  ds_read_b64_tr_b16 a[100:101], v19 offset:4096
  v_mfma_f32_16x16x32_bf16 a[168:171], a[72:75], a[28:31], a[168:171]
  v_mfma_f32_16x16x32_bf16 v[76:79], a[76:79], a[0:3], v[76:79]
  ds_read_b64_tr_b16 a[102:103], v19 offset:6144
  v_mfma_f32_16x16x32_bf16 v[108:111], a[76:79], a[4:7], v[108:111]
  v_mfma_f32_16x16x32_bf16 v[140:143], a[76:79], a[8:11], v[140:143]
  v_mfma_f32_16x16x32_bf16 v[172:175], a[76:79], a[12:15], v[172:175]
  ds_read_b64_tr_b16 a[104:105], v20 offset:4096
  v_mfma_f32_16x16x32_bf16 v[204:207], a[76:79], a[16:19], v[204:207]
  buffer_load_dwordx4 v37, s[8:11], s24 offen offset:1024 lds
  v_mfma_f32_16x16x32_bf16 v[236:239], a[76:79], a[20:23], v[236:239]
  ds_read_b64_tr_b16 a[106:107], v20 offset:6144
  v_mfma_f32_16x16x32_bf16 a[140:143], a[76:79], a[24:27], a[140:143]
  v_mfma_f32_16x16x32_bf16 a[172:175], a[76:79], a[28:31], a[172:175]
  ds_read_b64_tr_b16 a[108:109], v21 offset:4096
  v_mfma_f32_16x16x32_bf16 v[80:83], a[80:83], a[0:3], v[80:83]
  v_mfma_f32_16x16x32_bf16 v[112:115], a[80:83], a[4:7], v[112:115]
  ds_read_b64_tr_b16 a[110:111], v21 offset:6144
  v_mfma_f32_16x16x32_bf16 v[144:147], a[80:83], a[8:11], v[144:147]
  v_mfma_f32_16x16x32_bf16 v[176:179], a[80:83], a[12:15], v[176:179]
  v_mfma_f32_16x16x32_bf16 v[208:211], a[80:83], a[16:19], v[208:211]
  ds_read_b64_tr_b16 a[112:113], v18 offset:12288
  v_mfma_f32_16x16x32_bf16 v[240:243], a[80:83], a[20:23], v[240:243]
  v_mfma_f32_16x16x32_bf16 a[144:147], a[80:83], a[24:27], a[144:147]
  buffer_load_dwordx4 v38, s[8:11], s24 offen offset:2048 lds
  ds_read_b64_tr_b16 a[114:115], v18 offset:14336
  v_mfma_f32_16x16x32_bf16 a[176:179], a[80:83], a[28:31], a[176:179]
  v_mfma_f32_16x16x32_bf16 v[84:87], a[84:87], a[0:3], v[84:87]
  ds_read_b64_tr_b16 a[116:117], v19 offset:12288
  v_mfma_f32_16x16x32_bf16 v[116:119], a[84:87], a[4:7], v[116:119]
  v_mfma_f32_16x16x32_bf16 v[148:151], a[84:87], a[8:11], v[148:151]
  ds_read_b64_tr_b16 a[118:119], v19 offset:14336
  v_mfma_f32_16x16x32_bf16 v[180:183], a[84:87], a[12:15], v[180:183]
  v_mfma_f32_16x16x32_bf16 v[212:215], a[84:87], a[16:19], v[212:215]
  v_mfma_f32_16x16x32_bf16 v[244:247], a[84:87], a[20:23], v[244:247]
  ds_read_b64_tr_b16 a[120:121], v20 offset:12288
  v_mfma_f32_16x16x32_bf16 a[148:151], a[84:87], a[24:27], a[148:151]
  v_mfma_f32_16x16x32_bf16 a[180:183], a[84:87], a[28:31], a[180:183]
  buffer_load_dwordx4 v39, s[8:11], s24 offen offset:3072 lds
  ds_read_b64_tr_b16 a[122:123], v20 offset:14336
  v_mfma_f32_16x16x32_bf16 v[88:91], a[88:91], a[0:3], v[88:91]
  s_add_u32 s24, s24, 128
  v_mfma_f32_16x16x32_bf16 v[120:123], a[88:91], a[4:7], v[120:123]
  s_add_u32 s36, s36, s38
  s_add_u32 s37, s37, 1
  ds_read_b64_tr_b16 a[124:125], v21 offset:12288
  v_mfma_f32_16x16x32_bf16 v[152:155], a[88:91], a[8:11], v[152:155]
  s_cmp_eq_u32 s37, 3
  s_cselect_b32 s37, 0, s37
  s_cselect_b32 s38, s39, s40
  v_mfma_f32_16x16x32_bf16 v[184:187], a[88:91], a[12:15], v[184:187]
  s_add_u32 s41, s41, s43
  s_sub_u32 s43, 0, s43
  ds_read_b64_tr_b16 a[126:127], v21 offset:14336
  v_mfma_f32_16x16x32_bf16 v[216:219], a[88:91], a[16:19], v[216:219]
  v_add_u32 v16, s38, v16
  v_add_u32 v17, s38, v17
  v_mfma_f32_16x16x32_bf16 v[248:251], a[88:91], a[20:23], v[248:251]
  v_add_u32 v18, s43, v18
  v_add_u32 v19, s43, v19
  v_mfma_f32_16x16x32_bf16 a[152:155], a[88:91], a[24:27], a[152:155]
  v_add_u32 v20, s43, v20
  v_add_u32 v21, s43, v21
  v_mfma_f32_16x16x32_bf16 a[184:187], a[88:91], a[28:31], a[184:187]
  v_mfma_f32_16x16x32_bf16 v[92:95], a[92:95], a[0:3], v[92:95]
  v_mfma_f32_16x16x32_bf16 v[124:127], a[92:95], a[4:7], v[124:127]
  v_mfma_f32_16x16x32_bf16 v[156:159], a[92:95], a[8:11], v[156:159]
  v_mfma_f32_16x16x32_bf16 v[188:191], a[92:95], a[12:15], v[188:191]
  v_mfma_f32_16x16x32_bf16 v[220:223], a[92:95], a[16:19], v[220:223]
  v_mfma_f32_16x16x32_bf16 v[252:255], a[92:95], a[20:23], v[252:255]
  v_mfma_f32_16x16x32_bf16 a[156:159], a[92:95], a[24:27], a[156:159]
  v_mfma_f32_16x16x32_bf16 a[188:191], a[92:95], a[28:31], a[188:191]
  s_waitcnt vmcnt(4) lgkmcnt(0)
  s_barrier
  v_mfma_f32_16x16x32_bf16 v[64:67], a[96:99], a[32:35], v[64:67]
  s_add_u32 m0, s88, s26
  ds_read_b128 a[0:3], v16 offset:0
  v_mfma_f32_16x16x32_bf16 v[96:99], a[96:99], a[36:39], v[96:99]
  buffer_load_dwordx4 v8, s[20:23], s25 offen offset:0 lds
  v_mfma_f32_16x16x32_bf16 v[128:131], a[96:99], a[40:43], v[128:131]
  ds_read_b64_tr_b16 a[64:65], v18 offset:0
  v_mfma_f32_16x16x32_bf16 v[160:163], a[96:99], a[44:47], v[160:163]
  v_mfma_f32_16x16x32_bf16 v[192:195], a[96:99], a[48:51], v[192:195]
  ds_read_b64_tr_b16 a[66:67], v18 offset:2048
  v_mfma_f32_16x16x32_bf16 v[224:227], a[96:99], a[52:55], v[224:227]
  v_mfma_f32_16x16x32_bf16 a[128:131], a[96:99], a[56:59], a[128:131]
  ds_read_b128 a[4:7], v16 offset:2048
  v_mfma_f32_16x16x32_bf16 a[160:163], a[96:99], a[60:63], a[160:163]
  buffer_load_dwordx4 v9, s[20:23], s25 offen offset:1024 lds
  v_mfma_f32_16x16x32_bf16 v[68:71], a[100:103], a[32:35], v[68:71]
  v_mfma_f32_16x16x32_bf16 v[100:103], a[100:103], a[36:39], v[100:103]
  ds_read_b128 a[8:11], v16 offset:4096
  v_mfma_f32_16x16x32_bf16 v[132:135], a[100:103], a[40:43], v[132:135]
  v_mfma_f32_16x16x32_bf16 v[164:167], a[100:103], a[44:47], v[164:167]
  ds_read_b128 a[12:15], v16 offset:6144
  v_mfma_f32_16x16x32_bf16 v[196:199], a[100:103], a[48:51], v[196:199]
  v_mfma_f32_16x16x32_bf16 v[228:231], a[100:103], a[52:55], v[228:231]
  ds_read_b128 a[16:19], v16 offset:8192
  v_mfma_f32_16x16x32_bf16 a[132:135], a[100:103], a[56:59], a[132:135]
  v_mfma_f32_16x16x32_bf16 a[164:167], a[100:103], a[60:63], a[164:167]
  buffer_load_dwordx4 v10, s[20:23], s25 offen offset:2048 lds
  ds_read_b128 a[20:23], v16 offset:10240
  v_mfma_f32_16x16x32_bf16 v[72:75], a[104:107], a[32:35], v[72:75]
  s_add_u32 m0, s88, s27
  v_mfma_f32_16x16x32_bf16 v[104:107], a[104:107], a[36:39], v[104:107]
  v_mfma_f32_16x16x32_bf16 v[136:139], a[104:107], a[40:43], v[136:139]
  ds_read_b128 a[24:27], v16 offset:12288
  v_mfma_f32_16x16x32_bf16 v[168:171], a[104:107], a[44:47], v[168:171]
  v_mfma_f32_16x16x32_bf16 v[200:203], a[104:107], a[48:51], v[200:203]
  ds_read_b128 a[28:31], v16 offset:14336
  v_mfma_f32_16x16x32_bf16 v[232:235], a[104:107], a[52:55], v[232:235]
  v_mfma_f32_16x16x32_bf16 a[136:139], a[104:107], a[56:59], a[136:139]
  ds_read_b64_tr_b16 a[68:69], v19 offset:0
  v_mfma_f32_16x16x32_bf16 a[168:171], a[104:107], a[60:63], a[168:171]
  buffer_load_dwordx4 v11, s[20:23], s25 offen offset:0 lds
  v_mfma_f32_16x16x32_bf16 v[76:79], a[108:111], a[32:35], v[76:79]
  ds_read_b64_tr_b16 a[70:71], v19 offset:2048
  v_mfma_f32_16x16x32_bf16 v[108:111], a[108:111], a[36:39], v[108:111]
  v_mfma_f32_16x16x32_bf16 v[140:143], a[108:111], a[40:43], v[140:143]
  v_mfma_f32_16x16x32_bf16 v[172:175], a[108:111], a[44:47], v[172:175]
  ds_read_b64_tr_b16 a[72:73], v20 offset:0
  v_mfma_f32_16x16x32_bf16 v[204:207], a[108:111], a[48:51], v[204:207]
  v_mfma_f32_16x16x32_bf16 v[236:239], a[108:111], a[52:55], v[236:239]
  ds_read_b64_tr_b16 a[74:75], v20 offset:2048
  v_mfma_f32_16x16x32_bf16 a[140:143], a[108:111], a[56:59], a[140:143]
  v_mfma_f32_16x16x32_bf16 a[172:175], a[108:111], a[60:63], a[172:175]
  buffer_load_dwordx4 v12, s[20:23], s25 offen offset:1024 lds
  ds_read_b64_tr_b16 a[76:77], v21 offset:0
  v_mfma_f32_16x16x32_bf16 v[80:83], a[112:115], a[32:35], v[80:83]
  v_mfma_f32_16x16x32_bf16 v[112:115], a[112:115], a[36:39], v[112:115]
  ds_read_b64_tr_b16 a[78:79], v21 offset:2048
  v_mfma_f32_16x16x32_bf16 v[144:147], a[112:115], a[40:43], v[144:147]
  v_mfma_f32_16x16x32_bf16 v[176:179], a[112:115], a[44:47], v[176:179]
  v_mfma_f32_16x16x32_bf16 v[208:211], a[112:115], a[48:51], v[208:211]
  ds_read_b64_tr_b16 a[80:81], v18 offset:8192
  v_mfma_f32_16x16x32_bf16 v[240:243], a[112:115], a[52:55], v[240:243]
  v_mfma_f32_16x16x32_bf16 a[144:147], a[112:115], a[56:59], a[144:147]
  ds_read_b64_tr_b16 a[82:83], v18 offset:10240
  v_mfma_f32_16x16x32_bf16 a[176:179], a[112:115], a[60:63], a[176:179]
  buffer_load_dwordx4 v13, s[20:23], s25 offen offset:2048 lds
  v_mfma_f32_16x16x32_bf16 v[84:87], a[116:119], a[32:35], v[84:87]
  s_add_u32 s25, s25, 393216
  s_cmp_ge_u32 s3, 2
  s_cbranch_scc1 Lh_7
  s_add_u32 m0, s88, s28
  s_add_u32 m0, m0, 43008
  s_nop 0
  buffer_load_dwordx4 v40, s[8:11], s24 offen offset:0 lds
Lh_7:
  v_mfma_f32_16x16x32_bf16 v[116:119], a[116:119], a[36:39], v[116:119]
  s_add_u32 m0, s88, 43008
  ds_read_b64_tr_b16 a[84:85], v19 offset:8192
  v_mfma_f32_16x16x32_bf16 v[148:151], a[116:119], a[40:43], v[148:151]
  ds_read_b64_tr_b16 a[86:87], v19 offset:10240
  v_mfma_f32_16x16x32_bf16 v[180:183], a[116:119], a[44:47], v[180:183]
  v_mfma_f32_16x16x32_bf16 v[212:215], a[116:119], a[48:51], v[212:215]
  v_mfma_f32_16x16x32_bf16 v[244:247], a[116:119], a[52:55], v[244:247]
  ds_read_b64_tr_b16 a[88:89], v20 offset:8192
  v_mfma_f32_16x16x32_bf16 a[148:151], a[116:119], a[56:59], a[148:151]
  v_mfma_f32_16x16x32_bf16 a[180:183], a[116:119], a[60:63], a[180:183]
  buffer_load_dwordx4 v36, s[8:11], s24 offen offset:0 lds
  ds_read_b64_tr_b16 a[90:91], v20 offset:10240
  v_mfma_f32_16x16x32_bf16 v[88:91], a[120:123], a[32:35], v[88:91]
  v_mfma_f32_16x16x32_bf16 v[120:123], a[120:123], a[36:39], v[120:123]
  ds_read_b64_tr_b16 a[92:93], v21 offset:8192
  v_mfma_f32_16x16x32_bf16 v[152:155], a[120:123], a[40:43], v[152:155]
  v_mfma_f32_16x16x32_bf16 v[184:187], a[120:123], a[44:47], v[184:187]
  ds_read_b64_tr_b16 a[94:95], v21 offset:10240
  v_mfma_f32_16x16x32_bf16 v[216:219], a[120:123], a[48:51], v[216:219]
  v_mfma_f32_16x16x32_bf16 v[248:251], a[120:123], a[52:55], v[248:251]
  v_mfma_f32_16x16x32_bf16 a[152:155], a[120:123], a[56:59], a[152:155]
  v_mfma_f32_16x16x32_bf16 a[184:187], a[120:123], a[60:63], a[184:187]
  buffer_load_dwordx4 v37, s[8:11], s24 offen offset:1024 lds
  v_mfma_f32_16x16x32_bf16 v[92:95], a[124:127], a[32:35], v[92:95]
  v_mfma_f32_16x16x32_bf16 v[124:127], a[124:127], a[36:39], v[124:127]
  v_mfma_f32_16x16x32_bf16 v[156:159], a[124:127], a[40:43], v[156:159]
  v_mfma_f32_16x16x32_bf16 v[188:191], a[124:127], a[44:47], v[188:191]
  v_mfma_f32_16x16x32_bf16 v[220:223], a[124:127], a[48:51], v[220:223]
  v_mfma_f32_16x16x32_bf16 v[252:255], a[124:127], a[52:55], v[252:255]
  v_mfma_f32_16x16x32_bf16 a[156:159], a[124:127], a[56:59], a[156:159]
  v_mfma_f32_16x16x32_bf16 a[188:191], a[124:127], a[60:63], a[188:191]
  s_waitcnt lgkmcnt(0)
  v_mfma_f32_16x16x32_bf16 v[64:67], a[64:67], a[0:3], v[64:67]
  buffer_load_dwordx4 v38, s[8:11], s24 offen offset:2048 lds
  ds_read_b128 a[32:35], v17 offset:0
  v_mfma_f32_16x16x32_bf16 v[96:99], a[64:67], a[4:7], v[96:99]
  v_mfma_f32_16x16x32_bf16 v[128:131], a[64:67], a[8:11], v[128:131]
  ds_read_b64_tr_b16 a[96:97], v18 offset:4096
  v_mfma_f32_16x16x32_bf16 v[160:163], a[64:67], a[12:15], v[160:163]
  v_mfma_f32_16x16x32_bf16 v[192:195], a[64:67], a[16:19], v[192:195]
  ds_read_b64_tr_b16 a[98:99], v18 offset:6144
  v_mfma_f32_16x16x32_bf16 v[224:227], a[64:67], a[20:23], v[224:227]
  v_mfma_f32_16x16x32_bf16 a[128:131], a[64:67], a[24:27], a[128:131]
  ds_read_b128 a[36:39], v17 offset:2048
  v_mfma_f32_16x16x32_bf16 a[160:163], a[64:67], a[28:31], a[160:163]
  buffer_load_dwordx4 v39, s[8:11], s24 offen offset:3072 lds
  v_mfma_f32_16x16x32_bf16 v[68:71], a[68:71], a[0:3], v[68:71]
  s_add_u32 s24, s24, 128
  s_add_u32 m0, s88, s26
  s_add_u32 m0, m0, 43008
  v_mfma_f32_16x16x32_bf16 v[100:103], a[68:71], a[4:7], v[100:103]
  ds_read_b128 a[40:43], v17 offset:4096
  v_mfma_f32_16x16x32_bf16 v[132:135], a[68:71], a[8:11], v[132:135]
  v_mfma_f32_16x16x32_bf16 v[164:167], a[68:71], a[12:15], v[164:167]
  ds_read_b128 a[44:47], v17 offset:6144
  v_mfma_f32_16x16x32_bf16 v[196:199], a[68:71], a[16:19], v[196:199]
  v_mfma_f32_16x16x32_bf16 v[228:231], a[68:71], a[20:23], v[228:231]
  ds_read_b128 a[48:51], v17 offset:8192
  v_mfma_f32_16x16x32_bf16 a[132:135], a[68:71], a[24:27], a[132:135]
  v_mfma_f32_16x16x32_bf16 a[164:167], a[68:71], a[28:31], a[164:167]
  buffer_load_dwordx4 v8, s[20:23], s25 offen offset:0 lds
  ds_read_b128 a[52:55], v17 offset:10240
  v_mfma_f32_16x16x32_bf16 v[72:75], a[72:75], a[0:3], v[72:75]
  v_mfma_f32_16x16x32_bf16 v[104:107], a[72:75], a[4:7], v[104:107]
  v_mfma_f32_16x16x32_bf16 v[136:139], a[72:75], a[8:11], v[136:139]
  ds_read_b128 a[56:59], v17 offset:12288
  v_mfma_f32_16x16x32_bf16 v[168:171], a[72:75], a[12:15], v[168:171]
  v_mfma_f32_16x16x32_bf16 v[200:203], a[72:75], a[16:19], v[200:203]
  ds_read_b128 a[60:63], v17 offset:14336
  v_mfma_f32_16x16x32_bf16 v[232:235], a[72:75], a[20:23], v[232:235]
  v_mfma_f32_16x16x32_bf16 a[136:139], a[72:75], a[24:27], a[136:139]
  ds_read_b64_tr_b16 a[100:101], v19 offset:4096
  v_mfma_f32_16x16x32_bf16 a[168:171], a[72:75], a[28:31], a[168:171]
  buffer_load_dwordx4 v9, s[20:23], s25 offen offset:1024 lds
  v_mfma_f32_16x16x32_bf16 v[76:79], a[76:79], a[0:3], v[76:79]
  ds_read_b64_tr_b16 a[102:103], v19 offset:6144
  v_mfma_f32_16x16x32_bf16 v[108:111], a[76:79], a[4:7], v[108:111]
  v_mfma_f32_16x16x32_bf16 v[140:143], a[76:79], a[8:11], v[140:143]
  v_mfma_f32_16x16x32_bf16 v[172:175], a[76:79], a[12:15], v[172:175]
  ds_read_b64_tr_b16 a[104:105], v20 offset:4096
  v_mfma_f32_16x16x32_bf16 v[204:207], a[76:79], a[16:19], v[204:207]
  v_mfma_f32_16x16x32_bf16 v[236:239], a[76:79], a[20:23], v[236:239]
  ds_read_b64_tr_b16 a[106:107], v20 offset:6144
  v_mfma_f32_16x16x32_bf16 a[140:143], a[76:79], a[24:27], a[140:143]
  v_mfma_f32_16x16x32_bf16 a[172:175], a[76:79], a[28:31], a[172:175]
  buffer_load_dwordx4 v10, s[20:23], s25 offen offset:2048 lds
  ds_read_b64_tr_b16 a[108:109], v21 offset:4096
  v_mfma_f32_16x16x32_bf16 v[80:83], a[80:83], a[0:3], v[80:83]
  s_add_u32 m0, s88, s27
  s_add_u32 m0, m0, 43008
  v_mfma_f32_16x16x32_bf16 v[112:115], a[80:83], a[4:7], v[112:115]
  ds_read_b64_tr_b16 a[110:111], v21 offset:6144
  v_mfma_f32_16x16x32_bf16 v[144:147], a[80:83], a[8:11], v[144:147]
  v_mfma_f32_16x16x32_bf16 v[176:179], a[80:83], a[12:15], v[176:179]
  v_mfma_f32_16x16x32_bf16 v[208:211], a[80:83], a[16:19], v[208:211]
  ds_read_b64_tr_b16 a[112:113], v18 offset:12288
  v_mfma_f32_16x16x32_bf16 v[240:243], a[80:83], a[20:23], v[240:243]
  v_mfma_f32_16x16x32_bf16 a[144:147], a[80:83], a[24:27], a[144:147]
  ds_read_b64_tr_b16 a[114:115], v18 offset:14336
  v_mfma_f32_16x16x32_bf16 a[176:179], a[80:83], a[28:31], a[176:179]
  buffer_load_dwordx4 v11, s[20:23], s25 offen offset:0 lds
  v_mfma_f32_16x16x32_bf16 v[84:87], a[84:87], a[0:3], v[84:87]
  ds_read_b64_tr_b16 a[116:117], v19 offset:12288
  v_mfma_f32_16x16x32_bf16 v[116:119], a[84:87], a[4:7], v[116:119]
  v_mfma_f32_16x16x32_bf16 v[148:151], a[84:87], a[8:11], v[148:151]
  ds_read_b64_tr_b16 a[118:119], v19 offset:14336
  v_mfma_f32_16x16x32_bf16 v[180:183], a[84:87], a[12:15], v[180:183]
  v_mfma_f32_16x16x32_bf16 v[212:215], a[84:87], a[16:19], v[212:215]
  v_mfma_f32_16x16x32_bf16 v[244:247], a[84:87], a[20:23], v[244:247]
  ds_read_b64_tr_b16 a[120:121], v20 offset:12288
  v_mfma_f32_16x16x32_bf16 a[148:151], a[84:87], a[24:27], a[148:151]
  v_mfma_f32_16x16x32_bf16 a[180:183], a[84:87], a[28:31], a[180:183]
  buffer_load_dwordx4 v12, s[20:23], s25 offen offset:1024 lds
  ds_read_b64_tr_b16 a[122:123], v20 offset:14336
  v_mfma_f32_16x16x32_bf16 v[88:91], a[88:91], a[0:3], v[88:91]
  v_mfma_f32_16x16x32_bf16 v[120:123], a[88:91], a[4:7], v[120:123]
  ds_read_b64_tr_b16 a[124:125], v21 offset:12288
  v_mfma_f32_16x16x32_bf16 v[152:155], a[88:91], a[8:11], v[152:155]
  v_mfma_f32_16x16x32_bf16 v[184:187], a[88:91], a[12:15], v[184:187]
  ds_read_b64_tr_b16 a[126:127], v21 offset:14336
  v_mfma_f32_16x16x32_bf16 v[216:219], a[88:91], a[16:19], v[216:219]
  v_mfma_f32_16x16x32_bf16 v[248:251], a[88:91], a[20:23], v[248:251]
  v_mfma_f32_16x16x32_bf16 a[152:155], a[88:91], a[24:27], a[152:155]
  v_mfma_f32_16x16x32_bf16 a[184:187], a[88:91], a[28:31], a[184:187]
  buffer_load_dwordx4 v13, s[20:23], s25 offen offset:2048 lds
  v_mfma_f32_16x16x32_bf16 v[92:95], a[92:95], a[0:3], v[92:95]
  s_add_u32 s25, s25, 393216
  v_mfma_f32_16x16x32_bf16 v[124:127], a[92:95], a[4:7], v[124:127]
  v_mfma_f32_16x16x32_bf16 v[156:159], a[92:95], a[8:11], v[156:159]
  v_mfma_f32_16x16x32_bf16 v[188:191], a[92:95], a[12:15], v[188:191]
  v_mfma_f32_16x16x32_bf16 v[220:223], a[92:95], a[16:19], v[220:223]
  v_mfma_f32_16x16x32_bf16 v[252:255], a[92:95], a[20:23], v[252:255]
  v_mfma_f32_16x16x32_bf16 a[156:159], a[92:95], a[24:27], a[156:159]
  v_mfma_f32_16x16x32_bf16 a[188:191], a[92:95], a[28:31], a[188:191]
  s_mov_b32 s16, s84
  s_mov_b32 s17, s85
  s_mov_b32 s18, 256
  s_mov_b32 s19, 0x00020000
  buffer_load_dwordx2 v[30:31], off, s[16:19], 0 sc1
  s_waitcnt lgkmcnt(0)
  s_barrier
  v_mfma_f32_16x16x32_bf16 v[64:67], a[96:99], a[32:35], v[64:67]
  s_cmp_ge_u32 s3, 2
  s_cbranch_scc1 Lh_8
  s_add_u32 m0, s88, s28
  s_add_u32 m0, m0, 86016
  s_nop 0
  buffer_load_dwordx4 v40, s[8:11], s24 offen offset:0 lds
Lh_8:
  v_mfma_f32_16x16x32_bf16 v[96:99], a[96:99], a[36:39], v[96:99]
  s_add_u32 m0, s88, 86016
  v_mfma_f32_16x16x32_bf16 v[128:131], a[96:99], a[40:43], v[128:131]
  buffer_load_dwordx4 v36, s[8:11], s24 offen offset:0 lds
  v_mfma_f32_16x16x32_bf16 v[160:163], a[96:99], a[44:47], v[160:163]
  v_mfma_f32_16x16x32_bf16 v[192:195], a[96:99], a[48:51], v[192:195]
  v_mfma_f32_16x16x32_bf16 v[224:227], a[96:99], a[52:55], v[224:227]
  v_mfma_f32_16x16x32_bf16 a[128:131], a[96:99], a[56:59], a[128:131]
  buffer_load_dwordx4 v37, s[8:11], s24 offen offset:1024 lds
  v_mfma_f32_16x16x32_bf16 a[160:163], a[96:99], a[60:63], a[160:163]
  v_mfma_f32_16x16x32_bf16 v[68:71], a[100:103], a[32:35], v[68:71]
  v_mfma_f32_16x16x32_bf16 v[100:103], a[100:103], a[36:39], v[100:103]
  v_mfma_f32_16x16x32_bf16 v[132:135], a[100:103], a[40:43], v[132:135]
  v_mfma_f32_16x16x32_bf16 v[164:167], a[100:103], a[44:47], v[164:167]
  v_mfma_f32_16x16x32_bf16 v[196:199], a[100:103], a[48:51], v[196:199]
  buffer_load_dwordx4 v38, s[8:11], s24 offen offset:2048 lds
  v_mfma_f32_16x16x32_bf16 v[228:231], a[100:103], a[52:55], v[228:231]
  v_mfma_f32_16x16x32_bf16 a[132:135], a[100:103], a[56:59], a[132:135]
  v_mfma_f32_16x16x32_bf16 a[164:167], a[100:103], a[60:63], a[164:167]
  v_mfma_f32_16x16x32_bf16 v[72:75], a[104:107], a[32:35], v[72:75]
  v_mfma_f32_16x16x32_bf16 v[104:107], a[104:107], a[36:39], v[104:107]
  v_mfma_f32_16x16x32_bf16 v[136:139], a[104:107], a[40:43], v[136:139]
  buffer_load_dwordx4 v39, s[8:11], s24 offen offset:3072 lds
  v_mfma_f32_16x16x32_bf16 v[168:171], a[104:107], a[44:47], v[168:171]
  s_add_u32 s24, s24, 128
  s_add_u32 m0, s88, s26
  s_add_u32 m0, m0, 86016
  v_mfma_f32_16x16x32_bf16 v[200:203], a[104:107], a[48:51], v[200:203]
  v_mfma_f32_16x16x32_bf16 v[232:235], a[104:107], a[52:55], v[232:235]
  v_mfma_f32_16x16x32_bf16 a[136:139], a[104:107], a[56:59], a[136:139]
  v_mfma_f32_16x16x32_bf16 a[168:171], a[104:107], a[60:63], a[168:171]
  v_mfma_f32_16x16x32_bf16 v[76:79], a[108:111], a[32:35], v[76:79]
  v_mfma_f32_16x16x32_bf16 v[108:111], a[108:111], a[36:39], v[108:111]
  buffer_load_dwordx4 v8, s[20:23], s25 offen offset:0 lds
  v_mfma_f32_16x16x32_bf16 v[140:143], a[108:111], a[40:43], v[140:143]
  v_mfma_f32_16x16x32_bf16 v[172:175], a[108:111], a[44:47], v[172:175]
  v_mfma_f32_16x16x32_bf16 v[204:207], a[108:111], a[48:51], v[204:207]
  v_mfma_f32_16x16x32_bf16 v[236:239], a[108:111], a[52:55], v[236:239]
  v_mfma_f32_16x16x32_bf16 a[140:143], a[108:111], a[56:59], a[140:143]
  v_mfma_f32_16x16x32_bf16 a[172:175], a[108:111], a[60:63], a[172:175]
  buffer_load_dwordx4 v9, s[20:23], s25 offen offset:1024 lds
  v_mfma_f32_16x16x32_bf16 v[80:83], a[112:115], a[32:35], v[80:83]
  v_mfma_f32_16x16x32_bf16 v[112:115], a[112:115], a[36:39], v[112:115]
  v_mfma_f32_16x16x32_bf16 v[144:147], a[112:115], a[40:43], v[144:147]
  v_mfma_f32_16x16x32_bf16 v[176:179], a[112:115], a[44:47], v[176:179]
  v_mfma_f32_16x16x32_bf16 v[208:211], a[112:115], a[48:51], v[208:211]
  v_mfma_f32_16x16x32_bf16 v[240:243], a[112:115], a[52:55], v[240:243]
  buffer_load_dwordx4 v10, s[20:23], s25 offen offset:2048 lds
  v_mfma_f32_16x16x32_bf16 a[144:147], a[112:115], a[56:59], a[144:147]
  s_add_u32 m0, s88, s27
  s_add_u32 m0, m0, 86016
  v_mfma_f32_16x16x32_bf16 a[176:179], a[112:115], a[60:63], a[176:179]
  v_mfma_f32_16x16x32_bf16 v[84:87], a[116:119], a[32:35], v[84:87]
  v_mfma_f32_16x16x32_bf16 v[116:119], a[116:119], a[36:39], v[116:119]
  v_mfma_f32_16x16x32_bf16 v[148:151], a[116:119], a[40:43], v[148:151]
  v_mfma_f32_16x16x32_bf16 v[180:183], a[116:119], a[44:47], v[180:183]
  v_mfma_f32_16x16x32_bf16 v[212:215], a[116:119], a[48:51], v[212:215]
  buffer_load_dwordx4 v11, s[20:23], s25 offen offset:0 lds
  v_mfma_f32_16x16x32_bf16 v[244:247], a[116:119], a[52:55], v[244:247]
  v_mfma_f32_16x16x32_bf16 a[148:151], a[116:119], a[56:59], a[148:151]
  v_mfma_f32_16x16x32_bf16 a[180:183], a[116:119], a[60:63], a[180:183]
  v_mfma_f32_16x16x32_bf16 v[88:91], a[120:123], a[32:35], v[88:91]
  v_mfma_f32_16x16x32_bf16 v[120:123], a[120:123], a[36:39], v[120:123]
  v_mfma_f32_16x16x32_bf16 v[152:155], a[120:123], a[40:43], v[152:155]
  buffer_load_dwordx4 v12, s[20:23], s25 offen offset:1024 lds
  v_mfma_f32_16x16x32_bf16 v[184:187], a[120:123], a[44:47], v[184:187]
  v_mfma_f32_16x16x32_bf16 v[216:219], a[120:123], a[48:51], v[216:219]
  v_mfma_f32_16x16x32_bf16 v[248:251], a[120:123], a[52:55], v[248:251]
  v_mfma_f32_16x16x32_bf16 a[152:155], a[120:123], a[56:59], a[152:155]
  v_mfma_f32_16x16x32_bf16 a[184:187], a[120:123], a[60:63], a[184:187]
  v_mfma_f32_16x16x32_bf16 v[92:95], a[124:127], a[32:35], v[92:95]
  buffer_load_dwordx4 v13, s[20:23], s25 offen offset:2048 lds
  v_mfma_f32_16x16x32_bf16 v[124:127], a[124:127], a[36:39], v[124:127]
  s_add_u32 s25, s25, 393216
  v_mfma_f32_16x16x32_bf16 v[156:159], a[124:127], a[40:43], v[156:159]
  v_mfma_f32_16x16x32_bf16 v[188:191], a[124:127], a[44:47], v[188:191]
  v_mfma_f32_16x16x32_bf16 v[220:223], a[124:127], a[48:51], v[220:223]
  v_mfma_f32_16x16x32_bf16 v[252:255], a[124:127], a[52:55], v[252:255]
  v_mfma_f32_16x16x32_bf16 a[156:159], a[124:127], a[56:59], a[156:159]
  v_mfma_f32_16x16x32_bf16 a[188:191], a[124:127], a[60:63], a[188:191]
  s_and_b32 s4, s3, 1
  s_lshl_b32 s5, s62, 1
  s_add_u32 s4, s4, s5
  s_lshr_b32 s5, s3, 1
  s_lshl_b32 s6, s61, 1
  s_add_u32 s5, s5, s6
  s_mov_b32 s16, s86
  s_mov_b32 s17, s87
  s_mov_b32 s18, 16777216
  s_mov_b32 s19, 0x00020000
  s_lshl_b32 s4, s4, 15
  s_lshl_b32 s5, s5, 20
  s_mov_b32 s6, 0x3e0293ee
  s_mov_b32 s7, s6
  s_add_u32 s4, s4, s5
  v_pk_mul_f32 v[64:65], v[64:65], s[6:7]
  v_pk_mul_f32 v[66:67], v[66:67], s[6:7]
  v_pk_mul_f32 v[68:69], v[68:69], s[6:7]
  v_pk_mul_f32 v[70:71], v[70:71], s[6:7]
  v_cvt_pk_bf16_f32 v64, v64, v65
  v_cvt_pk_bf16_f32 v65, v66, v67
  v_cvt_pk_bf16_f32 v66, v68, v69
  v_cvt_pk_bf16_f32 v67, v70, v71
  buffer_store_dwordx4 v[64:67], v2, s[16:19], s4 offen offset:0 sc1
  v_pk_mul_f32 v[72:73], v[72:73], s[6:7]
  v_pk_mul_f32 v[74:75], v[74:75], s[6:7]
  v_pk_mul_f32 v[76:77], v[76:77], s[6:7]
  v_pk_mul_f32 v[78:79], v[78:79], s[6:7]
  v_cvt_pk_bf16_f32 v72, v72, v73
  v_cvt_pk_bf16_f32 v73, v74, v75
  v_cvt_pk_bf16_f32 v74, v76, v77
  v_cvt_pk_bf16_f32 v75, v78, v79
  buffer_store_dwordx4 v[72:75], v2, s[16:19], s4 offen offset:1024 sc1
  v_pk_mul_f32 v[80:81], v[80:81], s[6:7]
  v_pk_mul_f32 v[82:83], v[82:83], s[6:7]
  v_pk_mul_f32 v[84:85], v[84:85], s[6:7]
  v_pk_mul_f32 v[86:87], v[86:87], s[6:7]
  v_cvt_pk_bf16_f32 v80, v80, v81
  v_cvt_pk_bf16_f32 v81, v82, v83
  v_cvt_pk_bf16_f32 v82, v84, v85
  v_cvt_pk_bf16_f32 v83, v86, v87
  buffer_store_dwordx4 v[80:83], v2, s[16:19], s4 offen offset:2048 sc1
  v_pk_mul_f32 v[88:89], v[88:89], s[6:7]
  v_pk_mul_f32 v[90:91], v[90:91], s[6:7]
  v_pk_mul_f32 v[92:93], v[92:93], s[6:7]
  v_pk_mul_f32 v[94:95], v[94:95], s[6:7]
  v_cvt_pk_bf16_f32 v88, v88, v89
  v_cvt_pk_bf16_f32 v89, v90, v91
  v_cvt_pk_bf16_f32 v90, v92, v93
  v_cvt_pk_bf16_f32 v91, v94, v95
  buffer_store_dwordx4 v[88:91], v2, s[16:19], s4 offen offset:3072 sc1
  s_add_u32 s4, s4, 4096
  v_pk_mul_f32 v[96:97], v[96:97], s[6:7]
  v_pk_mul_f32 v[98:99], v[98:99], s[6:7]
  v_pk_mul_f32 v[100:101], v[100:101], s[6:7]
  v_pk_mul_f32 v[102:103], v[102:103], s[6:7]
  v_cvt_pk_bf16_f32 v96, v96, v97
  v_cvt_pk_bf16_f32 v97, v98, v99
  v_cvt_pk_bf16_f32 v98, v100, v101
  v_cvt_pk_bf16_f32 v99, v102, v103
  buffer_store_dwordx4 v[96:99], v2, s[16:19], s4 offen offset:0 sc1
  v_pk_mul_f32 v[104:105], v[104:105], s[6:7]
  v_pk_mul_f32 v[106:107], v[106:107], s[6:7]
  v_pk_mul_f32 v[108:109], v[108:109], s[6:7]
  v_pk_mul_f32 v[110:111], v[110:111], s[6:7]
  v_cvt_pk_bf16_f32 v104, v104, v105
  v_cvt_pk_bf16_f32 v105, v106, v107
  v_cvt_pk_bf16_f32 v106, v108, v109
  v_cvt_pk_bf16_f32 v107, v110, v111
  buffer_store_dwordx4 v[104:107], v2, s[16:19], s4 offen offset:1024 sc1
  v_pk_mul_f32 v[112:113], v[112:113], s[6:7]
  v_pk_mul_f32 v[114:115], v[114:115], s[6:7]
  v_pk_mul_f32 v[116:117], v[116:117], s[6:7]
  v_pk_mul_f32 v[118:119], v[118:119], s[6:7]
  v_cvt_pk_bf16_f32 v112, v112, v113
  v_cvt_pk_bf16_f32 v113, v114, v115
  v_cvt_pk_bf16_f32 v114, v116, v117
  v_cvt_pk_bf16_f32 v115, v118, v119
  buffer_store_dwordx4 v[112:115], v2, s[16:19], s4 offen offset:2048 sc1
  v_pk_mul_f32 v[120:121], v[120:121], s[6:7]
  v_pk_mul_f32 v[122:123], v[122:123], s[6:7]
  v_pk_mul_f32 v[124:125], v[124:125], s[6:7]
  v_pk_mul_f32 v[126:127], v[126:127], s[6:7]
  v_cvt_pk_bf16_f32 v120, v120, v121
  v_cvt_pk_bf16_f32 v121, v122, v123
  v_cvt_pk_bf16_f32 v122, v124, v125
  v_cvt_pk_bf16_f32 v123, v126, v127
  buffer_store_dwordx4 v[120:123], v2, s[16:19], s4 offen offset:3072 sc1
  s_add_u32 s4, s4, 4096
  v_pk_mul_f32 v[128:129], v[128:129], s[6:7]
  v_pk_mul_f32 v[130:131], v[130:131], s[6:7]
  v_pk_mul_f32 v[132:133], v[132:133], s[6:7]
  v_pk_mul_f32 v[134:135], v[134:135], s[6:7]
  v_cvt_pk_bf16_f32 v128, v128, v129
  v_cvt_pk_bf16_f32 v129, v130, v131
  v_cvt_pk_bf16_f32 v130, v132, v133
  v_cvt_pk_bf16_f32 v131, v134, v135
  buffer_store_dwordx4 v[128:131], v2, s[16:19], s4 offen offset:0 sc1
  v_pk_mul_f32 v[136:137], v[136:137], s[6:7]
  v_pk_mul_f32 v[138:139], v[138:139], s[6:7]
  v_pk_mul_f32 v[140:141], v[140:141], s[6:7]
  v_pk_mul_f32 v[142:143], v[142:143], s[6:7]
  v_cvt_pk_bf16_f32 v136, v136, v137
  v_cvt_pk_bf16_f32 v137, v138, v139
  v_cvt_pk_bf16_f32 v138, v140, v141
  v_cvt_pk_bf16_f32 v139, v142, v143
  buffer_store_dwordx4 v[136:139], v2, s[16:19], s4 offen offset:1024 sc1
  v_pk_mul_f32 v[144:145], v[144:145], s[6:7]
  v_pk_mul_f32 v[146:147], v[146:147], s[6:7]
  v_pk_mul_f32 v[148:149], v[148:149], s[6:7]
  v_pk_mul_f32 v[150:151], v[150:151], s[6:7]
  v_cvt_pk_bf16_f32 v144, v144, v145
  v_cvt_pk_bf16_f32 v145, v146, v147
  v_cvt_pk_bf16_f32 v146, v148, v149
  v_cvt_pk_bf16_f32 v147, v150, v151
  buffer_store_dwordx4 v[144:147], v2, s[16:19], s4 offen offset:2048 sc1
  v_pk_mul_f32 v[152:153], v[152:153], s[6:7]
  v_pk_mul_f32 v[154:155], v[154:155], s[6:7]
  v_pk_mul_f32 v[156:157], v[156:157], s[6:7]
  v_pk_mul_f32 v[158:159], v[158:159], s[6:7]
  v_cvt_pk_bf16_f32 v152, v152, v153
  v_cvt_pk_bf16_f32 v153, v154, v155
  v_cvt_pk_bf16_f32 v154, v156, v157
  v_cvt_pk_bf16_f32 v155, v158, v159
  buffer_store_dwordx4 v[152:155], v2, s[16:19], s4 offen offset:3072 sc1
  s_add_u32 s4, s4, 4096
  v_pk_mul_f32 v[160:161], v[160:161], s[6:7]
  v_pk_mul_f32 v[162:163], v[162:163], s[6:7]
  v_pk_mul_f32 v[164:165], v[164:165], s[6:7]
  v_pk_mul_f32 v[166:167], v[166:167], s[6:7]
  v_cvt_pk_bf16_f32 v160, v160, v161
  v_cvt_pk_bf16_f32 v161, v162, v163
  v_cvt_pk_bf16_f32 v162, v164, v165
  v_cvt_pk_bf16_f32 v163, v166, v167
  buffer_store_dwordx4 v[160:163], v2, s[16:19], s4 offen offset:0 sc1
  v_pk_mul_f32 v[168:169], v[168:169], s[6:7]
  v_pk_mul_f32 v[170:171], v[170:171], s[6:7]
  v_pk_mul_f32 v[172:173], v[172:173], s[6:7]
  v_pk_mul_f32 v[174:175], v[174:175], s[6:7]
  v_cvt_pk_bf16_f32 v168, v168, v169
  v_cvt_pk_bf16_f32 v169, v170, v171
  v_cvt_pk_bf16_f32 v170, v172, v173
  v_cvt_pk_bf16_f32 v171, v174, v175
  buffer_store_dwordx4 v[168:171], v2, s[16:19], s4 offen offset:1024 sc1
  v_pk_mul_f32 v[176:177], v[176:177], s[6:7]
  v_pk_mul_f32 v[178:179], v[178:179], s[6:7]
  v_pk_mul_f32 v[180:181], v[180:181], s[6:7]
  v_pk_mul_f32 v[182:183], v[182:183], s[6:7]
  v_cvt_pk_bf16_f32 v176, v176, v177
  v_cvt_pk_bf16_f32 v177, v178, v179
  v_cvt_pk_bf16_f32 v178, v180, v181
  v_cvt_pk_bf16_f32 v179, v182, v183
  buffer_store_dwordx4 v[176:179], v2, s[16:19], s4 offen offset:2048 sc1
  v_pk_mul_f32 v[184:185], v[184:185], s[6:7]
  v_pk_mul_f32 v[186:187], v[186:187], s[6:7]
  v_pk_mul_f32 v[188:189], v[188:189], s[6:7]
  v_pk_mul_f32 v[190:191], v[190:191], s[6:7]
  v_cvt_pk_bf16_f32 v184, v184, v185
  v_cvt_pk_bf16_f32 v185, v186, v187
  v_cvt_pk_bf16_f32 v186, v188, v189
  v_cvt_pk_bf16_f32 v187, v190, v191
  buffer_store_dwordx4 v[184:187], v2, s[16:19], s4 offen offset:3072 sc1
  s_add_u32 s4, s4, 4096
  v_pk_mul_f32 v[192:193], v[192:193], s[6:7]
  v_pk_mul_f32 v[194:195], v[194:195], s[6:7]
  v_pk_mul_f32 v[196:197], v[196:197], s[6:7]
  v_pk_mul_f32 v[198:199], v[198:199], s[6:7]
  v_cvt_pk_bf16_f32 v192, v192, v193
  v_cvt_pk_bf16_f32 v193, v194, v195
  v_cvt_pk_bf16_f32 v194, v196, v197
  v_cvt_pk_bf16_f32 v195, v198, v199
  buffer_store_dwordx4 v[192:195], v2, s[16:19], s4 offen offset:0 sc1
  v_pk_mul_f32 v[200:201], v[200:201], s[6:7]
  v_pk_mul_f32 v[202:203], v[202:203], s[6:7]
  v_pk_mul_f32 v[204:205], v[204:205], s[6:7]
  v_pk_mul_f32 v[206:207], v[206:207], s[6:7]
  v_cvt_pk_bf16_f32 v200, v200, v201
  v_cvt_pk_bf16_f32 v201, v202, v203
  v_cvt_pk_bf16_f32 v202, v204, v205
  v_cvt_pk_bf16_f32 v203, v206, v207
  buffer_store_dwordx4 v[200:203], v2, s[16:19], s4 offen offset:1024 sc1
  v_pk_mul_f32 v[208:209], v[208:209], s[6:7]
  v_pk_mul_f32 v[210:211], v[210:211], s[6:7]
  v_pk_mul_f32 v[212:213], v[212:213], s[6:7]
  v_pk_mul_f32 v[214:215], v[214:215], s[6:7]
  v_cvt_pk_bf16_f32 v208, v208, v209
  v_cvt_pk_bf16_f32 v209, v210, v211
  v_cvt_pk_bf16_f32 v210, v212, v213
  v_cvt_pk_bf16_f32 v211, v214, v215
  buffer_store_dwordx4 v[208:211], v2, s[16:19], s4 offen offset:2048 sc1
  v_pk_mul_f32 v[216:217], v[216:217], s[6:7]
  v_pk_mul_f32 v[218:219], v[218:219], s[6:7]
  v_pk_mul_f32 v[220:221], v[220:221], s[6:7]
  v_pk_mul_f32 v[222:223], v[222:223], s[6:7]
  v_cvt_pk_bf16_f32 v216, v216, v217
  v_cvt_pk_bf16_f32 v217, v218, v219
  v_cvt_pk_bf16_f32 v218, v220, v221
  v_cvt_pk_bf16_f32 v219, v222, v223
  buffer_store_dwordx4 v[216:219], v2, s[16:19], s4 offen offset:3072 sc1
  s_add_u32 s4, s4, 4096
  v_pk_mul_f32 v[224:225], v[224:225], s[6:7]
  v_pk_mul_f32 v[226:227], v[226:227], s[6:7]
  v_pk_mul_f32 v[228:229], v[228:229], s[6:7]
  v_pk_mul_f32 v[230:231], v[230:231], s[6:7]
  v_cvt_pk_bf16_f32 v224, v224, v225
  v_cvt_pk_bf16_f32 v225, v226, v227
  v_cvt_pk_bf16_f32 v226, v228, v229
  v_cvt_pk_bf16_f32 v227, v230, v231
  buffer_store_dwordx4 v[224:227], v2, s[16:19], s4 offen offset:0 sc1
  v_pk_mul_f32 v[232:233], v[232:233], s[6:7]
  v_pk_mul_f32 v[234:235], v[234:235], s[6:7]
  v_pk_mul_f32 v[236:237], v[236:237], s[6:7]
  v_pk_mul_f32 v[238:239], v[238:239], s[6:7]
  v_cvt_pk_bf16_f32 v232, v232, v233
  v_cvt_pk_bf16_f32 v233, v234, v235
  v_cvt_pk_bf16_f32 v234, v236, v237
  v_cvt_pk_bf16_f32 v235, v238, v239
  buffer_store_dwordx4 v[232:235], v2, s[16:19], s4 offen offset:1024 sc1
  v_pk_mul_f32 v[240:241], v[240:241], s[6:7]
  v_pk_mul_f32 v[242:243], v[242:243], s[6:7]
  v_pk_mul_f32 v[244:245], v[244:245], s[6:7]
  v_pk_mul_f32 v[246:247], v[246:247], s[6:7]
  v_cvt_pk_bf16_f32 v240, v240, v241
  v_cvt_pk_bf16_f32 v241, v242, v243
  v_cvt_pk_bf16_f32 v242, v244, v245
  v_cvt_pk_bf16_f32 v243, v246, v247
  buffer_store_dwordx4 v[240:243], v2, s[16:19], s4 offen offset:2048 sc1
  v_pk_mul_f32 v[248:249], v[248:249], s[6:7]
  v_pk_mul_f32 v[250:251], v[250:251], s[6:7]
  v_pk_mul_f32 v[252:253], v[252:253], s[6:7]
  v_pk_mul_f32 v[254:255], v[254:255], s[6:7]
  v_cvt_pk_bf16_f32 v248, v248, v249
  v_cvt_pk_bf16_f32 v249, v250, v251
  v_cvt_pk_bf16_f32 v250, v252, v253
  v_cvt_pk_bf16_f32 v251, v254, v255
  buffer_store_dwordx4 v[248:251], v2, s[16:19], s4 offen offset:3072 sc1
  s_add_u32 s4, s4, 4096
  v_accvgpr_read_b32 v64, a128
  v_accvgpr_read_b32 v65, a129
  v_accvgpr_read_b32 v66, a130
  v_accvgpr_read_b32 v67, a131
  v_accvgpr_read_b32 v68, a132
  v_accvgpr_read_b32 v69, a133
  v_accvgpr_read_b32 v70, a134
  v_accvgpr_read_b32 v71, a135
  v_pk_mul_f32 v[64:65], v[64:65], s[6:7]
  v_pk_mul_f32 v[66:67], v[66:67], s[6:7]
  v_pk_mul_f32 v[68:69], v[68:69], s[6:7]
  v_pk_mul_f32 v[70:71], v[70:71], s[6:7]
  v_cvt_pk_bf16_f32 v64, v64, v65
  v_cvt_pk_bf16_f32 v65, v66, v67
  v_cvt_pk_bf16_f32 v66, v68, v69
  v_cvt_pk_bf16_f32 v67, v70, v71
  buffer_store_dwordx4 v[64:67], v2, s[16:19], s4 offen offset:0 sc1
  v_accvgpr_read_b32 v72, a136
  v_accvgpr_read_b32 v73, a137
  v_accvgpr_read_b32 v74, a138
  v_accvgpr_read_b32 v75, a139
  v_accvgpr_read_b32 v76, a140
  v_accvgpr_read_b32 v77, a141
  v_accvgpr_read_b32 v78, a142
  v_accvgpr_read_b32 v79, a143
  v_pk_mul_f32 v[72:73], v[72:73], s[6:7]
  v_pk_mul_f32 v[74:75], v[74:75], s[6:7]
  v_pk_mul_f32 v[76:77], v[76:77], s[6:7]
  v_pk_mul_f32 v[78:79], v[78:79], s[6:7]
  v_cvt_pk_bf16_f32 v72, v72, v73
  v_cvt_pk_bf16_f32 v73, v74, v75
  v_cvt_pk_bf16_f32 v74, v76, v77
  v_cvt_pk_bf16_f32 v75, v78, v79
  buffer_store_dwordx4 v[72:75], v2, s[16:19], s4 offen offset:1024 sc1
  v_accvgpr_read_b32 v80, a144
  v_accvgpr_read_b32 v81, a145
  v_accvgpr_read_b32 v82, a146
  v_accvgpr_read_b32 v83, a147
  v_accvgpr_read_b32 v84, a148
  v_accvgpr_read_b32 v85, a149
  v_accvgpr_read_b32 v86, a150
  v_accvgpr_read_b32 v87, a151
  v_pk_mul_f32 v[80:81], v[80:81], s[6:7]
  v_pk_mul_f32 v[82:83], v[82:83], s[6:7]
  v_pk_mul_f32 v[84:85], v[84:85], s[6:7]
  v_pk_mul_f32 v[86:87], v[86:87], s[6:7]
  v_cvt_pk_bf16_f32 v80, v80, v81
  v_cvt_pk_bf16_f32 v81, v82, v83
  v_cvt_pk_bf16_f32 v82, v84, v85
  v_cvt_pk_bf16_f32 v83, v86, v87
  buffer_store_dwordx4 v[80:83], v2, s[16:19], s4 offen offset:2048 sc1
  v_accvgpr_read_b32 v88, a152
  v_accvgpr_read_b32 v89, a153
  v_accvgpr_read_b32 v90, a154
  v_accvgpr_read_b32 v91, a155
  v_accvgpr_read_b32 v92, a156
  v_accvgpr_read_b32 v93, a157
  v_accvgpr_read_b32 v94, a158
  v_accvgpr_read_b32 v95, a159
  v_pk_mul_f32 v[88:89], v[88:89], s[6:7]
  v_pk_mul_f32 v[90:91], v[90:91], s[6:7]
  v_pk_mul_f32 v[92:93], v[92:93], s[6:7]
  v_pk_mul_f32 v[94:95], v[94:95], s[6:7]
  v_cvt_pk_bf16_f32 v88, v88, v89
  v_cvt_pk_bf16_f32 v89, v90, v91
  v_cvt_pk_bf16_f32 v90, v92, v93
  v_cvt_pk_bf16_f32 v91, v94, v95
  buffer_store_dwordx4 v[88:91], v2, s[16:19], s4 offen offset:3072 sc1
  s_add_u32 s4, s4, 4096
  v_accvgpr_read_b32 v96, a160
  v_accvgpr_read_b32 v97, a161
  v_accvgpr_read_b32 v98, a162
  v_accvgpr_read_b32 v99, a163
  v_accvgpr_read_b32 v100, a164
  v_accvgpr_read_b32 v101, a165
  v_accvgpr_read_b32 v102, a166
  v_accvgpr_read_b32 v103, a167
  v_pk_mul_f32 v[96:97], v[96:97], s[6:7]
  v_pk_mul_f32 v[98:99], v[98:99], s[6:7]
  v_pk_mul_f32 v[100:101], v[100:101], s[6:7]
  v_pk_mul_f32 v[102:103], v[102:103], s[6:7]
  v_cvt_pk_bf16_f32 v96, v96, v97
  v_cvt_pk_bf16_f32 v97, v98, v99
  v_cvt_pk_bf16_f32 v98, v100, v101
  v_cvt_pk_bf16_f32 v99, v102, v103
  buffer_store_dwordx4 v[96:99], v2, s[16:19], s4 offen offset:0 sc1
  v_accvgpr_read_b32 v104, a168
  v_accvgpr_read_b32 v105, a169
  v_accvgpr_read_b32 v106, a170
  v_accvgpr_read_b32 v107, a171
  v_accvgpr_read_b32 v108, a172
  v_accvgpr_read_b32 v109, a173
  v_accvgpr_read_b32 v110, a174
  v_accvgpr_read_b32 v111, a175
  v_pk_mul_f32 v[104:105], v[104:105], s[6:7]
  v_pk_mul_f32 v[106:107], v[106:107], s[6:7]
  v_pk_mul_f32 v[108:109], v[108:109], s[6:7]
  v_pk_mul_f32 v[110:111], v[110:111], s[6:7]
  v_cvt_pk_bf16_f32 v104, v104, v105
  v_cvt_pk_bf16_f32 v105, v106, v107
  v_cvt_pk_bf16_f32 v106, v108, v109
  v_cvt_pk_bf16_f32 v107, v110, v111
  buffer_store_dwordx4 v[104:107], v2, s[16:19], s4 offen offset:1024 sc1
  v_accvgpr_read_b32 v112, a176
  v_accvgpr_read_b32 v113, a177
  v_accvgpr_read_b32 v114, a178
  v_accvgpr_read_b32 v115, a179
  v_accvgpr_read_b32 v116, a180
  v_accvgpr_read_b32 v117, a181
  v_accvgpr_read_b32 v118, a182
  v_accvgpr_read_b32 v119, a183
  v_pk_mul_f32 v[112:113], v[112:113], s[6:7]
  v_pk_mul_f32 v[114:115], v[114:115], s[6:7]
  v_pk_mul_f32 v[116:117], v[116:117], s[6:7]
  v_pk_mul_f32 v[118:119], v[118:119], s[6:7]
  v_cvt_pk_bf16_f32 v112, v112, v113
  v_cvt_pk_bf16_f32 v113, v114, v115
  v_cvt_pk_bf16_f32 v114, v116, v117
  v_cvt_pk_bf16_f32 v115, v118, v119
  buffer_store_dwordx4 v[112:115], v2, s[16:19], s4 offen offset:2048 sc1
  v_accvgpr_read_b32 v120, a184
  v_accvgpr_read_b32 v121, a185
  v_accvgpr_read_b32 v122, a186
  v_accvgpr_read_b32 v123, a187
  v_accvgpr_read_b32 v124, a188
  v_accvgpr_read_b32 v125, a189
  v_accvgpr_read_b32 v126, a190
  v_accvgpr_read_b32 v127, a191
  v_pk_mul_f32 v[120:121], v[120:121], s[6:7]
  v_pk_mul_f32 v[122:123], v[122:123], s[6:7]
  v_pk_mul_f32 v[124:125], v[124:125], s[6:7]
  v_pk_mul_f32 v[126:127], v[126:127], s[6:7]
  v_cvt_pk_bf16_f32 v120, v120, v121
  v_cvt_pk_bf16_f32 v121, v122, v123
  v_cvt_pk_bf16_f32 v122, v124, v125
  v_cvt_pk_bf16_f32 v123, v126, v127
  buffer_store_dwordx4 v[120:123], v2, s[16:19], s4 offen offset:3072 sc1
Lp2:
  s_mov_b32 s89, 0
  s_mov_b32 s91, 4294881280
  s_mov_b32 s92, 43008
  s_lshl_b32 s34, s62, 4
  s_add_u32 s34, s34, s61
  s_lshr_b32 s4, s2, 7
  s_lshl_b32 s4, s4, 3
  s_add_u32 s34, s34, s4
  s_lshl_b32 s34, s34, 7
  s_cmp_ge_u32 s3, 2
  s_cbranch_scc1 Lp2_r1
  s_waitcnt vmcnt(54)
  s_barrier
  ds_read_b128 a[0:3], v22 offset:0
  ds_read_b64_tr_b16 a[40:41], v26 offset:18432
  ds_read_b64_tr_b16 a[42:43], v26 offset:20480
  ds_read_b128 a[4:7], v22 offset:2048
  ds_read_b128 a[8:11], v22 offset:4096
  ds_read_b128 a[12:15], v22 offset:6144
  ds_read_b64_tr_b16 a[44:45], v27 offset:18432
  ds_read_b64_tr_b16 a[46:47], v27 offset:20480
  ds_read_b64_tr_b16 a[48:49], v26 offset:26624
  ds_read_b64_tr_b16 a[50:51], v26 offset:28672
  ds_read_b128 a[16:19], v24 offset:0
  ds_read_b64_tr_b16 a[52:53], v27 offset:26624
  ds_read_b64_tr_b16 a[54:55], v27 offset:28672
  ds_read_b64_tr_b16 a[56:57], v26 offset:34816
  ds_read_b64_tr_b16 a[58:59], v26 offset:36864
  ds_read_b64_tr_b16 a[60:61], v27 offset:34816
  ds_read_b64_tr_b16 a[62:63], v27 offset:36864
  s_waitcnt lgkmcnt(0)
  v_mfma_f32_16x16x32_bf16 v[128:131], a[40:43], a[0:3], 0
  s_add_u32 s89, s89, 1
  s_cmp_eq_u32 s89, 3
  s_cselect_b32 s89, 0, s89
  s_cselect_b32 s90, s91, s92
  ds_read_b128 a[20:23], v23 offset:0
  v_mfma_f32_16x16x32_bf16 v[136:139], a[40:43], a[4:7], 0
  ds_read_b64_tr_b16 a[64:65], v26 offset:22528
  v_mfma_f32_16x16x32_bf16 v[144:147], a[40:43], a[8:11], 0
  ds_read_b64_tr_b16 a[66:67], v26 offset:24576
  v_mfma_f32_16x16x32_bf16 v[152:155], a[40:43], a[12:15], 0
  ds_read_b128 a[24:27], v23 offset:2048
  v_mfma_f32_16x16x32_bf16 v[132:135], a[44:47], a[0:3], 0
  ds_read_b128 a[28:31], v23 offset:4096
  v_mfma_f32_16x16x32_bf16 v[140:143], a[44:47], a[4:7], 0
  ds_read_b128 a[32:35], v23 offset:6144
  v_mfma_f32_16x16x32_bf16 v[148:151], a[44:47], a[8:11], 0
  ds_read_b64_tr_b16 a[68:69], v27 offset:22528
  v_mfma_f32_16x16x32_bf16 v[156:159], a[44:47], a[12:15], 0
  ds_read_b64_tr_b16 a[70:71], v27 offset:24576
  v_mfma_f32_16x16x32_bf16 v[160:163], a[48:51], a[0:3], 0
  ds_read_b64_tr_b16 a[72:73], v26 offset:30720
  v_mfma_f32_16x16x32_bf16 v[168:171], a[48:51], a[4:7], 0
  ds_read_b64_tr_b16 a[74:75], v26 offset:32768
  v_mfma_f32_16x16x32_bf16 v[176:179], a[48:51], a[8:11], 0
  ds_read_b128 a[36:39], v25 offset:0
  v_mfma_f32_16x16x32_bf16 v[184:187], a[48:51], a[12:15], 0
  ds_read_b64_tr_b16 a[76:77], v27 offset:30720
  v_mfma_f32_16x16x32_bf16 v[224:227], a[48:51], a[16:19], 0
  ds_read_b64_tr_b16 a[78:79], v27 offset:32768
  v_mfma_f32_16x16x32_bf16 v[164:167], a[52:55], a[0:3], 0
  ds_read_b64_tr_b16 a[80:81], v26 offset:38912
  v_mfma_f32_16x16x32_bf16 v[172:175], a[52:55], a[4:7], 0
  ds_read_b64_tr_b16 a[82:83], v26 offset:40960
  v_mfma_f32_16x16x32_bf16 v[180:183], a[52:55], a[8:11], 0
  ds_read_b64_tr_b16 a[84:85], v27 offset:38912
  v_mfma_f32_16x16x32_bf16 v[188:191], a[52:55], a[12:15], 0
  ds_read_b64_tr_b16 a[86:87], v27 offset:40960
  v_mfma_f32_16x16x32_bf16 v[228:231], a[52:55], a[16:19], 0
  v_add_u32 v22, s90, v22
  v_add_u32 v23, s90, v23
  v_mfma_f32_16x16x32_bf16 v[192:195], a[0:3], a[56:59], 0
  v_add_u32 v24, s90, v24
  v_add_u32 v25, s90, v25
  v_mfma_f32_16x16x32_bf16 v[200:203], a[4:7], a[56:59], 0
  v_add_u32 v26, s90, v26
  v_add_u32 v27, s90, v27
  v_mfma_f32_16x16x32_bf16 v[208:211], a[8:11], a[56:59], 0
  v_mfma_f32_16x16x32_bf16 v[216:219], a[12:15], a[56:59], 0
  v_mfma_f32_16x16x32_bf16 v[196:199], a[0:3], a[60:63], 0
  v_mfma_f32_16x16x32_bf16 v[204:207], a[4:7], a[60:63], 0
  v_mfma_f32_16x16x32_bf16 v[212:215], a[8:11], a[60:63], 0
  v_mfma_f32_16x16x32_bf16 v[220:223], a[12:15], a[60:63], 0
  s_waitcnt vmcnt(43) lgkmcnt(0)
  s_barrier
  v_mfma_f32_16x16x32_bf16 v[128:131], a[64:67], a[20:23], v[128:131]
  s_add_u32 m0, s88, s28
  ds_read_b128 a[0:3], v22 offset:0
  v_mfma_f32_16x16x32_bf16 v[136:139], a[64:67], a[24:27], v[136:139]
  buffer_load_dwordx4 v40, s[8:11], s24 offen offset:0 lds
  ds_read_b64_tr_b16 a[40:41], v26 offset:18432
  v_mfma_f32_16x16x32_bf16 v[144:147], a[64:67], a[28:31], v[144:147]
  s_mov_b32 m0, s88
  ds_read_b64_tr_b16 a[42:43], v26 offset:20480
  v_mfma_f32_16x16x32_bf16 v[152:155], a[64:67], a[32:35], v[152:155]
  ds_read_b128 a[4:7], v22 offset:2048
  v_mfma_f32_16x16x32_bf16 v[132:135], a[68:71], a[20:23], v[132:135]
  buffer_load_dwordx4 v36, s[8:11], s24 offen offset:0 lds
  ds_read_b128 a[8:11], v22 offset:4096
  v_mfma_f32_16x16x32_bf16 v[140:143], a[68:71], a[24:27], v[140:143]
  ds_read_b128 a[12:15], v22 offset:6144
  v_mfma_f32_16x16x32_bf16 v[148:151], a[68:71], a[28:31], v[148:151]
  ds_read_b64_tr_b16 a[44:45], v27 offset:18432
  v_mfma_f32_16x16x32_bf16 v[156:159], a[68:71], a[32:35], v[156:159]
  ds_read_b64_tr_b16 a[46:47], v27 offset:20480
  v_mfma_f32_16x16x32_bf16 v[160:163], a[72:75], a[20:23], v[160:163]
  buffer_load_dwordx4 v37, s[8:11], s24 offen offset:1024 lds
  ds_read_b64_tr_b16 a[48:49], v26 offset:26624
  v_mfma_f32_16x16x32_bf16 v[168:171], a[72:75], a[24:27], v[168:171]
  ds_read_b64_tr_b16 a[50:51], v26 offset:28672
  v_mfma_f32_16x16x32_bf16 v[176:179], a[72:75], a[28:31], v[176:179]
  ds_read_b128 a[16:19], v24 offset:0
  v_mfma_f32_16x16x32_bf16 v[184:187], a[72:75], a[32:35], v[184:187]
  ds_read_b64_tr_b16 a[52:53], v27 offset:26624
  v_mfma_f32_16x16x32_bf16 v[224:227], a[72:75], a[36:39], v[224:227]
  buffer_load_dwordx4 v38, s[8:11], s24 offen offset:2048 lds
  ds_read_b64_tr_b16 a[54:55], v27 offset:28672
  v_mfma_f32_16x16x32_bf16 v[164:167], a[76:79], a[20:23], v[164:167]
  ds_read_b64_tr_b16 a[56:57], v26 offset:34816
  v_mfma_f32_16x16x32_bf16 v[172:175], a[76:79], a[24:27], v[172:175]
  ds_read_b64_tr_b16 a[58:59], v26 offset:36864
  v_mfma_f32_16x16x32_bf16 v[180:183], a[76:79], a[28:31], v[180:183]
  ds_read_b64_tr_b16 a[60:61], v27 offset:34816
  v_mfma_f32_16x16x32_bf16 v[188:191], a[76:79], a[32:35], v[188:191]
  buffer_load_dwordx4 v39, s[8:11], s24 offen offset:3072 lds
  ds_read_b64_tr_b16 a[62:63], v27 offset:36864
  v_mfma_f32_16x16x32_bf16 v[228:231], a[76:79], a[36:39], v[228:231]
  s_add_u32 s24, s24, 128
  s_add_u32 m0, s88, s26
  v_mfma_f32_16x16x32_bf16 v[192:195], a[20:23], a[80:83], v[192:195]
  v_mfma_f32_16x16x32_bf16 v[200:203], a[24:27], a[80:83], v[200:203]
  v_mfma_f32_16x16x32_bf16 v[208:211], a[28:31], a[80:83], v[208:211]
  buffer_load_dwordx4 v8, s[20:23], s25 offen offset:0 lds
  v_mfma_f32_16x16x32_bf16 v[216:219], a[32:35], a[80:83], v[216:219]
  v_mfma_f32_16x16x32_bf16 v[196:199], a[20:23], a[84:87], v[196:199]
  v_mfma_f32_16x16x32_bf16 v[204:207], a[24:27], a[84:87], v[204:207]
  v_mfma_f32_16x16x32_bf16 v[212:215], a[28:31], a[84:87], v[212:215]
  v_mfma_f32_16x16x32_bf16 v[220:223], a[32:35], a[84:87], v[220:223]
  s_waitcnt lgkmcnt(0)
  v_mfma_f32_16x16x32_bf16 v[128:131], a[40:43], a[0:3], v[128:131]
  buffer_load_dwordx4 v9, s[20:23], s25 offen offset:1024 lds
  ds_read_b128 a[20:23], v23 offset:0
  v_mfma_f32_16x16x32_bf16 v[136:139], a[40:43], a[4:7], v[136:139]
  ds_read_b64_tr_b16 a[64:65], v26 offset:22528
  v_mfma_f32_16x16x32_bf16 v[144:147], a[40:43], a[8:11], v[144:147]
  ds_read_b64_tr_b16 a[66:67], v26 offset:24576
  v_mfma_f32_16x16x32_bf16 v[152:155], a[40:43], a[12:15], v[152:155]
  buffer_load_dwordx4 v10, s[20:23], s25 offen offset:2048 lds
  ds_read_b128 a[24:27], v23 offset:2048
  v_mfma_f32_16x16x32_bf16 v[132:135], a[44:47], a[0:3], v[132:135]
  s_add_u32 m0, s88, s27
  ds_read_b128 a[28:31], v23 offset:4096
  v_mfma_f32_16x16x32_bf16 v[140:143], a[44:47], a[4:7], v[140:143]
  ds_read_b128 a[32:35], v23 offset:6144
  v_mfma_f32_16x16x32_bf16 v[148:151], a[44:47], a[8:11], v[148:151]
  ds_read_b64_tr_b16 a[68:69], v27 offset:22528
  v_mfma_f32_16x16x32_bf16 v[156:159], a[44:47], a[12:15], v[156:159]
  buffer_load_dwordx4 v11, s[20:23], s25 offen offset:0 lds
  ds_read_b64_tr_b16 a[70:71], v27 offset:24576
  v_mfma_f32_16x16x32_bf16 v[160:163], a[48:51], a[0:3], v[160:163]
  ds_read_b64_tr_b16 a[72:73], v26 offset:30720
  v_mfma_f32_16x16x32_bf16 v[168:171], a[48:51], a[4:7], v[168:171]
  ds_read_b64_tr_b16 a[74:75], v26 offset:32768
  v_mfma_f32_16x16x32_bf16 v[176:179], a[48:51], a[8:11], v[176:179]
  ds_read_b128 a[36:39], v25 offset:0
  v_mfma_f32_16x16x32_bf16 v[184:187], a[48:51], a[12:15], v[184:187]
  buffer_load_dwordx4 v12, s[20:23], s25 offen offset:1024 lds
  ds_read_b64_tr_b16 a[76:77], v27 offset:30720
  v_mfma_f32_16x16x32_bf16 v[224:227], a[48:51], a[16:19], v[224:227]
  ds_read_b64_tr_b16 a[78:79], v27 offset:32768
  v_mfma_f32_16x16x32_bf16 v[164:167], a[52:55], a[0:3], v[164:167]
  ds_read_b64_tr_b16 a[80:81], v26 offset:38912
  v_mfma_f32_16x16x32_bf16 v[172:175], a[52:55], a[4:7], v[172:175]
  ds_read_b64_tr_b16 a[82:83], v26 offset:40960
  v_mfma_f32_16x16x32_bf16 v[180:183], a[52:55], a[8:11], v[180:183]
  buffer_load_dwordx4 v13, s[20:23], s25 offen offset:2048 lds
  ds_read_b64_tr_b16 a[84:85], v27 offset:38912
  v_mfma_f32_16x16x32_bf16 v[188:191], a[52:55], a[12:15], v[188:191]
  s_add_u32 s25, s25, 393216
  ds_read_b64_tr_b16 a[86:87], v27 offset:40960
  v_mfma_f32_16x16x32_bf16 v[228:231], a[52:55], a[16:19], v[228:231]
  s_add_u32 s88, s88, s90
  s_add_u32 s89, s89, 1
  s_cmp_eq_u32 s89, 3
  s_cselect_b32 s89, 0, s89
  s_cselect_b32 s90, s91, s92
  v_mfma_f32_16x16x32_bf16 v[192:195], a[0:3], a[56:59], v[192:195]
  v_add_u32 v22, s90, v22
  v_add_u32 v23, s90, v23
  v_mfma_f32_16x16x32_bf16 v[200:203], a[4:7], a[56:59], v[200:203]
  v_add_u32 v24, s90, v24
  v_add_u32 v25, s90, v25
  v_mfma_f32_16x16x32_bf16 v[208:211], a[8:11], a[56:59], v[208:211]
  v_add_u32 v26, s90, v26
  v_add_u32 v27, s90, v27
  v_mfma_f32_16x16x32_bf16 v[216:219], a[12:15], a[56:59], v[216:219]
  v_mfma_f32_16x16x32_bf16 v[196:199], a[0:3], a[60:63], v[196:199]
  v_mfma_f32_16x16x32_bf16 v[204:207], a[4:7], a[60:63], v[204:207]
  v_mfma_f32_16x16x32_bf16 v[212:215], a[8:11], a[60:63], v[212:215]
  v_mfma_f32_16x16x32_bf16 v[220:223], a[12:15], a[60:63], v[220:223]
  s_waitcnt vmcnt(43) lgkmcnt(0)
  s_barrier
  v_mfma_f32_16x16x32_bf16 v[128:131], a[64:67], a[20:23], v[128:131]
  s_add_u32 m0, s88, s28
  ds_read_b128 a[0:3], v22 offset:0
  v_mfma_f32_16x16x32_bf16 v[136:139], a[64:67], a[24:27], v[136:139]
  buffer_load_dwordx4 v40, s[8:11], s24 offen offset:0 lds
  ds_read_b64_tr_b16 a[40:41], v26 offset:18432
  v_mfma_f32_16x16x32_bf16 v[144:147], a[64:67], a[28:31], v[144:147]
  s_mov_b32 m0, s88
  ds_read_b64_tr_b16 a[42:43], v26 offset:20480
  v_mfma_f32_16x16x32_bf16 v[152:155], a[64:67], a[32:35], v[152:155]
  ds_read_b128 a[4:7], v22 offset:2048
  v_mfma_f32_16x16x32_bf16 v[132:135], a[68:71], a[20:23], v[132:135]
  buffer_load_dwordx4 v36, s[8:11], s24 offen offset:0 lds
  ds_read_b128 a[8:11], v22 offset:4096
  v_mfma_f32_16x16x32_bf16 v[140:143], a[68:71], a[24:27], v[140:143]
  ds_read_b128 a[12:15], v22 offset:6144
  v_mfma_f32_16x16x32_bf16 v[148:151], a[68:71], a[28:31], v[148:151]
  ds_read_b64_tr_b16 a[44:45], v27 offset:18432
  v_mfma_f32_16x16x32_bf16 v[156:159], a[68:71], a[32:35], v[156:159]
  ds_read_b64_tr_b16 a[46:47], v27 offset:20480
  v_mfma_f32_16x16x32_bf16 v[160:163], a[72:75], a[20:23], v[160:163]
  buffer_load_dwordx4 v37, s[8:11], s24 offen offset:1024 lds
  ds_read_b64_tr_b16 a[48:49], v26 offset:26624
  v_mfma_f32_16x16x32_bf16 v[168:171], a[72:75], a[24:27], v[168:171]
  ds_read_b64_tr_b16 a[50:51], v26 offset:28672
  v_mfma_f32_16x16x32_bf16 v[176:179], a[72:75], a[28:31], v[176:179]
  ds_read_b128 a[16:19], v24 offset:0
  v_mfma_f32_16x16x32_bf16 v[184:187], a[72:75], a[32:35], v[184:187]
  ds_read_b64_tr_b16 a[52:53], v27 offset:26624
  v_mfma_f32_16x16x32_bf16 v[224:227], a[72:75], a[36:39], v[224:227]
  buffer_load_dwordx4 v38, s[8:11], s24 offen offset:2048 lds
  ds_read_b64_tr_b16 a[54:55], v27 offset:28672
  v_mfma_f32_16x16x32_bf16 v[164:167], a[76:79], a[20:23], v[164:167]
  ds_read_b64_tr_b16 a[56:57], v26 offset:34816
  v_mfma_f32_16x16x32_bf16 v[172:175], a[76:79], a[24:27], v[172:175]
  ds_read_b64_tr_b16 a[58:59], v26 offset:36864
  v_mfma_f32_16x16x32_bf16 v[180:183], a[76:79], a[28:31], v[180:183]
  ds_read_b64_tr_b16 a[60:61], v27 offset:34816
  v_mfma_f32_16x16x32_bf16 v[188:191], a[76:79], a[32:35], v[188:191]
  buffer_load_dwordx4 v39, s[8:11], s24 offen offset:3072 lds
  ds_read_b64_tr_b16 a[62:63], v27 offset:36864
  v_mfma_f32_16x16x32_bf16 v[228:231], a[76:79], a[36:39], v[228:231]
  s_add_u32 s24, s24, 128
  s_add_u32 m0, s88, s26
  v_mfma_f32_16x16x32_bf16 v[192:195], a[20:23], a[80:83], v[192:195]
  v_mfma_f32_16x16x32_bf16 v[200:203], a[24:27], a[80:83], v[200:203]
  v_mfma_f32_16x16x32_bf16 v[208:211], a[28:31], a[80:83], v[208:211]
  buffer_load_dwordx4 v8, s[20:23], s25 offen offset:0 lds
  v_mfma_f32_16x16x32_bf16 v[216:219], a[32:35], a[80:83], v[216:219]
  v_mfma_f32_16x16x32_bf16 v[196:199], a[20:23], a[84:87], v[196:199]
  v_mfma_f32_16x16x32_bf16 v[204:207], a[24:27], a[84:87], v[204:207]
  v_mfma_f32_16x16x32_bf16 v[212:215], a[28:31], a[84:87], v[212:215]
  v_mfma_f32_16x16x32_bf16 v[220:223], a[32:35], a[84:87], v[220:223]
  s_waitcnt lgkmcnt(0)
  v_mfma_f32_16x16x32_bf16 v[128:131], a[40:43], a[0:3], v[128:131]
  buffer_load_dwordx4 v9, s[20:23], s25 offen offset:1024 lds
  ds_read_b128 a[20:23], v23 offset:0
  v_mfma_f32_16x16x32_bf16 v[136:139], a[40:43], a[4:7], v[136:139]
  ds_read_b64_tr_b16 a[64:65], v26 offset:22528
  v_mfma_f32_16x16x32_bf16 v[144:147], a[40:43], a[8:11], v[144:147]
  ds_read_b64_tr_b16 a[66:67], v26 offset:24576
  v_mfma_f32_16x16x32_bf16 v[152:155], a[40:43], a[12:15], v[152:155]
  buffer_load_dwordx4 v10, s[20:23], s25 offen offset:2048 lds
  ds_read_b128 a[24:27], v23 offset:2048
  v_mfma_f32_16x16x32_bf16 v[132:135], a[44:47], a[0:3], v[132:135]
  s_add_u32 m0, s88, s27
  ds_read_b128 a[28:31], v23 offset:4096
  v_mfma_f32_16x16x32_bf16 v[140:143], a[44:47], a[4:7], v[140:143]
  ds_read_b128 a[32:35], v23 offset:6144
  v_mfma_f32_16x16x32_bf16 v[148:151], a[44:47], a[8:11], v[148:151]
  ds_read_b64_tr_b16 a[68:69], v27 offset:22528
  v_mfma_f32_16x16x32_bf16 v[156:159], a[44:47], a[12:15], v[156:159]
  buffer_load_dwordx4 v11, s[20:23], s25 offen offset:0 lds
  ds_read_b64_tr_b16 a[70:71], v27 offset:24576
  v_mfma_f32_16x16x32_bf16 v[160:163], a[48:51], a[0:3], v[160:163]
  ds_read_b64_tr_b16 a[72:73], v26 offset:30720
  v_mfma_f32_16x16x32_bf16 v[168:171], a[48:51], a[4:7], v[168:171]
  ds_read_b64_tr_b16 a[74:75], v26 offset:32768
  v_mfma_f32_16x16x32_bf16 v[176:179], a[48:51], a[8:11], v[176:179]
  ds_read_b128 a[36:39], v25 offset:0
  v_mfma_f32_16x16x32_bf16 v[184:187], a[48:51], a[12:15], v[184:187]
  buffer_load_dwordx4 v12, s[20:23], s25 offen offset:1024 lds
  ds_read_b64_tr_b16 a[76:77], v27 offset:30720
  v_mfma_f32_16x16x32_bf16 v[224:227], a[48:51], a[16:19], v[224:227]
  ds_read_b64_tr_b16 a[78:79], v27 offset:32768
  v_mfma_f32_16x16x32_bf16 v[164:167], a[52:55], a[0:3], v[164:167]
  ds_read_b64_tr_b16 a[80:81], v26 offset:38912
  v_mfma_f32_16x16x32_bf16 v[172:175], a[52:55], a[4:7], v[172:175]
  ds_read_b64_tr_b16 a[82:83], v26 offset:40960
  v_mfma_f32_16x16x32_bf16 v[180:183], a[52:55], a[8:11], v[180:183]
  buffer_load_dwordx4 v13, s[20:23], s25 offen offset:2048 lds
  ds_read_b64_tr_b16 a[84:85], v27 offset:38912
  v_mfma_f32_16x16x32_bf16 v[188:191], a[52:55], a[12:15], v[188:191]
  s_add_u32 s25, s25, 393216
  ds_read_b64_tr_b16 a[86:87], v27 offset:40960
  v_mfma_f32_16x16x32_bf16 v[228:231], a[52:55], a[16:19], v[228:231]
  s_add_u32 s88, s88, s90
  s_add_u32 s89, s89, 1
  s_cmp_eq_u32 s89, 3
  s_cselect_b32 s89, 0, s89
  s_cselect_b32 s90, s91, s92
  v_mfma_f32_16x16x32_bf16 v[192:195], a[0:3], a[56:59], v[192:195]
  v_add_u32 v22, s90, v22
  v_add_u32 v23, s90, v23
  v_mfma_f32_16x16x32_bf16 v[200:203], a[4:7], a[56:59], v[200:203]
  v_add_u32 v24, s90, v24
  v_add_u32 v25, s90, v25
  v_mfma_f32_16x16x32_bf16 v[208:211], a[8:11], a[56:59], v[208:211]
  v_add_u32 v26, s90, v26
  v_add_u32 v27, s90, v27
  v_mfma_f32_16x16x32_bf16 v[216:219], a[12:15], a[56:59], v[216:219]
  v_mfma_f32_16x16x32_bf16 v[196:199], a[0:3], a[60:63], v[196:199]
  v_mfma_f32_16x16x32_bf16 v[204:207], a[4:7], a[60:63], v[204:207]
  v_mfma_f32_16x16x32_bf16 v[212:215], a[8:11], a[60:63], v[212:215]
  v_mfma_f32_16x16x32_bf16 v[220:223], a[12:15], a[60:63], v[220:223]
  s_waitcnt vmcnt(11) lgkmcnt(0)
  s_barrier
  s_mov_b32 s5, 0x40000
Ltg_9:
  v_readfirstlane_b32 s94, v30
  v_readfirstlane_b32 s95, v31
  s_nop 0
  s_cmp_lg_u32 s95, 0
  s_cbranch_scc1 Lpolld_10
  s_sleep 4
  s_mov_b32 s16, s84
  s_mov_b32 s17, s85
  s_mov_b32 s18, 256
  s_mov_b32 s19, 0x00020000
  buffer_load_dwordx2 v[30:31], off, s[16:19], 0 sc1
  s_sub_u32 s5, s5, 1
  s_waitcnt vmcnt(0)
  s_cbranch_scc0 Ltg_9
Lpolld_10:
  v_mov_b32 v30, 0x40000000
  v_mov_b32 v28, s94
  v_cmp_eq_u32 vcc, 0, v0
  v_mov_b32 v29, s95
  s_nop 0
  v_cndmask_b32_e64 v30, v30, 0, vcc
  buffer_store_dwordx2 v[28:29], v30, s[96:99], s34 offen sc1
  v_mfma_f32_16x16x32_bf16 v[128:131], a[64:67], a[20:23], v[128:131]
  s_add_u32 m0, s88, s28
  ds_read_b128 a[0:3], v22 offset:0
  v_mfma_f32_16x16x32_bf16 v[136:139], a[64:67], a[24:27], v[136:139]
  buffer_load_dwordx4 v40, s[8:11], s24 offen offset:0 lds
  ds_read_b64_tr_b16 a[40:41], v26 offset:18432
  v_mfma_f32_16x16x32_bf16 v[144:147], a[64:67], a[28:31], v[144:147]
  s_mov_b32 m0, s88
  ds_read_b64_tr_b16 a[42:43], v26 offset:20480
  v_mfma_f32_16x16x32_bf16 v[152:155], a[64:67], a[32:35], v[152:155]
  ds_read_b128 a[4:7], v22 offset:2048
  v_mfma_f32_16x16x32_bf16 v[132:135], a[68:71], a[20:23], v[132:135]
  buffer_load_dwordx4 v36, s[8:11], s24 offen offset:0 lds
  ds_read_b128 a[8:11], v22 offset:4096
  v_mfma_f32_16x16x32_bf16 v[140:143], a[68:71], a[24:27], v[140:143]
  ds_read_b128 a[12:15], v22 offset:6144
  v_mfma_f32_16x16x32_bf16 v[148:151], a[68:71], a[28:31], v[148:151]
  ds_read_b64_tr_b16 a[44:45], v27 offset:18432
  v_mfma_f32_16x16x32_bf16 v[156:159], a[68:71], a[32:35], v[156:159]
  ds_read_b64_tr_b16 a[46:47], v27 offset:20480
  v_mfma_f32_16x16x32_bf16 v[160:163], a[72:75], a[20:23], v[160:163]
  buffer_load_dwordx4 v37, s[8:11], s24 offen offset:1024 lds
  ds_read_b64_tr_b16 a[48:49], v26 offset:26624
  v_mfma_f32_16x16x32_bf16 v[168:171], a[72:75], a[24:27], v[168:171]
  ds_read_b64_tr_b16 a[50:51], v26 offset:28672
  v_mfma_f32_16x16x32_bf16 v[176:179], a[72:75], a[28:31], v[176:179]
  ds_read_b128 a[16:19], v24 offset:0
  v_mfma_f32_16x16x32_bf16 v[184:187], a[72:75], a[32:35], v[184:187]
  ds_read_b64_tr_b16 a[52:53], v27 offset:26624
  v_mfma_f32_16x16x32_bf16 v[224:227], a[72:75], a[36:39], v[224:227]
  buffer_load_dwordx4 v38, s[8:11], s24 offen offset:2048 lds
  ds_read_b64_tr_b16 a[54:55], v27 offset:28672
  v_mfma_f32_16x16x32_bf16 v[164:167], a[76:79], a[20:23], v[164:167]
  ds_read_b64_tr_b16 a[56:57], v26 offset:34816
  v_mfma_f32_16x16x32_bf16 v[172:175], a[76:79], a[24:27], v[172:175]
  ds_read_b64_tr_b16 a[58:59], v26 offset:36864
  v_mfma_f32_16x16x32_bf16 v[180:183], a[76:79], a[28:31], v[180:183]
  ds_read_b64_tr_b16 a[60:61], v27 offset:34816
  v_mfma_f32_16x16x32_bf16 v[188:191], a[76:79], a[32:35], v[188:191]
  buffer_load_dwordx4 v39, s[8:11], s24 offen offset:3072 lds
  ds_read_b64_tr_b16 a[62:63], v27 offset:36864
  v_mfma_f32_16x16x32_bf16 v[228:231], a[76:79], a[36:39], v[228:231]
  s_add_u32 s24, s24, 128
  s_add_u32 m0, s88, s26
  v_mfma_f32_16x16x32_bf16 v[192:195], a[20:23], a[80:83], v[192:195]
  v_mfma_f32_16x16x32_bf16 v[200:203], a[24:27], a[80:83], v[200:203]
  v_mfma_f32_16x16x32_bf16 v[208:211], a[28:31], a[80:83], v[208:211]
  buffer_load_dwordx4 v8, s[20:23], s25 offen offset:0 lds
  v_mfma_f32_16x16x32_bf16 v[216:219], a[32:35], a[80:83], v[216:219]
  v_mfma_f32_16x16x32_bf16 v[196:199], a[20:23], a[84:87], v[196:199]
  v_mfma_f32_16x16x32_bf16 v[204:207], a[24:27], a[84:87], v[204:207]
  v_mfma_f32_16x16x32_bf16 v[212:215], a[28:31], a[84:87], v[212:215]
  v_mfma_f32_16x16x32_bf16 v[220:223], a[32:35], a[84:87], v[220:223]
  s_waitcnt lgkmcnt(0)
  v_mfma_f32_16x16x32_bf16 v[128:131], a[40:43], a[0:3], v[128:131]
  buffer_load_dwordx4 v9, s[20:23], s25 offen offset:1024 lds
  ds_read_b128 a[20:23], v23 offset:0
  v_mfma_f32_16x16x32_bf16 v[136:139], a[40:43], a[4:7], v[136:139]
  ds_read_b64_tr_b16 a[64:65], v26 offset:22528
  v_mfma_f32_16x16x32_bf16 v[144:147], a[40:43], a[8:11], v[144:147]
  ds_read_b64_tr_b16 a[66:67], v26 offset:24576
  v_mfma_f32_16x16x32_bf16 v[152:155], a[40:43], a[12:15], v[152:155]
  buffer_load_dwordx4 v10, s[20:23], s25 offen offset:2048 lds
  ds_read_b128 a[24:27], v23 offset:2048
  v_mfma_f32_16x16x32_bf16 v[132:135], a[44:47], a[0:3], v[132:135]
  s_add_u32 m0, s88, s27
  ds_read_b128 a[28:31], v23 offset:4096
  v_mfma_f32_16x16x32_bf16 v[140:143], a[44:47], a[4:7], v[140:143]
  ds_read_b128 a[32:35], v23 offset:6144
  v_mfma_f32_16x16x32_bf16 v[148:151], a[44:47], a[8:11], v[148:151]
  ds_read_b64_tr_b16 a[68:69], v27 offset:22528
  v_mfma_f32_16x16x32_bf16 v[156:159], a[44:47], a[12:15], v[156:159]
  buffer_load_dwordx4 v11, s[20:23], s25 offen offset:0 lds
  ds_read_b64_tr_b16 a[70:71], v27 offset:24576
  v_mfma_f32_16x16x32_bf16 v[160:163], a[48:51], a[0:3], v[160:163]
  ds_read_b64_tr_b16 a[72:73], v26 offset:30720
  v_mfma_f32_16x16x32_bf16 v[168:171], a[48:51], a[4:7], v[168:171]
  ds_read_b64_tr_b16 a[74:75], v26 offset:32768
  v_mfma_f32_16x16x32_bf16 v[176:179], a[48:51], a[8:11], v[176:179]
  ds_read_b128 a[36:39], v25 offset:0
  v_mfma_f32_16x16x32_bf16 v[184:187], a[48:51], a[12:15], v[184:187]
  buffer_load_dwordx4 v12, s[20:23], s25 offen offset:1024 lds
  ds_read_b64_tr_b16 a[76:77], v27 offset:30720
  v_mfma_f32_16x16x32_bf16 v[224:227], a[48:51], a[16:19], v[224:227]
  ds_read_b64_tr_b16 a[78:79], v27 offset:32768
  v_mfma_f32_16x16x32_bf16 v[164:167], a[52:55], a[0:3], v[164:167]
  ds_read_b64_tr_b16 a[80:81], v26 offset:38912
  v_mfma_f32_16x16x32_bf16 v[172:175], a[52:55], a[4:7], v[172:175]
  ds_read_b64_tr_b16 a[82:83], v26 offset:40960
  v_mfma_f32_16x16x32_bf16 v[180:183], a[52:55], a[8:11], v[180:183]
  buffer_load_dwordx4 v13, s[20:23], s25 offen offset:2048 lds
  ds_read_b64_tr_b16 a[84:85], v27 offset:38912
  v_mfma_f32_16x16x32_bf16 v[188:191], a[52:55], a[12:15], v[188:191]
  s_add_u32 s25, s25, 393216
  ds_read_b64_tr_b16 a[86:87], v27 offset:40960
  v_mfma_f32_16x16x32_bf16 v[228:231], a[52:55], a[16:19], v[228:231]
  s_add_u32 s88, s88, s90
  s_add_u32 s89, s89, 1
  s_cmp_eq_u32 s89, 3
  s_cselect_b32 s89, 0, s89
  s_cselect_b32 s90, s91, s92
  v_mfma_f32_16x16x32_bf16 v[192:195], a[0:3], a[56:59], v[192:195]
  v_add_u32 v22, s90, v22
  v_add_u32 v23, s90, v23
  v_mfma_f32_16x16x32_bf16 v[200:203], a[4:7], a[56:59], v[200:203]
  v_add_u32 v24, s90, v24
  v_add_u32 v25, s90, v25
  v_mfma_f32_16x16x32_bf16 v[208:211], a[8:11], a[56:59], v[208:211]
  v_add_u32 v26, s90, v26
  v_add_u32 v27, s90, v27
  v_mfma_f32_16x16x32_bf16 v[216:219], a[12:15], a[56:59], v[216:219]
  v_mfma_f32_16x16x32_bf16 v[196:199], a[0:3], a[60:63], v[196:199]
  v_mfma_f32_16x16x32_bf16 v[204:207], a[4:7], a[60:63], v[204:207]
  v_mfma_f32_16x16x32_bf16 v[212:215], a[8:11], a[60:63], v[212:215]
  v_mfma_f32_16x16x32_bf16 v[220:223], a[12:15], a[60:63], v[220:223]
  s_mov_b32 s35, 10
  .p2align 6
Lp2r0_loop:
  s_waitcnt vmcnt(11) lgkmcnt(0)
  s_barrier
  v_mfma_f32_16x16x32_bf16 v[128:131], a[64:67], a[20:23], v[128:131]
  s_add_u32 m0, s88, s28
  ds_read_b128 a[0:3], v22 offset:0
  v_mfma_f32_16x16x32_bf16 v[136:139], a[64:67], a[24:27], v[136:139]
  buffer_load_dwordx4 v40, s[8:11], s24 offen offset:0 lds
  ds_read_b64_tr_b16 a[40:41], v26 offset:18432
  v_mfma_f32_16x16x32_bf16 v[144:147], a[64:67], a[28:31], v[144:147]
  s_mov_b32 m0, s88
  ds_read_b64_tr_b16 a[42:43], v26 offset:20480
  v_mfma_f32_16x16x32_bf16 v[152:155], a[64:67], a[32:35], v[152:155]
  ds_read_b128 a[4:7], v22 offset:2048
  v_mfma_f32_16x16x32_bf16 v[132:135], a[68:71], a[20:23], v[132:135]
  buffer_load_dwordx4 v36, s[8:11], s24 offen offset:0 lds
  ds_read_b128 a[8:11], v22 offset:4096
  v_mfma_f32_16x16x32_bf16 v[140:143], a[68:71], a[24:27], v[140:143]
  ds_read_b128 a[12:15], v22 offset:6144
  v_mfma_f32_16x16x32_bf16 v[148:151], a[68:71], a[28:31], v[148:151]
  ds_read_b64_tr_b16 a[44:45], v27 offset:18432
  v_mfma_f32_16x16x32_bf16 v[156:159], a[68:71], a[32:35], v[156:159]
  ds_read_b64_tr_b16 a[46:47], v27 offset:20480
  v_mfma_f32_16x16x32_bf16 v[160:163], a[72:75], a[20:23], v[160:163]
  buffer_load_dwordx4 v37, s[8:11], s24 offen offset:1024 lds
  ds_read_b64_tr_b16 a[48:49], v26 offset:26624
  v_mfma_f32_16x16x32_bf16 v[168:171], a[72:75], a[24:27], v[168:171]
  ds_read_b64_tr_b16 a[50:51], v26 offset:28672
  v_mfma_f32_16x16x32_bf16 v[176:179], a[72:75], a[28:31], v[176:179]
  ds_read_b128 a[16:19], v24 offset:0
  v_mfma_f32_16x16x32_bf16 v[184:187], a[72:75], a[32:35], v[184:187]
  ds_read_b64_tr_b16 a[52:53], v27 offset:26624
  v_mfma_f32_16x16x32_bf16 v[224:227], a[72:75], a[36:39], v[224:227]
  buffer_load_dwordx4 v38, s[8:11], s24 offen offset:2048 lds
  ds_read_b64_tr_b16 a[54:55], v27 offset:28672
  v_mfma_f32_16x16x32_bf16 v[164:167], a[76:79], a[20:23], v[164:167]
  ds_read_b64_tr_b16 a[56:57], v26 offset:34816
  v_mfma_f32_16x16x32_bf16 v[172:175], a[76:79], a[24:27], v[172:175]
  ds_read_b64_tr_b16 a[58:59], v26 offset:36864
  v_mfma_f32_16x16x32_bf16 v[180:183], a[76:79], a[28:31], v[180:183]
  ds_read_b64_tr_b16 a[60:61], v27 offset:34816
  v_mfma_f32_16x16x32_bf16 v[188:191], a[76:79], a[32:35], v[188:191]
  buffer_load_dwordx4 v39, s[8:11], s24 offen offset:3072 lds
  ds_read_b64_tr_b16 a[62:63], v27 offset:36864
  v_mfma_f32_16x16x32_bf16 v[228:231], a[76:79], a[36:39], v[228:231]
  s_add_u32 s24, s24, 128
  s_add_u32 m0, s88, s26
  v_mfma_f32_16x16x32_bf16 v[192:195], a[20:23], a[80:83], v[192:195]
  v_mfma_f32_16x16x32_bf16 v[200:203], a[24:27], a[80:83], v[200:203]
  v_mfma_f32_16x16x32_bf16 v[208:211], a[28:31], a[80:83], v[208:211]
  buffer_load_dwordx4 v8, s[20:23], s25 offen offset:0 lds
  v_mfma_f32_16x16x32_bf16 v[216:219], a[32:35], a[80:83], v[216:219]
  v_mfma_f32_16x16x32_bf16 v[196:199], a[20:23], a[84:87], v[196:199]
  v_mfma_f32_16x16x32_bf16 v[204:207], a[24:27], a[84:87], v[204:207]
  v_mfma_f32_16x16x32_bf16 v[212:215], a[28:31], a[84:87], v[212:215]
  v_mfma_f32_16x16x32_bf16 v[220:223], a[32:35], a[84:87], v[220:223]
  s_waitcnt lgkmcnt(0)
  v_mfma_f32_16x16x32_bf16 v[128:131], a[40:43], a[0:3], v[128:131]
  buffer_load_dwordx4 v9, s[20:23], s25 offen offset:1024 lds
  ds_read_b128 a[20:23], v23 offset:0
  v_mfma_f32_16x16x32_bf16 v[136:139], a[40:43], a[4:7], v[136:139]
  ds_read_b64_tr_b16 a[64:65], v26 offset:22528
  v_mfma_f32_16x16x32_bf16 v[144:147], a[40:43], a[8:11], v[144:147]
  ds_read_b64_tr_b16 a[66:67], v26 offset:24576
  v_mfma_f32_16x16x32_bf16 v[152:155], a[40:43], a[12:15], v[152:155]
  buffer_load_dwordx4 v10, s[20:23], s25 offen offset:2048 lds
  ds_read_b128 a[24:27], v23 offset:2048
  v_mfma_f32_16x16x32_bf16 v[132:135], a[44:47], a[0:3], v[132:135]
  s_add_u32 m0, s88, s27
  ds_read_b128 a[28:31], v23 offset:4096
  v_mfma_f32_16x16x32_bf16 v[140:143], a[44:47], a[4:7], v[140:143]
  ds_read_b128 a[32:35], v23 offset:6144
  v_mfma_f32_16x16x32_bf16 v[148:151], a[44:47], a[8:11], v[148:151]
  ds_read_b64_tr_b16 a[68:69], v27 offset:22528
  v_mfma_f32_16x16x32_bf16 v[156:159], a[44:47], a[12:15], v[156:159]
  buffer_load_dwordx4 v11, s[20:23], s25 offen offset:0 lds
  ds_read_b64_tr_b16 a[70:71], v27 offset:24576
  v_mfma_f32_16x16x32_bf16 v[160:163], a[48:51], a[0:3], v[160:163]
  ds_read_b64_tr_b16 a[72:73], v26 offset:30720
  v_mfma_f32_16x16x32_bf16 v[168:171], a[48:51], a[4:7], v[168:171]
  ds_read_b64_tr_b16 a[74:75], v26 offset:32768
  v_mfma_f32_16x16x32_bf16 v[176:179], a[48:51], a[8:11], v[176:179]
  ds_read_b128 a[36:39], v25 offset:0
  v_mfma_f32_16x16x32_bf16 v[184:187], a[48:51], a[12:15], v[184:187]
  buffer_load_dwordx4 v12, s[20:23], s25 offen offset:1024 lds
  ds_read_b64_tr_b16 a[76:77], v27 offset:30720
  v_mfma_f32_16x16x32_bf16 v[224:227], a[48:51], a[16:19], v[224:227]
  ds_read_b64_tr_b16 a[78:79], v27 offset:32768
  v_mfma_f32_16x16x32_bf16 v[164:167], a[52:55], a[0:3], v[164:167]
  ds_read_b64_tr_b16 a[80:81], v26 offset:38912
  v_mfma_f32_16x16x32_bf16 v[172:175], a[52:55], a[4:7], v[172:175]
  ds_read_b64_tr_b16 a[82:83], v26 offset:40960
  v_mfma_f32_16x16x32_bf16 v[180:183], a[52:55], a[8:11], v[180:183]
  buffer_load_dwordx4 v13, s[20:23], s25 offen offset:2048 lds
  ds_read_b64_tr_b16 a[84:85], v27 offset:38912
  v_mfma_f32_16x16x32_bf16 v[188:191], a[52:55], a[12:15], v[188:191]
  s_add_u32 s25, s25, 393216
  ds_read_b64_tr_b16 a[86:87], v27 offset:40960
  v_mfma_f32_16x16x32_bf16 v[228:231], a[52:55], a[16:19], v[228:231]
  s_add_u32 s88, s88, s90
  s_add_u32 s89, s89, 1
  s_cmp_eq_u32 s89, 3
  s_cselect_b32 s89, 0, s89
  s_cselect_b32 s90, s91, s92
  v_mfma_f32_16x16x32_bf16 v[192:195], a[0:3], a[56:59], v[192:195]
  v_add_u32 v22, s90, v22
  v_add_u32 v23, s90, v23
  v_mfma_f32_16x16x32_bf16 v[200:203], a[4:7], a[56:59], v[200:203]
  v_add_u32 v24, s90, v24
  v_add_u32 v25, s90, v25
  v_mfma_f32_16x16x32_bf16 v[208:211], a[8:11], a[56:59], v[208:211]
  v_add_u32 v26, s90, v26
  v_add_u32 v27, s90, v27
  v_mfma_f32_16x16x32_bf16 v[216:219], a[12:15], a[56:59], v[216:219]
  v_mfma_f32_16x16x32_bf16 v[196:199], a[0:3], a[60:63], v[196:199]
  v_mfma_f32_16x16x32_bf16 v[204:207], a[4:7], a[60:63], v[204:207]
  v_mfma_f32_16x16x32_bf16 v[212:215], a[8:11], a[60:63], v[212:215]
  s_sub_u32 s35, s35, 1
  v_mfma_f32_16x16x32_bf16 v[220:223], a[12:15], a[60:63], v[220:223]
  s_cmp_lg_u32 s35, 0
  s_cbranch_scc1 Lp2r0_loop
  s_waitcnt vmcnt(11) lgkmcnt(0)
  s_barrier
  s_and_b32 s24, s2, 7
  s_lshr_b32 s4, s2, 6
  s_lshl_b32 s4, s4, 3
  s_add_u32 s24, s24, s4
  s_lshr_b32 s25, s2, 3
  s_and_b32 s25, s25, 7
  s_lshr_b32 s34, s24, 1
  s_lshl_b32 s34, s34, 11
  v_and_b32 v3, 15, v1
  v_lshlrev_b32 v3, 7, v3
  v_mfma_f32_16x16x32_bf16 v[128:131], a[64:67], a[20:23], v[128:131]
  buffer_load_dwordx2 v[4:5], v3, s[96:99], s34 offen sc1
  ds_read_b128 a[0:3], v22 offset:0
  v_mfma_f32_16x16x32_bf16 v[136:139], a[64:67], a[24:27], v[136:139]
  ds_read_b64_tr_b16 a[40:41], v26 offset:18432
  v_mfma_f32_16x16x32_bf16 v[144:147], a[64:67], a[28:31], v[144:147]
  ds_read_b64_tr_b16 a[42:43], v26 offset:20480
  v_mfma_f32_16x16x32_bf16 v[152:155], a[64:67], a[32:35], v[152:155]
  ds_read_b128 a[4:7], v22 offset:2048
  v_mfma_f32_16x16x32_bf16 v[132:135], a[68:71], a[20:23], v[132:135]
  ds_read_b128 a[8:11], v22 offset:4096
  v_mfma_f32_16x16x32_bf16 v[140:143], a[68:71], a[24:27], v[140:143]
  ds_read_b128 a[12:15], v22 offset:6144
  v_mfma_f32_16x16x32_bf16 v[148:151], a[68:71], a[28:31], v[148:151]
  ds_read_b64_tr_b16 a[44:45], v27 offset:18432
  v_mfma_f32_16x16x32_bf16 v[156:159], a[68:71], a[32:35], v[156:159]
  ds_read_b64_tr_b16 a[46:47], v27 offset:20480
  v_mfma_f32_16x16x32_bf16 v[160:163], a[72:75], a[20:23], v[160:163]
  ds_read_b64_tr_b16 a[48:49], v26 offset:26624
  v_mfma_f32_16x16x32_bf16 v[168:171], a[72:75], a[24:27], v[168:171]
  ds_read_b64_tr_b16 a[50:51], v26 offset:28672
  v_mfma_f32_16x16x32_bf16 v[176:179], a[72:75], a[28:31], v[176:179]
  ds_read_b128 a[16:19], v24 offset:0
  v_mfma_f32_16x16x32_bf16 v[184:187], a[72:75], a[32:35], v[184:187]
  ds_read_b64_tr_b16 a[52:53], v27 offset:26624
  v_mfma_f32_16x16x32_bf16 v[224:227], a[72:75], a[36:39], v[224:227]
  ds_read_b64_tr_b16 a[54:55], v27 offset:28672
  v_mfma_f32_16x16x32_bf16 v[164:167], a[76:79], a[20:23], v[164:167]
  ds_read_b64_tr_b16 a[56:57], v26 offset:34816
  v_mfma_f32_16x16x32_bf16 v[172:175], a[76:79], a[24:27], v[172:175]
  ds_read_b64_tr_b16 a[58:59], v26 offset:36864
  v_mfma_f32_16x16x32_bf16 v[180:183], a[76:79], a[28:31], v[180:183]
  ds_read_b64_tr_b16 a[60:61], v27 offset:34816
  v_mfma_f32_16x16x32_bf16 v[188:191], a[76:79], a[32:35], v[188:191]
  ds_read_b64_tr_b16 a[62:63], v27 offset:36864
  v_mfma_f32_16x16x32_bf16 v[228:231], a[76:79], a[36:39], v[228:231]
  v_mfma_f32_16x16x32_bf16 v[192:195], a[20:23], a[80:83], v[192:195]
  v_mfma_f32_16x16x32_bf16 v[200:203], a[24:27], a[80:83], v[200:203]
  v_mfma_f32_16x16x32_bf16 v[208:211], a[28:31], a[80:83], v[208:211]
  v_mfma_f32_16x16x32_bf16 v[216:219], a[32:35], a[80:83], v[216:219]
  v_mfma_f32_16x16x32_bf16 v[196:199], a[20:23], a[84:87], v[196:199]
  v_mfma_f32_16x16x32_bf16 v[204:207], a[24:27], a[84:87], v[204:207]
  v_mfma_f32_16x16x32_bf16 v[212:215], a[28:31], a[84:87], v[212:215]
  v_mfma_f32_16x16x32_bf16 v[220:223], a[32:35], a[84:87], v[220:223]
  s_waitcnt lgkmcnt(0)
  v_mfma_f32_16x16x32_bf16 v[128:131], a[40:43], a[0:3], v[128:131]
  s_add_u32 s88, s88, s90
  s_add_u32 s89, s89, 1
  ds_read_b128 a[20:23], v23 offset:0
  v_mfma_f32_16x16x32_bf16 v[136:139], a[40:43], a[4:7], v[136:139]
  s_cmp_eq_u32 s89, 3
  s_cselect_b32 s89, 0, s89
  s_cselect_b32 s90, s91, s92
  ds_read_b64_tr_b16 a[64:65], v26 offset:22528
  v_mfma_f32_16x16x32_bf16 v[144:147], a[40:43], a[8:11], v[144:147]
  ds_read_b64_tr_b16 a[66:67], v26 offset:24576
  v_mfma_f32_16x16x32_bf16 v[152:155], a[40:43], a[12:15], v[152:155]
  ds_read_b128 a[24:27], v23 offset:2048
  v_mfma_f32_16x16x32_bf16 v[132:135], a[44:47], a[0:3], v[132:135]
  ds_read_b128 a[28:31], v23 offset:4096
  v_mfma_f32_16x16x32_bf16 v[140:143], a[44:47], a[4:7], v[140:143]
  ds_read_b128 a[32:35], v23 offset:6144
  v_mfma_f32_16x16x32_bf16 v[148:151], a[44:47], a[8:11], v[148:151]
  ds_read_b64_tr_b16 a[68:69], v27 offset:22528
  v_mfma_f32_16x16x32_bf16 v[156:159], a[44:47], a[12:15], v[156:159]
  ds_read_b64_tr_b16 a[70:71], v27 offset:24576
  v_mfma_f32_16x16x32_bf16 v[160:163], a[48:51], a[0:3], v[160:163]
  ds_read_b64_tr_b16 a[72:73], v26 offset:30720
  v_mfma_f32_16x16x32_bf16 v[168:171], a[48:51], a[4:7], v[168:171]
  ds_read_b64_tr_b16 a[74:75], v26 offset:32768
  v_mfma_f32_16x16x32_bf16 v[176:179], a[48:51], a[8:11], v[176:179]
  ds_read_b128 a[36:39], v25 offset:0
  v_mfma_f32_16x16x32_bf16 v[184:187], a[48:51], a[12:15], v[184:187]
  ds_read_b64_tr_b16 a[76:77], v27 offset:30720
  v_mfma_f32_16x16x32_bf16 v[224:227], a[48:51], a[16:19], v[224:227]
  ds_read_b64_tr_b16 a[78:79], v27 offset:32768
  v_mfma_f32_16x16x32_bf16 v[164:167], a[52:55], a[0:3], v[164:167]
  ds_read_b64_tr_b16 a[80:81], v26 offset:38912
  v_mfma_f32_16x16x32_bf16 v[172:175], a[52:55], a[4:7], v[172:175]
  ds_read_b64_tr_b16 a[82:83], v26 offset:40960
  v_mfma_f32_16x16x32_bf16 v[180:183], a[52:55], a[8:11], v[180:183]
  ds_read_b64_tr_b16 a[84:85], v27 offset:38912
  v_mfma_f32_16x16x32_bf16 v[188:191], a[52:55], a[12:15], v[188:191]
  ds_read_b64_tr_b16 a[86:87], v27 offset:40960
  v_mfma_f32_16x16x32_bf16 v[228:231], a[52:55], a[16:19], v[228:231]
  v_add_u32 v22, s90, v22
  v_add_u32 v23, s90, v23
  v_mfma_f32_16x16x32_bf16 v[192:195], a[0:3], a[56:59], v[192:195]
  v_add_u32 v24, s90, v24
  v_add_u32 v25, s90, v25
  v_mfma_f32_16x16x32_bf16 v[200:203], a[4:7], a[56:59], v[200:203]
  v_add_u32 v26, s90, v26
  v_add_u32 v27, s90, v27
  v_mfma_f32_16x16x32_bf16 v[208:211], a[8:11], a[56:59], v[208:211]
  v_mfma_f32_16x16x32_bf16 v[216:219], a[12:15], a[56:59], v[216:219]
  v_mfma_f32_16x16x32_bf16 v[196:199], a[0:3], a[60:63], v[196:199]
  v_mfma_f32_16x16x32_bf16 v[204:207], a[4:7], a[60:63], v[204:207]
  v_mfma_f32_16x16x32_bf16 v[212:215], a[8:11], a[60:63], v[212:215]
  v_mfma_f32_16x16x32_bf16 v[220:223], a[12:15], a[60:63], v[220:223]
  s_waitcnt vmcnt(0) lgkmcnt(0)
  s_barrier
  s_mov_b32 s5, 0x40000
Lpoll_11:
  v_cmp_ne_u64 vcc, s[94:95], v[4:5]
  s_nop 0
  s_cbranch_vccz Lpolld_12
  s_sleep 4
  buffer_load_dwordx2 v[4:5], v3, s[96:99], s34 offen sc1
  s_sub_u32 s5, s5, 1
  s_waitcnt vmcnt(0)
  s_cbranch_scc0 Lpoll_11
Lpolld_12:
  s_lshl_b32 s4, s24, 20
  s_lshl_b32 s5, s25, 16
  s_sub_u32 s5, 1048576, s5
  s_add_u32 s20, s86, 16777216
  s_addc_u32 s21, s87, 0
  s_add_u32 s20, s20, s4
  s_addc_u32 s21, s21, 0
  s_mov_b32 s22, s5
  s_mov_b32 s23, 0x00020000
  s_lshl_b32 s26, s3, 12
  s_add_u32 s27, s26, 0x18000
  s_mov_b32 s28, s26
  s_add_u32 s29, s26, 0x4000
  s_mov_b32 s8, s86
  s_mov_b32 s9, s87
  s_mov_b32 s10, 16777216
  s_mov_b32 s11, 0x00020000
  s_lshl_b32 s4, s24, 15
  s_lshl_b32 s5, s3, 13
  s_add_u32 s4, s4, s5
  s_lshl_b32 s5, s25, 20
  s_add_u32 s6, s4, s5
  s_sub_u32 s7, s4, s5
  s_add_u32 s7, s7, 15728640
  v_mfma_f32_16x16x32_bf16 v[128:131], a[64:67], a[20:23], v[128:131]
  s_mov_b32 m0, s26
  ds_read_b128 a[0:3], v22 offset:0
  v_mfma_f32_16x16x32_bf16 v[136:139], a[64:67], a[24:27], v[136:139]
  buffer_load_dwordx4 v2, s[20:23], s28 offen offset:0 lds
  ds_read_b64_tr_b16 a[40:41], v26 offset:18432
  v_mfma_f32_16x16x32_bf16 v[144:147], a[64:67], a[28:31], v[144:147]
  buffer_load_dwordx4 v2, s[20:23], s28 offen offset:1024 lds
  ds_read_b64_tr_b16 a[42:43], v26 offset:20480
  v_mfma_f32_16x16x32_bf16 v[152:155], a[64:67], a[32:35], v[152:155]
  ds_read_b128 a[4:7], v22 offset:2048
  v_mfma_f32_16x16x32_bf16 v[132:135], a[68:71], a[20:23], v[132:135]
  ds_read_b128 a[8:11], v22 offset:4096
  v_mfma_f32_16x16x32_bf16 v[140:143], a[68:71], a[24:27], v[140:143]
  buffer_load_dwordx4 v2, s[20:23], s28 offen offset:2048 lds
  ds_read_b128 a[12:15], v22 offset:6144
  v_mfma_f32_16x16x32_bf16 v[148:151], a[68:71], a[28:31], v[148:151]
  ds_read_b64_tr_b16 a[44:45], v27 offset:18432
  v_mfma_f32_16x16x32_bf16 v[156:159], a[68:71], a[32:35], v[156:159]
  buffer_load_dwordx4 v2, s[20:23], s28 offen offset:3072 lds
  ds_read_b64_tr_b16 a[46:47], v27 offset:20480
  v_mfma_f32_16x16x32_bf16 v[160:163], a[72:75], a[20:23], v[160:163]
  s_xor_b32 s26, s26, 0x4000
  s_add_u32 s28, s28, 0x8000
  s_add_u32 s5, s6, 0
  v_mfma_f32_16x16x32_bf16 v[168:171], a[72:75], a[24:27], v[168:171]
  ds_read_b64_tr_b16 a[48:49], v26 offset:26624
  ds_read_b64_tr_b16 a[50:51], v26 offset:28672
  v_mfma_f32_16x16x32_bf16 v[176:179], a[72:75], a[28:31], v[176:179]
  buffer_load_dwordx4 a[128:131], v2, s[8:11], s5 offen offset:0 sc1
  ds_read_b128 a[16:19], v24 offset:0
  v_mfma_f32_16x16x32_bf16 v[184:187], a[72:75], a[32:35], v[184:187]
  ds_read_b64_tr_b16 a[52:53], v27 offset:26624
  v_mfma_f32_16x16x32_bf16 v[224:227], a[72:75], a[36:39], v[224:227]
  buffer_load_dwordx4 a[132:135], v2, s[8:11], s5 offen offset:1024 sc1
  ds_read_b64_tr_b16 a[54:55], v27 offset:28672
  v_mfma_f32_16x16x32_bf16 v[164:167], a[76:79], a[20:23], v[164:167]
  ds_read_b64_tr_b16 a[56:57], v26 offset:34816
  v_mfma_f32_16x16x32_bf16 v[172:175], a[76:79], a[24:27], v[172:175]
  ds_read_b64_tr_b16 a[58:59], v26 offset:36864
  v_mfma_f32_16x16x32_bf16 v[180:183], a[76:79], a[28:31], v[180:183]
  buffer_load_dwordx4 a[136:139], v2, s[8:11], s5 offen offset:2048 sc1
  ds_read_b64_tr_b16 a[60:61], v27 offset:34816
  v_mfma_f32_16x16x32_bf16 v[188:191], a[76:79], a[32:35], v[188:191]
  ds_read_b64_tr_b16 a[62:63], v27 offset:36864
  v_mfma_f32_16x16x32_bf16 v[228:231], a[76:79], a[36:39], v[228:231]
  buffer_load_dwordx4 a[140:143], v2, s[8:11], s5 offen offset:3072 sc1
  v_mfma_f32_16x16x32_bf16 v[192:195], a[20:23], a[80:83], v[192:195]
  s_add_u32 s5, s6, 4096
  v_mfma_f32_16x16x32_bf16 v[200:203], a[24:27], a[80:83], v[200:203]
  v_mfma_f32_16x16x32_bf16 v[208:211], a[28:31], a[80:83], v[208:211]
  buffer_load_dwordx4 a[144:147], v2, s[8:11], s5 offen offset:0 sc1
  v_mfma_f32_16x16x32_bf16 v[216:219], a[32:35], a[80:83], v[216:219]
  v_mfma_f32_16x16x32_bf16 v[196:199], a[20:23], a[84:87], v[196:199]
  buffer_load_dwordx4 a[148:151], v2, s[8:11], s5 offen offset:1024 sc1
  v_mfma_f32_16x16x32_bf16 v[204:207], a[24:27], a[84:87], v[204:207]
  v_mfma_f32_16x16x32_bf16 v[212:215], a[28:31], a[84:87], v[212:215]
  v_mfma_f32_16x16x32_bf16 v[220:223], a[32:35], a[84:87], v[220:223]
  s_waitcnt lgkmcnt(0)
  v_mfma_f32_16x16x32_bf16 v[128:131], a[40:43], a[0:3], v[128:131]
  buffer_load_dwordx4 a[152:155], v2, s[8:11], s5 offen offset:2048 sc1
  ds_read_b128 a[20:23], v23 offset:0
  v_mfma_f32_16x16x32_bf16 v[136:139], a[40:43], a[4:7], v[136:139]
  ds_read_b64_tr_b16 a[64:65], v26 offset:22528
  v_mfma_f32_16x16x32_bf16 v[144:147], a[40:43], a[8:11], v[144:147]
  buffer_load_dwordx4 a[156:159], v2, s[8:11], s5 offen offset:3072 sc1
  ds_read_b64_tr_b16 a[66:67], v26 offset:24576
  v_mfma_f32_16x16x32_bf16 v[152:155], a[40:43], a[12:15], v[152:155]
  s_add_u32 s5, s7, 0
  ds_read_b128 a[24:27], v23 offset:2048
  v_mfma_f32_16x16x32_bf16 v[132:135], a[44:47], a[0:3], v[132:135]
  ds_read_b128 a[28:31], v23 offset:4096
  v_mfma_f32_16x16x32_bf16 v[140:143], a[44:47], a[4:7], v[140:143]
  buffer_load_dwordx4 a[160:163], v2, s[8:11], s5 offen offset:0 sc1
  ds_read_b128 a[32:35], v23 offset:6144
  v_mfma_f32_16x16x32_bf16 v[148:151], a[44:47], a[8:11], v[148:151]
  ds_read_b64_tr_b16 a[68:69], v27 offset:22528
  v_mfma_f32_16x16x32_bf16 v[156:159], a[44:47], a[12:15], v[156:159]
  buffer_load_dwordx4 a[164:167], v2, s[8:11], s5 offen offset:1024 sc1
  ds_read_b64_tr_b16 a[70:71], v27 offset:24576
  v_mfma_f32_16x16x32_bf16 v[160:163], a[48:51], a[0:3], v[160:163]
  ds_read_b64_tr_b16 a[72:73], v26 offset:30720
  v_mfma_f32_16x16x32_bf16 v[168:171], a[48:51], a[4:7], v[168:171]
  ds_read_b64_tr_b16 a[74:75], v26 offset:32768
  v_mfma_f32_16x16x32_bf16 v[176:179], a[48:51], a[8:11], v[176:179]
  buffer_load_dwordx4 a[168:171], v2, s[8:11], s5 offen offset:2048 sc1
  ds_read_b128 a[36:39], v25 offset:0
  v_mfma_f32_16x16x32_bf16 v[184:187], a[48:51], a[12:15], v[184:187]
  ds_read_b64_tr_b16 a[76:77], v27 offset:30720
  v_mfma_f32_16x16x32_bf16 v[224:227], a[48:51], a[16:19], v[224:227]
  buffer_load_dwordx4 a[172:175], v2, s[8:11], s5 offen offset:3072 sc1
  ds_read_b64_tr_b16 a[78:79], v27 offset:32768
  v_mfma_f32_16x16x32_bf16 v[164:167], a[52:55], a[0:3], v[164:167]
  s_add_u32 s5, s7, 4096
  ds_read_b64_tr_b16 a[80:81], v26 offset:38912
  v_mfma_f32_16x16x32_bf16 v[172:175], a[52:55], a[4:7], v[172:175]
  ds_read_b64_tr_b16 a[82:83], v26 offset:40960
  v_mfma_f32_16x16x32_bf16 v[180:183], a[52:55], a[8:11], v[180:183]
  buffer_load_dwordx4 a[176:179], v2, s[8:11], s5 offen offset:0 sc1
  ds_read_b64_tr_b16 a[84:85], v27 offset:38912
  v_mfma_f32_16x16x32_bf16 v[188:191], a[52:55], a[12:15], v[188:191]
  ds_read_b64_tr_b16 a[86:87], v27 offset:40960
  v_mfma_f32_16x16x32_bf16 v[228:231], a[52:55], a[16:19], v[228:231]
  buffer_load_dwordx4 a[180:183], v2, s[8:11], s5 offen offset:1024 sc1
  v_mfma_f32_16x16x32_bf16 v[192:195], a[0:3], a[56:59], v[192:195]
  v_mfma_f32_16x16x32_bf16 v[200:203], a[4:7], a[56:59], v[200:203]
  v_mfma_f32_16x16x32_bf16 v[208:211], a[8:11], a[56:59], v[208:211]
  buffer_load_dwordx4 a[184:187], v2, s[8:11], s5 offen offset:2048 sc1
  v_mfma_f32_16x16x32_bf16 v[216:219], a[12:15], a[56:59], v[216:219]
  v_mfma_f32_16x16x32_bf16 v[196:199], a[0:3], a[60:63], v[196:199]
  buffer_load_dwordx4 a[188:191], v2, s[8:11], s5 offen offset:3072 sc1
  v_mfma_f32_16x16x32_bf16 v[204:207], a[4:7], a[60:63], v[204:207]
  v_mfma_f32_16x16x32_bf16 v[212:215], a[8:11], a[60:63], v[212:215]
  v_mfma_f32_16x16x32_bf16 v[220:223], a[12:15], a[60:63], v[220:223]
  s_waitcnt lgkmcnt(0)
  s_barrier
  v_mfma_f32_16x16x32_bf16 v[128:131], a[64:67], a[20:23], v[128:131]
  s_mov_b32 m0, s26
  v_mfma_f32_16x16x32_bf16 v[136:139], a[64:67], a[24:27], v[136:139]
  buffer_load_dwordx4 v2, s[20:23], s28 offen offset:0 lds
  v_mfma_f32_16x16x32_bf16 v[144:147], a[64:67], a[28:31], v[144:147]
  v_mfma_f32_16x16x32_bf16 v[152:155], a[64:67], a[32:35], v[152:155]
  buffer_load_dwordx4 v2, s[20:23], s28 offen offset:1024 lds
  v_mfma_f32_16x16x32_bf16 v[132:135], a[68:71], a[20:23], v[132:135]
  v_mfma_f32_16x16x32_bf16 v[140:143], a[68:71], a[24:27], v[140:143]
  v_mfma_f32_16x16x32_bf16 v[148:151], a[68:71], a[28:31], v[148:151]
  buffer_load_dwordx4 v2, s[20:23], s28 offen offset:2048 lds
  v_mfma_f32_16x16x32_bf16 v[156:159], a[68:71], a[32:35], v[156:159]
  v_mfma_f32_16x16x32_bf16 v[160:163], a[72:75], a[20:23], v[160:163]
  v_mfma_f32_16x16x32_bf16 v[168:171], a[72:75], a[24:27], v[168:171]
  buffer_load_dwordx4 v2, s[20:23], s28 offen offset:3072 lds
  v_mfma_f32_16x16x32_bf16 v[176:179], a[72:75], a[28:31], v[176:179]
  s_xor_b32 s26, s26, 0x8000
  s_add_u32 s28, s28, 0x8000
  s_mov_b32 m0, s27
  v_mfma_f32_16x16x32_bf16 v[184:187], a[72:75], a[32:35], v[184:187]
  v_mfma_f32_16x16x32_bf16 v[224:227], a[72:75], a[36:39], v[224:227]
  buffer_load_dwordx4 v2, s[20:23], s29 offen offset:0 lds
  v_mfma_f32_16x16x32_bf16 v[164:167], a[76:79], a[20:23], v[164:167]
  v_mfma_f32_16x16x32_bf16 v[172:175], a[76:79], a[24:27], v[172:175]
  v_mfma_f32_16x16x32_bf16 v[180:183], a[76:79], a[28:31], v[180:183]
  buffer_load_dwordx4 v2, s[20:23], s29 offen offset:1024 lds
  v_mfma_f32_16x16x32_bf16 v[188:191], a[76:79], a[32:35], v[188:191]
  v_mfma_f32_16x16x32_bf16 v[228:231], a[76:79], a[36:39], v[228:231]
  v_mfma_f32_16x16x32_bf16 v[192:195], a[20:23], a[80:83], v[192:195]
  buffer_load_dwordx4 v2, s[20:23], s29 offen offset:2048 lds
  v_mfma_f32_16x16x32_bf16 v[200:203], a[24:27], a[80:83], v[200:203]
  v_mfma_f32_16x16x32_bf16 v[208:211], a[28:31], a[80:83], v[208:211]
  v_mfma_f32_16x16x32_bf16 v[216:219], a[32:35], a[80:83], v[216:219]
  buffer_load_dwordx4 v2, s[20:23], s29 offen offset:3072 lds
  v_mfma_f32_16x16x32_bf16 v[196:199], a[20:23], a[84:87], v[196:199]
  s_xor_b32 s27, s27, 0x4000
  s_add_u32 s29, s29, 0x8000
  v_mfma_f32_16x16x32_bf16 v[204:207], a[24:27], a[84:87], v[204:207]
  v_mfma_f32_16x16x32_bf16 v[212:215], a[28:31], a[84:87], v[212:215]
  v_mfma_f32_16x16x32_bf16 v[220:223], a[32:35], a[84:87], v[220:223]
  s_and_b32 s4, s3, 1
  s_mul_i32 s4, s4, 3072
  s_add_u32 s4, s4, 32768
  v_add_u32 v116, s4, v2
  v_cvt_pk_bf16_f32 v80, v184, v185
  v_cvt_pk_bf16_f32 v81, v186, v187
  v_cvt_pk_bf16_f32 v92, v216, v217
  v_cvt_pk_bf16_f32 v93, v218, v219
  v_cvt_pk_bf16_f32 v82, v188, v189
  v_cvt_pk_bf16_f32 v83, v190, v191
  v_cvt_pk_bf16_f32 v102, v220, v221
  v_cvt_pk_bf16_f32 v103, v222, v223
  ds_write_b128 v116, v[80:83]
  ds_write_b64 v116, v[92:93] offset:1024
  ds_write_b64 v116, v[102:103] offset:1032
  v_and_b32 v117, 15, v1
  v_lshrrev_b32 v118, 4, v1
  v_lshlrev_b32 v118, 2, v118
  v_sub_u32 v117, v117, v118
  v_mov_b32 v118, 0xf149f2ca
  v_subrev_u32 v119, 0, v117
  v_and_b32 v104, 0x80000001, v119
  v_cmp_ne_u32 vcc, 0, v104
  s_nop 1
  v_cndmask_b32 v104, 0, v118, vcc
  v_add_u32 v119, 1, v119
  v_and_b32 v108, 0x80000001, v119
  v_cmp_ne_u32 vcc, 0x80000001, v108
  s_nop 1
  v_cndmask_b32 v108, 0, v118, vcc
  v_subrev_u32 v119, 1, v117
  v_and_b32 v105, 0x80000001, v119
  v_cmp_ne_u32 vcc, 0, v105
  s_nop 1
  v_cndmask_b32 v105, 0, v118, vcc
  v_add_u32 v119, 1, v119
  v_and_b32 v109, 0x80000001, v119
  v_cmp_ne_u32 vcc, 0x80000001, v109
  s_nop 1
  v_cndmask_b32 v109, 0, v118, vcc
  v_subrev_u32 v119, 2, v117
  v_and_b32 v106, 0x80000001, v119
  v_cmp_ne_u32 vcc, 0, v106
  s_nop 1
  v_cndmask_b32 v106, 0, v118, vcc
  v_add_u32 v119, 1, v119
  v_and_b32 v110, 0x80000001, v119
  v_cmp_ne_u32 vcc, 0x80000001, v110
  s_nop 1
  v_cndmask_b32 v110, 0, v118, vcc
  v_subrev_u32 v119, 3, v117
  v_and_b32 v107, 0x80000001, v119
  v_cmp_ne_u32 vcc, 0, v107
  s_nop 1
  v_cndmask_b32 v107, 0, v118, vcc
  v_add_u32 v119, 1, v119
  v_and_b32 v111, 0x80000001, v119
  v_cmp_ne_u32 vcc, 0x80000001, v111
  s_nop 1
  v_cndmask_b32 v111, 0, v118, vcc
  s_cmp_eq_u32 s32, 0
  s_cselect_b64 vcc, -1, 0
  v_cndmask_b32 v112, v108, v118, vcc
  v_cndmask_b32 v113, v109, v118, vcc
  v_cndmask_b32 v114, v110, v118, vcc
  v_cndmask_b32 v115, v111, v118, vcc
  s_mov_b32 s6, 0x3e8293ee
  s_mov_b32 s7, s6
  v_pk_mul_f32 v[128:129], v[128:129], s[6:7]
  v_pk_mul_f32 v[130:131], v[130:131], s[6:7]
  v_pk_mul_f32 v[132:133], v[132:133], s[6:7]
  v_pk_mul_f32 v[134:135], v[134:135], s[6:7]
  v_cvt_pk_bf16_f32 v48, v128, v129
  v_cvt_pk_bf16_f32 v49, v130, v131
  v_cvt_pk_bf16_f32 v50, v132, v133
  v_cvt_pk_bf16_f32 v51, v134, v135
  v_pk_mul_f32 v[136:137], v[136:137], s[6:7]
  v_pk_mul_f32 v[138:139], v[138:139], s[6:7]
  v_pk_mul_f32 v[140:141], v[140:141], s[6:7]
  v_pk_mul_f32 v[142:143], v[142:143], s[6:7]
  v_cvt_pk_bf16_f32 v52, v136, v137
  v_cvt_pk_bf16_f32 v53, v138, v139
  v_cvt_pk_bf16_f32 v54, v140, v141
  v_cvt_pk_bf16_f32 v55, v142, v143
  v_pk_mul_f32 v[144:145], v[144:145], s[6:7]
  v_pk_mul_f32 v[146:147], v[146:147], s[6:7]
  v_pk_mul_f32 v[148:149], v[148:149], s[6:7]
  v_pk_mul_f32 v[150:151], v[150:151], s[6:7]
  v_cvt_pk_bf16_f32 v56, v144, v145
  v_cvt_pk_bf16_f32 v57, v146, v147
  v_cvt_pk_bf16_f32 v58, v148, v149
  v_cvt_pk_bf16_f32 v59, v150, v151
  v_pk_mul_f32 v[152:153], v[152:153], s[6:7]
  v_pk_mul_f32 v[154:155], v[154:155], s[6:7]
  v_pk_mul_f32 v[156:157], v[156:157], s[6:7]
  v_pk_mul_f32 v[158:159], v[158:159], s[6:7]
  v_cvt_pk_bf16_f32 v60, v152, v153
  v_cvt_pk_bf16_f32 v61, v154, v155
  v_cvt_pk_bf16_f32 v62, v156, v157
  v_cvt_pk_bf16_f32 v63, v158, v159
  v_cvt_pk_bf16_f32 v68, v160, v161
  v_cvt_pk_bf16_f32 v69, v162, v163
  v_cvt_pk_bf16_f32 v86, v192, v193
  v_cvt_pk_bf16_f32 v87, v194, v195
  v_cvt_pk_bf16_f32 v70, v164, v165
  v_cvt_pk_bf16_f32 v71, v166, v167
  v_cvt_pk_bf16_f32 v96, v196, v197
  v_cvt_pk_bf16_f32 v97, v198, v199
  v_cvt_pk_bf16_f32 v72, v168, v169
  v_cvt_pk_bf16_f32 v73, v170, v171
  v_cvt_pk_bf16_f32 v88, v200, v201
  v_cvt_pk_bf16_f32 v89, v202, v203
  v_cvt_pk_bf16_f32 v74, v172, v173
  v_cvt_pk_bf16_f32 v75, v174, v175
  v_cvt_pk_bf16_f32 v98, v204, v205
  v_cvt_pk_bf16_f32 v99, v206, v207
  v_cvt_pk_bf16_f32 v76, v176, v177
  v_cvt_pk_bf16_f32 v77, v178, v179
  v_cvt_pk_bf16_f32 v90, v208, v209
  v_cvt_pk_bf16_f32 v91, v210, v211
  v_cvt_pk_bf16_f32 v78, v180, v181
  v_cvt_pk_bf16_f32 v79, v182, v183
  v_cvt_pk_bf16_f32 v100, v212, v213
  v_cvt_pk_bf16_f32 v101, v214, v215
  v_cvt_pk_bf16_f32 v64, v224, v225
  v_cvt_pk_bf16_f32 v65, v226, v227
  v_cvt_pk_bf16_f32 v66, v228, v229
  v_cvt_pk_bf16_f32 v67, v230, v231
  v_mov_b32 v120, 0x3f803f80
  v_mov_b32 v121, v120
  v_mov_b32 v122, v120
  v_mov_b32 v123, v120
  s_waitcnt lgkmcnt(0)
  s_barrier
  ds_read_b64 v[84:85], v116 offset:2048
  ds_read_b64 v[94:95], v116 offset:2056
  v_mfma_f32_16x16x32_bf16 v[40:43], v[76:79], v[60:63], v[108:111]
  v_mfma_f32_16x16x32_bf16 v[44:47], v[80:83], v[60:63], v[104:107]
  v_mfma_f32_16x16x32_bf16 v[32:35], v[72:75], v[56:59], v[108:111]
  v_mfma_f32_16x16x32_bf16 v[36:39], v[76:79], v[56:59], v[104:107]
  v_mfma_f32_16x16x32_bf16 v[24:27], v[68:71], v[52:55], v[108:111]
  v_mfma_f32_16x16x32_bf16 v[28:31], v[72:75], v[52:55], v[104:107]
  s_waitcnt lgkmcnt(0)
  v_mfma_f32_16x16x32_bf16 v[16:19], v[64:67], v[48:51], v[112:115]
  v_mfma_f32_16x16x32_bf16 v[20:23], v[68:71], v[48:51], v[104:107]
  v_max3_f32 v134, v40, v41, v42
  v_max3_f32 v135, v43, v44, v45
  v_max3_f32 v134, v134, v46, v47
  v_max_f32 v134, v134, v135
  v_max3_f32 v132, v32, v33, v34
  v_max3_f32 v133, v35, v36, v37
  v_max3_f32 v132, v132, v38, v39
  v_max_f32 v132, v132, v133
  v_max3_f32 v130, v24, v25, v26
  v_max3_f32 v131, v27, v28, v29
  v_max3_f32 v130, v130, v30, v31
  v_max_f32 v130, v130, v131
  v_max3_f32 v128, v16, v17, v18
  v_max3_f32 v129, v19, v20, v21
  v_max3_f32 v128, v128, v22, v23
  v_max_f32 v128, v128, v129
  v_mov_b32 v135, v134
  v_mov_b32 v133, v132
  v_mov_b32 v131, v130
  v_mov_b32 v129, v128
  v_permlane32_swap_b32 v134, v135
  v_permlane32_swap_b32 v132, v133
  v_permlane32_swap_b32 v130, v131
  v_permlane32_swap_b32 v128, v129
  v_max_f32 v134, v134, v135
  v_max_f32 v132, v132, v133
  v_max_f32 v130, v130, v131
  v_max_f32 v128, v128, v129
  v_mov_b32 v135, v134
  v_mov_b32 v133, v132
  v_mov_b32 v131, v130
  v_mov_b32 v129, v128
  v_permlane16_swap_b32 v134, v135
  v_permlane16_swap_b32 v132, v133
  v_permlane16_swap_b32 v130, v131
  v_permlane16_swap_b32 v128, v129
  v_max_f32 v134, v134, v135
  v_max_f32 v132, v132, v133
  v_max_f32 v130, v130, v131
  v_max_f32 v128, v128, v129
  v_sub_f32 v40, v40, v134
  v_sub_f32 v41, v41, v134
  v_sub_f32 v42, v42, v134
  v_sub_f32 v43, v43, v134
  v_sub_f32 v44, v44, v134
  v_sub_f32 v45, v45, v134
  v_sub_f32 v46, v46, v134
  v_sub_f32 v47, v47, v134
  v_exp_f32 v40, v40
  v_exp_f32 v41, v41
  v_exp_f32 v42, v42
  v_exp_f32 v43, v43
  v_exp_f32 v44, v44
  v_exp_f32 v45, v45
  v_exp_f32 v46, v46
  v_exp_f32 v47, v47
  v_sub_f32 v32, v32, v132
  v_sub_f32 v33, v33, v132
  v_sub_f32 v34, v34, v132
  v_sub_f32 v35, v35, v132
  v_sub_f32 v36, v36, v132
  v_sub_f32 v37, v37, v132
  v_sub_f32 v38, v38, v132
  v_sub_f32 v39, v39, v132
  v_exp_f32 v32, v32
  v_exp_f32 v33, v33
  v_exp_f32 v34, v34
  v_exp_f32 v35, v35
  v_exp_f32 v36, v36
  v_exp_f32 v37, v37
  v_exp_f32 v38, v38
  v_exp_f32 v39, v39
  v_sub_f32 v24, v24, v130
  v_sub_f32 v25, v25, v130
  v_sub_f32 v26, v26, v130
  v_sub_f32 v27, v27, v130
  v_sub_f32 v28, v28, v130
  v_sub_f32 v29, v29, v130
  v_sub_f32 v30, v30, v130
  v_sub_f32 v31, v31, v130
  v_exp_f32 v24, v24
  v_exp_f32 v25, v25
  v_exp_f32 v26, v26
  v_exp_f32 v27, v27
  v_exp_f32 v28, v28
  v_exp_f32 v29, v29
  v_exp_f32 v30, v30
  v_exp_f32 v31, v31
  v_sub_f32 v16, v16, v128
  v_sub_f32 v17, v17, v128
  v_sub_f32 v18, v18, v128
  v_sub_f32 v19, v19, v128
  v_sub_f32 v20, v20, v128
  v_sub_f32 v21, v21, v128
  v_sub_f32 v22, v22, v128
  v_sub_f32 v23, v23, v128
  v_exp_f32 v16, v16
  v_exp_f32 v17, v17
  v_exp_f32 v18, v18
  v_exp_f32 v19, v19
  v_exp_f32 v20, v20
  v_exp_f32 v21, v21
  v_exp_f32 v22, v22
  v_exp_f32 v23, v23
  v_cvt_pk_bf16_f32 v148, v40, v41
  v_cvt_pk_bf16_f32 v149, v42, v43
  v_cvt_pk_bf16_f32 v150, v44, v45
  v_cvt_pk_bf16_f32 v151, v46, v47
  v_cvt_pk_bf16_f32 v144, v32, v33
  v_cvt_pk_bf16_f32 v145, v34, v35
  v_cvt_pk_bf16_f32 v146, v36, v37
  v_cvt_pk_bf16_f32 v147, v38, v39
  v_cvt_pk_bf16_f32 v140, v24, v25
  v_cvt_pk_bf16_f32 v141, v26, v27
  v_cvt_pk_bf16_f32 v142, v28, v29
  v_cvt_pk_bf16_f32 v143, v30, v31
  v_cvt_pk_bf16_f32 v136, v16, v17
  v_cvt_pk_bf16_f32 v137, v18, v19
  v_cvt_pk_bf16_f32 v138, v20, v21
  v_cvt_pk_bf16_f32 v139, v22, v23
  v_mfma_f32_16x16x32_bf16 v[164:167], v[120:123], v[148:151], 0
  v_mfma_f32_16x16x32_bf16 v[192:195], v[90:93], v[148:151], 0
  v_mfma_f32_16x16x32_bf16 v[196:199], v[100:103], v[148:151], 0
  v_mfma_f32_16x16x32_bf16 v[160:163], v[120:123], v[144:147], 0
  v_mfma_f32_16x16x32_bf16 v[184:187], v[88:91], v[144:147], 0
  v_mfma_f32_16x16x32_bf16 v[188:191], v[98:101], v[144:147], 0
  v_mfma_f32_16x16x32_bf16 v[156:159], v[120:123], v[140:143], 0
  v_mfma_f32_16x16x32_bf16 v[176:179], v[86:89], v[140:143], 0
  v_mfma_f32_16x16x32_bf16 v[180:183], v[96:99], v[140:143], 0
  v_mfma_f32_16x16x32_bf16 v[152:155], v[120:123], v[136:139], 0
  v_mfma_f32_16x16x32_bf16 v[168:171], v[84:87], v[136:139], 0
  v_mfma_f32_16x16x32_bf16 v[172:175], v[94:97], v[136:139], 0
  s_add_u32 s16, s86, 83886080
  s_addc_u32 s17, s87, 0
  s_mov_b32 s18, 4194304
  s_mov_b32 s19, 0x00020000
  s_lshl_b32 s4, s32, 18
  s_lshl_b32 s5, s33, 14
  s_add_u32 s4, s4, s5
  s_and_b32 s5, s3, 1
  s_lshl_b32 s5, s5, 13
  s_add_u32 s4, s4, s5
  v_rcp_f32 v164, v164
  v_rcp_f32 v160, v160
  v_rcp_f32 v156, v156
  v_rcp_f32 v152, v152
  v_mov_b32 v165, v164
  v_mov_b32 v161, v160
  v_mov_b32 v157, v156
  v_mov_b32 v153, v152
  v_pk_mul_f32 v[192:193], v[192:193], v[164:165]
  v_pk_mul_f32 v[194:195], v[194:195], v[164:165]
  v_pk_mul_f32 v[196:197], v[196:197], v[164:165]
  v_pk_mul_f32 v[198:199], v[198:199], v[164:165]
  v_cvt_pk_bf16_f32 v192, v192, v193
  v_cvt_pk_bf16_f32 v193, v194, v195
  v_cvt_pk_bf16_f32 v194, v196, v197
  v_cvt_pk_bf16_f32 v195, v198, v199
  buffer_store_dwordx4 v[192:195], v2, s[16:19], s4 offen offset:3072 sc1
  v_pk_mul_f32 v[184:185], v[184:185], v[160:161]
  v_pk_mul_f32 v[186:187], v[186:187], v[160:161]
  v_pk_mul_f32 v[188:189], v[188:189], v[160:161]
  v_pk_mul_f32 v[190:191], v[190:191], v[160:161]
  v_cvt_pk_bf16_f32 v184, v184, v185
  v_cvt_pk_bf16_f32 v185, v186, v187
  v_cvt_pk_bf16_f32 v186, v188, v189
  v_cvt_pk_bf16_f32 v187, v190, v191
  buffer_store_dwordx4 v[184:187], v2, s[16:19], s4 offen offset:2048 sc1
  v_pk_mul_f32 v[176:177], v[176:177], v[156:157]
  v_pk_mul_f32 v[178:179], v[178:179], v[156:157]
  v_pk_mul_f32 v[180:181], v[180:181], v[156:157]
  v_pk_mul_f32 v[182:183], v[182:183], v[156:157]
  v_cvt_pk_bf16_f32 v176, v176, v177
  v_cvt_pk_bf16_f32 v177, v178, v179
  v_cvt_pk_bf16_f32 v178, v180, v181
  v_cvt_pk_bf16_f32 v179, v182, v183
  buffer_store_dwordx4 v[176:179], v2, s[16:19], s4 offen offset:1024 sc1
  v_pk_mul_f32 v[168:169], v[168:169], v[152:153]
  v_pk_mul_f32 v[170:171], v[170:171], v[152:153]
  v_pk_mul_f32 v[172:173], v[172:173], v[152:153]
  v_pk_mul_f32 v[174:175], v[174:175], v[152:153]
  v_cvt_pk_bf16_f32 v168, v168, v169
  v_cvt_pk_bf16_f32 v169, v170, v171
  v_cvt_pk_bf16_f32 v170, v172, v173
  v_cvt_pk_bf16_f32 v171, v174, v175
  buffer_store_dwordx4 v[168:171], v2, s[16:19], s4 offen offset:0 sc1
  s_branch Lp5
Lp2_r1:
  s_waitcnt vmcnt(52)
  s_barrier
  ds_read_b128 a[0:3], v22 offset:0
  ds_read_b64_tr_b16 a[40:41], v26 offset:18432
  ds_read_b64_tr_b16 a[42:43], v26 offset:20480
  ds_read_b128 a[4:7], v22 offset:2048
  ds_read_b128 a[8:11], v22 offset:4096
  ds_read_b128 a[12:15], v22 offset:6144
  ds_read_b64_tr_b16 a[44:45], v27 offset:18432
  ds_read_b64_tr_b16 a[46:47], v27 offset:20480
  ds_read_b64_tr_b16 a[48:49], v26 offset:26624
  ds_read_b64_tr_b16 a[50:51], v26 offset:28672
  ds_read_b64_tr_b16 a[52:53], v27 offset:26624
  ds_read_b64_tr_b16 a[54:55], v27 offset:28672
  ds_read_b64_tr_b16 a[56:57], v26 offset:34816
  ds_read_b64_tr_b16 a[58:59], v26 offset:36864
  ds_read_b128 a[16:19], v24 offset:0
  ds_read_b64_tr_b16 a[60:61], v27 offset:34816
  ds_read_b64_tr_b16 a[62:63], v27 offset:36864
  s_waitcnt lgkmcnt(0)
  v_mfma_f32_16x16x32_bf16 v[128:131], a[40:43], a[0:3], 0
  s_add_u32 s89, s89, 1
  s_cmp_eq_u32 s89, 3
  s_cselect_b32 s89, 0, s89
  s_cselect_b32 s90, s91, s92
  ds_read_b128 a[20:23], v23 offset:0
  v_mfma_f32_16x16x32_bf16 v[136:139], a[40:43], a[4:7], 0
  ds_read_b64_tr_b16 a[64:65], v26 offset:22528
  v_mfma_f32_16x16x32_bf16 v[144:147], a[40:43], a[8:11], 0
  ds_read_b64_tr_b16 a[66:67], v26 offset:24576
  v_mfma_f32_16x16x32_bf16 v[152:155], a[40:43], a[12:15], 0
  ds_read_b128 a[24:27], v23 offset:2048
  v_mfma_f32_16x16x32_bf16 v[132:135], a[44:47], a[0:3], 0
  ds_read_b128 a[28:31], v23 offset:4096
  v_mfma_f32_16x16x32_bf16 v[140:143], a[44:47], a[4:7], 0
  ds_read_b128 a[32:35], v23 offset:6144
  v_mfma_f32_16x16x32_bf16 v[148:151], a[44:47], a[8:11], 0
  ds_read_b64_tr_b16 a[68:69], v27 offset:22528
  v_mfma_f32_16x16x32_bf16 v[156:159], a[44:47], a[12:15], 0
  ds_read_b64_tr_b16 a[70:71], v27 offset:24576
  v_mfma_f32_16x16x32_bf16 v[160:163], a[48:51], a[0:3], 0
  ds_read_b64_tr_b16 a[72:73], v26 offset:30720
  v_mfma_f32_16x16x32_bf16 v[168:171], a[48:51], a[4:7], 0
  ds_read_b64_tr_b16 a[74:75], v26 offset:32768
  v_mfma_f32_16x16x32_bf16 v[176:179], a[48:51], a[8:11], 0
  ds_read_b64_tr_b16 a[76:77], v27 offset:30720
  v_mfma_f32_16x16x32_bf16 v[184:187], a[48:51], a[12:15], 0
  ds_read_b64_tr_b16 a[78:79], v27 offset:32768
  v_mfma_f32_16x16x32_bf16 v[164:167], a[52:55], a[0:3], 0
  ds_read_b64_tr_b16 a[80:81], v26 offset:38912
  v_mfma_f32_16x16x32_bf16 v[172:175], a[52:55], a[4:7], 0
  ds_read_b64_tr_b16 a[82:83], v26 offset:40960
  v_mfma_f32_16x16x32_bf16 v[180:183], a[52:55], a[8:11], 0
  ds_read_b128 a[36:39], v25 offset:0
  v_mfma_f32_16x16x32_bf16 v[188:191], a[52:55], a[12:15], 0
  ds_read_b64_tr_b16 a[84:85], v27 offset:38912
  v_mfma_f32_16x16x32_bf16 v[192:195], a[0:3], a[56:59], 0
  ds_read_b64_tr_b16 a[86:87], v27 offset:40960
  v_mfma_f32_16x16x32_bf16 v[200:203], a[4:7], a[56:59], 0
  v_add_u32 v22, s90, v22
  v_add_u32 v23, s90, v23
  v_mfma_f32_16x16x32_bf16 v[208:211], a[8:11], a[56:59], 0
  v_add_u32 v24, s90, v24
  v_add_u32 v25, s90, v25
  v_mfma_f32_16x16x32_bf16 v[216:219], a[12:15], a[56:59], 0
  v_add_u32 v26, s90, v26
  v_add_u32 v27, s90, v27
  v_mfma_f32_16x16x32_bf16 v[224:227], a[16:19], a[56:59], 0
  v_mfma_f32_16x16x32_bf16 v[196:199], a[0:3], a[60:63], 0
  v_mfma_f32_16x16x32_bf16 v[204:207], a[4:7], a[60:63], 0
  v_mfma_f32_16x16x32_bf16 v[212:215], a[8:11], a[60:63], 0
  v_mfma_f32_16x16x32_bf16 v[220:223], a[12:15], a[60:63], 0
  v_mfma_f32_16x16x32_bf16 v[228:231], a[16:19], a[60:63], 0
  s_waitcnt vmcnt(42) lgkmcnt(0)
  s_barrier
  v_mfma_f32_16x16x32_bf16 v[128:131], a[64:67], a[20:23], v[128:131]
  s_mov_b32 m0, s88
  ds_read_b128 a[0:3], v22 offset:0
  v_mfma_f32_16x16x32_bf16 v[136:139], a[64:67], a[24:27], v[136:139]
  buffer_load_dwordx4 v36, s[8:11], s24 offen offset:0 lds
  ds_read_b64_tr_b16 a[40:41], v26 offset:18432
  v_mfma_f32_16x16x32_bf16 v[144:147], a[64:67], a[28:31], v[144:147]
  ds_read_b64_tr_b16 a[42:43], v26 offset:20480
  v_mfma_f32_16x16x32_bf16 v[152:155], a[64:67], a[32:35], v[152:155]
  ds_read_b128 a[4:7], v22 offset:2048
  v_mfma_f32_16x16x32_bf16 v[132:135], a[68:71], a[20:23], v[132:135]
  ds_read_b128 a[8:11], v22 offset:4096
  v_mfma_f32_16x16x32_bf16 v[140:143], a[68:71], a[24:27], v[140:143]
  buffer_load_dwordx4 v37, s[8:11], s24 offen offset:1024 lds
  ds_read_b128 a[12:15], v22 offset:6144
  v_mfma_f32_16x16x32_bf16 v[148:151], a[68:71], a[28:31], v[148:151]
  ds_read_b64_tr_b16 a[44:45], v27 offset:18432
  v_mfma_f32_16x16x32_bf16 v[156:159], a[68:71], a[32:35], v[156:159]
  ds_read_b64_tr_b16 a[46:47], v27 offset:20480
  v_mfma_f32_16x16x32_bf16 v[160:163], a[72:75], a[20:23], v[160:163]
  ds_read_b64_tr_b16 a[48:49], v26 offset:26624
  v_mfma_f32_16x16x32_bf16 v[168:171], a[72:75], a[24:27], v[168:171]
  ds_read_b64_tr_b16 a[50:51], v26 offset:28672
  v_mfma_f32_16x16x32_bf16 v[176:179], a[72:75], a[28:31], v[176:179]
  buffer_load_dwordx4 v38, s[8:11], s24 offen offset:2048 lds
  ds_read_b64_tr_b16 a[52:53], v27 offset:26624
  v_mfma_f32_16x16x32_bf16 v[184:187], a[72:75], a[32:35], v[184:187]
  ds_read_b64_tr_b16 a[54:55], v27 offset:28672
  v_mfma_f32_16x16x32_bf16 v[164:167], a[76:79], a[20:23], v[164:167]
  ds_read_b64_tr_b16 a[56:57], v26 offset:34816
  v_mfma_f32_16x16x32_bf16 v[172:175], a[76:79], a[24:27], v[172:175]
  ds_read_b64_tr_b16 a[58:59], v26 offset:36864
  v_mfma_f32_16x16x32_bf16 v[180:183], a[76:79], a[28:31], v[180:183]
  ds_read_b128 a[16:19], v24 offset:0
  v_mfma_f32_16x16x32_bf16 v[188:191], a[76:79], a[32:35], v[188:191]
  buffer_load_dwordx4 v39, s[8:11], s24 offen offset:3072 lds
  ds_read_b64_tr_b16 a[60:61], v27 offset:34816
  v_mfma_f32_16x16x32_bf16 v[192:195], a[20:23], a[80:83], v[192:195]
  s_add_u32 s24, s24, 128
  s_add_u32 m0, s88, s26
  ds_read_b64_tr_b16 a[62:63], v27 offset:36864
  v_mfma_f32_16x16x32_bf16 v[200:203], a[24:27], a[80:83], v[200:203]
  v_mfma_f32_16x16x32_bf16 v[208:211], a[28:31], a[80:83], v[208:211]
  v_mfma_f32_16x16x32_bf16 v[216:219], a[32:35], a[80:83], v[216:219]
  v_mfma_f32_16x16x32_bf16 v[224:227], a[36:39], a[80:83], v[224:227]
  buffer_load_dwordx4 v8, s[20:23], s25 offen offset:0 lds
  v_mfma_f32_16x16x32_bf16 v[196:199], a[20:23], a[84:87], v[196:199]
  v_mfma_f32_16x16x32_bf16 v[204:207], a[24:27], a[84:87], v[204:207]
  v_mfma_f32_16x16x32_bf16 v[212:215], a[28:31], a[84:87], v[212:215]
  v_mfma_f32_16x16x32_bf16 v[220:223], a[32:35], a[84:87], v[220:223]
  v_mfma_f32_16x16x32_bf16 v[228:231], a[36:39], a[84:87], v[228:231]
  s_waitcnt lgkmcnt(0)
  v_mfma_f32_16x16x32_bf16 v[128:131], a[40:43], a[0:3], v[128:131]
  buffer_load_dwordx4 v9, s[20:23], s25 offen offset:1024 lds
  ds_read_b128 a[20:23], v23 offset:0
  v_mfma_f32_16x16x32_bf16 v[136:139], a[40:43], a[4:7], v[136:139]
  ds_read_b64_tr_b16 a[64:65], v26 offset:22528
  v_mfma_f32_16x16x32_bf16 v[144:147], a[40:43], a[8:11], v[144:147]
  ds_read_b64_tr_b16 a[66:67], v26 offset:24576
  v_mfma_f32_16x16x32_bf16 v[152:155], a[40:43], a[12:15], v[152:155]
  buffer_load_dwordx4 v10, s[20:23], s25 offen offset:2048 lds
  ds_read_b128 a[24:27], v23 offset:2048
  v_mfma_f32_16x16x32_bf16 v[132:135], a[44:47], a[0:3], v[132:135]
  s_add_u32 m0, s88, s27
  ds_read_b128 a[28:31], v23 offset:4096
  v_mfma_f32_16x16x32_bf16 v[140:143], a[44:47], a[4:7], v[140:143]
  ds_read_b128 a[32:35], v23 offset:6144
  v_mfma_f32_16x16x32_bf16 v[148:151], a[44:47], a[8:11], v[148:151]
  ds_read_b64_tr_b16 a[68:69], v27 offset:22528
  v_mfma_f32_16x16x32_bf16 v[156:159], a[44:47], a[12:15], v[156:159]
  buffer_load_dwordx4 v11, s[20:23], s25 offen offset:0 lds
  ds_read_b64_tr_b16 a[70:71], v27 offset:24576
  v_mfma_f32_16x16x32_bf16 v[160:163], a[48:51], a[0:3], v[160:163]
  ds_read_b64_tr_b16 a[72:73], v26 offset:30720
  v_mfma_f32_16x16x32_bf16 v[168:171], a[48:51], a[4:7], v[168:171]
  ds_read_b64_tr_b16 a[74:75], v26 offset:32768
  v_mfma_f32_16x16x32_bf16 v[176:179], a[48:51], a[8:11], v[176:179]
  ds_read_b64_tr_b16 a[76:77], v27 offset:30720
  v_mfma_f32_16x16x32_bf16 v[184:187], a[48:51], a[12:15], v[184:187]
  buffer_load_dwordx4 v12, s[20:23], s25 offen offset:1024 lds
  ds_read_b64_tr_b16 a[78:79], v27 offset:32768
  v_mfma_f32_16x16x32_bf16 v[164:167], a[52:55], a[0:3], v[164:167]
  ds_read_b64_tr_b16 a[80:81], v26 offset:38912
  v_mfma_f32_16x16x32_bf16 v[172:175], a[52:55], a[4:7], v[172:175]
  ds_read_b64_tr_b16 a[82:83], v26 offset:40960
  v_mfma_f32_16x16x32_bf16 v[180:183], a[52:55], a[8:11], v[180:183]
  ds_read_b128 a[36:39], v25 offset:0
  v_mfma_f32_16x16x32_bf16 v[188:191], a[52:55], a[12:15], v[188:191]
  buffer_load_dwordx4 v13, s[20:23], s25 offen offset:2048 lds
  ds_read_b64_tr_b16 a[84:85], v27 offset:38912
  v_mfma_f32_16x16x32_bf16 v[192:195], a[0:3], a[56:59], v[192:195]
  s_add_u32 s25, s25, 393216
  ds_read_b64_tr_b16 a[86:87], v27 offset:40960
  v_mfma_f32_16x16x32_bf16 v[200:203], a[4:7], a[56:59], v[200:203]
  s_add_u32 s88, s88, s90
  s_add_u32 s89, s89, 1
  s_cmp_eq_u32 s89, 3
  s_cselect_b32 s89, 0, s89
  s_cselect_b32 s90, s91, s92
  v_mfma_f32_16x16x32_bf16 v[208:211], a[8:11], a[56:59], v[208:211]
  v_add_u32 v22, s90, v22
  v_add_u32 v23, s90, v23
  v_mfma_f32_16x16x32_bf16 v[216:219], a[12:15], a[56:59], v[216:219]
  v_add_u32 v24, s90, v24
  v_add_u32 v25, s90, v25
  v_mfma_f32_16x16x32_bf16 v[224:227], a[16:19], a[56:59], v[224:227]
  v_add_u32 v26, s90, v26
  v_add_u32 v27, s90, v27
  v_mfma_f32_16x16x32_bf16 v[196:199], a[0:3], a[60:63], v[196:199]
  v_mfma_f32_16x16x32_bf16 v[204:207], a[4:7], a[60:63], v[204:207]
  v_mfma_f32_16x16x32_bf16 v[212:215], a[8:11], a[60:63], v[212:215]
  v_mfma_f32_16x16x32_bf16 v[220:223], a[12:15], a[60:63], v[220:223]
  v_mfma_f32_16x16x32_bf16 v[228:231], a[16:19], a[60:63], v[228:231]
  s_waitcnt vmcnt(42) lgkmcnt(0)
  s_barrier
  v_mfma_f32_16x16x32_bf16 v[128:131], a[64:67], a[20:23], v[128:131]
  s_mov_b32 m0, s88
  ds_read_b128 a[0:3], v22 offset:0
  v_mfma_f32_16x16x32_bf16 v[136:139], a[64:67], a[24:27], v[136:139]
  buffer_load_dwordx4 v36, s[8:11], s24 offen offset:0 lds
  ds_read_b64_tr_b16 a[40:41], v26 offset:18432
  v_mfma_f32_16x16x32_bf16 v[144:147], a[64:67], a[28:31], v[144:147]
  ds_read_b64_tr_b16 a[42:43], v26 offset:20480
  v_mfma_f32_16x16x32_bf16 v[152:155], a[64:67], a[32:35], v[152:155]
  ds_read_b128 a[4:7], v22 offset:2048
  v_mfma_f32_16x16x32_bf16 v[132:135], a[68:71], a[20:23], v[132:135]
  ds_read_b128 a[8:11], v22 offset:4096
  v_mfma_f32_16x16x32_bf16 v[140:143], a[68:71], a[24:27], v[140:143]
  buffer_load_dwordx4 v37, s[8:11], s24 offen offset:1024 lds
  ds_read_b128 a[12:15], v22 offset:6144
  v_mfma_f32_16x16x32_bf16 v[148:151], a[68:71], a[28:31], v[148:151]
  ds_read_b64_tr_b16 a[44:45], v27 offset:18432
  v_mfma_f32_16x16x32_bf16 v[156:159], a[68:71], a[32:35], v[156:159]
  ds_read_b64_tr_b16 a[46:47], v27 offset:20480
  v_mfma_f32_16x16x32_bf16 v[160:163], a[72:75], a[20:23], v[160:163]
  ds_read_b64_tr_b16 a[48:49], v26 offset:26624
  v_mfma_f32_16x16x32_bf16 v[168:171], a[72:75], a[24:27], v[168:171]
  ds_read_b64_tr_b16 a[50:51], v26 offset:28672
  v_mfma_f32_16x16x32_bf16 v[176:179], a[72:75], a[28:31], v[176:179]
  buffer_load_dwordx4 v38, s[8:11], s24 offen offset:2048 lds
  ds_read_b64_tr_b16 a[52:53], v27 offset:26624
  v_mfma_f32_16x16x32_bf16 v[184:187], a[72:75], a[32:35], v[184:187]
  ds_read_b64_tr_b16 a[54:55], v27 offset:28672
  v_mfma_f32_16x16x32_bf16 v[164:167], a[76:79], a[20:23], v[164:167]
  ds_read_b64_tr_b16 a[56:57], v26 offset:34816
  v_mfma_f32_16x16x32_bf16 v[172:175], a[76:79], a[24:27], v[172:175]
  ds_read_b64_tr_b16 a[58:59], v26 offset:36864
  v_mfma_f32_16x16x32_bf16 v[180:183], a[76:79], a[28:31], v[180:183]
  ds_read_b128 a[16:19], v24 offset:0
  v_mfma_f32_16x16x32_bf16 v[188:191], a[76:79], a[32:35], v[188:191]
  buffer_load_dwordx4 v39, s[8:11], s24 offen offset:3072 lds
  ds_read_b64_tr_b16 a[60:61], v27 offset:34816
  v_mfma_f32_16x16x32_bf16 v[192:195], a[20:23], a[80:83], v[192:195]
  s_add_u32 s24, s24, 128
  s_add_u32 m0, s88, s26
  ds_read_b64_tr_b16 a[62:63], v27 offset:36864
  v_mfma_f32_16x16x32_bf16 v[200:203], a[24:27], a[80:83], v[200:203]
  v_mfma_f32_16x16x32_bf16 v[208:211], a[28:31], a[80:83], v[208:211]
  v_mfma_f32_16x16x32_bf16 v[216:219], a[32:35], a[80:83], v[216:219]
  v_mfma_f32_16x16x32_bf16 v[224:227], a[36:39], a[80:83], v[224:227]
  buffer_load_dwordx4 v8, s[20:23], s25 offen offset:0 lds
  v_mfma_f32_16x16x32_bf16 v[196:199], a[20:23], a[84:87], v[196:199]
  v_mfma_f32_16x16x32_bf16 v[204:207], a[24:27], a[84:87], v[204:207]
  v_mfma_f32_16x16x32_bf16 v[212:215], a[28:31], a[84:87], v[212:215]
  v_mfma_f32_16x16x32_bf16 v[220:223], a[32:35], a[84:87], v[220:223]
  v_mfma_f32_16x16x32_bf16 v[228:231], a[36:39], a[84:87], v[228:231]
  s_waitcnt lgkmcnt(0)
  v_mfma_f32_16x16x32_bf16 v[128:131], a[40:43], a[0:3], v[128:131]
  buffer_load_dwordx4 v9, s[20:23], s25 offen offset:1024 lds
  ds_read_b128 a[20:23], v23 offset:0
  v_mfma_f32_16x16x32_bf16 v[136:139], a[40:43], a[4:7], v[136:139]
  ds_read_b64_tr_b16 a[64:65], v26 offset:22528
  v_mfma_f32_16x16x32_bf16 v[144:147], a[40:43], a[8:11], v[144:147]
  ds_read_b64_tr_b16 a[66:67], v26 offset:24576
  v_mfma_f32_16x16x32_bf16 v[152:155], a[40:43], a[12:15], v[152:155]
  buffer_load_dwordx4 v10, s[20:23], s25 offen offset:2048 lds
  ds_read_b128 a[24:27], v23 offset:2048
  v_mfma_f32_16x16x32_bf16 v[132:135], a[44:47], a[0:3], v[132:135]
  s_add_u32 m0, s88, s27
  ds_read_b128 a[28:31], v23 offset:4096
  v_mfma_f32_16x16x32_bf16 v[140:143], a[44:47], a[4:7], v[140:143]
  ds_read_b128 a[32:35], v23 offset:6144
  v_mfma_f32_16x16x32_bf16 v[148:151], a[44:47], a[8:11], v[148:151]
  ds_read_b64_tr_b16 a[68:69], v27 offset:22528
  v_mfma_f32_16x16x32_bf16 v[156:159], a[44:47], a[12:15], v[156:159]
  buffer_load_dwordx4 v11, s[20:23], s25 offen offset:0 lds
  ds_read_b64_tr_b16 a[70:71], v27 offset:24576
  v_mfma_f32_16x16x32_bf16 v[160:163], a[48:51], a[0:3], v[160:163]
  ds_read_b64_tr_b16 a[72:73], v26 offset:30720
  v_mfma_f32_16x16x32_bf16 v[168:171], a[48:51], a[4:7], v[168:171]
  ds_read_b64_tr_b16 a[74:75], v26 offset:32768
  v_mfma_f32_16x16x32_bf16 v[176:179], a[48:51], a[8:11], v[176:179]
  ds_read_b64_tr_b16 a[76:77], v27 offset:30720
  v_mfma_f32_16x16x32_bf16 v[184:187], a[48:51], a[12:15], v[184:187]
  buffer_load_dwordx4 v12, s[20:23], s25 offen offset:1024 lds
  ds_read_b64_tr_b16 a[78:79], v27 offset:32768
  v_mfma_f32_16x16x32_bf16 v[164:167], a[52:55], a[0:3], v[164:167]
  ds_read_b64_tr_b16 a[80:81], v26 offset:38912
  v_mfma_f32_16x16x32_bf16 v[172:175], a[52:55], a[4:7], v[172:175]
  ds_read_b64_tr_b16 a[82:83], v26 offset:40960
  v_mfma_f32_16x16x32_bf16 v[180:183], a[52:55], a[8:11], v[180:183]
  ds_read_b128 a[36:39], v25 offset:0
  v_mfma_f32_16x16x32_bf16 v[188:191], a[52:55], a[12:15], v[188:191]
  buffer_load_dwordx4 v13, s[20:23], s25 offen offset:2048 lds
  ds_read_b64_tr_b16 a[84:85], v27 offset:38912
  v_mfma_f32_16x16x32_bf16 v[192:195], a[0:3], a[56:59], v[192:195]
  s_add_u32 s25, s25, 393216
  ds_read_b64_tr_b16 a[86:87], v27 offset:40960
  v_mfma_f32_16x16x32_bf16 v[200:203], a[4:7], a[56:59], v[200:203]
  s_add_u32 s88, s88, s90
  s_add_u32 s89, s89, 1
  s_cmp_eq_u32 s89, 3
  s_cselect_b32 s89, 0, s89
  s_cselect_b32 s90, s91, s92
  v_mfma_f32_16x16x32_bf16 v[208:211], a[8:11], a[56:59], v[208:211]
  v_add_u32 v22, s90, v22
  v_add_u32 v23, s90, v23
  v_mfma_f32_16x16x32_bf16 v[216:219], a[12:15], a[56:59], v[216:219]
  v_add_u32 v24, s90, v24
  v_add_u32 v25, s90, v25
  v_mfma_f32_16x16x32_bf16 v[224:227], a[16:19], a[56:59], v[224:227]
  v_add_u32 v26, s90, v26
  v_add_u32 v27, s90, v27
  v_mfma_f32_16x16x32_bf16 v[196:199], a[0:3], a[60:63], v[196:199]
  v_mfma_f32_16x16x32_bf16 v[204:207], a[4:7], a[60:63], v[204:207]
  v_mfma_f32_16x16x32_bf16 v[212:215], a[8:11], a[60:63], v[212:215]
  v_mfma_f32_16x16x32_bf16 v[220:223], a[12:15], a[60:63], v[220:223]
  v_mfma_f32_16x16x32_bf16 v[228:231], a[16:19], a[60:63], v[228:231]
  s_waitcnt vmcnt(10) lgkmcnt(0)
  s_barrier
  s_mov_b32 s5, 0x40000
Ltg_13:
  v_readfirstlane_b32 s94, v30
  v_readfirstlane_b32 s95, v31
  s_nop 0
  s_cmp_lg_u32 s95, 0
  s_cbranch_scc1 Lpolld_14
  s_sleep 4
  s_mov_b32 s16, s84
  s_mov_b32 s17, s85
  s_mov_b32 s18, 256
  s_mov_b32 s19, 0x00020000
  buffer_load_dwordx2 v[30:31], off, s[16:19], 0 sc1
  s_sub_u32 s5, s5, 1
  s_waitcnt vmcnt(0)
  s_cbranch_scc0 Ltg_13
Lpolld_14:
  v_mov_b32 v30, 0x40000000
  v_mov_b32 v28, s94
  v_cmp_eq_u32 vcc, 0, v0
  v_mov_b32 v29, s95
  s_nop 0
  v_cndmask_b32_e64 v30, v30, 0, vcc
  buffer_store_dwordx2 v[28:29], v30, s[96:99], s34 offen sc1
  v_mfma_f32_16x16x32_bf16 v[128:131], a[64:67], a[20:23], v[128:131]
  s_mov_b32 m0, s88
  ds_read_b128 a[0:3], v22 offset:0
  v_mfma_f32_16x16x32_bf16 v[136:139], a[64:67], a[24:27], v[136:139]
  buffer_load_dwordx4 v36, s[8:11], s24 offen offset:0 lds
  ds_read_b64_tr_b16 a[40:41], v26 offset:18432
  v_mfma_f32_16x16x32_bf16 v[144:147], a[64:67], a[28:31], v[144:147]
  ds_read_b64_tr_b16 a[42:43], v26 offset:20480
  v_mfma_f32_16x16x32_bf16 v[152:155], a[64:67], a[32:35], v[152:155]
  ds_read_b128 a[4:7], v22 offset:2048
  v_mfma_f32_16x16x32_bf16 v[132:135], a[68:71], a[20:23], v[132:135]
  ds_read_b128 a[8:11], v22 offset:4096
  v_mfma_f32_16x16x32_bf16 v[140:143], a[68:71], a[24:27], v[140:143]
  buffer_load_dwordx4 v37, s[8:11], s24 offen offset:1024 lds
  ds_read_b128 a[12:15], v22 offset:6144
  v_mfma_f32_16x16x32_bf16 v[148:151], a[68:71], a[28:31], v[148:151]
  ds_read_b64_tr_b16 a[44:45], v27 offset:18432
  v_mfma_f32_16x16x32_bf16 v[156:159], a[68:71], a[32:35], v[156:159]
  ds_read_b64_tr_b16 a[46:47], v27 offset:20480
  v_mfma_f32_16x16x32_bf16 v[160:163], a[72:75], a[20:23], v[160:163]
  ds_read_b64_tr_b16 a[48:49], v26 offset:26624
  v_mfma_f32_16x16x32_bf16 v[168:171], a[72:75], a[24:27], v[168:171]
  ds_read_b64_tr_b16 a[50:51], v26 offset:28672
  v_mfma_f32_16x16x32_bf16 v[176:179], a[72:75], a[28:31], v[176:179]
  buffer_load_dwordx4 v38, s[8:11], s24 offen offset:2048 lds
  ds_read_b64_tr_b16 a[52:53], v27 offset:26624
  v_mfma_f32_16x16x32_bf16 v[184:187], a[72:75], a[32:35], v[184:187]
  ds_read_b64_tr_b16 a[54:55], v27 offset:28672
  v_mfma_f32_16x16x32_bf16 v[164:167], a[76:79], a[20:23], v[164:167]
  ds_read_b64_tr_b16 a[56:57], v26 offset:34816
  v_mfma_f32_16x16x32_bf16 v[172:175], a[76:79], a[24:27], v[172:175]
  ds_read_b64_tr_b16 a[58:59], v26 offset:36864
  v_mfma_f32_16x16x32_bf16 v[180:183], a[76:79], a[28:31], v[180:183]
  ds_read_b128 a[16:19], v24 offset:0
  v_mfma_f32_16x16x32_bf16 v[188:191], a[76:79], a[32:35], v[188:191]
  buffer_load_dwordx4 v39, s[8:11], s24 offen offset:3072 lds
  ds_read_b64_tr_b16 a[60:61], v27 offset:34816
  v_mfma_f32_16x16x32_bf16 v[192:195], a[20:23], a[80:83], v[192:195]
  s_add_u32 s24, s24, 128
  s_add_u32 m0, s88, s26
  ds_read_b64_tr_b16 a[62:63], v27 offset:36864
  v_mfma_f32_16x16x32_bf16 v[200:203], a[24:27], a[80:83], v[200:203]
  v_mfma_f32_16x16x32_bf16 v[208:211], a[28:31], a[80:83], v[208:211]
  v_mfma_f32_16x16x32_bf16 v[216:219], a[32:35], a[80:83], v[216:219]
  v_mfma_f32_16x16x32_bf16 v[224:227], a[36:39], a[80:83], v[224:227]
  buffer_load_dwordx4 v8, s[20:23], s25 offen offset:0 lds
  v_mfma_f32_16x16x32_bf16 v[196:199], a[20:23], a[84:87], v[196:199]
  v_mfma_f32_16x16x32_bf16 v[204:207], a[24:27], a[84:87], v[204:207]
  v_mfma_f32_16x16x32_bf16 v[212:215], a[28:31], a[84:87], v[212:215]
  v_mfma_f32_16x16x32_bf16 v[220:223], a[32:35], a[84:87], v[220:223]
  v_mfma_f32_16x16x32_bf16 v[228:231], a[36:39], a[84:87], v[228:231]
  s_waitcnt lgkmcnt(0)
  v_mfma_f32_16x16x32_bf16 v[128:131], a[40:43], a[0:3], v[128:131]
  buffer_load_dwordx4 v9, s[20:23], s25 offen offset:1024 lds
  ds_read_b128 a[20:23], v23 offset:0
  v_mfma_f32_16x16x32_bf16 v[136:139], a[40:43], a[4:7], v[136:139]
  ds_read_b64_tr_b16 a[64:65], v26 offset:22528
  v_mfma_f32_16x16x32_bf16 v[144:147], a[40:43], a[8:11], v[144:147]
  ds_read_b64_tr_b16 a[66:67], v26 offset:24576
  v_mfma_f32_16x16x32_bf16 v[152:155], a[40:43], a[12:15], v[152:155]
  buffer_load_dwordx4 v10, s[20:23], s25 offen offset:2048 lds
  ds_read_b128 a[24:27], v23 offset:2048
  v_mfma_f32_16x16x32_bf16 v[132:135], a[44:47], a[0:3], v[132:135]
  s_add_u32 m0, s88, s27
  ds_read_b128 a[28:31], v23 offset:4096
  v_mfma_f32_16x16x32_bf16 v[140:143], a[44:47], a[4:7], v[140:143]
  ds_read_b128 a[32:35], v23 offset:6144
  v_mfma_f32_16x16x32_bf16 v[148:151], a[44:47], a[8:11], v[148:151]
  ds_read_b64_tr_b16 a[68:69], v27 offset:22528
  v_mfma_f32_16x16x32_bf16 v[156:159], a[44:47], a[12:15], v[156:159]
  buffer_load_dwordx4 v11, s[20:23], s25 offen offset:0 lds
  ds_read_b64_tr_b16 a[70:71], v27 offset:24576
  v_mfma_f32_16x16x32_bf16 v[160:163], a[48:51], a[0:3], v[160:163]
  ds_read_b64_tr_b16 a[72:73], v26 offset:30720
  v_mfma_f32_16x16x32_bf16 v[168:171], a[48:51], a[4:7], v[168:171]
  ds_read_b64_tr_b16 a[74:75], v26 offset:32768
  v_mfma_f32_16x16x32_bf16 v[176:179], a[48:51], a[8:11], v[176:179]
  ds_read_b64_tr_b16 a[76:77], v27 offset:30720
  v_mfma_f32_16x16x32_bf16 v[184:187], a[48:51], a[12:15], v[184:187]
  buffer_load_dwordx4 v12, s[20:23], s25 offen offset:1024 lds
  ds_read_b64_tr_b16 a[78:79], v27 offset:32768
  v_mfma_f32_16x16x32_bf16 v[164:167], a[52:55], a[0:3], v[164:167]
  ds_read_b64_tr_b16 a[80:81], v26 offset:38912
  v_mfma_f32_16x16x32_bf16 v[172:175], a[52:55], a[4:7], v[172:175]
  ds_read_b64_tr_b16 a[82:83], v26 offset:40960
  v_mfma_f32_16x16x32_bf16 v[180:183], a[52:55], a[8:11], v[180:183]
  ds_read_b128 a[36:39], v25 offset:0
  v_mfma_f32_16x16x32_bf16 v[188:191], a[52:55], a[12:15], v[188:191]
  buffer_load_dwordx4 v13, s[20:23], s25 offen offset:2048 lds
  ds_read_b64_tr_b16 a[84:85], v27 offset:38912
  v_mfma_f32_16x16x32_bf16 v[192:195], a[0:3], a[56:59], v[192:195]
  s_add_u32 s25, s25, 393216
  ds_read_b64_tr_b16 a[86:87], v27 offset:40960
  v_mfma_f32_16x16x32_bf16 v[200:203], a[4:7], a[56:59], v[200:203]
  s_add_u32 s88, s88, s90
  s_add_u32 s89, s89, 1
  s_cmp_eq_u32 s89, 3
  s_cselect_b32 s89, 0, s89
  s_cselect_b32 s90, s91, s92
  v_mfma_f32_16x16x32_bf16 v[208:211], a[8:11], a[56:59], v[208:211]
  v_add_u32 v22, s90, v22
  v_add_u32 v23, s90, v23
  v_mfma_f32_16x16x32_bf16 v[216:219], a[12:15], a[56:59], v[216:219]
  v_add_u32 v24, s90, v24
  v_add_u32 v25, s90, v25
  v_mfma_f32_16x16x32_bf16 v[224:227], a[16:19], a[56:59], v[224:227]
  v_add_u32 v26, s90, v26
  v_add_u32 v27, s90, v27
  v_mfma_f32_16x16x32_bf16 v[196:199], a[0:3], a[60:63], v[196:199]
  v_mfma_f32_16x16x32_bf16 v[204:207], a[4:7], a[60:63], v[204:207]
  v_mfma_f32_16x16x32_bf16 v[212:215], a[8:11], a[60:63], v[212:215]
  v_mfma_f32_16x16x32_bf16 v[220:223], a[12:15], a[60:63], v[220:223]
  v_mfma_f32_16x16x32_bf16 v[228:231], a[16:19], a[60:63], v[228:231]
  s_mov_b32 s35, 10
  .p2align 6
Lp2r1_loop:
  s_waitcnt vmcnt(10) lgkmcnt(0)
  s_barrier
  v_mfma_f32_16x16x32_bf16 v[128:131], a[64:67], a[20:23], v[128:131]
  s_mov_b32 m0, s88
  ds_read_b128 a[0:3], v22 offset:0
  v_mfma_f32_16x16x32_bf16 v[136:139], a[64:67], a[24:27], v[136:139]
  buffer_load_dwordx4 v36, s[8:11], s24 offen offset:0 lds
  ds_read_b64_tr_b16 a[40:41], v26 offset:18432
  v_mfma_f32_16x16x32_bf16 v[144:147], a[64:67], a[28:31], v[144:147]
  ds_read_b64_tr_b16 a[42:43], v26 offset:20480
  v_mfma_f32_16x16x32_bf16 v[152:155], a[64:67], a[32:35], v[152:155]
  ds_read_b128 a[4:7], v22 offset:2048
  v_mfma_f32_16x16x32_bf16 v[132:135], a[68:71], a[20:23], v[132:135]
  ds_read_b128 a[8:11], v22 offset:4096
  v_mfma_f32_16x16x32_bf16 v[140:143], a[68:71], a[24:27], v[140:143]
  buffer_load_dwordx4 v37, s[8:11], s24 offen offset:1024 lds
  ds_read_b128 a[12:15], v22 offset:6144
  v_mfma_f32_16x16x32_bf16 v[148:151], a[68:71], a[28:31], v[148:151]
  ds_read_b64_tr_b16 a[44:45], v27 offset:18432
  v_mfma_f32_16x16x32_bf16 v[156:159], a[68:71], a[32:35], v[156:159]
  ds_read_b64_tr_b16 a[46:47], v27 offset:20480
  v_mfma_f32_16x16x32_bf16 v[160:163], a[72:75], a[20:23], v[160:163]
  ds_read_b64_tr_b16 a[48:49], v26 offset:26624
  v_mfma_f32_16x16x32_bf16 v[168:171], a[72:75], a[24:27], v[168:171]
  ds_read_b64_tr_b16 a[50:51], v26 offset:28672
  v_mfma_f32_16x16x32_bf16 v[176:179], a[72:75], a[28:31], v[176:179]
  buffer_load_dwordx4 v38, s[8:11], s24 offen offset:2048 lds
  ds_read_b64_tr_b16 a[52:53], v27 offset:26624
  v_mfma_f32_16x16x32_bf16 v[184:187], a[72:75], a[32:35], v[184:187]
  ds_read_b64_tr_b16 a[54:55], v27 offset:28672
  v_mfma_f32_16x16x32_bf16 v[164:167], a[76:79], a[20:23], v[164:167]
  ds_read_b64_tr_b16 a[56:57], v26 offset:34816
  v_mfma_f32_16x16x32_bf16 v[172:175], a[76:79], a[24:27], v[172:175]
  ds_read_b64_tr_b16 a[58:59], v26 offset:36864
  v_mfma_f32_16x16x32_bf16 v[180:183], a[76:79], a[28:31], v[180:183]
  ds_read_b128 a[16:19], v24 offset:0
  v_mfma_f32_16x16x32_bf16 v[188:191], a[76:79], a[32:35], v[188:191]
  buffer_load_dwordx4 v39, s[8:11], s24 offen offset:3072 lds
  ds_read_b64_tr_b16 a[60:61], v27 offset:34816
  v_mfma_f32_16x16x32_bf16 v[192:195], a[20:23], a[80:83], v[192:195]
  s_add_u32 s24, s24, 128
  s_add_u32 m0, s88, s26
  ds_read_b64_tr_b16 a[62:63], v27 offset:36864
  v_mfma_f32_16x16x32_bf16 v[200:203], a[24:27], a[80:83], v[200:203]
  v_mfma_f32_16x16x32_bf16 v[208:211], a[28:31], a[80:83], v[208:211]
  v_mfma_f32_16x16x32_bf16 v[216:219], a[32:35], a[80:83], v[216:219]
  v_mfma_f32_16x16x32_bf16 v[224:227], a[36:39], a[80:83], v[224:227]
  buffer_load_dwordx4 v8, s[20:23], s25 offen offset:0 lds
  v_mfma_f32_16x16x32_bf16 v[196:199], a[20:23], a[84:87], v[196:199]
  v_mfma_f32_16x16x32_bf16 v[204:207], a[24:27], a[84:87], v[204:207]
  v_mfma_f32_16x16x32_bf16 v[212:215], a[28:31], a[84:87], v[212:215]
  v_mfma_f32_16x16x32_bf16 v[220:223], a[32:35], a[84:87], v[220:223]
  v_mfma_f32_16x16x32_bf16 v[228:231], a[36:39], a[84:87], v[228:231]
  s_waitcnt lgkmcnt(0)
  v_mfma_f32_16x16x32_bf16 v[128:131], a[40:43], a[0:3], v[128:131]
  buffer_load_dwordx4 v9, s[20:23], s25 offen offset:1024 lds
  ds_read_b128 a[20:23], v23 offset:0
  v_mfma_f32_16x16x32_bf16 v[136:139], a[40:43], a[4:7], v[136:139]
  ds_read_b64_tr_b16 a[64:65], v26 offset:22528
  v_mfma_f32_16x16x32_bf16 v[144:147], a[40:43], a[8:11], v[144:147]
  ds_read_b64_tr_b16 a[66:67], v26 offset:24576
  v_mfma_f32_16x16x32_bf16 v[152:155], a[40:43], a[12:15], v[152:155]
  buffer_load_dwordx4 v10, s[20:23], s25 offen offset:2048 lds
  ds_read_b128 a[24:27], v23 offset:2048
  v_mfma_f32_16x16x32_bf16 v[132:135], a[44:47], a[0:3], v[132:135]
  s_add_u32 m0, s88, s27
  ds_read_b128 a[28:31], v23 offset:4096
  v_mfma_f32_16x16x32_bf16 v[140:143], a[44:47], a[4:7], v[140:143]
  ds_read_b128 a[32:35], v23 offset:6144
  v_mfma_f32_16x16x32_bf16 v[148:151], a[44:47], a[8:11], v[148:151]
  ds_read_b64_tr_b16 a[68:69], v27 offset:22528
  v_mfma_f32_16x16x32_bf16 v[156:159], a[44:47], a[12:15], v[156:159]
  buffer_load_dwordx4 v11, s[20:23], s25 offen offset:0 lds
  ds_read_b64_tr_b16 a[70:71], v27 offset:24576
  v_mfma_f32_16x16x32_bf16 v[160:163], a[48:51], a[0:3], v[160:163]
  ds_read_b64_tr_b16 a[72:73], v26 offset:30720
  v_mfma_f32_16x16x32_bf16 v[168:171], a[48:51], a[4:7], v[168:171]
  ds_read_b64_tr_b16 a[74:75], v26 offset:32768
  v_mfma_f32_16x16x32_bf16 v[176:179], a[48:51], a[8:11], v[176:179]
  ds_read_b64_tr_b16 a[76:77], v27 offset:30720
  v_mfma_f32_16x16x32_bf16 v[184:187], a[48:51], a[12:15], v[184:187]
  buffer_load_dwordx4 v12, s[20:23], s25 offen offset:1024 lds
  ds_read_b64_tr_b16 a[78:79], v27 offset:32768
  v_mfma_f32_16x16x32_bf16 v[164:167], a[52:55], a[0:3], v[164:167]
  ds_read_b64_tr_b16 a[80:81], v26 offset:38912
  v_mfma_f32_16x16x32_bf16 v[172:175], a[52:55], a[4:7], v[172:175]
  ds_read_b64_tr_b16 a[82:83], v26 offset:40960
  v_mfma_f32_16x16x32_bf16 v[180:183], a[52:55], a[8:11], v[180:183]
  ds_read_b128 a[36:39], v25 offset:0
  v_mfma_f32_16x16x32_bf16 v[188:191], a[52:55], a[12:15], v[188:191]
  buffer_load_dwordx4 v13, s[20:23], s25 offen offset:2048 lds
  ds_read_b64_tr_b16 a[84:85], v27 offset:38912
  v_mfma_f32_16x16x32_bf16 v[192:195], a[0:3], a[56:59], v[192:195]
  s_add_u32 s25, s25, 393216
  ds_read_b64_tr_b16 a[86:87], v27 offset:40960
  v_mfma_f32_16x16x32_bf16 v[200:203], a[4:7], a[56:59], v[200:203]
  s_add_u32 s88, s88, s90
  s_add_u32 s89, s89, 1
  s_cmp_eq_u32 s89, 3
  s_cselect_b32 s89, 0, s89
  s_cselect_b32 s90, s91, s92
  v_mfma_f32_16x16x32_bf16 v[208:211], a[8:11], a[56:59], v[208:211]
  v_add_u32 v22, s90, v22
  v_add_u32 v23, s90, v23
  v_mfma_f32_16x16x32_bf16 v[216:219], a[12:15], a[56:59], v[216:219]
  v_add_u32 v24, s90, v24
  v_add_u32 v25, s90, v25
  v_mfma_f32_16x16x32_bf16 v[224:227], a[16:19], a[56:59], v[224:227]
  v_add_u32 v26, s90, v26
  v_add_u32 v27, s90, v27
  v_mfma_f32_16x16x32_bf16 v[196:199], a[0:3], a[60:63], v[196:199]
  v_mfma_f32_16x16x32_bf16 v[204:207], a[4:7], a[60:63], v[204:207]
  v_mfma_f32_16x16x32_bf16 v[212:215], a[8:11], a[60:63], v[212:215]
  v_mfma_f32_16x16x32_bf16 v[220:223], a[12:15], a[60:63], v[220:223]
  s_sub_u32 s35, s35, 1
  v_mfma_f32_16x16x32_bf16 v[228:231], a[16:19], a[60:63], v[228:231]
  s_cmp_lg_u32 s35, 0
  s_cbranch_scc1 Lp2r1_loop
  s_waitcnt vmcnt(10) lgkmcnt(0)
  s_barrier
  s_and_b32 s24, s2, 7
  s_lshr_b32 s4, s2, 6
  s_lshl_b32 s4, s4, 3
  s_add_u32 s24, s24, s4
  s_lshr_b32 s25, s2, 3
  s_and_b32 s25, s25, 7
  s_lshr_b32 s34, s24, 1
  s_lshl_b32 s34, s34, 11
  v_and_b32 v3, 15, v1
  v_lshlrev_b32 v3, 7, v3
  v_mfma_f32_16x16x32_bf16 v[128:131], a[64:67], a[20:23], v[128:131]
  buffer_load_dwordx2 v[4:5], v3, s[96:99], s34 offen sc1
  ds_read_b128 a[0:3], v22 offset:0
  v_mfma_f32_16x16x32_bf16 v[136:139], a[64:67], a[24:27], v[136:139]
  ds_read_b64_tr_b16 a[40:41], v26 offset:18432
  v_mfma_f32_16x16x32_bf16 v[144:147], a[64:67], a[28:31], v[144:147]
  ds_read_b64_tr_b16 a[42:43], v26 offset:20480
  v_mfma_f32_16x16x32_bf16 v[152:155], a[64:67], a[32:35], v[152:155]
  ds_read_b128 a[4:7], v22 offset:2048
  v_mfma_f32_16x16x32_bf16 v[132:135], a[68:71], a[20:23], v[132:135]
  ds_read_b128 a[8:11], v22 offset:4096
  v_mfma_f32_16x16x32_bf16 v[140:143], a[68:71], a[24:27], v[140:143]
  ds_read_b128 a[12:15], v22 offset:6144
  v_mfma_f32_16x16x32_bf16 v[148:151], a[68:71], a[28:31], v[148:151]
  ds_read_b64_tr_b16 a[44:45], v27 offset:18432
  v_mfma_f32_16x16x32_bf16 v[156:159], a[68:71], a[32:35], v[156:159]
  ds_read_b64_tr_b16 a[46:47], v27 offset:20480
  v_mfma_f32_16x16x32_bf16 v[160:163], a[72:75], a[20:23], v[160:163]
  ds_read_b64_tr_b16 a[48:49], v26 offset:26624
  v_mfma_f32_16x16x32_bf16 v[168:171], a[72:75], a[24:27], v[168:171]
  ds_read_b64_tr_b16 a[50:51], v26 offset:28672
  v_mfma_f32_16x16x32_bf16 v[176:179], a[72:75], a[28:31], v[176:179]
  ds_read_b64_tr_b16 a[52:53], v27 offset:26624
  v_mfma_f32_16x16x32_bf16 v[184:187], a[72:75], a[32:35], v[184:187]
  ds_read_b64_tr_b16 a[54:55], v27 offset:28672
  v_mfma_f32_16x16x32_bf16 v[164:167], a[76:79], a[20:23], v[164:167]
  ds_read_b64_tr_b16 a[56:57], v26 offset:34816
  v_mfma_f32_16x16x32_bf16 v[172:175], a[76:79], a[24:27], v[172:175]
  ds_read_b64_tr_b16 a[58:59], v26 offset:36864
  v_mfma_f32_16x16x32_bf16 v[180:183], a[76:79], a[28:31], v[180:183]
  ds_read_b128 a[16:19], v24 offset:0
  v_mfma_f32_16x16x32_bf16 v[188:191], a[76:79], a[32:35], v[188:191]
  ds_read_b64_tr_b16 a[60:61], v27 offset:34816
  v_mfma_f32_16x16x32_bf16 v[192:195], a[20:23], a[80:83], v[192:195]
  ds_read_b64_tr_b16 a[62:63], v27 offset:36864
  v_mfma_f32_16x16x32_bf16 v[200:203], a[24:27], a[80:83], v[200:203]
  v_mfma_f32_16x16x32_bf16 v[208:211], a[28:31], a[80:83], v[208:211]
  v_mfma_f32_16x16x32_bf16 v[216:219], a[32:35], a[80:83], v[216:219]
  v_mfma_f32_16x16x32_bf16 v[224:227], a[36:39], a[80:83], v[224:227]
  v_mfma_f32_16x16x32_bf16 v[196:199], a[20:23], a[84:87], v[196:199]
  v_mfma_f32_16x16x32_bf16 v[204:207], a[24:27], a[84:87], v[204:207]
  v_mfma_f32_16x16x32_bf16 v[212:215], a[28:31], a[84:87], v[212:215]
  v_mfma_f32_16x16x32_bf16 v[220:223], a[32:35], a[84:87], v[220:223]
  v_mfma_f32_16x16x32_bf16 v[228:231], a[36:39], a[84:87], v[228:231]
  s_waitcnt lgkmcnt(0)
  v_mfma_f32_16x16x32_bf16 v[128:131], a[40:43], a[0:3], v[128:131]
  s_add_u32 s88, s88, s90
  s_add_u32 s89, s89, 1
  ds_read_b128 a[20:23], v23 offset:0
  v_mfma_f32_16x16x32_bf16 v[136:139], a[40:43], a[4:7], v[136:139]
  s_cmp_eq_u32 s89, 3
  s_cselect_b32 s89, 0, s89
  s_cselect_b32 s90, s91, s92
  ds_read_b64_tr_b16 a[64:65], v26 offset:22528
  v_mfma_f32_16x16x32_bf16 v[144:147], a[40:43], a[8:11], v[144:147]
  ds_read_b64_tr_b16 a[66:67], v26 offset:24576
  v_mfma_f32_16x16x32_bf16 v[152:155], a[40:43], a[12:15], v[152:155]
  ds_read_b128 a[24:27], v23 offset:2048
  v_mfma_f32_16x16x32_bf16 v[132:135], a[44:47], a[0:3], v[132:135]
  ds_read_b128 a[28:31], v23 offset:4096
  v_mfma_f32_16x16x32_bf16 v[140:143], a[44:47], a[4:7], v[140:143]
  ds_read_b128 a[32:35], v23 offset:6144
  v_mfma_f32_16x16x32_bf16 v[148:151], a[44:47], a[8:11], v[148:151]
  ds_read_b64_tr_b16 a[68:69], v27 offset:22528
  v_mfma_f32_16x16x32_bf16 v[156:159], a[44:47], a[12:15], v[156:159]
  ds_read_b64_tr_b16 a[70:71], v27 offset:24576
  v_mfma_f32_16x16x32_bf16 v[160:163], a[48:51], a[0:3], v[160:163]
  ds_read_b64_tr_b16 a[72:73], v26 offset:30720
  v_mfma_f32_16x16x32_bf16 v[168:171], a[48:51], a[4:7], v[168:171]
  ds_read_b64_tr_b16 a[74:75], v26 offset:32768
  v_mfma_f32_16x16x32_bf16 v[176:179], a[48:51], a[8:11], v[176:179]
  ds_read_b64_tr_b16 a[76:77], v27 offset:30720
  v_mfma_f32_16x16x32_bf16 v[184:187], a[48:51], a[12:15], v[184:187]
  ds_read_b64_tr_b16 a[78:79], v27 offset:32768
  v_mfma_f32_16x16x32_bf16 v[164:167], a[52:55], a[0:3], v[164:167]
  ds_read_b64_tr_b16 a[80:81], v26 offset:38912
  v_mfma_f32_16x16x32_bf16 v[172:175], a[52:55], a[4:7], v[172:175]
  ds_read_b64_tr_b16 a[82:83], v26 offset:40960
  v_mfma_f32_16x16x32_bf16 v[180:183], a[52:55], a[8:11], v[180:183]
  ds_read_b128 a[36:39], v25 offset:0
  v_mfma_f32_16x16x32_bf16 v[188:191], a[52:55], a[12:15], v[188:191]
  ds_read_b64_tr_b16 a[84:85], v27 offset:38912
  v_mfma_f32_16x16x32_bf16 v[192:195], a[0:3], a[56:59], v[192:195]
  ds_read_b64_tr_b16 a[86:87], v27 offset:40960
  v_mfma_f32_16x16x32_bf16 v[200:203], a[4:7], a[56:59], v[200:203]
  v_add_u32 v22, s90, v22
  v_add_u32 v23, s90, v23
  v_mfma_f32_16x16x32_bf16 v[208:211], a[8:11], a[56:59], v[208:211]
  v_add_u32 v24, s90, v24
  v_add_u32 v25, s90, v25
  v_mfma_f32_16x16x32_bf16 v[216:219], a[12:15], a[56:59], v[216:219]
  v_add_u32 v26, s90, v26
  v_add_u32 v27, s90, v27
  v_mfma_f32_16x16x32_bf16 v[224:227], a[16:19], a[56:59], v[224:227]
  v_mfma_f32_16x16x32_bf16 v[196:199], a[0:3], a[60:63], v[196:199]
  v_mfma_f32_16x16x32_bf16 v[204:207], a[4:7], a[60:63], v[204:207]
  v_mfma_f32_16x16x32_bf16 v[212:215], a[8:11], a[60:63], v[212:215]
  v_mfma_f32_16x16x32_bf16 v[220:223], a[12:15], a[60:63], v[220:223]
  v_mfma_f32_16x16x32_bf16 v[228:231], a[16:19], a[60:63], v[228:231]
  s_waitcnt vmcnt(0) lgkmcnt(0)
  s_barrier
  s_mov_b32 s5, 0x40000
Lpoll_15:
  v_cmp_ne_u64 vcc, s[94:95], v[4:5]
  s_nop 0
  s_cbranch_vccz Lpolld_16
  s_sleep 4
  buffer_load_dwordx2 v[4:5], v3, s[96:99], s34 offen sc1
  s_sub_u32 s5, s5, 1
  s_waitcnt vmcnt(0)
  s_cbranch_scc0 Lpoll_15
Lpolld_16:
  s_lshl_b32 s4, s24, 20
  s_lshl_b32 s5, s25, 16
  s_sub_u32 s5, 1048576, s5
  s_add_u32 s20, s86, 16777216
  s_addc_u32 s21, s87, 0
  s_add_u32 s20, s20, s4
  s_addc_u32 s21, s21, 0
  s_mov_b32 s22, s5
  s_mov_b32 s23, 0x00020000
  s_lshl_b32 s26, s3, 12
  s_add_u32 s27, s26, 0x18000
  s_mov_b32 s28, s26
  s_add_u32 s29, s26, 0x4000
  s_mov_b32 s8, s86
  s_mov_b32 s9, s87
  s_mov_b32 s10, 16777216
  s_mov_b32 s11, 0x00020000
  s_lshl_b32 s4, s24, 15
  s_lshl_b32 s5, s3, 13
  s_add_u32 s4, s4, s5
  s_lshl_b32 s5, s25, 20
  s_add_u32 s6, s4, s5
  s_sub_u32 s7, s4, s5
  s_add_u32 s7, s7, 15728640
  v_mfma_f32_16x16x32_bf16 v[128:131], a[64:67], a[20:23], v[128:131]
  s_mov_b32 m0, s26
  ds_read_b128 a[0:3], v22 offset:0
  v_mfma_f32_16x16x32_bf16 v[136:139], a[64:67], a[24:27], v[136:139]
  buffer_load_dwordx4 v2, s[20:23], s28 offen offset:0 lds
  ds_read_b64_tr_b16 a[40:41], v26 offset:18432
  v_mfma_f32_16x16x32_bf16 v[144:147], a[64:67], a[28:31], v[144:147]
  buffer_load_dwordx4 v2, s[20:23], s28 offen offset:1024 lds
  ds_read_b64_tr_b16 a[42:43], v26 offset:20480
  v_mfma_f32_16x16x32_bf16 v[152:155], a[64:67], a[32:35], v[152:155]
  ds_read_b128 a[4:7], v22 offset:2048
  v_mfma_f32_16x16x32_bf16 v[132:135], a[68:71], a[20:23], v[132:135]
  ds_read_b128 a[8:11], v22 offset:4096
  v_mfma_f32_16x16x32_bf16 v[140:143], a[68:71], a[24:27], v[140:143]
  buffer_load_dwordx4 v2, s[20:23], s28 offen offset:2048 lds
  ds_read_b128 a[12:15], v22 offset:6144
  v_mfma_f32_16x16x32_bf16 v[148:151], a[68:71], a[28:31], v[148:151]
  ds_read_b64_tr_b16 a[44:45], v27 offset:18432
  v_mfma_f32_16x16x32_bf16 v[156:159], a[68:71], a[32:35], v[156:159]
  buffer_load_dwordx4 v2, s[20:23], s28 offen offset:3072 lds
  ds_read_b64_tr_b16 a[46:47], v27 offset:20480
  v_mfma_f32_16x16x32_bf16 v[160:163], a[72:75], a[20:23], v[160:163]
  s_xor_b32 s26, s26, 0x4000
  s_add_u32 s28, s28, 0x8000
  s_add_u32 s5, s6, 0
  v_mfma_f32_16x16x32_bf16 v[168:171], a[72:75], a[24:27], v[168:171]
  ds_read_b64_tr_b16 a[48:49], v26 offset:26624
  ds_read_b64_tr_b16 a[50:51], v26 offset:28672
  v_mfma_f32_16x16x32_bf16 v[176:179], a[72:75], a[28:31], v[176:179]
  buffer_load_dwordx4 a[128:131], v2, s[8:11], s5 offen offset:0 sc1
  ds_read_b64_tr_b16 a[52:53], v27 offset:26624
  v_mfma_f32_16x16x32_bf16 v[184:187], a[72:75], a[32:35], v[184:187]
  ds_read_b64_tr_b16 a[54:55], v27 offset:28672
  v_mfma_f32_16x16x32_bf16 v[164:167], a[76:79], a[20:23], v[164:167]
  buffer_load_dwordx4 a[132:135], v2, s[8:11], s5 offen offset:1024 sc1
  ds_read_b64_tr_b16 a[56:57], v26 offset:34816
  v_mfma_f32_16x16x32_bf16 v[172:175], a[76:79], a[24:27], v[172:175]
  ds_read_b64_tr_b16 a[58:59], v26 offset:36864
  v_mfma_f32_16x16x32_bf16 v[180:183], a[76:79], a[28:31], v[180:183]
  ds_read_b128 a[16:19], v24 offset:0
  v_mfma_f32_16x16x32_bf16 v[188:191], a[76:79], a[32:35], v[188:191]
  buffer_load_dwordx4 a[136:139], v2, s[8:11], s5 offen offset:2048 sc1
  ds_read_b64_tr_b16 a[60:61], v27 offset:34816
  v_mfma_f32_16x16x32_bf16 v[192:195], a[20:23], a[80:83], v[192:195]
  ds_read_b64_tr_b16 a[62:63], v27 offset:36864
  v_mfma_f32_16x16x32_bf16 v[200:203], a[24:27], a[80:83], v[200:203]
  buffer_load_dwordx4 a[140:143], v2, s[8:11], s5 offen offset:3072 sc1
  v_mfma_f32_16x16x32_bf16 v[208:211], a[28:31], a[80:83], v[208:211]
  s_add_u32 s5, s6, 4096
  v_mfma_f32_16x16x32_bf16 v[216:219], a[32:35], a[80:83], v[216:219]
  v_mfma_f32_16x16x32_bf16 v[224:227], a[36:39], a[80:83], v[224:227]
  buffer_load_dwordx4 a[144:147], v2, s[8:11], s5 offen offset:0 sc1
  v_mfma_f32_16x16x32_bf16 v[196:199], a[20:23], a[84:87], v[196:199]
  v_mfma_f32_16x16x32_bf16 v[204:207], a[24:27], a[84:87], v[204:207]
  buffer_load_dwordx4 a[148:151], v2, s[8:11], s5 offen offset:1024 sc1
  v_mfma_f32_16x16x32_bf16 v[212:215], a[28:31], a[84:87], v[212:215]
  v_mfma_f32_16x16x32_bf16 v[220:223], a[32:35], a[84:87], v[220:223]
  v_mfma_f32_16x16x32_bf16 v[228:231], a[36:39], a[84:87], v[228:231]
  s_waitcnt lgkmcnt(0)
  v_mfma_f32_16x16x32_bf16 v[128:131], a[40:43], a[0:3], v[128:131]
  buffer_load_dwordx4 a[152:155], v2, s[8:11], s5 offen offset:2048 sc1
  ds_read_b128 a[20:23], v23 offset:0
  v_mfma_f32_16x16x32_bf16 v[136:139], a[40:43], a[4:7], v[136:139]
  ds_read_b64_tr_b16 a[64:65], v26 offset:22528
  v_mfma_f32_16x16x32_bf16 v[144:147], a[40:43], a[8:11], v[144:147]
  buffer_load_dwordx4 a[156:159], v2, s[8:11], s5 offen offset:3072 sc1
  ds_read_b64_tr_b16 a[66:67], v26 offset:24576
  v_mfma_f32_16x16x32_bf16 v[152:155], a[40:43], a[12:15], v[152:155]
  s_add_u32 s5, s7, 0
  ds_read_b128 a[24:27], v23 offset:2048
  v_mfma_f32_16x16x32_bf16 v[132:135], a[44:47], a[0:3], v[132:135]
  ds_read_b128 a[28:31], v23 offset:4096
  v_mfma_f32_16x16x32_bf16 v[140:143], a[44:47], a[4:7], v[140:143]
  buffer_load_dwordx4 a[160:163], v2, s[8:11], s5 offen offset:0 sc1
  ds_read_b128 a[32:35], v23 offset:6144
  v_mfma_f32_16x16x32_bf16 v[148:151], a[44:47], a[8:11], v[148:151]
  ds_read_b64_tr_b16 a[68:69], v27 offset:22528
  v_mfma_f32_16x16x32_bf16 v[156:159], a[44:47], a[12:15], v[156:159]
  buffer_load_dwordx4 a[164:167], v2, s[8:11], s5 offen offset:1024 sc1
  ds_read_b64_tr_b16 a[70:71], v27 offset:24576
  v_mfma_f32_16x16x32_bf16 v[160:163], a[48:51], a[0:3], v[160:163]
  ds_read_b64_tr_b16 a[72:73], v26 offset:30720
  v_mfma_f32_16x16x32_bf16 v[168:171], a[48:51], a[4:7], v[168:171]
  ds_read_b64_tr_b16 a[74:75], v26 offset:32768
  v_mfma_f32_16x16x32_bf16 v[176:179], a[48:51], a[8:11], v[176:179]
  buffer_load_dwordx4 a[168:171], v2, s[8:11], s5 offen offset:2048 sc1
  ds_read_b64_tr_b16 a[76:77], v27 offset:30720
  v_mfma_f32_16x16x32_bf16 v[184:187], a[48:51], a[12:15], v[184:187]
  ds_read_b64_tr_b16 a[78:79], v27 offset:32768
  v_mfma_f32_16x16x32_bf16 v[164:167], a[52:55], a[0:3], v[164:167]
  buffer_load_dwordx4 a[172:175], v2, s[8:11], s5 offen offset:3072 sc1
  ds_read_b64_tr_b16 a[80:81], v26 offset:38912
  v_mfma_f32_16x16x32_bf16 v[172:175], a[52:55], a[4:7], v[172:175]
  s_add_u32 s5, s7, 4096
  ds_read_b64_tr_b16 a[82:83], v26 offset:40960
  v_mfma_f32_16x16x32_bf16 v[180:183], a[52:55], a[8:11], v[180:183]
  ds_read_b128 a[36:39], v25 offset:0
  v_mfma_f32_16x16x32_bf16 v[188:191], a[52:55], a[12:15], v[188:191]
  buffer_load_dwordx4 a[176:179], v2, s[8:11], s5 offen offset:0 sc1
  ds_read_b64_tr_b16 a[84:85], v27 offset:38912
  v_mfma_f32_16x16x32_bf16 v[192:195], a[0:3], a[56:59], v[192:195]
  ds_read_b64_tr_b16 a[86:87], v27 offset:40960
  v_mfma_f32_16x16x32_bf16 v[200:203], a[4:7], a[56:59], v[200:203]
  buffer_load_dwordx4 a[180:183], v2, s[8:11], s5 offen offset:1024 sc1
  v_mfma_f32_16x16x32_bf16 v[208:211], a[8:11], a[56:59], v[208:211]
  v_mfma_f32_16x16x32_bf16 v[216:219], a[12:15], a[56:59], v[216:219]
  v_mfma_f32_16x16x32_bf16 v[224:227], a[16:19], a[56:59], v[224:227]
  buffer_load_dwordx4 a[184:187], v2, s[8:11], s5 offen offset:2048 sc1
  v_mfma_f32_16x16x32_bf16 v[196:199], a[0:3], a[60:63], v[196:199]
  v_mfma_f32_16x16x32_bf16 v[204:207], a[4:7], a[60:63], v[204:207]
  buffer_load_dwordx4 a[188:191], v2, s[8:11], s5 offen offset:3072 sc1
  v_mfma_f32_16x16x32_bf16 v[212:215], a[8:11], a[60:63], v[212:215]
  v_mfma_f32_16x16x32_bf16 v[220:223], a[12:15], a[60:63], v[220:223]
  v_mfma_f32_16x16x32_bf16 v[228:231], a[16:19], a[60:63], v[228:231]
  s_waitcnt lgkmcnt(0)
  s_barrier
  v_mfma_f32_16x16x32_bf16 v[128:131], a[64:67], a[20:23], v[128:131]
  s_mov_b32 m0, s26
  v_mfma_f32_16x16x32_bf16 v[136:139], a[64:67], a[24:27], v[136:139]
  buffer_load_dwordx4 v2, s[20:23], s28 offen offset:0 lds
  v_mfma_f32_16x16x32_bf16 v[144:147], a[64:67], a[28:31], v[144:147]
  v_mfma_f32_16x16x32_bf16 v[152:155], a[64:67], a[32:35], v[152:155]
  buffer_load_dwordx4 v2, s[20:23], s28 offen offset:1024 lds
  v_mfma_f32_16x16x32_bf16 v[132:135], a[68:71], a[20:23], v[132:135]
  v_mfma_f32_16x16x32_bf16 v[140:143], a[68:71], a[24:27], v[140:143]
  v_mfma_f32_16x16x32_bf16 v[148:151], a[68:71], a[28:31], v[148:151]
  buffer_load_dwordx4 v2, s[20:23], s28 offen offset:2048 lds
  v_mfma_f32_16x16x32_bf16 v[156:159], a[68:71], a[32:35], v[156:159]
  v_mfma_f32_16x16x32_bf16 v[160:163], a[72:75], a[20:23], v[160:163]
  v_mfma_f32_16x16x32_bf16 v[168:171], a[72:75], a[24:27], v[168:171]
  buffer_load_dwordx4 v2, s[20:23], s28 offen offset:3072 lds
  v_mfma_f32_16x16x32_bf16 v[176:179], a[72:75], a[28:31], v[176:179]
  s_xor_b32 s26, s26, 0x8000
  s_add_u32 s28, s28, 0x8000
  s_mov_b32 m0, s27
  v_mfma_f32_16x16x32_bf16 v[184:187], a[72:75], a[32:35], v[184:187]
  v_mfma_f32_16x16x32_bf16 v[164:167], a[76:79], a[20:23], v[164:167]
  buffer_load_dwordx4 v2, s[20:23], s29 offen offset:0 lds
  v_mfma_f32_16x16x32_bf16 v[172:175], a[76:79], a[24:27], v[172:175]
  v_mfma_f32_16x16x32_bf16 v[180:183], a[76:79], a[28:31], v[180:183]
  v_mfma_f32_16x16x32_bf16 v[188:191], a[76:79], a[32:35], v[188:191]
  buffer_load_dwordx4 v2, s[20:23], s29 offen offset:1024 lds
  v_mfma_f32_16x16x32_bf16 v[192:195], a[20:23], a[80:83], v[192:195]
  v_mfma_f32_16x16x32_bf16 v[200:203], a[24:27], a[80:83], v[200:203]
  v_mfma_f32_16x16x32_bf16 v[208:211], a[28:31], a[80:83], v[208:211]
  buffer_load_dwordx4 v2, s[20:23], s29 offen offset:2048 lds
  v_mfma_f32_16x16x32_bf16 v[216:219], a[32:35], a[80:83], v[216:219]
  v_mfma_f32_16x16x32_bf16 v[224:227], a[36:39], a[80:83], v[224:227]
  v_mfma_f32_16x16x32_bf16 v[196:199], a[20:23], a[84:87], v[196:199]
  buffer_load_dwordx4 v2, s[20:23], s29 offen offset:3072 lds
  v_mfma_f32_16x16x32_bf16 v[204:207], a[24:27], a[84:87], v[204:207]
  s_xor_b32 s27, s27, 0x4000
  s_add_u32 s29, s29, 0x8000
  v_mfma_f32_16x16x32_bf16 v[212:215], a[28:31], a[84:87], v[212:215]
  v_mfma_f32_16x16x32_bf16 v[220:223], a[32:35], a[84:87], v[220:223]
  v_mfma_f32_16x16x32_bf16 v[228:231], a[36:39], a[84:87], v[228:231]
  s_and_b32 s4, s3, 1
  s_mul_i32 s4, s4, 3072
  s_add_u32 s4, s4, 32768
  v_add_u32 v116, s4, v2
  v_cvt_pk_bf16_f32 v120, v224, v225
  v_cvt_pk_bf16_f32 v121, v226, v227
  s_nop 1
  v_cvt_pk_bf16_f32 v122, v228, v229
  v_cvt_pk_bf16_f32 v123, v230, v231
  ds_write_b128 v116, v[120:123] offset:2048
  v_and_b32 v117, 15, v1
  v_lshrrev_b32 v118, 4, v1
  v_lshlrev_b32 v118, 2, v118
  v_sub_u32 v117, v117, v118
  v_mov_b32 v118, 0xf149f2ca
  v_subrev_u32 v119, 0, v117
  v_and_b32 v104, 0x80000001, v119
  v_cmp_ne_u32 vcc, 0, v104
  s_nop 1
  v_cndmask_b32 v104, 0, v118, vcc
  v_add_u32 v119, 1, v119
  v_and_b32 v108, 0x80000001, v119
  v_cmp_ne_u32 vcc, 0x80000001, v108
  s_nop 1
  v_cndmask_b32 v108, 0, v118, vcc
  v_subrev_u32 v119, 1, v117
  v_and_b32 v105, 0x80000001, v119
  v_cmp_ne_u32 vcc, 0, v105
  s_nop 1
  v_cndmask_b32 v105, 0, v118, vcc
  v_add_u32 v119, 1, v119
  v_and_b32 v109, 0x80000001, v119
  v_cmp_ne_u32 vcc, 0x80000001, v109
  s_nop 1
  v_cndmask_b32 v109, 0, v118, vcc
  v_subrev_u32 v119, 2, v117
  v_and_b32 v106, 0x80000001, v119
  v_cmp_ne_u32 vcc, 0, v106
  s_nop 1
  v_cndmask_b32 v106, 0, v118, vcc
  v_add_u32 v119, 1, v119
  v_and_b32 v110, 0x80000001, v119
  v_cmp_ne_u32 vcc, 0x80000001, v110
  s_nop 1
  v_cndmask_b32 v110, 0, v118, vcc
  v_subrev_u32 v119, 3, v117
  v_and_b32 v107, 0x80000001, v119
  v_cmp_ne_u32 vcc, 0, v107
  s_nop 1
  v_cndmask_b32 v107, 0, v118, vcc
  v_add_u32 v119, 1, v119
  v_and_b32 v111, 0x80000001, v119
  v_cmp_ne_u32 vcc, 0x80000001, v111
  s_nop 1
  v_cndmask_b32 v111, 0, v118, vcc
  s_mov_b32 s6, 0x3e8293ee
  s_mov_b32 s7, s6
  v_pk_mul_f32 v[128:129], v[128:129], s[6:7]
  v_pk_mul_f32 v[130:131], v[130:131], s[6:7]
  v_pk_mul_f32 v[132:133], v[132:133], s[6:7]
  v_pk_mul_f32 v[134:135], v[134:135], s[6:7]
  v_cvt_pk_bf16_f32 v48, v128, v129
  v_cvt_pk_bf16_f32 v49, v130, v131
  v_cvt_pk_bf16_f32 v50, v132, v133
  v_cvt_pk_bf16_f32 v51, v134, v135
  v_pk_mul_f32 v[136:137], v[136:137], s[6:7]
  v_pk_mul_f32 v[138:139], v[138:139], s[6:7]
  v_pk_mul_f32 v[140:141], v[140:141], s[6:7]
  v_pk_mul_f32 v[142:143], v[142:143], s[6:7]
  v_cvt_pk_bf16_f32 v52, v136, v137
  v_cvt_pk_bf16_f32 v53, v138, v139
  v_cvt_pk_bf16_f32 v54, v140, v141
  v_cvt_pk_bf16_f32 v55, v142, v143
  v_pk_mul_f32 v[144:145], v[144:145], s[6:7]
  v_pk_mul_f32 v[146:147], v[146:147], s[6:7]
  v_pk_mul_f32 v[148:149], v[148:149], s[6:7]
  v_pk_mul_f32 v[150:151], v[150:151], s[6:7]
  v_cvt_pk_bf16_f32 v56, v144, v145
  v_cvt_pk_bf16_f32 v57, v146, v147
  v_cvt_pk_bf16_f32 v58, v148, v149
  v_cvt_pk_bf16_f32 v59, v150, v151
  v_pk_mul_f32 v[152:153], v[152:153], s[6:7]
  v_pk_mul_f32 v[154:155], v[154:155], s[6:7]
  v_pk_mul_f32 v[156:157], v[156:157], s[6:7]
  v_pk_mul_f32 v[158:159], v[158:159], s[6:7]
  v_cvt_pk_bf16_f32 v60, v152, v153
  v_cvt_pk_bf16_f32 v61, v154, v155
  v_cvt_pk_bf16_f32 v62, v156, v157
  v_cvt_pk_bf16_f32 v63, v158, v159
  v_cvt_pk_bf16_f32 v68, v160, v161
  v_cvt_pk_bf16_f32 v69, v162, v163
  v_cvt_pk_bf16_f32 v86, v192, v193
  v_cvt_pk_bf16_f32 v87, v194, v195
  v_cvt_pk_bf16_f32 v70, v164, v165
  v_cvt_pk_bf16_f32 v71, v166, v167
  v_cvt_pk_bf16_f32 v96, v196, v197
  v_cvt_pk_bf16_f32 v97, v198, v199
  v_cvt_pk_bf16_f32 v72, v168, v169
  v_cvt_pk_bf16_f32 v73, v170, v171
  v_cvt_pk_bf16_f32 v88, v200, v201
  v_cvt_pk_bf16_f32 v89, v202, v203
  v_cvt_pk_bf16_f32 v74, v172, v173
  v_cvt_pk_bf16_f32 v75, v174, v175
  v_cvt_pk_bf16_f32 v98, v204, v205
  v_cvt_pk_bf16_f32 v99, v206, v207
  v_cvt_pk_bf16_f32 v76, v176, v177
  v_cvt_pk_bf16_f32 v77, v178, v179
  v_cvt_pk_bf16_f32 v90, v208, v209
  v_cvt_pk_bf16_f32 v91, v210, v211
  v_cvt_pk_bf16_f32 v78, v180, v181
  v_cvt_pk_bf16_f32 v79, v182, v183
  v_cvt_pk_bf16_f32 v100, v212, v213
  v_cvt_pk_bf16_f32 v101, v214, v215
  v_cvt_pk_bf16_f32 v80, v184, v185
  v_cvt_pk_bf16_f32 v81, v186, v187
  v_cvt_pk_bf16_f32 v92, v216, v217
  v_cvt_pk_bf16_f32 v93, v218, v219
  v_cvt_pk_bf16_f32 v82, v188, v189
  v_cvt_pk_bf16_f32 v83, v190, v191
  v_cvt_pk_bf16_f32 v102, v220, v221
  v_cvt_pk_bf16_f32 v103, v222, v223
  v_mov_b32 v120, 0x3f803f80
  v_mov_b32 v121, v120
  v_mov_b32 v122, v120
  v_mov_b32 v123, v120
  s_waitcnt lgkmcnt(0)
  s_barrier
  ds_read_b128 v[64:67], v116
  ds_read_b64 v[84:85], v116 offset:1024
  ds_read_b64 v[94:95], v116 offset:1032
  v_mfma_f32_16x16x32_bf16 v[40:43], v[76:79], v[60:63], v[108:111]
  v_mfma_f32_16x16x32_bf16 v[44:47], v[80:83], v[60:63], v[104:107]
  v_mfma_f32_16x16x32_bf16 v[32:35], v[72:75], v[56:59], v[108:111]
  v_mfma_f32_16x16x32_bf16 v[36:39], v[76:79], v[56:59], v[104:107]
  v_mfma_f32_16x16x32_bf16 v[24:27], v[68:71], v[52:55], v[108:111]
  v_mfma_f32_16x16x32_bf16 v[28:31], v[72:75], v[52:55], v[104:107]
  s_waitcnt lgkmcnt(0)
  v_mfma_f32_16x16x32_bf16 v[16:19], v[64:67], v[48:51], v[108:111]
  v_mfma_f32_16x16x32_bf16 v[20:23], v[68:71], v[48:51], v[104:107]
  v_max3_f32 v134, v40, v41, v42
  v_max3_f32 v135, v43, v44, v45
  v_max3_f32 v134, v134, v46, v47
  v_max_f32 v134, v134, v135
  v_max3_f32 v132, v32, v33, v34
  v_max3_f32 v133, v35, v36, v37
  v_max3_f32 v132, v132, v38, v39
  v_max_f32 v132, v132, v133
  v_max3_f32 v130, v24, v25, v26
  v_max3_f32 v131, v27, v28, v29
  v_max3_f32 v130, v130, v30, v31
  v_max_f32 v130, v130, v131
  v_max3_f32 v128, v16, v17, v18
  v_max3_f32 v129, v19, v20, v21
  v_max3_f32 v128, v128, v22, v23
  v_max_f32 v128, v128, v129
  v_mov_b32 v135, v134
  v_mov_b32 v133, v132
  v_mov_b32 v131, v130
  v_mov_b32 v129, v128
  v_permlane32_swap_b32 v134, v135
  v_permlane32_swap_b32 v132, v133
  v_permlane32_swap_b32 v130, v131
  v_permlane32_swap_b32 v128, v129
  v_max_f32 v134, v134, v135
  v_max_f32 v132, v132, v133
  v_max_f32 v130, v130, v131
  v_max_f32 v128, v128, v129
  v_mov_b32 v135, v134
  v_mov_b32 v133, v132
  v_mov_b32 v131, v130
  v_mov_b32 v129, v128
  v_permlane16_swap_b32 v134, v135
  v_permlane16_swap_b32 v132, v133
  v_permlane16_swap_b32 v130, v131
  v_permlane16_swap_b32 v128, v129
  v_max_f32 v134, v134, v135
  v_max_f32 v132, v132, v133
  v_max_f32 v130, v130, v131
  v_max_f32 v128, v128, v129
  v_sub_f32 v40, v40, v134
  v_sub_f32 v41, v41, v134
  v_sub_f32 v42, v42, v134
  v_sub_f32 v43, v43, v134
  v_sub_f32 v44, v44, v134
  v_sub_f32 v45, v45, v134
  v_sub_f32 v46, v46, v134
  v_sub_f32 v47, v47, v134
  v_exp_f32 v40, v40
  v_exp_f32 v41, v41
  v_exp_f32 v42, v42
  v_exp_f32 v43, v43
  v_exp_f32 v44, v44
  v_exp_f32 v45, v45
  v_exp_f32 v46, v46
  v_exp_f32 v47, v47
  v_sub_f32 v32, v32, v132
  v_sub_f32 v33, v33, v132
  v_sub_f32 v34, v34, v132
  v_sub_f32 v35, v35, v132
  v_sub_f32 v36, v36, v132
  v_sub_f32 v37, v37, v132
  v_sub_f32 v38, v38, v132
  v_sub_f32 v39, v39, v132
  v_exp_f32 v32, v32
  v_exp_f32 v33, v33
  v_exp_f32 v34, v34
  v_exp_f32 v35, v35
  v_exp_f32 v36, v36
  v_exp_f32 v37, v37
  v_exp_f32 v38, v38
  v_exp_f32 v39, v39
  v_sub_f32 v24, v24, v130
  v_sub_f32 v25, v25, v130
  v_sub_f32 v26, v26, v130
  v_sub_f32 v27, v27, v130
  v_sub_f32 v28, v28, v130
  v_sub_f32 v29, v29, v130
  v_sub_f32 v30, v30, v130
  v_sub_f32 v31, v31, v130
  v_exp_f32 v24, v24
  v_exp_f32 v25, v25
  v_exp_f32 v26, v26
  v_exp_f32 v27, v27
  v_exp_f32 v28, v28
  v_exp_f32 v29, v29
  v_exp_f32 v30, v30
  v_exp_f32 v31, v31
  v_sub_f32 v16, v16, v128
  v_sub_f32 v17, v17, v128
  v_sub_f32 v18, v18, v128
  v_sub_f32 v19, v19, v128
  v_sub_f32 v20, v20, v128
  v_sub_f32 v21, v21, v128
  v_sub_f32 v22, v22, v128
  v_sub_f32 v23, v23, v128
  v_exp_f32 v16, v16
  v_exp_f32 v17, v17
  v_exp_f32 v18, v18
  v_exp_f32 v19, v19
  v_exp_f32 v20, v20
  v_exp_f32 v21, v21
  v_exp_f32 v22, v22
  v_exp_f32 v23, v23
  v_cvt_pk_bf16_f32 v148, v40, v41
  v_cvt_pk_bf16_f32 v149, v42, v43
  v_cvt_pk_bf16_f32 v150, v44, v45
  v_cvt_pk_bf16_f32 v151, v46, v47
  v_cvt_pk_bf16_f32 v144, v32, v33
  v_cvt_pk_bf16_f32 v145, v34, v35
  v_cvt_pk_bf16_f32 v146, v36, v37
  v_cvt_pk_bf16_f32 v147, v38, v39
  v_cvt_pk_bf16_f32 v140, v24, v25
  v_cvt_pk_bf16_f32 v141, v26, v27
  v_cvt_pk_bf16_f32 v142, v28, v29
  v_cvt_pk_bf16_f32 v143, v30, v31
  v_cvt_pk_bf16_f32 v136, v16, v17
  v_cvt_pk_bf16_f32 v137, v18, v19
  v_cvt_pk_bf16_f32 v138, v20, v21
  v_cvt_pk_bf16_f32 v139, v22, v23
  v_mfma_f32_16x16x32_bf16 v[164:167], v[120:123], v[148:151], 0
  v_mfma_f32_16x16x32_bf16 v[192:195], v[90:93], v[148:151], 0
  v_mfma_f32_16x16x32_bf16 v[196:199], v[100:103], v[148:151], 0
  v_mfma_f32_16x16x32_bf16 v[160:163], v[120:123], v[144:147], 0
  v_mfma_f32_16x16x32_bf16 v[184:187], v[88:91], v[144:147], 0
  v_mfma_f32_16x16x32_bf16 v[188:191], v[98:101], v[144:147], 0
  v_mfma_f32_16x16x32_bf16 v[156:159], v[120:123], v[140:143], 0
  v_mfma_f32_16x16x32_bf16 v[176:179], v[86:89], v[140:143], 0
  v_mfma_f32_16x16x32_bf16 v[180:183], v[96:99], v[140:143], 0
  v_mfma_f32_16x16x32_bf16 v[152:155], v[120:123], v[136:139], 0
  v_mfma_f32_16x16x32_bf16 v[168:171], v[84:87], v[136:139], 0
  v_mfma_f32_16x16x32_bf16 v[172:175], v[94:97], v[136:139], 0
  s_add_u32 s16, s86, 83886080
  s_addc_u32 s17, s87, 0
  s_mov_b32 s18, 4194304
  s_mov_b32 s19, 0x00020000
  s_lshl_b32 s4, s32, 18
  s_lshl_b32 s5, s33, 14
  s_add_u32 s4, s4, s5
  s_and_b32 s5, s3, 1
  s_lshl_b32 s5, s5, 13
  s_add_u32 s4, s4, s5
  s_add_u32 s4, s4, 4096
  v_rcp_f32 v164, v164
  v_rcp_f32 v160, v160
  v_rcp_f32 v156, v156
  v_rcp_f32 v152, v152
  v_mov_b32 v165, v164
  v_mov_b32 v161, v160
  v_mov_b32 v157, v156
  v_mov_b32 v153, v152
  v_pk_mul_f32 v[192:193], v[192:193], v[164:165]
  v_pk_mul_f32 v[194:195], v[194:195], v[164:165]
  v_pk_mul_f32 v[196:197], v[196:197], v[164:165]
  v_pk_mul_f32 v[198:199], v[198:199], v[164:165]
  v_cvt_pk_bf16_f32 v192, v192, v193
  v_cvt_pk_bf16_f32 v193, v194, v195
  v_cvt_pk_bf16_f32 v194, v196, v197
  v_cvt_pk_bf16_f32 v195, v198, v199
  buffer_store_dwordx4 v[192:195], v2, s[16:19], s4 offen offset:3072 sc1
  v_pk_mul_f32 v[184:185], v[184:185], v[160:161]
  v_pk_mul_f32 v[186:187], v[186:187], v[160:161]
  v_pk_mul_f32 v[188:189], v[188:189], v[160:161]
  v_pk_mul_f32 v[190:191], v[190:191], v[160:161]
  v_cvt_pk_bf16_f32 v184, v184, v185
  v_cvt_pk_bf16_f32 v185, v186, v187
  v_cvt_pk_bf16_f32 v186, v188, v189
  v_cvt_pk_bf16_f32 v187, v190, v191
  buffer_store_dwordx4 v[184:187], v2, s[16:19], s4 offen offset:2048 sc1
  v_pk_mul_f32 v[176:177], v[176:177], v[156:157]
  v_pk_mul_f32 v[178:179], v[178:179], v[156:157]
  v_pk_mul_f32 v[180:181], v[180:181], v[156:157]
  v_pk_mul_f32 v[182:183], v[182:183], v[156:157]
  v_cvt_pk_bf16_f32 v176, v176, v177
  v_cvt_pk_bf16_f32 v177, v178, v179
  v_cvt_pk_bf16_f32 v178, v180, v181
  v_cvt_pk_bf16_f32 v179, v182, v183
  buffer_store_dwordx4 v[176:179], v2, s[16:19], s4 offen offset:1024 sc1
  v_pk_mul_f32 v[168:169], v[168:169], v[152:153]
  v_pk_mul_f32 v[170:171], v[170:171], v[152:153]
  v_pk_mul_f32 v[172:173], v[172:173], v[152:153]
  v_pk_mul_f32 v[174:175], v[174:175], v[152:153]
  v_cvt_pk_bf16_f32 v168, v168, v169
  v_cvt_pk_bf16_f32 v169, v170, v171
  v_cvt_pk_bf16_f32 v170, v172, v173
  v_cvt_pk_bf16_f32 v171, v174, v175
  buffer_store_dwordx4 v[168:171], v2, s[16:19], s4 offen offset:0 sc1
Lp5:
  s_lshl_b32 s91, s32, 4
  s_add_u32 s91, s91, s33
  s_lshl_b32 s91, s91, 7
  s_add_u32 s91, s91, 32768
  s_and_b32 s4, s2, 1
  s_lshl_b32 s4, s4, 3
  s_bfe_u32 s5, s2, 0x30003
  s_add_u32 s73, s4, s5
  s_bfe_u32 s4, s2, 0x10001
  s_lshl_b32 s4, s4, 2
  s_lshr_b32 s5, s2, 6
  s_add_u32 s76, s4, s5
  s_bfe_u32 s77, s2, 0x10002
  s_lshl_b32 s78, s73, 3
  s_add_u32 s78, s78, s76
  s_lshl_b32 s79, s3, 12
  s_add_u32 s64, s79, 131072
  s_lshl_b32 s4, s2, 2
  s_add_u32 s4, s4, s3
  s_lshl_b32 s6, s4, 13
  s_lshl_b32 s7, s4, 11
  s_mov_b32 s8, s74
  s_mov_b32 s9, s75
  s_mov_b32 s10, 8388608
  s_mov_b32 s11, 0x00020000
  s_mov_b32 s12, s80
  s_mov_b32 s13, s81
  s_mov_b32 s14, 2097152
  s_mov_b32 s15, 0x00020000
  s_add_u32 s16, s86, 67108864
  s_addc_u32 s17, s87, 0
  s_mov_b32 s18, 16777216
  s_mov_b32 s19, 0x00020000
  v_mov_b32 v3, v2
  v_add_u32 v4, 0x18000, v2
  v_mov_b32 v5, 0xf149f2ca
  s_mov_b32 s89, 0
  v_mov_b32 v6, 0x3f803f80
  v_accvgpr_write_b32 a208, v6
  v_accvgpr_write_b32 a209, v6
  v_accvgpr_write_b32 a210, v6
  v_accvgpr_write_b32 a211, v6
  v_accvgpr_write_b32 a192, 0
  v_accvgpr_write_b32 a193, 0
  v_accvgpr_write_b32 a194, 0
  v_accvgpr_write_b32 a195, 0
  v_accvgpr_write_b32 a196, 0
  v_accvgpr_write_b32 a197, 0
  v_accvgpr_write_b32 a198, 0
  v_accvgpr_write_b32 a199, 0
  v_accvgpr_write_b32 a200, 0
  v_accvgpr_write_b32 a201, 0
  v_accvgpr_write_b32 a202, 0
  v_accvgpr_write_b32 a203, 0
  v_accvgpr_write_b32 a204, 0
  v_accvgpr_write_b32 a205, 0
  v_accvgpr_write_b32 a206, 0
  v_accvgpr_write_b32 a207, 0
  v_mov_b32 v128, 0
  v_mov_b32 v129, 0
  v_mov_b32 v130, 0
  v_mov_b32 v131, 0
  v_mov_b32 v132, 0
  v_mov_b32 v133, 0
  v_mov_b32 v134, 0
  v_mov_b32 v135, 0
  v_mov_b32 v136, 0
  v_mov_b32 v137, 0
  v_mov_b32 v138, 0
  v_mov_b32 v139, 0
  v_mov_b32 v140, 0
  v_mov_b32 v141, 0
  v_mov_b32 v142, 0
  v_mov_b32 v143, 0
  v_mov_b32 v144, 0
  v_mov_b32 v145, 0
  v_mov_b32 v146, 0
  v_mov_b32 v147, 0
  v_mov_b32 v148, 0
  v_mov_b32 v149, 0
  v_mov_b32 v150, 0
  v_mov_b32 v151, 0
  v_mov_b32 v152, 0
  v_mov_b32 v153, 0
  v_mov_b32 v154, 0
  v_mov_b32 v155, 0
  v_mov_b32 v156, 0
  v_mov_b32 v157, 0
  v_mov_b32 v158, 0
  v_mov_b32 v159, 0
  v_mov_b32 v160, 0
  v_mov_b32 v161, 0
  v_mov_b32 v162, 0
  v_mov_b32 v163, 0
  v_mov_b32 v164, 0
  v_mov_b32 v165, 0
  v_mov_b32 v166, 0
  v_mov_b32 v167, 0
  v_mov_b32 v168, 0
  v_mov_b32 v169, 0
  v_mov_b32 v170, 0
  v_mov_b32 v171, 0
  v_mov_b32 v172, 0
  v_mov_b32 v173, 0
  v_mov_b32 v174, 0
  v_mov_b32 v175, 0
  v_mov_b32 v176, 0
  v_mov_b32 v177, 0
  v_mov_b32 v178, 0
  v_mov_b32 v179, 0
  v_mov_b32 v180, 0
  v_mov_b32 v181, 0
  v_mov_b32 v182, 0
  v_mov_b32 v183, 0
  v_mov_b32 v184, 0
  v_mov_b32 v185, 0
  v_mov_b32 v186, 0
  v_mov_b32 v187, 0
  v_mov_b32 v188, 0
  v_mov_b32 v189, 0
  v_mov_b32 v190, 0
  v_mov_b32 v191, 0
  v_mov_b32 v192, 0
  v_mov_b32 v193, 0
  v_mov_b32 v194, 0
  v_mov_b32 v195, 0
  v_mov_b32 v196, 0
  v_mov_b32 v197, 0
  v_mov_b32 v198, 0
  v_mov_b32 v199, 0
  v_mov_b32 v200, 0
  v_mov_b32 v201, 0
  v_mov_b32 v202, 0
  v_mov_b32 v203, 0
  v_mov_b32 v204, 0
  v_mov_b32 v205, 0
  v_mov_b32 v206, 0
  v_mov_b32 v207, 0
  v_mov_b32 v208, 0
  v_mov_b32 v209, 0
  v_mov_b32 v210, 0
  v_mov_b32 v211, 0
  v_mov_b32 v212, 0
  v_mov_b32 v213, 0
  v_mov_b32 v214, 0
  v_mov_b32 v215, 0
  v_mov_b32 v216, 0
  v_mov_b32 v217, 0
  v_mov_b32 v218, 0
  v_mov_b32 v219, 0
  v_mov_b32 v220, 0
  v_mov_b32 v221, 0
  v_mov_b32 v222, 0
  v_mov_b32 v223, 0
  v_mov_b32 v224, 0
  v_mov_b32 v225, 0
  v_mov_b32 v226, 0
  v_mov_b32 v227, 0
  v_mov_b32 v228, 0
  v_mov_b32 v229, 0
  v_mov_b32 v230, 0
  v_mov_b32 v231, 0
  v_mov_b32 v232, 0
  v_mov_b32 v233, 0
  v_mov_b32 v234, 0
  v_mov_b32 v235, 0
  v_mov_b32 v236, 0
  v_mov_b32 v237, 0
  v_mov_b32 v238, 0
  v_mov_b32 v239, 0
  v_mov_b32 v240, 0
  v_mov_b32 v241, 0
  v_mov_b32 v242, 0
  v_mov_b32 v243, 0
  v_mov_b32 v244, 0
  v_mov_b32 v245, 0
  v_mov_b32 v246, 0
  v_mov_b32 v247, 0
  v_mov_b32 v248, 0
  v_mov_b32 v249, 0
  v_mov_b32 v250, 0
  v_mov_b32 v251, 0
  v_mov_b32 v252, 0
  v_mov_b32 v253, 0
  v_mov_b32 v254, 0
  v_mov_b32 v255, 0
  v_and_b32 v6, 15, v1
  v_lshrrev_b32 v7, 4, v1
  v_sub_u32 v6, v6, v7
  v_lshlrev_b32 v6, 2, v6
  v_add_u32 v6, s3, v6
  v_cmp_gt_i32 s[32:33], 0, v6
  v_cmp_gt_i32 s[34:35], 1, v6
  v_cmp_gt_i32 s[36:37], 2, v6
  v_cmp_gt_i32 s[38:39], 3, v6
  v_cmp_gt_i32 s[40:41], 16, v6
  v_cmp_gt_i32 s[42:43], 17, v6
  v_cmp_gt_i32 s[44:45], 18, v6
  v_cmp_gt_i32 s[46:47], 19, v6
  v_cmp_gt_i32 s[48:49], 32, v6
  v_cmp_gt_i32 s[50:51], 33, v6
  v_cmp_gt_i32 s[52:53], 34, v6
  v_cmp_gt_i32 s[54:55], 35, v6
  v_cmp_gt_i32 s[56:57], 48, v6
  v_cmp_gt_i32 s[58:59], 49, v6
  v_cmp_gt_i32 s[60:61], 50, v6
  v_cmp_gt_i32 s[62:63], 51, v6
  s_mov_b32 s30, 0x8000
  s_mov_b32 s31, 0x4000
  s_waitcnt vmcnt(12)
  s_barrier
  ds_read_b128 a[32:35], v3 offset:0
  ds_read_b128 a[36:39], v3 offset:1024
  ds_read_b128 a[40:43], v3 offset:2048
  ds_read_b128 a[44:47], v3 offset:3072
  ds_read_b128 a[48:51], v3 offset:4096
  ds_read_b128 a[52:55], v3 offset:5120
  ds_read_b128 a[56:59], v3 offset:6144
  ds_read_b128 a[60:63], v3 offset:7168
  s_waitcnt lgkmcnt(6)
  v_mfma_f32_16x16x32_bf16 v[64:67], a[32:35], a[128:131], 0
  v_mfma_f32_16x16x32_bf16 v[72:75], a[32:35], a[144:147], 0
  v_mfma_f32_16x16x32_bf16 v[80:83], a[32:35], a[160:163], 0
  v_mfma_f32_16x16x32_bf16 v[88:91], a[32:35], a[176:179], 0
  ds_read_b128 a[0:3], v3 offset:8192
  v_mfma_f32_16x16x32_bf16 v[64:67], a[36:39], a[132:135], v[64:67]
  v_mfma_f32_16x16x32_bf16 v[72:75], a[36:39], a[148:151], v[72:75]
  v_mfma_f32_16x16x32_bf16 v[80:83], a[36:39], a[164:167], v[80:83]
  v_mfma_f32_16x16x32_bf16 v[88:91], a[36:39], a[180:183], v[88:91]
  ds_read_b128 a[4:7], v3 offset:9216
  s_waitcnt lgkmcnt(6)
  v_mfma_f32_16x16x32_bf16 v[64:67], a[40:43], a[136:139], v[64:67]
  v_mfma_f32_16x16x32_bf16 v[72:75], a[40:43], a[152:155], v[72:75]
  v_mfma_f32_16x16x32_bf16 v[80:83], a[40:43], a[168:171], v[80:83]
  v_mfma_f32_16x16x32_bf16 v[88:91], a[40:43], a[184:187], v[88:91]
  ds_read_b128 a[8:11], v3 offset:10240
  v_mfma_f32_16x16x32_bf16 v[64:67], a[44:47], a[140:143], v[64:67]
  v_mfma_f32_16x16x32_bf16 v[72:75], a[44:47], a[156:159], v[72:75]
  v_mfma_f32_16x16x32_bf16 v[80:83], a[44:47], a[172:175], v[80:83]
  v_mfma_f32_16x16x32_bf16 v[88:91], a[44:47], a[188:191], v[88:91]
  ds_read_b128 a[12:15], v3 offset:11264
  s_waitcnt lgkmcnt(6)
  v_mfma_f32_16x16x32_bf16 v[68:71], a[48:51], a[128:131], 0
  v_mfma_f32_16x16x32_bf16 v[76:79], a[48:51], a[144:147], 0
  v_mfma_f32_16x16x32_bf16 v[84:87], a[48:51], a[160:163], 0
  v_mfma_f32_16x16x32_bf16 v[92:95], a[48:51], a[176:179], 0
  ds_read_b128 a[16:19], v3 offset:12288
  v_mfma_f32_16x16x32_bf16 v[68:71], a[52:55], a[132:135], v[68:71]
  v_mfma_f32_16x16x32_bf16 v[76:79], a[52:55], a[148:151], v[76:79]
  v_mfma_f32_16x16x32_bf16 v[84:87], a[52:55], a[164:167], v[84:87]
  v_mfma_f32_16x16x32_bf16 v[92:95], a[52:55], a[180:183], v[92:95]
  ds_read_b128 a[20:23], v3 offset:13312
  s_waitcnt lgkmcnt(6)
  v_mfma_f32_16x16x32_bf16 v[68:71], a[56:59], a[136:139], v[68:71]
  v_mfma_f32_16x16x32_bf16 v[76:79], a[56:59], a[152:155], v[76:79]
  v_mfma_f32_16x16x32_bf16 v[84:87], a[56:59], a[168:171], v[84:87]
  v_mfma_f32_16x16x32_bf16 v[92:95], a[56:59], a[184:187], v[92:95]
  ds_read_b128 a[24:27], v3 offset:14336
  v_mfma_f32_16x16x32_bf16 v[68:71], a[60:63], a[140:143], v[68:71]
  v_mfma_f32_16x16x32_bf16 v[76:79], a[60:63], a[156:159], v[76:79]
  v_mfma_f32_16x16x32_bf16 v[84:87], a[60:63], a[172:175], v[84:87]
  v_mfma_f32_16x16x32_bf16 v[92:95], a[60:63], a[188:191], v[92:95]
  ds_read_b128 a[28:31], v3 offset:15360
  s_cmp_lg_u32 s25, 0
  s_nop 0
  s_cbranch_scc1 La_nomask0
  v_cndmask_b32 v64, v64, v5, s[32:33]
  v_cndmask_b32 v65, v65, v5, s[34:35]
  v_cndmask_b32 v66, v66, v5, s[36:37]
  v_cndmask_b32 v67, v67, v5, s[38:39]
  v_cndmask_b32 v68, v68, v5, s[40:41]
  v_cndmask_b32 v69, v69, v5, s[42:43]
  v_cndmask_b32 v70, v70, v5, s[44:45]
  v_cndmask_b32 v71, v71, v5, s[46:47]
La_nomask0:
  v_max3_f32 v6, v64, v65, v66
  v_max3_f32 v7, v67, v68, v69
  v_max3_f32 v6, v6, v70, v71
  v_max_f32 v6, v6, v7
  v_max3_f32 v8, v72, v73, v74
  v_max3_f32 v9, v75, v76, v77
  v_max3_f32 v8, v8, v78, v79
  v_max_f32 v8, v8, v9
  v_max3_f32 v10, v80, v81, v82
  v_max3_f32 v11, v83, v84, v85
  v_max3_f32 v10, v10, v86, v87
  v_max_f32 v10, v10, v11
  v_max3_f32 v12, v88, v89, v90
  v_max3_f32 v13, v91, v92, v93
  v_max3_f32 v12, v12, v94, v95
  v_max_f32 v12, v12, v13
  v_mov_b32 v7, v6
  v_mov_b32 v9, v8
  v_mov_b32 v11, v10
  v_mov_b32 v13, v12
  v_permlane32_swap_b32 v6, v7
  v_permlane32_swap_b32 v8, v9
  v_permlane32_swap_b32 v10, v11
  v_permlane32_swap_b32 v12, v13
  v_max_f32 v6, v6, v7
  v_max_f32 v8, v8, v9
  v_max_f32 v10, v10, v11
  v_max_f32 v12, v12, v13
  v_mov_b32 v7, v6
  v_mov_b32 v9, v8
  v_mov_b32 v11, v10
  v_mov_b32 v13, v12
  v_permlane16_swap_b32 v6, v7
  v_permlane16_swap_b32 v8, v9
  v_permlane16_swap_b32 v10, v11
  v_permlane16_swap_b32 v12, v13
  v_max_f32 v6, v6, v7
  v_max_f32 v8, v8, v9
  v_max_f32 v10, v10, v11
  v_max_f32 v12, v12, v13
  v_sub_f32 v16, 0, v6
  v_sub_f32 v17, 0, v6
  v_sub_f32 v18, 0, v6
  v_sub_f32 v19, 0, v6
  v_sub_f32 v20, 0, v8
  v_sub_f32 v21, 0, v8
  v_sub_f32 v22, 0, v8
  v_sub_f32 v23, 0, v8
  v_sub_f32 v24, 0, v10
  v_sub_f32 v25, 0, v10
  v_sub_f32 v26, 0, v10
  v_sub_f32 v27, 0, v10
  v_sub_f32 v28, 0, v12
  v_sub_f32 v29, 0, v12
  v_sub_f32 v30, 0, v12
  v_sub_f32 v31, 0, v12
  v_pk_add_f32 v[64:65], v[64:65], v[16:17]
  v_pk_add_f32 v[66:67], v[66:67], v[16:17]
  v_pk_add_f32 v[68:69], v[68:69], v[16:17]
  v_pk_add_f32 v[70:71], v[70:71], v[16:17]
  v_pk_add_f32 v[72:73], v[72:73], v[20:21]
  v_pk_add_f32 v[74:75], v[74:75], v[20:21]
  v_pk_add_f32 v[76:77], v[76:77], v[20:21]
  v_pk_add_f32 v[78:79], v[78:79], v[20:21]
  v_pk_add_f32 v[80:81], v[80:81], v[24:25]
  v_pk_add_f32 v[82:83], v[82:83], v[24:25]
  v_pk_add_f32 v[84:85], v[84:85], v[24:25]
  v_pk_add_f32 v[86:87], v[86:87], v[24:25]
  v_pk_add_f32 v[88:89], v[88:89], v[28:29]
  v_pk_add_f32 v[90:91], v[90:91], v[28:29]
  v_pk_add_f32 v[92:93], v[92:93], v[28:29]
  v_pk_add_f32 v[94:95], v[94:95], v[28:29]
  s_lshl_b32 s88, s25, 1
  s_waitcnt vmcnt(4)
  s_barrier
  s_waitcnt lgkmcnt(4)
  v_mfma_f32_16x16x32_bf16 v[96:99], a[0:3], a[128:131], v[16:19]
  s_mov_b32 m0, s26
  v_exp_f32 v64, v64
  v_mfma_f32_16x16x32_bf16 v[104:107], a[0:3], a[144:147], v[20:23]
  buffer_load_dwordx4 v2, s[20:23], s28 offen offset:0 lds
  v_exp_f32 v65, v65
  v_mfma_f32_16x16x32_bf16 v[112:115], a[0:3], a[160:163], v[24:27]
  buffer_load_dwordx4 v2, s[20:23], s28 offen offset:1024 lds
  v_exp_f32 v66, v66
  v_mfma_f32_16x16x32_bf16 v[120:123], a[0:3], a[176:179], v[28:31]
  buffer_load_dwordx4 v2, s[20:23], s28 offen offset:2048 lds
  v_exp_f32 v67, v67
  v_mfma_f32_16x16x32_bf16 v[96:99], a[4:7], a[132:135], v[96:99]
  v_exp_f32 v68, v68
  v_cvt_pk_bf16_f32 v32, v64, v65
  v_mfma_f32_16x16x32_bf16 v[104:107], a[4:7], a[148:151], v[104:107]
  buffer_load_dwordx4 v2, s[20:23], s28 offen offset:3072 lds
  v_exp_f32 v69, v69
  v_mfma_f32_16x16x32_bf16 v[112:115], a[4:7], a[164:167], v[112:115]
  s_xor_b32 s26, s26, 0x4000
  v_exp_f32 v70, v70
  v_cvt_pk_bf16_f32 v33, v66, v67
  v_mfma_f32_16x16x32_bf16 v[120:123], a[4:7], a[180:183], v[120:123]
  s_add_u32 s28, s28, 0x8000
  v_exp_f32 v71, v71
  v_cvt_pk_bf16_f32 v34, v68, v69
  v_mfma_f32_16x16x32_bf16 v[96:99], a[8:11], a[136:139], v[96:99]
  s_mov_b32 m0, s27
  v_exp_f32 v72, v72
  v_cvt_pk_bf16_f32 v35, v70, v71
  v_mfma_f32_16x16x32_bf16 v[104:107], a[8:11], a[152:155], v[104:107]
  buffer_load_dwordx4 v2, s[20:23], s29 offen offset:0 lds
  v_exp_f32 v73, v73
  v_mfma_f32_16x16x32_bf16 v[112:115], a[8:11], a[168:171], v[112:115]
  buffer_load_dwordx4 v2, s[20:23], s29 offen offset:1024 lds
  v_exp_f32 v74, v74
  v_mfma_f32_16x16x32_bf16 v[120:123], a[8:11], a[184:187], v[120:123]
  buffer_load_dwordx4 v2, s[20:23], s29 offen offset:2048 lds
  v_exp_f32 v75, v75
  v_mfma_f32_16x16x32_bf16 v[96:99], a[12:15], a[140:143], v[96:99]
  v_exp_f32 v76, v76
  v_cvt_pk_bf16_f32 v36, v72, v73
  v_mfma_f32_16x16x32_bf16 v[104:107], a[12:15], a[156:159], v[104:107]
  buffer_load_dwordx4 v2, s[20:23], s29 offen offset:3072 lds
  v_exp_f32 v77, v77
  v_mfma_f32_16x16x32_bf16 v[112:115], a[12:15], a[172:175], v[112:115]
  s_xor_b32 s27, s27, 0x8000
  v_exp_f32 v78, v78
  v_cvt_pk_bf16_f32 v37, v74, v75
  v_mfma_f32_16x16x32_bf16 v[120:123], a[12:15], a[188:191], v[120:123]
  s_waitcnt lgkmcnt(0)
  v_exp_f32 v79, v79
  v_cvt_pk_bf16_f32 v38, v76, v77
  v_mfma_f32_16x16x32_bf16 v[100:103], a[16:19], a[128:131], v[16:19]
  s_add_u32 s29, s29, 0x8000
  v_exp_f32 v80, v80
  v_cvt_pk_bf16_f32 v39, v78, v79
  v_mfma_f32_16x16x32_bf16 v[108:111], a[16:19], a[144:147], v[20:23]
  s_mov_b32 m0, s26
  v_exp_f32 v81, v81
  v_xor_b32 v3, 0x4000, v3
  v_mfma_f32_16x16x32_bf16 v[116:119], a[16:19], a[160:163], v[24:27]
  buffer_load_dwordx4 v2, s[20:23], s28 offen offset:0 lds
  v_exp_f32 v82, v82
  v_mfma_f32_16x16x32_bf16 v[124:127], a[16:19], a[176:179], v[28:31]
  buffer_load_dwordx4 v2, s[20:23], s28 offen offset:1024 lds
  v_exp_f32 v83, v83
  v_mfma_f32_16x16x32_bf16 v[100:103], a[20:23], a[132:135], v[100:103]
  buffer_load_dwordx4 v2, s[20:23], s28 offen offset:2048 lds
  v_exp_f32 v84, v84
  v_cvt_pk_bf16_f32 v41, v82, v83
  v_mfma_f32_16x16x32_bf16 v[108:111], a[20:23], a[148:151], v[108:111]
  buffer_load_dwordx4 v2, s[20:23], s28 offen offset:3072 lds
  v_exp_f32 v85, v85
  v_mfma_f32_16x16x32_bf16 v[116:119], a[20:23], a[164:167], v[116:119]
  s_xor_b32 s26, s26, 0x8000
  ds_read_b128 a[32:35], v3 offset:0
  v_exp_f32 v86, v86
  v_cvt_pk_bf16_f32 v42, v84, v85
  v_mfma_f32_16x16x32_bf16 v[124:127], a[20:23], a[180:183], v[124:127]
  s_add_u32 s28, s28, 0x8000
  v_exp_f32 v87, v87
  v_cvt_pk_bf16_f32 v40, v80, v81
  v_mfma_f32_16x16x32_bf16 v[100:103], a[24:27], a[136:139], v[100:103]
  s_mov_b32 m0, s27
  ds_read_b128 a[36:39], v3 offset:1024
  v_exp_f32 v88, v88
  v_cvt_pk_bf16_f32 v43, v86, v87
  v_mfma_f32_16x16x32_bf16 v[108:111], a[24:27], a[152:155], v[108:111]
  buffer_load_dwordx4 v2, s[20:23], s29 offen offset:0 lds
  v_exp_f32 v89, v89
  v_mfma_f32_16x16x32_bf16 v[116:119], a[24:27], a[168:171], v[116:119]
  buffer_load_dwordx4 v2, s[20:23], s29 offen offset:1024 lds
  v_exp_f32 v90, v90
  v_cvt_pk_bf16_f32 v44, v88, v89
  v_mfma_f32_16x16x32_bf16 v[124:127], a[24:27], a[184:187], v[124:127]
  buffer_load_dwordx4 v2, s[20:23], s29 offen offset:2048 lds
  v_exp_f32 v91, v91
  v_mfma_f32_16x16x32_bf16 v[100:103], a[28:31], a[140:143], v[100:103]
  buffer_load_dwordx4 v2, s[20:23], s29 offen offset:3072 lds
  v_exp_f32 v92, v92
  v_cvt_pk_bf16_f32 v45, v90, v91
  v_mfma_f32_16x16x32_bf16 v[108:111], a[28:31], a[156:159], v[108:111]
  s_xor_b32 s27, s27, 0x4000
  ds_read_b128 a[40:43], v3 offset:2048
  v_exp_f32 v93, v93
  v_mfma_f32_16x16x32_bf16 v[116:119], a[28:31], a[172:175], v[116:119]
  s_add_u32 s29, s29, 0x8000
  ds_read_b128 a[44:47], v3 offset:3072
  v_exp_f32 v94, v94
  v_cvt_pk_bf16_f32 v46, v92, v93
  v_mfma_f32_16x16x32_bf16 v[124:127], a[28:31], a[188:191], v[124:127]
  ds_read_b128 a[48:51], v3 offset:4096
  ds_read_b128 a[52:55], v3 offset:5120
  ds_read_b128 a[56:59], v3 offset:6144
  ds_read_b128 a[60:63], v3 offset:7168
  ds_read_b128 a[0:3], v4 offset:0
  ds_read_b128 a[4:7], v4 offset:1024
  ds_read_b128 a[8:11], v4 offset:2048
  v_exp_f32 v95, v95
  s_nop 0
  v_cvt_pk_bf16_f32 v47, v94, v95
  s_cmp_eq_u32 s25, 0
  s_cbranch_scc1 La_d1
  .p2align 6
La_lo:
  s_waitcnt lgkmcnt(7)
  v_mfma_f32_16x16x32_bf16 v[64:67], a[32:35], a[128:131], v[16:19]
  v_exp_f32 v96, v96
  v_mfma_f32_16x16x32_bf16 v[72:75], a[32:35], a[144:147], v[20:23]
  ds_read_b128 a[12:15], v4 offset:3072
  v_mfma_f32_16x16x32_bf16 v[80:83], a[32:35], a[160:163], v[24:27]
  v_exp_f32 v97, v97
  v_mfma_f32_16x16x32_bf16 v[88:91], a[32:35], a[176:179], v[28:31]
  v_cvt_pk_bf16_f32 v48, v96, v97
  v_mfma_f32_16x16x32_bf16 v[64:67], a[36:39], a[132:135], v[64:67]
  v_exp_f32 v98, v98
  v_mfma_f32_16x16x32_bf16 v[72:75], a[36:39], a[148:151], v[72:75]
  ds_read_b128 a[16:19], v4 offset:4096
  v_mfma_f32_16x16x32_bf16 v[80:83], a[36:39], a[164:167], v[80:83]
  v_exp_f32 v99, v99
  v_mfma_f32_16x16x32_bf16 v[88:91], a[36:39], a[180:183], v[88:91]
  v_cvt_pk_bf16_f32 v49, v98, v99
  v_mfma_f32_16x16x32_bf16 v[64:67], a[40:43], a[136:139], v[64:67]
  v_exp_f32 v100, v100
  v_mfma_f32_16x16x32_bf16 v[72:75], a[40:43], a[152:155], v[72:75]
  ds_read_b128 a[20:23], v4 offset:5120
  v_mfma_f32_16x16x32_bf16 v[80:83], a[40:43], a[168:171], v[80:83]
  v_exp_f32 v101, v101
  v_mfma_f32_16x16x32_bf16 v[88:91], a[40:43], a[184:187], v[88:91]
  v_cvt_pk_bf16_f32 v50, v100, v101
  v_mfma_f32_16x16x32_bf16 v[64:67], a[44:47], a[140:143], v[64:67]
  v_exp_f32 v102, v102
  v_mfma_f32_16x16x32_bf16 v[72:75], a[44:47], a[156:159], v[72:75]
  ds_read_b128 a[24:27], v4 offset:6144
  v_mfma_f32_16x16x32_bf16 v[80:83], a[44:47], a[172:175], v[80:83]
  v_exp_f32 v103, v103
  v_mfma_f32_16x16x32_bf16 v[88:91], a[44:47], a[188:191], v[88:91]
  s_waitcnt lgkmcnt(7)
  v_cvt_pk_bf16_f32 v51, v102, v103
  v_mfma_f32_16x16x32_bf16 v[68:71], a[48:51], a[128:131], v[16:19]
  v_exp_f32 v104, v104
  v_mfma_f32_16x16x32_bf16 v[76:79], a[48:51], a[144:147], v[20:23]
  ds_read_b128 a[28:31], v4 offset:7168
  v_mfma_f32_16x16x32_bf16 v[84:87], a[48:51], a[160:163], v[24:27]
  v_exp_f32 v105, v105
  v_mfma_f32_16x16x32_bf16 v[92:95], a[48:51], a[176:179], v[28:31]
  v_cvt_pk_bf16_f32 v52, v104, v105
  v_mfma_f32_16x16x32_bf16 v[68:71], a[52:55], a[132:135], v[68:71]
  v_exp_f32 v106, v106
  v_mfma_f32_16x16x32_bf16 v[76:79], a[52:55], a[148:151], v[76:79]
  ds_read_b128 a[32:35], v3 offset:8192
  v_mfma_f32_16x16x32_bf16 v[84:87], a[52:55], a[164:167], v[84:87]
  v_exp_f32 v107, v107
  v_mfma_f32_16x16x32_bf16 v[92:95], a[52:55], a[180:183], v[92:95]
  v_cvt_pk_bf16_f32 v53, v106, v107
  v_mfma_f32_16x16x32_bf16 v[68:71], a[56:59], a[136:139], v[68:71]
  v_exp_f32 v108, v108
  v_mfma_f32_16x16x32_bf16 v[76:79], a[56:59], a[152:155], v[76:79]
  ds_read_b128 a[36:39], v3 offset:9216
  v_mfma_f32_16x16x32_bf16 v[84:87], a[56:59], a[168:171], v[84:87]
  v_exp_f32 v109, v109
  v_mfma_f32_16x16x32_bf16 v[92:95], a[56:59], a[184:187], v[92:95]
  v_cvt_pk_bf16_f32 v54, v108, v109
  v_mfma_f32_16x16x32_bf16 v[68:71], a[60:63], a[140:143], v[68:71]
  v_exp_f32 v110, v110
  v_mfma_f32_16x16x32_bf16 v[76:79], a[60:63], a[156:159], v[76:79]
  ds_read_b128 a[40:43], v3 offset:10240
  v_mfma_f32_16x16x32_bf16 v[84:87], a[60:63], a[172:175], v[84:87]
  v_exp_f32 v111, v111
  v_mfma_f32_16x16x32_bf16 v[92:95], a[60:63], a[188:191], v[92:95]
  s_waitcnt lgkmcnt(7)
  v_cvt_pk_bf16_f32 v55, v110, v111
  v_mfma_f32_16x16x32_bf16 v[128:131], a[0:3], v[32:35], v[128:131]
  ds_read_b128 a[44:47], v3 offset:11264
  v_mfma_f32_16x16x32_bf16 v[160:163], a[0:3], v[36:39], v[160:163]
  v_exp_f32 v112, v112
  v_mfma_f32_16x16x32_bf16 v[192:195], a[0:3], v[40:43], v[192:195]
  s_sub_u32 s88, s88, 1
  v_mfma_f32_16x16x32_bf16 v[224:227], a[0:3], v[44:47], v[224:227]
  v_exp_f32 v113, v113
  v_mfma_f32_16x16x32_bf16 a[192:195], a[208:211], v[32:35], a[192:195]
  v_cvt_pk_bf16_f32 v56, v112, v113
  v_mfma_f32_16x16x32_bf16 v[132:135], a[4:7], v[32:35], v[132:135]
  v_exp_f32 v114, v114
  v_mfma_f32_16x16x32_bf16 v[164:167], a[4:7], v[36:39], v[164:167]
  ds_read_b128 a[48:51], v3 offset:12288
  v_mfma_f32_16x16x32_bf16 v[196:199], a[4:7], v[40:43], v[196:199]
  v_exp_f32 v115, v115
  v_mfma_f32_16x16x32_bf16 v[228:231], a[4:7], v[44:47], v[228:231]
  v_cvt_pk_bf16_f32 v57, v114, v115
  v_mfma_f32_16x16x32_bf16 a[196:199], a[208:211], v[36:39], a[196:199]
  v_exp_f32 v116, v116
  v_mfma_f32_16x16x32_bf16 v[136:139], a[8:11], v[32:35], v[136:139]
  ds_read_b128 a[52:55], v3 offset:13312
  v_mfma_f32_16x16x32_bf16 v[168:171], a[8:11], v[36:39], v[168:171]
  v_exp_f32 v117, v117
  v_mfma_f32_16x16x32_bf16 v[200:203], a[8:11], v[40:43], v[200:203]
  v_cvt_pk_bf16_f32 v58, v116, v117
  v_mfma_f32_16x16x32_bf16 v[232:235], a[8:11], v[44:47], v[232:235]
  v_exp_f32 v118, v118
  v_mfma_f32_16x16x32_bf16 a[200:203], a[208:211], v[40:43], a[200:203]
  v_mfma_f32_16x16x32_bf16 v[140:143], a[12:15], v[32:35], v[140:143]
  v_exp_f32 v119, v119
  v_mfma_f32_16x16x32_bf16 v[172:175], a[12:15], v[36:39], v[172:175]
  ds_read_b128 a[56:59], v3 offset:14336
  v_cvt_pk_bf16_f32 v59, v118, v119
  v_mfma_f32_16x16x32_bf16 v[204:207], a[12:15], v[40:43], v[204:207]
  v_exp_f32 v120, v120
  v_mfma_f32_16x16x32_bf16 v[236:239], a[12:15], v[44:47], v[236:239]
  v_mfma_f32_16x16x32_bf16 a[204:207], a[208:211], v[44:47], a[204:207]
  s_waitcnt lgkmcnt(7)
  v_exp_f32 v121, v121
  v_mfma_f32_16x16x32_bf16 v[144:147], a[16:19], v[32:35], v[144:147]
  ds_read_b128 a[60:63], v3 offset:15360
  v_cvt_pk_bf16_f32 v60, v120, v121
  v_mfma_f32_16x16x32_bf16 v[176:179], a[16:19], v[36:39], v[176:179]
  v_exp_f32 v122, v122
  v_mfma_f32_16x16x32_bf16 v[208:211], a[16:19], v[40:43], v[208:211]
  v_mfma_f32_16x16x32_bf16 v[240:243], a[16:19], v[44:47], v[240:243]
  v_exp_f32 v123, v123
  v_mfma_f32_16x16x32_bf16 v[148:151], a[20:23], v[32:35], v[148:151]
  ds_read_b128 a[0:3], v4 offset:8192
  v_cvt_pk_bf16_f32 v61, v122, v123
  v_mfma_f32_16x16x32_bf16 v[180:183], a[20:23], v[36:39], v[180:183]
  v_exp_f32 v124, v124
  v_mfma_f32_16x16x32_bf16 v[212:215], a[20:23], v[40:43], v[212:215]
  v_mfma_f32_16x16x32_bf16 v[244:247], a[20:23], v[44:47], v[244:247]
  v_exp_f32 v125, v125
  v_mfma_f32_16x16x32_bf16 v[152:155], a[24:27], v[32:35], v[152:155]
  ds_read_b128 a[4:7], v4 offset:9216
  v_cvt_pk_bf16_f32 v62, v124, v125
  v_mfma_f32_16x16x32_bf16 v[184:187], a[24:27], v[36:39], v[184:187]
  v_exp_f32 v126, v126
  v_mfma_f32_16x16x32_bf16 v[216:219], a[24:27], v[40:43], v[216:219]
  v_mfma_f32_16x16x32_bf16 v[248:251], a[24:27], v[44:47], v[248:251]
  v_exp_f32 v127, v127
  v_mfma_f32_16x16x32_bf16 v[156:159], a[28:31], v[32:35], v[156:159]
  ds_read_b128 a[8:11], v4 offset:10240
  v_cvt_pk_bf16_f32 v63, v126, v127
  v_mfma_f32_16x16x32_bf16 v[188:191], a[28:31], v[36:39], v[188:191]
  v_mfma_f32_16x16x32_bf16 v[220:223], a[28:31], v[40:43], v[220:223]
  v_mfma_f32_16x16x32_bf16 v[252:255], a[28:31], v[44:47], v[252:255]
  s_cmp_eq_u32 s88, 0
  s_cbranch_scc1 La_d0
  s_waitcnt vmcnt(8)
  s_barrier
  s_waitcnt lgkmcnt(7)
  v_mfma_f32_16x16x32_bf16 v[96:99], a[32:35], a[128:131], v[16:19]
  s_mov_b32 m0, s26
  v_exp_f32 v64, v64
  v_mfma_f32_16x16x32_bf16 v[104:107], a[32:35], a[144:147], v[20:23]
  buffer_load_dwordx4 v2, s[20:23], s28 offen offset:0 lds
  ds_read_b128 a[12:15], v4 offset:11264
  v_mfma_f32_16x16x32_bf16 v[112:115], a[32:35], a[160:163], v[24:27]
  v_exp_f32 v65, v65
  v_mfma_f32_16x16x32_bf16 v[120:123], a[32:35], a[176:179], v[28:31]
  v_cvt_pk_bf16_f32 v32, v64, v65
  v_mfma_f32_16x16x32_bf16 v[96:99], a[36:39], a[132:135], v[96:99]
  v_exp_f32 v66, v66
  v_mfma_f32_16x16x32_bf16 v[104:107], a[36:39], a[148:151], v[104:107]
  ds_read_b128 a[16:19], v4 offset:12288
  v_mfma_f32_16x16x32_bf16 v[112:115], a[36:39], a[164:167], v[112:115]
  v_exp_f32 v67, v67
  v_mfma_f32_16x16x32_bf16 v[120:123], a[36:39], a[180:183], v[120:123]
  v_cvt_pk_bf16_f32 v33, v66, v67
  v_mfma_f32_16x16x32_bf16 v[96:99], a[40:43], a[136:139], v[96:99]
  v_exp_f32 v68, v68
  v_mfma_f32_16x16x32_bf16 v[104:107], a[40:43], a[152:155], v[104:107]
  buffer_load_dwordx4 v2, s[20:23], s28 offen offset:1024 lds
  ds_read_b128 a[20:23], v4 offset:13312
  v_mfma_f32_16x16x32_bf16 v[112:115], a[40:43], a[168:171], v[112:115]
  v_exp_f32 v69, v69
  v_mfma_f32_16x16x32_bf16 v[120:123], a[40:43], a[184:187], v[120:123]
  v_cvt_pk_bf16_f32 v34, v68, v69
  v_mfma_f32_16x16x32_bf16 v[96:99], a[44:47], a[140:143], v[96:99]
  v_exp_f32 v70, v70
  v_mfma_f32_16x16x32_bf16 v[104:107], a[44:47], a[156:159], v[104:107]
  ds_read_b128 a[24:27], v4 offset:14336
  v_mfma_f32_16x16x32_bf16 v[112:115], a[44:47], a[172:175], v[112:115]
  v_exp_f32 v71, v71
  v_mfma_f32_16x16x32_bf16 v[120:123], a[44:47], a[188:191], v[120:123]
  s_waitcnt lgkmcnt(7)
  v_cvt_pk_bf16_f32 v35, v70, v71
  v_mfma_f32_16x16x32_bf16 v[100:103], a[48:51], a[128:131], v[16:19]
  v_exp_f32 v72, v72
  v_mfma_f32_16x16x32_bf16 v[108:111], a[48:51], a[144:147], v[20:23]
  buffer_load_dwordx4 v2, s[20:23], s28 offen offset:2048 lds
  ds_read_b128 a[28:31], v4 offset:15360
  v_mfma_f32_16x16x32_bf16 v[116:119], a[48:51], a[160:163], v[24:27]
  v_exp_f32 v73, v73
  v_mfma_f32_16x16x32_bf16 v[124:127], a[48:51], a[176:179], v[28:31]
  v_xor_b32 v3, s30, v3
  v_cvt_pk_bf16_f32 v36, v72, v73
  v_mfma_f32_16x16x32_bf16 v[100:103], a[52:55], a[132:135], v[100:103]
  v_exp_f32 v74, v74
  v_mfma_f32_16x16x32_bf16 v[108:111], a[52:55], a[148:151], v[108:111]
  ds_read_b128 a[32:35], v3 offset:0
  v_mfma_f32_16x16x32_bf16 v[116:119], a[52:55], a[164:167], v[116:119]
  v_exp_f32 v75, v75
  v_mfma_f32_16x16x32_bf16 v[124:127], a[52:55], a[180:183], v[124:127]
  v_cvt_pk_bf16_f32 v37, v74, v75
  v_mfma_f32_16x16x32_bf16 v[100:103], a[56:59], a[136:139], v[100:103]
  v_exp_f32 v76, v76
  v_mfma_f32_16x16x32_bf16 v[108:111], a[56:59], a[152:155], v[108:111]
  buffer_load_dwordx4 v2, s[20:23], s28 offen offset:3072 lds
  ds_read_b128 a[36:39], v3 offset:1024
  v_mfma_f32_16x16x32_bf16 v[116:119], a[56:59], a[168:171], v[116:119]
  s_xor_b32 s26, s26, s31
  v_exp_f32 v77, v77
  v_mfma_f32_16x16x32_bf16 v[124:127], a[56:59], a[184:187], v[124:127]
  s_add_u32 s28, s28, 0x8000
  s_mov_b32 m0, s27
  v_cvt_pk_bf16_f32 v38, v76, v77
  v_mfma_f32_16x16x32_bf16 v[100:103], a[60:63], a[140:143], v[100:103]
  v_exp_f32 v78, v78
  v_mfma_f32_16x16x32_bf16 v[108:111], a[60:63], a[156:159], v[108:111]
  ds_read_b128 a[40:43], v3 offset:2048
  v_mfma_f32_16x16x32_bf16 v[116:119], a[60:63], a[172:175], v[116:119]
  v_exp_f32 v79, v79
  v_mfma_f32_16x16x32_bf16 v[124:127], a[60:63], a[188:191], v[124:127]
  s_waitcnt lgkmcnt(7)
  v_cvt_pk_bf16_f32 v39, v78, v79
  v_mfma_f32_16x16x32_bf16 v[128:131], a[0:3], v[48:51], v[128:131]
  ds_read_b128 a[44:47], v3 offset:3072
  v_mfma_f32_16x16x32_bf16 v[160:163], a[0:3], v[52:55], v[160:163]
  v_exp_f32 v80, v80
  v_mfma_f32_16x16x32_bf16 v[192:195], a[0:3], v[56:59], v[192:195]
  buffer_load_dwordx4 v2, s[20:23], s29 offen offset:0 lds
  v_mfma_f32_16x16x32_bf16 v[224:227], a[0:3], v[60:63], v[224:227]
  v_exp_f32 v81, v81
  v_mfma_f32_16x16x32_bf16 a[192:195], a[208:211], v[48:51], a[192:195]
  v_cvt_pk_bf16_f32 v40, v80, v81
  v_mfma_f32_16x16x32_bf16 v[132:135], a[4:7], v[48:51], v[132:135]
  v_exp_f32 v82, v82
  v_mfma_f32_16x16x32_bf16 v[164:167], a[4:7], v[52:55], v[164:167]
  ds_read_b128 a[48:51], v3 offset:4096
  v_mfma_f32_16x16x32_bf16 v[196:199], a[4:7], v[56:59], v[196:199]
  v_exp_f32 v83, v83
  v_mfma_f32_16x16x32_bf16 v[228:231], a[4:7], v[60:63], v[228:231]
  v_cvt_pk_bf16_f32 v41, v82, v83
  v_mfma_f32_16x16x32_bf16 a[196:199], a[208:211], v[52:55], a[196:199]
  v_exp_f32 v84, v84
  v_mfma_f32_16x16x32_bf16 v[136:139], a[8:11], v[48:51], v[136:139]
  buffer_load_dwordx4 v2, s[20:23], s29 offen offset:1024 lds
  ds_read_b128 a[52:55], v3 offset:5120
  v_mfma_f32_16x16x32_bf16 v[168:171], a[8:11], v[52:55], v[168:171]
  v_exp_f32 v85, v85
  v_mfma_f32_16x16x32_bf16 v[200:203], a[8:11], v[56:59], v[200:203]
  v_cvt_pk_bf16_f32 v42, v84, v85
  v_mfma_f32_16x16x32_bf16 v[232:235], a[8:11], v[60:63], v[232:235]
  v_exp_f32 v86, v86
  v_mfma_f32_16x16x32_bf16 a[200:203], a[208:211], v[56:59], a[200:203]
  v_mfma_f32_16x16x32_bf16 v[140:143], a[12:15], v[48:51], v[140:143]
  v_exp_f32 v87, v87
  v_mfma_f32_16x16x32_bf16 v[172:175], a[12:15], v[52:55], v[172:175]
  ds_read_b128 a[56:59], v3 offset:6144
  v_cvt_pk_bf16_f32 v43, v86, v87
  v_mfma_f32_16x16x32_bf16 v[204:207], a[12:15], v[56:59], v[204:207]
  v_exp_f32 v88, v88
  v_mfma_f32_16x16x32_bf16 v[236:239], a[12:15], v[60:63], v[236:239]
  buffer_load_dwordx4 v2, s[20:23], s29 offen offset:2048 lds
  v_mfma_f32_16x16x32_bf16 a[204:207], a[208:211], v[60:63], a[204:207]
  s_waitcnt lgkmcnt(7)
  v_exp_f32 v89, v89
  v_mfma_f32_16x16x32_bf16 v[144:147], a[16:19], v[48:51], v[144:147]
  ds_read_b128 a[60:63], v3 offset:7168
  v_cvt_pk_bf16_f32 v44, v88, v89
  v_mfma_f32_16x16x32_bf16 v[176:179], a[16:19], v[52:55], v[176:179]
  v_exp_f32 v90, v90
  v_mfma_f32_16x16x32_bf16 v[208:211], a[16:19], v[56:59], v[208:211]
  v_mfma_f32_16x16x32_bf16 v[240:243], a[16:19], v[60:63], v[240:243]
  v_exp_f32 v91, v91
  v_mfma_f32_16x16x32_bf16 v[148:151], a[20:23], v[48:51], v[148:151]
  v_xor_b32 v4, s31, v4
  v_cvt_pk_bf16_f32 v45, v90, v91
  v_mfma_f32_16x16x32_bf16 v[180:183], a[20:23], v[52:55], v[180:183]
  v_exp_f32 v92, v92
  v_mfma_f32_16x16x32_bf16 v[212:215], a[20:23], v[56:59], v[212:215]
  buffer_load_dwordx4 v2, s[20:23], s29 offen offset:3072 lds
  ds_read_b128 a[0:3], v4 offset:0
  v_mfma_f32_16x16x32_bf16 v[244:247], a[20:23], v[60:63], v[244:247]
  s_xor_b32 s27, s27, s30
  v_exp_f32 v93, v93
  v_mfma_f32_16x16x32_bf16 v[152:155], a[24:27], v[48:51], v[152:155]
  s_add_u32 s29, s29, 0x8000
  ds_read_b128 a[4:7], v4 offset:1024
  v_cvt_pk_bf16_f32 v46, v92, v93
  v_mfma_f32_16x16x32_bf16 v[184:187], a[24:27], v[52:55], v[184:187]
  v_exp_f32 v94, v94
  v_mfma_f32_16x16x32_bf16 v[216:219], a[24:27], v[56:59], v[216:219]
  v_mfma_f32_16x16x32_bf16 v[248:251], a[24:27], v[60:63], v[248:251]
  v_exp_f32 v95, v95
  v_mfma_f32_16x16x32_bf16 v[156:159], a[28:31], v[48:51], v[156:159]
  ds_read_b128 a[8:11], v4 offset:2048
  v_cvt_pk_bf16_f32 v47, v94, v95
  v_mfma_f32_16x16x32_bf16 v[188:191], a[28:31], v[52:55], v[188:191]
  v_mfma_f32_16x16x32_bf16 v[220:223], a[28:31], v[56:59], v[220:223]
  v_mfma_f32_16x16x32_bf16 v[252:255], a[28:31], v[60:63], v[252:255]
  s_xor_b32 s30, s30, 0xc000
  s_xor_b32 s31, s31, 0xc000
  s_branch La_lo
La_d0:
  s_waitcnt vmcnt(8)
  s_barrier
  s_waitcnt lgkmcnt(7)
  v_mfma_f32_16x16x32_bf16 v[96:99], a[32:35], a[128:131], v[16:19]
  s_mov_b32 m0, s26
  ds_read_b128 a[12:15], v4 offset:11264
  v_cndmask_b32 v64, v64, v5, s[32:33]
  v_mfma_f32_16x16x32_bf16 v[104:107], a[32:35], a[144:147], v[20:23]
  v_exp_f32 v64, v64
  v_mfma_f32_16x16x32_bf16 v[112:115], a[32:35], a[160:163], v[24:27]
  v_cndmask_b32 v65, v65, v5, s[34:35]
  v_exp_f32 v65, v65
  v_mfma_f32_16x16x32_bf16 v[120:123], a[32:35], a[176:179], v[28:31]
  buffer_load_dwordx4 v2, s[20:23], s28 offen offset:0 lds
  v_cndmask_b32 v66, v66, v5, s[36:37]
  v_mfma_f32_16x16x32_bf16 v[96:99], a[36:39], a[132:135], v[96:99]
  v_exp_f32 v66, v66
  v_mfma_f32_16x16x32_bf16 v[104:107], a[36:39], a[148:151], v[104:107]
  ds_read_b128 a[16:19], v4 offset:12288
  v_cndmask_b32 v67, v67, v5, s[38:39]
  v_mfma_f32_16x16x32_bf16 v[112:115], a[36:39], a[164:167], v[112:115]
  v_exp_f32 v67, v67
  v_mfma_f32_16x16x32_bf16 v[120:123], a[36:39], a[180:183], v[120:123]
  v_cndmask_b32 v68, v68, v5, s[40:41]
  v_cndmask_b32 v69, v69, v5, s[42:43]
  v_mfma_f32_16x16x32_bf16 v[96:99], a[40:43], a[136:139], v[96:99]
  v_exp_f32 v68, v68
  v_mfma_f32_16x16x32_bf16 v[104:107], a[40:43], a[152:155], v[104:107]
  buffer_load_dwordx4 v2, s[20:23], s28 offen offset:1024 lds
  ds_read_b128 a[20:23], v4 offset:13312
  v_mfma_f32_16x16x32_bf16 v[112:115], a[40:43], a[168:171], v[112:115]
  v_exp_f32 v69, v69
  v_mfma_f32_16x16x32_bf16 v[120:123], a[40:43], a[184:187], v[120:123]
  v_cndmask_b32 v70, v70, v5, s[44:45]
  v_cvt_pk_bf16_f32 v32, v64, v65
  v_mfma_f32_16x16x32_bf16 v[96:99], a[44:47], a[140:143], v[96:99]
  v_exp_f32 v70, v70
  v_mfma_f32_16x16x32_bf16 v[104:107], a[44:47], a[156:159], v[104:107]
  ds_read_b128 a[24:27], v4 offset:14336
  v_cndmask_b32 v71, v71, v5, s[46:47]
  v_mfma_f32_16x16x32_bf16 v[112:115], a[44:47], a[172:175], v[112:115]
  v_exp_f32 v71, v71
  v_mfma_f32_16x16x32_bf16 v[120:123], a[44:47], a[188:191], v[120:123]
  s_waitcnt lgkmcnt(7)
  v_cvt_pk_bf16_f32 v33, v66, v67
  v_cvt_pk_bf16_f32 v34, v68, v69
  v_mfma_f32_16x16x32_bf16 v[100:103], a[48:51], a[128:131], v[16:19]
  v_exp_f32 v72, v72
  v_mfma_f32_16x16x32_bf16 v[108:111], a[48:51], a[144:147], v[20:23]
  buffer_load_dwordx4 v2, s[20:23], s28 offen offset:2048 lds
  ds_read_b128 a[28:31], v4 offset:15360
  v_mfma_f32_16x16x32_bf16 v[116:119], a[48:51], a[160:163], v[24:27]
  v_exp_f32 v73, v73
  v_mfma_f32_16x16x32_bf16 v[124:127], a[48:51], a[176:179], v[28:31]
  v_xor_b32 v3, 0x4000, v3
  v_cvt_pk_bf16_f32 v35, v70, v71
  v_mfma_f32_16x16x32_bf16 v[100:103], a[52:55], a[132:135], v[100:103]
  v_exp_f32 v74, v74
  v_mfma_f32_16x16x32_bf16 v[108:111], a[52:55], a[148:151], v[108:111]
  ds_read_b128 a[32:35], v3 offset:0
  v_cvt_pk_bf16_f32 v36, v72, v73
  v_mfma_f32_16x16x32_bf16 v[116:119], a[52:55], a[164:167], v[116:119]
  v_exp_f32 v75, v75
  v_mfma_f32_16x16x32_bf16 v[124:127], a[52:55], a[180:183], v[124:127]
  v_cvt_pk_bf16_f32 v37, v74, v75
  v_mfma_f32_16x16x32_bf16 v[100:103], a[56:59], a[136:139], v[100:103]
  v_exp_f32 v76, v76
  v_mfma_f32_16x16x32_bf16 v[108:111], a[56:59], a[152:155], v[108:111]
  buffer_load_dwordx4 v2, s[20:23], s28 offen offset:3072 lds
  ds_read_b128 a[36:39], v3 offset:1024
  v_mfma_f32_16x16x32_bf16 v[116:119], a[56:59], a[168:171], v[116:119]
  s_xor_b32 s26, s26, 0x8000
  v_exp_f32 v77, v77
  v_mfma_f32_16x16x32_bf16 v[124:127], a[56:59], a[184:187], v[124:127]
  s_add_u32 s28, s28, 0x8000
  s_mov_b32 m0, s27
  v_cvt_pk_bf16_f32 v38, v76, v77
  v_mfma_f32_16x16x32_bf16 v[100:103], a[60:63], a[140:143], v[100:103]
  v_exp_f32 v78, v78
  v_mfma_f32_16x16x32_bf16 v[108:111], a[60:63], a[156:159], v[108:111]
  ds_read_b128 a[40:43], v3 offset:2048
  v_mfma_f32_16x16x32_bf16 v[116:119], a[60:63], a[172:175], v[116:119]
  v_exp_f32 v79, v79
  v_mfma_f32_16x16x32_bf16 v[124:127], a[60:63], a[188:191], v[124:127]
  s_waitcnt lgkmcnt(7)
  v_cvt_pk_bf16_f32 v39, v78, v79
  v_mfma_f32_16x16x32_bf16 v[128:131], a[0:3], v[48:51], v[128:131]
  ds_read_b128 a[44:47], v3 offset:3072
  v_mfma_f32_16x16x32_bf16 v[160:163], a[0:3], v[52:55], v[160:163]
  v_exp_f32 v80, v80
  v_mfma_f32_16x16x32_bf16 v[192:195], a[0:3], v[56:59], v[192:195]
  buffer_load_dwordx4 v2, s[20:23], s29 offen offset:0 lds
  v_mfma_f32_16x16x32_bf16 v[224:227], a[0:3], v[60:63], v[224:227]
  v_exp_f32 v81, v81
  v_mfma_f32_16x16x32_bf16 a[192:195], a[208:211], v[48:51], a[192:195]
  v_cvt_pk_bf16_f32 v40, v80, v81
  v_mfma_f32_16x16x32_bf16 v[132:135], a[4:7], v[48:51], v[132:135]
  v_exp_f32 v82, v82
  v_mfma_f32_16x16x32_bf16 v[164:167], a[4:7], v[52:55], v[164:167]
  ds_read_b128 a[48:51], v3 offset:4096
  v_mfma_f32_16x16x32_bf16 v[196:199], a[4:7], v[56:59], v[196:199]
  v_exp_f32 v83, v83
  v_mfma_f32_16x16x32_bf16 v[228:231], a[4:7], v[60:63], v[228:231]
  v_cvt_pk_bf16_f32 v41, v82, v83
  v_mfma_f32_16x16x32_bf16 a[196:199], a[208:211], v[52:55], a[196:199]
  v_exp_f32 v84, v84
  v_mfma_f32_16x16x32_bf16 v[136:139], a[8:11], v[48:51], v[136:139]
  buffer_load_dwordx4 v2, s[20:23], s29 offen offset:1024 lds
  ds_read_b128 a[52:55], v3 offset:5120
  v_mfma_f32_16x16x32_bf16 v[168:171], a[8:11], v[52:55], v[168:171]
  v_exp_f32 v85, v85
  v_mfma_f32_16x16x32_bf16 v[200:203], a[8:11], v[56:59], v[200:203]
  v_cvt_pk_bf16_f32 v42, v84, v85
  v_mfma_f32_16x16x32_bf16 v[232:235], a[8:11], v[60:63], v[232:235]
  v_exp_f32 v86, v86
  v_mfma_f32_16x16x32_bf16 a[200:203], a[208:211], v[56:59], a[200:203]
  v_mfma_f32_16x16x32_bf16 v[140:143], a[12:15], v[48:51], v[140:143]
  v_exp_f32 v87, v87
  v_mfma_f32_16x16x32_bf16 v[172:175], a[12:15], v[52:55], v[172:175]
  ds_read_b128 a[56:59], v3 offset:6144
  v_cvt_pk_bf16_f32 v43, v86, v87
  v_mfma_f32_16x16x32_bf16 v[204:207], a[12:15], v[56:59], v[204:207]
  v_exp_f32 v88, v88
  v_mfma_f32_16x16x32_bf16 v[236:239], a[12:15], v[60:63], v[236:239]
  buffer_load_dwordx4 v2, s[20:23], s29 offen offset:2048 lds
  v_mfma_f32_16x16x32_bf16 a[204:207], a[208:211], v[60:63], a[204:207]
  s_waitcnt lgkmcnt(7)
  v_exp_f32 v89, v89
  v_mfma_f32_16x16x32_bf16 v[144:147], a[16:19], v[48:51], v[144:147]
  ds_read_b128 a[60:63], v3 offset:7168
  v_cvt_pk_bf16_f32 v44, v88, v89
  v_mfma_f32_16x16x32_bf16 v[176:179], a[16:19], v[52:55], v[176:179]
  v_exp_f32 v90, v90
  v_mfma_f32_16x16x32_bf16 v[208:211], a[16:19], v[56:59], v[208:211]
  v_mfma_f32_16x16x32_bf16 v[240:243], a[16:19], v[60:63], v[240:243]
  v_exp_f32 v91, v91
  v_mfma_f32_16x16x32_bf16 v[148:151], a[20:23], v[48:51], v[148:151]
  v_xor_b32 v4, 0x8000, v4
  v_cvt_pk_bf16_f32 v45, v90, v91
  v_mfma_f32_16x16x32_bf16 v[180:183], a[20:23], v[52:55], v[180:183]
  v_exp_f32 v92, v92
  v_mfma_f32_16x16x32_bf16 v[212:215], a[20:23], v[56:59], v[212:215]
  buffer_load_dwordx4 v2, s[20:23], s29 offen offset:3072 lds
  ds_read_b128 a[0:3], v4 offset:0
  v_mfma_f32_16x16x32_bf16 v[244:247], a[20:23], v[60:63], v[244:247]
  s_xor_b32 s27, s27, 0x4000
  v_exp_f32 v93, v93
  v_mfma_f32_16x16x32_bf16 v[152:155], a[24:27], v[48:51], v[152:155]
  s_add_u32 s29, s29, 0x8000
  ds_read_b128 a[4:7], v4 offset:1024
  v_cvt_pk_bf16_f32 v46, v92, v93
  v_mfma_f32_16x16x32_bf16 v[184:187], a[24:27], v[52:55], v[184:187]
  v_exp_f32 v94, v94
  v_mfma_f32_16x16x32_bf16 v[216:219], a[24:27], v[56:59], v[216:219]
  v_mfma_f32_16x16x32_bf16 v[248:251], a[24:27], v[60:63], v[248:251]
  v_exp_f32 v95, v95
  v_mfma_f32_16x16x32_bf16 v[156:159], a[28:31], v[48:51], v[156:159]
  ds_read_b128 a[8:11], v4 offset:2048
  v_cvt_pk_bf16_f32 v47, v94, v95
  v_mfma_f32_16x16x32_bf16 v[188:191], a[28:31], v[52:55], v[188:191]
  v_mfma_f32_16x16x32_bf16 v[220:223], a[28:31], v[56:59], v[220:223]
  v_mfma_f32_16x16x32_bf16 v[252:255], a[28:31], v[60:63], v[252:255]
La_d1:
  s_waitcnt lgkmcnt(7)
  v_mfma_f32_16x16x32_bf16 v[72:75], a[32:35], a[144:147], v[20:23]
  buffer_load_dwordx4 a[64:67], v2, s[8:11], s6 offen offset:0
  ds_read_b128 a[12:15], v4 offset:3072
  v_mfma_f32_16x16x32_bf16 v[80:83], a[32:35], a[160:163], v[24:27]
  v_cndmask_b32 v96, v96, v5, s[48:49]
  v_exp_f32 v96, v96
  v_mfma_f32_16x16x32_bf16 v[88:91], a[32:35], a[176:179], v[28:31]
  v_cndmask_b32 v97, v97, v5, s[50:51]
  v_exp_f32 v97, v97
  v_mfma_f32_16x16x32_bf16 v[72:75], a[36:39], a[148:151], v[72:75]
  v_cndmask_b32 v98, v98, v5, s[52:53]
  v_exp_f32 v98, v98
  v_mfma_f32_16x16x32_bf16 v[80:83], a[36:39], a[164:167], v[80:83]
  ds_read_b128 a[16:19], v4 offset:4096
  v_cndmask_b32 v99, v99, v5, s[54:55]
  v_mfma_f32_16x16x32_bf16 v[88:91], a[36:39], a[180:183], v[88:91]
  v_exp_f32 v99, v99
  v_mfma_f32_16x16x32_bf16 v[72:75], a[40:43], a[152:155], v[72:75]
  buffer_load_dwordx4 a[64:67], v2, s[8:11], s6 offen offset:1024
  ds_read_b128 a[20:23], v4 offset:5120
  v_mfma_f32_16x16x32_bf16 v[80:83], a[40:43], a[168:171], v[80:83]
  v_cndmask_b32 v100, v100, v5, s[56:57]
  v_exp_f32 v100, v100
  v_mfma_f32_16x16x32_bf16 v[88:91], a[40:43], a[184:187], v[88:91]
  v_cndmask_b32 v101, v101, v5, s[58:59]
  v_cndmask_b32 v102, v102, v5, s[60:61]
  v_mfma_f32_16x16x32_bf16 v[72:75], a[44:47], a[156:159], v[72:75]
  v_exp_f32 v101, v101
  v_mfma_f32_16x16x32_bf16 v[80:83], a[44:47], a[172:175], v[80:83]
  v_exp_f32 v102, v102
  v_mfma_f32_16x16x32_bf16 v[88:91], a[44:47], a[188:191], v[88:91]
  s_waitcnt lgkmcnt(6)
  buffer_load_dwordx4 a[64:67], v2, s[8:11], s6 offen offset:2048
  ds_read_b128 a[24:27], v4 offset:6144
  v_mfma_f32_16x16x32_bf16 v[76:79], a[48:51], a[144:147], v[20:23]
  v_cndmask_b32 v103, v103, v5, s[62:63]
  v_exp_f32 v103, v103
  v_mfma_f32_16x16x32_bf16 v[84:87], a[48:51], a[160:163], v[24:27]
  ds_read_b128 a[28:31], v4 offset:7168
  v_cvt_pk_bf16_f32 v48, v96, v97
  v_mfma_f32_16x16x32_bf16 v[92:95], a[48:51], a[176:179], v[28:31]
  v_exp_f32 v104, v104
  v_mfma_f32_16x16x32_bf16 v[76:79], a[52:55], a[148:151], v[76:79]
  ds_read_b128 a[32:35], v3 offset:8192
  v_cvt_pk_bf16_f32 v49, v98, v99
  v_mfma_f32_16x16x32_bf16 v[84:87], a[52:55], a[164:167], v[84:87]
  v_exp_f32 v105, v105
  v_mfma_f32_16x16x32_bf16 v[92:95], a[52:55], a[180:183], v[92:95]
  buffer_load_dwordx4 a[64:67], v2, s[8:11], s6 offen offset:3072
  v_cvt_pk_bf16_f32 v50, v100, v101
  v_mfma_f32_16x16x32_bf16 v[76:79], a[56:59], a[152:155], v[76:79]
  s_add_u32 s6, s6, 4096
  v_exp_f32 v106, v106
  v_mfma_f32_16x16x32_bf16 v[84:87], a[56:59], a[168:171], v[84:87]
  v_exp_f32 v107, v107
  v_mfma_f32_16x16x32_bf16 v[92:95], a[56:59], a[184:187], v[92:95]
  ds_read_b128 a[36:39], v3 offset:9216
  v_cvt_pk_bf16_f32 v51, v102, v103
  v_mfma_f32_16x16x32_bf16 v[76:79], a[60:63], a[156:159], v[76:79]
  v_exp_f32 v108, v108
  v_mfma_f32_16x16x32_bf16 v[84:87], a[60:63], a[172:175], v[84:87]
  ds_read_b128 a[40:43], v3 offset:10240
  v_cvt_pk_bf16_f32 v52, v104, v105
  v_mfma_f32_16x16x32_bf16 v[92:95], a[60:63], a[188:191], v[92:95]
  s_waitcnt lgkmcnt(7)
  v_exp_f32 v109, v109
  v_mfma_f32_16x16x32_bf16 v[128:131], a[0:3], v[32:35], v[128:131]
  buffer_load_dwordx4 a[64:67], v2, s[8:11], s6 offen offset:0
  ds_read_b128 a[44:47], v3 offset:11264
  v_mfma_f32_16x16x32_bf16 v[160:163], a[0:3], v[36:39], v[160:163]
  v_exp_f32 v110, v110
  v_mfma_f32_16x16x32_bf16 v[192:195], a[0:3], v[40:43], v[192:195]
  v_cvt_pk_bf16_f32 v53, v106, v107
  v_cvt_pk_bf16_f32 v54, v108, v109
  v_mfma_f32_16x16x32_bf16 v[224:227], a[0:3], v[44:47], v[224:227]
  v_exp_f32 v111, v111
  v_mfma_f32_16x16x32_bf16 a[192:195], a[208:211], v[32:35], a[192:195]
  v_cvt_pk_bf16_f32 v55, v110, v111
  v_mfma_f32_16x16x32_bf16 v[132:135], a[4:7], v[32:35], v[132:135]
  v_exp_f32 v112, v112
  v_mfma_f32_16x16x32_bf16 v[164:167], a[4:7], v[36:39], v[164:167]
  v_exp_f32 v113, v113
  v_mfma_f32_16x16x32_bf16 v[196:199], a[4:7], v[40:43], v[196:199]
  buffer_load_dwordx4 a[64:67], v2, s[8:11], s6 offen offset:1024
  ds_read_b128 a[48:51], v3 offset:12288
  v_mfma_f32_16x16x32_bf16 v[228:231], a[4:7], v[44:47], v[228:231]
  v_exp_f32 v114, v114
  v_mfma_f32_16x16x32_bf16 a[196:199], a[208:211], v[36:39], a[196:199]
  v_cvt_pk_bf16_f32 v56, v112, v113
  v_mfma_f32_16x16x32_bf16 v[136:139], a[8:11], v[32:35], v[136:139]
  v_exp_f32 v115, v115
  v_mfma_f32_16x16x32_bf16 v[168:171], a[8:11], v[36:39], v[168:171]
  buffer_load_dwordx4 a[64:67], v2, s[8:11], s6 offen offset:2048
  ds_read_b128 a[52:55], v3 offset:13312
  v_mfma_f32_16x16x32_bf16 v[200:203], a[8:11], v[40:43], v[200:203]
  v_exp_f32 v116, v116
  v_mfma_f32_16x16x32_bf16 v[232:235], a[8:11], v[44:47], v[232:235]
  v_cvt_pk_bf16_f32 v57, v114, v115
  v_mfma_f32_16x16x32_bf16 a[200:203], a[208:211], v[40:43], a[200:203]
  v_exp_f32 v117, v117
  v_mfma_f32_16x16x32_bf16 v[140:143], a[12:15], v[32:35], v[140:143]
  v_exp_f32 v118, v118
  v_mfma_f32_16x16x32_bf16 v[172:175], a[12:15], v[36:39], v[172:175]
  buffer_load_dwordx4 a[64:67], v2, s[8:11], s6 offen offset:3072
  ds_read_b128 a[56:59], v3 offset:14336
  v_mfma_f32_16x16x32_bf16 v[204:207], a[12:15], v[40:43], v[204:207]
  v_exp_f32 v119, v119
  v_mfma_f32_16x16x32_bf16 v[236:239], a[12:15], v[44:47], v[236:239]
  v_cvt_pk_bf16_f32 v58, v116, v117
  v_cvt_pk_bf16_f32 v59, v118, v119
  v_mfma_f32_16x16x32_bf16 a[204:207], a[208:211], v[44:47], a[204:207]
  s_waitcnt lgkmcnt(7)
  v_exp_f32 v120, v120
  v_mfma_f32_16x16x32_bf16 v[144:147], a[16:19], v[32:35], v[144:147]
  ds_read_b128 a[60:63], v3 offset:15360
  v_mfma_f32_16x16x32_bf16 v[176:179], a[16:19], v[36:39], v[176:179]
  v_exp_f32 v121, v121
  v_mfma_f32_16x16x32_bf16 v[208:211], a[16:19], v[40:43], v[208:211]
  buffer_load_dwordx4 a[64:67], v2, s[12:15], s7 offen offset:0
  v_cvt_pk_bf16_f32 v60, v120, v121
  v_mfma_f32_16x16x32_bf16 v[240:243], a[16:19], v[44:47], v[240:243]
  v_exp_f32 v122, v122
  v_mfma_f32_16x16x32_bf16 v[148:151], a[20:23], v[32:35], v[148:151]
  v_exp_f32 v123, v123
  v_mfma_f32_16x16x32_bf16 v[180:183], a[20:23], v[36:39], v[180:183]
  ds_read_b128 a[0:3], v4 offset:8192
  v_cvt_pk_bf16_f32 v61, v122, v123
  v_mfma_f32_16x16x32_bf16 v[212:215], a[20:23], v[40:43], v[212:215]
  v_exp_f32 v124, v124
  v_mfma_f32_16x16x32_bf16 v[244:247], a[20:23], v[44:47], v[244:247]
  v_mfma_f32_16x16x32_bf16 v[152:155], a[24:27], v[32:35], v[152:155]
  v_exp_f32 v125, v125
  v_mfma_f32_16x16x32_bf16 v[184:187], a[24:27], v[36:39], v[184:187]
  buffer_load_dwordx4 a[64:67], v2, s[12:15], s7 offen offset:1024
  ds_read_b128 a[4:7], v4 offset:9216
  v_mfma_f32_16x16x32_bf16 v[216:219], a[24:27], v[40:43], v[216:219]
  v_exp_f32 v126, v126
  v_mfma_f32_16x16x32_bf16 v[248:251], a[24:27], v[44:47], v[248:251]
  v_cvt_pk_bf16_f32 v62, v124, v125
  v_mfma_f32_16x16x32_bf16 v[156:159], a[28:31], v[32:35], v[156:159]
  v_exp_f32 v127, v127
  v_mfma_f32_16x16x32_bf16 v[188:191], a[28:31], v[36:39], v[188:191]
  ds_read_b128 a[8:11], v4 offset:10240
  v_cvt_pk_bf16_f32 v63, v126, v127
  v_mfma_f32_16x16x32_bf16 v[220:223], a[28:31], v[40:43], v[220:223]
  v_mfma_f32_16x16x32_bf16 v[252:255], a[28:31], v[44:47], v[252:255]
  s_waitcnt vmcnt(22)
  s_barrier
  s_waitcnt lgkmcnt(7)
  v_mfma_f32_16x16x32_bf16 v[104:107], a[32:35], a[144:147], v[20:23]
  s_mov_b32 m0, s26
  ds_read_b128 a[12:15], v4 offset:11264
  v_cndmask_b32 v72, v72, v5, s[32:33]
  v_mfma_f32_16x16x32_bf16 v[112:115], a[32:35], a[160:163], v[24:27]
  v_exp_f32 v72, v72
  v_mfma_f32_16x16x32_bf16 v[120:123], a[32:35], a[176:179], v[28:31]
  v_cndmask_b32 v73, v73, v5, s[34:35]
  v_exp_f32 v73, v73
  v_mfma_f32_16x16x32_bf16 v[104:107], a[36:39], a[148:151], v[104:107]
  buffer_load_dwordx4 v2, s[20:23], s28 offen offset:0 lds
  ds_read_b128 a[16:19], v4 offset:12288
  v_mfma_f32_16x16x32_bf16 v[112:115], a[36:39], a[164:167], v[112:115]
  v_cndmask_b32 v74, v74, v5, s[36:37]
  v_exp_f32 v74, v74
  v_mfma_f32_16x16x32_bf16 v[120:123], a[36:39], a[180:183], v[120:123]
  v_cvt_pk_bf16_f32 v36, v72, v73
  v_mfma_f32_16x16x32_bf16 v[104:107], a[40:43], a[152:155], v[104:107]
  ds_read_b128 a[20:23], v4 offset:13312
  v_cndmask_b32 v75, v75, v5, s[38:39]
  v_mfma_f32_16x16x32_bf16 v[112:115], a[40:43], a[168:171], v[112:115]
  v_exp_f32 v75, v75
  v_mfma_f32_16x16x32_bf16 v[120:123], a[40:43], a[184:187], v[120:123]
  buffer_load_dwordx4 v2, s[20:23], s28 offen offset:1024 lds
  v_cndmask_b32 v76, v76, v5, s[40:41]
  v_mfma_f32_16x16x32_bf16 v[104:107], a[44:47], a[156:159], v[104:107]
  v_exp_f32 v76, v76
  v_mfma_f32_16x16x32_bf16 v[112:115], a[44:47], a[172:175], v[112:115]
  ds_read_b128 a[24:27], v4 offset:14336
  v_cndmask_b32 v79, v79, v5, s[46:47]
  v_mfma_f32_16x16x32_bf16 v[120:123], a[44:47], a[188:191], v[120:123]
  s_waitcnt lgkmcnt(7)
  v_cndmask_b32 v77, v77, v5, s[42:43]
  v_cndmask_b32 v78, v78, v5, s[44:45]
  v_mfma_f32_16x16x32_bf16 v[108:111], a[48:51], a[144:147], v[20:23]
  v_exp_f32 v77, v77
  v_mfma_f32_16x16x32_bf16 v[116:119], a[48:51], a[160:163], v[24:27]
  ds_read_b128 a[28:31], v4 offset:15360
  v_xor_b32 v4, 0x4000, v4
  v_mfma_f32_16x16x32_bf16 v[124:127], a[48:51], a[176:179], v[28:31]
  v_exp_f32 v78, v78
  v_mfma_f32_16x16x32_bf16 v[108:111], a[52:55], a[148:151], v[108:111]
  buffer_load_dwordx4 v2, s[20:23], s28 offen offset:2048 lds
  v_xor_b32 v3, 0x8000, v3
  v_mfma_f32_16x16x32_bf16 v[116:119], a[52:55], a[164:167], v[116:119]
  v_exp_f32 v79, v79
  v_mfma_f32_16x16x32_bf16 v[124:127], a[52:55], a[180:183], v[124:127]
  ds_read_b128 a[32:35], v3 offset:0
  v_cvt_pk_bf16_f32 v37, v74, v75
  v_mfma_f32_16x16x32_bf16 v[108:111], a[56:59], a[152:155], v[108:111]
  ds_read_b128 a[36:39], v3 offset:1024
  v_cvt_pk_bf16_f32 v38, v76, v77
  v_mfma_f32_16x16x32_bf16 v[116:119], a[56:59], a[168:171], v[116:119]
  v_exp_f32 v80, v80
  v_mfma_f32_16x16x32_bf16 v[124:127], a[56:59], a[184:187], v[124:127]
  v_cvt_pk_bf16_f32 v39, v78, v79
  v_mfma_f32_16x16x32_bf16 v[108:111], a[60:63], a[156:159], v[108:111]
  v_exp_f32 v81, v81
  v_mfma_f32_16x16x32_bf16 v[116:119], a[60:63], a[172:175], v[116:119]
  buffer_load_dwordx4 v2, s[20:23], s28 offen offset:3072 lds
  ds_read_b128 a[40:43], v3 offset:2048
  v_mfma_f32_16x16x32_bf16 v[124:127], a[60:63], a[188:191], v[124:127]
  s_waitcnt lgkmcnt(7)
  s_xor_b32 s26, s26, 0x4000
  s_add_u32 s28, s28, 0x8000
  v_mfma_f32_16x16x32_bf16 v[128:131], a[0:3], v[48:51], v[128:131]
  s_mov_b32 m0, s27
  v_exp_f32 v82, v82
  v_mfma_f32_16x16x32_bf16 v[160:163], a[0:3], v[52:55], v[160:163]
  ds_read_b128 a[44:47], v3 offset:3072
  v_cvt_pk_bf16_f32 v40, v80, v81
  v_mfma_f32_16x16x32_bf16 v[192:195], a[0:3], v[56:59], v[192:195]
  v_exp_f32 v83, v83
  v_mfma_f32_16x16x32_bf16 v[224:227], a[0:3], v[60:63], v[224:227]
  v_cvt_pk_bf16_f32 v41, v82, v83
  v_mfma_f32_16x16x32_bf16 a[192:195], a[208:211], v[48:51], a[192:195]
  v_mfma_f32_16x16x32_bf16 v[132:135], a[4:7], v[48:51], v[132:135]
  v_exp_f32 v84, v84
  v_mfma_f32_16x16x32_bf16 v[164:167], a[4:7], v[52:55], v[164:167]
  buffer_load_dwordx4 v2, s[20:23], s29 offen offset:0 lds
  ds_read_b128 a[48:51], v3 offset:4096
  v_mfma_f32_16x16x32_bf16 v[196:199], a[4:7], v[56:59], v[196:199]
  v_exp_f32 v85, v85
  v_mfma_f32_16x16x32_bf16 v[228:231], a[4:7], v[60:63], v[228:231]
  v_cvt_pk_bf16_f32 v42, v84, v85
  v_mfma_f32_16x16x32_bf16 a[196:199], a[208:211], v[52:55], a[196:199]
  v_exp_f32 v86, v86
  v_mfma_f32_16x16x32_bf16 v[136:139], a[8:11], v[48:51], v[136:139]
  ds_read_b128 a[52:55], v3 offset:5120
  v_mfma_f32_16x16x32_bf16 v[168:171], a[8:11], v[52:55], v[168:171]
  v_mfma_f32_16x16x32_bf16 v[200:203], a[8:11], v[56:59], v[200:203]
  v_exp_f32 v87, v87
  v_mfma_f32_16x16x32_bf16 v[232:235], a[8:11], v[60:63], v[232:235]
  buffer_load_dwordx4 v2, s[20:23], s29 offen offset:1024 lds
  v_cvt_pk_bf16_f32 v43, v86, v87
  v_mfma_f32_16x16x32_bf16 a[200:203], a[208:211], v[56:59], a[200:203]
  v_exp_f32 v88, v88
  v_mfma_f32_16x16x32_bf16 v[140:143], a[12:15], v[48:51], v[140:143]
  ds_read_b128 a[56:59], v3 offset:6144
  v_mfma_f32_16x16x32_bf16 v[172:175], a[12:15], v[52:55], v[172:175]
  v_mfma_f32_16x16x32_bf16 v[204:207], a[12:15], v[56:59], v[204:207]
  v_exp_f32 v89, v89
  v_mfma_f32_16x16x32_bf16 v[236:239], a[12:15], v[60:63], v[236:239]
  v_cvt_pk_bf16_f32 v44, v88, v89
  v_mfma_f32_16x16x32_bf16 a[204:207], a[208:211], v[60:63], a[204:207]
  s_waitcnt lgkmcnt(7)
  v_exp_f32 v90, v90
  v_mfma_f32_16x16x32_bf16 v[144:147], a[16:19], v[48:51], v[144:147]
  buffer_load_dwordx4 v2, s[20:23], s29 offen offset:2048 lds
  ds_read_b128 a[60:63], v3 offset:7168
  v_mfma_f32_16x16x32_bf16 v[176:179], a[16:19], v[52:55], v[176:179]
  v_exp_f32 v91, v91
  v_mfma_f32_16x16x32_bf16 v[208:211], a[16:19], v[56:59], v[208:211]
  v_cvt_pk_bf16_f32 v45, v90, v91
  v_mfma_f32_16x16x32_bf16 v[240:243], a[16:19], v[60:63], v[240:243]
  v_mfma_f32_16x16x32_bf16 v[148:151], a[20:23], v[48:51], v[148:151]
  v_exp_f32 v92, v92
  v_mfma_f32_16x16x32_bf16 v[180:183], a[20:23], v[52:55], v[180:183]
  ds_read_b128 a[0:3], v3 offset:8192
  v_mfma_f32_16x16x32_bf16 v[212:215], a[20:23], v[56:59], v[212:215]
  v_exp_f32 v93, v93
  v_mfma_f32_16x16x32_bf16 v[244:247], a[20:23], v[60:63], v[244:247]
  buffer_load_dwordx4 v2, s[20:23], s29 offen offset:3072 lds
  v_cvt_pk_bf16_f32 v46, v92, v93
  v_mfma_f32_16x16x32_bf16 v[152:155], a[24:27], v[48:51], v[152:155]
  s_xor_b32 s27, s27, 0x8000
  s_add_u32 s29, s29, 0x8000
  ds_read_b128 a[4:7], v3 offset:9216
  v_mfma_f32_16x16x32_bf16 v[184:187], a[24:27], v[52:55], v[184:187]
  v_exp_f32 v94, v94
  v_mfma_f32_16x16x32_bf16 v[216:219], a[24:27], v[56:59], v[216:219]
  v_mfma_f32_16x16x32_bf16 v[248:251], a[24:27], v[60:63], v[248:251]
  v_exp_f32 v95, v95
  v_mfma_f32_16x16x32_bf16 v[156:159], a[28:31], v[48:51], v[156:159]
  ds_read_b128 a[8:11], v3 offset:10240
  v_cvt_pk_bf16_f32 v47, v94, v95
  v_mfma_f32_16x16x32_bf16 v[188:191], a[28:31], v[52:55], v[188:191]
  v_mfma_f32_16x16x32_bf16 v[220:223], a[28:31], v[56:59], v[220:223]
  v_mfma_f32_16x16x32_bf16 v[252:255], a[28:31], v[60:63], v[252:255]
  v_mov_b32 v8, 0x40000000
  v_mov_b32 v6, s94
  v_cmp_eq_u32 vcc, 0, v0
  v_mov_b32 v7, s95
  s_nop 0
  v_cndmask_b32_e64 v8, v8, 0, vcc
  buffer_store_dwordx2 v[6:7], v8, s[96:99], s91 offen sc1
  s_lshl_b32 s91, s73, 11
  s_add_u32 s91, s91, 32768
  v_and_b32 v14, 15, v1
  v_lshlrev_b32 v14, 7, v14
  s_waitcnt vmcnt(23)
  s_barrier
  s_waitcnt lgkmcnt(3)
  v_mfma_f32_16x16x32_bf16 v[64:67], a[32:35], a[160:163], v[24:27]
  s_mov_b32 m0, s26
  ds_read_b128 a[12:15], v3 offset:11264
  v_cndmask_b32 v104, v104, v5, s[48:49]
  v_mfma_f32_16x16x32_bf16 v[72:75], a[32:35], a[176:179], v[28:31]
  v_exp_f32 v104, v104
  v_mfma_f32_16x16x32_bf16 v[64:67], a[36:39], a[164:167], v[64:67]
  v_cndmask_b32 v105, v105, v5, s[50:51]
  v_exp_f32 v105, v105
  v_mfma_f32_16x16x32_bf16 v[72:75], a[36:39], a[180:183], v[72:75]
  buffer_load_dwordx4 v2, s[20:23], s28 offen offset:0 lds
  ds_read_b128 a[16:19], v3 offset:12288
  v_mfma_f32_16x16x32_bf16 v[64:67], a[40:43], a[168:171], v[64:67]
  v_cndmask_b32 v106, v106, v5, s[52:53]
  v_exp_f32 v106, v106
  v_mfma_f32_16x16x32_bf16 v[72:75], a[40:43], a[184:187], v[72:75]
  ds_read_b128 a[20:23], v3 offset:13312
  v_cndmask_b32 v108, v108, v5, s[56:57]
  v_mfma_f32_16x16x32_bf16 v[64:67], a[44:47], a[172:175], v[64:67]
  ds_read_b128 a[24:27], v3 offset:14336
  v_cndmask_b32 v107, v107, v5, s[54:55]
  v_mfma_f32_16x16x32_bf16 v[72:75], a[44:47], a[188:191], v[72:75]
  v_exp_f32 v107, v107
  v_mfma_f32_16x16x32_bf16 v[68:71], a[48:51], a[160:163], v[24:27]
  buffer_load_dwordx4 v2, s[20:23], s28 offen offset:1024 lds
  ds_read_b128 a[28:31], v3 offset:15360
  v_mfma_f32_16x16x32_bf16 v[76:79], a[48:51], a[176:179], v[28:31]
  v_exp_f32 v108, v108
  v_mfma_f32_16x16x32_bf16 v[68:71], a[52:55], a[164:167], v[68:71]
  ds_read_b128 a[32:35], v4 offset:0
  v_cndmask_b32 v109, v109, v5, s[58:59]
  v_mfma_f32_16x16x32_bf16 v[76:79], a[52:55], a[180:183], v[76:79]
  v_exp_f32 v109, v109
  v_mfma_f32_16x16x32_bf16 v[68:71], a[56:59], a[168:171], v[68:71]
  ds_read_b128 a[36:39], v4 offset:1024
  v_cvt_pk_bf16_f32 v52, v104, v105
  v_mfma_f32_16x16x32_bf16 v[76:79], a[56:59], a[184:187], v[76:79]
  v_cndmask_b32 v110, v110, v5, s[60:61]
  v_cndmask_b32 v111, v111, v5, s[62:63]
  v_mfma_f32_16x16x32_bf16 v[68:71], a[60:63], a[172:175], v[68:71]
  v_exp_f32 v110, v110
  v_mfma_f32_16x16x32_bf16 v[76:79], a[60:63], a[188:191], v[76:79]
  s_waitcnt lgkmcnt(2)
  buffer_load_dwordx4 v2, s[20:23], s28 offen offset:2048 lds
  ds_read_b128 a[40:43], v4 offset:2048
  v_mfma_f32_16x16x32_bf16 v[80:83], a[0:3], a[160:163], v[24:27]
  v_exp_f32 v111, v111
  v_mfma_f32_16x16x32_bf16 v[88:91], a[0:3], a[176:179], v[28:31]
  ds_read_b128 a[44:47], v4 offset:3072
  v_cvt_pk_bf16_f32 v53, v106, v107
  v_mfma_f32_16x16x32_bf16 v[80:83], a[4:7], a[164:167], v[80:83]
  ds_read_b128 a[48:51], v4 offset:4096
  v_cvt_pk_bf16_f32 v54, v108, v109
  v_mfma_f32_16x16x32_bf16 v[88:91], a[4:7], a[180:183], v[88:91]
  v_exp_f32 v112, v112
  v_mfma_f32_16x16x32_bf16 v[80:83], a[8:11], a[168:171], v[80:83]
  ds_read_b128 a[52:55], v4 offset:5120
  v_cvt_pk_bf16_f32 v55, v110, v111
  v_mfma_f32_16x16x32_bf16 v[88:91], a[8:11], a[184:187], v[88:91]
  v_exp_f32 v113, v113
  v_mfma_f32_16x16x32_bf16 v[80:83], a[12:15], a[172:175], v[80:83]
  buffer_load_dwordx4 v2, s[20:23], s28 offen offset:3072 lds
  ds_read_b128 a[56:59], v4 offset:6144
  v_mfma_f32_16x16x32_bf16 v[88:91], a[12:15], a[188:191], v[88:91]
  s_xor_b32 s26, s26, 0x8000
  v_exp_f32 v114, v114
  v_mfma_f32_16x16x32_bf16 v[84:87], a[16:19], a[160:163], v[24:27]
  s_add_u32 s28, s28, 0x8000
  s_mov_b32 m0, s27
  ds_read_b128 a[60:63], v4 offset:7168
  v_mfma_f32_16x16x32_bf16 v[92:95], a[16:19], a[176:179], v[28:31]
  v_xor_b32 v3, 0x4000, v3
  v_cvt_pk_bf16_f32 v56, v112, v113
  v_mfma_f32_16x16x32_bf16 v[84:87], a[20:23], a[164:167], v[84:87]
  v_exp_f32 v115, v115
  v_mfma_f32_16x16x32_bf16 v[92:95], a[20:23], a[180:183], v[92:95]
  ds_read_b128 a[0:3], v3 offset:0
  v_cvt_pk_bf16_f32 v57, v114, v115
  v_mfma_f32_16x16x32_bf16 v[84:87], a[24:27], a[168:171], v[84:87]
  v_exp_f32 v116, v116
  v_mfma_f32_16x16x32_bf16 v[92:95], a[24:27], a[184:187], v[92:95]
  buffer_load_dwordx4 v2, s[20:23], s29 offen offset:0 lds
  ds_read_b128 a[4:7], v3 offset:1024
  v_mfma_f32_16x16x32_bf16 v[84:87], a[28:31], a[172:175], v[84:87]
  v_exp_f32 v117, v117
  v_mfma_f32_16x16x32_bf16 v[92:95], a[28:31], a[188:191], v[92:95]
  s_waitcnt lgkmcnt(6)
  ds_read_b128 a[8:11], v3 offset:2048
  v_cvt_pk_bf16_f32 v58, v116, v117
  v_mfma_f32_16x16x32_bf16 v[160:163], a[32:35], v[36:39], v[160:163]
  ds_read_b128 a[12:15], v3 offset:3072
  v_mfma_f32_16x16x32_bf16 v[192:195], a[32:35], v[40:43], v[192:195]
  v_exp_f32 v118, v118
  v_mfma_f32_16x16x32_bf16 v[224:227], a[32:35], v[44:47], v[224:227]
  v_mfma_f32_16x16x32_bf16 a[196:199], a[208:211], v[36:39], a[196:199]
  v_exp_f32 v119, v119
  v_mfma_f32_16x16x32_bf16 v[164:167], a[36:39], v[36:39], v[164:167]
  buffer_load_dwordx4 v2, s[20:23], s29 offen offset:1024 lds
  ds_read_b128 a[16:19], v3 offset:4096
  v_mfma_f32_16x16x32_bf16 v[196:199], a[36:39], v[40:43], v[196:199]
  v_cvt_pk_bf16_f32 v59, v118, v119
  v_mfma_f32_16x16x32_bf16 v[228:231], a[36:39], v[44:47], v[228:231]
  v_exp_f32 v120, v120
  v_mfma_f32_16x16x32_bf16 a[200:203], a[208:211], v[40:43], a[200:203]
  v_mfma_f32_16x16x32_bf16 v[168:171], a[40:43], v[36:39], v[168:171]
  v_exp_f32 v121, v121
  v_mfma_f32_16x16x32_bf16 v[200:203], a[40:43], v[40:43], v[200:203]
  ds_read_b128 a[20:23], v3 offset:5120
  v_cvt_pk_bf16_f32 v60, v120, v121
  v_mfma_f32_16x16x32_bf16 v[232:235], a[40:43], v[44:47], v[232:235]
  v_exp_f32 v122, v122
  v_mfma_f32_16x16x32_bf16 a[204:207], a[208:211], v[44:47], a[204:207]
  buffer_load_dwordx4 v2, s[20:23], s29 offen offset:2048 lds
  v_mfma_f32_16x16x32_bf16 v[172:175], a[44:47], v[36:39], v[172:175]
  ds_read_b128 a[24:27], v3 offset:6144
  v_mfma_f32_16x16x32_bf16 v[204:207], a[44:47], v[40:43], v[204:207]
  v_exp_f32 v123, v123
  v_mfma_f32_16x16x32_bf16 v[236:239], a[44:47], v[44:47], v[236:239]
  s_waitcnt lgkmcnt(7)
  v_cvt_pk_bf16_f32 v61, v122, v123
  v_mfma_f32_16x16x32_bf16 v[176:179], a[48:51], v[36:39], v[176:179]
  v_exp_f32 v124, v124
  v_mfma_f32_16x16x32_bf16 v[208:211], a[48:51], v[40:43], v[208:211]
  ds_read_b128 a[28:31], v3 offset:7168
  v_mfma_f32_16x16x32_bf16 v[240:243], a[48:51], v[44:47], v[240:243]
  v_exp_f32 v125, v125
  v_mfma_f32_16x16x32_bf16 v[180:183], a[52:55], v[36:39], v[180:183]
  buffer_load_dwordx4 v2, s[20:23], s29 offen offset:3072 lds
  ds_read_b128 a[32:35], v3 offset:8192
  v_mfma_f32_16x16x32_bf16 v[212:215], a[52:55], v[40:43], v[212:215]
  s_xor_b32 s27, s27, 0x4000
  s_add_u32 s29, s29, 0x8000
  v_cvt_pk_bf16_f32 v62, v124, v125
  v_mfma_f32_16x16x32_bf16 v[244:247], a[52:55], v[44:47], v[244:247]
  v_exp_f32 v126, v126
  v_mfma_f32_16x16x32_bf16 v[184:187], a[56:59], v[36:39], v[184:187]
  ds_read_b128 a[36:39], v3 offset:9216
  v_mfma_f32_16x16x32_bf16 v[216:219], a[56:59], v[40:43], v[216:219]
  v_exp_f32 v127, v127
  v_mfma_f32_16x16x32_bf16 v[248:251], a[56:59], v[44:47], v[248:251]
  v_cvt_pk_bf16_f32 v63, v126, v127
  v_mfma_f32_16x16x32_bf16 v[188:191], a[60:63], v[36:39], v[188:191]
  ds_read_b128 a[40:43], v3 offset:10240
  v_mfma_f32_16x16x32_bf16 v[220:223], a[60:63], v[40:43], v[220:223]
  v_mfma_f32_16x16x32_bf16 v[252:255], a[60:63], v[44:47], v[252:255]
  s_cmp_eq_u32 s25, 7
  s_cbranch_scc1 La_t7
  s_waitcnt vmcnt(12)
  s_barrier
  s_waitcnt lgkmcnt(3)
  v_mfma_f32_16x16x32_bf16 v[96:99], a[0:3], a[160:163], v[24:27]
  s_mov_b32 m0, s26
  v_exp_f32 v64, v64
  v_mfma_f32_16x16x32_bf16 v[104:107], a[0:3], a[176:179], v[28:31]
  v_exp_f32 v65, v65
  v_mfma_f32_16x16x32_bf16 v[96:99], a[4:7], a[164:167], v[96:99]
  buffer_load_dwordx4 v2, s[20:23], s28 offen offset:0 lds
  ds_read_b128 a[44:47], v3 offset:11264
  v_mfma_f32_16x16x32_bf16 v[104:107], a[4:7], a[180:183], v[104:107]
  v_exp_f32 v66, v66
  v_mfma_f32_16x16x32_bf16 v[96:99], a[8:11], a[168:171], v[96:99]
  ds_read_b128 a[48:51], v3 offset:12288
  ds_read_b128 a[52:55], v3 offset:13312
  v_mfma_f32_16x16x32_bf16 v[104:107], a[8:11], a[184:187], v[104:107]
  v_exp_f32 v67, v67
  v_mfma_f32_16x16x32_bf16 v[96:99], a[12:15], a[172:175], v[96:99]
  ds_read_b128 a[56:59], v3 offset:14336
  v_cvt_pk_bf16_f32 v32, v64, v65
  v_mfma_f32_16x16x32_bf16 v[104:107], a[12:15], a[188:191], v[104:107]
  v_exp_f32 v68, v68
  v_mfma_f32_16x16x32_bf16 v[100:103], a[16:19], a[160:163], v[24:27]
  v_exp_f32 v69, v69
  v_mfma_f32_16x16x32_bf16 v[108:111], a[16:19], a[176:179], v[28:31]
  ds_read_b128 a[60:63], v3 offset:15360
  v_cvt_pk_bf16_f32 v33, v66, v67
  v_mfma_f32_16x16x32_bf16 v[100:103], a[20:23], a[164:167], v[100:103]
  v_exp_f32 v70, v70
  v_mfma_f32_16x16x32_bf16 v[108:111], a[20:23], a[180:183], v[108:111]
  ds_read_b128 a[0:3], v4 offset:8192
  v_cvt_pk_bf16_f32 v34, v68, v69
  v_mfma_f32_16x16x32_bf16 v[100:103], a[24:27], a[168:171], v[100:103]
  v_exp_f32 v71, v71
  v_mfma_f32_16x16x32_bf16 v[108:111], a[24:27], a[184:187], v[108:111]
  ds_read_b128 a[4:7], v4 offset:9216
  v_cvt_pk_bf16_f32 v35, v70, v71
  v_mfma_f32_16x16x32_bf16 v[100:103], a[28:31], a[172:175], v[100:103]
  v_exp_f32 v72, v72
  v_mfma_f32_16x16x32_bf16 v[108:111], a[28:31], a[188:191], v[108:111]
  s_waitcnt lgkmcnt(2)
  buffer_load_dwordx4 v2, s[20:23], s28 offen offset:1024 lds
  ds_read_b128 a[8:11], v4 offset:10240
  v_mfma_f32_16x16x32_bf16 v[112:115], a[32:35], a[160:163], v[24:27]
  v_exp_f32 v73, v73
  v_mfma_f32_16x16x32_bf16 v[120:123], a[32:35], a[176:179], v[28:31]
  v_exp_f32 v74, v74
  v_mfma_f32_16x16x32_bf16 v[112:115], a[36:39], a[164:167], v[112:115]
  ds_read_b128 a[12:15], v4 offset:11264
  ds_read_b128 a[16:19], v4 offset:12288
  v_mfma_f32_16x16x32_bf16 v[120:123], a[36:39], a[180:183], v[120:123]
  v_exp_f32 v75, v75
  v_mfma_f32_16x16x32_bf16 v[112:115], a[40:43], a[168:171], v[112:115]
  ds_read_b128 a[20:23], v4 offset:13312
  v_cvt_pk_bf16_f32 v36, v72, v73
  v_mfma_f32_16x16x32_bf16 v[120:123], a[40:43], a[184:187], v[120:123]
  v_exp_f32 v76, v76
  v_mfma_f32_16x16x32_bf16 v[112:115], a[44:47], a[172:175], v[112:115]
  ds_read_b128 a[24:27], v4 offset:14336
  v_cvt_pk_bf16_f32 v37, v74, v75
  v_mfma_f32_16x16x32_bf16 v[120:123], a[44:47], a[188:191], v[120:123]
  v_exp_f32 v77, v77
  v_mfma_f32_16x16x32_bf16 v[116:119], a[48:51], a[160:163], v[24:27]
  v_exp_f32 v78, v78
  v_mfma_f32_16x16x32_bf16 v[124:127], a[48:51], a[176:179], v[28:31]
  ds_read_b128 a[28:31], v4 offset:15360
  v_xor_b32 v4, 0x8000, v4
  v_mfma_f32_16x16x32_bf16 v[116:119], a[52:55], a[164:167], v[116:119]
  v_exp_f32 v79, v79
  v_mfma_f32_16x16x32_bf16 v[124:127], a[52:55], a[180:183], v[124:127]
  v_xor_b32 v3, 0x8000, v3
  v_cvt_pk_bf16_f32 v38, v76, v77
  v_mfma_f32_16x16x32_bf16 v[116:119], a[56:59], a[168:171], v[116:119]
  v_exp_f32 v80, v80
  v_mfma_f32_16x16x32_bf16 v[124:127], a[56:59], a[184:187], v[124:127]
  buffer_load_dwordx4 v2, s[20:23], s28 offen offset:2048 lds
  ds_read_b128 a[32:35], v3 offset:0
  v_mfma_f32_16x16x32_bf16 v[116:119], a[60:63], a[172:175], v[116:119]
  v_exp_f32 v81, v81
  v_mfma_f32_16x16x32_bf16 v[124:127], a[60:63], a[188:191], v[124:127]
  s_waitcnt lgkmcnt(5)
  ds_read_b128 a[36:39], v3 offset:1024
  ds_read_b128 a[40:43], v3 offset:2048
  v_mfma_f32_16x16x32_bf16 v[160:163], a[0:3], v[52:55], v[160:163]
  v_exp_f32 v82, v82
  v_mfma_f32_16x16x32_bf16 v[192:195], a[0:3], v[56:59], v[192:195]
  v_exp_f32 v83, v83
  v_mfma_f32_16x16x32_bf16 v[224:227], a[0:3], v[60:63], v[224:227]
  ds_read_b128 a[44:47], v3 offset:3072
  v_cvt_pk_bf16_f32 v39, v78, v79
  v_mfma_f32_16x16x32_bf16 a[196:199], a[208:211], v[52:55], a[196:199]
  v_exp_f32 v84, v84
  v_mfma_f32_16x16x32_bf16 v[164:167], a[4:7], v[52:55], v[164:167]
  ds_read_b128 a[48:51], v3 offset:4096
  v_cvt_pk_bf16_f32 v40, v80, v81
  v_mfma_f32_16x16x32_bf16 v[196:199], a[4:7], v[56:59], v[196:199]
  v_exp_f32 v85, v85
  v_mfma_f32_16x16x32_bf16 v[228:231], a[4:7], v[60:63], v[228:231]
  v_cvt_pk_bf16_f32 v41, v82, v83
  v_cvt_pk_bf16_f32 v42, v84, v85
  v_mfma_f32_16x16x32_bf16 a[200:203], a[208:211], v[56:59], a[200:203]
  v_exp_f32 v86, v86
  v_mfma_f32_16x16x32_bf16 v[168:171], a[8:11], v[52:55], v[168:171]
  v_exp_f32 v87, v87
  v_mfma_f32_16x16x32_bf16 v[200:203], a[8:11], v[56:59], v[200:203]
  ds_read_b128 a[52:55], v3 offset:5120
  v_cvt_pk_bf16_f32 v43, v86, v87
  v_mfma_f32_16x16x32_bf16 v[232:235], a[8:11], v[60:63], v[232:235]
  v_exp_f32 v88, v88
  v_mfma_f32_16x16x32_bf16 a[204:207], a[208:211], v[60:63], a[204:207]
  buffer_load_dwordx4 v2, s[20:23], s28 offen offset:3072 lds
  v_mfma_f32_16x16x32_bf16 v[172:175], a[12:15], v[52:55], v[172:175]
  s_xor_b32 s26, s26, 0x4000
  v_exp_f32 v89, v89
  v_mfma_f32_16x16x32_bf16 v[204:207], a[12:15], v[56:59], v[204:207]
  s_add_u32 s28, s28, 0x8000
  ds_read_b128 a[56:59], v3 offset:6144
  v_cvt_pk_bf16_f32 v44, v88, v89
  v_mfma_f32_16x16x32_bf16 v[236:239], a[12:15], v[60:63], v[236:239]
  s_waitcnt lgkmcnt(7)
  v_exp_f32 v90, v90
  v_mfma_f32_16x16x32_bf16 v[176:179], a[16:19], v[52:55], v[176:179]
  ds_read_b128 a[60:63], v3 offset:7168
  v_mfma_f32_16x16x32_bf16 v[208:211], a[16:19], v[56:59], v[208:211]
  v_exp_f32 v91, v91
  v_mfma_f32_16x16x32_bf16 v[240:243], a[16:19], v[60:63], v[240:243]
  v_exp_f32 v92, v92
  v_mfma_f32_16x16x32_bf16 v[180:183], a[20:23], v[52:55], v[180:183]
  ds_read_b128 a[0:3], v3 offset:8192
  v_cvt_pk_bf16_f32 v45, v90, v91
  v_mfma_f32_16x16x32_bf16 v[212:215], a[20:23], v[56:59], v[212:215]
  v_exp_f32 v93, v93
  v_mfma_f32_16x16x32_bf16 v[244:247], a[20:23], v[60:63], v[244:247]
  v_cvt_pk_bf16_f32 v46, v92, v93
  v_mfma_f32_16x16x32_bf16 v[184:187], a[24:27], v[52:55], v[184:187]
  v_exp_f32 v94, v94
  v_mfma_f32_16x16x32_bf16 v[216:219], a[24:27], v[56:59], v[216:219]
  ds_read_b128 a[4:7], v3 offset:9216
  v_mfma_f32_16x16x32_bf16 v[248:251], a[24:27], v[60:63], v[248:251]
  v_exp_f32 v95, v95
  v_mfma_f32_16x16x32_bf16 v[188:191], a[28:31], v[52:55], v[188:191]
  ds_read_b128 a[8:11], v3 offset:10240
  v_cvt_pk_bf16_f32 v47, v94, v95
  v_mfma_f32_16x16x32_bf16 v[220:223], a[28:31], v[56:59], v[220:223]
  v_mfma_f32_16x16x32_bf16 v[252:255], a[28:31], v[60:63], v[252:255]
  s_lshl_b32 s4, s25, 20
  s_lshl_b32 s5, s24, 15
  s_add_u32 s4, s4, s5
  s_lshl_b32 s5, s3, 11
  s_add_u32 s4, s4, s5
  v_accvgpr_read_b32 v6, a192
  v_accvgpr_read_b32 v8, a196
  s_mov_b32 s5, 0x5f800000
  v_cmp_ngt_f32 vcc, s5, v6
  v_rcp_f32 v6, v6
  s_or_b32 s89, s89, vcc_lo
  s_or_b32 s89, s89, vcc_hi
  v_mov_b32 v7, v6
  v_cmp_ngt_f32 vcc, s5, v8
  v_rcp_f32 v8, v8
  s_or_b32 s89, s89, vcc_lo
  s_or_b32 s89, s89, vcc_hi
  v_mov_b32 v9, v8
  v_pk_mul_f32 v[128:129], v[128:129], v[6:7]
  v_pk_mul_f32 v[130:131], v[130:131], v[6:7]
  v_pk_mul_f32 v[132:133], v[132:133], v[6:7]
  v_pk_mul_f32 v[134:135], v[134:135], v[6:7]
  v_cvt_pk_bf16_f32 v128, v128, v129
  v_cvt_pk_bf16_f32 v129, v130, v131
  v_cvt_pk_bf16_f32 v130, v132, v133
  v_cvt_pk_bf16_f32 v131, v134, v135
  buffer_store_dwordx4 v[128:131], v2, s[16:19], s4 offen offset:0 sc1
  v_pk_mul_f32 v[160:161], v[160:161], v[8:9]
  v_pk_mul_f32 v[162:163], v[162:163], v[8:9]
  v_pk_mul_f32 v[164:165], v[164:165], v[8:9]
  v_pk_mul_f32 v[166:167], v[166:167], v[8:9]
  v_cvt_pk_bf16_f32 v160, v160, v161
  v_cvt_pk_bf16_f32 v161, v162, v163
  v_cvt_pk_bf16_f32 v162, v164, v165
  v_cvt_pk_bf16_f32 v163, v166, v167
  buffer_store_dwordx4 v[160:163], v2, s[16:19], s4 offen offset:1024 sc1
  s_add_u32 s4, s4, 8192
  v_pk_mul_f32 v[136:137], v[136:137], v[6:7]
  v_pk_mul_f32 v[138:139], v[138:139], v[6:7]
  v_pk_mul_f32 v[140:141], v[140:141], v[6:7]
  v_pk_mul_f32 v[142:143], v[142:143], v[6:7]
  v_cvt_pk_bf16_f32 v136, v136, v137
  v_cvt_pk_bf16_f32 v137, v138, v139
  v_cvt_pk_bf16_f32 v138, v140, v141
  v_cvt_pk_bf16_f32 v139, v142, v143
  buffer_store_dwordx4 v[136:139], v2, s[16:19], s4 offen offset:0 sc1
  v_pk_mul_f32 v[168:169], v[168:169], v[8:9]
  v_pk_mul_f32 v[170:171], v[170:171], v[8:9]
  v_pk_mul_f32 v[172:173], v[172:173], v[8:9]
  v_pk_mul_f32 v[174:175], v[174:175], v[8:9]
  v_cvt_pk_bf16_f32 v168, v168, v169
  v_cvt_pk_bf16_f32 v169, v170, v171
  v_cvt_pk_bf16_f32 v170, v172, v173
  v_cvt_pk_bf16_f32 v171, v174, v175
  buffer_store_dwordx4 v[168:171], v2, s[16:19], s4 offen offset:1024 sc1
  s_add_u32 s4, s4, 8192
  v_pk_mul_f32 v[144:145], v[144:145], v[6:7]
  v_pk_mul_f32 v[146:147], v[146:147], v[6:7]
  v_pk_mul_f32 v[148:149], v[148:149], v[6:7]
  v_pk_mul_f32 v[150:151], v[150:151], v[6:7]
  v_cvt_pk_bf16_f32 v144, v144, v145
  v_cvt_pk_bf16_f32 v145, v146, v147
  v_cvt_pk_bf16_f32 v146, v148, v149
  v_cvt_pk_bf16_f32 v147, v150, v151
  buffer_store_dwordx4 v[144:147], v2, s[16:19], s4 offen offset:0 sc1
  v_pk_mul_f32 v[176:177], v[176:177], v[8:9]
  v_pk_mul_f32 v[178:179], v[178:179], v[8:9]
  v_pk_mul_f32 v[180:181], v[180:181], v[8:9]
  v_pk_mul_f32 v[182:183], v[182:183], v[8:9]
  v_cvt_pk_bf16_f32 v176, v176, v177
  v_cvt_pk_bf16_f32 v177, v178, v179
  v_cvt_pk_bf16_f32 v178, v180, v181
  v_cvt_pk_bf16_f32 v179, v182, v183
  buffer_store_dwordx4 v[176:179], v2, s[16:19], s4 offen offset:1024 sc1
  s_add_u32 s4, s4, 8192
  v_pk_mul_f32 v[152:153], v[152:153], v[6:7]
  v_pk_mul_f32 v[154:155], v[154:155], v[6:7]
  v_pk_mul_f32 v[156:157], v[156:157], v[6:7]
  v_pk_mul_f32 v[158:159], v[158:159], v[6:7]
  v_cvt_pk_bf16_f32 v152, v152, v153
  v_cvt_pk_bf16_f32 v153, v154, v155
  v_cvt_pk_bf16_f32 v154, v156, v157
  v_cvt_pk_bf16_f32 v155, v158, v159
  buffer_store_dwordx4 v[152:155], v2, s[16:19], s4 offen offset:0 sc1
  v_pk_mul_f32 v[184:185], v[184:185], v[8:9]
  v_pk_mul_f32 v[186:187], v[186:187], v[8:9]
  v_pk_mul_f32 v[188:189], v[188:189], v[8:9]
  v_pk_mul_f32 v[190:191], v[190:191], v[8:9]
  v_cvt_pk_bf16_f32 v184, v184, v185
  v_cvt_pk_bf16_f32 v185, v186, v187
  v_cvt_pk_bf16_f32 v186, v188, v189
  v_cvt_pk_bf16_f32 v187, v190, v191
  buffer_store_dwordx4 v[184:187], v2, s[16:19], s4 offen offset:1024 sc1
  s_lshl_b32 s88, s25, 1
  s_sub_u32 s88, 14, s88
  .p2align 6
La_so:
  s_waitcnt vmcnt(12)
  s_barrier
  s_waitcnt lgkmcnt(3)
  v_mfma_f32_16x16x32_bf16 v[64:67], a[32:35], a[160:163], v[24:27]
  s_mov_b32 m0, s26
  v_exp_f32 v96, v96
  v_mfma_f32_16x16x32_bf16 v[72:75], a[32:35], a[176:179], v[28:31]
  buffer_load_dwordx4 v2, s[20:23], s28 offen offset:0 lds
  ds_read_b128 a[12:15], v3 offset:11264
  v_mfma_f32_16x16x32_bf16 v[64:67], a[36:39], a[164:167], v[64:67]
  v_exp_f32 v97, v97
  v_mfma_f32_16x16x32_bf16 v[72:75], a[36:39], a[180:183], v[72:75]
  ds_read_b128 a[16:19], v3 offset:12288
  v_cvt_pk_bf16_f32 v48, v96, v97
  v_mfma_f32_16x16x32_bf16 v[64:67], a[40:43], a[168:171], v[64:67]
  v_exp_f32 v98, v98
  v_mfma_f32_16x16x32_bf16 v[72:75], a[40:43], a[184:187], v[72:75]
  ds_read_b128 a[20:23], v3 offset:13312
  v_mfma_f32_16x16x32_bf16 v[64:67], a[44:47], a[172:175], v[64:67]
  v_exp_f32 v99, v99
  v_mfma_f32_16x16x32_bf16 v[72:75], a[44:47], a[188:191], v[72:75]
  ds_read_b128 a[24:27], v3 offset:14336
  v_cvt_pk_bf16_f32 v49, v98, v99
  v_mfma_f32_16x16x32_bf16 v[68:71], a[48:51], a[160:163], v[24:27]
  v_exp_f32 v100, v100
  v_mfma_f32_16x16x32_bf16 v[76:79], a[48:51], a[176:179], v[28:31]
  buffer_load_dwordx4 v2, s[20:23], s28 offen offset:1024 lds
  ds_read_b128 a[28:31], v3 offset:15360
  v_mfma_f32_16x16x32_bf16 v[68:71], a[52:55], a[164:167], v[68:71]
  v_exp_f32 v101, v101
  v_mfma_f32_16x16x32_bf16 v[76:79], a[52:55], a[180:183], v[76:79]
  ds_read_b128 a[32:35], v4 offset:0
  v_cvt_pk_bf16_f32 v50, v100, v101
  v_mfma_f32_16x16x32_bf16 v[68:71], a[56:59], a[168:171], v[68:71]
  v_exp_f32 v102, v102
  v_mfma_f32_16x16x32_bf16 v[76:79], a[56:59], a[184:187], v[76:79]
  ds_read_b128 a[36:39], v4 offset:1024
  v_mfma_f32_16x16x32_bf16 v[68:71], a[60:63], a[172:175], v[68:71]
  v_exp_f32 v103, v103
  v_mfma_f32_16x16x32_bf16 v[76:79], a[60:63], a[188:191], v[76:79]
  s_waitcnt lgkmcnt(2)
  ds_read_b128 a[40:43], v4 offset:2048
  v_cvt_pk_bf16_f32 v51, v102, v103
  v_mfma_f32_16x16x32_bf16 v[80:83], a[0:3], a[160:163], v[24:27]
  v_exp_f32 v104, v104
  v_mfma_f32_16x16x32_bf16 v[88:91], a[0:3], a[176:179], v[28:31]
  buffer_load_dwordx4 v2, s[20:23], s28 offen offset:2048 lds
  ds_read_b128 a[44:47], v4 offset:3072
  v_mfma_f32_16x16x32_bf16 v[80:83], a[4:7], a[164:167], v[80:83]
  v_exp_f32 v105, v105
  v_mfma_f32_16x16x32_bf16 v[88:91], a[4:7], a[180:183], v[88:91]
  ds_read_b128 a[48:51], v4 offset:4096
  v_cvt_pk_bf16_f32 v52, v104, v105
  v_mfma_f32_16x16x32_bf16 v[80:83], a[8:11], a[168:171], v[80:83]
  v_exp_f32 v106, v106
  v_mfma_f32_16x16x32_bf16 v[88:91], a[8:11], a[184:187], v[88:91]
  ds_read_b128 a[52:55], v4 offset:5120
  v_mfma_f32_16x16x32_bf16 v[80:83], a[12:15], a[172:175], v[80:83]
  v_exp_f32 v107, v107
  v_mfma_f32_16x16x32_bf16 v[88:91], a[12:15], a[188:191], v[88:91]
  ds_read_b128 a[56:59], v4 offset:6144
  v_cvt_pk_bf16_f32 v53, v106, v107
  v_mfma_f32_16x16x32_bf16 v[84:87], a[16:19], a[160:163], v[24:27]
  v_exp_f32 v108, v108
  v_mfma_f32_16x16x32_bf16 v[92:95], a[16:19], a[176:179], v[28:31]
  buffer_load_dwordx4 v2, s[20:23], s28 offen offset:3072 lds
  ds_read_b128 a[60:63], v4 offset:7168
  v_mfma_f32_16x16x32_bf16 v[84:87], a[20:23], a[164:167], v[84:87]
  s_xor_b32 s26, s26, 0x8000
  v_exp_f32 v109, v109
  v_mfma_f32_16x16x32_bf16 v[92:95], a[20:23], a[180:183], v[92:95]
  s_add_u32 s28, s28, 0x8000
  s_mov_b32 m0, s27
  ds_read_b128 a[0:3], v4 offset:8192
  v_mfma_f32_16x16x32_bf16 v[84:87], a[24:27], a[168:171], v[84:87]
  v_exp_f32 v110, v110
  v_mfma_f32_16x16x32_bf16 v[92:95], a[24:27], a[184:187], v[92:95]
  ds_read_b128 a[4:7], v4 offset:9216
  v_cvt_pk_bf16_f32 v54, v108, v109
  v_mfma_f32_16x16x32_bf16 v[84:87], a[28:31], a[172:175], v[84:87]
  v_exp_f32 v111, v111
  v_mfma_f32_16x16x32_bf16 v[92:95], a[28:31], a[188:191], v[92:95]
  s_waitcnt lgkmcnt(2)
  ds_read_b128 a[8:11], v4 offset:10240
  v_cvt_pk_bf16_f32 v55, v110, v111
  v_mfma_f32_16x16x32_bf16 v[192:195], a[32:35], v[32:35], v[192:195]
  ds_read_b128 a[12:15], v4 offset:11264
  v_mfma_f32_16x16x32_bf16 v[224:227], a[32:35], v[36:39], v[224:227]
  v_exp_f32 v112, v112
  v_mfma_f32_16x16x32_bf16 a[200:203], a[208:211], v[32:35], a[200:203]
  s_sub_u32 s88, s88, 1
  buffer_load_dwordx4 v2, s[20:23], s29 offen offset:0 lds
  v_mfma_f32_16x16x32_bf16 v[196:199], a[36:39], v[32:35], v[196:199]
  v_exp_f32 v113, v113
  v_mfma_f32_16x16x32_bf16 v[228:231], a[36:39], v[36:39], v[228:231]
  ds_read_b128 a[16:19], v4 offset:12288
  v_cvt_pk_bf16_f32 v56, v112, v113
  v_mfma_f32_16x16x32_bf16 a[204:207], a[208:211], v[36:39], a[204:207]
  v_exp_f32 v114, v114
  v_mfma_f32_16x16x32_bf16 v[200:203], a[40:43], v[32:35], v[200:203]
  ds_read_b128 a[20:23], v4 offset:13312
  v_mfma_f32_16x16x32_bf16 v[232:235], a[40:43], v[36:39], v[232:235]
  v_exp_f32 v115, v115
  v_mfma_f32_16x16x32_bf16 v[204:207], a[44:47], v[32:35], v[204:207]
  ds_read_b128 a[24:27], v4 offset:14336
  v_cvt_pk_bf16_f32 v57, v114, v115
  v_mfma_f32_16x16x32_bf16 v[236:239], a[44:47], v[36:39], v[236:239]
  v_exp_f32 v116, v116
  v_mfma_f32_16x16x32_bf16 v[208:211], a[48:51], v[32:35], v[208:211]
  buffer_load_dwordx4 v2, s[20:23], s29 offen offset:1024 lds
  ds_read_b128 a[28:31], v4 offset:15360
  v_mfma_f32_16x16x32_bf16 v[240:243], a[48:51], v[36:39], v[240:243]
  v_exp_f32 v117, v117
  v_mfma_f32_16x16x32_bf16 v[212:215], a[52:55], v[32:35], v[212:215]
  v_xor_b32 v4, 0x4000, v4
  v_xor_b32 v3, 0x4000, v3
  v_mfma_f32_16x16x32_bf16 v[244:247], a[52:55], v[36:39], v[244:247]
  v_exp_f32 v118, v118
  v_mfma_f32_16x16x32_bf16 v[216:219], a[56:59], v[32:35], v[216:219]
  ds_read_b128 a[32:35], v3 offset:0
  ds_read_b128 a[36:39], v3 offset:1024
  v_mfma_f32_16x16x32_bf16 v[248:251], a[56:59], v[36:39], v[248:251]
  v_exp_f32 v119, v119
  v_mfma_f32_16x16x32_bf16 v[220:223], a[60:63], v[32:35], v[220:223]
  ds_read_b128 a[40:43], v3 offset:2048
  v_cvt_pk_bf16_f32 v58, v116, v117
  v_mfma_f32_16x16x32_bf16 v[252:255], a[60:63], v[36:39], v[252:255]
  s_waitcnt lgkmcnt(3)
  v_exp_f32 v120, v120
  v_mfma_f32_16x16x32_bf16 v[192:195], a[0:3], v[40:43], v[192:195]
  buffer_load_dwordx4 v2, s[20:23], s29 offen offset:2048 lds
  ds_read_b128 a[44:47], v3 offset:3072
  v_mfma_f32_16x16x32_bf16 v[224:227], a[0:3], v[44:47], v[224:227]
  v_exp_f32 v121, v121
  v_mfma_f32_16x16x32_bf16 a[200:203], a[208:211], v[40:43], a[200:203]
  v_cvt_pk_bf16_f32 v59, v118, v119
  v_cvt_pk_bf16_f32 v60, v120, v121
  v_mfma_f32_16x16x32_bf16 v[196:199], a[4:7], v[40:43], v[196:199]
  v_exp_f32 v122, v122
  v_mfma_f32_16x16x32_bf16 v[228:231], a[4:7], v[44:47], v[228:231]
  ds_read_b128 a[48:51], v3 offset:4096
  v_mfma_f32_16x16x32_bf16 a[204:207], a[208:211], v[44:47], a[204:207]
  v_exp_f32 v123, v123
  v_mfma_f32_16x16x32_bf16 v[200:203], a[8:11], v[40:43], v[200:203]
  ds_read_b128 a[52:55], v3 offset:5120
  v_cvt_pk_bf16_f32 v61, v122, v123
  v_mfma_f32_16x16x32_bf16 v[232:235], a[8:11], v[44:47], v[232:235]
  v_exp_f32 v124, v124
  v_mfma_f32_16x16x32_bf16 v[204:207], a[12:15], v[40:43], v[204:207]
  buffer_load_dwordx4 v2, s[20:23], s29 offen offset:3072 lds
  ds_read_b128 a[56:59], v3 offset:6144
  v_mfma_f32_16x16x32_bf16 v[236:239], a[12:15], v[44:47], v[236:239]
  s_xor_b32 s27, s27, 0x8000
  v_exp_f32 v125, v125
  v_mfma_f32_16x16x32_bf16 v[208:211], a[16:19], v[40:43], v[208:211]
  s_add_u32 s29, s29, 0x8000
  ds_read_b128 a[60:63], v3 offset:7168
  v_cvt_pk_bf16_f32 v62, v124, v125
  v_mfma_f32_16x16x32_bf16 v[240:243], a[16:19], v[44:47], v[240:243]
  v_exp_f32 v126, v126
  v_mfma_f32_16x16x32_bf16 v[212:215], a[20:23], v[40:43], v[212:215]
  ds_read_b128 a[0:3], v3 offset:8192
  v_mfma_f32_16x16x32_bf16 v[244:247], a[20:23], v[44:47], v[244:247]
  v_exp_f32 v127, v127
  v_mfma_f32_16x16x32_bf16 v[216:219], a[24:27], v[40:43], v[216:219]
  ds_read_b128 a[4:7], v3 offset:9216
  v_cvt_pk_bf16_f32 v63, v126, v127
  v_mfma_f32_16x16x32_bf16 v[248:251], a[24:27], v[44:47], v[248:251]
  v_mfma_f32_16x16x32_bf16 v[220:223], a[28:31], v[40:43], v[220:223]
  ds_read_b128 a[8:11], v3 offset:10240
  v_mfma_f32_16x16x32_bf16 v[252:255], a[28:31], v[44:47], v[252:255]
  s_cmp_eq_u32 s88, 0
  s_cbranch_scc1 La_e0
  s_waitcnt vmcnt(12)
  s_barrier
  s_waitcnt lgkmcnt(3)
  v_mfma_f32_16x16x32_bf16 v[96:99], a[32:35], a[160:163], v[24:27]
  s_mov_b32 m0, s26
  v_exp_f32 v64, v64
  v_mfma_f32_16x16x32_bf16 v[104:107], a[32:35], a[176:179], v[28:31]
  buffer_load_dwordx4 v2, s[20:23], s28 offen offset:0 lds
  ds_read_b128 a[12:15], v3 offset:11264
  v_mfma_f32_16x16x32_bf16 v[96:99], a[36:39], a[164:167], v[96:99]
  v_exp_f32 v65, v65
  v_mfma_f32_16x16x32_bf16 v[104:107], a[36:39], a[180:183], v[104:107]
  ds_read_b128 a[16:19], v3 offset:12288
  v_cvt_pk_bf16_f32 v32, v64, v65
  v_mfma_f32_16x16x32_bf16 v[96:99], a[40:43], a[168:171], v[96:99]
  v_exp_f32 v66, v66
  v_mfma_f32_16x16x32_bf16 v[104:107], a[40:43], a[184:187], v[104:107]
  ds_read_b128 a[20:23], v3 offset:13312
  v_mfma_f32_16x16x32_bf16 v[96:99], a[44:47], a[172:175], v[96:99]
  v_exp_f32 v67, v67
  v_mfma_f32_16x16x32_bf16 v[104:107], a[44:47], a[188:191], v[104:107]
  ds_read_b128 a[24:27], v3 offset:14336
  v_cvt_pk_bf16_f32 v33, v66, v67
  v_mfma_f32_16x16x32_bf16 v[100:103], a[48:51], a[160:163], v[24:27]
  v_exp_f32 v68, v68
  v_mfma_f32_16x16x32_bf16 v[108:111], a[48:51], a[176:179], v[28:31]
  buffer_load_dwordx4 v2, s[20:23], s28 offen offset:1024 lds
  ds_read_b128 a[28:31], v3 offset:15360
  v_mfma_f32_16x16x32_bf16 v[100:103], a[52:55], a[164:167], v[100:103]
  v_exp_f32 v69, v69
  v_mfma_f32_16x16x32_bf16 v[108:111], a[52:55], a[180:183], v[108:111]
  ds_read_b128 a[32:35], v4 offset:0
  v_cvt_pk_bf16_f32 v34, v68, v69
  v_mfma_f32_16x16x32_bf16 v[100:103], a[56:59], a[168:171], v[100:103]
  v_exp_f32 v70, v70
  v_mfma_f32_16x16x32_bf16 v[108:111], a[56:59], a[184:187], v[108:111]
  ds_read_b128 a[36:39], v4 offset:1024
  v_mfma_f32_16x16x32_bf16 v[100:103], a[60:63], a[172:175], v[100:103]
  v_exp_f32 v71, v71
  v_mfma_f32_16x16x32_bf16 v[108:111], a[60:63], a[188:191], v[108:111]
  s_waitcnt lgkmcnt(2)
  ds_read_b128 a[40:43], v4 offset:2048
  v_cvt_pk_bf16_f32 v35, v70, v71
  v_mfma_f32_16x16x32_bf16 v[112:115], a[0:3], a[160:163], v[24:27]
  v_exp_f32 v72, v72
  v_mfma_f32_16x16x32_bf16 v[120:123], a[0:3], a[176:179], v[28:31]
  buffer_load_dwordx4 v2, s[20:23], s28 offen offset:2048 lds
  ds_read_b128 a[44:47], v4 offset:3072
  v_mfma_f32_16x16x32_bf16 v[112:115], a[4:7], a[164:167], v[112:115]
  v_exp_f32 v73, v73
  v_mfma_f32_16x16x32_bf16 v[120:123], a[4:7], a[180:183], v[120:123]
  ds_read_b128 a[48:51], v4 offset:4096
  v_cvt_pk_bf16_f32 v36, v72, v73
  v_mfma_f32_16x16x32_bf16 v[112:115], a[8:11], a[168:171], v[112:115]
  v_exp_f32 v74, v74
  v_mfma_f32_16x16x32_bf16 v[120:123], a[8:11], a[184:187], v[120:123]
  ds_read_b128 a[52:55], v4 offset:5120
  v_mfma_f32_16x16x32_bf16 v[112:115], a[12:15], a[172:175], v[112:115]
  v_exp_f32 v75, v75
  v_mfma_f32_16x16x32_bf16 v[120:123], a[12:15], a[188:191], v[120:123]
  ds_read_b128 a[56:59], v4 offset:6144
  v_cvt_pk_bf16_f32 v37, v74, v75
  v_mfma_f32_16x16x32_bf16 v[116:119], a[16:19], a[160:163], v[24:27]
  v_exp_f32 v76, v76
  v_mfma_f32_16x16x32_bf16 v[124:127], a[16:19], a[176:179], v[28:31]
  buffer_load_dwordx4 v2, s[20:23], s28 offen offset:3072 lds
  ds_read_b128 a[60:63], v4 offset:7168
  v_mfma_f32_16x16x32_bf16 v[116:119], a[20:23], a[164:167], v[116:119]
  s_xor_b32 s26, s26, 0x4000
  v_exp_f32 v77, v77
  v_mfma_f32_16x16x32_bf16 v[124:127], a[20:23], a[180:183], v[124:127]
  s_add_u32 s28, s28, 0x8000
  s_mov_b32 m0, s27
  ds_read_b128 a[0:3], v4 offset:8192
  v_mfma_f32_16x16x32_bf16 v[116:119], a[24:27], a[168:171], v[116:119]
  v_exp_f32 v78, v78
  v_mfma_f32_16x16x32_bf16 v[124:127], a[24:27], a[184:187], v[124:127]
  ds_read_b128 a[4:7], v4 offset:9216
  v_cvt_pk_bf16_f32 v38, v76, v77
  v_mfma_f32_16x16x32_bf16 v[116:119], a[28:31], a[172:175], v[116:119]
  v_exp_f32 v79, v79
  v_mfma_f32_16x16x32_bf16 v[124:127], a[28:31], a[188:191], v[124:127]
  s_waitcnt lgkmcnt(2)
  ds_read_b128 a[8:11], v4 offset:10240
  v_cvt_pk_bf16_f32 v39, v78, v79
  v_mfma_f32_16x16x32_bf16 v[192:195], a[32:35], v[48:51], v[192:195]
  ds_read_b128 a[12:15], v4 offset:11264
  v_mfma_f32_16x16x32_bf16 v[224:227], a[32:35], v[52:55], v[224:227]
  v_exp_f32 v80, v80
  v_mfma_f32_16x16x32_bf16 a[200:203], a[208:211], v[48:51], a[200:203]
  buffer_load_dwordx4 v2, s[20:23], s29 offen offset:0 lds
  v_mfma_f32_16x16x32_bf16 v[196:199], a[36:39], v[48:51], v[196:199]
  v_exp_f32 v81, v81
  v_mfma_f32_16x16x32_bf16 v[228:231], a[36:39], v[52:55], v[228:231]
  ds_read_b128 a[16:19], v4 offset:12288
  v_cvt_pk_bf16_f32 v40, v80, v81
  v_mfma_f32_16x16x32_bf16 a[204:207], a[208:211], v[52:55], a[204:207]
  v_exp_f32 v82, v82
  v_mfma_f32_16x16x32_bf16 v[200:203], a[40:43], v[48:51], v[200:203]
  ds_read_b128 a[20:23], v4 offset:13312
  v_mfma_f32_16x16x32_bf16 v[232:235], a[40:43], v[52:55], v[232:235]
  v_exp_f32 v83, v83
  v_mfma_f32_16x16x32_bf16 v[204:207], a[44:47], v[48:51], v[204:207]
  ds_read_b128 a[24:27], v4 offset:14336
  v_cvt_pk_bf16_f32 v41, v82, v83
  v_mfma_f32_16x16x32_bf16 v[236:239], a[44:47], v[52:55], v[236:239]
  v_exp_f32 v84, v84
  v_mfma_f32_16x16x32_bf16 v[208:211], a[48:51], v[48:51], v[208:211]
  buffer_load_dwordx4 v2, s[20:23], s29 offen offset:1024 lds
  ds_read_b128 a[28:31], v4 offset:15360
  v_mfma_f32_16x16x32_bf16 v[240:243], a[48:51], v[52:55], v[240:243]
  v_exp_f32 v85, v85
  v_mfma_f32_16x16x32_bf16 v[212:215], a[52:55], v[48:51], v[212:215]
  v_xor_b32 v4, 0x8000, v4
  v_xor_b32 v3, 0x8000, v3
  v_mfma_f32_16x16x32_bf16 v[244:247], a[52:55], v[52:55], v[244:247]
  v_exp_f32 v86, v86
  v_mfma_f32_16x16x32_bf16 v[216:219], a[56:59], v[48:51], v[216:219]
  ds_read_b128 a[32:35], v3 offset:0
  ds_read_b128 a[36:39], v3 offset:1024
  v_mfma_f32_16x16x32_bf16 v[248:251], a[56:59], v[52:55], v[248:251]
  v_exp_f32 v87, v87
  v_mfma_f32_16x16x32_bf16 v[220:223], a[60:63], v[48:51], v[220:223]
  ds_read_b128 a[40:43], v3 offset:2048
  v_cvt_pk_bf16_f32 v42, v84, v85
  v_mfma_f32_16x16x32_bf16 v[252:255], a[60:63], v[52:55], v[252:255]
  s_waitcnt lgkmcnt(3)
  v_exp_f32 v88, v88
  v_mfma_f32_16x16x32_bf16 v[192:195], a[0:3], v[56:59], v[192:195]
  buffer_load_dwordx4 v2, s[20:23], s29 offen offset:2048 lds
  ds_read_b128 a[44:47], v3 offset:3072
  v_mfma_f32_16x16x32_bf16 v[224:227], a[0:3], v[60:63], v[224:227]
  v_exp_f32 v89, v89
  v_mfma_f32_16x16x32_bf16 a[200:203], a[208:211], v[56:59], a[200:203]
  v_cvt_pk_bf16_f32 v43, v86, v87
  v_cvt_pk_bf16_f32 v44, v88, v89
  v_mfma_f32_16x16x32_bf16 v[196:199], a[4:7], v[56:59], v[196:199]
  v_exp_f32 v90, v90
  v_mfma_f32_16x16x32_bf16 v[228:231], a[4:7], v[60:63], v[228:231]
  ds_read_b128 a[48:51], v3 offset:4096
  v_mfma_f32_16x16x32_bf16 a[204:207], a[208:211], v[60:63], a[204:207]
  v_exp_f32 v91, v91
  v_mfma_f32_16x16x32_bf16 v[200:203], a[8:11], v[56:59], v[200:203]
  ds_read_b128 a[52:55], v3 offset:5120
  v_cvt_pk_bf16_f32 v45, v90, v91
  v_mfma_f32_16x16x32_bf16 v[232:235], a[8:11], v[60:63], v[232:235]
  v_exp_f32 v92, v92
  v_mfma_f32_16x16x32_bf16 v[204:207], a[12:15], v[56:59], v[204:207]
  buffer_load_dwordx4 v2, s[20:23], s29 offen offset:3072 lds
  ds_read_b128 a[56:59], v3 offset:6144
  v_mfma_f32_16x16x32_bf16 v[236:239], a[12:15], v[60:63], v[236:239]
  s_xor_b32 s27, s27, 0x4000
  v_exp_f32 v93, v93
  v_mfma_f32_16x16x32_bf16 v[208:211], a[16:19], v[56:59], v[208:211]
  s_add_u32 s29, s29, 0x8000
  ds_read_b128 a[60:63], v3 offset:7168
  v_cvt_pk_bf16_f32 v46, v92, v93
  v_mfma_f32_16x16x32_bf16 v[240:243], a[16:19], v[60:63], v[240:243]
  v_exp_f32 v94, v94
  v_mfma_f32_16x16x32_bf16 v[212:215], a[20:23], v[56:59], v[212:215]
  ds_read_b128 a[0:3], v3 offset:8192
  v_mfma_f32_16x16x32_bf16 v[244:247], a[20:23], v[60:63], v[244:247]
  v_exp_f32 v95, v95
  v_mfma_f32_16x16x32_bf16 v[216:219], a[24:27], v[56:59], v[216:219]
  ds_read_b128 a[4:7], v3 offset:9216
  v_cvt_pk_bf16_f32 v47, v94, v95
  v_mfma_f32_16x16x32_bf16 v[248:251], a[24:27], v[60:63], v[248:251]
  v_mfma_f32_16x16x32_bf16 v[220:223], a[28:31], v[56:59], v[220:223]
  ds_read_b128 a[8:11], v3 offset:10240
  v_mfma_f32_16x16x32_bf16 v[252:255], a[28:31], v[60:63], v[252:255]
  s_branch La_so
La_t7:
  s_waitcnt vmcnt(27)
  s_barrier
  s_waitcnt lgkmcnt(7)
  v_mfma_f32_16x16x32_bf16 v[104:107], a[0:3], a[176:179], v[28:31]
  buffer_load_dwordx2 v[12:13], v14, s[96:99], s91 offen sc1
  ds_read_b128 a[44:47], v3 offset:11264
  v_mfma_f32_16x16x32_bf16 v[104:107], a[4:7], a[180:183], v[104:107]
  v_cndmask_b32 v64, v64, v5, s[32:33]
  v_exp_f32 v64, v64
  v_mfma_f32_16x16x32_bf16 v[104:107], a[8:11], a[184:187], v[104:107]
  v_cndmask_b32 v65, v65, v5, s[34:35]
  v_exp_f32 v65, v65
  v_mfma_f32_16x16x32_bf16 v[104:107], a[12:15], a[188:191], v[104:107]
  s_waitcnt lgkmcnt(4)
  v_cndmask_b32 v66, v66, v5, s[36:37]
  v_exp_f32 v66, v66
  v_mfma_f32_16x16x32_bf16 v[108:111], a[16:19], a[176:179], v[28:31]
  v_cndmask_b32 v67, v67, v5, s[38:39]
  v_exp_f32 v67, v67
  v_mfma_f32_16x16x32_bf16 v[108:111], a[20:23], a[180:183], v[108:111]
  v_cndmask_b32 v68, v68, v5, s[40:41]
  v_exp_f32 v68, v68
  v_mfma_f32_16x16x32_bf16 v[108:111], a[24:27], a[184:187], v[108:111]
  v_cndmask_b32 v69, v69, v5, s[42:43]
  v_exp_f32 v69, v69
  v_mfma_f32_16x16x32_bf16 v[108:111], a[28:31], a[188:191], v[108:111]
  s_waitcnt lgkmcnt(0)
  v_cndmask_b32 v70, v70, v5, s[44:45]
  v_exp_f32 v70, v70
  v_mfma_f32_16x16x32_bf16 v[120:123], a[32:35], a[176:179], v[28:31]
  v_cndmask_b32 v71, v71, v5, s[46:47]
  v_exp_f32 v71, v71
  v_mfma_f32_16x16x32_bf16 v[120:123], a[36:39], a[180:183], v[120:123]
  ds_read_b128 a[48:51], v3 offset:12288
  ds_read_b128 a[52:55], v3 offset:13312
  ds_read_b128 a[56:59], v3 offset:14336
  v_mfma_f32_16x16x32_bf16 v[120:123], a[40:43], a[184:187], v[120:123]
  ds_read_b128 a[60:63], v3 offset:15360
  v_exp_f32 v72, v72
  v_mfma_f32_16x16x32_bf16 v[120:123], a[44:47], a[188:191], v[120:123]
  s_waitcnt lgkmcnt(0)
  v_exp_f32 v73, v73
  v_cvt_pk_bf16_f32 v33, v66, v67
  v_mfma_f32_16x16x32_bf16 v[124:127], a[48:51], a[176:179], v[28:31]
  v_exp_f32 v74, v74
  v_cvt_pk_bf16_f32 v34, v68, v69
  v_mfma_f32_16x16x32_bf16 v[124:127], a[52:55], a[180:183], v[124:127]
  ds_read_b128 a[0:3], v4 offset:8192
  ds_read_b128 a[4:7], v4 offset:9216
  ds_read_b128 a[8:11], v4 offset:10240
  v_mfma_f32_16x16x32_bf16 v[124:127], a[56:59], a[184:187], v[124:127]
  ds_read_b128 a[12:15], v4 offset:11264
  v_exp_f32 v75, v75
  v_mfma_f32_16x16x32_bf16 v[124:127], a[60:63], a[188:191], v[124:127]
  s_waitcnt lgkmcnt(0)
  v_exp_f32 v76, v76
  v_cvt_pk_bf16_f32 v35, v70, v71
  v_mfma_f32_16x16x32_bf16 v[160:163], a[0:3], v[52:55], v[160:163]
  v_exp_f32 v77, v77
  v_cvt_pk_bf16_f32 v36, v72, v73
  v_mfma_f32_16x16x32_bf16 v[192:195], a[0:3], v[56:59], v[192:195]
  v_exp_f32 v78, v78
  v_cvt_pk_bf16_f32 v37, v74, v75
  v_mfma_f32_16x16x32_bf16 v[224:227], a[0:3], v[60:63], v[224:227]
  ds_read_b128 a[16:19], v4 offset:12288
  ds_read_b128 a[20:23], v4 offset:13312
  v_cvt_pk_bf16_f32 v38, v76, v77
  v_mfma_f32_16x16x32_bf16 a[196:199], a[208:211], v[52:55], a[196:199]
  v_exp_f32 v79, v79
  v_mfma_f32_16x16x32_bf16 v[164:167], a[4:7], v[52:55], v[164:167]
  v_cndmask_b32 v80, v80, v5, s[48:49]
  v_exp_f32 v80, v80
  v_cvt_pk_bf16_f32 v39, v78, v79
  v_mfma_f32_16x16x32_bf16 v[196:199], a[4:7], v[56:59], v[196:199]
  v_cndmask_b32 v81, v81, v5, s[50:51]
  v_exp_f32 v81, v81
  v_mfma_f32_16x16x32_bf16 v[228:231], a[4:7], v[60:63], v[228:231]
  ds_read_b128 a[24:27], v4 offset:14336
  ds_read_b128 a[28:31], v4 offset:15360
  v_cvt_pk_bf16_f32 v40, v80, v81
  v_mfma_f32_16x16x32_bf16 a[200:203], a[208:211], v[56:59], a[200:203]
  v_cndmask_b32 v82, v82, v5, s[52:53]
  v_exp_f32 v82, v82
  v_mfma_f32_16x16x32_bf16 v[168:171], a[8:11], v[52:55], v[168:171]
  v_cndmask_b32 v83, v83, v5, s[54:55]
  v_exp_f32 v83, v83
  v_mfma_f32_16x16x32_bf16 v[200:203], a[8:11], v[56:59], v[200:203]
  v_cndmask_b32 v84, v84, v5, s[56:57]
  v_exp_f32 v84, v84
  v_mfma_f32_16x16x32_bf16 v[232:235], a[8:11], v[60:63], v[232:235]
  v_cndmask_b32 v85, v85, v5, s[58:59]
  v_exp_f32 v85, v85
  v_mfma_f32_16x16x32_bf16 a[204:207], a[208:211], v[60:63], a[204:207]
  v_xor_b32 v4, 0x8000, v4
  v_cvt_pk_bf16_f32 v32, v64, v65
  v_cvt_pk_bf16_f32 v41, v82, v83
  v_mfma_f32_16x16x32_bf16 v[172:175], a[12:15], v[52:55], v[172:175]
  v_cndmask_b32 v86, v86, v5, s[60:61]
  v_exp_f32 v86, v86
  v_mfma_f32_16x16x32_bf16 v[204:207], a[12:15], v[56:59], v[204:207]
  v_cndmask_b32 v87, v87, v5, s[62:63]
  v_exp_f32 v87, v87
  v_mfma_f32_16x16x32_bf16 v[236:239], a[12:15], v[60:63], v[236:239]
  s_waitcnt lgkmcnt(0)
  v_exp_f32 v88, v88
  v_cvt_pk_bf16_f32 v42, v84, v85
  v_mfma_f32_16x16x32_bf16 v[176:179], a[16:19], v[52:55], v[176:179]
  ds_read_b128 a[32:35], v4 offset:0
  ds_read_b128 a[36:39], v4 offset:1024
  v_cvt_pk_bf16_f32 v43, v86, v87
  v_mfma_f32_16x16x32_bf16 v[208:211], a[16:19], v[56:59], v[208:211]
  v_exp_f32 v89, v89
  v_mfma_f32_16x16x32_bf16 v[240:243], a[16:19], v[60:63], v[240:243]
  v_exp_f32 v90, v90
  v_cvt_pk_bf16_f32 v44, v88, v89
  v_mfma_f32_16x16x32_bf16 v[180:183], a[20:23], v[52:55], v[180:183]
  v_exp_f32 v91, v91
  v_mfma_f32_16x16x32_bf16 v[212:215], a[20:23], v[56:59], v[212:215]
  v_exp_f32 v92, v92
  v_cvt_pk_bf16_f32 v45, v90, v91
  v_mfma_f32_16x16x32_bf16 v[244:247], a[20:23], v[60:63], v[244:247]
  ds_read_b128 a[40:43], v4 offset:2048
  ds_read_b128 a[44:47], v4 offset:3072
  v_mfma_f32_16x16x32_bf16 v[184:187], a[24:27], v[52:55], v[184:187]
  v_exp_f32 v93, v93
  v_mfma_f32_16x16x32_bf16 v[216:219], a[24:27], v[56:59], v[216:219]
  v_exp_f32 v94, v94
  v_cvt_pk_bf16_f32 v46, v92, v93
  v_mfma_f32_16x16x32_bf16 v[248:251], a[24:27], v[60:63], v[248:251]
  v_exp_f32 v95, v95
  v_mfma_f32_16x16x32_bf16 v[188:191], a[28:31], v[52:55], v[188:191]
  ds_read_b128 a[48:51], v4 offset:4096
  ds_read_b128 a[52:55], v4 offset:5120
  v_cvt_pk_bf16_f32 v47, v94, v95
  v_mfma_f32_16x16x32_bf16 v[220:223], a[28:31], v[56:59], v[220:223]
  ds_read_b128 a[56:59], v4 offset:6144
  ds_read_b128 a[60:63], v4 offset:7168
  v_mfma_f32_16x16x32_bf16 v[252:255], a[28:31], v[60:63], v[252:255]
  ds_read_b128 a[0:3], v4 offset:8192
  ds_read_b128 a[4:7], v4 offset:9216
  ds_read_b128 a[8:11], v4 offset:10240
  s_lshl_b32 s4, s25, 20
  s_lshl_b32 s5, s24, 15
  s_add_u32 s4, s4, s5
  s_lshl_b32 s5, s3, 11
  s_add_u32 s4, s4, s5
  v_accvgpr_read_b32 v6, a192
  v_accvgpr_read_b32 v8, a196
  s_mov_b32 s5, 0x5f800000
  v_cmp_ngt_f32 vcc, s5, v6
  v_rcp_f32 v6, v6
  s_or_b32 s89, s89, vcc_lo
  s_or_b32 s89, s89, vcc_hi
  v_mov_b32 v7, v6
  v_cmp_ngt_f32 vcc, s5, v8
  v_rcp_f32 v8, v8
  s_or_b32 s89, s89, vcc_lo
  s_or_b32 s89, s89, vcc_hi
  v_mov_b32 v9, v8
  v_pk_mul_f32 v[128:129], v[128:129], v[6:7]
  v_pk_mul_f32 v[130:131], v[130:131], v[6:7]
  v_pk_mul_f32 v[132:133], v[132:133], v[6:7]
  v_pk_mul_f32 v[134:135], v[134:135], v[6:7]
  v_cvt_pk_bf16_f32 v128, v128, v129
  v_cvt_pk_bf16_f32 v129, v130, v131
  v_cvt_pk_bf16_f32 v130, v132, v133
  v_cvt_pk_bf16_f32 v131, v134, v135
  buffer_store_dwordx4 v[128:131], v2, s[16:19], s4 offen offset:0 sc1
  v_pk_mul_f32 v[160:161], v[160:161], v[8:9]
  v_pk_mul_f32 v[162:163], v[162:163], v[8:9]
  v_pk_mul_f32 v[164:165], v[164:165], v[8:9]
  v_pk_mul_f32 v[166:167], v[166:167], v[8:9]
  v_cvt_pk_bf16_f32 v160, v160, v161
  v_cvt_pk_bf16_f32 v161, v162, v163
  v_cvt_pk_bf16_f32 v162, v164, v165
  v_cvt_pk_bf16_f32 v163, v166, v167
  buffer_store_dwordx4 v[160:163], v2, s[16:19], s4 offen offset:1024 sc1
  s_add_u32 s4, s4, 8192
  v_pk_mul_f32 v[136:137], v[136:137], v[6:7]
  v_pk_mul_f32 v[138:139], v[138:139], v[6:7]
  v_pk_mul_f32 v[140:141], v[140:141], v[6:7]
  v_pk_mul_f32 v[142:143], v[142:143], v[6:7]
  v_cvt_pk_bf16_f32 v136, v136, v137
  v_cvt_pk_bf16_f32 v137, v138, v139
  v_cvt_pk_bf16_f32 v138, v140, v141
  v_cvt_pk_bf16_f32 v139, v142, v143
  buffer_store_dwordx4 v[136:139], v2, s[16:19], s4 offen offset:0 sc1
  v_pk_mul_f32 v[168:169], v[168:169], v[8:9]
  v_pk_mul_f32 v[170:171], v[170:171], v[8:9]
  v_pk_mul_f32 v[172:173], v[172:173], v[8:9]
  v_pk_mul_f32 v[174:175], v[174:175], v[8:9]
  v_cvt_pk_bf16_f32 v168, v168, v169
  v_cvt_pk_bf16_f32 v169, v170, v171
  v_cvt_pk_bf16_f32 v170, v172, v173
  v_cvt_pk_bf16_f32 v171, v174, v175
  buffer_store_dwordx4 v[168:171], v2, s[16:19], s4 offen offset:1024 sc1
  s_add_u32 s4, s4, 8192
  v_pk_mul_f32 v[144:145], v[144:145], v[6:7]
  v_pk_mul_f32 v[146:147], v[146:147], v[6:7]
  v_pk_mul_f32 v[148:149], v[148:149], v[6:7]
  v_pk_mul_f32 v[150:151], v[150:151], v[6:7]
  v_cvt_pk_bf16_f32 v144, v144, v145
  v_cvt_pk_bf16_f32 v145, v146, v147
  v_cvt_pk_bf16_f32 v146, v148, v149
  v_cvt_pk_bf16_f32 v147, v150, v151
  buffer_store_dwordx4 v[144:147], v2, s[16:19], s4 offen offset:0 sc1
  v_pk_mul_f32 v[176:177], v[176:177], v[8:9]
  v_pk_mul_f32 v[178:179], v[178:179], v[8:9]
  v_pk_mul_f32 v[180:181], v[180:181], v[8:9]
  v_pk_mul_f32 v[182:183], v[182:183], v[8:9]
  v_cvt_pk_bf16_f32 v176, v176, v177
  v_cvt_pk_bf16_f32 v177, v178, v179
  v_cvt_pk_bf16_f32 v178, v180, v181
  v_cvt_pk_bf16_f32 v179, v182, v183
  buffer_store_dwordx4 v[176:179], v2, s[16:19], s4 offen offset:1024 sc1
  s_add_u32 s4, s4, 8192
  v_pk_mul_f32 v[152:153], v[152:153], v[6:7]
  v_pk_mul_f32 v[154:155], v[154:155], v[6:7]
  v_pk_mul_f32 v[156:157], v[156:157], v[6:7]
  v_pk_mul_f32 v[158:159], v[158:159], v[6:7]
  v_cvt_pk_bf16_f32 v152, v152, v153
  v_cvt_pk_bf16_f32 v153, v154, v155
  v_cvt_pk_bf16_f32 v154, v156, v157
  v_cvt_pk_bf16_f32 v155, v158, v159
  buffer_store_dwordx4 v[152:155], v2, s[16:19], s4 offen offset:0 sc1
  v_pk_mul_f32 v[184:185], v[184:185], v[8:9]
  v_pk_mul_f32 v[186:187], v[186:187], v[8:9]
  v_pk_mul_f32 v[188:189], v[188:189], v[8:9]
  v_pk_mul_f32 v[190:191], v[190:191], v[8:9]
  v_cvt_pk_bf16_f32 v184, v184, v185
  v_cvt_pk_bf16_f32 v185, v186, v187
  v_cvt_pk_bf16_f32 v186, v188, v189
  v_cvt_pk_bf16_f32 v187, v190, v191
  buffer_store_dwordx4 v[184:187], v2, s[16:19], s4 offen offset:1024 sc1
  s_branch La_e1
La_e0:
  s_waitcnt vmcnt(8)
  s_barrier
  s_waitcnt lgkmcnt(7)
  v_mfma_f32_16x16x32_bf16 v[104:107], a[32:35], a[176:179], v[28:31]
  buffer_load_dwordx2 v[12:13], v14, s[96:99], s91 offen sc1
  ds_read_b128 a[12:15], v3 offset:11264
  v_mfma_f32_16x16x32_bf16 v[104:107], a[36:39], a[180:183], v[104:107]
  v_cndmask_b32 v64, v64, v5, s[32:33]
  v_exp_f32 v64, v64
  v_mfma_f32_16x16x32_bf16 v[104:107], a[40:43], a[184:187], v[104:107]
  v_cndmask_b32 v65, v65, v5, s[34:35]
  v_exp_f32 v65, v65
  v_mfma_f32_16x16x32_bf16 v[104:107], a[44:47], a[188:191], v[104:107]
  s_waitcnt lgkmcnt(4)
  v_cndmask_b32 v66, v66, v5, s[36:37]
  v_exp_f32 v66, v66
  v_mfma_f32_16x16x32_bf16 v[108:111], a[48:51], a[176:179], v[28:31]
  v_cndmask_b32 v67, v67, v5, s[38:39]
  v_exp_f32 v67, v67
  v_mfma_f32_16x16x32_bf16 v[108:111], a[52:55], a[180:183], v[108:111]
  ds_read_b128 a[16:19], v3 offset:12288
  ds_read_b128 a[20:23], v3 offset:13312
  v_mfma_f32_16x16x32_bf16 v[108:111], a[56:59], a[184:187], v[108:111]
  v_cndmask_b32 v68, v68, v5, s[40:41]
  v_exp_f32 v68, v68
  v_mfma_f32_16x16x32_bf16 v[108:111], a[60:63], a[188:191], v[108:111]
  s_waitcnt lgkmcnt(2)
  v_cndmask_b32 v69, v69, v5, s[42:43]
  v_exp_f32 v69, v69
  v_mfma_f32_16x16x32_bf16 v[120:123], a[0:3], a[176:179], v[28:31]
  ds_read_b128 a[24:27], v3 offset:14336
  ds_read_b128 a[28:31], v3 offset:15360
  v_mfma_f32_16x16x32_bf16 v[120:123], a[4:7], a[180:183], v[120:123]
  v_cndmask_b32 v70, v70, v5, s[44:45]
  v_exp_f32 v70, v70
  v_mfma_f32_16x16x32_bf16 v[120:123], a[8:11], a[184:187], v[120:123]
  v_cndmask_b32 v71, v71, v5, s[46:47]
  v_exp_f32 v71, v71
  v_mfma_f32_16x16x32_bf16 v[120:123], a[12:15], a[188:191], v[120:123]
  s_waitcnt lgkmcnt(0)
  ds_read_b128 a[32:35], v4 offset:0
  ds_read_b128 a[36:39], v4 offset:1024
  v_mfma_f32_16x16x32_bf16 v[124:127], a[16:19], a[176:179], v[28:31]
  v_exp_f32 v72, v72
  v_mfma_f32_16x16x32_bf16 v[124:127], a[20:23], a[180:183], v[124:127]
  ds_read_b128 a[40:43], v4 offset:2048
  ds_read_b128 a[44:47], v4 offset:3072
  ds_read_b128 a[48:51], v4 offset:4096
  v_mfma_f32_16x16x32_bf16 v[124:127], a[24:27], a[184:187], v[124:127]
  ds_read_b128 a[52:55], v4 offset:5120
  ds_read_b128 a[56:59], v4 offset:6144
  ds_read_b128 a[60:63], v4 offset:7168
  v_exp_f32 v73, v73
  v_mfma_f32_16x16x32_bf16 v[124:127], a[28:31], a[188:191], v[124:127]
  s_waitcnt lgkmcnt(0)
  v_exp_f32 v74, v74
  v_mfma_f32_16x16x32_bf16 v[192:195], a[32:35], v[48:51], v[192:195]
  ds_read_b128 a[0:3], v4 offset:8192
  ds_read_b128 a[4:7], v4 offset:9216
  v_mfma_f32_16x16x32_bf16 v[224:227], a[32:35], v[52:55], v[224:227]
  v_exp_f32 v75, v75
  v_mfma_f32_16x16x32_bf16 a[200:203], a[208:211], v[48:51], a[200:203]
  v_exp_f32 v76, v76
  v_mfma_f32_16x16x32_bf16 v[196:199], a[36:39], v[48:51], v[196:199]
  ds_read_b128 a[8:11], v4 offset:10240
  ds_read_b128 a[12:15], v4 offset:11264
  v_mfma_f32_16x16x32_bf16 v[228:231], a[36:39], v[52:55], v[228:231]
  v_exp_f32 v77, v77
  v_mfma_f32_16x16x32_bf16 a[204:207], a[208:211], v[52:55], a[204:207]
  v_exp_f32 v78, v78
  v_mfma_f32_16x16x32_bf16 v[200:203], a[40:43], v[48:51], v[200:203]
  ds_read_b128 a[16:19], v4 offset:12288
  ds_read_b128 a[20:23], v4 offset:13312
  v_mfma_f32_16x16x32_bf16 v[232:235], a[40:43], v[52:55], v[232:235]
  v_exp_f32 v79, v79
  v_mfma_f32_16x16x32_bf16 v[204:207], a[44:47], v[48:51], v[204:207]
  ds_read_b128 a[24:27], v4 offset:14336
  v_cvt_pk_bf16_f32 v32, v64, v65
  v_mfma_f32_16x16x32_bf16 v[236:239], a[44:47], v[52:55], v[236:239]
  v_cndmask_b32 v80, v80, v5, s[48:49]
  v_exp_f32 v80, v80
  v_mfma_f32_16x16x32_bf16 v[208:211], a[48:51], v[48:51], v[208:211]
  v_cndmask_b32 v81, v81, v5, s[50:51]
  v_exp_f32 v81, v81
  v_mfma_f32_16x16x32_bf16 v[240:243], a[48:51], v[52:55], v[240:243]
  ds_read_b128 a[28:31], v4 offset:15360
  v_xor_b32 v4, 0x8000, v4
  v_mfma_f32_16x16x32_bf16 v[212:215], a[52:55], v[48:51], v[212:215]
  v_cndmask_b32 v82, v82, v5, s[52:53]
  v_exp_f32 v82, v82
  v_mfma_f32_16x16x32_bf16 v[244:247], a[52:55], v[52:55], v[244:247]
  v_cndmask_b32 v83, v83, v5, s[54:55]
  v_exp_f32 v83, v83
  v_mfma_f32_16x16x32_bf16 v[216:219], a[56:59], v[48:51], v[216:219]
  ds_read_b128 a[32:35], v4 offset:0
  ds_read_b128 a[36:39], v4 offset:1024
  v_mfma_f32_16x16x32_bf16 v[248:251], a[56:59], v[52:55], v[248:251]
  v_cndmask_b32 v84, v84, v5, s[56:57]
  v_exp_f32 v84, v84
  v_mfma_f32_16x16x32_bf16 v[220:223], a[60:63], v[48:51], v[220:223]
  v_cndmask_b32 v85, v85, v5, s[58:59]
  v_exp_f32 v85, v85
  v_mfma_f32_16x16x32_bf16 v[252:255], a[60:63], v[52:55], v[252:255]
  s_waitcnt lgkmcnt(2)
  ds_read_b128 a[40:43], v4 offset:2048
  v_cvt_pk_bf16_f32 v33, v66, v67
  v_cvt_pk_bf16_f32 v42, v84, v85
  v_mfma_f32_16x16x32_bf16 v[192:195], a[0:3], v[56:59], v[192:195]
  v_cndmask_b32 v86, v86, v5, s[60:61]
  v_exp_f32 v86, v86
  v_mfma_f32_16x16x32_bf16 v[224:227], a[0:3], v[60:63], v[224:227]
  v_cndmask_b32 v87, v87, v5, s[62:63]
  v_exp_f32 v87, v87
  v_mfma_f32_16x16x32_bf16 a[200:203], a[208:211], v[56:59], a[200:203]
  ds_read_b128 a[44:47], v4 offset:3072
  v_cvt_pk_bf16_f32 v34, v68, v69
  v_cvt_pk_bf16_f32 v43, v86, v87
  v_mfma_f32_16x16x32_bf16 v[196:199], a[4:7], v[56:59], v[196:199]
  v_exp_f32 v88, v88
  v_mfma_f32_16x16x32_bf16 v[228:231], a[4:7], v[60:63], v[228:231]
  ds_read_b128 a[48:51], v4 offset:4096
  v_cvt_pk_bf16_f32 v35, v70, v71
  v_mfma_f32_16x16x32_bf16 a[204:207], a[208:211], v[60:63], a[204:207]
  v_exp_f32 v89, v89
  v_mfma_f32_16x16x32_bf16 v[200:203], a[8:11], v[56:59], v[200:203]
  v_exp_f32 v90, v90
  v_cvt_pk_bf16_f32 v44, v88, v89
  v_mfma_f32_16x16x32_bf16 v[232:235], a[8:11], v[60:63], v[232:235]
  ds_read_b128 a[52:55], v4 offset:5120
  v_cvt_pk_bf16_f32 v36, v72, v73
  v_mfma_f32_16x16x32_bf16 v[204:207], a[12:15], v[56:59], v[204:207]
  v_exp_f32 v91, v91
  v_mfma_f32_16x16x32_bf16 v[236:239], a[12:15], v[60:63], v[236:239]
  v_exp_f32 v92, v92
  v_cvt_pk_bf16_f32 v45, v90, v91
  v_mfma_f32_16x16x32_bf16 v[208:211], a[16:19], v[56:59], v[208:211]
  ds_read_b128 a[56:59], v4 offset:6144
  ds_read_b128 a[60:63], v4 offset:7168
  v_mfma_f32_16x16x32_bf16 v[240:243], a[16:19], v[60:63], v[240:243]
  v_exp_f32 v93, v93
  v_mfma_f32_16x16x32_bf16 v[212:215], a[20:23], v[56:59], v[212:215]
  v_exp_f32 v94, v94
  v_cvt_pk_bf16_f32 v46, v92, v93
  v_mfma_f32_16x16x32_bf16 v[244:247], a[20:23], v[60:63], v[244:247]
  ds_read_b128 a[0:3], v4 offset:8192
  v_cvt_pk_bf16_f32 v37, v74, v75
  v_mfma_f32_16x16x32_bf16 v[216:219], a[24:27], v[56:59], v[216:219]
  v_exp_f32 v95, v95
  v_mfma_f32_16x16x32_bf16 v[248:251], a[24:27], v[60:63], v[248:251]
  ds_read_b128 a[4:7], v4 offset:9216
  v_cvt_pk_bf16_f32 v38, v76, v77
  v_cvt_pk_bf16_f32 v47, v94, v95
  v_mfma_f32_16x16x32_bf16 v[220:223], a[28:31], v[56:59], v[220:223]
  ds_read_b128 a[8:11], v4 offset:10240
  v_cvt_pk_bf16_f32 v39, v78, v79
  v_mfma_f32_16x16x32_bf16 v[252:255], a[28:31], v[60:63], v[252:255]
  v_cvt_pk_bf16_f32 v40, v80, v81
  v_cvt_pk_bf16_f32 v41, v82, v83
La_e1:
  s_waitcnt vmcnt(0)
  s_barrier
  s_mov_b32 s5, 0x40000
Lpoll_17:
  v_cmp_ne_u64 vcc, s[94:95], v[12:13]
  s_nop 0
  s_cbranch_vccz Lpolld_18
  s_sleep 4
  buffer_load_dwordx2 v[12:13], v14, s[96:99], s91 offen sc1
  s_sub_u32 s5, s5, 1
  s_waitcnt vmcnt(0)
  s_cbranch_scc0 Lpoll_17
Lpolld_18:
  v_accvgpr_read_b32 v10, a212
  v_accvgpr_read_b32 v11, a213
  v_accvgpr_read_b32 v12, a214
  v_accvgpr_read_b32 v13, a215
  s_mov_b32 s12, s80
  s_mov_b32 s13, s81
  s_mov_b32 s14, 2097152
  s_mov_b32 s15, 0x00020000
  s_lshl_b32 s71, s77, 20
  s_lshl_b32 s72, s76, 8
  s_add_u32 s71, s71, s72
  s_add_u32 s8, s86, 83886080
  s_addc_u32 s9, s87, 0
  s_mov_b32 s10, 4194304
  s_mov_b32 s11, 0x00020000
  s_lshl_b32 s70, s73, 1
  s_add_u32 s70, s70, s77
  s_lshl_b32 s70, s70, 17
  s_add_u32 s70, s70, s79
  s_waitcnt lgkmcnt(3)
  v_mfma_f32_16x16x32_bf16 v[192:195], a[32:35], v[32:35], v[192:195]
  s_add_u32 m0, s79, 147456
  ds_read_b128 a[12:15], v4 offset:11264
  v_cndmask_b32 v104, v104, v5, s[32:33]
  v_mfma_f32_16x16x32_bf16 v[224:227], a[32:35], v[36:39], v[224:227]
  v_exp_f32 v104, v104
  v_mfma_f32_16x16x32_bf16 a[200:203], a[208:211], v[32:35], a[200:203]
  v_cndmask_b32 v105, v105, v5, s[34:35]
  v_exp_f32 v105, v105
  v_mfma_f32_16x16x32_bf16 v[196:199], a[36:39], v[32:35], v[196:199]
  buffer_load_dwordx4 v10, s[12:15], s71 offen offset:0 lds
  ds_read_b128 a[16:19], v4 offset:12288
  v_mfma_f32_16x16x32_bf16 v[228:231], a[36:39], v[36:39], v[228:231]
  v_cndmask_b32 v106, v106, v5, s[36:37]
  v_exp_f32 v106, v106
  v_mfma_f32_16x16x32_bf16 a[204:207], a[208:211], v[36:39], a[204:207]
  buffer_load_dwordx4 v11, s[12:15], s71 offen offset:1024 lds
  v_cndmask_b32 v107, v107, v5, s[38:39]
  v_mfma_f32_16x16x32_bf16 v[200:203], a[40:43], v[32:35], v[200:203]
  v_exp_f32 v107, v107
  v_mfma_f32_16x16x32_bf16 v[232:235], a[40:43], v[36:39], v[232:235]
  buffer_load_dwordx4 v12, s[12:15], s71 offen offset:2048 lds
  ds_read_b128 a[20:23], v4 offset:13312
  v_mfma_f32_16x16x32_bf16 v[204:207], a[44:47], v[32:35], v[204:207]
  v_cndmask_b32 v108, v108, v5, s[40:41]
  v_exp_f32 v108, v108
  v_mfma_f32_16x16x32_bf16 v[236:239], a[44:47], v[36:39], v[236:239]
  buffer_load_dwordx4 v13, s[12:15], s71 offen offset:3072 lds
  ds_read_b128 a[24:27], v4 offset:14336
  v_mfma_f32_16x16x32_bf16 v[208:211], a[48:51], v[32:35], v[208:211]
  s_add_u32 s71, s71, 131072
  v_cndmask_b32 v109, v109, v5, s[42:43]
  v_exp_f32 v109, v109
  v_mfma_f32_16x16x32_bf16 v[240:243], a[48:51], v[36:39], v[240:243]
  s_add_u32 m0, s79, 131072
  ds_read_b128 a[28:31], v4 offset:15360
  v_xor_b32 v4, 0x4000, v4
  v_mfma_f32_16x16x32_bf16 v[212:215], a[52:55], v[32:35], v[212:215]
  v_cndmask_b32 v110, v110, v5, s[44:45]
  v_exp_f32 v110, v110
  v_mfma_f32_16x16x32_bf16 v[244:247], a[52:55], v[36:39], v[244:247]
  buffer_load_dwordx4 v2, s[8:11], s70 offen offset:0 lds
  ds_read_b128 a[32:35], v4 offset:0
  v_mfma_f32_16x16x32_bf16 v[216:219], a[56:59], v[32:35], v[216:219]
  v_cndmask_b32 v111, v111, v5, s[46:47]
  v_exp_f32 v111, v111
  v_mfma_f32_16x16x32_bf16 v[248:251], a[56:59], v[36:39], v[248:251]
  buffer_load_dwordx4 v2, s[8:11], s70 offen offset:1024 lds
  ds_read_b128 a[36:39], v4 offset:1024
  v_mfma_f32_16x16x32_bf16 v[220:223], a[60:63], v[32:35], v[220:223]
  buffer_load_dwordx4 v2, s[8:11], s70 offen offset:2048 lds
  ds_read_b128 a[40:43], v4 offset:2048
  v_mfma_f32_16x16x32_bf16 v[252:255], a[60:63], v[36:39], v[252:255]
  s_waitcnt lgkmcnt(3)
  v_cndmask_b32 v120, v120, v5, s[48:49]
  v_exp_f32 v120, v120
  v_mfma_f32_16x16x32_bf16 v[192:195], a[0:3], v[40:43], v[192:195]
  buffer_load_dwordx4 v2, s[8:11], s70 offen offset:3072 lds
  ds_read_b128 a[44:47], v4 offset:3072
  v_mfma_f32_16x16x32_bf16 v[224:227], a[0:3], v[44:47], v[224:227]
  s_add_u32 s70, s70, 16384
  v_cndmask_b32 v121, v121, v5, s[50:51]
  v_exp_f32 v121, v121
  v_mfma_f32_16x16x32_bf16 a[200:203], a[208:211], v[40:43], a[200:203]
  s_add_u32 m0, s79, 16384
  v_cvt_pk_bf16_f32 v52, v104, v105
  v_cvt_pk_bf16_f32 v53, v106, v107
  v_mfma_f32_16x16x32_bf16 v[196:199], a[4:7], v[40:43], v[196:199]
  v_cndmask_b32 v122, v122, v5, s[52:53]
  v_exp_f32 v122, v122
  v_mfma_f32_16x16x32_bf16 v[228:231], a[4:7], v[44:47], v[228:231]
  buffer_load_dwordx4 v10, s[12:15], s71 offen offset:0 lds
  ds_read_b128 a[48:51], v4 offset:4096
  v_mfma_f32_16x16x32_bf16 a[204:207], a[208:211], v[44:47], a[204:207]
  v_cndmask_b32 v123, v123, v5, s[54:55]
  v_exp_f32 v123, v123
  v_mfma_f32_16x16x32_bf16 v[200:203], a[8:11], v[40:43], v[200:203]
  buffer_load_dwordx4 v11, s[12:15], s71 offen offset:1024 lds
  ds_read_b128 a[52:55], v4 offset:5120
  v_cvt_pk_bf16_f32 v61, v122, v123
  v_mfma_f32_16x16x32_bf16 v[232:235], a[8:11], v[44:47], v[232:235]
  v_cndmask_b32 v124, v124, v5, s[56:57]
  v_exp_f32 v124, v124
  v_mfma_f32_16x16x32_bf16 v[204:207], a[12:15], v[40:43], v[204:207]
  buffer_load_dwordx4 v12, s[12:15], s71 offen offset:2048 lds
  ds_read_b128 a[56:59], v4 offset:6144
  v_mfma_f32_16x16x32_bf16 v[236:239], a[12:15], v[44:47], v[236:239]
  v_cndmask_b32 v125, v125, v5, s[58:59]
  v_exp_f32 v125, v125
  v_mfma_f32_16x16x32_bf16 v[208:211], a[16:19], v[40:43], v[208:211]
  buffer_load_dwordx4 v13, s[12:15], s71 offen offset:3072 lds
  ds_read_b128 a[60:63], v4 offset:7168
  v_cvt_pk_bf16_f32 v62, v124, v125
  v_mfma_f32_16x16x32_bf16 v[240:243], a[16:19], v[44:47], v[240:243]
  s_add_u32 s71, s71, 131072
  v_cndmask_b32 v126, v126, v5, s[60:61]
  v_exp_f32 v126, v126
  v_mfma_f32_16x16x32_bf16 v[212:215], a[20:23], v[40:43], v[212:215]
  s_add_u32 m0, s79, 0
  ds_read_b128 a[0:3], v4 offset:8192
  v_cvt_pk_bf16_f32 v54, v108, v109
  v_mfma_f32_16x16x32_bf16 v[244:247], a[20:23], v[44:47], v[244:247]
  v_cndmask_b32 v127, v127, v5, s[62:63]
  v_exp_f32 v127, v127
  v_mfma_f32_16x16x32_bf16 v[216:219], a[24:27], v[40:43], v[216:219]
  buffer_load_dwordx4 v2, s[8:11], s70 offen offset:0 lds
  ds_read_b128 a[4:7], v4 offset:9216
  v_cvt_pk_bf16_f32 v63, v126, v127
  v_mfma_f32_16x16x32_bf16 v[248:251], a[24:27], v[44:47], v[248:251]
  buffer_load_dwordx4 v2, s[8:11], s70 offen offset:1024 lds
  v_cvt_pk_bf16_f32 v55, v110, v111
  v_mfma_f32_16x16x32_bf16 v[220:223], a[28:31], v[40:43], v[220:223]
  buffer_load_dwordx4 v2, s[8:11], s70 offen offset:2048 lds
  ds_read_b128 a[8:11], v4 offset:10240
  v_mfma_f32_16x16x32_bf16 v[252:255], a[28:31], v[44:47], v[252:255]
  buffer_load_dwordx4 v2, s[8:11], s70 offen offset:3072 lds
  v_cvt_pk_bf16_f32 v60, v120, v121
  s_add_u32 s70, s70, 16384
  s_waitcnt lgkmcnt(7)
  v_mfma_f32_16x16x32_bf16 v[224:227], a[32:35], v[52:55], v[224:227]
  s_add_u32 m0, s79, 49152
  ds_read_b128 a[12:15], v4 offset:11264
  v_mfma_f32_16x16x32_bf16 a[204:207], a[208:211], v[52:55], a[204:207]
  buffer_load_dwordx4 v10, s[12:15], s71 offen offset:0 lds
  v_mfma_f32_16x16x32_bf16 v[228:231], a[36:39], v[52:55], v[228:231]
  buffer_load_dwordx4 v11, s[12:15], s71 offen offset:1024 lds
  ds_read_b128 a[16:19], v4 offset:12288
  v_mfma_f32_16x16x32_bf16 v[232:235], a[40:43], v[52:55], v[232:235]
  ds_read_b128 a[20:23], v4 offset:13312
  v_mfma_f32_16x16x32_bf16 v[236:239], a[44:47], v[52:55], v[236:239]
  s_waitcnt lgkmcnt(6)
  buffer_load_dwordx4 v12, s[12:15], s71 offen offset:2048 lds
  ds_read_b128 a[24:27], v4 offset:14336
  v_mfma_f32_16x16x32_bf16 v[240:243], a[48:51], v[52:55], v[240:243]
  ds_read_b128 a[28:31], v4 offset:15360
  v_mfma_f32_16x16x32_bf16 v[244:247], a[52:55], v[52:55], v[244:247]
  buffer_load_dwordx4 v13, s[12:15], s71 offen offset:3072 lds
  v_mfma_f32_16x16x32_bf16 v[248:251], a[56:59], v[52:55], v[248:251]
  s_add_u32 s71, s71, 131072
  s_add_u32 m0, s79, 32768
  v_mfma_f32_16x16x32_bf16 v[252:255], a[60:63], v[52:55], v[252:255]
  s_waitcnt lgkmcnt(4)
  buffer_load_dwordx4 v2, s[8:11], s70 offen offset:0 lds
  v_mfma_f32_16x16x32_bf16 v[224:227], a[0:3], v[60:63], v[224:227]
  v_mfma_f32_16x16x32_bf16 a[204:207], a[208:211], v[60:63], a[204:207]
  buffer_load_dwordx4 v2, s[8:11], s70 offen offset:1024 lds
  v_mfma_f32_16x16x32_bf16 v[228:231], a[4:7], v[60:63], v[228:231]
  v_mfma_f32_16x16x32_bf16 v[232:235], a[8:11], v[60:63], v[232:235]
  buffer_load_dwordx4 v2, s[8:11], s70 offen offset:2048 lds
  v_mfma_f32_16x16x32_bf16 v[236:239], a[12:15], v[60:63], v[236:239]
  s_waitcnt lgkmcnt(0)
  v_mfma_f32_16x16x32_bf16 v[240:243], a[16:19], v[60:63], v[240:243]
  buffer_load_dwordx4 v2, s[8:11], s70 offen offset:3072 lds
  v_mfma_f32_16x16x32_bf16 v[244:247], a[20:23], v[60:63], v[244:247]
  s_add_u32 s70, s70, 16384
  v_mfma_f32_16x16x32_bf16 v[248:251], a[24:27], v[60:63], v[248:251]
  v_mfma_f32_16x16x32_bf16 v[252:255], a[28:31], v[60:63], v[252:255]
  s_sub_u32 s88, 15, s25
  s_lshl_b32 s4, s88, 20
  s_lshl_b32 s5, s24, 15
  s_add_u32 s4, s4, s5
  s_lshl_b32 s5, s3, 11
  s_add_u32 s4, s4, s5
  v_accvgpr_read_b32 v6, a200
  v_accvgpr_read_b32 v8, a204
  s_mov_b32 s5, 0x5f800000
  v_cmp_ngt_f32 vcc, s5, v6
  v_rcp_f32 v6, v6
  s_or_b32 s89, s89, vcc_lo
  s_or_b32 s89, s89, vcc_hi
  v_mov_b32 v7, v6
  v_cmp_ngt_f32 vcc, s5, v8
  v_rcp_f32 v8, v8
  s_or_b32 s89, s89, vcc_lo
  s_or_b32 s89, s89, vcc_hi
  v_mov_b32 v9, v8
  v_pk_mul_f32 v[192:193], v[192:193], v[6:7]
  v_pk_mul_f32 v[194:195], v[194:195], v[6:7]
  v_pk_mul_f32 v[196:197], v[196:197], v[6:7]
  v_pk_mul_f32 v[198:199], v[198:199], v[6:7]
  v_cvt_pk_bf16_f32 v192, v192, v193
  v_cvt_pk_bf16_f32 v193, v194, v195
  v_cvt_pk_bf16_f32 v194, v196, v197
  v_cvt_pk_bf16_f32 v195, v198, v199
  buffer_store_dwordx4 v[192:195], v2, s[16:19], s4 offen offset:0 sc1
  v_pk_mul_f32 v[224:225], v[224:225], v[8:9]
  v_pk_mul_f32 v[226:227], v[226:227], v[8:9]
  v_pk_mul_f32 v[228:229], v[228:229], v[8:9]
  v_pk_mul_f32 v[230:231], v[230:231], v[8:9]
  v_cvt_pk_bf16_f32 v224, v224, v225
  v_cvt_pk_bf16_f32 v225, v226, v227
  v_cvt_pk_bf16_f32 v226, v228, v229
  v_cvt_pk_bf16_f32 v227, v230, v231
  buffer_store_dwordx4 v[224:227], v2, s[16:19], s4 offen offset:1024 sc1
  s_add_u32 s4, s4, 8192
  v_pk_mul_f32 v[200:201], v[200:201], v[6:7]
  v_pk_mul_f32 v[202:203], v[202:203], v[6:7]
  v_pk_mul_f32 v[204:205], v[204:205], v[6:7]
  v_pk_mul_f32 v[206:207], v[206:207], v[6:7]
  v_cvt_pk_bf16_f32 v200, v200, v201
  v_cvt_pk_bf16_f32 v201, v202, v203
  v_cvt_pk_bf16_f32 v202, v204, v205
  v_cvt_pk_bf16_f32 v203, v206, v207
  buffer_store_dwordx4 v[200:203], v2, s[16:19], s4 offen offset:0 sc1
  v_pk_mul_f32 v[232:233], v[232:233], v[8:9]
  v_pk_mul_f32 v[234:235], v[234:235], v[8:9]
  v_pk_mul_f32 v[236:237], v[236:237], v[8:9]
  v_pk_mul_f32 v[238:239], v[238:239], v[8:9]
  v_cvt_pk_bf16_f32 v232, v232, v233
  v_cvt_pk_bf16_f32 v233, v234, v235
  v_cvt_pk_bf16_f32 v234, v236, v237
  v_cvt_pk_bf16_f32 v235, v238, v239
  buffer_store_dwordx4 v[232:235], v2, s[16:19], s4 offen offset:1024 sc1
  s_add_u32 s4, s4, 8192
  v_pk_mul_f32 v[208:209], v[208:209], v[6:7]
  v_pk_mul_f32 v[210:211], v[210:211], v[6:7]
  v_pk_mul_f32 v[212:213], v[212:213], v[6:7]
  v_pk_mul_f32 v[214:215], v[214:215], v[6:7]
  v_cvt_pk_bf16_f32 v208, v208, v209
  v_cvt_pk_bf16_f32 v209, v210, v211
  v_cvt_pk_bf16_f32 v210, v212, v213
  v_cvt_pk_bf16_f32 v211, v214, v215
  buffer_store_dwordx4 v[208:211], v2, s[16:19], s4 offen offset:0 sc1
  v_pk_mul_f32 v[240:241], v[240:241], v[8:9]
  v_pk_mul_f32 v[242:243], v[242:243], v[8:9]
  v_pk_mul_f32 v[244:245], v[244:245], v[8:9]
  v_pk_mul_f32 v[246:247], v[246:247], v[8:9]
  v_cvt_pk_bf16_f32 v240, v240, v241
  v_cvt_pk_bf16_f32 v241, v242, v243
  v_cvt_pk_bf16_f32 v242, v244, v245
  v_cvt_pk_bf16_f32 v243, v246, v247
  buffer_store_dwordx4 v[240:243], v2, s[16:19], s4 offen offset:1024 sc1
  s_add_u32 s4, s4, 8192
  v_pk_mul_f32 v[216:217], v[216:217], v[6:7]
  v_pk_mul_f32 v[218:219], v[218:219], v[6:7]
  v_pk_mul_f32 v[220:221], v[220:221], v[6:7]
  v_pk_mul_f32 v[222:223], v[222:223], v[6:7]
  v_cvt_pk_bf16_f32 v216, v216, v217
  v_cvt_pk_bf16_f32 v217, v218, v219
  v_cvt_pk_bf16_f32 v218, v220, v221
  v_cvt_pk_bf16_f32 v219, v222, v223
  buffer_store_dwordx4 v[216:219], v2, s[16:19], s4 offen offset:0 sc1
  v_pk_mul_f32 v[248:249], v[248:249], v[8:9]
  v_pk_mul_f32 v[250:251], v[250:251], v[8:9]
  v_pk_mul_f32 v[252:253], v[252:253], v[8:9]
  v_pk_mul_f32 v[254:255], v[254:255], v[8:9]
  v_cvt_pk_bf16_f32 v248, v248, v249
  v_cvt_pk_bf16_f32 v249, v250, v251
  v_cvt_pk_bf16_f32 v250, v252, v253
  v_cvt_pk_bf16_f32 v251, v254, v255
  buffer_store_dwordx4 v[248:251], v2, s[16:19], s4 offen offset:1024 sc1
  s_cmp_eq_u32 s89, 0
  s_cbranch_scc1 La_done
  s_waitcnt vmcnt(0)
  s_sub_u32 s6, 15, s25
La_sl_blk:
  v_mov_b32 v192, 0
  v_mov_b32 v193, 0
  v_mov_b32 v194, 0
  v_mov_b32 v195, 0
  v_mov_b32 v196, 0
  v_mov_b32 v197, 0
  v_mov_b32 v198, 0
  v_mov_b32 v199, 0
  v_mov_b32 v200, 0
  v_mov_b32 v201, 0
  v_mov_b32 v202, 0
  v_mov_b32 v203, 0
  v_mov_b32 v204, 0
  v_mov_b32 v205, 0
  v_mov_b32 v206, 0
  v_mov_b32 v207, 0
  v_mov_b32 v208, 0
  v_mov_b32 v209, 0
  v_mov_b32 v210, 0
  v_mov_b32 v211, 0
  v_mov_b32 v212, 0
  v_mov_b32 v213, 0
  v_mov_b32 v214, 0
  v_mov_b32 v215, 0
  v_mov_b32 v216, 0
  v_mov_b32 v217, 0
  v_mov_b32 v218, 0
  v_mov_b32 v219, 0
  v_mov_b32 v220, 0
  v_mov_b32 v221, 0
  v_mov_b32 v222, 0
  v_mov_b32 v223, 0
  v_mov_b32 v224, 0
  v_mov_b32 v225, 0
  v_mov_b32 v226, 0
  v_mov_b32 v227, 0
  v_mov_b32 v228, 0
  v_mov_b32 v229, 0
  v_mov_b32 v230, 0
  v_mov_b32 v231, 0
  v_mov_b32 v232, 0
  v_mov_b32 v233, 0
  v_mov_b32 v234, 0
  v_mov_b32 v235, 0
  v_mov_b32 v236, 0
  v_mov_b32 v237, 0
  v_mov_b32 v238, 0
  v_mov_b32 v239, 0
  v_mov_b32 v240, 0
  v_mov_b32 v241, 0
  v_mov_b32 v242, 0
  v_mov_b32 v243, 0
  v_mov_b32 v244, 0
  v_mov_b32 v245, 0
  v_mov_b32 v246, 0
  v_mov_b32 v247, 0
  v_mov_b32 v248, 0
  v_mov_b32 v249, 0
  v_mov_b32 v250, 0
  v_mov_b32 v251, 0
  v_mov_b32 v252, 0
  v_mov_b32 v253, 0
  v_mov_b32 v254, 0
  v_mov_b32 v255, 0
  v_mov_b32 v24, 0
  v_mov_b32 v25, 0
  v_mov_b32 v26, 0
  v_mov_b32 v27, 0
  v_mov_b32 v28, 0
  v_mov_b32 v29, 0
  v_mov_b32 v30, 0
  v_mov_b32 v31, 0
  v_mov_b32 v16, v5
  v_mov_b32 v17, v5
  v_and_b32 v20, 15, v1
  v_lshrrev_b32 v21, 4, v1
  v_sub_u32 v20, v20, v21
  v_lshlrev_b32 v20, 2, v20
  s_lshl_b32 s4, s6, 7
  s_add_u32 s4, s4, s3
  v_add_u32 v20, s4, v20
  v_add_u32 v21, 64, v20
  s_add_u32 s7, s6, 1
  s_lshl_b32 s7, s7, 2
  s_mov_b32 s90, 0
La_sl_loop:
  s_add_u32 s4, s90, 0
  buffer_load_dwordx4 a[0:3], v2, s[20:23], s4 offen offset:0 sc1
  buffer_load_dwordx4 a[4:7], v2, s[20:23], s4 offen offset:1024 sc1
  buffer_load_dwordx4 a[8:11], v2, s[20:23], s4 offen offset:2048 sc1
  buffer_load_dwordx4 a[12:15], v2, s[20:23], s4 offen offset:3072 sc1
  s_add_u32 s4, s90, 4096
  buffer_load_dwordx4 a[16:19], v2, s[20:23], s4 offen offset:0 sc1
  buffer_load_dwordx4 a[20:23], v2, s[20:23], s4 offen offset:1024 sc1
  buffer_load_dwordx4 a[24:27], v2, s[20:23], s4 offen offset:2048 sc1
  buffer_load_dwordx4 a[28:31], v2, s[20:23], s4 offen offset:3072 sc1
  s_add_u32 s4, s90, 16384
  buffer_load_dwordx4 a[32:35], v2, s[20:23], s4 offen offset:0 sc1
  buffer_load_dwordx4 a[36:39], v2, s[20:23], s4 offen offset:1024 sc1
  buffer_load_dwordx4 a[40:43], v2, s[20:23], s4 offen offset:2048 sc1
  buffer_load_dwordx4 a[44:47], v2, s[20:23], s4 offen offset:3072 sc1
  s_add_u32 s4, s90, 20480
  buffer_load_dwordx4 a[48:51], v2, s[20:23], s4 offen offset:0 sc1
  buffer_load_dwordx4 a[52:55], v2, s[20:23], s4 offen offset:1024 sc1
  buffer_load_dwordx4 a[56:59], v2, s[20:23], s4 offen offset:2048 sc1
  buffer_load_dwordx4 a[60:63], v2, s[20:23], s4 offen offset:3072 sc1
  s_waitcnt vmcnt(0)
  v_mfma_f32_16x16x32_bf16 v[64:67], a[0:3], a[160:163], 0
  v_mfma_f32_16x16x32_bf16 v[72:75], a[0:3], a[176:179], 0
  v_mfma_f32_16x16x32_bf16 v[64:67], a[4:7], a[164:167], v[64:67]
  v_mfma_f32_16x16x32_bf16 v[72:75], a[4:7], a[180:183], v[72:75]
  v_mfma_f32_16x16x32_bf16 v[64:67], a[8:11], a[168:171], v[64:67]
  v_mfma_f32_16x16x32_bf16 v[72:75], a[8:11], a[184:187], v[72:75]
  v_mfma_f32_16x16x32_bf16 v[64:67], a[12:15], a[172:175], v[64:67]
  v_mfma_f32_16x16x32_bf16 v[72:75], a[12:15], a[188:191], v[72:75]
  v_mfma_f32_16x16x32_bf16 v[68:71], a[16:19], a[160:163], 0
  v_mfma_f32_16x16x32_bf16 v[76:79], a[16:19], a[176:179], 0
  v_mfma_f32_16x16x32_bf16 v[68:71], a[20:23], a[164:167], v[68:71]
  v_mfma_f32_16x16x32_bf16 v[76:79], a[20:23], a[180:183], v[76:79]
  v_mfma_f32_16x16x32_bf16 v[68:71], a[24:27], a[168:171], v[68:71]
  v_mfma_f32_16x16x32_bf16 v[76:79], a[24:27], a[184:187], v[76:79]
  v_mfma_f32_16x16x32_bf16 v[68:71], a[28:31], a[172:175], v[68:71]
  v_mfma_f32_16x16x32_bf16 v[76:79], a[28:31], a[188:191], v[76:79]
  v_cmp_gt_i32 vcc, 0, v20
  s_nop 1
  v_cndmask_b32 v64, v64, v5, vcc
  v_cmp_gt_i32 vcc, 1, v20
  s_nop 1
  v_cndmask_b32 v65, v65, v5, vcc
  v_cmp_gt_i32 vcc, 2, v20
  s_nop 1
  v_cndmask_b32 v66, v66, v5, vcc
  v_cmp_gt_i32 vcc, 3, v20
  s_nop 1
  v_cndmask_b32 v67, v67, v5, vcc
  v_cmp_gt_i32 vcc, 16, v20
  s_nop 1
  v_cndmask_b32 v68, v68, v5, vcc
  v_cmp_gt_i32 vcc, 17, v20
  s_nop 1
  v_cndmask_b32 v69, v69, v5, vcc
  v_cmp_gt_i32 vcc, 18, v20
  s_nop 1
  v_cndmask_b32 v70, v70, v5, vcc
  v_cmp_gt_i32 vcc, 19, v20
  s_nop 1
  v_cndmask_b32 v71, v71, v5, vcc
  v_subrev_u32 v20, 32, v20
  v_max3_f32 v6, v64, v65, v66
  v_max3_f32 v7, v67, v68, v69
  v_max3_f32 v6, v6, v70, v71
  v_max_f32 v6, v6, v7
  v_cmp_gt_i32 vcc, 0, v21
  s_nop 1
  v_cndmask_b32 v72, v72, v5, vcc
  v_cmp_gt_i32 vcc, 1, v21
  s_nop 1
  v_cndmask_b32 v73, v73, v5, vcc
  v_cmp_gt_i32 vcc, 2, v21
  s_nop 1
  v_cndmask_b32 v74, v74, v5, vcc
  v_cmp_gt_i32 vcc, 3, v21
  s_nop 1
  v_cndmask_b32 v75, v75, v5, vcc
  v_cmp_gt_i32 vcc, 16, v21
  s_nop 1
  v_cndmask_b32 v76, v76, v5, vcc
  v_cmp_gt_i32 vcc, 17, v21
  s_nop 1
  v_cndmask_b32 v77, v77, v5, vcc
  v_cmp_gt_i32 vcc, 18, v21
  s_nop 1
  v_cndmask_b32 v78, v78, v5, vcc
  v_cmp_gt_i32 vcc, 19, v21
  s_nop 1
  v_cndmask_b32 v79, v79, v5, vcc
  v_subrev_u32 v21, 32, v21
  v_max3_f32 v8, v72, v73, v74
  v_max3_f32 v9, v75, v76, v77
  v_max3_f32 v8, v8, v78, v79
  v_max_f32 v8, v8, v9
  v_mov_b32 v7, v6
  v_mov_b32 v9, v8
  s_nop 0
  v_permlane32_swap_b32 v6, v7
  v_permlane32_swap_b32 v8, v9
  v_max_f32 v6, v6, v7
  v_max_f32 v8, v8, v9
  v_mov_b32 v7, v6
  v_mov_b32 v9, v8
  s_nop 0
  v_permlane16_swap_b32 v6, v7
  v_permlane16_swap_b32 v8, v9
  v_max_f32 v6, v6, v7
  v_max_f32 v8, v8, v9
  v_max_f32 v6, v6, v16
  v_sub_f32 v7, v16, v6
  v_exp_f32 v7, v7
  v_mov_b32 v16, v6
  v_sub_f32 v64, v64, v16
  v_sub_f32 v65, v65, v16
  v_sub_f32 v66, v66, v16
  v_sub_f32 v67, v67, v16
  v_sub_f32 v68, v68, v16
  v_sub_f32 v69, v69, v16
  v_sub_f32 v70, v70, v16
  v_sub_f32 v71, v71, v16
  v_exp_f32 v64, v64
  v_exp_f32 v65, v65
  v_exp_f32 v66, v66
  v_exp_f32 v67, v67
  v_exp_f32 v68, v68
  v_exp_f32 v69, v69
  v_exp_f32 v70, v70
  v_exp_f32 v71, v71
  v_mul_f32 v24, v24, v7
  v_mul_f32 v25, v25, v7
  v_mul_f32 v26, v26, v7
  v_mul_f32 v27, v27, v7
  v_mul_f32 v192, v192, v7
  v_mul_f32 v193, v193, v7
  v_mul_f32 v194, v194, v7
  v_mul_f32 v195, v195, v7
  v_mul_f32 v196, v196, v7
  v_mul_f32 v197, v197, v7
  v_mul_f32 v198, v198, v7
  v_mul_f32 v199, v199, v7
  v_mul_f32 v200, v200, v7
  v_mul_f32 v201, v201, v7
  v_mul_f32 v202, v202, v7
  v_mul_f32 v203, v203, v7
  v_mul_f32 v204, v204, v7
  v_mul_f32 v205, v205, v7
  v_mul_f32 v206, v206, v7
  v_mul_f32 v207, v207, v7
  v_mul_f32 v208, v208, v7
  v_mul_f32 v209, v209, v7
  v_mul_f32 v210, v210, v7
  v_mul_f32 v211, v211, v7
  v_mul_f32 v212, v212, v7
  v_mul_f32 v213, v213, v7
  v_mul_f32 v214, v214, v7
  v_mul_f32 v215, v215, v7
  v_mul_f32 v216, v216, v7
  v_mul_f32 v217, v217, v7
  v_mul_f32 v218, v218, v7
  v_mul_f32 v219, v219, v7
  v_mul_f32 v220, v220, v7
  v_mul_f32 v221, v221, v7
  v_mul_f32 v222, v222, v7
  v_mul_f32 v223, v223, v7
  v_cvt_pk_bf16_f32 v32, v64, v65
  v_cvt_pk_bf16_f32 v33, v66, v67
  v_cvt_pk_bf16_f32 v34, v68, v69
  v_cvt_pk_bf16_f32 v35, v70, v71
  v_max_f32 v8, v8, v17
  v_sub_f32 v9, v17, v8
  v_exp_f32 v9, v9
  v_mov_b32 v17, v8
  v_sub_f32 v72, v72, v17
  v_sub_f32 v73, v73, v17
  v_sub_f32 v74, v74, v17
  v_sub_f32 v75, v75, v17
  v_sub_f32 v76, v76, v17
  v_sub_f32 v77, v77, v17
  v_sub_f32 v78, v78, v17
  v_sub_f32 v79, v79, v17
  v_exp_f32 v72, v72
  v_exp_f32 v73, v73
  v_exp_f32 v74, v74
  v_exp_f32 v75, v75
  v_exp_f32 v76, v76
  v_exp_f32 v77, v77
  v_exp_f32 v78, v78
  v_exp_f32 v79, v79
  v_mul_f32 v28, v28, v9
  v_mul_f32 v29, v29, v9
  v_mul_f32 v30, v30, v9
  v_mul_f32 v31, v31, v9
  v_mul_f32 v224, v224, v9
  v_mul_f32 v225, v225, v9
  v_mul_f32 v226, v226, v9
  v_mul_f32 v227, v227, v9
  v_mul_f32 v228, v228, v9
  v_mul_f32 v229, v229, v9
  v_mul_f32 v230, v230, v9
  v_mul_f32 v231, v231, v9
  v_mul_f32 v232, v232, v9
  v_mul_f32 v233, v233, v9
  v_mul_f32 v234, v234, v9
  v_mul_f32 v235, v235, v9
  v_mul_f32 v236, v236, v9
  v_mul_f32 v237, v237, v9
  v_mul_f32 v238, v238, v9
  v_mul_f32 v239, v239, v9
  v_mul_f32 v240, v240, v9
  v_mul_f32 v241, v241, v9
  v_mul_f32 v242, v242, v9
  v_mul_f32 v243, v243, v9
  v_mul_f32 v244, v244, v9
  v_mul_f32 v245, v245, v9
  v_mul_f32 v246, v246, v9
  v_mul_f32 v247, v247, v9
  v_mul_f32 v248, v248, v9
  v_mul_f32 v249, v249, v9
  v_mul_f32 v250, v250, v9
  v_mul_f32 v251, v251, v9
  v_mul_f32 v252, v252, v9
  v_mul_f32 v253, v253, v9
  v_mul_f32 v254, v254, v9
  v_mul_f32 v255, v255, v9
  v_cvt_pk_bf16_f32 v36, v72, v73
  v_cvt_pk_bf16_f32 v37, v74, v75
  v_cvt_pk_bf16_f32 v38, v76, v77
  v_cvt_pk_bf16_f32 v39, v78, v79
  v_mfma_f32_16x16x32_bf16 v[24:27], a[208:211], v[32:35], v[24:27]
  v_mfma_f32_16x16x32_bf16 v[192:195], a[32:35], v[32:35], v[192:195]
  v_mfma_f32_16x16x32_bf16 v[196:199], a[36:39], v[32:35], v[196:199]
  v_mfma_f32_16x16x32_bf16 v[200:203], a[40:43], v[32:35], v[200:203]
  v_mfma_f32_16x16x32_bf16 v[204:207], a[44:47], v[32:35], v[204:207]
  v_mfma_f32_16x16x32_bf16 v[208:211], a[48:51], v[32:35], v[208:211]
  v_mfma_f32_16x16x32_bf16 v[212:215], a[52:55], v[32:35], v[212:215]
  v_mfma_f32_16x16x32_bf16 v[216:219], a[56:59], v[32:35], v[216:219]
  v_mfma_f32_16x16x32_bf16 v[220:223], a[60:63], v[32:35], v[220:223]
  v_mfma_f32_16x16x32_bf16 v[28:31], a[208:211], v[36:39], v[28:31]
  v_mfma_f32_16x16x32_bf16 v[224:227], a[32:35], v[36:39], v[224:227]
  v_mfma_f32_16x16x32_bf16 v[228:231], a[36:39], v[36:39], v[228:231]
  v_mfma_f32_16x16x32_bf16 v[232:235], a[40:43], v[36:39], v[232:235]
  v_mfma_f32_16x16x32_bf16 v[236:239], a[44:47], v[36:39], v[236:239]
  v_mfma_f32_16x16x32_bf16 v[240:243], a[48:51], v[36:39], v[240:243]
  v_mfma_f32_16x16x32_bf16 v[244:247], a[52:55], v[36:39], v[244:247]
  v_mfma_f32_16x16x32_bf16 v[248:251], a[56:59], v[36:39], v[248:251]
  v_mfma_f32_16x16x32_bf16 v[252:255], a[60:63], v[36:39], v[252:255]
  s_add_u32 s90, s90, 8192
  s_and_b32 s4, s90, 0x4000
  s_add_u32 s90, s90, s4
  s_sub_u32 s7, s7, 1
  s_cmp_lg_u32 s7, 0
  s_cbranch_scc1 La_sl_loop
  s_lshl_b32 s4, s6, 20
  s_lshl_b32 s5, s24, 15
  s_add_u32 s4, s4, s5
  s_lshl_b32 s5, s3, 11
  s_add_u32 s4, s4, s5
  v_rcp_f32 v6, v24
  s_nop 0
  v_mov_b32 v7, v6
  v_rcp_f32 v8, v28
  s_nop 0
  v_mov_b32 v9, v8
  v_pk_mul_f32 v[192:193], v[192:193], v[6:7]
  v_pk_mul_f32 v[194:195], v[194:195], v[6:7]
  v_pk_mul_f32 v[196:197], v[196:197], v[6:7]
  v_pk_mul_f32 v[198:199], v[198:199], v[6:7]
  v_cvt_pk_bf16_f32 v192, v192, v193
  v_cvt_pk_bf16_f32 v193, v194, v195
  v_cvt_pk_bf16_f32 v194, v196, v197
  v_cvt_pk_bf16_f32 v195, v198, v199
  buffer_store_dwordx4 v[192:195], v2, s[16:19], s4 offen offset:0 sc1
  v_pk_mul_f32 v[224:225], v[224:225], v[8:9]
  v_pk_mul_f32 v[226:227], v[226:227], v[8:9]
  v_pk_mul_f32 v[228:229], v[228:229], v[8:9]
  v_pk_mul_f32 v[230:231], v[230:231], v[8:9]
  v_cvt_pk_bf16_f32 v224, v224, v225
  v_cvt_pk_bf16_f32 v225, v226, v227
  v_cvt_pk_bf16_f32 v226, v228, v229
  v_cvt_pk_bf16_f32 v227, v230, v231
  buffer_store_dwordx4 v[224:227], v2, s[16:19], s4 offen offset:1024 sc1
  s_add_u32 s4, s4, 8192
  v_pk_mul_f32 v[200:201], v[200:201], v[6:7]
  v_pk_mul_f32 v[202:203], v[202:203], v[6:7]
  v_pk_mul_f32 v[204:205], v[204:205], v[6:7]
  v_pk_mul_f32 v[206:207], v[206:207], v[6:7]
  v_cvt_pk_bf16_f32 v200, v200, v201
  v_cvt_pk_bf16_f32 v201, v202, v203
  v_cvt_pk_bf16_f32 v202, v204, v205
  v_cvt_pk_bf16_f32 v203, v206, v207
  buffer_store_dwordx4 v[200:203], v2, s[16:19], s4 offen offset:0 sc1
  v_pk_mul_f32 v[232:233], v[232:233], v[8:9]
  v_pk_mul_f32 v[234:235], v[234:235], v[8:9]
  v_pk_mul_f32 v[236:237], v[236:237], v[8:9]
  v_pk_mul_f32 v[238:239], v[238:239], v[8:9]
  v_cvt_pk_bf16_f32 v232, v232, v233
  v_cvt_pk_bf16_f32 v233, v234, v235
  v_cvt_pk_bf16_f32 v234, v236, v237
  v_cvt_pk_bf16_f32 v235, v238, v239
  buffer_store_dwordx4 v[232:235], v2, s[16:19], s4 offen offset:1024 sc1
  s_add_u32 s4, s4, 8192
  v_pk_mul_f32 v[208:209], v[208:209], v[6:7]
  v_pk_mul_f32 v[210:211], v[210:211], v[6:7]
  v_pk_mul_f32 v[212:213], v[212:213], v[6:7]
  v_pk_mul_f32 v[214:215], v[214:215], v[6:7]
  v_cvt_pk_bf16_f32 v208, v208, v209
  v_cvt_pk_bf16_f32 v209, v210, v211
  v_cvt_pk_bf16_f32 v210, v212, v213
  v_cvt_pk_bf16_f32 v211, v214, v215
  buffer_store_dwordx4 v[208:211], v2, s[16:19], s4 offen offset:0 sc1
  v_pk_mul_f32 v[240:241], v[240:241], v[8:9]
  v_pk_mul_f32 v[242:243], v[242:243], v[8:9]
  v_pk_mul_f32 v[244:245], v[244:245], v[8:9]
  v_pk_mul_f32 v[246:247], v[246:247], v[8:9]
  v_cvt_pk_bf16_f32 v240, v240, v241
  v_cvt_pk_bf16_f32 v241, v242, v243
  v_cvt_pk_bf16_f32 v242, v244, v245
  v_cvt_pk_bf16_f32 v243, v246, v247
  buffer_store_dwordx4 v[240:243], v2, s[16:19], s4 offen offset:1024 sc1
  s_add_u32 s4, s4, 8192
  v_pk_mul_f32 v[216:217], v[216:217], v[6:7]
  v_pk_mul_f32 v[218:219], v[218:219], v[6:7]
  v_pk_mul_f32 v[220:221], v[220:221], v[6:7]
  v_pk_mul_f32 v[222:223], v[222:223], v[6:7]
  v_cvt_pk_bf16_f32 v216, v216, v217
  v_cvt_pk_bf16_f32 v217, v218, v219
  v_cvt_pk_bf16_f32 v218, v220, v221
  v_cvt_pk_bf16_f32 v219, v222, v223
  buffer_store_dwordx4 v[216:219], v2, s[16:19], s4 offen offset:0 sc1
  v_pk_mul_f32 v[248:249], v[248:249], v[8:9]
  v_pk_mul_f32 v[250:251], v[250:251], v[8:9]
  v_pk_mul_f32 v[252:253], v[252:253], v[8:9]
  v_pk_mul_f32 v[254:255], v[254:255], v[8:9]
  v_cvt_pk_bf16_f32 v248, v248, v249
  v_cvt_pk_bf16_f32 v249, v250, v251
  v_cvt_pk_bf16_f32 v250, v252, v253
  v_cvt_pk_bf16_f32 v251, v254, v255
  buffer_store_dwordx4 v[248:251], v2, s[16:19], s4 offen offset:1024 sc1
  s_cmp_eq_u32 s6, s25
  s_cbranch_scc1 La_done
  v_accvgpr_read_b32 v64, a128
  v_accvgpr_read_b32 v65, a129
  v_accvgpr_read_b32 v66, a130
  v_accvgpr_read_b32 v67, a131
  v_accvgpr_read_b32 v68, a132
  v_accvgpr_read_b32 v69, a133
  v_accvgpr_read_b32 v70, a134
  v_accvgpr_read_b32 v71, a135
  v_accvgpr_read_b32 v72, a136
  v_accvgpr_read_b32 v73, a137
  v_accvgpr_read_b32 v74, a138
  v_accvgpr_read_b32 v75, a139
  v_accvgpr_read_b32 v76, a140
  v_accvgpr_read_b32 v77, a141
  v_accvgpr_read_b32 v78, a142
  v_accvgpr_read_b32 v79, a143
  v_accvgpr_read_b32 v80, a144
  v_accvgpr_read_b32 v81, a145
  v_accvgpr_read_b32 v82, a146
  v_accvgpr_read_b32 v83, a147
  v_accvgpr_read_b32 v84, a148
  v_accvgpr_read_b32 v85, a149
  v_accvgpr_read_b32 v86, a150
  v_accvgpr_read_b32 v87, a151
  v_accvgpr_read_b32 v88, a152
  v_accvgpr_read_b32 v89, a153
  v_accvgpr_read_b32 v90, a154
  v_accvgpr_read_b32 v91, a155
  v_accvgpr_read_b32 v92, a156
  v_accvgpr_read_b32 v93, a157
  v_accvgpr_read_b32 v94, a158
  v_accvgpr_read_b32 v95, a159
  v_accvgpr_write_b32 a160, v64
  v_accvgpr_write_b32 a161, v65
  v_accvgpr_write_b32 a162, v66
  v_accvgpr_write_b32 a163, v67
  v_accvgpr_write_b32 a164, v68
  v_accvgpr_write_b32 a165, v69
  v_accvgpr_write_b32 a166, v70
  v_accvgpr_write_b32 a167, v71
  v_accvgpr_write_b32 a168, v72
  v_accvgpr_write_b32 a169, v73
  v_accvgpr_write_b32 a170, v74
  v_accvgpr_write_b32 a171, v75
  v_accvgpr_write_b32 a172, v76
  v_accvgpr_write_b32 a173, v77
  v_accvgpr_write_b32 a174, v78
  v_accvgpr_write_b32 a175, v79
  v_accvgpr_write_b32 a176, v80
  v_accvgpr_write_b32 a177, v81
  v_accvgpr_write_b32 a178, v82
  v_accvgpr_write_b32 a179, v83
  v_accvgpr_write_b32 a180, v84
  v_accvgpr_write_b32 a181, v85
  v_accvgpr_write_b32 a182, v86
  v_accvgpr_write_b32 a183, v87
  v_accvgpr_write_b32 a184, v88
  v_accvgpr_write_b32 a185, v89
  v_accvgpr_write_b32 a186, v90
  v_accvgpr_write_b32 a187, v91
  v_accvgpr_write_b32 a188, v92
  v_accvgpr_write_b32 a189, v93
  v_accvgpr_write_b32 a190, v94
  v_accvgpr_write_b32 a191, v95
  s_mov_b32 s6, s25
  s_branch La_sl_blk
La_done:
  s_lshr_b32 s4, s3, 1
  s_lshl_b32 s4, s4, 12
  s_add_u32 s4, s4, 131072
  v_add_u32 v16, s4, v2
  s_and_b32 s4, s3, 1
  s_lshl_b32 s4, s4, 13
  s_add_u32 s4, s4, 131072
  v_lshrrev_b32 v24, 2, v1
  v_and_b32 v25, 6, v24
  v_lshlrev_b32 v24, 7, v24
  v_and_b32 v26, 1, v1
  v_lshl_add_u32 v24, v26, 3, v24
  v_add_u32 v24, s4, v24
  v_bfe_u32 v26, v1, 1, 1
  v_xor_b32 v25, v25, v26
  v_xor_b32 v26, 0, v25
  v_lshl_add_u32 v17, v26, 4, v24
  v_xor_b32 v26, 2, v25
  v_lshl_add_u32 v18, v26, 4, v24
  v_xor_b32 v26, 4, v25
  v_lshl_add_u32 v19, v26, 4, v24
  v_xor_b32 v26, 6, v25
  v_lshl_add_u32 v20, v26, 4, v24
  s_mov_b32 s65, 0
  s_mov_b32 s67, 4294836224
  s_mov_b32 s68, 32768
  s_mov_b32 s65, 4
  s_waitcnt vmcnt(24)
  s_barrier
  ds_read_b128 a[64:67], v16 offset:0
  ds_read_b64_tr_b16 a[96:97], v17 offset:16384
  ds_read_b64_tr_b16 a[98:99], v17 offset:18432
  ds_read_b128 a[68:71], v16 offset:1024
  ds_read_b128 a[72:75], v16 offset:2048
  ds_read_b128 a[76:79], v16 offset:3072
  ds_read_b64_tr_b16 a[100:101], v18 offset:16384
  ds_read_b64_tr_b16 a[102:103], v18 offset:18432
  ds_read_b64_tr_b16 a[104:105], v19 offset:16384
  ds_read_b64_tr_b16 a[106:107], v19 offset:18432
  ds_read_b64_tr_b16 a[108:109], v20 offset:16384
  ds_read_b64_tr_b16 a[110:111], v20 offset:18432
  s_waitcnt lgkmcnt(0)
  v_mfma_f32_16x16x32_bf16 v[32:35], a[96:99], a[64:67], 0
  s_add_u32 m0, s79, 81920
  ds_read_b128 a[80:83], v16 offset:8192
  ds_read_b64_tr_b16 a[112:113], v17 offset:20480
  v_mfma_f32_16x16x32_bf16 v[48:51], a[96:99], a[68:71], 0
  buffer_load_dwordx4 v10, s[12:15], s71 offen offset:0 lds
  ds_read_b64_tr_b16 a[114:115], v17 offset:22528
  v_mfma_f32_16x16x32_bf16 v[64:67], a[96:99], a[72:75], 0
  buffer_load_dwordx4 v11, s[12:15], s71 offen offset:1024 lds
  ds_read_b128 a[84:87], v16 offset:9216
  v_mfma_f32_16x16x32_bf16 v[80:83], a[96:99], a[76:79], 0
  buffer_load_dwordx4 v12, s[12:15], s71 offen offset:2048 lds
  ds_read_b128 a[88:91], v16 offset:10240
  v_mfma_f32_16x16x32_bf16 v[36:39], a[100:103], a[64:67], 0
  buffer_load_dwordx4 v13, s[12:15], s71 offen offset:3072 lds
  ds_read_b128 a[92:95], v16 offset:11264
  v_mfma_f32_16x16x32_bf16 v[52:55], a[100:103], a[68:71], 0
  s_add_u32 s71, s71, 131072
  s_add_u32 m0, s79, 65536
  ds_read_b64_tr_b16 a[116:117], v18 offset:20480
  v_mfma_f32_16x16x32_bf16 v[68:71], a[100:103], a[72:75], 0
  buffer_load_dwordx4 v2, s[8:11], s70 offen offset:0 lds
  ds_read_b64_tr_b16 a[118:119], v18 offset:22528
  v_mfma_f32_16x16x32_bf16 v[84:87], a[100:103], a[76:79], 0
  buffer_load_dwordx4 v2, s[8:11], s70 offen offset:1024 lds
  ds_read_b64_tr_b16 a[120:121], v19 offset:20480
  v_mfma_f32_16x16x32_bf16 v[40:43], a[104:107], a[64:67], 0
  buffer_load_dwordx4 v2, s[8:11], s70 offen offset:2048 lds
  ds_read_b64_tr_b16 a[122:123], v19 offset:22528
  v_mfma_f32_16x16x32_bf16 v[56:59], a[104:107], a[68:71], 0
  buffer_load_dwordx4 v2, s[8:11], s70 offen offset:3072 lds
  ds_read_b64_tr_b16 a[124:125], v20 offset:20480
  v_mfma_f32_16x16x32_bf16 v[72:75], a[104:107], a[72:75], 0
  s_add_u32 s70, s70, 16384
  s_add_u32 m0, s79, 114688
  ds_read_b64_tr_b16 a[126:127], v20 offset:22528
  v_mfma_f32_16x16x32_bf16 v[88:91], a[104:107], a[76:79], 0
  buffer_load_dwordx4 v10, s[12:15], s71 offen offset:0 lds
  v_mfma_f32_16x16x32_bf16 v[44:47], a[108:111], a[64:67], 0
  buffer_load_dwordx4 v11, s[12:15], s71 offen offset:1024 lds
  v_mfma_f32_16x16x32_bf16 v[60:63], a[108:111], a[68:71], 0
  buffer_load_dwordx4 v12, s[12:15], s71 offen offset:2048 lds
  v_mfma_f32_16x16x32_bf16 v[76:79], a[108:111], a[72:75], 0
  buffer_load_dwordx4 v13, s[12:15], s71 offen offset:3072 lds
  v_mfma_f32_16x16x32_bf16 v[92:95], a[108:111], a[76:79], 0
  s_add_u32 s71, s71, 131072
  s_add_u32 m0, s79, 98304
  s_nop 0
  buffer_load_dwordx4 v2, s[8:11], s70 offen offset:0 lds
  buffer_load_dwordx4 v2, s[8:11], s70 offen offset:1024 lds
  buffer_load_dwordx4 v2, s[8:11], s70 offen offset:2048 lds
  buffer_load_dwordx4 v2, s[8:11], s70 offen offset:3072 lds
  s_add_u32 s70, s70, 16384
  s_add_u32 s65, s65, 1
  s_cmp_eq_u32 s65, 5
  s_cselect_b32 s65, 0, s65
  s_cselect_b32 s66, s67, s68
  v_add_u32 v16, s66, v16
  v_add_u32 v17, s66, v17
  v_add_u32 v18, s66, v18
  v_add_u32 v19, s66, v19
  v_add_u32 v20, s66, v20
  s_waitcnt vmcnt(16) lgkmcnt(0)
  s_barrier
  s_lshl_b32 s4, s24, 7
  s_lshl_b32 s5, s25, 12
  s_add_u32 s6, s4, 65536
  s_add_u32 s7, s6, 61440
  s_add_u32 s6, s6, s5
  s_sub_u32 s7, s7, s5
  v_mov_b32 v8, 0x40000000
  v_mov_b32 v6, s94
  v_cmp_eq_u32 vcc, 0, v0
  v_mov_b32 v7, s95
  s_nop 0
  v_cndmask_b32_e64 v8, v8, 0, vcc
  buffer_store_dwordx2 v[6:7], v8, s[96:99], s6 offen sc1
  buffer_store_dwordx2 v[6:7], v8, s[96:99], s7 offen sc1
  s_lshl_b32 s91, s73, 1
  s_add_u32 s91, s91, s77
  s_lshl_b32 s91, s91, 11
  s_add_u32 s91, s91, 65536
  v_mfma_f32_16x16x32_bf16 v[32:35], a[112:115], a[80:83], v[32:35]
  s_add_u32 m0, s64, 16384
  ds_read_b128 a[64:67], v16 offset:0
  ds_read_b64_tr_b16 a[96:97], v17 offset:16384
  v_mfma_f32_16x16x32_bf16 v[48:51], a[112:115], a[84:87], v[48:51]
  buffer_load_dwordx4 v10, s[12:15], s71 offen offset:0 lds
  ds_read_b64_tr_b16 a[98:99], v17 offset:18432
  v_mfma_f32_16x16x32_bf16 v[64:67], a[112:115], a[88:91], v[64:67]
  ds_read_b128 a[68:71], v16 offset:1024
  v_mfma_f32_16x16x32_bf16 v[80:83], a[112:115], a[92:95], v[80:83]
  buffer_load_dwordx4 v11, s[12:15], s71 offen offset:1024 lds
  ds_read_b128 a[72:75], v16 offset:2048
  v_mfma_f32_16x16x32_bf16 v[36:39], a[116:119], a[80:83], v[36:39]
  ds_read_b128 a[76:79], v16 offset:3072
  v_mfma_f32_16x16x32_bf16 v[52:55], a[116:119], a[84:87], v[52:55]
  ds_read_b64_tr_b16 a[100:101], v18 offset:16384
  v_mfma_f32_16x16x32_bf16 v[68:71], a[116:119], a[88:91], v[68:71]
  ds_read_b64_tr_b16 a[102:103], v18 offset:18432
  v_mfma_f32_16x16x32_bf16 v[84:87], a[116:119], a[92:95], v[84:87]
  buffer_load_dwordx4 v12, s[12:15], s71 offen offset:2048 lds
  ds_read_b64_tr_b16 a[104:105], v19 offset:16384
  v_mfma_f32_16x16x32_bf16 v[40:43], a[120:123], a[80:83], v[40:43]
  ds_read_b64_tr_b16 a[106:107], v19 offset:18432
  v_mfma_f32_16x16x32_bf16 v[56:59], a[120:123], a[84:87], v[56:59]
  ds_read_b64_tr_b16 a[108:109], v20 offset:16384
  v_mfma_f32_16x16x32_bf16 v[72:75], a[120:123], a[88:91], v[72:75]
  ds_read_b64_tr_b16 a[110:111], v20 offset:18432
  v_mfma_f32_16x16x32_bf16 v[88:91], a[120:123], a[92:95], v[88:91]
  buffer_load_dwordx4 v13, s[12:15], s71 offen offset:3072 lds
  v_mfma_f32_16x16x32_bf16 v[44:47], a[124:127], a[80:83], v[44:47]
  s_add_u32 s71, s71, 131072
  v_mfma_f32_16x16x32_bf16 v[60:63], a[124:127], a[84:87], v[60:63]
  v_mfma_f32_16x16x32_bf16 v[76:79], a[124:127], a[88:91], v[76:79]
  v_mfma_f32_16x16x32_bf16 v[92:95], a[124:127], a[92:95], v[92:95]
  s_waitcnt lgkmcnt(0)
  v_mfma_f32_16x16x32_bf16 v[32:35], a[96:99], a[64:67], v[32:35]
  s_mov_b32 m0, s64
  ds_read_b128 a[80:83], v16 offset:8192
  ds_read_b64_tr_b16 a[112:113], v17 offset:20480
  v_mfma_f32_16x16x32_bf16 v[48:51], a[96:99], a[68:71], v[48:51]
  buffer_load_dwordx4 v2, s[8:11], s70 offen offset:0 lds
  ds_read_b64_tr_b16 a[114:115], v17 offset:22528
  v_mfma_f32_16x16x32_bf16 v[64:67], a[96:99], a[72:75], v[64:67]
  ds_read_b128 a[84:87], v16 offset:9216
  v_mfma_f32_16x16x32_bf16 v[80:83], a[96:99], a[76:79], v[80:83]
  buffer_load_dwordx4 v2, s[8:11], s70 offen offset:1024 lds
  ds_read_b128 a[88:91], v16 offset:10240
  v_mfma_f32_16x16x32_bf16 v[36:39], a[100:103], a[64:67], v[36:39]
  ds_read_b128 a[92:95], v16 offset:11264
  v_mfma_f32_16x16x32_bf16 v[52:55], a[100:103], a[68:71], v[52:55]
  ds_read_b64_tr_b16 a[116:117], v18 offset:20480
  v_mfma_f32_16x16x32_bf16 v[68:71], a[100:103], a[72:75], v[68:71]
  ds_read_b64_tr_b16 a[118:119], v18 offset:22528
  v_mfma_f32_16x16x32_bf16 v[84:87], a[100:103], a[76:79], v[84:87]
  buffer_load_dwordx4 v2, s[8:11], s70 offen offset:2048 lds
  ds_read_b64_tr_b16 a[120:121], v19 offset:20480
  v_mfma_f32_16x16x32_bf16 v[40:43], a[104:107], a[64:67], v[40:43]
  ds_read_b64_tr_b16 a[122:123], v19 offset:22528
  v_mfma_f32_16x16x32_bf16 v[56:59], a[104:107], a[68:71], v[56:59]
  ds_read_b64_tr_b16 a[124:125], v20 offset:20480
  v_mfma_f32_16x16x32_bf16 v[72:75], a[104:107], a[72:75], v[72:75]
  ds_read_b64_tr_b16 a[126:127], v20 offset:22528
  v_mfma_f32_16x16x32_bf16 v[88:91], a[104:107], a[76:79], v[88:91]
  buffer_load_dwordx4 v2, s[8:11], s70 offen offset:3072 lds
  v_mfma_f32_16x16x32_bf16 v[44:47], a[108:111], a[64:67], v[44:47]
  s_add_u32 s70, s70, 16384
  v_mfma_f32_16x16x32_bf16 v[60:63], a[108:111], a[68:71], v[60:63]
  s_add_u32 s64, s64, s66
  s_add_u32 s65, s65, 1
  s_cmp_eq_u32 s65, 5
  s_cselect_b32 s65, 0, s65
  s_cselect_b32 s66, s67, s68
  v_mfma_f32_16x16x32_bf16 v[76:79], a[108:111], a[72:75], v[76:79]
  v_add_u32 v16, s66, v16
  v_add_u32 v17, s66, v17
  v_add_u32 v20, s66, v20
  v_mfma_f32_16x16x32_bf16 v[92:95], a[108:111], a[76:79], v[92:95]
  v_add_u32 v18, s66, v18
  v_add_u32 v19, s66, v19
  s_waitcnt vmcnt(26) lgkmcnt(0)
  s_barrier
  v_mfma_f32_16x16x32_bf16 v[32:35], a[112:115], a[80:83], v[32:35]
  s_add_u32 m0, s64, 16384
  ds_read_b128 a[64:67], v16 offset:0
  ds_read_b64_tr_b16 a[96:97], v17 offset:16384
  v_mfma_f32_16x16x32_bf16 v[48:51], a[112:115], a[84:87], v[48:51]
  buffer_load_dwordx4 v10, s[12:15], s71 offen offset:0 lds
  ds_read_b64_tr_b16 a[98:99], v17 offset:18432
  v_mfma_f32_16x16x32_bf16 v[64:67], a[112:115], a[88:91], v[64:67]
  ds_read_b128 a[68:71], v16 offset:1024
  v_mfma_f32_16x16x32_bf16 v[80:83], a[112:115], a[92:95], v[80:83]
  buffer_load_dwordx4 v11, s[12:15], s71 offen offset:1024 lds
  ds_read_b128 a[72:75], v16 offset:2048
  v_mfma_f32_16x16x32_bf16 v[36:39], a[116:119], a[80:83], v[36:39]
  ds_read_b128 a[76:79], v16 offset:3072
  v_mfma_f32_16x16x32_bf16 v[52:55], a[116:119], a[84:87], v[52:55]
  ds_read_b64_tr_b16 a[100:101], v18 offset:16384
  v_mfma_f32_16x16x32_bf16 v[68:71], a[116:119], a[88:91], v[68:71]
  ds_read_b64_tr_b16 a[102:103], v18 offset:18432
  v_mfma_f32_16x16x32_bf16 v[84:87], a[116:119], a[92:95], v[84:87]
  buffer_load_dwordx4 v12, s[12:15], s71 offen offset:2048 lds
  ds_read_b64_tr_b16 a[104:105], v19 offset:16384
  v_mfma_f32_16x16x32_bf16 v[40:43], a[120:123], a[80:83], v[40:43]
  ds_read_b64_tr_b16 a[106:107], v19 offset:18432
  v_mfma_f32_16x16x32_bf16 v[56:59], a[120:123], a[84:87], v[56:59]
  ds_read_b64_tr_b16 a[108:109], v20 offset:16384
  v_mfma_f32_16x16x32_bf16 v[72:75], a[120:123], a[88:91], v[72:75]
  ds_read_b64_tr_b16 a[110:111], v20 offset:18432
  v_mfma_f32_16x16x32_bf16 v[88:91], a[120:123], a[92:95], v[88:91]
  buffer_load_dwordx4 v13, s[12:15], s71 offen offset:3072 lds
  v_mfma_f32_16x16x32_bf16 v[44:47], a[124:127], a[80:83], v[44:47]
  s_add_u32 s71, s71, 131072
  v_mfma_f32_16x16x32_bf16 v[60:63], a[124:127], a[84:87], v[60:63]
  v_mfma_f32_16x16x32_bf16 v[76:79], a[124:127], a[88:91], v[76:79]
  v_mfma_f32_16x16x32_bf16 v[92:95], a[124:127], a[92:95], v[92:95]
  s_waitcnt lgkmcnt(0)
  v_mfma_f32_16x16x32_bf16 v[32:35], a[96:99], a[64:67], v[32:35]
  s_mov_b32 m0, s64
  ds_read_b128 a[80:83], v16 offset:8192
  ds_read_b64_tr_b16 a[112:113], v17 offset:20480
  v_mfma_f32_16x16x32_bf16 v[48:51], a[96:99], a[68:71], v[48:51]
  buffer_load_dwordx4 v2, s[8:11], s70 offen offset:0 lds
  ds_read_b64_tr_b16 a[114:115], v17 offset:22528
  v_mfma_f32_16x16x32_bf16 v[64:67], a[96:99], a[72:75], v[64:67]
  ds_read_b128 a[84:87], v16 offset:9216
  v_mfma_f32_16x16x32_bf16 v[80:83], a[96:99], a[76:79], v[80:83]
  buffer_load_dwordx4 v2, s[8:11], s70 offen offset:1024 lds
  ds_read_b128 a[88:91], v16 offset:10240
  v_mfma_f32_16x16x32_bf16 v[36:39], a[100:103], a[64:67], v[36:39]
  ds_read_b128 a[92:95], v16 offset:11264
  v_mfma_f32_16x16x32_bf16 v[52:55], a[100:103], a[68:71], v[52:55]
  ds_read_b64_tr_b16 a[116:117], v18 offset:20480
  v_mfma_f32_16x16x32_bf16 v[68:71], a[100:103], a[72:75], v[68:71]
  ds_read_b64_tr_b16 a[118:119], v18 offset:22528
  v_mfma_f32_16x16x32_bf16 v[84:87], a[100:103], a[76:79], v[84:87]
  buffer_load_dwordx4 v2, s[8:11], s70 offen offset:2048 lds
  ds_read_b64_tr_b16 a[120:121], v19 offset:20480
  v_mfma_f32_16x16x32_bf16 v[40:43], a[104:107], a[64:67], v[40:43]
  ds_read_b64_tr_b16 a[122:123], v19 offset:22528
  v_mfma_f32_16x16x32_bf16 v[56:59], a[104:107], a[68:71], v[56:59]
  ds_read_b64_tr_b16 a[124:125], v20 offset:20480
  v_mfma_f32_16x16x32_bf16 v[72:75], a[104:107], a[72:75], v[72:75]
  ds_read_b64_tr_b16 a[126:127], v20 offset:22528
  v_mfma_f32_16x16x32_bf16 v[88:91], a[104:107], a[76:79], v[88:91]
  buffer_load_dwordx4 v2, s[8:11], s70 offen offset:3072 lds
  v_mfma_f32_16x16x32_bf16 v[44:47], a[108:111], a[64:67], v[44:47]
  s_add_u32 s70, s70, 16384
  v_mfma_f32_16x16x32_bf16 v[60:63], a[108:111], a[68:71], v[60:63]
  s_add_u32 s64, s64, s66
  s_add_u32 s65, s65, 1
  s_cmp_eq_u32 s65, 5
  s_cselect_b32 s65, 0, s65
  s_cselect_b32 s66, s67, s68
  v_mfma_f32_16x16x32_bf16 v[76:79], a[108:111], a[72:75], v[76:79]
  v_add_u32 v16, s66, v16
  v_add_u32 v17, s66, v17
  v_add_u32 v20, s66, v20
  v_mfma_f32_16x16x32_bf16 v[92:95], a[108:111], a[76:79], v[92:95]
  v_add_u32 v18, s66, v18
  v_add_u32 v19, s66, v19
  s_waitcnt vmcnt(26) lgkmcnt(0)
  s_barrier
  v_mfma_f32_16x16x32_bf16 v[32:35], a[112:115], a[80:83], v[32:35]
  s_add_u32 m0, s64, 16384
  ds_read_b128 a[64:67], v16 offset:0
  ds_read_b64_tr_b16 a[96:97], v17 offset:16384
  v_mfma_f32_16x16x32_bf16 v[48:51], a[112:115], a[84:87], v[48:51]
  buffer_load_dwordx4 v10, s[12:15], s71 offen offset:0 lds
  ds_read_b64_tr_b16 a[98:99], v17 offset:18432
  v_mfma_f32_16x16x32_bf16 v[64:67], a[112:115], a[88:91], v[64:67]
  ds_read_b128 a[68:71], v16 offset:1024
  v_mfma_f32_16x16x32_bf16 v[80:83], a[112:115], a[92:95], v[80:83]
  buffer_load_dwordx4 v11, s[12:15], s71 offen offset:1024 lds
  ds_read_b128 a[72:75], v16 offset:2048
  v_mfma_f32_16x16x32_bf16 v[36:39], a[116:119], a[80:83], v[36:39]
  ds_read_b128 a[76:79], v16 offset:3072
  v_mfma_f32_16x16x32_bf16 v[52:55], a[116:119], a[84:87], v[52:55]
  ds_read_b64_tr_b16 a[100:101], v18 offset:16384
  v_mfma_f32_16x16x32_bf16 v[68:71], a[116:119], a[88:91], v[68:71]
  ds_read_b64_tr_b16 a[102:103], v18 offset:18432
  v_mfma_f32_16x16x32_bf16 v[84:87], a[116:119], a[92:95], v[84:87]
  buffer_load_dwordx4 v12, s[12:15], s71 offen offset:2048 lds
  ds_read_b64_tr_b16 a[104:105], v19 offset:16384
  v_mfma_f32_16x16x32_bf16 v[40:43], a[120:123], a[80:83], v[40:43]
  ds_read_b64_tr_b16 a[106:107], v19 offset:18432
  v_mfma_f32_16x16x32_bf16 v[56:59], a[120:123], a[84:87], v[56:59]
  ds_read_b64_tr_b16 a[108:109], v20 offset:16384
  v_mfma_f32_16x16x32_bf16 v[72:75], a[120:123], a[88:91], v[72:75]
  ds_read_b64_tr_b16 a[110:111], v20 offset:18432
  v_mfma_f32_16x16x32_bf16 v[88:91], a[120:123], a[92:95], v[88:91]
  buffer_load_dwordx4 v13, s[12:15], s71 offen offset:3072 lds
  v_mfma_f32_16x16x32_bf16 v[44:47], a[124:127], a[80:83], v[44:47]
  s_add_u32 s71, s71, 131072
  v_mfma_f32_16x16x32_bf16 v[60:63], a[124:127], a[84:87], v[60:63]
  v_mfma_f32_16x16x32_bf16 v[76:79], a[124:127], a[88:91], v[76:79]
  v_mfma_f32_16x16x32_bf16 v[92:95], a[124:127], a[92:95], v[92:95]
  s_waitcnt lgkmcnt(0)
  v_mfma_f32_16x16x32_bf16 v[32:35], a[96:99], a[64:67], v[32:35]
  s_mov_b32 m0, s64
  ds_read_b128 a[80:83], v16 offset:8192
  ds_read_b64_tr_b16 a[112:113], v17 offset:20480
  v_mfma_f32_16x16x32_bf16 v[48:51], a[96:99], a[68:71], v[48:51]
  buffer_load_dwordx4 v2, s[8:11], s70 offen offset:0 lds
  ds_read_b64_tr_b16 a[114:115], v17 offset:22528
  v_mfma_f32_16x16x32_bf16 v[64:67], a[96:99], a[72:75], v[64:67]
  ds_read_b128 a[84:87], v16 offset:9216
  v_mfma_f32_16x16x32_bf16 v[80:83], a[96:99], a[76:79], v[80:83]
  buffer_load_dwordx4 v2, s[8:11], s70 offen offset:1024 lds
  ds_read_b128 a[88:91], v16 offset:10240
  v_mfma_f32_16x16x32_bf16 v[36:39], a[100:103], a[64:67], v[36:39]
  ds_read_b128 a[92:95], v16 offset:11264
  v_mfma_f32_16x16x32_bf16 v[52:55], a[100:103], a[68:71], v[52:55]
  ds_read_b64_tr_b16 a[116:117], v18 offset:20480
  v_mfma_f32_16x16x32_bf16 v[68:71], a[100:103], a[72:75], v[68:71]
  ds_read_b64_tr_b16 a[118:119], v18 offset:22528
  v_mfma_f32_16x16x32_bf16 v[84:87], a[100:103], a[76:79], v[84:87]
  buffer_load_dwordx4 v2, s[8:11], s70 offen offset:2048 lds
  ds_read_b64_tr_b16 a[120:121], v19 offset:20480
  v_mfma_f32_16x16x32_bf16 v[40:43], a[104:107], a[64:67], v[40:43]
  ds_read_b64_tr_b16 a[122:123], v19 offset:22528
  v_mfma_f32_16x16x32_bf16 v[56:59], a[104:107], a[68:71], v[56:59]
  ds_read_b64_tr_b16 a[124:125], v20 offset:20480
  v_mfma_f32_16x16x32_bf16 v[72:75], a[104:107], a[72:75], v[72:75]
  ds_read_b64_tr_b16 a[126:127], v20 offset:22528
  v_mfma_f32_16x16x32_bf16 v[88:91], a[104:107], a[76:79], v[88:91]
  buffer_load_dwordx4 v2, s[8:11], s70 offen offset:3072 lds
  v_mfma_f32_16x16x32_bf16 v[44:47], a[108:111], a[64:67], v[44:47]
  s_add_u32 s70, s70, 16384
  v_mfma_f32_16x16x32_bf16 v[60:63], a[108:111], a[68:71], v[60:63]
  s_add_u32 s64, s64, s66
  s_add_u32 s65, s65, 1
  s_cmp_eq_u32 s65, 5
  s_cselect_b32 s65, 0, s65
  s_cselect_b32 s66, s67, s68
  v_mfma_f32_16x16x32_bf16 v[76:79], a[108:111], a[72:75], v[76:79]
  v_add_u32 v16, s66, v16
  v_add_u32 v17, s66, v17
  v_add_u32 v20, s66, v20
  v_mfma_f32_16x16x32_bf16 v[92:95], a[108:111], a[76:79], v[92:95]
  v_add_u32 v18, s66, v18
  v_add_u32 v19, s66, v19
  s_waitcnt vmcnt(26) lgkmcnt(0)
  s_barrier
  v_mfma_f32_16x16x32_bf16 v[32:35], a[112:115], a[80:83], v[32:35]
  s_mov_b32 s12, s74
  s_mov_b32 s13, s75
  s_mov_b32 s14, 8388608
  v_mfma_f32_16x16x32_bf16 v[48:51], a[112:115], a[84:87], v[48:51]
  s_mov_b32 s15, 0x00020000
  s_lshl_b32 s71, s77, 22
  s_lshl_b32 s72, s76, 8
  v_mfma_f32_16x16x32_bf16 v[64:67], a[112:115], a[88:91], v[64:67]
  s_add_u32 s71, s71, s72
  s_add_u32 m0, s64, 16384
  ds_read_b128 a[64:67], v16 offset:0
  v_mfma_f32_16x16x32_bf16 v[80:83], a[112:115], a[92:95], v[80:83]
  buffer_load_dwordx4 v10, s[12:15], s71 offen offset:0 lds
  ds_read_b64_tr_b16 a[96:97], v17 offset:16384
  v_mfma_f32_16x16x32_bf16 v[36:39], a[116:119], a[80:83], v[36:39]
  ds_read_b64_tr_b16 a[98:99], v17 offset:18432
  ds_read_b128 a[68:71], v16 offset:1024
  v_mfma_f32_16x16x32_bf16 v[52:55], a[116:119], a[84:87], v[52:55]
  ds_read_b128 a[72:75], v16 offset:2048
  ds_read_b128 a[76:79], v16 offset:3072
  v_mfma_f32_16x16x32_bf16 v[68:71], a[116:119], a[88:91], v[68:71]
  ds_read_b64_tr_b16 a[100:101], v18 offset:16384
  ds_read_b64_tr_b16 a[102:103], v18 offset:18432
  v_mfma_f32_16x16x32_bf16 v[84:87], a[116:119], a[92:95], v[84:87]
  buffer_load_dwordx4 v11, s[12:15], s71 offen offset:1024 lds
  ds_read_b64_tr_b16 a[104:105], v19 offset:16384
  v_mfma_f32_16x16x32_bf16 v[40:43], a[120:123], a[80:83], v[40:43]
  ds_read_b64_tr_b16 a[106:107], v19 offset:18432
  v_mfma_f32_16x16x32_bf16 v[56:59], a[120:123], a[84:87], v[56:59]
  ds_read_b64_tr_b16 a[108:109], v20 offset:16384
  v_mfma_f32_16x16x32_bf16 v[72:75], a[120:123], a[88:91], v[72:75]
  ds_read_b64_tr_b16 a[110:111], v20 offset:18432
  v_mfma_f32_16x16x32_bf16 v[88:91], a[120:123], a[92:95], v[88:91]
  v_mfma_f32_16x16x32_bf16 v[44:47], a[124:127], a[80:83], v[44:47]
  v_mfma_f32_16x16x32_bf16 v[60:63], a[124:127], a[84:87], v[60:63]
  v_mfma_f32_16x16x32_bf16 v[76:79], a[124:127], a[88:91], v[76:79]
  v_mfma_f32_16x16x32_bf16 v[92:95], a[124:127], a[92:95], v[92:95]
  s_waitcnt lgkmcnt(0)
  v_mfma_f32_16x16x32_bf16 v[32:35], a[96:99], a[64:67], v[32:35]
  buffer_load_dwordx4 v12, s[12:15], s71 offen offset:2048 lds
  ds_read_b128 a[80:83], v16 offset:8192
  v_mfma_f32_16x16x32_bf16 v[48:51], a[96:99], a[68:71], v[48:51]
  ds_read_b64_tr_b16 a[112:113], v17 offset:20480
  ds_read_b64_tr_b16 a[114:115], v17 offset:22528
  v_mfma_f32_16x16x32_bf16 v[64:67], a[96:99], a[72:75], v[64:67]
  ds_read_b128 a[84:87], v16 offset:9216
  v_mfma_f32_16x16x32_bf16 v[80:83], a[96:99], a[76:79], v[80:83]
  ds_read_b128 a[88:91], v16 offset:10240
  v_mfma_f32_16x16x32_bf16 v[36:39], a[100:103], a[64:67], v[36:39]
  ds_read_b128 a[92:95], v16 offset:11264
  v_mfma_f32_16x16x32_bf16 v[52:55], a[100:103], a[68:71], v[52:55]
  ds_read_b64_tr_b16 a[116:117], v18 offset:20480
  v_mfma_f32_16x16x32_bf16 v[68:71], a[100:103], a[72:75], v[68:71]
  ds_read_b64_tr_b16 a[118:119], v18 offset:22528
  v_mfma_f32_16x16x32_bf16 v[84:87], a[100:103], a[76:79], v[84:87]
  buffer_load_dwordx4 v13, s[12:15], s71 offen offset:3072 lds
  ds_read_b64_tr_b16 a[120:121], v19 offset:20480
  v_mfma_f32_16x16x32_bf16 v[40:43], a[104:107], a[64:67], v[40:43]
  s_add_u32 s71, s71, 131072
  ds_read_b64_tr_b16 a[122:123], v19 offset:22528
  v_mfma_f32_16x16x32_bf16 v[56:59], a[104:107], a[68:71], v[56:59]
  s_add_u32 s64, s64, s66
  s_add_u32 s65, s65, 1
  ds_read_b64_tr_b16 a[124:125], v20 offset:20480
  v_mfma_f32_16x16x32_bf16 v[72:75], a[104:107], a[72:75], v[72:75]
  s_cmp_eq_u32 s65, 5
  s_cselect_b32 s65, 0, s65
  s_cselect_b32 s66, s67, s68
  ds_read_b64_tr_b16 a[126:127], v20 offset:22528
  v_mfma_f32_16x16x32_bf16 v[88:91], a[104:107], a[76:79], v[88:91]
  v_add_u32 v16, s66, v16
  v_add_u32 v17, s66, v17
  v_mfma_f32_16x16x32_bf16 v[44:47], a[108:111], a[64:67], v[44:47]
  v_add_u32 v18, s66, v18
  v_add_u32 v19, s66, v19
  v_mfma_f32_16x16x32_bf16 v[60:63], a[108:111], a[68:71], v[60:63]
  v_add_u32 v20, s66, v20
  v_mfma_f32_16x16x32_bf16 v[76:79], a[108:111], a[72:75], v[76:79]
  v_mfma_f32_16x16x32_bf16 v[92:95], a[108:111], a[76:79], v[92:95]
  s_waitcnt vmcnt(20) lgkmcnt(0)
  s_barrier
  v_mfma_f32_16x16x32_bf16 v[32:35], a[112:115], a[80:83], v[32:35]
  s_add_u32 m0, s64, 16384
  ds_read_b128 a[64:67], v16 offset:0
  ds_read_b64_tr_b16 a[96:97], v17 offset:16384
  v_mfma_f32_16x16x32_bf16 v[48:51], a[112:115], a[84:87], v[48:51]
  buffer_load_dwordx4 v10, s[12:15], s71 offen offset:0 lds
  ds_read_b64_tr_b16 a[98:99], v17 offset:18432
  v_mfma_f32_16x16x32_bf16 v[64:67], a[112:115], a[88:91], v[64:67]
  ds_read_b128 a[68:71], v16 offset:1024
  v_mfma_f32_16x16x32_bf16 v[80:83], a[112:115], a[92:95], v[80:83]
  ds_read_b128 a[72:75], v16 offset:2048
  v_mfma_f32_16x16x32_bf16 v[36:39], a[116:119], a[80:83], v[36:39]
  ds_read_b128 a[76:79], v16 offset:3072
  v_mfma_f32_16x16x32_bf16 v[52:55], a[116:119], a[84:87], v[52:55]
  ds_read_b64_tr_b16 a[100:101], v18 offset:16384
  v_mfma_f32_16x16x32_bf16 v[68:71], a[116:119], a[88:91], v[68:71]
  ds_read_b64_tr_b16 a[102:103], v18 offset:18432
  v_mfma_f32_16x16x32_bf16 v[84:87], a[116:119], a[92:95], v[84:87]
  buffer_load_dwordx4 v11, s[12:15], s71 offen offset:1024 lds
  ds_read_b64_tr_b16 a[104:105], v19 offset:16384
  v_mfma_f32_16x16x32_bf16 v[40:43], a[120:123], a[80:83], v[40:43]
  ds_read_b64_tr_b16 a[106:107], v19 offset:18432
  v_mfma_f32_16x16x32_bf16 v[56:59], a[120:123], a[84:87], v[56:59]
  ds_read_b64_tr_b16 a[108:109], v20 offset:16384
  v_mfma_f32_16x16x32_bf16 v[72:75], a[120:123], a[88:91], v[72:75]
  ds_read_b64_tr_b16 a[110:111], v20 offset:18432
  v_mfma_f32_16x16x32_bf16 v[88:91], a[120:123], a[92:95], v[88:91]
  v_mfma_f32_16x16x32_bf16 v[44:47], a[124:127], a[80:83], v[44:47]
  v_mfma_f32_16x16x32_bf16 v[60:63], a[124:127], a[84:87], v[60:63]
  v_mfma_f32_16x16x32_bf16 v[76:79], a[124:127], a[88:91], v[76:79]
  v_mfma_f32_16x16x32_bf16 v[92:95], a[124:127], a[92:95], v[92:95]
  s_waitcnt lgkmcnt(0)
  v_mfma_f32_16x16x32_bf16 v[32:35], a[96:99], a[64:67], v[32:35]
  buffer_load_dwordx4 v12, s[12:15], s71 offen offset:2048 lds
  ds_read_b128 a[80:83], v16 offset:8192
  v_mfma_f32_16x16x32_bf16 v[48:51], a[96:99], a[68:71], v[48:51]
  ds_read_b64_tr_b16 a[112:113], v17 offset:20480
  ds_read_b64_tr_b16 a[114:115], v17 offset:22528
  v_mfma_f32_16x16x32_bf16 v[64:67], a[96:99], a[72:75], v[64:67]
  ds_read_b128 a[84:87], v16 offset:9216
  v_mfma_f32_16x16x32_bf16 v[80:83], a[96:99], a[76:79], v[80:83]
  ds_read_b128 a[88:91], v16 offset:10240
  v_mfma_f32_16x16x32_bf16 v[36:39], a[100:103], a[64:67], v[36:39]
  ds_read_b128 a[92:95], v16 offset:11264
  v_mfma_f32_16x16x32_bf16 v[52:55], a[100:103], a[68:71], v[52:55]
  ds_read_b64_tr_b16 a[116:117], v18 offset:20480
  v_mfma_f32_16x16x32_bf16 v[68:71], a[100:103], a[72:75], v[68:71]
  ds_read_b64_tr_b16 a[118:119], v18 offset:22528
  v_mfma_f32_16x16x32_bf16 v[84:87], a[100:103], a[76:79], v[84:87]
  buffer_load_dwordx4 v13, s[12:15], s71 offen offset:3072 lds
  ds_read_b64_tr_b16 a[120:121], v19 offset:20480
  v_mfma_f32_16x16x32_bf16 v[40:43], a[104:107], a[64:67], v[40:43]
  s_add_u32 s71, s71, 131072
  ds_read_b64_tr_b16 a[122:123], v19 offset:22528
  v_mfma_f32_16x16x32_bf16 v[56:59], a[104:107], a[68:71], v[56:59]
  s_add_u32 s64, s64, s66
  s_add_u32 s65, s65, 1
  ds_read_b64_tr_b16 a[124:125], v20 offset:20480
  v_mfma_f32_16x16x32_bf16 v[72:75], a[104:107], a[72:75], v[72:75]
  s_cmp_eq_u32 s65, 5
  s_cselect_b32 s65, 0, s65
  s_cselect_b32 s66, s67, s68
  ds_read_b64_tr_b16 a[126:127], v20 offset:22528
  v_mfma_f32_16x16x32_bf16 v[88:91], a[104:107], a[76:79], v[88:91]
  v_add_u32 v16, s66, v16
  v_add_u32 v17, s66, v17
  v_mfma_f32_16x16x32_bf16 v[44:47], a[108:111], a[64:67], v[44:47]
  v_add_u32 v18, s66, v18
  v_add_u32 v19, s66, v19
  v_mfma_f32_16x16x32_bf16 v[60:63], a[108:111], a[68:71], v[60:63]
  v_add_u32 v20, s66, v20
  v_mfma_f32_16x16x32_bf16 v[76:79], a[108:111], a[72:75], v[76:79]
  v_mfma_f32_16x16x32_bf16 v[92:95], a[108:111], a[76:79], v[92:95]
  s_waitcnt vmcnt(16) lgkmcnt(0)
  s_barrier
  v_mfma_f32_16x16x32_bf16 v[32:35], a[112:115], a[80:83], v[32:35]
  s_add_u32 m0, s64, 16384
  ds_read_b128 a[64:67], v16 offset:0
  ds_read_b64_tr_b16 a[96:97], v17 offset:16384
  v_mfma_f32_16x16x32_bf16 v[48:51], a[112:115], a[84:87], v[48:51]
  buffer_load_dwordx4 v10, s[12:15], s71 offen offset:0 lds
  ds_read_b64_tr_b16 a[98:99], v17 offset:18432
  v_mfma_f32_16x16x32_bf16 v[64:67], a[112:115], a[88:91], v[64:67]
  ds_read_b128 a[68:71], v16 offset:1024
  v_mfma_f32_16x16x32_bf16 v[80:83], a[112:115], a[92:95], v[80:83]
  ds_read_b128 a[72:75], v16 offset:2048
  v_mfma_f32_16x16x32_bf16 v[36:39], a[116:119], a[80:83], v[36:39]
  ds_read_b128 a[76:79], v16 offset:3072
  v_mfma_f32_16x16x32_bf16 v[52:55], a[116:119], a[84:87], v[52:55]
  ds_read_b64_tr_b16 a[100:101], v18 offset:16384
  v_mfma_f32_16x16x32_bf16 v[68:71], a[116:119], a[88:91], v[68:71]
  ds_read_b64_tr_b16 a[102:103], v18 offset:18432
  v_mfma_f32_16x16x32_bf16 v[84:87], a[116:119], a[92:95], v[84:87]
  buffer_load_dwordx4 v11, s[12:15], s71 offen offset:1024 lds
  ds_read_b64_tr_b16 a[104:105], v19 offset:16384
  v_mfma_f32_16x16x32_bf16 v[40:43], a[120:123], a[80:83], v[40:43]
  ds_read_b64_tr_b16 a[106:107], v19 offset:18432
  v_mfma_f32_16x16x32_bf16 v[56:59], a[120:123], a[84:87], v[56:59]
  ds_read_b64_tr_b16 a[108:109], v20 offset:16384
  v_mfma_f32_16x16x32_bf16 v[72:75], a[120:123], a[88:91], v[72:75]
  ds_read_b64_tr_b16 a[110:111], v20 offset:18432
  v_mfma_f32_16x16x32_bf16 v[88:91], a[120:123], a[92:95], v[88:91]
  v_mfma_f32_16x16x32_bf16 v[44:47], a[124:127], a[80:83], v[44:47]
  v_mfma_f32_16x16x32_bf16 v[60:63], a[124:127], a[84:87], v[60:63]
  v_mfma_f32_16x16x32_bf16 v[76:79], a[124:127], a[88:91], v[76:79]
  v_mfma_f32_16x16x32_bf16 v[92:95], a[124:127], a[92:95], v[92:95]
  s_waitcnt lgkmcnt(0)
  v_mfma_f32_16x16x32_bf16 v[32:35], a[96:99], a[64:67], v[32:35]
  buffer_load_dwordx4 v12, s[12:15], s71 offen offset:2048 lds
  ds_read_b128 a[80:83], v16 offset:8192
  v_mfma_f32_16x16x32_bf16 v[48:51], a[96:99], a[68:71], v[48:51]
  ds_read_b64_tr_b16 a[112:113], v17 offset:20480
  ds_read_b64_tr_b16 a[114:115], v17 offset:22528
  v_mfma_f32_16x16x32_bf16 v[64:67], a[96:99], a[72:75], v[64:67]
  ds_read_b128 a[84:87], v16 offset:9216
  v_mfma_f32_16x16x32_bf16 v[80:83], a[96:99], a[76:79], v[80:83]
  ds_read_b128 a[88:91], v16 offset:10240
  v_mfma_f32_16x16x32_bf16 v[36:39], a[100:103], a[64:67], v[36:39]
  ds_read_b128 a[92:95], v16 offset:11264
  v_mfma_f32_16x16x32_bf16 v[52:55], a[100:103], a[68:71], v[52:55]
  ds_read_b64_tr_b16 a[116:117], v18 offset:20480
  v_mfma_f32_16x16x32_bf16 v[68:71], a[100:103], a[72:75], v[68:71]
  ds_read_b64_tr_b16 a[118:119], v18 offset:22528
  v_mfma_f32_16x16x32_bf16 v[84:87], a[100:103], a[76:79], v[84:87]
  buffer_load_dwordx4 v13, s[12:15], s71 offen offset:3072 lds
  ds_read_b64_tr_b16 a[120:121], v19 offset:20480
  v_mfma_f32_16x16x32_bf16 v[40:43], a[104:107], a[64:67], v[40:43]
  s_add_u32 s71, s71, 131072
  ds_read_b64_tr_b16 a[122:123], v19 offset:22528
  v_mfma_f32_16x16x32_bf16 v[56:59], a[104:107], a[68:71], v[56:59]
  s_add_u32 s64, s64, s66
  s_add_u32 s65, s65, 1
  ds_read_b64_tr_b16 a[124:125], v20 offset:20480
  v_mfma_f32_16x16x32_bf16 v[72:75], a[104:107], a[72:75], v[72:75]
  s_cmp_eq_u32 s65, 5
  s_cselect_b32 s65, 0, s65
  s_cselect_b32 s66, s67, s68
  ds_read_b64_tr_b16 a[126:127], v20 offset:22528
  v_mfma_f32_16x16x32_bf16 v[88:91], a[104:107], a[76:79], v[88:91]
  v_add_u32 v16, s66, v16
  v_add_u32 v17, s66, v17
  v_mfma_f32_16x16x32_bf16 v[44:47], a[108:111], a[64:67], v[44:47]
  v_add_u32 v18, s66, v18
  v_add_u32 v19, s66, v19
  v_mfma_f32_16x16x32_bf16 v[60:63], a[108:111], a[68:71], v[60:63]
  v_add_u32 v20, s66, v20
  v_mfma_f32_16x16x32_bf16 v[76:79], a[108:111], a[72:75], v[76:79]
  v_mfma_f32_16x16x32_bf16 v[92:95], a[108:111], a[76:79], v[92:95]
  s_waitcnt vmcnt(12) lgkmcnt(0)
  s_barrier
  v_mfma_f32_16x16x32_bf16 v[32:35], a[112:115], a[80:83], v[32:35]
  s_add_u32 m0, s64, 16384
  ds_read_b128 a[64:67], v16 offset:0
  ds_read_b64_tr_b16 a[96:97], v17 offset:16384
  v_mfma_f32_16x16x32_bf16 v[48:51], a[112:115], a[84:87], v[48:51]
  buffer_load_dwordx4 v10, s[12:15], s71 offen offset:0 lds
  ds_read_b64_tr_b16 a[98:99], v17 offset:18432
  v_mfma_f32_16x16x32_bf16 v[64:67], a[112:115], a[88:91], v[64:67]
  ds_read_b128 a[68:71], v16 offset:1024
  v_mfma_f32_16x16x32_bf16 v[80:83], a[112:115], a[92:95], v[80:83]
  ds_read_b128 a[72:75], v16 offset:2048
  v_mfma_f32_16x16x32_bf16 v[36:39], a[116:119], a[80:83], v[36:39]
  ds_read_b128 a[76:79], v16 offset:3072
  v_mfma_f32_16x16x32_bf16 v[52:55], a[116:119], a[84:87], v[52:55]
  buffer_load_dwordx4 v11, s[12:15], s71 offen offset:1024 lds
  ds_read_b64_tr_b16 a[100:101], v18 offset:16384
  v_mfma_f32_16x16x32_bf16 v[68:71], a[116:119], a[88:91], v[68:71]
  ds_read_b64_tr_b16 a[102:103], v18 offset:18432
  v_mfma_f32_16x16x32_bf16 v[84:87], a[116:119], a[92:95], v[84:87]
  ds_read_b64_tr_b16 a[104:105], v19 offset:16384
  v_mfma_f32_16x16x32_bf16 v[40:43], a[120:123], a[80:83], v[40:43]
  ds_read_b64_tr_b16 a[106:107], v19 offset:18432
  v_mfma_f32_16x16x32_bf16 v[56:59], a[120:123], a[84:87], v[56:59]
  ds_read_b64_tr_b16 a[108:109], v20 offset:16384
  v_mfma_f32_16x16x32_bf16 v[72:75], a[120:123], a[88:91], v[72:75]
  buffer_load_dwordx4 v12, s[12:15], s71 offen offset:2048 lds
  ds_read_b64_tr_b16 a[110:111], v20 offset:18432
  v_mfma_f32_16x16x32_bf16 v[88:91], a[120:123], a[92:95], v[88:91]
  v_mfma_f32_16x16x32_bf16 v[44:47], a[124:127], a[80:83], v[44:47]
  v_mfma_f32_16x16x32_bf16 v[60:63], a[124:127], a[84:87], v[60:63]
  v_mfma_f32_16x16x32_bf16 v[76:79], a[124:127], a[88:91], v[76:79]
  v_mfma_f32_16x16x32_bf16 v[92:95], a[124:127], a[92:95], v[92:95]
  s_waitcnt lgkmcnt(0)
  v_mfma_f32_16x16x32_bf16 v[32:35], a[96:99], a[64:67], v[32:35]
  buffer_load_dwordx4 v13, s[12:15], s71 offen offset:3072 lds
  ds_read_b128 a[80:83], v16 offset:8192
  v_mfma_f32_16x16x32_bf16 v[48:51], a[96:99], a[68:71], v[48:51]
  s_add_u32 s71, s71, 131072
  ds_read_b64_tr_b16 a[112:113], v17 offset:20480
  ds_read_b64_tr_b16 a[114:115], v17 offset:22528
  v_mfma_f32_16x16x32_bf16 v[64:67], a[96:99], a[72:75], v[64:67]
  ds_read_b128 a[84:87], v16 offset:9216
  v_mfma_f32_16x16x32_bf16 v[80:83], a[96:99], a[76:79], v[80:83]
  ds_read_b128 a[88:91], v16 offset:10240
  v_mfma_f32_16x16x32_bf16 v[36:39], a[100:103], a[64:67], v[36:39]
  ds_read_b128 a[92:95], v16 offset:11264
  v_mfma_f32_16x16x32_bf16 v[52:55], a[100:103], a[68:71], v[52:55]
  ds_read_b64_tr_b16 a[116:117], v18 offset:20480
  v_mfma_f32_16x16x32_bf16 v[68:71], a[100:103], a[72:75], v[68:71]
  ds_read_b64_tr_b16 a[118:119], v18 offset:22528
  v_mfma_f32_16x16x32_bf16 v[84:87], a[100:103], a[76:79], v[84:87]
  buffer_load_dwordx2 v[6:7], v14, s[96:99], s91 offen sc1
  ds_read_b64_tr_b16 a[120:121], v19 offset:20480
  v_mfma_f32_16x16x32_bf16 v[40:43], a[104:107], a[64:67], v[40:43]
  s_add_u32 s64, s64, s66
  s_add_u32 s65, s65, 1
  ds_read_b64_tr_b16 a[122:123], v19 offset:22528
  v_mfma_f32_16x16x32_bf16 v[56:59], a[104:107], a[68:71], v[56:59]
  s_cmp_eq_u32 s65, 5
  s_cselect_b32 s65, 0, s65
  s_cselect_b32 s66, s67, s68
  ds_read_b64_tr_b16 a[124:125], v20 offset:20480
  v_mfma_f32_16x16x32_bf16 v[72:75], a[104:107], a[72:75], v[72:75]
  ds_read_b64_tr_b16 a[126:127], v20 offset:22528
  v_mfma_f32_16x16x32_bf16 v[88:91], a[104:107], a[76:79], v[88:91]
  v_add_u32 v16, s66, v16
  v_add_u32 v17, s66, v17
  v_mfma_f32_16x16x32_bf16 v[44:47], a[108:111], a[64:67], v[44:47]
  v_add_u32 v18, s66, v18
  v_add_u32 v19, s66, v19
  v_mfma_f32_16x16x32_bf16 v[60:63], a[108:111], a[68:71], v[60:63]
  v_add_u32 v20, s66, v20
  v_mfma_f32_16x16x32_bf16 v[76:79], a[108:111], a[72:75], v[76:79]
  v_mfma_f32_16x16x32_bf16 v[92:95], a[108:111], a[76:79], v[92:95]
  s_waitcnt vmcnt(0) lgkmcnt(0)
  s_barrier
  s_mov_b32 s5, 0x40000
Lpoll_19:
  v_cmp_ne_u64 vcc, s[94:95], v[6:7]
  s_nop 0
  s_cbranch_vccz Lpolld_20
  s_sleep 4
  buffer_load_dwordx2 v[6:7], v14, s[96:99], s91 offen sc1
  s_sub_u32 s5, s5, 1
  s_waitcnt vmcnt(0)
  s_cbranch_scc0 Lpoll_19
Lpolld_20:
  s_add_u32 s8, s86, 67108864
  s_addc_u32 s9, s87, 0
  s_mov_b32 s10, 16777216
  s_mov_b32 s11, 0x00020000
  s_lshl_b32 s70, s73, 1
  s_add_u32 s70, s70, s77
  s_lshl_b32 s70, s70, 19
  s_add_u32 s70, s70, s79
  v_mfma_f32_16x16x32_bf16 v[32:35], a[112:115], a[80:83], v[32:35]
  s_add_u32 m0, s79, 65536
  v_mfma_f32_16x16x32_bf16 v[48:51], a[112:115], a[84:87], v[48:51]
  buffer_load_dwordx4 v2, s[8:11], s70 offen offset:0 lds
  v_mfma_f32_16x16x32_bf16 v[64:67], a[112:115], a[88:91], v[64:67]
  buffer_load_dwordx4 v2, s[8:11], s70 offen offset:1024 lds
  v_mfma_f32_16x16x32_bf16 v[80:83], a[112:115], a[92:95], v[80:83]
  buffer_load_dwordx4 v2, s[8:11], s70 offen offset:2048 lds
  v_mfma_f32_16x16x32_bf16 v[36:39], a[116:119], a[80:83], v[36:39]
  buffer_load_dwordx4 v2, s[8:11], s70 offen offset:3072 lds
  v_mfma_f32_16x16x32_bf16 v[52:55], a[116:119], a[84:87], v[52:55]
  s_add_u32 s70, s70, 16384
  s_add_u32 m0, s79, 98304
  v_mfma_f32_16x16x32_bf16 v[68:71], a[116:119], a[88:91], v[68:71]
  buffer_load_dwordx4 v2, s[8:11], s70 offen offset:0 lds
  v_mfma_f32_16x16x32_bf16 v[84:87], a[116:119], a[92:95], v[84:87]
  buffer_load_dwordx4 v2, s[8:11], s70 offen offset:1024 lds
  v_mfma_f32_16x16x32_bf16 v[40:43], a[120:123], a[80:83], v[40:43]
  buffer_load_dwordx4 v2, s[8:11], s70 offen offset:2048 lds
  v_mfma_f32_16x16x32_bf16 v[56:59], a[120:123], a[84:87], v[56:59]
  buffer_load_dwordx4 v2, s[8:11], s70 offen offset:3072 lds
  v_mfma_f32_16x16x32_bf16 v[72:75], a[120:123], a[88:91], v[72:75]
  s_add_u32 s70, s70, 16384
  s_add_u32 m0, s79, 131072
  v_mfma_f32_16x16x32_bf16 v[88:91], a[120:123], a[92:95], v[88:91]
  buffer_load_dwordx4 v2, s[8:11], s70 offen offset:0 lds
  v_mfma_f32_16x16x32_bf16 v[44:47], a[124:127], a[80:83], v[44:47]
  buffer_load_dwordx4 v2, s[8:11], s70 offen offset:1024 lds
  v_mfma_f32_16x16x32_bf16 v[60:63], a[124:127], a[84:87], v[60:63]
  buffer_load_dwordx4 v2, s[8:11], s70 offen offset:2048 lds
  v_mfma_f32_16x16x32_bf16 v[76:79], a[124:127], a[88:91], v[76:79]
  buffer_load_dwordx4 v2, s[8:11], s70 offen offset:3072 lds
  v_mfma_f32_16x16x32_bf16 v[92:95], a[124:127], a[92:95], v[92:95]
  s_add_u32 s70, s70, 16384
  s_add_u32 m0, s79, 0
  s_nop 0
  buffer_load_dwordx4 v2, s[8:11], s70 offen offset:0 lds
  buffer_load_dwordx4 v2, s[8:11], s70 offen offset:1024 lds
  buffer_load_dwordx4 v2, s[8:11], s70 offen offset:2048 lds
  buffer_load_dwordx4 v2, s[8:11], s70 offen offset:3072 lds
  s_add_u32 s70, s70, 16384
  s_add_u32 m0, s79, 49152
  s_nop 0
  buffer_load_dwordx4 v10, s[12:15], s71 offen offset:0 lds
  buffer_load_dwordx4 v11, s[12:15], s71 offen offset:1024 lds
  buffer_load_dwordx4 v12, s[12:15], s71 offen offset:2048 lds
  buffer_load_dwordx4 v13, s[12:15], s71 offen offset:3072 lds
  s_add_u32 s71, s71, 131072
  s_add_u32 m0, s79, 32768
  s_nop 0
  buffer_load_dwordx4 v2, s[8:11], s70 offen offset:0 lds
  buffer_load_dwordx4 v2, s[8:11], s70 offen offset:1024 lds
  buffer_load_dwordx4 v2, s[8:11], s70 offen offset:2048 lds
  buffer_load_dwordx4 v2, s[8:11], s70 offen offset:3072 lds
  s_add_u32 s70, s70, 16384
  s_add_u32 s16, s86, 100663296
  s_addc_u32 s17, s87, 0
  s_mov_b32 s18, 16777216
  s_mov_b32 s19, 0x00020000
  s_lshl_b32 s6, s78, 1
  s_add_u32 s6, s6, s77
  s_xor_b32 s6, s6, 1
  s_lshl_b32 s6, s6, 2
  s_add_u32 s6, s6, s3
  s_lshl_b32 s6, s6, 13
  s_add_u32 s6, s6, 8388608
  s_add_u32 s7, s6, 4096
  s_cmp_eq_u32 s77, 0
  s_cbranch_scc1 Lsend_21_0
  buffer_store_dwordx4 v[32:35], v2, s[16:19], s6 offen offset:0 sc1
  buffer_store_dwordx4 v[36:39], v2, s[16:19], s6 offen offset:1024 sc1
  buffer_store_dwordx4 v[40:43], v2, s[16:19], s6 offen offset:2048 sc1
  buffer_store_dwordx4 v[44:47], v2, s[16:19], s6 offen offset:3072 sc1
  buffer_store_dwordx4 v[48:51], v2, s[16:19], s7 offen offset:0 sc1
  buffer_store_dwordx4 v[52:55], v2, s[16:19], s7 offen offset:1024 sc1
  buffer_store_dwordx4 v[56:59], v2, s[16:19], s7 offen offset:2048 sc1
  buffer_store_dwordx4 v[60:63], v2, s[16:19], s7 offen offset:3072 sc1
  s_branch Lsend_21_e
Lsend_21_0:
  buffer_store_dwordx4 v[64:67], v2, s[16:19], s6 offen offset:0 sc1
  buffer_store_dwordx4 v[68:71], v2, s[16:19], s6 offen offset:1024 sc1
  buffer_store_dwordx4 v[72:75], v2, s[16:19], s6 offen offset:2048 sc1
  buffer_store_dwordx4 v[76:79], v2, s[16:19], s6 offen offset:3072 sc1
  buffer_store_dwordx4 v[80:83], v2, s[16:19], s7 offen offset:0 sc1
  buffer_store_dwordx4 v[84:87], v2, s[16:19], s7 offen offset:1024 sc1
  buffer_store_dwordx4 v[88:91], v2, s[16:19], s7 offen offset:2048 sc1
  buffer_store_dwordx4 v[92:95], v2, s[16:19], s7 offen offset:3072 sc1
Lsend_21_e:
  s_waitcnt vmcnt(28)
  s_barrier
  ds_read_b128 a[64:67], v16 offset:0
  ds_read_b64_tr_b16 a[96:97], v17 offset:16384
  ds_read_b64_tr_b16 a[98:99], v17 offset:18432
  ds_read_b128 a[68:71], v16 offset:1024
  ds_read_b128 a[72:75], v16 offset:2048
  ds_read_b128 a[76:79], v16 offset:3072
  ds_read_b64_tr_b16 a[100:101], v18 offset:16384
  ds_read_b64_tr_b16 a[102:103], v18 offset:18432
  ds_read_b64_tr_b16 a[104:105], v19 offset:16384
  ds_read_b64_tr_b16 a[106:107], v19 offset:18432
  ds_read_b64_tr_b16 a[108:109], v20 offset:16384
  ds_read_b64_tr_b16 a[110:111], v20 offset:18432
  s_waitcnt lgkmcnt(0)
  v_mfma_f32_16x16x32_bf16 v[96:99], a[96:99], a[64:67], 0
  s_add_u32 s64, s64, s66
  ds_read_b128 a[80:83], v16 offset:8192
  ds_read_b64_tr_b16 a[112:113], v17 offset:20480
  v_mfma_f32_16x16x32_bf16 v[112:115], a[96:99], a[68:71], 0
  s_add_u32 s65, s65, 1
  s_cmp_eq_u32 s65, 5
  s_cselect_b32 s65, 0, s65
  s_cselect_b32 s66, s67, s68
  ds_read_b64_tr_b16 a[114:115], v17 offset:22528
  v_mfma_f32_16x16x32_bf16 v[128:131], a[96:99], a[72:75], 0
  ds_read_b128 a[84:87], v16 offset:9216
  v_mfma_f32_16x16x32_bf16 v[144:147], a[96:99], a[76:79], 0
  ds_read_b128 a[88:91], v16 offset:10240
  v_mfma_f32_16x16x32_bf16 v[100:103], a[100:103], a[64:67], 0
  ds_read_b128 a[92:95], v16 offset:11264
  v_mfma_f32_16x16x32_bf16 v[116:119], a[100:103], a[68:71], 0
  ds_read_b64_tr_b16 a[116:117], v18 offset:20480
  v_mfma_f32_16x16x32_bf16 v[132:135], a[100:103], a[72:75], 0
  ds_read_b64_tr_b16 a[118:119], v18 offset:22528
  v_mfma_f32_16x16x32_bf16 v[148:151], a[100:103], a[76:79], 0
  ds_read_b64_tr_b16 a[120:121], v19 offset:20480
  v_mfma_f32_16x16x32_bf16 v[104:107], a[104:107], a[64:67], 0
  ds_read_b64_tr_b16 a[122:123], v19 offset:22528
  v_mfma_f32_16x16x32_bf16 v[120:123], a[104:107], a[68:71], 0
  ds_read_b64_tr_b16 a[124:125], v20 offset:20480
  v_mfma_f32_16x16x32_bf16 v[136:139], a[104:107], a[72:75], 0
  ds_read_b64_tr_b16 a[126:127], v20 offset:22528
  v_mfma_f32_16x16x32_bf16 v[152:155], a[104:107], a[76:79], 0
  v_add_u32 v16, s66, v16
  v_add_u32 v17, s66, v17
  v_mfma_f32_16x16x32_bf16 v[108:111], a[108:111], a[64:67], 0
  v_add_u32 v18, s66, v18
  v_add_u32 v19, s66, v19
  v_mfma_f32_16x16x32_bf16 v[124:127], a[108:111], a[68:71], 0
  v_add_u32 v20, s66, v20
  v_mfma_f32_16x16x32_bf16 v[140:143], a[108:111], a[72:75], 0
  v_mfma_f32_16x16x32_bf16 v[156:159], a[108:111], a[76:79], 0
  s_waitcnt vmcnt(24) lgkmcnt(0)
  s_barrier
  v_mfma_f32_16x16x32_bf16 v[96:99], a[112:115], a[80:83], v[96:99]
  s_add_u32 m0, s64, 16384
  ds_read_b128 a[64:67], v16 offset:0
  ds_read_b64_tr_b16 a[96:97], v17 offset:16384
  v_mfma_f32_16x16x32_bf16 v[112:115], a[112:115], a[84:87], v[112:115]
  buffer_load_dwordx4 v10, s[12:15], s71 offen offset:0 lds
  ds_read_b64_tr_b16 a[98:99], v17 offset:18432
  v_mfma_f32_16x16x32_bf16 v[128:131], a[112:115], a[88:91], v[128:131]
  ds_read_b128 a[68:71], v16 offset:1024
  v_mfma_f32_16x16x32_bf16 v[144:147], a[112:115], a[92:95], v[144:147]
  buffer_load_dwordx4 v11, s[12:15], s71 offen offset:1024 lds
  ds_read_b128 a[72:75], v16 offset:2048
  v_mfma_f32_16x16x32_bf16 v[100:103], a[116:119], a[80:83], v[100:103]
  ds_read_b128 a[76:79], v16 offset:3072
  v_mfma_f32_16x16x32_bf16 v[116:119], a[116:119], a[84:87], v[116:119]
  ds_read_b64_tr_b16 a[100:101], v18 offset:16384
  v_mfma_f32_16x16x32_bf16 v[132:135], a[116:119], a[88:91], v[132:135]
  ds_read_b64_tr_b16 a[102:103], v18 offset:18432
  v_mfma_f32_16x16x32_bf16 v[148:151], a[116:119], a[92:95], v[148:151]
  buffer_load_dwordx4 v12, s[12:15], s71 offen offset:2048 lds
  ds_read_b64_tr_b16 a[104:105], v19 offset:16384
  v_mfma_f32_16x16x32_bf16 v[104:107], a[120:123], a[80:83], v[104:107]
  ds_read_b64_tr_b16 a[106:107], v19 offset:18432
  v_mfma_f32_16x16x32_bf16 v[120:123], a[120:123], a[84:87], v[120:123]
  ds_read_b64_tr_b16 a[108:109], v20 offset:16384
  v_mfma_f32_16x16x32_bf16 v[136:139], a[120:123], a[88:91], v[136:139]
  ds_read_b64_tr_b16 a[110:111], v20 offset:18432
  v_mfma_f32_16x16x32_bf16 v[152:155], a[120:123], a[92:95], v[152:155]
  buffer_load_dwordx4 v13, s[12:15], s71 offen offset:3072 lds
  v_mfma_f32_16x16x32_bf16 v[108:111], a[124:127], a[80:83], v[108:111]
  s_add_u32 s71, s71, 131072
  v_mfma_f32_16x16x32_bf16 v[124:127], a[124:127], a[84:87], v[124:127]
  v_mfma_f32_16x16x32_bf16 v[140:143], a[124:127], a[88:91], v[140:143]
  v_mfma_f32_16x16x32_bf16 v[156:159], a[124:127], a[92:95], v[156:159]
  s_waitcnt lgkmcnt(0)
  v_mfma_f32_16x16x32_bf16 v[96:99], a[96:99], a[64:67], v[96:99]
  s_mov_b32 m0, s64
  ds_read_b128 a[80:83], v16 offset:8192
  ds_read_b64_tr_b16 a[112:113], v17 offset:20480
  v_mfma_f32_16x16x32_bf16 v[112:115], a[96:99], a[68:71], v[112:115]
  buffer_load_dwordx4 v2, s[8:11], s70 offen offset:0 lds
  ds_read_b64_tr_b16 a[114:115], v17 offset:22528
  v_mfma_f32_16x16x32_bf16 v[128:131], a[96:99], a[72:75], v[128:131]
  ds_read_b128 a[84:87], v16 offset:9216
  v_mfma_f32_16x16x32_bf16 v[144:147], a[96:99], a[76:79], v[144:147]
  buffer_load_dwordx4 v2, s[8:11], s70 offen offset:1024 lds
  ds_read_b128 a[88:91], v16 offset:10240
  v_mfma_f32_16x16x32_bf16 v[100:103], a[100:103], a[64:67], v[100:103]
  ds_read_b128 a[92:95], v16 offset:11264
  v_mfma_f32_16x16x32_bf16 v[116:119], a[100:103], a[68:71], v[116:119]
  ds_read_b64_tr_b16 a[116:117], v18 offset:20480
  v_mfma_f32_16x16x32_bf16 v[132:135], a[100:103], a[72:75], v[132:135]
  ds_read_b64_tr_b16 a[118:119], v18 offset:22528
  v_mfma_f32_16x16x32_bf16 v[148:151], a[100:103], a[76:79], v[148:151]
  buffer_load_dwordx4 v2, s[8:11], s70 offen offset:2048 lds
  ds_read_b64_tr_b16 a[120:121], v19 offset:20480
  v_mfma_f32_16x16x32_bf16 v[104:107], a[104:107], a[64:67], v[104:107]
  ds_read_b64_tr_b16 a[122:123], v19 offset:22528
  v_mfma_f32_16x16x32_bf16 v[120:123], a[104:107], a[68:71], v[120:123]
  ds_read_b64_tr_b16 a[124:125], v20 offset:20480
  v_mfma_f32_16x16x32_bf16 v[136:139], a[104:107], a[72:75], v[136:139]
  ds_read_b64_tr_b16 a[126:127], v20 offset:22528
  v_mfma_f32_16x16x32_bf16 v[152:155], a[104:107], a[76:79], v[152:155]
  buffer_load_dwordx4 v2, s[8:11], s70 offen offset:3072 lds
  v_mfma_f32_16x16x32_bf16 v[108:111], a[108:111], a[64:67], v[108:111]
  s_add_u32 s70, s70, 16384
  v_mfma_f32_16x16x32_bf16 v[124:127], a[108:111], a[68:71], v[124:127]
  s_add_u32 s64, s64, s66
  s_add_u32 s65, s65, 1
  s_cmp_eq_u32 s65, 5
  s_cselect_b32 s65, 0, s65
  s_cselect_b32 s66, s67, s68
  v_mfma_f32_16x16x32_bf16 v[140:143], a[108:111], a[72:75], v[140:143]
  v_add_u32 v16, s66, v16
  v_add_u32 v17, s66, v17
  v_add_u32 v20, s66, v20
  v_mfma_f32_16x16x32_bf16 v[156:159], a[108:111], a[76:79], v[156:159]
  v_add_u32 v18, s66, v18
  v_add_u32 v19, s66, v19
  s_mov_b32 s69, 26
  .p2align 6
Lp7_loop:
  s_waitcnt vmcnt(24) lgkmcnt(0)
  s_barrier
  v_mfma_f32_16x16x32_bf16 v[96:99], a[112:115], a[80:83], v[96:99]
  s_add_u32 m0, s64, 16384
  ds_read_b128 a[64:67], v16 offset:0
  ds_read_b64_tr_b16 a[96:97], v17 offset:16384
  v_mfma_f32_16x16x32_bf16 v[112:115], a[112:115], a[84:87], v[112:115]
  buffer_load_dwordx4 v10, s[12:15], s71 offen offset:0 lds
  ds_read_b64_tr_b16 a[98:99], v17 offset:18432
  v_mfma_f32_16x16x32_bf16 v[128:131], a[112:115], a[88:91], v[128:131]
  ds_read_b128 a[68:71], v16 offset:1024
  v_mfma_f32_16x16x32_bf16 v[144:147], a[112:115], a[92:95], v[144:147]
  buffer_load_dwordx4 v11, s[12:15], s71 offen offset:1024 lds
  ds_read_b128 a[72:75], v16 offset:2048
  v_mfma_f32_16x16x32_bf16 v[100:103], a[116:119], a[80:83], v[100:103]
  ds_read_b128 a[76:79], v16 offset:3072
  v_mfma_f32_16x16x32_bf16 v[116:119], a[116:119], a[84:87], v[116:119]
  ds_read_b64_tr_b16 a[100:101], v18 offset:16384
  v_mfma_f32_16x16x32_bf16 v[132:135], a[116:119], a[88:91], v[132:135]
  ds_read_b64_tr_b16 a[102:103], v18 offset:18432
  v_mfma_f32_16x16x32_bf16 v[148:151], a[116:119], a[92:95], v[148:151]
  buffer_load_dwordx4 v12, s[12:15], s71 offen offset:2048 lds
  ds_read_b64_tr_b16 a[104:105], v19 offset:16384
  v_mfma_f32_16x16x32_bf16 v[104:107], a[120:123], a[80:83], v[104:107]
  ds_read_b64_tr_b16 a[106:107], v19 offset:18432
  v_mfma_f32_16x16x32_bf16 v[120:123], a[120:123], a[84:87], v[120:123]
  ds_read_b64_tr_b16 a[108:109], v20 offset:16384
  v_mfma_f32_16x16x32_bf16 v[136:139], a[120:123], a[88:91], v[136:139]
  ds_read_b64_tr_b16 a[110:111], v20 offset:18432
  v_mfma_f32_16x16x32_bf16 v[152:155], a[120:123], a[92:95], v[152:155]
  buffer_load_dwordx4 v13, s[12:15], s71 offen offset:3072 lds
  v_mfma_f32_16x16x32_bf16 v[108:111], a[124:127], a[80:83], v[108:111]
  s_add_u32 s71, s71, 131072
  v_mfma_f32_16x16x32_bf16 v[124:127], a[124:127], a[84:87], v[124:127]
  v_mfma_f32_16x16x32_bf16 v[140:143], a[124:127], a[88:91], v[140:143]
  v_mfma_f32_16x16x32_bf16 v[156:159], a[124:127], a[92:95], v[156:159]
  s_waitcnt lgkmcnt(0)
  v_mfma_f32_16x16x32_bf16 v[96:99], a[96:99], a[64:67], v[96:99]
  s_mov_b32 m0, s64
  ds_read_b128 a[80:83], v16 offset:8192
  ds_read_b64_tr_b16 a[112:113], v17 offset:20480
  v_mfma_f32_16x16x32_bf16 v[112:115], a[96:99], a[68:71], v[112:115]
  buffer_load_dwordx4 v2, s[8:11], s70 offen offset:0 lds
  ds_read_b64_tr_b16 a[114:115], v17 offset:22528
  v_mfma_f32_16x16x32_bf16 v[128:131], a[96:99], a[72:75], v[128:131]
  ds_read_b128 a[84:87], v16 offset:9216
  v_mfma_f32_16x16x32_bf16 v[144:147], a[96:99], a[76:79], v[144:147]
  buffer_load_dwordx4 v2, s[8:11], s70 offen offset:1024 lds
  ds_read_b128 a[88:91], v16 offset:10240
  v_mfma_f32_16x16x32_bf16 v[100:103], a[100:103], a[64:67], v[100:103]
  ds_read_b128 a[92:95], v16 offset:11264
  v_mfma_f32_16x16x32_bf16 v[116:119], a[100:103], a[68:71], v[116:119]
  ds_read_b64_tr_b16 a[116:117], v18 offset:20480
  v_mfma_f32_16x16x32_bf16 v[132:135], a[100:103], a[72:75], v[132:135]
  ds_read_b64_tr_b16 a[118:119], v18 offset:22528
  v_mfma_f32_16x16x32_bf16 v[148:151], a[100:103], a[76:79], v[148:151]
  buffer_load_dwordx4 v2, s[8:11], s70 offen offset:2048 lds
  ds_read_b64_tr_b16 a[120:121], v19 offset:20480
  v_mfma_f32_16x16x32_bf16 v[104:107], a[104:107], a[64:67], v[104:107]
  ds_read_b64_tr_b16 a[122:123], v19 offset:22528
  v_mfma_f32_16x16x32_bf16 v[120:123], a[104:107], a[68:71], v[120:123]
  ds_read_b64_tr_b16 a[124:125], v20 offset:20480
  v_mfma_f32_16x16x32_bf16 v[136:139], a[104:107], a[72:75], v[136:139]
  ds_read_b64_tr_b16 a[126:127], v20 offset:22528
  v_mfma_f32_16x16x32_bf16 v[152:155], a[104:107], a[76:79], v[152:155]
  buffer_load_dwordx4 v2, s[8:11], s70 offen offset:3072 lds
  v_mfma_f32_16x16x32_bf16 v[108:111], a[108:111], a[64:67], v[108:111]
  s_add_u32 s70, s70, 16384
  v_mfma_f32_16x16x32_bf16 v[124:127], a[108:111], a[68:71], v[124:127]
  s_add_u32 s64, s64, s66
  s_add_u32 s65, s65, 1
  s_cmp_eq_u32 s65, 5
  s_cselect_b32 s65, 0, s65
  s_cselect_b32 s66, s67, s68
  v_mfma_f32_16x16x32_bf16 v[140:143], a[108:111], a[72:75], v[140:143]
  s_sub_u32 s69, s69, 1
  v_add_u32 v16, s66, v16
  v_add_u32 v17, s66, v17
  v_add_u32 v20, s66, v20
  v_mfma_f32_16x16x32_bf16 v[156:159], a[108:111], a[76:79], v[156:159]
  v_add_u32 v18, s66, v18
  v_add_u32 v19, s66, v19
  s_cmp_lg_u32 s69, 0
  s_cbranch_scc1 Lp7_loop
  s_waitcnt vmcnt(24) lgkmcnt(0)
  s_barrier
  s_lshl_b32 s6, s78, 1
  s_add_u32 s6, s6, s77
  s_lshl_b32 s6, s6, 7
  s_add_u32 s6, s6, 163840
  v_mov_b32 v8, 0x40000000
  v_mov_b32 v6, s94
  v_cmp_eq_u32 vcc, 0, v0
  v_mov_b32 v7, s95
  s_nop 0
  v_cndmask_b32_e64 v8, v8, 0, vcc
  buffer_store_dwordx2 v[6:7], v8, s[96:99], s6 offen sc1
  s_lshl_b32 s90, s78, 1
  s_add_u32 s90, s90, s77
  s_xor_b32 s90, s90, 1
  s_lshl_b32 s90, s90, 7
  s_add_u32 s90, s90, 163840
  v_mfma_f32_16x16x32_bf16 v[96:99], a[112:115], a[80:83], v[96:99]
  ds_read_b128 a[64:67], v16 offset:0
  ds_read_b64_tr_b16 a[96:97], v17 offset:16384
  v_mfma_f32_16x16x32_bf16 v[112:115], a[112:115], a[84:87], v[112:115]
  ds_read_b64_tr_b16 a[98:99], v17 offset:18432
  v_mfma_f32_16x16x32_bf16 v[128:131], a[112:115], a[88:91], v[128:131]
  ds_read_b128 a[68:71], v16 offset:1024
  v_mfma_f32_16x16x32_bf16 v[144:147], a[112:115], a[92:95], v[144:147]
  ds_read_b128 a[72:75], v16 offset:2048
  v_mfma_f32_16x16x32_bf16 v[100:103], a[116:119], a[80:83], v[100:103]
  ds_read_b128 a[76:79], v16 offset:3072
  v_mfma_f32_16x16x32_bf16 v[116:119], a[116:119], a[84:87], v[116:119]
  ds_read_b64_tr_b16 a[100:101], v18 offset:16384
  v_mfma_f32_16x16x32_bf16 v[132:135], a[116:119], a[88:91], v[132:135]
  ds_read_b64_tr_b16 a[102:103], v18 offset:18432
  v_mfma_f32_16x16x32_bf16 v[148:151], a[116:119], a[92:95], v[148:151]
  ds_read_b64_tr_b16 a[104:105], v19 offset:16384
  v_mfma_f32_16x16x32_bf16 v[104:107], a[120:123], a[80:83], v[104:107]
  ds_read_b64_tr_b16 a[106:107], v19 offset:18432
  v_mfma_f32_16x16x32_bf16 v[120:123], a[120:123], a[84:87], v[120:123]
  ds_read_b64_tr_b16 a[108:109], v20 offset:16384
  v_mfma_f32_16x16x32_bf16 v[136:139], a[120:123], a[88:91], v[136:139]
  ds_read_b64_tr_b16 a[110:111], v20 offset:18432
  v_mfma_f32_16x16x32_bf16 v[152:155], a[120:123], a[92:95], v[152:155]
  v_mfma_f32_16x16x32_bf16 v[108:111], a[124:127], a[80:83], v[108:111]
  v_mfma_f32_16x16x32_bf16 v[124:127], a[124:127], a[84:87], v[124:127]
  v_mfma_f32_16x16x32_bf16 v[140:143], a[124:127], a[88:91], v[140:143]
  v_mfma_f32_16x16x32_bf16 v[156:159], a[124:127], a[92:95], v[156:159]
  s_waitcnt lgkmcnt(0)
  v_mfma_f32_16x16x32_bf16 v[96:99], a[96:99], a[64:67], v[96:99]
  s_add_u32 s64, s64, s66
  ds_read_b128 a[80:83], v16 offset:8192
  ds_read_b64_tr_b16 a[112:113], v17 offset:20480
  v_mfma_f32_16x16x32_bf16 v[112:115], a[96:99], a[68:71], v[112:115]
  s_add_u32 s65, s65, 1
  s_cmp_eq_u32 s65, 5
  s_cselect_b32 s65, 0, s65
  s_cselect_b32 s66, s67, s68
  ds_read_b64_tr_b16 a[114:115], v17 offset:22528
  v_mfma_f32_16x16x32_bf16 v[128:131], a[96:99], a[72:75], v[128:131]
  ds_read_b128 a[84:87], v16 offset:9216
  v_mfma_f32_16x16x32_bf16 v[144:147], a[96:99], a[76:79], v[144:147]
  ds_read_b128 a[88:91], v16 offset:10240
  v_mfma_f32_16x16x32_bf16 v[100:103], a[100:103], a[64:67], v[100:103]
  ds_read_b128 a[92:95], v16 offset:11264
  v_mfma_f32_16x16x32_bf16 v[116:119], a[100:103], a[68:71], v[116:119]
  ds_read_b64_tr_b16 a[116:117], v18 offset:20480
  v_mfma_f32_16x16x32_bf16 v[132:135], a[100:103], a[72:75], v[132:135]
  ds_read_b64_tr_b16 a[118:119], v18 offset:22528
  v_mfma_f32_16x16x32_bf16 v[148:151], a[100:103], a[76:79], v[148:151]
  ds_read_b64_tr_b16 a[120:121], v19 offset:20480
  v_mfma_f32_16x16x32_bf16 v[104:107], a[104:107], a[64:67], v[104:107]
  ds_read_b64_tr_b16 a[122:123], v19 offset:22528
  v_mfma_f32_16x16x32_bf16 v[120:123], a[104:107], a[68:71], v[120:123]
  ds_read_b64_tr_b16 a[124:125], v20 offset:20480
  v_mfma_f32_16x16x32_bf16 v[136:139], a[104:107], a[72:75], v[136:139]
  ds_read_b64_tr_b16 a[126:127], v20 offset:22528
  v_mfma_f32_16x16x32_bf16 v[152:155], a[104:107], a[76:79], v[152:155]
  v_add_u32 v16, s66, v16
  v_add_u32 v17, s66, v17
  v_mfma_f32_16x16x32_bf16 v[108:111], a[108:111], a[64:67], v[108:111]
  v_add_u32 v18, s66, v18
  v_add_u32 v19, s66, v19
  v_mfma_f32_16x16x32_bf16 v[124:127], a[108:111], a[68:71], v[124:127]
  v_add_u32 v20, s66, v20
  v_mfma_f32_16x16x32_bf16 v[140:143], a[108:111], a[72:75], v[140:143]
  v_mfma_f32_16x16x32_bf16 v[156:159], a[108:111], a[76:79], v[156:159]
  s_waitcnt vmcnt(17) lgkmcnt(0)
  s_barrier
  v_mfma_f32_16x16x32_bf16 v[96:99], a[112:115], a[80:83], v[96:99]
  ds_read_b128 a[64:67], v16 offset:0
  ds_read_b64_tr_b16 a[96:97], v17 offset:16384
  v_mfma_f32_16x16x32_bf16 v[112:115], a[112:115], a[84:87], v[112:115]
  ds_read_b64_tr_b16 a[98:99], v17 offset:18432
  v_mfma_f32_16x16x32_bf16 v[128:131], a[112:115], a[88:91], v[128:131]
  ds_read_b128 a[68:71], v16 offset:1024
  v_mfma_f32_16x16x32_bf16 v[144:147], a[112:115], a[92:95], v[144:147]
  ds_read_b128 a[72:75], v16 offset:2048
  v_mfma_f32_16x16x32_bf16 v[100:103], a[116:119], a[80:83], v[100:103]
  ds_read_b128 a[76:79], v16 offset:3072
  v_mfma_f32_16x16x32_bf16 v[116:119], a[116:119], a[84:87], v[116:119]
  ds_read_b64_tr_b16 a[100:101], v18 offset:16384
  v_mfma_f32_16x16x32_bf16 v[132:135], a[116:119], a[88:91], v[132:135]
  ds_read_b64_tr_b16 a[102:103], v18 offset:18432
  v_mfma_f32_16x16x32_bf16 v[148:151], a[116:119], a[92:95], v[148:151]
  ds_read_b64_tr_b16 a[104:105], v19 offset:16384
  v_mfma_f32_16x16x32_bf16 v[104:107], a[120:123], a[80:83], v[104:107]
  ds_read_b64_tr_b16 a[106:107], v19 offset:18432
  v_mfma_f32_16x16x32_bf16 v[120:123], a[120:123], a[84:87], v[120:123]
  ds_read_b64_tr_b16 a[108:109], v20 offset:16384
  v_mfma_f32_16x16x32_bf16 v[136:139], a[120:123], a[88:91], v[136:139]
  ds_read_b64_tr_b16 a[110:111], v20 offset:18432
  v_mfma_f32_16x16x32_bf16 v[152:155], a[120:123], a[92:95], v[152:155]
  v_mfma_f32_16x16x32_bf16 v[108:111], a[124:127], a[80:83], v[108:111]
  v_mfma_f32_16x16x32_bf16 v[124:127], a[124:127], a[84:87], v[124:127]
  v_mfma_f32_16x16x32_bf16 v[140:143], a[124:127], a[88:91], v[140:143]
  v_mfma_f32_16x16x32_bf16 v[156:159], a[124:127], a[92:95], v[156:159]
  s_waitcnt lgkmcnt(0)
  v_mfma_f32_16x16x32_bf16 v[96:99], a[96:99], a[64:67], v[96:99]
  s_add_u32 s64, s64, s66
  ds_read_b128 a[80:83], v16 offset:8192
  ds_read_b64_tr_b16 a[112:113], v17 offset:20480
  v_mfma_f32_16x16x32_bf16 v[112:115], a[96:99], a[68:71], v[112:115]
  s_add_u32 s65, s65, 1
  s_cmp_eq_u32 s65, 5
  s_cselect_b32 s65, 0, s65
  s_cselect_b32 s66, s67, s68
  ds_read_b64_tr_b16 a[114:115], v17 offset:22528
  v_mfma_f32_16x16x32_bf16 v[128:131], a[96:99], a[72:75], v[128:131]
  ds_read_b128 a[84:87], v16 offset:9216
  v_mfma_f32_16x16x32_bf16 v[144:147], a[96:99], a[76:79], v[144:147]
  ds_read_b128 a[88:91], v16 offset:10240
  v_mfma_f32_16x16x32_bf16 v[100:103], a[100:103], a[64:67], v[100:103]
  ds_read_b128 a[92:95], v16 offset:11264
  v_mfma_f32_16x16x32_bf16 v[116:119], a[100:103], a[68:71], v[116:119]
  ds_read_b64_tr_b16 a[116:117], v18 offset:20480
  v_mfma_f32_16x16x32_bf16 v[132:135], a[100:103], a[72:75], v[132:135]
  ds_read_b64_tr_b16 a[118:119], v18 offset:22528
  v_mfma_f32_16x16x32_bf16 v[148:151], a[100:103], a[76:79], v[148:151]
  ds_read_b64_tr_b16 a[120:121], v19 offset:20480
  v_mfma_f32_16x16x32_bf16 v[104:107], a[104:107], a[64:67], v[104:107]
  ds_read_b64_tr_b16 a[122:123], v19 offset:22528
  v_mfma_f32_16x16x32_bf16 v[120:123], a[104:107], a[68:71], v[120:123]
  ds_read_b64_tr_b16 a[124:125], v20 offset:20480
  v_mfma_f32_16x16x32_bf16 v[136:139], a[104:107], a[72:75], v[136:139]
  ds_read_b64_tr_b16 a[126:127], v20 offset:22528
  v_mfma_f32_16x16x32_bf16 v[152:155], a[104:107], a[76:79], v[152:155]
  v_add_u32 v16, s66, v16
  v_add_u32 v17, s66, v17
  v_mfma_f32_16x16x32_bf16 v[108:111], a[108:111], a[64:67], v[108:111]
  v_add_u32 v18, s66, v18
  v_add_u32 v19, s66, v19
  v_mfma_f32_16x16x32_bf16 v[124:127], a[108:111], a[68:71], v[124:127]
  v_add_u32 v20, s66, v20
  v_mfma_f32_16x16x32_bf16 v[140:143], a[108:111], a[72:75], v[140:143]
  v_mfma_f32_16x16x32_bf16 v[156:159], a[108:111], a[76:79], v[156:159]
  s_waitcnt vmcnt(9) lgkmcnt(0)
  s_barrier
  v_mfma_f32_16x16x32_bf16 v[96:99], a[112:115], a[80:83], v[96:99]
  buffer_load_dwordx2 v[6:7], off, s[96:99], s90 sc1
  ds_read_b128 a[64:67], v16 offset:0
  v_mfma_f32_16x16x32_bf16 v[112:115], a[112:115], a[84:87], v[112:115]
  ds_read_b64_tr_b16 a[96:97], v17 offset:16384
  ds_read_b64_tr_b16 a[98:99], v17 offset:18432
  v_mfma_f32_16x16x32_bf16 v[128:131], a[112:115], a[88:91], v[128:131]
  ds_read_b128 a[68:71], v16 offset:1024
  v_mfma_f32_16x16x32_bf16 v[144:147], a[112:115], a[92:95], v[144:147]
  ds_read_b128 a[72:75], v16 offset:2048
  v_mfma_f32_16x16x32_bf16 v[100:103], a[116:119], a[80:83], v[100:103]
  ds_read_b128 a[76:79], v16 offset:3072
  v_mfma_f32_16x16x32_bf16 v[116:119], a[116:119], a[84:87], v[116:119]
  ds_read_b64_tr_b16 a[100:101], v18 offset:16384
  v_mfma_f32_16x16x32_bf16 v[132:135], a[116:119], a[88:91], v[132:135]
  ds_read_b64_tr_b16 a[102:103], v18 offset:18432
  v_mfma_f32_16x16x32_bf16 v[148:151], a[116:119], a[92:95], v[148:151]
  ds_read_b64_tr_b16 a[104:105], v19 offset:16384
  v_mfma_f32_16x16x32_bf16 v[104:107], a[120:123], a[80:83], v[104:107]
  ds_read_b64_tr_b16 a[106:107], v19 offset:18432
  v_mfma_f32_16x16x32_bf16 v[120:123], a[120:123], a[84:87], v[120:123]
  ds_read_b64_tr_b16 a[108:109], v20 offset:16384
  v_mfma_f32_16x16x32_bf16 v[136:139], a[120:123], a[88:91], v[136:139]
  ds_read_b64_tr_b16 a[110:111], v20 offset:18432
  v_mfma_f32_16x16x32_bf16 v[152:155], a[120:123], a[92:95], v[152:155]
  v_mfma_f32_16x16x32_bf16 v[108:111], a[124:127], a[80:83], v[108:111]
  v_mfma_f32_16x16x32_bf16 v[124:127], a[124:127], a[84:87], v[124:127]
  v_mfma_f32_16x16x32_bf16 v[140:143], a[124:127], a[88:91], v[140:143]
  v_mfma_f32_16x16x32_bf16 v[156:159], a[124:127], a[92:95], v[156:159]
  s_waitcnt lgkmcnt(0)
  v_mfma_f32_16x16x32_bf16 v[96:99], a[96:99], a[64:67], v[96:99]
  s_add_u32 s64, s64, s66
  ds_read_b128 a[80:83], v16 offset:8192
  ds_read_b64_tr_b16 a[112:113], v17 offset:20480
  v_mfma_f32_16x16x32_bf16 v[112:115], a[96:99], a[68:71], v[112:115]
  s_add_u32 s65, s65, 1
  s_cmp_eq_u32 s65, 5
  s_cselect_b32 s65, 0, s65
  s_cselect_b32 s66, s67, s68
  ds_read_b64_tr_b16 a[114:115], v17 offset:22528
  v_mfma_f32_16x16x32_bf16 v[128:131], a[96:99], a[72:75], v[128:131]
  ds_read_b128 a[84:87], v16 offset:9216
  v_mfma_f32_16x16x32_bf16 v[144:147], a[96:99], a[76:79], v[144:147]
  ds_read_b128 a[88:91], v16 offset:10240
  v_mfma_f32_16x16x32_bf16 v[100:103], a[100:103], a[64:67], v[100:103]
  ds_read_b128 a[92:95], v16 offset:11264
  v_mfma_f32_16x16x32_bf16 v[116:119], a[100:103], a[68:71], v[116:119]
  ds_read_b64_tr_b16 a[116:117], v18 offset:20480
  v_mfma_f32_16x16x32_bf16 v[132:135], a[100:103], a[72:75], v[132:135]
  ds_read_b64_tr_b16 a[118:119], v18 offset:22528
  v_mfma_f32_16x16x32_bf16 v[148:151], a[100:103], a[76:79], v[148:151]
  ds_read_b64_tr_b16 a[120:121], v19 offset:20480
  v_mfma_f32_16x16x32_bf16 v[104:107], a[104:107], a[64:67], v[104:107]
  ds_read_b64_tr_b16 a[122:123], v19 offset:22528
  v_mfma_f32_16x16x32_bf16 v[120:123], a[104:107], a[68:71], v[120:123]
  ds_read_b64_tr_b16 a[124:125], v20 offset:20480
  v_mfma_f32_16x16x32_bf16 v[136:139], a[104:107], a[72:75], v[136:139]
  ds_read_b64_tr_b16 a[126:127], v20 offset:22528
  v_mfma_f32_16x16x32_bf16 v[152:155], a[104:107], a[76:79], v[152:155]
  v_add_u32 v16, s66, v16
  v_add_u32 v17, s66, v17
  v_mfma_f32_16x16x32_bf16 v[108:111], a[108:111], a[64:67], v[108:111]
  v_add_u32 v18, s66, v18
  v_add_u32 v19, s66, v19
  v_mfma_f32_16x16x32_bf16 v[124:127], a[108:111], a[68:71], v[124:127]
  v_add_u32 v20, s66, v20
  v_mfma_f32_16x16x32_bf16 v[140:143], a[108:111], a[72:75], v[140:143]
  v_mfma_f32_16x16x32_bf16 v[156:159], a[108:111], a[76:79], v[156:159]
  s_waitcnt vmcnt(0) lgkmcnt(0)
  s_barrier
  s_mov_b32 s5, 0x40000
Lpoll_22:
  v_cmp_ne_u64 vcc, s[94:95], v[6:7]
  s_nop 0
  s_cbranch_vccz Lpolld_23
  s_sleep 4
  buffer_load_dwordx2 v[6:7], off, s[96:99], s90 sc1
  s_sub_u32 s5, s5, 1
  s_waitcnt vmcnt(0)
  s_cbranch_scc0 Lpoll_22
Lpolld_23:
  v_mfma_f32_16x16x32_bf16 v[96:99], a[112:115], a[80:83], v[96:99]
  s_lshl_b32 s6, s78, 1
  s_add_u32 s6, s6, s77
  s_lshl_b32 s6, s6, 2
  v_mfma_f32_16x16x32_bf16 v[112:115], a[112:115], a[84:87], v[112:115]
  s_add_u32 s6, s6, s3
  s_lshl_b32 s6, s6, 13
  s_add_u32 s6, s6, 8388608
  v_mfma_f32_16x16x32_bf16 v[128:131], a[112:115], a[88:91], v[128:131]
  s_add_u32 s7, s6, 4096
  buffer_load_dwordx4 v[160:163], v2, s[16:19], s6 offen offset:0 sc1
  ds_read_b128 a[64:67], v16 offset:0
  v_mfma_f32_16x16x32_bf16 v[144:147], a[112:115], a[92:95], v[144:147]
  buffer_load_dwordx4 v[164:167], v2, s[16:19], s6 offen offset:1024 sc1
  ds_read_b64_tr_b16 a[96:97], v17 offset:16384
  v_mfma_f32_16x16x32_bf16 v[100:103], a[116:119], a[80:83], v[100:103]
  ds_read_b64_tr_b16 a[98:99], v17 offset:18432
  ds_read_b128 a[68:71], v16 offset:1024
  v_mfma_f32_16x16x32_bf16 v[116:119], a[116:119], a[84:87], v[116:119]
  ds_read_b128 a[72:75], v16 offset:2048
  ds_read_b128 a[76:79], v16 offset:3072
  v_mfma_f32_16x16x32_bf16 v[132:135], a[116:119], a[88:91], v[132:135]
  ds_read_b64_tr_b16 a[100:101], v18 offset:16384
  ds_read_b64_tr_b16 a[102:103], v18 offset:18432
  v_mfma_f32_16x16x32_bf16 v[148:151], a[116:119], a[92:95], v[148:151]
  buffer_load_dwordx4 v[168:171], v2, s[16:19], s6 offen offset:2048 sc1
  ds_read_b64_tr_b16 a[104:105], v19 offset:16384
  v_mfma_f32_16x16x32_bf16 v[104:107], a[120:123], a[80:83], v[104:107]
  ds_read_b64_tr_b16 a[106:107], v19 offset:18432
  v_mfma_f32_16x16x32_bf16 v[120:123], a[120:123], a[84:87], v[120:123]
  ds_read_b64_tr_b16 a[108:109], v20 offset:16384
  v_mfma_f32_16x16x32_bf16 v[136:139], a[120:123], a[88:91], v[136:139]
  ds_read_b64_tr_b16 a[110:111], v20 offset:18432
  v_mfma_f32_16x16x32_bf16 v[152:155], a[120:123], a[92:95], v[152:155]
  buffer_load_dwordx4 v[172:175], v2, s[16:19], s6 offen offset:3072 sc1
  v_mfma_f32_16x16x32_bf16 v[108:111], a[124:127], a[80:83], v[108:111]
  v_mfma_f32_16x16x32_bf16 v[124:127], a[124:127], a[84:87], v[124:127]
  v_mfma_f32_16x16x32_bf16 v[140:143], a[124:127], a[88:91], v[140:143]
  v_mfma_f32_16x16x32_bf16 v[156:159], a[124:127], a[92:95], v[156:159]
  s_waitcnt lgkmcnt(0)
  v_mfma_f32_16x16x32_bf16 v[96:99], a[96:99], a[64:67], v[96:99]
  buffer_load_dwordx4 v[176:179], v2, s[16:19], s7 offen offset:0 sc1
  ds_read_b128 a[80:83], v16 offset:8192
  v_mfma_f32_16x16x32_bf16 v[112:115], a[96:99], a[68:71], v[112:115]
  ds_read_b64_tr_b16 a[112:113], v17 offset:20480
  ds_read_b64_tr_b16 a[114:115], v17 offset:22528
  v_mfma_f32_16x16x32_bf16 v[128:131], a[96:99], a[72:75], v[128:131]
  ds_read_b128 a[84:87], v16 offset:9216
  v_mfma_f32_16x16x32_bf16 v[144:147], a[96:99], a[76:79], v[144:147]
  buffer_load_dwordx4 v[180:183], v2, s[16:19], s7 offen offset:1024 sc1
  ds_read_b128 a[88:91], v16 offset:10240
  v_mfma_f32_16x16x32_bf16 v[100:103], a[100:103], a[64:67], v[100:103]
  ds_read_b128 a[92:95], v16 offset:11264
  v_mfma_f32_16x16x32_bf16 v[116:119], a[100:103], a[68:71], v[116:119]
  ds_read_b64_tr_b16 a[116:117], v18 offset:20480
  v_mfma_f32_16x16x32_bf16 v[132:135], a[100:103], a[72:75], v[132:135]
  ds_read_b64_tr_b16 a[118:119], v18 offset:22528
  v_mfma_f32_16x16x32_bf16 v[148:151], a[100:103], a[76:79], v[148:151]
  buffer_load_dwordx4 v[184:187], v2, s[16:19], s7 offen offset:2048 sc1
  ds_read_b64_tr_b16 a[120:121], v19 offset:20480
  v_mfma_f32_16x16x32_bf16 v[104:107], a[104:107], a[64:67], v[104:107]
  ds_read_b64_tr_b16 a[122:123], v19 offset:22528
  v_mfma_f32_16x16x32_bf16 v[120:123], a[104:107], a[68:71], v[120:123]
  ds_read_b64_tr_b16 a[124:125], v20 offset:20480
  v_mfma_f32_16x16x32_bf16 v[136:139], a[104:107], a[72:75], v[136:139]
  ds_read_b64_tr_b16 a[126:127], v20 offset:22528
  v_mfma_f32_16x16x32_bf16 v[152:155], a[104:107], a[76:79], v[152:155]
  buffer_load_dwordx4 v[188:191], v2, s[16:19], s7 offen offset:3072 sc1
  v_mfma_f32_16x16x32_bf16 v[108:111], a[108:111], a[64:67], v[108:111]
  v_mfma_f32_16x16x32_bf16 v[124:127], a[108:111], a[68:71], v[124:127]
  v_mfma_f32_16x16x32_bf16 v[140:143], a[108:111], a[72:75], v[140:143]
  v_mfma_f32_16x16x32_bf16 v[156:159], a[108:111], a[76:79], v[156:159]
  s_waitcnt lgkmcnt(0)
  v_mfma_f32_16x16x32_bf16 v[96:99], a[112:115], a[80:83], v[96:99]
  v_mfma_f32_16x16x32_bf16 v[112:115], a[112:115], a[84:87], v[112:115]
  v_mfma_f32_16x16x32_bf16 v[128:131], a[112:115], a[88:91], v[128:131]
  v_mfma_f32_16x16x32_bf16 v[144:147], a[112:115], a[92:95], v[144:147]
  v_mfma_f32_16x16x32_bf16 v[100:103], a[116:119], a[80:83], v[100:103]
  v_mfma_f32_16x16x32_bf16 v[116:119], a[116:119], a[84:87], v[116:119]
  v_mfma_f32_16x16x32_bf16 v[132:135], a[116:119], a[88:91], v[132:135]
  v_mfma_f32_16x16x32_bf16 v[148:151], a[116:119], a[92:95], v[148:151]
  v_mfma_f32_16x16x32_bf16 v[104:107], a[120:123], a[80:83], v[104:107]
  v_mfma_f32_16x16x32_bf16 v[120:123], a[120:123], a[84:87], v[120:123]
  v_mfma_f32_16x16x32_bf16 v[136:139], a[120:123], a[88:91], v[136:139]
  v_mfma_f32_16x16x32_bf16 v[152:155], a[120:123], a[92:95], v[152:155]
  v_mfma_f32_16x16x32_bf16 v[108:111], a[124:127], a[80:83], v[108:111]
  v_mfma_f32_16x16x32_bf16 v[124:127], a[124:127], a[84:87], v[124:127]
  v_mfma_f32_16x16x32_bf16 v[140:143], a[124:127], a[88:91], v[140:143]
  v_mfma_f32_16x16x32_bf16 v[156:159], a[124:127], a[92:95], v[156:159]
  s_lshl_b32 s6, s78, 1
  s_add_u32 s6, s6, s77
  s_xor_b32 s6, s6, 1
  s_lshl_b32 s6, s6, 2
  s_add_u32 s6, s6, s3
  s_lshl_b32 s6, s6, 13
  s_add_u32 s7, s6, 4096
  s_cmp_eq_u32 s77, 0
  s_cbranch_scc1 Lsend_24_0
  buffer_store_dwordx4 v[96:99], v2, s[16:19], s6 offen offset:0 sc1
  buffer_store_dwordx4 v[100:103], v2, s[16:19], s6 offen offset:1024 sc1
  buffer_store_dwordx4 v[104:107], v2, s[16:19], s6 offen offset:2048 sc1
  buffer_store_dwordx4 v[108:111], v2, s[16:19], s6 offen offset:3072 sc1
  buffer_store_dwordx4 v[112:115], v2, s[16:19], s7 offen offset:0 sc1
  buffer_store_dwordx4 v[116:119], v2, s[16:19], s7 offen offset:1024 sc1
  buffer_store_dwordx4 v[120:123], v2, s[16:19], s7 offen offset:2048 sc1
  buffer_store_dwordx4 v[124:127], v2, s[16:19], s7 offen offset:3072 sc1
  s_branch Lsend_24_e
Lsend_24_0:
  buffer_store_dwordx4 v[128:131], v2, s[16:19], s6 offen offset:0 sc1
  buffer_store_dwordx4 v[132:135], v2, s[16:19], s6 offen offset:1024 sc1
  buffer_store_dwordx4 v[136:139], v2, s[16:19], s6 offen offset:2048 sc1
  buffer_store_dwordx4 v[140:143], v2, s[16:19], s6 offen offset:3072 sc1
  buffer_store_dwordx4 v[144:147], v2, s[16:19], s7 offen offset:0 sc1
  buffer_store_dwordx4 v[148:151], v2, s[16:19], s7 offen offset:1024 sc1
  buffer_store_dwordx4 v[152:155], v2, s[16:19], s7 offen offset:2048 sc1
  buffer_store_dwordx4 v[156:159], v2, s[16:19], s7 offen offset:3072 sc1
Lsend_24_e:
  s_mov_b32 s20, s82
  s_mov_b32 s21, s83
  s_mov_b32 s22, 8388608
  s_mov_b32 s23, 0x00020000
  v_bfe_u32 v25, v1, 4, 1
  v_lshrrev_b32 v26, 5, v1
  v_lshl_or_b32 v25, v25, 1, v26
  v_lshlrev_b32 v25, 4, v25
  v_and_b32 v24, 15, v1
  v_lshl_add_u32 v26, v24, 14, v25
  v_lshl_add_u32 v27, v24, 12, v25
  s_waitcnt vmcnt(8)
  s_lshl_b32 s4, s73, 19
  s_lshl_b32 s5, s76, 8
  s_add_u32 s4, s4, s5
  s_and_b32 s5, s3, 1
  s_lshl_b32 s5, s5, 7
  s_add_u32 s4, s4, s5
  s_lshr_b32 s5, s3, 1
  s_lshl_b32 s5, s5, 1
  s_add_u32 s5, s5, s77
  s_lshl_b32 s5, s5, 17
  s_add_u32 s4, s4, s5
  s_add_u32 s4, s4, 2048
  s_add_u32 s5, s4, 65536
  s_cmp_eq_u32 s77, 0
  s_cbranch_scc1 Lfin_25_0
  v_pk_add_f32 v[160:161], v[160:161], v[64:65]
  v_pk_add_f32 v[162:163], v[162:163], v[66:67]
  v_pk_add_f32 v[164:165], v[164:165], v[68:69]
  v_pk_add_f32 v[166:167], v[166:167], v[70:71]
  v_pk_add_f32 v[168:169], v[168:169], v[72:73]
  v_pk_add_f32 v[170:171], v[170:171], v[74:75]
  v_pk_add_f32 v[172:173], v[172:173], v[76:77]
  v_pk_add_f32 v[174:175], v[174:175], v[78:79]
  v_pk_add_f32 v[176:177], v[176:177], v[80:81]
  v_pk_add_f32 v[178:179], v[178:179], v[82:83]
  v_pk_add_f32 v[180:181], v[180:181], v[84:85]
  v_pk_add_f32 v[182:183], v[182:183], v[86:87]
  v_pk_add_f32 v[184:185], v[184:185], v[88:89]
  v_pk_add_f32 v[186:187], v[186:187], v[90:91]
  v_pk_add_f32 v[188:189], v[188:189], v[92:93]
  v_pk_add_f32 v[190:191], v[190:191], v[94:95]
  s_branch Lfin_25_e
Lfin_25_0:
  v_pk_add_f32 v[160:161], v[160:161], v[32:33]
  v_pk_add_f32 v[162:163], v[162:163], v[34:35]
  v_pk_add_f32 v[164:165], v[164:165], v[36:37]
  v_pk_add_f32 v[166:167], v[166:167], v[38:39]
  v_pk_add_f32 v[168:169], v[168:169], v[40:41]
  v_pk_add_f32 v[170:171], v[170:171], v[42:43]
  v_pk_add_f32 v[172:173], v[172:173], v[44:45]
  v_pk_add_f32 v[174:175], v[174:175], v[46:47]
  v_pk_add_f32 v[176:177], v[176:177], v[48:49]
  v_pk_add_f32 v[178:179], v[178:179], v[50:51]
  v_pk_add_f32 v[180:181], v[180:181], v[52:53]
  v_pk_add_f32 v[182:183], v[182:183], v[54:55]
  v_pk_add_f32 v[184:185], v[184:185], v[56:57]
  v_pk_add_f32 v[186:187], v[186:187], v[58:59]
  v_pk_add_f32 v[188:189], v[188:189], v[60:61]
  v_pk_add_f32 v[190:191], v[190:191], v[62:63]
Lfin_25_e:
  v_cvt_pk_bf16_f32 v160, v160, v161
  v_cvt_pk_bf16_f32 v161, v162, v163
  v_cvt_pk_bf16_f32 v162, v164, v165
  v_cvt_pk_bf16_f32 v163, v166, v167
  v_cvt_pk_bf16_f32 v168, v168, v169
  v_cvt_pk_bf16_f32 v169, v170, v171
  v_cvt_pk_bf16_f32 v170, v172, v173
  v_cvt_pk_bf16_f32 v171, v174, v175
  v_cvt_pk_bf16_f32 v176, v176, v177
  v_cvt_pk_bf16_f32 v177, v178, v179
  v_cvt_pk_bf16_f32 v178, v180, v181
  v_cvt_pk_bf16_f32 v179, v182, v183
  v_cvt_pk_bf16_f32 v184, v184, v185
  v_cvt_pk_bf16_f32 v185, v186, v187
  v_cvt_pk_bf16_f32 v186, v188, v189
  v_cvt_pk_bf16_f32 v187, v190, v191
  v_permlane16_swap_b32 v160, v162
  v_permlane16_swap_b32 v161, v163
  buffer_store_dwordx4 v[160:163], v27, s[20:23], s4 offen offset:0
  v_permlane16_swap_b32 v168, v170
  v_permlane16_swap_b32 v169, v171
  buffer_store_dwordx4 v[168:171], v27, s[20:23], s4 offen offset:64
  v_permlane16_swap_b32 v176, v178
  v_permlane16_swap_b32 v177, v179
  buffer_store_dwordx4 v[176:179], v27, s[20:23], s5 offen offset:0
  v_permlane16_swap_b32 v184, v186
  v_permlane16_swap_b32 v185, v187
  buffer_store_dwordx4 v[184:187], v27, s[20:23], s5 offen offset:64
  s_lshl_b32 s6, s78, 1
  s_add_u32 s6, s6, s77
  s_lshl_b32 s6, s6, 7
  s_add_u32 s6, s6, 131072
  s_lshl_b32 s90, s78, 1
  s_add_u32 s90, s90, s77
  s_xor_b32 s90, s90, 1
  s_lshl_b32 s90, s90, 7
  s_add_u32 s90, s90, 131072
  s_waitcnt vmcnt(4)
  s_barrier
  v_mov_b32 v8, 0x40000000
  v_mov_b32 v6, s94
  v_cmp_eq_u32 vcc, 0, v0
  v_mov_b32 v7, s95
  s_nop 0
  v_cndmask_b32_e64 v8, v8, 0, vcc
  buffer_store_dwordx2 v[6:7], v8, s[96:99], s6 offen sc1
  buffer_load_dwordx2 v[4:5], off, s[96:99], s90 sc1
  s_waitcnt vmcnt(0)
  s_mov_b32 s5, 0x40000
Lpoll_26:
  v_cmp_ne_u64 vcc, s[94:95], v[4:5]
  s_nop 0
  s_cbranch_vccz Lpolld_27
  s_sleep 4
  buffer_load_dwordx2 v[4:5], off, s[96:99], s90 sc1
  s_sub_u32 s5, s5, 1
  s_waitcnt vmcnt(0)
  s_cbranch_scc0 Lpoll_26
Lpolld_27:
  s_lshl_b32 s6, s78, 1
  s_add_u32 s6, s6, s77
  s_lshl_b32 s6, s6, 2
  s_add_u32 s6, s6, s3
  s_lshl_b32 s6, s6, 13
  s_add_u32 s7, s6, 4096
  buffer_load_dwordx4 v[160:163], v2, s[16:19], s6 offen offset:0 sc1
  buffer_load_dwordx4 v[164:167], v2, s[16:19], s6 offen offset:1024 sc1
  buffer_load_dwordx4 v[168:171], v2, s[16:19], s6 offen offset:2048 sc1
  buffer_load_dwordx4 v[172:175], v2, s[16:19], s6 offen offset:3072 sc1
  buffer_load_dwordx4 v[176:179], v2, s[16:19], s7 offen offset:0 sc1
  buffer_load_dwordx4 v[180:183], v2, s[16:19], s7 offen offset:1024 sc1
  buffer_load_dwordx4 v[184:187], v2, s[16:19], s7 offen offset:2048 sc1
  buffer_load_dwordx4 v[188:191], v2, s[16:19], s7 offen offset:3072 sc1
  s_waitcnt vmcnt(0)
  s_lshl_b32 s4, s73, 19
  s_lshl_b32 s5, s76, 8
  s_add_u32 s4, s4, s5
  s_and_b32 s5, s3, 1
  s_lshl_b32 s5, s5, 7
  s_add_u32 s4, s4, s5
  s_lshr_b32 s5, s3, 1
  s_lshl_b32 s5, s5, 1
  s_add_u32 s5, s5, s77
  s_lshl_b32 s5, s5, 12
  s_add_u32 s4, s4, s5
  s_add_u32 s5, s4, 262144
  s_cmp_eq_u32 s77, 0
  s_cbranch_scc1 Lfin_28_0
  v_pk_add_f32 v[160:161], v[160:161], v[128:129]
  v_pk_add_f32 v[162:163], v[162:163], v[130:131]
  v_pk_add_f32 v[164:165], v[164:165], v[132:133]
  v_pk_add_f32 v[166:167], v[166:167], v[134:135]
  v_pk_add_f32 v[168:169], v[168:169], v[136:137]
  v_pk_add_f32 v[170:171], v[170:171], v[138:139]
  v_pk_add_f32 v[172:173], v[172:173], v[140:141]
  v_pk_add_f32 v[174:175], v[174:175], v[142:143]
  v_pk_add_f32 v[176:177], v[176:177], v[144:145]
  v_pk_add_f32 v[178:179], v[178:179], v[146:147]
  v_pk_add_f32 v[180:181], v[180:181], v[148:149]
  v_pk_add_f32 v[182:183], v[182:183], v[150:151]
  v_pk_add_f32 v[184:185], v[184:185], v[152:153]
  v_pk_add_f32 v[186:187], v[186:187], v[154:155]
  v_pk_add_f32 v[188:189], v[188:189], v[156:157]
  v_pk_add_f32 v[190:191], v[190:191], v[158:159]
  s_branch Lfin_28_e
Lfin_28_0:
  v_pk_add_f32 v[160:161], v[160:161], v[96:97]
  v_pk_add_f32 v[162:163], v[162:163], v[98:99]
  v_pk_add_f32 v[164:165], v[164:165], v[100:101]
  v_pk_add_f32 v[166:167], v[166:167], v[102:103]
  v_pk_add_f32 v[168:169], v[168:169], v[104:105]
  v_pk_add_f32 v[170:171], v[170:171], v[106:107]
  v_pk_add_f32 v[172:173], v[172:173], v[108:109]
  v_pk_add_f32 v[174:175], v[174:175], v[110:111]
  v_pk_add_f32 v[176:177], v[176:177], v[112:113]
  v_pk_add_f32 v[178:179], v[178:179], v[114:115]
  v_pk_add_f32 v[180:181], v[180:181], v[116:117]
  v_pk_add_f32 v[182:183], v[182:183], v[118:119]
  v_pk_add_f32 v[184:185], v[184:185], v[120:121]
  v_pk_add_f32 v[186:187], v[186:187], v[122:123]
  v_pk_add_f32 v[188:189], v[188:189], v[124:125]
  v_pk_add_f32 v[190:191], v[190:191], v[126:127]
Lfin_28_e:
  v_cvt_pk_bf16_f32 v160, v160, v161
  v_cvt_pk_bf16_f32 v161, v162, v163
  v_cvt_pk_bf16_f32 v162, v164, v165
  v_cvt_pk_bf16_f32 v163, v166, v167
  v_cvt_pk_bf16_f32 v168, v168, v169
  v_cvt_pk_bf16_f32 v169, v170, v171
  v_cvt_pk_bf16_f32 v170, v172, v173
  v_cvt_pk_bf16_f32 v171, v174, v175
  v_cvt_pk_bf16_f32 v176, v176, v177
  v_cvt_pk_bf16_f32 v177, v178, v179
  v_cvt_pk_bf16_f32 v178, v180, v181
  v_cvt_pk_bf16_f32 v179, v182, v183
  v_cvt_pk_bf16_f32 v184, v184, v185
  v_cvt_pk_bf16_f32 v185, v186, v187
  v_cvt_pk_bf16_f32 v186, v188, v189
  v_cvt_pk_bf16_f32 v187, v190, v191
  v_permlane16_swap_b32 v160, v162
  v_permlane16_swap_b32 v161, v163
  buffer_store_dwordx4 v[160:163], v26, s[20:23], s4 offen offset:0
  v_permlane16_swap_b32 v168, v170
  v_permlane16_swap_b32 v169, v171
  buffer_store_dwordx4 v[168:171], v26, s[20:23], s4 offen offset:64
  v_permlane16_swap_b32 v176, v178
  v_permlane16_swap_b32 v177, v179
  buffer_store_dwordx4 v[176:179], v26, s[20:23], s5 offen offset:0
  v_permlane16_swap_b32 v184, v186
  v_permlane16_swap_b32 v185, v187
  buffer_store_dwordx4 v[184:187], v26, s[20:23], s5 offen offset:64
Lend:
  s_endpgm
.section .rodata,"a"
.p2align 6
.amdhsa_kernel concat_heads__compressed_kv_cla__sliding_local_dilated__prompt_kernel
  .amdhsa_next_free_vgpr 512
  .amdhsa_next_free_sgpr 102
  .amdhsa_accum_offset 256
  .amdhsa_group_segment_fixed_size 0
  .amdhsa_kernarg_size 96
  .amdhsa_user_sgpr_count 2
  .amdhsa_user_sgpr_kernarg_segment_ptr 1
  .amdhsa_system_sgpr_workgroup_id_x 1
.end_amdhsa_kernel
```

```asm
; @launch grid=(256,1,1) block=(256,1,1) lds=163840
.amdgcn_target "amdgcn-amd-amdhsa--gfx950"
.text
.globl concat_heads__compressed_kv_cla__sliding_local_dilated__prompt_kernel
.p2align 8
.type concat_heads__compressed_kv_cla__sliding_local_dilated__prompt_kernel,@function
concat_heads__compressed_kv_cla__sliding_local_dilated__prompt_kernel:
  s_cmp_ge_u32 s2, 256
  s_cbranch_scc1 Lend
  s_load_dwordx16 s[64:79], s[0:1], 0
  s_load_dwordx8 s[80:87], s[0:1], 64
  v_lshrrev_b32 v2, 6, v0
  v_and_b32 v1, 63, v0
  v_readfirstlane_b32 s3, v2
  v_lshlrev_b32 v2, 4, v1
  s_and_b32 s4, s2, 1
  s_lshl_b32 s4, s4, 2
  s_bfe_u32 s5, s2, 0x20003
  s_add_u32 s61, s4, s5
  s_bfe_u32 s4, s2, 0x20001
  s_lshl_b32 s4, s4, 2
  s_bfe_u32 s5, s2, 0x20005
  s_add_u32 s62, s4, s5
  s_lshl_b32 s4, s3, 13
  s_add_u32 s36, s4, 65536
  s_add_u32 s41, s4, 98304
  v_lshrrev_b32 v32, 3, v1
  v_and_b32 v33, 6, v32
  v_and_b32 v34, 7, v1
  v_xor_b32 v33, v33, v34
  v_lshlrev_b32 v33, 4, v33
  s_lshl_b32 s4, s61, 2
  s_add_u32 s4, s4, s3
  s_lshl_b32 s4, s4, 6
  v_add_u32 v34, s4, v32
  v_lshl_add_u32 v34, v34, 10, v33
  v_add_u32 v48, 0, v34
  v_add_u32 v49, 7168, v34
  v_add_u32 v50, 14336, v34
  v_add_u32 v51, 21504, v34
  v_add_u32 v52, 32768, v34
  v_add_u32 v53, 39936, v34
  v_add_u32 v54, 47104, v34
  v_add_u32 v55, 54272, v34
  v_lshrrev_b32 v34, 2, v32
  v_and_b32 v35, 3, v32
  v_lshl_add_u32 v34, v34, 3, v35
  s_lshl_b32 s4, s62, 2
  s_add_u32 s4, s4, s3
  s_lshl_b32 s4, s4, 7
  v_lshl_add_u32 v34, v34, 13, v33
  v_add_u32 v34, s4, v34
  v_add_u32 v56, 0, v34
  v_add_u32 v57, 130048, v34
  v_add_u32 v58, 30720, v34
  v_add_u32 v59, 160768, v34
  v_add_u32 v60, 262144, v34
  v_add_u32 v61, 392192, v34
  v_add_u32 v62, 292864, v34
  v_add_u32 v63, 422912, v34
  s_and_b32 s6, s2, 7
  s_lshl_b32 s46, s6, 7
  s_lshl_b32 s47, s6, 19
  s_waitcnt lgkmcnt(0)
  s_mov_b32 s8, s66
  s_mov_b32 s9, s67
  s_mov_b32 s10, 2097152
  s_mov_b32 s11, 0x00020000
  s_cmp_lt_u32 s2, 128
  s_cselect_b32 s12, s70, s72
  s_cselect_b32 s13, s71, s73
  s_mov_b32 s14, 4194304
  s_mov_b32 s15, 0x00020000
  s_add_u32 s96, s86, 125829120
  s_addc_u32 s97, s87, 0
  s_mov_b32 s98, 262144
  s_mov_b32 s99, 0x00020000
  s_or_b32 s4, s2, s3
  s_cbranch_scc1 Ltag_1
  s_mov_b32 s4, 196608
  buffer_load_dwordx2 v[22:23], off, s[96:99], s4 sc1
Ltag_1:
  s_mov_b32 m0, s36
  s_nop 0
  buffer_load_dwordx4 v48, s[8:11], s46 offen offset:0 lds
  buffer_load_dwordx4 v49, s[8:11], s46 offen offset:1024 lds
  buffer_load_dwordx4 v50, s[8:11], s46 offen offset:2048 lds
  buffer_load_dwordx4 v51, s[8:11], s46 offen offset:3072 lds
  s_add_u32 m0, s36, 4096
  s_nop 0
  buffer_load_dwordx4 v52, s[8:11], s46 offen offset:0 lds
  buffer_load_dwordx4 v53, s[8:11], s46 offen offset:1024 lds
  buffer_load_dwordx4 v54, s[8:11], s46 offen offset:2048 lds
  buffer_load_dwordx4 v55, s[8:11], s46 offen offset:3072 lds
  s_add_u32 s46, s46, 128
  s_and_b32 s46, s46, 1023
  s_mov_b32 m0, s41
  s_nop 0
  buffer_load_dwordx4 v56, s[12:15], s47 offen offset:0 lds
  buffer_load_dwordx4 v57, s[12:15], s47 offen offset:1024 lds
  buffer_load_dwordx4 v58, s[12:15], s47 offen offset:2048 lds
  buffer_load_dwordx4 v59, s[12:15], s47 offen offset:3072 lds
  s_add_u32 m0, s41, 4096
  s_nop 0
  buffer_load_dwordx4 v60, s[12:15], s47 offen offset:0 lds
  buffer_load_dwordx4 v61, s[12:15], s47 offen offset:1024 lds
  buffer_load_dwordx4 v62, s[12:15], s47 offen offset:2048 lds
  buffer_load_dwordx4 v63, s[12:15], s47 offen offset:3072 lds
  s_add_u32 s47, s47, 524288
  s_and_b32 s47, s47, 4194303
  s_lshr_b32 s4, s3, 1
  s_lshl_b32 s4, s4, 14
  s_add_u32 s4, s4, 65536
  v_and_b32 v32, 15, v1
  v_lshlrev_b32 v32, 7, v32
  v_lshrrev_b32 v33, 4, v1
  v_and_b32 v34, 6, v1
  v_xor_b32 v33, v33, v34
  v_lshl_add_u32 v32, v33, 4, v32
  v_add_u32 v16, s4, v32
  v_xor_b32 v17, 64, v16
  s_and_b32 s4, s3, 1
  s_lshl_b32 s4, s4, 14
  s_add_u32 s4, s4, 98304
  v_lshrrev_b32 v32, 2, v1
  v_and_b32 v33, 6, v32
  v_lshlrev_b32 v32, 7, v32
  v_and_b32 v34, 1, v1
  v_lshl_add_u32 v32, v34, 3, v32
  v_add_u32 v32, s4, v32
  v_bfe_u32 v34, v1, 1, 1
  v_xor_b32 v33, v33, v34
  v_xor_b32 v34, 0, v33
  v_lshl_add_u32 v18, v34, 4, v32
  v_xor_b32 v34, 2, v33
  v_lshl_add_u32 v19, v34, 4, v32
  v_xor_b32 v34, 4, v33
  v_lshl_add_u32 v20, v34, 4, v32
  v_xor_b32 v34, 6, v33
  v_lshl_add_u32 v21, v34, 4, v32
  s_cmp_lt_u32 s2, 154
  s_cselect_b32 s56, s78, s76
  s_cselect_b32 s57, s79, s77
  s_cselect_b32 s50, 0, 154
  s_mov_b32 s58, 4194304
  s_cselect_b32 s58, 6291456, s58
  s_mov_b32 s59, 0x00020000
  s_sub_u32 s50, s2, s50
  s_lshl_b32 s50, s50, 2
  s_add_u32 s50, s50, s3
  s_mul_i32 s50, s50, 10240
  s_cmp_lt_u32 s2, 171
  s_cselect_b32 s52, s68, s64
  s_cselect_b32 s53, s69, s65
  s_cselect_b32 s51, 0, 171
  s_mov_b32 s54, 4194304
  s_cselect_b32 s54, 8388608, s54
  s_mov_b32 s55, 0x00020000
  s_sub_u32 s51, s2, s51
  s_lshl_b32 s51, s51, 2
  s_add_u32 s51, s51, s3
  s_mul_i32 s51, s51, 12288
  s_and_b32 s24, s2, 7
  s_lshr_b32 s4, s2, 6
  s_lshl_b32 s4, s4, 3
  s_add_u32 s24, s24, s4
  s_lshr_b32 s25, s2, 3
  s_and_b32 s25, s25, 7
  s_and_b32 s4, s2, 1
  s_lshl_b32 s4, s4, 3
  s_bfe_u32 s5, s2, 0x30003
  s_add_u32 s32, s4, s5
  s_bfe_u32 s4, s2, 0x20001
  s_lshl_b32 s4, s4, 2
  s_lshr_b32 s5, s2, 6
  s_add_u32 s33, s4, s5
  s_mov_b32 s20, s78
  s_mov_b32 s21, s79
  s_mov_b32 s22, 6291456
  s_mov_b32 s23, 0x00020000
  s_and_b32 s4, s2, 7
  s_lshl_b32 s4, s4, 1
  s_add_u32 s5, s32, s33
  s_and_b32 s5, s5, 3
  s_mul_i32 s5, s5, 1
  s_add_u32 s4, s4, s5
  s_and_b32 s4, s4, 15
  s_lshl_b32 s30, s4, 7
  s_mul_i32 s4, s4, 393216
  s_lshl_b32 s31, s33, 7
  s_add_u32 s31, s31, s4
  s_lshl_b32 s88, s3, 12
  s_add_u32 s88, s88, 32768
  s_lshl_b32 s4, s3, 11
  s_add_u32 s26, s4, 18432
  s_add_u32 s27, s26, 3072
  s_mul_i32 s4, s3, 3072
  s_sub_u32 s28, 16384, s4
  v_lshrrev_b32 v32, 3, v1
  v_and_b32 v33, 6, v32
  v_and_b32 v34, 7, v1
  v_xor_b32 v33, v33, v34
  v_lshlrev_b32 v33, 4, v33
  s_lshl_b32 s4, s3, 5
  s_add_u32 s4, s4, 16
  v_add_u32 v34, s4, v32
  v_lshl_add_u32 v34, v34, 11, v33
  v_add_u32 v4, 0, v34
  v_add_u32 v5, 15360, v34
  v_add_u32 v6, 30720, v34
  v_add_u32 v7, 46080, v34
  s_lshl_b32 s4, s3, 14
  s_cmp_eq_u32 s32, 0
  s_cselect_b32 s4, 0x40000000, s4
  v_lshl_add_u32 v34, v32, 11, v33
  v_add_u32 v14, s4, v34
  v_lshrrev_b32 v34, 2, v32
  v_and_b32 v35, 3, v32
  v_lshl_add_u32 v34, v34, 3, v35
  v_mul_u32_u24 v34, 6144, v34
  v_add_u32 v34, v34, v33
  s_mul_i32 s6, s3, 6
  s_add_u32 s7, s6, 0
  s_bfe_u32 s4, s7, 0x10002
  s_lshl_b32 s4, s4, 5
  s_and_b32 s5, s7, 1
  s_lshl_b32 s5, s5, 4
  s_add_u32 s4, s4, s5
  s_bfe_u32 s5, s7, 0x10001
  s_lshl_b32 s5, s5, 2
  s_add_u32 s4, s4, s5
  s_mul_i32 s4, s4, 6144
  s_lshr_b32 s5, s7, 3
  s_lshl_b32 s5, s5, 11
  s_add_u32 s4, s4, s5
  s_add_u32 s4, s4, 2048
  v_add_u32 v8, s4, v34
  s_add_u32 s7, s6, 1
  s_bfe_u32 s4, s7, 0x10002
  s_lshl_b32 s4, s4, 5
  s_and_b32 s5, s7, 1
  s_lshl_b32 s5, s5, 4
  s_add_u32 s4, s4, s5
  s_bfe_u32 s5, s7, 0x10001
  s_lshl_b32 s5, s5, 2
  s_add_u32 s4, s4, s5
  s_mul_i32 s4, s4, 6144
  s_lshr_b32 s5, s7, 3
  s_lshl_b32 s5, s5, 11
  s_add_u32 s4, s4, s5
  s_add_u32 s4, s4, 1024
  v_add_u32 v9, s4, v34
  s_add_u32 s7, s6, 2
  s_bfe_u32 s4, s7, 0x10002
  s_lshl_b32 s4, s4, 5
  s_and_b32 s5, s7, 1
  s_lshl_b32 s5, s5, 4
  s_add_u32 s4, s4, s5
  s_bfe_u32 s5, s7, 0x10001
  s_lshl_b32 s5, s5, 2
  s_add_u32 s4, s4, s5
  s_mul_i32 s4, s4, 6144
  s_lshr_b32 s5, s7, 3
  s_lshl_b32 s5, s5, 11
  s_add_u32 s4, s4, s5
  s_add_u32 s4, s4, 0
  v_add_u32 v10, s4, v34
  s_add_u32 s7, s6, 3
  s_bfe_u32 s4, s7, 0x10002
  s_lshl_b32 s4, s4, 5
  s_and_b32 s5, s7, 1
  s_lshl_b32 s5, s5, 4
  s_add_u32 s4, s4, s5
  s_bfe_u32 s5, s7, 0x10001
  s_lshl_b32 s5, s5, 2
  s_add_u32 s4, s4, s5
  s_mul_i32 s4, s4, 6144
  s_lshr_b32 s5, s7, 3
  s_lshl_b32 s5, s5, 11
  s_add_u32 s4, s4, s5
  s_add_u32 s4, s4, 2048
  v_add_u32 v11, s4, v34
  s_add_u32 s7, s6, 4
  s_bfe_u32 s4, s7, 0x10002
  s_lshl_b32 s4, s4, 5
  s_and_b32 s5, s7, 1
  s_lshl_b32 s5, s5, 4
  s_add_u32 s4, s4, s5
  s_bfe_u32 s5, s7, 0x10001
  s_lshl_b32 s5, s5, 2
  s_add_u32 s4, s4, s5
  s_mul_i32 s4, s4, 6144
  s_lshr_b32 s5, s7, 3
  s_lshl_b32 s5, s5, 11
  s_add_u32 s4, s4, s5
  s_add_u32 s4, s4, 1024
  v_add_u32 v12, s4, v34
  s_add_u32 s7, s6, 5
  s_bfe_u32 s4, s7, 0x10002
  s_lshl_b32 s4, s4, 5
  s_and_b32 s5, s7, 1
  s_lshl_b32 s5, s5, 4
  s_add_u32 s4, s4, s5
  s_bfe_u32 s5, s7, 0x10001
  s_lshl_b32 s5, s5, 2
  s_add_u32 s4, s4, s5
  s_mul_i32 s4, s4, 6144
  s_lshr_b32 s5, s7, 3
  s_lshl_b32 s5, s5, 11
  s_add_u32 s4, s4, s5
  s_add_u32 s4, s4, 0
  v_add_u32 v13, s4, v34
  s_sub_u32 s20, s20, 2048
  s_subb_u32 s21, s21, 0
  s_add_u32 s22, s22, 2048
  s_lshr_b32 s4, s3, 1
  s_lshl_b32 s4, s4, 13
  s_add_u32 s4, s4, 32768
  v_and_b32 v32, 15, v1
  v_lshlrev_b32 v32, 7, v32
  v_lshrrev_b32 v33, 4, v1
  v_and_b32 v34, 6, v1
  v_xor_b32 v33, v33, v34
  v_lshl_add_u32 v32, v33, 4, v32
  v_add_u32 v40, s4, v32
  v_xor_b32 v41, 64, v40
  v_and_b32 v32, 15, v1
  v_lshlrev_b32 v32, 7, v32
  v_lshrrev_b32 v33, 4, v1
  v_and_b32 v34, 6, v1
  v_xor_b32 v33, v33, v34
  v_lshl_add_u32 v32, v33, 4, v32
  v_add_u32 v42, 49152, v32
  v_xor_b32 v43, 64, v42
  v_lshrrev_b32 v32, 2, v1
  v_and_b32 v33, 6, v32
  v_lshlrev_b32 v32, 7, v32
  v_and_b32 v34, 1, v1
  v_lshl_add_u32 v32, v34, 3, v32
  v_add_u32 v32, 32768, v32
  v_bfe_u32 v34, v1, 1, 1
  v_xor_b32 v33, v33, v34
  v_xor_b32 v34, 0, v33
  v_lshl_add_u32 v44, v34, 4, v32
  v_xor_b32 v34, 2, v33
  v_lshl_add_u32 v45, v34, 4, v32
  s_and_b32 s4, s3, 1
  s_lshl_b32 s4, s4, 6
  v_xor_b32 v44, s4, v44
  v_xor_b32 v45, s4, v45
  v_accvgpr_write_b32 a216, v40
  v_accvgpr_write_b32 a217, v41
  v_accvgpr_write_b32 a218, v42
  v_accvgpr_write_b32 a219, v43
  v_accvgpr_write_b32 a220, v44
  v_accvgpr_write_b32 a221, v45
  v_lshrrev_b32 v28, 3, v1
  v_and_b32 v29, 6, v28
  v_and_b32 v30, 7, v1
  v_xor_b32 v29, v29, v30
  v_lshlrev_b32 v29, 4, v29
  s_and_b32 s4, s3, 1
  s_lshl_b32 s4, s4, 16
  s_lshr_b32 s5, s3, 1
  s_lshl_b32 s5, s5, 7
  s_add_u32 s4, s4, s5
  v_lshl_add_u32 v28, v28, 11, v29
  v_add_u32 v28, s4, v28
  v_add_u32 v29, 0, v28
  v_accvgpr_write_b32 a212, v29
  v_add_u32 v29, 15360, v28
  v_accvgpr_write_b32 a213, v29
  v_add_u32 v29, 30720, v28
  v_accvgpr_write_b32 a214, v29
  v_add_u32 v29, 46080, v28
  v_accvgpr_write_b32 a215, v29
  v_lshrrev_b32 v28, 3, v1
  v_and_b32 v29, 6, v28
  v_and_b32 v30, 7, v1
  v_xor_b32 v29, v29, v30
  v_lshlrev_b32 v29, 4, v29
  v_lshlrev_b32 v30, 2, v28
  v_add_u32 v30, s3, v30
  v_lshl_add_u32 v30, v30, 11, v29
  v_add_u32 v31, 0, v30
  v_accvgpr_write_b32 a222, v31
  v_add_u32 v31, 64512, v30
  v_accvgpr_write_b32 a223, v31
  v_add_u32 v31, 129024, v30
  v_accvgpr_write_b32 a224, v31
  v_add_u32 v31, 193536, v30
  v_accvgpr_write_b32 a225, v31
  v_lshrrev_b32 v30, 2, v28
  v_and_b32 v31, 3, v28
  v_lshl_add_u32 v30, v30, 3, v31
  s_and_b32 s4, s3, 1
  s_lshl_b32 s4, s4, 18
  s_lshr_b32 s5, s3, 1
  s_lshl_b32 s5, s5, 7
  s_add_u32 s4, s4, s5
  s_lshl_b32 s5, s24, 8
  s_add_u32 s4, s4, s5
  v_lshl_add_u32 v30, v30, 13, v29
  v_add_u32 v30, s4, v30
  v_add_u32 v31, 0, v30
  v_accvgpr_write_b32 a226, v31
  v_add_u32 v31, 130048, v30
  v_accvgpr_write_b32 a227, v31
  v_add_u32 v31, 30720, v30
  v_accvgpr_write_b32 a228, v31
  v_add_u32 v31, 160768, v30
  v_accvgpr_write_b32 a229, v31
  s_lshl_b32 s4, s3, 13
  s_add_u32 s4, s4, 98304
  v_and_b32 v28, 15, v1
  v_lshlrev_b32 v28, 7, v28
  v_lshrrev_b32 v29, 4, v1
  v_and_b32 v30, 6, v1
  v_xor_b32 v29, v29, v30
  v_lshl_add_u32 v28, v29, 4, v28
  v_add_u32 v32, s4, v28
  v_xor_b32 v33, 64, v32
  v_lshrrev_b32 v28, 2, v1
  v_and_b32 v29, 6, v28
  v_lshlrev_b32 v28, 7, v28
  v_and_b32 v30, 1, v1
  v_lshl_add_u32 v28, v30, 3, v28
  v_add_u32 v28, 0, v28
  v_bfe_u32 v30, v1, 1, 1
  v_xor_b32 v29, v29, v30
  v_xor_b32 v30, 0, v29
  v_lshl_add_u32 v34, v30, 4, v28
  v_xor_b32 v30, 2, v29
  v_lshl_add_u32 v35, v30, 4, v28
  v_xor_b32 v30, 4, v29
  v_lshl_add_u32 v36, v30, 4, v28
  v_xor_b32 v30, 6, v29
  v_lshl_add_u32 v37, v30, 4, v28
  v_accvgpr_write_b32 a230, v32
  v_accvgpr_write_b32 a231, v33
  v_accvgpr_write_b32 a232, v34
  v_accvgpr_write_b32 a233, v35
  v_accvgpr_write_b32 a234, v36
  v_accvgpr_write_b32 a235, v37
  s_and_b32 s4, s3, 1
  s_lshl_b32 s5, s62, 1
  s_add_u32 s4, s4, s5
  s_lshr_b32 s5, s3, 1
  s_lshl_b32 s6, s61, 1
  s_add_u32 s5, s5, s6
  s_add_u32 s16, s86, 16777216
  s_addc_u32 s17, s87, 0
  s_mov_b32 s18, 33554432
  s_mov_b32 s19, 0x00020000
  s_lshl_b32 s4, s4, 20
  s_lshl_b32 s5, s5, 16
  s_add_u32 s63, s4, s5
  s_lshr_b32 s4, s2, 7
  s_lshl_b32 s4, s4, 14
  s_add_u32 s63, s63, s4
  s_mov_b32 s37, 0
  s_mov_b32 s39, 4294901760
  s_mov_b32 s40, 32768
  s_mov_b32 s37, 2
  s_mov_b32 s42, 0
  s_mov_b32 s44, 4294934528
  s_mov_b32 s45, 32768
  s_mov_b32 s43, s44
  s_add_u32 m0, s36, -65536
  s_nop 0
  buffer_load_dwordx4 v48, s[8:11], s46 offen offset:0 lds
  buffer_load_dwordx4 v49, s[8:11], s46 offen offset:1024 lds
  buffer_load_dwordx4 v50, s[8:11], s46 offen offset:2048 lds
  buffer_load_dwordx4 v51, s[8:11], s46 offen offset:3072 lds
  s_add_u32 m0, s36, -61440
  s_nop 0
  buffer_load_dwordx4 v52, s[8:11], s46 offen offset:0 lds
  buffer_load_dwordx4 v53, s[8:11], s46 offen offset:1024 lds
  buffer_load_dwordx4 v54, s[8:11], s46 offen offset:2048 lds
  buffer_load_dwordx4 v55, s[8:11], s46 offen offset:3072 lds
  s_add_u32 s46, s46, 128
  s_and_b32 s46, s46, 1023
  s_add_u32 m0, s41, 32768
  s_nop 0
  buffer_load_dwordx4 v56, s[12:15], s47 offen offset:0 lds
  buffer_load_dwordx4 v57, s[12:15], s47 offen offset:1024 lds
  buffer_load_dwordx4 v58, s[12:15], s47 offen offset:2048 lds
  buffer_load_dwordx4 v59, s[12:15], s47 offen offset:3072 lds
  s_add_u32 m0, s41, 36864
  s_nop 0
  buffer_load_dwordx4 v60, s[12:15], s47 offen offset:0 lds
  buffer_load_dwordx4 v61, s[12:15], s47 offen offset:1024 lds
  buffer_load_dwordx4 v62, s[12:15], s47 offen offset:2048 lds
  buffer_load_dwordx4 v63, s[12:15], s47 offen offset:3072 lds
  s_add_u32 s47, s47, 524288
  s_and_b32 s47, s47, 4194303
  s_or_b32 s4, s2, s3
  s_cbranch_scc1 Ltag_2
  s_mov_b32 s4, 196608
  s_mov_b32 s92, s84
  s_mov_b32 s93, s85
  s_mov_b32 s94, 256
  s_mov_b32 s95, 0x00020000
  s_waitcnt vmcnt(32)
  v_add_u32 v22, 1, v22
  v_or_b32 v23, 0x80000000, v23
  buffer_store_dwordx2 v[22:23], off, s[96:99], s4 sc1
  buffer_store_dwordx2 v[22:23], off, s[92:95], 0 sc1
Ltag_2:
  s_cmp_lt_u32 s2, 128
  s_cbranch_scc1 Lp1_k
  s_waitcnt vmcnt(16)
  s_barrier
  ds_read_b128 a[0:3], v16 offset:0
  ds_read_b64_tr_b16 a[64:65], v18 offset:0
  ds_read_b64_tr_b16 a[66:67], v18 offset:2048
  ds_read_b128 a[4:7], v16 offset:2048
  ds_read_b128 a[8:11], v16 offset:4096
  ds_read_b128 a[12:15], v16 offset:6144
  ds_read_b128 a[16:19], v16 offset:8192
  ds_read_b128 a[20:23], v16 offset:10240
  ds_read_b128 a[24:27], v16 offset:12288
  ds_read_b128 a[28:31], v16 offset:14336
  ds_read_b64_tr_b16 a[68:69], v19 offset:0
  ds_read_b64_tr_b16 a[70:71], v19 offset:2048
  ds_read_b64_tr_b16 a[72:73], v20 offset:0
  ds_read_b64_tr_b16 a[74:75], v20 offset:2048
  ds_read_b64_tr_b16 a[76:77], v21 offset:0
  ds_read_b64_tr_b16 a[78:79], v21 offset:2048
  ds_read_b64_tr_b16 a[80:81], v18 offset:8192
  ds_read_b64_tr_b16 a[82:83], v18 offset:10240
  ds_read_b64_tr_b16 a[84:85], v19 offset:8192
  ds_read_b64_tr_b16 a[86:87], v19 offset:10240
  ds_read_b64_tr_b16 a[88:89], v20 offset:8192
  ds_read_b64_tr_b16 a[90:91], v20 offset:10240
  ds_read_b64_tr_b16 a[92:93], v21 offset:8192
  ds_read_b64_tr_b16 a[94:95], v21 offset:10240
  s_waitcnt lgkmcnt(0)
  v_mfma_f32_16x16x32_bf16 v[64:67], a[0:3], a[64:67], 0
  s_add_u32 m0, s36, -32768
  ds_read_b128 a[32:35], v17 offset:0
  v_mfma_f32_16x16x32_bf16 v[96:99], a[4:7], a[64:67], 0
  buffer_load_dwordx4 v48, s[8:11], s46 offen offset:0 lds
  v_mfma_f32_16x16x32_bf16 v[128:131], a[8:11], a[64:67], 0
  ds_read_b64_tr_b16 a[96:97], v18 offset:4096
  v_mfma_f32_16x16x32_bf16 v[160:163], a[12:15], a[64:67], 0
  v_mfma_f32_16x16x32_bf16 v[192:195], a[16:19], a[64:67], 0
  ds_read_b64_tr_b16 a[98:99], v18 offset:6144
  v_mfma_f32_16x16x32_bf16 v[224:227], a[20:23], a[64:67], 0
  v_mfma_f32_16x16x32_bf16 a[128:131], a[24:27], a[64:67], 0
  ds_read_b128 a[36:39], v17 offset:2048
  v_mfma_f32_16x16x32_bf16 a[160:163], a[28:31], a[64:67], 0
  buffer_load_dwordx4 v49, s[8:11], s46 offen offset:1024 lds
  v_mfma_f32_16x16x32_bf16 v[68:71], a[0:3], a[68:71], 0
  v_mfma_f32_16x16x32_bf16 v[100:103], a[4:7], a[68:71], 0
  ds_read_b128 a[40:43], v17 offset:4096
  v_mfma_f32_16x16x32_bf16 v[132:135], a[8:11], a[68:71], 0
  v_mfma_f32_16x16x32_bf16 v[164:167], a[12:15], a[68:71], 0
  ds_read_b128 a[44:47], v17 offset:6144
  v_mfma_f32_16x16x32_bf16 v[196:199], a[16:19], a[68:71], 0
  v_mfma_f32_16x16x32_bf16 v[228:231], a[20:23], a[68:71], 0
  ds_read_b128 a[48:51], v17 offset:8192
  v_mfma_f32_16x16x32_bf16 a[132:135], a[24:27], a[68:71], 0
  buffer_load_dwordx4 v50, s[8:11], s46 offen offset:2048 lds
  v_mfma_f32_16x16x32_bf16 a[164:167], a[28:31], a[68:71], 0
  ds_read_b128 a[52:55], v17 offset:10240
  v_mfma_f32_16x16x32_bf16 v[72:75], a[0:3], a[72:75], 0
  v_mfma_f32_16x16x32_bf16 v[104:107], a[4:7], a[72:75], 0
  v_mfma_f32_16x16x32_bf16 v[136:139], a[8:11], a[72:75], 0
  ds_read_b128 a[56:59], v17 offset:12288
  v_mfma_f32_16x16x32_bf16 v[168:171], a[12:15], a[72:75], 0
  v_mfma_f32_16x16x32_bf16 v[200:203], a[16:19], a[72:75], 0
  ds_read_b128 a[60:63], v17 offset:14336
  v_mfma_f32_16x16x32_bf16 v[232:235], a[20:23], a[72:75], 0
  buffer_load_dwordx4 v51, s[8:11], s46 offen offset:3072 lds
  v_mfma_f32_16x16x32_bf16 a[136:139], a[24:27], a[72:75], 0
  s_add_u32 m0, s36, -28672
  ds_read_b64_tr_b16 a[100:101], v19 offset:4096
  v_mfma_f32_16x16x32_bf16 a[168:171], a[28:31], a[72:75], 0
  v_mfma_f32_16x16x32_bf16 v[76:79], a[0:3], a[76:79], 0
  ds_read_b64_tr_b16 a[102:103], v19 offset:6144
  v_mfma_f32_16x16x32_bf16 v[108:111], a[4:7], a[76:79], 0
  v_mfma_f32_16x16x32_bf16 v[140:143], a[8:11], a[76:79], 0
  v_mfma_f32_16x16x32_bf16 v[172:175], a[12:15], a[76:79], 0
  ds_read_b64_tr_b16 a[104:105], v20 offset:4096
  v_mfma_f32_16x16x32_bf16 v[204:207], a[16:19], a[76:79], 0
  buffer_load_dwordx4 v52, s[8:11], s46 offen offset:0 lds
  v_mfma_f32_16x16x32_bf16 v[236:239], a[20:23], a[76:79], 0
  ds_read_b64_tr_b16 a[106:107], v20 offset:6144
  v_mfma_f32_16x16x32_bf16 a[140:143], a[24:27], a[76:79], 0
  v_mfma_f32_16x16x32_bf16 a[172:175], a[28:31], a[76:79], 0
  ds_read_b64_tr_b16 a[108:109], v21 offset:4096
  v_mfma_f32_16x16x32_bf16 v[80:83], a[0:3], a[80:83], 0
  v_mfma_f32_16x16x32_bf16 v[112:115], a[4:7], a[80:83], 0
  ds_read_b64_tr_b16 a[110:111], v21 offset:6144
  v_mfma_f32_16x16x32_bf16 v[144:147], a[8:11], a[80:83], 0
  v_mfma_f32_16x16x32_bf16 v[176:179], a[12:15], a[80:83], 0
  buffer_load_dwordx4 v53, s[8:11], s46 offen offset:1024 lds
  v_mfma_f32_16x16x32_bf16 v[208:211], a[16:19], a[80:83], 0
  ds_read_b64_tr_b16 a[112:113], v18 offset:12288
  v_mfma_f32_16x16x32_bf16 v[240:243], a[20:23], a[80:83], 0
  v_mfma_f32_16x16x32_bf16 a[144:147], a[24:27], a[80:83], 0
  ds_read_b64_tr_b16 a[114:115], v18 offset:14336
  v_mfma_f32_16x16x32_bf16 a[176:179], a[28:31], a[80:83], 0
  v_mfma_f32_16x16x32_bf16 v[84:87], a[0:3], a[84:87], 0
  ds_read_b64_tr_b16 a[116:117], v19 offset:12288
  v_mfma_f32_16x16x32_bf16 v[116:119], a[4:7], a[84:87], 0
  v_mfma_f32_16x16x32_bf16 v[148:151], a[8:11], a[84:87], 0
  buffer_load_dwordx4 v54, s[8:11], s46 offen offset:2048 lds
  ds_read_b64_tr_b16 a[118:119], v19 offset:14336
  v_mfma_f32_16x16x32_bf16 v[180:183], a[12:15], a[84:87], 0
  v_mfma_f32_16x16x32_bf16 v[212:215], a[16:19], a[84:87], 0
  v_mfma_f32_16x16x32_bf16 v[244:247], a[20:23], a[84:87], 0
  ds_read_b64_tr_b16 a[120:121], v20 offset:12288
  v_mfma_f32_16x16x32_bf16 a[148:151], a[24:27], a[84:87], 0
  v_mfma_f32_16x16x32_bf16 a[180:183], a[28:31], a[84:87], 0
  ds_read_b64_tr_b16 a[122:123], v20 offset:14336
  v_mfma_f32_16x16x32_bf16 v[88:91], a[0:3], a[88:91], 0
  v_mfma_f32_16x16x32_bf16 v[120:123], a[4:7], a[88:91], 0
  buffer_load_dwordx4 v55, s[8:11], s46 offen offset:3072 lds
  ds_read_b64_tr_b16 a[124:125], v21 offset:12288
  v_mfma_f32_16x16x32_bf16 v[152:155], a[8:11], a[88:91], 0
  s_add_u32 s46, s46, 128
  s_and_b32 s46, s46, 1023
  v_mfma_f32_16x16x32_bf16 v[184:187], a[12:15], a[88:91], 0
  s_add_u32 s37, s37, 1
  s_cmp_eq_u32 s37, 3
  s_cselect_b32 s37, 0, s37
  s_cselect_b32 s38, s39, s40
  ds_read_b64_tr_b16 a[126:127], v21 offset:14336
  v_mfma_f32_16x16x32_bf16 v[216:219], a[16:19], a[88:91], 0
  s_sub_u32 s43, 0, s43
  v_mfma_f32_16x16x32_bf16 v[248:251], a[20:23], a[88:91], 0
  v_add_u32 v16, s38, v16
  v_add_u32 v17, s38, v17
  v_mfma_f32_16x16x32_bf16 a[152:155], a[24:27], a[88:91], 0
  v_add_u32 v18, s43, v18
  v_add_u32 v19, s43, v19
  v_mfma_f32_16x16x32_bf16 a[184:187], a[28:31], a[88:91], 0
  v_add_u32 v20, s43, v20
  v_add_u32 v21, s43, v21
  v_mfma_f32_16x16x32_bf16 v[92:95], a[0:3], a[92:95], 0
  v_mfma_f32_16x16x32_bf16 v[124:127], a[4:7], a[92:95], 0
  v_mfma_f32_16x16x32_bf16 v[156:159], a[8:11], a[92:95], 0
  v_mfma_f32_16x16x32_bf16 v[188:191], a[12:15], a[92:95], 0
  v_mfma_f32_16x16x32_bf16 v[220:223], a[16:19], a[92:95], 0
  v_mfma_f32_16x16x32_bf16 v[252:255], a[20:23], a[92:95], 0
  v_mfma_f32_16x16x32_bf16 a[156:159], a[24:27], a[92:95], 0
  v_mfma_f32_16x16x32_bf16 a[188:191], a[28:31], a[92:95], 0
  s_mov_b32 s35, 5
  .p2align 6
Lp1xw_loop:
  s_waitcnt vmcnt(8) lgkmcnt(0)
  s_barrier
  v_mfma_f32_16x16x32_bf16 v[64:67], a[32:35], a[96:99], v[64:67]
  buffer_load_dwordx4 a[192:195], v2, s[56:59], s50 offen offset:0
  ds_read_b128 a[0:3], v16 offset:0
  v_mfma_f32_16x16x32_bf16 v[96:99], a[36:39], a[96:99], v[96:99]
  v_mfma_f32_16x16x32_bf16 v[128:131], a[40:43], a[96:99], v[128:131]
  ds_read_b64_tr_b16 a[64:65], v18 offset:0
  v_mfma_f32_16x16x32_bf16 v[160:163], a[44:47], a[96:99], v[160:163]
  v_mfma_f32_16x16x32_bf16 v[192:195], a[48:51], a[96:99], v[192:195]
  ds_read_b64_tr_b16 a[66:67], v18 offset:2048
  v_mfma_f32_16x16x32_bf16 v[224:227], a[52:55], a[96:99], v[224:227]
  v_mfma_f32_16x16x32_bf16 a[128:131], a[56:59], a[96:99], a[128:131]
  buffer_load_dwordx4 a[192:195], v2, s[56:59], s50 offen offset:1024
  ds_read_b128 a[4:7], v16 offset:2048
  v_mfma_f32_16x16x32_bf16 a[160:163], a[60:63], a[96:99], a[160:163]
  s_add_u32 s50, s50, 2048
  v_mfma_f32_16x16x32_bf16 v[68:71], a[32:35], a[100:103], v[68:71]
  v_mfma_f32_16x16x32_bf16 v[100:103], a[36:39], a[100:103], v[100:103]
  ds_read_b128 a[8:11], v16 offset:4096
  v_mfma_f32_16x16x32_bf16 v[132:135], a[40:43], a[100:103], v[132:135]
  v_mfma_f32_16x16x32_bf16 v[164:167], a[44:47], a[100:103], v[164:167]
  ds_read_b128 a[12:15], v16 offset:6144
  v_mfma_f32_16x16x32_bf16 v[196:199], a[48:51], a[100:103], v[196:199]
  buffer_load_dwordx4 a[192:195], v2, s[52:55], s51 offen offset:0
  v_mfma_f32_16x16x32_bf16 v[228:231], a[52:55], a[100:103], v[228:231]
  ds_read_b128 a[16:19], v16 offset:8192
  v_mfma_f32_16x16x32_bf16 a[132:135], a[56:59], a[100:103], a[132:135]
  v_mfma_f32_16x16x32_bf16 a[164:167], a[60:63], a[100:103], a[164:167]
  ds_read_b128 a[20:23], v16 offset:10240
  v_mfma_f32_16x16x32_bf16 v[72:75], a[32:35], a[104:107], v[72:75]
  v_mfma_f32_16x16x32_bf16 v[104:107], a[36:39], a[104:107], v[104:107]
  v_mfma_f32_16x16x32_bf16 v[136:139], a[40:43], a[104:107], v[136:139]
  buffer_load_dwordx4 a[192:195], v2, s[52:55], s51 offen offset:1024
  ds_read_b128 a[24:27], v16 offset:12288
  v_mfma_f32_16x16x32_bf16 v[168:171], a[44:47], a[104:107], v[168:171]
  s_add_u32 s51, s51, 2048
  s_mov_b32 m0, s41
  v_mfma_f32_16x16x32_bf16 v[200:203], a[48:51], a[104:107], v[200:203]
  ds_read_b128 a[28:31], v16 offset:14336
  v_mfma_f32_16x16x32_bf16 v[232:235], a[52:55], a[104:107], v[232:235]
  v_mfma_f32_16x16x32_bf16 a[136:139], a[56:59], a[104:107], a[136:139]
  ds_read_b64_tr_b16 a[68:69], v19 offset:0
  v_mfma_f32_16x16x32_bf16 a[168:171], a[60:63], a[104:107], a[168:171]
  v_mfma_f32_16x16x32_bf16 v[76:79], a[32:35], a[108:111], v[76:79]
  ds_read_b64_tr_b16 a[70:71], v19 offset:2048
  v_mfma_f32_16x16x32_bf16 v[108:111], a[36:39], a[108:111], v[108:111]
  buffer_load_dwordx4 v56, s[12:15], s47 offen offset:0 lds
  v_mfma_f32_16x16x32_bf16 v[140:143], a[40:43], a[108:111], v[140:143]
  v_mfma_f32_16x16x32_bf16 v[172:175], a[44:47], a[108:111], v[172:175]
  ds_read_b64_tr_b16 a[72:73], v20 offset:0
  v_mfma_f32_16x16x32_bf16 v[204:207], a[48:51], a[108:111], v[204:207]
  v_mfma_f32_16x16x32_bf16 v[236:239], a[52:55], a[108:111], v[236:239]
  ds_read_b64_tr_b16 a[74:75], v20 offset:2048
  v_mfma_f32_16x16x32_bf16 a[140:143], a[56:59], a[108:111], a[140:143]
  v_mfma_f32_16x16x32_bf16 a[172:175], a[60:63], a[108:111], a[172:175]
  buffer_load_dwordx4 v57, s[12:15], s47 offen offset:1024 lds
  ds_read_b64_tr_b16 a[76:77], v21 offset:0
  v_mfma_f32_16x16x32_bf16 v[80:83], a[32:35], a[112:115], v[80:83]
  v_mfma_f32_16x16x32_bf16 v[112:115], a[36:39], a[112:115], v[112:115]
  ds_read_b64_tr_b16 a[78:79], v21 offset:2048
  v_mfma_f32_16x16x32_bf16 v[144:147], a[40:43], a[112:115], v[144:147]
  v_mfma_f32_16x16x32_bf16 v[176:179], a[44:47], a[112:115], v[176:179]
  v_mfma_f32_16x16x32_bf16 v[208:211], a[48:51], a[112:115], v[208:211]
  ds_read_b64_tr_b16 a[80:81], v18 offset:8192
  v_mfma_f32_16x16x32_bf16 v[240:243], a[52:55], a[112:115], v[240:243]
  buffer_load_dwordx4 v58, s[12:15], s47 offen offset:2048 lds
  v_mfma_f32_16x16x32_bf16 a[144:147], a[56:59], a[112:115], a[144:147]
  ds_read_b64_tr_b16 a[82:83], v18 offset:10240
  v_mfma_f32_16x16x32_bf16 a[176:179], a[60:63], a[112:115], a[176:179]
  v_mfma_f32_16x16x32_bf16 v[84:87], a[32:35], a[116:119], v[84:87]
  ds_read_b64_tr_b16 a[84:85], v19 offset:8192
  v_mfma_f32_16x16x32_bf16 v[116:119], a[36:39], a[116:119], v[116:119]
  v_mfma_f32_16x16x32_bf16 v[148:151], a[40:43], a[116:119], v[148:151]
  ds_read_b64_tr_b16 a[86:87], v19 offset:10240
  v_mfma_f32_16x16x32_bf16 v[180:183], a[44:47], a[116:119], v[180:183]
  v_mfma_f32_16x16x32_bf16 v[212:215], a[48:51], a[116:119], v[212:215]
  buffer_load_dwordx4 v59, s[12:15], s47 offen offset:3072 lds
  v_mfma_f32_16x16x32_bf16 v[244:247], a[52:55], a[116:119], v[244:247]
  s_add_u32 m0, s41, 4096
  ds_read_b64_tr_b16 a[88:89], v20 offset:8192
  v_mfma_f32_16x16x32_bf16 a[148:151], a[56:59], a[116:119], a[148:151]
  v_mfma_f32_16x16x32_bf16 a[180:183], a[60:63], a[116:119], a[180:183]
  ds_read_b64_tr_b16 a[90:91], v20 offset:10240
  v_mfma_f32_16x16x32_bf16 v[88:91], a[32:35], a[120:123], v[88:91]
  v_mfma_f32_16x16x32_bf16 v[120:123], a[36:39], a[120:123], v[120:123]
  ds_read_b64_tr_b16 a[92:93], v21 offset:8192
  v_mfma_f32_16x16x32_bf16 v[152:155], a[40:43], a[120:123], v[152:155]
  buffer_load_dwordx4 v60, s[12:15], s47 offen offset:0 lds
  v_mfma_f32_16x16x32_bf16 v[184:187], a[44:47], a[120:123], v[184:187]
  ds_read_b64_tr_b16 a[94:95], v21 offset:10240
  v_mfma_f32_16x16x32_bf16 v[216:219], a[48:51], a[120:123], v[216:219]
  v_mfma_f32_16x16x32_bf16 v[248:251], a[52:55], a[120:123], v[248:251]
  v_mfma_f32_16x16x32_bf16 a[152:155], a[56:59], a[120:123], a[152:155]
  v_mfma_f32_16x16x32_bf16 a[184:187], a[60:63], a[120:123], a[184:187]
  v_mfma_f32_16x16x32_bf16 v[92:95], a[32:35], a[124:127], v[92:95]
  buffer_load_dwordx4 v61, s[12:15], s47 offen offset:1024 lds
  v_mfma_f32_16x16x32_bf16 v[124:127], a[36:39], a[124:127], v[124:127]
  v_mfma_f32_16x16x32_bf16 v[156:159], a[40:43], a[124:127], v[156:159]
  v_mfma_f32_16x16x32_bf16 v[188:191], a[44:47], a[124:127], v[188:191]
  v_mfma_f32_16x16x32_bf16 v[220:223], a[48:51], a[124:127], v[220:223]
  v_mfma_f32_16x16x32_bf16 v[252:255], a[52:55], a[124:127], v[252:255]
  v_mfma_f32_16x16x32_bf16 a[156:159], a[56:59], a[124:127], a[156:159]
  v_mfma_f32_16x16x32_bf16 a[188:191], a[60:63], a[124:127], a[188:191]
  s_waitcnt lgkmcnt(0)
  v_mfma_f32_16x16x32_bf16 v[64:67], a[0:3], a[64:67], v[64:67]
  buffer_load_dwordx4 v62, s[12:15], s47 offen offset:2048 lds
  ds_read_b128 a[32:35], v17 offset:0
  v_mfma_f32_16x16x32_bf16 v[96:99], a[4:7], a[64:67], v[96:99]
  v_mfma_f32_16x16x32_bf16 v[128:131], a[8:11], a[64:67], v[128:131]
  ds_read_b64_tr_b16 a[96:97], v18 offset:4096
  v_mfma_f32_16x16x32_bf16 v[160:163], a[12:15], a[64:67], v[160:163]
  v_mfma_f32_16x16x32_bf16 v[192:195], a[16:19], a[64:67], v[192:195]
  ds_read_b64_tr_b16 a[98:99], v18 offset:6144
  v_mfma_f32_16x16x32_bf16 v[224:227], a[20:23], a[64:67], v[224:227]
  buffer_load_dwordx4 v63, s[12:15], s47 offen offset:3072 lds
  v_mfma_f32_16x16x32_bf16 a[128:131], a[24:27], a[64:67], a[128:131]
  s_add_u32 s47, s47, 524288
  s_and_b32 s47, s47, 4194303
  s_mov_b32 m0, s36
  v_mfma_f32_16x16x32_bf16 a[160:163], a[28:31], a[64:67], a[160:163]
  ds_read_b128 a[36:39], v17 offset:2048
  v_mfma_f32_16x16x32_bf16 v[68:71], a[0:3], a[68:71], v[68:71]
  v_mfma_f32_16x16x32_bf16 v[100:103], a[4:7], a[68:71], v[100:103]
  ds_read_b128 a[40:43], v17 offset:4096
  v_mfma_f32_16x16x32_bf16 v[132:135], a[8:11], a[68:71], v[132:135]
  v_mfma_f32_16x16x32_bf16 v[164:167], a[12:15], a[68:71], v[164:167]
  buffer_load_dwordx4 v48, s[8:11], s46 offen offset:0 lds
  ds_read_b128 a[44:47], v17 offset:6144
  v_mfma_f32_16x16x32_bf16 v[196:199], a[16:19], a[68:71], v[196:199]
  v_mfma_f32_16x16x32_bf16 v[228:231], a[20:23], a[68:71], v[228:231]
  ds_read_b128 a[48:51], v17 offset:8192
  v_mfma_f32_16x16x32_bf16 a[132:135], a[24:27], a[68:71], a[132:135]
  v_mfma_f32_16x16x32_bf16 a[164:167], a[28:31], a[68:71], a[164:167]
  ds_read_b128 a[52:55], v17 offset:10240
  v_mfma_f32_16x16x32_bf16 v[72:75], a[0:3], a[72:75], v[72:75]
  v_mfma_f32_16x16x32_bf16 v[104:107], a[4:7], a[72:75], v[104:107]
  buffer_load_dwordx4 v49, s[8:11], s46 offen offset:1024 lds
  v_mfma_f32_16x16x32_bf16 v[136:139], a[8:11], a[72:75], v[136:139]
  ds_read_b128 a[56:59], v17 offset:12288
  v_mfma_f32_16x16x32_bf16 v[168:171], a[12:15], a[72:75], v[168:171]
  v_mfma_f32_16x16x32_bf16 v[200:203], a[16:19], a[72:75], v[200:203]
  ds_read_b128 a[60:63], v17 offset:14336
  v_mfma_f32_16x16x32_bf16 v[232:235], a[20:23], a[72:75], v[232:235]
  v_mfma_f32_16x16x32_bf16 a[136:139], a[24:27], a[72:75], a[136:139]
  buffer_load_dwordx4 v50, s[8:11], s46 offen offset:2048 lds
  ds_read_b64_tr_b16 a[100:101], v19 offset:4096
  v_mfma_f32_16x16x32_bf16 a[168:171], a[28:31], a[72:75], a[168:171]
  v_mfma_f32_16x16x32_bf16 v[76:79], a[0:3], a[76:79], v[76:79]
  ds_read_b64_tr_b16 a[102:103], v19 offset:6144
  v_mfma_f32_16x16x32_bf16 v[108:111], a[4:7], a[76:79], v[108:111]
  v_mfma_f32_16x16x32_bf16 v[140:143], a[8:11], a[76:79], v[140:143]
  v_mfma_f32_16x16x32_bf16 v[172:175], a[12:15], a[76:79], v[172:175]
  ds_read_b64_tr_b16 a[104:105], v20 offset:4096
  v_mfma_f32_16x16x32_bf16 v[204:207], a[16:19], a[76:79], v[204:207]
  buffer_load_dwordx4 v51, s[8:11], s46 offen offset:3072 lds
  v_mfma_f32_16x16x32_bf16 v[236:239], a[20:23], a[76:79], v[236:239]
  s_add_u32 m0, s36, 4096
  ds_read_b64_tr_b16 a[106:107], v20 offset:6144
  v_mfma_f32_16x16x32_bf16 a[140:143], a[24:27], a[76:79], a[140:143]
  v_mfma_f32_16x16x32_bf16 a[172:175], a[28:31], a[76:79], a[172:175]
  ds_read_b64_tr_b16 a[108:109], v21 offset:4096
  v_mfma_f32_16x16x32_bf16 v[80:83], a[0:3], a[80:83], v[80:83]
  v_mfma_f32_16x16x32_bf16 v[112:115], a[4:7], a[80:83], v[112:115]
  ds_read_b64_tr_b16 a[110:111], v21 offset:6144
  v_mfma_f32_16x16x32_bf16 v[144:147], a[8:11], a[80:83], v[144:147]
  buffer_load_dwordx4 v52, s[8:11], s46 offen offset:0 lds
  v_mfma_f32_16x16x32_bf16 v[176:179], a[12:15], a[80:83], v[176:179]
  v_mfma_f32_16x16x32_bf16 v[208:211], a[16:19], a[80:83], v[208:211]
  ds_read_b64_tr_b16 a[112:113], v18 offset:12288
  v_mfma_f32_16x16x32_bf16 v[240:243], a[20:23], a[80:83], v[240:243]
  v_mfma_f32_16x16x32_bf16 a[144:147], a[24:27], a[80:83], a[144:147]
  ds_read_b64_tr_b16 a[114:115], v18 offset:14336
  v_mfma_f32_16x16x32_bf16 a[176:179], a[28:31], a[80:83], a[176:179]
  buffer_load_dwordx4 v53, s[8:11], s46 offen offset:1024 lds
  v_mfma_f32_16x16x32_bf16 v[84:87], a[0:3], a[84:87], v[84:87]
  ds_read_b64_tr_b16 a[116:117], v19 offset:12288
  v_mfma_f32_16x16x32_bf16 v[116:119], a[4:7], a[84:87], v[116:119]
  v_mfma_f32_16x16x32_bf16 v[148:151], a[8:11], a[84:87], v[148:151]
  ds_read_b64_tr_b16 a[118:119], v19 offset:14336
  v_mfma_f32_16x16x32_bf16 v[180:183], a[12:15], a[84:87], v[180:183]
  v_mfma_f32_16x16x32_bf16 v[212:215], a[16:19], a[84:87], v[212:215]
  v_mfma_f32_16x16x32_bf16 v[244:247], a[20:23], a[84:87], v[244:247]
  buffer_load_dwordx4 v54, s[8:11], s46 offen offset:2048 lds
  ds_read_b64_tr_b16 a[120:121], v20 offset:12288
  v_mfma_f32_16x16x32_bf16 a[148:151], a[24:27], a[84:87], a[148:151]
  v_mfma_f32_16x16x32_bf16 a[180:183], a[28:31], a[84:87], a[180:183]
  ds_read_b64_tr_b16 a[122:123], v20 offset:14336
  v_mfma_f32_16x16x32_bf16 v[88:91], a[0:3], a[88:91], v[88:91]
  v_mfma_f32_16x16x32_bf16 v[120:123], a[4:7], a[88:91], v[120:123]
  ds_read_b64_tr_b16 a[124:125], v21 offset:12288
  v_mfma_f32_16x16x32_bf16 v[152:155], a[8:11], a[88:91], v[152:155]
  v_mfma_f32_16x16x32_bf16 v[184:187], a[12:15], a[88:91], v[184:187]
  buffer_load_dwordx4 v55, s[8:11], s46 offen offset:3072 lds
  ds_read_b64_tr_b16 a[126:127], v21 offset:14336
  v_mfma_f32_16x16x32_bf16 v[216:219], a[16:19], a[88:91], v[216:219]
  s_add_u32 s46, s46, 128
  s_and_b32 s46, s46, 1023
  v_mfma_f32_16x16x32_bf16 v[248:251], a[20:23], a[88:91], v[248:251]
  s_add_u32 s36, s36, s38
  s_add_u32 s37, s37, 1
  s_cmp_eq_u32 s37, 3
  s_cselect_b32 s37, 0, s37
  s_cselect_b32 s38, s39, s40
  v_mfma_f32_16x16x32_bf16 a[152:155], a[24:27], a[88:91], a[152:155]
  s_add_u32 s41, s41, s43
  s_sub_u32 s43, 0, s43
  v_mfma_f32_16x16x32_bf16 a[184:187], a[28:31], a[88:91], a[184:187]
  v_add_u32 v16, s38, v16
  v_add_u32 v17, s38, v17
  v_mfma_f32_16x16x32_bf16 v[92:95], a[0:3], a[92:95], v[92:95]
  v_add_u32 v18, s43, v18
  v_add_u32 v19, s43, v19
  v_mfma_f32_16x16x32_bf16 v[124:127], a[4:7], a[92:95], v[124:127]
  v_add_u32 v20, s43, v20
  v_add_u32 v21, s43, v21
  v_mfma_f32_16x16x32_bf16 v[156:159], a[8:11], a[92:95], v[156:159]
  v_mfma_f32_16x16x32_bf16 v[188:191], a[12:15], a[92:95], v[188:191]
  v_mfma_f32_16x16x32_bf16 v[220:223], a[16:19], a[92:95], v[220:223]
  v_mfma_f32_16x16x32_bf16 v[252:255], a[20:23], a[92:95], v[252:255]
  v_mfma_f32_16x16x32_bf16 a[156:159], a[24:27], a[92:95], a[156:159]
  s_sub_u32 s35, s35, 1
  v_mfma_f32_16x16x32_bf16 a[188:191], a[28:31], a[92:95], a[188:191]
  s_cmp_lg_u32 s35, 0
  s_cbranch_scc1 Lp1xw_loop
  s_waitcnt vmcnt(8) lgkmcnt(0)
  s_barrier
  v_mfma_f32_16x16x32_bf16 v[64:67], a[32:35], a[96:99], v[64:67]
  s_mov_b32 m0, s41
  ds_read_b128 a[0:3], v16 offset:0
  v_mfma_f32_16x16x32_bf16 v[96:99], a[36:39], a[96:99], v[96:99]
  buffer_load_dwordx4 v56, s[12:15], s47 offen offset:0 lds
  v_mfma_f32_16x16x32_bf16 v[128:131], a[40:43], a[96:99], v[128:131]
  ds_read_b64_tr_b16 a[64:65], v18 offset:0
  v_mfma_f32_16x16x32_bf16 v[160:163], a[44:47], a[96:99], v[160:163]
  v_mfma_f32_16x16x32_bf16 v[192:195], a[48:51], a[96:99], v[192:195]
  ds_read_b64_tr_b16 a[66:67], v18 offset:2048
  v_mfma_f32_16x16x32_bf16 v[224:227], a[52:55], a[96:99], v[224:227]
  v_mfma_f32_16x16x32_bf16 a[128:131], a[56:59], a[96:99], a[128:131]
  ds_read_b128 a[4:7], v16 offset:2048
  v_mfma_f32_16x16x32_bf16 a[160:163], a[60:63], a[96:99], a[160:163]
  v_mfma_f32_16x16x32_bf16 v[68:71], a[32:35], a[100:103], v[68:71]
  v_mfma_f32_16x16x32_bf16 v[100:103], a[36:39], a[100:103], v[100:103]
  ds_read_b128 a[8:11], v16 offset:4096
  v_mfma_f32_16x16x32_bf16 v[132:135], a[40:43], a[100:103], v[132:135]
  buffer_load_dwordx4 v57, s[12:15], s47 offen offset:1024 lds
  v_mfma_f32_16x16x32_bf16 v[164:167], a[44:47], a[100:103], v[164:167]
  ds_read_b128 a[12:15], v16 offset:6144
  v_mfma_f32_16x16x32_bf16 v[196:199], a[48:51], a[100:103], v[196:199]
  v_mfma_f32_16x16x32_bf16 v[228:231], a[52:55], a[100:103], v[228:231]
  ds_read_b128 a[16:19], v16 offset:8192
  v_mfma_f32_16x16x32_bf16 a[132:135], a[56:59], a[100:103], a[132:135]
  v_mfma_f32_16x16x32_bf16 a[164:167], a[60:63], a[100:103], a[164:167]
  ds_read_b128 a[20:23], v16 offset:10240
  v_mfma_f32_16x16x32_bf16 v[72:75], a[32:35], a[104:107], v[72:75]
  v_mfma_f32_16x16x32_bf16 v[104:107], a[36:39], a[104:107], v[104:107]
  v_mfma_f32_16x16x32_bf16 v[136:139], a[40:43], a[104:107], v[136:139]
  ds_read_b128 a[24:27], v16 offset:12288
  v_mfma_f32_16x16x32_bf16 v[168:171], a[44:47], a[104:107], v[168:171]
  v_mfma_f32_16x16x32_bf16 v[200:203], a[48:51], a[104:107], v[200:203]
  ds_read_b128 a[28:31], v16 offset:14336
  v_mfma_f32_16x16x32_bf16 v[232:235], a[52:55], a[104:107], v[232:235]
  buffer_load_dwordx4 v58, s[12:15], s47 offen offset:2048 lds
  v_mfma_f32_16x16x32_bf16 a[136:139], a[56:59], a[104:107], a[136:139]
  ds_read_b64_tr_b16 a[68:69], v19 offset:0
  v_mfma_f32_16x16x32_bf16 a[168:171], a[60:63], a[104:107], a[168:171]
  v_mfma_f32_16x16x32_bf16 v[76:79], a[32:35], a[108:111], v[76:79]
  ds_read_b64_tr_b16 a[70:71], v19 offset:2048
  v_mfma_f32_16x16x32_bf16 v[108:111], a[36:39], a[108:111], v[108:111]
  v_mfma_f32_16x16x32_bf16 v[140:143], a[40:43], a[108:111], v[140:143]
  v_mfma_f32_16x16x32_bf16 v[172:175], a[44:47], a[108:111], v[172:175]
  ds_read_b64_tr_b16 a[72:73], v20 offset:0
  v_mfma_f32_16x16x32_bf16 v[204:207], a[48:51], a[108:111], v[204:207]
  v_mfma_f32_16x16x32_bf16 v[236:239], a[52:55], a[108:111], v[236:239]
  ds_read_b64_tr_b16 a[74:75], v20 offset:2048
  v_mfma_f32_16x16x32_bf16 a[140:143], a[56:59], a[108:111], a[140:143]
  v_mfma_f32_16x16x32_bf16 a[172:175], a[60:63], a[108:111], a[172:175]
  buffer_load_dwordx4 v59, s[12:15], s47 offen offset:3072 lds
  ds_read_b64_tr_b16 a[76:77], v21 offset:0
  v_mfma_f32_16x16x32_bf16 v[80:83], a[32:35], a[112:115], v[80:83]
  s_add_u32 m0, s41, 4096
  v_mfma_f32_16x16x32_bf16 v[112:115], a[36:39], a[112:115], v[112:115]
  ds_read_b64_tr_b16 a[78:79], v21 offset:2048
  v_mfma_f32_16x16x32_bf16 v[144:147], a[40:43], a[112:115], v[144:147]
  v_mfma_f32_16x16x32_bf16 v[176:179], a[44:47], a[112:115], v[176:179]
  v_mfma_f32_16x16x32_bf16 v[208:211], a[48:51], a[112:115], v[208:211]
  ds_read_b64_tr_b16 a[80:81], v18 offset:8192
  v_mfma_f32_16x16x32_bf16 v[240:243], a[52:55], a[112:115], v[240:243]
  v_mfma_f32_16x16x32_bf16 a[144:147], a[56:59], a[112:115], a[144:147]
  ds_read_b64_tr_b16 a[82:83], v18 offset:10240
  v_mfma_f32_16x16x32_bf16 a[176:179], a[60:63], a[112:115], a[176:179]
  v_mfma_f32_16x16x32_bf16 v[84:87], a[32:35], a[116:119], v[84:87]
  ds_read_b64_tr_b16 a[84:85], v19 offset:8192
  v_mfma_f32_16x16x32_bf16 v[116:119], a[36:39], a[116:119], v[116:119]
  v_mfma_f32_16x16x32_bf16 v[148:151], a[40:43], a[116:119], v[148:151]
  buffer_load_dwordx4 v60, s[12:15], s47 offen offset:0 lds
  ds_read_b64_tr_b16 a[86:87], v19 offset:10240
  v_mfma_f32_16x16x32_bf16 v[180:183], a[44:47], a[116:119], v[180:183]
  v_mfma_f32_16x16x32_bf16 v[212:215], a[48:51], a[116:119], v[212:215]
  v_mfma_f32_16x16x32_bf16 v[244:247], a[52:55], a[116:119], v[244:247]
  ds_read_b64_tr_b16 a[88:89], v20 offset:8192
  v_mfma_f32_16x16x32_bf16 a[148:151], a[56:59], a[116:119], a[148:151]
  v_mfma_f32_16x16x32_bf16 a[180:183], a[60:63], a[116:119], a[180:183]
  ds_read_b64_tr_b16 a[90:91], v20 offset:10240
  v_mfma_f32_16x16x32_bf16 v[88:91], a[32:35], a[120:123], v[88:91]
  v_mfma_f32_16x16x32_bf16 v[120:123], a[36:39], a[120:123], v[120:123]
  ds_read_b64_tr_b16 a[92:93], v21 offset:8192
  v_mfma_f32_16x16x32_bf16 v[152:155], a[40:43], a[120:123], v[152:155]
  v_mfma_f32_16x16x32_bf16 v[184:187], a[44:47], a[120:123], v[184:187]
  ds_read_b64_tr_b16 a[94:95], v21 offset:10240
  v_mfma_f32_16x16x32_bf16 v[216:219], a[48:51], a[120:123], v[216:219]
  buffer_load_dwordx4 v61, s[12:15], s47 offen offset:1024 lds
  v_mfma_f32_16x16x32_bf16 v[248:251], a[52:55], a[120:123], v[248:251]
  v_mfma_f32_16x16x32_bf16 a[152:155], a[56:59], a[120:123], a[152:155]
  v_mfma_f32_16x16x32_bf16 a[184:187], a[60:63], a[120:123], a[184:187]
  v_mfma_f32_16x16x32_bf16 v[92:95], a[32:35], a[124:127], v[92:95]
  v_mfma_f32_16x16x32_bf16 v[124:127], a[36:39], a[124:127], v[124:127]
  v_mfma_f32_16x16x32_bf16 v[156:159], a[40:43], a[124:127], v[156:159]
  v_mfma_f32_16x16x32_bf16 v[188:191], a[44:47], a[124:127], v[188:191]
  v_mfma_f32_16x16x32_bf16 v[220:223], a[48:51], a[124:127], v[220:223]
  v_mfma_f32_16x16x32_bf16 v[252:255], a[52:55], a[124:127], v[252:255]
  v_mfma_f32_16x16x32_bf16 a[156:159], a[56:59], a[124:127], a[156:159]
  v_mfma_f32_16x16x32_bf16 a[188:191], a[60:63], a[124:127], a[188:191]
  s_waitcnt lgkmcnt(0)
  v_mfma_f32_16x16x32_bf16 v[64:67], a[0:3], a[64:67], v[64:67]
  buffer_load_dwordx4 v62, s[12:15], s47 offen offset:2048 lds
  ds_read_b128 a[32:35], v17 offset:0
  v_mfma_f32_16x16x32_bf16 v[96:99], a[4:7], a[64:67], v[96:99]
  v_mfma_f32_16x16x32_bf16 v[128:131], a[8:11], a[64:67], v[128:131]
  ds_read_b64_tr_b16 a[96:97], v18 offset:4096
  v_mfma_f32_16x16x32_bf16 v[160:163], a[12:15], a[64:67], v[160:163]
  v_mfma_f32_16x16x32_bf16 v[192:195], a[16:19], a[64:67], v[192:195]
  ds_read_b64_tr_b16 a[98:99], v18 offset:6144
  v_mfma_f32_16x16x32_bf16 v[224:227], a[20:23], a[64:67], v[224:227]
  v_mfma_f32_16x16x32_bf16 a[128:131], a[24:27], a[64:67], a[128:131]
  ds_read_b128 a[36:39], v17 offset:2048
  v_mfma_f32_16x16x32_bf16 a[160:163], a[28:31], a[64:67], a[160:163]
  v_mfma_f32_16x16x32_bf16 v[68:71], a[0:3], a[68:71], v[68:71]
  v_mfma_f32_16x16x32_bf16 v[100:103], a[4:7], a[68:71], v[100:103]
  buffer_load_dwordx4 v63, s[12:15], s47 offen offset:3072 lds
  ds_read_b128 a[40:43], v17 offset:4096
  v_mfma_f32_16x16x32_bf16 v[132:135], a[8:11], a[68:71], v[132:135]
  s_add_u32 s47, s47, 524288
  s_and_b32 s47, s47, 4194303
  s_lshl_b32 s10, s32, 18
  v_mfma_f32_16x16x32_bf16 v[164:167], a[12:15], a[68:71], v[164:167]
  s_add_u32 s8, s76, s10
  s_addc_u32 s9, s77, 0
  s_sub_u32 s8, s8, 32768
  s_subb_u32 s9, s9, 0
  v_mfma_f32_16x16x32_bf16 v[196:199], a[16:19], a[68:71], v[196:199]
  s_mov_b32 s10, 294912
  s_mov_b32 s11, 0x00020000
  s_cmp_ge_u32 s3, 2
  s_cbranch_scc1 Lh_3
  s_add_u32 m0, s88, s28
  s_nop 0
  buffer_load_dwordx4 v14, s[8:11], s30 offen offset:0 lds
Lh_3:
  v_mfma_f32_16x16x32_bf16 v[228:231], a[20:23], a[68:71], v[228:231]
  s_mov_b32 m0, s88
  ds_read_b128 a[44:47], v17 offset:6144
  ds_read_b128 a[48:51], v17 offset:8192
  v_mfma_f32_16x16x32_bf16 a[132:135], a[24:27], a[68:71], a[132:135]
  v_mfma_f32_16x16x32_bf16 a[164:167], a[28:31], a[68:71], a[164:167]
  ds_read_b128 a[52:55], v17 offset:10240
  v_mfma_f32_16x16x32_bf16 v[72:75], a[0:3], a[72:75], v[72:75]
  v_mfma_f32_16x16x32_bf16 v[104:107], a[4:7], a[72:75], v[104:107]
  v_mfma_f32_16x16x32_bf16 v[136:139], a[8:11], a[72:75], v[136:139]
  ds_read_b128 a[56:59], v17 offset:12288
  v_mfma_f32_16x16x32_bf16 v[168:171], a[12:15], a[72:75], v[168:171]
  buffer_load_dwordx4 v4, s[8:11], s30 offen offset:0 lds
  v_mfma_f32_16x16x32_bf16 v[200:203], a[16:19], a[72:75], v[200:203]
  ds_read_b128 a[60:63], v17 offset:14336
  v_mfma_f32_16x16x32_bf16 v[232:235], a[20:23], a[72:75], v[232:235]
  v_mfma_f32_16x16x32_bf16 a[136:139], a[24:27], a[72:75], a[136:139]
  ds_read_b64_tr_b16 a[100:101], v19 offset:4096
  v_mfma_f32_16x16x32_bf16 a[168:171], a[28:31], a[72:75], a[168:171]
  v_mfma_f32_16x16x32_bf16 v[76:79], a[0:3], a[76:79], v[76:79]
  ds_read_b64_tr_b16 a[102:103], v19 offset:6144
  v_mfma_f32_16x16x32_bf16 v[108:111], a[4:7], a[76:79], v[108:111]
  v_mfma_f32_16x16x32_bf16 v[140:143], a[8:11], a[76:79], v[140:143]
  v_mfma_f32_16x16x32_bf16 v[172:175], a[12:15], a[76:79], v[172:175]
  ds_read_b64_tr_b16 a[104:105], v20 offset:4096
  v_mfma_f32_16x16x32_bf16 v[204:207], a[16:19], a[76:79], v[204:207]
  buffer_load_dwordx4 v5, s[8:11], s30 offen offset:1024 lds
  v_mfma_f32_16x16x32_bf16 v[236:239], a[20:23], a[76:79], v[236:239]
  ds_read_b64_tr_b16 a[106:107], v20 offset:6144
  v_mfma_f32_16x16x32_bf16 a[140:143], a[24:27], a[76:79], a[140:143]
  v_mfma_f32_16x16x32_bf16 a[172:175], a[28:31], a[76:79], a[172:175]
  ds_read_b64_tr_b16 a[108:109], v21 offset:4096
  v_mfma_f32_16x16x32_bf16 v[80:83], a[0:3], a[80:83], v[80:83]
  v_mfma_f32_16x16x32_bf16 v[112:115], a[4:7], a[80:83], v[112:115]
  ds_read_b64_tr_b16 a[110:111], v21 offset:6144
  v_mfma_f32_16x16x32_bf16 v[144:147], a[8:11], a[80:83], v[144:147]
  v_mfma_f32_16x16x32_bf16 v[176:179], a[12:15], a[80:83], v[176:179]
  v_mfma_f32_16x16x32_bf16 v[208:211], a[16:19], a[80:83], v[208:211]
  ds_read_b64_tr_b16 a[112:113], v18 offset:12288
  v_mfma_f32_16x16x32_bf16 v[240:243], a[20:23], a[80:83], v[240:243]
  v_mfma_f32_16x16x32_bf16 a[144:147], a[24:27], a[80:83], a[144:147]
  buffer_load_dwordx4 v6, s[8:11], s30 offen offset:2048 lds
  ds_read_b64_tr_b16 a[114:115], v18 offset:14336
  v_mfma_f32_16x16x32_bf16 a[176:179], a[28:31], a[80:83], a[176:179]
  v_mfma_f32_16x16x32_bf16 v[84:87], a[0:3], a[84:87], v[84:87]
  ds_read_b64_tr_b16 a[116:117], v19 offset:12288
  v_mfma_f32_16x16x32_bf16 v[116:119], a[4:7], a[84:87], v[116:119]
  v_mfma_f32_16x16x32_bf16 v[148:151], a[8:11], a[84:87], v[148:151]
  ds_read_b64_tr_b16 a[118:119], v19 offset:14336
  v_mfma_f32_16x16x32_bf16 v[180:183], a[12:15], a[84:87], v[180:183]
  v_mfma_f32_16x16x32_bf16 v[212:215], a[16:19], a[84:87], v[212:215]
  v_mfma_f32_16x16x32_bf16 v[244:247], a[20:23], a[84:87], v[244:247]
  ds_read_b64_tr_b16 a[120:121], v20 offset:12288
  v_mfma_f32_16x16x32_bf16 a[148:151], a[24:27], a[84:87], a[148:151]
  v_mfma_f32_16x16x32_bf16 a[180:183], a[28:31], a[84:87], a[180:183]
  buffer_load_dwordx4 v7, s[8:11], s30 offen offset:3072 lds
  ds_read_b64_tr_b16 a[122:123], v20 offset:14336
  v_mfma_f32_16x16x32_bf16 v[88:91], a[0:3], a[88:91], v[88:91]
  s_add_u32 s30, s30, 128
  s_and_b32 s30, s30, 2047
  v_mfma_f32_16x16x32_bf16 v[120:123], a[4:7], a[88:91], v[120:123]
  s_add_u32 s36, s36, s38
  s_add_u32 s37, s37, 1
  ds_read_b64_tr_b16 a[124:125], v21 offset:12288
  v_mfma_f32_16x16x32_bf16 v[152:155], a[8:11], a[88:91], v[152:155]
  s_cmp_eq_u32 s37, 3
  s_cselect_b32 s37, 0, s37
  s_cselect_b32 s38, s39, s40
  v_mfma_f32_16x16x32_bf16 v[184:187], a[12:15], a[88:91], v[184:187]
  s_add_u32 s41, s41, s43
  s_sub_u32 s43, 0, s43
  ds_read_b64_tr_b16 a[126:127], v21 offset:14336
  v_mfma_f32_16x16x32_bf16 v[216:219], a[16:19], a[88:91], v[216:219]
  v_add_u32 v16, s38, v16
  v_add_u32 v17, s38, v17
  v_mfma_f32_16x16x32_bf16 v[248:251], a[20:23], a[88:91], v[248:251]
  v_add_u32 v18, s43, v18
  v_add_u32 v19, s43, v19
  v_mfma_f32_16x16x32_bf16 a[152:155], a[24:27], a[88:91], a[152:155]
  v_add_u32 v20, s43, v20
  v_add_u32 v21, s43, v21
  v_mfma_f32_16x16x32_bf16 a[184:187], a[28:31], a[88:91], a[184:187]
  v_mfma_f32_16x16x32_bf16 v[92:95], a[0:3], a[92:95], v[92:95]
  v_mfma_f32_16x16x32_bf16 v[124:127], a[4:7], a[92:95], v[124:127]
  v_mfma_f32_16x16x32_bf16 v[156:159], a[8:11], a[92:95], v[156:159]
  v_mfma_f32_16x16x32_bf16 v[188:191], a[12:15], a[92:95], v[188:191]
  v_mfma_f32_16x16x32_bf16 v[220:223], a[16:19], a[92:95], v[220:223]
  v_mfma_f32_16x16x32_bf16 v[252:255], a[20:23], a[92:95], v[252:255]
  v_mfma_f32_16x16x32_bf16 a[156:159], a[24:27], a[92:95], a[156:159]
  v_mfma_f32_16x16x32_bf16 a[188:191], a[28:31], a[92:95], a[188:191]
  s_waitcnt vmcnt(4) lgkmcnt(0)
  s_barrier
  v_mfma_f32_16x16x32_bf16 v[64:67], a[32:35], a[96:99], v[64:67]
  s_add_u32 m0, s88, s26
  ds_read_b128 a[0:3], v16 offset:0
  v_mfma_f32_16x16x32_bf16 v[96:99], a[36:39], a[96:99], v[96:99]
  buffer_load_dwordx4 v8, s[20:23], s31 offen offset:0 lds
  v_mfma_f32_16x16x32_bf16 v[128:131], a[40:43], a[96:99], v[128:131]
  ds_read_b64_tr_b16 a[64:65], v18 offset:0
  v_mfma_f32_16x16x32_bf16 v[160:163], a[44:47], a[96:99], v[160:163]
  v_mfma_f32_16x16x32_bf16 v[192:195], a[48:51], a[96:99], v[192:195]
  ds_read_b64_tr_b16 a[66:67], v18 offset:2048
  v_mfma_f32_16x16x32_bf16 v[224:227], a[52:55], a[96:99], v[224:227]
  v_mfma_f32_16x16x32_bf16 a[128:131], a[56:59], a[96:99], a[128:131]
  ds_read_b128 a[4:7], v16 offset:2048
  v_mfma_f32_16x16x32_bf16 a[160:163], a[60:63], a[96:99], a[160:163]
  buffer_load_dwordx4 v9, s[20:23], s31 offen offset:1024 lds
  v_mfma_f32_16x16x32_bf16 v[68:71], a[32:35], a[100:103], v[68:71]
  v_mfma_f32_16x16x32_bf16 v[100:103], a[36:39], a[100:103], v[100:103]
  ds_read_b128 a[8:11], v16 offset:4096
  v_mfma_f32_16x16x32_bf16 v[132:135], a[40:43], a[100:103], v[132:135]
  v_mfma_f32_16x16x32_bf16 v[164:167], a[44:47], a[100:103], v[164:167]
  ds_read_b128 a[12:15], v16 offset:6144
  v_mfma_f32_16x16x32_bf16 v[196:199], a[48:51], a[100:103], v[196:199]
  v_mfma_f32_16x16x32_bf16 v[228:231], a[52:55], a[100:103], v[228:231]
  ds_read_b128 a[16:19], v16 offset:8192
  v_mfma_f32_16x16x32_bf16 a[132:135], a[56:59], a[100:103], a[132:135]
  v_mfma_f32_16x16x32_bf16 a[164:167], a[60:63], a[100:103], a[164:167]
  buffer_load_dwordx4 v10, s[20:23], s31 offen offset:2048 lds
  ds_read_b128 a[20:23], v16 offset:10240
  v_mfma_f32_16x16x32_bf16 v[72:75], a[32:35], a[104:107], v[72:75]
  s_add_u32 m0, s88, s27
  v_mfma_f32_16x16x32_bf16 v[104:107], a[36:39], a[104:107], v[104:107]
  v_mfma_f32_16x16x32_bf16 v[136:139], a[40:43], a[104:107], v[136:139]
  ds_read_b128 a[24:27], v16 offset:12288
  v_mfma_f32_16x16x32_bf16 v[168:171], a[44:47], a[104:107], v[168:171]
  v_mfma_f32_16x16x32_bf16 v[200:203], a[48:51], a[104:107], v[200:203]
  ds_read_b128 a[28:31], v16 offset:14336
  v_mfma_f32_16x16x32_bf16 v[232:235], a[52:55], a[104:107], v[232:235]
  v_mfma_f32_16x16x32_bf16 a[136:139], a[56:59], a[104:107], a[136:139]
  ds_read_b64_tr_b16 a[68:69], v19 offset:0
  v_mfma_f32_16x16x32_bf16 a[168:171], a[60:63], a[104:107], a[168:171]
  buffer_load_dwordx4 v11, s[20:23], s31 offen offset:0 lds
  v_mfma_f32_16x16x32_bf16 v[76:79], a[32:35], a[108:111], v[76:79]
  ds_read_b64_tr_b16 a[70:71], v19 offset:2048
  v_mfma_f32_16x16x32_bf16 v[108:111], a[36:39], a[108:111], v[108:111]
  v_mfma_f32_16x16x32_bf16 v[140:143], a[40:43], a[108:111], v[140:143]
  v_mfma_f32_16x16x32_bf16 v[172:175], a[44:47], a[108:111], v[172:175]
  ds_read_b64_tr_b16 a[72:73], v20 offset:0
  v_mfma_f32_16x16x32_bf16 v[204:207], a[48:51], a[108:111], v[204:207]
  v_mfma_f32_16x16x32_bf16 v[236:239], a[52:55], a[108:111], v[236:239]
  ds_read_b64_tr_b16 a[74:75], v20 offset:2048
  v_mfma_f32_16x16x32_bf16 a[140:143], a[56:59], a[108:111], a[140:143]
  v_mfma_f32_16x16x32_bf16 a[172:175], a[60:63], a[108:111], a[172:175]
  buffer_load_dwordx4 v12, s[20:23], s31 offen offset:1024 lds
  ds_read_b64_tr_b16 a[76:77], v21 offset:0
  v_mfma_f32_16x16x32_bf16 v[80:83], a[32:35], a[112:115], v[80:83]
  v_mfma_f32_16x16x32_bf16 v[112:115], a[36:39], a[112:115], v[112:115]
  ds_read_b64_tr_b16 a[78:79], v21 offset:2048
  v_mfma_f32_16x16x32_bf16 v[144:147], a[40:43], a[112:115], v[144:147]
  v_mfma_f32_16x16x32_bf16 v[176:179], a[44:47], a[112:115], v[176:179]
  v_mfma_f32_16x16x32_bf16 v[208:211], a[48:51], a[112:115], v[208:211]
  ds_read_b64_tr_b16 a[80:81], v18 offset:8192
  v_mfma_f32_16x16x32_bf16 v[240:243], a[52:55], a[112:115], v[240:243]
  v_mfma_f32_16x16x32_bf16 a[144:147], a[56:59], a[112:115], a[144:147]
  ds_read_b64_tr_b16 a[82:83], v18 offset:10240
  v_mfma_f32_16x16x32_bf16 a[176:179], a[60:63], a[112:115], a[176:179]
  buffer_load_dwordx4 v13, s[20:23], s31 offen offset:2048 lds
  v_mfma_f32_16x16x32_bf16 v[84:87], a[32:35], a[116:119], v[84:87]
  s_add_u32 s31, s31, 393216
  s_cmp_ge_u32 s31, 6291456
  s_cselect_b32 s29, 6291456, 0
  v_mfma_f32_16x16x32_bf16 v[116:119], a[36:39], a[116:119], v[116:119]
  s_sub_u32 s31, s31, s29
  s_cmp_ge_u32 s3, 2
  s_cbranch_scc1 Lh_4
  s_add_u32 m0, s88, s28
  s_add_u32 m0, m0, 43008
  s_nop 0
  buffer_load_dwordx4 v14, s[8:11], s30 offen offset:0 lds
Lh_4:
  v_mfma_f32_16x16x32_bf16 v[148:151], a[40:43], a[116:119], v[148:151]
  s_add_u32 m0, s88, 43008
  ds_read_b64_tr_b16 a[84:85], v19 offset:8192
  ds_read_b64_tr_b16 a[86:87], v19 offset:10240
  v_mfma_f32_16x16x32_bf16 v[180:183], a[44:47], a[116:119], v[180:183]
  v_mfma_f32_16x16x32_bf16 v[212:215], a[48:51], a[116:119], v[212:215]
  v_mfma_f32_16x16x32_bf16 v[244:247], a[52:55], a[116:119], v[244:247]
  ds_read_b64_tr_b16 a[88:89], v20 offset:8192
  v_mfma_f32_16x16x32_bf16 a[148:151], a[56:59], a[116:119], a[148:151]
  v_mfma_f32_16x16x32_bf16 a[180:183], a[60:63], a[116:119], a[180:183]
  buffer_load_dwordx4 v4, s[8:11], s30 offen offset:0 lds
  ds_read_b64_tr_b16 a[90:91], v20 offset:10240
  v_mfma_f32_16x16x32_bf16 v[88:91], a[32:35], a[120:123], v[88:91]
  v_mfma_f32_16x16x32_bf16 v[120:123], a[36:39], a[120:123], v[120:123]
  ds_read_b64_tr_b16 a[92:93], v21 offset:8192
  v_mfma_f32_16x16x32_bf16 v[152:155], a[40:43], a[120:123], v[152:155]
  v_mfma_f32_16x16x32_bf16 v[184:187], a[44:47], a[120:123], v[184:187]
  ds_read_b64_tr_b16 a[94:95], v21 offset:10240
  v_mfma_f32_16x16x32_bf16 v[216:219], a[48:51], a[120:123], v[216:219]
  v_mfma_f32_16x16x32_bf16 v[248:251], a[52:55], a[120:123], v[248:251]
  v_mfma_f32_16x16x32_bf16 a[152:155], a[56:59], a[120:123], a[152:155]
  v_mfma_f32_16x16x32_bf16 a[184:187], a[60:63], a[120:123], a[184:187]
  buffer_load_dwordx4 v5, s[8:11], s30 offen offset:1024 lds
  v_mfma_f32_16x16x32_bf16 v[92:95], a[32:35], a[124:127], v[92:95]
  v_mfma_f32_16x16x32_bf16 v[124:127], a[36:39], a[124:127], v[124:127]
  v_mfma_f32_16x16x32_bf16 v[156:159], a[40:43], a[124:127], v[156:159]
  v_mfma_f32_16x16x32_bf16 v[188:191], a[44:47], a[124:127], v[188:191]
  v_mfma_f32_16x16x32_bf16 v[220:223], a[48:51], a[124:127], v[220:223]
  v_mfma_f32_16x16x32_bf16 v[252:255], a[52:55], a[124:127], v[252:255]
  v_mfma_f32_16x16x32_bf16 a[156:159], a[56:59], a[124:127], a[156:159]
  v_mfma_f32_16x16x32_bf16 a[188:191], a[60:63], a[124:127], a[188:191]
  s_waitcnt lgkmcnt(0)
  v_mfma_f32_16x16x32_bf16 v[64:67], a[0:3], a[64:67], v[64:67]
  buffer_load_dwordx4 v6, s[8:11], s30 offen offset:2048 lds
  ds_read_b128 a[32:35], v17 offset:0
  v_mfma_f32_16x16x32_bf16 v[96:99], a[4:7], a[64:67], v[96:99]
  v_mfma_f32_16x16x32_bf16 v[128:131], a[8:11], a[64:67], v[128:131]
  ds_read_b64_tr_b16 a[96:97], v18 offset:4096
  v_mfma_f32_16x16x32_bf16 v[160:163], a[12:15], a[64:67], v[160:163]
  v_mfma_f32_16x16x32_bf16 v[192:195], a[16:19], a[64:67], v[192:195]
  ds_read_b64_tr_b16 a[98:99], v18 offset:6144
  v_mfma_f32_16x16x32_bf16 v[224:227], a[20:23], a[64:67], v[224:227]
  v_mfma_f32_16x16x32_bf16 a[128:131], a[24:27], a[64:67], a[128:131]
  ds_read_b128 a[36:39], v17 offset:2048
  v_mfma_f32_16x16x32_bf16 a[160:163], a[28:31], a[64:67], a[160:163]
  buffer_load_dwordx4 v7, s[8:11], s30 offen offset:3072 lds
  v_mfma_f32_16x16x32_bf16 v[68:71], a[0:3], a[68:71], v[68:71]
  s_add_u32 s30, s30, 128
  s_and_b32 s30, s30, 2047
  s_add_u32 m0, s88, s26
  s_add_u32 m0, m0, 43008
  v_mfma_f32_16x16x32_bf16 v[100:103], a[4:7], a[68:71], v[100:103]
  ds_read_b128 a[40:43], v17 offset:4096
  v_mfma_f32_16x16x32_bf16 v[132:135], a[8:11], a[68:71], v[132:135]
  v_mfma_f32_16x16x32_bf16 v[164:167], a[12:15], a[68:71], v[164:167]
  ds_read_b128 a[44:47], v17 offset:6144
  v_mfma_f32_16x16x32_bf16 v[196:199], a[16:19], a[68:71], v[196:199]
  v_mfma_f32_16x16x32_bf16 v[228:231], a[20:23], a[68:71], v[228:231]
  ds_read_b128 a[48:51], v17 offset:8192
  v_mfma_f32_16x16x32_bf16 a[132:135], a[24:27], a[68:71], a[132:135]
  v_mfma_f32_16x16x32_bf16 a[164:167], a[28:31], a[68:71], a[164:167]
  buffer_load_dwordx4 v8, s[20:23], s31 offen offset:0 lds
  ds_read_b128 a[52:55], v17 offset:10240
  v_mfma_f32_16x16x32_bf16 v[72:75], a[0:3], a[72:75], v[72:75]
  v_mfma_f32_16x16x32_bf16 v[104:107], a[4:7], a[72:75], v[104:107]
  v_mfma_f32_16x16x32_bf16 v[136:139], a[8:11], a[72:75], v[136:139]
  ds_read_b128 a[56:59], v17 offset:12288
  v_mfma_f32_16x16x32_bf16 v[168:171], a[12:15], a[72:75], v[168:171]
  v_mfma_f32_16x16x32_bf16 v[200:203], a[16:19], a[72:75], v[200:203]
  ds_read_b128 a[60:63], v17 offset:14336
  v_mfma_f32_16x16x32_bf16 v[232:235], a[20:23], a[72:75], v[232:235]
  v_mfma_f32_16x16x32_bf16 a[136:139], a[24:27], a[72:75], a[136:139]
  ds_read_b64_tr_b16 a[100:101], v19 offset:4096
  v_mfma_f32_16x16x32_bf16 a[168:171], a[28:31], a[72:75], a[168:171]
  buffer_load_dwordx4 v9, s[20:23], s31 offen offset:1024 lds
  v_mfma_f32_16x16x32_bf16 v[76:79], a[0:3], a[76:79], v[76:79]
  ds_read_b64_tr_b16 a[102:103], v19 offset:6144
  v_mfma_f32_16x16x32_bf16 v[108:111], a[4:7], a[76:79], v[108:111]
  v_mfma_f32_16x16x32_bf16 v[140:143], a[8:11], a[76:79], v[140:143]
  v_mfma_f32_16x16x32_bf16 v[172:175], a[12:15], a[76:79], v[172:175]
  ds_read_b64_tr_b16 a[104:105], v20 offset:4096
  v_mfma_f32_16x16x32_bf16 v[204:207], a[16:19], a[76:79], v[204:207]
  v_mfma_f32_16x16x32_bf16 v[236:239], a[20:23], a[76:79], v[236:239]
  ds_read_b64_tr_b16 a[106:107], v20 offset:6144
  v_mfma_f32_16x16x32_bf16 a[140:143], a[24:27], a[76:79], a[140:143]
  v_mfma_f32_16x16x32_bf16 a[172:175], a[28:31], a[76:79], a[172:175]
  buffer_load_dwordx4 v10, s[20:23], s31 offen offset:2048 lds
  ds_read_b64_tr_b16 a[108:109], v21 offset:4096
  v_mfma_f32_16x16x32_bf16 v[80:83], a[0:3], a[80:83], v[80:83]
  s_add_u32 m0, s88, s27
  s_add_u32 m0, m0, 43008
  v_mfma_f32_16x16x32_bf16 v[112:115], a[4:7], a[80:83], v[112:115]
  ds_read_b64_tr_b16 a[110:111], v21 offset:6144
  v_mfma_f32_16x16x32_bf16 v[144:147], a[8:11], a[80:83], v[144:147]
  v_mfma_f32_16x16x32_bf16 v[176:179], a[12:15], a[80:83], v[176:179]
  v_mfma_f32_16x16x32_bf16 v[208:211], a[16:19], a[80:83], v[208:211]
  ds_read_b64_tr_b16 a[112:113], v18 offset:12288
  v_mfma_f32_16x16x32_bf16 v[240:243], a[20:23], a[80:83], v[240:243]
  v_mfma_f32_16x16x32_bf16 a[144:147], a[24:27], a[80:83], a[144:147]
  ds_read_b64_tr_b16 a[114:115], v18 offset:14336
  v_mfma_f32_16x16x32_bf16 a[176:179], a[28:31], a[80:83], a[176:179]
  buffer_load_dwordx4 v11, s[20:23], s31 offen offset:0 lds
  v_mfma_f32_16x16x32_bf16 v[84:87], a[0:3], a[84:87], v[84:87]
  ds_read_b64_tr_b16 a[116:117], v19 offset:12288
  v_mfma_f32_16x16x32_bf16 v[116:119], a[4:7], a[84:87], v[116:119]
  v_mfma_f32_16x16x32_bf16 v[148:151], a[8:11], a[84:87], v[148:151]
  ds_read_b64_tr_b16 a[118:119], v19 offset:14336
  v_mfma_f32_16x16x32_bf16 v[180:183], a[12:15], a[84:87], v[180:183]
  v_mfma_f32_16x16x32_bf16 v[212:215], a[16:19], a[84:87], v[212:215]
  v_mfma_f32_16x16x32_bf16 v[244:247], a[20:23], a[84:87], v[244:247]
  ds_read_b64_tr_b16 a[120:121], v20 offset:12288
  v_mfma_f32_16x16x32_bf16 a[148:151], a[24:27], a[84:87], a[148:151]
  v_mfma_f32_16x16x32_bf16 a[180:183], a[28:31], a[84:87], a[180:183]
  buffer_load_dwordx4 v12, s[20:23], s31 offen offset:1024 lds
  ds_read_b64_tr_b16 a[122:123], v20 offset:14336
  v_mfma_f32_16x16x32_bf16 v[88:91], a[0:3], a[88:91], v[88:91]
  v_mfma_f32_16x16x32_bf16 v[120:123], a[4:7], a[88:91], v[120:123]
  ds_read_b64_tr_b16 a[124:125], v21 offset:12288
  v_mfma_f32_16x16x32_bf16 v[152:155], a[8:11], a[88:91], v[152:155]
  v_mfma_f32_16x16x32_bf16 v[184:187], a[12:15], a[88:91], v[184:187]
  ds_read_b64_tr_b16 a[126:127], v21 offset:14336
  v_mfma_f32_16x16x32_bf16 v[216:219], a[16:19], a[88:91], v[216:219]
  v_mfma_f32_16x16x32_bf16 v[248:251], a[20:23], a[88:91], v[248:251]
  v_mfma_f32_16x16x32_bf16 a[152:155], a[24:27], a[88:91], a[152:155]
  v_mfma_f32_16x16x32_bf16 a[184:187], a[28:31], a[88:91], a[184:187]
  buffer_load_dwordx4 v13, s[20:23], s31 offen offset:2048 lds
  v_mfma_f32_16x16x32_bf16 v[92:95], a[0:3], a[92:95], v[92:95]
  s_add_u32 s31, s31, 393216
  s_cmp_ge_u32 s31, 6291456
  s_cselect_b32 s29, 6291456, 0
  v_mfma_f32_16x16x32_bf16 v[124:127], a[4:7], a[92:95], v[124:127]
  s_sub_u32 s31, s31, s29
  v_mfma_f32_16x16x32_bf16 v[156:159], a[8:11], a[92:95], v[156:159]
  v_mfma_f32_16x16x32_bf16 v[188:191], a[12:15], a[92:95], v[188:191]
  v_mfma_f32_16x16x32_bf16 v[220:223], a[16:19], a[92:95], v[220:223]
  v_mfma_f32_16x16x32_bf16 v[252:255], a[20:23], a[92:95], v[252:255]
  v_mfma_f32_16x16x32_bf16 a[156:159], a[24:27], a[92:95], a[156:159]
  v_mfma_f32_16x16x32_bf16 a[188:191], a[28:31], a[92:95], a[188:191]
  s_mov_b32 s12, s84
  s_mov_b32 s13, s85
  s_mov_b32 s14, 256
  s_mov_b32 s15, 0x00020000
  buffer_load_dwordx2 v[22:23], off, s[12:15], 0 sc1
  s_waitcnt lgkmcnt(0)
  s_barrier
  v_mfma_f32_16x16x32_bf16 v[64:67], a[32:35], a[96:99], v[64:67]
  s_cmp_ge_u32 s3, 2
  s_cbranch_scc1 Lh_5
  s_add_u32 m0, s88, s28
  s_add_u32 m0, m0, 86016
  s_nop 0
  buffer_load_dwordx4 v14, s[8:11], s30 offen offset:0 lds
Lh_5:
  v_mfma_f32_16x16x32_bf16 v[96:99], a[36:39], a[96:99], v[96:99]
  s_add_u32 m0, s88, 86016
  v_mfma_f32_16x16x32_bf16 v[128:131], a[40:43], a[96:99], v[128:131]
  buffer_load_dwordx4 v4, s[8:11], s30 offen offset:0 lds
  v_mfma_f32_16x16x32_bf16 v[160:163], a[44:47], a[96:99], v[160:163]
  v_mfma_f32_16x16x32_bf16 v[192:195], a[48:51], a[96:99], v[192:195]
  v_mfma_f32_16x16x32_bf16 v[224:227], a[52:55], a[96:99], v[224:227]
  v_mfma_f32_16x16x32_bf16 a[128:131], a[56:59], a[96:99], a[128:131]
  buffer_load_dwordx4 v5, s[8:11], s30 offen offset:1024 lds
  v_mfma_f32_16x16x32_bf16 a[160:163], a[60:63], a[96:99], a[160:163]
  v_mfma_f32_16x16x32_bf16 v[68:71], a[32:35], a[100:103], v[68:71]
  v_mfma_f32_16x16x32_bf16 v[100:103], a[36:39], a[100:103], v[100:103]
  v_mfma_f32_16x16x32_bf16 v[132:135], a[40:43], a[100:103], v[132:135]
  v_mfma_f32_16x16x32_bf16 v[164:167], a[44:47], a[100:103], v[164:167]
  v_mfma_f32_16x16x32_bf16 v[196:199], a[48:51], a[100:103], v[196:199]
  buffer_load_dwordx4 v6, s[8:11], s30 offen offset:2048 lds
  v_mfma_f32_16x16x32_bf16 v[228:231], a[52:55], a[100:103], v[228:231]
  v_mfma_f32_16x16x32_bf16 a[132:135], a[56:59], a[100:103], a[132:135]
  v_mfma_f32_16x16x32_bf16 a[164:167], a[60:63], a[100:103], a[164:167]
  v_mfma_f32_16x16x32_bf16 v[72:75], a[32:35], a[104:107], v[72:75]
  v_mfma_f32_16x16x32_bf16 v[104:107], a[36:39], a[104:107], v[104:107]
  v_mfma_f32_16x16x32_bf16 v[136:139], a[40:43], a[104:107], v[136:139]
  buffer_load_dwordx4 v7, s[8:11], s30 offen offset:3072 lds
  v_mfma_f32_16x16x32_bf16 v[168:171], a[44:47], a[104:107], v[168:171]
  s_add_u32 s30, s30, 128
  s_and_b32 s30, s30, 2047
  s_add_u32 m0, s88, s26
  s_add_u32 m0, m0, 86016
  v_mfma_f32_16x16x32_bf16 v[200:203], a[48:51], a[104:107], v[200:203]
  v_mfma_f32_16x16x32_bf16 v[232:235], a[52:55], a[104:107], v[232:235]
  v_mfma_f32_16x16x32_bf16 a[136:139], a[56:59], a[104:107], a[136:139]
  v_mfma_f32_16x16x32_bf16 a[168:171], a[60:63], a[104:107], a[168:171]
  v_mfma_f32_16x16x32_bf16 v[76:79], a[32:35], a[108:111], v[76:79]
  v_mfma_f32_16x16x32_bf16 v[108:111], a[36:39], a[108:111], v[108:111]
  buffer_load_dwordx4 v8, s[20:23], s31 offen offset:0 lds
  v_mfma_f32_16x16x32_bf16 v[140:143], a[40:43], a[108:111], v[140:143]
  v_mfma_f32_16x16x32_bf16 v[172:175], a[44:47], a[108:111], v[172:175]
  v_mfma_f32_16x16x32_bf16 v[204:207], a[48:51], a[108:111], v[204:207]
  v_mfma_f32_16x16x32_bf16 v[236:239], a[52:55], a[108:111], v[236:239]
  v_mfma_f32_16x16x32_bf16 a[140:143], a[56:59], a[108:111], a[140:143]
  v_mfma_f32_16x16x32_bf16 a[172:175], a[60:63], a[108:111], a[172:175]
  buffer_load_dwordx4 v9, s[20:23], s31 offen offset:1024 lds
  v_mfma_f32_16x16x32_bf16 v[80:83], a[32:35], a[112:115], v[80:83]
  v_mfma_f32_16x16x32_bf16 v[112:115], a[36:39], a[112:115], v[112:115]
  v_mfma_f32_16x16x32_bf16 v[144:147], a[40:43], a[112:115], v[144:147]
  v_mfma_f32_16x16x32_bf16 v[176:179], a[44:47], a[112:115], v[176:179]
  v_mfma_f32_16x16x32_bf16 v[208:211], a[48:51], a[112:115], v[208:211]
  v_mfma_f32_16x16x32_bf16 v[240:243], a[52:55], a[112:115], v[240:243]
  buffer_load_dwordx4 v10, s[20:23], s31 offen offset:2048 lds
  v_mfma_f32_16x16x32_bf16 a[144:147], a[56:59], a[112:115], a[144:147]
  s_add_u32 m0, s88, s27
  s_add_u32 m0, m0, 86016
  v_mfma_f32_16x16x32_bf16 a[176:179], a[60:63], a[112:115], a[176:179]
  v_mfma_f32_16x16x32_bf16 v[84:87], a[32:35], a[116:119], v[84:87]
  v_mfma_f32_16x16x32_bf16 v[116:119], a[36:39], a[116:119], v[116:119]
  v_mfma_f32_16x16x32_bf16 v[148:151], a[40:43], a[116:119], v[148:151]
  v_mfma_f32_16x16x32_bf16 v[180:183], a[44:47], a[116:119], v[180:183]
  v_mfma_f32_16x16x32_bf16 v[212:215], a[48:51], a[116:119], v[212:215]
  buffer_load_dwordx4 v11, s[20:23], s31 offen offset:0 lds
  v_mfma_f32_16x16x32_bf16 v[244:247], a[52:55], a[116:119], v[244:247]
  v_mfma_f32_16x16x32_bf16 a[148:151], a[56:59], a[116:119], a[148:151]
  v_mfma_f32_16x16x32_bf16 a[180:183], a[60:63], a[116:119], a[180:183]
  v_mfma_f32_16x16x32_bf16 v[88:91], a[32:35], a[120:123], v[88:91]
  v_mfma_f32_16x16x32_bf16 v[120:123], a[36:39], a[120:123], v[120:123]
  v_mfma_f32_16x16x32_bf16 v[152:155], a[40:43], a[120:123], v[152:155]
  buffer_load_dwordx4 v12, s[20:23], s31 offen offset:1024 lds
  v_mfma_f32_16x16x32_bf16 v[184:187], a[44:47], a[120:123], v[184:187]
  v_mfma_f32_16x16x32_bf16 v[216:219], a[48:51], a[120:123], v[216:219]
  v_mfma_f32_16x16x32_bf16 v[248:251], a[52:55], a[120:123], v[248:251]
  v_mfma_f32_16x16x32_bf16 a[152:155], a[56:59], a[120:123], a[152:155]
  v_mfma_f32_16x16x32_bf16 a[184:187], a[60:63], a[120:123], a[184:187]
  v_mfma_f32_16x16x32_bf16 v[92:95], a[32:35], a[124:127], v[92:95]
  buffer_load_dwordx4 v13, s[20:23], s31 offen offset:2048 lds
  v_mfma_f32_16x16x32_bf16 v[124:127], a[36:39], a[124:127], v[124:127]
  s_add_u32 s31, s31, 393216
  s_cmp_ge_u32 s31, 6291456
  s_cselect_b32 s29, 6291456, 0
  v_mfma_f32_16x16x32_bf16 v[156:159], a[40:43], a[124:127], v[156:159]
  s_sub_u32 s31, s31, s29
  v_mfma_f32_16x16x32_bf16 v[188:191], a[44:47], a[124:127], v[188:191]
  v_mfma_f32_16x16x32_bf16 v[220:223], a[48:51], a[124:127], v[220:223]
  v_mfma_f32_16x16x32_bf16 v[252:255], a[52:55], a[124:127], v[252:255]
  v_mfma_f32_16x16x32_bf16 a[156:159], a[56:59], a[124:127], a[156:159]
  v_mfma_f32_16x16x32_bf16 a[188:191], a[60:63], a[124:127], a[188:191]
  v_cvt_pk_bf16_f32 v128, v128, v129
  v_cvt_pk_bf16_f32 v129, v130, v131
  v_cvt_pk_bf16_f32 v130, v160, v161
  v_cvt_pk_bf16_f32 v131, v162, v163
  v_cvt_pk_bf16_f32 v132, v132, v133
  v_cvt_pk_bf16_f32 v133, v134, v135
  v_cvt_pk_bf16_f32 v134, v164, v165
  v_cvt_pk_bf16_f32 v135, v166, v167
  v_cvt_pk_bf16_f32 v136, v136, v137
  v_cvt_pk_bf16_f32 v137, v138, v139
  s_add_u32 s60, s63, 8192
  buffer_store_dwordx4 v[128:131], v2, s[16:19], s60 offen offset:0 sc1
  v_cvt_pk_bf16_f32 v138, v168, v169
  v_cvt_pk_bf16_f32 v139, v170, v171
  v_cvt_pk_bf16_f32 v140, v140, v141
  v_cvt_pk_bf16_f32 v141, v142, v143
  v_cvt_pk_bf16_f32 v142, v172, v173
  v_cvt_pk_bf16_f32 v143, v174, v175
  v_cvt_pk_bf16_f32 v144, v144, v145
  v_cvt_pk_bf16_f32 v145, v146, v147
  v_cvt_pk_bf16_f32 v146, v176, v177
  v_cvt_pk_bf16_f32 v147, v178, v179
  v_cvt_pk_bf16_f32 v148, v148, v149
  v_cvt_pk_bf16_f32 v149, v150, v151
  v_cvt_pk_bf16_f32 v150, v180, v181
  v_cvt_pk_bf16_f32 v151, v182, v183
  v_cvt_pk_bf16_f32 v152, v152, v153
  v_cvt_pk_bf16_f32 v153, v154, v155
  v_cvt_pk_bf16_f32 v154, v184, v185
  v_cvt_pk_bf16_f32 v155, v186, v187
  v_cvt_pk_bf16_f32 v156, v156, v157
  v_cvt_pk_bf16_f32 v157, v158, v159
  v_cvt_pk_bf16_f32 v158, v188, v189
  v_cvt_pk_bf16_f32 v159, v190, v191
  v_cvt_pk_bf16_f32 v192, v192, v193
  v_cvt_pk_bf16_f32 v193, v194, v195
  v_cvt_pk_bf16_f32 v194, v224, v225
  v_cvt_pk_bf16_f32 v195, v226, v227
  v_cvt_pk_bf16_f32 v196, v196, v197
  v_cvt_pk_bf16_f32 v197, v198, v199
  v_cvt_pk_bf16_f32 v198, v228, v229
  v_cvt_pk_bf16_f32 v199, v230, v231
  v_cvt_pk_bf16_f32 v200, v200, v201
  v_cvt_pk_bf16_f32 v201, v202, v203
  v_cvt_pk_bf16_f32 v202, v232, v233
  v_cvt_pk_bf16_f32 v203, v234, v235
  v_cvt_pk_bf16_f32 v204, v204, v205
  v_cvt_pk_bf16_f32 v205, v206, v207
  v_cvt_pk_bf16_f32 v206, v236, v237
  v_cvt_pk_bf16_f32 v207, v238, v239
  v_cvt_pk_bf16_f32 v208, v208, v209
  v_cvt_pk_bf16_f32 v209, v210, v211
  v_cvt_pk_bf16_f32 v210, v240, v241
  v_cvt_pk_bf16_f32 v211, v242, v243
  v_cvt_pk_bf16_f32 v212, v212, v213
  v_cvt_pk_bf16_f32 v213, v214, v215
  v_cvt_pk_bf16_f32 v214, v244, v245
  v_cvt_pk_bf16_f32 v215, v246, v247
  v_cvt_pk_bf16_f32 v216, v216, v217
  v_cvt_pk_bf16_f32 v217, v218, v219
  v_cvt_pk_bf16_f32 v218, v248, v249
  v_cvt_pk_bf16_f32 v219, v250, v251
  v_cvt_pk_bf16_f32 v220, v220, v221
  v_cvt_pk_bf16_f32 v221, v222, v223
  v_cvt_pk_bf16_f32 v222, v252, v253
  v_cvt_pk_bf16_f32 v223, v254, v255
  v_cvt_pk_bf16_f32 v160, v64, v65
  v_cvt_pk_bf16_f32 v161, v66, v67
  v_cvt_pk_bf16_f32 v162, v96, v97
  buffer_store_dwordx4 v[132:135], v2, s[16:19], s60 offen offset:1024 sc1
  v_cvt_pk_bf16_f32 v163, v98, v99
  v_cvt_pk_bf16_f32 v164, v68, v69
  v_cvt_pk_bf16_f32 v165, v70, v71
  v_cvt_pk_bf16_f32 v166, v100, v101
  v_cvt_pk_bf16_f32 v167, v102, v103
  v_cvt_pk_bf16_f32 v168, v72, v73
  v_cvt_pk_bf16_f32 v169, v74, v75
  v_cvt_pk_bf16_f32 v170, v104, v105
  v_cvt_pk_bf16_f32 v171, v106, v107
  v_cvt_pk_bf16_f32 v172, v76, v77
  v_cvt_pk_bf16_f32 v173, v78, v79
  v_cvt_pk_bf16_f32 v174, v108, v109
  v_cvt_pk_bf16_f32 v175, v110, v111
  v_cvt_pk_bf16_f32 v176, v80, v81
  v_cvt_pk_bf16_f32 v177, v82, v83
  v_cvt_pk_bf16_f32 v178, v112, v113
  v_cvt_pk_bf16_f32 v179, v114, v115
  v_cvt_pk_bf16_f32 v180, v84, v85
  v_cvt_pk_bf16_f32 v181, v86, v87
  v_cvt_pk_bf16_f32 v182, v116, v117
  v_cvt_pk_bf16_f32 v183, v118, v119
  v_cvt_pk_bf16_f32 v184, v88, v89
  v_cvt_pk_bf16_f32 v185, v90, v91
  v_cvt_pk_bf16_f32 v186, v120, v121
  v_cvt_pk_bf16_f32 v187, v122, v123
  v_cvt_pk_bf16_f32 v188, v92, v93
  v_cvt_pk_bf16_f32 v189, v94, v95
  v_cvt_pk_bf16_f32 v190, v124, v125
  v_cvt_pk_bf16_f32 v191, v126, v127
  v_accvgpr_read_b32 v64, a128
  v_accvgpr_read_b32 v65, a129
  v_accvgpr_read_b32 v66, a130
  v_accvgpr_read_b32 v67, a131
  v_accvgpr_read_b32 v68, a160
  v_accvgpr_read_b32 v69, a161
  v_accvgpr_read_b32 v70, a162
  v_accvgpr_read_b32 v71, a163
  v_cvt_pk_bf16_f32 v224, v64, v65
  v_cvt_pk_bf16_f32 v225, v66, v67
  v_cvt_pk_bf16_f32 v226, v68, v69
  v_cvt_pk_bf16_f32 v227, v70, v71
  v_accvgpr_read_b32 v72, a132
  v_accvgpr_read_b32 v73, a133
  v_accvgpr_read_b32 v74, a134
  v_accvgpr_read_b32 v75, a135
  v_accvgpr_read_b32 v76, a164
  v_accvgpr_read_b32 v77, a165
  v_accvgpr_read_b32 v78, a166
  v_accvgpr_read_b32 v79, a167
  v_cvt_pk_bf16_f32 v228, v72, v73
  v_cvt_pk_bf16_f32 v229, v74, v75
  v_cvt_pk_bf16_f32 v230, v76, v77
  v_cvt_pk_bf16_f32 v231, v78, v79
  v_accvgpr_read_b32 v80, a136
  v_accvgpr_read_b32 v81, a137
  v_accvgpr_read_b32 v82, a138
  v_accvgpr_read_b32 v83, a139
  buffer_store_dwordx4 v[136:139], v2, s[16:19], s60 offen offset:2048 sc1
  v_accvgpr_read_b32 v84, a168
  v_accvgpr_read_b32 v85, a169
  v_accvgpr_read_b32 v86, a170
  v_accvgpr_read_b32 v87, a171
  v_cvt_pk_bf16_f32 v232, v80, v81
  v_cvt_pk_bf16_f32 v233, v82, v83
  v_cvt_pk_bf16_f32 v234, v84, v85
  v_cvt_pk_bf16_f32 v235, v86, v87
  v_accvgpr_read_b32 v88, a140
  v_accvgpr_read_b32 v89, a141
  v_accvgpr_read_b32 v90, a142
  v_accvgpr_read_b32 v91, a143
  v_accvgpr_read_b32 v92, a172
  v_accvgpr_read_b32 v93, a173
  v_accvgpr_read_b32 v94, a174
  v_accvgpr_read_b32 v95, a175
  v_cvt_pk_bf16_f32 v236, v88, v89
  v_cvt_pk_bf16_f32 v237, v90, v91
  v_cvt_pk_bf16_f32 v238, v92, v93
  v_cvt_pk_bf16_f32 v239, v94, v95
  v_accvgpr_read_b32 v96, a144
  v_accvgpr_read_b32 v97, a145
  v_accvgpr_read_b32 v98, a146
  v_accvgpr_read_b32 v99, a147
  v_accvgpr_read_b32 v100, a176
  v_accvgpr_read_b32 v101, a177
  v_accvgpr_read_b32 v102, a178
  v_accvgpr_read_b32 v103, a179
  v_cvt_pk_bf16_f32 v240, v96, v97
  v_cvt_pk_bf16_f32 v241, v98, v99
  v_cvt_pk_bf16_f32 v242, v100, v101
  v_cvt_pk_bf16_f32 v243, v102, v103
  v_accvgpr_read_b32 v104, a148
  v_accvgpr_read_b32 v105, a149
  v_accvgpr_read_b32 v106, a150
  v_accvgpr_read_b32 v107, a151
  v_accvgpr_read_b32 v108, a180
  v_accvgpr_read_b32 v109, a181
  v_accvgpr_read_b32 v110, a182
  v_accvgpr_read_b32 v111, a183
  v_cvt_pk_bf16_f32 v244, v104, v105
  v_cvt_pk_bf16_f32 v245, v106, v107
  v_cvt_pk_bf16_f32 v246, v108, v109
  v_cvt_pk_bf16_f32 v247, v110, v111
  v_accvgpr_read_b32 v112, a152
  v_accvgpr_read_b32 v113, a153
  v_accvgpr_read_b32 v114, a154
  v_accvgpr_read_b32 v115, a155
  v_accvgpr_read_b32 v116, a184
  v_accvgpr_read_b32 v117, a185
  v_accvgpr_read_b32 v118, a186
  v_accvgpr_read_b32 v119, a187
  v_cvt_pk_bf16_f32 v248, v112, v113
  v_cvt_pk_bf16_f32 v249, v114, v115
  v_cvt_pk_bf16_f32 v250, v116, v117
  v_cvt_pk_bf16_f32 v251, v118, v119
  v_accvgpr_read_b32 v120, a156
  v_accvgpr_read_b32 v121, a157
  v_accvgpr_read_b32 v122, a158
  v_accvgpr_read_b32 v123, a159
  v_accvgpr_read_b32 v124, a188
  v_accvgpr_read_b32 v125, a189
  v_accvgpr_read_b32 v126, a190
  v_accvgpr_read_b32 v127, a191
  v_cvt_pk_bf16_f32 v252, v120, v121
  v_cvt_pk_bf16_f32 v253, v122, v123
  v_cvt_pk_bf16_f32 v254, v124, v125
  v_cvt_pk_bf16_f32 v255, v126, v127
  s_branch Lp2
Lp1_k:
  s_waitcnt vmcnt(16)
  s_barrier
  ds_read_b128 a[0:3], v16 offset:0
  ds_read_b64_tr_b16 a[64:65], v18 offset:0
  ds_read_b64_tr_b16 a[66:67], v18 offset:2048
  ds_read_b128 a[4:7], v16 offset:2048
  ds_read_b128 a[8:11], v16 offset:4096
  ds_read_b128 a[12:15], v16 offset:6144
  ds_read_b128 a[16:19], v16 offset:8192
  ds_read_b128 a[20:23], v16 offset:10240
  ds_read_b128 a[24:27], v16 offset:12288
  ds_read_b128 a[28:31], v16 offset:14336
  ds_read_b64_tr_b16 a[68:69], v19 offset:0
  ds_read_b64_tr_b16 a[70:71], v19 offset:2048
  ds_read_b64_tr_b16 a[72:73], v20 offset:0
  ds_read_b64_tr_b16 a[74:75], v20 offset:2048
  ds_read_b64_tr_b16 a[76:77], v21 offset:0
  ds_read_b64_tr_b16 a[78:79], v21 offset:2048
  ds_read_b64_tr_b16 a[80:81], v18 offset:8192
  ds_read_b64_tr_b16 a[82:83], v18 offset:10240
  ds_read_b64_tr_b16 a[84:85], v19 offset:8192
  ds_read_b64_tr_b16 a[86:87], v19 offset:10240
  ds_read_b64_tr_b16 a[88:89], v20 offset:8192
  ds_read_b64_tr_b16 a[90:91], v20 offset:10240
  ds_read_b64_tr_b16 a[92:93], v21 offset:8192
  ds_read_b64_tr_b16 a[94:95], v21 offset:10240
  s_waitcnt lgkmcnt(0)
  v_mfma_f32_16x16x32_bf16 v[64:67], a[64:67], a[0:3], 0
  s_add_u32 m0, s36, -32768
  ds_read_b128 a[32:35], v17 offset:0
  v_mfma_f32_16x16x32_bf16 v[96:99], a[64:67], a[4:7], 0
  buffer_load_dwordx4 v48, s[8:11], s46 offen offset:0 lds
  v_mfma_f32_16x16x32_bf16 v[128:131], a[64:67], a[8:11], 0
  ds_read_b64_tr_b16 a[96:97], v18 offset:4096
  v_mfma_f32_16x16x32_bf16 v[160:163], a[64:67], a[12:15], 0
  v_mfma_f32_16x16x32_bf16 v[192:195], a[64:67], a[16:19], 0
  ds_read_b64_tr_b16 a[98:99], v18 offset:6144
  v_mfma_f32_16x16x32_bf16 v[224:227], a[64:67], a[20:23], 0
  v_mfma_f32_16x16x32_bf16 a[128:131], a[64:67], a[24:27], 0
  ds_read_b128 a[36:39], v17 offset:2048
  v_mfma_f32_16x16x32_bf16 a[160:163], a[64:67], a[28:31], 0
  buffer_load_dwordx4 v49, s[8:11], s46 offen offset:1024 lds
  v_mfma_f32_16x16x32_bf16 v[68:71], a[68:71], a[0:3], 0
  v_mfma_f32_16x16x32_bf16 v[100:103], a[68:71], a[4:7], 0
  ds_read_b128 a[40:43], v17 offset:4096
  v_mfma_f32_16x16x32_bf16 v[132:135], a[68:71], a[8:11], 0
  v_mfma_f32_16x16x32_bf16 v[164:167], a[68:71], a[12:15], 0
  ds_read_b128 a[44:47], v17 offset:6144
  v_mfma_f32_16x16x32_bf16 v[196:199], a[68:71], a[16:19], 0
  v_mfma_f32_16x16x32_bf16 v[228:231], a[68:71], a[20:23], 0
  ds_read_b128 a[48:51], v17 offset:8192
  v_mfma_f32_16x16x32_bf16 a[132:135], a[68:71], a[24:27], 0
  buffer_load_dwordx4 v50, s[8:11], s46 offen offset:2048 lds
  v_mfma_f32_16x16x32_bf16 a[164:167], a[68:71], a[28:31], 0
  ds_read_b128 a[52:55], v17 offset:10240
  v_mfma_f32_16x16x32_bf16 v[72:75], a[72:75], a[0:3], 0
  v_mfma_f32_16x16x32_bf16 v[104:107], a[72:75], a[4:7], 0
  v_mfma_f32_16x16x32_bf16 v[136:139], a[72:75], a[8:11], 0
  ds_read_b128 a[56:59], v17 offset:12288
  v_mfma_f32_16x16x32_bf16 v[168:171], a[72:75], a[12:15], 0
  v_mfma_f32_16x16x32_bf16 v[200:203], a[72:75], a[16:19], 0
  ds_read_b128 a[60:63], v17 offset:14336
  v_mfma_f32_16x16x32_bf16 v[232:235], a[72:75], a[20:23], 0
  buffer_load_dwordx4 v51, s[8:11], s46 offen offset:3072 lds
  v_mfma_f32_16x16x32_bf16 a[136:139], a[72:75], a[24:27], 0
  s_add_u32 m0, s36, -28672
  ds_read_b64_tr_b16 a[100:101], v19 offset:4096
  v_mfma_f32_16x16x32_bf16 a[168:171], a[72:75], a[28:31], 0
  v_mfma_f32_16x16x32_bf16 v[76:79], a[76:79], a[0:3], 0
  ds_read_b64_tr_b16 a[102:103], v19 offset:6144
  v_mfma_f32_16x16x32_bf16 v[108:111], a[76:79], a[4:7], 0
  v_mfma_f32_16x16x32_bf16 v[140:143], a[76:79], a[8:11], 0
  v_mfma_f32_16x16x32_bf16 v[172:175], a[76:79], a[12:15], 0
  ds_read_b64_tr_b16 a[104:105], v20 offset:4096
  v_mfma_f32_16x16x32_bf16 v[204:207], a[76:79], a[16:19], 0
  buffer_load_dwordx4 v52, s[8:11], s46 offen offset:0 lds
  v_mfma_f32_16x16x32_bf16 v[236:239], a[76:79], a[20:23], 0
  ds_read_b64_tr_b16 a[106:107], v20 offset:6144
  v_mfma_f32_16x16x32_bf16 a[140:143], a[76:79], a[24:27], 0
  v_mfma_f32_16x16x32_bf16 a[172:175], a[76:79], a[28:31], 0
  ds_read_b64_tr_b16 a[108:109], v21 offset:4096
  v_mfma_f32_16x16x32_bf16 v[80:83], a[80:83], a[0:3], 0
  v_mfma_f32_16x16x32_bf16 v[112:115], a[80:83], a[4:7], 0
  ds_read_b64_tr_b16 a[110:111], v21 offset:6144
  v_mfma_f32_16x16x32_bf16 v[144:147], a[80:83], a[8:11], 0
  v_mfma_f32_16x16x32_bf16 v[176:179], a[80:83], a[12:15], 0
  buffer_load_dwordx4 v53, s[8:11], s46 offen offset:1024 lds
  v_mfma_f32_16x16x32_bf16 v[208:211], a[80:83], a[16:19], 0
  ds_read_b64_tr_b16 a[112:113], v18 offset:12288
  v_mfma_f32_16x16x32_bf16 v[240:243], a[80:83], a[20:23], 0
  v_mfma_f32_16x16x32_bf16 a[144:147], a[80:83], a[24:27], 0
  ds_read_b64_tr_b16 a[114:115], v18 offset:14336
  v_mfma_f32_16x16x32_bf16 a[176:179], a[80:83], a[28:31], 0
  v_mfma_f32_16x16x32_bf16 v[84:87], a[84:87], a[0:3], 0
  ds_read_b64_tr_b16 a[116:117], v19 offset:12288
  v_mfma_f32_16x16x32_bf16 v[116:119], a[84:87], a[4:7], 0
  v_mfma_f32_16x16x32_bf16 v[148:151], a[84:87], a[8:11], 0
  buffer_load_dwordx4 v54, s[8:11], s46 offen offset:2048 lds
  ds_read_b64_tr_b16 a[118:119], v19 offset:14336
  v_mfma_f32_16x16x32_bf16 v[180:183], a[84:87], a[12:15], 0
  v_mfma_f32_16x16x32_bf16 v[212:215], a[84:87], a[16:19], 0
  v_mfma_f32_16x16x32_bf16 v[244:247], a[84:87], a[20:23], 0
  ds_read_b64_tr_b16 a[120:121], v20 offset:12288
  v_mfma_f32_16x16x32_bf16 a[148:151], a[84:87], a[24:27], 0
  v_mfma_f32_16x16x32_bf16 a[180:183], a[84:87], a[28:31], 0
  ds_read_b64_tr_b16 a[122:123], v20 offset:14336
  v_mfma_f32_16x16x32_bf16 v[88:91], a[88:91], a[0:3], 0
  v_mfma_f32_16x16x32_bf16 v[120:123], a[88:91], a[4:7], 0
  buffer_load_dwordx4 v55, s[8:11], s46 offen offset:3072 lds
  ds_read_b64_tr_b16 a[124:125], v21 offset:12288
  v_mfma_f32_16x16x32_bf16 v[152:155], a[88:91], a[8:11], 0
  s_add_u32 s46, s46, 128
  s_and_b32 s46, s46, 1023
  v_mfma_f32_16x16x32_bf16 v[184:187], a[88:91], a[12:15], 0
  s_add_u32 s37, s37, 1
  s_cmp_eq_u32 s37, 3
  s_cselect_b32 s37, 0, s37
  s_cselect_b32 s38, s39, s40
  ds_read_b64_tr_b16 a[126:127], v21 offset:14336
  v_mfma_f32_16x16x32_bf16 v[216:219], a[88:91], a[16:19], 0
  s_sub_u32 s43, 0, s43
  v_mfma_f32_16x16x32_bf16 v[248:251], a[88:91], a[20:23], 0
  v_add_u32 v16, s38, v16
  v_add_u32 v17, s38, v17
  v_mfma_f32_16x16x32_bf16 a[152:155], a[88:91], a[24:27], 0
  v_add_u32 v18, s43, v18
  v_add_u32 v19, s43, v19
  v_mfma_f32_16x16x32_bf16 a[184:187], a[88:91], a[28:31], 0
  v_add_u32 v20, s43, v20
  v_add_u32 v21, s43, v21
  v_mfma_f32_16x16x32_bf16 v[92:95], a[92:95], a[0:3], 0
  v_mfma_f32_16x16x32_bf16 v[124:127], a[92:95], a[4:7], 0
  v_mfma_f32_16x16x32_bf16 v[156:159], a[92:95], a[8:11], 0
  v_mfma_f32_16x16x32_bf16 v[188:191], a[92:95], a[12:15], 0
  v_mfma_f32_16x16x32_bf16 v[220:223], a[92:95], a[16:19], 0
  v_mfma_f32_16x16x32_bf16 v[252:255], a[92:95], a[20:23], 0
  v_mfma_f32_16x16x32_bf16 a[156:159], a[92:95], a[24:27], 0
  v_mfma_f32_16x16x32_bf16 a[188:191], a[92:95], a[28:31], 0
  s_mov_b32 s35, 5
  .p2align 6
Lp1wx_loop:
  s_waitcnt vmcnt(8) lgkmcnt(0)
  s_barrier
  v_mfma_f32_16x16x32_bf16 v[64:67], a[96:99], a[32:35], v[64:67]
  buffer_load_dwordx4 a[192:195], v2, s[56:59], s50 offen offset:0
  ds_read_b128 a[0:3], v16 offset:0
  v_mfma_f32_16x16x32_bf16 v[96:99], a[96:99], a[36:39], v[96:99]
  v_mfma_f32_16x16x32_bf16 v[128:131], a[96:99], a[40:43], v[128:131]
  ds_read_b64_tr_b16 a[64:65], v18 offset:0
  v_mfma_f32_16x16x32_bf16 v[160:163], a[96:99], a[44:47], v[160:163]
  v_mfma_f32_16x16x32_bf16 v[192:195], a[96:99], a[48:51], v[192:195]
  ds_read_b64_tr_b16 a[66:67], v18 offset:2048
  v_mfma_f32_16x16x32_bf16 v[224:227], a[96:99], a[52:55], v[224:227]
  v_mfma_f32_16x16x32_bf16 a[128:131], a[96:99], a[56:59], a[128:131]
  buffer_load_dwordx4 a[192:195], v2, s[56:59], s50 offen offset:1024
  ds_read_b128 a[4:7], v16 offset:2048
  v_mfma_f32_16x16x32_bf16 a[160:163], a[96:99], a[60:63], a[160:163]
  s_add_u32 s50, s50, 2048
  v_mfma_f32_16x16x32_bf16 v[68:71], a[100:103], a[32:35], v[68:71]
  v_mfma_f32_16x16x32_bf16 v[100:103], a[100:103], a[36:39], v[100:103]
  ds_read_b128 a[8:11], v16 offset:4096
  v_mfma_f32_16x16x32_bf16 v[132:135], a[100:103], a[40:43], v[132:135]
  v_mfma_f32_16x16x32_bf16 v[164:167], a[100:103], a[44:47], v[164:167]
  ds_read_b128 a[12:15], v16 offset:6144
  v_mfma_f32_16x16x32_bf16 v[196:199], a[100:103], a[48:51], v[196:199]
  buffer_load_dwordx4 a[192:195], v2, s[52:55], s51 offen offset:0
  v_mfma_f32_16x16x32_bf16 v[228:231], a[100:103], a[52:55], v[228:231]
  ds_read_b128 a[16:19], v16 offset:8192
  v_mfma_f32_16x16x32_bf16 a[132:135], a[100:103], a[56:59], a[132:135]
  v_mfma_f32_16x16x32_bf16 a[164:167], a[100:103], a[60:63], a[164:167]
  ds_read_b128 a[20:23], v16 offset:10240
  v_mfma_f32_16x16x32_bf16 v[72:75], a[104:107], a[32:35], v[72:75]
  v_mfma_f32_16x16x32_bf16 v[104:107], a[104:107], a[36:39], v[104:107]
  v_mfma_f32_16x16x32_bf16 v[136:139], a[104:107], a[40:43], v[136:139]
  buffer_load_dwordx4 a[192:195], v2, s[52:55], s51 offen offset:1024
  ds_read_b128 a[24:27], v16 offset:12288
  v_mfma_f32_16x16x32_bf16 v[168:171], a[104:107], a[44:47], v[168:171]
  s_add_u32 s51, s51, 2048
  s_mov_b32 m0, s41
  v_mfma_f32_16x16x32_bf16 v[200:203], a[104:107], a[48:51], v[200:203]
  ds_read_b128 a[28:31], v16 offset:14336
  v_mfma_f32_16x16x32_bf16 v[232:235], a[104:107], a[52:55], v[232:235]
  v_mfma_f32_16x16x32_bf16 a[136:139], a[104:107], a[56:59], a[136:139]
  ds_read_b64_tr_b16 a[68:69], v19 offset:0
  v_mfma_f32_16x16x32_bf16 a[168:171], a[104:107], a[60:63], a[168:171]
  v_mfma_f32_16x16x32_bf16 v[76:79], a[108:111], a[32:35], v[76:79]
  ds_read_b64_tr_b16 a[70:71], v19 offset:2048
  v_mfma_f32_16x16x32_bf16 v[108:111], a[108:111], a[36:39], v[108:111]
  buffer_load_dwordx4 v56, s[12:15], s47 offen offset:0 lds
  v_mfma_f32_16x16x32_bf16 v[140:143], a[108:111], a[40:43], v[140:143]
  v_mfma_f32_16x16x32_bf16 v[172:175], a[108:111], a[44:47], v[172:175]
  ds_read_b64_tr_b16 a[72:73], v20 offset:0
  v_mfma_f32_16x16x32_bf16 v[204:207], a[108:111], a[48:51], v[204:207]
  v_mfma_f32_16x16x32_bf16 v[236:239], a[108:111], a[52:55], v[236:239]
  ds_read_b64_tr_b16 a[74:75], v20 offset:2048
  v_mfma_f32_16x16x32_bf16 a[140:143], a[108:111], a[56:59], a[140:143]
  v_mfma_f32_16x16x32_bf16 a[172:175], a[108:111], a[60:63], a[172:175]
  buffer_load_dwordx4 v57, s[12:15], s47 offen offset:1024 lds
  ds_read_b64_tr_b16 a[76:77], v21 offset:0
  v_mfma_f32_16x16x32_bf16 v[80:83], a[112:115], a[32:35], v[80:83]
  v_mfma_f32_16x16x32_bf16 v[112:115], a[112:115], a[36:39], v[112:115]
  ds_read_b64_tr_b16 a[78:79], v21 offset:2048
  v_mfma_f32_16x16x32_bf16 v[144:147], a[112:115], a[40:43], v[144:147]
  v_mfma_f32_16x16x32_bf16 v[176:179], a[112:115], a[44:47], v[176:179]
  v_mfma_f32_16x16x32_bf16 v[208:211], a[112:115], a[48:51], v[208:211]
  ds_read_b64_tr_b16 a[80:81], v18 offset:8192
  v_mfma_f32_16x16x32_bf16 v[240:243], a[112:115], a[52:55], v[240:243]
  buffer_load_dwordx4 v58, s[12:15], s47 offen offset:2048 lds
  v_mfma_f32_16x16x32_bf16 a[144:147], a[112:115], a[56:59], a[144:147]
  ds_read_b64_tr_b16 a[82:83], v18 offset:10240
  v_mfma_f32_16x16x32_bf16 a[176:179], a[112:115], a[60:63], a[176:179]
  v_mfma_f32_16x16x32_bf16 v[84:87], a[116:119], a[32:35], v[84:87]
  ds_read_b64_tr_b16 a[84:85], v19 offset:8192
  v_mfma_f32_16x16x32_bf16 v[116:119], a[116:119], a[36:39], v[116:119]
  v_mfma_f32_16x16x32_bf16 v[148:151], a[116:119], a[40:43], v[148:151]
  ds_read_b64_tr_b16 a[86:87], v19 offset:10240
  v_mfma_f32_16x16x32_bf16 v[180:183], a[116:119], a[44:47], v[180:183]
  v_mfma_f32_16x16x32_bf16 v[212:215], a[116:119], a[48:51], v[212:215]
  buffer_load_dwordx4 v59, s[12:15], s47 offen offset:3072 lds
  v_mfma_f32_16x16x32_bf16 v[244:247], a[116:119], a[52:55], v[244:247]
  s_add_u32 m0, s41, 4096
  ds_read_b64_tr_b16 a[88:89], v20 offset:8192
  v_mfma_f32_16x16x32_bf16 a[148:151], a[116:119], a[56:59], a[148:151]
  v_mfma_f32_16x16x32_bf16 a[180:183], a[116:119], a[60:63], a[180:183]
  ds_read_b64_tr_b16 a[90:91], v20 offset:10240
  v_mfma_f32_16x16x32_bf16 v[88:91], a[120:123], a[32:35], v[88:91]
  v_mfma_f32_16x16x32_bf16 v[120:123], a[120:123], a[36:39], v[120:123]
  ds_read_b64_tr_b16 a[92:93], v21 offset:8192
  v_mfma_f32_16x16x32_bf16 v[152:155], a[120:123], a[40:43], v[152:155]
  buffer_load_dwordx4 v60, s[12:15], s47 offen offset:0 lds
  v_mfma_f32_16x16x32_bf16 v[184:187], a[120:123], a[44:47], v[184:187]
  ds_read_b64_tr_b16 a[94:95], v21 offset:10240
  v_mfma_f32_16x16x32_bf16 v[216:219], a[120:123], a[48:51], v[216:219]
  v_mfma_f32_16x16x32_bf16 v[248:251], a[120:123], a[52:55], v[248:251]
  v_mfma_f32_16x16x32_bf16 a[152:155], a[120:123], a[56:59], a[152:155]
  v_mfma_f32_16x16x32_bf16 a[184:187], a[120:123], a[60:63], a[184:187]
  v_mfma_f32_16x16x32_bf16 v[92:95], a[124:127], a[32:35], v[92:95]
  buffer_load_dwordx4 v61, s[12:15], s47 offen offset:1024 lds
  v_mfma_f32_16x16x32_bf16 v[124:127], a[124:127], a[36:39], v[124:127]
  v_mfma_f32_16x16x32_bf16 v[156:159], a[124:127], a[40:43], v[156:159]
  v_mfma_f32_16x16x32_bf16 v[188:191], a[124:127], a[44:47], v[188:191]
  v_mfma_f32_16x16x32_bf16 v[220:223], a[124:127], a[48:51], v[220:223]
  v_mfma_f32_16x16x32_bf16 v[252:255], a[124:127], a[52:55], v[252:255]
  v_mfma_f32_16x16x32_bf16 a[156:159], a[124:127], a[56:59], a[156:159]
  v_mfma_f32_16x16x32_bf16 a[188:191], a[124:127], a[60:63], a[188:191]
  s_waitcnt lgkmcnt(0)
  v_mfma_f32_16x16x32_bf16 v[64:67], a[64:67], a[0:3], v[64:67]
  buffer_load_dwordx4 v62, s[12:15], s47 offen offset:2048 lds
  ds_read_b128 a[32:35], v17 offset:0
  v_mfma_f32_16x16x32_bf16 v[96:99], a[64:67], a[4:7], v[96:99]
  v_mfma_f32_16x16x32_bf16 v[128:131], a[64:67], a[8:11], v[128:131]
  ds_read_b64_tr_b16 a[96:97], v18 offset:4096
  v_mfma_f32_16x16x32_bf16 v[160:163], a[64:67], a[12:15], v[160:163]
  v_mfma_f32_16x16x32_bf16 v[192:195], a[64:67], a[16:19], v[192:195]
  ds_read_b64_tr_b16 a[98:99], v18 offset:6144
  v_mfma_f32_16x16x32_bf16 v[224:227], a[64:67], a[20:23], v[224:227]
  buffer_load_dwordx4 v63, s[12:15], s47 offen offset:3072 lds
  v_mfma_f32_16x16x32_bf16 a[128:131], a[64:67], a[24:27], a[128:131]
  s_add_u32 s47, s47, 524288
  s_and_b32 s47, s47, 4194303
  s_mov_b32 m0, s36
  v_mfma_f32_16x16x32_bf16 a[160:163], a[64:67], a[28:31], a[160:163]
  ds_read_b128 a[36:39], v17 offset:2048
  v_mfma_f32_16x16x32_bf16 v[68:71], a[68:71], a[0:3], v[68:71]
  v_mfma_f32_16x16x32_bf16 v[100:103], a[68:71], a[4:7], v[100:103]
  ds_read_b128 a[40:43], v17 offset:4096
  v_mfma_f32_16x16x32_bf16 v[132:135], a[68:71], a[8:11], v[132:135]
  v_mfma_f32_16x16x32_bf16 v[164:167], a[68:71], a[12:15], v[164:167]
  buffer_load_dwordx4 v48, s[8:11], s46 offen offset:0 lds
  ds_read_b128 a[44:47], v17 offset:6144
  v_mfma_f32_16x16x32_bf16 v[196:199], a[68:71], a[16:19], v[196:199]
  v_mfma_f32_16x16x32_bf16 v[228:231], a[68:71], a[20:23], v[228:231]
  ds_read_b128 a[48:51], v17 offset:8192
  v_mfma_f32_16x16x32_bf16 a[132:135], a[68:71], a[24:27], a[132:135]
  v_mfma_f32_16x16x32_bf16 a[164:167], a[68:71], a[28:31], a[164:167]
  ds_read_b128 a[52:55], v17 offset:10240
  v_mfma_f32_16x16x32_bf16 v[72:75], a[72:75], a[0:3], v[72:75]
  v_mfma_f32_16x16x32_bf16 v[104:107], a[72:75], a[4:7], v[104:107]
  buffer_load_dwordx4 v49, s[8:11], s46 offen offset:1024 lds
  v_mfma_f32_16x16x32_bf16 v[136:139], a[72:75], a[8:11], v[136:139]
  ds_read_b128 a[56:59], v17 offset:12288
  v_mfma_f32_16x16x32_bf16 v[168:171], a[72:75], a[12:15], v[168:171]
  v_mfma_f32_16x16x32_bf16 v[200:203], a[72:75], a[16:19], v[200:203]
  ds_read_b128 a[60:63], v17 offset:14336
  v_mfma_f32_16x16x32_bf16 v[232:235], a[72:75], a[20:23], v[232:235]
  v_mfma_f32_16x16x32_bf16 a[136:139], a[72:75], a[24:27], a[136:139]
  buffer_load_dwordx4 v50, s[8:11], s46 offen offset:2048 lds
  ds_read_b64_tr_b16 a[100:101], v19 offset:4096
  v_mfma_f32_16x16x32_bf16 a[168:171], a[72:75], a[28:31], a[168:171]
  v_mfma_f32_16x16x32_bf16 v[76:79], a[76:79], a[0:3], v[76:79]
  ds_read_b64_tr_b16 a[102:103], v19 offset:6144
  v_mfma_f32_16x16x32_bf16 v[108:111], a[76:79], a[4:7], v[108:111]
  v_mfma_f32_16x16x32_bf16 v[140:143], a[76:79], a[8:11], v[140:143]
  v_mfma_f32_16x16x32_bf16 v[172:175], a[76:79], a[12:15], v[172:175]
  ds_read_b64_tr_b16 a[104:105], v20 offset:4096
  v_mfma_f32_16x16x32_bf16 v[204:207], a[76:79], a[16:19], v[204:207]
  buffer_load_dwordx4 v51, s[8:11], s46 offen offset:3072 lds
  v_mfma_f32_16x16x32_bf16 v[236:239], a[76:79], a[20:23], v[236:239]
  s_add_u32 m0, s36, 4096
  ds_read_b64_tr_b16 a[106:107], v20 offset:6144
  v_mfma_f32_16x16x32_bf16 a[140:143], a[76:79], a[24:27], a[140:143]
  v_mfma_f32_16x16x32_bf16 a[172:175], a[76:79], a[28:31], a[172:175]
  ds_read_b64_tr_b16 a[108:109], v21 offset:4096
  v_mfma_f32_16x16x32_bf16 v[80:83], a[80:83], a[0:3], v[80:83]
  v_mfma_f32_16x16x32_bf16 v[112:115], a[80:83], a[4:7], v[112:115]
  ds_read_b64_tr_b16 a[110:111], v21 offset:6144
  v_mfma_f32_16x16x32_bf16 v[144:147], a[80:83], a[8:11], v[144:147]
  buffer_load_dwordx4 v52, s[8:11], s46 offen offset:0 lds
  v_mfma_f32_16x16x32_bf16 v[176:179], a[80:83], a[12:15], v[176:179]
  v_mfma_f32_16x16x32_bf16 v[208:211], a[80:83], a[16:19], v[208:211]
  ds_read_b64_tr_b16 a[112:113], v18 offset:12288
  v_mfma_f32_16x16x32_bf16 v[240:243], a[80:83], a[20:23], v[240:243]
  v_mfma_f32_16x16x32_bf16 a[144:147], a[80:83], a[24:27], a[144:147]
  ds_read_b64_tr_b16 a[114:115], v18 offset:14336
  v_mfma_f32_16x16x32_bf16 a[176:179], a[80:83], a[28:31], a[176:179]
  buffer_load_dwordx4 v53, s[8:11], s46 offen offset:1024 lds
  v_mfma_f32_16x16x32_bf16 v[84:87], a[84:87], a[0:3], v[84:87]
  ds_read_b64_tr_b16 a[116:117], v19 offset:12288
  v_mfma_f32_16x16x32_bf16 v[116:119], a[84:87], a[4:7], v[116:119]
  v_mfma_f32_16x16x32_bf16 v[148:151], a[84:87], a[8:11], v[148:151]
  ds_read_b64_tr_b16 a[118:119], v19 offset:14336
  v_mfma_f32_16x16x32_bf16 v[180:183], a[84:87], a[12:15], v[180:183]
  v_mfma_f32_16x16x32_bf16 v[212:215], a[84:87], a[16:19], v[212:215]
  v_mfma_f32_16x16x32_bf16 v[244:247], a[84:87], a[20:23], v[244:247]
  buffer_load_dwordx4 v54, s[8:11], s46 offen offset:2048 lds
  ds_read_b64_tr_b16 a[120:121], v20 offset:12288
  v_mfma_f32_16x16x32_bf16 a[148:151], a[84:87], a[24:27], a[148:151]
  v_mfma_f32_16x16x32_bf16 a[180:183], a[84:87], a[28:31], a[180:183]
  ds_read_b64_tr_b16 a[122:123], v20 offset:14336
  v_mfma_f32_16x16x32_bf16 v[88:91], a[88:91], a[0:3], v[88:91]
  v_mfma_f32_16x16x32_bf16 v[120:123], a[88:91], a[4:7], v[120:123]
  ds_read_b64_tr_b16 a[124:125], v21 offset:12288
  v_mfma_f32_16x16x32_bf16 v[152:155], a[88:91], a[8:11], v[152:155]
  v_mfma_f32_16x16x32_bf16 v[184:187], a[88:91], a[12:15], v[184:187]
  buffer_load_dwordx4 v55, s[8:11], s46 offen offset:3072 lds
  ds_read_b64_tr_b16 a[126:127], v21 offset:14336
  v_mfma_f32_16x16x32_bf16 v[216:219], a[88:91], a[16:19], v[216:219]
  s_add_u32 s46, s46, 128
  s_and_b32 s46, s46, 1023
  v_mfma_f32_16x16x32_bf16 v[248:251], a[88:91], a[20:23], v[248:251]
  s_add_u32 s36, s36, s38
  s_add_u32 s37, s37, 1
  s_cmp_eq_u32 s37, 3
  s_cselect_b32 s37, 0, s37
  s_cselect_b32 s38, s39, s40
  v_mfma_f32_16x16x32_bf16 a[152:155], a[88:91], a[24:27], a[152:155]
  s_add_u32 s41, s41, s43
  s_sub_u32 s43, 0, s43
  v_mfma_f32_16x16x32_bf16 a[184:187], a[88:91], a[28:31], a[184:187]
  v_add_u32 v16, s38, v16
  v_add_u32 v17, s38, v17
  v_mfma_f32_16x16x32_bf16 v[92:95], a[92:95], a[0:3], v[92:95]
  v_add_u32 v18, s43, v18
  v_add_u32 v19, s43, v19
  v_mfma_f32_16x16x32_bf16 v[124:127], a[92:95], a[4:7], v[124:127]
  v_add_u32 v20, s43, v20
  v_add_u32 v21, s43, v21
  v_mfma_f32_16x16x32_bf16 v[156:159], a[92:95], a[8:11], v[156:159]
  v_mfma_f32_16x16x32_bf16 v[188:191], a[92:95], a[12:15], v[188:191]
  v_mfma_f32_16x16x32_bf16 v[220:223], a[92:95], a[16:19], v[220:223]
  v_mfma_f32_16x16x32_bf16 v[252:255], a[92:95], a[20:23], v[252:255]
  v_mfma_f32_16x16x32_bf16 a[156:159], a[92:95], a[24:27], a[156:159]
  s_sub_u32 s35, s35, 1
  v_mfma_f32_16x16x32_bf16 a[188:191], a[92:95], a[28:31], a[188:191]
  s_cmp_lg_u32 s35, 0
  s_cbranch_scc1 Lp1wx_loop
  s_waitcnt vmcnt(8) lgkmcnt(0)
  s_barrier
  v_mfma_f32_16x16x32_bf16 v[64:67], a[96:99], a[32:35], v[64:67]
  s_mov_b32 m0, s41
  ds_read_b128 a[0:3], v16 offset:0
  v_mfma_f32_16x16x32_bf16 v[96:99], a[96:99], a[36:39], v[96:99]
  buffer_load_dwordx4 v56, s[12:15], s47 offen offset:0 lds
  v_mfma_f32_16x16x32_bf16 v[128:131], a[96:99], a[40:43], v[128:131]
  ds_read_b64_tr_b16 a[64:65], v18 offset:0
  v_mfma_f32_16x16x32_bf16 v[160:163], a[96:99], a[44:47], v[160:163]
  v_mfma_f32_16x16x32_bf16 v[192:195], a[96:99], a[48:51], v[192:195]
  ds_read_b64_tr_b16 a[66:67], v18 offset:2048
  v_mfma_f32_16x16x32_bf16 v[224:227], a[96:99], a[52:55], v[224:227]
  v_mfma_f32_16x16x32_bf16 a[128:131], a[96:99], a[56:59], a[128:131]
  ds_read_b128 a[4:7], v16 offset:2048
  v_mfma_f32_16x16x32_bf16 a[160:163], a[96:99], a[60:63], a[160:163]
  v_mfma_f32_16x16x32_bf16 v[68:71], a[100:103], a[32:35], v[68:71]
  v_mfma_f32_16x16x32_bf16 v[100:103], a[100:103], a[36:39], v[100:103]
  ds_read_b128 a[8:11], v16 offset:4096
  v_mfma_f32_16x16x32_bf16 v[132:135], a[100:103], a[40:43], v[132:135]
  buffer_load_dwordx4 v57, s[12:15], s47 offen offset:1024 lds
  v_mfma_f32_16x16x32_bf16 v[164:167], a[100:103], a[44:47], v[164:167]
  ds_read_b128 a[12:15], v16 offset:6144
  v_mfma_f32_16x16x32_bf16 v[196:199], a[100:103], a[48:51], v[196:199]
  v_mfma_f32_16x16x32_bf16 v[228:231], a[100:103], a[52:55], v[228:231]
  ds_read_b128 a[16:19], v16 offset:8192
  v_mfma_f32_16x16x32_bf16 a[132:135], a[100:103], a[56:59], a[132:135]
  v_mfma_f32_16x16x32_bf16 a[164:167], a[100:103], a[60:63], a[164:167]
  ds_read_b128 a[20:23], v16 offset:10240
  v_mfma_f32_16x16x32_bf16 v[72:75], a[104:107], a[32:35], v[72:75]
  v_mfma_f32_16x16x32_bf16 v[104:107], a[104:107], a[36:39], v[104:107]
  v_mfma_f32_16x16x32_bf16 v[136:139], a[104:107], a[40:43], v[136:139]
  ds_read_b128 a[24:27], v16 offset:12288
  v_mfma_f32_16x16x32_bf16 v[168:171], a[104:107], a[44:47], v[168:171]
  v_mfma_f32_16x16x32_bf16 v[200:203], a[104:107], a[48:51], v[200:203]
  ds_read_b128 a[28:31], v16 offset:14336
  v_mfma_f32_16x16x32_bf16 v[232:235], a[104:107], a[52:55], v[232:235]
  buffer_load_dwordx4 v58, s[12:15], s47 offen offset:2048 lds
  v_mfma_f32_16x16x32_bf16 a[136:139], a[104:107], a[56:59], a[136:139]
  ds_read_b64_tr_b16 a[68:69], v19 offset:0
  v_mfma_f32_16x16x32_bf16 a[168:171], a[104:107], a[60:63], a[168:171]
  v_mfma_f32_16x16x32_bf16 v[76:79], a[108:111], a[32:35], v[76:79]
  ds_read_b64_tr_b16 a[70:71], v19 offset:2048
  v_mfma_f32_16x16x32_bf16 v[108:111], a[108:111], a[36:39], v[108:111]
  v_mfma_f32_16x16x32_bf16 v[140:143], a[108:111], a[40:43], v[140:143]
  v_mfma_f32_16x16x32_bf16 v[172:175], a[108:111], a[44:47], v[172:175]
  ds_read_b64_tr_b16 a[72:73], v20 offset:0
  v_mfma_f32_16x16x32_bf16 v[204:207], a[108:111], a[48:51], v[204:207]
  v_mfma_f32_16x16x32_bf16 v[236:239], a[108:111], a[52:55], v[236:239]
  ds_read_b64_tr_b16 a[74:75], v20 offset:2048
  v_mfma_f32_16x16x32_bf16 a[140:143], a[108:111], a[56:59], a[140:143]
  v_mfma_f32_16x16x32_bf16 a[172:175], a[108:111], a[60:63], a[172:175]
  buffer_load_dwordx4 v59, s[12:15], s47 offen offset:3072 lds
  ds_read_b64_tr_b16 a[76:77], v21 offset:0
  v_mfma_f32_16x16x32_bf16 v[80:83], a[112:115], a[32:35], v[80:83]
  s_add_u32 m0, s41, 4096
  v_mfma_f32_16x16x32_bf16 v[112:115], a[112:115], a[36:39], v[112:115]
  ds_read_b64_tr_b16 a[78:79], v21 offset:2048
  v_mfma_f32_16x16x32_bf16 v[144:147], a[112:115], a[40:43], v[144:147]
  v_mfma_f32_16x16x32_bf16 v[176:179], a[112:115], a[44:47], v[176:179]
  v_mfma_f32_16x16x32_bf16 v[208:211], a[112:115], a[48:51], v[208:211]
  ds_read_b64_tr_b16 a[80:81], v18 offset:8192
  v_mfma_f32_16x16x32_bf16 v[240:243], a[112:115], a[52:55], v[240:243]
  v_mfma_f32_16x16x32_bf16 a[144:147], a[112:115], a[56:59], a[144:147]
  ds_read_b64_tr_b16 a[82:83], v18 offset:10240
  v_mfma_f32_16x16x32_bf16 a[176:179], a[112:115], a[60:63], a[176:179]
  v_mfma_f32_16x16x32_bf16 v[84:87], a[116:119], a[32:35], v[84:87]
  ds_read_b64_tr_b16 a[84:85], v19 offset:8192
  v_mfma_f32_16x16x32_bf16 v[116:119], a[116:119], a[36:39], v[116:119]
  v_mfma_f32_16x16x32_bf16 v[148:151], a[116:119], a[40:43], v[148:151]
  buffer_load_dwordx4 v60, s[12:15], s47 offen offset:0 lds
  ds_read_b64_tr_b16 a[86:87], v19 offset:10240
  v_mfma_f32_16x16x32_bf16 v[180:183], a[116:119], a[44:47], v[180:183]
  v_mfma_f32_16x16x32_bf16 v[212:215], a[116:119], a[48:51], v[212:215]
  v_mfma_f32_16x16x32_bf16 v[244:247], a[116:119], a[52:55], v[244:247]
  ds_read_b64_tr_b16 a[88:89], v20 offset:8192
  v_mfma_f32_16x16x32_bf16 a[148:151], a[116:119], a[56:59], a[148:151]
  v_mfma_f32_16x16x32_bf16 a[180:183], a[116:119], a[60:63], a[180:183]
  ds_read_b64_tr_b16 a[90:91], v20 offset:10240
  v_mfma_f32_16x16x32_bf16 v[88:91], a[120:123], a[32:35], v[88:91]
  v_mfma_f32_16x16x32_bf16 v[120:123], a[120:123], a[36:39], v[120:123]
  ds_read_b64_tr_b16 a[92:93], v21 offset:8192
  v_mfma_f32_16x16x32_bf16 v[152:155], a[120:123], a[40:43], v[152:155]
  v_mfma_f32_16x16x32_bf16 v[184:187], a[120:123], a[44:47], v[184:187]
  ds_read_b64_tr_b16 a[94:95], v21 offset:10240
  v_mfma_f32_16x16x32_bf16 v[216:219], a[120:123], a[48:51], v[216:219]
  buffer_load_dwordx4 v61, s[12:15], s47 offen offset:1024 lds
  v_mfma_f32_16x16x32_bf16 v[248:251], a[120:123], a[52:55], v[248:251]
  v_mfma_f32_16x16x32_bf16 a[152:155], a[120:123], a[56:59], a[152:155]
  v_mfma_f32_16x16x32_bf16 a[184:187], a[120:123], a[60:63], a[184:187]
  v_mfma_f32_16x16x32_bf16 v[92:95], a[124:127], a[32:35], v[92:95]
  v_mfma_f32_16x16x32_bf16 v[124:127], a[124:127], a[36:39], v[124:127]
  v_mfma_f32_16x16x32_bf16 v[156:159], a[124:127], a[40:43], v[156:159]
  v_mfma_f32_16x16x32_bf16 v[188:191], a[124:127], a[44:47], v[188:191]
  v_mfma_f32_16x16x32_bf16 v[220:223], a[124:127], a[48:51], v[220:223]
  v_mfma_f32_16x16x32_bf16 v[252:255], a[124:127], a[52:55], v[252:255]
  v_mfma_f32_16x16x32_bf16 a[156:159], a[124:127], a[56:59], a[156:159]
  v_mfma_f32_16x16x32_bf16 a[188:191], a[124:127], a[60:63], a[188:191]
  s_waitcnt lgkmcnt(0)
  v_mfma_f32_16x16x32_bf16 v[64:67], a[64:67], a[0:3], v[64:67]
  buffer_load_dwordx4 v62, s[12:15], s47 offen offset:2048 lds
  ds_read_b128 a[32:35], v17 offset:0
  v_mfma_f32_16x16x32_bf16 v[96:99], a[64:67], a[4:7], v[96:99]
  v_mfma_f32_16x16x32_bf16 v[128:131], a[64:67], a[8:11], v[128:131]
  ds_read_b64_tr_b16 a[96:97], v18 offset:4096
  v_mfma_f32_16x16x32_bf16 v[160:163], a[64:67], a[12:15], v[160:163]
  v_mfma_f32_16x16x32_bf16 v[192:195], a[64:67], a[16:19], v[192:195]
  ds_read_b64_tr_b16 a[98:99], v18 offset:6144
  v_mfma_f32_16x16x32_bf16 v[224:227], a[64:67], a[20:23], v[224:227]
  v_mfma_f32_16x16x32_bf16 a[128:131], a[64:67], a[24:27], a[128:131]
  ds_read_b128 a[36:39], v17 offset:2048
  v_mfma_f32_16x16x32_bf16 a[160:163], a[64:67], a[28:31], a[160:163]
  v_mfma_f32_16x16x32_bf16 v[68:71], a[68:71], a[0:3], v[68:71]
  v_mfma_f32_16x16x32_bf16 v[100:103], a[68:71], a[4:7], v[100:103]
  buffer_load_dwordx4 v63, s[12:15], s47 offen offset:3072 lds
  ds_read_b128 a[40:43], v17 offset:4096
  v_mfma_f32_16x16x32_bf16 v[132:135], a[68:71], a[8:11], v[132:135]
  s_add_u32 s47, s47, 524288
  s_and_b32 s47, s47, 4194303
  s_lshl_b32 s10, s32, 18
  v_mfma_f32_16x16x32_bf16 v[164:167], a[68:71], a[12:15], v[164:167]
  s_add_u32 s8, s76, s10
  s_addc_u32 s9, s77, 0
  s_sub_u32 s8, s8, 32768
  s_subb_u32 s9, s9, 0
  v_mfma_f32_16x16x32_bf16 v[196:199], a[68:71], a[16:19], v[196:199]
  s_mov_b32 s10, 294912
  s_mov_b32 s11, 0x00020000
  s_cmp_ge_u32 s3, 2
  s_cbranch_scc1 Lh_6
  s_add_u32 m0, s88, s28
  s_nop 0
  buffer_load_dwordx4 v14, s[8:11], s30 offen offset:0 lds
Lh_6:
  v_mfma_f32_16x16x32_bf16 v[228:231], a[68:71], a[20:23], v[228:231]
  s_mov_b32 m0, s88
  ds_read_b128 a[44:47], v17 offset:6144
  ds_read_b128 a[48:51], v17 offset:8192
  v_mfma_f32_16x16x32_bf16 a[132:135], a[68:71], a[24:27], a[132:135]
  v_mfma_f32_16x16x32_bf16 a[164:167], a[68:71], a[28:31], a[164:167]
  ds_read_b128 a[52:55], v17 offset:10240
  v_mfma_f32_16x16x32_bf16 v[72:75], a[72:75], a[0:3], v[72:75]
  v_mfma_f32_16x16x32_bf16 v[104:107], a[72:75], a[4:7], v[104:107]
  v_mfma_f32_16x16x32_bf16 v[136:139], a[72:75], a[8:11], v[136:139]
  ds_read_b128 a[56:59], v17 offset:12288
  v_mfma_f32_16x16x32_bf16 v[168:171], a[72:75], a[12:15], v[168:171]
  buffer_load_dwordx4 v4, s[8:11], s30 offen offset:0 lds
  v_mfma_f32_16x16x32_bf16 v[200:203], a[72:75], a[16:19], v[200:203]
  ds_read_b128 a[60:63], v17 offset:14336
  v_mfma_f32_16x16x32_bf16 v[232:235], a[72:75], a[20:23], v[232:235]
  v_mfma_f32_16x16x32_bf16 a[136:139], a[72:75], a[24:27], a[136:139]
  ds_read_b64_tr_b16 a[100:101], v19 offset:4096
  v_mfma_f32_16x16x32_bf16 a[168:171], a[72:75], a[28:31], a[168:171]
  v_mfma_f32_16x16x32_bf16 v[76:79], a[76:79], a[0:3], v[76:79]
  ds_read_b64_tr_b16 a[102:103], v19 offset:6144
  v_mfma_f32_16x16x32_bf16 v[108:111], a[76:79], a[4:7], v[108:111]
  v_mfma_f32_16x16x32_bf16 v[140:143], a[76:79], a[8:11], v[140:143]
  v_mfma_f32_16x16x32_bf16 v[172:175], a[76:79], a[12:15], v[172:175]
  ds_read_b64_tr_b16 a[104:105], v20 offset:4096
  v_mfma_f32_16x16x32_bf16 v[204:207], a[76:79], a[16:19], v[204:207]
  buffer_load_dwordx4 v5, s[8:11], s30 offen offset:1024 lds
  v_mfma_f32_16x16x32_bf16 v[236:239], a[76:79], a[20:23], v[236:239]
  ds_read_b64_tr_b16 a[106:107], v20 offset:6144
  v_mfma_f32_16x16x32_bf16 a[140:143], a[76:79], a[24:27], a[140:143]
  v_mfma_f32_16x16x32_bf16 a[172:175], a[76:79], a[28:31], a[172:175]
  ds_read_b64_tr_b16 a[108:109], v21 offset:4096
  v_mfma_f32_16x16x32_bf16 v[80:83], a[80:83], a[0:3], v[80:83]
  v_mfma_f32_16x16x32_bf16 v[112:115], a[80:83], a[4:7], v[112:115]
  ds_read_b64_tr_b16 a[110:111], v21 offset:6144
  v_mfma_f32_16x16x32_bf16 v[144:147], a[80:83], a[8:11], v[144:147]
  v_mfma_f32_16x16x32_bf16 v[176:179], a[80:83], a[12:15], v[176:179]
  v_mfma_f32_16x16x32_bf16 v[208:211], a[80:83], a[16:19], v[208:211]
  ds_read_b64_tr_b16 a[112:113], v18 offset:12288
  v_mfma_f32_16x16x32_bf16 v[240:243], a[80:83], a[20:23], v[240:243]
  v_mfma_f32_16x16x32_bf16 a[144:147], a[80:83], a[24:27], a[144:147]
  buffer_load_dwordx4 v6, s[8:11], s30 offen offset:2048 lds
  ds_read_b64_tr_b16 a[114:115], v18 offset:14336
  v_mfma_f32_16x16x32_bf16 a[176:179], a[80:83], a[28:31], a[176:179]
  v_mfma_f32_16x16x32_bf16 v[84:87], a[84:87], a[0:3], v[84:87]
  ds_read_b64_tr_b16 a[116:117], v19 offset:12288
  v_mfma_f32_16x16x32_bf16 v[116:119], a[84:87], a[4:7], v[116:119]
  v_mfma_f32_16x16x32_bf16 v[148:151], a[84:87], a[8:11], v[148:151]
  ds_read_b64_tr_b16 a[118:119], v19 offset:14336
  v_mfma_f32_16x16x32_bf16 v[180:183], a[84:87], a[12:15], v[180:183]
  v_mfma_f32_16x16x32_bf16 v[212:215], a[84:87], a[16:19], v[212:215]
  v_mfma_f32_16x16x32_bf16 v[244:247], a[84:87], a[20:23], v[244:247]
  ds_read_b64_tr_b16 a[120:121], v20 offset:12288
  v_mfma_f32_16x16x32_bf16 a[148:151], a[84:87], a[24:27], a[148:151]
  v_mfma_f32_16x16x32_bf16 a[180:183], a[84:87], a[28:31], a[180:183]
  buffer_load_dwordx4 v7, s[8:11], s30 offen offset:3072 lds
  ds_read_b64_tr_b16 a[122:123], v20 offset:14336
  v_mfma_f32_16x16x32_bf16 v[88:91], a[88:91], a[0:3], v[88:91]
  s_add_u32 s30, s30, 128
  s_and_b32 s30, s30, 2047
  v_mfma_f32_16x16x32_bf16 v[120:123], a[88:91], a[4:7], v[120:123]
  s_add_u32 s36, s36, s38
  s_add_u32 s37, s37, 1
  ds_read_b64_tr_b16 a[124:125], v21 offset:12288
  v_mfma_f32_16x16x32_bf16 v[152:155], a[88:91], a[8:11], v[152:155]
  s_cmp_eq_u32 s37, 3
  s_cselect_b32 s37, 0, s37
  s_cselect_b32 s38, s39, s40
  v_mfma_f32_16x16x32_bf16 v[184:187], a[88:91], a[12:15], v[184:187]
  s_add_u32 s41, s41, s43
  s_sub_u32 s43, 0, s43
  ds_read_b64_tr_b16 a[126:127], v21 offset:14336
  v_mfma_f32_16x16x32_bf16 v[216:219], a[88:91], a[16:19], v[216:219]
  v_add_u32 v16, s38, v16
  v_add_u32 v17, s38, v17
  v_mfma_f32_16x16x32_bf16 v[248:251], a[88:91], a[20:23], v[248:251]
  v_add_u32 v18, s43, v18
  v_add_u32 v19, s43, v19
  v_mfma_f32_16x16x32_bf16 a[152:155], a[88:91], a[24:27], a[152:155]
  v_add_u32 v20, s43, v20
  v_add_u32 v21, s43, v21
  v_mfma_f32_16x16x32_bf16 a[184:187], a[88:91], a[28:31], a[184:187]
  v_mfma_f32_16x16x32_bf16 v[92:95], a[92:95], a[0:3], v[92:95]
  v_mfma_f32_16x16x32_bf16 v[124:127], a[92:95], a[4:7], v[124:127]
  v_mfma_f32_16x16x32_bf16 v[156:159], a[92:95], a[8:11], v[156:159]
  v_mfma_f32_16x16x32_bf16 v[188:191], a[92:95], a[12:15], v[188:191]
  v_mfma_f32_16x16x32_bf16 v[220:223], a[92:95], a[16:19], v[220:223]
  v_mfma_f32_16x16x32_bf16 v[252:255], a[92:95], a[20:23], v[252:255]
  v_mfma_f32_16x16x32_bf16 a[156:159], a[92:95], a[24:27], a[156:159]
  v_mfma_f32_16x16x32_bf16 a[188:191], a[92:95], a[28:31], a[188:191]
  s_waitcnt vmcnt(4) lgkmcnt(0)
  s_barrier
  v_mfma_f32_16x16x32_bf16 v[64:67], a[96:99], a[32:35], v[64:67]
  s_add_u32 m0, s88, s26
  ds_read_b128 a[0:3], v16 offset:0
  v_mfma_f32_16x16x32_bf16 v[96:99], a[96:99], a[36:39], v[96:99]
  buffer_load_dwordx4 v8, s[20:23], s31 offen offset:0 lds
  v_mfma_f32_16x16x32_bf16 v[128:131], a[96:99], a[40:43], v[128:131]
  ds_read_b64_tr_b16 a[64:65], v18 offset:0
  v_mfma_f32_16x16x32_bf16 v[160:163], a[96:99], a[44:47], v[160:163]
  v_mfma_f32_16x16x32_bf16 v[192:195], a[96:99], a[48:51], v[192:195]
  ds_read_b64_tr_b16 a[66:67], v18 offset:2048
  v_mfma_f32_16x16x32_bf16 v[224:227], a[96:99], a[52:55], v[224:227]
  v_mfma_f32_16x16x32_bf16 a[128:131], a[96:99], a[56:59], a[128:131]
  ds_read_b128 a[4:7], v16 offset:2048
  v_mfma_f32_16x16x32_bf16 a[160:163], a[96:99], a[60:63], a[160:163]
  buffer_load_dwordx4 v9, s[20:23], s31 offen offset:1024 lds
  v_mfma_f32_16x16x32_bf16 v[68:71], a[100:103], a[32:35], v[68:71]
  v_mfma_f32_16x16x32_bf16 v[100:103], a[100:103], a[36:39], v[100:103]
  ds_read_b128 a[8:11], v16 offset:4096
  v_mfma_f32_16x16x32_bf16 v[132:135], a[100:103], a[40:43], v[132:135]
  v_mfma_f32_16x16x32_bf16 v[164:167], a[100:103], a[44:47], v[164:167]
  ds_read_b128 a[12:15], v16 offset:6144
  v_mfma_f32_16x16x32_bf16 v[196:199], a[100:103], a[48:51], v[196:199]
  v_mfma_f32_16x16x32_bf16 v[228:231], a[100:103], a[52:55], v[228:231]
  ds_read_b128 a[16:19], v16 offset:8192
  v_mfma_f32_16x16x32_bf16 a[132:135], a[100:103], a[56:59], a[132:135]
  v_mfma_f32_16x16x32_bf16 a[164:167], a[100:103], a[60:63], a[164:167]
  buffer_load_dwordx4 v10, s[20:23], s31 offen offset:2048 lds
  ds_read_b128 a[20:23], v16 offset:10240
  v_mfma_f32_16x16x32_bf16 v[72:75], a[104:107], a[32:35], v[72:75]
  s_add_u32 m0, s88, s27
  v_mfma_f32_16x16x32_bf16 v[104:107], a[104:107], a[36:39], v[104:107]
  v_mfma_f32_16x16x32_bf16 v[136:139], a[104:107], a[40:43], v[136:139]
  ds_read_b128 a[24:27], v16 offset:12288
  v_mfma_f32_16x16x32_bf16 v[168:171], a[104:107], a[44:47], v[168:171]
  v_mfma_f32_16x16x32_bf16 v[200:203], a[104:107], a[48:51], v[200:203]
  ds_read_b128 a[28:31], v16 offset:14336
  v_mfma_f32_16x16x32_bf16 v[232:235], a[104:107], a[52:55], v[232:235]
  v_mfma_f32_16x16x32_bf16 a[136:139], a[104:107], a[56:59], a[136:139]
  ds_read_b64_tr_b16 a[68:69], v19 offset:0
  v_mfma_f32_16x16x32_bf16 a[168:171], a[104:107], a[60:63], a[168:171]
  buffer_load_dwordx4 v11, s[20:23], s31 offen offset:0 lds
  v_mfma_f32_16x16x32_bf16 v[76:79], a[108:111], a[32:35], v[76:79]
  ds_read_b64_tr_b16 a[70:71], v19 offset:2048
  v_mfma_f32_16x16x32_bf16 v[108:111], a[108:111], a[36:39], v[108:111]
  v_mfma_f32_16x16x32_bf16 v[140:143], a[108:111], a[40:43], v[140:143]
  v_mfma_f32_16x16x32_bf16 v[172:175], a[108:111], a[44:47], v[172:175]
  ds_read_b64_tr_b16 a[72:73], v20 offset:0
  v_mfma_f32_16x16x32_bf16 v[204:207], a[108:111], a[48:51], v[204:207]
  v_mfma_f32_16x16x32_bf16 v[236:239], a[108:111], a[52:55], v[236:239]
  ds_read_b64_tr_b16 a[74:75], v20 offset:2048
  v_mfma_f32_16x16x32_bf16 a[140:143], a[108:111], a[56:59], a[140:143]
  v_mfma_f32_16x16x32_bf16 a[172:175], a[108:111], a[60:63], a[172:175]
  buffer_load_dwordx4 v12, s[20:23], s31 offen offset:1024 lds
  ds_read_b64_tr_b16 a[76:77], v21 offset:0
  v_mfma_f32_16x16x32_bf16 v[80:83], a[112:115], a[32:35], v[80:83]
  v_mfma_f32_16x16x32_bf16 v[112:115], a[112:115], a[36:39], v[112:115]
  ds_read_b64_tr_b16 a[78:79], v21 offset:2048
  v_mfma_f32_16x16x32_bf16 v[144:147], a[112:115], a[40:43], v[144:147]
  v_mfma_f32_16x16x32_bf16 v[176:179], a[112:115], a[44:47], v[176:179]
  v_mfma_f32_16x16x32_bf16 v[208:211], a[112:115], a[48:51], v[208:211]
  ds_read_b64_tr_b16 a[80:81], v18 offset:8192
  v_mfma_f32_16x16x32_bf16 v[240:243], a[112:115], a[52:55], v[240:243]
  v_mfma_f32_16x16x32_bf16 a[144:147], a[112:115], a[56:59], a[144:147]
  ds_read_b64_tr_b16 a[82:83], v18 offset:10240
  v_mfma_f32_16x16x32_bf16 a[176:179], a[112:115], a[60:63], a[176:179]
  buffer_load_dwordx4 v13, s[20:23], s31 offen offset:2048 lds
  v_mfma_f32_16x16x32_bf16 v[84:87], a[116:119], a[32:35], v[84:87]
  s_add_u32 s31, s31, 393216
  s_cmp_ge_u32 s31, 6291456
  s_cselect_b32 s29, 6291456, 0
  v_mfma_f32_16x16x32_bf16 v[116:119], a[116:119], a[36:39], v[116:119]
  s_sub_u32 s31, s31, s29
  s_cmp_ge_u32 s3, 2
  s_cbranch_scc1 Lh_7
  s_add_u32 m0, s88, s28
  s_add_u32 m0, m0, 43008
  s_nop 0
  buffer_load_dwordx4 v14, s[8:11], s30 offen offset:0 lds
Lh_7:
  v_mfma_f32_16x16x32_bf16 v[148:151], a[116:119], a[40:43], v[148:151]
  s_add_u32 m0, s88, 43008
  ds_read_b64_tr_b16 a[84:85], v19 offset:8192
  ds_read_b64_tr_b16 a[86:87], v19 offset:10240
  v_mfma_f32_16x16x32_bf16 v[180:183], a[116:119], a[44:47], v[180:183]
  v_mfma_f32_16x16x32_bf16 v[212:215], a[116:119], a[48:51], v[212:215]
  v_mfma_f32_16x16x32_bf16 v[244:247], a[116:119], a[52:55], v[244:247]
  ds_read_b64_tr_b16 a[88:89], v20 offset:8192
  v_mfma_f32_16x16x32_bf16 a[148:151], a[116:119], a[56:59], a[148:151]
  v_mfma_f32_16x16x32_bf16 a[180:183], a[116:119], a[60:63], a[180:183]
  buffer_load_dwordx4 v4, s[8:11], s30 offen offset:0 lds
  ds_read_b64_tr_b16 a[90:91], v20 offset:10240
  v_mfma_f32_16x16x32_bf16 v[88:91], a[120:123], a[32:35], v[88:91]
  v_mfma_f32_16x16x32_bf16 v[120:123], a[120:123], a[36:39], v[120:123]
  ds_read_b64_tr_b16 a[92:93], v21 offset:8192
  v_mfma_f32_16x16x32_bf16 v[152:155], a[120:123], a[40:43], v[152:155]
  v_mfma_f32_16x16x32_bf16 v[184:187], a[120:123], a[44:47], v[184:187]
  ds_read_b64_tr_b16 a[94:95], v21 offset:10240
  v_mfma_f32_16x16x32_bf16 v[216:219], a[120:123], a[48:51], v[216:219]
  v_mfma_f32_16x16x32_bf16 v[248:251], a[120:123], a[52:55], v[248:251]
  v_mfma_f32_16x16x32_bf16 a[152:155], a[120:123], a[56:59], a[152:155]
  v_mfma_f32_16x16x32_bf16 a[184:187], a[120:123], a[60:63], a[184:187]
  buffer_load_dwordx4 v5, s[8:11], s30 offen offset:1024 lds
  v_mfma_f32_16x16x32_bf16 v[92:95], a[124:127], a[32:35], v[92:95]
  v_mfma_f32_16x16x32_bf16 v[124:127], a[124:127], a[36:39], v[124:127]
  v_mfma_f32_16x16x32_bf16 v[156:159], a[124:127], a[40:43], v[156:159]
  v_mfma_f32_16x16x32_bf16 v[188:191], a[124:127], a[44:47], v[188:191]
  v_mfma_f32_16x16x32_bf16 v[220:223], a[124:127], a[48:51], v[220:223]
  v_mfma_f32_16x16x32_bf16 v[252:255], a[124:127], a[52:55], v[252:255]
  v_mfma_f32_16x16x32_bf16 a[156:159], a[124:127], a[56:59], a[156:159]
  v_mfma_f32_16x16x32_bf16 a[188:191], a[124:127], a[60:63], a[188:191]
  s_waitcnt lgkmcnt(0)
  v_mfma_f32_16x16x32_bf16 v[64:67], a[64:67], a[0:3], v[64:67]
  buffer_load_dwordx4 v6, s[8:11], s30 offen offset:2048 lds
  ds_read_b128 a[32:35], v17 offset:0
  v_mfma_f32_16x16x32_bf16 v[96:99], a[64:67], a[4:7], v[96:99]
  v_mfma_f32_16x16x32_bf16 v[128:131], a[64:67], a[8:11], v[128:131]
  ds_read_b64_tr_b16 a[96:97], v18 offset:4096
  v_mfma_f32_16x16x32_bf16 v[160:163], a[64:67], a[12:15], v[160:163]
  v_mfma_f32_16x16x32_bf16 v[192:195], a[64:67], a[16:19], v[192:195]
  ds_read_b64_tr_b16 a[98:99], v18 offset:6144
  v_mfma_f32_16x16x32_bf16 v[224:227], a[64:67], a[20:23], v[224:227]
  v_mfma_f32_16x16x32_bf16 a[128:131], a[64:67], a[24:27], a[128:131]
  ds_read_b128 a[36:39], v17 offset:2048
  v_mfma_f32_16x16x32_bf16 a[160:163], a[64:67], a[28:31], a[160:163]
  buffer_load_dwordx4 v7, s[8:11], s30 offen offset:3072 lds
  v_mfma_f32_16x16x32_bf16 v[68:71], a[68:71], a[0:3], v[68:71]
  s_add_u32 s30, s30, 128
  s_and_b32 s30, s30, 2047
  s_add_u32 m0, s88, s26
  s_add_u32 m0, m0, 43008
  v_mfma_f32_16x16x32_bf16 v[100:103], a[68:71], a[4:7], v[100:103]
  ds_read_b128 a[40:43], v17 offset:4096
  v_mfma_f32_16x16x32_bf16 v[132:135], a[68:71], a[8:11], v[132:135]
  v_mfma_f32_16x16x32_bf16 v[164:167], a[68:71], a[12:15], v[164:167]
  ds_read_b128 a[44:47], v17 offset:6144
  v_mfma_f32_16x16x32_bf16 v[196:199], a[68:71], a[16:19], v[196:199]
  v_mfma_f32_16x16x32_bf16 v[228:231], a[68:71], a[20:23], v[228:231]
  ds_read_b128 a[48:51], v17 offset:8192
  v_mfma_f32_16x16x32_bf16 a[132:135], a[68:71], a[24:27], a[132:135]
  v_mfma_f32_16x16x32_bf16 a[164:167], a[68:71], a[28:31], a[164:167]
  buffer_load_dwordx4 v8, s[20:23], s31 offen offset:0 lds
  ds_read_b128 a[52:55], v17 offset:10240
  v_mfma_f32_16x16x32_bf16 v[72:75], a[72:75], a[0:3], v[72:75]
  v_mfma_f32_16x16x32_bf16 v[104:107], a[72:75], a[4:7], v[104:107]
  v_mfma_f32_16x16x32_bf16 v[136:139], a[72:75], a[8:11], v[136:139]
  ds_read_b128 a[56:59], v17 offset:12288
  v_mfma_f32_16x16x32_bf16 v[168:171], a[72:75], a[12:15], v[168:171]
  v_mfma_f32_16x16x32_bf16 v[200:203], a[72:75], a[16:19], v[200:203]
  ds_read_b128 a[60:63], v17 offset:14336
  v_mfma_f32_16x16x32_bf16 v[232:235], a[72:75], a[20:23], v[232:235]
  v_mfma_f32_16x16x32_bf16 a[136:139], a[72:75], a[24:27], a[136:139]
  ds_read_b64_tr_b16 a[100:101], v19 offset:4096
  v_mfma_f32_16x16x32_bf16 a[168:171], a[72:75], a[28:31], a[168:171]
  buffer_load_dwordx4 v9, s[20:23], s31 offen offset:1024 lds
  v_mfma_f32_16x16x32_bf16 v[76:79], a[76:79], a[0:3], v[76:79]
  ds_read_b64_tr_b16 a[102:103], v19 offset:6144
  v_mfma_f32_16x16x32_bf16 v[108:111], a[76:79], a[4:7], v[108:111]
  v_mfma_f32_16x16x32_bf16 v[140:143], a[76:79], a[8:11], v[140:143]
  v_mfma_f32_16x16x32_bf16 v[172:175], a[76:79], a[12:15], v[172:175]
  ds_read_b64_tr_b16 a[104:105], v20 offset:4096
  v_mfma_f32_16x16x32_bf16 v[204:207], a[76:79], a[16:19], v[204:207]
  v_mfma_f32_16x16x32_bf16 v[236:239], a[76:79], a[20:23], v[236:239]
  ds_read_b64_tr_b16 a[106:107], v20 offset:6144
  v_mfma_f32_16x16x32_bf16 a[140:143], a[76:79], a[24:27], a[140:143]
  v_mfma_f32_16x16x32_bf16 a[172:175], a[76:79], a[28:31], a[172:175]
  buffer_load_dwordx4 v10, s[20:23], s31 offen offset:2048 lds
  ds_read_b64_tr_b16 a[108:109], v21 offset:4096
  v_mfma_f32_16x16x32_bf16 v[80:83], a[80:83], a[0:3], v[80:83]
  s_add_u32 m0, s88, s27
  s_add_u32 m0, m0, 43008
  v_mfma_f32_16x16x32_bf16 v[112:115], a[80:83], a[4:7], v[112:115]
  ds_read_b64_tr_b16 a[110:111], v21 offset:6144
  v_mfma_f32_16x16x32_bf16 v[144:147], a[80:83], a[8:11], v[144:147]
  v_mfma_f32_16x16x32_bf16 v[176:179], a[80:83], a[12:15], v[176:179]
  v_mfma_f32_16x16x32_bf16 v[208:211], a[80:83], a[16:19], v[208:211]
  ds_read_b64_tr_b16 a[112:113], v18 offset:12288
  v_mfma_f32_16x16x32_bf16 v[240:243], a[80:83], a[20:23], v[240:243]
  v_mfma_f32_16x16x32_bf16 a[144:147], a[80:83], a[24:27], a[144:147]
  ds_read_b64_tr_b16 a[114:115], v18 offset:14336
  v_mfma_f32_16x16x32_bf16 a[176:179], a[80:83], a[28:31], a[176:179]
  buffer_load_dwordx4 v11, s[20:23], s31 offen offset:0 lds
  v_mfma_f32_16x16x32_bf16 v[84:87], a[84:87], a[0:3], v[84:87]
  ds_read_b64_tr_b16 a[116:117], v19 offset:12288
  v_mfma_f32_16x16x32_bf16 v[116:119], a[84:87], a[4:7], v[116:119]
  v_mfma_f32_16x16x32_bf16 v[148:151], a[84:87], a[8:11], v[148:151]
  ds_read_b64_tr_b16 a[118:119], v19 offset:14336
  v_mfma_f32_16x16x32_bf16 v[180:183], a[84:87], a[12:15], v[180:183]
  v_mfma_f32_16x16x32_bf16 v[212:215], a[84:87], a[16:19], v[212:215]
  v_mfma_f32_16x16x32_bf16 v[244:247], a[84:87], a[20:23], v[244:247]
  ds_read_b64_tr_b16 a[120:121], v20 offset:12288
  v_mfma_f32_16x16x32_bf16 a[148:151], a[84:87], a[24:27], a[148:151]
  v_mfma_f32_16x16x32_bf16 a[180:183], a[84:87], a[28:31], a[180:183]
  buffer_load_dwordx4 v12, s[20:23], s31 offen offset:1024 lds
  ds_read_b64_tr_b16 a[122:123], v20 offset:14336
  v_mfma_f32_16x16x32_bf16 v[88:91], a[88:91], a[0:3], v[88:91]
  v_mfma_f32_16x16x32_bf16 v[120:123], a[88:91], a[4:7], v[120:123]
  ds_read_b64_tr_b16 a[124:125], v21 offset:12288
  v_mfma_f32_16x16x32_bf16 v[152:155], a[88:91], a[8:11], v[152:155]
  v_mfma_f32_16x16x32_bf16 v[184:187], a[88:91], a[12:15], v[184:187]
  ds_read_b64_tr_b16 a[126:127], v21 offset:14336
  v_mfma_f32_16x16x32_bf16 v[216:219], a[88:91], a[16:19], v[216:219]
  v_mfma_f32_16x16x32_bf16 v[248:251], a[88:91], a[20:23], v[248:251]
  v_mfma_f32_16x16x32_bf16 a[152:155], a[88:91], a[24:27], a[152:155]
  v_mfma_f32_16x16x32_bf16 a[184:187], a[88:91], a[28:31], a[184:187]
  buffer_load_dwordx4 v13, s[20:23], s31 offen offset:2048 lds
  v_mfma_f32_16x16x32_bf16 v[92:95], a[92:95], a[0:3], v[92:95]
  s_add_u32 s31, s31, 393216
  s_cmp_ge_u32 s31, 6291456
  s_cselect_b32 s29, 6291456, 0
  v_mfma_f32_16x16x32_bf16 v[124:127], a[92:95], a[4:7], v[124:127]
  s_sub_u32 s31, s31, s29
  v_mfma_f32_16x16x32_bf16 v[156:159], a[92:95], a[8:11], v[156:159]
  v_mfma_f32_16x16x32_bf16 v[188:191], a[92:95], a[12:15], v[188:191]
  v_mfma_f32_16x16x32_bf16 v[220:223], a[92:95], a[16:19], v[220:223]
  v_mfma_f32_16x16x32_bf16 v[252:255], a[92:95], a[20:23], v[252:255]
  v_mfma_f32_16x16x32_bf16 a[156:159], a[92:95], a[24:27], a[156:159]
  v_mfma_f32_16x16x32_bf16 a[188:191], a[92:95], a[28:31], a[188:191]
  s_mov_b32 s12, s84
  s_mov_b32 s13, s85
  s_mov_b32 s14, 256
  s_mov_b32 s15, 0x00020000
  buffer_load_dwordx2 v[22:23], off, s[12:15], 0 sc1
  s_waitcnt lgkmcnt(0)
  s_barrier
  v_mfma_f32_16x16x32_bf16 v[64:67], a[96:99], a[32:35], v[64:67]
  s_cmp_ge_u32 s3, 2
  s_cbranch_scc1 Lh_8
  s_add_u32 m0, s88, s28
  s_add_u32 m0, m0, 86016
  s_nop 0
  buffer_load_dwordx4 v14, s[8:11], s30 offen offset:0 lds
Lh_8:
  v_mfma_f32_16x16x32_bf16 v[96:99], a[96:99], a[36:39], v[96:99]
  s_add_u32 m0, s88, 86016
  v_mfma_f32_16x16x32_bf16 v[128:131], a[96:99], a[40:43], v[128:131]
  buffer_load_dwordx4 v4, s[8:11], s30 offen offset:0 lds
  v_mfma_f32_16x16x32_bf16 v[160:163], a[96:99], a[44:47], v[160:163]
  v_mfma_f32_16x16x32_bf16 v[192:195], a[96:99], a[48:51], v[192:195]
  v_mfma_f32_16x16x32_bf16 v[224:227], a[96:99], a[52:55], v[224:227]
  v_mfma_f32_16x16x32_bf16 a[128:131], a[96:99], a[56:59], a[128:131]
  buffer_load_dwordx4 v5, s[8:11], s30 offen offset:1024 lds
  v_mfma_f32_16x16x32_bf16 a[160:163], a[96:99], a[60:63], a[160:163]
  v_mfma_f32_16x16x32_bf16 v[68:71], a[100:103], a[32:35], v[68:71]
  v_mfma_f32_16x16x32_bf16 v[100:103], a[100:103], a[36:39], v[100:103]
  v_mfma_f32_16x16x32_bf16 v[132:135], a[100:103], a[40:43], v[132:135]
  v_mfma_f32_16x16x32_bf16 v[164:167], a[100:103], a[44:47], v[164:167]
  v_mfma_f32_16x16x32_bf16 v[196:199], a[100:103], a[48:51], v[196:199]
  buffer_load_dwordx4 v6, s[8:11], s30 offen offset:2048 lds
  v_mfma_f32_16x16x32_bf16 v[228:231], a[100:103], a[52:55], v[228:231]
  v_mfma_f32_16x16x32_bf16 a[132:135], a[100:103], a[56:59], a[132:135]
  v_mfma_f32_16x16x32_bf16 a[164:167], a[100:103], a[60:63], a[164:167]
  v_mfma_f32_16x16x32_bf16 v[72:75], a[104:107], a[32:35], v[72:75]
  v_mfma_f32_16x16x32_bf16 v[104:107], a[104:107], a[36:39], v[104:107]
  v_mfma_f32_16x16x32_bf16 v[136:139], a[104:107], a[40:43], v[136:139]
  buffer_load_dwordx4 v7, s[8:11], s30 offen offset:3072 lds
  v_mfma_f32_16x16x32_bf16 v[168:171], a[104:107], a[44:47], v[168:171]
  s_add_u32 s30, s30, 128
  s_and_b32 s30, s30, 2047
  s_add_u32 m0, s88, s26
  s_add_u32 m0, m0, 86016
  v_mfma_f32_16x16x32_bf16 v[200:203], a[104:107], a[48:51], v[200:203]
  v_mfma_f32_16x16x32_bf16 v[232:235], a[104:107], a[52:55], v[232:235]
  v_mfma_f32_16x16x32_bf16 a[136:139], a[104:107], a[56:59], a[136:139]
  v_mfma_f32_16x16x32_bf16 a[168:171], a[104:107], a[60:63], a[168:171]
  v_mfma_f32_16x16x32_bf16 v[76:79], a[108:111], a[32:35], v[76:79]
  v_mfma_f32_16x16x32_bf16 v[108:111], a[108:111], a[36:39], v[108:111]
  buffer_load_dwordx4 v8, s[20:23], s31 offen offset:0 lds
  v_mfma_f32_16x16x32_bf16 v[140:143], a[108:111], a[40:43], v[140:143]
  v_mfma_f32_16x16x32_bf16 v[172:175], a[108:111], a[44:47], v[172:175]
  v_mfma_f32_16x16x32_bf16 v[204:207], a[108:111], a[48:51], v[204:207]
  v_mfma_f32_16x16x32_bf16 v[236:239], a[108:111], a[52:55], v[236:239]
  v_mfma_f32_16x16x32_bf16 a[140:143], a[108:111], a[56:59], a[140:143]
  v_mfma_f32_16x16x32_bf16 a[172:175], a[108:111], a[60:63], a[172:175]
  buffer_load_dwordx4 v9, s[20:23], s31 offen offset:1024 lds
  v_mfma_f32_16x16x32_bf16 v[80:83], a[112:115], a[32:35], v[80:83]
  v_mfma_f32_16x16x32_bf16 v[112:115], a[112:115], a[36:39], v[112:115]
  v_mfma_f32_16x16x32_bf16 v[144:147], a[112:115], a[40:43], v[144:147]
  v_mfma_f32_16x16x32_bf16 v[176:179], a[112:115], a[44:47], v[176:179]
  v_mfma_f32_16x16x32_bf16 v[208:211], a[112:115], a[48:51], v[208:211]
  v_mfma_f32_16x16x32_bf16 v[240:243], a[112:115], a[52:55], v[240:243]
  buffer_load_dwordx4 v10, s[20:23], s31 offen offset:2048 lds
  v_mfma_f32_16x16x32_bf16 a[144:147], a[112:115], a[56:59], a[144:147]
  s_add_u32 m0, s88, s27
  s_add_u32 m0, m0, 86016
  v_mfma_f32_16x16x32_bf16 a[176:179], a[112:115], a[60:63], a[176:179]
  v_mfma_f32_16x16x32_bf16 v[84:87], a[116:119], a[32:35], v[84:87]
  v_mfma_f32_16x16x32_bf16 v[116:119], a[116:119], a[36:39], v[116:119]
  v_mfma_f32_16x16x32_bf16 v[148:151], a[116:119], a[40:43], v[148:151]
  v_mfma_f32_16x16x32_bf16 v[180:183], a[116:119], a[44:47], v[180:183]
  v_mfma_f32_16x16x32_bf16 v[212:215], a[116:119], a[48:51], v[212:215]
  buffer_load_dwordx4 v11, s[20:23], s31 offen offset:0 lds
  v_mfma_f32_16x16x32_bf16 v[244:247], a[116:119], a[52:55], v[244:247]
  v_mfma_f32_16x16x32_bf16 a[148:151], a[116:119], a[56:59], a[148:151]
  v_mfma_f32_16x16x32_bf16 a[180:183], a[116:119], a[60:63], a[180:183]
  v_mfma_f32_16x16x32_bf16 v[88:91], a[120:123], a[32:35], v[88:91]
  v_mfma_f32_16x16x32_bf16 v[120:123], a[120:123], a[36:39], v[120:123]
  v_mfma_f32_16x16x32_bf16 v[152:155], a[120:123], a[40:43], v[152:155]
  buffer_load_dwordx4 v12, s[20:23], s31 offen offset:1024 lds
  v_mfma_f32_16x16x32_bf16 v[184:187], a[120:123], a[44:47], v[184:187]
  v_mfma_f32_16x16x32_bf16 v[216:219], a[120:123], a[48:51], v[216:219]
  v_mfma_f32_16x16x32_bf16 v[248:251], a[120:123], a[52:55], v[248:251]
  v_mfma_f32_16x16x32_bf16 a[152:155], a[120:123], a[56:59], a[152:155]
  v_mfma_f32_16x16x32_bf16 a[184:187], a[120:123], a[60:63], a[184:187]
  v_mfma_f32_16x16x32_bf16 v[92:95], a[124:127], a[32:35], v[92:95]
  buffer_load_dwordx4 v13, s[20:23], s31 offen offset:2048 lds
  v_mfma_f32_16x16x32_bf16 v[124:127], a[124:127], a[36:39], v[124:127]
  s_add_u32 s31, s31, 393216
  s_cmp_ge_u32 s31, 6291456
  s_cselect_b32 s29, 6291456, 0
  v_mfma_f32_16x16x32_bf16 v[156:159], a[124:127], a[40:43], v[156:159]
  s_sub_u32 s31, s31, s29
  v_mfma_f32_16x16x32_bf16 v[188:191], a[124:127], a[44:47], v[188:191]
  v_mfma_f32_16x16x32_bf16 v[220:223], a[124:127], a[48:51], v[220:223]
  v_mfma_f32_16x16x32_bf16 v[252:255], a[124:127], a[52:55], v[252:255]
  v_mfma_f32_16x16x32_bf16 a[156:159], a[124:127], a[56:59], a[156:159]
  v_mfma_f32_16x16x32_bf16 a[188:191], a[124:127], a[60:63], a[188:191]
  v_cvt_pk_bf16_f32 v128, v128, v129
  v_cvt_pk_bf16_f32 v129, v130, v131
  v_cvt_pk_bf16_f32 v130, v132, v133
  v_cvt_pk_bf16_f32 v131, v134, v135
  v_cvt_pk_bf16_f32 v132, v136, v137
  v_cvt_pk_bf16_f32 v133, v138, v139
  v_cvt_pk_bf16_f32 v134, v140, v141
  v_cvt_pk_bf16_f32 v135, v142, v143
  v_cvt_pk_bf16_f32 v136, v144, v145
  v_cvt_pk_bf16_f32 v137, v146, v147
  s_add_u32 s60, s63, 8192
  buffer_store_dwordx4 v[128:131], v2, s[16:19], s60 offen offset:0 sc1
  v_cvt_pk_bf16_f32 v138, v148, v149
  v_cvt_pk_bf16_f32 v139, v150, v151
  v_cvt_pk_bf16_f32 v140, v152, v153
  v_cvt_pk_bf16_f32 v141, v154, v155
  v_cvt_pk_bf16_f32 v142, v156, v157
  v_cvt_pk_bf16_f32 v143, v158, v159
  v_cvt_pk_bf16_f32 v144, v160, v161
  v_cvt_pk_bf16_f32 v145, v162, v163
  v_cvt_pk_bf16_f32 v146, v164, v165
  v_cvt_pk_bf16_f32 v147, v166, v167
  v_cvt_pk_bf16_f32 v148, v168, v169
  v_cvt_pk_bf16_f32 v149, v170, v171
  v_cvt_pk_bf16_f32 v150, v172, v173
  v_cvt_pk_bf16_f32 v151, v174, v175
  v_cvt_pk_bf16_f32 v152, v176, v177
  v_cvt_pk_bf16_f32 v153, v178, v179
  v_cvt_pk_bf16_f32 v154, v180, v181
  v_cvt_pk_bf16_f32 v155, v182, v183
  v_cvt_pk_bf16_f32 v156, v184, v185
  v_cvt_pk_bf16_f32 v157, v186, v187
  v_cvt_pk_bf16_f32 v158, v188, v189
  v_cvt_pk_bf16_f32 v159, v190, v191
  v_cvt_pk_bf16_f32 v192, v192, v193
  v_cvt_pk_bf16_f32 v193, v194, v195
  v_cvt_pk_bf16_f32 v194, v196, v197
  v_cvt_pk_bf16_f32 v195, v198, v199
  v_cvt_pk_bf16_f32 v196, v200, v201
  v_cvt_pk_bf16_f32 v197, v202, v203
  v_cvt_pk_bf16_f32 v198, v204, v205
  v_cvt_pk_bf16_f32 v199, v206, v207
  v_cvt_pk_bf16_f32 v200, v208, v209
  v_cvt_pk_bf16_f32 v201, v210, v211
  v_cvt_pk_bf16_f32 v202, v212, v213
  v_cvt_pk_bf16_f32 v203, v214, v215
  v_cvt_pk_bf16_f32 v204, v216, v217
  v_cvt_pk_bf16_f32 v205, v218, v219
  v_cvt_pk_bf16_f32 v206, v220, v221
  v_cvt_pk_bf16_f32 v207, v222, v223
  v_cvt_pk_bf16_f32 v208, v224, v225
  v_cvt_pk_bf16_f32 v209, v226, v227
  v_cvt_pk_bf16_f32 v210, v228, v229
  v_cvt_pk_bf16_f32 v211, v230, v231
  v_cvt_pk_bf16_f32 v212, v232, v233
  v_cvt_pk_bf16_f32 v213, v234, v235
  v_cvt_pk_bf16_f32 v214, v236, v237
  v_cvt_pk_bf16_f32 v215, v238, v239
  v_cvt_pk_bf16_f32 v216, v240, v241
  v_cvt_pk_bf16_f32 v217, v242, v243
  v_cvt_pk_bf16_f32 v218, v244, v245
  v_cvt_pk_bf16_f32 v219, v246, v247
  v_cvt_pk_bf16_f32 v220, v248, v249
  v_cvt_pk_bf16_f32 v221, v250, v251
  v_cvt_pk_bf16_f32 v222, v252, v253
  v_cvt_pk_bf16_f32 v223, v254, v255
  v_cvt_pk_bf16_f32 v160, v64, v65
  v_cvt_pk_bf16_f32 v161, v66, v67
  v_cvt_pk_bf16_f32 v162, v68, v69
  buffer_store_dwordx4 v[132:135], v2, s[16:19], s60 offen offset:1024 sc1
  v_cvt_pk_bf16_f32 v163, v70, v71
  v_cvt_pk_bf16_f32 v164, v72, v73
  v_cvt_pk_bf16_f32 v165, v74, v75
  v_cvt_pk_bf16_f32 v166, v76, v77
  v_cvt_pk_bf16_f32 v167, v78, v79
  v_cvt_pk_bf16_f32 v168, v80, v81
  v_cvt_pk_bf16_f32 v169, v82, v83
  v_cvt_pk_bf16_f32 v170, v84, v85
  v_cvt_pk_bf16_f32 v171, v86, v87
  v_cvt_pk_bf16_f32 v172, v88, v89
  v_cvt_pk_bf16_f32 v173, v90, v91
  v_cvt_pk_bf16_f32 v174, v92, v93
  v_cvt_pk_bf16_f32 v175, v94, v95
  v_cvt_pk_bf16_f32 v176, v96, v97
  v_cvt_pk_bf16_f32 v177, v98, v99
  v_cvt_pk_bf16_f32 v178, v100, v101
  v_cvt_pk_bf16_f32 v179, v102, v103
  v_cvt_pk_bf16_f32 v180, v104, v105
  v_cvt_pk_bf16_f32 v181, v106, v107
  v_cvt_pk_bf16_f32 v182, v108, v109
  v_cvt_pk_bf16_f32 v183, v110, v111
  v_cvt_pk_bf16_f32 v184, v112, v113
  v_cvt_pk_bf16_f32 v185, v114, v115
  v_cvt_pk_bf16_f32 v186, v116, v117
  v_cvt_pk_bf16_f32 v187, v118, v119
  v_cvt_pk_bf16_f32 v188, v120, v121
  v_cvt_pk_bf16_f32 v189, v122, v123
  v_cvt_pk_bf16_f32 v190, v124, v125
  v_cvt_pk_bf16_f32 v191, v126, v127
  v_accvgpr_read_b32 v64, a128
  v_accvgpr_read_b32 v65, a129
  v_accvgpr_read_b32 v66, a130
  v_accvgpr_read_b32 v67, a131
  v_accvgpr_read_b32 v68, a132
  v_accvgpr_read_b32 v69, a133
  v_accvgpr_read_b32 v70, a134
  v_accvgpr_read_b32 v71, a135
  v_cvt_pk_bf16_f32 v224, v64, v65
  v_cvt_pk_bf16_f32 v225, v66, v67
  v_cvt_pk_bf16_f32 v226, v68, v69
  v_cvt_pk_bf16_f32 v227, v70, v71
  v_accvgpr_read_b32 v72, a136
  v_accvgpr_read_b32 v73, a137
  v_accvgpr_read_b32 v74, a138
  v_accvgpr_read_b32 v75, a139
  v_accvgpr_read_b32 v76, a140
  v_accvgpr_read_b32 v77, a141
  v_accvgpr_read_b32 v78, a142
  v_accvgpr_read_b32 v79, a143
  v_cvt_pk_bf16_f32 v228, v72, v73
  v_cvt_pk_bf16_f32 v229, v74, v75
  v_cvt_pk_bf16_f32 v230, v76, v77
  v_cvt_pk_bf16_f32 v231, v78, v79
  v_accvgpr_read_b32 v80, a144
  v_accvgpr_read_b32 v81, a145
  v_accvgpr_read_b32 v82, a146
  v_accvgpr_read_b32 v83, a147
  buffer_store_dwordx4 v[136:139], v2, s[16:19], s60 offen offset:2048 sc1
  v_accvgpr_read_b32 v84, a148
  v_accvgpr_read_b32 v85, a149
  v_accvgpr_read_b32 v86, a150
  v_accvgpr_read_b32 v87, a151
  v_cvt_pk_bf16_f32 v232, v80, v81
  v_cvt_pk_bf16_f32 v233, v82, v83
  v_cvt_pk_bf16_f32 v234, v84, v85
  v_cvt_pk_bf16_f32 v235, v86, v87
  v_accvgpr_read_b32 v88, a152
  v_accvgpr_read_b32 v89, a153
  v_accvgpr_read_b32 v90, a154
  v_accvgpr_read_b32 v91, a155
  v_accvgpr_read_b32 v92, a156
  v_accvgpr_read_b32 v93, a157
  v_accvgpr_read_b32 v94, a158
  v_accvgpr_read_b32 v95, a159
  v_cvt_pk_bf16_f32 v236, v88, v89
  v_cvt_pk_bf16_f32 v237, v90, v91
  v_cvt_pk_bf16_f32 v238, v92, v93
  v_cvt_pk_bf16_f32 v239, v94, v95
  v_accvgpr_read_b32 v96, a160
  v_accvgpr_read_b32 v97, a161
  v_accvgpr_read_b32 v98, a162
  v_accvgpr_read_b32 v99, a163
  v_accvgpr_read_b32 v100, a164
  v_accvgpr_read_b32 v101, a165
  v_accvgpr_read_b32 v102, a166
  v_accvgpr_read_b32 v103, a167
  v_cvt_pk_bf16_f32 v240, v96, v97
  v_cvt_pk_bf16_f32 v241, v98, v99
  v_cvt_pk_bf16_f32 v242, v100, v101
  v_cvt_pk_bf16_f32 v243, v102, v103
  v_accvgpr_read_b32 v104, a168
  v_accvgpr_read_b32 v105, a169
  v_accvgpr_read_b32 v106, a170
  v_accvgpr_read_b32 v107, a171
  v_accvgpr_read_b32 v108, a172
  v_accvgpr_read_b32 v109, a173
  v_accvgpr_read_b32 v110, a174
  v_accvgpr_read_b32 v111, a175
  v_cvt_pk_bf16_f32 v244, v104, v105
  v_cvt_pk_bf16_f32 v245, v106, v107
  v_cvt_pk_bf16_f32 v246, v108, v109
  v_cvt_pk_bf16_f32 v247, v110, v111
  v_accvgpr_read_b32 v112, a176
  v_accvgpr_read_b32 v113, a177
  v_accvgpr_read_b32 v114, a178
  v_accvgpr_read_b32 v115, a179
  v_accvgpr_read_b32 v116, a180
  v_accvgpr_read_b32 v117, a181
  v_accvgpr_read_b32 v118, a182
  v_accvgpr_read_b32 v119, a183
  v_cvt_pk_bf16_f32 v248, v112, v113
  v_cvt_pk_bf16_f32 v249, v114, v115
  v_cvt_pk_bf16_f32 v250, v116, v117
  v_cvt_pk_bf16_f32 v251, v118, v119
  v_accvgpr_read_b32 v120, a184
  v_accvgpr_read_b32 v121, a185
  v_accvgpr_read_b32 v122, a186
  v_accvgpr_read_b32 v123, a187
  v_accvgpr_read_b32 v124, a188
  v_accvgpr_read_b32 v125, a189
  v_accvgpr_read_b32 v126, a190
  v_accvgpr_read_b32 v127, a191
  v_cvt_pk_bf16_f32 v252, v120, v121
  v_cvt_pk_bf16_f32 v253, v122, v123
  v_cvt_pk_bf16_f32 v254, v124, v125
  v_cvt_pk_bf16_f32 v255, v126, v127
Lp2:
  s_mov_b32 s89, 0
  s_mov_b32 s91, 4294881280
  s_mov_b32 s92, 43008
  v_accvgpr_read_b32 v16, a216
  v_accvgpr_read_b32 v17, a217
  v_accvgpr_read_b32 v18, a218
  v_accvgpr_read_b32 v19, a219
  v_accvgpr_read_b32 v20, a220
  v_accvgpr_read_b32 v21, a221
  s_cmp_ge_u32 s3, 2
  s_cbranch_scc1 Lp2_r1
  s_waitcnt vmcnt(26)
  s_barrier
  ds_read_b128 a[0:3], v16 offset:0
  ds_read_b64_tr_b16 a[40:41], v20 offset:18432
  ds_read_b64_tr_b16 a[42:43], v20 offset:20480
  ds_read_b128 a[4:7], v16 offset:2048
  ds_read_b128 a[8:11], v16 offset:4096
  ds_read_b128 a[12:15], v16 offset:6144
  ds_read_b64_tr_b16 a[44:45], v21 offset:18432
  ds_read_b64_tr_b16 a[46:47], v21 offset:20480
  ds_read_b64_tr_b16 a[48:49], v20 offset:26624
  ds_read_b64_tr_b16 a[50:51], v20 offset:28672
  ds_read_b128 a[16:19], v18 offset:0
  ds_read_b64_tr_b16 a[52:53], v21 offset:26624
  ds_read_b64_tr_b16 a[54:55], v21 offset:28672
  ds_read_b64_tr_b16 a[56:57], v20 offset:34816
  ds_read_b64_tr_b16 a[58:59], v20 offset:36864
  ds_read_b64_tr_b16 a[60:61], v21 offset:34816
  ds_read_b64_tr_b16 a[62:63], v21 offset:36864
  s_waitcnt lgkmcnt(0)
  v_mfma_f32_16x16x32_bf16 v[24:27], a[40:43], a[0:3], 0
  s_add_u32 s60, s63, 8192
  buffer_store_dwordx4 v[140:143], v2, s[16:19], s60 offen offset:3072 sc1
  ds_read_b128 a[20:23], v17 offset:0
  v_mfma_f32_16x16x32_bf16 v[32:35], a[40:43], a[4:7], 0
  s_add_u32 s89, s89, 1
  ds_read_b64_tr_b16 a[64:65], v20 offset:22528
  ds_read_b64_tr_b16 a[66:67], v20 offset:24576
  v_mfma_f32_16x16x32_bf16 v[40:43], a[40:43], a[8:11], 0
  s_cmp_eq_u32 s89, 3
  s_cselect_b32 s89, 0, s89
  s_cselect_b32 s90, s91, s92
  ds_read_b128 a[24:27], v17 offset:2048
  v_mfma_f32_16x16x32_bf16 v[48:51], a[40:43], a[12:15], 0
  ds_read_b128 a[28:31], v17 offset:4096
  v_mfma_f32_16x16x32_bf16 v[28:31], a[44:47], a[0:3], 0
  ds_read_b128 a[32:35], v17 offset:6144
  v_mfma_f32_16x16x32_bf16 v[36:39], a[44:47], a[4:7], 0
  ds_read_b64_tr_b16 a[68:69], v21 offset:22528
  v_mfma_f32_16x16x32_bf16 v[44:47], a[44:47], a[8:11], 0
  ds_read_b64_tr_b16 a[70:71], v21 offset:24576
  v_mfma_f32_16x16x32_bf16 v[52:55], a[44:47], a[12:15], 0
  ds_read_b64_tr_b16 a[72:73], v20 offset:30720
  v_mfma_f32_16x16x32_bf16 v[56:59], a[48:51], a[0:3], 0
  ds_read_b64_tr_b16 a[74:75], v20 offset:32768
  v_mfma_f32_16x16x32_bf16 v[64:67], a[48:51], a[4:7], 0
  ds_read_b128 a[36:39], v19 offset:0
  v_mfma_f32_16x16x32_bf16 v[72:75], a[48:51], a[8:11], 0
  ds_read_b64_tr_b16 a[76:77], v21 offset:30720
  v_mfma_f32_16x16x32_bf16 v[80:83], a[48:51], a[12:15], 0
  ds_read_b64_tr_b16 a[78:79], v21 offset:32768
  v_mfma_f32_16x16x32_bf16 v[120:123], a[48:51], a[16:19], 0
  ds_read_b64_tr_b16 a[80:81], v20 offset:38912
  v_mfma_f32_16x16x32_bf16 v[60:63], a[52:55], a[0:3], 0
  ds_read_b64_tr_b16 a[82:83], v20 offset:40960
  v_mfma_f32_16x16x32_bf16 v[68:71], a[52:55], a[4:7], 0
  ds_read_b64_tr_b16 a[84:85], v21 offset:38912
  v_mfma_f32_16x16x32_bf16 v[76:79], a[52:55], a[8:11], 0
  ds_read_b64_tr_b16 a[86:87], v21 offset:40960
  v_mfma_f32_16x16x32_bf16 v[84:87], a[52:55], a[12:15], 0
  v_add_u32 v16, s90, v16
  v_add_u32 v17, s90, v17
  v_mfma_f32_16x16x32_bf16 v[124:127], a[52:55], a[16:19], 0
  v_add_u32 v18, s90, v18
  v_add_u32 v19, s90, v19
  v_mfma_f32_16x16x32_bf16 v[88:91], a[0:3], a[56:59], 0
  v_add_u32 v20, s90, v20
  v_add_u32 v21, s90, v21
  v_mfma_f32_16x16x32_bf16 v[96:99], a[4:7], a[56:59], 0
  v_mfma_f32_16x16x32_bf16 v[104:107], a[8:11], a[56:59], 0
  v_mfma_f32_16x16x32_bf16 v[112:115], a[12:15], a[56:59], 0
  v_mfma_f32_16x16x32_bf16 v[92:95], a[0:3], a[60:63], 0
  v_mfma_f32_16x16x32_bf16 v[100:103], a[4:7], a[60:63], 0
  v_mfma_f32_16x16x32_bf16 v[108:111], a[8:11], a[60:63], 0
  v_mfma_f32_16x16x32_bf16 v[116:119], a[12:15], a[60:63], 0
  s_waitcnt vmcnt(16) lgkmcnt(0)
  s_barrier
  v_mfma_f32_16x16x32_bf16 v[24:27], a[64:67], a[20:23], v[24:27]
  buffer_load_dwordx4 a[192:195], v2, s[52:55], s51 offen offset:0
  ds_read_b128 a[0:3], v16 offset:0
  v_mfma_f32_16x16x32_bf16 v[32:35], a[64:67], a[24:27], v[32:35]
  s_add_u32 s51, s51, 1024
  s_add_u32 m0, s88, s28
  ds_read_b64_tr_b16 a[40:41], v20 offset:18432
  v_mfma_f32_16x16x32_bf16 v[40:43], a[64:67], a[28:31], v[40:43]
  ds_read_b64_tr_b16 a[42:43], v20 offset:20480
  ds_read_b128 a[4:7], v16 offset:2048
  v_mfma_f32_16x16x32_bf16 v[48:51], a[64:67], a[32:35], v[48:51]
  buffer_load_dwordx4 v14, s[8:11], s30 offen offset:0 lds
  ds_read_b128 a[8:11], v16 offset:4096
  v_mfma_f32_16x16x32_bf16 v[28:31], a[68:71], a[20:23], v[28:31]
  s_mov_b32 m0, s88
  ds_read_b128 a[12:15], v16 offset:6144
  v_mfma_f32_16x16x32_bf16 v[36:39], a[68:71], a[24:27], v[36:39]
  ds_read_b64_tr_b16 a[44:45], v21 offset:18432
  v_mfma_f32_16x16x32_bf16 v[44:47], a[68:71], a[28:31], v[44:47]
  ds_read_b64_tr_b16 a[46:47], v21 offset:20480
  v_mfma_f32_16x16x32_bf16 v[52:55], a[68:71], a[32:35], v[52:55]
  buffer_load_dwordx4 v4, s[8:11], s30 offen offset:0 lds
  ds_read_b64_tr_b16 a[48:49], v20 offset:26624
  v_mfma_f32_16x16x32_bf16 v[56:59], a[72:75], a[20:23], v[56:59]
  ds_read_b64_tr_b16 a[50:51], v20 offset:28672
  v_mfma_f32_16x16x32_bf16 v[64:67], a[72:75], a[24:27], v[64:67]
  ds_read_b128 a[16:19], v18 offset:0
  v_mfma_f32_16x16x32_bf16 v[72:75], a[72:75], a[28:31], v[72:75]
  buffer_load_dwordx4 v5, s[8:11], s30 offen offset:1024 lds
  ds_read_b64_tr_b16 a[52:53], v21 offset:26624
  v_mfma_f32_16x16x32_bf16 v[80:83], a[72:75], a[32:35], v[80:83]
  ds_read_b64_tr_b16 a[54:55], v21 offset:28672
  v_mfma_f32_16x16x32_bf16 v[120:123], a[72:75], a[36:39], v[120:123]
  ds_read_b64_tr_b16 a[56:57], v20 offset:34816
  v_mfma_f32_16x16x32_bf16 v[60:63], a[76:79], a[20:23], v[60:63]
  ds_read_b64_tr_b16 a[58:59], v20 offset:36864
  v_mfma_f32_16x16x32_bf16 v[68:71], a[76:79], a[24:27], v[68:71]
  buffer_load_dwordx4 v6, s[8:11], s30 offen offset:2048 lds
  ds_read_b64_tr_b16 a[60:61], v21 offset:34816
  v_mfma_f32_16x16x32_bf16 v[76:79], a[76:79], a[28:31], v[76:79]
  ds_read_b64_tr_b16 a[62:63], v21 offset:36864
  v_mfma_f32_16x16x32_bf16 v[84:87], a[76:79], a[32:35], v[84:87]
  v_mfma_f32_16x16x32_bf16 v[124:127], a[76:79], a[36:39], v[124:127]
  buffer_load_dwordx4 v7, s[8:11], s30 offen offset:3072 lds
  v_mfma_f32_16x16x32_bf16 v[88:91], a[20:23], a[80:83], v[88:91]
  s_add_u32 s30, s30, 128
  s_and_b32 s30, s30, 2047
  s_add_u32 m0, s88, s26
  v_mfma_f32_16x16x32_bf16 v[96:99], a[24:27], a[80:83], v[96:99]
  v_mfma_f32_16x16x32_bf16 v[104:107], a[28:31], a[80:83], v[104:107]
  v_mfma_f32_16x16x32_bf16 v[112:115], a[32:35], a[80:83], v[112:115]
  buffer_load_dwordx4 v8, s[20:23], s31 offen offset:0 lds
  v_mfma_f32_16x16x32_bf16 v[92:95], a[20:23], a[84:87], v[92:95]
  v_mfma_f32_16x16x32_bf16 v[100:103], a[24:27], a[84:87], v[100:103]
  v_mfma_f32_16x16x32_bf16 v[108:111], a[28:31], a[84:87], v[108:111]
  v_mfma_f32_16x16x32_bf16 v[116:119], a[32:35], a[84:87], v[116:119]
  s_waitcnt lgkmcnt(0)
  v_mfma_f32_16x16x32_bf16 v[24:27], a[40:43], a[0:3], v[24:27]
  buffer_load_dwordx4 v9, s[20:23], s31 offen offset:1024 lds
  ds_read_b128 a[20:23], v17 offset:0
  v_mfma_f32_16x16x32_bf16 v[32:35], a[40:43], a[4:7], v[32:35]
  ds_read_b64_tr_b16 a[64:65], v20 offset:22528
  ds_read_b64_tr_b16 a[66:67], v20 offset:24576
  v_mfma_f32_16x16x32_bf16 v[40:43], a[40:43], a[8:11], v[40:43]
  ds_read_b128 a[24:27], v17 offset:2048
  v_mfma_f32_16x16x32_bf16 v[48:51], a[40:43], a[12:15], v[48:51]
  buffer_load_dwordx4 v10, s[20:23], s31 offen offset:2048 lds
  ds_read_b128 a[28:31], v17 offset:4096
  v_mfma_f32_16x16x32_bf16 v[28:31], a[44:47], a[0:3], v[28:31]
  s_add_u32 m0, s88, s27
  ds_read_b128 a[32:35], v17 offset:6144
  v_mfma_f32_16x16x32_bf16 v[36:39], a[44:47], a[4:7], v[36:39]
  ds_read_b64_tr_b16 a[68:69], v21 offset:22528
  v_mfma_f32_16x16x32_bf16 v[44:47], a[44:47], a[8:11], v[44:47]
  buffer_load_dwordx4 v11, s[20:23], s31 offen offset:0 lds
  ds_read_b64_tr_b16 a[70:71], v21 offset:24576
  v_mfma_f32_16x16x32_bf16 v[52:55], a[44:47], a[12:15], v[52:55]
  ds_read_b64_tr_b16 a[72:73], v20 offset:30720
  v_mfma_f32_16x16x32_bf16 v[56:59], a[48:51], a[0:3], v[56:59]
  ds_read_b64_tr_b16 a[74:75], v20 offset:32768
  v_mfma_f32_16x16x32_bf16 v[64:67], a[48:51], a[4:7], v[64:67]
  buffer_load_dwordx4 v12, s[20:23], s31 offen offset:1024 lds
  ds_read_b128 a[36:39], v19 offset:0
  v_mfma_f32_16x16x32_bf16 v[72:75], a[48:51], a[8:11], v[72:75]
  ds_read_b64_tr_b16 a[76:77], v21 offset:30720
  v_mfma_f32_16x16x32_bf16 v[80:83], a[48:51], a[12:15], v[80:83]
  ds_read_b64_tr_b16 a[78:79], v21 offset:32768
  v_mfma_f32_16x16x32_bf16 v[120:123], a[48:51], a[16:19], v[120:123]
  buffer_load_dwordx4 v13, s[20:23], s31 offen offset:2048 lds
  ds_read_b64_tr_b16 a[80:81], v20 offset:38912
  v_mfma_f32_16x16x32_bf16 v[60:63], a[52:55], a[0:3], v[60:63]
  s_add_u32 s31, s31, 393216
  s_cmp_ge_u32 s31, 6291456
  s_cselect_b32 s29, 6291456, 0
  v_mfma_f32_16x16x32_bf16 v[68:71], a[52:55], a[4:7], v[68:71]
  s_sub_u32 s31, s31, s29
  s_add_u32 s60, s63, 12288
  ds_read_b64_tr_b16 a[82:83], v20 offset:40960
  v_mfma_f32_16x16x32_bf16 v[76:79], a[52:55], a[8:11], v[76:79]
  buffer_store_dwordx4 v[144:147], v2, s[16:19], s60 offen offset:0 sc1
  ds_read_b64_tr_b16 a[84:85], v21 offset:38912
  v_mfma_f32_16x16x32_bf16 v[84:87], a[52:55], a[12:15], v[84:87]
  s_add_u32 s88, s88, s90
  s_add_u32 s89, s89, 1
  ds_read_b64_tr_b16 a[86:87], v21 offset:40960
  v_mfma_f32_16x16x32_bf16 v[124:127], a[52:55], a[16:19], v[124:127]
  s_cmp_eq_u32 s89, 3
  s_cselect_b32 s89, 0, s89
  s_cselect_b32 s90, s91, s92
  v_mfma_f32_16x16x32_bf16 v[88:91], a[0:3], a[56:59], v[88:91]
  v_add_u32 v16, s90, v16
  v_add_u32 v17, s90, v17
  v_mfma_f32_16x16x32_bf16 v[96:99], a[4:7], a[56:59], v[96:99]
  v_add_u32 v18, s90, v18
  v_add_u32 v19, s90, v19
  v_mfma_f32_16x16x32_bf16 v[104:107], a[8:11], a[56:59], v[104:107]
  v_add_u32 v20, s90, v20
  v_add_u32 v21, s90, v21
  v_mfma_f32_16x16x32_bf16 v[112:115], a[12:15], a[56:59], v[112:115]
  v_mfma_f32_16x16x32_bf16 v[92:95], a[0:3], a[60:63], v[92:95]
  v_mfma_f32_16x16x32_bf16 v[100:103], a[4:7], a[60:63], v[100:103]
  v_mfma_f32_16x16x32_bf16 v[108:111], a[8:11], a[60:63], v[108:111]
  v_mfma_f32_16x16x32_bf16 v[116:119], a[12:15], a[60:63], v[116:119]
  s_waitcnt vmcnt(17) lgkmcnt(0)
  s_barrier
  v_mfma_f32_16x16x32_bf16 v[24:27], a[64:67], a[20:23], v[24:27]
  buffer_load_dwordx4 a[192:195], v2, s[52:55], s51 offen offset:0
  ds_read_b128 a[0:3], v16 offset:0
  v_mfma_f32_16x16x32_bf16 v[32:35], a[64:67], a[24:27], v[32:35]
  s_add_u32 s51, s51, 1024
  s_add_u32 m0, s88, s28
  ds_read_b64_tr_b16 a[40:41], v20 offset:18432
  v_mfma_f32_16x16x32_bf16 v[40:43], a[64:67], a[28:31], v[40:43]
  ds_read_b64_tr_b16 a[42:43], v20 offset:20480
  ds_read_b128 a[4:7], v16 offset:2048
  v_mfma_f32_16x16x32_bf16 v[48:51], a[64:67], a[32:35], v[48:51]
  buffer_load_dwordx4 v14, s[8:11], s30 offen offset:0 lds
  ds_read_b128 a[8:11], v16 offset:4096
  v_mfma_f32_16x16x32_bf16 v[28:31], a[68:71], a[20:23], v[28:31]
  s_mov_b32 m0, s88
  ds_read_b128 a[12:15], v16 offset:6144
  v_mfma_f32_16x16x32_bf16 v[36:39], a[68:71], a[24:27], v[36:39]
  ds_read_b64_tr_b16 a[44:45], v21 offset:18432
  v_mfma_f32_16x16x32_bf16 v[44:47], a[68:71], a[28:31], v[44:47]
  ds_read_b64_tr_b16 a[46:47], v21 offset:20480
  v_mfma_f32_16x16x32_bf16 v[52:55], a[68:71], a[32:35], v[52:55]
  buffer_load_dwordx4 v4, s[8:11], s30 offen offset:0 lds
  ds_read_b64_tr_b16 a[48:49], v20 offset:26624
  v_mfma_f32_16x16x32_bf16 v[56:59], a[72:75], a[20:23], v[56:59]
  ds_read_b64_tr_b16 a[50:51], v20 offset:28672
  v_mfma_f32_16x16x32_bf16 v[64:67], a[72:75], a[24:27], v[64:67]
  ds_read_b128 a[16:19], v18 offset:0
  v_mfma_f32_16x16x32_bf16 v[72:75], a[72:75], a[28:31], v[72:75]
  buffer_load_dwordx4 v5, s[8:11], s30 offen offset:1024 lds
  ds_read_b64_tr_b16 a[52:53], v21 offset:26624
  v_mfma_f32_16x16x32_bf16 v[80:83], a[72:75], a[32:35], v[80:83]
  ds_read_b64_tr_b16 a[54:55], v21 offset:28672
  v_mfma_f32_16x16x32_bf16 v[120:123], a[72:75], a[36:39], v[120:123]
  ds_read_b64_tr_b16 a[56:57], v20 offset:34816
  v_mfma_f32_16x16x32_bf16 v[60:63], a[76:79], a[20:23], v[60:63]
  ds_read_b64_tr_b16 a[58:59], v20 offset:36864
  v_mfma_f32_16x16x32_bf16 v[68:71], a[76:79], a[24:27], v[68:71]
  buffer_load_dwordx4 v6, s[8:11], s30 offen offset:2048 lds
  ds_read_b64_tr_b16 a[60:61], v21 offset:34816
  v_mfma_f32_16x16x32_bf16 v[76:79], a[76:79], a[28:31], v[76:79]
  ds_read_b64_tr_b16 a[62:63], v21 offset:36864
  v_mfma_f32_16x16x32_bf16 v[84:87], a[76:79], a[32:35], v[84:87]
  v_mfma_f32_16x16x32_bf16 v[124:127], a[76:79], a[36:39], v[124:127]
  buffer_load_dwordx4 v7, s[8:11], s30 offen offset:3072 lds
  v_mfma_f32_16x16x32_bf16 v[88:91], a[20:23], a[80:83], v[88:91]
  s_add_u32 s30, s30, 128
  s_and_b32 s30, s30, 2047
  s_add_u32 m0, s88, s26
  v_mfma_f32_16x16x32_bf16 v[96:99], a[24:27], a[80:83], v[96:99]
  v_mfma_f32_16x16x32_bf16 v[104:107], a[28:31], a[80:83], v[104:107]
  v_mfma_f32_16x16x32_bf16 v[112:115], a[32:35], a[80:83], v[112:115]
  buffer_load_dwordx4 v8, s[20:23], s31 offen offset:0 lds
  v_mfma_f32_16x16x32_bf16 v[92:95], a[20:23], a[84:87], v[92:95]
  v_mfma_f32_16x16x32_bf16 v[100:103], a[24:27], a[84:87], v[100:103]
  v_mfma_f32_16x16x32_bf16 v[108:111], a[28:31], a[84:87], v[108:111]
  v_mfma_f32_16x16x32_bf16 v[116:119], a[32:35], a[84:87], v[116:119]
  s_waitcnt lgkmcnt(0)
  v_mfma_f32_16x16x32_bf16 v[24:27], a[40:43], a[0:3], v[24:27]
  buffer_load_dwordx4 v9, s[20:23], s31 offen offset:1024 lds
  ds_read_b128 a[20:23], v17 offset:0
  v_mfma_f32_16x16x32_bf16 v[32:35], a[40:43], a[4:7], v[32:35]
  ds_read_b64_tr_b16 a[64:65], v20 offset:22528
  ds_read_b64_tr_b16 a[66:67], v20 offset:24576
  v_mfma_f32_16x16x32_bf16 v[40:43], a[40:43], a[8:11], v[40:43]
  buffer_load_dwordx4 v10, s[20:23], s31 offen offset:2048 lds
  ds_read_b128 a[24:27], v17 offset:2048
  v_mfma_f32_16x16x32_bf16 v[48:51], a[40:43], a[12:15], v[48:51]
  s_add_u32 m0, s88, s27
  ds_read_b128 a[28:31], v17 offset:4096
  v_mfma_f32_16x16x32_bf16 v[28:31], a[44:47], a[0:3], v[28:31]
  ds_read_b128 a[32:35], v17 offset:6144
  v_mfma_f32_16x16x32_bf16 v[36:39], a[44:47], a[4:7], v[36:39]
  buffer_load_dwordx4 v11, s[20:23], s31 offen offset:0 lds
  ds_read_b64_tr_b16 a[68:69], v21 offset:22528
  v_mfma_f32_16x16x32_bf16 v[44:47], a[44:47], a[8:11], v[44:47]
  ds_read_b64_tr_b16 a[70:71], v21 offset:24576
  v_mfma_f32_16x16x32_bf16 v[52:55], a[44:47], a[12:15], v[52:55]
  ds_read_b64_tr_b16 a[72:73], v20 offset:30720
  v_mfma_f32_16x16x32_bf16 v[56:59], a[48:51], a[0:3], v[56:59]
  buffer_load_dwordx4 v12, s[20:23], s31 offen offset:1024 lds
  ds_read_b64_tr_b16 a[74:75], v20 offset:32768
  v_mfma_f32_16x16x32_bf16 v[64:67], a[48:51], a[4:7], v[64:67]
  ds_read_b128 a[36:39], v19 offset:0
  v_mfma_f32_16x16x32_bf16 v[72:75], a[48:51], a[8:11], v[72:75]
  buffer_load_dwordx4 v13, s[20:23], s31 offen offset:2048 lds
  ds_read_b64_tr_b16 a[76:77], v21 offset:30720
  v_mfma_f32_16x16x32_bf16 v[80:83], a[48:51], a[12:15], v[80:83]
  s_add_u32 s31, s31, 393216
  s_cmp_ge_u32 s31, 6291456
  s_cselect_b32 s29, 6291456, 0
  v_mfma_f32_16x16x32_bf16 v[120:123], a[48:51], a[16:19], v[120:123]
  s_sub_u32 s31, s31, s29
  s_add_u32 s60, s63, 12288
  ds_read_b64_tr_b16 a[78:79], v21 offset:32768
  v_mfma_f32_16x16x32_bf16 v[60:63], a[52:55], a[0:3], v[60:63]
  buffer_store_dwordx4 v[148:151], v2, s[16:19], s60 offen offset:1024 sc1
  ds_read_b64_tr_b16 a[80:81], v20 offset:38912
  v_mfma_f32_16x16x32_bf16 v[68:71], a[52:55], a[4:7], v[68:71]
  ds_read_b64_tr_b16 a[82:83], v20 offset:40960
  ds_read_b64_tr_b16 a[84:85], v21 offset:38912
  v_mfma_f32_16x16x32_bf16 v[76:79], a[52:55], a[8:11], v[76:79]
  ds_read_b64_tr_b16 a[86:87], v21 offset:40960
  v_mfma_f32_16x16x32_bf16 v[84:87], a[52:55], a[12:15], v[84:87]
  buffer_store_dwordx4 v[152:155], v2, s[16:19], s60 offen offset:2048 sc1
  v_mfma_f32_16x16x32_bf16 v[124:127], a[52:55], a[16:19], v[124:127]
  s_add_u32 s88, s88, s90
  s_add_u32 s89, s89, 1
  s_cmp_eq_u32 s89, 3
  s_cselect_b32 s89, 0, s89
  s_cselect_b32 s90, s91, s92
  v_mfma_f32_16x16x32_bf16 v[88:91], a[0:3], a[56:59], v[88:91]
  v_add_u32 v16, s90, v16
  v_add_u32 v17, s90, v17
  v_mfma_f32_16x16x32_bf16 v[96:99], a[4:7], a[56:59], v[96:99]
  v_add_u32 v18, s90, v18
  v_add_u32 v19, s90, v19
  v_mfma_f32_16x16x32_bf16 v[104:107], a[8:11], a[56:59], v[104:107]
  v_add_u32 v20, s90, v20
  v_add_u32 v21, s90, v21
  v_mfma_f32_16x16x32_bf16 v[112:115], a[12:15], a[56:59], v[112:115]
  v_mfma_f32_16x16x32_bf16 v[92:95], a[0:3], a[60:63], v[92:95]
  v_mfma_f32_16x16x32_bf16 v[100:103], a[4:7], a[60:63], v[100:103]
  v_mfma_f32_16x16x32_bf16 v[108:111], a[8:11], a[60:63], v[108:111]
  v_mfma_f32_16x16x32_bf16 v[116:119], a[12:15], a[60:63], v[116:119]
  s_waitcnt vmcnt(15) lgkmcnt(0)
  s_barrier
  v_mfma_f32_16x16x32_bf16 v[24:27], a[64:67], a[20:23], v[24:27]
  s_add_u32 m0, s88, s28
  ds_read_b128 a[0:3], v16 offset:0
  ds_read_b64_tr_b16 a[40:41], v20 offset:18432
  v_mfma_f32_16x16x32_bf16 v[32:35], a[64:67], a[24:27], v[32:35]
  buffer_load_dwordx4 v14, s[8:11], s30 offen offset:0 lds
  ds_read_b64_tr_b16 a[42:43], v20 offset:20480
  v_mfma_f32_16x16x32_bf16 v[40:43], a[64:67], a[28:31], v[40:43]
  s_mov_b32 m0, s88
  ds_read_b128 a[4:7], v16 offset:2048
  v_mfma_f32_16x16x32_bf16 v[48:51], a[64:67], a[32:35], v[48:51]
  ds_read_b128 a[8:11], v16 offset:4096
  v_mfma_f32_16x16x32_bf16 v[28:31], a[68:71], a[20:23], v[28:31]
  buffer_load_dwordx4 v4, s[8:11], s30 offen offset:0 lds
  ds_read_b128 a[12:15], v16 offset:6144
  v_mfma_f32_16x16x32_bf16 v[36:39], a[68:71], a[24:27], v[36:39]
  ds_read_b64_tr_b16 a[44:45], v21 offset:18432
  v_mfma_f32_16x16x32_bf16 v[44:47], a[68:71], a[28:31], v[44:47]
  ds_read_b64_tr_b16 a[46:47], v21 offset:20480
  v_mfma_f32_16x16x32_bf16 v[52:55], a[68:71], a[32:35], v[52:55]
  ds_read_b64_tr_b16 a[48:49], v20 offset:26624
  v_mfma_f32_16x16x32_bf16 v[56:59], a[72:75], a[20:23], v[56:59]
  buffer_load_dwordx4 v5, s[8:11], s30 offen offset:1024 lds
  ds_read_b64_tr_b16 a[50:51], v20 offset:28672
  v_mfma_f32_16x16x32_bf16 v[64:67], a[72:75], a[24:27], v[64:67]
  ds_read_b128 a[16:19], v18 offset:0
  v_mfma_f32_16x16x32_bf16 v[72:75], a[72:75], a[28:31], v[72:75]
  ds_read_b64_tr_b16 a[52:53], v21 offset:26624
  v_mfma_f32_16x16x32_bf16 v[80:83], a[72:75], a[32:35], v[80:83]
  ds_read_b64_tr_b16 a[54:55], v21 offset:28672
  v_mfma_f32_16x16x32_bf16 v[120:123], a[72:75], a[36:39], v[120:123]
  buffer_load_dwordx4 v6, s[8:11], s30 offen offset:2048 lds
  ds_read_b64_tr_b16 a[56:57], v20 offset:34816
  v_mfma_f32_16x16x32_bf16 v[60:63], a[76:79], a[20:23], v[60:63]
  ds_read_b64_tr_b16 a[58:59], v20 offset:36864
  v_mfma_f32_16x16x32_bf16 v[68:71], a[76:79], a[24:27], v[68:71]
  ds_read_b64_tr_b16 a[60:61], v21 offset:34816
  v_mfma_f32_16x16x32_bf16 v[76:79], a[76:79], a[28:31], v[76:79]
  ds_read_b64_tr_b16 a[62:63], v21 offset:36864
  v_mfma_f32_16x16x32_bf16 v[84:87], a[76:79], a[32:35], v[84:87]
  buffer_load_dwordx4 v7, s[8:11], s30 offen offset:3072 lds
  v_mfma_f32_16x16x32_bf16 v[124:127], a[76:79], a[36:39], v[124:127]
  s_add_u32 s30, s30, 128
  s_and_b32 s30, s30, 2047
  s_add_u32 m0, s88, s26
  v_mfma_f32_16x16x32_bf16 v[88:91], a[20:23], a[80:83], v[88:91]
  v_mfma_f32_16x16x32_bf16 v[96:99], a[24:27], a[80:83], v[96:99]
  v_mfma_f32_16x16x32_bf16 v[104:107], a[28:31], a[80:83], v[104:107]
  buffer_load_dwordx4 v8, s[20:23], s31 offen offset:0 lds
  v_mfma_f32_16x16x32_bf16 v[112:115], a[32:35], a[80:83], v[112:115]
  v_mfma_f32_16x16x32_bf16 v[92:95], a[20:23], a[84:87], v[92:95]
  v_mfma_f32_16x16x32_bf16 v[100:103], a[24:27], a[84:87], v[100:103]
  v_mfma_f32_16x16x32_bf16 v[108:111], a[28:31], a[84:87], v[108:111]
  v_mfma_f32_16x16x32_bf16 v[116:119], a[32:35], a[84:87], v[116:119]
  s_waitcnt lgkmcnt(0)
  v_mfma_f32_16x16x32_bf16 v[24:27], a[40:43], a[0:3], v[24:27]
  buffer_load_dwordx4 v9, s[20:23], s31 offen offset:1024 lds
  ds_read_b128 a[20:23], v17 offset:0
  v_mfma_f32_16x16x32_bf16 v[32:35], a[40:43], a[4:7], v[32:35]
  ds_read_b64_tr_b16 a[64:65], v20 offset:22528
  ds_read_b64_tr_b16 a[66:67], v20 offset:24576
  v_mfma_f32_16x16x32_bf16 v[40:43], a[40:43], a[8:11], v[40:43]
  ds_read_b128 a[24:27], v17 offset:2048
  v_mfma_f32_16x16x32_bf16 v[48:51], a[40:43], a[12:15], v[48:51]
  buffer_load_dwordx4 v10, s[20:23], s31 offen offset:2048 lds
  ds_read_b128 a[28:31], v17 offset:4096
  v_mfma_f32_16x16x32_bf16 v[28:31], a[44:47], a[0:3], v[28:31]
  s_add_u32 m0, s88, s27
  ds_read_b128 a[32:35], v17 offset:6144
  v_mfma_f32_16x16x32_bf16 v[36:39], a[44:47], a[4:7], v[36:39]
  ds_read_b64_tr_b16 a[68:69], v21 offset:22528
  v_mfma_f32_16x16x32_bf16 v[44:47], a[44:47], a[8:11], v[44:47]
  buffer_load_dwordx4 v11, s[20:23], s31 offen offset:0 lds
  ds_read_b64_tr_b16 a[70:71], v21 offset:24576
  v_mfma_f32_16x16x32_bf16 v[52:55], a[44:47], a[12:15], v[52:55]
  ds_read_b64_tr_b16 a[72:73], v20 offset:30720
  v_mfma_f32_16x16x32_bf16 v[56:59], a[48:51], a[0:3], v[56:59]
  ds_read_b64_tr_b16 a[74:75], v20 offset:32768
  v_mfma_f32_16x16x32_bf16 v[64:67], a[48:51], a[4:7], v[64:67]
  buffer_load_dwordx4 v12, s[20:23], s31 offen offset:1024 lds
  ds_read_b128 a[36:39], v19 offset:0
  v_mfma_f32_16x16x32_bf16 v[72:75], a[48:51], a[8:11], v[72:75]
  ds_read_b64_tr_b16 a[76:77], v21 offset:30720
  v_mfma_f32_16x16x32_bf16 v[80:83], a[48:51], a[12:15], v[80:83]
  ds_read_b64_tr_b16 a[78:79], v21 offset:32768
  v_mfma_f32_16x16x32_bf16 v[120:123], a[48:51], a[16:19], v[120:123]
  buffer_load_dwordx4 v13, s[20:23], s31 offen offset:2048 lds
  ds_read_b64_tr_b16 a[80:81], v20 offset:38912
  v_mfma_f32_16x16x32_bf16 v[60:63], a[52:55], a[0:3], v[60:63]
  s_add_u32 s31, s31, 393216
  s_cmp_ge_u32 s31, 6291456
  s_cselect_b32 s29, 6291456, 0
  v_mfma_f32_16x16x32_bf16 v[68:71], a[52:55], a[4:7], v[68:71]
  s_sub_u32 s31, s31, s29
  s_add_u32 s60, s63, 12288
  ds_read_b64_tr_b16 a[82:83], v20 offset:40960
  v_mfma_f32_16x16x32_bf16 v[76:79], a[52:55], a[8:11], v[76:79]
  buffer_store_dwordx4 v[156:159], v2, s[16:19], s60 offen offset:3072 sc1
  ds_read_b64_tr_b16 a[84:85], v21 offset:38912
  v_mfma_f32_16x16x32_bf16 v[84:87], a[52:55], a[12:15], v[84:87]
  s_add_u32 s88, s88, s90
  s_add_u32 s89, s89, 1
  ds_read_b64_tr_b16 a[86:87], v21 offset:40960
  v_mfma_f32_16x16x32_bf16 v[124:127], a[52:55], a[16:19], v[124:127]
  s_cmp_eq_u32 s89, 3
  s_cselect_b32 s89, 0, s89
  s_cselect_b32 s90, s91, s92
  v_mfma_f32_16x16x32_bf16 v[88:91], a[0:3], a[56:59], v[88:91]
  v_add_u32 v16, s90, v16
  v_add_u32 v17, s90, v17
  v_mfma_f32_16x16x32_bf16 v[96:99], a[4:7], a[56:59], v[96:99]
  v_add_u32 v18, s90, v18
  v_add_u32 v19, s90, v19
  v_mfma_f32_16x16x32_bf16 v[104:107], a[8:11], a[56:59], v[104:107]
  v_add_u32 v20, s90, v20
  v_add_u32 v21, s90, v21
  v_mfma_f32_16x16x32_bf16 v[112:115], a[12:15], a[56:59], v[112:115]
  v_mfma_f32_16x16x32_bf16 v[92:95], a[0:3], a[60:63], v[92:95]
  v_mfma_f32_16x16x32_bf16 v[100:103], a[4:7], a[60:63], v[100:103]
  v_mfma_f32_16x16x32_bf16 v[108:111], a[8:11], a[60:63], v[108:111]
  v_mfma_f32_16x16x32_bf16 v[116:119], a[12:15], a[60:63], v[116:119]
  s_waitcnt vmcnt(14) lgkmcnt(0)
  s_barrier
  v_mfma_f32_16x16x32_bf16 v[24:27], a[64:67], a[20:23], v[24:27]
  s_add_u32 m0, s88, s28
  ds_read_b128 a[0:3], v16 offset:0
  ds_read_b64_tr_b16 a[40:41], v20 offset:18432
  v_mfma_f32_16x16x32_bf16 v[32:35], a[64:67], a[24:27], v[32:35]
  buffer_load_dwordx4 v14, s[8:11], s30 offen offset:0 lds
  ds_read_b64_tr_b16 a[42:43], v20 offset:20480
  v_mfma_f32_16x16x32_bf16 v[40:43], a[64:67], a[28:31], v[40:43]
  s_mov_b32 m0, s88
  ds_read_b128 a[4:7], v16 offset:2048
  v_mfma_f32_16x16x32_bf16 v[48:51], a[64:67], a[32:35], v[48:51]
  buffer_load_dwordx4 v4, s[8:11], s30 offen offset:0 lds
  ds_read_b128 a[8:11], v16 offset:4096
  v_mfma_f32_16x16x32_bf16 v[28:31], a[68:71], a[20:23], v[28:31]
  ds_read_b128 a[12:15], v16 offset:6144
  v_mfma_f32_16x16x32_bf16 v[36:39], a[68:71], a[24:27], v[36:39]
  ds_read_b64_tr_b16 a[44:45], v21 offset:18432
  v_mfma_f32_16x16x32_bf16 v[44:47], a[68:71], a[28:31], v[44:47]
  ds_read_b64_tr_b16 a[46:47], v21 offset:20480
  v_mfma_f32_16x16x32_bf16 v[52:55], a[68:71], a[32:35], v[52:55]
  buffer_load_dwordx4 v5, s[8:11], s30 offen offset:1024 lds
  ds_read_b64_tr_b16 a[48:49], v20 offset:26624
  v_mfma_f32_16x16x32_bf16 v[56:59], a[72:75], a[20:23], v[56:59]
  ds_read_b64_tr_b16 a[50:51], v20 offset:28672
  v_mfma_f32_16x16x32_bf16 v[64:67], a[72:75], a[24:27], v[64:67]
  ds_read_b128 a[16:19], v18 offset:0
  v_mfma_f32_16x16x32_bf16 v[72:75], a[72:75], a[28:31], v[72:75]
  buffer_load_dwordx4 v6, s[8:11], s30 offen offset:2048 lds
  ds_read_b64_tr_b16 a[52:53], v21 offset:26624
  v_mfma_f32_16x16x32_bf16 v[80:83], a[72:75], a[32:35], v[80:83]
  ds_read_b64_tr_b16 a[54:55], v21 offset:28672
  v_mfma_f32_16x16x32_bf16 v[120:123], a[72:75], a[36:39], v[120:123]
  ds_read_b64_tr_b16 a[56:57], v20 offset:34816
  v_mfma_f32_16x16x32_bf16 v[60:63], a[76:79], a[20:23], v[60:63]
  ds_read_b64_tr_b16 a[58:59], v20 offset:36864
  v_mfma_f32_16x16x32_bf16 v[68:71], a[76:79], a[24:27], v[68:71]
  buffer_load_dwordx4 v7, s[8:11], s30 offen offset:3072 lds
  ds_read_b64_tr_b16 a[60:61], v21 offset:34816
  v_mfma_f32_16x16x32_bf16 v[76:79], a[76:79], a[28:31], v[76:79]
  s_add_u32 s30, s30, 128
  s_and_b32 s30, s30, 2047
  s_add_u32 m0, s88, s26
  v_mfma_f32_16x16x32_bf16 v[84:87], a[76:79], a[32:35], v[84:87]
  ds_read_b64_tr_b16 a[62:63], v21 offset:36864
  v_mfma_f32_16x16x32_bf16 v[124:127], a[76:79], a[36:39], v[124:127]
  buffer_load_dwordx4 v8, s[20:23], s31 offen offset:0 lds
  v_mfma_f32_16x16x32_bf16 v[88:91], a[20:23], a[80:83], v[88:91]
  v_mfma_f32_16x16x32_bf16 v[96:99], a[24:27], a[80:83], v[96:99]
  v_mfma_f32_16x16x32_bf16 v[104:107], a[28:31], a[80:83], v[104:107]
  v_mfma_f32_16x16x32_bf16 v[112:115], a[32:35], a[80:83], v[112:115]
  buffer_load_dwordx4 v9, s[20:23], s31 offen offset:1024 lds
  v_mfma_f32_16x16x32_bf16 v[92:95], a[20:23], a[84:87], v[92:95]
  v_mfma_f32_16x16x32_bf16 v[100:103], a[24:27], a[84:87], v[100:103]
  v_mfma_f32_16x16x32_bf16 v[108:111], a[28:31], a[84:87], v[108:111]
  v_mfma_f32_16x16x32_bf16 v[116:119], a[32:35], a[84:87], v[116:119]
  s_waitcnt lgkmcnt(0)
  v_mfma_f32_16x16x32_bf16 v[24:27], a[40:43], a[0:3], v[24:27]
  buffer_load_dwordx4 v10, s[20:23], s31 offen offset:2048 lds
  ds_read_b128 a[20:23], v17 offset:0
  v_mfma_f32_16x16x32_bf16 v[32:35], a[40:43], a[4:7], v[32:35]
  s_add_u32 m0, s88, s27
  ds_read_b64_tr_b16 a[64:65], v20 offset:22528
  ds_read_b64_tr_b16 a[66:67], v20 offset:24576
  v_mfma_f32_16x16x32_bf16 v[40:43], a[40:43], a[8:11], v[40:43]
  ds_read_b128 a[24:27], v17 offset:2048
  v_mfma_f32_16x16x32_bf16 v[48:51], a[40:43], a[12:15], v[48:51]
  buffer_load_dwordx4 v11, s[20:23], s31 offen offset:0 lds
  ds_read_b128 a[28:31], v17 offset:4096
  v_mfma_f32_16x16x32_bf16 v[28:31], a[44:47], a[0:3], v[28:31]
  ds_read_b128 a[32:35], v17 offset:6144
  v_mfma_f32_16x16x32_bf16 v[36:39], a[44:47], a[4:7], v[36:39]
  ds_read_b64_tr_b16 a[68:69], v21 offset:22528
  v_mfma_f32_16x16x32_bf16 v[44:47], a[44:47], a[8:11], v[44:47]
  buffer_load_dwordx4 v12, s[20:23], s31 offen offset:1024 lds
  ds_read_b64_tr_b16 a[70:71], v21 offset:24576
  v_mfma_f32_16x16x32_bf16 v[52:55], a[44:47], a[12:15], v[52:55]
  ds_read_b64_tr_b16 a[72:73], v20 offset:30720
  v_mfma_f32_16x16x32_bf16 v[56:59], a[48:51], a[0:3], v[56:59]
  ds_read_b64_tr_b16 a[74:75], v20 offset:32768
  v_mfma_f32_16x16x32_bf16 v[64:67], a[48:51], a[4:7], v[64:67]
  buffer_load_dwordx4 v13, s[20:23], s31 offen offset:2048 lds
  ds_read_b128 a[36:39], v19 offset:0
  v_mfma_f32_16x16x32_bf16 v[72:75], a[48:51], a[8:11], v[72:75]
  s_add_u32 s31, s31, 393216
  s_cmp_ge_u32 s31, 6291456
  s_cselect_b32 s29, 6291456, 0
  v_mfma_f32_16x16x32_bf16 v[80:83], a[48:51], a[12:15], v[80:83]
  s_sub_u32 s31, s31, s29
  s_add_u32 s60, s63, 32768
  ds_read_b64_tr_b16 a[76:77], v21 offset:30720
  v_mfma_f32_16x16x32_bf16 v[120:123], a[48:51], a[16:19], v[120:123]
  buffer_store_dwordx4 v[192:195], v2, s[16:19], s60 offen offset:0 sc1
  ds_read_b64_tr_b16 a[78:79], v21 offset:32768
  v_mfma_f32_16x16x32_bf16 v[60:63], a[52:55], a[0:3], v[60:63]
  ds_read_b64_tr_b16 a[80:81], v20 offset:38912
  ds_read_b64_tr_b16 a[82:83], v20 offset:40960
  v_mfma_f32_16x16x32_bf16 v[68:71], a[52:55], a[4:7], v[68:71]
  ds_read_b64_tr_b16 a[84:85], v21 offset:38912
  v_mfma_f32_16x16x32_bf16 v[76:79], a[52:55], a[8:11], v[76:79]
  buffer_store_dwordx4 v[196:199], v2, s[16:19], s60 offen offset:1024 sc1
  ds_read_b64_tr_b16 a[86:87], v21 offset:40960
  v_mfma_f32_16x16x32_bf16 v[84:87], a[52:55], a[12:15], v[84:87]
  s_add_u32 s88, s88, s90
  s_add_u32 s89, s89, 1
  s_cmp_eq_u32 s89, 3
  s_cselect_b32 s89, 0, s89
  s_cselect_b32 s90, s91, s92
  v_mfma_f32_16x16x32_bf16 v[124:127], a[52:55], a[16:19], v[124:127]
  v_add_u32 v16, s90, v16
  v_add_u32 v17, s90, v17
  v_mfma_f32_16x16x32_bf16 v[88:91], a[0:3], a[56:59], v[88:91]
  v_add_u32 v18, s90, v18
  v_add_u32 v19, s90, v19
  v_mfma_f32_16x16x32_bf16 v[96:99], a[4:7], a[56:59], v[96:99]
  v_add_u32 v20, s90, v20
  v_add_u32 v21, s90, v21
  v_mfma_f32_16x16x32_bf16 v[104:107], a[8:11], a[56:59], v[104:107]
  v_mfma_f32_16x16x32_bf16 v[112:115], a[12:15], a[56:59], v[112:115]
  v_mfma_f32_16x16x32_bf16 v[92:95], a[0:3], a[60:63], v[92:95]
  v_mfma_f32_16x16x32_bf16 v[100:103], a[4:7], a[60:63], v[100:103]
  v_mfma_f32_16x16x32_bf16 v[108:111], a[8:11], a[60:63], v[108:111]
  v_mfma_f32_16x16x32_bf16 v[116:119], a[12:15], a[60:63], v[116:119]
  s_waitcnt vmcnt(14) lgkmcnt(0)
  s_barrier
  v_mfma_f32_16x16x32_bf16 v[24:27], a[64:67], a[20:23], v[24:27]
  s_add_u32 m0, s88, s28
  ds_read_b128 a[0:3], v16 offset:0
  ds_read_b64_tr_b16 a[40:41], v20 offset:18432
  v_mfma_f32_16x16x32_bf16 v[32:35], a[64:67], a[24:27], v[32:35]
  buffer_load_dwordx4 v14, s[8:11], s30 offen offset:0 lds
  ds_read_b64_tr_b16 a[42:43], v20 offset:20480
  v_mfma_f32_16x16x32_bf16 v[40:43], a[64:67], a[28:31], v[40:43]
  s_mov_b32 m0, s88
  ds_read_b128 a[4:7], v16 offset:2048
  v_mfma_f32_16x16x32_bf16 v[48:51], a[64:67], a[32:35], v[48:51]
  ds_read_b128 a[8:11], v16 offset:4096
  v_mfma_f32_16x16x32_bf16 v[28:31], a[68:71], a[20:23], v[28:31]
  buffer_load_dwordx4 v4, s[8:11], s30 offen offset:0 lds
  ds_read_b128 a[12:15], v16 offset:6144
  v_mfma_f32_16x16x32_bf16 v[36:39], a[68:71], a[24:27], v[36:39]
  ds_read_b64_tr_b16 a[44:45], v21 offset:18432
  v_mfma_f32_16x16x32_bf16 v[44:47], a[68:71], a[28:31], v[44:47]
  ds_read_b64_tr_b16 a[46:47], v21 offset:20480
  v_mfma_f32_16x16x32_bf16 v[52:55], a[68:71], a[32:35], v[52:55]
  ds_read_b64_tr_b16 a[48:49], v20 offset:26624
  v_mfma_f32_16x16x32_bf16 v[56:59], a[72:75], a[20:23], v[56:59]
  buffer_load_dwordx4 v5, s[8:11], s30 offen offset:1024 lds
  ds_read_b64_tr_b16 a[50:51], v20 offset:28672
  v_mfma_f32_16x16x32_bf16 v[64:67], a[72:75], a[24:27], v[64:67]
  ds_read_b128 a[16:19], v18 offset:0
  v_mfma_f32_16x16x32_bf16 v[72:75], a[72:75], a[28:31], v[72:75]
  ds_read_b64_tr_b16 a[52:53], v21 offset:26624
  v_mfma_f32_16x16x32_bf16 v[80:83], a[72:75], a[32:35], v[80:83]
  ds_read_b64_tr_b16 a[54:55], v21 offset:28672
  v_mfma_f32_16x16x32_bf16 v[120:123], a[72:75], a[36:39], v[120:123]
  buffer_load_dwordx4 v6, s[8:11], s30 offen offset:2048 lds
  ds_read_b64_tr_b16 a[56:57], v20 offset:34816
  v_mfma_f32_16x16x32_bf16 v[60:63], a[76:79], a[20:23], v[60:63]
  ds_read_b64_tr_b16 a[58:59], v20 offset:36864
  v_mfma_f32_16x16x32_bf16 v[68:71], a[76:79], a[24:27], v[68:71]
  ds_read_b64_tr_b16 a[60:61], v21 offset:34816
  v_mfma_f32_16x16x32_bf16 v[76:79], a[76:79], a[28:31], v[76:79]
  ds_read_b64_tr_b16 a[62:63], v21 offset:36864
  v_mfma_f32_16x16x32_bf16 v[84:87], a[76:79], a[32:35], v[84:87]
  buffer_load_dwordx4 v7, s[8:11], s30 offen offset:3072 lds
  v_mfma_f32_16x16x32_bf16 v[124:127], a[76:79], a[36:39], v[124:127]
  s_add_u32 s30, s30, 128
  s_and_b32 s30, s30, 2047
  s_add_u32 m0, s88, s26
  v_mfma_f32_16x16x32_bf16 v[88:91], a[20:23], a[80:83], v[88:91]
  v_mfma_f32_16x16x32_bf16 v[96:99], a[24:27], a[80:83], v[96:99]
  v_mfma_f32_16x16x32_bf16 v[104:107], a[28:31], a[80:83], v[104:107]
  buffer_load_dwordx4 v8, s[20:23], s31 offen offset:0 lds
  v_mfma_f32_16x16x32_bf16 v[112:115], a[32:35], a[80:83], v[112:115]
  v_mfma_f32_16x16x32_bf16 v[92:95], a[20:23], a[84:87], v[92:95]
  v_mfma_f32_16x16x32_bf16 v[100:103], a[24:27], a[84:87], v[100:103]
  v_mfma_f32_16x16x32_bf16 v[108:111], a[28:31], a[84:87], v[108:111]
  v_mfma_f32_16x16x32_bf16 v[116:119], a[32:35], a[84:87], v[116:119]
  s_waitcnt lgkmcnt(0)
  v_mfma_f32_16x16x32_bf16 v[24:27], a[40:43], a[0:3], v[24:27]
  buffer_load_dwordx4 v9, s[20:23], s31 offen offset:1024 lds
  ds_read_b128 a[20:23], v17 offset:0
  v_mfma_f32_16x16x32_bf16 v[32:35], a[40:43], a[4:7], v[32:35]
  ds_read_b64_tr_b16 a[64:65], v20 offset:22528
  ds_read_b64_tr_b16 a[66:67], v20 offset:24576
  v_mfma_f32_16x16x32_bf16 v[40:43], a[40:43], a[8:11], v[40:43]
  ds_read_b128 a[24:27], v17 offset:2048
  v_mfma_f32_16x16x32_bf16 v[48:51], a[40:43], a[12:15], v[48:51]
  buffer_load_dwordx4 v10, s[20:23], s31 offen offset:2048 lds
  ds_read_b128 a[28:31], v17 offset:4096
  v_mfma_f32_16x16x32_bf16 v[28:31], a[44:47], a[0:3], v[28:31]
  s_add_u32 m0, s88, s27
  ds_read_b128 a[32:35], v17 offset:6144
  v_mfma_f32_16x16x32_bf16 v[36:39], a[44:47], a[4:7], v[36:39]
  ds_read_b64_tr_b16 a[68:69], v21 offset:22528
  v_mfma_f32_16x16x32_bf16 v[44:47], a[44:47], a[8:11], v[44:47]
  buffer_load_dwordx4 v11, s[20:23], s31 offen offset:0 lds
  ds_read_b64_tr_b16 a[70:71], v21 offset:24576
  v_mfma_f32_16x16x32_bf16 v[52:55], a[44:47], a[12:15], v[52:55]
  ds_read_b64_tr_b16 a[72:73], v20 offset:30720
  v_mfma_f32_16x16x32_bf16 v[56:59], a[48:51], a[0:3], v[56:59]
  ds_read_b64_tr_b16 a[74:75], v20 offset:32768
  v_mfma_f32_16x16x32_bf16 v[64:67], a[48:51], a[4:7], v[64:67]
  buffer_load_dwordx4 v12, s[20:23], s31 offen offset:1024 lds
  ds_read_b128 a[36:39], v19 offset:0
  v_mfma_f32_16x16x32_bf16 v[72:75], a[48:51], a[8:11], v[72:75]
  ds_read_b64_tr_b16 a[76:77], v21 offset:30720
  v_mfma_f32_16x16x32_bf16 v[80:83], a[48:51], a[12:15], v[80:83]
  ds_read_b64_tr_b16 a[78:79], v21 offset:32768
  v_mfma_f32_16x16x32_bf16 v[120:123], a[48:51], a[16:19], v[120:123]
  buffer_load_dwordx4 v13, s[20:23], s31 offen offset:2048 lds
  ds_read_b64_tr_b16 a[80:81], v20 offset:38912
  v_mfma_f32_16x16x32_bf16 v[60:63], a[52:55], a[0:3], v[60:63]
  s_add_u32 s31, s31, 393216
  s_cmp_ge_u32 s31, 6291456
  s_cselect_b32 s29, 6291456, 0
  v_mfma_f32_16x16x32_bf16 v[68:71], a[52:55], a[4:7], v[68:71]
  s_sub_u32 s31, s31, s29
  s_add_u32 s60, s63, 32768
  ds_read_b64_tr_b16 a[82:83], v20 offset:40960
  v_mfma_f32_16x16x32_bf16 v[76:79], a[52:55], a[8:11], v[76:79]
  buffer_store_dwordx4 v[200:203], v2, s[16:19], s60 offen offset:2048 sc1
  ds_read_b64_tr_b16 a[84:85], v21 offset:38912
  v_mfma_f32_16x16x32_bf16 v[84:87], a[52:55], a[12:15], v[84:87]
  s_add_u32 s88, s88, s90
  s_add_u32 s89, s89, 1
  ds_read_b64_tr_b16 a[86:87], v21 offset:40960
  v_mfma_f32_16x16x32_bf16 v[124:127], a[52:55], a[16:19], v[124:127]
  s_cmp_eq_u32 s89, 3
  s_cselect_b32 s89, 0, s89
  s_cselect_b32 s90, s91, s92
  v_mfma_f32_16x16x32_bf16 v[88:91], a[0:3], a[56:59], v[88:91]
  v_add_u32 v16, s90, v16
  v_add_u32 v17, s90, v17
  v_mfma_f32_16x16x32_bf16 v[96:99], a[4:7], a[56:59], v[96:99]
  v_add_u32 v18, s90, v18
  v_add_u32 v19, s90, v19
  v_mfma_f32_16x16x32_bf16 v[104:107], a[8:11], a[56:59], v[104:107]
  v_add_u32 v20, s90, v20
  v_add_u32 v21, s90, v21
  v_mfma_f32_16x16x32_bf16 v[112:115], a[12:15], a[56:59], v[112:115]
  v_mfma_f32_16x16x32_bf16 v[92:95], a[0:3], a[60:63], v[92:95]
  v_mfma_f32_16x16x32_bf16 v[100:103], a[4:7], a[60:63], v[100:103]
  v_mfma_f32_16x16x32_bf16 v[108:111], a[8:11], a[60:63], v[108:111]
  v_mfma_f32_16x16x32_bf16 v[116:119], a[12:15], a[60:63], v[116:119]
  s_waitcnt vmcnt(14) lgkmcnt(0)
  s_barrier
  v_mfma_f32_16x16x32_bf16 v[24:27], a[64:67], a[20:23], v[24:27]
  s_add_u32 m0, s88, s28
  ds_read_b128 a[0:3], v16 offset:0
  ds_read_b64_tr_b16 a[40:41], v20 offset:18432
  v_mfma_f32_16x16x32_bf16 v[32:35], a[64:67], a[24:27], v[32:35]
  buffer_load_dwordx4 v14, s[8:11], s30 offen offset:0 lds
  ds_read_b64_tr_b16 a[42:43], v20 offset:20480
  v_mfma_f32_16x16x32_bf16 v[40:43], a[64:67], a[28:31], v[40:43]
  s_mov_b32 m0, s88
  ds_read_b128 a[4:7], v16 offset:2048
  v_mfma_f32_16x16x32_bf16 v[48:51], a[64:67], a[32:35], v[48:51]
  buffer_load_dwordx4 v4, s[8:11], s30 offen offset:0 lds
  ds_read_b128 a[8:11], v16 offset:4096
  v_mfma_f32_16x16x32_bf16 v[28:31], a[68:71], a[20:23], v[28:31]
  ds_read_b128 a[12:15], v16 offset:6144
  v_mfma_f32_16x16x32_bf16 v[36:39], a[68:71], a[24:27], v[36:39]
  ds_read_b64_tr_b16 a[44:45], v21 offset:18432
  v_mfma_f32_16x16x32_bf16 v[44:47], a[68:71], a[28:31], v[44:47]
  ds_read_b64_tr_b16 a[46:47], v21 offset:20480
  v_mfma_f32_16x16x32_bf16 v[52:55], a[68:71], a[32:35], v[52:55]
  buffer_load_dwordx4 v5, s[8:11], s30 offen offset:1024 lds
  ds_read_b64_tr_b16 a[48:49], v20 offset:26624
  v_mfma_f32_16x16x32_bf16 v[56:59], a[72:75], a[20:23], v[56:59]
  ds_read_b64_tr_b16 a[50:51], v20 offset:28672
  v_mfma_f32_16x16x32_bf16 v[64:67], a[72:75], a[24:27], v[64:67]
  ds_read_b128 a[16:19], v18 offset:0
  v_mfma_f32_16x16x32_bf16 v[72:75], a[72:75], a[28:31], v[72:75]
  buffer_load_dwordx4 v6, s[8:11], s30 offen offset:2048 lds
  ds_read_b64_tr_b16 a[52:53], v21 offset:26624
  v_mfma_f32_16x16x32_bf16 v[80:83], a[72:75], a[32:35], v[80:83]
  ds_read_b64_tr_b16 a[54:55], v21 offset:28672
  v_mfma_f32_16x16x32_bf16 v[120:123], a[72:75], a[36:39], v[120:123]
  ds_read_b64_tr_b16 a[56:57], v20 offset:34816
  v_mfma_f32_16x16x32_bf16 v[60:63], a[76:79], a[20:23], v[60:63]
  ds_read_b64_tr_b16 a[58:59], v20 offset:36864
  v_mfma_f32_16x16x32_bf16 v[68:71], a[76:79], a[24:27], v[68:71]
  buffer_load_dwordx4 v7, s[8:11], s30 offen offset:3072 lds
  ds_read_b64_tr_b16 a[60:61], v21 offset:34816
  v_mfma_f32_16x16x32_bf16 v[76:79], a[76:79], a[28:31], v[76:79]
  s_add_u32 s30, s30, 128
  s_and_b32 s30, s30, 2047
  s_add_u32 m0, s88, s26
  v_mfma_f32_16x16x32_bf16 v[84:87], a[76:79], a[32:35], v[84:87]
  ds_read_b64_tr_b16 a[62:63], v21 offset:36864
  v_mfma_f32_16x16x32_bf16 v[124:127], a[76:79], a[36:39], v[124:127]
  buffer_load_dwordx4 v8, s[20:23], s31 offen offset:0 lds
  v_mfma_f32_16x16x32_bf16 v[88:91], a[20:23], a[80:83], v[88:91]
  v_mfma_f32_16x16x32_bf16 v[96:99], a[24:27], a[80:83], v[96:99]
  v_mfma_f32_16x16x32_bf16 v[104:107], a[28:31], a[80:83], v[104:107]
  v_mfma_f32_16x16x32_bf16 v[112:115], a[32:35], a[80:83], v[112:115]
  buffer_load_dwordx4 v9, s[20:23], s31 offen offset:1024 lds
  v_mfma_f32_16x16x32_bf16 v[92:95], a[20:23], a[84:87], v[92:95]
  v_mfma_f32_16x16x32_bf16 v[100:103], a[24:27], a[84:87], v[100:103]
  v_mfma_f32_16x16x32_bf16 v[108:111], a[28:31], a[84:87], v[108:111]
  v_mfma_f32_16x16x32_bf16 v[116:119], a[32:35], a[84:87], v[116:119]
  s_waitcnt lgkmcnt(0)
  v_mfma_f32_16x16x32_bf16 v[24:27], a[40:43], a[0:3], v[24:27]
  buffer_load_dwordx4 v10, s[20:23], s31 offen offset:2048 lds
  ds_read_b128 a[20:23], v17 offset:0
  v_mfma_f32_16x16x32_bf16 v[32:35], a[40:43], a[4:7], v[32:35]
  s_add_u32 m0, s88, s27
  ds_read_b64_tr_b16 a[64:65], v20 offset:22528
  ds_read_b64_tr_b16 a[66:67], v20 offset:24576
  v_mfma_f32_16x16x32_bf16 v[40:43], a[40:43], a[8:11], v[40:43]
  ds_read_b128 a[24:27], v17 offset:2048
  v_mfma_f32_16x16x32_bf16 v[48:51], a[40:43], a[12:15], v[48:51]
  buffer_load_dwordx4 v11, s[20:23], s31 offen offset:0 lds
  ds_read_b128 a[28:31], v17 offset:4096
  v_mfma_f32_16x16x32_bf16 v[28:31], a[44:47], a[0:3], v[28:31]
  ds_read_b128 a[32:35], v17 offset:6144
  v_mfma_f32_16x16x32_bf16 v[36:39], a[44:47], a[4:7], v[36:39]
  ds_read_b64_tr_b16 a[68:69], v21 offset:22528
  v_mfma_f32_16x16x32_bf16 v[44:47], a[44:47], a[8:11], v[44:47]
  buffer_load_dwordx4 v12, s[20:23], s31 offen offset:1024 lds
  ds_read_b64_tr_b16 a[70:71], v21 offset:24576
  v_mfma_f32_16x16x32_bf16 v[52:55], a[44:47], a[12:15], v[52:55]
  ds_read_b64_tr_b16 a[72:73], v20 offset:30720
  v_mfma_f32_16x16x32_bf16 v[56:59], a[48:51], a[0:3], v[56:59]
  ds_read_b64_tr_b16 a[74:75], v20 offset:32768
  v_mfma_f32_16x16x32_bf16 v[64:67], a[48:51], a[4:7], v[64:67]
  buffer_load_dwordx4 v13, s[20:23], s31 offen offset:2048 lds
  ds_read_b128 a[36:39], v19 offset:0
  v_mfma_f32_16x16x32_bf16 v[72:75], a[48:51], a[8:11], v[72:75]
  s_add_u32 s31, s31, 393216
  s_cmp_ge_u32 s31, 6291456
  s_cselect_b32 s29, 6291456, 0
  v_mfma_f32_16x16x32_bf16 v[80:83], a[48:51], a[12:15], v[80:83]
  s_sub_u32 s31, s31, s29
  s_add_u32 s60, s63, 0
  ds_read_b64_tr_b16 a[76:77], v21 offset:30720
  v_mfma_f32_16x16x32_bf16 v[120:123], a[48:51], a[16:19], v[120:123]
  buffer_store_dwordx4 v[160:163], v2, s[16:19], s60 offen offset:0 sc1
  ds_read_b64_tr_b16 a[78:79], v21 offset:32768
  v_mfma_f32_16x16x32_bf16 v[60:63], a[52:55], a[0:3], v[60:63]
  ds_read_b64_tr_b16 a[80:81], v20 offset:38912
  ds_read_b64_tr_b16 a[82:83], v20 offset:40960
  v_mfma_f32_16x16x32_bf16 v[68:71], a[52:55], a[4:7], v[68:71]
  ds_read_b64_tr_b16 a[84:85], v21 offset:38912
  v_mfma_f32_16x16x32_bf16 v[76:79], a[52:55], a[8:11], v[76:79]
  buffer_store_dwordx4 v[164:167], v2, s[16:19], s60 offen offset:1024 sc1
  ds_read_b64_tr_b16 a[86:87], v21 offset:40960
  v_mfma_f32_16x16x32_bf16 v[84:87], a[52:55], a[12:15], v[84:87]
  s_add_u32 s88, s88, s90
  s_add_u32 s89, s89, 1
  s_cmp_eq_u32 s89, 3
  s_cselect_b32 s89, 0, s89
  s_cselect_b32 s90, s91, s92
  v_mfma_f32_16x16x32_bf16 v[124:127], a[52:55], a[16:19], v[124:127]
  v_add_u32 v16, s90, v16
  v_add_u32 v17, s90, v17
  v_mfma_f32_16x16x32_bf16 v[88:91], a[0:3], a[56:59], v[88:91]
  v_add_u32 v18, s90, v18
  v_add_u32 v19, s90, v19
  v_mfma_f32_16x16x32_bf16 v[96:99], a[4:7], a[56:59], v[96:99]
  v_add_u32 v20, s90, v20
  v_add_u32 v21, s90, v21
  v_mfma_f32_16x16x32_bf16 v[104:107], a[8:11], a[56:59], v[104:107]
  v_mfma_f32_16x16x32_bf16 v[112:115], a[12:15], a[56:59], v[112:115]
  v_mfma_f32_16x16x32_bf16 v[92:95], a[0:3], a[60:63], v[92:95]
  v_mfma_f32_16x16x32_bf16 v[100:103], a[4:7], a[60:63], v[100:103]
  v_mfma_f32_16x16x32_bf16 v[108:111], a[8:11], a[60:63], v[108:111]
  v_mfma_f32_16x16x32_bf16 v[116:119], a[12:15], a[60:63], v[116:119]
  s_waitcnt vmcnt(14) lgkmcnt(0)
  s_barrier
  v_mfma_f32_16x16x32_bf16 v[24:27], a[64:67], a[20:23], v[24:27]
  s_add_u32 m0, s88, s28
  ds_read_b128 a[0:3], v16 offset:0
  ds_read_b64_tr_b16 a[40:41], v20 offset:18432
  v_mfma_f32_16x16x32_bf16 v[32:35], a[64:67], a[24:27], v[32:35]
  buffer_load_dwordx4 v14, s[8:11], s30 offen offset:0 lds
  ds_read_b64_tr_b16 a[42:43], v20 offset:20480
  v_mfma_f32_16x16x32_bf16 v[40:43], a[64:67], a[28:31], v[40:43]
  s_mov_b32 m0, s88
  ds_read_b128 a[4:7], v16 offset:2048
  v_mfma_f32_16x16x32_bf16 v[48:51], a[64:67], a[32:35], v[48:51]
  ds_read_b128 a[8:11], v16 offset:4096
  v_mfma_f32_16x16x32_bf16 v[28:31], a[68:71], a[20:23], v[28:31]
  buffer_load_dwordx4 v4, s[8:11], s30 offen offset:0 lds
  ds_read_b128 a[12:15], v16 offset:6144
  v_mfma_f32_16x16x32_bf16 v[36:39], a[68:71], a[24:27], v[36:39]
  ds_read_b64_tr_b16 a[44:45], v21 offset:18432
  v_mfma_f32_16x16x32_bf16 v[44:47], a[68:71], a[28:31], v[44:47]
  ds_read_b64_tr_b16 a[46:47], v21 offset:20480
  v_mfma_f32_16x16x32_bf16 v[52:55], a[68:71], a[32:35], v[52:55]
  ds_read_b64_tr_b16 a[48:49], v20 offset:26624
  v_mfma_f32_16x16x32_bf16 v[56:59], a[72:75], a[20:23], v[56:59]
  buffer_load_dwordx4 v5, s[8:11], s30 offen offset:1024 lds
  ds_read_b64_tr_b16 a[50:51], v20 offset:28672
  v_mfma_f32_16x16x32_bf16 v[64:67], a[72:75], a[24:27], v[64:67]
  ds_read_b128 a[16:19], v18 offset:0
  v_mfma_f32_16x16x32_bf16 v[72:75], a[72:75], a[28:31], v[72:75]
  ds_read_b64_tr_b16 a[52:53], v21 offset:26624
  v_mfma_f32_16x16x32_bf16 v[80:83], a[72:75], a[32:35], v[80:83]
  ds_read_b64_tr_b16 a[54:55], v21 offset:28672
  v_mfma_f32_16x16x32_bf16 v[120:123], a[72:75], a[36:39], v[120:123]
  buffer_load_dwordx4 v6, s[8:11], s30 offen offset:2048 lds
  ds_read_b64_tr_b16 a[56:57], v20 offset:34816
  v_mfma_f32_16x16x32_bf16 v[60:63], a[76:79], a[20:23], v[60:63]
  ds_read_b64_tr_b16 a[58:59], v20 offset:36864
  v_mfma_f32_16x16x32_bf16 v[68:71], a[76:79], a[24:27], v[68:71]
  ds_read_b64_tr_b16 a[60:61], v21 offset:34816
  v_mfma_f32_16x16x32_bf16 v[76:79], a[76:79], a[28:31], v[76:79]
  ds_read_b64_tr_b16 a[62:63], v21 offset:36864
  v_mfma_f32_16x16x32_bf16 v[84:87], a[76:79], a[32:35], v[84:87]
  buffer_load_dwordx4 v7, s[8:11], s30 offen offset:3072 lds
  v_mfma_f32_16x16x32_bf16 v[124:127], a[76:79], a[36:39], v[124:127]
  s_add_u32 s30, s30, 128
  s_and_b32 s30, s30, 2047
  s_add_u32 m0, s88, s26
  v_mfma_f32_16x16x32_bf16 v[88:91], a[20:23], a[80:83], v[88:91]
  v_mfma_f32_16x16x32_bf16 v[96:99], a[24:27], a[80:83], v[96:99]
  v_mfma_f32_16x16x32_bf16 v[104:107], a[28:31], a[80:83], v[104:107]
  buffer_load_dwordx4 v8, s[20:23], s31 offen offset:0 lds
  v_mfma_f32_16x16x32_bf16 v[112:115], a[32:35], a[80:83], v[112:115]
  v_mfma_f32_16x16x32_bf16 v[92:95], a[20:23], a[84:87], v[92:95]
  v_mfma_f32_16x16x32_bf16 v[100:103], a[24:27], a[84:87], v[100:103]
  v_mfma_f32_16x16x32_bf16 v[108:111], a[28:31], a[84:87], v[108:111]
  v_mfma_f32_16x16x32_bf16 v[116:119], a[32:35], a[84:87], v[116:119]
  s_waitcnt lgkmcnt(0)
  v_mfma_f32_16x16x32_bf16 v[24:27], a[40:43], a[0:3], v[24:27]
  buffer_load_dwordx4 v9, s[20:23], s31 offen offset:1024 lds
  ds_read_b128 a[20:23], v17 offset:0
  v_mfma_f32_16x16x32_bf16 v[32:35], a[40:43], a[4:7], v[32:35]
  ds_read_b64_tr_b16 a[64:65], v20 offset:22528
  ds_read_b64_tr_b16 a[66:67], v20 offset:24576
  v_mfma_f32_16x16x32_bf16 v[40:43], a[40:43], a[8:11], v[40:43]
  ds_read_b128 a[24:27], v17 offset:2048
  v_mfma_f32_16x16x32_bf16 v[48:51], a[40:43], a[12:15], v[48:51]
  buffer_load_dwordx4 v10, s[20:23], s31 offen offset:2048 lds
  ds_read_b128 a[28:31], v17 offset:4096
  v_mfma_f32_16x16x32_bf16 v[28:31], a[44:47], a[0:3], v[28:31]
  s_add_u32 m0, s88, s27
  ds_read_b128 a[32:35], v17 offset:6144
  v_mfma_f32_16x16x32_bf16 v[36:39], a[44:47], a[4:7], v[36:39]
  ds_read_b64_tr_b16 a[68:69], v21 offset:22528
  v_mfma_f32_16x16x32_bf16 v[44:47], a[44:47], a[8:11], v[44:47]
  buffer_load_dwordx4 v11, s[20:23], s31 offen offset:0 lds
  ds_read_b64_tr_b16 a[70:71], v21 offset:24576
  v_mfma_f32_16x16x32_bf16 v[52:55], a[44:47], a[12:15], v[52:55]
  ds_read_b64_tr_b16 a[72:73], v20 offset:30720
  v_mfma_f32_16x16x32_bf16 v[56:59], a[48:51], a[0:3], v[56:59]
  ds_read_b64_tr_b16 a[74:75], v20 offset:32768
  v_mfma_f32_16x16x32_bf16 v[64:67], a[48:51], a[4:7], v[64:67]
  buffer_load_dwordx4 v12, s[20:23], s31 offen offset:1024 lds
  ds_read_b128 a[36:39], v19 offset:0
  v_mfma_f32_16x16x32_bf16 v[72:75], a[48:51], a[8:11], v[72:75]
  ds_read_b64_tr_b16 a[76:77], v21 offset:30720
  v_mfma_f32_16x16x32_bf16 v[80:83], a[48:51], a[12:15], v[80:83]
  ds_read_b64_tr_b16 a[78:79], v21 offset:32768
  v_mfma_f32_16x16x32_bf16 v[120:123], a[48:51], a[16:19], v[120:123]
  buffer_load_dwordx4 v13, s[20:23], s31 offen offset:2048 lds
  ds_read_b64_tr_b16 a[80:81], v20 offset:38912
  v_mfma_f32_16x16x32_bf16 v[60:63], a[52:55], a[0:3], v[60:63]
  s_add_u32 s31, s31, 393216
  s_cmp_ge_u32 s31, 6291456
  s_cselect_b32 s29, 6291456, 0
  v_mfma_f32_16x16x32_bf16 v[68:71], a[52:55], a[4:7], v[68:71]
  s_sub_u32 s31, s31, s29
  s_add_u32 s60, s63, 0
  ds_read_b64_tr_b16 a[82:83], v20 offset:40960
  v_mfma_f32_16x16x32_bf16 v[76:79], a[52:55], a[8:11], v[76:79]
  buffer_store_dwordx4 v[168:171], v2, s[16:19], s60 offen offset:2048 sc1
  ds_read_b64_tr_b16 a[84:85], v21 offset:38912
  v_mfma_f32_16x16x32_bf16 v[84:87], a[52:55], a[12:15], v[84:87]
  s_add_u32 s88, s88, s90
  s_add_u32 s89, s89, 1
  ds_read_b64_tr_b16 a[86:87], v21 offset:40960
  v_mfma_f32_16x16x32_bf16 v[124:127], a[52:55], a[16:19], v[124:127]
  s_cmp_eq_u32 s89, 3
  s_cselect_b32 s89, 0, s89
  s_cselect_b32 s90, s91, s92
  v_mfma_f32_16x16x32_bf16 v[88:91], a[0:3], a[56:59], v[88:91]
  v_add_u32 v16, s90, v16
  v_add_u32 v17, s90, v17
  v_mfma_f32_16x16x32_bf16 v[96:99], a[4:7], a[56:59], v[96:99]
  v_add_u32 v18, s90, v18
  v_add_u32 v19, s90, v19
  v_mfma_f32_16x16x32_bf16 v[104:107], a[8:11], a[56:59], v[104:107]
  v_add_u32 v20, s90, v20
  v_add_u32 v21, s90, v21
  v_mfma_f32_16x16x32_bf16 v[112:115], a[12:15], a[56:59], v[112:115]
  v_mfma_f32_16x16x32_bf16 v[92:95], a[0:3], a[60:63], v[92:95]
  v_mfma_f32_16x16x32_bf16 v[100:103], a[4:7], a[60:63], v[100:103]
  v_mfma_f32_16x16x32_bf16 v[108:111], a[8:11], a[60:63], v[108:111]
  v_mfma_f32_16x16x32_bf16 v[116:119], a[12:15], a[60:63], v[116:119]
  s_waitcnt vmcnt(14) lgkmcnt(0)
  s_barrier
  v_mfma_f32_16x16x32_bf16 v[24:27], a[64:67], a[20:23], v[24:27]
  s_add_u32 m0, s88, s28
  ds_read_b128 a[0:3], v16 offset:0
  ds_read_b64_tr_b16 a[40:41], v20 offset:18432
  v_mfma_f32_16x16x32_bf16 v[32:35], a[64:67], a[24:27], v[32:35]
  buffer_load_dwordx4 v14, s[8:11], s30 offen offset:0 lds
  ds_read_b64_tr_b16 a[42:43], v20 offset:20480
  v_mfma_f32_16x16x32_bf16 v[40:43], a[64:67], a[28:31], v[40:43]
  s_mov_b32 m0, s88
  ds_read_b128 a[4:7], v16 offset:2048
  v_mfma_f32_16x16x32_bf16 v[48:51], a[64:67], a[32:35], v[48:51]
  ds_read_b128 a[8:11], v16 offset:4096
  v_mfma_f32_16x16x32_bf16 v[28:31], a[68:71], a[20:23], v[28:31]
  buffer_load_dwordx4 v4, s[8:11], s30 offen offset:0 lds
  ds_read_b128 a[12:15], v16 offset:6144
  v_mfma_f32_16x16x32_bf16 v[36:39], a[68:71], a[24:27], v[36:39]
  ds_read_b64_tr_b16 a[44:45], v21 offset:18432
  v_mfma_f32_16x16x32_bf16 v[44:47], a[68:71], a[28:31], v[44:47]
  ds_read_b64_tr_b16 a[46:47], v21 offset:20480
  v_mfma_f32_16x16x32_bf16 v[52:55], a[68:71], a[32:35], v[52:55]
  ds_read_b64_tr_b16 a[48:49], v20 offset:26624
  v_mfma_f32_16x16x32_bf16 v[56:59], a[72:75], a[20:23], v[56:59]
  buffer_load_dwordx4 v5, s[8:11], s30 offen offset:1024 lds
  ds_read_b64_tr_b16 a[50:51], v20 offset:28672
  v_mfma_f32_16x16x32_bf16 v[64:67], a[72:75], a[24:27], v[64:67]
  ds_read_b128 a[16:19], v18 offset:0
  v_mfma_f32_16x16x32_bf16 v[72:75], a[72:75], a[28:31], v[72:75]
  ds_read_b64_tr_b16 a[52:53], v21 offset:26624
  v_mfma_f32_16x16x32_bf16 v[80:83], a[72:75], a[32:35], v[80:83]
  ds_read_b64_tr_b16 a[54:55], v21 offset:28672
  v_mfma_f32_16x16x32_bf16 v[120:123], a[72:75], a[36:39], v[120:123]
  buffer_load_dwordx4 v6, s[8:11], s30 offen offset:2048 lds
  ds_read_b64_tr_b16 a[56:57], v20 offset:34816
  v_mfma_f32_16x16x32_bf16 v[60:63], a[76:79], a[20:23], v[60:63]
  ds_read_b64_tr_b16 a[58:59], v20 offset:36864
  v_mfma_f32_16x16x32_bf16 v[68:71], a[76:79], a[24:27], v[68:71]
  ds_read_b64_tr_b16 a[60:61], v21 offset:34816
  v_mfma_f32_16x16x32_bf16 v[76:79], a[76:79], a[28:31], v[76:79]
  ds_read_b64_tr_b16 a[62:63], v21 offset:36864
  v_mfma_f32_16x16x32_bf16 v[84:87], a[76:79], a[32:35], v[84:87]
  buffer_load_dwordx4 v7, s[8:11], s30 offen offset:3072 lds
  v_mfma_f32_16x16x32_bf16 v[124:127], a[76:79], a[36:39], v[124:127]
  s_add_u32 s30, s30, 128
  s_and_b32 s30, s30, 2047
  s_add_u32 m0, s88, s26
  v_mfma_f32_16x16x32_bf16 v[88:91], a[20:23], a[80:83], v[88:91]
  v_mfma_f32_16x16x32_bf16 v[96:99], a[24:27], a[80:83], v[96:99]
  v_mfma_f32_16x16x32_bf16 v[104:107], a[28:31], a[80:83], v[104:107]
  buffer_load_dwordx4 v8, s[20:23], s31 offen offset:0 lds
  v_mfma_f32_16x16x32_bf16 v[112:115], a[32:35], a[80:83], v[112:115]
  v_mfma_f32_16x16x32_bf16 v[92:95], a[20:23], a[84:87], v[92:95]
  v_mfma_f32_16x16x32_bf16 v[100:103], a[24:27], a[84:87], v[100:103]
  v_mfma_f32_16x16x32_bf16 v[108:111], a[28:31], a[84:87], v[108:111]
  v_mfma_f32_16x16x32_bf16 v[116:119], a[32:35], a[84:87], v[116:119]
  s_waitcnt lgkmcnt(0)
  v_mfma_f32_16x16x32_bf16 v[24:27], a[40:43], a[0:3], v[24:27]
  buffer_load_dwordx4 v9, s[20:23], s31 offen offset:1024 lds
  ds_read_b128 a[20:23], v17 offset:0
  v_mfma_f32_16x16x32_bf16 v[32:35], a[40:43], a[4:7], v[32:35]
  ds_read_b64_tr_b16 a[64:65], v20 offset:22528
  ds_read_b64_tr_b16 a[66:67], v20 offset:24576
  v_mfma_f32_16x16x32_bf16 v[40:43], a[40:43], a[8:11], v[40:43]
  ds_read_b128 a[24:27], v17 offset:2048
  v_mfma_f32_16x16x32_bf16 v[48:51], a[40:43], a[12:15], v[48:51]
  buffer_load_dwordx4 v10, s[20:23], s31 offen offset:2048 lds
  ds_read_b128 a[28:31], v17 offset:4096
  v_mfma_f32_16x16x32_bf16 v[28:31], a[44:47], a[0:3], v[28:31]
  s_add_u32 m0, s88, s27
  ds_read_b128 a[32:35], v17 offset:6144
  v_mfma_f32_16x16x32_bf16 v[36:39], a[44:47], a[4:7], v[36:39]
  ds_read_b64_tr_b16 a[68:69], v21 offset:22528
  v_mfma_f32_16x16x32_bf16 v[44:47], a[44:47], a[8:11], v[44:47]
  buffer_load_dwordx4 v11, s[20:23], s31 offen offset:0 lds
  ds_read_b64_tr_b16 a[70:71], v21 offset:24576
  v_mfma_f32_16x16x32_bf16 v[52:55], a[44:47], a[12:15], v[52:55]
  ds_read_b64_tr_b16 a[72:73], v20 offset:30720
  v_mfma_f32_16x16x32_bf16 v[56:59], a[48:51], a[0:3], v[56:59]
  ds_read_b64_tr_b16 a[74:75], v20 offset:32768
  v_mfma_f32_16x16x32_bf16 v[64:67], a[48:51], a[4:7], v[64:67]
  buffer_load_dwordx4 v12, s[20:23], s31 offen offset:1024 lds
  ds_read_b128 a[36:39], v19 offset:0
  v_mfma_f32_16x16x32_bf16 v[72:75], a[48:51], a[8:11], v[72:75]
  ds_read_b64_tr_b16 a[76:77], v21 offset:30720
  v_mfma_f32_16x16x32_bf16 v[80:83], a[48:51], a[12:15], v[80:83]
  ds_read_b64_tr_b16 a[78:79], v21 offset:32768
  v_mfma_f32_16x16x32_bf16 v[120:123], a[48:51], a[16:19], v[120:123]
  buffer_load_dwordx4 v13, s[20:23], s31 offen offset:2048 lds
  ds_read_b64_tr_b16 a[80:81], v20 offset:38912
  v_mfma_f32_16x16x32_bf16 v[60:63], a[52:55], a[0:3], v[60:63]
  s_add_u32 s31, s31, 393216
  s_cmp_ge_u32 s31, 6291456
  s_cselect_b32 s29, 6291456, 0
  v_mfma_f32_16x16x32_bf16 v[68:71], a[52:55], a[4:7], v[68:71]
  s_sub_u32 s31, s31, s29
  s_add_u32 s60, s63, 0
  ds_read_b64_tr_b16 a[82:83], v20 offset:40960
  v_mfma_f32_16x16x32_bf16 v[76:79], a[52:55], a[8:11], v[76:79]
  buffer_store_dwordx4 v[172:175], v2, s[16:19], s60 offen offset:3072 sc1
  ds_read_b64_tr_b16 a[84:85], v21 offset:38912
  v_mfma_f32_16x16x32_bf16 v[84:87], a[52:55], a[12:15], v[84:87]
  s_add_u32 s88, s88, s90
  s_add_u32 s89, s89, 1
  ds_read_b64_tr_b16 a[86:87], v21 offset:40960
  v_mfma_f32_16x16x32_bf16 v[124:127], a[52:55], a[16:19], v[124:127]
  s_cmp_eq_u32 s89, 3
  s_cselect_b32 s89, 0, s89
  s_cselect_b32 s90, s91, s92
  v_mfma_f32_16x16x32_bf16 v[88:91], a[0:3], a[56:59], v[88:91]
  v_add_u32 v16, s90, v16
  v_add_u32 v17, s90, v17
  v_mfma_f32_16x16x32_bf16 v[96:99], a[4:7], a[56:59], v[96:99]
  v_add_u32 v18, s90, v18
  v_add_u32 v19, s90, v19
  v_mfma_f32_16x16x32_bf16 v[104:107], a[8:11], a[56:59], v[104:107]
  v_add_u32 v20, s90, v20
  v_add_u32 v21, s90, v21
  v_mfma_f32_16x16x32_bf16 v[112:115], a[12:15], a[56:59], v[112:115]
  v_mfma_f32_16x16x32_bf16 v[92:95], a[0:3], a[60:63], v[92:95]
  v_mfma_f32_16x16x32_bf16 v[100:103], a[4:7], a[60:63], v[100:103]
  v_mfma_f32_16x16x32_bf16 v[108:111], a[8:11], a[60:63], v[108:111]
  v_mfma_f32_16x16x32_bf16 v[116:119], a[12:15], a[60:63], v[116:119]
  s_waitcnt vmcnt(13) lgkmcnt(0)
  s_barrier
  v_mfma_f32_16x16x32_bf16 v[24:27], a[64:67], a[20:23], v[24:27]
  s_add_u32 m0, s88, s28
  ds_read_b128 a[0:3], v16 offset:0
  ds_read_b64_tr_b16 a[40:41], v20 offset:18432
  v_mfma_f32_16x16x32_bf16 v[32:35], a[64:67], a[24:27], v[32:35]
  buffer_load_dwordx4 v14, s[8:11], s30 offen offset:0 lds
  ds_read_b64_tr_b16 a[42:43], v20 offset:20480
  v_mfma_f32_16x16x32_bf16 v[40:43], a[64:67], a[28:31], v[40:43]
  s_mov_b32 m0, s88
  ds_read_b128 a[4:7], v16 offset:2048
  v_mfma_f32_16x16x32_bf16 v[48:51], a[64:67], a[32:35], v[48:51]
  buffer_load_dwordx4 v4, s[8:11], s30 offen offset:0 lds
  ds_read_b128 a[8:11], v16 offset:4096
  v_mfma_f32_16x16x32_bf16 v[28:31], a[68:71], a[20:23], v[28:31]
  ds_read_b128 a[12:15], v16 offset:6144
  v_mfma_f32_16x16x32_bf16 v[36:39], a[68:71], a[24:27], v[36:39]
  ds_read_b64_tr_b16 a[44:45], v21 offset:18432
  v_mfma_f32_16x16x32_bf16 v[44:47], a[68:71], a[28:31], v[44:47]
  ds_read_b64_tr_b16 a[46:47], v21 offset:20480
  v_mfma_f32_16x16x32_bf16 v[52:55], a[68:71], a[32:35], v[52:55]
  buffer_load_dwordx4 v5, s[8:11], s30 offen offset:1024 lds
  ds_read_b64_tr_b16 a[48:49], v20 offset:26624
  v_mfma_f32_16x16x32_bf16 v[56:59], a[72:75], a[20:23], v[56:59]
  ds_read_b64_tr_b16 a[50:51], v20 offset:28672
  v_mfma_f32_16x16x32_bf16 v[64:67], a[72:75], a[24:27], v[64:67]
  ds_read_b128 a[16:19], v18 offset:0
  v_mfma_f32_16x16x32_bf16 v[72:75], a[72:75], a[28:31], v[72:75]
  buffer_load_dwordx4 v6, s[8:11], s30 offen offset:2048 lds
  ds_read_b64_tr_b16 a[52:53], v21 offset:26624
  v_mfma_f32_16x16x32_bf16 v[80:83], a[72:75], a[32:35], v[80:83]
  ds_read_b64_tr_b16 a[54:55], v21 offset:28672
  v_mfma_f32_16x16x32_bf16 v[120:123], a[72:75], a[36:39], v[120:123]
  ds_read_b64_tr_b16 a[56:57], v20 offset:34816
  v_mfma_f32_16x16x32_bf16 v[60:63], a[76:79], a[20:23], v[60:63]
  ds_read_b64_tr_b16 a[58:59], v20 offset:36864
  v_mfma_f32_16x16x32_bf16 v[68:71], a[76:79], a[24:27], v[68:71]
  buffer_load_dwordx4 v7, s[8:11], s30 offen offset:3072 lds
  ds_read_b64_tr_b16 a[60:61], v21 offset:34816
  v_mfma_f32_16x16x32_bf16 v[76:79], a[76:79], a[28:31], v[76:79]
  s_add_u32 s30, s30, 128
  s_and_b32 s30, s30, 2047
  s_add_u32 m0, s88, s26
  v_mfma_f32_16x16x32_bf16 v[84:87], a[76:79], a[32:35], v[84:87]
  ds_read_b64_tr_b16 a[62:63], v21 offset:36864
  v_mfma_f32_16x16x32_bf16 v[124:127], a[76:79], a[36:39], v[124:127]
  buffer_load_dwordx4 v8, s[20:23], s31 offen offset:0 lds
  v_mfma_f32_16x16x32_bf16 v[88:91], a[20:23], a[80:83], v[88:91]
  v_mfma_f32_16x16x32_bf16 v[96:99], a[24:27], a[80:83], v[96:99]
  v_mfma_f32_16x16x32_bf16 v[104:107], a[28:31], a[80:83], v[104:107]
  v_mfma_f32_16x16x32_bf16 v[112:115], a[32:35], a[80:83], v[112:115]
  buffer_load_dwordx4 v9, s[20:23], s31 offen offset:1024 lds
  v_mfma_f32_16x16x32_bf16 v[92:95], a[20:23], a[84:87], v[92:95]
  v_mfma_f32_16x16x32_bf16 v[100:103], a[24:27], a[84:87], v[100:103]
  v_mfma_f32_16x16x32_bf16 v[108:111], a[28:31], a[84:87], v[108:111]
  v_mfma_f32_16x16x32_bf16 v[116:119], a[32:35], a[84:87], v[116:119]
  s_waitcnt lgkmcnt(0)
  v_mfma_f32_16x16x32_bf16 v[24:27], a[40:43], a[0:3], v[24:27]
  buffer_load_dwordx4 v10, s[20:23], s31 offen offset:2048 lds
  ds_read_b128 a[20:23], v17 offset:0
  v_mfma_f32_16x16x32_bf16 v[32:35], a[40:43], a[4:7], v[32:35]
  s_add_u32 m0, s88, s27
  ds_read_b64_tr_b16 a[64:65], v20 offset:22528
  ds_read_b64_tr_b16 a[66:67], v20 offset:24576
  v_mfma_f32_16x16x32_bf16 v[40:43], a[40:43], a[8:11], v[40:43]
  ds_read_b128 a[24:27], v17 offset:2048
  v_mfma_f32_16x16x32_bf16 v[48:51], a[40:43], a[12:15], v[48:51]
  buffer_load_dwordx4 v11, s[20:23], s31 offen offset:0 lds
  ds_read_b128 a[28:31], v17 offset:4096
  v_mfma_f32_16x16x32_bf16 v[28:31], a[44:47], a[0:3], v[28:31]
  ds_read_b128 a[32:35], v17 offset:6144
  v_mfma_f32_16x16x32_bf16 v[36:39], a[44:47], a[4:7], v[36:39]
  ds_read_b64_tr_b16 a[68:69], v21 offset:22528
  v_mfma_f32_16x16x32_bf16 v[44:47], a[44:47], a[8:11], v[44:47]
  buffer_load_dwordx4 v12, s[20:23], s31 offen offset:1024 lds
  ds_read_b64_tr_b16 a[70:71], v21 offset:24576
  v_mfma_f32_16x16x32_bf16 v[52:55], a[44:47], a[12:15], v[52:55]
  ds_read_b64_tr_b16 a[72:73], v20 offset:30720
  v_mfma_f32_16x16x32_bf16 v[56:59], a[48:51], a[0:3], v[56:59]
  ds_read_b64_tr_b16 a[74:75], v20 offset:32768
  v_mfma_f32_16x16x32_bf16 v[64:67], a[48:51], a[4:7], v[64:67]
  buffer_load_dwordx4 v13, s[20:23], s31 offen offset:2048 lds
  ds_read_b128 a[36:39], v19 offset:0
  v_mfma_f32_16x16x32_bf16 v[72:75], a[48:51], a[8:11], v[72:75]
  s_add_u32 s31, s31, 393216
  s_cmp_ge_u32 s31, 6291456
  s_cselect_b32 s29, 6291456, 0
  v_mfma_f32_16x16x32_bf16 v[80:83], a[48:51], a[12:15], v[80:83]
  s_sub_u32 s31, s31, s29
  s_add_u32 s60, s63, 4096
  ds_read_b64_tr_b16 a[76:77], v21 offset:30720
  v_mfma_f32_16x16x32_bf16 v[120:123], a[48:51], a[16:19], v[120:123]
  buffer_store_dwordx4 v[176:179], v2, s[16:19], s60 offen offset:0 sc1
  ds_read_b64_tr_b16 a[78:79], v21 offset:32768
  v_mfma_f32_16x16x32_bf16 v[60:63], a[52:55], a[0:3], v[60:63]
  ds_read_b64_tr_b16 a[80:81], v20 offset:38912
  ds_read_b64_tr_b16 a[82:83], v20 offset:40960
  v_mfma_f32_16x16x32_bf16 v[68:71], a[52:55], a[4:7], v[68:71]
  ds_read_b64_tr_b16 a[84:85], v21 offset:38912
  v_mfma_f32_16x16x32_bf16 v[76:79], a[52:55], a[8:11], v[76:79]
  buffer_store_dwordx4 v[180:183], v2, s[16:19], s60 offen offset:1024 sc1
  ds_read_b64_tr_b16 a[86:87], v21 offset:40960
  v_mfma_f32_16x16x32_bf16 v[84:87], a[52:55], a[12:15], v[84:87]
  s_add_u32 s88, s88, s90
  s_add_u32 s89, s89, 1
  s_cmp_eq_u32 s89, 3
  s_cselect_b32 s89, 0, s89
  s_cselect_b32 s90, s91, s92
  v_mfma_f32_16x16x32_bf16 v[124:127], a[52:55], a[16:19], v[124:127]
  v_add_u32 v16, s90, v16
  v_add_u32 v17, s90, v17
  v_mfma_f32_16x16x32_bf16 v[88:91], a[0:3], a[56:59], v[88:91]
  v_add_u32 v18, s90, v18
  v_add_u32 v19, s90, v19
  v_mfma_f32_16x16x32_bf16 v[96:99], a[4:7], a[56:59], v[96:99]
  v_add_u32 v20, s90, v20
  v_add_u32 v21, s90, v21
  v_mfma_f32_16x16x32_bf16 v[104:107], a[8:11], a[56:59], v[104:107]
  v_mfma_f32_16x16x32_bf16 v[112:115], a[12:15], a[56:59], v[112:115]
  v_mfma_f32_16x16x32_bf16 v[92:95], a[0:3], a[60:63], v[92:95]
  v_mfma_f32_16x16x32_bf16 v[100:103], a[4:7], a[60:63], v[100:103]
  v_mfma_f32_16x16x32_bf16 v[108:111], a[8:11], a[60:63], v[108:111]
  v_mfma_f32_16x16x32_bf16 v[116:119], a[12:15], a[60:63], v[116:119]
  s_waitcnt vmcnt(14) lgkmcnt(0)
  s_barrier
  v_mfma_f32_16x16x32_bf16 v[24:27], a[64:67], a[20:23], v[24:27]
  s_add_u32 m0, s88, s28
  ds_read_b128 a[0:3], v16 offset:0
  ds_read_b64_tr_b16 a[40:41], v20 offset:18432
  v_mfma_f32_16x16x32_bf16 v[32:35], a[64:67], a[24:27], v[32:35]
  buffer_load_dwordx4 v14, s[8:11], s30 offen offset:0 lds
  ds_read_b64_tr_b16 a[42:43], v20 offset:20480
  v_mfma_f32_16x16x32_bf16 v[40:43], a[64:67], a[28:31], v[40:43]
  s_mov_b32 m0, s88
  ds_read_b128 a[4:7], v16 offset:2048
  v_mfma_f32_16x16x32_bf16 v[48:51], a[64:67], a[32:35], v[48:51]
  ds_read_b128 a[8:11], v16 offset:4096
  v_mfma_f32_16x16x32_bf16 v[28:31], a[68:71], a[20:23], v[28:31]
  buffer_load_dwordx4 v4, s[8:11], s30 offen offset:0 lds
  ds_read_b128 a[12:15], v16 offset:6144
  v_mfma_f32_16x16x32_bf16 v[36:39], a[68:71], a[24:27], v[36:39]
  ds_read_b64_tr_b16 a[44:45], v21 offset:18432
  v_mfma_f32_16x16x32_bf16 v[44:47], a[68:71], a[28:31], v[44:47]
  ds_read_b64_tr_b16 a[46:47], v21 offset:20480
  v_mfma_f32_16x16x32_bf16 v[52:55], a[68:71], a[32:35], v[52:55]
  ds_read_b64_tr_b16 a[48:49], v20 offset:26624
  v_mfma_f32_16x16x32_bf16 v[56:59], a[72:75], a[20:23], v[56:59]
  buffer_load_dwordx4 v5, s[8:11], s30 offen offset:1024 lds
  ds_read_b64_tr_b16 a[50:51], v20 offset:28672
  v_mfma_f32_16x16x32_bf16 v[64:67], a[72:75], a[24:27], v[64:67]
  ds_read_b128 a[16:19], v18 offset:0
  v_mfma_f32_16x16x32_bf16 v[72:75], a[72:75], a[28:31], v[72:75]
  ds_read_b64_tr_b16 a[52:53], v21 offset:26624
  v_mfma_f32_16x16x32_bf16 v[80:83], a[72:75], a[32:35], v[80:83]
  ds_read_b64_tr_b16 a[54:55], v21 offset:28672
  v_mfma_f32_16x16x32_bf16 v[120:123], a[72:75], a[36:39], v[120:123]
  buffer_load_dwordx4 v6, s[8:11], s30 offen offset:2048 lds
  ds_read_b64_tr_b16 a[56:57], v20 offset:34816
  v_mfma_f32_16x16x32_bf16 v[60:63], a[76:79], a[20:23], v[60:63]
  ds_read_b64_tr_b16 a[58:59], v20 offset:36864
  v_mfma_f32_16x16x32_bf16 v[68:71], a[76:79], a[24:27], v[68:71]
  ds_read_b64_tr_b16 a[60:61], v21 offset:34816
  v_mfma_f32_16x16x32_bf16 v[76:79], a[76:79], a[28:31], v[76:79]
  ds_read_b64_tr_b16 a[62:63], v21 offset:36864
  v_mfma_f32_16x16x32_bf16 v[84:87], a[76:79], a[32:35], v[84:87]
  buffer_load_dwordx4 v7, s[8:11], s30 offen offset:3072 lds
  v_mfma_f32_16x16x32_bf16 v[124:127], a[76:79], a[36:39], v[124:127]
  s_add_u32 s30, s30, 128
  s_and_b32 s30, s30, 2047
  s_add_u32 m0, s88, s26
  v_mfma_f32_16x16x32_bf16 v[88:91], a[20:23], a[80:83], v[88:91]
  v_mfma_f32_16x16x32_bf16 v[96:99], a[24:27], a[80:83], v[96:99]
  v_mfma_f32_16x16x32_bf16 v[104:107], a[28:31], a[80:83], v[104:107]
  buffer_load_dwordx4 v8, s[20:23], s31 offen offset:0 lds
  v_mfma_f32_16x16x32_bf16 v[112:115], a[32:35], a[80:83], v[112:115]
  v_mfma_f32_16x16x32_bf16 v[92:95], a[20:23], a[84:87], v[92:95]
  v_mfma_f32_16x16x32_bf16 v[100:103], a[24:27], a[84:87], v[100:103]
  v_mfma_f32_16x16x32_bf16 v[108:111], a[28:31], a[84:87], v[108:111]
  v_mfma_f32_16x16x32_bf16 v[116:119], a[32:35], a[84:87], v[116:119]
  s_waitcnt lgkmcnt(0)
  v_mfma_f32_16x16x32_bf16 v[24:27], a[40:43], a[0:3], v[24:27]
  buffer_load_dwordx4 v9, s[20:23], s31 offen offset:1024 lds
  ds_read_b128 a[20:23], v17 offset:0
  v_mfma_f32_16x16x32_bf16 v[32:35], a[40:43], a[4:7], v[32:35]
  ds_read_b64_tr_b16 a[64:65], v20 offset:22528
  ds_read_b64_tr_b16 a[66:67], v20 offset:24576
  v_mfma_f32_16x16x32_bf16 v[40:43], a[40:43], a[8:11], v[40:43]
  ds_read_b128 a[24:27], v17 offset:2048
  v_mfma_f32_16x16x32_bf16 v[48:51], a[40:43], a[12:15], v[48:51]
  buffer_load_dwordx4 v10, s[20:23], s31 offen offset:2048 lds
  ds_read_b128 a[28:31], v17 offset:4096
  v_mfma_f32_16x16x32_bf16 v[28:31], a[44:47], a[0:3], v[28:31]
  s_add_u32 m0, s88, s27
  ds_read_b128 a[32:35], v17 offset:6144
  v_mfma_f32_16x16x32_bf16 v[36:39], a[44:47], a[4:7], v[36:39]
  ds_read_b64_tr_b16 a[68:69], v21 offset:22528
  v_mfma_f32_16x16x32_bf16 v[44:47], a[44:47], a[8:11], v[44:47]
  buffer_load_dwordx4 v11, s[20:23], s31 offen offset:0 lds
  ds_read_b64_tr_b16 a[70:71], v21 offset:24576
  v_mfma_f32_16x16x32_bf16 v[52:55], a[44:47], a[12:15], v[52:55]
  ds_read_b64_tr_b16 a[72:73], v20 offset:30720
  v_mfma_f32_16x16x32_bf16 v[56:59], a[48:51], a[0:3], v[56:59]
  ds_read_b64_tr_b16 a[74:75], v20 offset:32768
  v_mfma_f32_16x16x32_bf16 v[64:67], a[48:51], a[4:7], v[64:67]
  buffer_load_dwordx4 v12, s[20:23], s31 offen offset:1024 lds
  ds_read_b128 a[36:39], v19 offset:0
  v_mfma_f32_16x16x32_bf16 v[72:75], a[48:51], a[8:11], v[72:75]
  ds_read_b64_tr_b16 a[76:77], v21 offset:30720
  v_mfma_f32_16x16x32_bf16 v[80:83], a[48:51], a[12:15], v[80:83]
  ds_read_b64_tr_b16 a[78:79], v21 offset:32768
  v_mfma_f32_16x16x32_bf16 v[120:123], a[48:51], a[16:19], v[120:123]
  buffer_load_dwordx4 v13, s[20:23], s31 offen offset:2048 lds
  ds_read_b64_tr_b16 a[80:81], v20 offset:38912
  v_mfma_f32_16x16x32_bf16 v[60:63], a[52:55], a[0:3], v[60:63]
  s_add_u32 s31, s31, 393216
  s_cmp_ge_u32 s31, 6291456
  s_cselect_b32 s29, 6291456, 0
  v_mfma_f32_16x16x32_bf16 v[68:71], a[52:55], a[4:7], v[68:71]
  s_sub_u32 s31, s31, s29
  s_add_u32 s60, s63, 4096
  ds_read_b64_tr_b16 a[82:83], v20 offset:40960
  v_mfma_f32_16x16x32_bf16 v[76:79], a[52:55], a[8:11], v[76:79]
  buffer_store_dwordx4 v[184:187], v2, s[16:19], s60 offen offset:2048 sc1
  ds_read_b64_tr_b16 a[84:85], v21 offset:38912
  v_mfma_f32_16x16x32_bf16 v[84:87], a[52:55], a[12:15], v[84:87]
  s_add_u32 s88, s88, s90
  s_add_u32 s89, s89, 1
  ds_read_b64_tr_b16 a[86:87], v21 offset:40960
  v_mfma_f32_16x16x32_bf16 v[124:127], a[52:55], a[16:19], v[124:127]
  s_cmp_eq_u32 s89, 3
  s_cselect_b32 s89, 0, s89
  s_cselect_b32 s90, s91, s92
  v_mfma_f32_16x16x32_bf16 v[88:91], a[0:3], a[56:59], v[88:91]
  v_add_u32 v16, s90, v16
  v_add_u32 v17, s90, v17
  v_mfma_f32_16x16x32_bf16 v[96:99], a[4:7], a[56:59], v[96:99]
  v_add_u32 v18, s90, v18
  v_add_u32 v19, s90, v19
  v_mfma_f32_16x16x32_bf16 v[104:107], a[8:11], a[56:59], v[104:107]
  v_add_u32 v20, s90, v20
  v_add_u32 v21, s90, v21
  v_mfma_f32_16x16x32_bf16 v[112:115], a[12:15], a[56:59], v[112:115]
  v_mfma_f32_16x16x32_bf16 v[92:95], a[0:3], a[60:63], v[92:95]
  v_mfma_f32_16x16x32_bf16 v[100:103], a[4:7], a[60:63], v[100:103]
  v_mfma_f32_16x16x32_bf16 v[108:111], a[8:11], a[60:63], v[108:111]
  v_mfma_f32_16x16x32_bf16 v[116:119], a[12:15], a[60:63], v[116:119]
  s_waitcnt vmcnt(14) lgkmcnt(0)
  s_barrier
  v_mfma_f32_16x16x32_bf16 v[24:27], a[64:67], a[20:23], v[24:27]
  s_add_u32 m0, s88, s28
  ds_read_b128 a[0:3], v16 offset:0
  ds_read_b64_tr_b16 a[40:41], v20 offset:18432
  v_mfma_f32_16x16x32_bf16 v[32:35], a[64:67], a[24:27], v[32:35]
  buffer_load_dwordx4 v14, s[8:11], s30 offen offset:0 lds
  ds_read_b64_tr_b16 a[42:43], v20 offset:20480
  v_mfma_f32_16x16x32_bf16 v[40:43], a[64:67], a[28:31], v[40:43]
  s_mov_b32 m0, s88
  ds_read_b128 a[4:7], v16 offset:2048
  v_mfma_f32_16x16x32_bf16 v[48:51], a[64:67], a[32:35], v[48:51]
  buffer_load_dwordx4 v4, s[8:11], s30 offen offset:0 lds
  ds_read_b128 a[8:11], v16 offset:4096
  v_mfma_f32_16x16x32_bf16 v[28:31], a[68:71], a[20:23], v[28:31]
  ds_read_b128 a[12:15], v16 offset:6144
  v_mfma_f32_16x16x32_bf16 v[36:39], a[68:71], a[24:27], v[36:39]
  ds_read_b64_tr_b16 a[44:45], v21 offset:18432
  v_mfma_f32_16x16x32_bf16 v[44:47], a[68:71], a[28:31], v[44:47]
  ds_read_b64_tr_b16 a[46:47], v21 offset:20480
  v_mfma_f32_16x16x32_bf16 v[52:55], a[68:71], a[32:35], v[52:55]
  buffer_load_dwordx4 v5, s[8:11], s30 offen offset:1024 lds
  ds_read_b64_tr_b16 a[48:49], v20 offset:26624
  v_mfma_f32_16x16x32_bf16 v[56:59], a[72:75], a[20:23], v[56:59]
  ds_read_b64_tr_b16 a[50:51], v20 offset:28672
  v_mfma_f32_16x16x32_bf16 v[64:67], a[72:75], a[24:27], v[64:67]
  ds_read_b128 a[16:19], v18 offset:0
  v_mfma_f32_16x16x32_bf16 v[72:75], a[72:75], a[28:31], v[72:75]
  buffer_load_dwordx4 v6, s[8:11], s30 offen offset:2048 lds
  ds_read_b64_tr_b16 a[52:53], v21 offset:26624
  v_mfma_f32_16x16x32_bf16 v[80:83], a[72:75], a[32:35], v[80:83]
  ds_read_b64_tr_b16 a[54:55], v21 offset:28672
  v_mfma_f32_16x16x32_bf16 v[120:123], a[72:75], a[36:39], v[120:123]
  ds_read_b64_tr_b16 a[56:57], v20 offset:34816
  v_mfma_f32_16x16x32_bf16 v[60:63], a[76:79], a[20:23], v[60:63]
  ds_read_b64_tr_b16 a[58:59], v20 offset:36864
  v_mfma_f32_16x16x32_bf16 v[68:71], a[76:79], a[24:27], v[68:71]
  buffer_load_dwordx4 v7, s[8:11], s30 offen offset:3072 lds
  ds_read_b64_tr_b16 a[60:61], v21 offset:34816
  v_mfma_f32_16x16x32_bf16 v[76:79], a[76:79], a[28:31], v[76:79]
  s_add_u32 s30, s30, 128
  s_and_b32 s30, s30, 2047
  s_add_u32 m0, s88, s26
  v_mfma_f32_16x16x32_bf16 v[84:87], a[76:79], a[32:35], v[84:87]
  ds_read_b64_tr_b16 a[62:63], v21 offset:36864
  v_mfma_f32_16x16x32_bf16 v[124:127], a[76:79], a[36:39], v[124:127]
  buffer_load_dwordx4 v8, s[20:23], s31 offen offset:0 lds
  v_mfma_f32_16x16x32_bf16 v[88:91], a[20:23], a[80:83], v[88:91]
  v_mfma_f32_16x16x32_bf16 v[96:99], a[24:27], a[80:83], v[96:99]
  v_mfma_f32_16x16x32_bf16 v[104:107], a[28:31], a[80:83], v[104:107]
  v_mfma_f32_16x16x32_bf16 v[112:115], a[32:35], a[80:83], v[112:115]
  buffer_load_dwordx4 v9, s[20:23], s31 offen offset:1024 lds
  v_mfma_f32_16x16x32_bf16 v[92:95], a[20:23], a[84:87], v[92:95]
  v_mfma_f32_16x16x32_bf16 v[100:103], a[24:27], a[84:87], v[100:103]
  v_mfma_f32_16x16x32_bf16 v[108:111], a[28:31], a[84:87], v[108:111]
  v_mfma_f32_16x16x32_bf16 v[116:119], a[32:35], a[84:87], v[116:119]
  s_waitcnt lgkmcnt(0)
  v_mfma_f32_16x16x32_bf16 v[24:27], a[40:43], a[0:3], v[24:27]
  buffer_load_dwordx4 v10, s[20:23], s31 offen offset:2048 lds
  ds_read_b128 a[20:23], v17 offset:0
  v_mfma_f32_16x16x32_bf16 v[32:35], a[40:43], a[4:7], v[32:35]
  s_add_u32 m0, s88, s27
  ds_read_b64_tr_b16 a[64:65], v20 offset:22528
  ds_read_b64_tr_b16 a[66:67], v20 offset:24576
  v_mfma_f32_16x16x32_bf16 v[40:43], a[40:43], a[8:11], v[40:43]
  ds_read_b128 a[24:27], v17 offset:2048
  v_mfma_f32_16x16x32_bf16 v[48:51], a[40:43], a[12:15], v[48:51]
  buffer_load_dwordx4 v11, s[20:23], s31 offen offset:0 lds
  ds_read_b128 a[28:31], v17 offset:4096
  v_mfma_f32_16x16x32_bf16 v[28:31], a[44:47], a[0:3], v[28:31]
  ds_read_b128 a[32:35], v17 offset:6144
  v_mfma_f32_16x16x32_bf16 v[36:39], a[44:47], a[4:7], v[36:39]
  ds_read_b64_tr_b16 a[68:69], v21 offset:22528
  v_mfma_f32_16x16x32_bf16 v[44:47], a[44:47], a[8:11], v[44:47]
  buffer_load_dwordx4 v12, s[20:23], s31 offen offset:1024 lds
  ds_read_b64_tr_b16 a[70:71], v21 offset:24576
  v_mfma_f32_16x16x32_bf16 v[52:55], a[44:47], a[12:15], v[52:55]
  ds_read_b64_tr_b16 a[72:73], v20 offset:30720
  v_mfma_f32_16x16x32_bf16 v[56:59], a[48:51], a[0:3], v[56:59]
  ds_read_b64_tr_b16 a[74:75], v20 offset:32768
  v_mfma_f32_16x16x32_bf16 v[64:67], a[48:51], a[4:7], v[64:67]
  buffer_load_dwordx4 v13, s[20:23], s31 offen offset:2048 lds
  ds_read_b128 a[36:39], v19 offset:0
  v_mfma_f32_16x16x32_bf16 v[72:75], a[48:51], a[8:11], v[72:75]
  s_add_u32 s31, s31, 393216
  s_cmp_ge_u32 s31, 6291456
  s_cselect_b32 s29, 6291456, 0
  v_mfma_f32_16x16x32_bf16 v[80:83], a[48:51], a[12:15], v[80:83]
  s_sub_u32 s31, s31, s29
  s_add_u32 s60, s63, 4096
  ds_read_b64_tr_b16 a[76:77], v21 offset:30720
  v_mfma_f32_16x16x32_bf16 v[120:123], a[48:51], a[16:19], v[120:123]
  buffer_store_dwordx4 v[188:191], v2, s[16:19], s60 offen offset:3072 sc1
  ds_read_b64_tr_b16 a[78:79], v21 offset:32768
  v_mfma_f32_16x16x32_bf16 v[60:63], a[52:55], a[0:3], v[60:63]
  s_add_u32 s60, s63, 32768
  ds_read_b64_tr_b16 a[80:81], v20 offset:38912
  ds_read_b64_tr_b16 a[82:83], v20 offset:40960
  v_mfma_f32_16x16x32_bf16 v[68:71], a[52:55], a[4:7], v[68:71]
  ds_read_b64_tr_b16 a[84:85], v21 offset:38912
  v_mfma_f32_16x16x32_bf16 v[76:79], a[52:55], a[8:11], v[76:79]
  buffer_store_dwordx4 v[204:207], v2, s[16:19], s60 offen offset:3072 sc1
  ds_read_b64_tr_b16 a[86:87], v21 offset:40960
  v_mfma_f32_16x16x32_bf16 v[84:87], a[52:55], a[12:15], v[84:87]
  s_add_u32 s88, s88, s90
  s_add_u32 s89, s89, 1
  s_cmp_eq_u32 s89, 3
  s_cselect_b32 s89, 0, s89
  s_cselect_b32 s90, s91, s92
  v_mfma_f32_16x16x32_bf16 v[124:127], a[52:55], a[16:19], v[124:127]
  v_add_u32 v16, s90, v16
  v_add_u32 v17, s90, v17
  v_mfma_f32_16x16x32_bf16 v[88:91], a[0:3], a[56:59], v[88:91]
  v_add_u32 v18, s90, v18
  v_add_u32 v19, s90, v19
  v_mfma_f32_16x16x32_bf16 v[96:99], a[4:7], a[56:59], v[96:99]
  v_add_u32 v20, s90, v20
  v_add_u32 v21, s90, v21
  v_mfma_f32_16x16x32_bf16 v[104:107], a[8:11], a[56:59], v[104:107]
  v_mfma_f32_16x16x32_bf16 v[112:115], a[12:15], a[56:59], v[112:115]
  v_mfma_f32_16x16x32_bf16 v[92:95], a[0:3], a[60:63], v[92:95]
  v_mfma_f32_16x16x32_bf16 v[100:103], a[4:7], a[60:63], v[100:103]
  v_mfma_f32_16x16x32_bf16 v[108:111], a[8:11], a[60:63], v[108:111]
  v_mfma_f32_16x16x32_bf16 v[116:119], a[12:15], a[60:63], v[116:119]
  s_waitcnt vmcnt(14) lgkmcnt(0)
  s_barrier
  v_mfma_f32_16x16x32_bf16 v[24:27], a[64:67], a[20:23], v[24:27]
  s_add_u32 m0, s88, s28
  ds_read_b128 a[0:3], v16 offset:0
  ds_read_b64_tr_b16 a[40:41], v20 offset:18432
  v_mfma_f32_16x16x32_bf16 v[32:35], a[64:67], a[24:27], v[32:35]
  buffer_load_dwordx4 v14, s[8:11], s30 offen offset:0 lds
  ds_read_b64_tr_b16 a[42:43], v20 offset:20480
  v_mfma_f32_16x16x32_bf16 v[40:43], a[64:67], a[28:31], v[40:43]
  s_mov_b32 m0, s88
  ds_read_b128 a[4:7], v16 offset:2048
  v_mfma_f32_16x16x32_bf16 v[48:51], a[64:67], a[32:35], v[48:51]
  ds_read_b128 a[8:11], v16 offset:4096
  v_mfma_f32_16x16x32_bf16 v[28:31], a[68:71], a[20:23], v[28:31]
  buffer_load_dwordx4 v4, s[8:11], s30 offen offset:0 lds
  ds_read_b128 a[12:15], v16 offset:6144
  v_mfma_f32_16x16x32_bf16 v[36:39], a[68:71], a[24:27], v[36:39]
  ds_read_b64_tr_b16 a[44:45], v21 offset:18432
  v_mfma_f32_16x16x32_bf16 v[44:47], a[68:71], a[28:31], v[44:47]
  ds_read_b64_tr_b16 a[46:47], v21 offset:20480
  v_mfma_f32_16x16x32_bf16 v[52:55], a[68:71], a[32:35], v[52:55]
  ds_read_b64_tr_b16 a[48:49], v20 offset:26624
  v_mfma_f32_16x16x32_bf16 v[56:59], a[72:75], a[20:23], v[56:59]
  buffer_load_dwordx4 v5, s[8:11], s30 offen offset:1024 lds
  ds_read_b64_tr_b16 a[50:51], v20 offset:28672
  v_mfma_f32_16x16x32_bf16 v[64:67], a[72:75], a[24:27], v[64:67]
  ds_read_b128 a[16:19], v18 offset:0
  v_mfma_f32_16x16x32_bf16 v[72:75], a[72:75], a[28:31], v[72:75]
  ds_read_b64_tr_b16 a[52:53], v21 offset:26624
  v_mfma_f32_16x16x32_bf16 v[80:83], a[72:75], a[32:35], v[80:83]
  ds_read_b64_tr_b16 a[54:55], v21 offset:28672
  v_mfma_f32_16x16x32_bf16 v[120:123], a[72:75], a[36:39], v[120:123]
  buffer_load_dwordx4 v6, s[8:11], s30 offen offset:2048 lds
  ds_read_b64_tr_b16 a[56:57], v20 offset:34816
  v_mfma_f32_16x16x32_bf16 v[60:63], a[76:79], a[20:23], v[60:63]
  ds_read_b64_tr_b16 a[58:59], v20 offset:36864
  v_mfma_f32_16x16x32_bf16 v[68:71], a[76:79], a[24:27], v[68:71]
  ds_read_b64_tr_b16 a[60:61], v21 offset:34816
  v_mfma_f32_16x16x32_bf16 v[76:79], a[76:79], a[28:31], v[76:79]
  ds_read_b64_tr_b16 a[62:63], v21 offset:36864
  v_mfma_f32_16x16x32_bf16 v[84:87], a[76:79], a[32:35], v[84:87]
  buffer_load_dwordx4 v7, s[8:11], s30 offen offset:3072 lds
  v_mfma_f32_16x16x32_bf16 v[124:127], a[76:79], a[36:39], v[124:127]
  s_add_u32 s30, s30, 128
  s_and_b32 s30, s30, 2047
  s_add_u32 m0, s88, s26
  v_mfma_f32_16x16x32_bf16 v[88:91], a[20:23], a[80:83], v[88:91]
  v_mfma_f32_16x16x32_bf16 v[96:99], a[24:27], a[80:83], v[96:99]
  v_mfma_f32_16x16x32_bf16 v[104:107], a[28:31], a[80:83], v[104:107]
  buffer_load_dwordx4 v8, s[20:23], s31 offen offset:0 lds
  v_mfma_f32_16x16x32_bf16 v[112:115], a[32:35], a[80:83], v[112:115]
  v_mfma_f32_16x16x32_bf16 v[92:95], a[20:23], a[84:87], v[92:95]
  v_mfma_f32_16x16x32_bf16 v[100:103], a[24:27], a[84:87], v[100:103]
  v_mfma_f32_16x16x32_bf16 v[108:111], a[28:31], a[84:87], v[108:111]
  v_mfma_f32_16x16x32_bf16 v[116:119], a[32:35], a[84:87], v[116:119]
  s_waitcnt lgkmcnt(0)
  v_mfma_f32_16x16x32_bf16 v[24:27], a[40:43], a[0:3], v[24:27]
  buffer_load_dwordx4 v9, s[20:23], s31 offen offset:1024 lds
  ds_read_b128 a[20:23], v17 offset:0
  v_mfma_f32_16x16x32_bf16 v[32:35], a[40:43], a[4:7], v[32:35]
  ds_read_b64_tr_b16 a[64:65], v20 offset:22528
  ds_read_b64_tr_b16 a[66:67], v20 offset:24576
  v_mfma_f32_16x16x32_bf16 v[40:43], a[40:43], a[8:11], v[40:43]
  ds_read_b128 a[24:27], v17 offset:2048
  v_mfma_f32_16x16x32_bf16 v[48:51], a[40:43], a[12:15], v[48:51]
  buffer_load_dwordx4 v10, s[20:23], s31 offen offset:2048 lds
  ds_read_b128 a[28:31], v17 offset:4096
  v_mfma_f32_16x16x32_bf16 v[28:31], a[44:47], a[0:3], v[28:31]
  s_add_u32 m0, s88, s27
  ds_read_b128 a[32:35], v17 offset:6144
  v_mfma_f32_16x16x32_bf16 v[36:39], a[44:47], a[4:7], v[36:39]
  ds_read_b64_tr_b16 a[68:69], v21 offset:22528
  v_mfma_f32_16x16x32_bf16 v[44:47], a[44:47], a[8:11], v[44:47]
  buffer_load_dwordx4 v11, s[20:23], s31 offen offset:0 lds
  ds_read_b64_tr_b16 a[70:71], v21 offset:24576
  v_mfma_f32_16x16x32_bf16 v[52:55], a[44:47], a[12:15], v[52:55]
  ds_read_b64_tr_b16 a[72:73], v20 offset:30720
  v_mfma_f32_16x16x32_bf16 v[56:59], a[48:51], a[0:3], v[56:59]
  ds_read_b64_tr_b16 a[74:75], v20 offset:32768
  v_mfma_f32_16x16x32_bf16 v[64:67], a[48:51], a[4:7], v[64:67]
  buffer_load_dwordx4 v12, s[20:23], s31 offen offset:1024 lds
  ds_read_b128 a[36:39], v19 offset:0
  v_mfma_f32_16x16x32_bf16 v[72:75], a[48:51], a[8:11], v[72:75]
  ds_read_b64_tr_b16 a[76:77], v21 offset:30720
  v_mfma_f32_16x16x32_bf16 v[80:83], a[48:51], a[12:15], v[80:83]
  ds_read_b64_tr_b16 a[78:79], v21 offset:32768
  v_mfma_f32_16x16x32_bf16 v[120:123], a[48:51], a[16:19], v[120:123]
  buffer_load_dwordx4 v13, s[20:23], s31 offen offset:2048 lds
  ds_read_b64_tr_b16 a[80:81], v20 offset:38912
  v_mfma_f32_16x16x32_bf16 v[60:63], a[52:55], a[0:3], v[60:63]
  s_add_u32 s31, s31, 393216
  s_cmp_ge_u32 s31, 6291456
  s_cselect_b32 s29, 6291456, 0
  v_mfma_f32_16x16x32_bf16 v[68:71], a[52:55], a[4:7], v[68:71]
  s_sub_u32 s31, s31, s29
  s_add_u32 s60, s63, 36864
  ds_read_b64_tr_b16 a[82:83], v20 offset:40960
  v_mfma_f32_16x16x32_bf16 v[76:79], a[52:55], a[8:11], v[76:79]
  buffer_store_dwordx4 v[208:211], v2, s[16:19], s60 offen offset:0 sc1
  ds_read_b64_tr_b16 a[84:85], v21 offset:38912
  v_mfma_f32_16x16x32_bf16 v[84:87], a[52:55], a[12:15], v[84:87]
  s_add_u32 s88, s88, s90
  s_add_u32 s89, s89, 1
  ds_read_b64_tr_b16 a[86:87], v21 offset:40960
  v_mfma_f32_16x16x32_bf16 v[124:127], a[52:55], a[16:19], v[124:127]
  s_cmp_eq_u32 s89, 3
  s_cselect_b32 s89, 0, s89
  s_cselect_b32 s90, s91, s92
  v_mfma_f32_16x16x32_bf16 v[88:91], a[0:3], a[56:59], v[88:91]
  v_add_u32 v16, s90, v16
  v_add_u32 v17, s90, v17
  v_mfma_f32_16x16x32_bf16 v[96:99], a[4:7], a[56:59], v[96:99]
  v_add_u32 v18, s90, v18
  v_add_u32 v19, s90, v19
  v_mfma_f32_16x16x32_bf16 v[104:107], a[8:11], a[56:59], v[104:107]
  v_add_u32 v20, s90, v20
  v_add_u32 v21, s90, v21
  v_mfma_f32_16x16x32_bf16 v[112:115], a[12:15], a[56:59], v[112:115]
  v_mfma_f32_16x16x32_bf16 v[92:95], a[0:3], a[60:63], v[92:95]
  v_mfma_f32_16x16x32_bf16 v[100:103], a[4:7], a[60:63], v[100:103]
  v_mfma_f32_16x16x32_bf16 v[108:111], a[8:11], a[60:63], v[108:111]
  v_mfma_f32_16x16x32_bf16 v[116:119], a[12:15], a[60:63], v[116:119]
  s_waitcnt vmcnt(14) lgkmcnt(0)
  s_barrier
  v_mfma_f32_16x16x32_bf16 v[24:27], a[64:67], a[20:23], v[24:27]
  s_add_u32 m0, s88, s28
  ds_read_b128 a[0:3], v16 offset:0
  ds_read_b64_tr_b16 a[40:41], v20 offset:18432
  v_mfma_f32_16x16x32_bf16 v[32:35], a[64:67], a[24:27], v[32:35]
  buffer_load_dwordx4 v14, s[8:11], s30 offen offset:0 lds
  ds_read_b64_tr_b16 a[42:43], v20 offset:20480
  v_mfma_f32_16x16x32_bf16 v[40:43], a[64:67], a[28:31], v[40:43]
  s_mov_b32 m0, s88
  ds_read_b128 a[4:7], v16 offset:2048
  v_mfma_f32_16x16x32_bf16 v[48:51], a[64:67], a[32:35], v[48:51]
  buffer_load_dwordx4 v4, s[8:11], s30 offen offset:0 lds
  ds_read_b128 a[8:11], v16 offset:4096
  v_mfma_f32_16x16x32_bf16 v[28:31], a[68:71], a[20:23], v[28:31]
  ds_read_b128 a[12:15], v16 offset:6144
  v_mfma_f32_16x16x32_bf16 v[36:39], a[68:71], a[24:27], v[36:39]
  ds_read_b64_tr_b16 a[44:45], v21 offset:18432
  v_mfma_f32_16x16x32_bf16 v[44:47], a[68:71], a[28:31], v[44:47]
  ds_read_b64_tr_b16 a[46:47], v21 offset:20480
  v_mfma_f32_16x16x32_bf16 v[52:55], a[68:71], a[32:35], v[52:55]
  buffer_load_dwordx4 v5, s[8:11], s30 offen offset:1024 lds
  ds_read_b64_tr_b16 a[48:49], v20 offset:26624
  v_mfma_f32_16x16x32_bf16 v[56:59], a[72:75], a[20:23], v[56:59]
  ds_read_b64_tr_b16 a[50:51], v20 offset:28672
  v_mfma_f32_16x16x32_bf16 v[64:67], a[72:75], a[24:27], v[64:67]
  ds_read_b128 a[16:19], v18 offset:0
  v_mfma_f32_16x16x32_bf16 v[72:75], a[72:75], a[28:31], v[72:75]
  buffer_load_dwordx4 v6, s[8:11], s30 offen offset:2048 lds
  ds_read_b64_tr_b16 a[52:53], v21 offset:26624
  v_mfma_f32_16x16x32_bf16 v[80:83], a[72:75], a[32:35], v[80:83]
  ds_read_b64_tr_b16 a[54:55], v21 offset:28672
  v_mfma_f32_16x16x32_bf16 v[120:123], a[72:75], a[36:39], v[120:123]
  ds_read_b64_tr_b16 a[56:57], v20 offset:34816
  v_mfma_f32_16x16x32_bf16 v[60:63], a[76:79], a[20:23], v[60:63]
  ds_read_b64_tr_b16 a[58:59], v20 offset:36864
  v_mfma_f32_16x16x32_bf16 v[68:71], a[76:79], a[24:27], v[68:71]
  buffer_load_dwordx4 v7, s[8:11], s30 offen offset:3072 lds
  ds_read_b64_tr_b16 a[60:61], v21 offset:34816
  v_mfma_f32_16x16x32_bf16 v[76:79], a[76:79], a[28:31], v[76:79]
  s_add_u32 s30, s30, 128
  s_and_b32 s30, s30, 2047
  s_add_u32 m0, s88, s26
  v_mfma_f32_16x16x32_bf16 v[84:87], a[76:79], a[32:35], v[84:87]
  ds_read_b64_tr_b16 a[62:63], v21 offset:36864
  v_mfma_f32_16x16x32_bf16 v[124:127], a[76:79], a[36:39], v[124:127]
  buffer_load_dwordx4 v8, s[20:23], s31 offen offset:0 lds
  v_mfma_f32_16x16x32_bf16 v[88:91], a[20:23], a[80:83], v[88:91]
  v_mfma_f32_16x16x32_bf16 v[96:99], a[24:27], a[80:83], v[96:99]
  v_mfma_f32_16x16x32_bf16 v[104:107], a[28:31], a[80:83], v[104:107]
  v_mfma_f32_16x16x32_bf16 v[112:115], a[32:35], a[80:83], v[112:115]
  buffer_load_dwordx4 v9, s[20:23], s31 offen offset:1024 lds
  v_mfma_f32_16x16x32_bf16 v[92:95], a[20:23], a[84:87], v[92:95]
  v_mfma_f32_16x16x32_bf16 v[100:103], a[24:27], a[84:87], v[100:103]
  v_mfma_f32_16x16x32_bf16 v[108:111], a[28:31], a[84:87], v[108:111]
  v_mfma_f32_16x16x32_bf16 v[116:119], a[32:35], a[84:87], v[116:119]
  s_waitcnt lgkmcnt(0)
  v_mfma_f32_16x16x32_bf16 v[24:27], a[40:43], a[0:3], v[24:27]
  buffer_load_dwordx4 v10, s[20:23], s31 offen offset:2048 lds
  ds_read_b128 a[20:23], v17 offset:0
  v_mfma_f32_16x16x32_bf16 v[32:35], a[40:43], a[4:7], v[32:35]
  s_add_u32 m0, s88, s27
  ds_read_b64_tr_b16 a[64:65], v20 offset:22528
  ds_read_b64_tr_b16 a[66:67], v20 offset:24576
  v_mfma_f32_16x16x32_bf16 v[40:43], a[40:43], a[8:11], v[40:43]
  ds_read_b128 a[24:27], v17 offset:2048
  v_mfma_f32_16x16x32_bf16 v[48:51], a[40:43], a[12:15], v[48:51]
  buffer_load_dwordx4 v11, s[20:23], s31 offen offset:0 lds
  ds_read_b128 a[28:31], v17 offset:4096
  v_mfma_f32_16x16x32_bf16 v[28:31], a[44:47], a[0:3], v[28:31]
  ds_read_b128 a[32:35], v17 offset:6144
  v_mfma_f32_16x16x32_bf16 v[36:39], a[44:47], a[4:7], v[36:39]
  ds_read_b64_tr_b16 a[68:69], v21 offset:22528
  v_mfma_f32_16x16x32_bf16 v[44:47], a[44:47], a[8:11], v[44:47]
  buffer_load_dwordx4 v12, s[20:23], s31 offen offset:1024 lds
  ds_read_b64_tr_b16 a[70:71], v21 offset:24576
  v_mfma_f32_16x16x32_bf16 v[52:55], a[44:47], a[12:15], v[52:55]
  ds_read_b64_tr_b16 a[72:73], v20 offset:30720
  v_mfma_f32_16x16x32_bf16 v[56:59], a[48:51], a[0:3], v[56:59]
  ds_read_b64_tr_b16 a[74:75], v20 offset:32768
  v_mfma_f32_16x16x32_bf16 v[64:67], a[48:51], a[4:7], v[64:67]
  buffer_load_dwordx4 v13, s[20:23], s31 offen offset:2048 lds
  ds_read_b128 a[36:39], v19 offset:0
  v_mfma_f32_16x16x32_bf16 v[72:75], a[48:51], a[8:11], v[72:75]
  s_add_u32 s31, s31, 393216
  s_cmp_ge_u32 s31, 6291456
  s_cselect_b32 s29, 6291456, 0
  v_mfma_f32_16x16x32_bf16 v[80:83], a[48:51], a[12:15], v[80:83]
  s_sub_u32 s31, s31, s29
  s_add_u32 s60, s63, 36864
  ds_read_b64_tr_b16 a[76:77], v21 offset:30720
  v_mfma_f32_16x16x32_bf16 v[120:123], a[48:51], a[16:19], v[120:123]
  buffer_store_dwordx4 v[212:215], v2, s[16:19], s60 offen offset:1024 sc1
  ds_read_b64_tr_b16 a[78:79], v21 offset:32768
  v_mfma_f32_16x16x32_bf16 v[60:63], a[52:55], a[0:3], v[60:63]
  ds_read_b64_tr_b16 a[80:81], v20 offset:38912
  ds_read_b64_tr_b16 a[82:83], v20 offset:40960
  v_mfma_f32_16x16x32_bf16 v[68:71], a[52:55], a[4:7], v[68:71]
  ds_read_b64_tr_b16 a[84:85], v21 offset:38912
  v_mfma_f32_16x16x32_bf16 v[76:79], a[52:55], a[8:11], v[76:79]
  buffer_store_dwordx4 v[216:219], v2, s[16:19], s60 offen offset:2048 sc1
  ds_read_b64_tr_b16 a[86:87], v21 offset:40960
  v_mfma_f32_16x16x32_bf16 v[84:87], a[52:55], a[12:15], v[84:87]
  s_add_u32 s88, s88, s90
  s_add_u32 s89, s89, 1
  s_cmp_eq_u32 s89, 3
  s_cselect_b32 s89, 0, s89
  s_cselect_b32 s90, s91, s92
  v_mfma_f32_16x16x32_bf16 v[124:127], a[52:55], a[16:19], v[124:127]
  v_add_u32 v16, s90, v16
  v_add_u32 v17, s90, v17
  v_mfma_f32_16x16x32_bf16 v[88:91], a[0:3], a[56:59], v[88:91]
  v_add_u32 v18, s90, v18
  v_add_u32 v19, s90, v19
  v_mfma_f32_16x16x32_bf16 v[96:99], a[4:7], a[56:59], v[96:99]
  v_add_u32 v20, s90, v20
  v_add_u32 v21, s90, v21
  v_mfma_f32_16x16x32_bf16 v[104:107], a[8:11], a[56:59], v[104:107]
  v_mfma_f32_16x16x32_bf16 v[112:115], a[12:15], a[56:59], v[112:115]
  v_mfma_f32_16x16x32_bf16 v[92:95], a[0:3], a[60:63], v[92:95]
  v_mfma_f32_16x16x32_bf16 v[100:103], a[4:7], a[60:63], v[100:103]
  v_mfma_f32_16x16x32_bf16 v[108:111], a[8:11], a[60:63], v[108:111]
  v_mfma_f32_16x16x32_bf16 v[116:119], a[12:15], a[60:63], v[116:119]
  s_waitcnt vmcnt(14) lgkmcnt(0)
  s_barrier
  v_accvgpr_read_b32 v4, a222
  v_accvgpr_read_b32 v5, a223
  v_accvgpr_read_b32 v6, a224
  v_accvgpr_read_b32 v7, a225
  v_accvgpr_read_b32 v8, a226
  v_accvgpr_read_b32 v9, a227
  v_accvgpr_read_b32 v10, a228
  v_accvgpr_read_b32 v11, a229
  s_mov_b32 s8, s64
  s_mov_b32 s9, s65
  s_mov_b32 s10, 4194304
  s_mov_b32 s11, 0x00020000
  s_mov_b32 s12, s68
  s_mov_b32 s13, s69
  s_mov_b32 s14, 8388608
  s_mov_b32 s15, 0x00020000
  s_and_b32 s4, s2, 7
  s_lshl_b32 s4, s4, 1
  s_lshr_b32 s5, s2, 6
  s_add_u32 s5, s5, s25
  s_and_b32 s5, s5, 3
  s_mul_i32 s5, s5, 1
  s_add_u32 s4, s4, s5
  s_and_b32 s4, s4, 15
  s_lshl_b32 s49, s4, 7
  s_lshl_b32 s48, s4, 19
  s_lshl_b32 s50, s25, 18
  s_sub_u32 s51, 3932160, s50
  s_or_b32 s46, s50, s49
  s_or_b32 s47, s51, s49
  s_lshl_b32 s41, s3, 12
  s_lshl_b32 s36, s3, 13
  s_add_u32 s36, s36, 98304
  v_mfma_f32_16x16x32_bf16 v[24:27], a[64:67], a[20:23], v[24:27]
  s_mov_b32 m0, s41
  ds_read_b128 a[0:3], v16 offset:0
  ds_read_b64_tr_b16 a[40:41], v20 offset:18432
  v_mfma_f32_16x16x32_bf16 v[32:35], a[64:67], a[24:27], v[32:35]
  buffer_load_dwordx4 v8, s[12:15], s48 offen offset:0 lds
  ds_read_b64_tr_b16 a[42:43], v20 offset:20480
  v_mfma_f32_16x16x32_bf16 v[40:43], a[64:67], a[28:31], v[40:43]
  ds_read_b128 a[4:7], v16 offset:2048
  v_mfma_f32_16x16x32_bf16 v[48:51], a[64:67], a[32:35], v[48:51]
  ds_read_b128 a[8:11], v16 offset:4096
  v_mfma_f32_16x16x32_bf16 v[28:31], a[68:71], a[20:23], v[28:31]
  ds_read_b128 a[12:15], v16 offset:6144
  v_mfma_f32_16x16x32_bf16 v[36:39], a[68:71], a[24:27], v[36:39]
  buffer_load_dwordx4 v9, s[12:15], s48 offen offset:1024 lds
  ds_read_b64_tr_b16 a[44:45], v21 offset:18432
  v_mfma_f32_16x16x32_bf16 v[44:47], a[68:71], a[28:31], v[44:47]
  ds_read_b64_tr_b16 a[46:47], v21 offset:20480
  v_mfma_f32_16x16x32_bf16 v[52:55], a[68:71], a[32:35], v[52:55]
  ds_read_b64_tr_b16 a[48:49], v20 offset:26624
  v_mfma_f32_16x16x32_bf16 v[56:59], a[72:75], a[20:23], v[56:59]
  ds_read_b64_tr_b16 a[50:51], v20 offset:28672
  v_mfma_f32_16x16x32_bf16 v[64:67], a[72:75], a[24:27], v[64:67]
  ds_read_b128 a[16:19], v18 offset:0
  v_mfma_f32_16x16x32_bf16 v[72:75], a[72:75], a[28:31], v[72:75]
  buffer_load_dwordx4 v10, s[12:15], s48 offen offset:2048 lds
  ds_read_b64_tr_b16 a[52:53], v21 offset:26624
  v_mfma_f32_16x16x32_bf16 v[80:83], a[72:75], a[32:35], v[80:83]
  ds_read_b64_tr_b16 a[54:55], v21 offset:28672
  v_mfma_f32_16x16x32_bf16 v[120:123], a[72:75], a[36:39], v[120:123]
  ds_read_b64_tr_b16 a[56:57], v20 offset:34816
  v_mfma_f32_16x16x32_bf16 v[60:63], a[76:79], a[20:23], v[60:63]
  ds_read_b64_tr_b16 a[58:59], v20 offset:36864
  v_mfma_f32_16x16x32_bf16 v[68:71], a[76:79], a[24:27], v[68:71]
  ds_read_b64_tr_b16 a[60:61], v21 offset:34816
  v_mfma_f32_16x16x32_bf16 v[76:79], a[76:79], a[28:31], v[76:79]
  buffer_load_dwordx4 v11, s[12:15], s48 offen offset:3072 lds
  ds_read_b64_tr_b16 a[62:63], v21 offset:36864
  v_mfma_f32_16x16x32_bf16 v[84:87], a[76:79], a[32:35], v[84:87]
  s_add_u32 s48, s48, 524288
  s_and_b32 s48, s48, 8388607
  s_add_u32 m0, s41, 16384
  v_mfma_f32_16x16x32_bf16 v[124:127], a[76:79], a[36:39], v[124:127]
  v_mfma_f32_16x16x32_bf16 v[88:91], a[20:23], a[80:83], v[88:91]
  v_mfma_f32_16x16x32_bf16 v[96:99], a[24:27], a[80:83], v[96:99]
  v_mfma_f32_16x16x32_bf16 v[104:107], a[28:31], a[80:83], v[104:107]
  buffer_load_dwordx4 v8, s[12:15], s48 offen offset:0 lds
  v_mfma_f32_16x16x32_bf16 v[112:115], a[32:35], a[80:83], v[112:115]
  v_mfma_f32_16x16x32_bf16 v[92:95], a[20:23], a[84:87], v[92:95]
  v_mfma_f32_16x16x32_bf16 v[100:103], a[24:27], a[84:87], v[100:103]
  v_mfma_f32_16x16x32_bf16 v[108:111], a[28:31], a[84:87], v[108:111]
  v_mfma_f32_16x16x32_bf16 v[116:119], a[32:35], a[84:87], v[116:119]
  s_waitcnt lgkmcnt(0)
  v_mfma_f32_16x16x32_bf16 v[24:27], a[40:43], a[0:3], v[24:27]
  buffer_load_dwordx4 v9, s[12:15], s48 offen offset:1024 lds
  ds_read_b128 a[20:23], v17 offset:0
  v_mfma_f32_16x16x32_bf16 v[32:35], a[40:43], a[4:7], v[32:35]
  ds_read_b64_tr_b16 a[64:65], v20 offset:22528
  ds_read_b64_tr_b16 a[66:67], v20 offset:24576
  v_mfma_f32_16x16x32_bf16 v[40:43], a[40:43], a[8:11], v[40:43]
  ds_read_b128 a[24:27], v17 offset:2048
  v_mfma_f32_16x16x32_bf16 v[48:51], a[40:43], a[12:15], v[48:51]
  ds_read_b128 a[28:31], v17 offset:4096
  v_mfma_f32_16x16x32_bf16 v[28:31], a[44:47], a[0:3], v[28:31]
  buffer_load_dwordx4 v10, s[12:15], s48 offen offset:2048 lds
  ds_read_b128 a[32:35], v17 offset:6144
  v_mfma_f32_16x16x32_bf16 v[36:39], a[44:47], a[4:7], v[36:39]
  ds_read_b64_tr_b16 a[68:69], v21 offset:22528
  v_mfma_f32_16x16x32_bf16 v[44:47], a[44:47], a[8:11], v[44:47]
  ds_read_b64_tr_b16 a[70:71], v21 offset:24576
  v_mfma_f32_16x16x32_bf16 v[52:55], a[44:47], a[12:15], v[52:55]
  ds_read_b64_tr_b16 a[72:73], v20 offset:30720
  v_mfma_f32_16x16x32_bf16 v[56:59], a[48:51], a[0:3], v[56:59]
  ds_read_b64_tr_b16 a[74:75], v20 offset:32768
  v_mfma_f32_16x16x32_bf16 v[64:67], a[48:51], a[4:7], v[64:67]
  buffer_load_dwordx4 v11, s[12:15], s48 offen offset:3072 lds
  ds_read_b128 a[36:39], v19 offset:0
  v_mfma_f32_16x16x32_bf16 v[72:75], a[48:51], a[8:11], v[72:75]
  s_add_u32 s48, s48, 524288
  s_and_b32 s48, s48, 8388607
  s_add_u32 s60, s63, 36864
  v_mfma_f32_16x16x32_bf16 v[80:83], a[48:51], a[12:15], v[80:83]
  ds_read_b64_tr_b16 a[76:77], v21 offset:30720
  ds_read_b64_tr_b16 a[78:79], v21 offset:32768
  v_mfma_f32_16x16x32_bf16 v[120:123], a[48:51], a[16:19], v[120:123]
  ds_read_b64_tr_b16 a[80:81], v20 offset:38912
  v_mfma_f32_16x16x32_bf16 v[60:63], a[52:55], a[0:3], v[60:63]
  ds_read_b64_tr_b16 a[82:83], v20 offset:40960
  v_mfma_f32_16x16x32_bf16 v[68:71], a[52:55], a[4:7], v[68:71]
  buffer_store_dwordx4 v[220:223], v2, s[16:19], s60 offen offset:3072 sc1
  ds_read_b64_tr_b16 a[84:85], v21 offset:38912
  v_mfma_f32_16x16x32_bf16 v[76:79], a[52:55], a[8:11], v[76:79]
  s_add_u32 s88, s88, s90
  s_add_u32 s89, s89, 1
  ds_read_b64_tr_b16 a[86:87], v21 offset:40960
  v_mfma_f32_16x16x32_bf16 v[84:87], a[52:55], a[12:15], v[84:87]
  s_cmp_eq_u32 s89, 3
  s_cselect_b32 s89, 0, s89
  s_cselect_b32 s90, s91, s92
  v_mfma_f32_16x16x32_bf16 v[124:127], a[52:55], a[16:19], v[124:127]
  v_add_u32 v16, s90, v16
  v_add_u32 v17, s90, v17
  v_mfma_f32_16x16x32_bf16 v[88:91], a[0:3], a[56:59], v[88:91]
  v_add_u32 v18, s90, v18
  v_add_u32 v19, s90, v19
  v_mfma_f32_16x16x32_bf16 v[96:99], a[4:7], a[56:59], v[96:99]
  v_add_u32 v20, s90, v20
  v_add_u32 v21, s90, v21
  v_mfma_f32_16x16x32_bf16 v[104:107], a[8:11], a[56:59], v[104:107]
  v_mfma_f32_16x16x32_bf16 v[112:115], a[12:15], a[56:59], v[112:115]
  v_mfma_f32_16x16x32_bf16 v[92:95], a[0:3], a[60:63], v[92:95]
  v_mfma_f32_16x16x32_bf16 v[100:103], a[4:7], a[60:63], v[100:103]
  v_mfma_f32_16x16x32_bf16 v[108:111], a[8:11], a[60:63], v[108:111]
  v_mfma_f32_16x16x32_bf16 v[116:119], a[12:15], a[60:63], v[116:119]
  s_waitcnt vmcnt(11) lgkmcnt(0)
  s_barrier
  v_mfma_f32_16x16x32_bf16 v[24:27], a[64:67], a[20:23], v[24:27]
  s_mov_b32 m0, s36
  ds_read_b128 a[0:3], v16 offset:0
  ds_read_b64_tr_b16 a[40:41], v20 offset:18432
  v_mfma_f32_16x16x32_bf16 v[32:35], a[64:67], a[24:27], v[32:35]
  buffer_load_dwordx4 v4, s[8:11], s46 offen offset:0 lds
  ds_read_b64_tr_b16 a[42:43], v20 offset:20480
  v_mfma_f32_16x16x32_bf16 v[40:43], a[64:67], a[28:31], v[40:43]
  ds_read_b128 a[4:7], v16 offset:2048
  v_mfma_f32_16x16x32_bf16 v[48:51], a[64:67], a[32:35], v[48:51]
  ds_read_b128 a[8:11], v16 offset:4096
  v_mfma_f32_16x16x32_bf16 v[28:31], a[68:71], a[20:23], v[28:31]
  ds_read_b128 a[12:15], v16 offset:6144
  v_mfma_f32_16x16x32_bf16 v[36:39], a[68:71], a[24:27], v[36:39]
  buffer_load_dwordx4 v5, s[8:11], s46 offen offset:1024 lds
  ds_read_b64_tr_b16 a[44:45], v21 offset:18432
  v_mfma_f32_16x16x32_bf16 v[44:47], a[68:71], a[28:31], v[44:47]
  ds_read_b64_tr_b16 a[46:47], v21 offset:20480
  v_mfma_f32_16x16x32_bf16 v[52:55], a[68:71], a[32:35], v[52:55]
  ds_read_b64_tr_b16 a[48:49], v20 offset:26624
  v_mfma_f32_16x16x32_bf16 v[56:59], a[72:75], a[20:23], v[56:59]
  ds_read_b64_tr_b16 a[50:51], v20 offset:28672
  v_mfma_f32_16x16x32_bf16 v[64:67], a[72:75], a[24:27], v[64:67]
  ds_read_b128 a[16:19], v18 offset:0
  v_mfma_f32_16x16x32_bf16 v[72:75], a[72:75], a[28:31], v[72:75]
  buffer_load_dwordx4 v6, s[8:11], s46 offen offset:2048 lds
  ds_read_b64_tr_b16 a[52:53], v21 offset:26624
  v_mfma_f32_16x16x32_bf16 v[80:83], a[72:75], a[32:35], v[80:83]
  ds_read_b64_tr_b16 a[54:55], v21 offset:28672
  v_mfma_f32_16x16x32_bf16 v[120:123], a[72:75], a[36:39], v[120:123]
  ds_read_b64_tr_b16 a[56:57], v20 offset:34816
  v_mfma_f32_16x16x32_bf16 v[60:63], a[76:79], a[20:23], v[60:63]
  ds_read_b64_tr_b16 a[58:59], v20 offset:36864
  v_mfma_f32_16x16x32_bf16 v[68:71], a[76:79], a[24:27], v[68:71]
  ds_read_b64_tr_b16 a[60:61], v21 offset:34816
  v_mfma_f32_16x16x32_bf16 v[76:79], a[76:79], a[28:31], v[76:79]
  buffer_load_dwordx4 v7, s[8:11], s46 offen offset:3072 lds
  ds_read_b64_tr_b16 a[62:63], v21 offset:36864
  v_mfma_f32_16x16x32_bf16 v[84:87], a[76:79], a[32:35], v[84:87]
  s_add_u32 m0, s36, 4096
  v_mfma_f32_16x16x32_bf16 v[124:127], a[76:79], a[36:39], v[124:127]
  v_mfma_f32_16x16x32_bf16 v[88:91], a[20:23], a[80:83], v[88:91]
  v_mfma_f32_16x16x32_bf16 v[96:99], a[24:27], a[80:83], v[96:99]
  v_mfma_f32_16x16x32_bf16 v[104:107], a[28:31], a[80:83], v[104:107]
  buffer_load_dwordx4 v4, s[8:11], s47 offen offset:0 lds
  v_mfma_f32_16x16x32_bf16 v[112:115], a[32:35], a[80:83], v[112:115]
  v_mfma_f32_16x16x32_bf16 v[92:95], a[20:23], a[84:87], v[92:95]
  v_mfma_f32_16x16x32_bf16 v[100:103], a[24:27], a[84:87], v[100:103]
  v_mfma_f32_16x16x32_bf16 v[108:111], a[28:31], a[84:87], v[108:111]
  v_mfma_f32_16x16x32_bf16 v[116:119], a[32:35], a[84:87], v[116:119]
  s_waitcnt lgkmcnt(0)
  v_mfma_f32_16x16x32_bf16 v[24:27], a[40:43], a[0:3], v[24:27]
  buffer_load_dwordx4 v5, s[8:11], s47 offen offset:1024 lds
  ds_read_b128 a[20:23], v17 offset:0
  v_mfma_f32_16x16x32_bf16 v[32:35], a[40:43], a[4:7], v[32:35]
  ds_read_b64_tr_b16 a[64:65], v20 offset:22528
  ds_read_b64_tr_b16 a[66:67], v20 offset:24576
  v_mfma_f32_16x16x32_bf16 v[40:43], a[40:43], a[8:11], v[40:43]
  ds_read_b128 a[24:27], v17 offset:2048
  v_mfma_f32_16x16x32_bf16 v[48:51], a[40:43], a[12:15], v[48:51]
  ds_read_b128 a[28:31], v17 offset:4096
  v_mfma_f32_16x16x32_bf16 v[28:31], a[44:47], a[0:3], v[28:31]
  ds_read_b128 a[32:35], v17 offset:6144
  v_mfma_f32_16x16x32_bf16 v[36:39], a[44:47], a[4:7], v[36:39]
  buffer_load_dwordx4 v6, s[8:11], s47 offen offset:2048 lds
  ds_read_b64_tr_b16 a[68:69], v21 offset:22528
  v_mfma_f32_16x16x32_bf16 v[44:47], a[44:47], a[8:11], v[44:47]
  ds_read_b64_tr_b16 a[70:71], v21 offset:24576
  v_mfma_f32_16x16x32_bf16 v[52:55], a[44:47], a[12:15], v[52:55]
  ds_read_b64_tr_b16 a[72:73], v20 offset:30720
  v_mfma_f32_16x16x32_bf16 v[56:59], a[48:51], a[0:3], v[56:59]
  ds_read_b64_tr_b16 a[74:75], v20 offset:32768
  v_mfma_f32_16x16x32_bf16 v[64:67], a[48:51], a[4:7], v[64:67]
  ds_read_b128 a[36:39], v19 offset:0
  v_mfma_f32_16x16x32_bf16 v[72:75], a[48:51], a[8:11], v[72:75]
  buffer_load_dwordx4 v7, s[8:11], s47 offen offset:3072 lds
  ds_read_b64_tr_b16 a[76:77], v21 offset:30720
  v_mfma_f32_16x16x32_bf16 v[80:83], a[48:51], a[12:15], v[80:83]
  s_add_u32 s49, s49, 128
  s_and_b32 s49, s49, 2047
  s_or_b32 s46, s50, s49
  v_mfma_f32_16x16x32_bf16 v[120:123], a[48:51], a[16:19], v[120:123]
  s_or_b32 s47, s51, s49
  s_add_u32 s60, s63, 40960
  ds_read_b64_tr_b16 a[78:79], v21 offset:32768
  v_mfma_f32_16x16x32_bf16 v[60:63], a[52:55], a[0:3], v[60:63]
  ds_read_b64_tr_b16 a[80:81], v20 offset:38912
  ds_read_b64_tr_b16 a[82:83], v20 offset:40960
  v_mfma_f32_16x16x32_bf16 v[68:71], a[52:55], a[4:7], v[68:71]
  ds_read_b64_tr_b16 a[84:85], v21 offset:38912
  v_mfma_f32_16x16x32_bf16 v[76:79], a[52:55], a[8:11], v[76:79]
  buffer_store_dwordx4 v[224:227], v2, s[16:19], s60 offen offset:0 sc1
  ds_read_b64_tr_b16 a[86:87], v21 offset:40960
  v_mfma_f32_16x16x32_bf16 v[84:87], a[52:55], a[12:15], v[84:87]
  v_mfma_f32_16x16x32_bf16 v[124:127], a[52:55], a[16:19], v[124:127]
  v_mfma_f32_16x16x32_bf16 v[88:91], a[0:3], a[56:59], v[88:91]
  v_mfma_f32_16x16x32_bf16 v[96:99], a[4:7], a[56:59], v[96:99]
  v_mfma_f32_16x16x32_bf16 v[104:107], a[8:11], a[56:59], v[104:107]
  buffer_store_dwordx4 v[228:231], v2, s[16:19], s60 offen offset:1024 sc1
  v_mfma_f32_16x16x32_bf16 v[112:115], a[12:15], a[56:59], v[112:115]
  v_mfma_f32_16x16x32_bf16 v[92:95], a[0:3], a[60:63], v[92:95]
  v_mfma_f32_16x16x32_bf16 v[100:103], a[4:7], a[60:63], v[100:103]
  v_mfma_f32_16x16x32_bf16 v[108:111], a[8:11], a[60:63], v[108:111]
  v_mfma_f32_16x16x32_bf16 v[116:119], a[12:15], a[60:63], v[116:119]
  s_waitcnt lgkmcnt(0)
  s_barrier
  v_mfma_f32_16x16x32_bf16 v[24:27], a[64:67], a[20:23], v[24:27]
  s_add_u32 m0, s36, 32768
  v_mfma_f32_16x16x32_bf16 v[32:35], a[64:67], a[24:27], v[32:35]
  buffer_load_dwordx4 v4, s[8:11], s46 offen offset:0 lds
  v_mfma_f32_16x16x32_bf16 v[40:43], a[64:67], a[28:31], v[40:43]
  v_mfma_f32_16x16x32_bf16 v[48:51], a[64:67], a[32:35], v[48:51]
  buffer_load_dwordx4 v5, s[8:11], s46 offen offset:1024 lds
  v_mfma_f32_16x16x32_bf16 v[28:31], a[68:71], a[20:23], v[28:31]
  v_mfma_f32_16x16x32_bf16 v[36:39], a[68:71], a[24:27], v[36:39]
  v_mfma_f32_16x16x32_bf16 v[44:47], a[68:71], a[28:31], v[44:47]
  buffer_load_dwordx4 v6, s[8:11], s46 offen offset:2048 lds
  v_mfma_f32_16x16x32_bf16 v[52:55], a[68:71], a[32:35], v[52:55]
  v_mfma_f32_16x16x32_bf16 v[56:59], a[72:75], a[20:23], v[56:59]
  v_mfma_f32_16x16x32_bf16 v[64:67], a[72:75], a[24:27], v[64:67]
  buffer_load_dwordx4 v7, s[8:11], s46 offen offset:3072 lds
  v_mfma_f32_16x16x32_bf16 v[72:75], a[72:75], a[28:31], v[72:75]
  s_add_u32 m0, s36, 36864
  v_mfma_f32_16x16x32_bf16 v[80:83], a[72:75], a[32:35], v[80:83]
  v_mfma_f32_16x16x32_bf16 v[120:123], a[72:75], a[36:39], v[120:123]
  buffer_load_dwordx4 v4, s[8:11], s47 offen offset:0 lds
  v_mfma_f32_16x16x32_bf16 v[60:63], a[76:79], a[20:23], v[60:63]
  v_mfma_f32_16x16x32_bf16 v[68:71], a[76:79], a[24:27], v[68:71]
  v_mfma_f32_16x16x32_bf16 v[76:79], a[76:79], a[28:31], v[76:79]
  buffer_load_dwordx4 v5, s[8:11], s47 offen offset:1024 lds
  v_mfma_f32_16x16x32_bf16 v[84:87], a[76:79], a[32:35], v[84:87]
  v_mfma_f32_16x16x32_bf16 v[124:127], a[76:79], a[36:39], v[124:127]
  v_mfma_f32_16x16x32_bf16 v[88:91], a[20:23], a[80:83], v[88:91]
  buffer_load_dwordx4 v6, s[8:11], s47 offen offset:2048 lds
  v_mfma_f32_16x16x32_bf16 v[96:99], a[24:27], a[80:83], v[96:99]
  v_mfma_f32_16x16x32_bf16 v[104:107], a[28:31], a[80:83], v[104:107]
  v_mfma_f32_16x16x32_bf16 v[112:115], a[32:35], a[80:83], v[112:115]
  buffer_load_dwordx4 v7, s[8:11], s47 offen offset:3072 lds
  v_mfma_f32_16x16x32_bf16 v[92:95], a[20:23], a[84:87], v[92:95]
  s_add_u32 s49, s49, 128
  s_and_b32 s49, s49, 2047
  s_or_b32 s46, s50, s49
  v_mfma_f32_16x16x32_bf16 v[100:103], a[24:27], a[84:87], v[100:103]
  s_or_b32 s47, s51, s49
  v_mfma_f32_16x16x32_bf16 v[108:111], a[28:31], a[84:87], v[108:111]
  v_mfma_f32_16x16x32_bf16 v[116:119], a[32:35], a[84:87], v[116:119]
  s_and_b32 s4, s3, 1
  s_mul_i32 s4, s4, 3072
  s_add_u32 s4, s4, 49152
  v_add_u32 v196, s4, v2
  s_add_u32 s60, s63, 40960
  buffer_store_dwordx4 v[232:235], v2, s[16:19], s60 offen offset:2048 sc1
  v_cvt_pk_bf16_f32 v160, v80, v81
  v_cvt_pk_bf16_f32 v161, v82, v83
  v_cvt_pk_bf16_f32 v172, v112, v113
  v_cvt_pk_bf16_f32 v173, v114, v115
  v_cvt_pk_bf16_f32 v162, v84, v85
  v_cvt_pk_bf16_f32 v163, v86, v87
  v_cvt_pk_bf16_f32 v182, v116, v117
  v_cvt_pk_bf16_f32 v183, v118, v119
  ds_write_b128 v196, v[160:163]
  ds_write_b64 v196, v[172:173] offset:1024
  ds_write_b64 v196, v[182:183] offset:1032
  v_and_b32 v197, 15, v1
  v_lshrrev_b32 v198, 4, v1
  v_lshlrev_b32 v198, 2, v198
  v_sub_u32 v197, v197, v198
  v_mov_b32 v198, 0xf149f2ca
  buffer_store_dwordx4 v[236:239], v2, s[16:19], s60 offen offset:3072 sc1
  v_subrev_u32 v199, 0, v197
  v_and_b32 v184, 0x80000001, v199
  v_cmp_ne_u32 vcc, 0, v184
  s_nop 1
  v_cndmask_b32 v184, 0, v198, vcc
  v_add_u32 v199, 1, v199
  v_and_b32 v188, 0x80000001, v199
  v_cmp_ne_u32 vcc, 0x80000001, v188
  s_nop 1
  v_cndmask_b32 v188, 0, v198, vcc
  v_subrev_u32 v199, 1, v197
  v_and_b32 v185, 0x80000001, v199
  v_cmp_ne_u32 vcc, 0, v185
  s_nop 1
  v_cndmask_b32 v185, 0, v198, vcc
  v_add_u32 v199, 1, v199
  v_and_b32 v189, 0x80000001, v199
  v_cmp_ne_u32 vcc, 0x80000001, v189
  s_nop 1
  v_cndmask_b32 v189, 0, v198, vcc
  v_subrev_u32 v199, 2, v197
  v_and_b32 v186, 0x80000001, v199
  v_cmp_ne_u32 vcc, 0, v186
  s_nop 1
  v_cndmask_b32 v186, 0, v198, vcc
  v_add_u32 v199, 1, v199
  v_and_b32 v190, 0x80000001, v199
  v_cmp_ne_u32 vcc, 0x80000001, v190
  s_nop 1
  v_cndmask_b32 v190, 0, v198, vcc
  v_subrev_u32 v199, 3, v197
  s_add_u32 s60, s63, 45056
  buffer_store_dwordx4 v[240:243], v2, s[16:19], s60 offen offset:0 sc1
  v_and_b32 v187, 0x80000001, v199
  v_cmp_ne_u32 vcc, 0, v187
  s_nop 1
  v_cndmask_b32 v187, 0, v198, vcc
  v_add_u32 v199, 1, v199
  v_and_b32 v191, 0x80000001, v199
  v_cmp_ne_u32 vcc, 0x80000001, v191
  s_nop 1
  v_cndmask_b32 v191, 0, v198, vcc
  s_cmp_eq_u32 s32, 0
  s_cselect_b64 vcc, -1, 0
  v_cndmask_b32 v192, v188, v198, vcc
  v_cndmask_b32 v193, v189, v198, vcc
  v_cndmask_b32 v194, v190, v198, vcc
  v_cndmask_b32 v195, v191, v198, vcc
  s_mov_b32 s6, 0x3e8293ee
  s_mov_b32 s7, s6
  v_pk_mul_f32 v[24:25], v[24:25], s[6:7]
  v_pk_mul_f32 v[26:27], v[26:27], s[6:7]
  v_pk_mul_f32 v[28:29], v[28:29], s[6:7]
  v_pk_mul_f32 v[30:31], v[30:31], s[6:7]
  v_cvt_pk_bf16_f32 v128, v24, v25
  v_cvt_pk_bf16_f32 v129, v26, v27
  v_cvt_pk_bf16_f32 v130, v28, v29
  v_cvt_pk_bf16_f32 v131, v30, v31
  v_pk_mul_f32 v[32:33], v[32:33], s[6:7]
  v_pk_mul_f32 v[34:35], v[34:35], s[6:7]
  buffer_store_dwordx4 v[244:247], v2, s[16:19], s60 offen offset:1024 sc1
  v_pk_mul_f32 v[36:37], v[36:37], s[6:7]
  v_pk_mul_f32 v[38:39], v[38:39], s[6:7]
  v_cvt_pk_bf16_f32 v132, v32, v33
  v_cvt_pk_bf16_f32 v133, v34, v35
  v_cvt_pk_bf16_f32 v134, v36, v37
  v_cvt_pk_bf16_f32 v135, v38, v39
  v_pk_mul_f32 v[40:41], v[40:41], s[6:7]
  v_pk_mul_f32 v[42:43], v[42:43], s[6:7]
  v_pk_mul_f32 v[44:45], v[44:45], s[6:7]
  v_pk_mul_f32 v[46:47], v[46:47], s[6:7]
  v_cvt_pk_bf16_f32 v136, v40, v41
  v_cvt_pk_bf16_f32 v137, v42, v43
  v_cvt_pk_bf16_f32 v138, v44, v45
  buffer_store_dwordx4 v[248:251], v2, s[16:19], s60 offen offset:2048 sc1
  v_cvt_pk_bf16_f32 v139, v46, v47
  v_pk_mul_f32 v[48:49], v[48:49], s[6:7]
  v_pk_mul_f32 v[50:51], v[50:51], s[6:7]
  v_pk_mul_f32 v[52:53], v[52:53], s[6:7]
  v_pk_mul_f32 v[54:55], v[54:55], s[6:7]
  v_cvt_pk_bf16_f32 v140, v48, v49
  v_cvt_pk_bf16_f32 v141, v50, v51
  v_cvt_pk_bf16_f32 v142, v52, v53
  v_cvt_pk_bf16_f32 v143, v54, v55
  v_cvt_pk_bf16_f32 v148, v56, v57
  v_cvt_pk_bf16_f32 v149, v58, v59
  v_cvt_pk_bf16_f32 v166, v88, v89
  buffer_store_dwordx4 v[252:255], v2, s[16:19], s60 offen offset:3072 sc1
  v_cvt_pk_bf16_f32 v167, v90, v91
  v_cvt_pk_bf16_f32 v150, v60, v61
  v_cvt_pk_bf16_f32 v151, v62, v63
  v_cvt_pk_bf16_f32 v176, v92, v93
  v_cvt_pk_bf16_f32 v177, v94, v95
  v_cvt_pk_bf16_f32 v152, v64, v65
  v_cvt_pk_bf16_f32 v153, v66, v67
  v_cvt_pk_bf16_f32 v168, v96, v97
  v_cvt_pk_bf16_f32 v169, v98, v99
  v_cvt_pk_bf16_f32 v154, v68, v69
  v_cvt_pk_bf16_f32 v155, v70, v71
  v_cvt_pk_bf16_f32 v178, v100, v101
  v_cvt_pk_bf16_f32 v179, v102, v103
  s_add_u32 m0, s41, 32768
  s_nop 0
  buffer_load_dwordx4 v8, s[12:15], s48 offen offset:0 lds
  v_cvt_pk_bf16_f32 v156, v72, v73
  v_cvt_pk_bf16_f32 v157, v74, v75
  v_cvt_pk_bf16_f32 v170, v104, v105
  v_cvt_pk_bf16_f32 v171, v106, v107
  v_cvt_pk_bf16_f32 v158, v76, v77
  v_cvt_pk_bf16_f32 v159, v78, v79
  v_cvt_pk_bf16_f32 v180, v108, v109
  v_cvt_pk_bf16_f32 v181, v110, v111
  v_cvt_pk_bf16_f32 v144, v120, v121
  v_cvt_pk_bf16_f32 v145, v122, v123
  v_cvt_pk_bf16_f32 v146, v124, v125
  v_cvt_pk_bf16_f32 v147, v126, v127
  buffer_load_dwordx4 v9, s[12:15], s48 offen offset:1024 lds
  v_mov_b32 v200, 0x3f803f80
  v_mov_b32 v201, v200
  v_mov_b32 v202, v200
  v_mov_b32 v203, v200
  s_waitcnt lgkmcnt(0)
  s_barrier
  ds_read_b64 v[164:165], v196 offset:2048
  ds_read_b64 v[174:175], v196 offset:2056
  v_mfma_f32_16x16x32_bf16 v[48:51], v[156:159], v[140:143], v[188:191]
  v_mfma_f32_16x16x32_bf16 v[52:55], v[160:163], v[140:143], v[184:187]
  v_mfma_f32_16x16x32_bf16 v[40:43], v[152:155], v[136:139], v[188:191]
  v_mfma_f32_16x16x32_bf16 v[44:47], v[156:159], v[136:139], v[184:187]
  v_mfma_f32_16x16x32_bf16 v[32:35], v[148:151], v[132:135], v[188:191]
  v_mfma_f32_16x16x32_bf16 v[36:39], v[152:155], v[132:135], v[184:187]
  s_waitcnt lgkmcnt(0)
  v_mfma_f32_16x16x32_bf16 v[24:27], v[144:147], v[128:131], v[192:195]
  v_mfma_f32_16x16x32_bf16 v[28:31], v[148:151], v[128:131], v[184:187]
  v_max3_f32 v62, v48, v49, v50
  v_max3_f32 v63, v51, v52, v53
  v_max3_f32 v62, v62, v54, v55
  buffer_load_dwordx4 v10, s[12:15], s48 offen offset:2048 lds
  v_max_f32 v62, v62, v63
  v_max3_f32 v60, v40, v41, v42
  v_max3_f32 v61, v43, v44, v45
  v_max3_f32 v60, v60, v46, v47
  v_max_f32 v60, v60, v61
  v_max3_f32 v58, v32, v33, v34
  v_max3_f32 v59, v35, v36, v37
  v_max3_f32 v58, v58, v38, v39
  v_max_f32 v58, v58, v59
  v_max3_f32 v56, v24, v25, v26
  v_max3_f32 v57, v27, v28, v29
  v_max3_f32 v56, v56, v30, v31
  buffer_load_dwordx4 v11, s[12:15], s48 offen offset:3072 lds
  v_max_f32 v56, v56, v57
  v_mov_b32 v63, v62
  v_mov_b32 v61, v60
  v_mov_b32 v59, v58
  v_mov_b32 v57, v56
  v_permlane32_swap_b32 v62, v63
  v_permlane32_swap_b32 v60, v61
  v_permlane32_swap_b32 v58, v59
  v_permlane32_swap_b32 v56, v57
  v_max_f32 v62, v62, v63
  v_max_f32 v60, v60, v61
  v_max_f32 v58, v58, v59
  v_max_f32 v56, v56, v57
  s_add_u32 s48, s48, 524288
  s_and_b32 s48, s48, 8388607
  s_add_u32 m0, s36, -32768
  s_nop 0
  buffer_load_dwordx4 v4, s[8:11], s46 offen offset:0 lds
  v_mov_b32 v63, v62
  v_mov_b32 v61, v60
  v_mov_b32 v59, v58
  v_mov_b32 v57, v56
  v_permlane16_swap_b32 v62, v63
  v_permlane16_swap_b32 v60, v61
  v_permlane16_swap_b32 v58, v59
  v_permlane16_swap_b32 v56, v57
  v_max_f32 v62, v62, v63
  v_max_f32 v60, v60, v61
  v_max_f32 v58, v58, v59
  v_max_f32 v56, v56, v57
  buffer_load_dwordx4 v5, s[8:11], s46 offen offset:1024 lds
  v_sub_f32 v48, v48, v62
  v_sub_f32 v49, v49, v62
  v_sub_f32 v50, v50, v62
  v_sub_f32 v51, v51, v62
  v_sub_f32 v52, v52, v62
  v_sub_f32 v53, v53, v62
  v_sub_f32 v54, v54, v62
  v_sub_f32 v55, v55, v62
  v_exp_f32 v48, v48
  v_exp_f32 v49, v49
  v_exp_f32 v50, v50
  v_exp_f32 v51, v51
  v_exp_f32 v52, v52
  buffer_load_dwordx4 v6, s[8:11], s46 offen offset:2048 lds
  v_exp_f32 v53, v53
  v_exp_f32 v54, v54
  v_exp_f32 v55, v55
  v_sub_f32 v40, v40, v60
  v_sub_f32 v41, v41, v60
  v_sub_f32 v42, v42, v60
  v_sub_f32 v43, v43, v60
  v_sub_f32 v44, v44, v60
  v_sub_f32 v45, v45, v60
  v_sub_f32 v46, v46, v60
  v_sub_f32 v47, v47, v60
  v_exp_f32 v40, v40
  buffer_load_dwordx4 v7, s[8:11], s46 offen offset:3072 lds
  v_exp_f32 v41, v41
  v_exp_f32 v42, v42
  v_exp_f32 v43, v43
  v_exp_f32 v44, v44
  v_exp_f32 v45, v45
  v_exp_f32 v46, v46
  v_exp_f32 v47, v47
  v_sub_f32 v32, v32, v58
  v_sub_f32 v33, v33, v58
  v_sub_f32 v34, v34, v58
  v_sub_f32 v35, v35, v58
  v_sub_f32 v36, v36, v58
  v_sub_f32 v37, v37, v58
  s_add_u32 m0, s36, -28672
  s_nop 0
  buffer_load_dwordx4 v4, s[8:11], s47 offen offset:0 lds
  v_sub_f32 v38, v38, v58
  v_sub_f32 v39, v39, v58
  v_exp_f32 v32, v32
  v_exp_f32 v33, v33
  v_exp_f32 v34, v34
  v_exp_f32 v35, v35
  v_exp_f32 v36, v36
  v_exp_f32 v37, v37
  v_exp_f32 v38, v38
  v_exp_f32 v39, v39
  v_sub_f32 v24, v24, v56
  v_sub_f32 v25, v25, v56
  buffer_load_dwordx4 v5, s[8:11], s47 offen offset:1024 lds
  v_sub_f32 v26, v26, v56
  v_sub_f32 v27, v27, v56
  v_sub_f32 v28, v28, v56
  v_sub_f32 v29, v29, v56
  v_sub_f32 v30, v30, v56
  v_sub_f32 v31, v31, v56
  v_exp_f32 v24, v24
  v_exp_f32 v25, v25
  v_exp_f32 v26, v26
  v_exp_f32 v27, v27
  v_exp_f32 v28, v28
  v_exp_f32 v29, v29
  v_exp_f32 v30, v30
  buffer_load_dwordx4 v6, s[8:11], s47 offen offset:2048 lds
  v_exp_f32 v31, v31
  v_cvt_pk_bf16_f32 v76, v48, v49
  v_cvt_pk_bf16_f32 v77, v50, v51
  v_cvt_pk_bf16_f32 v78, v52, v53
  v_cvt_pk_bf16_f32 v79, v54, v55
  v_cvt_pk_bf16_f32 v72, v40, v41
  v_cvt_pk_bf16_f32 v73, v42, v43
  v_cvt_pk_bf16_f32 v74, v44, v45
  v_cvt_pk_bf16_f32 v75, v46, v47
  v_cvt_pk_bf16_f32 v68, v32, v33
  v_cvt_pk_bf16_f32 v69, v34, v35
  v_cvt_pk_bf16_f32 v70, v36, v37
  buffer_load_dwordx4 v7, s[8:11], s47 offen offset:3072 lds
  s_add_u32 s49, s49, 128
  s_and_b32 s49, s49, 2047
  s_or_b32 s46, s50, s49
  s_or_b32 s47, s51, s49
  v_cvt_pk_bf16_f32 v71, v38, v39
  v_cvt_pk_bf16_f32 v64, v24, v25
  v_cvt_pk_bf16_f32 v65, v26, v27
  v_cvt_pk_bf16_f32 v66, v28, v29
  v_cvt_pk_bf16_f32 v67, v30, v31
  v_mfma_f32_16x16x32_bf16 v[92:95], v[200:203], v[76:79], 0
  v_mfma_f32_16x16x32_bf16 v[120:123], v[170:173], v[76:79], 0
  v_mfma_f32_16x16x32_bf16 v[124:127], v[180:183], v[76:79], 0
  v_mfma_f32_16x16x32_bf16 v[88:91], v[200:203], v[72:75], 0
  v_mfma_f32_16x16x32_bf16 v[112:115], v[168:171], v[72:75], 0
  v_mfma_f32_16x16x32_bf16 v[116:119], v[178:181], v[72:75], 0
  v_mfma_f32_16x16x32_bf16 v[84:87], v[200:203], v[68:71], 0
  v_mfma_f32_16x16x32_bf16 v[104:107], v[166:169], v[68:71], 0
  v_mfma_f32_16x16x32_bf16 v[108:111], v[176:179], v[68:71], 0
  v_mfma_f32_16x16x32_bf16 v[80:83], v[200:203], v[64:67], 0
  v_mfma_f32_16x16x32_bf16 v[96:99], v[164:167], v[64:67], 0
  v_mfma_f32_16x16x32_bf16 v[100:103], v[174:177], v[64:67], 0
  s_add_u32 s20, s86, 83886080
  s_addc_u32 s21, s87, 0
  s_mov_b32 s22, 4194304
  s_mov_b32 s23, 0x00020000
  s_lshl_b32 s4, s32, 18
  s_lshl_b32 s5, s33, 14
  s_add_u32 s4, s4, s5
  s_and_b32 s5, s3, 1
  s_lshl_b32 s5, s5, 13
  s_add_u32 s4, s4, s5
  v_rcp_f32 v92, v92
  v_rcp_f32 v88, v88
  v_rcp_f32 v84, v84
  v_rcp_f32 v80, v80
  v_mov_b32 v93, v92
  v_mov_b32 v89, v88
  v_mov_b32 v85, v84
  v_mov_b32 v81, v80
  v_pk_mul_f32 v[120:121], v[120:121], v[92:93]
  v_pk_mul_f32 v[122:123], v[122:123], v[92:93]
  v_pk_mul_f32 v[124:125], v[124:125], v[92:93]
  v_pk_mul_f32 v[126:127], v[126:127], v[92:93]
  v_cvt_pk_bf16_f32 v120, v120, v121
  v_cvt_pk_bf16_f32 v121, v122, v123
  v_cvt_pk_bf16_f32 v122, v124, v125
  v_cvt_pk_bf16_f32 v123, v126, v127
  buffer_store_dwordx4 v[120:123], v2, s[20:23], s4 offen offset:3072 sc1
  v_pk_mul_f32 v[112:113], v[112:113], v[88:89]
  v_pk_mul_f32 v[114:115], v[114:115], v[88:89]
  v_pk_mul_f32 v[116:117], v[116:117], v[88:89]
  v_pk_mul_f32 v[118:119], v[118:119], v[88:89]
  v_cvt_pk_bf16_f32 v112, v112, v113
  v_cvt_pk_bf16_f32 v113, v114, v115
  v_cvt_pk_bf16_f32 v114, v116, v117
  v_cvt_pk_bf16_f32 v115, v118, v119
  buffer_store_dwordx4 v[112:115], v2, s[20:23], s4 offen offset:2048 sc1
  v_pk_mul_f32 v[104:105], v[104:105], v[84:85]
  v_pk_mul_f32 v[106:107], v[106:107], v[84:85]
  v_pk_mul_f32 v[108:109], v[108:109], v[84:85]
  v_pk_mul_f32 v[110:111], v[110:111], v[84:85]
  v_cvt_pk_bf16_f32 v104, v104, v105
  v_cvt_pk_bf16_f32 v105, v106, v107
  v_cvt_pk_bf16_f32 v106, v108, v109
  v_cvt_pk_bf16_f32 v107, v110, v111
  buffer_store_dwordx4 v[104:107], v2, s[20:23], s4 offen offset:1024 sc1
  v_pk_mul_f32 v[96:97], v[96:97], v[80:81]
  v_pk_mul_f32 v[98:99], v[98:99], v[80:81]
  v_pk_mul_f32 v[100:101], v[100:101], v[80:81]
  v_pk_mul_f32 v[102:103], v[102:103], v[80:81]
  v_cvt_pk_bf16_f32 v96, v96, v97
  v_cvt_pk_bf16_f32 v97, v98, v99
  v_cvt_pk_bf16_f32 v98, v100, v101
  v_cvt_pk_bf16_f32 v99, v102, v103
  buffer_store_dwordx4 v[96:99], v2, s[20:23], s4 offen offset:0 sc1
  s_branch Lp3
Lp2_r1:
  s_waitcnt vmcnt(24)
  s_barrier
  ds_read_b128 a[0:3], v16 offset:0
  ds_read_b64_tr_b16 a[40:41], v20 offset:18432
  ds_read_b64_tr_b16 a[42:43], v20 offset:20480
  ds_read_b128 a[4:7], v16 offset:2048
  ds_read_b128 a[8:11], v16 offset:4096
  ds_read_b128 a[12:15], v16 offset:6144
  ds_read_b64_tr_b16 a[44:45], v21 offset:18432
  ds_read_b64_tr_b16 a[46:47], v21 offset:20480
  ds_read_b64_tr_b16 a[48:49], v20 offset:26624
  ds_read_b64_tr_b16 a[50:51], v20 offset:28672
  ds_read_b64_tr_b16 a[52:53], v21 offset:26624
  ds_read_b64_tr_b16 a[54:55], v21 offset:28672
  ds_read_b64_tr_b16 a[56:57], v20 offset:34816
  ds_read_b64_tr_b16 a[58:59], v20 offset:36864
  ds_read_b128 a[16:19], v18 offset:0
  ds_read_b64_tr_b16 a[60:61], v21 offset:34816
  ds_read_b64_tr_b16 a[62:63], v21 offset:36864
  s_waitcnt lgkmcnt(0)
  v_mfma_f32_16x16x32_bf16 v[24:27], a[40:43], a[0:3], 0
  s_add_u32 s60, s63, 8192
  buffer_store_dwordx4 v[140:143], v2, s[16:19], s60 offen offset:3072 sc1
  ds_read_b128 a[20:23], v17 offset:0
  v_mfma_f32_16x16x32_bf16 v[32:35], a[40:43], a[4:7], 0
  s_add_u32 s89, s89, 1
  ds_read_b64_tr_b16 a[64:65], v20 offset:22528
  ds_read_b64_tr_b16 a[66:67], v20 offset:24576
  v_mfma_f32_16x16x32_bf16 v[40:43], a[40:43], a[8:11], 0
  s_cmp_eq_u32 s89, 3
  s_cselect_b32 s89, 0, s89
  s_cselect_b32 s90, s91, s92
  ds_read_b128 a[24:27], v17 offset:2048
  v_mfma_f32_16x16x32_bf16 v[48:51], a[40:43], a[12:15], 0
  ds_read_b128 a[28:31], v17 offset:4096
  v_mfma_f32_16x16x32_bf16 v[28:31], a[44:47], a[0:3], 0
  ds_read_b128 a[32:35], v17 offset:6144
  v_mfma_f32_16x16x32_bf16 v[36:39], a[44:47], a[4:7], 0
  ds_read_b64_tr_b16 a[68:69], v21 offset:22528
  v_mfma_f32_16x16x32_bf16 v[44:47], a[44:47], a[8:11], 0
  ds_read_b64_tr_b16 a[70:71], v21 offset:24576
  v_mfma_f32_16x16x32_bf16 v[52:55], a[44:47], a[12:15], 0
  ds_read_b64_tr_b16 a[72:73], v20 offset:30720
  v_mfma_f32_16x16x32_bf16 v[56:59], a[48:51], a[0:3], 0
  ds_read_b64_tr_b16 a[74:75], v20 offset:32768
  v_mfma_f32_16x16x32_bf16 v[64:67], a[48:51], a[4:7], 0
  ds_read_b64_tr_b16 a[76:77], v21 offset:30720
  v_mfma_f32_16x16x32_bf16 v[72:75], a[48:51], a[8:11], 0
  ds_read_b64_tr_b16 a[78:79], v21 offset:32768
  v_mfma_f32_16x16x32_bf16 v[80:83], a[48:51], a[12:15], 0
  ds_read_b64_tr_b16 a[80:81], v20 offset:38912
  v_mfma_f32_16x16x32_bf16 v[60:63], a[52:55], a[0:3], 0
  ds_read_b64_tr_b16 a[82:83], v20 offset:40960
  v_mfma_f32_16x16x32_bf16 v[68:71], a[52:55], a[4:7], 0
  ds_read_b128 a[36:39], v19 offset:0
  v_mfma_f32_16x16x32_bf16 v[76:79], a[52:55], a[8:11], 0
  ds_read_b64_tr_b16 a[84:85], v21 offset:38912
  v_mfma_f32_16x16x32_bf16 v[84:87], a[52:55], a[12:15], 0
  ds_read_b64_tr_b16 a[86:87], v21 offset:40960
  v_mfma_f32_16x16x32_bf16 v[88:91], a[0:3], a[56:59], 0
  v_add_u32 v16, s90, v16
  v_add_u32 v17, s90, v17
  v_mfma_f32_16x16x32_bf16 v[96:99], a[4:7], a[56:59], 0
  v_add_u32 v18, s90, v18
  v_add_u32 v19, s90, v19
  v_mfma_f32_16x16x32_bf16 v[104:107], a[8:11], a[56:59], 0
  v_add_u32 v20, s90, v20
  v_add_u32 v21, s90, v21
  v_mfma_f32_16x16x32_bf16 v[112:115], a[12:15], a[56:59], 0
  v_mfma_f32_16x16x32_bf16 v[120:123], a[16:19], a[56:59], 0
  v_mfma_f32_16x16x32_bf16 v[92:95], a[0:3], a[60:63], 0
  v_mfma_f32_16x16x32_bf16 v[100:103], a[4:7], a[60:63], 0
  v_mfma_f32_16x16x32_bf16 v[108:111], a[8:11], a[60:63], 0
  v_mfma_f32_16x16x32_bf16 v[116:119], a[12:15], a[60:63], 0
  v_mfma_f32_16x16x32_bf16 v[124:127], a[16:19], a[60:63], 0
  s_waitcnt vmcnt(15) lgkmcnt(0)
  s_barrier
  v_mfma_f32_16x16x32_bf16 v[24:27], a[64:67], a[20:23], v[24:27]
  buffer_load_dwordx4 a[192:195], v2, s[52:55], s51 offen offset:0
  ds_read_b128 a[0:3], v16 offset:0
  v_mfma_f32_16x16x32_bf16 v[32:35], a[64:67], a[24:27], v[32:35]
  s_add_u32 s51, s51, 1024
  s_mov_b32 m0, s88
  ds_read_b64_tr_b16 a[40:41], v20 offset:18432
  v_mfma_f32_16x16x32_bf16 v[40:43], a[64:67], a[28:31], v[40:43]
  ds_read_b64_tr_b16 a[42:43], v20 offset:20480
  ds_read_b128 a[4:7], v16 offset:2048
  v_mfma_f32_16x16x32_bf16 v[48:51], a[64:67], a[32:35], v[48:51]
  ds_read_b128 a[8:11], v16 offset:4096
  v_mfma_f32_16x16x32_bf16 v[28:31], a[68:71], a[20:23], v[28:31]
  buffer_load_dwordx4 v4, s[8:11], s30 offen offset:0 lds
  ds_read_b128 a[12:15], v16 offset:6144
  v_mfma_f32_16x16x32_bf16 v[36:39], a[68:71], a[24:27], v[36:39]
  ds_read_b64_tr_b16 a[44:45], v21 offset:18432
  v_mfma_f32_16x16x32_bf16 v[44:47], a[68:71], a[28:31], v[44:47]
  ds_read_b64_tr_b16 a[46:47], v21 offset:20480
  v_mfma_f32_16x16x32_bf16 v[52:55], a[68:71], a[32:35], v[52:55]
  ds_read_b64_tr_b16 a[48:49], v20 offset:26624
  v_mfma_f32_16x16x32_bf16 v[56:59], a[72:75], a[20:23], v[56:59]
  buffer_load_dwordx4 v5, s[8:11], s30 offen offset:1024 lds
  ds_read_b64_tr_b16 a[50:51], v20 offset:28672
  v_mfma_f32_16x16x32_bf16 v[64:67], a[72:75], a[24:27], v[64:67]
  ds_read_b64_tr_b16 a[52:53], v21 offset:26624
  v_mfma_f32_16x16x32_bf16 v[72:75], a[72:75], a[28:31], v[72:75]
  ds_read_b64_tr_b16 a[54:55], v21 offset:28672
  v_mfma_f32_16x16x32_bf16 v[80:83], a[72:75], a[32:35], v[80:83]
  ds_read_b64_tr_b16 a[56:57], v20 offset:34816
  v_mfma_f32_16x16x32_bf16 v[60:63], a[76:79], a[20:23], v[60:63]
  buffer_load_dwordx4 v6, s[8:11], s30 offen offset:2048 lds
  ds_read_b64_tr_b16 a[58:59], v20 offset:36864
  v_mfma_f32_16x16x32_bf16 v[68:71], a[76:79], a[24:27], v[68:71]
  ds_read_b128 a[16:19], v18 offset:0
  v_mfma_f32_16x16x32_bf16 v[76:79], a[76:79], a[28:31], v[76:79]
  ds_read_b64_tr_b16 a[60:61], v21 offset:34816
  v_mfma_f32_16x16x32_bf16 v[84:87], a[76:79], a[32:35], v[84:87]
  ds_read_b64_tr_b16 a[62:63], v21 offset:36864
  v_mfma_f32_16x16x32_bf16 v[88:91], a[20:23], a[80:83], v[88:91]
  buffer_load_dwordx4 v7, s[8:11], s30 offen offset:3072 lds
  v_mfma_f32_16x16x32_bf16 v[96:99], a[24:27], a[80:83], v[96:99]
  s_add_u32 s30, s30, 128
  s_and_b32 s30, s30, 2047
  s_add_u32 m0, s88, s26
  v_mfma_f32_16x16x32_bf16 v[104:107], a[28:31], a[80:83], v[104:107]
  v_mfma_f32_16x16x32_bf16 v[112:115], a[32:35], a[80:83], v[112:115]
  v_mfma_f32_16x16x32_bf16 v[120:123], a[36:39], a[80:83], v[120:123]
  buffer_load_dwordx4 v8, s[20:23], s31 offen offset:0 lds
  v_mfma_f32_16x16x32_bf16 v[92:95], a[20:23], a[84:87], v[92:95]
  v_mfma_f32_16x16x32_bf16 v[100:103], a[24:27], a[84:87], v[100:103]
  v_mfma_f32_16x16x32_bf16 v[108:111], a[28:31], a[84:87], v[108:111]
  v_mfma_f32_16x16x32_bf16 v[116:119], a[32:35], a[84:87], v[116:119]
  v_mfma_f32_16x16x32_bf16 v[124:127], a[36:39], a[84:87], v[124:127]
  s_waitcnt lgkmcnt(0)
  v_mfma_f32_16x16x32_bf16 v[24:27], a[40:43], a[0:3], v[24:27]
  buffer_load_dwordx4 v9, s[20:23], s31 offen offset:1024 lds
  ds_read_b128 a[20:23], v17 offset:0
  v_mfma_f32_16x16x32_bf16 v[32:35], a[40:43], a[4:7], v[32:35]
  ds_read_b64_tr_b16 a[64:65], v20 offset:22528
  ds_read_b64_tr_b16 a[66:67], v20 offset:24576
  v_mfma_f32_16x16x32_bf16 v[40:43], a[40:43], a[8:11], v[40:43]
  ds_read_b128 a[24:27], v17 offset:2048
  v_mfma_f32_16x16x32_bf16 v[48:51], a[40:43], a[12:15], v[48:51]
  buffer_load_dwordx4 v10, s[20:23], s31 offen offset:2048 lds
  ds_read_b128 a[28:31], v17 offset:4096
  v_mfma_f32_16x16x32_bf16 v[28:31], a[44:47], a[0:3], v[28:31]
  s_add_u32 m0, s88, s27
  ds_read_b128 a[32:35], v17 offset:6144
  v_mfma_f32_16x16x32_bf16 v[36:39], a[44:47], a[4:7], v[36:39]
  ds_read_b64_tr_b16 a[68:69], v21 offset:22528
  v_mfma_f32_16x16x32_bf16 v[44:47], a[44:47], a[8:11], v[44:47]
  buffer_load_dwordx4 v11, s[20:23], s31 offen offset:0 lds
  ds_read_b64_tr_b16 a[70:71], v21 offset:24576
  v_mfma_f32_16x16x32_bf16 v[52:55], a[44:47], a[12:15], v[52:55]
  ds_read_b64_tr_b16 a[72:73], v20 offset:30720
  v_mfma_f32_16x16x32_bf16 v[56:59], a[48:51], a[0:3], v[56:59]
  ds_read_b64_tr_b16 a[74:75], v20 offset:32768
  v_mfma_f32_16x16x32_bf16 v[64:67], a[48:51], a[4:7], v[64:67]
  buffer_load_dwordx4 v12, s[20:23], s31 offen offset:1024 lds
  ds_read_b64_tr_b16 a[76:77], v21 offset:30720
  v_mfma_f32_16x16x32_bf16 v[72:75], a[48:51], a[8:11], v[72:75]
  ds_read_b64_tr_b16 a[78:79], v21 offset:32768
  v_mfma_f32_16x16x32_bf16 v[80:83], a[48:51], a[12:15], v[80:83]
  ds_read_b64_tr_b16 a[80:81], v20 offset:38912
  v_mfma_f32_16x16x32_bf16 v[60:63], a[52:55], a[0:3], v[60:63]
  buffer_load_dwordx4 v13, s[20:23], s31 offen offset:2048 lds
  ds_read_b64_tr_b16 a[82:83], v20 offset:40960
  v_mfma_f32_16x16x32_bf16 v[68:71], a[52:55], a[4:7], v[68:71]
  s_add_u32 s31, s31, 393216
  s_cmp_ge_u32 s31, 6291456
  s_cselect_b32 s29, 6291456, 0
  v_mfma_f32_16x16x32_bf16 v[76:79], a[52:55], a[8:11], v[76:79]
  s_sub_u32 s31, s31, s29
  s_add_u32 s60, s63, 12288
  ds_read_b128 a[36:39], v19 offset:0
  v_mfma_f32_16x16x32_bf16 v[84:87], a[52:55], a[12:15], v[84:87]
  buffer_store_dwordx4 v[144:147], v2, s[16:19], s60 offen offset:0 sc1
  ds_read_b64_tr_b16 a[84:85], v21 offset:38912
  v_mfma_f32_16x16x32_bf16 v[88:91], a[0:3], a[56:59], v[88:91]
  s_add_u32 s88, s88, s90
  s_add_u32 s89, s89, 1
  ds_read_b64_tr_b16 a[86:87], v21 offset:40960
  v_mfma_f32_16x16x32_bf16 v[96:99], a[4:7], a[56:59], v[96:99]
  s_cmp_eq_u32 s89, 3
  s_cselect_b32 s89, 0, s89
  s_cselect_b32 s90, s91, s92
  v_mfma_f32_16x16x32_bf16 v[104:107], a[8:11], a[56:59], v[104:107]
  v_add_u32 v16, s90, v16
  v_add_u32 v17, s90, v17
  v_mfma_f32_16x16x32_bf16 v[112:115], a[12:15], a[56:59], v[112:115]
  v_add_u32 v18, s90, v18
  v_add_u32 v19, s90, v19
  v_mfma_f32_16x16x32_bf16 v[120:123], a[16:19], a[56:59], v[120:123]
  v_add_u32 v20, s90, v20
  v_add_u32 v21, s90, v21
  v_mfma_f32_16x16x32_bf16 v[92:95], a[0:3], a[60:63], v[92:95]
  v_mfma_f32_16x16x32_bf16 v[100:103], a[4:7], a[60:63], v[100:103]
  v_mfma_f32_16x16x32_bf16 v[108:111], a[8:11], a[60:63], v[108:111]
  v_mfma_f32_16x16x32_bf16 v[116:119], a[12:15], a[60:63], v[116:119]
  v_mfma_f32_16x16x32_bf16 v[124:127], a[16:19], a[60:63], v[124:127]
  s_waitcnt vmcnt(16) lgkmcnt(0)
  s_barrier
  v_mfma_f32_16x16x32_bf16 v[24:27], a[64:67], a[20:23], v[24:27]
  buffer_load_dwordx4 a[192:195], v2, s[52:55], s51 offen offset:0
  ds_read_b128 a[0:3], v16 offset:0
  v_mfma_f32_16x16x32_bf16 v[32:35], a[64:67], a[24:27], v[32:35]
  s_add_u32 s51, s51, 1024
  s_mov_b32 m0, s88
  ds_read_b64_tr_b16 a[40:41], v20 offset:18432
  v_mfma_f32_16x16x32_bf16 v[40:43], a[64:67], a[28:31], v[40:43]
  ds_read_b64_tr_b16 a[42:43], v20 offset:20480
  ds_read_b128 a[4:7], v16 offset:2048
  v_mfma_f32_16x16x32_bf16 v[48:51], a[64:67], a[32:35], v[48:51]
  buffer_load_dwordx4 v4, s[8:11], s30 offen offset:0 lds
  ds_read_b128 a[8:11], v16 offset:4096
  v_mfma_f32_16x16x32_bf16 v[28:31], a[68:71], a[20:23], v[28:31]
  ds_read_b128 a[12:15], v16 offset:6144
  v_mfma_f32_16x16x32_bf16 v[36:39], a[68:71], a[24:27], v[36:39]
  ds_read_b64_tr_b16 a[44:45], v21 offset:18432
  v_mfma_f32_16x16x32_bf16 v[44:47], a[68:71], a[28:31], v[44:47]
  ds_read_b64_tr_b16 a[46:47], v21 offset:20480
  v_mfma_f32_16x16x32_bf16 v[52:55], a[68:71], a[32:35], v[52:55]
  buffer_load_dwordx4 v5, s[8:11], s30 offen offset:1024 lds
  ds_read_b64_tr_b16 a[48:49], v20 offset:26624
  v_mfma_f32_16x16x32_bf16 v[56:59], a[72:75], a[20:23], v[56:59]
  ds_read_b64_tr_b16 a[50:51], v20 offset:28672
  v_mfma_f32_16x16x32_bf16 v[64:67], a[72:75], a[24:27], v[64:67]
  ds_read_b64_tr_b16 a[52:53], v21 offset:26624
  v_mfma_f32_16x16x32_bf16 v[72:75], a[72:75], a[28:31], v[72:75]
  buffer_load_dwordx4 v6, s[8:11], s30 offen offset:2048 lds
  ds_read_b64_tr_b16 a[54:55], v21 offset:28672
  v_mfma_f32_16x16x32_bf16 v[80:83], a[72:75], a[32:35], v[80:83]
  ds_read_b64_tr_b16 a[56:57], v20 offset:34816
  v_mfma_f32_16x16x32_bf16 v[60:63], a[76:79], a[20:23], v[60:63]
  ds_read_b64_tr_b16 a[58:59], v20 offset:36864
  v_mfma_f32_16x16x32_bf16 v[68:71], a[76:79], a[24:27], v[68:71]
  ds_read_b128 a[16:19], v18 offset:0
  v_mfma_f32_16x16x32_bf16 v[76:79], a[76:79], a[28:31], v[76:79]
  buffer_load_dwordx4 v7, s[8:11], s30 offen offset:3072 lds
  ds_read_b64_tr_b16 a[60:61], v21 offset:34816
  v_mfma_f32_16x16x32_bf16 v[84:87], a[76:79], a[32:35], v[84:87]
  s_add_u32 s30, s30, 128
  s_and_b32 s30, s30, 2047
  s_add_u32 m0, s88, s26
  v_mfma_f32_16x16x32_bf16 v[88:91], a[20:23], a[80:83], v[88:91]
  ds_read_b64_tr_b16 a[62:63], v21 offset:36864
  v_mfma_f32_16x16x32_bf16 v[96:99], a[24:27], a[80:83], v[96:99]
  buffer_load_dwordx4 v8, s[20:23], s31 offen offset:0 lds
  v_mfma_f32_16x16x32_bf16 v[104:107], a[28:31], a[80:83], v[104:107]
  v_mfma_f32_16x16x32_bf16 v[112:115], a[32:35], a[80:83], v[112:115]
  v_mfma_f32_16x16x32_bf16 v[120:123], a[36:39], a[80:83], v[120:123]
  v_mfma_f32_16x16x32_bf16 v[92:95], a[20:23], a[84:87], v[92:95]
  buffer_load_dwordx4 v9, s[20:23], s31 offen offset:1024 lds
  v_mfma_f32_16x16x32_bf16 v[100:103], a[24:27], a[84:87], v[100:103]
  v_mfma_f32_16x16x32_bf16 v[108:111], a[28:31], a[84:87], v[108:111]
  v_mfma_f32_16x16x32_bf16 v[116:119], a[32:35], a[84:87], v[116:119]
  v_mfma_f32_16x16x32_bf16 v[124:127], a[36:39], a[84:87], v[124:127]
  s_waitcnt lgkmcnt(0)
  v_mfma_f32_16x16x32_bf16 v[24:27], a[40:43], a[0:3], v[24:27]
  buffer_load_dwordx4 v10, s[20:23], s31 offen offset:2048 lds
  ds_read_b128 a[20:23], v17 offset:0
  v_mfma_f32_16x16x32_bf16 v[32:35], a[40:43], a[4:7], v[32:35]
  s_add_u32 m0, s88, s27
  ds_read_b64_tr_b16 a[64:65], v20 offset:22528
  ds_read_b64_tr_b16 a[66:67], v20 offset:24576
  v_mfma_f32_16x16x32_bf16 v[40:43], a[40:43], a[8:11], v[40:43]
  ds_read_b128 a[24:27], v17 offset:2048
  v_mfma_f32_16x16x32_bf16 v[48:51], a[40:43], a[12:15], v[48:51]
  buffer_load_dwordx4 v11, s[20:23], s31 offen offset:0 lds
  ds_read_b128 a[28:31], v17 offset:4096
  v_mfma_f32_16x16x32_bf16 v[28:31], a[44:47], a[0:3], v[28:31]
  ds_read_b128 a[32:35], v17 offset:6144
  v_mfma_f32_16x16x32_bf16 v[36:39], a[44:47], a[4:7], v[36:39]
  ds_read_b64_tr_b16 a[68:69], v21 offset:22528
  v_mfma_f32_16x16x32_bf16 v[44:47], a[44:47], a[8:11], v[44:47]
  buffer_load_dwordx4 v12, s[20:23], s31 offen offset:1024 lds
  ds_read_b64_tr_b16 a[70:71], v21 offset:24576
  v_mfma_f32_16x16x32_bf16 v[52:55], a[44:47], a[12:15], v[52:55]
  ds_read_b64_tr_b16 a[72:73], v20 offset:30720
  v_mfma_f32_16x16x32_bf16 v[56:59], a[48:51], a[0:3], v[56:59]
  ds_read_b64_tr_b16 a[74:75], v20 offset:32768
  v_mfma_f32_16x16x32_bf16 v[64:67], a[48:51], a[4:7], v[64:67]
  buffer_load_dwordx4 v13, s[20:23], s31 offen offset:2048 lds
  ds_read_b64_tr_b16 a[76:77], v21 offset:30720
  v_mfma_f32_16x16x32_bf16 v[72:75], a[48:51], a[8:11], v[72:75]
  s_add_u32 s31, s31, 393216
  s_cmp_ge_u32 s31, 6291456
  s_cselect_b32 s29, 6291456, 0
  v_mfma_f32_16x16x32_bf16 v[80:83], a[48:51], a[12:15], v[80:83]
  s_sub_u32 s31, s31, s29
  s_add_u32 s60, s63, 12288
  ds_read_b64_tr_b16 a[78:79], v21 offset:32768
  v_mfma_f32_16x16x32_bf16 v[60:63], a[52:55], a[0:3], v[60:63]
  buffer_store_dwordx4 v[148:151], v2, s[16:19], s60 offen offset:1024 sc1
  ds_read_b64_tr_b16 a[80:81], v20 offset:38912
  v_mfma_f32_16x16x32_bf16 v[68:71], a[52:55], a[4:7], v[68:71]
  ds_read_b64_tr_b16 a[82:83], v20 offset:40960
  ds_read_b128 a[36:39], v19 offset:0
  v_mfma_f32_16x16x32_bf16 v[76:79], a[52:55], a[8:11], v[76:79]
  ds_read_b64_tr_b16 a[84:85], v21 offset:38912
  v_mfma_f32_16x16x32_bf16 v[84:87], a[52:55], a[12:15], v[84:87]
  buffer_store_dwordx4 v[152:155], v2, s[16:19], s60 offen offset:2048 sc1
  ds_read_b64_tr_b16 a[86:87], v21 offset:40960
  v_mfma_f32_16x16x32_bf16 v[88:91], a[0:3], a[56:59], v[88:91]
  s_add_u32 s88, s88, s90
  s_add_u32 s89, s89, 1
  s_cmp_eq_u32 s89, 3
  s_cselect_b32 s89, 0, s89
  s_cselect_b32 s90, s91, s92
  v_mfma_f32_16x16x32_bf16 v[96:99], a[4:7], a[56:59], v[96:99]
  v_add_u32 v16, s90, v16
  v_add_u32 v17, s90, v17
  v_mfma_f32_16x16x32_bf16 v[104:107], a[8:11], a[56:59], v[104:107]
  v_add_u32 v18, s90, v18
  v_add_u32 v19, s90, v19
  v_mfma_f32_16x16x32_bf16 v[112:115], a[12:15], a[56:59], v[112:115]
  v_add_u32 v20, s90, v20
  v_add_u32 v21, s90, v21
  v_mfma_f32_16x16x32_bf16 v[120:123], a[16:19], a[56:59], v[120:123]
  v_mfma_f32_16x16x32_bf16 v[92:95], a[0:3], a[60:63], v[92:95]
  v_mfma_f32_16x16x32_bf16 v[100:103], a[4:7], a[60:63], v[100:103]
  v_mfma_f32_16x16x32_bf16 v[108:111], a[8:11], a[60:63], v[108:111]
  v_mfma_f32_16x16x32_bf16 v[116:119], a[12:15], a[60:63], v[116:119]
  v_mfma_f32_16x16x32_bf16 v[124:127], a[16:19], a[60:63], v[124:127]
  s_waitcnt vmcnt(14) lgkmcnt(0)
  s_barrier
  v_mfma_f32_16x16x32_bf16 v[24:27], a[64:67], a[20:23], v[24:27]
  s_mov_b32 m0, s88
  ds_read_b128 a[0:3], v16 offset:0
  ds_read_b64_tr_b16 a[40:41], v20 offset:18432
  v_mfma_f32_16x16x32_bf16 v[32:35], a[64:67], a[24:27], v[32:35]
  buffer_load_dwordx4 v4, s[8:11], s30 offen offset:0 lds
  ds_read_b64_tr_b16 a[42:43], v20 offset:20480
  v_mfma_f32_16x16x32_bf16 v[40:43], a[64:67], a[28:31], v[40:43]
  ds_read_b128 a[4:7], v16 offset:2048
  v_mfma_f32_16x16x32_bf16 v[48:51], a[64:67], a[32:35], v[48:51]
  ds_read_b128 a[8:11], v16 offset:4096
  v_mfma_f32_16x16x32_bf16 v[28:31], a[68:71], a[20:23], v[28:31]
  buffer_load_dwordx4 v5, s[8:11], s30 offen offset:1024 lds
  ds_read_b128 a[12:15], v16 offset:6144
  v_mfma_f32_16x16x32_bf16 v[36:39], a[68:71], a[24:27], v[36:39]
  ds_read_b64_tr_b16 a[44:45], v21 offset:18432
  v_mfma_f32_16x16x32_bf16 v[44:47], a[68:71], a[28:31], v[44:47]
  ds_read_b64_tr_b16 a[46:47], v21 offset:20480
  v_mfma_f32_16x16x32_bf16 v[52:55], a[68:71], a[32:35], v[52:55]
  ds_read_b64_tr_b16 a[48:49], v20 offset:26624
  v_mfma_f32_16x16x32_bf16 v[56:59], a[72:75], a[20:23], v[56:59]
  buffer_load_dwordx4 v6, s[8:11], s30 offen offset:2048 lds
  ds_read_b64_tr_b16 a[50:51], v20 offset:28672
  v_mfma_f32_16x16x32_bf16 v[64:67], a[72:75], a[24:27], v[64:67]
  ds_read_b64_tr_b16 a[52:53], v21 offset:26624
  v_mfma_f32_16x16x32_bf16 v[72:75], a[72:75], a[28:31], v[72:75]
  ds_read_b64_tr_b16 a[54:55], v21 offset:28672
  v_mfma_f32_16x16x32_bf16 v[80:83], a[72:75], a[32:35], v[80:83]
  ds_read_b64_tr_b16 a[56:57], v20 offset:34816
  v_mfma_f32_16x16x32_bf16 v[60:63], a[76:79], a[20:23], v[60:63]
  buffer_load_dwordx4 v7, s[8:11], s30 offen offset:3072 lds
  ds_read_b64_tr_b16 a[58:59], v20 offset:36864
  v_mfma_f32_16x16x32_bf16 v[68:71], a[76:79], a[24:27], v[68:71]
  s_add_u32 s30, s30, 128
  s_and_b32 s30, s30, 2047
  s_add_u32 m0, s88, s26
  v_mfma_f32_16x16x32_bf16 v[76:79], a[76:79], a[28:31], v[76:79]
  ds_read_b128 a[16:19], v18 offset:0
  ds_read_b64_tr_b16 a[60:61], v21 offset:34816
  v_mfma_f32_16x16x32_bf16 v[84:87], a[76:79], a[32:35], v[84:87]
  ds_read_b64_tr_b16 a[62:63], v21 offset:36864
  v_mfma_f32_16x16x32_bf16 v[88:91], a[20:23], a[80:83], v[88:91]
  buffer_load_dwordx4 v8, s[20:23], s31 offen offset:0 lds
  v_mfma_f32_16x16x32_bf16 v[96:99], a[24:27], a[80:83], v[96:99]
  v_mfma_f32_16x16x32_bf16 v[104:107], a[28:31], a[80:83], v[104:107]
  v_mfma_f32_16x16x32_bf16 v[112:115], a[32:35], a[80:83], v[112:115]
  v_mfma_f32_16x16x32_bf16 v[120:123], a[36:39], a[80:83], v[120:123]
  buffer_load_dwordx4 v9, s[20:23], s31 offen offset:1024 lds
  v_mfma_f32_16x16x32_bf16 v[92:95], a[20:23], a[84:87], v[92:95]
  v_mfma_f32_16x16x32_bf16 v[100:103], a[24:27], a[84:87], v[100:103]
  v_mfma_f32_16x16x32_bf16 v[108:111], a[28:31], a[84:87], v[108:111]
  v_mfma_f32_16x16x32_bf16 v[116:119], a[32:35], a[84:87], v[116:119]
  v_mfma_f32_16x16x32_bf16 v[124:127], a[36:39], a[84:87], v[124:127]
  s_waitcnt lgkmcnt(0)
  v_mfma_f32_16x16x32_bf16 v[24:27], a[40:43], a[0:3], v[24:27]
  buffer_load_dwordx4 v10, s[20:23], s31 offen offset:2048 lds
  ds_read_b128 a[20:23], v17 offset:0
  v_mfma_f32_16x16x32_bf16 v[32:35], a[40:43], a[4:7], v[32:35]
  s_add_u32 m0, s88, s27
  ds_read_b64_tr_b16 a[64:65], v20 offset:22528
  ds_read_b64_tr_b16 a[66:67], v20 offset:24576
  v_mfma_f32_16x16x32_bf16 v[40:43], a[40:43], a[8:11], v[40:43]
  ds_read_b128 a[24:27], v17 offset:2048
  v_mfma_f32_16x16x32_bf16 v[48:51], a[40:43], a[12:15], v[48:51]
  buffer_load_dwordx4 v11, s[20:23], s31 offen offset:0 lds
  ds_read_b128 a[28:31], v17 offset:4096
  v_mfma_f32_16x16x32_bf16 v[28:31], a[44:47], a[0:3], v[28:31]
  ds_read_b128 a[32:35], v17 offset:6144
  v_mfma_f32_16x16x32_bf16 v[36:39], a[44:47], a[4:7], v[36:39]
  ds_read_b64_tr_b16 a[68:69], v21 offset:22528
  v_mfma_f32_16x16x32_bf16 v[44:47], a[44:47], a[8:11], v[44:47]
  ds_read_b64_tr_b16 a[70:71], v21 offset:24576
  v_mfma_f32_16x16x32_bf16 v[52:55], a[44:47], a[12:15], v[52:55]
  buffer_load_dwordx4 v12, s[20:23], s31 offen offset:1024 lds
  ds_read_b64_tr_b16 a[72:73], v20 offset:30720
  v_mfma_f32_16x16x32_bf16 v[56:59], a[48:51], a[0:3], v[56:59]
  ds_read_b64_tr_b16 a[74:75], v20 offset:32768
  v_mfma_f32_16x16x32_bf16 v[64:67], a[48:51], a[4:7], v[64:67]
  ds_read_b64_tr_b16 a[76:77], v21 offset:30720
  v_mfma_f32_16x16x32_bf16 v[72:75], a[48:51], a[8:11], v[72:75]
  ds_read_b64_tr_b16 a[78:79], v21 offset:32768
  v_mfma_f32_16x16x32_bf16 v[80:83], a[48:51], a[12:15], v[80:83]
  buffer_load_dwordx4 v13, s[20:23], s31 offen offset:2048 lds
  ds_read_b64_tr_b16 a[80:81], v20 offset:38912
  v_mfma_f32_16x16x32_bf16 v[60:63], a[52:55], a[0:3], v[60:63]
  s_add_u32 s31, s31, 393216
  s_cmp_ge_u32 s31, 6291456
  s_cselect_b32 s29, 6291456, 0
  v_mfma_f32_16x16x32_bf16 v[68:71], a[52:55], a[4:7], v[68:71]
  s_sub_u32 s31, s31, s29
  s_add_u32 s60, s63, 12288
  ds_read_b64_tr_b16 a[82:83], v20 offset:40960
  v_mfma_f32_16x16x32_bf16 v[76:79], a[52:55], a[8:11], v[76:79]
  ds_read_b128 a[36:39], v19 offset:0
  ds_read_b64_tr_b16 a[84:85], v21 offset:38912
  v_mfma_f32_16x16x32_bf16 v[84:87], a[52:55], a[12:15], v[84:87]
  buffer_store_dwordx4 v[156:159], v2, s[16:19], s60 offen offset:3072 sc1
  ds_read_b64_tr_b16 a[86:87], v21 offset:40960
  v_mfma_f32_16x16x32_bf16 v[88:91], a[0:3], a[56:59], v[88:91]
  s_add_u32 s88, s88, s90
  s_add_u32 s89, s89, 1
  s_cmp_eq_u32 s89, 3
  s_cselect_b32 s89, 0, s89
  s_cselect_b32 s90, s91, s92
  v_mfma_f32_16x16x32_bf16 v[96:99], a[4:7], a[56:59], v[96:99]
  v_add_u32 v16, s90, v16
  v_add_u32 v17, s90, v17
  v_mfma_f32_16x16x32_bf16 v[104:107], a[8:11], a[56:59], v[104:107]
  v_add_u32 v18, s90, v18
  v_add_u32 v19, s90, v19
  v_mfma_f32_16x16x32_bf16 v[112:115], a[12:15], a[56:59], v[112:115]
  v_add_u32 v20, s90, v20
  v_add_u32 v21, s90, v21
  v_mfma_f32_16x16x32_bf16 v[120:123], a[16:19], a[56:59], v[120:123]
  v_mfma_f32_16x16x32_bf16 v[92:95], a[0:3], a[60:63], v[92:95]
  v_mfma_f32_16x16x32_bf16 v[100:103], a[4:7], a[60:63], v[100:103]
  v_mfma_f32_16x16x32_bf16 v[108:111], a[8:11], a[60:63], v[108:111]
  v_mfma_f32_16x16x32_bf16 v[116:119], a[12:15], a[60:63], v[116:119]
  v_mfma_f32_16x16x32_bf16 v[124:127], a[16:19], a[60:63], v[124:127]
  s_waitcnt vmcnt(13) lgkmcnt(0)
  s_barrier
  v_mfma_f32_16x16x32_bf16 v[24:27], a[64:67], a[20:23], v[24:27]
  s_mov_b32 m0, s88
  ds_read_b128 a[0:3], v16 offset:0
  ds_read_b64_tr_b16 a[40:41], v20 offset:18432
  v_mfma_f32_16x16x32_bf16 v[32:35], a[64:67], a[24:27], v[32:35]
  buffer_load_dwordx4 v4, s[8:11], s30 offen offset:0 lds
  ds_read_b64_tr_b16 a[42:43], v20 offset:20480
  v_mfma_f32_16x16x32_bf16 v[40:43], a[64:67], a[28:31], v[40:43]
  ds_read_b128 a[4:7], v16 offset:2048
  v_mfma_f32_16x16x32_bf16 v[48:51], a[64:67], a[32:35], v[48:51]
  ds_read_b128 a[8:11], v16 offset:4096
  v_mfma_f32_16x16x32_bf16 v[28:31], a[68:71], a[20:23], v[28:31]
  buffer_load_dwordx4 v5, s[8:11], s30 offen offset:1024 lds
  ds_read_b128 a[12:15], v16 offset:6144
  v_mfma_f32_16x16x32_bf16 v[36:39], a[68:71], a[24:27], v[36:39]
  ds_read_b64_tr_b16 a[44:45], v21 offset:18432
  v_mfma_f32_16x16x32_bf16 v[44:47], a[68:71], a[28:31], v[44:47]
  ds_read_b64_tr_b16 a[46:47], v21 offset:20480
  v_mfma_f32_16x16x32_bf16 v[52:55], a[68:71], a[32:35], v[52:55]
  ds_read_b64_tr_b16 a[48:49], v20 offset:26624
  v_mfma_f32_16x16x32_bf16 v[56:59], a[72:75], a[20:23], v[56:59]
  buffer_load_dwordx4 v6, s[8:11], s30 offen offset:2048 lds
  ds_read_b64_tr_b16 a[50:51], v20 offset:28672
  v_mfma_f32_16x16x32_bf16 v[64:67], a[72:75], a[24:27], v[64:67]
  ds_read_b64_tr_b16 a[52:53], v21 offset:26624
  v_mfma_f32_16x16x32_bf16 v[72:75], a[72:75], a[28:31], v[72:75]
  ds_read_b64_tr_b16 a[54:55], v21 offset:28672
  v_mfma_f32_16x16x32_bf16 v[80:83], a[72:75], a[32:35], v[80:83]
  ds_read_b64_tr_b16 a[56:57], v20 offset:34816
  v_mfma_f32_16x16x32_bf16 v[60:63], a[76:79], a[20:23], v[60:63]
  buffer_load_dwordx4 v7, s[8:11], s30 offen offset:3072 lds
  ds_read_b64_tr_b16 a[58:59], v20 offset:36864
  v_mfma_f32_16x16x32_bf16 v[68:71], a[76:79], a[24:27], v[68:71]
  s_add_u32 s30, s30, 128
  s_and_b32 s30, s30, 2047
  s_add_u32 m0, s88, s26
  v_mfma_f32_16x16x32_bf16 v[76:79], a[76:79], a[28:31], v[76:79]
  ds_read_b128 a[16:19], v18 offset:0
  ds_read_b64_tr_b16 a[60:61], v21 offset:34816
  v_mfma_f32_16x16x32_bf16 v[84:87], a[76:79], a[32:35], v[84:87]
  ds_read_b64_tr_b16 a[62:63], v21 offset:36864
  v_mfma_f32_16x16x32_bf16 v[88:91], a[20:23], a[80:83], v[88:91]
  buffer_load_dwordx4 v8, s[20:23], s31 offen offset:0 lds
  v_mfma_f32_16x16x32_bf16 v[96:99], a[24:27], a[80:83], v[96:99]
  v_mfma_f32_16x16x32_bf16 v[104:107], a[28:31], a[80:83], v[104:107]
  v_mfma_f32_16x16x32_bf16 v[112:115], a[32:35], a[80:83], v[112:115]
  v_mfma_f32_16x16x32_bf16 v[120:123], a[36:39], a[80:83], v[120:123]
  buffer_load_dwordx4 v9, s[20:23], s31 offen offset:1024 lds
  v_mfma_f32_16x16x32_bf16 v[92:95], a[20:23], a[84:87], v[92:95]
  v_mfma_f32_16x16x32_bf16 v[100:103], a[24:27], a[84:87], v[100:103]
  v_mfma_f32_16x16x32_bf16 v[108:111], a[28:31], a[84:87], v[108:111]
  v_mfma_f32_16x16x32_bf16 v[116:119], a[32:35], a[84:87], v[116:119]
  v_mfma_f32_16x16x32_bf16 v[124:127], a[36:39], a[84:87], v[124:127]
  s_waitcnt lgkmcnt(0)
  v_mfma_f32_16x16x32_bf16 v[24:27], a[40:43], a[0:3], v[24:27]
  buffer_load_dwordx4 v10, s[20:23], s31 offen offset:2048 lds
  ds_read_b128 a[20:23], v17 offset:0
  v_mfma_f32_16x16x32_bf16 v[32:35], a[40:43], a[4:7], v[32:35]
  s_add_u32 m0, s88, s27
  ds_read_b64_tr_b16 a[64:65], v20 offset:22528
  ds_read_b64_tr_b16 a[66:67], v20 offset:24576
  v_mfma_f32_16x16x32_bf16 v[40:43], a[40:43], a[8:11], v[40:43]
  ds_read_b128 a[24:27], v17 offset:2048
  v_mfma_f32_16x16x32_bf16 v[48:51], a[40:43], a[12:15], v[48:51]
  buffer_load_dwordx4 v11, s[20:23], s31 offen offset:0 lds
  ds_read_b128 a[28:31], v17 offset:4096
  v_mfma_f32_16x16x32_bf16 v[28:31], a[44:47], a[0:3], v[28:31]
  ds_read_b128 a[32:35], v17 offset:6144
  v_mfma_f32_16x16x32_bf16 v[36:39], a[44:47], a[4:7], v[36:39]
  ds_read_b64_tr_b16 a[68:69], v21 offset:22528
  v_mfma_f32_16x16x32_bf16 v[44:47], a[44:47], a[8:11], v[44:47]
  buffer_load_dwordx4 v12, s[20:23], s31 offen offset:1024 lds
  ds_read_b64_tr_b16 a[70:71], v21 offset:24576
  v_mfma_f32_16x16x32_bf16 v[52:55], a[44:47], a[12:15], v[52:55]
  ds_read_b64_tr_b16 a[72:73], v20 offset:30720
  v_mfma_f32_16x16x32_bf16 v[56:59], a[48:51], a[0:3], v[56:59]
  ds_read_b64_tr_b16 a[74:75], v20 offset:32768
  v_mfma_f32_16x16x32_bf16 v[64:67], a[48:51], a[4:7], v[64:67]
  buffer_load_dwordx4 v13, s[20:23], s31 offen offset:2048 lds
  ds_read_b64_tr_b16 a[76:77], v21 offset:30720
  v_mfma_f32_16x16x32_bf16 v[72:75], a[48:51], a[8:11], v[72:75]
  s_add_u32 s31, s31, 393216
  s_cmp_ge_u32 s31, 6291456
  s_cselect_b32 s29, 6291456, 0
  v_mfma_f32_16x16x32_bf16 v[80:83], a[48:51], a[12:15], v[80:83]
  s_sub_u32 s31, s31, s29
  s_add_u32 s60, s63, 32768
  ds_read_b64_tr_b16 a[78:79], v21 offset:32768
  v_mfma_f32_16x16x32_bf16 v[60:63], a[52:55], a[0:3], v[60:63]
  buffer_store_dwordx4 v[192:195], v2, s[16:19], s60 offen offset:0 sc1
  ds_read_b64_tr_b16 a[80:81], v20 offset:38912
  v_mfma_f32_16x16x32_bf16 v[68:71], a[52:55], a[4:7], v[68:71]
  ds_read_b64_tr_b16 a[82:83], v20 offset:40960
  ds_read_b128 a[36:39], v19 offset:0
  v_mfma_f32_16x16x32_bf16 v[76:79], a[52:55], a[8:11], v[76:79]
  ds_read_b64_tr_b16 a[84:85], v21 offset:38912
  v_mfma_f32_16x16x32_bf16 v[84:87], a[52:55], a[12:15], v[84:87]
  buffer_store_dwordx4 v[196:199], v2, s[16:19], s60 offen offset:1024 sc1
  ds_read_b64_tr_b16 a[86:87], v21 offset:40960
  v_mfma_f32_16x16x32_bf16 v[88:91], a[0:3], a[56:59], v[88:91]
  s_add_u32 s88, s88, s90
  s_add_u32 s89, s89, 1
  s_cmp_eq_u32 s89, 3
  s_cselect_b32 s89, 0, s89
  s_cselect_b32 s90, s91, s92
  v_mfma_f32_16x16x32_bf16 v[96:99], a[4:7], a[56:59], v[96:99]
  v_add_u32 v16, s90, v16
  v_add_u32 v17, s90, v17
  v_mfma_f32_16x16x32_bf16 v[104:107], a[8:11], a[56:59], v[104:107]
  v_add_u32 v18, s90, v18
  v_add_u32 v19, s90, v19
  v_mfma_f32_16x16x32_bf16 v[112:115], a[12:15], a[56:59], v[112:115]
  v_add_u32 v20, s90, v20
  v_add_u32 v21, s90, v21
  v_mfma_f32_16x16x32_bf16 v[120:123], a[16:19], a[56:59], v[120:123]
  v_mfma_f32_16x16x32_bf16 v[92:95], a[0:3], a[60:63], v[92:95]
  v_mfma_f32_16x16x32_bf16 v[100:103], a[4:7], a[60:63], v[100:103]
  v_mfma_f32_16x16x32_bf16 v[108:111], a[8:11], a[60:63], v[108:111]
  v_mfma_f32_16x16x32_bf16 v[116:119], a[12:15], a[60:63], v[116:119]
  v_mfma_f32_16x16x32_bf16 v[124:127], a[16:19], a[60:63], v[124:127]
  s_waitcnt vmcnt(13) lgkmcnt(0)
  s_barrier
  v_mfma_f32_16x16x32_bf16 v[24:27], a[64:67], a[20:23], v[24:27]
  s_mov_b32 m0, s88
  ds_read_b128 a[0:3], v16 offset:0
  ds_read_b64_tr_b16 a[40:41], v20 offset:18432
  v_mfma_f32_16x16x32_bf16 v[32:35], a[64:67], a[24:27], v[32:35]
  buffer_load_dwordx4 v4, s[8:11], s30 offen offset:0 lds
  ds_read_b64_tr_b16 a[42:43], v20 offset:20480
  v_mfma_f32_16x16x32_bf16 v[40:43], a[64:67], a[28:31], v[40:43]
  ds_read_b128 a[4:7], v16 offset:2048
  v_mfma_f32_16x16x32_bf16 v[48:51], a[64:67], a[32:35], v[48:51]
  ds_read_b128 a[8:11], v16 offset:4096
  v_mfma_f32_16x16x32_bf16 v[28:31], a[68:71], a[20:23], v[28:31]
  buffer_load_dwordx4 v5, s[8:11], s30 offen offset:1024 lds
  ds_read_b128 a[12:15], v16 offset:6144
  v_mfma_f32_16x16x32_bf16 v[36:39], a[68:71], a[24:27], v[36:39]
  ds_read_b64_tr_b16 a[44:45], v21 offset:18432
  v_mfma_f32_16x16x32_bf16 v[44:47], a[68:71], a[28:31], v[44:47]
  ds_read_b64_tr_b16 a[46:47], v21 offset:20480
  v_mfma_f32_16x16x32_bf16 v[52:55], a[68:71], a[32:35], v[52:55]
  ds_read_b64_tr_b16 a[48:49], v20 offset:26624
  v_mfma_f32_16x16x32_bf16 v[56:59], a[72:75], a[20:23], v[56:59]
  buffer_load_dwordx4 v6, s[8:11], s30 offen offset:2048 lds
  ds_read_b64_tr_b16 a[50:51], v20 offset:28672
  v_mfma_f32_16x16x32_bf16 v[64:67], a[72:75], a[24:27], v[64:67]
  ds_read_b64_tr_b16 a[52:53], v21 offset:26624
  v_mfma_f32_16x16x32_bf16 v[72:75], a[72:75], a[28:31], v[72:75]
  ds_read_b64_tr_b16 a[54:55], v21 offset:28672
  v_mfma_f32_16x16x32_bf16 v[80:83], a[72:75], a[32:35], v[80:83]
  ds_read_b64_tr_b16 a[56:57], v20 offset:34816
  v_mfma_f32_16x16x32_bf16 v[60:63], a[76:79], a[20:23], v[60:63]
  buffer_load_dwordx4 v7, s[8:11], s30 offen offset:3072 lds
  ds_read_b64_tr_b16 a[58:59], v20 offset:36864
  v_mfma_f32_16x16x32_bf16 v[68:71], a[76:79], a[24:27], v[68:71]
  s_add_u32 s30, s30, 128
  s_and_b32 s30, s30, 2047
  s_add_u32 m0, s88, s26
  v_mfma_f32_16x16x32_bf16 v[76:79], a[76:79], a[28:31], v[76:79]
  ds_read_b128 a[16:19], v18 offset:0
  ds_read_b64_tr_b16 a[60:61], v21 offset:34816
  v_mfma_f32_16x16x32_bf16 v[84:87], a[76:79], a[32:35], v[84:87]
  ds_read_b64_tr_b16 a[62:63], v21 offset:36864
  v_mfma_f32_16x16x32_bf16 v[88:91], a[20:23], a[80:83], v[88:91]
  buffer_load_dwordx4 v8, s[20:23], s31 offen offset:0 lds
  v_mfma_f32_16x16x32_bf16 v[96:99], a[24:27], a[80:83], v[96:99]
  v_mfma_f32_16x16x32_bf16 v[104:107], a[28:31], a[80:83], v[104:107]
  v_mfma_f32_16x16x32_bf16 v[112:115], a[32:35], a[80:83], v[112:115]
  v_mfma_f32_16x16x32_bf16 v[120:123], a[36:39], a[80:83], v[120:123]
  buffer_load_dwordx4 v9, s[20:23], s31 offen offset:1024 lds
  v_mfma_f32_16x16x32_bf16 v[92:95], a[20:23], a[84:87], v[92:95]
  v_mfma_f32_16x16x32_bf16 v[100:103], a[24:27], a[84:87], v[100:103]
  v_mfma_f32_16x16x32_bf16 v[108:111], a[28:31], a[84:87], v[108:111]
  v_mfma_f32_16x16x32_bf16 v[116:119], a[32:35], a[84:87], v[116:119]
  v_mfma_f32_16x16x32_bf16 v[124:127], a[36:39], a[84:87], v[124:127]
  s_waitcnt lgkmcnt(0)
  v_mfma_f32_16x16x32_bf16 v[24:27], a[40:43], a[0:3], v[24:27]
  buffer_load_dwordx4 v10, s[20:23], s31 offen offset:2048 lds
  ds_read_b128 a[20:23], v17 offset:0
  v_mfma_f32_16x16x32_bf16 v[32:35], a[40:43], a[4:7], v[32:35]
  s_add_u32 m0, s88, s27
  ds_read_b64_tr_b16 a[64:65], v20 offset:22528
  ds_read_b64_tr_b16 a[66:67], v20 offset:24576
  v_mfma_f32_16x16x32_bf16 v[40:43], a[40:43], a[8:11], v[40:43]
  ds_read_b128 a[24:27], v17 offset:2048
  v_mfma_f32_16x16x32_bf16 v[48:51], a[40:43], a[12:15], v[48:51]
  buffer_load_dwordx4 v11, s[20:23], s31 offen offset:0 lds
  ds_read_b128 a[28:31], v17 offset:4096
  v_mfma_f32_16x16x32_bf16 v[28:31], a[44:47], a[0:3], v[28:31]
  ds_read_b128 a[32:35], v17 offset:6144
  v_mfma_f32_16x16x32_bf16 v[36:39], a[44:47], a[4:7], v[36:39]
  ds_read_b64_tr_b16 a[68:69], v21 offset:22528
  v_mfma_f32_16x16x32_bf16 v[44:47], a[44:47], a[8:11], v[44:47]
  ds_read_b64_tr_b16 a[70:71], v21 offset:24576
  v_mfma_f32_16x16x32_bf16 v[52:55], a[44:47], a[12:15], v[52:55]
  buffer_load_dwordx4 v12, s[20:23], s31 offen offset:1024 lds
  ds_read_b64_tr_b16 a[72:73], v20 offset:30720
  v_mfma_f32_16x16x32_bf16 v[56:59], a[48:51], a[0:3], v[56:59]
  ds_read_b64_tr_b16 a[74:75], v20 offset:32768
  v_mfma_f32_16x16x32_bf16 v[64:67], a[48:51], a[4:7], v[64:67]
  ds_read_b64_tr_b16 a[76:77], v21 offset:30720
  v_mfma_f32_16x16x32_bf16 v[72:75], a[48:51], a[8:11], v[72:75]
  ds_read_b64_tr_b16 a[78:79], v21 offset:32768
  v_mfma_f32_16x16x32_bf16 v[80:83], a[48:51], a[12:15], v[80:83]
  buffer_load_dwordx4 v13, s[20:23], s31 offen offset:2048 lds
  ds_read_b64_tr_b16 a[80:81], v20 offset:38912
  v_mfma_f32_16x16x32_bf16 v[60:63], a[52:55], a[0:3], v[60:63]
  s_add_u32 s31, s31, 393216
  s_cmp_ge_u32 s31, 6291456
  s_cselect_b32 s29, 6291456, 0
  v_mfma_f32_16x16x32_bf16 v[68:71], a[52:55], a[4:7], v[68:71]
  s_sub_u32 s31, s31, s29
  s_add_u32 s60, s63, 32768
  ds_read_b64_tr_b16 a[82:83], v20 offset:40960
  v_mfma_f32_16x16x32_bf16 v[76:79], a[52:55], a[8:11], v[76:79]
  ds_read_b128 a[36:39], v19 offset:0
  ds_read_b64_tr_b16 a[84:85], v21 offset:38912
  v_mfma_f32_16x16x32_bf16 v[84:87], a[52:55], a[12:15], v[84:87]
  buffer_store_dwordx4 v[200:203], v2, s[16:19], s60 offen offset:2048 sc1
  ds_read_b64_tr_b16 a[86:87], v21 offset:40960
  v_mfma_f32_16x16x32_bf16 v[88:91], a[0:3], a[56:59], v[88:91]
  s_add_u32 s88, s88, s90
  s_add_u32 s89, s89, 1
  s_cmp_eq_u32 s89, 3
  s_cselect_b32 s89, 0, s89
  s_cselect_b32 s90, s91, s92
  v_mfma_f32_16x16x32_bf16 v[96:99], a[4:7], a[56:59], v[96:99]
  v_add_u32 v16, s90, v16
  v_add_u32 v17, s90, v17
  v_mfma_f32_16x16x32_bf16 v[104:107], a[8:11], a[56:59], v[104:107]
  v_add_u32 v18, s90, v18
  v_add_u32 v19, s90, v19
  v_mfma_f32_16x16x32_bf16 v[112:115], a[12:15], a[56:59], v[112:115]
  v_add_u32 v20, s90, v20
  v_add_u32 v21, s90, v21
  v_mfma_f32_16x16x32_bf16 v[120:123], a[16:19], a[56:59], v[120:123]
  v_mfma_f32_16x16x32_bf16 v[92:95], a[0:3], a[60:63], v[92:95]
  v_mfma_f32_16x16x32_bf16 v[100:103], a[4:7], a[60:63], v[100:103]
  v_mfma_f32_16x16x32_bf16 v[108:111], a[8:11], a[60:63], v[108:111]
  v_mfma_f32_16x16x32_bf16 v[116:119], a[12:15], a[60:63], v[116:119]
  v_mfma_f32_16x16x32_bf16 v[124:127], a[16:19], a[60:63], v[124:127]
  s_waitcnt vmcnt(13) lgkmcnt(0)
  s_barrier
  v_mfma_f32_16x16x32_bf16 v[24:27], a[64:67], a[20:23], v[24:27]
  s_mov_b32 m0, s88
  ds_read_b128 a[0:3], v16 offset:0
  ds_read_b64_tr_b16 a[40:41], v20 offset:18432
  v_mfma_f32_16x16x32_bf16 v[32:35], a[64:67], a[24:27], v[32:35]
  buffer_load_dwordx4 v4, s[8:11], s30 offen offset:0 lds
  ds_read_b64_tr_b16 a[42:43], v20 offset:20480
  v_mfma_f32_16x16x32_bf16 v[40:43], a[64:67], a[28:31], v[40:43]
  ds_read_b128 a[4:7], v16 offset:2048
  v_mfma_f32_16x16x32_bf16 v[48:51], a[64:67], a[32:35], v[48:51]
  ds_read_b128 a[8:11], v16 offset:4096
  v_mfma_f32_16x16x32_bf16 v[28:31], a[68:71], a[20:23], v[28:31]
  buffer_load_dwordx4 v5, s[8:11], s30 offen offset:1024 lds
  ds_read_b128 a[12:15], v16 offset:6144
  v_mfma_f32_16x16x32_bf16 v[36:39], a[68:71], a[24:27], v[36:39]
  ds_read_b64_tr_b16 a[44:45], v21 offset:18432
  v_mfma_f32_16x16x32_bf16 v[44:47], a[68:71], a[28:31], v[44:47]
  ds_read_b64_tr_b16 a[46:47], v21 offset:20480
  v_mfma_f32_16x16x32_bf16 v[52:55], a[68:71], a[32:35], v[52:55]
  ds_read_b64_tr_b16 a[48:49], v20 offset:26624
  v_mfma_f32_16x16x32_bf16 v[56:59], a[72:75], a[20:23], v[56:59]
  buffer_load_dwordx4 v6, s[8:11], s30 offen offset:2048 lds
  ds_read_b64_tr_b16 a[50:51], v20 offset:28672
  v_mfma_f32_16x16x32_bf16 v[64:67], a[72:75], a[24:27], v[64:67]
  ds_read_b64_tr_b16 a[52:53], v21 offset:26624
  v_mfma_f32_16x16x32_bf16 v[72:75], a[72:75], a[28:31], v[72:75]
  ds_read_b64_tr_b16 a[54:55], v21 offset:28672
  v_mfma_f32_16x16x32_bf16 v[80:83], a[72:75], a[32:35], v[80:83]
  ds_read_b64_tr_b16 a[56:57], v20 offset:34816
  v_mfma_f32_16x16x32_bf16 v[60:63], a[76:79], a[20:23], v[60:63]
  buffer_load_dwordx4 v7, s[8:11], s30 offen offset:3072 lds
  ds_read_b64_tr_b16 a[58:59], v20 offset:36864
  v_mfma_f32_16x16x32_bf16 v[68:71], a[76:79], a[24:27], v[68:71]
  s_add_u32 s30, s30, 128
  s_and_b32 s30, s30, 2047
  s_add_u32 m0, s88, s26
  v_mfma_f32_16x16x32_bf16 v[76:79], a[76:79], a[28:31], v[76:79]
  ds_read_b128 a[16:19], v18 offset:0
  ds_read_b64_tr_b16 a[60:61], v21 offset:34816
  v_mfma_f32_16x16x32_bf16 v[84:87], a[76:79], a[32:35], v[84:87]
  ds_read_b64_tr_b16 a[62:63], v21 offset:36864
  v_mfma_f32_16x16x32_bf16 v[88:91], a[20:23], a[80:83], v[88:91]
  buffer_load_dwordx4 v8, s[20:23], s31 offen offset:0 lds
  v_mfma_f32_16x16x32_bf16 v[96:99], a[24:27], a[80:83], v[96:99]
  v_mfma_f32_16x16x32_bf16 v[104:107], a[28:31], a[80:83], v[104:107]
  v_mfma_f32_16x16x32_bf16 v[112:115], a[32:35], a[80:83], v[112:115]
  v_mfma_f32_16x16x32_bf16 v[120:123], a[36:39], a[80:83], v[120:123]
  buffer_load_dwordx4 v9, s[20:23], s31 offen offset:1024 lds
  v_mfma_f32_16x16x32_bf16 v[92:95], a[20:23], a[84:87], v[92:95]
  v_mfma_f32_16x16x32_bf16 v[100:103], a[24:27], a[84:87], v[100:103]
  v_mfma_f32_16x16x32_bf16 v[108:111], a[28:31], a[84:87], v[108:111]
  v_mfma_f32_16x16x32_bf16 v[116:119], a[32:35], a[84:87], v[116:119]
  v_mfma_f32_16x16x32_bf16 v[124:127], a[36:39], a[84:87], v[124:127]
  s_waitcnt lgkmcnt(0)
  v_mfma_f32_16x16x32_bf16 v[24:27], a[40:43], a[0:3], v[24:27]
  buffer_load_dwordx4 v10, s[20:23], s31 offen offset:2048 lds
  ds_read_b128 a[20:23], v17 offset:0
  v_mfma_f32_16x16x32_bf16 v[32:35], a[40:43], a[4:7], v[32:35]
  s_add_u32 m0, s88, s27
  ds_read_b64_tr_b16 a[64:65], v20 offset:22528
  ds_read_b64_tr_b16 a[66:67], v20 offset:24576
  v_mfma_f32_16x16x32_bf16 v[40:43], a[40:43], a[8:11], v[40:43]
  ds_read_b128 a[24:27], v17 offset:2048
  v_mfma_f32_16x16x32_bf16 v[48:51], a[40:43], a[12:15], v[48:51]
  buffer_load_dwordx4 v11, s[20:23], s31 offen offset:0 lds
  ds_read_b128 a[28:31], v17 offset:4096
  v_mfma_f32_16x16x32_bf16 v[28:31], a[44:47], a[0:3], v[28:31]
  ds_read_b128 a[32:35], v17 offset:6144
  v_mfma_f32_16x16x32_bf16 v[36:39], a[44:47], a[4:7], v[36:39]
  ds_read_b64_tr_b16 a[68:69], v21 offset:22528
  v_mfma_f32_16x16x32_bf16 v[44:47], a[44:47], a[8:11], v[44:47]
  buffer_load_dwordx4 v12, s[20:23], s31 offen offset:1024 lds
  ds_read_b64_tr_b16 a[70:71], v21 offset:24576
  v_mfma_f32_16x16x32_bf16 v[52:55], a[44:47], a[12:15], v[52:55]
  ds_read_b64_tr_b16 a[72:73], v20 offset:30720
  v_mfma_f32_16x16x32_bf16 v[56:59], a[48:51], a[0:3], v[56:59]
  ds_read_b64_tr_b16 a[74:75], v20 offset:32768
  v_mfma_f32_16x16x32_bf16 v[64:67], a[48:51], a[4:7], v[64:67]
  buffer_load_dwordx4 v13, s[20:23], s31 offen offset:2048 lds
  ds_read_b64_tr_b16 a[76:77], v21 offset:30720
  v_mfma_f32_16x16x32_bf16 v[72:75], a[48:51], a[8:11], v[72:75]
  s_add_u32 s31, s31, 393216
  s_cmp_ge_u32 s31, 6291456
  s_cselect_b32 s29, 6291456, 0
  v_mfma_f32_16x16x32_bf16 v[80:83], a[48:51], a[12:15], v[80:83]
  s_sub_u32 s31, s31, s29
  s_add_u32 s60, s63, 0
  ds_read_b64_tr_b16 a[78:79], v21 offset:32768
  v_mfma_f32_16x16x32_bf16 v[60:63], a[52:55], a[0:3], v[60:63]
  buffer_store_dwordx4 v[160:163], v2, s[16:19], s60 offen offset:0 sc1
  ds_read_b64_tr_b16 a[80:81], v20 offset:38912
  v_mfma_f32_16x16x32_bf16 v[68:71], a[52:55], a[4:7], v[68:71]
  ds_read_b64_tr_b16 a[82:83], v20 offset:40960
  ds_read_b128 a[36:39], v19 offset:0
  v_mfma_f32_16x16x32_bf16 v[76:79], a[52:55], a[8:11], v[76:79]
  ds_read_b64_tr_b16 a[84:85], v21 offset:38912
  v_mfma_f32_16x16x32_bf16 v[84:87], a[52:55], a[12:15], v[84:87]
  buffer_store_dwordx4 v[164:167], v2, s[16:19], s60 offen offset:1024 sc1
  ds_read_b64_tr_b16 a[86:87], v21 offset:40960
  v_mfma_f32_16x16x32_bf16 v[88:91], a[0:3], a[56:59], v[88:91]
  s_add_u32 s88, s88, s90
  s_add_u32 s89, s89, 1
  s_cmp_eq_u32 s89, 3
  s_cselect_b32 s89, 0, s89
  s_cselect_b32 s90, s91, s92
  v_mfma_f32_16x16x32_bf16 v[96:99], a[4:7], a[56:59], v[96:99]
  v_add_u32 v16, s90, v16
  v_add_u32 v17, s90, v17
  v_mfma_f32_16x16x32_bf16 v[104:107], a[8:11], a[56:59], v[104:107]
  v_add_u32 v18, s90, v18
  v_add_u32 v19, s90, v19
  v_mfma_f32_16x16x32_bf16 v[112:115], a[12:15], a[56:59], v[112:115]
  v_add_u32 v20, s90, v20
  v_add_u32 v21, s90, v21
  v_mfma_f32_16x16x32_bf16 v[120:123], a[16:19], a[56:59], v[120:123]
  v_mfma_f32_16x16x32_bf16 v[92:95], a[0:3], a[60:63], v[92:95]
  v_mfma_f32_16x16x32_bf16 v[100:103], a[4:7], a[60:63], v[100:103]
  v_mfma_f32_16x16x32_bf16 v[108:111], a[8:11], a[60:63], v[108:111]
  v_mfma_f32_16x16x32_bf16 v[116:119], a[12:15], a[60:63], v[116:119]
  v_mfma_f32_16x16x32_bf16 v[124:127], a[16:19], a[60:63], v[124:127]
  s_waitcnt vmcnt(13) lgkmcnt(0)
  s_barrier
  v_mfma_f32_16x16x32_bf16 v[24:27], a[64:67], a[20:23], v[24:27]
  s_mov_b32 m0, s88
  ds_read_b128 a[0:3], v16 offset:0
  ds_read_b64_tr_b16 a[40:41], v20 offset:18432
  v_mfma_f32_16x16x32_bf16 v[32:35], a[64:67], a[24:27], v[32:35]
  buffer_load_dwordx4 v4, s[8:11], s30 offen offset:0 lds
  ds_read_b64_tr_b16 a[42:43], v20 offset:20480
  v_mfma_f32_16x16x32_bf16 v[40:43], a[64:67], a[28:31], v[40:43]
  ds_read_b128 a[4:7], v16 offset:2048
  v_mfma_f32_16x16x32_bf16 v[48:51], a[64:67], a[32:35], v[48:51]
  ds_read_b128 a[8:11], v16 offset:4096
  v_mfma_f32_16x16x32_bf16 v[28:31], a[68:71], a[20:23], v[28:31]
  buffer_load_dwordx4 v5, s[8:11], s30 offen offset:1024 lds
  ds_read_b128 a[12:15], v16 offset:6144
  v_mfma_f32_16x16x32_bf16 v[36:39], a[68:71], a[24:27], v[36:39]
  ds_read_b64_tr_b16 a[44:45], v21 offset:18432
  v_mfma_f32_16x16x32_bf16 v[44:47], a[68:71], a[28:31], v[44:47]
  ds_read_b64_tr_b16 a[46:47], v21 offset:20480
  v_mfma_f32_16x16x32_bf16 v[52:55], a[68:71], a[32:35], v[52:55]
  ds_read_b64_tr_b16 a[48:49], v20 offset:26624
  v_mfma_f32_16x16x32_bf16 v[56:59], a[72:75], a[20:23], v[56:59]
  buffer_load_dwordx4 v6, s[8:11], s30 offen offset:2048 lds
  ds_read_b64_tr_b16 a[50:51], v20 offset:28672
  v_mfma_f32_16x16x32_bf16 v[64:67], a[72:75], a[24:27], v[64:67]
  ds_read_b64_tr_b16 a[52:53], v21 offset:26624
  v_mfma_f32_16x16x32_bf16 v[72:75], a[72:75], a[28:31], v[72:75]
  ds_read_b64_tr_b16 a[54:55], v21 offset:28672
  v_mfma_f32_16x16x32_bf16 v[80:83], a[72:75], a[32:35], v[80:83]
  ds_read_b64_tr_b16 a[56:57], v20 offset:34816
  v_mfma_f32_16x16x32_bf16 v[60:63], a[76:79], a[20:23], v[60:63]
  buffer_load_dwordx4 v7, s[8:11], s30 offen offset:3072 lds
  ds_read_b64_tr_b16 a[58:59], v20 offset:36864
  v_mfma_f32_16x16x32_bf16 v[68:71], a[76:79], a[24:27], v[68:71]
  s_add_u32 s30, s30, 128
  s_and_b32 s30, s30, 2047
  s_add_u32 m0, s88, s26
  v_mfma_f32_16x16x32_bf16 v[76:79], a[76:79], a[28:31], v[76:79]
  ds_read_b128 a[16:19], v18 offset:0
  ds_read_b64_tr_b16 a[60:61], v21 offset:34816
  v_mfma_f32_16x16x32_bf16 v[84:87], a[76:79], a[32:35], v[84:87]
  ds_read_b64_tr_b16 a[62:63], v21 offset:36864
  v_mfma_f32_16x16x32_bf16 v[88:91], a[20:23], a[80:83], v[88:91]
  buffer_load_dwordx4 v8, s[20:23], s31 offen offset:0 lds
  v_mfma_f32_16x16x32_bf16 v[96:99], a[24:27], a[80:83], v[96:99]
  v_mfma_f32_16x16x32_bf16 v[104:107], a[28:31], a[80:83], v[104:107]
  v_mfma_f32_16x16x32_bf16 v[112:115], a[32:35], a[80:83], v[112:115]
  v_mfma_f32_16x16x32_bf16 v[120:123], a[36:39], a[80:83], v[120:123]
  buffer_load_dwordx4 v9, s[20:23], s31 offen offset:1024 lds
  v_mfma_f32_16x16x32_bf16 v[92:95], a[20:23], a[84:87], v[92:95]
  v_mfma_f32_16x16x32_bf16 v[100:103], a[24:27], a[84:87], v[100:103]
  v_mfma_f32_16x16x32_bf16 v[108:111], a[28:31], a[84:87], v[108:111]
  v_mfma_f32_16x16x32_bf16 v[116:119], a[32:35], a[84:87], v[116:119]
  v_mfma_f32_16x16x32_bf16 v[124:127], a[36:39], a[84:87], v[124:127]
  s_waitcnt lgkmcnt(0)
  v_mfma_f32_16x16x32_bf16 v[24:27], a[40:43], a[0:3], v[24:27]
  buffer_load_dwordx4 v10, s[20:23], s31 offen offset:2048 lds
  ds_read_b128 a[20:23], v17 offset:0
  v_mfma_f32_16x16x32_bf16 v[32:35], a[40:43], a[4:7], v[32:35]
  s_add_u32 m0, s88, s27
  ds_read_b64_tr_b16 a[64:65], v20 offset:22528
  ds_read_b64_tr_b16 a[66:67], v20 offset:24576
  v_mfma_f32_16x16x32_bf16 v[40:43], a[40:43], a[8:11], v[40:43]
  ds_read_b128 a[24:27], v17 offset:2048
  v_mfma_f32_16x16x32_bf16 v[48:51], a[40:43], a[12:15], v[48:51]
  buffer_load_dwordx4 v11, s[20:23], s31 offen offset:0 lds
  ds_read_b128 a[28:31], v17 offset:4096
  v_mfma_f32_16x16x32_bf16 v[28:31], a[44:47], a[0:3], v[28:31]
  ds_read_b128 a[32:35], v17 offset:6144
  v_mfma_f32_16x16x32_bf16 v[36:39], a[44:47], a[4:7], v[36:39]
  ds_read_b64_tr_b16 a[68:69], v21 offset:22528
  v_mfma_f32_16x16x32_bf16 v[44:47], a[44:47], a[8:11], v[44:47]
  ds_read_b64_tr_b16 a[70:71], v21 offset:24576
  v_mfma_f32_16x16x32_bf16 v[52:55], a[44:47], a[12:15], v[52:55]
  buffer_load_dwordx4 v12, s[20:23], s31 offen offset:1024 lds
  ds_read_b64_tr_b16 a[72:73], v20 offset:30720
  v_mfma_f32_16x16x32_bf16 v[56:59], a[48:51], a[0:3], v[56:59]
  ds_read_b64_tr_b16 a[74:75], v20 offset:32768
  v_mfma_f32_16x16x32_bf16 v[64:67], a[48:51], a[4:7], v[64:67]
  ds_read_b64_tr_b16 a[76:77], v21 offset:30720
  v_mfma_f32_16x16x32_bf16 v[72:75], a[48:51], a[8:11], v[72:75]
  ds_read_b64_tr_b16 a[78:79], v21 offset:32768
  v_mfma_f32_16x16x32_bf16 v[80:83], a[48:51], a[12:15], v[80:83]
  buffer_load_dwordx4 v13, s[20:23], s31 offen offset:2048 lds
  ds_read_b64_tr_b16 a[80:81], v20 offset:38912
  v_mfma_f32_16x16x32_bf16 v[60:63], a[52:55], a[0:3], v[60:63]
  s_add_u32 s31, s31, 393216
  s_cmp_ge_u32 s31, 6291456
  s_cselect_b32 s29, 6291456, 0
  v_mfma_f32_16x16x32_bf16 v[68:71], a[52:55], a[4:7], v[68:71]
  s_sub_u32 s31, s31, s29
  s_add_u32 s60, s63, 0
  ds_read_b64_tr_b16 a[82:83], v20 offset:40960
  v_mfma_f32_16x16x32_bf16 v[76:79], a[52:55], a[8:11], v[76:79]
  ds_read_b128 a[36:39], v19 offset:0
  ds_read_b64_tr_b16 a[84:85], v21 offset:38912
  v_mfma_f32_16x16x32_bf16 v[84:87], a[52:55], a[12:15], v[84:87]
  buffer_store_dwordx4 v[168:171], v2, s[16:19], s60 offen offset:2048 sc1
  ds_read_b64_tr_b16 a[86:87], v21 offset:40960
  v_mfma_f32_16x16x32_bf16 v[88:91], a[0:3], a[56:59], v[88:91]
  s_add_u32 s88, s88, s90
  s_add_u32 s89, s89, 1
  s_cmp_eq_u32 s89, 3
  s_cselect_b32 s89, 0, s89
  s_cselect_b32 s90, s91, s92
  v_mfma_f32_16x16x32_bf16 v[96:99], a[4:7], a[56:59], v[96:99]
  v_add_u32 v16, s90, v16
  v_add_u32 v17, s90, v17
  v_mfma_f32_16x16x32_bf16 v[104:107], a[8:11], a[56:59], v[104:107]
  v_add_u32 v18, s90, v18
  v_add_u32 v19, s90, v19
  v_mfma_f32_16x16x32_bf16 v[112:115], a[12:15], a[56:59], v[112:115]
  v_add_u32 v20, s90, v20
  v_add_u32 v21, s90, v21
  v_mfma_f32_16x16x32_bf16 v[120:123], a[16:19], a[56:59], v[120:123]
  v_mfma_f32_16x16x32_bf16 v[92:95], a[0:3], a[60:63], v[92:95]
  v_mfma_f32_16x16x32_bf16 v[100:103], a[4:7], a[60:63], v[100:103]
  v_mfma_f32_16x16x32_bf16 v[108:111], a[8:11], a[60:63], v[108:111]
  v_mfma_f32_16x16x32_bf16 v[116:119], a[12:15], a[60:63], v[116:119]
  v_mfma_f32_16x16x32_bf16 v[124:127], a[16:19], a[60:63], v[124:127]
  s_waitcnt vmcnt(13) lgkmcnt(0)
  s_barrier
  v_mfma_f32_16x16x32_bf16 v[24:27], a[64:67], a[20:23], v[24:27]
  s_mov_b32 m0, s88
  ds_read_b128 a[0:3], v16 offset:0
  ds_read_b64_tr_b16 a[40:41], v20 offset:18432
  v_mfma_f32_16x16x32_bf16 v[32:35], a[64:67], a[24:27], v[32:35]
  buffer_load_dwordx4 v4, s[8:11], s30 offen offset:0 lds
  ds_read_b64_tr_b16 a[42:43], v20 offset:20480
  v_mfma_f32_16x16x32_bf16 v[40:43], a[64:67], a[28:31], v[40:43]
  ds_read_b128 a[4:7], v16 offset:2048
  v_mfma_f32_16x16x32_bf16 v[48:51], a[64:67], a[32:35], v[48:51]
  ds_read_b128 a[8:11], v16 offset:4096
  v_mfma_f32_16x16x32_bf16 v[28:31], a[68:71], a[20:23], v[28:31]
  buffer_load_dwordx4 v5, s[8:11], s30 offen offset:1024 lds
  ds_read_b128 a[12:15], v16 offset:6144
  v_mfma_f32_16x16x32_bf16 v[36:39], a[68:71], a[24:27], v[36:39]
  ds_read_b64_tr_b16 a[44:45], v21 offset:18432
  v_mfma_f32_16x16x32_bf16 v[44:47], a[68:71], a[28:31], v[44:47]
  ds_read_b64_tr_b16 a[46:47], v21 offset:20480
  v_mfma_f32_16x16x32_bf16 v[52:55], a[68:71], a[32:35], v[52:55]
  ds_read_b64_tr_b16 a[48:49], v20 offset:26624
  v_mfma_f32_16x16x32_bf16 v[56:59], a[72:75], a[20:23], v[56:59]
  buffer_load_dwordx4 v6, s[8:11], s30 offen offset:2048 lds
  ds_read_b64_tr_b16 a[50:51], v20 offset:28672
  v_mfma_f32_16x16x32_bf16 v[64:67], a[72:75], a[24:27], v[64:67]
  ds_read_b64_tr_b16 a[52:53], v21 offset:26624
  v_mfma_f32_16x16x32_bf16 v[72:75], a[72:75], a[28:31], v[72:75]
  ds_read_b64_tr_b16 a[54:55], v21 offset:28672
  v_mfma_f32_16x16x32_bf16 v[80:83], a[72:75], a[32:35], v[80:83]
  ds_read_b64_tr_b16 a[56:57], v20 offset:34816
  v_mfma_f32_16x16x32_bf16 v[60:63], a[76:79], a[20:23], v[60:63]
  buffer_load_dwordx4 v7, s[8:11], s30 offen offset:3072 lds
  ds_read_b64_tr_b16 a[58:59], v20 offset:36864
  v_mfma_f32_16x16x32_bf16 v[68:71], a[76:79], a[24:27], v[68:71]
  s_add_u32 s30, s30, 128
  s_and_b32 s30, s30, 2047
  s_add_u32 m0, s88, s26
  v_mfma_f32_16x16x32_bf16 v[76:79], a[76:79], a[28:31], v[76:79]
  ds_read_b128 a[16:19], v18 offset:0
  ds_read_b64_tr_b16 a[60:61], v21 offset:34816
  v_mfma_f32_16x16x32_bf16 v[84:87], a[76:79], a[32:35], v[84:87]
  ds_read_b64_tr_b16 a[62:63], v21 offset:36864
  v_mfma_f32_16x16x32_bf16 v[88:91], a[20:23], a[80:83], v[88:91]
  buffer_load_dwordx4 v8, s[20:23], s31 offen offset:0 lds
  v_mfma_f32_16x16x32_bf16 v[96:99], a[24:27], a[80:83], v[96:99]
  v_mfma_f32_16x16x32_bf16 v[104:107], a[28:31], a[80:83], v[104:107]
  v_mfma_f32_16x16x32_bf16 v[112:115], a[32:35], a[80:83], v[112:115]
  v_mfma_f32_16x16x32_bf16 v[120:123], a[36:39], a[80:83], v[120:123]
  buffer_load_dwordx4 v9, s[20:23], s31 offen offset:1024 lds
  v_mfma_f32_16x16x32_bf16 v[92:95], a[20:23], a[84:87], v[92:95]
  v_mfma_f32_16x16x32_bf16 v[100:103], a[24:27], a[84:87], v[100:103]
  v_mfma_f32_16x16x32_bf16 v[108:111], a[28:31], a[84:87], v[108:111]
  v_mfma_f32_16x16x32_bf16 v[116:119], a[32:35], a[84:87], v[116:119]
  v_mfma_f32_16x16x32_bf16 v[124:127], a[36:39], a[84:87], v[124:127]
  s_waitcnt lgkmcnt(0)
  v_mfma_f32_16x16x32_bf16 v[24:27], a[40:43], a[0:3], v[24:27]
  buffer_load_dwordx4 v10, s[20:23], s31 offen offset:2048 lds
  ds_read_b128 a[20:23], v17 offset:0
  v_mfma_f32_16x16x32_bf16 v[32:35], a[40:43], a[4:7], v[32:35]
  s_add_u32 m0, s88, s27
  ds_read_b64_tr_b16 a[64:65], v20 offset:22528
  ds_read_b64_tr_b16 a[66:67], v20 offset:24576
  v_mfma_f32_16x16x32_bf16 v[40:43], a[40:43], a[8:11], v[40:43]
  ds_read_b128 a[24:27], v17 offset:2048
  v_mfma_f32_16x16x32_bf16 v[48:51], a[40:43], a[12:15], v[48:51]
  buffer_load_dwordx4 v11, s[20:23], s31 offen offset:0 lds
  ds_read_b128 a[28:31], v17 offset:4096
  v_mfma_f32_16x16x32_bf16 v[28:31], a[44:47], a[0:3], v[28:31]
  ds_read_b128 a[32:35], v17 offset:6144
  v_mfma_f32_16x16x32_bf16 v[36:39], a[44:47], a[4:7], v[36:39]
  ds_read_b64_tr_b16 a[68:69], v21 offset:22528
  v_mfma_f32_16x16x32_bf16 v[44:47], a[44:47], a[8:11], v[44:47]
  ds_read_b64_tr_b16 a[70:71], v21 offset:24576
  v_mfma_f32_16x16x32_bf16 v[52:55], a[44:47], a[12:15], v[52:55]
  buffer_load_dwordx4 v12, s[20:23], s31 offen offset:1024 lds
  ds_read_b64_tr_b16 a[72:73], v20 offset:30720
  v_mfma_f32_16x16x32_bf16 v[56:59], a[48:51], a[0:3], v[56:59]
  ds_read_b64_tr_b16 a[74:75], v20 offset:32768
  v_mfma_f32_16x16x32_bf16 v[64:67], a[48:51], a[4:7], v[64:67]
  ds_read_b64_tr_b16 a[76:77], v21 offset:30720
  v_mfma_f32_16x16x32_bf16 v[72:75], a[48:51], a[8:11], v[72:75]
  ds_read_b64_tr_b16 a[78:79], v21 offset:32768
  v_mfma_f32_16x16x32_bf16 v[80:83], a[48:51], a[12:15], v[80:83]
  buffer_load_dwordx4 v13, s[20:23], s31 offen offset:2048 lds
  ds_read_b64_tr_b16 a[80:81], v20 offset:38912
  v_mfma_f32_16x16x32_bf16 v[60:63], a[52:55], a[0:3], v[60:63]
  s_add_u32 s31, s31, 393216
  s_cmp_ge_u32 s31, 6291456
  s_cselect_b32 s29, 6291456, 0
  v_mfma_f32_16x16x32_bf16 v[68:71], a[52:55], a[4:7], v[68:71]
  s_sub_u32 s31, s31, s29
  s_add_u32 s60, s63, 0
  ds_read_b64_tr_b16 a[82:83], v20 offset:40960
  v_mfma_f32_16x16x32_bf16 v[76:79], a[52:55], a[8:11], v[76:79]
  ds_read_b128 a[36:39], v19 offset:0
  ds_read_b64_tr_b16 a[84:85], v21 offset:38912
  v_mfma_f32_16x16x32_bf16 v[84:87], a[52:55], a[12:15], v[84:87]
  buffer_store_dwordx4 v[172:175], v2, s[16:19], s60 offen offset:3072 sc1
  ds_read_b64_tr_b16 a[86:87], v21 offset:40960
  v_mfma_f32_16x16x32_bf16 v[88:91], a[0:3], a[56:59], v[88:91]
  s_add_u32 s88, s88, s90
  s_add_u32 s89, s89, 1
  s_cmp_eq_u32 s89, 3
  s_cselect_b32 s89, 0, s89
  s_cselect_b32 s90, s91, s92
  v_mfma_f32_16x16x32_bf16 v[96:99], a[4:7], a[56:59], v[96:99]
  v_add_u32 v16, s90, v16
  v_add_u32 v17, s90, v17
  v_mfma_f32_16x16x32_bf16 v[104:107], a[8:11], a[56:59], v[104:107]
  v_add_u32 v18, s90, v18
  v_add_u32 v19, s90, v19
  v_mfma_f32_16x16x32_bf16 v[112:115], a[12:15], a[56:59], v[112:115]
  v_add_u32 v20, s90, v20
  v_add_u32 v21, s90, v21
  v_mfma_f32_16x16x32_bf16 v[120:123], a[16:19], a[56:59], v[120:123]
  v_mfma_f32_16x16x32_bf16 v[92:95], a[0:3], a[60:63], v[92:95]
  v_mfma_f32_16x16x32_bf16 v[100:103], a[4:7], a[60:63], v[100:103]
  v_mfma_f32_16x16x32_bf16 v[108:111], a[8:11], a[60:63], v[108:111]
  v_mfma_f32_16x16x32_bf16 v[116:119], a[12:15], a[60:63], v[116:119]
  v_mfma_f32_16x16x32_bf16 v[124:127], a[16:19], a[60:63], v[124:127]
  s_waitcnt vmcnt(12) lgkmcnt(0)
  s_barrier
  v_mfma_f32_16x16x32_bf16 v[24:27], a[64:67], a[20:23], v[24:27]
  s_mov_b32 m0, s88
  ds_read_b128 a[0:3], v16 offset:0
  ds_read_b64_tr_b16 a[40:41], v20 offset:18432
  v_mfma_f32_16x16x32_bf16 v[32:35], a[64:67], a[24:27], v[32:35]
  buffer_load_dwordx4 v4, s[8:11], s30 offen offset:0 lds
  ds_read_b64_tr_b16 a[42:43], v20 offset:20480
  v_mfma_f32_16x16x32_bf16 v[40:43], a[64:67], a[28:31], v[40:43]
  ds_read_b128 a[4:7], v16 offset:2048
  v_mfma_f32_16x16x32_bf16 v[48:51], a[64:67], a[32:35], v[48:51]
  ds_read_b128 a[8:11], v16 offset:4096
  v_mfma_f32_16x16x32_bf16 v[28:31], a[68:71], a[20:23], v[28:31]
  buffer_load_dwordx4 v5, s[8:11], s30 offen offset:1024 lds
  ds_read_b128 a[12:15], v16 offset:6144
  v_mfma_f32_16x16x32_bf16 v[36:39], a[68:71], a[24:27], v[36:39]
  ds_read_b64_tr_b16 a[44:45], v21 offset:18432
  v_mfma_f32_16x16x32_bf16 v[44:47], a[68:71], a[28:31], v[44:47]
  ds_read_b64_tr_b16 a[46:47], v21 offset:20480
  v_mfma_f32_16x16x32_bf16 v[52:55], a[68:71], a[32:35], v[52:55]
  ds_read_b64_tr_b16 a[48:49], v20 offset:26624
  v_mfma_f32_16x16x32_bf16 v[56:59], a[72:75], a[20:23], v[56:59]
  buffer_load_dwordx4 v6, s[8:11], s30 offen offset:2048 lds
  ds_read_b64_tr_b16 a[50:51], v20 offset:28672
  v_mfma_f32_16x16x32_bf16 v[64:67], a[72:75], a[24:27], v[64:67]
  ds_read_b64_tr_b16 a[52:53], v21 offset:26624
  v_mfma_f32_16x16x32_bf16 v[72:75], a[72:75], a[28:31], v[72:75]
  ds_read_b64_tr_b16 a[54:55], v21 offset:28672
  v_mfma_f32_16x16x32_bf16 v[80:83], a[72:75], a[32:35], v[80:83]
  ds_read_b64_tr_b16 a[56:57], v20 offset:34816
  v_mfma_f32_16x16x32_bf16 v[60:63], a[76:79], a[20:23], v[60:63]
  buffer_load_dwordx4 v7, s[8:11], s30 offen offset:3072 lds
  ds_read_b64_tr_b16 a[58:59], v20 offset:36864
  v_mfma_f32_16x16x32_bf16 v[68:71], a[76:79], a[24:27], v[68:71]
  s_add_u32 s30, s30, 128
  s_and_b32 s30, s30, 2047
  s_add_u32 m0, s88, s26
  v_mfma_f32_16x16x32_bf16 v[76:79], a[76:79], a[28:31], v[76:79]
  ds_read_b128 a[16:19], v18 offset:0
  ds_read_b64_tr_b16 a[60:61], v21 offset:34816
  v_mfma_f32_16x16x32_bf16 v[84:87], a[76:79], a[32:35], v[84:87]
  ds_read_b64_tr_b16 a[62:63], v21 offset:36864
  v_mfma_f32_16x16x32_bf16 v[88:91], a[20:23], a[80:83], v[88:91]
  buffer_load_dwordx4 v8, s[20:23], s31 offen offset:0 lds
  v_mfma_f32_16x16x32_bf16 v[96:99], a[24:27], a[80:83], v[96:99]
  v_mfma_f32_16x16x32_bf16 v[104:107], a[28:31], a[80:83], v[104:107]
  v_mfma_f32_16x16x32_bf16 v[112:115], a[32:35], a[80:83], v[112:115]
  v_mfma_f32_16x16x32_bf16 v[120:123], a[36:39], a[80:83], v[120:123]
  buffer_load_dwordx4 v9, s[20:23], s31 offen offset:1024 lds
  v_mfma_f32_16x16x32_bf16 v[92:95], a[20:23], a[84:87], v[92:95]
  v_mfma_f32_16x16x32_bf16 v[100:103], a[24:27], a[84:87], v[100:103]
  v_mfma_f32_16x16x32_bf16 v[108:111], a[28:31], a[84:87], v[108:111]
  v_mfma_f32_16x16x32_bf16 v[116:119], a[32:35], a[84:87], v[116:119]
  v_mfma_f32_16x16x32_bf16 v[124:127], a[36:39], a[84:87], v[124:127]
  s_waitcnt lgkmcnt(0)
  v_mfma_f32_16x16x32_bf16 v[24:27], a[40:43], a[0:3], v[24:27]
  buffer_load_dwordx4 v10, s[20:23], s31 offen offset:2048 lds
  ds_read_b128 a[20:23], v17 offset:0
  v_mfma_f32_16x16x32_bf16 v[32:35], a[40:43], a[4:7], v[32:35]
  s_add_u32 m0, s88, s27
  ds_read_b64_tr_b16 a[64:65], v20 offset:22528
  ds_read_b64_tr_b16 a[66:67], v20 offset:24576
  v_mfma_f32_16x16x32_bf16 v[40:43], a[40:43], a[8:11], v[40:43]
  ds_read_b128 a[24:27], v17 offset:2048
  v_mfma_f32_16x16x32_bf16 v[48:51], a[40:43], a[12:15], v[48:51]
  buffer_load_dwordx4 v11, s[20:23], s31 offen offset:0 lds
  ds_read_b128 a[28:31], v17 offset:4096
  v_mfma_f32_16x16x32_bf16 v[28:31], a[44:47], a[0:3], v[28:31]
  ds_read_b128 a[32:35], v17 offset:6144
  v_mfma_f32_16x16x32_bf16 v[36:39], a[44:47], a[4:7], v[36:39]
  ds_read_b64_tr_b16 a[68:69], v21 offset:22528
  v_mfma_f32_16x16x32_bf16 v[44:47], a[44:47], a[8:11], v[44:47]
  buffer_load_dwordx4 v12, s[20:23], s31 offen offset:1024 lds
  ds_read_b64_tr_b16 a[70:71], v21 offset:24576
  v_mfma_f32_16x16x32_bf16 v[52:55], a[44:47], a[12:15], v[52:55]
  ds_read_b64_tr_b16 a[72:73], v20 offset:30720
  v_mfma_f32_16x16x32_bf16 v[56:59], a[48:51], a[0:3], v[56:59]
  ds_read_b64_tr_b16 a[74:75], v20 offset:32768
  v_mfma_f32_16x16x32_bf16 v[64:67], a[48:51], a[4:7], v[64:67]
  buffer_load_dwordx4 v13, s[20:23], s31 offen offset:2048 lds
  ds_read_b64_tr_b16 a[76:77], v21 offset:30720
  v_mfma_f32_16x16x32_bf16 v[72:75], a[48:51], a[8:11], v[72:75]
  s_add_u32 s31, s31, 393216
  s_cmp_ge_u32 s31, 6291456
  s_cselect_b32 s29, 6291456, 0
  v_mfma_f32_16x16x32_bf16 v[80:83], a[48:51], a[12:15], v[80:83]
  s_sub_u32 s31, s31, s29
  s_add_u32 s60, s63, 4096
  ds_read_b64_tr_b16 a[78:79], v21 offset:32768
  v_mfma_f32_16x16x32_bf16 v[60:63], a[52:55], a[0:3], v[60:63]
  buffer_store_dwordx4 v[176:179], v2, s[16:19], s60 offen offset:0 sc1
  ds_read_b64_tr_b16 a[80:81], v20 offset:38912
  v_mfma_f32_16x16x32_bf16 v[68:71], a[52:55], a[4:7], v[68:71]
  ds_read_b64_tr_b16 a[82:83], v20 offset:40960
  ds_read_b128 a[36:39], v19 offset:0
  v_mfma_f32_16x16x32_bf16 v[76:79], a[52:55], a[8:11], v[76:79]
  ds_read_b64_tr_b16 a[84:85], v21 offset:38912
  v_mfma_f32_16x16x32_bf16 v[84:87], a[52:55], a[12:15], v[84:87]
  buffer_store_dwordx4 v[180:183], v2, s[16:19], s60 offen offset:1024 sc1
  ds_read_b64_tr_b16 a[86:87], v21 offset:40960
  v_mfma_f32_16x16x32_bf16 v[88:91], a[0:3], a[56:59], v[88:91]
  s_add_u32 s88, s88, s90
  s_add_u32 s89, s89, 1
  s_cmp_eq_u32 s89, 3
  s_cselect_b32 s89, 0, s89
  s_cselect_b32 s90, s91, s92
  v_mfma_f32_16x16x32_bf16 v[96:99], a[4:7], a[56:59], v[96:99]
  v_add_u32 v16, s90, v16
  v_add_u32 v17, s90, v17
  v_mfma_f32_16x16x32_bf16 v[104:107], a[8:11], a[56:59], v[104:107]
  v_add_u32 v18, s90, v18
  v_add_u32 v19, s90, v19
  v_mfma_f32_16x16x32_bf16 v[112:115], a[12:15], a[56:59], v[112:115]
  v_add_u32 v20, s90, v20
  v_add_u32 v21, s90, v21
  v_mfma_f32_16x16x32_bf16 v[120:123], a[16:19], a[56:59], v[120:123]
  v_mfma_f32_16x16x32_bf16 v[92:95], a[0:3], a[60:63], v[92:95]
  v_mfma_f32_16x16x32_bf16 v[100:103], a[4:7], a[60:63], v[100:103]
  v_mfma_f32_16x16x32_bf16 v[108:111], a[8:11], a[60:63], v[108:111]
  v_mfma_f32_16x16x32_bf16 v[116:119], a[12:15], a[60:63], v[116:119]
  v_mfma_f32_16x16x32_bf16 v[124:127], a[16:19], a[60:63], v[124:127]
  s_waitcnt vmcnt(13) lgkmcnt(0)
  s_barrier
  v_mfma_f32_16x16x32_bf16 v[24:27], a[64:67], a[20:23], v[24:27]
  s_mov_b32 m0, s88
  ds_read_b128 a[0:3], v16 offset:0
  ds_read_b64_tr_b16 a[40:41], v20 offset:18432
  v_mfma_f32_16x16x32_bf16 v[32:35], a[64:67], a[24:27], v[32:35]
  buffer_load_dwordx4 v4, s[8:11], s30 offen offset:0 lds
  ds_read_b64_tr_b16 a[42:43], v20 offset:20480
  v_mfma_f32_16x16x32_bf16 v[40:43], a[64:67], a[28:31], v[40:43]
  ds_read_b128 a[4:7], v16 offset:2048
  v_mfma_f32_16x16x32_bf16 v[48:51], a[64:67], a[32:35], v[48:51]
  ds_read_b128 a[8:11], v16 offset:4096
  v_mfma_f32_16x16x32_bf16 v[28:31], a[68:71], a[20:23], v[28:31]
  buffer_load_dwordx4 v5, s[8:11], s30 offen offset:1024 lds
  ds_read_b128 a[12:15], v16 offset:6144
  v_mfma_f32_16x16x32_bf16 v[36:39], a[68:71], a[24:27], v[36:39]
  ds_read_b64_tr_b16 a[44:45], v21 offset:18432
  v_mfma_f32_16x16x32_bf16 v[44:47], a[68:71], a[28:31], v[44:47]
  ds_read_b64_tr_b16 a[46:47], v21 offset:20480
  v_mfma_f32_16x16x32_bf16 v[52:55], a[68:71], a[32:35], v[52:55]
  ds_read_b64_tr_b16 a[48:49], v20 offset:26624
  v_mfma_f32_16x16x32_bf16 v[56:59], a[72:75], a[20:23], v[56:59]
  buffer_load_dwordx4 v6, s[8:11], s30 offen offset:2048 lds
  ds_read_b64_tr_b16 a[50:51], v20 offset:28672
  v_mfma_f32_16x16x32_bf16 v[64:67], a[72:75], a[24:27], v[64:67]
  ds_read_b64_tr_b16 a[52:53], v21 offset:26624
  v_mfma_f32_16x16x32_bf16 v[72:75], a[72:75], a[28:31], v[72:75]
  ds_read_b64_tr_b16 a[54:55], v21 offset:28672
  v_mfma_f32_16x16x32_bf16 v[80:83], a[72:75], a[32:35], v[80:83]
  ds_read_b64_tr_b16 a[56:57], v20 offset:34816
  v_mfma_f32_16x16x32_bf16 v[60:63], a[76:79], a[20:23], v[60:63]
  buffer_load_dwordx4 v7, s[8:11], s30 offen offset:3072 lds
  ds_read_b64_tr_b16 a[58:59], v20 offset:36864
  v_mfma_f32_16x16x32_bf16 v[68:71], a[76:79], a[24:27], v[68:71]
  s_add_u32 s30, s30, 128
  s_and_b32 s30, s30, 2047
  s_add_u32 m0, s88, s26
  v_mfma_f32_16x16x32_bf16 v[76:79], a[76:79], a[28:31], v[76:79]
  ds_read_b128 a[16:19], v18 offset:0
  ds_read_b64_tr_b16 a[60:61], v21 offset:34816
  v_mfma_f32_16x16x32_bf16 v[84:87], a[76:79], a[32:35], v[84:87]
  ds_read_b64_tr_b16 a[62:63], v21 offset:36864
  v_mfma_f32_16x16x32_bf16 v[88:91], a[20:23], a[80:83], v[88:91]
  buffer_load_dwordx4 v8, s[20:23], s31 offen offset:0 lds
  v_mfma_f32_16x16x32_bf16 v[96:99], a[24:27], a[80:83], v[96:99]
  v_mfma_f32_16x16x32_bf16 v[104:107], a[28:31], a[80:83], v[104:107]
  v_mfma_f32_16x16x32_bf16 v[112:115], a[32:35], a[80:83], v[112:115]
  v_mfma_f32_16x16x32_bf16 v[120:123], a[36:39], a[80:83], v[120:123]
  buffer_load_dwordx4 v9, s[20:23], s31 offen offset:1024 lds
  v_mfma_f32_16x16x32_bf16 v[92:95], a[20:23], a[84:87], v[92:95]
  v_mfma_f32_16x16x32_bf16 v[100:103], a[24:27], a[84:87], v[100:103]
  v_mfma_f32_16x16x32_bf16 v[108:111], a[28:31], a[84:87], v[108:111]
  v_mfma_f32_16x16x32_bf16 v[116:119], a[32:35], a[84:87], v[116:119]
  v_mfma_f32_16x16x32_bf16 v[124:127], a[36:39], a[84:87], v[124:127]
  s_waitcnt lgkmcnt(0)
  v_mfma_f32_16x16x32_bf16 v[24:27], a[40:43], a[0:3], v[24:27]
  buffer_load_dwordx4 v10, s[20:23], s31 offen offset:2048 lds
  ds_read_b128 a[20:23], v17 offset:0
  v_mfma_f32_16x16x32_bf16 v[32:35], a[40:43], a[4:7], v[32:35]
  s_add_u32 m0, s88, s27
  ds_read_b64_tr_b16 a[64:65], v20 offset:22528
  ds_read_b64_tr_b16 a[66:67], v20 offset:24576
  v_mfma_f32_16x16x32_bf16 v[40:43], a[40:43], a[8:11], v[40:43]
  ds_read_b128 a[24:27], v17 offset:2048
  v_mfma_f32_16x16x32_bf16 v[48:51], a[40:43], a[12:15], v[48:51]
  buffer_load_dwordx4 v11, s[20:23], s31 offen offset:0 lds
  ds_read_b128 a[28:31], v17 offset:4096
  v_mfma_f32_16x16x32_bf16 v[28:31], a[44:47], a[0:3], v[28:31]
  ds_read_b128 a[32:35], v17 offset:6144
  v_mfma_f32_16x16x32_bf16 v[36:39], a[44:47], a[4:7], v[36:39]
  ds_read_b64_tr_b16 a[68:69], v21 offset:22528
  v_mfma_f32_16x16x32_bf16 v[44:47], a[44:47], a[8:11], v[44:47]
  ds_read_b64_tr_b16 a[70:71], v21 offset:24576
  v_mfma_f32_16x16x32_bf16 v[52:55], a[44:47], a[12:15], v[52:55]
  buffer_load_dwordx4 v12, s[20:23], s31 offen offset:1024 lds
  ds_read_b64_tr_b16 a[72:73], v20 offset:30720
  v_mfma_f32_16x16x32_bf16 v[56:59], a[48:51], a[0:3], v[56:59]
  ds_read_b64_tr_b16 a[74:75], v20 offset:32768
  v_mfma_f32_16x16x32_bf16 v[64:67], a[48:51], a[4:7], v[64:67]
  ds_read_b64_tr_b16 a[76:77], v21 offset:30720
  v_mfma_f32_16x16x32_bf16 v[72:75], a[48:51], a[8:11], v[72:75]
  ds_read_b64_tr_b16 a[78:79], v21 offset:32768
  v_mfma_f32_16x16x32_bf16 v[80:83], a[48:51], a[12:15], v[80:83]
  buffer_load_dwordx4 v13, s[20:23], s31 offen offset:2048 lds
  ds_read_b64_tr_b16 a[80:81], v20 offset:38912
  v_mfma_f32_16x16x32_bf16 v[60:63], a[52:55], a[0:3], v[60:63]
  s_add_u32 s31, s31, 393216
  s_cmp_ge_u32 s31, 6291456
  s_cselect_b32 s29, 6291456, 0
  v_mfma_f32_16x16x32_bf16 v[68:71], a[52:55], a[4:7], v[68:71]
  s_sub_u32 s31, s31, s29
  s_add_u32 s60, s63, 4096
  ds_read_b64_tr_b16 a[82:83], v20 offset:40960
  v_mfma_f32_16x16x32_bf16 v[76:79], a[52:55], a[8:11], v[76:79]
  ds_read_b128 a[36:39], v19 offset:0
  ds_read_b64_tr_b16 a[84:85], v21 offset:38912
  v_mfma_f32_16x16x32_bf16 v[84:87], a[52:55], a[12:15], v[84:87]
  buffer_store_dwordx4 v[184:187], v2, s[16:19], s60 offen offset:2048 sc1
  ds_read_b64_tr_b16 a[86:87], v21 offset:40960
  v_mfma_f32_16x16x32_bf16 v[88:91], a[0:3], a[56:59], v[88:91]
  s_add_u32 s88, s88, s90
  s_add_u32 s89, s89, 1
  s_cmp_eq_u32 s89, 3
  s_cselect_b32 s89, 0, s89
  s_cselect_b32 s90, s91, s92
  v_mfma_f32_16x16x32_bf16 v[96:99], a[4:7], a[56:59], v[96:99]
  v_add_u32 v16, s90, v16
  v_add_u32 v17, s90, v17
  v_mfma_f32_16x16x32_bf16 v[104:107], a[8:11], a[56:59], v[104:107]
  v_add_u32 v18, s90, v18
  v_add_u32 v19, s90, v19
  v_mfma_f32_16x16x32_bf16 v[112:115], a[12:15], a[56:59], v[112:115]
  v_add_u32 v20, s90, v20
  v_add_u32 v21, s90, v21
  v_mfma_f32_16x16x32_bf16 v[120:123], a[16:19], a[56:59], v[120:123]
  v_mfma_f32_16x16x32_bf16 v[92:95], a[0:3], a[60:63], v[92:95]
  v_mfma_f32_16x16x32_bf16 v[100:103], a[4:7], a[60:63], v[100:103]
  v_mfma_f32_16x16x32_bf16 v[108:111], a[8:11], a[60:63], v[108:111]
  v_mfma_f32_16x16x32_bf16 v[116:119], a[12:15], a[60:63], v[116:119]
  v_mfma_f32_16x16x32_bf16 v[124:127], a[16:19], a[60:63], v[124:127]
  s_waitcnt vmcnt(13) lgkmcnt(0)
  s_barrier
  v_mfma_f32_16x16x32_bf16 v[24:27], a[64:67], a[20:23], v[24:27]
  s_mov_b32 m0, s88
  ds_read_b128 a[0:3], v16 offset:0
  ds_read_b64_tr_b16 a[40:41], v20 offset:18432
  v_mfma_f32_16x16x32_bf16 v[32:35], a[64:67], a[24:27], v[32:35]
  buffer_load_dwordx4 v4, s[8:11], s30 offen offset:0 lds
  ds_read_b64_tr_b16 a[42:43], v20 offset:20480
  v_mfma_f32_16x16x32_bf16 v[40:43], a[64:67], a[28:31], v[40:43]
  ds_read_b128 a[4:7], v16 offset:2048
  v_mfma_f32_16x16x32_bf16 v[48:51], a[64:67], a[32:35], v[48:51]
  ds_read_b128 a[8:11], v16 offset:4096
  v_mfma_f32_16x16x32_bf16 v[28:31], a[68:71], a[20:23], v[28:31]
  buffer_load_dwordx4 v5, s[8:11], s30 offen offset:1024 lds
  ds_read_b128 a[12:15], v16 offset:6144
  v_mfma_f32_16x16x32_bf16 v[36:39], a[68:71], a[24:27], v[36:39]
  ds_read_b64_tr_b16 a[44:45], v21 offset:18432
  v_mfma_f32_16x16x32_bf16 v[44:47], a[68:71], a[28:31], v[44:47]
  ds_read_b64_tr_b16 a[46:47], v21 offset:20480
  v_mfma_f32_16x16x32_bf16 v[52:55], a[68:71], a[32:35], v[52:55]
  ds_read_b64_tr_b16 a[48:49], v20 offset:26624
  v_mfma_f32_16x16x32_bf16 v[56:59], a[72:75], a[20:23], v[56:59]
  buffer_load_dwordx4 v6, s[8:11], s30 offen offset:2048 lds
  ds_read_b64_tr_b16 a[50:51], v20 offset:28672
  v_mfma_f32_16x16x32_bf16 v[64:67], a[72:75], a[24:27], v[64:67]
  ds_read_b64_tr_b16 a[52:53], v21 offset:26624
  v_mfma_f32_16x16x32_bf16 v[72:75], a[72:75], a[28:31], v[72:75]
  ds_read_b64_tr_b16 a[54:55], v21 offset:28672
  v_mfma_f32_16x16x32_bf16 v[80:83], a[72:75], a[32:35], v[80:83]
  ds_read_b64_tr_b16 a[56:57], v20 offset:34816
  v_mfma_f32_16x16x32_bf16 v[60:63], a[76:79], a[20:23], v[60:63]
  buffer_load_dwordx4 v7, s[8:11], s30 offen offset:3072 lds
  ds_read_b64_tr_b16 a[58:59], v20 offset:36864
  v_mfma_f32_16x16x32_bf16 v[68:71], a[76:79], a[24:27], v[68:71]
  s_add_u32 s30, s30, 128
  s_and_b32 s30, s30, 2047
  s_add_u32 m0, s88, s26
  v_mfma_f32_16x16x32_bf16 v[76:79], a[76:79], a[28:31], v[76:79]
  ds_read_b128 a[16:19], v18 offset:0
  ds_read_b64_tr_b16 a[60:61], v21 offset:34816
  v_mfma_f32_16x16x32_bf16 v[84:87], a[76:79], a[32:35], v[84:87]
  ds_read_b64_tr_b16 a[62:63], v21 offset:36864
  v_mfma_f32_16x16x32_bf16 v[88:91], a[20:23], a[80:83], v[88:91]
  buffer_load_dwordx4 v8, s[20:23], s31 offen offset:0 lds
  v_mfma_f32_16x16x32_bf16 v[96:99], a[24:27], a[80:83], v[96:99]
  v_mfma_f32_16x16x32_bf16 v[104:107], a[28:31], a[80:83], v[104:107]
  v_mfma_f32_16x16x32_bf16 v[112:115], a[32:35], a[80:83], v[112:115]
  v_mfma_f32_16x16x32_bf16 v[120:123], a[36:39], a[80:83], v[120:123]
  buffer_load_dwordx4 v9, s[20:23], s31 offen offset:1024 lds
  v_mfma_f32_16x16x32_bf16 v[92:95], a[20:23], a[84:87], v[92:95]
  v_mfma_f32_16x16x32_bf16 v[100:103], a[24:27], a[84:87], v[100:103]
  v_mfma_f32_16x16x32_bf16 v[108:111], a[28:31], a[84:87], v[108:111]
  v_mfma_f32_16x16x32_bf16 v[116:119], a[32:35], a[84:87], v[116:119]
  v_mfma_f32_16x16x32_bf16 v[124:127], a[36:39], a[84:87], v[124:127]
  s_waitcnt lgkmcnt(0)
  v_mfma_f32_16x16x32_bf16 v[24:27], a[40:43], a[0:3], v[24:27]
  buffer_load_dwordx4 v10, s[20:23], s31 offen offset:2048 lds
  ds_read_b128 a[20:23], v17 offset:0
  v_mfma_f32_16x16x32_bf16 v[32:35], a[40:43], a[4:7], v[32:35]
  s_add_u32 m0, s88, s27
  ds_read_b64_tr_b16 a[64:65], v20 offset:22528
  ds_read_b64_tr_b16 a[66:67], v20 offset:24576
  v_mfma_f32_16x16x32_bf16 v[40:43], a[40:43], a[8:11], v[40:43]
  ds_read_b128 a[24:27], v17 offset:2048
  v_mfma_f32_16x16x32_bf16 v[48:51], a[40:43], a[12:15], v[48:51]
  buffer_load_dwordx4 v11, s[20:23], s31 offen offset:0 lds
  ds_read_b128 a[28:31], v17 offset:4096
  v_mfma_f32_16x16x32_bf16 v[28:31], a[44:47], a[0:3], v[28:31]
  ds_read_b128 a[32:35], v17 offset:6144
  v_mfma_f32_16x16x32_bf16 v[36:39], a[44:47], a[4:7], v[36:39]
  ds_read_b64_tr_b16 a[68:69], v21 offset:22528
  v_mfma_f32_16x16x32_bf16 v[44:47], a[44:47], a[8:11], v[44:47]
  buffer_load_dwordx4 v12, s[20:23], s31 offen offset:1024 lds
  ds_read_b64_tr_b16 a[70:71], v21 offset:24576
  v_mfma_f32_16x16x32_bf16 v[52:55], a[44:47], a[12:15], v[52:55]
  ds_read_b64_tr_b16 a[72:73], v20 offset:30720
  v_mfma_f32_16x16x32_bf16 v[56:59], a[48:51], a[0:3], v[56:59]
  ds_read_b64_tr_b16 a[74:75], v20 offset:32768
  v_mfma_f32_16x16x32_bf16 v[64:67], a[48:51], a[4:7], v[64:67]
  buffer_load_dwordx4 v13, s[20:23], s31 offen offset:2048 lds
  ds_read_b64_tr_b16 a[76:77], v21 offset:30720
  v_mfma_f32_16x16x32_bf16 v[72:75], a[48:51], a[8:11], v[72:75]
  s_add_u32 s31, s31, 393216
  s_cmp_ge_u32 s31, 6291456
  s_cselect_b32 s29, 6291456, 0
  v_mfma_f32_16x16x32_bf16 v[80:83], a[48:51], a[12:15], v[80:83]
  s_sub_u32 s31, s31, s29
  s_add_u32 s60, s63, 4096
  ds_read_b64_tr_b16 a[78:79], v21 offset:32768
  v_mfma_f32_16x16x32_bf16 v[60:63], a[52:55], a[0:3], v[60:63]
  buffer_store_dwordx4 v[188:191], v2, s[16:19], s60 offen offset:3072 sc1
  ds_read_b64_tr_b16 a[80:81], v20 offset:38912
  v_mfma_f32_16x16x32_bf16 v[68:71], a[52:55], a[4:7], v[68:71]
  s_add_u32 s60, s63, 32768
  ds_read_b64_tr_b16 a[82:83], v20 offset:40960
  ds_read_b128 a[36:39], v19 offset:0
  v_mfma_f32_16x16x32_bf16 v[76:79], a[52:55], a[8:11], v[76:79]
  ds_read_b64_tr_b16 a[84:85], v21 offset:38912
  v_mfma_f32_16x16x32_bf16 v[84:87], a[52:55], a[12:15], v[84:87]
  buffer_store_dwordx4 v[204:207], v2, s[16:19], s60 offen offset:3072 sc1
  ds_read_b64_tr_b16 a[86:87], v21 offset:40960
  v_mfma_f32_16x16x32_bf16 v[88:91], a[0:3], a[56:59], v[88:91]
  s_add_u32 s88, s88, s90
  s_add_u32 s89, s89, 1
  s_cmp_eq_u32 s89, 3
  s_cselect_b32 s89, 0, s89
  s_cselect_b32 s90, s91, s92
  v_mfma_f32_16x16x32_bf16 v[96:99], a[4:7], a[56:59], v[96:99]
  v_add_u32 v16, s90, v16
  v_add_u32 v17, s90, v17
  v_mfma_f32_16x16x32_bf16 v[104:107], a[8:11], a[56:59], v[104:107]
  v_add_u32 v18, s90, v18
  v_add_u32 v19, s90, v19
  v_mfma_f32_16x16x32_bf16 v[112:115], a[12:15], a[56:59], v[112:115]
  v_add_u32 v20, s90, v20
  v_add_u32 v21, s90, v21
  v_mfma_f32_16x16x32_bf16 v[120:123], a[16:19], a[56:59], v[120:123]
  v_mfma_f32_16x16x32_bf16 v[92:95], a[0:3], a[60:63], v[92:95]
  v_mfma_f32_16x16x32_bf16 v[100:103], a[4:7], a[60:63], v[100:103]
  v_mfma_f32_16x16x32_bf16 v[108:111], a[8:11], a[60:63], v[108:111]
  v_mfma_f32_16x16x32_bf16 v[116:119], a[12:15], a[60:63], v[116:119]
  v_mfma_f32_16x16x32_bf16 v[124:127], a[16:19], a[60:63], v[124:127]
  s_waitcnt vmcnt(13) lgkmcnt(0)
  s_barrier
  v_mfma_f32_16x16x32_bf16 v[24:27], a[64:67], a[20:23], v[24:27]
  s_mov_b32 m0, s88
  ds_read_b128 a[0:3], v16 offset:0
  ds_read_b64_tr_b16 a[40:41], v20 offset:18432
  v_mfma_f32_16x16x32_bf16 v[32:35], a[64:67], a[24:27], v[32:35]
  buffer_load_dwordx4 v4, s[8:11], s30 offen offset:0 lds
  ds_read_b64_tr_b16 a[42:43], v20 offset:20480
  v_mfma_f32_16x16x32_bf16 v[40:43], a[64:67], a[28:31], v[40:43]
  ds_read_b128 a[4:7], v16 offset:2048
  v_mfma_f32_16x16x32_bf16 v[48:51], a[64:67], a[32:35], v[48:51]
  ds_read_b128 a[8:11], v16 offset:4096
  v_mfma_f32_16x16x32_bf16 v[28:31], a[68:71], a[20:23], v[28:31]
  buffer_load_dwordx4 v5, s[8:11], s30 offen offset:1024 lds
  ds_read_b128 a[12:15], v16 offset:6144
  v_mfma_f32_16x16x32_bf16 v[36:39], a[68:71], a[24:27], v[36:39]
  ds_read_b64_tr_b16 a[44:45], v21 offset:18432
  v_mfma_f32_16x16x32_bf16 v[44:47], a[68:71], a[28:31], v[44:47]
  ds_read_b64_tr_b16 a[46:47], v21 offset:20480
  v_mfma_f32_16x16x32_bf16 v[52:55], a[68:71], a[32:35], v[52:55]
  ds_read_b64_tr_b16 a[48:49], v20 offset:26624
  v_mfma_f32_16x16x32_bf16 v[56:59], a[72:75], a[20:23], v[56:59]
  buffer_load_dwordx4 v6, s[8:11], s30 offen offset:2048 lds
  ds_read_b64_tr_b16 a[50:51], v20 offset:28672
  v_mfma_f32_16x16x32_bf16 v[64:67], a[72:75], a[24:27], v[64:67]
  ds_read_b64_tr_b16 a[52:53], v21 offset:26624
  v_mfma_f32_16x16x32_bf16 v[72:75], a[72:75], a[28:31], v[72:75]
  ds_read_b64_tr_b16 a[54:55], v21 offset:28672
  v_mfma_f32_16x16x32_bf16 v[80:83], a[72:75], a[32:35], v[80:83]
  ds_read_b64_tr_b16 a[56:57], v20 offset:34816
  v_mfma_f32_16x16x32_bf16 v[60:63], a[76:79], a[20:23], v[60:63]
  buffer_load_dwordx4 v7, s[8:11], s30 offen offset:3072 lds
  ds_read_b64_tr_b16 a[58:59], v20 offset:36864
  v_mfma_f32_16x16x32_bf16 v[68:71], a[76:79], a[24:27], v[68:71]
  s_add_u32 s30, s30, 128
  s_and_b32 s30, s30, 2047
  s_add_u32 m0, s88, s26
  v_mfma_f32_16x16x32_bf16 v[76:79], a[76:79], a[28:31], v[76:79]
  ds_read_b128 a[16:19], v18 offset:0
  ds_read_b64_tr_b16 a[60:61], v21 offset:34816
  v_mfma_f32_16x16x32_bf16 v[84:87], a[76:79], a[32:35], v[84:87]
  ds_read_b64_tr_b16 a[62:63], v21 offset:36864
  v_mfma_f32_16x16x32_bf16 v[88:91], a[20:23], a[80:83], v[88:91]
  buffer_load_dwordx4 v8, s[20:23], s31 offen offset:0 lds
  v_mfma_f32_16x16x32_bf16 v[96:99], a[24:27], a[80:83], v[96:99]
  v_mfma_f32_16x16x32_bf16 v[104:107], a[28:31], a[80:83], v[104:107]
  v_mfma_f32_16x16x32_bf16 v[112:115], a[32:35], a[80:83], v[112:115]
  v_mfma_f32_16x16x32_bf16 v[120:123], a[36:39], a[80:83], v[120:123]
  buffer_load_dwordx4 v9, s[20:23], s31 offen offset:1024 lds
  v_mfma_f32_16x16x32_bf16 v[92:95], a[20:23], a[84:87], v[92:95]
  v_mfma_f32_16x16x32_bf16 v[100:103], a[24:27], a[84:87], v[100:103]
  v_mfma_f32_16x16x32_bf16 v[108:111], a[28:31], a[84:87], v[108:111]
  v_mfma_f32_16x16x32_bf16 v[116:119], a[32:35], a[84:87], v[116:119]
  v_mfma_f32_16x16x32_bf16 v[124:127], a[36:39], a[84:87], v[124:127]
  s_waitcnt lgkmcnt(0)
  v_mfma_f32_16x16x32_bf16 v[24:27], a[40:43], a[0:3], v[24:27]
  buffer_load_dwordx4 v10, s[20:23], s31 offen offset:2048 lds
  ds_read_b128 a[20:23], v17 offset:0
  v_mfma_f32_16x16x32_bf16 v[32:35], a[40:43], a[4:7], v[32:35]
  s_add_u32 m0, s88, s27
  ds_read_b64_tr_b16 a[64:65], v20 offset:22528
  ds_read_b64_tr_b16 a[66:67], v20 offset:24576
  v_mfma_f32_16x16x32_bf16 v[40:43], a[40:43], a[8:11], v[40:43]
  ds_read_b128 a[24:27], v17 offset:2048
  v_mfma_f32_16x16x32_bf16 v[48:51], a[40:43], a[12:15], v[48:51]
  buffer_load_dwordx4 v11, s[20:23], s31 offen offset:0 lds
  ds_read_b128 a[28:31], v17 offset:4096
  v_mfma_f32_16x16x32_bf16 v[28:31], a[44:47], a[0:3], v[28:31]
  ds_read_b128 a[32:35], v17 offset:6144
  v_mfma_f32_16x16x32_bf16 v[36:39], a[44:47], a[4:7], v[36:39]
  ds_read_b64_tr_b16 a[68:69], v21 offset:22528
  v_mfma_f32_16x16x32_bf16 v[44:47], a[44:47], a[8:11], v[44:47]
  ds_read_b64_tr_b16 a[70:71], v21 offset:24576
  v_mfma_f32_16x16x32_bf16 v[52:55], a[44:47], a[12:15], v[52:55]
  buffer_load_dwordx4 v12, s[20:23], s31 offen offset:1024 lds
  ds_read_b64_tr_b16 a[72:73], v20 offset:30720
  v_mfma_f32_16x16x32_bf16 v[56:59], a[48:51], a[0:3], v[56:59]
  ds_read_b64_tr_b16 a[74:75], v20 offset:32768
  v_mfma_f32_16x16x32_bf16 v[64:67], a[48:51], a[4:7], v[64:67]
  ds_read_b64_tr_b16 a[76:77], v21 offset:30720
  v_mfma_f32_16x16x32_bf16 v[72:75], a[48:51], a[8:11], v[72:75]
  ds_read_b64_tr_b16 a[78:79], v21 offset:32768
  v_mfma_f32_16x16x32_bf16 v[80:83], a[48:51], a[12:15], v[80:83]
  buffer_load_dwordx4 v13, s[20:23], s31 offen offset:2048 lds
  ds_read_b64_tr_b16 a[80:81], v20 offset:38912
  v_mfma_f32_16x16x32_bf16 v[60:63], a[52:55], a[0:3], v[60:63]
  s_add_u32 s31, s31, 393216
  s_cmp_ge_u32 s31, 6291456
  s_cselect_b32 s29, 6291456, 0
  v_mfma_f32_16x16x32_bf16 v[68:71], a[52:55], a[4:7], v[68:71]
  s_sub_u32 s31, s31, s29
  s_add_u32 s60, s63, 36864
  ds_read_b64_tr_b16 a[82:83], v20 offset:40960
  v_mfma_f32_16x16x32_bf16 v[76:79], a[52:55], a[8:11], v[76:79]
  ds_read_b128 a[36:39], v19 offset:0
  ds_read_b64_tr_b16 a[84:85], v21 offset:38912
  v_mfma_f32_16x16x32_bf16 v[84:87], a[52:55], a[12:15], v[84:87]
  buffer_store_dwordx4 v[208:211], v2, s[16:19], s60 offen offset:0 sc1
  ds_read_b64_tr_b16 a[86:87], v21 offset:40960
  v_mfma_f32_16x16x32_bf16 v[88:91], a[0:3], a[56:59], v[88:91]
  s_add_u32 s88, s88, s90
  s_add_u32 s89, s89, 1
  s_cmp_eq_u32 s89, 3
  s_cselect_b32 s89, 0, s89
  s_cselect_b32 s90, s91, s92
  v_mfma_f32_16x16x32_bf16 v[96:99], a[4:7], a[56:59], v[96:99]
  v_add_u32 v16, s90, v16
  v_add_u32 v17, s90, v17
  v_mfma_f32_16x16x32_bf16 v[104:107], a[8:11], a[56:59], v[104:107]
  v_add_u32 v18, s90, v18
  v_add_u32 v19, s90, v19
  v_mfma_f32_16x16x32_bf16 v[112:115], a[12:15], a[56:59], v[112:115]
  v_add_u32 v20, s90, v20
  v_add_u32 v21, s90, v21
  v_mfma_f32_16x16x32_bf16 v[120:123], a[16:19], a[56:59], v[120:123]
  v_mfma_f32_16x16x32_bf16 v[92:95], a[0:3], a[60:63], v[92:95]
  v_mfma_f32_16x16x32_bf16 v[100:103], a[4:7], a[60:63], v[100:103]
  v_mfma_f32_16x16x32_bf16 v[108:111], a[8:11], a[60:63], v[108:111]
  v_mfma_f32_16x16x32_bf16 v[116:119], a[12:15], a[60:63], v[116:119]
  v_mfma_f32_16x16x32_bf16 v[124:127], a[16:19], a[60:63], v[124:127]
  s_waitcnt vmcnt(13) lgkmcnt(0)
  s_barrier
  v_mfma_f32_16x16x32_bf16 v[24:27], a[64:67], a[20:23], v[24:27]
  s_mov_b32 m0, s88
  ds_read_b128 a[0:3], v16 offset:0
  ds_read_b64_tr_b16 a[40:41], v20 offset:18432
  v_mfma_f32_16x16x32_bf16 v[32:35], a[64:67], a[24:27], v[32:35]
  buffer_load_dwordx4 v4, s[8:11], s30 offen offset:0 lds
  ds_read_b64_tr_b16 a[42:43], v20 offset:20480
  v_mfma_f32_16x16x32_bf16 v[40:43], a[64:67], a[28:31], v[40:43]
  ds_read_b128 a[4:7], v16 offset:2048
  v_mfma_f32_16x16x32_bf16 v[48:51], a[64:67], a[32:35], v[48:51]
  ds_read_b128 a[8:11], v16 offset:4096
  v_mfma_f32_16x16x32_bf16 v[28:31], a[68:71], a[20:23], v[28:31]
  buffer_load_dwordx4 v5, s[8:11], s30 offen offset:1024 lds
  ds_read_b128 a[12:15], v16 offset:6144
  v_mfma_f32_16x16x32_bf16 v[36:39], a[68:71], a[24:27], v[36:39]
  ds_read_b64_tr_b16 a[44:45], v21 offset:18432
  v_mfma_f32_16x16x32_bf16 v[44:47], a[68:71], a[28:31], v[44:47]
  ds_read_b64_tr_b16 a[46:47], v21 offset:20480
  v_mfma_f32_16x16x32_bf16 v[52:55], a[68:71], a[32:35], v[52:55]
  ds_read_b64_tr_b16 a[48:49], v20 offset:26624
  v_mfma_f32_16x16x32_bf16 v[56:59], a[72:75], a[20:23], v[56:59]
  buffer_load_dwordx4 v6, s[8:11], s30 offen offset:2048 lds
  ds_read_b64_tr_b16 a[50:51], v20 offset:28672
  v_mfma_f32_16x16x32_bf16 v[64:67], a[72:75], a[24:27], v[64:67]
  ds_read_b64_tr_b16 a[52:53], v21 offset:26624
  v_mfma_f32_16x16x32_bf16 v[72:75], a[72:75], a[28:31], v[72:75]
  ds_read_b64_tr_b16 a[54:55], v21 offset:28672
  v_mfma_f32_16x16x32_bf16 v[80:83], a[72:75], a[32:35], v[80:83]
  ds_read_b64_tr_b16 a[56:57], v20 offset:34816
  v_mfma_f32_16x16x32_bf16 v[60:63], a[76:79], a[20:23], v[60:63]
  buffer_load_dwordx4 v7, s[8:11], s30 offen offset:3072 lds
  ds_read_b64_tr_b16 a[58:59], v20 offset:36864
  v_mfma_f32_16x16x32_bf16 v[68:71], a[76:79], a[24:27], v[68:71]
  s_add_u32 s30, s30, 128
  s_and_b32 s30, s30, 2047
  s_add_u32 m0, s88, s26
  v_mfma_f32_16x16x32_bf16 v[76:79], a[76:79], a[28:31], v[76:79]
  ds_read_b128 a[16:19], v18 offset:0
  ds_read_b64_tr_b16 a[60:61], v21 offset:34816
  v_mfma_f32_16x16x32_bf16 v[84:87], a[76:79], a[32:35], v[84:87]
  ds_read_b64_tr_b16 a[62:63], v21 offset:36864
  v_mfma_f32_16x16x32_bf16 v[88:91], a[20:23], a[80:83], v[88:91]
  buffer_load_dwordx4 v8, s[20:23], s31 offen offset:0 lds
  v_mfma_f32_16x16x32_bf16 v[96:99], a[24:27], a[80:83], v[96:99]
  v_mfma_f32_16x16x32_bf16 v[104:107], a[28:31], a[80:83], v[104:107]
  v_mfma_f32_16x16x32_bf16 v[112:115], a[32:35], a[80:83], v[112:115]
  v_mfma_f32_16x16x32_bf16 v[120:123], a[36:39], a[80:83], v[120:123]
  buffer_load_dwordx4 v9, s[20:23], s31 offen offset:1024 lds
  v_mfma_f32_16x16x32_bf16 v[92:95], a[20:23], a[84:87], v[92:95]
  v_mfma_f32_16x16x32_bf16 v[100:103], a[24:27], a[84:87], v[100:103]
  v_mfma_f32_16x16x32_bf16 v[108:111], a[28:31], a[84:87], v[108:111]
  v_mfma_f32_16x16x32_bf16 v[116:119], a[32:35], a[84:87], v[116:119]
  v_mfma_f32_16x16x32_bf16 v[124:127], a[36:39], a[84:87], v[124:127]
  s_waitcnt lgkmcnt(0)
  v_mfma_f32_16x16x32_bf16 v[24:27], a[40:43], a[0:3], v[24:27]
  buffer_load_dwordx4 v10, s[20:23], s31 offen offset:2048 lds
  ds_read_b128 a[20:23], v17 offset:0
  v_mfma_f32_16x16x32_bf16 v[32:35], a[40:43], a[4:7], v[32:35]
  s_add_u32 m0, s88, s27
  ds_read_b64_tr_b16 a[64:65], v20 offset:22528
  ds_read_b64_tr_b16 a[66:67], v20 offset:24576
  v_mfma_f32_16x16x32_bf16 v[40:43], a[40:43], a[8:11], v[40:43]
  ds_read_b128 a[24:27], v17 offset:2048
  v_mfma_f32_16x16x32_bf16 v[48:51], a[40:43], a[12:15], v[48:51]
  buffer_load_dwordx4 v11, s[20:23], s31 offen offset:0 lds
  ds_read_b128 a[28:31], v17 offset:4096
  v_mfma_f32_16x16x32_bf16 v[28:31], a[44:47], a[0:3], v[28:31]
  ds_read_b128 a[32:35], v17 offset:6144
  v_mfma_f32_16x16x32_bf16 v[36:39], a[44:47], a[4:7], v[36:39]
  ds_read_b64_tr_b16 a[68:69], v21 offset:22528
  v_mfma_f32_16x16x32_bf16 v[44:47], a[44:47], a[8:11], v[44:47]
  buffer_load_dwordx4 v12, s[20:23], s31 offen offset:1024 lds
  ds_read_b64_tr_b16 a[70:71], v21 offset:24576
  v_mfma_f32_16x16x32_bf16 v[52:55], a[44:47], a[12:15], v[52:55]
  ds_read_b64_tr_b16 a[72:73], v20 offset:30720
  v_mfma_f32_16x16x32_bf16 v[56:59], a[48:51], a[0:3], v[56:59]
  ds_read_b64_tr_b16 a[74:75], v20 offset:32768
  v_mfma_f32_16x16x32_bf16 v[64:67], a[48:51], a[4:7], v[64:67]
  buffer_load_dwordx4 v13, s[20:23], s31 offen offset:2048 lds
  ds_read_b64_tr_b16 a[76:77], v21 offset:30720
  v_mfma_f32_16x16x32_bf16 v[72:75], a[48:51], a[8:11], v[72:75]
  s_add_u32 s31, s31, 393216
  s_cmp_ge_u32 s31, 6291456
  s_cselect_b32 s29, 6291456, 0
  v_mfma_f32_16x16x32_bf16 v[80:83], a[48:51], a[12:15], v[80:83]
  s_sub_u32 s31, s31, s29
  s_add_u32 s60, s63, 36864
  ds_read_b64_tr_b16 a[78:79], v21 offset:32768
  v_mfma_f32_16x16x32_bf16 v[60:63], a[52:55], a[0:3], v[60:63]
  buffer_store_dwordx4 v[212:215], v2, s[16:19], s60 offen offset:1024 sc1
  ds_read_b64_tr_b16 a[80:81], v20 offset:38912
  v_mfma_f32_16x16x32_bf16 v[68:71], a[52:55], a[4:7], v[68:71]
  ds_read_b64_tr_b16 a[82:83], v20 offset:40960
  ds_read_b128 a[36:39], v19 offset:0
  v_mfma_f32_16x16x32_bf16 v[76:79], a[52:55], a[8:11], v[76:79]
  ds_read_b64_tr_b16 a[84:85], v21 offset:38912
  v_mfma_f32_16x16x32_bf16 v[84:87], a[52:55], a[12:15], v[84:87]
  buffer_store_dwordx4 v[216:219], v2, s[16:19], s60 offen offset:2048 sc1
  ds_read_b64_tr_b16 a[86:87], v21 offset:40960
  v_mfma_f32_16x16x32_bf16 v[88:91], a[0:3], a[56:59], v[88:91]
  s_add_u32 s88, s88, s90
  s_add_u32 s89, s89, 1
  s_cmp_eq_u32 s89, 3
  s_cselect_b32 s89, 0, s89
  s_cselect_b32 s90, s91, s92
  v_mfma_f32_16x16x32_bf16 v[96:99], a[4:7], a[56:59], v[96:99]
  v_add_u32 v16, s90, v16
  v_add_u32 v17, s90, v17
  v_mfma_f32_16x16x32_bf16 v[104:107], a[8:11], a[56:59], v[104:107]
  v_add_u32 v18, s90, v18
  v_add_u32 v19, s90, v19
  v_mfma_f32_16x16x32_bf16 v[112:115], a[12:15], a[56:59], v[112:115]
  v_add_u32 v20, s90, v20
  v_add_u32 v21, s90, v21
  v_mfma_f32_16x16x32_bf16 v[120:123], a[16:19], a[56:59], v[120:123]
  v_mfma_f32_16x16x32_bf16 v[92:95], a[0:3], a[60:63], v[92:95]
  v_mfma_f32_16x16x32_bf16 v[100:103], a[4:7], a[60:63], v[100:103]
  v_mfma_f32_16x16x32_bf16 v[108:111], a[8:11], a[60:63], v[108:111]
  v_mfma_f32_16x16x32_bf16 v[116:119], a[12:15], a[60:63], v[116:119]
  v_mfma_f32_16x16x32_bf16 v[124:127], a[16:19], a[60:63], v[124:127]
  s_waitcnt vmcnt(13) lgkmcnt(0)
  s_barrier
  v_accvgpr_read_b32 v4, a222
  v_accvgpr_read_b32 v5, a223
  v_accvgpr_read_b32 v6, a224
  v_accvgpr_read_b32 v7, a225
  v_accvgpr_read_b32 v8, a226
  v_accvgpr_read_b32 v9, a227
  v_accvgpr_read_b32 v10, a228
  v_accvgpr_read_b32 v11, a229
  s_mov_b32 s8, s64
  s_mov_b32 s9, s65
  s_mov_b32 s10, 4194304
  s_mov_b32 s11, 0x00020000
  s_mov_b32 s12, s68
  s_mov_b32 s13, s69
  s_mov_b32 s14, 8388608
  s_mov_b32 s15, 0x00020000
  s_and_b32 s4, s2, 7
  s_lshl_b32 s4, s4, 1
  s_lshr_b32 s5, s2, 6
  s_add_u32 s5, s5, s25
  s_and_b32 s5, s5, 3
  s_mul_i32 s5, s5, 1
  s_add_u32 s4, s4, s5
  s_and_b32 s4, s4, 15
  s_lshl_b32 s49, s4, 7
  s_lshl_b32 s48, s4, 19
  s_lshl_b32 s50, s25, 18
  s_sub_u32 s51, 3932160, s50
  s_or_b32 s46, s50, s49
  s_or_b32 s47, s51, s49
  s_lshl_b32 s41, s3, 12
  s_lshl_b32 s36, s3, 13
  s_add_u32 s36, s36, 98304
  v_mfma_f32_16x16x32_bf16 v[24:27], a[64:67], a[20:23], v[24:27]
  s_mov_b32 m0, s41
  ds_read_b128 a[0:3], v16 offset:0
  ds_read_b64_tr_b16 a[40:41], v20 offset:18432
  v_mfma_f32_16x16x32_bf16 v[32:35], a[64:67], a[24:27], v[32:35]
  buffer_load_dwordx4 v8, s[12:15], s48 offen offset:0 lds
  ds_read_b64_tr_b16 a[42:43], v20 offset:20480
  v_mfma_f32_16x16x32_bf16 v[40:43], a[64:67], a[28:31], v[40:43]
  ds_read_b128 a[4:7], v16 offset:2048
  v_mfma_f32_16x16x32_bf16 v[48:51], a[64:67], a[32:35], v[48:51]
  ds_read_b128 a[8:11], v16 offset:4096
  v_mfma_f32_16x16x32_bf16 v[28:31], a[68:71], a[20:23], v[28:31]
  ds_read_b128 a[12:15], v16 offset:6144
  v_mfma_f32_16x16x32_bf16 v[36:39], a[68:71], a[24:27], v[36:39]
  buffer_load_dwordx4 v9, s[12:15], s48 offen offset:1024 lds
  ds_read_b64_tr_b16 a[44:45], v21 offset:18432
  v_mfma_f32_16x16x32_bf16 v[44:47], a[68:71], a[28:31], v[44:47]
  ds_read_b64_tr_b16 a[46:47], v21 offset:20480
  v_mfma_f32_16x16x32_bf16 v[52:55], a[68:71], a[32:35], v[52:55]
  ds_read_b64_tr_b16 a[48:49], v20 offset:26624
  v_mfma_f32_16x16x32_bf16 v[56:59], a[72:75], a[20:23], v[56:59]
  ds_read_b64_tr_b16 a[50:51], v20 offset:28672
  v_mfma_f32_16x16x32_bf16 v[64:67], a[72:75], a[24:27], v[64:67]
  ds_read_b64_tr_b16 a[52:53], v21 offset:26624
  v_mfma_f32_16x16x32_bf16 v[72:75], a[72:75], a[28:31], v[72:75]
  buffer_load_dwordx4 v10, s[12:15], s48 offen offset:2048 lds
  ds_read_b64_tr_b16 a[54:55], v21 offset:28672
  v_mfma_f32_16x16x32_bf16 v[80:83], a[72:75], a[32:35], v[80:83]
  ds_read_b64_tr_b16 a[56:57], v20 offset:34816
  v_mfma_f32_16x16x32_bf16 v[60:63], a[76:79], a[20:23], v[60:63]
  ds_read_b64_tr_b16 a[58:59], v20 offset:36864
  v_mfma_f32_16x16x32_bf16 v[68:71], a[76:79], a[24:27], v[68:71]
  ds_read_b128 a[16:19], v18 offset:0
  v_mfma_f32_16x16x32_bf16 v[76:79], a[76:79], a[28:31], v[76:79]
  ds_read_b64_tr_b16 a[60:61], v21 offset:34816
  v_mfma_f32_16x16x32_bf16 v[84:87], a[76:79], a[32:35], v[84:87]
  buffer_load_dwordx4 v11, s[12:15], s48 offen offset:3072 lds
  ds_read_b64_tr_b16 a[62:63], v21 offset:36864
  v_mfma_f32_16x16x32_bf16 v[88:91], a[20:23], a[80:83], v[88:91]
  s_add_u32 s48, s48, 524288
  s_and_b32 s48, s48, 8388607
  s_add_u32 m0, s41, 16384
  v_mfma_f32_16x16x32_bf16 v[96:99], a[24:27], a[80:83], v[96:99]
  v_mfma_f32_16x16x32_bf16 v[104:107], a[28:31], a[80:83], v[104:107]
  v_mfma_f32_16x16x32_bf16 v[112:115], a[32:35], a[80:83], v[112:115]
  v_mfma_f32_16x16x32_bf16 v[120:123], a[36:39], a[80:83], v[120:123]
  buffer_load_dwordx4 v8, s[12:15], s48 offen offset:0 lds
  v_mfma_f32_16x16x32_bf16 v[92:95], a[20:23], a[84:87], v[92:95]
  v_mfma_f32_16x16x32_bf16 v[100:103], a[24:27], a[84:87], v[100:103]
  v_mfma_f32_16x16x32_bf16 v[108:111], a[28:31], a[84:87], v[108:111]
  v_mfma_f32_16x16x32_bf16 v[116:119], a[32:35], a[84:87], v[116:119]
  v_mfma_f32_16x16x32_bf16 v[124:127], a[36:39], a[84:87], v[124:127]
  s_waitcnt lgkmcnt(0)
  v_mfma_f32_16x16x32_bf16 v[24:27], a[40:43], a[0:3], v[24:27]
  buffer_load_dwordx4 v9, s[12:15], s48 offen offset:1024 lds
  ds_read_b128 a[20:23], v17 offset:0
  v_mfma_f32_16x16x32_bf16 v[32:35], a[40:43], a[4:7], v[32:35]
  ds_read_b64_tr_b16 a[64:65], v20 offset:22528
  ds_read_b64_tr_b16 a[66:67], v20 offset:24576
  v_mfma_f32_16x16x32_bf16 v[40:43], a[40:43], a[8:11], v[40:43]
  ds_read_b128 a[24:27], v17 offset:2048
  v_mfma_f32_16x16x32_bf16 v[48:51], a[40:43], a[12:15], v[48:51]
  ds_read_b128 a[28:31], v17 offset:4096
  v_mfma_f32_16x16x32_bf16 v[28:31], a[44:47], a[0:3], v[28:31]
  buffer_load_dwordx4 v10, s[12:15], s48 offen offset:2048 lds
  ds_read_b128 a[32:35], v17 offset:6144
  v_mfma_f32_16x16x32_bf16 v[36:39], a[44:47], a[4:7], v[36:39]
  ds_read_b64_tr_b16 a[68:69], v21 offset:22528
  v_mfma_f32_16x16x32_bf16 v[44:47], a[44:47], a[8:11], v[44:47]
  ds_read_b64_tr_b16 a[70:71], v21 offset:24576
  v_mfma_f32_16x16x32_bf16 v[52:55], a[44:47], a[12:15], v[52:55]
  ds_read_b64_tr_b16 a[72:73], v20 offset:30720
  v_mfma_f32_16x16x32_bf16 v[56:59], a[48:51], a[0:3], v[56:59]
  ds_read_b64_tr_b16 a[74:75], v20 offset:32768
  v_mfma_f32_16x16x32_bf16 v[64:67], a[48:51], a[4:7], v[64:67]
  buffer_load_dwordx4 v11, s[12:15], s48 offen offset:3072 lds
  ds_read_b64_tr_b16 a[76:77], v21 offset:30720
  v_mfma_f32_16x16x32_bf16 v[72:75], a[48:51], a[8:11], v[72:75]
  s_add_u32 s48, s48, 524288
  s_and_b32 s48, s48, 8388607
  s_add_u32 s60, s63, 36864
  v_mfma_f32_16x16x32_bf16 v[80:83], a[48:51], a[12:15], v[80:83]
  ds_read_b64_tr_b16 a[78:79], v21 offset:32768
  ds_read_b64_tr_b16 a[80:81], v20 offset:38912
  v_mfma_f32_16x16x32_bf16 v[60:63], a[52:55], a[0:3], v[60:63]
  ds_read_b64_tr_b16 a[82:83], v20 offset:40960
  v_mfma_f32_16x16x32_bf16 v[68:71], a[52:55], a[4:7], v[68:71]
  ds_read_b128 a[36:39], v19 offset:0
  v_mfma_f32_16x16x32_bf16 v[76:79], a[52:55], a[8:11], v[76:79]
  buffer_store_dwordx4 v[220:223], v2, s[16:19], s60 offen offset:3072 sc1
  ds_read_b64_tr_b16 a[84:85], v21 offset:38912
  v_mfma_f32_16x16x32_bf16 v[84:87], a[52:55], a[12:15], v[84:87]
  s_add_u32 s88, s88, s90
  s_add_u32 s89, s89, 1
  ds_read_b64_tr_b16 a[86:87], v21 offset:40960
  v_mfma_f32_16x16x32_bf16 v[88:91], a[0:3], a[56:59], v[88:91]
  s_cmp_eq_u32 s89, 3
  s_cselect_b32 s89, 0, s89
  s_cselect_b32 s90, s91, s92
  v_mfma_f32_16x16x32_bf16 v[96:99], a[4:7], a[56:59], v[96:99]
  v_add_u32 v16, s90, v16
  v_add_u32 v17, s90, v17
  v_mfma_f32_16x16x32_bf16 v[104:107], a[8:11], a[56:59], v[104:107]
  v_add_u32 v18, s90, v18
  v_add_u32 v19, s90, v19
  v_mfma_f32_16x16x32_bf16 v[112:115], a[12:15], a[56:59], v[112:115]
  v_add_u32 v20, s90, v20
  v_add_u32 v21, s90, v21
  v_mfma_f32_16x16x32_bf16 v[120:123], a[16:19], a[56:59], v[120:123]
  v_mfma_f32_16x16x32_bf16 v[92:95], a[0:3], a[60:63], v[92:95]
  v_mfma_f32_16x16x32_bf16 v[100:103], a[4:7], a[60:63], v[100:103]
  v_mfma_f32_16x16x32_bf16 v[108:111], a[8:11], a[60:63], v[108:111]
  v_mfma_f32_16x16x32_bf16 v[116:119], a[12:15], a[60:63], v[116:119]
  v_mfma_f32_16x16x32_bf16 v[124:127], a[16:19], a[60:63], v[124:127]
  s_waitcnt vmcnt(11) lgkmcnt(0)
  s_barrier
  v_mfma_f32_16x16x32_bf16 v[24:27], a[64:67], a[20:23], v[24:27]
  s_mov_b32 m0, s36
  ds_read_b128 a[0:3], v16 offset:0
  ds_read_b64_tr_b16 a[40:41], v20 offset:18432
  v_mfma_f32_16x16x32_bf16 v[32:35], a[64:67], a[24:27], v[32:35]
  buffer_load_dwordx4 v4, s[8:11], s46 offen offset:0 lds
  ds_read_b64_tr_b16 a[42:43], v20 offset:20480
  v_mfma_f32_16x16x32_bf16 v[40:43], a[64:67], a[28:31], v[40:43]
  ds_read_b128 a[4:7], v16 offset:2048
  v_mfma_f32_16x16x32_bf16 v[48:51], a[64:67], a[32:35], v[48:51]
  ds_read_b128 a[8:11], v16 offset:4096
  v_mfma_f32_16x16x32_bf16 v[28:31], a[68:71], a[20:23], v[28:31]
  ds_read_b128 a[12:15], v16 offset:6144
  v_mfma_f32_16x16x32_bf16 v[36:39], a[68:71], a[24:27], v[36:39]
  buffer_load_dwordx4 v5, s[8:11], s46 offen offset:1024 lds
  ds_read_b64_tr_b16 a[44:45], v21 offset:18432
  v_mfma_f32_16x16x32_bf16 v[44:47], a[68:71], a[28:31], v[44:47]
  ds_read_b64_tr_b16 a[46:47], v21 offset:20480
  v_mfma_f32_16x16x32_bf16 v[52:55], a[68:71], a[32:35], v[52:55]
  ds_read_b64_tr_b16 a[48:49], v20 offset:26624
  v_mfma_f32_16x16x32_bf16 v[56:59], a[72:75], a[20:23], v[56:59]
  ds_read_b64_tr_b16 a[50:51], v20 offset:28672
  v_mfma_f32_16x16x32_bf16 v[64:67], a[72:75], a[24:27], v[64:67]
  ds_read_b64_tr_b16 a[52:53], v21 offset:26624
  v_mfma_f32_16x16x32_bf16 v[72:75], a[72:75], a[28:31], v[72:75]
  buffer_load_dwordx4 v6, s[8:11], s46 offen offset:2048 lds
  ds_read_b64_tr_b16 a[54:55], v21 offset:28672
  v_mfma_f32_16x16x32_bf16 v[80:83], a[72:75], a[32:35], v[80:83]
  ds_read_b64_tr_b16 a[56:57], v20 offset:34816
  v_mfma_f32_16x16x32_bf16 v[60:63], a[76:79], a[20:23], v[60:63]
  ds_read_b64_tr_b16 a[58:59], v20 offset:36864
  v_mfma_f32_16x16x32_bf16 v[68:71], a[76:79], a[24:27], v[68:71]
  ds_read_b128 a[16:19], v18 offset:0
  v_mfma_f32_16x16x32_bf16 v[76:79], a[76:79], a[28:31], v[76:79]
  ds_read_b64_tr_b16 a[60:61], v21 offset:34816
  v_mfma_f32_16x16x32_bf16 v[84:87], a[76:79], a[32:35], v[84:87]
  buffer_load_dwordx4 v7, s[8:11], s46 offen offset:3072 lds
  ds_read_b64_tr_b16 a[62:63], v21 offset:36864
  v_mfma_f32_16x16x32_bf16 v[88:91], a[20:23], a[80:83], v[88:91]
  s_add_u32 m0, s36, 4096
  v_mfma_f32_16x16x32_bf16 v[96:99], a[24:27], a[80:83], v[96:99]
  v_mfma_f32_16x16x32_bf16 v[104:107], a[28:31], a[80:83], v[104:107]
  v_mfma_f32_16x16x32_bf16 v[112:115], a[32:35], a[80:83], v[112:115]
  v_mfma_f32_16x16x32_bf16 v[120:123], a[36:39], a[80:83], v[120:123]
  buffer_load_dwordx4 v4, s[8:11], s47 offen offset:0 lds
  v_mfma_f32_16x16x32_bf16 v[92:95], a[20:23], a[84:87], v[92:95]
  v_mfma_f32_16x16x32_bf16 v[100:103], a[24:27], a[84:87], v[100:103]
  v_mfma_f32_16x16x32_bf16 v[108:111], a[28:31], a[84:87], v[108:111]
  v_mfma_f32_16x16x32_bf16 v[116:119], a[32:35], a[84:87], v[116:119]
  v_mfma_f32_16x16x32_bf16 v[124:127], a[36:39], a[84:87], v[124:127]
  s_waitcnt lgkmcnt(0)
  v_mfma_f32_16x16x32_bf16 v[24:27], a[40:43], a[0:3], v[24:27]
  buffer_load_dwordx4 v5, s[8:11], s47 offen offset:1024 lds
  ds_read_b128 a[20:23], v17 offset:0
  v_mfma_f32_16x16x32_bf16 v[32:35], a[40:43], a[4:7], v[32:35]
  ds_read_b64_tr_b16 a[64:65], v20 offset:22528
  ds_read_b64_tr_b16 a[66:67], v20 offset:24576
  v_mfma_f32_16x16x32_bf16 v[40:43], a[40:43], a[8:11], v[40:43]
  ds_read_b128 a[24:27], v17 offset:2048
  v_mfma_f32_16x16x32_bf16 v[48:51], a[40:43], a[12:15], v[48:51]
  ds_read_b128 a[28:31], v17 offset:4096
  v_mfma_f32_16x16x32_bf16 v[28:31], a[44:47], a[0:3], v[28:31]
  ds_read_b128 a[32:35], v17 offset:6144
  v_mfma_f32_16x16x32_bf16 v[36:39], a[44:47], a[4:7], v[36:39]
  buffer_load_dwordx4 v6, s[8:11], s47 offen offset:2048 lds
  ds_read_b64_tr_b16 a[68:69], v21 offset:22528
  v_mfma_f32_16x16x32_bf16 v[44:47], a[44:47], a[8:11], v[44:47]
  ds_read_b64_tr_b16 a[70:71], v21 offset:24576
  v_mfma_f32_16x16x32_bf16 v[52:55], a[44:47], a[12:15], v[52:55]
  ds_read_b64_tr_b16 a[72:73], v20 offset:30720
  v_mfma_f32_16x16x32_bf16 v[56:59], a[48:51], a[0:3], v[56:59]
  ds_read_b64_tr_b16 a[74:75], v20 offset:32768
  v_mfma_f32_16x16x32_bf16 v[64:67], a[48:51], a[4:7], v[64:67]
  ds_read_b64_tr_b16 a[76:77], v21 offset:30720
  v_mfma_f32_16x16x32_bf16 v[72:75], a[48:51], a[8:11], v[72:75]
  buffer_load_dwordx4 v7, s[8:11], s47 offen offset:3072 lds
  ds_read_b64_tr_b16 a[78:79], v21 offset:32768
  v_mfma_f32_16x16x32_bf16 v[80:83], a[48:51], a[12:15], v[80:83]
  s_add_u32 s49, s49, 128
  s_and_b32 s49, s49, 2047
  s_or_b32 s46, s50, s49
  v_mfma_f32_16x16x32_bf16 v[60:63], a[52:55], a[0:3], v[60:63]
  s_or_b32 s47, s51, s49
  s_add_u32 s60, s63, 40960
  ds_read_b64_tr_b16 a[80:81], v20 offset:38912
  v_mfma_f32_16x16x32_bf16 v[68:71], a[52:55], a[4:7], v[68:71]
  ds_read_b64_tr_b16 a[82:83], v20 offset:40960
  ds_read_b128 a[36:39], v19 offset:0
  v_mfma_f32_16x16x32_bf16 v[76:79], a[52:55], a[8:11], v[76:79]
  ds_read_b64_tr_b16 a[84:85], v21 offset:38912
  v_mfma_f32_16x16x32_bf16 v[84:87], a[52:55], a[12:15], v[84:87]
  buffer_store_dwordx4 v[224:227], v2, s[16:19], s60 offen offset:0 sc1
  ds_read_b64_tr_b16 a[86:87], v21 offset:40960
  v_mfma_f32_16x16x32_bf16 v[88:91], a[0:3], a[56:59], v[88:91]
  v_mfma_f32_16x16x32_bf16 v[96:99], a[4:7], a[56:59], v[96:99]
  v_mfma_f32_16x16x32_bf16 v[104:107], a[8:11], a[56:59], v[104:107]
  v_mfma_f32_16x16x32_bf16 v[112:115], a[12:15], a[56:59], v[112:115]
  v_mfma_f32_16x16x32_bf16 v[120:123], a[16:19], a[56:59], v[120:123]
  buffer_store_dwordx4 v[228:231], v2, s[16:19], s60 offen offset:1024 sc1
  v_mfma_f32_16x16x32_bf16 v[92:95], a[0:3], a[60:63], v[92:95]
  v_mfma_f32_16x16x32_bf16 v[100:103], a[4:7], a[60:63], v[100:103]
  v_mfma_f32_16x16x32_bf16 v[108:111], a[8:11], a[60:63], v[108:111]
  v_mfma_f32_16x16x32_bf16 v[116:119], a[12:15], a[60:63], v[116:119]
  v_mfma_f32_16x16x32_bf16 v[124:127], a[16:19], a[60:63], v[124:127]
  s_waitcnt lgkmcnt(0)
  s_barrier
  v_mfma_f32_16x16x32_bf16 v[24:27], a[64:67], a[20:23], v[24:27]
  s_add_u32 m0, s36, 32768
  v_mfma_f32_16x16x32_bf16 v[32:35], a[64:67], a[24:27], v[32:35]
  buffer_load_dwordx4 v4, s[8:11], s46 offen offset:0 lds
  v_mfma_f32_16x16x32_bf16 v[40:43], a[64:67], a[28:31], v[40:43]
  v_mfma_f32_16x16x32_bf16 v[48:51], a[64:67], a[32:35], v[48:51]
  buffer_load_dwordx4 v5, s[8:11], s46 offen offset:1024 lds
  v_mfma_f32_16x16x32_bf16 v[28:31], a[68:71], a[20:23], v[28:31]
  v_mfma_f32_16x16x32_bf16 v[36:39], a[68:71], a[24:27], v[36:39]
  v_mfma_f32_16x16x32_bf16 v[44:47], a[68:71], a[28:31], v[44:47]
  buffer_load_dwordx4 v6, s[8:11], s46 offen offset:2048 lds
  v_mfma_f32_16x16x32_bf16 v[52:55], a[68:71], a[32:35], v[52:55]
  v_mfma_f32_16x16x32_bf16 v[56:59], a[72:75], a[20:23], v[56:59]
  v_mfma_f32_16x16x32_bf16 v[64:67], a[72:75], a[24:27], v[64:67]
  buffer_load_dwordx4 v7, s[8:11], s46 offen offset:3072 lds
  v_mfma_f32_16x16x32_bf16 v[72:75], a[72:75], a[28:31], v[72:75]
  s_add_u32 m0, s36, 36864
  v_mfma_f32_16x16x32_bf16 v[80:83], a[72:75], a[32:35], v[80:83]
  v_mfma_f32_16x16x32_bf16 v[60:63], a[76:79], a[20:23], v[60:63]
  buffer_load_dwordx4 v4, s[8:11], s47 offen offset:0 lds
  v_mfma_f32_16x16x32_bf16 v[68:71], a[76:79], a[24:27], v[68:71]
  v_mfma_f32_16x16x32_bf16 v[76:79], a[76:79], a[28:31], v[76:79]
  v_mfma_f32_16x16x32_bf16 v[84:87], a[76:79], a[32:35], v[84:87]
  buffer_load_dwordx4 v5, s[8:11], s47 offen offset:1024 lds
  v_mfma_f32_16x16x32_bf16 v[88:91], a[20:23], a[80:83], v[88:91]
  v_mfma_f32_16x16x32_bf16 v[96:99], a[24:27], a[80:83], v[96:99]
  v_mfma_f32_16x16x32_bf16 v[104:107], a[28:31], a[80:83], v[104:107]
  buffer_load_dwordx4 v6, s[8:11], s47 offen offset:2048 lds
  v_mfma_f32_16x16x32_bf16 v[112:115], a[32:35], a[80:83], v[112:115]
  v_mfma_f32_16x16x32_bf16 v[120:123], a[36:39], a[80:83], v[120:123]
  v_mfma_f32_16x16x32_bf16 v[92:95], a[20:23], a[84:87], v[92:95]
  buffer_load_dwordx4 v7, s[8:11], s47 offen offset:3072 lds
  v_mfma_f32_16x16x32_bf16 v[100:103], a[24:27], a[84:87], v[100:103]
  s_add_u32 s49, s49, 128
  s_and_b32 s49, s49, 2047
  s_or_b32 s46, s50, s49
  v_mfma_f32_16x16x32_bf16 v[108:111], a[28:31], a[84:87], v[108:111]
  s_or_b32 s47, s51, s49
  v_mfma_f32_16x16x32_bf16 v[116:119], a[32:35], a[84:87], v[116:119]
  v_mfma_f32_16x16x32_bf16 v[124:127], a[36:39], a[84:87], v[124:127]
  s_and_b32 s4, s3, 1
  s_mul_i32 s4, s4, 3072
  s_add_u32 s4, s4, 49152
  v_add_u32 v196, s4, v2
  s_add_u32 s60, s63, 40960
  buffer_store_dwordx4 v[232:235], v2, s[16:19], s60 offen offset:2048 sc1
  v_cvt_pk_bf16_f32 v200, v120, v121
  v_cvt_pk_bf16_f32 v201, v122, v123
  v_cvt_pk_bf16_f32 v202, v124, v125
  v_cvt_pk_bf16_f32 v203, v126, v127
  ds_write_b128 v196, v[200:203] offset:2048
  v_and_b32 v197, 15, v1
  v_lshrrev_b32 v198, 4, v1
  v_lshlrev_b32 v198, 2, v198
  v_sub_u32 v197, v197, v198
  v_mov_b32 v198, 0xf149f2ca
  v_subrev_u32 v199, 0, v197
  v_and_b32 v184, 0x80000001, v199
  v_cmp_ne_u32 vcc, 0, v184
  s_nop 1
  v_cndmask_b32 v184, 0, v198, vcc
  v_add_u32 v199, 1, v199
  v_and_b32 v188, 0x80000001, v199
  v_cmp_ne_u32 vcc, 0x80000001, v188
  s_nop 1
  v_cndmask_b32 v188, 0, v198, vcc
  buffer_store_dwordx4 v[236:239], v2, s[16:19], s60 offen offset:3072 sc1
  v_subrev_u32 v199, 1, v197
  v_and_b32 v185, 0x80000001, v199
  v_cmp_ne_u32 vcc, 0, v185
  s_nop 1
  v_cndmask_b32 v185, 0, v198, vcc
  v_add_u32 v199, 1, v199
  v_and_b32 v189, 0x80000001, v199
  v_cmp_ne_u32 vcc, 0x80000001, v189
  s_nop 1
  v_cndmask_b32 v189, 0, v198, vcc
  v_subrev_u32 v199, 2, v197
  v_and_b32 v186, 0x80000001, v199
  v_cmp_ne_u32 vcc, 0, v186
  s_nop 1
  v_cndmask_b32 v186, 0, v198, vcc
  v_add_u32 v199, 1, v199
  v_and_b32 v190, 0x80000001, v199
  v_cmp_ne_u32 vcc, 0x80000001, v190
  s_nop 1
  v_cndmask_b32 v190, 0, v198, vcc
  v_subrev_u32 v199, 3, v197
  v_and_b32 v187, 0x80000001, v199
  v_cmp_ne_u32 vcc, 0, v187
  s_nop 1
  v_cndmask_b32 v187, 0, v198, vcc
  v_add_u32 v199, 1, v199
  v_and_b32 v191, 0x80000001, v199
  v_cmp_ne_u32 vcc, 0x80000001, v191
  s_nop 1
  v_cndmask_b32 v191, 0, v198, vcc
  s_mov_b32 s6, 0x3e8293ee
  s_mov_b32 s7, s6
  v_pk_mul_f32 v[24:25], v[24:25], s[6:7]
  v_pk_mul_f32 v[26:27], v[26:27], s[6:7]
  s_add_u32 s60, s63, 45056
  buffer_store_dwordx4 v[240:243], v2, s[16:19], s60 offen offset:0 sc1
  v_pk_mul_f32 v[28:29], v[28:29], s[6:7]
  v_pk_mul_f32 v[30:31], v[30:31], s[6:7]
  v_cvt_pk_bf16_f32 v128, v24, v25
  v_cvt_pk_bf16_f32 v129, v26, v27
  v_cvt_pk_bf16_f32 v130, v28, v29
  v_cvt_pk_bf16_f32 v131, v30, v31
  v_pk_mul_f32 v[32:33], v[32:33], s[6:7]
  v_pk_mul_f32 v[34:35], v[34:35], s[6:7]
  v_pk_mul_f32 v[36:37], v[36:37], s[6:7]
  v_pk_mul_f32 v[38:39], v[38:39], s[6:7]
  v_cvt_pk_bf16_f32 v132, v32, v33
  v_cvt_pk_bf16_f32 v133, v34, v35
  buffer_store_dwordx4 v[244:247], v2, s[16:19], s60 offen offset:1024 sc1
  v_cvt_pk_bf16_f32 v134, v36, v37
  v_cvt_pk_bf16_f32 v135, v38, v39
  v_pk_mul_f32 v[40:41], v[40:41], s[6:7]
  v_pk_mul_f32 v[42:43], v[42:43], s[6:7]
  v_pk_mul_f32 v[44:45], v[44:45], s[6:7]
  v_pk_mul_f32 v[46:47], v[46:47], s[6:7]
  v_cvt_pk_bf16_f32 v136, v40, v41
  v_cvt_pk_bf16_f32 v137, v42, v43
  v_cvt_pk_bf16_f32 v138, v44, v45
  v_cvt_pk_bf16_f32 v139, v46, v47
  v_pk_mul_f32 v[48:49], v[48:49], s[6:7]
  v_pk_mul_f32 v[50:51], v[50:51], s[6:7]
  v_pk_mul_f32 v[52:53], v[52:53], s[6:7]
  buffer_store_dwordx4 v[248:251], v2, s[16:19], s60 offen offset:2048 sc1
  v_pk_mul_f32 v[54:55], v[54:55], s[6:7]
  v_cvt_pk_bf16_f32 v140, v48, v49
  v_cvt_pk_bf16_f32 v141, v50, v51
  v_cvt_pk_bf16_f32 v142, v52, v53
  v_cvt_pk_bf16_f32 v143, v54, v55
  v_cvt_pk_bf16_f32 v148, v56, v57
  v_cvt_pk_bf16_f32 v149, v58, v59
  v_cvt_pk_bf16_f32 v166, v88, v89
  v_cvt_pk_bf16_f32 v167, v90, v91
  v_cvt_pk_bf16_f32 v150, v60, v61
  v_cvt_pk_bf16_f32 v151, v62, v63
  v_cvt_pk_bf16_f32 v176, v92, v93
  buffer_store_dwordx4 v[252:255], v2, s[16:19], s60 offen offset:3072 sc1
  v_cvt_pk_bf16_f32 v177, v94, v95
  v_cvt_pk_bf16_f32 v152, v64, v65
  v_cvt_pk_bf16_f32 v153, v66, v67
  v_cvt_pk_bf16_f32 v168, v96, v97
  v_cvt_pk_bf16_f32 v169, v98, v99
  v_cvt_pk_bf16_f32 v154, v68, v69
  v_cvt_pk_bf16_f32 v155, v70, v71
  v_cvt_pk_bf16_f32 v178, v100, v101
  v_cvt_pk_bf16_f32 v179, v102, v103
  v_cvt_pk_bf16_f32 v156, v72, v73
  v_cvt_pk_bf16_f32 v157, v74, v75
  v_cvt_pk_bf16_f32 v170, v104, v105
  v_cvt_pk_bf16_f32 v171, v106, v107
  s_add_u32 m0, s41, 32768
  s_nop 0
  buffer_load_dwordx4 v8, s[12:15], s48 offen offset:0 lds
  v_cvt_pk_bf16_f32 v158, v76, v77
  v_cvt_pk_bf16_f32 v159, v78, v79
  v_cvt_pk_bf16_f32 v180, v108, v109
  v_cvt_pk_bf16_f32 v181, v110, v111
  v_cvt_pk_bf16_f32 v160, v80, v81
  v_cvt_pk_bf16_f32 v161, v82, v83
  v_cvt_pk_bf16_f32 v172, v112, v113
  v_cvt_pk_bf16_f32 v173, v114, v115
  v_cvt_pk_bf16_f32 v162, v84, v85
  v_cvt_pk_bf16_f32 v163, v86, v87
  v_cvt_pk_bf16_f32 v182, v116, v117
  v_cvt_pk_bf16_f32 v183, v118, v119
  buffer_load_dwordx4 v9, s[12:15], s48 offen offset:1024 lds
  v_mov_b32 v200, 0x3f803f80
  v_mov_b32 v201, v200
  v_mov_b32 v202, v200
  v_mov_b32 v203, v200
  s_waitcnt lgkmcnt(0)
  s_barrier
  ds_read_b128 v[144:147], v196
  ds_read_b64 v[164:165], v196 offset:1024
  ds_read_b64 v[174:175], v196 offset:1032
  v_mfma_f32_16x16x32_bf16 v[48:51], v[156:159], v[140:143], v[188:191]
  v_mfma_f32_16x16x32_bf16 v[52:55], v[160:163], v[140:143], v[184:187]
  v_mfma_f32_16x16x32_bf16 v[40:43], v[152:155], v[136:139], v[188:191]
  v_mfma_f32_16x16x32_bf16 v[44:47], v[156:159], v[136:139], v[184:187]
  v_mfma_f32_16x16x32_bf16 v[32:35], v[148:151], v[132:135], v[188:191]
  v_mfma_f32_16x16x32_bf16 v[36:39], v[152:155], v[132:135], v[184:187]
  s_waitcnt lgkmcnt(0)
  v_mfma_f32_16x16x32_bf16 v[24:27], v[144:147], v[128:131], v[188:191]
  v_mfma_f32_16x16x32_bf16 v[28:31], v[148:151], v[128:131], v[184:187]
  v_max3_f32 v62, v48, v49, v50
  v_max3_f32 v63, v51, v52, v53
  v_max3_f32 v62, v62, v54, v55
  buffer_load_dwordx4 v10, s[12:15], s48 offen offset:2048 lds
  v_max_f32 v62, v62, v63
  v_max3_f32 v60, v40, v41, v42
  v_max3_f32 v61, v43, v44, v45
  v_max3_f32 v60, v60, v46, v47
  v_max_f32 v60, v60, v61
  v_max3_f32 v58, v32, v33, v34
  v_max3_f32 v59, v35, v36, v37
  v_max3_f32 v58, v58, v38, v39
  v_max_f32 v58, v58, v59
  v_max3_f32 v56, v24, v25, v26
  v_max3_f32 v57, v27, v28, v29
  v_max3_f32 v56, v56, v30, v31
  buffer_load_dwordx4 v11, s[12:15], s48 offen offset:3072 lds
  v_max_f32 v56, v56, v57
  v_mov_b32 v63, v62
  v_mov_b32 v61, v60
  v_mov_b32 v59, v58
  v_mov_b32 v57, v56
  v_permlane32_swap_b32 v62, v63
  v_permlane32_swap_b32 v60, v61
  v_permlane32_swap_b32 v58, v59
  v_permlane32_swap_b32 v56, v57
  v_max_f32 v62, v62, v63
  v_max_f32 v60, v60, v61
  v_max_f32 v58, v58, v59
  v_max_f32 v56, v56, v57
  s_add_u32 s48, s48, 524288
  s_and_b32 s48, s48, 8388607
  s_add_u32 m0, s36, -32768
  s_nop 0
  buffer_load_dwordx4 v4, s[8:11], s46 offen offset:0 lds
  v_mov_b32 v63, v62
  v_mov_b32 v61, v60
  v_mov_b32 v59, v58
  v_mov_b32 v57, v56
  v_permlane16_swap_b32 v62, v63
  v_permlane16_swap_b32 v60, v61
  v_permlane16_swap_b32 v58, v59
  v_permlane16_swap_b32 v56, v57
  v_max_f32 v62, v62, v63
  v_max_f32 v60, v60, v61
  v_max_f32 v58, v58, v59
  v_max_f32 v56, v56, v57
  buffer_load_dwordx4 v5, s[8:11], s46 offen offset:1024 lds
  v_sub_f32 v48, v48, v62
  v_sub_f32 v49, v49, v62
  v_sub_f32 v50, v50, v62
  v_sub_f32 v51, v51, v62
  v_sub_f32 v52, v52, v62
  v_sub_f32 v53, v53, v62
  v_sub_f32 v54, v54, v62
  v_sub_f32 v55, v55, v62
  v_exp_f32 v48, v48
  v_exp_f32 v49, v49
  v_exp_f32 v50, v50
  v_exp_f32 v51, v51
  v_exp_f32 v52, v52
  buffer_load_dwordx4 v6, s[8:11], s46 offen offset:2048 lds
  v_exp_f32 v53, v53
  v_exp_f32 v54, v54
  v_exp_f32 v55, v55
  v_sub_f32 v40, v40, v60
  v_sub_f32 v41, v41, v60
  v_sub_f32 v42, v42, v60
  v_sub_f32 v43, v43, v60
  v_sub_f32 v44, v44, v60
  v_sub_f32 v45, v45, v60
  v_sub_f32 v46, v46, v60
  v_sub_f32 v47, v47, v60
  v_exp_f32 v40, v40
  buffer_load_dwordx4 v7, s[8:11], s46 offen offset:3072 lds
  v_exp_f32 v41, v41
  v_exp_f32 v42, v42
  v_exp_f32 v43, v43
  v_exp_f32 v44, v44
  v_exp_f32 v45, v45
  v_exp_f32 v46, v46
  v_exp_f32 v47, v47
  v_sub_f32 v32, v32, v58
  v_sub_f32 v33, v33, v58
  v_sub_f32 v34, v34, v58
  v_sub_f32 v35, v35, v58
  v_sub_f32 v36, v36, v58
  v_sub_f32 v37, v37, v58
  s_add_u32 m0, s36, -28672
  s_nop 0
  buffer_load_dwordx4 v4, s[8:11], s47 offen offset:0 lds
  v_sub_f32 v38, v38, v58
  v_sub_f32 v39, v39, v58
  v_exp_f32 v32, v32
  v_exp_f32 v33, v33
  v_exp_f32 v34, v34
  v_exp_f32 v35, v35
  v_exp_f32 v36, v36
  v_exp_f32 v37, v37
  v_exp_f32 v38, v38
  v_exp_f32 v39, v39
  v_sub_f32 v24, v24, v56
  v_sub_f32 v25, v25, v56
  buffer_load_dwordx4 v5, s[8:11], s47 offen offset:1024 lds
  v_sub_f32 v26, v26, v56
  v_sub_f32 v27, v27, v56
  v_sub_f32 v28, v28, v56
  v_sub_f32 v29, v29, v56
  v_sub_f32 v30, v30, v56
  v_sub_f32 v31, v31, v56
  v_exp_f32 v24, v24
  v_exp_f32 v25, v25
  v_exp_f32 v26, v26
  v_exp_f32 v27, v27
  v_exp_f32 v28, v28
  v_exp_f32 v29, v29
  v_exp_f32 v30, v30
  buffer_load_dwordx4 v6, s[8:11], s47 offen offset:2048 lds
  v_exp_f32 v31, v31
  v_cvt_pk_bf16_f32 v76, v48, v49
  v_cvt_pk_bf16_f32 v77, v50, v51
  v_cvt_pk_bf16_f32 v78, v52, v53
  v_cvt_pk_bf16_f32 v79, v54, v55
  v_cvt_pk_bf16_f32 v72, v40, v41
  v_cvt_pk_bf16_f32 v73, v42, v43
  v_cvt_pk_bf16_f32 v74, v44, v45
  v_cvt_pk_bf16_f32 v75, v46, v47
  v_cvt_pk_bf16_f32 v68, v32, v33
  v_cvt_pk_bf16_f32 v69, v34, v35
  v_cvt_pk_bf16_f32 v70, v36, v37
  buffer_load_dwordx4 v7, s[8:11], s47 offen offset:3072 lds
  s_add_u32 s49, s49, 128
  s_and_b32 s49, s49, 2047
  s_or_b32 s46, s50, s49
  s_or_b32 s47, s51, s49
  v_cvt_pk_bf16_f32 v71, v38, v39
  v_cvt_pk_bf16_f32 v64, v24, v25
  v_cvt_pk_bf16_f32 v65, v26, v27
  v_cvt_pk_bf16_f32 v66, v28, v29
  v_cvt_pk_bf16_f32 v67, v30, v31
  v_mfma_f32_16x16x32_bf16 v[92:95], v[200:203], v[76:79], 0
  v_mfma_f32_16x16x32_bf16 v[120:123], v[170:173], v[76:79], 0
  v_mfma_f32_16x16x32_bf16 v[124:127], v[180:183], v[76:79], 0
  v_mfma_f32_16x16x32_bf16 v[88:91], v[200:203], v[72:75], 0
  v_mfma_f32_16x16x32_bf16 v[112:115], v[168:171], v[72:75], 0
  v_mfma_f32_16x16x32_bf16 v[116:119], v[178:181], v[72:75], 0
  v_mfma_f32_16x16x32_bf16 v[84:87], v[200:203], v[68:71], 0
  v_mfma_f32_16x16x32_bf16 v[104:107], v[166:169], v[68:71], 0
  v_mfma_f32_16x16x32_bf16 v[108:111], v[176:179], v[68:71], 0
  v_mfma_f32_16x16x32_bf16 v[80:83], v[200:203], v[64:67], 0
  v_mfma_f32_16x16x32_bf16 v[96:99], v[164:167], v[64:67], 0
  v_mfma_f32_16x16x32_bf16 v[100:103], v[174:177], v[64:67], 0
  s_add_u32 s20, s86, 83886080
  s_addc_u32 s21, s87, 0
  s_mov_b32 s22, 4194304
  s_mov_b32 s23, 0x00020000
  s_lshl_b32 s4, s32, 18
  s_lshl_b32 s5, s33, 14
  s_add_u32 s4, s4, s5
  s_and_b32 s5, s3, 1
  s_lshl_b32 s5, s5, 13
  s_add_u32 s4, s4, s5
  s_add_u32 s4, s4, 4096
  v_rcp_f32 v92, v92
  v_rcp_f32 v88, v88
  v_rcp_f32 v84, v84
  v_rcp_f32 v80, v80
  v_mov_b32 v93, v92
  v_mov_b32 v89, v88
  v_mov_b32 v85, v84
  v_mov_b32 v81, v80
  v_pk_mul_f32 v[120:121], v[120:121], v[92:93]
  v_pk_mul_f32 v[122:123], v[122:123], v[92:93]
  v_pk_mul_f32 v[124:125], v[124:125], v[92:93]
  v_pk_mul_f32 v[126:127], v[126:127], v[92:93]
  v_cvt_pk_bf16_f32 v120, v120, v121
  v_cvt_pk_bf16_f32 v121, v122, v123
  v_cvt_pk_bf16_f32 v122, v124, v125
  v_cvt_pk_bf16_f32 v123, v126, v127
  buffer_store_dwordx4 v[120:123], v2, s[20:23], s4 offen offset:3072 sc1
  v_pk_mul_f32 v[112:113], v[112:113], v[88:89]
  v_pk_mul_f32 v[114:115], v[114:115], v[88:89]
  v_pk_mul_f32 v[116:117], v[116:117], v[88:89]
  v_pk_mul_f32 v[118:119], v[118:119], v[88:89]
  v_cvt_pk_bf16_f32 v112, v112, v113
  v_cvt_pk_bf16_f32 v113, v114, v115
  v_cvt_pk_bf16_f32 v114, v116, v117
  v_cvt_pk_bf16_f32 v115, v118, v119
  buffer_store_dwordx4 v[112:115], v2, s[20:23], s4 offen offset:2048 sc1
  v_pk_mul_f32 v[104:105], v[104:105], v[84:85]
  v_pk_mul_f32 v[106:107], v[106:107], v[84:85]
  v_pk_mul_f32 v[108:109], v[108:109], v[84:85]
  v_pk_mul_f32 v[110:111], v[110:111], v[84:85]
  v_cvt_pk_bf16_f32 v104, v104, v105
  v_cvt_pk_bf16_f32 v105, v106, v107
  v_cvt_pk_bf16_f32 v106, v108, v109
  v_cvt_pk_bf16_f32 v107, v110, v111
  buffer_store_dwordx4 v[104:107], v2, s[20:23], s4 offen offset:1024 sc1
  v_pk_mul_f32 v[96:97], v[96:97], v[80:81]
  v_pk_mul_f32 v[98:99], v[98:99], v[80:81]
  v_pk_mul_f32 v[100:101], v[100:101], v[80:81]
  v_pk_mul_f32 v[102:103], v[102:103], v[80:81]
  v_cvt_pk_bf16_f32 v96, v96, v97
  v_cvt_pk_bf16_f32 v97, v98, v99
  v_cvt_pk_bf16_f32 v98, v100, v101
  v_cvt_pk_bf16_f32 v99, v102, v103
  buffer_store_dwordx4 v[96:99], v2, s[20:23], s4 offen offset:0 sc1
Lp3:
  v_accvgpr_read_b32 v16, a230
  v_accvgpr_read_b32 v17, a231
  v_accvgpr_read_b32 v18, a232
  v_accvgpr_read_b32 v19, a233
  v_accvgpr_read_b32 v20, a234
  v_accvgpr_read_b32 v21, a235
  s_mov_b32 s37, 0
  s_mov_b32 s39, 4294901760
  s_mov_b32 s40, 32768
  s_mov_b32 s37, 1
  s_mov_b32 s42, 0
  s_mov_b32 s44, 4294934528
  s_mov_b32 s45, 16384
  s_lshl_b32 s34, s62, 4
  s_add_u32 s34, s34, s61
  s_lshr_b32 s4, s2, 7
  s_lshl_b32 s4, s4, 3
  s_add_u32 s34, s34, s4
  s_lshl_b32 s34, s34, 7
  s_lshl_b32 s91, s32, 4
  s_add_u32 s91, s91, s33
  s_lshl_b32 s91, s91, 7
  s_add_u32 s91, s91, 32768
  s_waitcnt vmcnt(32)
  s_barrier
  ds_read_b128 a[0:3], v16 offset:0
  ds_read_b64_tr_b16 a[32:33], v18 offset:0
  ds_read_b64_tr_b16 a[34:35], v18 offset:2048
  ds_read_b128 a[4:7], v16 offset:2048
  ds_read_b128 a[8:11], v16 offset:4096
  ds_read_b128 a[12:15], v16 offset:6144
  ds_read_b64_tr_b16 a[36:37], v19 offset:0
  ds_read_b64_tr_b16 a[38:39], v19 offset:2048
  ds_read_b64_tr_b16 a[40:41], v20 offset:0
  ds_read_b64_tr_b16 a[42:43], v20 offset:2048
  ds_read_b64_tr_b16 a[44:45], v21 offset:0
  ds_read_b64_tr_b16 a[46:47], v21 offset:2048
  ds_read_b64_tr_b16 a[48:49], v18 offset:8192
  ds_read_b64_tr_b16 a[50:51], v18 offset:10240
  ds_read_b64_tr_b16 a[52:53], v19 offset:8192
  ds_read_b64_tr_b16 a[54:55], v19 offset:10240
  ds_read_b64_tr_b16 a[56:57], v20 offset:8192
  ds_read_b64_tr_b16 a[58:59], v20 offset:10240
  ds_read_b64_tr_b16 a[60:61], v21 offset:8192
  ds_read_b64_tr_b16 a[62:63], v21 offset:10240
  s_waitcnt lgkmcnt(0)
  v_mfma_f32_16x16x32_bf16 v[128:131], a[32:35], a[0:3], 0
  s_add_u32 s37, s37, 1
  s_cmp_eq_u32 s37, 3
  s_cselect_b32 s37, 0, s37
  s_cselect_b32 s38, s39, s40
  ds_read_b128 a[16:19], v17 offset:0
  v_mfma_f32_16x16x32_bf16 v[160:163], a[32:35], a[4:7], 0
  s_add_u32 s42, s42, 1
  s_cmp_eq_u32 s42, 3
  s_cselect_b32 s42, 0, s42
  s_cselect_b32 s43, s44, s45
  ds_read_b64_tr_b16 a[64:65], v18 offset:4096
  v_mfma_f32_16x16x32_bf16 v[192:195], a[32:35], a[8:11], 0
  ds_read_b64_tr_b16 a[66:67], v18 offset:6144
  v_mfma_f32_16x16x32_bf16 v[224:227], a[32:35], a[12:15], 0
  ds_read_b128 a[20:23], v17 offset:2048
  v_mfma_f32_16x16x32_bf16 v[132:135], a[36:39], a[0:3], 0
  ds_read_b128 a[24:27], v17 offset:4096
  v_mfma_f32_16x16x32_bf16 v[164:167], a[36:39], a[4:7], 0
  ds_read_b128 a[28:31], v17 offset:6144
  v_mfma_f32_16x16x32_bf16 v[196:199], a[36:39], a[8:11], 0
  ds_read_b64_tr_b16 a[68:69], v19 offset:4096
  v_mfma_f32_16x16x32_bf16 v[228:231], a[36:39], a[12:15], 0
  ds_read_b64_tr_b16 a[70:71], v19 offset:6144
  v_mfma_f32_16x16x32_bf16 v[136:139], a[40:43], a[0:3], 0
  ds_read_b64_tr_b16 a[72:73], v20 offset:4096
  v_mfma_f32_16x16x32_bf16 v[168:171], a[40:43], a[4:7], 0
  ds_read_b64_tr_b16 a[74:75], v20 offset:6144
  v_mfma_f32_16x16x32_bf16 v[200:203], a[40:43], a[8:11], 0
  v_mfma_f32_16x16x32_bf16 v[232:235], a[40:43], a[12:15], 0
  ds_read_b64_tr_b16 a[76:77], v21 offset:4096
  v_mfma_f32_16x16x32_bf16 v[140:143], a[44:47], a[0:3], 0
  ds_read_b64_tr_b16 a[78:79], v21 offset:6144
  v_mfma_f32_16x16x32_bf16 v[172:175], a[44:47], a[4:7], 0
  ds_read_b64_tr_b16 a[80:81], v18 offset:12288
  v_mfma_f32_16x16x32_bf16 v[204:207], a[44:47], a[8:11], 0
  ds_read_b64_tr_b16 a[82:83], v18 offset:14336
  v_mfma_f32_16x16x32_bf16 v[236:239], a[44:47], a[12:15], 0
  ds_read_b64_tr_b16 a[84:85], v19 offset:12288
  v_mfma_f32_16x16x32_bf16 v[144:147], a[48:51], a[0:3], 0
  ds_read_b64_tr_b16 a[86:87], v19 offset:14336
  v_mfma_f32_16x16x32_bf16 v[176:179], a[48:51], a[4:7], 0
  ds_read_b64_tr_b16 a[88:89], v20 offset:12288
  v_mfma_f32_16x16x32_bf16 v[208:211], a[48:51], a[8:11], 0
  ds_read_b64_tr_b16 a[90:91], v20 offset:14336
  v_mfma_f32_16x16x32_bf16 v[240:243], a[48:51], a[12:15], 0
  ds_read_b64_tr_b16 a[92:93], v21 offset:12288
  v_mfma_f32_16x16x32_bf16 v[148:151], a[52:55], a[0:3], 0
  ds_read_b64_tr_b16 a[94:95], v21 offset:14336
  v_mfma_f32_16x16x32_bf16 v[180:183], a[52:55], a[4:7], 0
  v_add_u32 v16, s38, v16
  v_add_u32 v17, s38, v17
  v_mfma_f32_16x16x32_bf16 v[212:215], a[52:55], a[8:11], 0
  v_add_u32 v18, s43, v18
  v_add_u32 v19, s43, v19
  v_mfma_f32_16x16x32_bf16 v[244:247], a[52:55], a[12:15], 0
  v_add_u32 v20, s43, v20
  v_add_u32 v21, s43, v21
  v_mfma_f32_16x16x32_bf16 v[152:155], a[56:59], a[0:3], 0
  v_mfma_f32_16x16x32_bf16 v[184:187], a[56:59], a[4:7], 0
  v_mfma_f32_16x16x32_bf16 v[216:219], a[56:59], a[8:11], 0
  v_mfma_f32_16x16x32_bf16 v[248:251], a[56:59], a[12:15], 0
  v_mfma_f32_16x16x32_bf16 v[156:159], a[60:63], a[0:3], 0
  v_mfma_f32_16x16x32_bf16 v[188:191], a[60:63], a[4:7], 0
  v_mfma_f32_16x16x32_bf16 v[220:223], a[60:63], a[8:11], 0
  v_mfma_f32_16x16x32_bf16 v[252:255], a[60:63], a[12:15], 0
  s_waitcnt vmcnt(22) lgkmcnt(0)
  s_barrier
  v_mfma_f32_16x16x32_bf16 v[128:131], a[64:67], a[16:19], v[128:131]
  s_mov_b32 m0, s41
  ds_read_b128 a[0:3], v16 offset:0
  v_mfma_f32_16x16x32_bf16 v[160:163], a[64:67], a[20:23], v[160:163]
  buffer_load_dwordx4 v8, s[12:15], s48 offen offset:0 lds
  ds_read_b64_tr_b16 a[32:33], v18 offset:0
  v_mfma_f32_16x16x32_bf16 v[192:195], a[64:67], a[24:27], v[192:195]
  ds_read_b64_tr_b16 a[34:35], v18 offset:2048
  v_mfma_f32_16x16x32_bf16 v[224:227], a[64:67], a[28:31], v[224:227]
  ds_read_b128 a[4:7], v16 offset:2048
  v_mfma_f32_16x16x32_bf16 v[132:135], a[68:71], a[16:19], v[132:135]
  ds_read_b128 a[8:11], v16 offset:4096
  v_mfma_f32_16x16x32_bf16 v[164:167], a[68:71], a[20:23], v[164:167]
  buffer_load_dwordx4 v9, s[12:15], s48 offen offset:1024 lds
  ds_read_b128 a[12:15], v16 offset:6144
  v_mfma_f32_16x16x32_bf16 v[196:199], a[68:71], a[24:27], v[196:199]
  ds_read_b64_tr_b16 a[36:37], v19 offset:0
  v_mfma_f32_16x16x32_bf16 v[228:231], a[68:71], a[28:31], v[228:231]
  ds_read_b64_tr_b16 a[38:39], v19 offset:2048
  v_mfma_f32_16x16x32_bf16 v[136:139], a[72:75], a[16:19], v[136:139]
  ds_read_b64_tr_b16 a[40:41], v20 offset:0
  v_mfma_f32_16x16x32_bf16 v[168:171], a[72:75], a[20:23], v[168:171]
  ds_read_b64_tr_b16 a[42:43], v20 offset:2048
  v_mfma_f32_16x16x32_bf16 v[200:203], a[72:75], a[24:27], v[200:203]
  buffer_load_dwordx4 v10, s[12:15], s48 offen offset:2048 lds
  v_mfma_f32_16x16x32_bf16 v[232:235], a[72:75], a[28:31], v[232:235]
  ds_read_b64_tr_b16 a[44:45], v21 offset:0
  v_mfma_f32_16x16x32_bf16 v[140:143], a[76:79], a[16:19], v[140:143]
  ds_read_b64_tr_b16 a[46:47], v21 offset:2048
  v_mfma_f32_16x16x32_bf16 v[172:175], a[76:79], a[20:23], v[172:175]
  ds_read_b64_tr_b16 a[48:49], v18 offset:8192
  v_mfma_f32_16x16x32_bf16 v[204:207], a[76:79], a[24:27], v[204:207]
  ds_read_b64_tr_b16 a[50:51], v18 offset:10240
  v_mfma_f32_16x16x32_bf16 v[236:239], a[76:79], a[28:31], v[236:239]
  buffer_load_dwordx4 v11, s[12:15], s48 offen offset:3072 lds
  ds_read_b64_tr_b16 a[52:53], v19 offset:8192
  v_mfma_f32_16x16x32_bf16 v[144:147], a[80:83], a[16:19], v[144:147]
  s_add_u32 s48, s48, 524288
  s_and_b32 s48, s48, 8388607
  s_mov_b32 m0, s36
  v_mfma_f32_16x16x32_bf16 v[176:179], a[80:83], a[20:23], v[176:179]
  ds_read_b64_tr_b16 a[54:55], v19 offset:10240
  ds_read_b64_tr_b16 a[56:57], v20 offset:8192
  v_mfma_f32_16x16x32_bf16 v[208:211], a[80:83], a[24:27], v[208:211]
  ds_read_b64_tr_b16 a[58:59], v20 offset:10240
  v_mfma_f32_16x16x32_bf16 v[240:243], a[80:83], a[28:31], v[240:243]
  ds_read_b64_tr_b16 a[60:61], v21 offset:8192
  v_mfma_f32_16x16x32_bf16 v[148:151], a[84:87], a[16:19], v[148:151]
  buffer_load_dwordx4 v4, s[8:11], s46 offen offset:0 lds
  ds_read_b64_tr_b16 a[62:63], v21 offset:10240
  v_mfma_f32_16x16x32_bf16 v[180:183], a[84:87], a[20:23], v[180:183]
  v_mfma_f32_16x16x32_bf16 v[212:215], a[84:87], a[24:27], v[212:215]
  v_mfma_f32_16x16x32_bf16 v[244:247], a[84:87], a[28:31], v[244:247]
  v_mfma_f32_16x16x32_bf16 v[152:155], a[88:91], a[16:19], v[152:155]
  v_mfma_f32_16x16x32_bf16 v[184:187], a[88:91], a[20:23], v[184:187]
  buffer_load_dwordx4 v5, s[8:11], s46 offen offset:1024 lds
  v_mfma_f32_16x16x32_bf16 v[216:219], a[88:91], a[24:27], v[216:219]
  v_mfma_f32_16x16x32_bf16 v[248:251], a[88:91], a[28:31], v[248:251]
  v_mfma_f32_16x16x32_bf16 v[156:159], a[92:95], a[16:19], v[156:159]
  v_mfma_f32_16x16x32_bf16 v[188:191], a[92:95], a[20:23], v[188:191]
  v_mfma_f32_16x16x32_bf16 v[220:223], a[92:95], a[24:27], v[220:223]
  v_mfma_f32_16x16x32_bf16 v[252:255], a[92:95], a[28:31], v[252:255]
  s_waitcnt lgkmcnt(0)
  v_mfma_f32_16x16x32_bf16 v[128:131], a[32:35], a[0:3], v[128:131]
  buffer_load_dwordx4 v6, s[8:11], s46 offen offset:2048 lds
  ds_read_b128 a[16:19], v17 offset:0
  v_mfma_f32_16x16x32_bf16 v[160:163], a[32:35], a[4:7], v[160:163]
  ds_read_b64_tr_b16 a[64:65], v18 offset:4096
  v_mfma_f32_16x16x32_bf16 v[192:195], a[32:35], a[8:11], v[192:195]
  ds_read_b64_tr_b16 a[66:67], v18 offset:6144
  v_mfma_f32_16x16x32_bf16 v[224:227], a[32:35], a[12:15], v[224:227]
  ds_read_b128 a[20:23], v17 offset:2048
  v_mfma_f32_16x16x32_bf16 v[132:135], a[36:39], a[0:3], v[132:135]
  buffer_load_dwordx4 v7, s[8:11], s46 offen offset:3072 lds
  ds_read_b128 a[24:27], v17 offset:4096
  v_mfma_f32_16x16x32_bf16 v[164:167], a[36:39], a[4:7], v[164:167]
  s_add_u32 m0, s36, 4096
  ds_read_b128 a[28:31], v17 offset:6144
  v_mfma_f32_16x16x32_bf16 v[196:199], a[36:39], a[8:11], v[196:199]
  ds_read_b64_tr_b16 a[68:69], v19 offset:4096
  v_mfma_f32_16x16x32_bf16 v[228:231], a[36:39], a[12:15], v[228:231]
  ds_read_b64_tr_b16 a[70:71], v19 offset:6144
  v_mfma_f32_16x16x32_bf16 v[136:139], a[40:43], a[0:3], v[136:139]
  buffer_load_dwordx4 v4, s[8:11], s47 offen offset:0 lds
  ds_read_b64_tr_b16 a[72:73], v20 offset:4096
  v_mfma_f32_16x16x32_bf16 v[168:171], a[40:43], a[4:7], v[168:171]
  ds_read_b64_tr_b16 a[74:75], v20 offset:6144
  v_mfma_f32_16x16x32_bf16 v[200:203], a[40:43], a[8:11], v[200:203]
  v_mfma_f32_16x16x32_bf16 v[232:235], a[40:43], a[12:15], v[232:235]
  ds_read_b64_tr_b16 a[76:77], v21 offset:4096
  v_mfma_f32_16x16x32_bf16 v[140:143], a[44:47], a[0:3], v[140:143]
  buffer_load_dwordx4 v5, s[8:11], s47 offen offset:1024 lds
  ds_read_b64_tr_b16 a[78:79], v21 offset:6144
  v_mfma_f32_16x16x32_bf16 v[172:175], a[44:47], a[4:7], v[172:175]
  ds_read_b64_tr_b16 a[80:81], v18 offset:12288
  v_mfma_f32_16x16x32_bf16 v[204:207], a[44:47], a[8:11], v[204:207]
  ds_read_b64_tr_b16 a[82:83], v18 offset:14336
  v_mfma_f32_16x16x32_bf16 v[236:239], a[44:47], a[12:15], v[236:239]
  ds_read_b64_tr_b16 a[84:85], v19 offset:12288
  v_mfma_f32_16x16x32_bf16 v[144:147], a[48:51], a[0:3], v[144:147]
  buffer_load_dwordx4 v6, s[8:11], s47 offen offset:2048 lds
  ds_read_b64_tr_b16 a[86:87], v19 offset:14336
  v_mfma_f32_16x16x32_bf16 v[176:179], a[48:51], a[4:7], v[176:179]
  ds_read_b64_tr_b16 a[88:89], v20 offset:12288
  v_mfma_f32_16x16x32_bf16 v[208:211], a[48:51], a[8:11], v[208:211]
  ds_read_b64_tr_b16 a[90:91], v20 offset:14336
  v_mfma_f32_16x16x32_bf16 v[240:243], a[48:51], a[12:15], v[240:243]
  ds_read_b64_tr_b16 a[92:93], v21 offset:12288
  v_mfma_f32_16x16x32_bf16 v[148:151], a[52:55], a[0:3], v[148:151]
  buffer_load_dwordx4 v7, s[8:11], s47 offen offset:3072 lds
  ds_read_b64_tr_b16 a[94:95], v21 offset:14336
  v_mfma_f32_16x16x32_bf16 v[180:183], a[52:55], a[4:7], v[180:183]
  s_add_u32 s49, s49, 128
  s_and_b32 s49, s49, 2047
  s_or_b32 s46, s50, s49
  v_mfma_f32_16x16x32_bf16 v[212:215], a[52:55], a[8:11], v[212:215]
  s_or_b32 s47, s51, s49
  v_mfma_f32_16x16x32_bf16 v[244:247], a[52:55], a[12:15], v[244:247]
  s_add_u32 s36, s36, s38
  s_add_u32 s37, s37, 1
  s_cmp_eq_u32 s37, 3
  s_cselect_b32 s37, 0, s37
  s_cselect_b32 s38, s39, s40
  v_mfma_f32_16x16x32_bf16 v[152:155], a[56:59], a[0:3], v[152:155]
  s_add_u32 s41, s41, s43
  s_add_u32 s42, s42, 1
  s_cmp_eq_u32 s42, 3
  s_cselect_b32 s42, 0, s42
  s_cselect_b32 s43, s44, s45
  v_mfma_f32_16x16x32_bf16 v[184:187], a[56:59], a[4:7], v[184:187]
  v_add_u32 v16, s38, v16
  v_add_u32 v17, s38, v17
  v_mfma_f32_16x16x32_bf16 v[216:219], a[56:59], a[8:11], v[216:219]
  v_add_u32 v18, s43, v18
  v_add_u32 v19, s43, v19
  v_mfma_f32_16x16x32_bf16 v[248:251], a[56:59], a[12:15], v[248:251]
  v_add_u32 v20, s43, v20
  v_add_u32 v21, s43, v21
  v_mfma_f32_16x16x32_bf16 v[156:159], a[60:63], a[0:3], v[156:159]
  v_mfma_f32_16x16x32_bf16 v[188:191], a[60:63], a[4:7], v[188:191]
  v_mfma_f32_16x16x32_bf16 v[220:223], a[60:63], a[8:11], v[220:223]
  v_mfma_f32_16x16x32_bf16 v[252:255], a[60:63], a[12:15], v[252:255]
  s_waitcnt vmcnt(12) lgkmcnt(0)
  s_barrier
  s_mov_b32 s5, 0x40000
Ltg_9:
  v_readfirstlane_b32 s94, v22
  v_readfirstlane_b32 s95, v23
  s_nop 0
  s_cmp_lg_u32 s95, 0
  s_cbranch_scc1 Lpolld_10
  s_sleep 4
  s_mov_b32 s20, s84
  s_mov_b32 s21, s85
  s_mov_b32 s22, 256
  s_mov_b32 s23, 0x00020000
  buffer_load_dwordx2 v[22:23], off, s[20:23], 0 sc1
  s_sub_u32 s5, s5, 1
  s_waitcnt vmcnt(0)
  s_cbranch_scc0 Ltg_9
Lpolld_10:
  v_mov_b32 v3, 0x40000000
  v_mov_b32 v22, s94
  v_cmp_eq_u32 vcc, 0, v0
  v_mov_b32 v23, s95
  s_nop 0
  v_cndmask_b32_e64 v3, v3, 0, vcc
  buffer_store_dwordx2 v[22:23], v3, s[96:99], s34 offen sc1
  buffer_store_dwordx2 v[22:23], v3, s[96:99], s91 offen sc1
  v_mfma_f32_16x16x32_bf16 v[128:131], a[64:67], a[16:19], v[128:131]
  s_mov_b32 m0, s41
  ds_read_b128 a[0:3], v16 offset:0
  v_mfma_f32_16x16x32_bf16 v[160:163], a[64:67], a[20:23], v[160:163]
  buffer_load_dwordx4 v8, s[12:15], s48 offen offset:0 lds
  ds_read_b64_tr_b16 a[32:33], v18 offset:0
  v_mfma_f32_16x16x32_bf16 v[192:195], a[64:67], a[24:27], v[192:195]
  ds_read_b64_tr_b16 a[34:35], v18 offset:2048
  v_mfma_f32_16x16x32_bf16 v[224:227], a[64:67], a[28:31], v[224:227]
  ds_read_b128 a[4:7], v16 offset:2048
  v_mfma_f32_16x16x32_bf16 v[132:135], a[68:71], a[16:19], v[132:135]
  ds_read_b128 a[8:11], v16 offset:4096
  v_mfma_f32_16x16x32_bf16 v[164:167], a[68:71], a[20:23], v[164:167]
  buffer_load_dwordx4 v9, s[12:15], s48 offen offset:1024 lds
  ds_read_b128 a[12:15], v16 offset:6144
  v_mfma_f32_16x16x32_bf16 v[196:199], a[68:71], a[24:27], v[196:199]
  ds_read_b64_tr_b16 a[36:37], v19 offset:0
  v_mfma_f32_16x16x32_bf16 v[228:231], a[68:71], a[28:31], v[228:231]
  ds_read_b64_tr_b16 a[38:39], v19 offset:2048
  v_mfma_f32_16x16x32_bf16 v[136:139], a[72:75], a[16:19], v[136:139]
  ds_read_b64_tr_b16 a[40:41], v20 offset:0
  v_mfma_f32_16x16x32_bf16 v[168:171], a[72:75], a[20:23], v[168:171]
  ds_read_b64_tr_b16 a[42:43], v20 offset:2048
  v_mfma_f32_16x16x32_bf16 v[200:203], a[72:75], a[24:27], v[200:203]
  buffer_load_dwordx4 v10, s[12:15], s48 offen offset:2048 lds
  v_mfma_f32_16x16x32_bf16 v[232:235], a[72:75], a[28:31], v[232:235]
  ds_read_b64_tr_b16 a[44:45], v21 offset:0
  v_mfma_f32_16x16x32_bf16 v[140:143], a[76:79], a[16:19], v[140:143]
  ds_read_b64_tr_b16 a[46:47], v21 offset:2048
  v_mfma_f32_16x16x32_bf16 v[172:175], a[76:79], a[20:23], v[172:175]
  ds_read_b64_tr_b16 a[48:49], v18 offset:8192
  v_mfma_f32_16x16x32_bf16 v[204:207], a[76:79], a[24:27], v[204:207]
  ds_read_b64_tr_b16 a[50:51], v18 offset:10240
  v_mfma_f32_16x16x32_bf16 v[236:239], a[76:79], a[28:31], v[236:239]
  buffer_load_dwordx4 v11, s[12:15], s48 offen offset:3072 lds
  ds_read_b64_tr_b16 a[52:53], v19 offset:8192
  v_mfma_f32_16x16x32_bf16 v[144:147], a[80:83], a[16:19], v[144:147]
  s_add_u32 s48, s48, 524288
  s_and_b32 s48, s48, 8388607
  s_mov_b32 m0, s36
  v_mfma_f32_16x16x32_bf16 v[176:179], a[80:83], a[20:23], v[176:179]
  ds_read_b64_tr_b16 a[54:55], v19 offset:10240
  ds_read_b64_tr_b16 a[56:57], v20 offset:8192
  v_mfma_f32_16x16x32_bf16 v[208:211], a[80:83], a[24:27], v[208:211]
  ds_read_b64_tr_b16 a[58:59], v20 offset:10240
  v_mfma_f32_16x16x32_bf16 v[240:243], a[80:83], a[28:31], v[240:243]
  ds_read_b64_tr_b16 a[60:61], v21 offset:8192
  v_mfma_f32_16x16x32_bf16 v[148:151], a[84:87], a[16:19], v[148:151]
  buffer_load_dwordx4 v4, s[8:11], s46 offen offset:0 lds
  ds_read_b64_tr_b16 a[62:63], v21 offset:10240
  v_mfma_f32_16x16x32_bf16 v[180:183], a[84:87], a[20:23], v[180:183]
  v_mfma_f32_16x16x32_bf16 v[212:215], a[84:87], a[24:27], v[212:215]
  v_mfma_f32_16x16x32_bf16 v[244:247], a[84:87], a[28:31], v[244:247]
  v_mfma_f32_16x16x32_bf16 v[152:155], a[88:91], a[16:19], v[152:155]
  v_mfma_f32_16x16x32_bf16 v[184:187], a[88:91], a[20:23], v[184:187]
  buffer_load_dwordx4 v5, s[8:11], s46 offen offset:1024 lds
  v_mfma_f32_16x16x32_bf16 v[216:219], a[88:91], a[24:27], v[216:219]
  v_mfma_f32_16x16x32_bf16 v[248:251], a[88:91], a[28:31], v[248:251]
  v_mfma_f32_16x16x32_bf16 v[156:159], a[92:95], a[16:19], v[156:159]
  v_mfma_f32_16x16x32_bf16 v[188:191], a[92:95], a[20:23], v[188:191]
  v_mfma_f32_16x16x32_bf16 v[220:223], a[92:95], a[24:27], v[220:223]
  v_mfma_f32_16x16x32_bf16 v[252:255], a[92:95], a[28:31], v[252:255]
  s_waitcnt lgkmcnt(0)
  v_mfma_f32_16x16x32_bf16 v[128:131], a[32:35], a[0:3], v[128:131]
  buffer_load_dwordx4 v6, s[8:11], s46 offen offset:2048 lds
  ds_read_b128 a[16:19], v17 offset:0
  v_mfma_f32_16x16x32_bf16 v[160:163], a[32:35], a[4:7], v[160:163]
  ds_read_b64_tr_b16 a[64:65], v18 offset:4096
  v_mfma_f32_16x16x32_bf16 v[192:195], a[32:35], a[8:11], v[192:195]
  ds_read_b64_tr_b16 a[66:67], v18 offset:6144
  v_mfma_f32_16x16x32_bf16 v[224:227], a[32:35], a[12:15], v[224:227]
  ds_read_b128 a[20:23], v17 offset:2048
  v_mfma_f32_16x16x32_bf16 v[132:135], a[36:39], a[0:3], v[132:135]
  buffer_load_dwordx4 v7, s[8:11], s46 offen offset:3072 lds
  ds_read_b128 a[24:27], v17 offset:4096
  v_mfma_f32_16x16x32_bf16 v[164:167], a[36:39], a[4:7], v[164:167]
  s_add_u32 m0, s36, 4096
  ds_read_b128 a[28:31], v17 offset:6144
  v_mfma_f32_16x16x32_bf16 v[196:199], a[36:39], a[8:11], v[196:199]
  ds_read_b64_tr_b16 a[68:69], v19 offset:4096
  v_mfma_f32_16x16x32_bf16 v[228:231], a[36:39], a[12:15], v[228:231]
  ds_read_b64_tr_b16 a[70:71], v19 offset:6144
  v_mfma_f32_16x16x32_bf16 v[136:139], a[40:43], a[0:3], v[136:139]
  buffer_load_dwordx4 v4, s[8:11], s47 offen offset:0 lds
  ds_read_b64_tr_b16 a[72:73], v20 offset:4096
  v_mfma_f32_16x16x32_bf16 v[168:171], a[40:43], a[4:7], v[168:171]
  ds_read_b64_tr_b16 a[74:75], v20 offset:6144
  v_mfma_f32_16x16x32_bf16 v[200:203], a[40:43], a[8:11], v[200:203]
  v_mfma_f32_16x16x32_bf16 v[232:235], a[40:43], a[12:15], v[232:235]
  ds_read_b64_tr_b16 a[76:77], v21 offset:4096
  v_mfma_f32_16x16x32_bf16 v[140:143], a[44:47], a[0:3], v[140:143]
  buffer_load_dwordx4 v5, s[8:11], s47 offen offset:1024 lds
  ds_read_b64_tr_b16 a[78:79], v21 offset:6144
  v_mfma_f32_16x16x32_bf16 v[172:175], a[44:47], a[4:7], v[172:175]
  ds_read_b64_tr_b16 a[80:81], v18 offset:12288
  v_mfma_f32_16x16x32_bf16 v[204:207], a[44:47], a[8:11], v[204:207]
  ds_read_b64_tr_b16 a[82:83], v18 offset:14336
  v_mfma_f32_16x16x32_bf16 v[236:239], a[44:47], a[12:15], v[236:239]
  ds_read_b64_tr_b16 a[84:85], v19 offset:12288
  v_mfma_f32_16x16x32_bf16 v[144:147], a[48:51], a[0:3], v[144:147]
  buffer_load_dwordx4 v6, s[8:11], s47 offen offset:2048 lds
  ds_read_b64_tr_b16 a[86:87], v19 offset:14336
  v_mfma_f32_16x16x32_bf16 v[176:179], a[48:51], a[4:7], v[176:179]
  ds_read_b64_tr_b16 a[88:89], v20 offset:12288
  v_mfma_f32_16x16x32_bf16 v[208:211], a[48:51], a[8:11], v[208:211]
  ds_read_b64_tr_b16 a[90:91], v20 offset:14336
  v_mfma_f32_16x16x32_bf16 v[240:243], a[48:51], a[12:15], v[240:243]
  ds_read_b64_tr_b16 a[92:93], v21 offset:12288
  v_mfma_f32_16x16x32_bf16 v[148:151], a[52:55], a[0:3], v[148:151]
  buffer_load_dwordx4 v7, s[8:11], s47 offen offset:3072 lds
  ds_read_b64_tr_b16 a[94:95], v21 offset:14336
  v_mfma_f32_16x16x32_bf16 v[180:183], a[52:55], a[4:7], v[180:183]
  s_add_u32 s49, s49, 128
  s_and_b32 s49, s49, 2047
  s_or_b32 s46, s50, s49
  v_mfma_f32_16x16x32_bf16 v[212:215], a[52:55], a[8:11], v[212:215]
  s_or_b32 s47, s51, s49
  v_mfma_f32_16x16x32_bf16 v[244:247], a[52:55], a[12:15], v[244:247]
  s_add_u32 s36, s36, s38
  s_add_u32 s37, s37, 1
  s_cmp_eq_u32 s37, 3
  s_cselect_b32 s37, 0, s37
  s_cselect_b32 s38, s39, s40
  v_mfma_f32_16x16x32_bf16 v[152:155], a[56:59], a[0:3], v[152:155]
  s_add_u32 s41, s41, s43
  s_add_u32 s42, s42, 1
  s_cmp_eq_u32 s42, 3
  s_cselect_b32 s42, 0, s42
  s_cselect_b32 s43, s44, s45
  v_mfma_f32_16x16x32_bf16 v[184:187], a[56:59], a[4:7], v[184:187]
  v_add_u32 v16, s38, v16
  v_add_u32 v17, s38, v17
  v_mfma_f32_16x16x32_bf16 v[216:219], a[56:59], a[8:11], v[216:219]
  v_add_u32 v18, s43, v18
  v_add_u32 v19, s43, v19
  v_mfma_f32_16x16x32_bf16 v[248:251], a[56:59], a[12:15], v[248:251]
  v_add_u32 v20, s43, v20
  v_add_u32 v21, s43, v21
  v_mfma_f32_16x16x32_bf16 v[156:159], a[60:63], a[0:3], v[156:159]
  v_mfma_f32_16x16x32_bf16 v[188:191], a[60:63], a[4:7], v[188:191]
  v_mfma_f32_16x16x32_bf16 v[220:223], a[60:63], a[8:11], v[220:223]
  v_mfma_f32_16x16x32_bf16 v[252:255], a[60:63], a[12:15], v[252:255]
  s_mov_b32 s35, 10
  .p2align 6
Lp3_loop:
  s_waitcnt vmcnt(12) lgkmcnt(0)
  s_barrier
  v_mfma_f32_16x16x32_bf16 v[128:131], a[64:67], a[16:19], v[128:131]
  s_mov_b32 m0, s41
  ds_read_b128 a[0:3], v16 offset:0
  v_mfma_f32_16x16x32_bf16 v[160:163], a[64:67], a[20:23], v[160:163]
  buffer_load_dwordx4 v8, s[12:15], s48 offen offset:0 lds
  ds_read_b64_tr_b16 a[32:33], v18 offset:0
  v_mfma_f32_16x16x32_bf16 v[192:195], a[64:67], a[24:27], v[192:195]
  ds_read_b64_tr_b16 a[34:35], v18 offset:2048
  v_mfma_f32_16x16x32_bf16 v[224:227], a[64:67], a[28:31], v[224:227]
  ds_read_b128 a[4:7], v16 offset:2048
  v_mfma_f32_16x16x32_bf16 v[132:135], a[68:71], a[16:19], v[132:135]
  ds_read_b128 a[8:11], v16 offset:4096
  v_mfma_f32_16x16x32_bf16 v[164:167], a[68:71], a[20:23], v[164:167]
  buffer_load_dwordx4 v9, s[12:15], s48 offen offset:1024 lds
  ds_read_b128 a[12:15], v16 offset:6144
  v_mfma_f32_16x16x32_bf16 v[196:199], a[68:71], a[24:27], v[196:199]
  ds_read_b64_tr_b16 a[36:37], v19 offset:0
  v_mfma_f32_16x16x32_bf16 v[228:231], a[68:71], a[28:31], v[228:231]
  ds_read_b64_tr_b16 a[38:39], v19 offset:2048
  v_mfma_f32_16x16x32_bf16 v[136:139], a[72:75], a[16:19], v[136:139]
  ds_read_b64_tr_b16 a[40:41], v20 offset:0
  v_mfma_f32_16x16x32_bf16 v[168:171], a[72:75], a[20:23], v[168:171]
  ds_read_b64_tr_b16 a[42:43], v20 offset:2048
  v_mfma_f32_16x16x32_bf16 v[200:203], a[72:75], a[24:27], v[200:203]
  buffer_load_dwordx4 v10, s[12:15], s48 offen offset:2048 lds
  v_mfma_f32_16x16x32_bf16 v[232:235], a[72:75], a[28:31], v[232:235]
  ds_read_b64_tr_b16 a[44:45], v21 offset:0
  v_mfma_f32_16x16x32_bf16 v[140:143], a[76:79], a[16:19], v[140:143]
  ds_read_b64_tr_b16 a[46:47], v21 offset:2048
  v_mfma_f32_16x16x32_bf16 v[172:175], a[76:79], a[20:23], v[172:175]
  ds_read_b64_tr_b16 a[48:49], v18 offset:8192
  v_mfma_f32_16x16x32_bf16 v[204:207], a[76:79], a[24:27], v[204:207]
  ds_read_b64_tr_b16 a[50:51], v18 offset:10240
  v_mfma_f32_16x16x32_bf16 v[236:239], a[76:79], a[28:31], v[236:239]
  buffer_load_dwordx4 v11, s[12:15], s48 offen offset:3072 lds
  ds_read_b64_tr_b16 a[52:53], v19 offset:8192
  v_mfma_f32_16x16x32_bf16 v[144:147], a[80:83], a[16:19], v[144:147]
  s_add_u32 s48, s48, 524288
  s_and_b32 s48, s48, 8388607
  s_mov_b32 m0, s36
  v_mfma_f32_16x16x32_bf16 v[176:179], a[80:83], a[20:23], v[176:179]
  ds_read_b64_tr_b16 a[54:55], v19 offset:10240
  ds_read_b64_tr_b16 a[56:57], v20 offset:8192
  v_mfma_f32_16x16x32_bf16 v[208:211], a[80:83], a[24:27], v[208:211]
  ds_read_b64_tr_b16 a[58:59], v20 offset:10240
  v_mfma_f32_16x16x32_bf16 v[240:243], a[80:83], a[28:31], v[240:243]
  ds_read_b64_tr_b16 a[60:61], v21 offset:8192
  v_mfma_f32_16x16x32_bf16 v[148:151], a[84:87], a[16:19], v[148:151]
  buffer_load_dwordx4 v4, s[8:11], s46 offen offset:0 lds
  ds_read_b64_tr_b16 a[62:63], v21 offset:10240
  v_mfma_f32_16x16x32_bf16 v[180:183], a[84:87], a[20:23], v[180:183]
  v_mfma_f32_16x16x32_bf16 v[212:215], a[84:87], a[24:27], v[212:215]
  v_mfma_f32_16x16x32_bf16 v[244:247], a[84:87], a[28:31], v[244:247]
  v_mfma_f32_16x16x32_bf16 v[152:155], a[88:91], a[16:19], v[152:155]
  v_mfma_f32_16x16x32_bf16 v[184:187], a[88:91], a[20:23], v[184:187]
  buffer_load_dwordx4 v5, s[8:11], s46 offen offset:1024 lds
  v_mfma_f32_16x16x32_bf16 v[216:219], a[88:91], a[24:27], v[216:219]
  v_mfma_f32_16x16x32_bf16 v[248:251], a[88:91], a[28:31], v[248:251]
  v_mfma_f32_16x16x32_bf16 v[156:159], a[92:95], a[16:19], v[156:159]
  v_mfma_f32_16x16x32_bf16 v[188:191], a[92:95], a[20:23], v[188:191]
  v_mfma_f32_16x16x32_bf16 v[220:223], a[92:95], a[24:27], v[220:223]
  v_mfma_f32_16x16x32_bf16 v[252:255], a[92:95], a[28:31], v[252:255]
  s_waitcnt lgkmcnt(0)
  v_mfma_f32_16x16x32_bf16 v[128:131], a[32:35], a[0:3], v[128:131]
  buffer_load_dwordx4 v6, s[8:11], s46 offen offset:2048 lds
  ds_read_b128 a[16:19], v17 offset:0
  v_mfma_f32_16x16x32_bf16 v[160:163], a[32:35], a[4:7], v[160:163]
  ds_read_b64_tr_b16 a[64:65], v18 offset:4096
  v_mfma_f32_16x16x32_bf16 v[192:195], a[32:35], a[8:11], v[192:195]
  ds_read_b64_tr_b16 a[66:67], v18 offset:6144
  v_mfma_f32_16x16x32_bf16 v[224:227], a[32:35], a[12:15], v[224:227]
  ds_read_b128 a[20:23], v17 offset:2048
  v_mfma_f32_16x16x32_bf16 v[132:135], a[36:39], a[0:3], v[132:135]
  buffer_load_dwordx4 v7, s[8:11], s46 offen offset:3072 lds
  ds_read_b128 a[24:27], v17 offset:4096
  v_mfma_f32_16x16x32_bf16 v[164:167], a[36:39], a[4:7], v[164:167]
  s_add_u32 m0, s36, 4096
  ds_read_b128 a[28:31], v17 offset:6144
  v_mfma_f32_16x16x32_bf16 v[196:199], a[36:39], a[8:11], v[196:199]
  ds_read_b64_tr_b16 a[68:69], v19 offset:4096
  v_mfma_f32_16x16x32_bf16 v[228:231], a[36:39], a[12:15], v[228:231]
  ds_read_b64_tr_b16 a[70:71], v19 offset:6144
  v_mfma_f32_16x16x32_bf16 v[136:139], a[40:43], a[0:3], v[136:139]
  buffer_load_dwordx4 v4, s[8:11], s47 offen offset:0 lds
  ds_read_b64_tr_b16 a[72:73], v20 offset:4096
  v_mfma_f32_16x16x32_bf16 v[168:171], a[40:43], a[4:7], v[168:171]
  ds_read_b64_tr_b16 a[74:75], v20 offset:6144
  v_mfma_f32_16x16x32_bf16 v[200:203], a[40:43], a[8:11], v[200:203]
  v_mfma_f32_16x16x32_bf16 v[232:235], a[40:43], a[12:15], v[232:235]
  ds_read_b64_tr_b16 a[76:77], v21 offset:4096
  v_mfma_f32_16x16x32_bf16 v[140:143], a[44:47], a[0:3], v[140:143]
  buffer_load_dwordx4 v5, s[8:11], s47 offen offset:1024 lds
  ds_read_b64_tr_b16 a[78:79], v21 offset:6144
  v_mfma_f32_16x16x32_bf16 v[172:175], a[44:47], a[4:7], v[172:175]
  ds_read_b64_tr_b16 a[80:81], v18 offset:12288
  v_mfma_f32_16x16x32_bf16 v[204:207], a[44:47], a[8:11], v[204:207]
  ds_read_b64_tr_b16 a[82:83], v18 offset:14336
  v_mfma_f32_16x16x32_bf16 v[236:239], a[44:47], a[12:15], v[236:239]
  ds_read_b64_tr_b16 a[84:85], v19 offset:12288
  v_mfma_f32_16x16x32_bf16 v[144:147], a[48:51], a[0:3], v[144:147]
  buffer_load_dwordx4 v6, s[8:11], s47 offen offset:2048 lds
  ds_read_b64_tr_b16 a[86:87], v19 offset:14336
  v_mfma_f32_16x16x32_bf16 v[176:179], a[48:51], a[4:7], v[176:179]
  ds_read_b64_tr_b16 a[88:89], v20 offset:12288
  v_mfma_f32_16x16x32_bf16 v[208:211], a[48:51], a[8:11], v[208:211]
  ds_read_b64_tr_b16 a[90:91], v20 offset:14336
  v_mfma_f32_16x16x32_bf16 v[240:243], a[48:51], a[12:15], v[240:243]
  ds_read_b64_tr_b16 a[92:93], v21 offset:12288
  v_mfma_f32_16x16x32_bf16 v[148:151], a[52:55], a[0:3], v[148:151]
  buffer_load_dwordx4 v7, s[8:11], s47 offen offset:3072 lds
  ds_read_b64_tr_b16 a[94:95], v21 offset:14336
  v_mfma_f32_16x16x32_bf16 v[180:183], a[52:55], a[4:7], v[180:183]
  s_add_u32 s49, s49, 128
  s_and_b32 s49, s49, 2047
  s_or_b32 s46, s50, s49
  v_mfma_f32_16x16x32_bf16 v[212:215], a[52:55], a[8:11], v[212:215]
  s_or_b32 s47, s51, s49
  v_mfma_f32_16x16x32_bf16 v[244:247], a[52:55], a[12:15], v[244:247]
  s_add_u32 s36, s36, s38
  s_add_u32 s37, s37, 1
  s_cmp_eq_u32 s37, 3
  s_cselect_b32 s37, 0, s37
  s_cselect_b32 s38, s39, s40
  v_mfma_f32_16x16x32_bf16 v[152:155], a[56:59], a[0:3], v[152:155]
  s_add_u32 s41, s41, s43
  s_add_u32 s42, s42, 1
  s_cmp_eq_u32 s42, 3
  s_cselect_b32 s42, 0, s42
  s_cselect_b32 s43, s44, s45
  v_mfma_f32_16x16x32_bf16 v[184:187], a[56:59], a[4:7], v[184:187]
  v_add_u32 v16, s38, v16
  v_add_u32 v17, s38, v17
  v_mfma_f32_16x16x32_bf16 v[216:219], a[56:59], a[8:11], v[216:219]
  v_add_u32 v18, s43, v18
  v_add_u32 v19, s43, v19
  v_mfma_f32_16x16x32_bf16 v[248:251], a[56:59], a[12:15], v[248:251]
  v_add_u32 v20, s43, v20
  v_add_u32 v21, s43, v21
  v_mfma_f32_16x16x32_bf16 v[156:159], a[60:63], a[0:3], v[156:159]
  v_mfma_f32_16x16x32_bf16 v[188:191], a[60:63], a[4:7], v[188:191]
  v_mfma_f32_16x16x32_bf16 v[220:223], a[60:63], a[8:11], v[220:223]
  s_sub_u32 s35, s35, 1
  v_mfma_f32_16x16x32_bf16 v[252:255], a[60:63], a[12:15], v[252:255]
  s_cmp_lg_u32 s35, 0
  s_cbranch_scc1 Lp3_loop
  s_waitcnt vmcnt(12) lgkmcnt(0)
  s_barrier
  s_lshr_b32 s34, s24, 1
  s_lshl_b32 s34, s34, 11
  v_and_b32 v3, 15, v1
  v_lshlrev_b32 v3, 7, v3
  v_mfma_f32_16x16x32_bf16 v[128:131], a[64:67], a[16:19], v[128:131]
  buffer_load_dwordx2 v[22:23], v3, s[96:99], s34 offen sc1
  ds_read_b128 a[0:3], v16 offset:0
  v_mfma_f32_16x16x32_bf16 v[160:163], a[64:67], a[20:23], v[160:163]
  s_mov_b32 m0, s41
  ds_read_b64_tr_b16 a[32:33], v18 offset:0
  v_mfma_f32_16x16x32_bf16 v[192:195], a[64:67], a[24:27], v[192:195]
  ds_read_b64_tr_b16 a[34:35], v18 offset:2048
  v_mfma_f32_16x16x32_bf16 v[224:227], a[64:67], a[28:31], v[224:227]
  ds_read_b128 a[4:7], v16 offset:2048
  v_mfma_f32_16x16x32_bf16 v[132:135], a[68:71], a[16:19], v[132:135]
  buffer_load_dwordx4 v8, s[12:15], s48 offen offset:0 lds
  ds_read_b128 a[8:11], v16 offset:4096
  v_mfma_f32_16x16x32_bf16 v[164:167], a[68:71], a[20:23], v[164:167]
  ds_read_b128 a[12:15], v16 offset:6144
  v_mfma_f32_16x16x32_bf16 v[196:199], a[68:71], a[24:27], v[196:199]
  ds_read_b64_tr_b16 a[36:37], v19 offset:0
  v_mfma_f32_16x16x32_bf16 v[228:231], a[68:71], a[28:31], v[228:231]
  ds_read_b64_tr_b16 a[38:39], v19 offset:2048
  v_mfma_f32_16x16x32_bf16 v[136:139], a[72:75], a[16:19], v[136:139]
  buffer_load_dwordx4 v9, s[12:15], s48 offen offset:1024 lds
  ds_read_b64_tr_b16 a[40:41], v20 offset:0
  v_mfma_f32_16x16x32_bf16 v[168:171], a[72:75], a[20:23], v[168:171]
  ds_read_b64_tr_b16 a[42:43], v20 offset:2048
  v_mfma_f32_16x16x32_bf16 v[200:203], a[72:75], a[24:27], v[200:203]
  v_mfma_f32_16x16x32_bf16 v[232:235], a[72:75], a[28:31], v[232:235]
  ds_read_b64_tr_b16 a[44:45], v21 offset:0
  v_mfma_f32_16x16x32_bf16 v[140:143], a[76:79], a[16:19], v[140:143]
  ds_read_b64_tr_b16 a[46:47], v21 offset:2048
  v_mfma_f32_16x16x32_bf16 v[172:175], a[76:79], a[20:23], v[172:175]
  buffer_load_dwordx4 v10, s[12:15], s48 offen offset:2048 lds
  ds_read_b64_tr_b16 a[48:49], v18 offset:8192
  v_mfma_f32_16x16x32_bf16 v[204:207], a[76:79], a[24:27], v[204:207]
  ds_read_b64_tr_b16 a[50:51], v18 offset:10240
  v_mfma_f32_16x16x32_bf16 v[236:239], a[76:79], a[28:31], v[236:239]
  ds_read_b64_tr_b16 a[52:53], v19 offset:8192
  v_mfma_f32_16x16x32_bf16 v[144:147], a[80:83], a[16:19], v[144:147]
  ds_read_b64_tr_b16 a[54:55], v19 offset:10240
  v_mfma_f32_16x16x32_bf16 v[176:179], a[80:83], a[20:23], v[176:179]
  buffer_load_dwordx4 v11, s[12:15], s48 offen offset:3072 lds
  ds_read_b64_tr_b16 a[56:57], v20 offset:8192
  v_mfma_f32_16x16x32_bf16 v[208:211], a[80:83], a[24:27], v[208:211]
  s_add_u32 s48, s48, 524288
  s_and_b32 s48, s48, 8388607
  s_mov_b32 m0, s36
  v_mfma_f32_16x16x32_bf16 v[240:243], a[80:83], a[28:31], v[240:243]
  ds_read_b64_tr_b16 a[58:59], v20 offset:10240
  ds_read_b64_tr_b16 a[60:61], v21 offset:8192
  v_mfma_f32_16x16x32_bf16 v[148:151], a[84:87], a[16:19], v[148:151]
  ds_read_b64_tr_b16 a[62:63], v21 offset:10240
  v_mfma_f32_16x16x32_bf16 v[180:183], a[84:87], a[20:23], v[180:183]
  v_mfma_f32_16x16x32_bf16 v[212:215], a[84:87], a[24:27], v[212:215]
  buffer_load_dwordx4 v4, s[8:11], s46 offen offset:0 lds
  v_mfma_f32_16x16x32_bf16 v[244:247], a[84:87], a[28:31], v[244:247]
  v_mfma_f32_16x16x32_bf16 v[152:155], a[88:91], a[16:19], v[152:155]
  v_mfma_f32_16x16x32_bf16 v[184:187], a[88:91], a[20:23], v[184:187]
  v_mfma_f32_16x16x32_bf16 v[216:219], a[88:91], a[24:27], v[216:219]
  buffer_load_dwordx4 v5, s[8:11], s46 offen offset:1024 lds
  v_mfma_f32_16x16x32_bf16 v[248:251], a[88:91], a[28:31], v[248:251]
  v_mfma_f32_16x16x32_bf16 v[156:159], a[92:95], a[16:19], v[156:159]
  v_mfma_f32_16x16x32_bf16 v[188:191], a[92:95], a[20:23], v[188:191]
  v_mfma_f32_16x16x32_bf16 v[220:223], a[92:95], a[24:27], v[220:223]
  v_mfma_f32_16x16x32_bf16 v[252:255], a[92:95], a[28:31], v[252:255]
  s_waitcnt lgkmcnt(0)
  v_mfma_f32_16x16x32_bf16 v[128:131], a[32:35], a[0:3], v[128:131]
  buffer_load_dwordx4 v6, s[8:11], s46 offen offset:2048 lds
  ds_read_b128 a[16:19], v17 offset:0
  v_mfma_f32_16x16x32_bf16 v[160:163], a[32:35], a[4:7], v[160:163]
  ds_read_b64_tr_b16 a[64:65], v18 offset:4096
  v_mfma_f32_16x16x32_bf16 v[192:195], a[32:35], a[8:11], v[192:195]
  ds_read_b64_tr_b16 a[66:67], v18 offset:6144
  v_mfma_f32_16x16x32_bf16 v[224:227], a[32:35], a[12:15], v[224:227]
  ds_read_b128 a[20:23], v17 offset:2048
  v_mfma_f32_16x16x32_bf16 v[132:135], a[36:39], a[0:3], v[132:135]
  buffer_load_dwordx4 v7, s[8:11], s46 offen offset:3072 lds
  ds_read_b128 a[24:27], v17 offset:4096
  v_mfma_f32_16x16x32_bf16 v[164:167], a[36:39], a[4:7], v[164:167]
  s_add_u32 m0, s36, 4096
  ds_read_b128 a[28:31], v17 offset:6144
  v_mfma_f32_16x16x32_bf16 v[196:199], a[36:39], a[8:11], v[196:199]
  ds_read_b64_tr_b16 a[68:69], v19 offset:4096
  v_mfma_f32_16x16x32_bf16 v[228:231], a[36:39], a[12:15], v[228:231]
  ds_read_b64_tr_b16 a[70:71], v19 offset:6144
  v_mfma_f32_16x16x32_bf16 v[136:139], a[40:43], a[0:3], v[136:139]
  buffer_load_dwordx4 v4, s[8:11], s47 offen offset:0 lds
  ds_read_b64_tr_b16 a[72:73], v20 offset:4096
  v_mfma_f32_16x16x32_bf16 v[168:171], a[40:43], a[4:7], v[168:171]
  ds_read_b64_tr_b16 a[74:75], v20 offset:6144
  v_mfma_f32_16x16x32_bf16 v[200:203], a[40:43], a[8:11], v[200:203]
  v_mfma_f32_16x16x32_bf16 v[232:235], a[40:43], a[12:15], v[232:235]
  ds_read_b64_tr_b16 a[76:77], v21 offset:4096
  v_mfma_f32_16x16x32_bf16 v[140:143], a[44:47], a[0:3], v[140:143]
  buffer_load_dwordx4 v5, s[8:11], s47 offen offset:1024 lds
  ds_read_b64_tr_b16 a[78:79], v21 offset:6144
  v_mfma_f32_16x16x32_bf16 v[172:175], a[44:47], a[4:7], v[172:175]
  ds_read_b64_tr_b16 a[80:81], v18 offset:12288
  v_mfma_f32_16x16x32_bf16 v[204:207], a[44:47], a[8:11], v[204:207]
  ds_read_b64_tr_b16 a[82:83], v18 offset:14336
  v_mfma_f32_16x16x32_bf16 v[236:239], a[44:47], a[12:15], v[236:239]
  ds_read_b64_tr_b16 a[84:85], v19 offset:12288
  v_mfma_f32_16x16x32_bf16 v[144:147], a[48:51], a[0:3], v[144:147]
  buffer_load_dwordx4 v6, s[8:11], s47 offen offset:2048 lds
  ds_read_b64_tr_b16 a[86:87], v19 offset:14336
  v_mfma_f32_16x16x32_bf16 v[176:179], a[48:51], a[4:7], v[176:179]
  ds_read_b64_tr_b16 a[88:89], v20 offset:12288
  v_mfma_f32_16x16x32_bf16 v[208:211], a[48:51], a[8:11], v[208:211]
  ds_read_b64_tr_b16 a[90:91], v20 offset:14336
  v_mfma_f32_16x16x32_bf16 v[240:243], a[48:51], a[12:15], v[240:243]
  ds_read_b64_tr_b16 a[92:93], v21 offset:12288
  v_mfma_f32_16x16x32_bf16 v[148:151], a[52:55], a[0:3], v[148:151]
  buffer_load_dwordx4 v7, s[8:11], s47 offen offset:3072 lds
  ds_read_b64_tr_b16 a[94:95], v21 offset:14336
  v_mfma_f32_16x16x32_bf16 v[180:183], a[52:55], a[4:7], v[180:183]
  s_add_u32 s49, s49, 128
  s_and_b32 s49, s49, 2047
  s_or_b32 s46, s50, s49
  v_mfma_f32_16x16x32_bf16 v[212:215], a[52:55], a[8:11], v[212:215]
  s_or_b32 s47, s51, s49
  v_mfma_f32_16x16x32_bf16 v[244:247], a[52:55], a[12:15], v[244:247]
  s_add_u32 s36, s36, s38
  s_add_u32 s37, s37, 1
  s_cmp_eq_u32 s37, 3
  s_cselect_b32 s37, 0, s37
  s_cselect_b32 s38, s39, s40
  v_mfma_f32_16x16x32_bf16 v[152:155], a[56:59], a[0:3], v[152:155]
  s_add_u32 s41, s41, s43
  s_add_u32 s42, s42, 1
  s_cmp_eq_u32 s42, 3
  s_cselect_b32 s42, 0, s42
  s_cselect_b32 s43, s44, s45
  v_mfma_f32_16x16x32_bf16 v[184:187], a[56:59], a[4:7], v[184:187]
  v_add_u32 v16, s38, v16
  v_add_u32 v17, s38, v17
  v_mfma_f32_16x16x32_bf16 v[216:219], a[56:59], a[8:11], v[216:219]
  v_add_u32 v18, s43, v18
  v_add_u32 v19, s43, v19
  v_mfma_f32_16x16x32_bf16 v[248:251], a[56:59], a[12:15], v[248:251]
  v_add_u32 v20, s43, v20
  v_add_u32 v21, s43, v21
  v_mfma_f32_16x16x32_bf16 v[156:159], a[60:63], a[0:3], v[156:159]
  v_mfma_f32_16x16x32_bf16 v[188:191], a[60:63], a[4:7], v[188:191]
  v_mfma_f32_16x16x32_bf16 v[220:223], a[60:63], a[8:11], v[220:223]
  v_mfma_f32_16x16x32_bf16 v[252:255], a[60:63], a[12:15], v[252:255]
  s_waitcnt vmcnt(12) lgkmcnt(0)
  s_barrier
  s_mov_b32 s5, 0x40000
Lpoll_11:
  v_cmp_ne_u64 vcc, s[94:95], v[22:23]
  s_nop 0
  s_cbranch_vccz Lpolld_12
  s_sleep 4
  buffer_load_dwordx2 v[22:23], v3, s[96:99], s34 offen sc1
  s_sub_u32 s5, s5, 1
  s_waitcnt vmcnt(0)
  s_cbranch_scc0 Lpoll_11
Lpolld_12:
  s_lshl_b32 s4, s24, 20
  s_lshl_b32 s5, s25, 16
  s_sub_u32 s5, 1048576, s5
  s_add_u32 s20, s86, 16777216
  s_addc_u32 s21, s87, 0
  s_add_u32 s20, s20, s4
  s_addc_u32 s21, s21, 0
  s_mov_b32 s22, s5
  s_mov_b32 s23, 0x00020000
  s_lshl_b32 s28, s3, 12
  s_add_u32 s26, s28, 0xc000
  s_add_u32 s27, s28, 0x10000
  s_add_u32 s29, s28, 0x4000
  s_and_b32 s4, s2, 1
  s_lshl_b32 s4, s4, 3
  s_bfe_u32 s5, s2, 0x30003
  s_add_u32 s73, s4, s5
  s_bfe_u32 s4, s2, 0x10001
  s_lshl_b32 s4, s4, 2
  s_lshr_b32 s5, s2, 6
  s_add_u32 s76, s4, s5
  s_bfe_u32 s77, s2, 0x10002
  s_lshl_b32 s78, s73, 3
  s_add_u32 s78, s78, s76
  s_lshl_b32 s79, s3, 12
  s_add_u32 s64, s79, 131072
  v_mfma_f32_16x16x32_bf16 v[128:131], a[64:67], a[16:19], v[128:131]
  s_mov_b32 m0, s26
  ds_read_b128 a[0:3], v16 offset:0
  v_mfma_f32_16x16x32_bf16 v[160:163], a[64:67], a[20:23], v[160:163]
  buffer_load_dwordx4 v2, s[20:23], s28 offen offset:0 sc1 lds
  ds_read_b64_tr_b16 a[32:33], v18 offset:0
  v_mfma_f32_16x16x32_bf16 v[192:195], a[64:67], a[24:27], v[192:195]
  ds_read_b64_tr_b16 a[34:35], v18 offset:2048
  v_mfma_f32_16x16x32_bf16 v[224:227], a[64:67], a[28:31], v[224:227]
  ds_read_b128 a[4:7], v16 offset:2048
  v_mfma_f32_16x16x32_bf16 v[132:135], a[68:71], a[16:19], v[132:135]
  ds_read_b128 a[8:11], v16 offset:4096
  v_mfma_f32_16x16x32_bf16 v[164:167], a[68:71], a[20:23], v[164:167]
  ds_read_b128 a[12:15], v16 offset:6144
  v_mfma_f32_16x16x32_bf16 v[196:199], a[68:71], a[24:27], v[196:199]
  ds_read_b64_tr_b16 a[36:37], v19 offset:0
  v_mfma_f32_16x16x32_bf16 v[228:231], a[68:71], a[28:31], v[228:231]
  ds_read_b64_tr_b16 a[38:39], v19 offset:2048
  v_mfma_f32_16x16x32_bf16 v[136:139], a[72:75], a[16:19], v[136:139]
  ds_read_b64_tr_b16 a[40:41], v20 offset:0
  v_mfma_f32_16x16x32_bf16 v[168:171], a[72:75], a[20:23], v[168:171]
  ds_read_b64_tr_b16 a[42:43], v20 offset:2048
  v_mfma_f32_16x16x32_bf16 v[200:203], a[72:75], a[24:27], v[200:203]
  v_mfma_f32_16x16x32_bf16 v[232:235], a[72:75], a[28:31], v[232:235]
  ds_read_b64_tr_b16 a[44:45], v21 offset:0
  v_mfma_f32_16x16x32_bf16 v[140:143], a[76:79], a[16:19], v[140:143]
  ds_read_b64_tr_b16 a[46:47], v21 offset:2048
  v_mfma_f32_16x16x32_bf16 v[172:175], a[76:79], a[20:23], v[172:175]
  ds_read_b64_tr_b16 a[48:49], v18 offset:8192
  v_mfma_f32_16x16x32_bf16 v[204:207], a[76:79], a[24:27], v[204:207]
  ds_read_b64_tr_b16 a[50:51], v18 offset:10240
  v_mfma_f32_16x16x32_bf16 v[236:239], a[76:79], a[28:31], v[236:239]
  buffer_load_dwordx4 v2, s[20:23], s28 offen offset:1024 sc1 lds
  ds_read_b64_tr_b16 a[52:53], v19 offset:8192
  v_mfma_f32_16x16x32_bf16 v[144:147], a[80:83], a[16:19], v[144:147]
  ds_read_b64_tr_b16 a[54:55], v19 offset:10240
  v_mfma_f32_16x16x32_bf16 v[176:179], a[80:83], a[20:23], v[176:179]
  ds_read_b64_tr_b16 a[56:57], v20 offset:8192
  v_mfma_f32_16x16x32_bf16 v[208:211], a[80:83], a[24:27], v[208:211]
  ds_read_b64_tr_b16 a[58:59], v20 offset:10240
  v_mfma_f32_16x16x32_bf16 v[240:243], a[80:83], a[28:31], v[240:243]
  ds_read_b64_tr_b16 a[60:61], v21 offset:8192
  v_mfma_f32_16x16x32_bf16 v[148:151], a[84:87], a[16:19], v[148:151]
  ds_read_b64_tr_b16 a[62:63], v21 offset:10240
  v_mfma_f32_16x16x32_bf16 v[180:183], a[84:87], a[20:23], v[180:183]
  v_mfma_f32_16x16x32_bf16 v[212:215], a[84:87], a[24:27], v[212:215]
  v_mfma_f32_16x16x32_bf16 v[244:247], a[84:87], a[28:31], v[244:247]
  v_mfma_f32_16x16x32_bf16 v[152:155], a[88:91], a[16:19], v[152:155]
  v_mfma_f32_16x16x32_bf16 v[184:187], a[88:91], a[20:23], v[184:187]
  v_mfma_f32_16x16x32_bf16 v[216:219], a[88:91], a[24:27], v[216:219]
  v_mfma_f32_16x16x32_bf16 v[248:251], a[88:91], a[28:31], v[248:251]
  v_mfma_f32_16x16x32_bf16 v[156:159], a[92:95], a[16:19], v[156:159]
  v_mfma_f32_16x16x32_bf16 v[188:191], a[92:95], a[20:23], v[188:191]
  v_mfma_f32_16x16x32_bf16 v[220:223], a[92:95], a[24:27], v[220:223]
  v_mfma_f32_16x16x32_bf16 v[252:255], a[92:95], a[28:31], v[252:255]
  s_waitcnt lgkmcnt(0)
  v_mfma_f32_16x16x32_bf16 v[128:131], a[32:35], a[0:3], v[128:131]
  buffer_load_dwordx4 v2, s[20:23], s28 offen offset:2048 sc1 lds
  ds_read_b128 a[16:19], v17 offset:0
  v_mfma_f32_16x16x32_bf16 v[160:163], a[32:35], a[4:7], v[160:163]
  ds_read_b64_tr_b16 a[64:65], v18 offset:4096
  v_mfma_f32_16x16x32_bf16 v[192:195], a[32:35], a[8:11], v[192:195]
  ds_read_b64_tr_b16 a[66:67], v18 offset:6144
  v_mfma_f32_16x16x32_bf16 v[224:227], a[32:35], a[12:15], v[224:227]
  ds_read_b128 a[20:23], v17 offset:2048
  v_mfma_f32_16x16x32_bf16 v[132:135], a[36:39], a[0:3], v[132:135]
  ds_read_b128 a[24:27], v17 offset:4096
  v_mfma_f32_16x16x32_bf16 v[164:167], a[36:39], a[4:7], v[164:167]
  ds_read_b128 a[28:31], v17 offset:6144
  v_mfma_f32_16x16x32_bf16 v[196:199], a[36:39], a[8:11], v[196:199]
  ds_read_b64_tr_b16 a[68:69], v19 offset:4096
  v_mfma_f32_16x16x32_bf16 v[228:231], a[36:39], a[12:15], v[228:231]
  ds_read_b64_tr_b16 a[70:71], v19 offset:6144
  v_mfma_f32_16x16x32_bf16 v[136:139], a[40:43], a[0:3], v[136:139]
  ds_read_b64_tr_b16 a[72:73], v20 offset:4096
  v_mfma_f32_16x16x32_bf16 v[168:171], a[40:43], a[4:7], v[168:171]
  ds_read_b64_tr_b16 a[74:75], v20 offset:6144
  v_mfma_f32_16x16x32_bf16 v[200:203], a[40:43], a[8:11], v[200:203]
  v_mfma_f32_16x16x32_bf16 v[232:235], a[40:43], a[12:15], v[232:235]
  ds_read_b64_tr_b16 a[76:77], v21 offset:4096
  v_mfma_f32_16x16x32_bf16 v[140:143], a[44:47], a[0:3], v[140:143]
  buffer_load_dwordx4 v2, s[20:23], s28 offen offset:3072 sc1 lds
  ds_read_b64_tr_b16 a[78:79], v21 offset:6144
  v_mfma_f32_16x16x32_bf16 v[172:175], a[44:47], a[4:7], v[172:175]
  s_xor_b32 s26, s26, 0x4000
  s_add_u32 s28, s28, 0x8000
  ds_read_b64_tr_b16 a[80:81], v18 offset:12288
  v_mfma_f32_16x16x32_bf16 v[204:207], a[44:47], a[8:11], v[204:207]
  s_add_u32 s36, s36, s38
  s_add_u32 s37, s37, 1
  ds_read_b64_tr_b16 a[82:83], v18 offset:14336
  v_mfma_f32_16x16x32_bf16 v[236:239], a[44:47], a[12:15], v[236:239]
  s_cmp_eq_u32 s37, 3
  s_cselect_b32 s37, 0, s37
  s_cselect_b32 s38, s39, s40
  ds_read_b64_tr_b16 a[84:85], v19 offset:12288
  v_mfma_f32_16x16x32_bf16 v[144:147], a[48:51], a[0:3], v[144:147]
  s_add_u32 s41, s41, s43
  s_add_u32 s42, s42, 1
  ds_read_b64_tr_b16 a[86:87], v19 offset:14336
  v_mfma_f32_16x16x32_bf16 v[176:179], a[48:51], a[4:7], v[176:179]
  s_cmp_eq_u32 s42, 3
  s_cselect_b32 s42, 0, s42
  s_cselect_b32 s43, s44, s45
  ds_read_b64_tr_b16 a[88:89], v20 offset:12288
  v_mfma_f32_16x16x32_bf16 v[208:211], a[48:51], a[8:11], v[208:211]
  ds_read_b64_tr_b16 a[90:91], v20 offset:14336
  v_mfma_f32_16x16x32_bf16 v[240:243], a[48:51], a[12:15], v[240:243]
  ds_read_b64_tr_b16 a[92:93], v21 offset:12288
  v_mfma_f32_16x16x32_bf16 v[148:151], a[52:55], a[0:3], v[148:151]
  ds_read_b64_tr_b16 a[94:95], v21 offset:14336
  v_mfma_f32_16x16x32_bf16 v[180:183], a[52:55], a[4:7], v[180:183]
  v_add_u32 v16, s38, v16
  v_add_u32 v17, s38, v17
  v_mfma_f32_16x16x32_bf16 v[212:215], a[52:55], a[8:11], v[212:215]
  v_add_u32 v18, s43, v18
  v_add_u32 v19, s43, v19
  v_mfma_f32_16x16x32_bf16 v[244:247], a[52:55], a[12:15], v[244:247]
  v_add_u32 v20, s43, v20
  v_add_u32 v21, s43, v21
  v_mfma_f32_16x16x32_bf16 v[152:155], a[56:59], a[0:3], v[152:155]
  v_mfma_f32_16x16x32_bf16 v[184:187], a[56:59], a[4:7], v[184:187]
  v_mfma_f32_16x16x32_bf16 v[216:219], a[56:59], a[8:11], v[216:219]
  v_mfma_f32_16x16x32_bf16 v[248:251], a[56:59], a[12:15], v[248:251]
  v_mfma_f32_16x16x32_bf16 v[156:159], a[60:63], a[0:3], v[156:159]
  v_mfma_f32_16x16x32_bf16 v[188:191], a[60:63], a[4:7], v[188:191]
  v_mfma_f32_16x16x32_bf16 v[220:223], a[60:63], a[8:11], v[220:223]
  v_mfma_f32_16x16x32_bf16 v[252:255], a[60:63], a[12:15], v[252:255]
  s_waitcnt vmcnt(4) lgkmcnt(0)
  s_barrier
  v_mfma_f32_16x16x32_bf16 v[128:131], a[64:67], a[16:19], v[128:131]
  s_mov_b32 m0, s26
  ds_read_b128 a[0:3], v16 offset:0
  v_mfma_f32_16x16x32_bf16 v[160:163], a[64:67], a[20:23], v[160:163]
  buffer_load_dwordx4 v2, s[20:23], s28 offen offset:0 sc1 lds
  ds_read_b64_tr_b16 a[32:33], v18 offset:0
  v_mfma_f32_16x16x32_bf16 v[192:195], a[64:67], a[24:27], v[192:195]
  ds_read_b64_tr_b16 a[34:35], v18 offset:2048
  v_mfma_f32_16x16x32_bf16 v[224:227], a[64:67], a[28:31], v[224:227]
  ds_read_b128 a[4:7], v16 offset:2048
  v_mfma_f32_16x16x32_bf16 v[132:135], a[68:71], a[16:19], v[132:135]
  ds_read_b128 a[8:11], v16 offset:4096
  v_mfma_f32_16x16x32_bf16 v[164:167], a[68:71], a[20:23], v[164:167]
  ds_read_b128 a[12:15], v16 offset:6144
  v_mfma_f32_16x16x32_bf16 v[196:199], a[68:71], a[24:27], v[196:199]
  ds_read_b64_tr_b16 a[36:37], v19 offset:0
  v_mfma_f32_16x16x32_bf16 v[228:231], a[68:71], a[28:31], v[228:231]
  buffer_load_dwordx4 v2, s[20:23], s28 offen offset:1024 sc1 lds
  ds_read_b64_tr_b16 a[38:39], v19 offset:2048
  v_mfma_f32_16x16x32_bf16 v[136:139], a[72:75], a[16:19], v[136:139]
  ds_read_b64_tr_b16 a[40:41], v20 offset:0
  v_mfma_f32_16x16x32_bf16 v[168:171], a[72:75], a[20:23], v[168:171]
  ds_read_b64_tr_b16 a[42:43], v20 offset:2048
  v_mfma_f32_16x16x32_bf16 v[200:203], a[72:75], a[24:27], v[200:203]
  v_mfma_f32_16x16x32_bf16 v[232:235], a[72:75], a[28:31], v[232:235]
  ds_read_b64_tr_b16 a[44:45], v21 offset:0
  v_mfma_f32_16x16x32_bf16 v[140:143], a[76:79], a[16:19], v[140:143]
  ds_read_b64_tr_b16 a[46:47], v21 offset:2048
  v_mfma_f32_16x16x32_bf16 v[172:175], a[76:79], a[20:23], v[172:175]
  ds_read_b64_tr_b16 a[48:49], v18 offset:8192
  v_mfma_f32_16x16x32_bf16 v[204:207], a[76:79], a[24:27], v[204:207]
  ds_read_b64_tr_b16 a[50:51], v18 offset:10240
  v_mfma_f32_16x16x32_bf16 v[236:239], a[76:79], a[28:31], v[236:239]
  buffer_load_dwordx4 v2, s[20:23], s28 offen offset:2048 sc1 lds
  ds_read_b64_tr_b16 a[52:53], v19 offset:8192
  v_mfma_f32_16x16x32_bf16 v[144:147], a[80:83], a[16:19], v[144:147]
  ds_read_b64_tr_b16 a[54:55], v19 offset:10240
  v_mfma_f32_16x16x32_bf16 v[176:179], a[80:83], a[20:23], v[176:179]
  ds_read_b64_tr_b16 a[56:57], v20 offset:8192
  v_mfma_f32_16x16x32_bf16 v[208:211], a[80:83], a[24:27], v[208:211]
  ds_read_b64_tr_b16 a[58:59], v20 offset:10240
  v_mfma_f32_16x16x32_bf16 v[240:243], a[80:83], a[28:31], v[240:243]
  ds_read_b64_tr_b16 a[60:61], v21 offset:8192
  v_mfma_f32_16x16x32_bf16 v[148:151], a[84:87], a[16:19], v[148:151]
  ds_read_b64_tr_b16 a[62:63], v21 offset:10240
  v_mfma_f32_16x16x32_bf16 v[180:183], a[84:87], a[20:23], v[180:183]
  v_mfma_f32_16x16x32_bf16 v[212:215], a[84:87], a[24:27], v[212:215]
  v_mfma_f32_16x16x32_bf16 v[244:247], a[84:87], a[28:31], v[244:247]
  buffer_load_dwordx4 v2, s[20:23], s28 offen offset:3072 sc1 lds
  v_mfma_f32_16x16x32_bf16 v[152:155], a[88:91], a[16:19], v[152:155]
  s_xor_b32 s26, s26, 0x8000
  s_add_u32 s28, s28, 0x8000
  v_mfma_f32_16x16x32_bf16 v[184:187], a[88:91], a[20:23], v[184:187]
  v_mfma_f32_16x16x32_bf16 v[216:219], a[88:91], a[24:27], v[216:219]
  v_mfma_f32_16x16x32_bf16 v[248:251], a[88:91], a[28:31], v[248:251]
  v_mfma_f32_16x16x32_bf16 v[156:159], a[92:95], a[16:19], v[156:159]
  v_mfma_f32_16x16x32_bf16 v[188:191], a[92:95], a[20:23], v[188:191]
  v_mfma_f32_16x16x32_bf16 v[220:223], a[92:95], a[24:27], v[220:223]
  v_mfma_f32_16x16x32_bf16 v[252:255], a[92:95], a[28:31], v[252:255]
  s_waitcnt lgkmcnt(0)
  v_mfma_f32_16x16x32_bf16 v[128:131], a[32:35], a[0:3], v[128:131]
  s_mov_b32 m0, s27
  ds_read_b128 a[16:19], v17 offset:0
  v_mfma_f32_16x16x32_bf16 v[160:163], a[32:35], a[4:7], v[160:163]
  buffer_load_dwordx4 v2, s[20:23], s29 offen offset:0 sc1 lds
  ds_read_b64_tr_b16 a[64:65], v18 offset:4096
  v_mfma_f32_16x16x32_bf16 v[192:195], a[32:35], a[8:11], v[192:195]
  ds_read_b64_tr_b16 a[66:67], v18 offset:6144
  v_mfma_f32_16x16x32_bf16 v[224:227], a[32:35], a[12:15], v[224:227]
  ds_read_b128 a[20:23], v17 offset:2048
  v_mfma_f32_16x16x32_bf16 v[132:135], a[36:39], a[0:3], v[132:135]
  ds_read_b128 a[24:27], v17 offset:4096
  v_mfma_f32_16x16x32_bf16 v[164:167], a[36:39], a[4:7], v[164:167]
  ds_read_b128 a[28:31], v17 offset:6144
  v_mfma_f32_16x16x32_bf16 v[196:199], a[36:39], a[8:11], v[196:199]
  ds_read_b64_tr_b16 a[68:69], v19 offset:4096
  v_mfma_f32_16x16x32_bf16 v[228:231], a[36:39], a[12:15], v[228:231]
  buffer_load_dwordx4 v2, s[20:23], s29 offen offset:1024 sc1 lds
  ds_read_b64_tr_b16 a[70:71], v19 offset:6144
  v_mfma_f32_16x16x32_bf16 v[136:139], a[40:43], a[0:3], v[136:139]
  ds_read_b64_tr_b16 a[72:73], v20 offset:4096
  v_mfma_f32_16x16x32_bf16 v[168:171], a[40:43], a[4:7], v[168:171]
  ds_read_b64_tr_b16 a[74:75], v20 offset:6144
  v_mfma_f32_16x16x32_bf16 v[200:203], a[40:43], a[8:11], v[200:203]
  v_mfma_f32_16x16x32_bf16 v[232:235], a[40:43], a[12:15], v[232:235]
  ds_read_b64_tr_b16 a[76:77], v21 offset:4096
  v_mfma_f32_16x16x32_bf16 v[140:143], a[44:47], a[0:3], v[140:143]
  ds_read_b64_tr_b16 a[78:79], v21 offset:6144
  v_mfma_f32_16x16x32_bf16 v[172:175], a[44:47], a[4:7], v[172:175]
  ds_read_b64_tr_b16 a[80:81], v18 offset:12288
  v_mfma_f32_16x16x32_bf16 v[204:207], a[44:47], a[8:11], v[204:207]
  ds_read_b64_tr_b16 a[82:83], v18 offset:14336
  v_mfma_f32_16x16x32_bf16 v[236:239], a[44:47], a[12:15], v[236:239]
  buffer_load_dwordx4 v2, s[20:23], s29 offen offset:2048 sc1 lds
  ds_read_b64_tr_b16 a[84:85], v19 offset:12288
  v_mfma_f32_16x16x32_bf16 v[144:147], a[48:51], a[0:3], v[144:147]
  ds_read_b64_tr_b16 a[86:87], v19 offset:14336
  v_mfma_f32_16x16x32_bf16 v[176:179], a[48:51], a[4:7], v[176:179]
  ds_read_b64_tr_b16 a[88:89], v20 offset:12288
  v_mfma_f32_16x16x32_bf16 v[208:211], a[48:51], a[8:11], v[208:211]
  ds_read_b64_tr_b16 a[90:91], v20 offset:14336
  v_mfma_f32_16x16x32_bf16 v[240:243], a[48:51], a[12:15], v[240:243]
  ds_read_b64_tr_b16 a[92:93], v21 offset:12288
  v_mfma_f32_16x16x32_bf16 v[148:151], a[52:55], a[0:3], v[148:151]
  ds_read_b64_tr_b16 a[94:95], v21 offset:14336
  v_mfma_f32_16x16x32_bf16 v[180:183], a[52:55], a[4:7], v[180:183]
  v_mfma_f32_16x16x32_bf16 v[212:215], a[52:55], a[8:11], v[212:215]
  v_mfma_f32_16x16x32_bf16 v[244:247], a[52:55], a[12:15], v[244:247]
  buffer_load_dwordx4 v2, s[20:23], s29 offen offset:3072 sc1 lds
  v_mfma_f32_16x16x32_bf16 v[152:155], a[56:59], a[0:3], v[152:155]
  s_xor_b32 s27, s27, 0x4000
  s_add_u32 s29, s29, 0x8000
  v_mfma_f32_16x16x32_bf16 v[184:187], a[56:59], a[4:7], v[184:187]
  v_mfma_f32_16x16x32_bf16 v[216:219], a[56:59], a[8:11], v[216:219]
  v_mfma_f32_16x16x32_bf16 v[248:251], a[56:59], a[12:15], v[248:251]
  v_mfma_f32_16x16x32_bf16 v[156:159], a[60:63], a[0:3], v[156:159]
  v_mfma_f32_16x16x32_bf16 v[188:191], a[60:63], a[4:7], v[188:191]
  v_mfma_f32_16x16x32_bf16 v[220:223], a[60:63], a[8:11], v[220:223]
  v_mfma_f32_16x16x32_bf16 v[252:255], a[60:63], a[12:15], v[252:255]
  s_waitcnt lgkmcnt(0)
  v_mfma_f32_16x16x32_bf16 v[128:131], a[64:67], a[16:19], v[128:131]
  v_mfma_f32_16x16x32_bf16 v[160:163], a[64:67], a[20:23], v[160:163]
  v_mfma_f32_16x16x32_bf16 v[192:195], a[64:67], a[24:27], v[192:195]
  v_mfma_f32_16x16x32_bf16 v[224:227], a[64:67], a[28:31], v[224:227]
  v_mfma_f32_16x16x32_bf16 v[132:135], a[68:71], a[16:19], v[132:135]
  v_mfma_f32_16x16x32_bf16 v[164:167], a[68:71], a[20:23], v[164:167]
  v_mfma_f32_16x16x32_bf16 v[196:199], a[68:71], a[24:27], v[196:199]
  v_mfma_f32_16x16x32_bf16 v[228:231], a[68:71], a[28:31], v[228:231]
  v_mfma_f32_16x16x32_bf16 v[136:139], a[72:75], a[16:19], v[136:139]
  v_mfma_f32_16x16x32_bf16 v[168:171], a[72:75], a[20:23], v[168:171]
  v_mfma_f32_16x16x32_bf16 v[200:203], a[72:75], a[24:27], v[200:203]
  v_mfma_f32_16x16x32_bf16 v[232:235], a[72:75], a[28:31], v[232:235]
  v_mfma_f32_16x16x32_bf16 v[140:143], a[76:79], a[16:19], v[140:143]
  v_mfma_f32_16x16x32_bf16 v[172:175], a[76:79], a[20:23], v[172:175]
  v_mfma_f32_16x16x32_bf16 v[204:207], a[76:79], a[24:27], v[204:207]
  v_mfma_f32_16x16x32_bf16 v[236:239], a[76:79], a[28:31], v[236:239]
  v_mfma_f32_16x16x32_bf16 v[144:147], a[80:83], a[16:19], v[144:147]
  v_mfma_f32_16x16x32_bf16 v[176:179], a[80:83], a[20:23], v[176:179]
  v_mfma_f32_16x16x32_bf16 v[208:211], a[80:83], a[24:27], v[208:211]
  v_mfma_f32_16x16x32_bf16 v[240:243], a[80:83], a[28:31], v[240:243]
  v_mfma_f32_16x16x32_bf16 v[148:151], a[84:87], a[16:19], v[148:151]
  v_mfma_f32_16x16x32_bf16 v[180:183], a[84:87], a[20:23], v[180:183]
  v_mfma_f32_16x16x32_bf16 v[212:215], a[84:87], a[24:27], v[212:215]
  v_mfma_f32_16x16x32_bf16 v[244:247], a[84:87], a[28:31], v[244:247]
  v_mfma_f32_16x16x32_bf16 v[152:155], a[88:91], a[16:19], v[152:155]
  v_mfma_f32_16x16x32_bf16 v[184:187], a[88:91], a[20:23], v[184:187]
  v_mfma_f32_16x16x32_bf16 v[216:219], a[88:91], a[24:27], v[216:219]
  v_mfma_f32_16x16x32_bf16 v[248:251], a[88:91], a[28:31], v[248:251]
  v_mfma_f32_16x16x32_bf16 v[156:159], a[92:95], a[16:19], v[156:159]
  v_mfma_f32_16x16x32_bf16 v[188:191], a[92:95], a[20:23], v[188:191]
  v_mfma_f32_16x16x32_bf16 v[220:223], a[92:95], a[24:27], v[220:223]
  v_mfma_f32_16x16x32_bf16 v[252:255], a[92:95], a[28:31], v[252:255]
  s_mov_b32 s4, 0x3e0293ee
  s_mov_b32 s5, s4
  v_pk_mul_f32 v[128:129], v[128:129], s[4:5]
  v_pk_mul_f32 v[130:131], v[130:131], s[4:5]
  v_pk_mul_f32 v[132:133], v[132:133], s[4:5]
  v_pk_mul_f32 v[134:135], v[134:135], s[4:5]
  v_cvt_pk_bf16_f32 v128, v128, v129
  v_cvt_pk_bf16_f32 v129, v130, v131
  v_cvt_pk_bf16_f32 v130, v132, v133
  v_cvt_pk_bf16_f32 v131, v134, v135
  v_accvgpr_write_b32 a128, v128
  v_accvgpr_write_b32 a129, v129
  v_accvgpr_write_b32 a130, v130
  v_accvgpr_write_b32 a131, v131
  v_pk_mul_f32 v[136:137], v[136:137], s[4:5]
  v_pk_mul_f32 v[138:139], v[138:139], s[4:5]
  v_pk_mul_f32 v[140:141], v[140:141], s[4:5]
  v_pk_mul_f32 v[142:143], v[142:143], s[4:5]
  v_cvt_pk_bf16_f32 v136, v136, v137
  v_cvt_pk_bf16_f32 v137, v138, v139
  v_cvt_pk_bf16_f32 v138, v140, v141
  v_cvt_pk_bf16_f32 v139, v142, v143
  v_accvgpr_write_b32 a132, v136
  v_accvgpr_write_b32 a133, v137
  v_accvgpr_write_b32 a134, v138
  v_accvgpr_write_b32 a135, v139
  v_pk_mul_f32 v[144:145], v[144:145], s[4:5]
  v_pk_mul_f32 v[146:147], v[146:147], s[4:5]
  v_pk_mul_f32 v[148:149], v[148:149], s[4:5]
  v_pk_mul_f32 v[150:151], v[150:151], s[4:5]
  v_cvt_pk_bf16_f32 v144, v144, v145
  v_cvt_pk_bf16_f32 v145, v146, v147
  v_cvt_pk_bf16_f32 v146, v148, v149
  v_cvt_pk_bf16_f32 v147, v150, v151
  v_accvgpr_write_b32 a136, v144
  v_accvgpr_write_b32 a137, v145
  v_accvgpr_write_b32 a138, v146
  v_accvgpr_write_b32 a139, v147
  v_pk_mul_f32 v[152:153], v[152:153], s[4:5]
  v_pk_mul_f32 v[154:155], v[154:155], s[4:5]
  v_pk_mul_f32 v[156:157], v[156:157], s[4:5]
  v_pk_mul_f32 v[158:159], v[158:159], s[4:5]
  v_cvt_pk_bf16_f32 v152, v152, v153
  v_cvt_pk_bf16_f32 v153, v154, v155
  v_cvt_pk_bf16_f32 v154, v156, v157
  v_cvt_pk_bf16_f32 v155, v158, v159
  v_accvgpr_write_b32 a140, v152
  v_accvgpr_write_b32 a141, v153
  v_accvgpr_write_b32 a142, v154
  v_accvgpr_write_b32 a143, v155
  v_pk_mul_f32 v[160:161], v[160:161], s[4:5]
  v_pk_mul_f32 v[162:163], v[162:163], s[4:5]
  v_pk_mul_f32 v[164:165], v[164:165], s[4:5]
  v_pk_mul_f32 v[166:167], v[166:167], s[4:5]
  v_cvt_pk_bf16_f32 v160, v160, v161
  v_cvt_pk_bf16_f32 v161, v162, v163
  v_cvt_pk_bf16_f32 v162, v164, v165
  v_cvt_pk_bf16_f32 v163, v166, v167
  v_accvgpr_write_b32 a144, v160
  v_accvgpr_write_b32 a145, v161
  v_accvgpr_write_b32 a146, v162
  v_accvgpr_write_b32 a147, v163
  v_pk_mul_f32 v[168:169], v[168:169], s[4:5]
  v_pk_mul_f32 v[170:171], v[170:171], s[4:5]
  v_pk_mul_f32 v[172:173], v[172:173], s[4:5]
  v_pk_mul_f32 v[174:175], v[174:175], s[4:5]
  v_cvt_pk_bf16_f32 v168, v168, v169
  v_cvt_pk_bf16_f32 v169, v170, v171
  v_cvt_pk_bf16_f32 v170, v172, v173
  v_cvt_pk_bf16_f32 v171, v174, v175
  v_accvgpr_write_b32 a148, v168
  v_accvgpr_write_b32 a149, v169
  v_accvgpr_write_b32 a150, v170
  v_accvgpr_write_b32 a151, v171
  v_pk_mul_f32 v[176:177], v[176:177], s[4:5]
  v_pk_mul_f32 v[178:179], v[178:179], s[4:5]
  v_pk_mul_f32 v[180:181], v[180:181], s[4:5]
  v_pk_mul_f32 v[182:183], v[182:183], s[4:5]
  v_cvt_pk_bf16_f32 v176, v176, v177
  v_cvt_pk_bf16_f32 v177, v178, v179
  v_cvt_pk_bf16_f32 v178, v180, v181
  v_cvt_pk_bf16_f32 v179, v182, v183
  v_accvgpr_write_b32 a152, v176
  v_accvgpr_write_b32 a153, v177
  v_accvgpr_write_b32 a154, v178
  v_accvgpr_write_b32 a155, v179
  v_pk_mul_f32 v[184:185], v[184:185], s[4:5]
  v_pk_mul_f32 v[186:187], v[186:187], s[4:5]
  v_pk_mul_f32 v[188:189], v[188:189], s[4:5]
  v_pk_mul_f32 v[190:191], v[190:191], s[4:5]
  v_cvt_pk_bf16_f32 v184, v184, v185
  v_cvt_pk_bf16_f32 v185, v186, v187
  v_cvt_pk_bf16_f32 v186, v188, v189
  v_cvt_pk_bf16_f32 v187, v190, v191
  v_accvgpr_write_b32 a156, v184
  v_accvgpr_write_b32 a157, v185
  v_accvgpr_write_b32 a158, v186
  v_accvgpr_write_b32 a159, v187
  v_pk_mul_f32 v[192:193], v[192:193], s[4:5]
  v_pk_mul_f32 v[194:195], v[194:195], s[4:5]
  v_pk_mul_f32 v[196:197], v[196:197], s[4:5]
  v_pk_mul_f32 v[198:199], v[198:199], s[4:5]
  v_cvt_pk_bf16_f32 v192, v192, v193
  v_cvt_pk_bf16_f32 v193, v194, v195
  v_cvt_pk_bf16_f32 v194, v196, v197
  v_cvt_pk_bf16_f32 v195, v198, v199
  v_accvgpr_write_b32 a160, v192
  v_accvgpr_write_b32 a161, v193
  v_accvgpr_write_b32 a162, v194
  v_accvgpr_write_b32 a163, v195
  v_pk_mul_f32 v[200:201], v[200:201], s[4:5]
  v_pk_mul_f32 v[202:203], v[202:203], s[4:5]
  v_pk_mul_f32 v[204:205], v[204:205], s[4:5]
  v_pk_mul_f32 v[206:207], v[206:207], s[4:5]
  v_cvt_pk_bf16_f32 v200, v200, v201
  v_cvt_pk_bf16_f32 v201, v202, v203
  v_cvt_pk_bf16_f32 v202, v204, v205
  v_cvt_pk_bf16_f32 v203, v206, v207
  v_accvgpr_write_b32 a164, v200
  v_accvgpr_write_b32 a165, v201
  v_accvgpr_write_b32 a166, v202
  v_accvgpr_write_b32 a167, v203
  v_pk_mul_f32 v[208:209], v[208:209], s[4:5]
  v_pk_mul_f32 v[210:211], v[210:211], s[4:5]
  v_pk_mul_f32 v[212:213], v[212:213], s[4:5]
  v_pk_mul_f32 v[214:215], v[214:215], s[4:5]
  v_cvt_pk_bf16_f32 v208, v208, v209
  v_cvt_pk_bf16_f32 v209, v210, v211
  v_cvt_pk_bf16_f32 v210, v212, v213
  v_cvt_pk_bf16_f32 v211, v214, v215
  v_accvgpr_write_b32 a168, v208
  v_accvgpr_write_b32 a169, v209
  v_accvgpr_write_b32 a170, v210
  v_accvgpr_write_b32 a171, v211
  v_pk_mul_f32 v[216:217], v[216:217], s[4:5]
  v_pk_mul_f32 v[218:219], v[218:219], s[4:5]
  v_pk_mul_f32 v[220:221], v[220:221], s[4:5]
  v_pk_mul_f32 v[222:223], v[222:223], s[4:5]
  v_cvt_pk_bf16_f32 v216, v216, v217
  v_cvt_pk_bf16_f32 v217, v218, v219
  v_cvt_pk_bf16_f32 v218, v220, v221
  v_cvt_pk_bf16_f32 v219, v222, v223
  v_accvgpr_write_b32 a172, v216
  v_accvgpr_write_b32 a173, v217
  v_accvgpr_write_b32 a174, v218
  v_accvgpr_write_b32 a175, v219
  v_pk_mul_f32 v[224:225], v[224:225], s[4:5]
  v_pk_mul_f32 v[226:227], v[226:227], s[4:5]
  v_pk_mul_f32 v[228:229], v[228:229], s[4:5]
  v_pk_mul_f32 v[230:231], v[230:231], s[4:5]
  v_cvt_pk_bf16_f32 v224, v224, v225
  v_cvt_pk_bf16_f32 v225, v226, v227
  v_cvt_pk_bf16_f32 v226, v228, v229
  v_cvt_pk_bf16_f32 v227, v230, v231
  v_accvgpr_write_b32 a176, v224
  v_accvgpr_write_b32 a177, v225
  v_accvgpr_write_b32 a178, v226
  v_accvgpr_write_b32 a179, v227
  v_pk_mul_f32 v[232:233], v[232:233], s[4:5]
  v_pk_mul_f32 v[234:235], v[234:235], s[4:5]
  v_pk_mul_f32 v[236:237], v[236:237], s[4:5]
  v_pk_mul_f32 v[238:239], v[238:239], s[4:5]
  v_cvt_pk_bf16_f32 v232, v232, v233
  v_cvt_pk_bf16_f32 v233, v234, v235
  v_cvt_pk_bf16_f32 v234, v236, v237
  v_cvt_pk_bf16_f32 v235, v238, v239
  v_accvgpr_write_b32 a180, v232
  v_accvgpr_write_b32 a181, v233
  v_accvgpr_write_b32 a182, v234
  v_accvgpr_write_b32 a183, v235
  v_pk_mul_f32 v[240:241], v[240:241], s[4:5]
  v_pk_mul_f32 v[242:243], v[242:243], s[4:5]
  v_pk_mul_f32 v[244:245], v[244:245], s[4:5]
  v_pk_mul_f32 v[246:247], v[246:247], s[4:5]
  v_cvt_pk_bf16_f32 v240, v240, v241
  v_cvt_pk_bf16_f32 v241, v242, v243
  v_cvt_pk_bf16_f32 v242, v244, v245
  v_cvt_pk_bf16_f32 v243, v246, v247
  v_accvgpr_write_b32 a184, v240
  v_accvgpr_write_b32 a185, v241
  v_accvgpr_write_b32 a186, v242
  v_accvgpr_write_b32 a187, v243
  v_pk_mul_f32 v[248:249], v[248:249], s[4:5]
  v_pk_mul_f32 v[250:251], v[250:251], s[4:5]
  v_pk_mul_f32 v[252:253], v[252:253], s[4:5]
  v_pk_mul_f32 v[254:255], v[254:255], s[4:5]
  v_cvt_pk_bf16_f32 v248, v248, v249
  v_cvt_pk_bf16_f32 v249, v250, v251
  v_cvt_pk_bf16_f32 v250, v252, v253
  v_cvt_pk_bf16_f32 v251, v254, v255
  v_accvgpr_write_b32 a188, v248
  v_accvgpr_write_b32 a189, v249
  v_accvgpr_write_b32 a190, v250
  v_accvgpr_write_b32 a191, v251
  v_add_u32 v3, 0xc000, v2
  v_add_u32 v4, 0x10000, v2
  v_mov_b32 v5, 0xf149f2ca
  s_mov_b32 s89, 0
  v_mov_b32 v6, 0x3f803f80
  v_accvgpr_write_b32 a208, v6
  v_accvgpr_write_b32 a209, v6
  v_accvgpr_write_b32 a210, v6
  v_accvgpr_write_b32 a211, v6
  v_accvgpr_write_b32 a192, 0
  v_accvgpr_write_b32 a193, 0
  v_accvgpr_write_b32 a194, 0
  v_accvgpr_write_b32 a195, 0
  v_accvgpr_write_b32 a196, 0
  v_accvgpr_write_b32 a197, 0
  v_accvgpr_write_b32 a198, 0
  v_accvgpr_write_b32 a199, 0
  v_accvgpr_write_b32 a200, 0
  v_accvgpr_write_b32 a201, 0
  v_accvgpr_write_b32 a202, 0
  v_accvgpr_write_b32 a203, 0
  v_accvgpr_write_b32 a204, 0
  v_accvgpr_write_b32 a205, 0
  v_accvgpr_write_b32 a206, 0
  v_accvgpr_write_b32 a207, 0
  v_mov_b32 v128, 0
  v_mov_b32 v129, 0
  v_mov_b32 v130, 0
  v_mov_b32 v131, 0
  v_mov_b32 v132, 0
  v_mov_b32 v133, 0
  v_mov_b32 v134, 0
  v_mov_b32 v135, 0
  v_mov_b32 v136, 0
  v_mov_b32 v137, 0
  v_mov_b32 v138, 0
  v_mov_b32 v139, 0
  v_mov_b32 v140, 0
  v_mov_b32 v141, 0
  v_mov_b32 v142, 0
  v_mov_b32 v143, 0
  v_mov_b32 v144, 0
  v_mov_b32 v145, 0
  v_mov_b32 v146, 0
  v_mov_b32 v147, 0
  v_mov_b32 v148, 0
  v_mov_b32 v149, 0
  v_mov_b32 v150, 0
  v_mov_b32 v151, 0
  v_mov_b32 v152, 0
  v_mov_b32 v153, 0
  v_mov_b32 v154, 0
  v_mov_b32 v155, 0
  v_mov_b32 v156, 0
  v_mov_b32 v157, 0
  v_mov_b32 v158, 0
  v_mov_b32 v159, 0
  v_mov_b32 v160, 0
  v_mov_b32 v161, 0
  v_mov_b32 v162, 0
  v_mov_b32 v163, 0
  v_mov_b32 v164, 0
  v_mov_b32 v165, 0
  v_mov_b32 v166, 0
  v_mov_b32 v167, 0
  v_mov_b32 v168, 0
  v_mov_b32 v169, 0
  v_mov_b32 v170, 0
  v_mov_b32 v171, 0
  v_mov_b32 v172, 0
  v_mov_b32 v173, 0
  v_mov_b32 v174, 0
  v_mov_b32 v175, 0
  v_mov_b32 v176, 0
  v_mov_b32 v177, 0
  v_mov_b32 v178, 0
  v_mov_b32 v179, 0
  v_mov_b32 v180, 0
  v_mov_b32 v181, 0
  v_mov_b32 v182, 0
  v_mov_b32 v183, 0
  v_mov_b32 v184, 0
  v_mov_b32 v185, 0
  v_mov_b32 v186, 0
  v_mov_b32 v187, 0
  v_mov_b32 v188, 0
  v_mov_b32 v189, 0
  v_mov_b32 v190, 0
  v_mov_b32 v191, 0
  v_mov_b32 v192, 0
  v_mov_b32 v193, 0
  v_mov_b32 v194, 0
  v_mov_b32 v195, 0
  v_mov_b32 v196, 0
  v_mov_b32 v197, 0
  v_mov_b32 v198, 0
  v_mov_b32 v199, 0
  v_mov_b32 v200, 0
  v_mov_b32 v201, 0
  v_mov_b32 v202, 0
  v_mov_b32 v203, 0
  v_mov_b32 v204, 0
  v_mov_b32 v205, 0
  v_mov_b32 v206, 0
  v_mov_b32 v207, 0
  v_mov_b32 v208, 0
  v_mov_b32 v209, 0
  v_mov_b32 v210, 0
  v_mov_b32 v211, 0
  v_mov_b32 v212, 0
  v_mov_b32 v213, 0
  v_mov_b32 v214, 0
  v_mov_b32 v215, 0
  v_mov_b32 v216, 0
  v_mov_b32 v217, 0
  v_mov_b32 v218, 0
  v_mov_b32 v219, 0
  v_mov_b32 v220, 0
  v_mov_b32 v221, 0
  v_mov_b32 v222, 0
  v_mov_b32 v223, 0
  v_mov_b32 v224, 0
  v_mov_b32 v225, 0
  v_mov_b32 v226, 0
  v_mov_b32 v227, 0
  v_mov_b32 v228, 0
  v_mov_b32 v229, 0
  v_mov_b32 v230, 0
  v_mov_b32 v231, 0
  v_mov_b32 v232, 0
  v_mov_b32 v233, 0
  v_mov_b32 v234, 0
  v_mov_b32 v235, 0
  v_mov_b32 v236, 0
  v_mov_b32 v237, 0
  v_mov_b32 v238, 0
  v_mov_b32 v239, 0
  v_mov_b32 v240, 0
  v_mov_b32 v241, 0
  v_mov_b32 v242, 0
  v_mov_b32 v243, 0
  v_mov_b32 v244, 0
  v_mov_b32 v245, 0
  v_mov_b32 v246, 0
  v_mov_b32 v247, 0
  v_mov_b32 v248, 0
  v_mov_b32 v249, 0
  v_mov_b32 v250, 0
  v_mov_b32 v251, 0
  v_mov_b32 v252, 0
  v_mov_b32 v253, 0
  v_mov_b32 v254, 0
  v_mov_b32 v255, 0
  s_lshl_b32 s4, s2, 2
  s_add_u32 s4, s4, s3
  s_lshl_b32 s6, s4, 13
  s_lshl_b32 s7, s4, 11
  s_mov_b32 s8, s74
  s_mov_b32 s9, s75
  s_mov_b32 s10, 8388608
  s_mov_b32 s11, 0x00020000
  s_mov_b32 s12, s80
  s_mov_b32 s13, s81
  s_mov_b32 s14, 2097152
  s_mov_b32 s15, 0x00020000
  s_add_u32 s16, s86, 67108864
  s_addc_u32 s17, s87, 0
  s_mov_b32 s18, 16777216
  s_mov_b32 s19, 0x00020000
  v_and_b32 v6, 15, v1
  v_lshrrev_b32 v7, 4, v1
  v_sub_u32 v6, v6, v7
  v_lshlrev_b32 v6, 2, v6
  v_add_u32 v6, s3, v6
  v_cmp_gt_i32 s[32:33], 0, v6
  v_cmp_gt_i32 s[34:35], 1, v6
  v_cmp_gt_i32 s[36:37], 2, v6
  v_cmp_gt_i32 s[38:39], 3, v6
  v_cmp_gt_i32 s[40:41], 16, v6
  v_cmp_gt_i32 s[42:43], 17, v6
  v_cmp_gt_i32 s[44:45], 18, v6
  v_cmp_gt_i32 s[46:47], 19, v6
  v_cmp_gt_i32 s[48:49], 32, v6
  v_cmp_gt_i32 s[50:51], 33, v6
  v_cmp_gt_i32 s[52:53], 34, v6
  v_cmp_gt_i32 s[54:55], 35, v6
  v_cmp_gt_i32 s[56:57], 48, v6
  v_cmp_gt_i32 s[58:59], 49, v6
  v_cmp_gt_i32 s[60:61], 50, v6
  v_cmp_gt_i32 s[62:63], 51, v6
  s_mov_b32 s30, 0x8000
  s_mov_b32 s31, 0x4000
  s_waitcnt vmcnt(8)
  s_barrier
  ds_read_b128 a[32:35], v3 offset:0
  ds_read_b128 a[36:39], v3 offset:1024
  ds_read_b128 a[40:43], v3 offset:2048
  ds_read_b128 a[44:47], v3 offset:3072
  ds_read_b128 a[48:51], v3 offset:4096
  ds_read_b128 a[52:55], v3 offset:5120
  ds_read_b128 a[56:59], v3 offset:6144
  ds_read_b128 a[60:63], v3 offset:7168
  s_waitcnt lgkmcnt(6)
  v_mfma_f32_16x16x32_bf16 v[64:67], a[32:35], a[128:131], 0
  v_mfma_f32_16x16x32_bf16 v[72:75], a[32:35], a[144:147], 0
  v_mfma_f32_16x16x32_bf16 v[80:83], a[32:35], a[160:163], 0
  v_mfma_f32_16x16x32_bf16 v[88:91], a[32:35], a[176:179], 0
  ds_read_b128 a[0:3], v3 offset:8192
  v_mfma_f32_16x16x32_bf16 v[64:67], a[36:39], a[132:135], v[64:67]
  v_mfma_f32_16x16x32_bf16 v[72:75], a[36:39], a[148:151], v[72:75]
  v_mfma_f32_16x16x32_bf16 v[80:83], a[36:39], a[164:167], v[80:83]
  v_mfma_f32_16x16x32_bf16 v[88:91], a[36:39], a[180:183], v[88:91]
  ds_read_b128 a[4:7], v3 offset:9216
  s_waitcnt lgkmcnt(6)
  v_mfma_f32_16x16x32_bf16 v[64:67], a[40:43], a[136:139], v[64:67]
  v_mfma_f32_16x16x32_bf16 v[72:75], a[40:43], a[152:155], v[72:75]
  v_mfma_f32_16x16x32_bf16 v[80:83], a[40:43], a[168:171], v[80:83]
  v_mfma_f32_16x16x32_bf16 v[88:91], a[40:43], a[184:187], v[88:91]
  ds_read_b128 a[8:11], v3 offset:10240
  v_mfma_f32_16x16x32_bf16 v[64:67], a[44:47], a[140:143], v[64:67]
  v_mfma_f32_16x16x32_bf16 v[72:75], a[44:47], a[156:159], v[72:75]
  v_mfma_f32_16x16x32_bf16 v[80:83], a[44:47], a[172:175], v[80:83]
  v_mfma_f32_16x16x32_bf16 v[88:91], a[44:47], a[188:191], v[88:91]
  ds_read_b128 a[12:15], v3 offset:11264
  s_waitcnt lgkmcnt(6)
  v_mfma_f32_16x16x32_bf16 v[68:71], a[48:51], a[128:131], 0
  v_mfma_f32_16x16x32_bf16 v[76:79], a[48:51], a[144:147], 0
  v_mfma_f32_16x16x32_bf16 v[84:87], a[48:51], a[160:163], 0
  v_mfma_f32_16x16x32_bf16 v[92:95], a[48:51], a[176:179], 0
  ds_read_b128 a[16:19], v3 offset:12288
  v_mfma_f32_16x16x32_bf16 v[68:71], a[52:55], a[132:135], v[68:71]
  v_mfma_f32_16x16x32_bf16 v[76:79], a[52:55], a[148:151], v[76:79]
  v_mfma_f32_16x16x32_bf16 v[84:87], a[52:55], a[164:167], v[84:87]
  v_mfma_f32_16x16x32_bf16 v[92:95], a[52:55], a[180:183], v[92:95]
  ds_read_b128 a[20:23], v3 offset:13312
  s_waitcnt lgkmcnt(6)
  v_mfma_f32_16x16x32_bf16 v[68:71], a[56:59], a[136:139], v[68:71]
  v_mfma_f32_16x16x32_bf16 v[76:79], a[56:59], a[152:155], v[76:79]
  v_mfma_f32_16x16x32_bf16 v[84:87], a[56:59], a[168:171], v[84:87]
  v_mfma_f32_16x16x32_bf16 v[92:95], a[56:59], a[184:187], v[92:95]
  ds_read_b128 a[24:27], v3 offset:14336
  v_mfma_f32_16x16x32_bf16 v[68:71], a[60:63], a[140:143], v[68:71]
  v_mfma_f32_16x16x32_bf16 v[76:79], a[60:63], a[156:159], v[76:79]
  v_mfma_f32_16x16x32_bf16 v[84:87], a[60:63], a[172:175], v[84:87]
  v_mfma_f32_16x16x32_bf16 v[92:95], a[60:63], a[188:191], v[92:95]
  ds_read_b128 a[28:31], v3 offset:15360
  s_cmp_lg_u32 s25, 0
  s_nop 0
  s_cbranch_scc1 La_nomask0
  v_cndmask_b32 v64, v64, v5, s[32:33]
  v_cndmask_b32 v65, v65, v5, s[34:35]
  v_cndmask_b32 v66, v66, v5, s[36:37]
  v_cndmask_b32 v67, v67, v5, s[38:39]
  v_cndmask_b32 v68, v68, v5, s[40:41]
  v_cndmask_b32 v69, v69, v5, s[42:43]
  v_cndmask_b32 v70, v70, v5, s[44:45]
  v_cndmask_b32 v71, v71, v5, s[46:47]
La_nomask0:
  v_max3_f32 v6, v64, v65, v66
  v_max3_f32 v7, v67, v68, v69
  v_max3_f32 v6, v6, v70, v71
  v_max_f32 v6, v6, v7
  v_max3_f32 v8, v72, v73, v74
  v_max3_f32 v9, v75, v76, v77
  v_max3_f32 v8, v8, v78, v79
  v_max_f32 v8, v8, v9
  v_max3_f32 v10, v80, v81, v82
  v_max3_f32 v11, v83, v84, v85
  v_max3_f32 v10, v10, v86, v87
  v_max_f32 v10, v10, v11
  v_max3_f32 v12, v88, v89, v90
  v_max3_f32 v13, v91, v92, v93
  v_max3_f32 v12, v12, v94, v95
  v_max_f32 v12, v12, v13
  v_mov_b32 v7, v6
  v_mov_b32 v9, v8
  v_mov_b32 v11, v10
  v_mov_b32 v13, v12
  v_permlane32_swap_b32 v6, v7
  v_permlane32_swap_b32 v8, v9
  v_permlane32_swap_b32 v10, v11
  v_permlane32_swap_b32 v12, v13
  v_max_f32 v6, v6, v7
  v_max_f32 v8, v8, v9
  v_max_f32 v10, v10, v11
  v_max_f32 v12, v12, v13
  v_mov_b32 v7, v6
  v_mov_b32 v9, v8
  v_mov_b32 v11, v10
  v_mov_b32 v13, v12
  v_permlane16_swap_b32 v6, v7
  v_permlane16_swap_b32 v8, v9
  v_permlane16_swap_b32 v10, v11
  v_permlane16_swap_b32 v12, v13
  v_max_f32 v6, v6, v7
  v_max_f32 v8, v8, v9
  v_max_f32 v10, v10, v11
  v_max_f32 v12, v12, v13
  v_sub_f32 v16, 0, v6
  v_sub_f32 v17, 0, v6
  v_sub_f32 v18, 0, v6
  v_sub_f32 v19, 0, v6
  v_sub_f32 v20, 0, v8
  v_sub_f32 v21, 0, v8
  v_sub_f32 v22, 0, v8
  v_sub_f32 v23, 0, v8
  v_sub_f32 v24, 0, v10
  v_sub_f32 v25, 0, v10
  v_sub_f32 v26, 0, v10
  v_sub_f32 v27, 0, v10
  v_sub_f32 v28, 0, v12
  v_sub_f32 v29, 0, v12
  v_sub_f32 v30, 0, v12
  v_sub_f32 v31, 0, v12
  v_pk_add_f32 v[64:65], v[64:65], v[16:17]
  v_pk_add_f32 v[66:67], v[66:67], v[16:17]
  v_pk_add_f32 v[68:69], v[68:69], v[16:17]
  v_pk_add_f32 v[70:71], v[70:71], v[16:17]
  v_pk_add_f32 v[72:73], v[72:73], v[20:21]
  v_pk_add_f32 v[74:75], v[74:75], v[20:21]
  v_pk_add_f32 v[76:77], v[76:77], v[20:21]
  v_pk_add_f32 v[78:79], v[78:79], v[20:21]
  v_pk_add_f32 v[80:81], v[80:81], v[24:25]
  v_pk_add_f32 v[82:83], v[82:83], v[24:25]
  v_pk_add_f32 v[84:85], v[84:85], v[24:25]
  v_pk_add_f32 v[86:87], v[86:87], v[24:25]
  v_pk_add_f32 v[88:89], v[88:89], v[28:29]
  v_pk_add_f32 v[90:91], v[90:91], v[28:29]
  v_pk_add_f32 v[92:93], v[92:93], v[28:29]
  v_pk_add_f32 v[94:95], v[94:95], v[28:29]
  s_lshl_b32 s88, s25, 1
  s_waitcnt vmcnt(0)
  s_barrier
  s_waitcnt lgkmcnt(4)
  v_mfma_f32_16x16x32_bf16 v[96:99], a[0:3], a[128:131], v[16:19]
  s_mov_b32 m0, s26
  v_exp_f32 v64, v64
  v_mfma_f32_16x16x32_bf16 v[104:107], a[0:3], a[144:147], v[20:23]
  buffer_load_dwordx4 v2, s[20:23], s28 offen offset:0 sc1 lds
  v_exp_f32 v65, v65
  v_mfma_f32_16x16x32_bf16 v[112:115], a[0:3], a[160:163], v[24:27]
  buffer_load_dwordx4 v2, s[20:23], s28 offen offset:1024 sc1 lds
  v_exp_f32 v66, v66
  v_mfma_f32_16x16x32_bf16 v[120:123], a[0:3], a[176:179], v[28:31]
  buffer_load_dwordx4 v2, s[20:23], s28 offen offset:2048 sc1 lds
  v_exp_f32 v67, v67
  v_mfma_f32_16x16x32_bf16 v[96:99], a[4:7], a[132:135], v[96:99]
  v_exp_f32 v68, v68
  v_cvt_pk_bf16_f32 v32, v64, v65
  v_mfma_f32_16x16x32_bf16 v[104:107], a[4:7], a[148:151], v[104:107]
  buffer_load_dwordx4 v2, s[20:23], s28 offen offset:3072 sc1 lds
  v_exp_f32 v69, v69
  v_mfma_f32_16x16x32_bf16 v[112:115], a[4:7], a[164:167], v[112:115]
  s_xor_b32 s26, s26, 0x4000
  v_exp_f32 v70, v70
  v_cvt_pk_bf16_f32 v33, v66, v67
  v_mfma_f32_16x16x32_bf16 v[120:123], a[4:7], a[180:183], v[120:123]
  s_add_u32 s28, s28, 0x8000
  v_exp_f32 v71, v71
  v_cvt_pk_bf16_f32 v34, v68, v69
  v_mfma_f32_16x16x32_bf16 v[96:99], a[8:11], a[136:139], v[96:99]
  s_mov_b32 m0, s27
  v_exp_f32 v72, v72
  v_cvt_pk_bf16_f32 v35, v70, v71
  v_mfma_f32_16x16x32_bf16 v[104:107], a[8:11], a[152:155], v[104:107]
  buffer_load_dwordx4 v2, s[20:23], s29 offen offset:0 sc1 lds
  v_exp_f32 v73, v73
  v_mfma_f32_16x16x32_bf16 v[112:115], a[8:11], a[168:171], v[112:115]
  buffer_load_dwordx4 v2, s[20:23], s29 offen offset:1024 sc1 lds
  v_exp_f32 v74, v74
  v_mfma_f32_16x16x32_bf16 v[120:123], a[8:11], a[184:187], v[120:123]
  buffer_load_dwordx4 v2, s[20:23], s29 offen offset:2048 sc1 lds
  v_exp_f32 v75, v75
  v_mfma_f32_16x16x32_bf16 v[96:99], a[12:15], a[140:143], v[96:99]
  v_exp_f32 v76, v76
  v_cvt_pk_bf16_f32 v36, v72, v73
  v_mfma_f32_16x16x32_bf16 v[104:107], a[12:15], a[156:159], v[104:107]
  buffer_load_dwordx4 v2, s[20:23], s29 offen offset:3072 sc1 lds
  v_exp_f32 v77, v77
  v_mfma_f32_16x16x32_bf16 v[112:115], a[12:15], a[172:175], v[112:115]
  s_xor_b32 s27, s27, 0x8000
  v_exp_f32 v78, v78
  v_cvt_pk_bf16_f32 v37, v74, v75
  v_mfma_f32_16x16x32_bf16 v[120:123], a[12:15], a[188:191], v[120:123]
  s_waitcnt lgkmcnt(0)
  v_exp_f32 v79, v79
  v_cvt_pk_bf16_f32 v38, v76, v77
  v_mfma_f32_16x16x32_bf16 v[100:103], a[16:19], a[128:131], v[16:19]
  s_add_u32 s29, s29, 0x8000
  v_exp_f32 v80, v80
  v_cvt_pk_bf16_f32 v39, v78, v79
  v_mfma_f32_16x16x32_bf16 v[108:111], a[16:19], a[144:147], v[20:23]
  s_mov_b32 m0, s26
  v_exp_f32 v81, v81
  v_xor_b32 v3, 0x4000, v3
  v_mfma_f32_16x16x32_bf16 v[116:119], a[16:19], a[160:163], v[24:27]
  buffer_load_dwordx4 v2, s[20:23], s28 offen offset:0 sc1 lds
  v_exp_f32 v82, v82
  v_mfma_f32_16x16x32_bf16 v[124:127], a[16:19], a[176:179], v[28:31]
  buffer_load_dwordx4 v2, s[20:23], s28 offen offset:1024 sc1 lds
  v_exp_f32 v83, v83
  v_mfma_f32_16x16x32_bf16 v[100:103], a[20:23], a[132:135], v[100:103]
  buffer_load_dwordx4 v2, s[20:23], s28 offen offset:2048 sc1 lds
  v_exp_f32 v84, v84
  v_cvt_pk_bf16_f32 v41, v82, v83
  v_mfma_f32_16x16x32_bf16 v[108:111], a[20:23], a[148:151], v[108:111]
  buffer_load_dwordx4 v2, s[20:23], s28 offen offset:3072 sc1 lds
  v_exp_f32 v85, v85
  v_mfma_f32_16x16x32_bf16 v[116:119], a[20:23], a[164:167], v[116:119]
  s_xor_b32 s26, s26, 0x8000
  ds_read_b128 a[32:35], v3 offset:0
  v_exp_f32 v86, v86
  v_cvt_pk_bf16_f32 v42, v84, v85
  v_mfma_f32_16x16x32_bf16 v[124:127], a[20:23], a[180:183], v[124:127]
  s_add_u32 s28, s28, 0x8000
  v_exp_f32 v87, v87
  v_cvt_pk_bf16_f32 v40, v80, v81
  v_mfma_f32_16x16x32_bf16 v[100:103], a[24:27], a[136:139], v[100:103]
  s_mov_b32 m0, s27
  ds_read_b128 a[36:39], v3 offset:1024
  v_exp_f32 v88, v88
  v_cvt_pk_bf16_f32 v43, v86, v87
  v_mfma_f32_16x16x32_bf16 v[108:111], a[24:27], a[152:155], v[108:111]
  buffer_load_dwordx4 v2, s[20:23], s29 offen offset:0 sc1 lds
  v_exp_f32 v89, v89
  v_mfma_f32_16x16x32_bf16 v[116:119], a[24:27], a[168:171], v[116:119]
  buffer_load_dwordx4 v2, s[20:23], s29 offen offset:1024 sc1 lds
  v_exp_f32 v90, v90
  v_cvt_pk_bf16_f32 v44, v88, v89
  v_mfma_f32_16x16x32_bf16 v[124:127], a[24:27], a[184:187], v[124:127]
  buffer_load_dwordx4 v2, s[20:23], s29 offen offset:2048 sc1 lds
  v_exp_f32 v91, v91
  v_mfma_f32_16x16x32_bf16 v[100:103], a[28:31], a[140:143], v[100:103]
  buffer_load_dwordx4 v2, s[20:23], s29 offen offset:3072 sc1 lds
  v_exp_f32 v92, v92
  v_cvt_pk_bf16_f32 v45, v90, v91
  v_mfma_f32_16x16x32_bf16 v[108:111], a[28:31], a[156:159], v[108:111]
  s_xor_b32 s27, s27, 0x4000
  ds_read_b128 a[40:43], v3 offset:2048
  v_exp_f32 v93, v93
  v_mfma_f32_16x16x32_bf16 v[116:119], a[28:31], a[172:175], v[116:119]
  s_add_u32 s29, s29, 0x8000
  ds_read_b128 a[44:47], v3 offset:3072
  v_exp_f32 v94, v94
  v_cvt_pk_bf16_f32 v46, v92, v93
  v_mfma_f32_16x16x32_bf16 v[124:127], a[28:31], a[188:191], v[124:127]
  ds_read_b128 a[48:51], v3 offset:4096
  ds_read_b128 a[52:55], v3 offset:5120
  ds_read_b128 a[56:59], v3 offset:6144
  ds_read_b128 a[60:63], v3 offset:7168
  ds_read_b128 a[0:3], v4 offset:0
  ds_read_b128 a[4:7], v4 offset:1024
  ds_read_b128 a[8:11], v4 offset:2048
  v_exp_f32 v95, v95
  s_nop 0
  v_cvt_pk_bf16_f32 v47, v94, v95
  s_cmp_eq_u32 s25, 0
  s_cbranch_scc1 La_d1
  .p2align 6
La_lo:
  s_waitcnt lgkmcnt(7)
  v_mfma_f32_16x16x32_bf16 v[64:67], a[32:35], a[128:131], v[16:19]
  v_exp_f32 v96, v96
  v_mfma_f32_16x16x32_bf16 v[72:75], a[32:35], a[144:147], v[20:23]
  ds_read_b128 a[12:15], v4 offset:3072
  v_mfma_f32_16x16x32_bf16 v[80:83], a[32:35], a[160:163], v[24:27]
  v_exp_f32 v97, v97
  v_mfma_f32_16x16x32_bf16 v[88:91], a[32:35], a[176:179], v[28:31]
  v_cvt_pk_bf16_f32 v48, v96, v97
  v_mfma_f32_16x16x32_bf16 v[64:67], a[36:39], a[132:135], v[64:67]
  v_exp_f32 v98, v98
  v_mfma_f32_16x16x32_bf16 v[72:75], a[36:39], a[148:151], v[72:75]
  ds_read_b128 a[16:19], v4 offset:4096
  v_mfma_f32_16x16x32_bf16 v[80:83], a[36:39], a[164:167], v[80:83]
  v_exp_f32 v99, v99
  v_mfma_f32_16x16x32_bf16 v[88:91], a[36:39], a[180:183], v[88:91]
  v_cvt_pk_bf16_f32 v49, v98, v99
  v_mfma_f32_16x16x32_bf16 v[64:67], a[40:43], a[136:139], v[64:67]
  v_exp_f32 v100, v100
  v_mfma_f32_16x16x32_bf16 v[72:75], a[40:43], a[152:155], v[72:75]
  ds_read_b128 a[20:23], v4 offset:5120
  v_mfma_f32_16x16x32_bf16 v[80:83], a[40:43], a[168:171], v[80:83]
  v_exp_f32 v101, v101
  v_mfma_f32_16x16x32_bf16 v[88:91], a[40:43], a[184:187], v[88:91]
  v_cvt_pk_bf16_f32 v50, v100, v101
  v_mfma_f32_16x16x32_bf16 v[64:67], a[44:47], a[140:143], v[64:67]
  v_exp_f32 v102, v102
  v_mfma_f32_16x16x32_bf16 v[72:75], a[44:47], a[156:159], v[72:75]
  ds_read_b128 a[24:27], v4 offset:6144
  v_mfma_f32_16x16x32_bf16 v[80:83], a[44:47], a[172:175], v[80:83]
  v_exp_f32 v103, v103
  v_mfma_f32_16x16x32_bf16 v[88:91], a[44:47], a[188:191], v[88:91]
  s_waitcnt lgkmcnt(7)
  v_cvt_pk_bf16_f32 v51, v102, v103
  v_mfma_f32_16x16x32_bf16 v[68:71], a[48:51], a[128:131], v[16:19]
  v_exp_f32 v104, v104
  v_mfma_f32_16x16x32_bf16 v[76:79], a[48:51], a[144:147], v[20:23]
  ds_read_b128 a[28:31], v4 offset:7168
  v_mfma_f32_16x16x32_bf16 v[84:87], a[48:51], a[160:163], v[24:27]
  v_exp_f32 v105, v105
  v_mfma_f32_16x16x32_bf16 v[92:95], a[48:51], a[176:179], v[28:31]
  v_cvt_pk_bf16_f32 v52, v104, v105
  v_mfma_f32_16x16x32_bf16 v[68:71], a[52:55], a[132:135], v[68:71]
  v_exp_f32 v106, v106
  v_mfma_f32_16x16x32_bf16 v[76:79], a[52:55], a[148:151], v[76:79]
  ds_read_b128 a[32:35], v3 offset:8192
  v_mfma_f32_16x16x32_bf16 v[84:87], a[52:55], a[164:167], v[84:87]
  v_exp_f32 v107, v107
  v_mfma_f32_16x16x32_bf16 v[92:95], a[52:55], a[180:183], v[92:95]
  v_cvt_pk_bf16_f32 v53, v106, v107
  v_mfma_f32_16x16x32_bf16 v[68:71], a[56:59], a[136:139], v[68:71]
  v_exp_f32 v108, v108
  v_mfma_f32_16x16x32_bf16 v[76:79], a[56:59], a[152:155], v[76:79]
  ds_read_b128 a[36:39], v3 offset:9216
  v_mfma_f32_16x16x32_bf16 v[84:87], a[56:59], a[168:171], v[84:87]
  v_exp_f32 v109, v109
  v_mfma_f32_16x16x32_bf16 v[92:95], a[56:59], a[184:187], v[92:95]
  v_cvt_pk_bf16_f32 v54, v108, v109
  v_mfma_f32_16x16x32_bf16 v[68:71], a[60:63], a[140:143], v[68:71]
  v_exp_f32 v110, v110
  v_mfma_f32_16x16x32_bf16 v[76:79], a[60:63], a[156:159], v[76:79]
  ds_read_b128 a[40:43], v3 offset:10240
  v_mfma_f32_16x16x32_bf16 v[84:87], a[60:63], a[172:175], v[84:87]
  v_exp_f32 v111, v111
  v_mfma_f32_16x16x32_bf16 v[92:95], a[60:63], a[188:191], v[92:95]
  s_waitcnt lgkmcnt(7)
  v_cvt_pk_bf16_f32 v55, v110, v111
  v_mfma_f32_16x16x32_bf16 v[128:131], a[0:3], v[32:35], v[128:131]
  ds_read_b128 a[44:47], v3 offset:11264
  v_mfma_f32_16x16x32_bf16 v[160:163], a[0:3], v[36:39], v[160:163]
  v_exp_f32 v112, v112
  v_mfma_f32_16x16x32_bf16 v[192:195], a[0:3], v[40:43], v[192:195]
  s_sub_u32 s88, s88, 1
  v_mfma_f32_16x16x32_bf16 v[224:227], a[0:3], v[44:47], v[224:227]
  v_exp_f32 v113, v113
  v_mfma_f32_16x16x32_bf16 a[192:195], a[208:211], v[32:35], a[192:195]
  v_cvt_pk_bf16_f32 v56, v112, v113
  v_mfma_f32_16x16x32_bf16 v[132:135], a[4:7], v[32:35], v[132:135]
  v_exp_f32 v114, v114
  v_mfma_f32_16x16x32_bf16 v[164:167], a[4:7], v[36:39], v[164:167]
  ds_read_b128 a[48:51], v3 offset:12288
  v_mfma_f32_16x16x32_bf16 v[196:199], a[4:7], v[40:43], v[196:199]
  v_exp_f32 v115, v115
  v_mfma_f32_16x16x32_bf16 v[228:231], a[4:7], v[44:47], v[228:231]
  v_cvt_pk_bf16_f32 v57, v114, v115
  v_mfma_f32_16x16x32_bf16 a[196:199], a[208:211], v[36:39], a[196:199]
  v_exp_f32 v116, v116
  v_mfma_f32_16x16x32_bf16 v[136:139], a[8:11], v[32:35], v[136:139]
  ds_read_b128 a[52:55], v3 offset:13312
  v_mfma_f32_16x16x32_bf16 v[168:171], a[8:11], v[36:39], v[168:171]
  v_exp_f32 v117, v117
  v_mfma_f32_16x16x32_bf16 v[200:203], a[8:11], v[40:43], v[200:203]
  v_cvt_pk_bf16_f32 v58, v116, v117
  v_mfma_f32_16x16x32_bf16 v[232:235], a[8:11], v[44:47], v[232:235]
  v_exp_f32 v118, v118
  v_mfma_f32_16x16x32_bf16 a[200:203], a[208:211], v[40:43], a[200:203]
  v_mfma_f32_16x16x32_bf16 v[140:143], a[12:15], v[32:35], v[140:143]
  v_exp_f32 v119, v119
  v_mfma_f32_16x16x32_bf16 v[172:175], a[12:15], v[36:39], v[172:175]
  ds_read_b128 a[56:59], v3 offset:14336
  v_cvt_pk_bf16_f32 v59, v118, v119
  v_mfma_f32_16x16x32_bf16 v[204:207], a[12:15], v[40:43], v[204:207]
  v_exp_f32 v120, v120
  v_mfma_f32_16x16x32_bf16 v[236:239], a[12:15], v[44:47], v[236:239]
  v_mfma_f32_16x16x32_bf16 a[204:207], a[208:211], v[44:47], a[204:207]
  s_waitcnt lgkmcnt(7)
  v_exp_f32 v121, v121
  v_mfma_f32_16x16x32_bf16 v[144:147], a[16:19], v[32:35], v[144:147]
  ds_read_b128 a[60:63], v3 offset:15360
  v_cvt_pk_bf16_f32 v60, v120, v121
  v_mfma_f32_16x16x32_bf16 v[176:179], a[16:19], v[36:39], v[176:179]
  v_exp_f32 v122, v122
  v_mfma_f32_16x16x32_bf16 v[208:211], a[16:19], v[40:43], v[208:211]
  v_mfma_f32_16x16x32_bf16 v[240:243], a[16:19], v[44:47], v[240:243]
  v_exp_f32 v123, v123
  v_mfma_f32_16x16x32_bf16 v[148:151], a[20:23], v[32:35], v[148:151]
  ds_read_b128 a[0:3], v4 offset:8192
  v_cvt_pk_bf16_f32 v61, v122, v123
  v_mfma_f32_16x16x32_bf16 v[180:183], a[20:23], v[36:39], v[180:183]
  v_exp_f32 v124, v124
  v_mfma_f32_16x16x32_bf16 v[212:215], a[20:23], v[40:43], v[212:215]
  v_mfma_f32_16x16x32_bf16 v[244:247], a[20:23], v[44:47], v[244:247]
  v_exp_f32 v125, v125
  v_mfma_f32_16x16x32_bf16 v[152:155], a[24:27], v[32:35], v[152:155]
  ds_read_b128 a[4:7], v4 offset:9216
  v_cvt_pk_bf16_f32 v62, v124, v125
  v_mfma_f32_16x16x32_bf16 v[184:187], a[24:27], v[36:39], v[184:187]
  v_exp_f32 v126, v126
  v_mfma_f32_16x16x32_bf16 v[216:219], a[24:27], v[40:43], v[216:219]
  v_mfma_f32_16x16x32_bf16 v[248:251], a[24:27], v[44:47], v[248:251]
  v_exp_f32 v127, v127
  v_mfma_f32_16x16x32_bf16 v[156:159], a[28:31], v[32:35], v[156:159]
  ds_read_b128 a[8:11], v4 offset:10240
  v_cvt_pk_bf16_f32 v63, v126, v127
  v_mfma_f32_16x16x32_bf16 v[188:191], a[28:31], v[36:39], v[188:191]
  v_mfma_f32_16x16x32_bf16 v[220:223], a[28:31], v[40:43], v[220:223]
  v_mfma_f32_16x16x32_bf16 v[252:255], a[28:31], v[44:47], v[252:255]
  s_cmp_eq_u32 s88, 0
  s_cbranch_scc1 La_d0
  s_waitcnt vmcnt(8)
  s_barrier
  s_waitcnt lgkmcnt(7)
  v_mfma_f32_16x16x32_bf16 v[96:99], a[32:35], a[128:131], v[16:19]
  s_mov_b32 m0, s26
  v_exp_f32 v64, v64
  v_mfma_f32_16x16x32_bf16 v[104:107], a[32:35], a[144:147], v[20:23]
  buffer_load_dwordx4 v2, s[20:23], s28 offen offset:0 sc1 lds
  ds_read_b128 a[12:15], v4 offset:11264
  v_mfma_f32_16x16x32_bf16 v[112:115], a[32:35], a[160:163], v[24:27]
  v_exp_f32 v65, v65
  v_mfma_f32_16x16x32_bf16 v[120:123], a[32:35], a[176:179], v[28:31]
  v_cvt_pk_bf16_f32 v32, v64, v65
  v_mfma_f32_16x16x32_bf16 v[96:99], a[36:39], a[132:135], v[96:99]
  v_exp_f32 v66, v66
  v_mfma_f32_16x16x32_bf16 v[104:107], a[36:39], a[148:151], v[104:107]
  ds_read_b128 a[16:19], v4 offset:12288
  v_mfma_f32_16x16x32_bf16 v[112:115], a[36:39], a[164:167], v[112:115]
  v_exp_f32 v67, v67
  v_mfma_f32_16x16x32_bf16 v[120:123], a[36:39], a[180:183], v[120:123]
  v_cvt_pk_bf16_f32 v33, v66, v67
  v_mfma_f32_16x16x32_bf16 v[96:99], a[40:43], a[136:139], v[96:99]
  v_exp_f32 v68, v68
  v_mfma_f32_16x16x32_bf16 v[104:107], a[40:43], a[152:155], v[104:107]
  buffer_load_dwordx4 v2, s[20:23], s28 offen offset:1024 sc1 lds
  ds_read_b128 a[20:23], v4 offset:13312
  v_mfma_f32_16x16x32_bf16 v[112:115], a[40:43], a[168:171], v[112:115]
  v_exp_f32 v69, v69
  v_mfma_f32_16x16x32_bf16 v[120:123], a[40:43], a[184:187], v[120:123]
  v_cvt_pk_bf16_f32 v34, v68, v69
  v_mfma_f32_16x16x32_bf16 v[96:99], a[44:47], a[140:143], v[96:99]
  v_exp_f32 v70, v70
  v_mfma_f32_16x16x32_bf16 v[104:107], a[44:47], a[156:159], v[104:107]
  ds_read_b128 a[24:27], v4 offset:14336
  v_mfma_f32_16x16x32_bf16 v[112:115], a[44:47], a[172:175], v[112:115]
  v_exp_f32 v71, v71
  v_mfma_f32_16x16x32_bf16 v[120:123], a[44:47], a[188:191], v[120:123]
  s_waitcnt lgkmcnt(7)
  v_cvt_pk_bf16_f32 v35, v70, v71
  v_mfma_f32_16x16x32_bf16 v[100:103], a[48:51], a[128:131], v[16:19]
  v_exp_f32 v72, v72
  v_mfma_f32_16x16x32_bf16 v[108:111], a[48:51], a[144:147], v[20:23]
  buffer_load_dwordx4 v2, s[20:23], s28 offen offset:2048 sc1 lds
  ds_read_b128 a[28:31], v4 offset:15360
  v_mfma_f32_16x16x32_bf16 v[116:119], a[48:51], a[160:163], v[24:27]
  v_exp_f32 v73, v73
  v_mfma_f32_16x16x32_bf16 v[124:127], a[48:51], a[176:179], v[28:31]
  v_xor_b32 v3, s30, v3
  v_cvt_pk_bf16_f32 v36, v72, v73
  v_mfma_f32_16x16x32_bf16 v[100:103], a[52:55], a[132:135], v[100:103]
  v_exp_f32 v74, v74
  v_mfma_f32_16x16x32_bf16 v[108:111], a[52:55], a[148:151], v[108:111]
  ds_read_b128 a[32:35], v3 offset:0
  v_mfma_f32_16x16x32_bf16 v[116:119], a[52:55], a[164:167], v[116:119]
  v_exp_f32 v75, v75
  v_mfma_f32_16x16x32_bf16 v[124:127], a[52:55], a[180:183], v[124:127]
  v_cvt_pk_bf16_f32 v37, v74, v75
  v_mfma_f32_16x16x32_bf16 v[100:103], a[56:59], a[136:139], v[100:103]
  v_exp_f32 v76, v76
  v_mfma_f32_16x16x32_bf16 v[108:111], a[56:59], a[152:155], v[108:111]
  buffer_load_dwordx4 v2, s[20:23], s28 offen offset:3072 sc1 lds
  ds_read_b128 a[36:39], v3 offset:1024
  v_mfma_f32_16x16x32_bf16 v[116:119], a[56:59], a[168:171], v[116:119]
  s_xor_b32 s26, s26, s31
  v_exp_f32 v77, v77
  v_mfma_f32_16x16x32_bf16 v[124:127], a[56:59], a[184:187], v[124:127]
  s_add_u32 s28, s28, 0x8000
  s_mov_b32 m0, s27
  v_cvt_pk_bf16_f32 v38, v76, v77
  v_mfma_f32_16x16x32_bf16 v[100:103], a[60:63], a[140:143], v[100:103]
  v_exp_f32 v78, v78
  v_mfma_f32_16x16x32_bf16 v[108:111], a[60:63], a[156:159], v[108:111]
  ds_read_b128 a[40:43], v3 offset:2048
  v_mfma_f32_16x16x32_bf16 v[116:119], a[60:63], a[172:175], v[116:119]
  v_exp_f32 v79, v79
  v_mfma_f32_16x16x32_bf16 v[124:127], a[60:63], a[188:191], v[124:127]
  s_waitcnt lgkmcnt(7)
  v_cvt_pk_bf16_f32 v39, v78, v79
  v_mfma_f32_16x16x32_bf16 v[128:131], a[0:3], v[48:51], v[128:131]
  ds_read_b128 a[44:47], v3 offset:3072
  v_mfma_f32_16x16x32_bf16 v[160:163], a[0:3], v[52:55], v[160:163]
  v_exp_f32 v80, v80
  v_mfma_f32_16x16x32_bf16 v[192:195], a[0:3], v[56:59], v[192:195]
  buffer_load_dwordx4 v2, s[20:23], s29 offen offset:0 sc1 lds
  v_mfma_f32_16x16x32_bf16 v[224:227], a[0:3], v[60:63], v[224:227]
  v_exp_f32 v81, v81
  v_mfma_f32_16x16x32_bf16 a[192:195], a[208:211], v[48:51], a[192:195]
  v_cvt_pk_bf16_f32 v40, v80, v81
  v_mfma_f32_16x16x32_bf16 v[132:135], a[4:7], v[48:51], v[132:135]
  v_exp_f32 v82, v82
  v_mfma_f32_16x16x32_bf16 v[164:167], a[4:7], v[52:55], v[164:167]
  ds_read_b128 a[48:51], v3 offset:4096
  v_mfma_f32_16x16x32_bf16 v[196:199], a[4:7], v[56:59], v[196:199]
  v_exp_f32 v83, v83
  v_mfma_f32_16x16x32_bf16 v[228:231], a[4:7], v[60:63], v[228:231]
  v_cvt_pk_bf16_f32 v41, v82, v83
  v_mfma_f32_16x16x32_bf16 a[196:199], a[208:211], v[52:55], a[196:199]
  v_exp_f32 v84, v84
  v_mfma_f32_16x16x32_bf16 v[136:139], a[8:11], v[48:51], v[136:139]
  buffer_load_dwordx4 v2, s[20:23], s29 offen offset:1024 sc1 lds
  ds_read_b128 a[52:55], v3 offset:5120
  v_mfma_f32_16x16x32_bf16 v[168:171], a[8:11], v[52:55], v[168:171]
  v_exp_f32 v85, v85
  v_mfma_f32_16x16x32_bf16 v[200:203], a[8:11], v[56:59], v[200:203]
  v_cvt_pk_bf16_f32 v42, v84, v85
  v_mfma_f32_16x16x32_bf16 v[232:235], a[8:11], v[60:63], v[232:235]
  v_exp_f32 v86, v86
  v_mfma_f32_16x16x32_bf16 a[200:203], a[208:211], v[56:59], a[200:203]
  v_mfma_f32_16x16x32_bf16 v[140:143], a[12:15], v[48:51], v[140:143]
  v_exp_f32 v87, v87
  v_mfma_f32_16x16x32_bf16 v[172:175], a[12:15], v[52:55], v[172:175]
  ds_read_b128 a[56:59], v3 offset:6144
  v_cvt_pk_bf16_f32 v43, v86, v87
  v_mfma_f32_16x16x32_bf16 v[204:207], a[12:15], v[56:59], v[204:207]
  v_exp_f32 v88, v88
  v_mfma_f32_16x16x32_bf16 v[236:239], a[12:15], v[60:63], v[236:239]
  buffer_load_dwordx4 v2, s[20:23], s29 offen offset:2048 sc1 lds
  v_mfma_f32_16x16x32_bf16 a[204:207], a[208:211], v[60:63], a[204:207]
  s_waitcnt lgkmcnt(7)
  v_exp_f32 v89, v89
  v_mfma_f32_16x16x32_bf16 v[144:147], a[16:19], v[48:51], v[144:147]
  ds_read_b128 a[60:63], v3 offset:7168
  v_cvt_pk_bf16_f32 v44, v88, v89
  v_mfma_f32_16x16x32_bf16 v[176:179], a[16:19], v[52:55], v[176:179]
  v_exp_f32 v90, v90
  v_mfma_f32_16x16x32_bf16 v[208:211], a[16:19], v[56:59], v[208:211]
  v_mfma_f32_16x16x32_bf16 v[240:243], a[16:19], v[60:63], v[240:243]
  v_exp_f32 v91, v91
  v_mfma_f32_16x16x32_bf16 v[148:151], a[20:23], v[48:51], v[148:151]
  v_xor_b32 v4, s31, v4
  v_cvt_pk_bf16_f32 v45, v90, v91
  v_mfma_f32_16x16x32_bf16 v[180:183], a[20:23], v[52:55], v[180:183]
  v_exp_f32 v92, v92
  v_mfma_f32_16x16x32_bf16 v[212:215], a[20:23], v[56:59], v[212:215]
  buffer_load_dwordx4 v2, s[20:23], s29 offen offset:3072 sc1 lds
  ds_read_b128 a[0:3], v4 offset:0
  v_mfma_f32_16x16x32_bf16 v[244:247], a[20:23], v[60:63], v[244:247]
  s_xor_b32 s27, s27, s30
  v_exp_f32 v93, v93
  v_mfma_f32_16x16x32_bf16 v[152:155], a[24:27], v[48:51], v[152:155]
  s_add_u32 s29, s29, 0x8000
  ds_read_b128 a[4:7], v4 offset:1024
  v_cvt_pk_bf16_f32 v46, v92, v93
  v_mfma_f32_16x16x32_bf16 v[184:187], a[24:27], v[52:55], v[184:187]
  v_exp_f32 v94, v94
  v_mfma_f32_16x16x32_bf16 v[216:219], a[24:27], v[56:59], v[216:219]
  v_mfma_f32_16x16x32_bf16 v[248:251], a[24:27], v[60:63], v[248:251]
  v_exp_f32 v95, v95
  v_mfma_f32_16x16x32_bf16 v[156:159], a[28:31], v[48:51], v[156:159]
  ds_read_b128 a[8:11], v4 offset:2048
  v_cvt_pk_bf16_f32 v47, v94, v95
  v_mfma_f32_16x16x32_bf16 v[188:191], a[28:31], v[52:55], v[188:191]
  v_mfma_f32_16x16x32_bf16 v[220:223], a[28:31], v[56:59], v[220:223]
  v_mfma_f32_16x16x32_bf16 v[252:255], a[28:31], v[60:63], v[252:255]
  s_xor_b32 s30, s30, 0xc000
  s_xor_b32 s31, s31, 0xc000
  s_branch La_lo
La_d0:
  s_waitcnt vmcnt(8)
  s_barrier
  s_waitcnt lgkmcnt(7)
  v_mfma_f32_16x16x32_bf16 v[96:99], a[32:35], a[128:131], v[16:19]
  s_mov_b32 m0, s26
  ds_read_b128 a[12:15], v4 offset:11264
  v_cndmask_b32 v64, v64, v5, s[32:33]
  v_mfma_f32_16x16x32_bf16 v[104:107], a[32:35], a[144:147], v[20:23]
  v_exp_f32 v64, v64
  v_mfma_f32_16x16x32_bf16 v[112:115], a[32:35], a[160:163], v[24:27]
  v_cndmask_b32 v65, v65, v5, s[34:35]
  v_exp_f32 v65, v65
  v_mfma_f32_16x16x32_bf16 v[120:123], a[32:35], a[176:179], v[28:31]
  buffer_load_dwordx4 v2, s[20:23], s28 offen offset:0 sc1 lds
  v_cndmask_b32 v66, v66, v5, s[36:37]
  v_mfma_f32_16x16x32_bf16 v[96:99], a[36:39], a[132:135], v[96:99]
  v_exp_f32 v66, v66
  v_mfma_f32_16x16x32_bf16 v[104:107], a[36:39], a[148:151], v[104:107]
  ds_read_b128 a[16:19], v4 offset:12288
  v_cndmask_b32 v67, v67, v5, s[38:39]
  v_mfma_f32_16x16x32_bf16 v[112:115], a[36:39], a[164:167], v[112:115]
  v_exp_f32 v67, v67
  v_mfma_f32_16x16x32_bf16 v[120:123], a[36:39], a[180:183], v[120:123]
  v_cndmask_b32 v68, v68, v5, s[40:41]
  v_cndmask_b32 v69, v69, v5, s[42:43]
  v_mfma_f32_16x16x32_bf16 v[96:99], a[40:43], a[136:139], v[96:99]
  v_exp_f32 v68, v68
  v_mfma_f32_16x16x32_bf16 v[104:107], a[40:43], a[152:155], v[104:107]
  buffer_load_dwordx4 v2, s[20:23], s28 offen offset:1024 sc1 lds
  ds_read_b128 a[20:23], v4 offset:13312
  v_mfma_f32_16x16x32_bf16 v[112:115], a[40:43], a[168:171], v[112:115]
  v_exp_f32 v69, v69
  v_mfma_f32_16x16x32_bf16 v[120:123], a[40:43], a[184:187], v[120:123]
  v_cndmask_b32 v70, v70, v5, s[44:45]
  v_cvt_pk_bf16_f32 v32, v64, v65
  v_mfma_f32_16x16x32_bf16 v[96:99], a[44:47], a[140:143], v[96:99]
  v_exp_f32 v70, v70
  v_mfma_f32_16x16x32_bf16 v[104:107], a[44:47], a[156:159], v[104:107]
  ds_read_b128 a[24:27], v4 offset:14336
  v_cndmask_b32 v71, v71, v5, s[46:47]
  v_mfma_f32_16x16x32_bf16 v[112:115], a[44:47], a[172:175], v[112:115]
  v_exp_f32 v71, v71
  v_mfma_f32_16x16x32_bf16 v[120:123], a[44:47], a[188:191], v[120:123]
  s_waitcnt lgkmcnt(7)
  v_cvt_pk_bf16_f32 v33, v66, v67
  v_cvt_pk_bf16_f32 v34, v68, v69
  v_mfma_f32_16x16x32_bf16 v[100:103], a[48:51], a[128:131], v[16:19]
  v_exp_f32 v72, v72
  v_mfma_f32_16x16x32_bf16 v[108:111], a[48:51], a[144:147], v[20:23]
  buffer_load_dwordx4 v2, s[20:23], s28 offen offset:2048 sc1 lds
  ds_read_b128 a[28:31], v4 offset:15360
  v_mfma_f32_16x16x32_bf16 v[116:119], a[48:51], a[160:163], v[24:27]
  v_exp_f32 v73, v73
  v_mfma_f32_16x16x32_bf16 v[124:127], a[48:51], a[176:179], v[28:31]
  v_xor_b32 v3, 0x4000, v3
  v_cvt_pk_bf16_f32 v35, v70, v71
  v_mfma_f32_16x16x32_bf16 v[100:103], a[52:55], a[132:135], v[100:103]
  v_exp_f32 v74, v74
  v_mfma_f32_16x16x32_bf16 v[108:111], a[52:55], a[148:151], v[108:111]
  ds_read_b128 a[32:35], v3 offset:0
  v_cvt_pk_bf16_f32 v36, v72, v73
  v_mfma_f32_16x16x32_bf16 v[116:119], a[52:55], a[164:167], v[116:119]
  v_exp_f32 v75, v75
  v_mfma_f32_16x16x32_bf16 v[124:127], a[52:55], a[180:183], v[124:127]
  v_cvt_pk_bf16_f32 v37, v74, v75
  v_mfma_f32_16x16x32_bf16 v[100:103], a[56:59], a[136:139], v[100:103]
  v_exp_f32 v76, v76
  v_mfma_f32_16x16x32_bf16 v[108:111], a[56:59], a[152:155], v[108:111]
  buffer_load_dwordx4 v2, s[20:23], s28 offen offset:3072 sc1 lds
  ds_read_b128 a[36:39], v3 offset:1024
  v_mfma_f32_16x16x32_bf16 v[116:119], a[56:59], a[168:171], v[116:119]
  s_xor_b32 s26, s26, 0x8000
  v_exp_f32 v77, v77
  v_mfma_f32_16x16x32_bf16 v[124:127], a[56:59], a[184:187], v[124:127]
  s_add_u32 s28, s28, 0x8000
  s_mov_b32 m0, s27
  v_cvt_pk_bf16_f32 v38, v76, v77
  v_mfma_f32_16x16x32_bf16 v[100:103], a[60:63], a[140:143], v[100:103]
  v_exp_f32 v78, v78
  v_mfma_f32_16x16x32_bf16 v[108:111], a[60:63], a[156:159], v[108:111]
  ds_read_b128 a[40:43], v3 offset:2048
  v_mfma_f32_16x16x32_bf16 v[116:119], a[60:63], a[172:175], v[116:119]
  v_exp_f32 v79, v79
  v_mfma_f32_16x16x32_bf16 v[124:127], a[60:63], a[188:191], v[124:127]
  s_waitcnt lgkmcnt(7)
  v_cvt_pk_bf16_f32 v39, v78, v79
  v_mfma_f32_16x16x32_bf16 v[128:131], a[0:3], v[48:51], v[128:131]
  ds_read_b128 a[44:47], v3 offset:3072
  v_mfma_f32_16x16x32_bf16 v[160:163], a[0:3], v[52:55], v[160:163]
  v_exp_f32 v80, v80
  v_mfma_f32_16x16x32_bf16 v[192:195], a[0:3], v[56:59], v[192:195]
  buffer_load_dwordx4 v2, s[20:23], s29 offen offset:0 sc1 lds
  v_mfma_f32_16x16x32_bf16 v[224:227], a[0:3], v[60:63], v[224:227]
  v_exp_f32 v81, v81
  v_mfma_f32_16x16x32_bf16 a[192:195], a[208:211], v[48:51], a[192:195]
  v_cvt_pk_bf16_f32 v40, v80, v81
  v_mfma_f32_16x16x32_bf16 v[132:135], a[4:7], v[48:51], v[132:135]
  v_exp_f32 v82, v82
  v_mfma_f32_16x16x32_bf16 v[164:167], a[4:7], v[52:55], v[164:167]
  ds_read_b128 a[48:51], v3 offset:4096
  v_mfma_f32_16x16x32_bf16 v[196:199], a[4:7], v[56:59], v[196:199]
  v_exp_f32 v83, v83
  v_mfma_f32_16x16x32_bf16 v[228:231], a[4:7], v[60:63], v[228:231]
  v_cvt_pk_bf16_f32 v41, v82, v83
  v_mfma_f32_16x16x32_bf16 a[196:199], a[208:211], v[52:55], a[196:199]
  v_exp_f32 v84, v84
  v_mfma_f32_16x16x32_bf16 v[136:139], a[8:11], v[48:51], v[136:139]
  buffer_load_dwordx4 v2, s[20:23], s29 offen offset:1024 sc1 lds
  ds_read_b128 a[52:55], v3 offset:5120
  v_mfma_f32_16x16x32_bf16 v[168:171], a[8:11], v[52:55], v[168:171]
  v_exp_f32 v85, v85
  v_mfma_f32_16x16x32_bf16 v[200:203], a[8:11], v[56:59], v[200:203]
  v_cvt_pk_bf16_f32 v42, v84, v85
  v_mfma_f32_16x16x32_bf16 v[232:235], a[8:11], v[60:63], v[232:235]
  v_exp_f32 v86, v86
  v_mfma_f32_16x16x32_bf16 a[200:203], a[208:211], v[56:59], a[200:203]
  v_mfma_f32_16x16x32_bf16 v[140:143], a[12:15], v[48:51], v[140:143]
  v_exp_f32 v87, v87
  v_mfma_f32_16x16x32_bf16 v[172:175], a[12:15], v[52:55], v[172:175]
  ds_read_b128 a[56:59], v3 offset:6144
  v_cvt_pk_bf16_f32 v43, v86, v87
  v_mfma_f32_16x16x32_bf16 v[204:207], a[12:15], v[56:59], v[204:207]
  v_exp_f32 v88, v88
  v_mfma_f32_16x16x32_bf16 v[236:239], a[12:15], v[60:63], v[236:239]
  buffer_load_dwordx4 v2, s[20:23], s29 offen offset:2048 sc1 lds
  v_mfma_f32_16x16x32_bf16 a[204:207], a[208:211], v[60:63], a[204:207]
  s_waitcnt lgkmcnt(7)
  v_exp_f32 v89, v89
  v_mfma_f32_16x16x32_bf16 v[144:147], a[16:19], v[48:51], v[144:147]
  ds_read_b128 a[60:63], v3 offset:7168
  v_cvt_pk_bf16_f32 v44, v88, v89
  v_mfma_f32_16x16x32_bf16 v[176:179], a[16:19], v[52:55], v[176:179]
  v_exp_f32 v90, v90
  v_mfma_f32_16x16x32_bf16 v[208:211], a[16:19], v[56:59], v[208:211]
  v_mfma_f32_16x16x32_bf16 v[240:243], a[16:19], v[60:63], v[240:243]
  v_exp_f32 v91, v91
  v_mfma_f32_16x16x32_bf16 v[148:151], a[20:23], v[48:51], v[148:151]
  v_xor_b32 v4, 0x8000, v4
  v_cvt_pk_bf16_f32 v45, v90, v91
  v_mfma_f32_16x16x32_bf16 v[180:183], a[20:23], v[52:55], v[180:183]
  v_exp_f32 v92, v92
  v_mfma_f32_16x16x32_bf16 v[212:215], a[20:23], v[56:59], v[212:215]
  buffer_load_dwordx4 v2, s[20:23], s29 offen offset:3072 sc1 lds
  ds_read_b128 a[0:3], v4 offset:0
  v_mfma_f32_16x16x32_bf16 v[244:247], a[20:23], v[60:63], v[244:247]
  s_xor_b32 s27, s27, 0x4000
  v_exp_f32 v93, v93
  v_mfma_f32_16x16x32_bf16 v[152:155], a[24:27], v[48:51], v[152:155]
  s_add_u32 s29, s29, 0x8000
  ds_read_b128 a[4:7], v4 offset:1024
  v_cvt_pk_bf16_f32 v46, v92, v93
  v_mfma_f32_16x16x32_bf16 v[184:187], a[24:27], v[52:55], v[184:187]
  v_exp_f32 v94, v94
  v_mfma_f32_16x16x32_bf16 v[216:219], a[24:27], v[56:59], v[216:219]
  v_mfma_f32_16x16x32_bf16 v[248:251], a[24:27], v[60:63], v[248:251]
  v_exp_f32 v95, v95
  v_mfma_f32_16x16x32_bf16 v[156:159], a[28:31], v[48:51], v[156:159]
  ds_read_b128 a[8:11], v4 offset:2048
  v_cvt_pk_bf16_f32 v47, v94, v95
  v_mfma_f32_16x16x32_bf16 v[188:191], a[28:31], v[52:55], v[188:191]
  v_mfma_f32_16x16x32_bf16 v[220:223], a[28:31], v[56:59], v[220:223]
  v_mfma_f32_16x16x32_bf16 v[252:255], a[28:31], v[60:63], v[252:255]
La_d1:
  s_waitcnt lgkmcnt(7)
  v_mfma_f32_16x16x32_bf16 v[72:75], a[32:35], a[144:147], v[20:23]
  buffer_load_dwordx4 a[64:67], v2, s[8:11], s6 offen offset:0
  ds_read_b128 a[12:15], v4 offset:3072
  v_mfma_f32_16x16x32_bf16 v[80:83], a[32:35], a[160:163], v[24:27]
  v_cndmask_b32 v96, v96, v5, s[48:49]
  v_exp_f32 v96, v96
  v_mfma_f32_16x16x32_bf16 v[88:91], a[32:35], a[176:179], v[28:31]
  v_cndmask_b32 v97, v97, v5, s[50:51]
  v_exp_f32 v97, v97
  v_mfma_f32_16x16x32_bf16 v[72:75], a[36:39], a[148:151], v[72:75]
  v_cndmask_b32 v98, v98, v5, s[52:53]
  v_exp_f32 v98, v98
  v_mfma_f32_16x16x32_bf16 v[80:83], a[36:39], a[164:167], v[80:83]
  ds_read_b128 a[16:19], v4 offset:4096
  v_cndmask_b32 v99, v99, v5, s[54:55]
  v_mfma_f32_16x16x32_bf16 v[88:91], a[36:39], a[180:183], v[88:91]
  v_exp_f32 v99, v99
  v_mfma_f32_16x16x32_bf16 v[72:75], a[40:43], a[152:155], v[72:75]
  buffer_load_dwordx4 a[64:67], v2, s[8:11], s6 offen offset:1024
  ds_read_b128 a[20:23], v4 offset:5120
  v_mfma_f32_16x16x32_bf16 v[80:83], a[40:43], a[168:171], v[80:83]
  v_cndmask_b32 v100, v100, v5, s[56:57]
  v_exp_f32 v100, v100
  v_mfma_f32_16x16x32_bf16 v[88:91], a[40:43], a[184:187], v[88:91]
  v_cndmask_b32 v101, v101, v5, s[58:59]
  v_cndmask_b32 v102, v102, v5, s[60:61]
  v_mfma_f32_16x16x32_bf16 v[72:75], a[44:47], a[156:159], v[72:75]
  v_exp_f32 v101, v101
  v_mfma_f32_16x16x32_bf16 v[80:83], a[44:47], a[172:175], v[80:83]
  v_exp_f32 v102, v102
  v_mfma_f32_16x16x32_bf16 v[88:91], a[44:47], a[188:191], v[88:91]
  s_waitcnt lgkmcnt(6)
  buffer_load_dwordx4 a[64:67], v2, s[8:11], s6 offen offset:2048
  ds_read_b128 a[24:27], v4 offset:6144
  v_mfma_f32_16x16x32_bf16 v[76:79], a[48:51], a[144:147], v[20:23]
  v_cndmask_b32 v103, v103, v5, s[62:63]
  v_exp_f32 v103, v103
  v_mfma_f32_16x16x32_bf16 v[84:87], a[48:51], a[160:163], v[24:27]
  ds_read_b128 a[28:31], v4 offset:7168
  v_cvt_pk_bf16_f32 v48, v96, v97
  v_mfma_f32_16x16x32_bf16 v[92:95], a[48:51], a[176:179], v[28:31]
  v_exp_f32 v104, v104
  v_mfma_f32_16x16x32_bf16 v[76:79], a[52:55], a[148:151], v[76:79]
  ds_read_b128 a[32:35], v3 offset:8192
  v_cvt_pk_bf16_f32 v49, v98, v99
  v_mfma_f32_16x16x32_bf16 v[84:87], a[52:55], a[164:167], v[84:87]
  v_exp_f32 v105, v105
  v_mfma_f32_16x16x32_bf16 v[92:95], a[52:55], a[180:183], v[92:95]
  buffer_load_dwordx4 a[64:67], v2, s[8:11], s6 offen offset:3072
  v_cvt_pk_bf16_f32 v50, v100, v101
  v_mfma_f32_16x16x32_bf16 v[76:79], a[56:59], a[152:155], v[76:79]
  s_add_u32 s6, s6, 4096
  v_exp_f32 v106, v106
  v_mfma_f32_16x16x32_bf16 v[84:87], a[56:59], a[168:171], v[84:87]
  v_exp_f32 v107, v107
  v_mfma_f32_16x16x32_bf16 v[92:95], a[56:59], a[184:187], v[92:95]
  ds_read_b128 a[36:39], v3 offset:9216
  v_cvt_pk_bf16_f32 v51, v102, v103
  v_mfma_f32_16x16x32_bf16 v[76:79], a[60:63], a[156:159], v[76:79]
  v_exp_f32 v108, v108
  v_mfma_f32_16x16x32_bf16 v[84:87], a[60:63], a[172:175], v[84:87]
  ds_read_b128 a[40:43], v3 offset:10240
  v_cvt_pk_bf16_f32 v52, v104, v105
  v_mfma_f32_16x16x32_bf16 v[92:95], a[60:63], a[188:191], v[92:95]
  s_waitcnt lgkmcnt(7)
  v_exp_f32 v109, v109
  v_mfma_f32_16x16x32_bf16 v[128:131], a[0:3], v[32:35], v[128:131]
  buffer_load_dwordx4 a[64:67], v2, s[8:11], s6 offen offset:0
  ds_read_b128 a[44:47], v3 offset:11264
  v_mfma_f32_16x16x32_bf16 v[160:163], a[0:3], v[36:39], v[160:163]
  v_exp_f32 v110, v110
  v_mfma_f32_16x16x32_bf16 v[192:195], a[0:3], v[40:43], v[192:195]
  v_cvt_pk_bf16_f32 v53, v106, v107
  v_cvt_pk_bf16_f32 v54, v108, v109
  v_mfma_f32_16x16x32_bf16 v[224:227], a[0:3], v[44:47], v[224:227]
  v_exp_f32 v111, v111
  v_mfma_f32_16x16x32_bf16 a[192:195], a[208:211], v[32:35], a[192:195]
  v_cvt_pk_bf16_f32 v55, v110, v111
  v_mfma_f32_16x16x32_bf16 v[132:135], a[4:7], v[32:35], v[132:135]
  v_exp_f32 v112, v112
  v_mfma_f32_16x16x32_bf16 v[164:167], a[4:7], v[36:39], v[164:167]
  v_exp_f32 v113, v113
  v_mfma_f32_16x16x32_bf16 v[196:199], a[4:7], v[40:43], v[196:199]
  buffer_load_dwordx4 a[64:67], v2, s[8:11], s6 offen offset:1024
  ds_read_b128 a[48:51], v3 offset:12288
  v_mfma_f32_16x16x32_bf16 v[228:231], a[4:7], v[44:47], v[228:231]
  v_exp_f32 v114, v114
  v_mfma_f32_16x16x32_bf16 a[196:199], a[208:211], v[36:39], a[196:199]
  v_cvt_pk_bf16_f32 v56, v112, v113
  v_mfma_f32_16x16x32_bf16 v[136:139], a[8:11], v[32:35], v[136:139]
  v_exp_f32 v115, v115
  v_mfma_f32_16x16x32_bf16 v[168:171], a[8:11], v[36:39], v[168:171]
  buffer_load_dwordx4 a[64:67], v2, s[8:11], s6 offen offset:2048
  ds_read_b128 a[52:55], v3 offset:13312
  v_mfma_f32_16x16x32_bf16 v[200:203], a[8:11], v[40:43], v[200:203]
  v_exp_f32 v116, v116
  v_mfma_f32_16x16x32_bf16 v[232:235], a[8:11], v[44:47], v[232:235]
  v_cvt_pk_bf16_f32 v57, v114, v115
  v_mfma_f32_16x16x32_bf16 a[200:203], a[208:211], v[40:43], a[200:203]
  v_exp_f32 v117, v117
  v_mfma_f32_16x16x32_bf16 v[140:143], a[12:15], v[32:35], v[140:143]
  v_exp_f32 v118, v118
  v_mfma_f32_16x16x32_bf16 v[172:175], a[12:15], v[36:39], v[172:175]
  buffer_load_dwordx4 a[64:67], v2, s[8:11], s6 offen offset:3072
  ds_read_b128 a[56:59], v3 offset:14336
  v_mfma_f32_16x16x32_bf16 v[204:207], a[12:15], v[40:43], v[204:207]
  v_exp_f32 v119, v119
  v_mfma_f32_16x16x32_bf16 v[236:239], a[12:15], v[44:47], v[236:239]
  v_cvt_pk_bf16_f32 v58, v116, v117
  v_cvt_pk_bf16_f32 v59, v118, v119
  v_mfma_f32_16x16x32_bf16 a[204:207], a[208:211], v[44:47], a[204:207]
  s_waitcnt lgkmcnt(7)
  v_exp_f32 v120, v120
  v_mfma_f32_16x16x32_bf16 v[144:147], a[16:19], v[32:35], v[144:147]
  ds_read_b128 a[60:63], v3 offset:15360
  v_mfma_f32_16x16x32_bf16 v[176:179], a[16:19], v[36:39], v[176:179]
  v_exp_f32 v121, v121
  v_mfma_f32_16x16x32_bf16 v[208:211], a[16:19], v[40:43], v[208:211]
  buffer_load_dwordx4 a[64:67], v2, s[12:15], s7 offen offset:0
  v_cvt_pk_bf16_f32 v60, v120, v121
  v_mfma_f32_16x16x32_bf16 v[240:243], a[16:19], v[44:47], v[240:243]
  v_exp_f32 v122, v122
  v_mfma_f32_16x16x32_bf16 v[148:151], a[20:23], v[32:35], v[148:151]
  v_exp_f32 v123, v123
  v_mfma_f32_16x16x32_bf16 v[180:183], a[20:23], v[36:39], v[180:183]
  ds_read_b128 a[0:3], v4 offset:8192
  v_cvt_pk_bf16_f32 v61, v122, v123
  v_mfma_f32_16x16x32_bf16 v[212:215], a[20:23], v[40:43], v[212:215]
  v_exp_f32 v124, v124
  v_mfma_f32_16x16x32_bf16 v[244:247], a[20:23], v[44:47], v[244:247]
  v_mfma_f32_16x16x32_bf16 v[152:155], a[24:27], v[32:35], v[152:155]
  v_exp_f32 v125, v125
  v_mfma_f32_16x16x32_bf16 v[184:187], a[24:27], v[36:39], v[184:187]
  buffer_load_dwordx4 a[64:67], v2, s[12:15], s7 offen offset:1024
  ds_read_b128 a[4:7], v4 offset:9216
  v_mfma_f32_16x16x32_bf16 v[216:219], a[24:27], v[40:43], v[216:219]
  v_exp_f32 v126, v126
  v_mfma_f32_16x16x32_bf16 v[248:251], a[24:27], v[44:47], v[248:251]
  v_cvt_pk_bf16_f32 v62, v124, v125
  v_mfma_f32_16x16x32_bf16 v[156:159], a[28:31], v[32:35], v[156:159]
  v_exp_f32 v127, v127
  v_mfma_f32_16x16x32_bf16 v[188:191], a[28:31], v[36:39], v[188:191]
  ds_read_b128 a[8:11], v4 offset:10240
  v_cvt_pk_bf16_f32 v63, v126, v127
  v_mfma_f32_16x16x32_bf16 v[220:223], a[28:31], v[40:43], v[220:223]
  v_mfma_f32_16x16x32_bf16 v[252:255], a[28:31], v[44:47], v[252:255]
  s_waitcnt vmcnt(22)
  s_barrier
  s_waitcnt lgkmcnt(7)
  v_mfma_f32_16x16x32_bf16 v[104:107], a[32:35], a[144:147], v[20:23]
  s_mov_b32 m0, s26
  ds_read_b128 a[12:15], v4 offset:11264
  v_cndmask_b32 v72, v72, v5, s[32:33]
  v_mfma_f32_16x16x32_bf16 v[112:115], a[32:35], a[160:163], v[24:27]
  v_exp_f32 v72, v72
  v_mfma_f32_16x16x32_bf16 v[120:123], a[32:35], a[176:179], v[28:31]
  v_cndmask_b32 v73, v73, v5, s[34:35]
  v_exp_f32 v73, v73
  v_mfma_f32_16x16x32_bf16 v[104:107], a[36:39], a[148:151], v[104:107]
  buffer_load_dwordx4 v2, s[20:23], s28 offen offset:0 sc1 lds
  ds_read_b128 a[16:19], v4 offset:12288
  v_mfma_f32_16x16x32_bf16 v[112:115], a[36:39], a[164:167], v[112:115]
  v_cndmask_b32 v74, v74, v5, s[36:37]
  v_exp_f32 v74, v74
  v_mfma_f32_16x16x32_bf16 v[120:123], a[36:39], a[180:183], v[120:123]
  v_cvt_pk_bf16_f32 v36, v72, v73
  v_mfma_f32_16x16x32_bf16 v[104:107], a[40:43], a[152:155], v[104:107]
  ds_read_b128 a[20:23], v4 offset:13312
  v_cndmask_b32 v75, v75, v5, s[38:39]
  v_mfma_f32_16x16x32_bf16 v[112:115], a[40:43], a[168:171], v[112:115]
  v_exp_f32 v75, v75
  v_mfma_f32_16x16x32_bf16 v[120:123], a[40:43], a[184:187], v[120:123]
  buffer_load_dwordx4 v2, s[20:23], s28 offen offset:1024 sc1 lds
  v_cndmask_b32 v76, v76, v5, s[40:41]
  v_mfma_f32_16x16x32_bf16 v[104:107], a[44:47], a[156:159], v[104:107]
  v_exp_f32 v76, v76
  v_mfma_f32_16x16x32_bf16 v[112:115], a[44:47], a[172:175], v[112:115]
  ds_read_b128 a[24:27], v4 offset:14336
  v_cndmask_b32 v79, v79, v5, s[46:47]
  v_mfma_f32_16x16x32_bf16 v[120:123], a[44:47], a[188:191], v[120:123]
  s_waitcnt lgkmcnt(7)
  v_cndmask_b32 v77, v77, v5, s[42:43]
  v_cndmask_b32 v78, v78, v5, s[44:45]
  v_mfma_f32_16x16x32_bf16 v[108:111], a[48:51], a[144:147], v[20:23]
  v_exp_f32 v77, v77
  v_mfma_f32_16x16x32_bf16 v[116:119], a[48:51], a[160:163], v[24:27]
  ds_read_b128 a[28:31], v4 offset:15360
  v_xor_b32 v4, 0x4000, v4
  v_mfma_f32_16x16x32_bf16 v[124:127], a[48:51], a[176:179], v[28:31]
  v_exp_f32 v78, v78
  v_mfma_f32_16x16x32_bf16 v[108:111], a[52:55], a[148:151], v[108:111]
  buffer_load_dwordx4 v2, s[20:23], s28 offen offset:2048 sc1 lds
  v_xor_b32 v3, 0x8000, v3
  v_mfma_f32_16x16x32_bf16 v[116:119], a[52:55], a[164:167], v[116:119]
  v_exp_f32 v79, v79
  v_mfma_f32_16x16x32_bf16 v[124:127], a[52:55], a[180:183], v[124:127]
  ds_read_b128 a[32:35], v3 offset:0
  v_cvt_pk_bf16_f32 v37, v74, v75
  v_mfma_f32_16x16x32_bf16 v[108:111], a[56:59], a[152:155], v[108:111]
  ds_read_b128 a[36:39], v3 offset:1024
  v_cvt_pk_bf16_f32 v38, v76, v77
  v_mfma_f32_16x16x32_bf16 v[116:119], a[56:59], a[168:171], v[116:119]
  v_exp_f32 v80, v80
  v_mfma_f32_16x16x32_bf16 v[124:127], a[56:59], a[184:187], v[124:127]
  v_cvt_pk_bf16_f32 v39, v78, v79
  v_mfma_f32_16x16x32_bf16 v[108:111], a[60:63], a[156:159], v[108:111]
  v_exp_f32 v81, v81
  v_mfma_f32_16x16x32_bf16 v[116:119], a[60:63], a[172:175], v[116:119]
  buffer_load_dwordx4 v2, s[20:23], s28 offen offset:3072 sc1 lds
  ds_read_b128 a[40:43], v3 offset:2048
  v_mfma_f32_16x16x32_bf16 v[124:127], a[60:63], a[188:191], v[124:127]
  s_waitcnt lgkmcnt(7)
  s_xor_b32 s26, s26, 0x4000
  s_add_u32 s28, s28, 0x8000
  v_mfma_f32_16x16x32_bf16 v[128:131], a[0:3], v[48:51], v[128:131]
  s_mov_b32 m0, s27
  v_exp_f32 v82, v82
  v_mfma_f32_16x16x32_bf16 v[160:163], a[0:3], v[52:55], v[160:163]
  ds_read_b128 a[44:47], v3 offset:3072
  v_cvt_pk_bf16_f32 v40, v80, v81
  v_mfma_f32_16x16x32_bf16 v[192:195], a[0:3], v[56:59], v[192:195]
  v_exp_f32 v83, v83
  v_mfma_f32_16x16x32_bf16 v[224:227], a[0:3], v[60:63], v[224:227]
  v_cvt_pk_bf16_f32 v41, v82, v83
  v_mfma_f32_16x16x32_bf16 a[192:195], a[208:211], v[48:51], a[192:195]
  v_mfma_f32_16x16x32_bf16 v[132:135], a[4:7], v[48:51], v[132:135]
  v_exp_f32 v84, v84
  v_mfma_f32_16x16x32_bf16 v[164:167], a[4:7], v[52:55], v[164:167]
  buffer_load_dwordx4 v2, s[20:23], s29 offen offset:0 sc1 lds
  ds_read_b128 a[48:51], v3 offset:4096
  v_mfma_f32_16x16x32_bf16 v[196:199], a[4:7], v[56:59], v[196:199]
  v_exp_f32 v85, v85
  v_mfma_f32_16x16x32_bf16 v[228:231], a[4:7], v[60:63], v[228:231]
  v_cvt_pk_bf16_f32 v42, v84, v85
  v_mfma_f32_16x16x32_bf16 a[196:199], a[208:211], v[52:55], a[196:199]
  v_exp_f32 v86, v86
  v_mfma_f32_16x16x32_bf16 v[136:139], a[8:11], v[48:51], v[136:139]
  ds_read_b128 a[52:55], v3 offset:5120
  v_mfma_f32_16x16x32_bf16 v[168:171], a[8:11], v[52:55], v[168:171]
  v_mfma_f32_16x16x32_bf16 v[200:203], a[8:11], v[56:59], v[200:203]
  v_exp_f32 v87, v87
  v_mfma_f32_16x16x32_bf16 v[232:235], a[8:11], v[60:63], v[232:235]
  buffer_load_dwordx4 v2, s[20:23], s29 offen offset:1024 sc1 lds
  v_cvt_pk_bf16_f32 v43, v86, v87
  v_mfma_f32_16x16x32_bf16 a[200:203], a[208:211], v[56:59], a[200:203]
  v_exp_f32 v88, v88
  v_mfma_f32_16x16x32_bf16 v[140:143], a[12:15], v[48:51], v[140:143]
  ds_read_b128 a[56:59], v3 offset:6144
  v_mfma_f32_16x16x32_bf16 v[172:175], a[12:15], v[52:55], v[172:175]
  v_mfma_f32_16x16x32_bf16 v[204:207], a[12:15], v[56:59], v[204:207]
  v_exp_f32 v89, v89
  v_mfma_f32_16x16x32_bf16 v[236:239], a[12:15], v[60:63], v[236:239]
  v_cvt_pk_bf16_f32 v44, v88, v89
  v_mfma_f32_16x16x32_bf16 a[204:207], a[208:211], v[60:63], a[204:207]
  s_waitcnt lgkmcnt(7)
  v_exp_f32 v90, v90
  v_mfma_f32_16x16x32_bf16 v[144:147], a[16:19], v[48:51], v[144:147]
  buffer_load_dwordx4 v2, s[20:23], s29 offen offset:2048 sc1 lds
  ds_read_b128 a[60:63], v3 offset:7168
  v_mfma_f32_16x16x32_bf16 v[176:179], a[16:19], v[52:55], v[176:179]
  v_exp_f32 v91, v91
  v_mfma_f32_16x16x32_bf16 v[208:211], a[16:19], v[56:59], v[208:211]
  v_cvt_pk_bf16_f32 v45, v90, v91
  v_mfma_f32_16x16x32_bf16 v[240:243], a[16:19], v[60:63], v[240:243]
  v_mfma_f32_16x16x32_bf16 v[148:151], a[20:23], v[48:51], v[148:151]
  v_exp_f32 v92, v92
  v_mfma_f32_16x16x32_bf16 v[180:183], a[20:23], v[52:55], v[180:183]
  ds_read_b128 a[0:3], v3 offset:8192
  v_mfma_f32_16x16x32_bf16 v[212:215], a[20:23], v[56:59], v[212:215]
  v_exp_f32 v93, v93
  v_mfma_f32_16x16x32_bf16 v[244:247], a[20:23], v[60:63], v[244:247]
  buffer_load_dwordx4 v2, s[20:23], s29 offen offset:3072 sc1 lds
  v_cvt_pk_bf16_f32 v46, v92, v93
  v_mfma_f32_16x16x32_bf16 v[152:155], a[24:27], v[48:51], v[152:155]
  s_xor_b32 s27, s27, 0x8000
  s_add_u32 s29, s29, 0x8000
  ds_read_b128 a[4:7], v3 offset:9216
  v_mfma_f32_16x16x32_bf16 v[184:187], a[24:27], v[52:55], v[184:187]
  v_exp_f32 v94, v94
  v_mfma_f32_16x16x32_bf16 v[216:219], a[24:27], v[56:59], v[216:219]
  v_mfma_f32_16x16x32_bf16 v[248:251], a[24:27], v[60:63], v[248:251]
  v_exp_f32 v95, v95
  v_mfma_f32_16x16x32_bf16 v[156:159], a[28:31], v[48:51], v[156:159]
  ds_read_b128 a[8:11], v3 offset:10240
  v_cvt_pk_bf16_f32 v47, v94, v95
  v_mfma_f32_16x16x32_bf16 v[188:191], a[28:31], v[52:55], v[188:191]
  v_mfma_f32_16x16x32_bf16 v[220:223], a[28:31], v[56:59], v[220:223]
  v_mfma_f32_16x16x32_bf16 v[252:255], a[28:31], v[60:63], v[252:255]
  s_lshl_b32 s91, s73, 11
  s_add_u32 s91, s91, 32768
  v_and_b32 v14, 15, v1
  v_lshlrev_b32 v14, 7, v14
  s_waitcnt vmcnt(22)
  s_barrier
  s_waitcnt lgkmcnt(3)
  v_mfma_f32_16x16x32_bf16 v[64:67], a[32:35], a[160:163], v[24:27]
  s_mov_b32 m0, s26
  ds_read_b128 a[12:15], v3 offset:11264
  v_cndmask_b32 v104, v104, v5, s[48:49]
  v_mfma_f32_16x16x32_bf16 v[72:75], a[32:35], a[176:179], v[28:31]
  v_exp_f32 v104, v104
  v_mfma_f32_16x16x32_bf16 v[64:67], a[36:39], a[164:167], v[64:67]
  v_cndmask_b32 v105, v105, v5, s[50:51]
  v_exp_f32 v105, v105
  v_mfma_f32_16x16x32_bf16 v[72:75], a[36:39], a[180:183], v[72:75]
  buffer_load_dwordx4 v2, s[20:23], s28 offen offset:0 sc1 lds
  ds_read_b128 a[16:19], v3 offset:12288
  v_mfma_f32_16x16x32_bf16 v[64:67], a[40:43], a[168:171], v[64:67]
  v_cndmask_b32 v106, v106, v5, s[52:53]
  v_exp_f32 v106, v106
  v_mfma_f32_16x16x32_bf16 v[72:75], a[40:43], a[184:187], v[72:75]
  ds_read_b128 a[20:23], v3 offset:13312
  v_cndmask_b32 v108, v108, v5, s[56:57]
  v_mfma_f32_16x16x32_bf16 v[64:67], a[44:47], a[172:175], v[64:67]
  ds_read_b128 a[24:27], v3 offset:14336
  v_cndmask_b32 v107, v107, v5, s[54:55]
  v_mfma_f32_16x16x32_bf16 v[72:75], a[44:47], a[188:191], v[72:75]
  v_exp_f32 v107, v107
  v_mfma_f32_16x16x32_bf16 v[68:71], a[48:51], a[160:163], v[24:27]
  buffer_load_dwordx4 v2, s[20:23], s28 offen offset:1024 sc1 lds
  ds_read_b128 a[28:31], v3 offset:15360
  v_mfma_f32_16x16x32_bf16 v[76:79], a[48:51], a[176:179], v[28:31]
  v_exp_f32 v108, v108
  v_mfma_f32_16x16x32_bf16 v[68:71], a[52:55], a[164:167], v[68:71]
  ds_read_b128 a[32:35], v4 offset:0
  v_cndmask_b32 v109, v109, v5, s[58:59]
  v_mfma_f32_16x16x32_bf16 v[76:79], a[52:55], a[180:183], v[76:79]
  v_exp_f32 v109, v109
  v_mfma_f32_16x16x32_bf16 v[68:71], a[56:59], a[168:171], v[68:71]
  ds_read_b128 a[36:39], v4 offset:1024
  v_cvt_pk_bf16_f32 v52, v104, v105
  v_mfma_f32_16x16x32_bf16 v[76:79], a[56:59], a[184:187], v[76:79]
  v_cndmask_b32 v110, v110, v5, s[60:61]
  v_cndmask_b32 v111, v111, v5, s[62:63]
  v_mfma_f32_16x16x32_bf16 v[68:71], a[60:63], a[172:175], v[68:71]
  v_exp_f32 v110, v110
  v_mfma_f32_16x16x32_bf16 v[76:79], a[60:63], a[188:191], v[76:79]
  s_waitcnt lgkmcnt(2)
  buffer_load_dwordx4 v2, s[20:23], s28 offen offset:2048 sc1 lds
  ds_read_b128 a[40:43], v4 offset:2048
  v_mfma_f32_16x16x32_bf16 v[80:83], a[0:3], a[160:163], v[24:27]
  v_exp_f32 v111, v111
  v_mfma_f32_16x16x32_bf16 v[88:91], a[0:3], a[176:179], v[28:31]
  ds_read_b128 a[44:47], v4 offset:3072
  v_cvt_pk_bf16_f32 v53, v106, v107
  v_mfma_f32_16x16x32_bf16 v[80:83], a[4:7], a[164:167], v[80:83]
  ds_read_b128 a[48:51], v4 offset:4096
  v_cvt_pk_bf16_f32 v54, v108, v109
  v_mfma_f32_16x16x32_bf16 v[88:91], a[4:7], a[180:183], v[88:91]
  v_exp_f32 v112, v112
  v_mfma_f32_16x16x32_bf16 v[80:83], a[8:11], a[168:171], v[80:83]
  ds_read_b128 a[52:55], v4 offset:5120
  v_cvt_pk_bf16_f32 v55, v110, v111
  v_mfma_f32_16x16x32_bf16 v[88:91], a[8:11], a[184:187], v[88:91]
  v_exp_f32 v113, v113
  v_mfma_f32_16x16x32_bf16 v[80:83], a[12:15], a[172:175], v[80:83]
  buffer_load_dwordx4 v2, s[20:23], s28 offen offset:3072 sc1 lds
  ds_read_b128 a[56:59], v4 offset:6144
  v_mfma_f32_16x16x32_bf16 v[88:91], a[12:15], a[188:191], v[88:91]
  s_xor_b32 s26, s26, 0x8000
  v_exp_f32 v114, v114
  v_mfma_f32_16x16x32_bf16 v[84:87], a[16:19], a[160:163], v[24:27]
  s_add_u32 s28, s28, 0x8000
  s_mov_b32 m0, s27
  ds_read_b128 a[60:63], v4 offset:7168
  v_mfma_f32_16x16x32_bf16 v[92:95], a[16:19], a[176:179], v[28:31]
  v_xor_b32 v3, 0x4000, v3
  v_cvt_pk_bf16_f32 v56, v112, v113
  v_mfma_f32_16x16x32_bf16 v[84:87], a[20:23], a[164:167], v[84:87]
  v_exp_f32 v115, v115
  v_mfma_f32_16x16x32_bf16 v[92:95], a[20:23], a[180:183], v[92:95]
  ds_read_b128 a[0:3], v3 offset:0
  v_cvt_pk_bf16_f32 v57, v114, v115
  v_mfma_f32_16x16x32_bf16 v[84:87], a[24:27], a[168:171], v[84:87]
  v_exp_f32 v116, v116
  v_mfma_f32_16x16x32_bf16 v[92:95], a[24:27], a[184:187], v[92:95]
  buffer_load_dwordx4 v2, s[20:23], s29 offen offset:0 sc1 lds
  ds_read_b128 a[4:7], v3 offset:1024
  v_mfma_f32_16x16x32_bf16 v[84:87], a[28:31], a[172:175], v[84:87]
  v_exp_f32 v117, v117
  v_mfma_f32_16x16x32_bf16 v[92:95], a[28:31], a[188:191], v[92:95]
  s_waitcnt lgkmcnt(6)
  ds_read_b128 a[8:11], v3 offset:2048
  v_cvt_pk_bf16_f32 v58, v116, v117
  v_mfma_f32_16x16x32_bf16 v[160:163], a[32:35], v[36:39], v[160:163]
  ds_read_b128 a[12:15], v3 offset:3072
  v_mfma_f32_16x16x32_bf16 v[192:195], a[32:35], v[40:43], v[192:195]
  v_exp_f32 v118, v118
  v_mfma_f32_16x16x32_bf16 v[224:227], a[32:35], v[44:47], v[224:227]
  v_mfma_f32_16x16x32_bf16 a[196:199], a[208:211], v[36:39], a[196:199]
  v_exp_f32 v119, v119
  v_mfma_f32_16x16x32_bf16 v[164:167], a[36:39], v[36:39], v[164:167]
  buffer_load_dwordx4 v2, s[20:23], s29 offen offset:1024 sc1 lds
  ds_read_b128 a[16:19], v3 offset:4096
  v_mfma_f32_16x16x32_bf16 v[196:199], a[36:39], v[40:43], v[196:199]
  v_cvt_pk_bf16_f32 v59, v118, v119
  v_mfma_f32_16x16x32_bf16 v[228:231], a[36:39], v[44:47], v[228:231]
  v_exp_f32 v120, v120
  v_mfma_f32_16x16x32_bf16 a[200:203], a[208:211], v[40:43], a[200:203]
  v_mfma_f32_16x16x32_bf16 v[168:171], a[40:43], v[36:39], v[168:171]
  v_exp_f32 v121, v121
  v_mfma_f32_16x16x32_bf16 v[200:203], a[40:43], v[40:43], v[200:203]
  ds_read_b128 a[20:23], v3 offset:5120
  v_cvt_pk_bf16_f32 v60, v120, v121
  v_mfma_f32_16x16x32_bf16 v[232:235], a[40:43], v[44:47], v[232:235]
  v_exp_f32 v122, v122
  v_mfma_f32_16x16x32_bf16 a[204:207], a[208:211], v[44:47], a[204:207]
  buffer_load_dwordx4 v2, s[20:23], s29 offen offset:2048 sc1 lds
  v_mfma_f32_16x16x32_bf16 v[172:175], a[44:47], v[36:39], v[172:175]
  ds_read_b128 a[24:27], v3 offset:6144
  v_mfma_f32_16x16x32_bf16 v[204:207], a[44:47], v[40:43], v[204:207]
  v_exp_f32 v123, v123
  v_mfma_f32_16x16x32_bf16 v[236:239], a[44:47], v[44:47], v[236:239]
  s_waitcnt lgkmcnt(7)
  v_cvt_pk_bf16_f32 v61, v122, v123
  v_mfma_f32_16x16x32_bf16 v[176:179], a[48:51], v[36:39], v[176:179]
  v_exp_f32 v124, v124
  v_mfma_f32_16x16x32_bf16 v[208:211], a[48:51], v[40:43], v[208:211]
  ds_read_b128 a[28:31], v3 offset:7168
  v_mfma_f32_16x16x32_bf16 v[240:243], a[48:51], v[44:47], v[240:243]
  v_exp_f32 v125, v125
  v_mfma_f32_16x16x32_bf16 v[180:183], a[52:55], v[36:39], v[180:183]
  buffer_load_dwordx4 v2, s[20:23], s29 offen offset:3072 sc1 lds
  ds_read_b128 a[32:35], v3 offset:8192
  v_mfma_f32_16x16x32_bf16 v[212:215], a[52:55], v[40:43], v[212:215]
  s_xor_b32 s27, s27, 0x4000
  s_add_u32 s29, s29, 0x8000
  v_cvt_pk_bf16_f32 v62, v124, v125
  v_mfma_f32_16x16x32_bf16 v[244:247], a[52:55], v[44:47], v[244:247]
  v_exp_f32 v126, v126
  v_mfma_f32_16x16x32_bf16 v[184:187], a[56:59], v[36:39], v[184:187]
  ds_read_b128 a[36:39], v3 offset:9216
  v_mfma_f32_16x16x32_bf16 v[216:219], a[56:59], v[40:43], v[216:219]
  v_exp_f32 v127, v127
  v_mfma_f32_16x16x32_bf16 v[248:251], a[56:59], v[44:47], v[248:251]
  v_cvt_pk_bf16_f32 v63, v126, v127
  v_mfma_f32_16x16x32_bf16 v[188:191], a[60:63], v[36:39], v[188:191]
  ds_read_b128 a[40:43], v3 offset:10240
  v_mfma_f32_16x16x32_bf16 v[220:223], a[60:63], v[40:43], v[220:223]
  v_mfma_f32_16x16x32_bf16 v[252:255], a[60:63], v[44:47], v[252:255]
  s_cmp_eq_u32 s25, 7
  s_cbranch_scc1 La_t7
  s_waitcnt vmcnt(12)
  s_barrier
  s_waitcnt lgkmcnt(3)
  v_mfma_f32_16x16x32_bf16 v[96:99], a[0:3], a[160:163], v[24:27]
  s_mov_b32 m0, s26
  v_exp_f32 v64, v64
  v_mfma_f32_16x16x32_bf16 v[104:107], a[0:3], a[176:179], v[28:31]
  v_exp_f32 v65, v65
  v_mfma_f32_16x16x32_bf16 v[96:99], a[4:7], a[164:167], v[96:99]
  buffer_load_dwordx4 v2, s[20:23], s28 offen offset:0 sc1 lds
  ds_read_b128 a[44:47], v3 offset:11264
  v_mfma_f32_16x16x32_bf16 v[104:107], a[4:7], a[180:183], v[104:107]
  v_exp_f32 v66, v66
  v_mfma_f32_16x16x32_bf16 v[96:99], a[8:11], a[168:171], v[96:99]
  ds_read_b128 a[48:51], v3 offset:12288
  ds_read_b128 a[52:55], v3 offset:13312
  v_mfma_f32_16x16x32_bf16 v[104:107], a[8:11], a[184:187], v[104:107]
  v_exp_f32 v67, v67
  v_mfma_f32_16x16x32_bf16 v[96:99], a[12:15], a[172:175], v[96:99]
  ds_read_b128 a[56:59], v3 offset:14336
  v_cvt_pk_bf16_f32 v32, v64, v65
  v_mfma_f32_16x16x32_bf16 v[104:107], a[12:15], a[188:191], v[104:107]
  v_exp_f32 v68, v68
  v_mfma_f32_16x16x32_bf16 v[100:103], a[16:19], a[160:163], v[24:27]
  v_exp_f32 v69, v69
  v_mfma_f32_16x16x32_bf16 v[108:111], a[16:19], a[176:179], v[28:31]
  ds_read_b128 a[60:63], v3 offset:15360
  v_cvt_pk_bf16_f32 v33, v66, v67
  v_mfma_f32_16x16x32_bf16 v[100:103], a[20:23], a[164:167], v[100:103]
  v_exp_f32 v70, v70
  v_mfma_f32_16x16x32_bf16 v[108:111], a[20:23], a[180:183], v[108:111]
  ds_read_b128 a[0:3], v4 offset:8192
  v_cvt_pk_bf16_f32 v34, v68, v69
  v_mfma_f32_16x16x32_bf16 v[100:103], a[24:27], a[168:171], v[100:103]
  v_exp_f32 v71, v71
  v_mfma_f32_16x16x32_bf16 v[108:111], a[24:27], a[184:187], v[108:111]
  ds_read_b128 a[4:7], v4 offset:9216
  v_cvt_pk_bf16_f32 v35, v70, v71
  v_mfma_f32_16x16x32_bf16 v[100:103], a[28:31], a[172:175], v[100:103]
  v_exp_f32 v72, v72
  v_mfma_f32_16x16x32_bf16 v[108:111], a[28:31], a[188:191], v[108:111]
  s_waitcnt lgkmcnt(2)
  buffer_load_dwordx4 v2, s[20:23], s28 offen offset:1024 sc1 lds
  ds_read_b128 a[8:11], v4 offset:10240
  v_mfma_f32_16x16x32_bf16 v[112:115], a[32:35], a[160:163], v[24:27]
  v_exp_f32 v73, v73
  v_mfma_f32_16x16x32_bf16 v[120:123], a[32:35], a[176:179], v[28:31]
  v_exp_f32 v74, v74
  v_mfma_f32_16x16x32_bf16 v[112:115], a[36:39], a[164:167], v[112:115]
  ds_read_b128 a[12:15], v4 offset:11264
  ds_read_b128 a[16:19], v4 offset:12288
  v_mfma_f32_16x16x32_bf16 v[120:123], a[36:39], a[180:183], v[120:123]
  v_exp_f32 v75, v75
  v_mfma_f32_16x16x32_bf16 v[112:115], a[40:43], a[168:171], v[112:115]
  ds_read_b128 a[20:23], v4 offset:13312
  v_cvt_pk_bf16_f32 v36, v72, v73
  v_mfma_f32_16x16x32_bf16 v[120:123], a[40:43], a[184:187], v[120:123]
  v_exp_f32 v76, v76
  v_mfma_f32_16x16x32_bf16 v[112:115], a[44:47], a[172:175], v[112:115]
  ds_read_b128 a[24:27], v4 offset:14336
  v_cvt_pk_bf16_f32 v37, v74, v75
  v_mfma_f32_16x16x32_bf16 v[120:123], a[44:47], a[188:191], v[120:123]
  v_exp_f32 v77, v77
  v_mfma_f32_16x16x32_bf16 v[116:119], a[48:51], a[160:163], v[24:27]
  v_exp_f32 v78, v78
  v_mfma_f32_16x16x32_bf16 v[124:127], a[48:51], a[176:179], v[28:31]
  ds_read_b128 a[28:31], v4 offset:15360
  v_xor_b32 v4, 0x8000, v4
  v_mfma_f32_16x16x32_bf16 v[116:119], a[52:55], a[164:167], v[116:119]
  v_exp_f32 v79, v79
  v_mfma_f32_16x16x32_bf16 v[124:127], a[52:55], a[180:183], v[124:127]
  v_xor_b32 v3, 0x8000, v3
  v_cvt_pk_bf16_f32 v38, v76, v77
  v_mfma_f32_16x16x32_bf16 v[116:119], a[56:59], a[168:171], v[116:119]
  v_exp_f32 v80, v80
  v_mfma_f32_16x16x32_bf16 v[124:127], a[56:59], a[184:187], v[124:127]
  buffer_load_dwordx4 v2, s[20:23], s28 offen offset:2048 sc1 lds
  ds_read_b128 a[32:35], v3 offset:0
  v_mfma_f32_16x16x32_bf16 v[116:119], a[60:63], a[172:175], v[116:119]
  v_exp_f32 v81, v81
  v_mfma_f32_16x16x32_bf16 v[124:127], a[60:63], a[188:191], v[124:127]
  s_waitcnt lgkmcnt(5)
  ds_read_b128 a[36:39], v3 offset:1024
  ds_read_b128 a[40:43], v3 offset:2048
  v_mfma_f32_16x16x32_bf16 v[160:163], a[0:3], v[52:55], v[160:163]
  v_exp_f32 v82, v82
  v_mfma_f32_16x16x32_bf16 v[192:195], a[0:3], v[56:59], v[192:195]
  v_exp_f32 v83, v83
  v_mfma_f32_16x16x32_bf16 v[224:227], a[0:3], v[60:63], v[224:227]
  ds_read_b128 a[44:47], v3 offset:3072
  v_cvt_pk_bf16_f32 v39, v78, v79
  v_mfma_f32_16x16x32_bf16 a[196:199], a[208:211], v[52:55], a[196:199]
  v_exp_f32 v84, v84
  v_mfma_f32_16x16x32_bf16 v[164:167], a[4:7], v[52:55], v[164:167]
  ds_read_b128 a[48:51], v3 offset:4096
  v_cvt_pk_bf16_f32 v40, v80, v81
  v_mfma_f32_16x16x32_bf16 v[196:199], a[4:7], v[56:59], v[196:199]
  v_exp_f32 v85, v85
  v_mfma_f32_16x16x32_bf16 v[228:231], a[4:7], v[60:63], v[228:231]
  v_cvt_pk_bf16_f32 v41, v82, v83
  v_cvt_pk_bf16_f32 v42, v84, v85
  v_mfma_f32_16x16x32_bf16 a[200:203], a[208:211], v[56:59], a[200:203]
  v_exp_f32 v86, v86
  v_mfma_f32_16x16x32_bf16 v[168:171], a[8:11], v[52:55], v[168:171]
  v_exp_f32 v87, v87
  v_mfma_f32_16x16x32_bf16 v[200:203], a[8:11], v[56:59], v[200:203]
  ds_read_b128 a[52:55], v3 offset:5120
  v_cvt_pk_bf16_f32 v43, v86, v87
  v_mfma_f32_16x16x32_bf16 v[232:235], a[8:11], v[60:63], v[232:235]
  v_exp_f32 v88, v88
  v_mfma_f32_16x16x32_bf16 a[204:207], a[208:211], v[60:63], a[204:207]
  buffer_load_dwordx4 v2, s[20:23], s28 offen offset:3072 sc1 lds
  v_mfma_f32_16x16x32_bf16 v[172:175], a[12:15], v[52:55], v[172:175]
  s_xor_b32 s26, s26, 0x4000
  v_exp_f32 v89, v89
  v_mfma_f32_16x16x32_bf16 v[204:207], a[12:15], v[56:59], v[204:207]
  s_add_u32 s28, s28, 0x8000
  ds_read_b128 a[56:59], v3 offset:6144
  v_cvt_pk_bf16_f32 v44, v88, v89
  v_mfma_f32_16x16x32_bf16 v[236:239], a[12:15], v[60:63], v[236:239]
  s_waitcnt lgkmcnt(7)
  v_exp_f32 v90, v90
  v_mfma_f32_16x16x32_bf16 v[176:179], a[16:19], v[52:55], v[176:179]
  ds_read_b128 a[60:63], v3 offset:7168
  v_mfma_f32_16x16x32_bf16 v[208:211], a[16:19], v[56:59], v[208:211]
  v_exp_f32 v91, v91
  v_mfma_f32_16x16x32_bf16 v[240:243], a[16:19], v[60:63], v[240:243]
  v_exp_f32 v92, v92
  v_mfma_f32_16x16x32_bf16 v[180:183], a[20:23], v[52:55], v[180:183]
  ds_read_b128 a[0:3], v3 offset:8192
  v_cvt_pk_bf16_f32 v45, v90, v91
  v_mfma_f32_16x16x32_bf16 v[212:215], a[20:23], v[56:59], v[212:215]
  v_exp_f32 v93, v93
  v_mfma_f32_16x16x32_bf16 v[244:247], a[20:23], v[60:63], v[244:247]
  v_cvt_pk_bf16_f32 v46, v92, v93
  v_mfma_f32_16x16x32_bf16 v[184:187], a[24:27], v[52:55], v[184:187]
  v_exp_f32 v94, v94
  v_mfma_f32_16x16x32_bf16 v[216:219], a[24:27], v[56:59], v[216:219]
  ds_read_b128 a[4:7], v3 offset:9216
  v_mfma_f32_16x16x32_bf16 v[248:251], a[24:27], v[60:63], v[248:251]
  v_exp_f32 v95, v95
  v_mfma_f32_16x16x32_bf16 v[188:191], a[28:31], v[52:55], v[188:191]
  ds_read_b128 a[8:11], v3 offset:10240
  v_cvt_pk_bf16_f32 v47, v94, v95
  v_mfma_f32_16x16x32_bf16 v[220:223], a[28:31], v[56:59], v[220:223]
  v_mfma_f32_16x16x32_bf16 v[252:255], a[28:31], v[60:63], v[252:255]
  s_lshl_b32 s4, s25, 20
  s_lshl_b32 s5, s24, 15
  s_add_u32 s4, s4, s5
  s_lshl_b32 s5, s3, 11
  s_add_u32 s4, s4, s5
  v_accvgpr_read_b32 v6, a192
  v_accvgpr_read_b32 v8, a196
  s_mov_b32 s5, 0x5f800000
  v_cmp_ngt_f32 vcc, s5, v6
  v_rcp_f32 v6, v6
  s_or_b32 s89, s89, vcc_lo
  s_or_b32 s89, s89, vcc_hi
  v_mov_b32 v7, v6
  v_cmp_ngt_f32 vcc, s5, v8
  v_rcp_f32 v8, v8
  s_or_b32 s89, s89, vcc_lo
  s_or_b32 s89, s89, vcc_hi
  v_mov_b32 v9, v8
  v_pk_mul_f32 v[128:129], v[128:129], v[6:7]
  v_pk_mul_f32 v[130:131], v[130:131], v[6:7]
  v_pk_mul_f32 v[132:133], v[132:133], v[6:7]
  v_pk_mul_f32 v[134:135], v[134:135], v[6:7]
  v_cvt_pk_bf16_f32 v128, v128, v129
  v_cvt_pk_bf16_f32 v129, v130, v131
  v_cvt_pk_bf16_f32 v130, v132, v133
  v_cvt_pk_bf16_f32 v131, v134, v135
  buffer_store_dwordx4 v[128:131], v2, s[16:19], s4 offen offset:0 sc1
  v_pk_mul_f32 v[160:161], v[160:161], v[8:9]
  v_pk_mul_f32 v[162:163], v[162:163], v[8:9]
  v_pk_mul_f32 v[164:165], v[164:165], v[8:9]
  v_pk_mul_f32 v[166:167], v[166:167], v[8:9]
  v_cvt_pk_bf16_f32 v160, v160, v161
  v_cvt_pk_bf16_f32 v161, v162, v163
  v_cvt_pk_bf16_f32 v162, v164, v165
  v_cvt_pk_bf16_f32 v163, v166, v167
  buffer_store_dwordx4 v[160:163], v2, s[16:19], s4 offen offset:1024 sc1
  s_add_u32 s4, s4, 8192
  v_pk_mul_f32 v[136:137], v[136:137], v[6:7]
  v_pk_mul_f32 v[138:139], v[138:139], v[6:7]
  v_pk_mul_f32 v[140:141], v[140:141], v[6:7]
  v_pk_mul_f32 v[142:143], v[142:143], v[6:7]
  v_cvt_pk_bf16_f32 v136, v136, v137
  v_cvt_pk_bf16_f32 v137, v138, v139
  v_cvt_pk_bf16_f32 v138, v140, v141
  v_cvt_pk_bf16_f32 v139, v142, v143
  buffer_store_dwordx4 v[136:139], v2, s[16:19], s4 offen offset:0 sc1
  v_pk_mul_f32 v[168:169], v[168:169], v[8:9]
  v_pk_mul_f32 v[170:171], v[170:171], v[8:9]
  v_pk_mul_f32 v[172:173], v[172:173], v[8:9]
  v_pk_mul_f32 v[174:175], v[174:175], v[8:9]
  v_cvt_pk_bf16_f32 v168, v168, v169
  v_cvt_pk_bf16_f32 v169, v170, v171
  v_cvt_pk_bf16_f32 v170, v172, v173
  v_cvt_pk_bf16_f32 v171, v174, v175
  buffer_store_dwordx4 v[168:171], v2, s[16:19], s4 offen offset:1024 sc1
  s_add_u32 s4, s4, 8192
  v_pk_mul_f32 v[144:145], v[144:145], v[6:7]
  v_pk_mul_f32 v[146:147], v[146:147], v[6:7]
  v_pk_mul_f32 v[148:149], v[148:149], v[6:7]
  v_pk_mul_f32 v[150:151], v[150:151], v[6:7]
  v_cvt_pk_bf16_f32 v144, v144, v145
  v_cvt_pk_bf16_f32 v145, v146, v147
  v_cvt_pk_bf16_f32 v146, v148, v149
  v_cvt_pk_bf16_f32 v147, v150, v151
  buffer_store_dwordx4 v[144:147], v2, s[16:19], s4 offen offset:0 sc1
  v_pk_mul_f32 v[176:177], v[176:177], v[8:9]
  v_pk_mul_f32 v[178:179], v[178:179], v[8:9]
  v_pk_mul_f32 v[180:181], v[180:181], v[8:9]
  v_pk_mul_f32 v[182:183], v[182:183], v[8:9]
  v_cvt_pk_bf16_f32 v176, v176, v177
  v_cvt_pk_bf16_f32 v177, v178, v179
  v_cvt_pk_bf16_f32 v178, v180, v181
  v_cvt_pk_bf16_f32 v179, v182, v183
  buffer_store_dwordx4 v[176:179], v2, s[16:19], s4 offen offset:1024 sc1
  s_add_u32 s4, s4, 8192
  v_pk_mul_f32 v[152:153], v[152:153], v[6:7]
  v_pk_mul_f32 v[154:155], v[154:155], v[6:7]
  v_pk_mul_f32 v[156:157], v[156:157], v[6:7]
  v_pk_mul_f32 v[158:159], v[158:159], v[6:7]
  v_cvt_pk_bf16_f32 v152, v152, v153
  v_cvt_pk_bf16_f32 v153, v154, v155
  v_cvt_pk_bf16_f32 v154, v156, v157
  v_cvt_pk_bf16_f32 v155, v158, v159
  buffer_store_dwordx4 v[152:155], v2, s[16:19], s4 offen offset:0 sc1
  v_pk_mul_f32 v[184:185], v[184:185], v[8:9]
  v_pk_mul_f32 v[186:187], v[186:187], v[8:9]
  v_pk_mul_f32 v[188:189], v[188:189], v[8:9]
  v_pk_mul_f32 v[190:191], v[190:191], v[8:9]
  v_cvt_pk_bf16_f32 v184, v184, v185
  v_cvt_pk_bf16_f32 v185, v186, v187
  v_cvt_pk_bf16_f32 v186, v188, v189
  v_cvt_pk_bf16_f32 v187, v190, v191
  buffer_store_dwordx4 v[184:187], v2, s[16:19], s4 offen offset:1024 sc1
  s_lshl_b32 s88, s25, 1
  s_sub_u32 s88, 14, s88
  .p2align 6
La_so:
  s_waitcnt vmcnt(12)
  s_barrier
  s_waitcnt lgkmcnt(3)
  v_mfma_f32_16x16x32_bf16 v[64:67], a[32:35], a[160:163], v[24:27]
  s_mov_b32 m0, s26
  v_exp_f32 v96, v96
  v_mfma_f32_16x16x32_bf16 v[72:75], a[32:35], a[176:179], v[28:31]
  buffer_load_dwordx4 v2, s[20:23], s28 offen offset:0 sc1 lds
  ds_read_b128 a[12:15], v3 offset:11264
  v_mfma_f32_16x16x32_bf16 v[64:67], a[36:39], a[164:167], v[64:67]
  v_exp_f32 v97, v97
  v_mfma_f32_16x16x32_bf16 v[72:75], a[36:39], a[180:183], v[72:75]
  ds_read_b128 a[16:19], v3 offset:12288
  v_cvt_pk_bf16_f32 v48, v96, v97
  v_mfma_f32_16x16x32_bf16 v[64:67], a[40:43], a[168:171], v[64:67]
  v_exp_f32 v98, v98
  v_mfma_f32_16x16x32_bf16 v[72:75], a[40:43], a[184:187], v[72:75]
  ds_read_b128 a[20:23], v3 offset:13312
  v_mfma_f32_16x16x32_bf16 v[64:67], a[44:47], a[172:175], v[64:67]
  v_exp_f32 v99, v99
  v_mfma_f32_16x16x32_bf16 v[72:75], a[44:47], a[188:191], v[72:75]
  ds_read_b128 a[24:27], v3 offset:14336
  v_cvt_pk_bf16_f32 v49, v98, v99
  v_mfma_f32_16x16x32_bf16 v[68:71], a[48:51], a[160:163], v[24:27]
  v_exp_f32 v100, v100
  v_mfma_f32_16x16x32_bf16 v[76:79], a[48:51], a[176:179], v[28:31]
  buffer_load_dwordx4 v2, s[20:23], s28 offen offset:1024 sc1 lds
  ds_read_b128 a[28:31], v3 offset:15360
  v_mfma_f32_16x16x32_bf16 v[68:71], a[52:55], a[164:167], v[68:71]
  v_exp_f32 v101, v101
  v_mfma_f32_16x16x32_bf16 v[76:79], a[52:55], a[180:183], v[76:79]
  ds_read_b128 a[32:35], v4 offset:0
  v_cvt_pk_bf16_f32 v50, v100, v101
  v_mfma_f32_16x16x32_bf16 v[68:71], a[56:59], a[168:171], v[68:71]
  v_exp_f32 v102, v102
  v_mfma_f32_16x16x32_bf16 v[76:79], a[56:59], a[184:187], v[76:79]
  ds_read_b128 a[36:39], v4 offset:1024
  v_mfma_f32_16x16x32_bf16 v[68:71], a[60:63], a[172:175], v[68:71]
  v_exp_f32 v103, v103
  v_mfma_f32_16x16x32_bf16 v[76:79], a[60:63], a[188:191], v[76:79]
  s_waitcnt lgkmcnt(2)
  ds_read_b128 a[40:43], v4 offset:2048
  v_cvt_pk_bf16_f32 v51, v102, v103
  v_mfma_f32_16x16x32_bf16 v[80:83], a[0:3], a[160:163], v[24:27]
  v_exp_f32 v104, v104
  v_mfma_f32_16x16x32_bf16 v[88:91], a[0:3], a[176:179], v[28:31]
  buffer_load_dwordx4 v2, s[20:23], s28 offen offset:2048 sc1 lds
  ds_read_b128 a[44:47], v4 offset:3072
  v_mfma_f32_16x16x32_bf16 v[80:83], a[4:7], a[164:167], v[80:83]
  v_exp_f32 v105, v105
  v_mfma_f32_16x16x32_bf16 v[88:91], a[4:7], a[180:183], v[88:91]
  ds_read_b128 a[48:51], v4 offset:4096
  v_cvt_pk_bf16_f32 v52, v104, v105
  v_mfma_f32_16x16x32_bf16 v[80:83], a[8:11], a[168:171], v[80:83]
  v_exp_f32 v106, v106
  v_mfma_f32_16x16x32_bf16 v[88:91], a[8:11], a[184:187], v[88:91]
  ds_read_b128 a[52:55], v4 offset:5120
  v_mfma_f32_16x16x32_bf16 v[80:83], a[12:15], a[172:175], v[80:83]
  v_exp_f32 v107, v107
  v_mfma_f32_16x16x32_bf16 v[88:91], a[12:15], a[188:191], v[88:91]
  ds_read_b128 a[56:59], v4 offset:6144
  v_cvt_pk_bf16_f32 v53, v106, v107
  v_mfma_f32_16x16x32_bf16 v[84:87], a[16:19], a[160:163], v[24:27]
  v_exp_f32 v108, v108
  v_mfma_f32_16x16x32_bf16 v[92:95], a[16:19], a[176:179], v[28:31]
  buffer_load_dwordx4 v2, s[20:23], s28 offen offset:3072 sc1 lds
  ds_read_b128 a[60:63], v4 offset:7168
  v_mfma_f32_16x16x32_bf16 v[84:87], a[20:23], a[164:167], v[84:87]
  s_xor_b32 s26, s26, 0x8000
  v_exp_f32 v109, v109
  v_mfma_f32_16x16x32_bf16 v[92:95], a[20:23], a[180:183], v[92:95]
  s_add_u32 s28, s28, 0x8000
  s_mov_b32 m0, s27
  ds_read_b128 a[0:3], v4 offset:8192
  v_mfma_f32_16x16x32_bf16 v[84:87], a[24:27], a[168:171], v[84:87]
  v_exp_f32 v110, v110
  v_mfma_f32_16x16x32_bf16 v[92:95], a[24:27], a[184:187], v[92:95]
  ds_read_b128 a[4:7], v4 offset:9216
  v_cvt_pk_bf16_f32 v54, v108, v109
  v_mfma_f32_16x16x32_bf16 v[84:87], a[28:31], a[172:175], v[84:87]
  v_exp_f32 v111, v111
  v_mfma_f32_16x16x32_bf16 v[92:95], a[28:31], a[188:191], v[92:95]
  s_waitcnt lgkmcnt(2)
  ds_read_b128 a[8:11], v4 offset:10240
  v_cvt_pk_bf16_f32 v55, v110, v111
  v_mfma_f32_16x16x32_bf16 v[192:195], a[32:35], v[32:35], v[192:195]
  ds_read_b128 a[12:15], v4 offset:11264
  v_mfma_f32_16x16x32_bf16 v[224:227], a[32:35], v[36:39], v[224:227]
  v_exp_f32 v112, v112
  v_mfma_f32_16x16x32_bf16 a[200:203], a[208:211], v[32:35], a[200:203]
  s_sub_u32 s88, s88, 1
  buffer_load_dwordx4 v2, s[20:23], s29 offen offset:0 sc1 lds
  v_mfma_f32_16x16x32_bf16 v[196:199], a[36:39], v[32:35], v[196:199]
  v_exp_f32 v113, v113
  v_mfma_f32_16x16x32_bf16 v[228:231], a[36:39], v[36:39], v[228:231]
  ds_read_b128 a[16:19], v4 offset:12288
  v_cvt_pk_bf16_f32 v56, v112, v113
  v_mfma_f32_16x16x32_bf16 a[204:207], a[208:211], v[36:39], a[204:207]
  v_exp_f32 v114, v114
  v_mfma_f32_16x16x32_bf16 v[200:203], a[40:43], v[32:35], v[200:203]
  ds_read_b128 a[20:23], v4 offset:13312
  v_mfma_f32_16x16x32_bf16 v[232:235], a[40:43], v[36:39], v[232:235]
  v_exp_f32 v115, v115
  v_mfma_f32_16x16x32_bf16 v[204:207], a[44:47], v[32:35], v[204:207]
  ds_read_b128 a[24:27], v4 offset:14336
  v_cvt_pk_bf16_f32 v57, v114, v115
  v_mfma_f32_16x16x32_bf16 v[236:239], a[44:47], v[36:39], v[236:239]
  v_exp_f32 v116, v116
  v_mfma_f32_16x16x32_bf16 v[208:211], a[48:51], v[32:35], v[208:211]
  buffer_load_dwordx4 v2, s[20:23], s29 offen offset:1024 sc1 lds
  ds_read_b128 a[28:31], v4 offset:15360
  v_mfma_f32_16x16x32_bf16 v[240:243], a[48:51], v[36:39], v[240:243]
  v_exp_f32 v117, v117
  v_mfma_f32_16x16x32_bf16 v[212:215], a[52:55], v[32:35], v[212:215]
  v_xor_b32 v4, 0x4000, v4
  v_xor_b32 v3, 0x4000, v3
  v_mfma_f32_16x16x32_bf16 v[244:247], a[52:55], v[36:39], v[244:247]
  v_exp_f32 v118, v118
  v_mfma_f32_16x16x32_bf16 v[216:219], a[56:59], v[32:35], v[216:219]
  ds_read_b128 a[32:35], v3 offset:0
  ds_read_b128 a[36:39], v3 offset:1024
  v_mfma_f32_16x16x32_bf16 v[248:251], a[56:59], v[36:39], v[248:251]
  v_exp_f32 v119, v119
  v_mfma_f32_16x16x32_bf16 v[220:223], a[60:63], v[32:35], v[220:223]
  ds_read_b128 a[40:43], v3 offset:2048
  v_cvt_pk_bf16_f32 v58, v116, v117
  v_mfma_f32_16x16x32_bf16 v[252:255], a[60:63], v[36:39], v[252:255]
  s_waitcnt lgkmcnt(3)
  v_exp_f32 v120, v120
  v_mfma_f32_16x16x32_bf16 v[192:195], a[0:3], v[40:43], v[192:195]
  buffer_load_dwordx4 v2, s[20:23], s29 offen offset:2048 sc1 lds
  ds_read_b128 a[44:47], v3 offset:3072
  v_mfma_f32_16x16x32_bf16 v[224:227], a[0:3], v[44:47], v[224:227]
  v_exp_f32 v121, v121
  v_mfma_f32_16x16x32_bf16 a[200:203], a[208:211], v[40:43], a[200:203]
  v_cvt_pk_bf16_f32 v59, v118, v119
  v_cvt_pk_bf16_f32 v60, v120, v121
  v_mfma_f32_16x16x32_bf16 v[196:199], a[4:7], v[40:43], v[196:199]
  v_exp_f32 v122, v122
  v_mfma_f32_16x16x32_bf16 v[228:231], a[4:7], v[44:47], v[228:231]
  ds_read_b128 a[48:51], v3 offset:4096
  v_mfma_f32_16x16x32_bf16 a[204:207], a[208:211], v[44:47], a[204:207]
  v_exp_f32 v123, v123
  v_mfma_f32_16x16x32_bf16 v[200:203], a[8:11], v[40:43], v[200:203]
  ds_read_b128 a[52:55], v3 offset:5120
  v_cvt_pk_bf16_f32 v61, v122, v123
  v_mfma_f32_16x16x32_bf16 v[232:235], a[8:11], v[44:47], v[232:235]
  v_exp_f32 v124, v124
  v_mfma_f32_16x16x32_bf16 v[204:207], a[12:15], v[40:43], v[204:207]
  buffer_load_dwordx4 v2, s[20:23], s29 offen offset:3072 sc1 lds
  ds_read_b128 a[56:59], v3 offset:6144
  v_mfma_f32_16x16x32_bf16 v[236:239], a[12:15], v[44:47], v[236:239]
  s_xor_b32 s27, s27, 0x8000
  v_exp_f32 v125, v125
  v_mfma_f32_16x16x32_bf16 v[208:211], a[16:19], v[40:43], v[208:211]
  s_add_u32 s29, s29, 0x8000
  ds_read_b128 a[60:63], v3 offset:7168
  v_cvt_pk_bf16_f32 v62, v124, v125
  v_mfma_f32_16x16x32_bf16 v[240:243], a[16:19], v[44:47], v[240:243]
  v_exp_f32 v126, v126
  v_mfma_f32_16x16x32_bf16 v[212:215], a[20:23], v[40:43], v[212:215]
  ds_read_b128 a[0:3], v3 offset:8192
  v_mfma_f32_16x16x32_bf16 v[244:247], a[20:23], v[44:47], v[244:247]
  v_exp_f32 v127, v127
  v_mfma_f32_16x16x32_bf16 v[216:219], a[24:27], v[40:43], v[216:219]
  ds_read_b128 a[4:7], v3 offset:9216
  v_cvt_pk_bf16_f32 v63, v126, v127
  v_mfma_f32_16x16x32_bf16 v[248:251], a[24:27], v[44:47], v[248:251]
  v_mfma_f32_16x16x32_bf16 v[220:223], a[28:31], v[40:43], v[220:223]
  ds_read_b128 a[8:11], v3 offset:10240
  v_mfma_f32_16x16x32_bf16 v[252:255], a[28:31], v[44:47], v[252:255]
  s_cmp_eq_u32 s88, 0
  s_cbranch_scc1 La_e0
  s_waitcnt vmcnt(12)
  s_barrier
  s_waitcnt lgkmcnt(3)
  v_mfma_f32_16x16x32_bf16 v[96:99], a[32:35], a[160:163], v[24:27]
  s_mov_b32 m0, s26
  v_exp_f32 v64, v64
  v_mfma_f32_16x16x32_bf16 v[104:107], a[32:35], a[176:179], v[28:31]
  buffer_load_dwordx4 v2, s[20:23], s28 offen offset:0 sc1 lds
  ds_read_b128 a[12:15], v3 offset:11264
  v_mfma_f32_16x16x32_bf16 v[96:99], a[36:39], a[164:167], v[96:99]
  v_exp_f32 v65, v65
  v_mfma_f32_16x16x32_bf16 v[104:107], a[36:39], a[180:183], v[104:107]
  ds_read_b128 a[16:19], v3 offset:12288
  v_cvt_pk_bf16_f32 v32, v64, v65
  v_mfma_f32_16x16x32_bf16 v[96:99], a[40:43], a[168:171], v[96:99]
  v_exp_f32 v66, v66
  v_mfma_f32_16x16x32_bf16 v[104:107], a[40:43], a[184:187], v[104:107]
  ds_read_b128 a[20:23], v3 offset:13312
  v_mfma_f32_16x16x32_bf16 v[96:99], a[44:47], a[172:175], v[96:99]
  v_exp_f32 v67, v67
  v_mfma_f32_16x16x32_bf16 v[104:107], a[44:47], a[188:191], v[104:107]
  ds_read_b128 a[24:27], v3 offset:14336
  v_cvt_pk_bf16_f32 v33, v66, v67
  v_mfma_f32_16x16x32_bf16 v[100:103], a[48:51], a[160:163], v[24:27]
  v_exp_f32 v68, v68
  v_mfma_f32_16x16x32_bf16 v[108:111], a[48:51], a[176:179], v[28:31]
  buffer_load_dwordx4 v2, s[20:23], s28 offen offset:1024 sc1 lds
  ds_read_b128 a[28:31], v3 offset:15360
  v_mfma_f32_16x16x32_bf16 v[100:103], a[52:55], a[164:167], v[100:103]
  v_exp_f32 v69, v69
  v_mfma_f32_16x16x32_bf16 v[108:111], a[52:55], a[180:183], v[108:111]
  ds_read_b128 a[32:35], v4 offset:0
  v_cvt_pk_bf16_f32 v34, v68, v69
  v_mfma_f32_16x16x32_bf16 v[100:103], a[56:59], a[168:171], v[100:103]
  v_exp_f32 v70, v70
  v_mfma_f32_16x16x32_bf16 v[108:111], a[56:59], a[184:187], v[108:111]
  ds_read_b128 a[36:39], v4 offset:1024
  v_mfma_f32_16x16x32_bf16 v[100:103], a[60:63], a[172:175], v[100:103]
  v_exp_f32 v71, v71
  v_mfma_f32_16x16x32_bf16 v[108:111], a[60:63], a[188:191], v[108:111]
  s_waitcnt lgkmcnt(2)
  ds_read_b128 a[40:43], v4 offset:2048
  v_cvt_pk_bf16_f32 v35, v70, v71
  v_mfma_f32_16x16x32_bf16 v[112:115], a[0:3], a[160:163], v[24:27]
  v_exp_f32 v72, v72
  v_mfma_f32_16x16x32_bf16 v[120:123], a[0:3], a[176:179], v[28:31]
  buffer_load_dwordx4 v2, s[20:23], s28 offen offset:2048 sc1 lds
  ds_read_b128 a[44:47], v4 offset:3072
  v_mfma_f32_16x16x32_bf16 v[112:115], a[4:7], a[164:167], v[112:115]
  v_exp_f32 v73, v73
  v_mfma_f32_16x16x32_bf16 v[120:123], a[4:7], a[180:183], v[120:123]
  ds_read_b128 a[48:51], v4 offset:4096
  v_cvt_pk_bf16_f32 v36, v72, v73
  v_mfma_f32_16x16x32_bf16 v[112:115], a[8:11], a[168:171], v[112:115]
  v_exp_f32 v74, v74
  v_mfma_f32_16x16x32_bf16 v[120:123], a[8:11], a[184:187], v[120:123]
  ds_read_b128 a[52:55], v4 offset:5120
  v_mfma_f32_16x16x32_bf16 v[112:115], a[12:15], a[172:175], v[112:115]
  v_exp_f32 v75, v75
  v_mfma_f32_16x16x32_bf16 v[120:123], a[12:15], a[188:191], v[120:123]
  ds_read_b128 a[56:59], v4 offset:6144
  v_cvt_pk_bf16_f32 v37, v74, v75
  v_mfma_f32_16x16x32_bf16 v[116:119], a[16:19], a[160:163], v[24:27]
  v_exp_f32 v76, v76
  v_mfma_f32_16x16x32_bf16 v[124:127], a[16:19], a[176:179], v[28:31]
  buffer_load_dwordx4 v2, s[20:23], s28 offen offset:3072 sc1 lds
  ds_read_b128 a[60:63], v4 offset:7168
  v_mfma_f32_16x16x32_bf16 v[116:119], a[20:23], a[164:167], v[116:119]
  s_xor_b32 s26, s26, 0x4000
  v_exp_f32 v77, v77
  v_mfma_f32_16x16x32_bf16 v[124:127], a[20:23], a[180:183], v[124:127]
  s_add_u32 s28, s28, 0x8000
  s_mov_b32 m0, s27
  ds_read_b128 a[0:3], v4 offset:8192
  v_mfma_f32_16x16x32_bf16 v[116:119], a[24:27], a[168:171], v[116:119]
  v_exp_f32 v78, v78
  v_mfma_f32_16x16x32_bf16 v[124:127], a[24:27], a[184:187], v[124:127]
  ds_read_b128 a[4:7], v4 offset:9216
  v_cvt_pk_bf16_f32 v38, v76, v77
  v_mfma_f32_16x16x32_bf16 v[116:119], a[28:31], a[172:175], v[116:119]
  v_exp_f32 v79, v79
  v_mfma_f32_16x16x32_bf16 v[124:127], a[28:31], a[188:191], v[124:127]
  s_waitcnt lgkmcnt(2)
  ds_read_b128 a[8:11], v4 offset:10240
  v_cvt_pk_bf16_f32 v39, v78, v79
  v_mfma_f32_16x16x32_bf16 v[192:195], a[32:35], v[48:51], v[192:195]
  ds_read_b128 a[12:15], v4 offset:11264
  v_mfma_f32_16x16x32_bf16 v[224:227], a[32:35], v[52:55], v[224:227]
  v_exp_f32 v80, v80
  v_mfma_f32_16x16x32_bf16 a[200:203], a[208:211], v[48:51], a[200:203]
  buffer_load_dwordx4 v2, s[20:23], s29 offen offset:0 sc1 lds
  v_mfma_f32_16x16x32_bf16 v[196:199], a[36:39], v[48:51], v[196:199]
  v_exp_f32 v81, v81
  v_mfma_f32_16x16x32_bf16 v[228:231], a[36:39], v[52:55], v[228:231]
  ds_read_b128 a[16:19], v4 offset:12288
  v_cvt_pk_bf16_f32 v40, v80, v81
  v_mfma_f32_16x16x32_bf16 a[204:207], a[208:211], v[52:55], a[204:207]
  v_exp_f32 v82, v82
  v_mfma_f32_16x16x32_bf16 v[200:203], a[40:43], v[48:51], v[200:203]
  ds_read_b128 a[20:23], v4 offset:13312
  v_mfma_f32_16x16x32_bf16 v[232:235], a[40:43], v[52:55], v[232:235]
  v_exp_f32 v83, v83
  v_mfma_f32_16x16x32_bf16 v[204:207], a[44:47], v[48:51], v[204:207]
  ds_read_b128 a[24:27], v4 offset:14336
  v_cvt_pk_bf16_f32 v41, v82, v83
  v_mfma_f32_16x16x32_bf16 v[236:239], a[44:47], v[52:55], v[236:239]
  v_exp_f32 v84, v84
  v_mfma_f32_16x16x32_bf16 v[208:211], a[48:51], v[48:51], v[208:211]
  buffer_load_dwordx4 v2, s[20:23], s29 offen offset:1024 sc1 lds
  ds_read_b128 a[28:31], v4 offset:15360
  v_mfma_f32_16x16x32_bf16 v[240:243], a[48:51], v[52:55], v[240:243]
  v_exp_f32 v85, v85
  v_mfma_f32_16x16x32_bf16 v[212:215], a[52:55], v[48:51], v[212:215]
  v_xor_b32 v4, 0x8000, v4
  v_xor_b32 v3, 0x8000, v3
  v_mfma_f32_16x16x32_bf16 v[244:247], a[52:55], v[52:55], v[244:247]
  v_exp_f32 v86, v86
  v_mfma_f32_16x16x32_bf16 v[216:219], a[56:59], v[48:51], v[216:219]
  ds_read_b128 a[32:35], v3 offset:0
  ds_read_b128 a[36:39], v3 offset:1024
  v_mfma_f32_16x16x32_bf16 v[248:251], a[56:59], v[52:55], v[248:251]
  v_exp_f32 v87, v87
  v_mfma_f32_16x16x32_bf16 v[220:223], a[60:63], v[48:51], v[220:223]
  ds_read_b128 a[40:43], v3 offset:2048
  v_cvt_pk_bf16_f32 v42, v84, v85
  v_mfma_f32_16x16x32_bf16 v[252:255], a[60:63], v[52:55], v[252:255]
  s_waitcnt lgkmcnt(3)
  v_exp_f32 v88, v88
  v_mfma_f32_16x16x32_bf16 v[192:195], a[0:3], v[56:59], v[192:195]
  buffer_load_dwordx4 v2, s[20:23], s29 offen offset:2048 sc1 lds
  ds_read_b128 a[44:47], v3 offset:3072
  v_mfma_f32_16x16x32_bf16 v[224:227], a[0:3], v[60:63], v[224:227]
  v_exp_f32 v89, v89
  v_mfma_f32_16x16x32_bf16 a[200:203], a[208:211], v[56:59], a[200:203]
  v_cvt_pk_bf16_f32 v43, v86, v87
  v_cvt_pk_bf16_f32 v44, v88, v89
  v_mfma_f32_16x16x32_bf16 v[196:199], a[4:7], v[56:59], v[196:199]
  v_exp_f32 v90, v90
  v_mfma_f32_16x16x32_bf16 v[228:231], a[4:7], v[60:63], v[228:231]
  ds_read_b128 a[48:51], v3 offset:4096
  v_mfma_f32_16x16x32_bf16 a[204:207], a[208:211], v[60:63], a[204:207]
  v_exp_f32 v91, v91
  v_mfma_f32_16x16x32_bf16 v[200:203], a[8:11], v[56:59], v[200:203]
  ds_read_b128 a[52:55], v3 offset:5120
  v_cvt_pk_bf16_f32 v45, v90, v91
  v_mfma_f32_16x16x32_bf16 v[232:235], a[8:11], v[60:63], v[232:235]
  v_exp_f32 v92, v92
  v_mfma_f32_16x16x32_bf16 v[204:207], a[12:15], v[56:59], v[204:207]
  buffer_load_dwordx4 v2, s[20:23], s29 offen offset:3072 sc1 lds
  ds_read_b128 a[56:59], v3 offset:6144
  v_mfma_f32_16x16x32_bf16 v[236:239], a[12:15], v[60:63], v[236:239]
  s_xor_b32 s27, s27, 0x4000
  v_exp_f32 v93, v93
  v_mfma_f32_16x16x32_bf16 v[208:211], a[16:19], v[56:59], v[208:211]
  s_add_u32 s29, s29, 0x8000
  ds_read_b128 a[60:63], v3 offset:7168
  v_cvt_pk_bf16_f32 v46, v92, v93
  v_mfma_f32_16x16x32_bf16 v[240:243], a[16:19], v[60:63], v[240:243]
  v_exp_f32 v94, v94
  v_mfma_f32_16x16x32_bf16 v[212:215], a[20:23], v[56:59], v[212:215]
  ds_read_b128 a[0:3], v3 offset:8192
  v_mfma_f32_16x16x32_bf16 v[244:247], a[20:23], v[60:63], v[244:247]
  v_exp_f32 v95, v95
  v_mfma_f32_16x16x32_bf16 v[216:219], a[24:27], v[56:59], v[216:219]
  ds_read_b128 a[4:7], v3 offset:9216
  v_cvt_pk_bf16_f32 v47, v94, v95
  v_mfma_f32_16x16x32_bf16 v[248:251], a[24:27], v[60:63], v[248:251]
  v_mfma_f32_16x16x32_bf16 v[220:223], a[28:31], v[56:59], v[220:223]
  ds_read_b128 a[8:11], v3 offset:10240
  v_mfma_f32_16x16x32_bf16 v[252:255], a[28:31], v[60:63], v[252:255]
  s_branch La_so
La_t7:
  s_waitcnt vmcnt(26)
  s_barrier
  s_waitcnt lgkmcnt(7)
  v_mfma_f32_16x16x32_bf16 v[104:107], a[0:3], a[176:179], v[28:31]
  buffer_load_dwordx2 v[12:13], v14, s[96:99], s91 offen sc1
  ds_read_b128 a[44:47], v3 offset:11264
  v_mfma_f32_16x16x32_bf16 v[104:107], a[4:7], a[180:183], v[104:107]
  v_cndmask_b32 v64, v64, v5, s[32:33]
  v_exp_f32 v64, v64
  v_mfma_f32_16x16x32_bf16 v[104:107], a[8:11], a[184:187], v[104:107]
  v_cndmask_b32 v65, v65, v5, s[34:35]
  v_exp_f32 v65, v65
  v_mfma_f32_16x16x32_bf16 v[104:107], a[12:15], a[188:191], v[104:107]
  s_waitcnt lgkmcnt(4)
  v_cndmask_b32 v66, v66, v5, s[36:37]
  v_exp_f32 v66, v66
  v_mfma_f32_16x16x32_bf16 v[108:111], a[16:19], a[176:179], v[28:31]
  v_cndmask_b32 v67, v67, v5, s[38:39]
  v_exp_f32 v67, v67
  v_mfma_f32_16x16x32_bf16 v[108:111], a[20:23], a[180:183], v[108:111]
  v_cndmask_b32 v68, v68, v5, s[40:41]
  v_exp_f32 v68, v68
  v_mfma_f32_16x16x32_bf16 v[108:111], a[24:27], a[184:187], v[108:111]
  v_cndmask_b32 v69, v69, v5, s[42:43]
  v_exp_f32 v69, v69
  v_mfma_f32_16x16x32_bf16 v[108:111], a[28:31], a[188:191], v[108:111]
  s_waitcnt lgkmcnt(0)
  v_cndmask_b32 v70, v70, v5, s[44:45]
  v_exp_f32 v70, v70
  v_mfma_f32_16x16x32_bf16 v[120:123], a[32:35], a[176:179], v[28:31]
  v_cndmask_b32 v71, v71, v5, s[46:47]
  v_exp_f32 v71, v71
  v_mfma_f32_16x16x32_bf16 v[120:123], a[36:39], a[180:183], v[120:123]
  ds_read_b128 a[48:51], v3 offset:12288
  ds_read_b128 a[52:55], v3 offset:13312
  ds_read_b128 a[56:59], v3 offset:14336
  v_mfma_f32_16x16x32_bf16 v[120:123], a[40:43], a[184:187], v[120:123]
  ds_read_b128 a[60:63], v3 offset:15360
  v_exp_f32 v72, v72
  v_mfma_f32_16x16x32_bf16 v[120:123], a[44:47], a[188:191], v[120:123]
  s_waitcnt lgkmcnt(0)
  v_exp_f32 v73, v73
  v_cvt_pk_bf16_f32 v33, v66, v67
  v_mfma_f32_16x16x32_bf16 v[124:127], a[48:51], a[176:179], v[28:31]
  v_exp_f32 v74, v74
  v_cvt_pk_bf16_f32 v34, v68, v69
  v_mfma_f32_16x16x32_bf16 v[124:127], a[52:55], a[180:183], v[124:127]
  ds_read_b128 a[0:3], v4 offset:8192
  ds_read_b128 a[4:7], v4 offset:9216
  ds_read_b128 a[8:11], v4 offset:10240
  v_mfma_f32_16x16x32_bf16 v[124:127], a[56:59], a[184:187], v[124:127]
  ds_read_b128 a[12:15], v4 offset:11264
  v_exp_f32 v75, v75
  v_mfma_f32_16x16x32_bf16 v[124:127], a[60:63], a[188:191], v[124:127]
  s_waitcnt lgkmcnt(0)
  v_exp_f32 v76, v76
  v_cvt_pk_bf16_f32 v35, v70, v71
  v_mfma_f32_16x16x32_bf16 v[160:163], a[0:3], v[52:55], v[160:163]
  v_exp_f32 v77, v77
  v_cvt_pk_bf16_f32 v36, v72, v73
  v_mfma_f32_16x16x32_bf16 v[192:195], a[0:3], v[56:59], v[192:195]
  v_exp_f32 v78, v78
  v_cvt_pk_bf16_f32 v37, v74, v75
  v_mfma_f32_16x16x32_bf16 v[224:227], a[0:3], v[60:63], v[224:227]
  ds_read_b128 a[16:19], v4 offset:12288
  ds_read_b128 a[20:23], v4 offset:13312
  v_cvt_pk_bf16_f32 v38, v76, v77
  v_mfma_f32_16x16x32_bf16 a[196:199], a[208:211], v[52:55], a[196:199]
  v_exp_f32 v79, v79
  v_mfma_f32_16x16x32_bf16 v[164:167], a[4:7], v[52:55], v[164:167]
  v_cndmask_b32 v80, v80, v5, s[48:49]
  v_exp_f32 v80, v80
  v_cvt_pk_bf16_f32 v39, v78, v79
  v_mfma_f32_16x16x32_bf16 v[196:199], a[4:7], v[56:59], v[196:199]
  v_cndmask_b32 v81, v81, v5, s[50:51]
  v_exp_f32 v81, v81
  v_mfma_f32_16x16x32_bf16 v[228:231], a[4:7], v[60:63], v[228:231]
  ds_read_b128 a[24:27], v4 offset:14336
  ds_read_b128 a[28:31], v4 offset:15360
  v_cvt_pk_bf16_f32 v40, v80, v81
  v_mfma_f32_16x16x32_bf16 a[200:203], a[208:211], v[56:59], a[200:203]
  v_cndmask_b32 v82, v82, v5, s[52:53]
  v_exp_f32 v82, v82
  v_mfma_f32_16x16x32_bf16 v[168:171], a[8:11], v[52:55], v[168:171]
  v_cndmask_b32 v83, v83, v5, s[54:55]
  v_exp_f32 v83, v83
  v_mfma_f32_16x16x32_bf16 v[200:203], a[8:11], v[56:59], v[200:203]
  v_cndmask_b32 v84, v84, v5, s[56:57]
  v_exp_f32 v84, v84
  v_mfma_f32_16x16x32_bf16 v[232:235], a[8:11], v[60:63], v[232:235]
  v_cndmask_b32 v85, v85, v5, s[58:59]
  v_exp_f32 v85, v85
  v_mfma_f32_16x16x32_bf16 a[204:207], a[208:211], v[60:63], a[204:207]
  v_xor_b32 v4, 0x8000, v4
  v_cvt_pk_bf16_f32 v32, v64, v65
  v_cvt_pk_bf16_f32 v41, v82, v83
  v_mfma_f32_16x16x32_bf16 v[172:175], a[12:15], v[52:55], v[172:175]
  v_cndmask_b32 v86, v86, v5, s[60:61]
  v_exp_f32 v86, v86
  v_mfma_f32_16x16x32_bf16 v[204:207], a[12:15], v[56:59], v[204:207]
  v_cndmask_b32 v87, v87, v5, s[62:63]
  v_exp_f32 v87, v87
  v_mfma_f32_16x16x32_bf16 v[236:239], a[12:15], v[60:63], v[236:239]
  s_waitcnt lgkmcnt(0)
  v_exp_f32 v88, v88
  v_cvt_pk_bf16_f32 v42, v84, v85
  v_mfma_f32_16x16x32_bf16 v[176:179], a[16:19], v[52:55], v[176:179]
  ds_read_b128 a[32:35], v4 offset:0
  ds_read_b128 a[36:39], v4 offset:1024
  v_cvt_pk_bf16_f32 v43, v86, v87
  v_mfma_f32_16x16x32_bf16 v[208:211], a[16:19], v[56:59], v[208:211]
  v_exp_f32 v89, v89
  v_mfma_f32_16x16x32_bf16 v[240:243], a[16:19], v[60:63], v[240:243]
  v_exp_f32 v90, v90
  v_cvt_pk_bf16_f32 v44, v88, v89
  v_mfma_f32_16x16x32_bf16 v[180:183], a[20:23], v[52:55], v[180:183]
  v_exp_f32 v91, v91
  v_mfma_f32_16x16x32_bf16 v[212:215], a[20:23], v[56:59], v[212:215]
  v_exp_f32 v92, v92
  v_cvt_pk_bf16_f32 v45, v90, v91
  v_mfma_f32_16x16x32_bf16 v[244:247], a[20:23], v[60:63], v[244:247]
  ds_read_b128 a[40:43], v4 offset:2048
  ds_read_b128 a[44:47], v4 offset:3072
  v_mfma_f32_16x16x32_bf16 v[184:187], a[24:27], v[52:55], v[184:187]
  v_exp_f32 v93, v93
  v_mfma_f32_16x16x32_bf16 v[216:219], a[24:27], v[56:59], v[216:219]
  v_exp_f32 v94, v94
  v_cvt_pk_bf16_f32 v46, v92, v93
  v_mfma_f32_16x16x32_bf16 v[248:251], a[24:27], v[60:63], v[248:251]
  v_exp_f32 v95, v95
  v_mfma_f32_16x16x32_bf16 v[188:191], a[28:31], v[52:55], v[188:191]
  ds_read_b128 a[48:51], v4 offset:4096
  ds_read_b128 a[52:55], v4 offset:5120
  v_cvt_pk_bf16_f32 v47, v94, v95
  v_mfma_f32_16x16x32_bf16 v[220:223], a[28:31], v[56:59], v[220:223]
  ds_read_b128 a[56:59], v4 offset:6144
  ds_read_b128 a[60:63], v4 offset:7168
  v_mfma_f32_16x16x32_bf16 v[252:255], a[28:31], v[60:63], v[252:255]
  ds_read_b128 a[0:3], v4 offset:8192
  ds_read_b128 a[4:7], v4 offset:9216
  ds_read_b128 a[8:11], v4 offset:10240
  s_lshl_b32 s4, s25, 20
  s_lshl_b32 s5, s24, 15
  s_add_u32 s4, s4, s5
  s_lshl_b32 s5, s3, 11
  s_add_u32 s4, s4, s5
  v_accvgpr_read_b32 v6, a192
  v_accvgpr_read_b32 v8, a196
  s_mov_b32 s5, 0x5f800000
  v_cmp_ngt_f32 vcc, s5, v6
  v_rcp_f32 v6, v6
  s_or_b32 s89, s89, vcc_lo
  s_or_b32 s89, s89, vcc_hi
  v_mov_b32 v7, v6
  v_cmp_ngt_f32 vcc, s5, v8
  v_rcp_f32 v8, v8
  s_or_b32 s89, s89, vcc_lo
  s_or_b32 s89, s89, vcc_hi
  v_mov_b32 v9, v8
  v_pk_mul_f32 v[128:129], v[128:129], v[6:7]
  v_pk_mul_f32 v[130:131], v[130:131], v[6:7]
  v_pk_mul_f32 v[132:133], v[132:133], v[6:7]
  v_pk_mul_f32 v[134:135], v[134:135], v[6:7]
  v_cvt_pk_bf16_f32 v128, v128, v129
  v_cvt_pk_bf16_f32 v129, v130, v131
  v_cvt_pk_bf16_f32 v130, v132, v133
  v_cvt_pk_bf16_f32 v131, v134, v135
  buffer_store_dwordx4 v[128:131], v2, s[16:19], s4 offen offset:0 sc1
  v_pk_mul_f32 v[160:161], v[160:161], v[8:9]
  v_pk_mul_f32 v[162:163], v[162:163], v[8:9]
  v_pk_mul_f32 v[164:165], v[164:165], v[8:9]
  v_pk_mul_f32 v[166:167], v[166:167], v[8:9]
  v_cvt_pk_bf16_f32 v160, v160, v161
  v_cvt_pk_bf16_f32 v161, v162, v163
  v_cvt_pk_bf16_f32 v162, v164, v165
  v_cvt_pk_bf16_f32 v163, v166, v167
  buffer_store_dwordx4 v[160:163], v2, s[16:19], s4 offen offset:1024 sc1
  s_add_u32 s4, s4, 8192
  v_pk_mul_f32 v[136:137], v[136:137], v[6:7]
  v_pk_mul_f32 v[138:139], v[138:139], v[6:7]
  v_pk_mul_f32 v[140:141], v[140:141], v[6:7]
  v_pk_mul_f32 v[142:143], v[142:143], v[6:7]
  v_cvt_pk_bf16_f32 v136, v136, v137
  v_cvt_pk_bf16_f32 v137, v138, v139
  v_cvt_pk_bf16_f32 v138, v140, v141
  v_cvt_pk_bf16_f32 v139, v142, v143
  buffer_store_dwordx4 v[136:139], v2, s[16:19], s4 offen offset:0 sc1
  v_pk_mul_f32 v[168:169], v[168:169], v[8:9]
  v_pk_mul_f32 v[170:171], v[170:171], v[8:9]
  v_pk_mul_f32 v[172:173], v[172:173], v[8:9]
  v_pk_mul_f32 v[174:175], v[174:175], v[8:9]
  v_cvt_pk_bf16_f32 v168, v168, v169
  v_cvt_pk_bf16_f32 v169, v170, v171
  v_cvt_pk_bf16_f32 v170, v172, v173
  v_cvt_pk_bf16_f32 v171, v174, v175
  buffer_store_dwordx4 v[168:171], v2, s[16:19], s4 offen offset:1024 sc1
  s_add_u32 s4, s4, 8192
  v_pk_mul_f32 v[144:145], v[144:145], v[6:7]
  v_pk_mul_f32 v[146:147], v[146:147], v[6:7]
  v_pk_mul_f32 v[148:149], v[148:149], v[6:7]
  v_pk_mul_f32 v[150:151], v[150:151], v[6:7]
  v_cvt_pk_bf16_f32 v144, v144, v145
  v_cvt_pk_bf16_f32 v145, v146, v147
  v_cvt_pk_bf16_f32 v146, v148, v149
  v_cvt_pk_bf16_f32 v147, v150, v151
  buffer_store_dwordx4 v[144:147], v2, s[16:19], s4 offen offset:0 sc1
  v_pk_mul_f32 v[176:177], v[176:177], v[8:9]
  v_pk_mul_f32 v[178:179], v[178:179], v[8:9]
  v_pk_mul_f32 v[180:181], v[180:181], v[8:9]
  v_pk_mul_f32 v[182:183], v[182:183], v[8:9]
  v_cvt_pk_bf16_f32 v176, v176, v177
  v_cvt_pk_bf16_f32 v177, v178, v179
  v_cvt_pk_bf16_f32 v178, v180, v181
  v_cvt_pk_bf16_f32 v179, v182, v183
  buffer_store_dwordx4 v[176:179], v2, s[16:19], s4 offen offset:1024 sc1
  s_add_u32 s4, s4, 8192
  v_pk_mul_f32 v[152:153], v[152:153], v[6:7]
  v_pk_mul_f32 v[154:155], v[154:155], v[6:7]
  v_pk_mul_f32 v[156:157], v[156:157], v[6:7]
  v_pk_mul_f32 v[158:159], v[158:159], v[6:7]
  v_cvt_pk_bf16_f32 v152, v152, v153
  v_cvt_pk_bf16_f32 v153, v154, v155
  v_cvt_pk_bf16_f32 v154, v156, v157
  v_cvt_pk_bf16_f32 v155, v158, v159
  buffer_store_dwordx4 v[152:155], v2, s[16:19], s4 offen offset:0 sc1
  v_pk_mul_f32 v[184:185], v[184:185], v[8:9]
  v_pk_mul_f32 v[186:187], v[186:187], v[8:9]
  v_pk_mul_f32 v[188:189], v[188:189], v[8:9]
  v_pk_mul_f32 v[190:191], v[190:191], v[8:9]
  v_cvt_pk_bf16_f32 v184, v184, v185
  v_cvt_pk_bf16_f32 v185, v186, v187
  v_cvt_pk_bf16_f32 v186, v188, v189
  v_cvt_pk_bf16_f32 v187, v190, v191
  buffer_store_dwordx4 v[184:187], v2, s[16:19], s4 offen offset:1024 sc1
  s_branch La_e1
La_e0:
  s_waitcnt vmcnt(8)
  s_barrier
  s_waitcnt lgkmcnt(7)
  v_mfma_f32_16x16x32_bf16 v[104:107], a[32:35], a[176:179], v[28:31]
  buffer_load_dwordx2 v[12:13], v14, s[96:99], s91 offen sc1
  ds_read_b128 a[12:15], v3 offset:11264
  v_mfma_f32_16x16x32_bf16 v[104:107], a[36:39], a[180:183], v[104:107]
  v_cndmask_b32 v64, v64, v5, s[32:33]
  v_exp_f32 v64, v64
  v_mfma_f32_16x16x32_bf16 v[104:107], a[40:43], a[184:187], v[104:107]
  v_cndmask_b32 v65, v65, v5, s[34:35]
  v_exp_f32 v65, v65
  v_mfma_f32_16x16x32_bf16 v[104:107], a[44:47], a[188:191], v[104:107]
  s_waitcnt lgkmcnt(4)
  v_cndmask_b32 v66, v66, v5, s[36:37]
  v_exp_f32 v66, v66
  v_mfma_f32_16x16x32_bf16 v[108:111], a[48:51], a[176:179], v[28:31]
  v_cndmask_b32 v67, v67, v5, s[38:39]
  v_exp_f32 v67, v67
  v_mfma_f32_16x16x32_bf16 v[108:111], a[52:55], a[180:183], v[108:111]
  ds_read_b128 a[16:19], v3 offset:12288
  ds_read_b128 a[20:23], v3 offset:13312
  v_mfma_f32_16x16x32_bf16 v[108:111], a[56:59], a[184:187], v[108:111]
  v_cndmask_b32 v68, v68, v5, s[40:41]
  v_exp_f32 v68, v68
  v_mfma_f32_16x16x32_bf16 v[108:111], a[60:63], a[188:191], v[108:111]
  s_waitcnt lgkmcnt(2)
  v_cndmask_b32 v69, v69, v5, s[42:43]
  v_exp_f32 v69, v69
  v_mfma_f32_16x16x32_bf16 v[120:123], a[0:3], a[176:179], v[28:31]
  ds_read_b128 a[24:27], v3 offset:14336
  ds_read_b128 a[28:31], v3 offset:15360
  v_mfma_f32_16x16x32_bf16 v[120:123], a[4:7], a[180:183], v[120:123]
  v_cndmask_b32 v70, v70, v5, s[44:45]
  v_exp_f32 v70, v70
  v_mfma_f32_16x16x32_bf16 v[120:123], a[8:11], a[184:187], v[120:123]
  v_cndmask_b32 v71, v71, v5, s[46:47]
  v_exp_f32 v71, v71
  v_mfma_f32_16x16x32_bf16 v[120:123], a[12:15], a[188:191], v[120:123]
  s_waitcnt lgkmcnt(0)
  ds_read_b128 a[32:35], v4 offset:0
  ds_read_b128 a[36:39], v4 offset:1024
  v_mfma_f32_16x16x32_bf16 v[124:127], a[16:19], a[176:179], v[28:31]
  v_exp_f32 v72, v72
  v_mfma_f32_16x16x32_bf16 v[124:127], a[20:23], a[180:183], v[124:127]
  ds_read_b128 a[40:43], v4 offset:2048
  ds_read_b128 a[44:47], v4 offset:3072
  ds_read_b128 a[48:51], v4 offset:4096
  v_mfma_f32_16x16x32_bf16 v[124:127], a[24:27], a[184:187], v[124:127]
  ds_read_b128 a[52:55], v4 offset:5120
  ds_read_b128 a[56:59], v4 offset:6144
  ds_read_b128 a[60:63], v4 offset:7168
  v_exp_f32 v73, v73
  v_mfma_f32_16x16x32_bf16 v[124:127], a[28:31], a[188:191], v[124:127]
  s_waitcnt lgkmcnt(0)
  v_exp_f32 v74, v74
  v_mfma_f32_16x16x32_bf16 v[192:195], a[32:35], v[48:51], v[192:195]
  ds_read_b128 a[0:3], v4 offset:8192
  ds_read_b128 a[4:7], v4 offset:9216
  v_mfma_f32_16x16x32_bf16 v[224:227], a[32:35], v[52:55], v[224:227]
  v_exp_f32 v75, v75
  v_mfma_f32_16x16x32_bf16 a[200:203], a[208:211], v[48:51], a[200:203]
  v_exp_f32 v76, v76
  v_mfma_f32_16x16x32_bf16 v[196:199], a[36:39], v[48:51], v[196:199]
  ds_read_b128 a[8:11], v4 offset:10240
  ds_read_b128 a[12:15], v4 offset:11264
  v_mfma_f32_16x16x32_bf16 v[228:231], a[36:39], v[52:55], v[228:231]
  v_exp_f32 v77, v77
  v_mfma_f32_16x16x32_bf16 a[204:207], a[208:211], v[52:55], a[204:207]
  v_exp_f32 v78, v78
  v_mfma_f32_16x16x32_bf16 v[200:203], a[40:43], v[48:51], v[200:203]
  ds_read_b128 a[16:19], v4 offset:12288
  ds_read_b128 a[20:23], v4 offset:13312
  v_mfma_f32_16x16x32_bf16 v[232:235], a[40:43], v[52:55], v[232:235]
  v_exp_f32 v79, v79
  v_mfma_f32_16x16x32_bf16 v[204:207], a[44:47], v[48:51], v[204:207]
  ds_read_b128 a[24:27], v4 offset:14336
  v_cvt_pk_bf16_f32 v32, v64, v65
  v_mfma_f32_16x16x32_bf16 v[236:239], a[44:47], v[52:55], v[236:239]
  v_cndmask_b32 v80, v80, v5, s[48:49]
  v_exp_f32 v80, v80
  v_mfma_f32_16x16x32_bf16 v[208:211], a[48:51], v[48:51], v[208:211]
  v_cndmask_b32 v81, v81, v5, s[50:51]
  v_exp_f32 v81, v81
  v_mfma_f32_16x16x32_bf16 v[240:243], a[48:51], v[52:55], v[240:243]
  ds_read_b128 a[28:31], v4 offset:15360
  v_xor_b32 v4, 0x8000, v4
  v_mfma_f32_16x16x32_bf16 v[212:215], a[52:55], v[48:51], v[212:215]
  v_cndmask_b32 v82, v82, v5, s[52:53]
  v_exp_f32 v82, v82
  v_mfma_f32_16x16x32_bf16 v[244:247], a[52:55], v[52:55], v[244:247]
  v_cndmask_b32 v83, v83, v5, s[54:55]
  v_exp_f32 v83, v83
  v_mfma_f32_16x16x32_bf16 v[216:219], a[56:59], v[48:51], v[216:219]
  ds_read_b128 a[32:35], v4 offset:0
  ds_read_b128 a[36:39], v4 offset:1024
  v_mfma_f32_16x16x32_bf16 v[248:251], a[56:59], v[52:55], v[248:251]
  v_cndmask_b32 v84, v84, v5, s[56:57]
  v_exp_f32 v84, v84
  v_mfma_f32_16x16x32_bf16 v[220:223], a[60:63], v[48:51], v[220:223]
  v_cndmask_b32 v85, v85, v5, s[58:59]
  v_exp_f32 v85, v85
  v_mfma_f32_16x16x32_bf16 v[252:255], a[60:63], v[52:55], v[252:255]
  s_waitcnt lgkmcnt(2)
  ds_read_b128 a[40:43], v4 offset:2048
  v_cvt_pk_bf16_f32 v33, v66, v67
  v_cvt_pk_bf16_f32 v42, v84, v85
  v_mfma_f32_16x16x32_bf16 v[192:195], a[0:3], v[56:59], v[192:195]
  v_cndmask_b32 v86, v86, v5, s[60:61]
  v_exp_f32 v86, v86
  v_mfma_f32_16x16x32_bf16 v[224:227], a[0:3], v[60:63], v[224:227]
  v_cndmask_b32 v87, v87, v5, s[62:63]
  v_exp_f32 v87, v87
  v_mfma_f32_16x16x32_bf16 a[200:203], a[208:211], v[56:59], a[200:203]
  ds_read_b128 a[44:47], v4 offset:3072
  v_cvt_pk_bf16_f32 v34, v68, v69
  v_cvt_pk_bf16_f32 v43, v86, v87
  v_mfma_f32_16x16x32_bf16 v[196:199], a[4:7], v[56:59], v[196:199]
  v_exp_f32 v88, v88
  v_mfma_f32_16x16x32_bf16 v[228:231], a[4:7], v[60:63], v[228:231]
  ds_read_b128 a[48:51], v4 offset:4096
  v_cvt_pk_bf16_f32 v35, v70, v71
  v_mfma_f32_16x16x32_bf16 a[204:207], a[208:211], v[60:63], a[204:207]
  v_exp_f32 v89, v89
  v_mfma_f32_16x16x32_bf16 v[200:203], a[8:11], v[56:59], v[200:203]
  v_exp_f32 v90, v90
  v_cvt_pk_bf16_f32 v44, v88, v89
  v_mfma_f32_16x16x32_bf16 v[232:235], a[8:11], v[60:63], v[232:235]
  ds_read_b128 a[52:55], v4 offset:5120
  v_cvt_pk_bf16_f32 v36, v72, v73
  v_mfma_f32_16x16x32_bf16 v[204:207], a[12:15], v[56:59], v[204:207]
  v_exp_f32 v91, v91
  v_mfma_f32_16x16x32_bf16 v[236:239], a[12:15], v[60:63], v[236:239]
  v_exp_f32 v92, v92
  v_cvt_pk_bf16_f32 v45, v90, v91
  v_mfma_f32_16x16x32_bf16 v[208:211], a[16:19], v[56:59], v[208:211]
  ds_read_b128 a[56:59], v4 offset:6144
  ds_read_b128 a[60:63], v4 offset:7168
  v_mfma_f32_16x16x32_bf16 v[240:243], a[16:19], v[60:63], v[240:243]
  v_exp_f32 v93, v93
  v_mfma_f32_16x16x32_bf16 v[212:215], a[20:23], v[56:59], v[212:215]
  v_exp_f32 v94, v94
  v_cvt_pk_bf16_f32 v46, v92, v93
  v_mfma_f32_16x16x32_bf16 v[244:247], a[20:23], v[60:63], v[244:247]
  ds_read_b128 a[0:3], v4 offset:8192
  v_cvt_pk_bf16_f32 v37, v74, v75
  v_mfma_f32_16x16x32_bf16 v[216:219], a[24:27], v[56:59], v[216:219]
  v_exp_f32 v95, v95
  v_mfma_f32_16x16x32_bf16 v[248:251], a[24:27], v[60:63], v[248:251]
  ds_read_b128 a[4:7], v4 offset:9216
  v_cvt_pk_bf16_f32 v38, v76, v77
  v_cvt_pk_bf16_f32 v47, v94, v95
  v_mfma_f32_16x16x32_bf16 v[220:223], a[28:31], v[56:59], v[220:223]
  ds_read_b128 a[8:11], v4 offset:10240
  v_cvt_pk_bf16_f32 v39, v78, v79
  v_mfma_f32_16x16x32_bf16 v[252:255], a[28:31], v[60:63], v[252:255]
  v_cvt_pk_bf16_f32 v40, v80, v81
  v_cvt_pk_bf16_f32 v41, v82, v83
La_e1:
  s_waitcnt vmcnt(0)
  s_barrier
  s_mov_b32 s5, 0x40000
Lpoll_13:
  v_cmp_ne_u64 vcc, s[94:95], v[12:13]
  s_nop 0
  s_cbranch_vccz Lpolld_14
  s_sleep 4
  buffer_load_dwordx2 v[12:13], v14, s[96:99], s91 offen sc1
  s_sub_u32 s5, s5, 1
  s_waitcnt vmcnt(0)
  s_cbranch_scc0 Lpoll_13
Lpolld_14:
  v_accvgpr_read_b32 v10, a212
  v_accvgpr_read_b32 v11, a213
  v_accvgpr_read_b32 v12, a214
  v_accvgpr_read_b32 v13, a215
  s_mov_b32 s12, s80
  s_mov_b32 s13, s81
  s_mov_b32 s14, 2097152
  s_mov_b32 s15, 0x00020000
  s_lshl_b32 s71, s77, 20
  s_lshl_b32 s72, s76, 8
  s_add_u32 s71, s71, s72
  s_add_u32 s8, s86, 83886080
  s_addc_u32 s9, s87, 0
  s_mov_b32 s10, 4194304
  s_mov_b32 s11, 0x00020000
  s_lshl_b32 s70, s73, 1
  s_add_u32 s70, s70, s77
  s_lshl_b32 s70, s70, 17
  s_add_u32 s70, s70, s79
  s_waitcnt lgkmcnt(3)
  v_mfma_f32_16x16x32_bf16 v[192:195], a[32:35], v[32:35], v[192:195]
  s_add_u32 m0, s79, 147456
  ds_read_b128 a[12:15], v4 offset:11264
  v_cndmask_b32 v104, v104, v5, s[32:33]
  v_mfma_f32_16x16x32_bf16 v[224:227], a[32:35], v[36:39], v[224:227]
  v_exp_f32 v104, v104
  v_mfma_f32_16x16x32_bf16 a[200:203], a[208:211], v[32:35], a[200:203]
  v_cndmask_b32 v105, v105, v5, s[34:35]
  v_exp_f32 v105, v105
  v_mfma_f32_16x16x32_bf16 v[196:199], a[36:39], v[32:35], v[196:199]
  buffer_load_dwordx4 v10, s[12:15], s71 offen offset:0 lds
  ds_read_b128 a[16:19], v4 offset:12288
  v_mfma_f32_16x16x32_bf16 v[228:231], a[36:39], v[36:39], v[228:231]
  v_cndmask_b32 v106, v106, v5, s[36:37]
  v_exp_f32 v106, v106
  v_mfma_f32_16x16x32_bf16 a[204:207], a[208:211], v[36:39], a[204:207]
  buffer_load_dwordx4 v11, s[12:15], s71 offen offset:1024 lds
  v_cndmask_b32 v107, v107, v5, s[38:39]
  v_mfma_f32_16x16x32_bf16 v[200:203], a[40:43], v[32:35], v[200:203]
  v_exp_f32 v107, v107
  v_mfma_f32_16x16x32_bf16 v[232:235], a[40:43], v[36:39], v[232:235]
  ds_read_b128 a[20:23], v4 offset:13312
  v_cndmask_b32 v108, v108, v5, s[40:41]
  v_mfma_f32_16x16x32_bf16 v[204:207], a[44:47], v[32:35], v[204:207]
  v_exp_f32 v108, v108
  v_mfma_f32_16x16x32_bf16 v[236:239], a[44:47], v[36:39], v[236:239]
  buffer_load_dwordx4 v12, s[12:15], s71 offen offset:2048 lds
  ds_read_b128 a[24:27], v4 offset:14336
  v_mfma_f32_16x16x32_bf16 v[208:211], a[48:51], v[32:35], v[208:211]
  v_cndmask_b32 v109, v109, v5, s[42:43]
  v_exp_f32 v109, v109
  v_mfma_f32_16x16x32_bf16 v[240:243], a[48:51], v[36:39], v[240:243]
  ds_read_b128 a[28:31], v4 offset:15360
  v_xor_b32 v4, 0x4000, v4
  v_mfma_f32_16x16x32_bf16 v[212:215], a[52:55], v[32:35], v[212:215]
  v_cndmask_b32 v110, v110, v5, s[44:45]
  v_exp_f32 v110, v110
  v_mfma_f32_16x16x32_bf16 v[244:247], a[52:55], v[36:39], v[244:247]
  buffer_load_dwordx4 v13, s[12:15], s71 offen offset:3072 lds
  ds_read_b128 a[32:35], v4 offset:0
  v_mfma_f32_16x16x32_bf16 v[216:219], a[56:59], v[32:35], v[216:219]
  s_add_u32 s71, s71, 131072
  v_cndmask_b32 v111, v111, v5, s[46:47]
  v_exp_f32 v111, v111
  v_mfma_f32_16x16x32_bf16 v[248:251], a[56:59], v[36:39], v[248:251]
  s_add_u32 m0, s79, 131072
  ds_read_b128 a[36:39], v4 offset:1024
  v_cvt_pk_bf16_f32 v52, v104, v105
  v_mfma_f32_16x16x32_bf16 v[220:223], a[60:63], v[32:35], v[220:223]
  ds_read_b128 a[40:43], v4 offset:2048
  v_cvt_pk_bf16_f32 v53, v106, v107
  v_mfma_f32_16x16x32_bf16 v[252:255], a[60:63], v[36:39], v[252:255]
  s_waitcnt lgkmcnt(3)
  v_cndmask_b32 v120, v120, v5, s[48:49]
  v_exp_f32 v120, v120
  v_mfma_f32_16x16x32_bf16 v[192:195], a[0:3], v[40:43], v[192:195]
  buffer_load_dwordx4 v2, s[8:11], s70 offen offset:0 sc1 lds
  ds_read_b128 a[44:47], v4 offset:3072
  v_mfma_f32_16x16x32_bf16 v[224:227], a[0:3], v[44:47], v[224:227]
  v_cndmask_b32 v121, v121, v5, s[50:51]
  v_exp_f32 v121, v121
  v_mfma_f32_16x16x32_bf16 a[200:203], a[208:211], v[40:43], a[200:203]
  v_cvt_pk_bf16_f32 v54, v108, v109
  v_cvt_pk_bf16_f32 v55, v110, v111
  v_mfma_f32_16x16x32_bf16 v[196:199], a[4:7], v[40:43], v[196:199]
  v_cndmask_b32 v122, v122, v5, s[52:53]
  v_exp_f32 v122, v122
  v_mfma_f32_16x16x32_bf16 v[228:231], a[4:7], v[44:47], v[228:231]
  buffer_load_dwordx4 v2, s[8:11], s70 offen offset:1024 sc1 lds
  ds_read_b128 a[48:51], v4 offset:4096
  v_mfma_f32_16x16x32_bf16 a[204:207], a[208:211], v[44:47], a[204:207]
  v_cndmask_b32 v123, v123, v5, s[54:55]
  v_exp_f32 v123, v123
  v_mfma_f32_16x16x32_bf16 v[200:203], a[8:11], v[40:43], v[200:203]
  ds_read_b128 a[52:55], v4 offset:5120
  v_cndmask_b32 v124, v124, v5, s[56:57]
  v_mfma_f32_16x16x32_bf16 v[232:235], a[8:11], v[44:47], v[232:235]
  v_exp_f32 v124, v124
  v_mfma_f32_16x16x32_bf16 v[204:207], a[12:15], v[40:43], v[204:207]
  buffer_load_dwordx4 v2, s[8:11], s70 offen offset:2048 sc1 lds
  ds_read_b128 a[56:59], v4 offset:6144
  v_mfma_f32_16x16x32_bf16 v[236:239], a[12:15], v[44:47], v[236:239]
  v_cndmask_b32 v125, v125, v5, s[58:59]
  v_exp_f32 v125, v125
  v_mfma_f32_16x16x32_bf16 v[208:211], a[16:19], v[40:43], v[208:211]
  ds_read_b128 a[60:63], v4 offset:7168
  v_cndmask_b32 v126, v126, v5, s[60:61]
  v_mfma_f32_16x16x32_bf16 v[240:243], a[16:19], v[44:47], v[240:243]
  v_exp_f32 v126, v126
  v_mfma_f32_16x16x32_bf16 v[212:215], a[20:23], v[40:43], v[212:215]
  buffer_load_dwordx4 v2, s[8:11], s70 offen offset:3072 sc1 lds
  ds_read_b128 a[0:3], v4 offset:8192
  v_mfma_f32_16x16x32_bf16 v[244:247], a[20:23], v[44:47], v[244:247]
  s_add_u32 s70, s70, 16384
  v_cndmask_b32 v127, v127, v5, s[62:63]
  v_exp_f32 v127, v127
  v_mfma_f32_16x16x32_bf16 v[216:219], a[24:27], v[40:43], v[216:219]
  ds_read_b128 a[4:7], v4 offset:9216
  v_cvt_pk_bf16_f32 v60, v120, v121
  v_mfma_f32_16x16x32_bf16 v[248:251], a[24:27], v[44:47], v[248:251]
  v_cvt_pk_bf16_f32 v61, v122, v123
  v_cvt_pk_bf16_f32 v62, v124, v125
  v_mfma_f32_16x16x32_bf16 v[220:223], a[28:31], v[40:43], v[220:223]
  ds_read_b128 a[8:11], v4 offset:10240
  v_cvt_pk_bf16_f32 v63, v126, v127
  v_mfma_f32_16x16x32_bf16 v[252:255], a[28:31], v[44:47], v[252:255]
  s_waitcnt lgkmcnt(7)
  v_mfma_f32_16x16x32_bf16 v[224:227], a[32:35], v[52:55], v[224:227]
  s_add_u32 m0, s79, 49152
  ds_read_b128 a[12:15], v4 offset:11264
  v_mfma_f32_16x16x32_bf16 a[204:207], a[208:211], v[52:55], a[204:207]
  buffer_load_dwordx4 v10, s[12:15], s71 offen offset:0 lds
  v_mfma_f32_16x16x32_bf16 v[228:231], a[36:39], v[52:55], v[228:231]
  buffer_load_dwordx4 v11, s[12:15], s71 offen offset:1024 lds
  ds_read_b128 a[16:19], v4 offset:12288
  v_mfma_f32_16x16x32_bf16 v[232:235], a[40:43], v[52:55], v[232:235]
  ds_read_b128 a[20:23], v4 offset:13312
  v_mfma_f32_16x16x32_bf16 v[236:239], a[44:47], v[52:55], v[236:239]
  s_waitcnt lgkmcnt(6)
  buffer_load_dwordx4 v12, s[12:15], s71 offen offset:2048 lds
  ds_read_b128 a[24:27], v4 offset:14336
  v_mfma_f32_16x16x32_bf16 v[240:243], a[48:51], v[52:55], v[240:243]
  ds_read_b128 a[28:31], v4 offset:15360
  v_mfma_f32_16x16x32_bf16 v[244:247], a[52:55], v[52:55], v[244:247]
  buffer_load_dwordx4 v13, s[12:15], s71 offen offset:3072 lds
  v_mfma_f32_16x16x32_bf16 v[248:251], a[56:59], v[52:55], v[248:251]
  s_add_u32 s71, s71, 131072
  s_add_u32 m0, s79, 32768
  v_mfma_f32_16x16x32_bf16 v[252:255], a[60:63], v[52:55], v[252:255]
  s_waitcnt lgkmcnt(4)
  buffer_load_dwordx4 v2, s[8:11], s70 offen offset:0 sc1 lds
  v_mfma_f32_16x16x32_bf16 v[224:227], a[0:3], v[60:63], v[224:227]
  v_mfma_f32_16x16x32_bf16 a[204:207], a[208:211], v[60:63], a[204:207]
  buffer_load_dwordx4 v2, s[8:11], s70 offen offset:1024 sc1 lds
  v_mfma_f32_16x16x32_bf16 v[228:231], a[4:7], v[60:63], v[228:231]
  v_mfma_f32_16x16x32_bf16 v[232:235], a[8:11], v[60:63], v[232:235]
  buffer_load_dwordx4 v2, s[8:11], s70 offen offset:2048 sc1 lds
  v_mfma_f32_16x16x32_bf16 v[236:239], a[12:15], v[60:63], v[236:239]
  s_waitcnt lgkmcnt(0)
  v_mfma_f32_16x16x32_bf16 v[240:243], a[16:19], v[60:63], v[240:243]
  buffer_load_dwordx4 v2, s[8:11], s70 offen offset:3072 sc1 lds
  v_mfma_f32_16x16x32_bf16 v[244:247], a[20:23], v[60:63], v[244:247]
  s_add_u32 s70, s70, 16384
  v_mfma_f32_16x16x32_bf16 v[248:251], a[24:27], v[60:63], v[248:251]
  v_mfma_f32_16x16x32_bf16 v[252:255], a[28:31], v[60:63], v[252:255]
  s_sub_u32 s88, 15, s25
  s_lshl_b32 s4, s88, 20
  s_lshl_b32 s5, s24, 15
  s_add_u32 s4, s4, s5
  s_lshl_b32 s5, s3, 11
  s_add_u32 s4, s4, s5
  v_accvgpr_read_b32 v6, a200
  v_accvgpr_read_b32 v8, a204
  s_mov_b32 s5, 0x5f800000
  v_cmp_ngt_f32 vcc, s5, v6
  v_rcp_f32 v6, v6
  s_or_b32 s89, s89, vcc_lo
  s_or_b32 s89, s89, vcc_hi
  v_mov_b32 v7, v6
  v_cmp_ngt_f32 vcc, s5, v8
  v_rcp_f32 v8, v8
  s_or_b32 s89, s89, vcc_lo
  s_or_b32 s89, s89, vcc_hi
  v_mov_b32 v9, v8
  v_pk_mul_f32 v[192:193], v[192:193], v[6:7]
  v_pk_mul_f32 v[194:195], v[194:195], v[6:7]
  v_pk_mul_f32 v[196:197], v[196:197], v[6:7]
  v_pk_mul_f32 v[198:199], v[198:199], v[6:7]
  v_cvt_pk_bf16_f32 v192, v192, v193
  v_cvt_pk_bf16_f32 v193, v194, v195
  v_cvt_pk_bf16_f32 v194, v196, v197
  v_cvt_pk_bf16_f32 v195, v198, v199
  buffer_store_dwordx4 v[192:195], v2, s[16:19], s4 offen offset:0 sc1
  v_pk_mul_f32 v[224:225], v[224:225], v[8:9]
  v_pk_mul_f32 v[226:227], v[226:227], v[8:9]
  v_pk_mul_f32 v[228:229], v[228:229], v[8:9]
  v_pk_mul_f32 v[230:231], v[230:231], v[8:9]
  v_cvt_pk_bf16_f32 v224, v224, v225
  v_cvt_pk_bf16_f32 v225, v226, v227
  v_cvt_pk_bf16_f32 v226, v228, v229
  v_cvt_pk_bf16_f32 v227, v230, v231
  buffer_store_dwordx4 v[224:227], v2, s[16:19], s4 offen offset:1024 sc1
  s_add_u32 s4, s4, 8192
  v_pk_mul_f32 v[200:201], v[200:201], v[6:7]
  v_pk_mul_f32 v[202:203], v[202:203], v[6:7]
  v_pk_mul_f32 v[204:205], v[204:205], v[6:7]
  v_pk_mul_f32 v[206:207], v[206:207], v[6:7]
  v_cvt_pk_bf16_f32 v200, v200, v201
  v_cvt_pk_bf16_f32 v201, v202, v203
  v_cvt_pk_bf16_f32 v202, v204, v205
  v_cvt_pk_bf16_f32 v203, v206, v207
  buffer_store_dwordx4 v[200:203], v2, s[16:19], s4 offen offset:0 sc1
  v_pk_mul_f32 v[232:233], v[232:233], v[8:9]
  v_pk_mul_f32 v[234:235], v[234:235], v[8:9]
  v_pk_mul_f32 v[236:237], v[236:237], v[8:9]
  v_pk_mul_f32 v[238:239], v[238:239], v[8:9]
  v_cvt_pk_bf16_f32 v232, v232, v233
  v_cvt_pk_bf16_f32 v233, v234, v235
  v_cvt_pk_bf16_f32 v234, v236, v237
  v_cvt_pk_bf16_f32 v235, v238, v239
  buffer_store_dwordx4 v[232:235], v2, s[16:19], s4 offen offset:1024 sc1
  s_add_u32 s4, s4, 8192
  v_pk_mul_f32 v[208:209], v[208:209], v[6:7]
  v_pk_mul_f32 v[210:211], v[210:211], v[6:7]
  v_pk_mul_f32 v[212:213], v[212:213], v[6:7]
  v_pk_mul_f32 v[214:215], v[214:215], v[6:7]
  v_cvt_pk_bf16_f32 v208, v208, v209
  v_cvt_pk_bf16_f32 v209, v210, v211
  v_cvt_pk_bf16_f32 v210, v212, v213
  v_cvt_pk_bf16_f32 v211, v214, v215
  buffer_store_dwordx4 v[208:211], v2, s[16:19], s4 offen offset:0 sc1
  v_pk_mul_f32 v[240:241], v[240:241], v[8:9]
  v_pk_mul_f32 v[242:243], v[242:243], v[8:9]
  v_pk_mul_f32 v[244:245], v[244:245], v[8:9]
  v_pk_mul_f32 v[246:247], v[246:247], v[8:9]
  v_cvt_pk_bf16_f32 v240, v240, v241
  v_cvt_pk_bf16_f32 v241, v242, v243
  v_cvt_pk_bf16_f32 v242, v244, v245
  v_cvt_pk_bf16_f32 v243, v246, v247
  buffer_store_dwordx4 v[240:243], v2, s[16:19], s4 offen offset:1024 sc1
  s_add_u32 s4, s4, 8192
  v_pk_mul_f32 v[216:217], v[216:217], v[6:7]
  v_pk_mul_f32 v[218:219], v[218:219], v[6:7]
  v_pk_mul_f32 v[220:221], v[220:221], v[6:7]
  v_pk_mul_f32 v[222:223], v[222:223], v[6:7]
  v_cvt_pk_bf16_f32 v216, v216, v217
  v_cvt_pk_bf16_f32 v217, v218, v219
  v_cvt_pk_bf16_f32 v218, v220, v221
  v_cvt_pk_bf16_f32 v219, v222, v223
  buffer_store_dwordx4 v[216:219], v2, s[16:19], s4 offen offset:0 sc1
  v_pk_mul_f32 v[248:249], v[248:249], v[8:9]
  v_pk_mul_f32 v[250:251], v[250:251], v[8:9]
  v_pk_mul_f32 v[252:253], v[252:253], v[8:9]
  v_pk_mul_f32 v[254:255], v[254:255], v[8:9]
  v_cvt_pk_bf16_f32 v248, v248, v249
  v_cvt_pk_bf16_f32 v249, v250, v251
  v_cvt_pk_bf16_f32 v250, v252, v253
  v_cvt_pk_bf16_f32 v251, v254, v255
  buffer_store_dwordx4 v[248:251], v2, s[16:19], s4 offen offset:1024 sc1
  s_cmp_eq_u32 s89, 0
  s_cbranch_scc1 La_done
  s_waitcnt vmcnt(0)
  s_sub_u32 s6, 15, s25
La_sl_blk:
  v_mov_b32 v192, 0
  v_mov_b32 v193, 0
  v_mov_b32 v194, 0
  v_mov_b32 v195, 0
  v_mov_b32 v196, 0
  v_mov_b32 v197, 0
  v_mov_b32 v198, 0
  v_mov_b32 v199, 0
  v_mov_b32 v200, 0
  v_mov_b32 v201, 0
  v_mov_b32 v202, 0
  v_mov_b32 v203, 0
  v_mov_b32 v204, 0
  v_mov_b32 v205, 0
  v_mov_b32 v206, 0
  v_mov_b32 v207, 0
  v_mov_b32 v208, 0
  v_mov_b32 v209, 0
  v_mov_b32 v210, 0
  v_mov_b32 v211, 0
  v_mov_b32 v212, 0
  v_mov_b32 v213, 0
  v_mov_b32 v214, 0
  v_mov_b32 v215, 0
  v_mov_b32 v216, 0
  v_mov_b32 v217, 0
  v_mov_b32 v218, 0
  v_mov_b32 v219, 0
  v_mov_b32 v220, 0
  v_mov_b32 v221, 0
  v_mov_b32 v222, 0
  v_mov_b32 v223, 0
  v_mov_b32 v224, 0
  v_mov_b32 v225, 0
  v_mov_b32 v226, 0
  v_mov_b32 v227, 0
  v_mov_b32 v228, 0
  v_mov_b32 v229, 0
  v_mov_b32 v230, 0
  v_mov_b32 v231, 0
  v_mov_b32 v232, 0
  v_mov_b32 v233, 0
  v_mov_b32 v234, 0
  v_mov_b32 v235, 0
  v_mov_b32 v236, 0
  v_mov_b32 v237, 0
  v_mov_b32 v238, 0
  v_mov_b32 v239, 0
  v_mov_b32 v240, 0
  v_mov_b32 v241, 0
  v_mov_b32 v242, 0
  v_mov_b32 v243, 0
  v_mov_b32 v244, 0
  v_mov_b32 v245, 0
  v_mov_b32 v246, 0
  v_mov_b32 v247, 0
  v_mov_b32 v248, 0
  v_mov_b32 v249, 0
  v_mov_b32 v250, 0
  v_mov_b32 v251, 0
  v_mov_b32 v252, 0
  v_mov_b32 v253, 0
  v_mov_b32 v254, 0
  v_mov_b32 v255, 0
  v_mov_b32 v24, 0
  v_mov_b32 v25, 0
  v_mov_b32 v26, 0
  v_mov_b32 v27, 0
  v_mov_b32 v28, 0
  v_mov_b32 v29, 0
  v_mov_b32 v30, 0
  v_mov_b32 v31, 0
  v_mov_b32 v16, v5
  v_mov_b32 v17, v5
  v_and_b32 v20, 15, v1
  v_lshrrev_b32 v21, 4, v1
  v_sub_u32 v20, v20, v21
  v_lshlrev_b32 v20, 2, v20
  s_lshl_b32 s4, s6, 7
  s_add_u32 s4, s4, s3
  v_add_u32 v20, s4, v20
  v_add_u32 v21, 64, v20
  s_add_u32 s7, s6, 1
  s_lshl_b32 s7, s7, 2
  s_mov_b32 s90, 0
La_sl_loop:
  s_add_u32 s4, s90, 0
  buffer_load_dwordx4 a[0:3], v2, s[20:23], s4 offen offset:0 sc1
  buffer_load_dwordx4 a[4:7], v2, s[20:23], s4 offen offset:1024 sc1
  buffer_load_dwordx4 a[8:11], v2, s[20:23], s4 offen offset:2048 sc1
  buffer_load_dwordx4 a[12:15], v2, s[20:23], s4 offen offset:3072 sc1
  s_add_u32 s4, s90, 4096
  buffer_load_dwordx4 a[16:19], v2, s[20:23], s4 offen offset:0 sc1
  buffer_load_dwordx4 a[20:23], v2, s[20:23], s4 offen offset:1024 sc1
  buffer_load_dwordx4 a[24:27], v2, s[20:23], s4 offen offset:2048 sc1
  buffer_load_dwordx4 a[28:31], v2, s[20:23], s4 offen offset:3072 sc1
  s_add_u32 s4, s90, 16384
  buffer_load_dwordx4 a[32:35], v2, s[20:23], s4 offen offset:0 sc1
  buffer_load_dwordx4 a[36:39], v2, s[20:23], s4 offen offset:1024 sc1
  buffer_load_dwordx4 a[40:43], v2, s[20:23], s4 offen offset:2048 sc1
  buffer_load_dwordx4 a[44:47], v2, s[20:23], s4 offen offset:3072 sc1
  s_add_u32 s4, s90, 20480
  buffer_load_dwordx4 a[48:51], v2, s[20:23], s4 offen offset:0 sc1
  buffer_load_dwordx4 a[52:55], v2, s[20:23], s4 offen offset:1024 sc1
  buffer_load_dwordx4 a[56:59], v2, s[20:23], s4 offen offset:2048 sc1
  buffer_load_dwordx4 a[60:63], v2, s[20:23], s4 offen offset:3072 sc1
  s_waitcnt vmcnt(0)
  v_mfma_f32_16x16x32_bf16 v[64:67], a[0:3], a[160:163], 0
  v_mfma_f32_16x16x32_bf16 v[72:75], a[0:3], a[176:179], 0
  v_mfma_f32_16x16x32_bf16 v[64:67], a[4:7], a[164:167], v[64:67]
  v_mfma_f32_16x16x32_bf16 v[72:75], a[4:7], a[180:183], v[72:75]
  v_mfma_f32_16x16x32_bf16 v[64:67], a[8:11], a[168:171], v[64:67]
  v_mfma_f32_16x16x32_bf16 v[72:75], a[8:11], a[184:187], v[72:75]
  v_mfma_f32_16x16x32_bf16 v[64:67], a[12:15], a[172:175], v[64:67]
  v_mfma_f32_16x16x32_bf16 v[72:75], a[12:15], a[188:191], v[72:75]
  v_mfma_f32_16x16x32_bf16 v[68:71], a[16:19], a[160:163], 0
  v_mfma_f32_16x16x32_bf16 v[76:79], a[16:19], a[176:179], 0
  v_mfma_f32_16x16x32_bf16 v[68:71], a[20:23], a[164:167], v[68:71]
  v_mfma_f32_16x16x32_bf16 v[76:79], a[20:23], a[180:183], v[76:79]
  v_mfma_f32_16x16x32_bf16 v[68:71], a[24:27], a[168:171], v[68:71]
  v_mfma_f32_16x16x32_bf16 v[76:79], a[24:27], a[184:187], v[76:79]
  v_mfma_f32_16x16x32_bf16 v[68:71], a[28:31], a[172:175], v[68:71]
  v_mfma_f32_16x16x32_bf16 v[76:79], a[28:31], a[188:191], v[76:79]
  v_cmp_gt_i32 vcc, 0, v20
  s_nop 1
  v_cndmask_b32 v64, v64, v5, vcc
  v_cmp_gt_i32 vcc, 1, v20
  s_nop 1
  v_cndmask_b32 v65, v65, v5, vcc
  v_cmp_gt_i32 vcc, 2, v20
  s_nop 1
  v_cndmask_b32 v66, v66, v5, vcc
  v_cmp_gt_i32 vcc, 3, v20
  s_nop 1
  v_cndmask_b32 v67, v67, v5, vcc
  v_cmp_gt_i32 vcc, 16, v20
  s_nop 1
  v_cndmask_b32 v68, v68, v5, vcc
  v_cmp_gt_i32 vcc, 17, v20
  s_nop 1
  v_cndmask_b32 v69, v69, v5, vcc
  v_cmp_gt_i32 vcc, 18, v20
  s_nop 1
  v_cndmask_b32 v70, v70, v5, vcc
  v_cmp_gt_i32 vcc, 19, v20
  s_nop 1
  v_cndmask_b32 v71, v71, v5, vcc
  v_subrev_u32 v20, 32, v20
  v_max3_f32 v6, v64, v65, v66
  v_max3_f32 v7, v67, v68, v69
  v_max3_f32 v6, v6, v70, v71
  v_max_f32 v6, v6, v7
  v_cmp_gt_i32 vcc, 0, v21
  s_nop 1
  v_cndmask_b32 v72, v72, v5, vcc
  v_cmp_gt_i32 vcc, 1, v21
  s_nop 1
  v_cndmask_b32 v73, v73, v5, vcc
  v_cmp_gt_i32 vcc, 2, v21
  s_nop 1
  v_cndmask_b32 v74, v74, v5, vcc
  v_cmp_gt_i32 vcc, 3, v21
  s_nop 1
  v_cndmask_b32 v75, v75, v5, vcc
  v_cmp_gt_i32 vcc, 16, v21
  s_nop 1
  v_cndmask_b32 v76, v76, v5, vcc
  v_cmp_gt_i32 vcc, 17, v21
  s_nop 1
  v_cndmask_b32 v77, v77, v5, vcc
  v_cmp_gt_i32 vcc, 18, v21
  s_nop 1
  v_cndmask_b32 v78, v78, v5, vcc
  v_cmp_gt_i32 vcc, 19, v21
  s_nop 1
  v_cndmask_b32 v79, v79, v5, vcc
  v_subrev_u32 v21, 32, v21
  v_max3_f32 v8, v72, v73, v74
  v_max3_f32 v9, v75, v76, v77
  v_max3_f32 v8, v8, v78, v79
  v_max_f32 v8, v8, v9
  v_mov_b32 v7, v6
  v_mov_b32 v9, v8
  s_nop 0
  v_permlane32_swap_b32 v6, v7
  v_permlane32_swap_b32 v8, v9
  v_max_f32 v6, v6, v7
  v_max_f32 v8, v8, v9
  v_mov_b32 v7, v6
  v_mov_b32 v9, v8
  s_nop 0
  v_permlane16_swap_b32 v6, v7
  v_permlane16_swap_b32 v8, v9
  v_max_f32 v6, v6, v7
  v_max_f32 v8, v8, v9
  v_max_f32 v6, v6, v16
  v_sub_f32 v7, v16, v6
  v_exp_f32 v7, v7
  v_mov_b32 v16, v6
  v_sub_f32 v64, v64, v16
  v_sub_f32 v65, v65, v16
  v_sub_f32 v66, v66, v16
  v_sub_f32 v67, v67, v16
  v_sub_f32 v68, v68, v16
  v_sub_f32 v69, v69, v16
  v_sub_f32 v70, v70, v16
  v_sub_f32 v71, v71, v16
  v_exp_f32 v64, v64
  v_exp_f32 v65, v65
  v_exp_f32 v66, v66
  v_exp_f32 v67, v67
  v_exp_f32 v68, v68
  v_exp_f32 v69, v69
  v_exp_f32 v70, v70
  v_exp_f32 v71, v71
  v_mul_f32 v24, v24, v7
  v_mul_f32 v25, v25, v7
  v_mul_f32 v26, v26, v7
  v_mul_f32 v27, v27, v7
  v_mul_f32 v192, v192, v7
  v_mul_f32 v193, v193, v7
  v_mul_f32 v194, v194, v7
  v_mul_f32 v195, v195, v7
  v_mul_f32 v196, v196, v7
  v_mul_f32 v197, v197, v7
  v_mul_f32 v198, v198, v7
  v_mul_f32 v199, v199, v7
  v_mul_f32 v200, v200, v7
  v_mul_f32 v201, v201, v7
  v_mul_f32 v202, v202, v7
  v_mul_f32 v203, v203, v7
  v_mul_f32 v204, v204, v7
  v_mul_f32 v205, v205, v7
  v_mul_f32 v206, v206, v7
  v_mul_f32 v207, v207, v7
  v_mul_f32 v208, v208, v7
  v_mul_f32 v209, v209, v7
  v_mul_f32 v210, v210, v7
  v_mul_f32 v211, v211, v7
  v_mul_f32 v212, v212, v7
  v_mul_f32 v213, v213, v7
  v_mul_f32 v214, v214, v7
  v_mul_f32 v215, v215, v7
  v_mul_f32 v216, v216, v7
  v_mul_f32 v217, v217, v7
  v_mul_f32 v218, v218, v7
  v_mul_f32 v219, v219, v7
  v_mul_f32 v220, v220, v7
  v_mul_f32 v221, v221, v7
  v_mul_f32 v222, v222, v7
  v_mul_f32 v223, v223, v7
  v_cvt_pk_bf16_f32 v32, v64, v65
  v_cvt_pk_bf16_f32 v33, v66, v67
  v_cvt_pk_bf16_f32 v34, v68, v69
  v_cvt_pk_bf16_f32 v35, v70, v71
  v_max_f32 v8, v8, v17
  v_sub_f32 v9, v17, v8
  v_exp_f32 v9, v9
  v_mov_b32 v17, v8
  v_sub_f32 v72, v72, v17
  v_sub_f32 v73, v73, v17
  v_sub_f32 v74, v74, v17
  v_sub_f32 v75, v75, v17
  v_sub_f32 v76, v76, v17
  v_sub_f32 v77, v77, v17
  v_sub_f32 v78, v78, v17
  v_sub_f32 v79, v79, v17
  v_exp_f32 v72, v72
  v_exp_f32 v73, v73
  v_exp_f32 v74, v74
  v_exp_f32 v75, v75
  v_exp_f32 v76, v76
  v_exp_f32 v77, v77
  v_exp_f32 v78, v78
  v_exp_f32 v79, v79
  v_mul_f32 v28, v28, v9
  v_mul_f32 v29, v29, v9
  v_mul_f32 v30, v30, v9
  v_mul_f32 v31, v31, v9
  v_mul_f32 v224, v224, v9
  v_mul_f32 v225, v225, v9
  v_mul_f32 v226, v226, v9
  v_mul_f32 v227, v227, v9
  v_mul_f32 v228, v228, v9
  v_mul_f32 v229, v229, v9
  v_mul_f32 v230, v230, v9
  v_mul_f32 v231, v231, v9
  v_mul_f32 v232, v232, v9
  v_mul_f32 v233, v233, v9
  v_mul_f32 v234, v234, v9
  v_mul_f32 v235, v235, v9
  v_mul_f32 v236, v236, v9
  v_mul_f32 v237, v237, v9
  v_mul_f32 v238, v238, v9
  v_mul_f32 v239, v239, v9
  v_mul_f32 v240, v240, v9
  v_mul_f32 v241, v241, v9
  v_mul_f32 v242, v242, v9
  v_mul_f32 v243, v243, v9
  v_mul_f32 v244, v244, v9
  v_mul_f32 v245, v245, v9
  v_mul_f32 v246, v246, v9
  v_mul_f32 v247, v247, v9
  v_mul_f32 v248, v248, v9
  v_mul_f32 v249, v249, v9
  v_mul_f32 v250, v250, v9
  v_mul_f32 v251, v251, v9
  v_mul_f32 v252, v252, v9
  v_mul_f32 v253, v253, v9
  v_mul_f32 v254, v254, v9
  v_mul_f32 v255, v255, v9
  v_cvt_pk_bf16_f32 v36, v72, v73
  v_cvt_pk_bf16_f32 v37, v74, v75
  v_cvt_pk_bf16_f32 v38, v76, v77
  v_cvt_pk_bf16_f32 v39, v78, v79
  v_mfma_f32_16x16x32_bf16 v[24:27], a[208:211], v[32:35], v[24:27]
  v_mfma_f32_16x16x32_bf16 v[192:195], a[32:35], v[32:35], v[192:195]
  v_mfma_f32_16x16x32_bf16 v[196:199], a[36:39], v[32:35], v[196:199]
  v_mfma_f32_16x16x32_bf16 v[200:203], a[40:43], v[32:35], v[200:203]
  v_mfma_f32_16x16x32_bf16 v[204:207], a[44:47], v[32:35], v[204:207]
  v_mfma_f32_16x16x32_bf16 v[208:211], a[48:51], v[32:35], v[208:211]
  v_mfma_f32_16x16x32_bf16 v[212:215], a[52:55], v[32:35], v[212:215]
  v_mfma_f32_16x16x32_bf16 v[216:219], a[56:59], v[32:35], v[216:219]
  v_mfma_f32_16x16x32_bf16 v[220:223], a[60:63], v[32:35], v[220:223]
  v_mfma_f32_16x16x32_bf16 v[28:31], a[208:211], v[36:39], v[28:31]
  v_mfma_f32_16x16x32_bf16 v[224:227], a[32:35], v[36:39], v[224:227]
  v_mfma_f32_16x16x32_bf16 v[228:231], a[36:39], v[36:39], v[228:231]
  v_mfma_f32_16x16x32_bf16 v[232:235], a[40:43], v[36:39], v[232:235]
  v_mfma_f32_16x16x32_bf16 v[236:239], a[44:47], v[36:39], v[236:239]
  v_mfma_f32_16x16x32_bf16 v[240:243], a[48:51], v[36:39], v[240:243]
  v_mfma_f32_16x16x32_bf16 v[244:247], a[52:55], v[36:39], v[244:247]
  v_mfma_f32_16x16x32_bf16 v[248:251], a[56:59], v[36:39], v[248:251]
  v_mfma_f32_16x16x32_bf16 v[252:255], a[60:63], v[36:39], v[252:255]
  s_add_u32 s90, s90, 8192
  s_and_b32 s4, s90, 0x4000
  s_add_u32 s90, s90, s4
  s_sub_u32 s7, s7, 1
  s_cmp_lg_u32 s7, 0
  s_cbranch_scc1 La_sl_loop
  s_lshl_b32 s4, s6, 20
  s_lshl_b32 s5, s24, 15
  s_add_u32 s4, s4, s5
  s_lshl_b32 s5, s3, 11
  s_add_u32 s4, s4, s5
  v_rcp_f32 v6, v24
  s_nop 0
  v_mov_b32 v7, v6
  v_rcp_f32 v8, v28
  s_nop 0
  v_mov_b32 v9, v8
  v_pk_mul_f32 v[192:193], v[192:193], v[6:7]
  v_pk_mul_f32 v[194:195], v[194:195], v[6:7]
  v_pk_mul_f32 v[196:197], v[196:197], v[6:7]
  v_pk_mul_f32 v[198:199], v[198:199], v[6:7]
  v_cvt_pk_bf16_f32 v192, v192, v193
  v_cvt_pk_bf16_f32 v193, v194, v195
  v_cvt_pk_bf16_f32 v194, v196, v197
  v_cvt_pk_bf16_f32 v195, v198, v199
  buffer_store_dwordx4 v[192:195], v2, s[16:19], s4 offen offset:0 sc1
  v_pk_mul_f32 v[224:225], v[224:225], v[8:9]
  v_pk_mul_f32 v[226:227], v[226:227], v[8:9]
  v_pk_mul_f32 v[228:229], v[228:229], v[8:9]
  v_pk_mul_f32 v[230:231], v[230:231], v[8:9]
  v_cvt_pk_bf16_f32 v224, v224, v225
  v_cvt_pk_bf16_f32 v225, v226, v227
  v_cvt_pk_bf16_f32 v226, v228, v229
  v_cvt_pk_bf16_f32 v227, v230, v231
  buffer_store_dwordx4 v[224:227], v2, s[16:19], s4 offen offset:1024 sc1
  s_add_u32 s4, s4, 8192
  v_pk_mul_f32 v[200:201], v[200:201], v[6:7]
  v_pk_mul_f32 v[202:203], v[202:203], v[6:7]
  v_pk_mul_f32 v[204:205], v[204:205], v[6:7]
  v_pk_mul_f32 v[206:207], v[206:207], v[6:7]
  v_cvt_pk_bf16_f32 v200, v200, v201
  v_cvt_pk_bf16_f32 v201, v202, v203
  v_cvt_pk_bf16_f32 v202, v204, v205
  v_cvt_pk_bf16_f32 v203, v206, v207
  buffer_store_dwordx4 v[200:203], v2, s[16:19], s4 offen offset:0 sc1
  v_pk_mul_f32 v[232:233], v[232:233], v[8:9]
  v_pk_mul_f32 v[234:235], v[234:235], v[8:9]
  v_pk_mul_f32 v[236:237], v[236:237], v[8:9]
  v_pk_mul_f32 v[238:239], v[238:239], v[8:9]
  v_cvt_pk_bf16_f32 v232, v232, v233
  v_cvt_pk_bf16_f32 v233, v234, v235
  v_cvt_pk_bf16_f32 v234, v236, v237
  v_cvt_pk_bf16_f32 v235, v238, v239
  buffer_store_dwordx4 v[232:235], v2, s[16:19], s4 offen offset:1024 sc1
  s_add_u32 s4, s4, 8192
  v_pk_mul_f32 v[208:209], v[208:209], v[6:7]
  v_pk_mul_f32 v[210:211], v[210:211], v[6:7]
  v_pk_mul_f32 v[212:213], v[212:213], v[6:7]
  v_pk_mul_f32 v[214:215], v[214:215], v[6:7]
  v_cvt_pk_bf16_f32 v208, v208, v209
  v_cvt_pk_bf16_f32 v209, v210, v211
  v_cvt_pk_bf16_f32 v210, v212, v213
  v_cvt_pk_bf16_f32 v211, v214, v215
  buffer_store_dwordx4 v[208:211], v2, s[16:19], s4 offen offset:0 sc1
  v_pk_mul_f32 v[240:241], v[240:241], v[8:9]
  v_pk_mul_f32 v[242:243], v[242:243], v[8:9]
  v_pk_mul_f32 v[244:245], v[244:245], v[8:9]
  v_pk_mul_f32 v[246:247], v[246:247], v[8:9]
  v_cvt_pk_bf16_f32 v240, v240, v241
  v_cvt_pk_bf16_f32 v241, v242, v243
  v_cvt_pk_bf16_f32 v242, v244, v245
  v_cvt_pk_bf16_f32 v243, v246, v247
  buffer_store_dwordx4 v[240:243], v2, s[16:19], s4 offen offset:1024 sc1
  s_add_u32 s4, s4, 8192
  v_pk_mul_f32 v[216:217], v[216:217], v[6:7]
  v_pk_mul_f32 v[218:219], v[218:219], v[6:7]
  v_pk_mul_f32 v[220:221], v[220:221], v[6:7]
  v_pk_mul_f32 v[222:223], v[222:223], v[6:7]
  v_cvt_pk_bf16_f32 v216, v216, v217
  v_cvt_pk_bf16_f32 v217, v218, v219
  v_cvt_pk_bf16_f32 v218, v220, v221
  v_cvt_pk_bf16_f32 v219, v222, v223
  buffer_store_dwordx4 v[216:219], v2, s[16:19], s4 offen offset:0 sc1
  v_pk_mul_f32 v[248:249], v[248:249], v[8:9]
  v_pk_mul_f32 v[250:251], v[250:251], v[8:9]
  v_pk_mul_f32 v[252:253], v[252:253], v[8:9]
  v_pk_mul_f32 v[254:255], v[254:255], v[8:9]
  v_cvt_pk_bf16_f32 v248, v248, v249
  v_cvt_pk_bf16_f32 v249, v250, v251
  v_cvt_pk_bf16_f32 v250, v252, v253
  v_cvt_pk_bf16_f32 v251, v254, v255
  buffer_store_dwordx4 v[248:251], v2, s[16:19], s4 offen offset:1024 sc1
  s_cmp_eq_u32 s6, s25
  s_cbranch_scc1 La_done
  v_accvgpr_read_b32 v64, a128
  v_accvgpr_read_b32 v65, a129
  v_accvgpr_read_b32 v66, a130
  v_accvgpr_read_b32 v67, a131
  v_accvgpr_read_b32 v68, a132
  v_accvgpr_read_b32 v69, a133
  v_accvgpr_read_b32 v70, a134
  v_accvgpr_read_b32 v71, a135
  v_accvgpr_read_b32 v72, a136
  v_accvgpr_read_b32 v73, a137
  v_accvgpr_read_b32 v74, a138
  v_accvgpr_read_b32 v75, a139
  v_accvgpr_read_b32 v76, a140
  v_accvgpr_read_b32 v77, a141
  v_accvgpr_read_b32 v78, a142
  v_accvgpr_read_b32 v79, a143
  v_accvgpr_read_b32 v80, a144
  v_accvgpr_read_b32 v81, a145
  v_accvgpr_read_b32 v82, a146
  v_accvgpr_read_b32 v83, a147
  v_accvgpr_read_b32 v84, a148
  v_accvgpr_read_b32 v85, a149
  v_accvgpr_read_b32 v86, a150
  v_accvgpr_read_b32 v87, a151
  v_accvgpr_read_b32 v88, a152
  v_accvgpr_read_b32 v89, a153
  v_accvgpr_read_b32 v90, a154
  v_accvgpr_read_b32 v91, a155
  v_accvgpr_read_b32 v92, a156
  v_accvgpr_read_b32 v93, a157
  v_accvgpr_read_b32 v94, a158
  v_accvgpr_read_b32 v95, a159
  v_accvgpr_write_b32 a160, v64
  v_accvgpr_write_b32 a161, v65
  v_accvgpr_write_b32 a162, v66
  v_accvgpr_write_b32 a163, v67
  v_accvgpr_write_b32 a164, v68
  v_accvgpr_write_b32 a165, v69
  v_accvgpr_write_b32 a166, v70
  v_accvgpr_write_b32 a167, v71
  v_accvgpr_write_b32 a168, v72
  v_accvgpr_write_b32 a169, v73
  v_accvgpr_write_b32 a170, v74
  v_accvgpr_write_b32 a171, v75
  v_accvgpr_write_b32 a172, v76
  v_accvgpr_write_b32 a173, v77
  v_accvgpr_write_b32 a174, v78
  v_accvgpr_write_b32 a175, v79
  v_accvgpr_write_b32 a176, v80
  v_accvgpr_write_b32 a177, v81
  v_accvgpr_write_b32 a178, v82
  v_accvgpr_write_b32 a179, v83
  v_accvgpr_write_b32 a180, v84
  v_accvgpr_write_b32 a181, v85
  v_accvgpr_write_b32 a182, v86
  v_accvgpr_write_b32 a183, v87
  v_accvgpr_write_b32 a184, v88
  v_accvgpr_write_b32 a185, v89
  v_accvgpr_write_b32 a186, v90
  v_accvgpr_write_b32 a187, v91
  v_accvgpr_write_b32 a188, v92
  v_accvgpr_write_b32 a189, v93
  v_accvgpr_write_b32 a190, v94
  v_accvgpr_write_b32 a191, v95
  s_mov_b32 s6, s25
  s_branch La_sl_blk
La_done:
  s_lshr_b32 s4, s3, 1
  s_lshl_b32 s4, s4, 12
  s_add_u32 s4, s4, 131072
  s_lshl_b32 s5, s77, 11
  s_add_u32 s4, s4, s5
  v_add_u32 v16, s4, v2
  v_xor_b32 v17, 0x800, v16
  s_and_b32 s4, s3, 1
  s_lshl_b32 s4, s4, 13
  s_add_u32 s4, s4, 131072
  v_lshrrev_b32 v24, 2, v1
  v_and_b32 v25, 6, v24
  v_lshlrev_b32 v24, 7, v24
  v_and_b32 v26, 1, v1
  v_lshl_add_u32 v24, v26, 3, v24
  v_add_u32 v24, s4, v24
  v_bfe_u32 v26, v1, 1, 1
  v_xor_b32 v25, v25, v26
  v_xor_b32 v26, 0, v25
  v_lshl_add_u32 v18, v26, 4, v24
  v_xor_b32 v26, 2, v25
  v_lshl_add_u32 v19, v26, 4, v24
  v_xor_b32 v26, 4, v25
  v_lshl_add_u32 v20, v26, 4, v24
  v_xor_b32 v26, 6, v25
  v_lshl_add_u32 v21, v26, 4, v24
  s_mov_b32 s65, 0
  s_mov_b32 s67, 4294868992
  s_mov_b32 s68, 32768
  s_mov_b32 s65, 3
  s_waitcnt vmcnt(16)
  s_barrier
  ds_read_b128 a[64:67], v16 offset:0
  ds_read_b64_tr_b16 a[96:97], v18 offset:16384
  ds_read_b64_tr_b16 a[98:99], v18 offset:18432
  ds_read_b128 a[68:71], v16 offset:1024
  ds_read_b128 a[72:75], v17 offset:0
  ds_read_b128 a[76:79], v17 offset:1024
  ds_read_b64_tr_b16 a[100:101], v19 offset:16384
  ds_read_b64_tr_b16 a[102:103], v19 offset:18432
  ds_read_b64_tr_b16 a[104:105], v20 offset:16384
  ds_read_b64_tr_b16 a[106:107], v20 offset:18432
  ds_read_b64_tr_b16 a[108:109], v21 offset:16384
  ds_read_b64_tr_b16 a[110:111], v21 offset:18432
  s_waitcnt lgkmcnt(0)
  v_mfma_f32_16x16x32_bf16 v[32:35], a[96:99], a[64:67], 0
  s_add_u32 m0, s79, 81920
  ds_read_b128 a[80:83], v16 offset:8192
  ds_read_b64_tr_b16 a[112:113], v18 offset:20480
  v_mfma_f32_16x16x32_bf16 v[48:51], a[96:99], a[68:71], 0
  buffer_load_dwordx4 v10, s[12:15], s71 offen offset:0 lds
  ds_read_b64_tr_b16 a[114:115], v18 offset:22528
  v_mfma_f32_16x16x32_bf16 v[64:67], a[96:99], a[72:75], 0
  buffer_load_dwordx4 v11, s[12:15], s71 offen offset:1024 lds
  ds_read_b128 a[84:87], v16 offset:9216
  v_mfma_f32_16x16x32_bf16 v[80:83], a[96:99], a[76:79], 0
  buffer_load_dwordx4 v12, s[12:15], s71 offen offset:2048 lds
  ds_read_b128 a[88:91], v17 offset:8192
  v_mfma_f32_16x16x32_bf16 v[36:39], a[100:103], a[64:67], 0
  buffer_load_dwordx4 v13, s[12:15], s71 offen offset:3072 lds
  ds_read_b128 a[92:95], v17 offset:9216
  v_mfma_f32_16x16x32_bf16 v[52:55], a[100:103], a[68:71], 0
  s_add_u32 s71, s71, 131072
  s_add_u32 m0, s79, 65536
  ds_read_b64_tr_b16 a[116:117], v19 offset:20480
  v_mfma_f32_16x16x32_bf16 v[68:71], a[100:103], a[72:75], 0
  buffer_load_dwordx4 v2, s[8:11], s70 offen offset:0 sc1 lds
  ds_read_b64_tr_b16 a[118:119], v19 offset:22528
  v_mfma_f32_16x16x32_bf16 v[84:87], a[100:103], a[76:79], 0
  buffer_load_dwordx4 v2, s[8:11], s70 offen offset:1024 sc1 lds
  ds_read_b64_tr_b16 a[120:121], v20 offset:20480
  v_mfma_f32_16x16x32_bf16 v[40:43], a[104:107], a[64:67], 0
  buffer_load_dwordx4 v2, s[8:11], s70 offen offset:2048 sc1 lds
  ds_read_b64_tr_b16 a[122:123], v20 offset:22528
  v_mfma_f32_16x16x32_bf16 v[56:59], a[104:107], a[68:71], 0
  buffer_load_dwordx4 v2, s[8:11], s70 offen offset:3072 sc1 lds
  ds_read_b64_tr_b16 a[124:125], v21 offset:20480
  v_mfma_f32_16x16x32_bf16 v[72:75], a[104:107], a[72:75], 0
  s_add_u32 s70, s70, 16384
  s_add_u32 m0, s79, 114688
  ds_read_b64_tr_b16 a[126:127], v21 offset:22528
  v_mfma_f32_16x16x32_bf16 v[88:91], a[104:107], a[76:79], 0
  buffer_load_dwordx4 v10, s[12:15], s71 offen offset:0 lds
  v_mfma_f32_16x16x32_bf16 v[44:47], a[108:111], a[64:67], 0
  buffer_load_dwordx4 v11, s[12:15], s71 offen offset:1024 lds
  v_mfma_f32_16x16x32_bf16 v[60:63], a[108:111], a[68:71], 0
  buffer_load_dwordx4 v12, s[12:15], s71 offen offset:2048 lds
  v_mfma_f32_16x16x32_bf16 v[76:79], a[108:111], a[72:75], 0
  buffer_load_dwordx4 v13, s[12:15], s71 offen offset:3072 lds
  v_mfma_f32_16x16x32_bf16 v[92:95], a[108:111], a[76:79], 0
  s_add_u32 s71, s71, 131072
  s_add_u32 m0, s79, 98304
  s_nop 0
  buffer_load_dwordx4 v2, s[8:11], s70 offen offset:0 sc1 lds
  buffer_load_dwordx4 v2, s[8:11], s70 offen offset:1024 sc1 lds
  buffer_load_dwordx4 v2, s[8:11], s70 offen offset:2048 sc1 lds
  buffer_load_dwordx4 v2, s[8:11], s70 offen offset:3072 sc1 lds
  s_add_u32 s70, s70, 16384
  s_add_u32 s65, s65, 1
  s_cmp_eq_u32 s65, 4
  s_cselect_b32 s65, 0, s65
  s_cselect_b32 s66, s67, s68
  v_add_u32 v16, s66, v16
  v_add_u32 v17, s66, v17
  v_add_u32 v18, s66, v18
  v_add_u32 v19, s66, v19
  v_add_u32 v20, s66, v20
  v_add_u32 v21, s66, v21
  s_waitcnt vmcnt(16) lgkmcnt(0)
  s_barrier
  s_lshl_b32 s4, s24, 7
  s_lshl_b32 s5, s25, 12
  s_add_u32 s6, s4, 65536
  s_add_u32 s7, s6, 61440
  s_add_u32 s6, s6, s5
  s_sub_u32 s7, s7, s5
  v_mov_b32 v8, 0x40000000
  v_mov_b32 v6, s94
  v_cmp_eq_u32 vcc, 0, v0
  v_mov_b32 v7, s95
  s_nop 0
  v_cndmask_b32_e64 v8, v8, 0, vcc
  buffer_store_dwordx2 v[6:7], v8, s[96:99], s6 offen sc1
  buffer_store_dwordx2 v[6:7], v8, s[96:99], s7 offen sc1
  s_lshl_b32 s91, s73, 12
  s_add_u32 s91, s91, 65536
  v_and_b32 v14, 31, v1
  v_lshlrev_b32 v14, 7, v14
  s_add_u32 s16, s86, 100663296
  s_addc_u32 s17, s87, 0
  s_mov_b32 s18, 16777216
  s_mov_b32 s19, 0x00020000
  v_mfma_f32_16x16x32_bf16 v[32:35], a[112:115], a[80:83], v[32:35]
  s_add_u32 m0, s64, 16384
  ds_read_b128 a[64:67], v16 offset:0
  ds_read_b64_tr_b16 a[96:97], v18 offset:16384
  v_mfma_f32_16x16x32_bf16 v[48:51], a[112:115], a[84:87], v[48:51]
  buffer_load_dwordx4 v10, s[12:15], s71 offen offset:0 lds
  ds_read_b64_tr_b16 a[98:99], v18 offset:18432
  v_mfma_f32_16x16x32_bf16 v[64:67], a[112:115], a[88:91], v[64:67]
  ds_read_b128 a[68:71], v16 offset:1024
  ds_read_b128 a[72:75], v17 offset:0
  v_mfma_f32_16x16x32_bf16 v[80:83], a[112:115], a[92:95], v[80:83]
  buffer_load_dwordx4 v11, s[12:15], s71 offen offset:1024 lds
  ds_read_b128 a[76:79], v17 offset:1024
  v_mfma_f32_16x16x32_bf16 v[36:39], a[116:119], a[80:83], v[36:39]
  ds_read_b64_tr_b16 a[100:101], v19 offset:16384
  ds_read_b64_tr_b16 a[102:103], v19 offset:18432
  v_mfma_f32_16x16x32_bf16 v[52:55], a[116:119], a[84:87], v[52:55]
  ds_read_b64_tr_b16 a[104:105], v20 offset:16384
  ds_read_b64_tr_b16 a[106:107], v20 offset:18432
  v_mfma_f32_16x16x32_bf16 v[68:71], a[116:119], a[88:91], v[68:71]
  ds_read_b64_tr_b16 a[108:109], v21 offset:16384
  ds_read_b64_tr_b16 a[110:111], v21 offset:18432
  v_mfma_f32_16x16x32_bf16 v[84:87], a[116:119], a[92:95], v[84:87]
  buffer_load_dwordx4 v12, s[12:15], s71 offen offset:2048 lds
  v_mfma_f32_16x16x32_bf16 v[40:43], a[120:123], a[80:83], v[40:43]
  v_mfma_f32_16x16x32_bf16 v[56:59], a[120:123], a[84:87], v[56:59]
  v_mfma_f32_16x16x32_bf16 v[72:75], a[120:123], a[88:91], v[72:75]
  v_mfma_f32_16x16x32_bf16 v[88:91], a[120:123], a[92:95], v[88:91]
  buffer_load_dwordx4 v13, s[12:15], s71 offen offset:3072 lds
  v_mfma_f32_16x16x32_bf16 v[44:47], a[124:127], a[80:83], v[44:47]
  s_add_u32 s71, s71, 131072
  v_mfma_f32_16x16x32_bf16 v[60:63], a[124:127], a[84:87], v[60:63]
  v_mfma_f32_16x16x32_bf16 v[76:79], a[124:127], a[88:91], v[76:79]
  v_mfma_f32_16x16x32_bf16 v[92:95], a[124:127], a[92:95], v[92:95]
  s_waitcnt lgkmcnt(0)
  v_mfma_f32_16x16x32_bf16 v[32:35], a[96:99], a[64:67], v[32:35]
  s_mov_b32 m0, s64
  ds_read_b128 a[80:83], v16 offset:8192
  ds_read_b64_tr_b16 a[112:113], v18 offset:20480
  v_mfma_f32_16x16x32_bf16 v[48:51], a[96:99], a[68:71], v[48:51]
  buffer_load_dwordx4 v2, s[8:11], s70 offen offset:0 sc1 lds
  ds_read_b64_tr_b16 a[114:115], v18 offset:22528
  v_mfma_f32_16x16x32_bf16 v[64:67], a[96:99], a[72:75], v[64:67]
  ds_read_b128 a[84:87], v16 offset:9216
  ds_read_b128 a[88:91], v17 offset:8192
  v_mfma_f32_16x16x32_bf16 v[80:83], a[96:99], a[76:79], v[80:83]
  buffer_load_dwordx4 v2, s[8:11], s70 offen offset:1024 sc1 lds
  ds_read_b128 a[92:95], v17 offset:9216
  v_mfma_f32_16x16x32_bf16 v[36:39], a[100:103], a[64:67], v[36:39]
  ds_read_b64_tr_b16 a[116:117], v19 offset:20480
  ds_read_b64_tr_b16 a[118:119], v19 offset:22528
  v_mfma_f32_16x16x32_bf16 v[52:55], a[100:103], a[68:71], v[52:55]
  ds_read_b64_tr_b16 a[120:121], v20 offset:20480
  ds_read_b64_tr_b16 a[122:123], v20 offset:22528
  v_mfma_f32_16x16x32_bf16 v[68:71], a[100:103], a[72:75], v[68:71]
  ds_read_b64_tr_b16 a[124:125], v21 offset:20480
  ds_read_b64_tr_b16 a[126:127], v21 offset:22528
  v_mfma_f32_16x16x32_bf16 v[84:87], a[100:103], a[76:79], v[84:87]
  buffer_load_dwordx4 v2, s[8:11], s70 offen offset:2048 sc1 lds
  v_mfma_f32_16x16x32_bf16 v[40:43], a[104:107], a[64:67], v[40:43]
  v_mfma_f32_16x16x32_bf16 v[56:59], a[104:107], a[68:71], v[56:59]
  v_mfma_f32_16x16x32_bf16 v[72:75], a[104:107], a[72:75], v[72:75]
  v_mfma_f32_16x16x32_bf16 v[88:91], a[104:107], a[76:79], v[88:91]
  buffer_load_dwordx4 v2, s[8:11], s70 offen offset:3072 sc1 lds
  v_mfma_f32_16x16x32_bf16 v[44:47], a[108:111], a[64:67], v[44:47]
  s_add_u32 s70, s70, 16384
  v_mfma_f32_16x16x32_bf16 v[60:63], a[108:111], a[68:71], v[60:63]
  s_add_u32 s64, s64, s66
  s_add_u32 s65, s65, 1
  s_cmp_eq_u32 s65, 4
  s_cselect_b32 s65, 0, s65
  s_cselect_b32 s66, s67, s68
  v_mfma_f32_16x16x32_bf16 v[76:79], a[108:111], a[72:75], v[76:79]
  v_add_u32 v16, s66, v16
  v_add_u32 v17, s66, v17
  v_add_u32 v20, s66, v20
  v_mfma_f32_16x16x32_bf16 v[92:95], a[108:111], a[76:79], v[92:95]
  v_add_u32 v18, s66, v18
  v_add_u32 v19, s66, v19
  v_add_u32 v21, s66, v21
  s_waitcnt vmcnt(18) lgkmcnt(0)
  s_barrier
  v_mfma_f32_16x16x32_bf16 v[32:35], a[112:115], a[80:83], v[32:35]
  s_add_u32 m0, s64, 16384
  ds_read_b128 a[64:67], v16 offset:0
  ds_read_b64_tr_b16 a[96:97], v18 offset:16384
  v_mfma_f32_16x16x32_bf16 v[48:51], a[112:115], a[84:87], v[48:51]
  buffer_load_dwordx4 v10, s[12:15], s71 offen offset:0 lds
  ds_read_b64_tr_b16 a[98:99], v18 offset:18432
  v_mfma_f32_16x16x32_bf16 v[64:67], a[112:115], a[88:91], v[64:67]
  ds_read_b128 a[68:71], v16 offset:1024
  ds_read_b128 a[72:75], v17 offset:0
  v_mfma_f32_16x16x32_bf16 v[80:83], a[112:115], a[92:95], v[80:83]
  buffer_load_dwordx4 v11, s[12:15], s71 offen offset:1024 lds
  ds_read_b128 a[76:79], v17 offset:1024
  v_mfma_f32_16x16x32_bf16 v[36:39], a[116:119], a[80:83], v[36:39]
  ds_read_b64_tr_b16 a[100:101], v19 offset:16384
  ds_read_b64_tr_b16 a[102:103], v19 offset:18432
  v_mfma_f32_16x16x32_bf16 v[52:55], a[116:119], a[84:87], v[52:55]
  ds_read_b64_tr_b16 a[104:105], v20 offset:16384
  ds_read_b64_tr_b16 a[106:107], v20 offset:18432
  v_mfma_f32_16x16x32_bf16 v[68:71], a[116:119], a[88:91], v[68:71]
  ds_read_b64_tr_b16 a[108:109], v21 offset:16384
  ds_read_b64_tr_b16 a[110:111], v21 offset:18432
  v_mfma_f32_16x16x32_bf16 v[84:87], a[116:119], a[92:95], v[84:87]
  buffer_load_dwordx4 v12, s[12:15], s71 offen offset:2048 lds
  v_mfma_f32_16x16x32_bf16 v[40:43], a[120:123], a[80:83], v[40:43]
  v_mfma_f32_16x16x32_bf16 v[56:59], a[120:123], a[84:87], v[56:59]
  v_mfma_f32_16x16x32_bf16 v[72:75], a[120:123], a[88:91], v[72:75]
  v_mfma_f32_16x16x32_bf16 v[88:91], a[120:123], a[92:95], v[88:91]
  buffer_load_dwordx4 v13, s[12:15], s71 offen offset:3072 lds
  v_mfma_f32_16x16x32_bf16 v[44:47], a[124:127], a[80:83], v[44:47]
  s_add_u32 s71, s71, 131072
  v_mfma_f32_16x16x32_bf16 v[60:63], a[124:127], a[84:87], v[60:63]
  v_mfma_f32_16x16x32_bf16 v[76:79], a[124:127], a[88:91], v[76:79]
  v_mfma_f32_16x16x32_bf16 v[92:95], a[124:127], a[92:95], v[92:95]
  s_waitcnt lgkmcnt(0)
  v_mfma_f32_16x16x32_bf16 v[32:35], a[96:99], a[64:67], v[32:35]
  s_mov_b32 m0, s64
  ds_read_b128 a[80:83], v16 offset:8192
  ds_read_b64_tr_b16 a[112:113], v18 offset:20480
  v_mfma_f32_16x16x32_bf16 v[48:51], a[96:99], a[68:71], v[48:51]
  buffer_load_dwordx4 v2, s[8:11], s70 offen offset:0 sc1 lds
  ds_read_b64_tr_b16 a[114:115], v18 offset:22528
  v_mfma_f32_16x16x32_bf16 v[64:67], a[96:99], a[72:75], v[64:67]
  ds_read_b128 a[84:87], v16 offset:9216
  ds_read_b128 a[88:91], v17 offset:8192
  v_mfma_f32_16x16x32_bf16 v[80:83], a[96:99], a[76:79], v[80:83]
  buffer_load_dwordx4 v2, s[8:11], s70 offen offset:1024 sc1 lds
  ds_read_b128 a[92:95], v17 offset:9216
  v_mfma_f32_16x16x32_bf16 v[36:39], a[100:103], a[64:67], v[36:39]
  ds_read_b64_tr_b16 a[116:117], v19 offset:20480
  ds_read_b64_tr_b16 a[118:119], v19 offset:22528
  v_mfma_f32_16x16x32_bf16 v[52:55], a[100:103], a[68:71], v[52:55]
  ds_read_b64_tr_b16 a[120:121], v20 offset:20480
  ds_read_b64_tr_b16 a[122:123], v20 offset:22528
  v_mfma_f32_16x16x32_bf16 v[68:71], a[100:103], a[72:75], v[68:71]
  ds_read_b64_tr_b16 a[124:125], v21 offset:20480
  ds_read_b64_tr_b16 a[126:127], v21 offset:22528
  v_mfma_f32_16x16x32_bf16 v[84:87], a[100:103], a[76:79], v[84:87]
  buffer_load_dwordx4 v2, s[8:11], s70 offen offset:2048 sc1 lds
  v_mfma_f32_16x16x32_bf16 v[40:43], a[104:107], a[64:67], v[40:43]
  v_mfma_f32_16x16x32_bf16 v[56:59], a[104:107], a[68:71], v[56:59]
  v_mfma_f32_16x16x32_bf16 v[72:75], a[104:107], a[72:75], v[72:75]
  v_mfma_f32_16x16x32_bf16 v[88:91], a[104:107], a[76:79], v[88:91]
  buffer_load_dwordx4 v2, s[8:11], s70 offen offset:3072 sc1 lds
  v_mfma_f32_16x16x32_bf16 v[44:47], a[108:111], a[64:67], v[44:47]
  s_add_u32 s70, s70, 16384
  v_mfma_f32_16x16x32_bf16 v[60:63], a[108:111], a[68:71], v[60:63]
  s_add_u32 s64, s64, s66
  s_add_u32 s65, s65, 1
  s_cmp_eq_u32 s65, 4
  s_cselect_b32 s65, 0, s65
  s_cselect_b32 s66, s67, s68
  v_mfma_f32_16x16x32_bf16 v[76:79], a[108:111], a[72:75], v[76:79]
  v_add_u32 v16, s66, v16
  v_add_u32 v17, s66, v17
  v_add_u32 v20, s66, v20
  v_mfma_f32_16x16x32_bf16 v[92:95], a[108:111], a[76:79], v[92:95]
  v_add_u32 v18, s66, v18
  v_add_u32 v19, s66, v19
  v_add_u32 v21, s66, v21
  s_waitcnt vmcnt(18) lgkmcnt(0)
  s_barrier
  v_mfma_f32_16x16x32_bf16 v[32:35], a[112:115], a[80:83], v[32:35]
  s_add_u32 m0, s64, 16384
  ds_read_b128 a[64:67], v16 offset:0
  ds_read_b64_tr_b16 a[96:97], v18 offset:16384
  v_mfma_f32_16x16x32_bf16 v[48:51], a[112:115], a[84:87], v[48:51]
  buffer_load_dwordx4 v10, s[12:15], s71 offen offset:0 lds
  ds_read_b64_tr_b16 a[98:99], v18 offset:18432
  v_mfma_f32_16x16x32_bf16 v[64:67], a[112:115], a[88:91], v[64:67]
  ds_read_b128 a[68:71], v16 offset:1024
  ds_read_b128 a[72:75], v17 offset:0
  v_mfma_f32_16x16x32_bf16 v[80:83], a[112:115], a[92:95], v[80:83]
  buffer_load_dwordx4 v11, s[12:15], s71 offen offset:1024 lds
  ds_read_b128 a[76:79], v17 offset:1024
  v_mfma_f32_16x16x32_bf16 v[36:39], a[116:119], a[80:83], v[36:39]
  ds_read_b64_tr_b16 a[100:101], v19 offset:16384
  ds_read_b64_tr_b16 a[102:103], v19 offset:18432
  v_mfma_f32_16x16x32_bf16 v[52:55], a[116:119], a[84:87], v[52:55]
  ds_read_b64_tr_b16 a[104:105], v20 offset:16384
  ds_read_b64_tr_b16 a[106:107], v20 offset:18432
  v_mfma_f32_16x16x32_bf16 v[68:71], a[116:119], a[88:91], v[68:71]
  ds_read_b64_tr_b16 a[108:109], v21 offset:16384
  ds_read_b64_tr_b16 a[110:111], v21 offset:18432
  v_mfma_f32_16x16x32_bf16 v[84:87], a[116:119], a[92:95], v[84:87]
  buffer_load_dwordx4 v12, s[12:15], s71 offen offset:2048 lds
  v_mfma_f32_16x16x32_bf16 v[40:43], a[120:123], a[80:83], v[40:43]
  v_mfma_f32_16x16x32_bf16 v[56:59], a[120:123], a[84:87], v[56:59]
  v_mfma_f32_16x16x32_bf16 v[72:75], a[120:123], a[88:91], v[72:75]
  v_mfma_f32_16x16x32_bf16 v[88:91], a[120:123], a[92:95], v[88:91]
  buffer_load_dwordx4 v13, s[12:15], s71 offen offset:3072 lds
  v_mfma_f32_16x16x32_bf16 v[44:47], a[124:127], a[80:83], v[44:47]
  s_add_u32 s71, s71, 131072
  v_mfma_f32_16x16x32_bf16 v[60:63], a[124:127], a[84:87], v[60:63]
  v_mfma_f32_16x16x32_bf16 v[76:79], a[124:127], a[88:91], v[76:79]
  v_mfma_f32_16x16x32_bf16 v[92:95], a[124:127], a[92:95], v[92:95]
  s_waitcnt lgkmcnt(0)
  v_mfma_f32_16x16x32_bf16 v[32:35], a[96:99], a[64:67], v[32:35]
  s_mov_b32 m0, s64
  ds_read_b128 a[80:83], v16 offset:8192
  ds_read_b64_tr_b16 a[112:113], v18 offset:20480
  v_mfma_f32_16x16x32_bf16 v[48:51], a[96:99], a[68:71], v[48:51]
  buffer_load_dwordx4 v2, s[8:11], s70 offen offset:0 sc1 lds
  ds_read_b64_tr_b16 a[114:115], v18 offset:22528
  v_mfma_f32_16x16x32_bf16 v[64:67], a[96:99], a[72:75], v[64:67]
  ds_read_b128 a[84:87], v16 offset:9216
  ds_read_b128 a[88:91], v17 offset:8192
  v_mfma_f32_16x16x32_bf16 v[80:83], a[96:99], a[76:79], v[80:83]
  buffer_load_dwordx4 v2, s[8:11], s70 offen offset:1024 sc1 lds
  ds_read_b128 a[92:95], v17 offset:9216
  v_mfma_f32_16x16x32_bf16 v[36:39], a[100:103], a[64:67], v[36:39]
  ds_read_b64_tr_b16 a[116:117], v19 offset:20480
  ds_read_b64_tr_b16 a[118:119], v19 offset:22528
  v_mfma_f32_16x16x32_bf16 v[52:55], a[100:103], a[68:71], v[52:55]
  ds_read_b64_tr_b16 a[120:121], v20 offset:20480
  ds_read_b64_tr_b16 a[122:123], v20 offset:22528
  v_mfma_f32_16x16x32_bf16 v[68:71], a[100:103], a[72:75], v[68:71]
  ds_read_b64_tr_b16 a[124:125], v21 offset:20480
  ds_read_b64_tr_b16 a[126:127], v21 offset:22528
  v_mfma_f32_16x16x32_bf16 v[84:87], a[100:103], a[76:79], v[84:87]
  buffer_load_dwordx4 v2, s[8:11], s70 offen offset:2048 sc1 lds
  v_mfma_f32_16x16x32_bf16 v[40:43], a[104:107], a[64:67], v[40:43]
  v_mfma_f32_16x16x32_bf16 v[56:59], a[104:107], a[68:71], v[56:59]
  v_mfma_f32_16x16x32_bf16 v[72:75], a[104:107], a[72:75], v[72:75]
  v_mfma_f32_16x16x32_bf16 v[88:91], a[104:107], a[76:79], v[88:91]
  buffer_load_dwordx4 v2, s[8:11], s70 offen offset:3072 sc1 lds
  v_mfma_f32_16x16x32_bf16 v[44:47], a[108:111], a[64:67], v[44:47]
  s_add_u32 s70, s70, 16384
  v_mfma_f32_16x16x32_bf16 v[60:63], a[108:111], a[68:71], v[60:63]
  s_add_u32 s64, s64, s66
  s_add_u32 s65, s65, 1
  s_cmp_eq_u32 s65, 4
  s_cselect_b32 s65, 0, s65
  s_cselect_b32 s66, s67, s68
  v_mfma_f32_16x16x32_bf16 v[76:79], a[108:111], a[72:75], v[76:79]
  v_add_u32 v16, s66, v16
  v_add_u32 v17, s66, v17
  v_add_u32 v20, s66, v20
  v_mfma_f32_16x16x32_bf16 v[92:95], a[108:111], a[76:79], v[92:95]
  v_add_u32 v18, s66, v18
  v_add_u32 v19, s66, v19
  v_add_u32 v21, s66, v21
  s_waitcnt vmcnt(16) lgkmcnt(0)
  s_barrier
  v_mfma_f32_16x16x32_bf16 v[32:35], a[112:115], a[80:83], v[32:35]
  s_add_u32 m0, s64, 16384
  ds_read_b128 a[64:67], v16 offset:0
  ds_read_b64_tr_b16 a[96:97], v18 offset:16384
  v_mfma_f32_16x16x32_bf16 v[48:51], a[112:115], a[84:87], v[48:51]
  buffer_load_dwordx4 v10, s[12:15], s71 offen offset:0 lds
  ds_read_b64_tr_b16 a[98:99], v18 offset:18432
  v_mfma_f32_16x16x32_bf16 v[64:67], a[112:115], a[88:91], v[64:67]
  ds_read_b128 a[68:71], v16 offset:1024
  ds_read_b128 a[72:75], v17 offset:0
  v_mfma_f32_16x16x32_bf16 v[80:83], a[112:115], a[92:95], v[80:83]
  buffer_load_dwordx4 v11, s[12:15], s71 offen offset:1024 lds
  ds_read_b128 a[76:79], v17 offset:1024
  v_mfma_f32_16x16x32_bf16 v[36:39], a[116:119], a[80:83], v[36:39]
  ds_read_b64_tr_b16 a[100:101], v19 offset:16384
  ds_read_b64_tr_b16 a[102:103], v19 offset:18432
  v_mfma_f32_16x16x32_bf16 v[52:55], a[116:119], a[84:87], v[52:55]
  ds_read_b64_tr_b16 a[104:105], v20 offset:16384
  ds_read_b64_tr_b16 a[106:107], v20 offset:18432
  v_mfma_f32_16x16x32_bf16 v[68:71], a[116:119], a[88:91], v[68:71]
  ds_read_b64_tr_b16 a[108:109], v21 offset:16384
  ds_read_b64_tr_b16 a[110:111], v21 offset:18432
  v_mfma_f32_16x16x32_bf16 v[84:87], a[116:119], a[92:95], v[84:87]
  buffer_load_dwordx4 v12, s[12:15], s71 offen offset:2048 lds
  v_mfma_f32_16x16x32_bf16 v[40:43], a[120:123], a[80:83], v[40:43]
  v_mfma_f32_16x16x32_bf16 v[56:59], a[120:123], a[84:87], v[56:59]
  v_mfma_f32_16x16x32_bf16 v[72:75], a[120:123], a[88:91], v[72:75]
  v_mfma_f32_16x16x32_bf16 v[88:91], a[120:123], a[92:95], v[88:91]
  buffer_load_dwordx4 v13, s[12:15], s71 offen offset:3072 lds
  v_mfma_f32_16x16x32_bf16 v[44:47], a[124:127], a[80:83], v[44:47]
  s_add_u32 s71, s71, 131072
  v_mfma_f32_16x16x32_bf16 v[60:63], a[124:127], a[84:87], v[60:63]
  v_mfma_f32_16x16x32_bf16 v[76:79], a[124:127], a[88:91], v[76:79]
  v_mfma_f32_16x16x32_bf16 v[92:95], a[124:127], a[92:95], v[92:95]
  s_waitcnt lgkmcnt(0)
  v_mfma_f32_16x16x32_bf16 v[32:35], a[96:99], a[64:67], v[32:35]
  s_mov_b32 m0, s64
  ds_read_b128 a[80:83], v16 offset:8192
  ds_read_b64_tr_b16 a[112:113], v18 offset:20480
  v_mfma_f32_16x16x32_bf16 v[48:51], a[96:99], a[68:71], v[48:51]
  buffer_load_dwordx4 v2, s[8:11], s70 offen offset:0 sc1 lds
  ds_read_b64_tr_b16 a[114:115], v18 offset:22528
  v_mfma_f32_16x16x32_bf16 v[64:67], a[96:99], a[72:75], v[64:67]
  ds_read_b128 a[84:87], v16 offset:9216
  ds_read_b128 a[88:91], v17 offset:8192
  v_mfma_f32_16x16x32_bf16 v[80:83], a[96:99], a[76:79], v[80:83]
  buffer_load_dwordx4 v2, s[8:11], s70 offen offset:1024 sc1 lds
  ds_read_b128 a[92:95], v17 offset:9216
  v_mfma_f32_16x16x32_bf16 v[36:39], a[100:103], a[64:67], v[36:39]
  ds_read_b64_tr_b16 a[116:117], v19 offset:20480
  ds_read_b64_tr_b16 a[118:119], v19 offset:22528
  v_mfma_f32_16x16x32_bf16 v[52:55], a[100:103], a[68:71], v[52:55]
  ds_read_b64_tr_b16 a[120:121], v20 offset:20480
  ds_read_b64_tr_b16 a[122:123], v20 offset:22528
  v_mfma_f32_16x16x32_bf16 v[68:71], a[100:103], a[72:75], v[68:71]
  ds_read_b64_tr_b16 a[124:125], v21 offset:20480
  ds_read_b64_tr_b16 a[126:127], v21 offset:22528
  v_mfma_f32_16x16x32_bf16 v[84:87], a[100:103], a[76:79], v[84:87]
  buffer_load_dwordx4 v2, s[8:11], s70 offen offset:2048 sc1 lds
  v_mfma_f32_16x16x32_bf16 v[40:43], a[104:107], a[64:67], v[40:43]
  v_mfma_f32_16x16x32_bf16 v[56:59], a[104:107], a[68:71], v[56:59]
  v_mfma_f32_16x16x32_bf16 v[72:75], a[104:107], a[72:75], v[72:75]
  v_mfma_f32_16x16x32_bf16 v[88:91], a[104:107], a[76:79], v[88:91]
  buffer_load_dwordx4 v2, s[8:11], s70 offen offset:3072 sc1 lds
  v_mfma_f32_16x16x32_bf16 v[44:47], a[108:111], a[64:67], v[44:47]
  s_add_u32 s70, s70, 16384
  v_mfma_f32_16x16x32_bf16 v[60:63], a[108:111], a[68:71], v[60:63]
  s_add_u32 s64, s64, s66
  s_add_u32 s65, s65, 1
  s_cmp_eq_u32 s65, 4
  s_cselect_b32 s65, 0, s65
  s_cselect_b32 s66, s67, s68
  v_mfma_f32_16x16x32_bf16 v[76:79], a[108:111], a[72:75], v[76:79]
  v_add_u32 v16, s66, v16
  v_add_u32 v17, s66, v17
  v_add_u32 v20, s66, v20
  v_mfma_f32_16x16x32_bf16 v[92:95], a[108:111], a[76:79], v[92:95]
  v_add_u32 v18, s66, v18
  v_add_u32 v19, s66, v19
  v_add_u32 v21, s66, v21
  s_waitcnt vmcnt(16) lgkmcnt(0)
  s_barrier
  v_mfma_f32_16x16x32_bf16 v[32:35], a[112:115], a[80:83], v[32:35]
  s_mov_b32 s12, s74
  s_mov_b32 s13, s75
  s_mov_b32 s14, 8388608
  v_mfma_f32_16x16x32_bf16 v[48:51], a[112:115], a[84:87], v[48:51]
  s_mov_b32 s15, 0x00020000
  s_lshl_b32 s71, s77, 22
  s_lshl_b32 s72, s76, 8
  v_mfma_f32_16x16x32_bf16 v[64:67], a[112:115], a[88:91], v[64:67]
  s_add_u32 s71, s71, s72
  s_add_u32 m0, s64, 16384
  ds_read_b128 a[64:67], v16 offset:0
  v_mfma_f32_16x16x32_bf16 v[80:83], a[112:115], a[92:95], v[80:83]
  buffer_load_dwordx4 v10, s[12:15], s71 offen offset:0 lds
  ds_read_b64_tr_b16 a[96:97], v18 offset:16384
  v_mfma_f32_16x16x32_bf16 v[36:39], a[116:119], a[80:83], v[36:39]
  ds_read_b64_tr_b16 a[98:99], v18 offset:18432
  ds_read_b128 a[68:71], v16 offset:1024
  v_mfma_f32_16x16x32_bf16 v[52:55], a[116:119], a[84:87], v[52:55]
  buffer_load_dwordx4 v11, s[12:15], s71 offen offset:1024 lds
  ds_read_b128 a[72:75], v17 offset:0
  v_mfma_f32_16x16x32_bf16 v[68:71], a[116:119], a[88:91], v[68:71]
  ds_read_b128 a[76:79], v17 offset:1024
  ds_read_b64_tr_b16 a[100:101], v19 offset:16384
  v_mfma_f32_16x16x32_bf16 v[84:87], a[116:119], a[92:95], v[84:87]
  ds_read_b64_tr_b16 a[102:103], v19 offset:18432
  ds_read_b64_tr_b16 a[104:105], v20 offset:16384
  v_mfma_f32_16x16x32_bf16 v[40:43], a[120:123], a[80:83], v[40:43]
  ds_read_b64_tr_b16 a[106:107], v20 offset:18432
  ds_read_b64_tr_b16 a[108:109], v21 offset:16384
  v_mfma_f32_16x16x32_bf16 v[56:59], a[120:123], a[84:87], v[56:59]
  ds_read_b64_tr_b16 a[110:111], v21 offset:18432
  v_mfma_f32_16x16x32_bf16 v[72:75], a[120:123], a[88:91], v[72:75]
  buffer_load_dwordx4 v12, s[12:15], s71 offen offset:2048 lds
  v_mfma_f32_16x16x32_bf16 v[88:91], a[120:123], a[92:95], v[88:91]
  v_mfma_f32_16x16x32_bf16 v[44:47], a[124:127], a[80:83], v[44:47]
  v_mfma_f32_16x16x32_bf16 v[60:63], a[124:127], a[84:87], v[60:63]
  v_mfma_f32_16x16x32_bf16 v[76:79], a[124:127], a[88:91], v[76:79]
  v_mfma_f32_16x16x32_bf16 v[92:95], a[124:127], a[92:95], v[92:95]
  s_waitcnt lgkmcnt(0)
  v_mfma_f32_16x16x32_bf16 v[32:35], a[96:99], a[64:67], v[32:35]
  buffer_load_dwordx4 v13, s[12:15], s71 offen offset:3072 lds
  ds_read_b128 a[80:83], v16 offset:8192
  v_mfma_f32_16x16x32_bf16 v[48:51], a[96:99], a[68:71], v[48:51]
  s_add_u32 s71, s71, 131072
  ds_read_b64_tr_b16 a[112:113], v18 offset:20480
  ds_read_b64_tr_b16 a[114:115], v18 offset:22528
  v_mfma_f32_16x16x32_bf16 v[64:67], a[96:99], a[72:75], v[64:67]
  ds_read_b128 a[84:87], v16 offset:9216
  ds_read_b128 a[88:91], v17 offset:8192
  v_mfma_f32_16x16x32_bf16 v[80:83], a[96:99], a[76:79], v[80:83]
  ds_read_b128 a[92:95], v17 offset:9216
  ds_read_b64_tr_b16 a[116:117], v19 offset:20480
  v_mfma_f32_16x16x32_bf16 v[36:39], a[100:103], a[64:67], v[36:39]
  ds_read_b64_tr_b16 a[118:119], v19 offset:22528
  ds_read_b64_tr_b16 a[120:121], v20 offset:20480
  v_mfma_f32_16x16x32_bf16 v[52:55], a[100:103], a[68:71], v[52:55]
  ds_read_b64_tr_b16 a[122:123], v20 offset:22528
  ds_read_b64_tr_b16 a[124:125], v21 offset:20480
  v_mfma_f32_16x16x32_bf16 v[68:71], a[100:103], a[72:75], v[68:71]
  ds_read_b64_tr_b16 a[126:127], v21 offset:22528
  v_mfma_f32_16x16x32_bf16 v[84:87], a[100:103], a[76:79], v[84:87]
  buffer_load_dwordx2 v[6:7], v14, s[96:99], s91 offen sc1
  v_mfma_f32_16x16x32_bf16 v[40:43], a[104:107], a[64:67], v[40:43]
  s_add_u32 s64, s64, s66
  s_add_u32 s65, s65, 1
  s_cmp_eq_u32 s65, 4
  s_cselect_b32 s65, 0, s65
  s_cselect_b32 s66, s67, s68
  v_mfma_f32_16x16x32_bf16 v[56:59], a[104:107], a[68:71], v[56:59]
  v_add_u32 v16, s66, v16
  v_add_u32 v17, s66, v17
  v_mfma_f32_16x16x32_bf16 v[72:75], a[104:107], a[72:75], v[72:75]
  v_add_u32 v18, s66, v18
  v_add_u32 v19, s66, v19
  v_mfma_f32_16x16x32_bf16 v[88:91], a[104:107], a[76:79], v[88:91]
  v_add_u32 v20, s66, v20
  v_add_u32 v21, s66, v21
  v_mfma_f32_16x16x32_bf16 v[44:47], a[108:111], a[64:67], v[44:47]
  v_mfma_f32_16x16x32_bf16 v[60:63], a[108:111], a[68:71], v[60:63]
  v_mfma_f32_16x16x32_bf16 v[76:79], a[108:111], a[72:75], v[76:79]
  v_mfma_f32_16x16x32_bf16 v[92:95], a[108:111], a[76:79], v[92:95]
  s_waitcnt vmcnt(0)
  v_cmp_ne_u64 vcc, s[94:95], v[6:7]
  s_nop 1
  v_cndmask_b32_e64 v8, 0, 1, vcc
  v_lshlrev_b32 v9, 2, v0
  ds_write_b32 v9, v8
  v_lshlrev_b32 v9, 4, v1
  s_waitcnt lgkmcnt(0)
  s_barrier
  ds_read_b128 v[160:163], v9
  s_waitcnt lgkmcnt(0)
  v_or3_b32 v160, v160, v161, v162
  v_or_b32 v160, v160, v163
  v_cmp_ne_u32 vcc, 0, v160
  s_nop 0
  s_cbranch_vccnz Lp6_late
  s_add_u32 s8, s86, 67108864
  s_addc_u32 s9, s87, 0
  s_mov_b32 s10, 16777216
  s_mov_b32 s11, 0x00020000
  s_lshl_b32 s70, s73, 1
  s_add_u32 s70, s70, s77
  s_lshl_b32 s70, s70, 19
  s_add_u32 s70, s70, s79
  v_mfma_f32_16x16x32_bf16 v[32:35], a[112:115], a[80:83], v[32:35]
  s_add_u32 m0, s79, 131072
  ds_read_b128 a[64:67], v16 offset:0
  ds_read_b64_tr_b16 a[96:97], v18 offset:16384
  v_mfma_f32_16x16x32_bf16 v[48:51], a[112:115], a[84:87], v[48:51]
  buffer_load_dwordx4 v2, s[8:11], s70 offen offset:0 sc1 lds
  ds_read_b64_tr_b16 a[98:99], v18 offset:18432
  v_mfma_f32_16x16x32_bf16 v[64:67], a[112:115], a[88:91], v[64:67]
  buffer_load_dwordx4 v2, s[8:11], s70 offen offset:1024 sc1 lds
  ds_read_b128 a[68:71], v16 offset:1024
  v_mfma_f32_16x16x32_bf16 v[80:83], a[112:115], a[92:95], v[80:83]
  ds_read_b128 a[72:75], v17 offset:0
  ds_read_b128 a[76:79], v17 offset:1024
  v_mfma_f32_16x16x32_bf16 v[36:39], a[116:119], a[80:83], v[36:39]
  ds_read_b64_tr_b16 a[100:101], v19 offset:16384
  ds_read_b64_tr_b16 a[102:103], v19 offset:18432
  v_mfma_f32_16x16x32_bf16 v[52:55], a[116:119], a[84:87], v[52:55]
  buffer_load_dwordx4 v2, s[8:11], s70 offen offset:2048 sc1 lds
  ds_read_b64_tr_b16 a[104:105], v20 offset:16384
  v_mfma_f32_16x16x32_bf16 v[68:71], a[116:119], a[88:91], v[68:71]
  ds_read_b64_tr_b16 a[106:107], v20 offset:18432
  ds_read_b64_tr_b16 a[108:109], v21 offset:16384
  v_mfma_f32_16x16x32_bf16 v[84:87], a[116:119], a[92:95], v[84:87]
  buffer_load_dwordx4 v2, s[8:11], s70 offen offset:3072 sc1 lds
  ds_read_b64_tr_b16 a[110:111], v21 offset:18432
  v_mfma_f32_16x16x32_bf16 v[40:43], a[120:123], a[80:83], v[40:43]
  s_add_u32 s70, s70, 16384
  s_add_u32 m0, s64, 16384
  v_mfma_f32_16x16x32_bf16 v[56:59], a[120:123], a[84:87], v[56:59]
  v_mfma_f32_16x16x32_bf16 v[72:75], a[120:123], a[88:91], v[72:75]
  buffer_load_dwordx4 v10, s[12:15], s71 offen offset:0 lds
  v_mfma_f32_16x16x32_bf16 v[88:91], a[120:123], a[92:95], v[88:91]
  v_mfma_f32_16x16x32_bf16 v[44:47], a[124:127], a[80:83], v[44:47]
  buffer_load_dwordx4 v11, s[12:15], s71 offen offset:1024 lds
  v_mfma_f32_16x16x32_bf16 v[60:63], a[124:127], a[84:87], v[60:63]
  v_mfma_f32_16x16x32_bf16 v[76:79], a[124:127], a[88:91], v[76:79]
  v_mfma_f32_16x16x32_bf16 v[92:95], a[124:127], a[92:95], v[92:95]
  s_waitcnt lgkmcnt(0)
  v_mfma_f32_16x16x32_bf16 v[32:35], a[96:99], a[64:67], v[32:35]
  buffer_load_dwordx4 v12, s[12:15], s71 offen offset:2048 lds
  ds_read_b128 a[80:83], v16 offset:8192
  v_mfma_f32_16x16x32_bf16 v[48:51], a[96:99], a[68:71], v[48:51]
  ds_read_b64_tr_b16 a[112:113], v18 offset:20480
  ds_read_b64_tr_b16 a[114:115], v18 offset:22528
  v_mfma_f32_16x16x32_bf16 v[64:67], a[96:99], a[72:75], v[64:67]
  buffer_load_dwordx4 v13, s[12:15], s71 offen offset:3072 lds
  ds_read_b128 a[84:87], v16 offset:9216
  v_mfma_f32_16x16x32_bf16 v[80:83], a[96:99], a[76:79], v[80:83]
  s_add_u32 s71, s71, 131072
  s_mov_b32 m0, s64
  ds_read_b128 a[88:91], v17 offset:8192
  v_mfma_f32_16x16x32_bf16 v[36:39], a[100:103], a[64:67], v[36:39]
  ds_read_b128 a[92:95], v17 offset:9216
  ds_read_b64_tr_b16 a[116:117], v19 offset:20480
  v_mfma_f32_16x16x32_bf16 v[52:55], a[100:103], a[68:71], v[52:55]
  buffer_load_dwordx4 v2, s[8:11], s70 offen offset:0 sc1 lds
  ds_read_b64_tr_b16 a[118:119], v19 offset:22528
  v_mfma_f32_16x16x32_bf16 v[68:71], a[100:103], a[72:75], v[68:71]
  ds_read_b64_tr_b16 a[120:121], v20 offset:20480
  ds_read_b64_tr_b16 a[122:123], v20 offset:22528
  v_mfma_f32_16x16x32_bf16 v[84:87], a[100:103], a[76:79], v[84:87]
  buffer_load_dwordx4 v2, s[8:11], s70 offen offset:1024 sc1 lds
  ds_read_b64_tr_b16 a[124:125], v21 offset:20480
  v_mfma_f32_16x16x32_bf16 v[40:43], a[104:107], a[64:67], v[40:43]
  ds_read_b64_tr_b16 a[126:127], v21 offset:22528
  v_mfma_f32_16x16x32_bf16 v[56:59], a[104:107], a[68:71], v[56:59]
  v_mfma_f32_16x16x32_bf16 v[72:75], a[104:107], a[72:75], v[72:75]
  buffer_load_dwordx4 v2, s[8:11], s70 offen offset:2048 sc1 lds
  v_mfma_f32_16x16x32_bf16 v[88:91], a[104:107], a[76:79], v[88:91]
  v_mfma_f32_16x16x32_bf16 v[44:47], a[108:111], a[64:67], v[44:47]
  buffer_load_dwordx4 v2, s[8:11], s70 offen offset:3072 sc1 lds
  v_mfma_f32_16x16x32_bf16 v[60:63], a[108:111], a[68:71], v[60:63]
  s_add_u32 s70, s70, 16384
  v_mfma_f32_16x16x32_bf16 v[76:79], a[108:111], a[72:75], v[76:79]
  s_add_u32 s64, s64, s66
  s_add_u32 s65, s65, 1
  s_cmp_eq_u32 s65, 4
  s_cselect_b32 s65, 0, s65
  s_cselect_b32 s66, s67, s68
  v_mfma_f32_16x16x32_bf16 v[92:95], a[108:111], a[76:79], v[92:95]
  v_add_u32 v16, s66, v16
  v_add_u32 v17, s66, v17
  v_add_u32 v18, s66, v18
  v_add_u32 v19, s66, v19
  v_add_u32 v20, s66, v20
  v_add_u32 v21, s66, v21
  s_waitcnt vmcnt(12) lgkmcnt(0)
  s_barrier
  v_mfma_f32_16x16x32_bf16 v[32:35], a[112:115], a[80:83], v[32:35]
  s_add_u32 m0, s64, 16384
  ds_read_b128 a[64:67], v16 offset:0
  ds_read_b64_tr_b16 a[96:97], v18 offset:16384
  v_mfma_f32_16x16x32_bf16 v[48:51], a[112:115], a[84:87], v[48:51]
  buffer_load_dwordx4 v10, s[12:15], s71 offen offset:0 lds
  ds_read_b64_tr_b16 a[98:99], v18 offset:18432
  v_mfma_f32_16x16x32_bf16 v[64:67], a[112:115], a[88:91], v[64:67]
  ds_read_b128 a[68:71], v16 offset:1024
  ds_read_b128 a[72:75], v17 offset:0
  v_mfma_f32_16x16x32_bf16 v[80:83], a[112:115], a[92:95], v[80:83]
  buffer_load_dwordx4 v11, s[12:15], s71 offen offset:1024 lds
  ds_read_b128 a[76:79], v17 offset:1024
  v_mfma_f32_16x16x32_bf16 v[36:39], a[116:119], a[80:83], v[36:39]
  ds_read_b64_tr_b16 a[100:101], v19 offset:16384
  ds_read_b64_tr_b16 a[102:103], v19 offset:18432
  v_mfma_f32_16x16x32_bf16 v[52:55], a[116:119], a[84:87], v[52:55]
  ds_read_b64_tr_b16 a[104:105], v20 offset:16384
  ds_read_b64_tr_b16 a[106:107], v20 offset:18432
  v_mfma_f32_16x16x32_bf16 v[68:71], a[116:119], a[88:91], v[68:71]
  ds_read_b64_tr_b16 a[108:109], v21 offset:16384
  ds_read_b64_tr_b16 a[110:111], v21 offset:18432
  v_mfma_f32_16x16x32_bf16 v[84:87], a[116:119], a[92:95], v[84:87]
  buffer_load_dwordx4 v12, s[12:15], s71 offen offset:2048 lds
  v_mfma_f32_16x16x32_bf16 v[40:43], a[120:123], a[80:83], v[40:43]
  v_mfma_f32_16x16x32_bf16 v[56:59], a[120:123], a[84:87], v[56:59]
  v_mfma_f32_16x16x32_bf16 v[72:75], a[120:123], a[88:91], v[72:75]
  v_mfma_f32_16x16x32_bf16 v[88:91], a[120:123], a[92:95], v[88:91]
  buffer_load_dwordx4 v13, s[12:15], s71 offen offset:3072 lds
  v_mfma_f32_16x16x32_bf16 v[44:47], a[124:127], a[80:83], v[44:47]
  s_add_u32 s71, s71, 131072
  v_mfma_f32_16x16x32_bf16 v[60:63], a[124:127], a[84:87], v[60:63]
  v_mfma_f32_16x16x32_bf16 v[76:79], a[124:127], a[88:91], v[76:79]
  v_mfma_f32_16x16x32_bf16 v[92:95], a[124:127], a[92:95], v[92:95]
  s_waitcnt lgkmcnt(0)
  v_mfma_f32_16x16x32_bf16 v[32:35], a[96:99], a[64:67], v[32:35]
  s_mov_b32 m0, s64
  ds_read_b128 a[80:83], v16 offset:8192
  ds_read_b64_tr_b16 a[112:113], v18 offset:20480
  v_mfma_f32_16x16x32_bf16 v[48:51], a[96:99], a[68:71], v[48:51]
  buffer_load_dwordx4 v2, s[8:11], s70 offen offset:0 sc1 lds
  ds_read_b64_tr_b16 a[114:115], v18 offset:22528
  v_mfma_f32_16x16x32_bf16 v[64:67], a[96:99], a[72:75], v[64:67]
  ds_read_b128 a[84:87], v16 offset:9216
  ds_read_b128 a[88:91], v17 offset:8192
  v_mfma_f32_16x16x32_bf16 v[80:83], a[96:99], a[76:79], v[80:83]
  buffer_load_dwordx4 v2, s[8:11], s70 offen offset:1024 sc1 lds
  ds_read_b128 a[92:95], v17 offset:9216
  v_mfma_f32_16x16x32_bf16 v[36:39], a[100:103], a[64:67], v[36:39]
  ds_read_b64_tr_b16 a[116:117], v19 offset:20480
  ds_read_b64_tr_b16 a[118:119], v19 offset:22528
  v_mfma_f32_16x16x32_bf16 v[52:55], a[100:103], a[68:71], v[52:55]
  ds_read_b64_tr_b16 a[120:121], v20 offset:20480
  ds_read_b64_tr_b16 a[122:123], v20 offset:22528
  v_mfma_f32_16x16x32_bf16 v[68:71], a[100:103], a[72:75], v[68:71]
  ds_read_b64_tr_b16 a[124:125], v21 offset:20480
  ds_read_b64_tr_b16 a[126:127], v21 offset:22528
  v_mfma_f32_16x16x32_bf16 v[84:87], a[100:103], a[76:79], v[84:87]
  buffer_load_dwordx4 v2, s[8:11], s70 offen offset:2048 sc1 lds
  v_mfma_f32_16x16x32_bf16 v[40:43], a[104:107], a[64:67], v[40:43]
  v_mfma_f32_16x16x32_bf16 v[56:59], a[104:107], a[68:71], v[56:59]
  v_mfma_f32_16x16x32_bf16 v[72:75], a[104:107], a[72:75], v[72:75]
  v_mfma_f32_16x16x32_bf16 v[88:91], a[104:107], a[76:79], v[88:91]
  buffer_load_dwordx4 v2, s[8:11], s70 offen offset:3072 sc1 lds
  v_mfma_f32_16x16x32_bf16 v[44:47], a[108:111], a[64:67], v[44:47]
  s_add_u32 s70, s70, 16384
  v_mfma_f32_16x16x32_bf16 v[60:63], a[108:111], a[68:71], v[60:63]
  s_add_u32 s64, s64, s66
  s_add_u32 s65, s65, 1
  s_cmp_eq_u32 s65, 4
  s_cselect_b32 s65, 0, s65
  s_cselect_b32 s66, s67, s68
  v_mfma_f32_16x16x32_bf16 v[76:79], a[108:111], a[72:75], v[76:79]
  v_add_u32 v16, s66, v16
  v_add_u32 v17, s66, v17
  v_add_u32 v20, s66, v20
  v_mfma_f32_16x16x32_bf16 v[92:95], a[108:111], a[76:79], v[92:95]
  v_add_u32 v18, s66, v18
  v_add_u32 v19, s66, v19
  v_add_u32 v21, s66, v21
  s_waitcnt vmcnt(16) lgkmcnt(0)
  s_barrier
  v_mfma_f32_16x16x32_bf16 v[32:35], a[112:115], a[80:83], v[32:35]
  s_add_u32 m0, s64, 16384
  ds_read_b128 a[64:67], v16 offset:0
  ds_read_b64_tr_b16 a[96:97], v18 offset:16384
  v_mfma_f32_16x16x32_bf16 v[48:51], a[112:115], a[84:87], v[48:51]
  buffer_load_dwordx4 v10, s[12:15], s71 offen offset:0 lds
  ds_read_b64_tr_b16 a[98:99], v18 offset:18432
  v_mfma_f32_16x16x32_bf16 v[64:67], a[112:115], a[88:91], v[64:67]
  buffer_load_dwordx4 v11, s[12:15], s71 offen offset:1024 lds
  ds_read_b128 a[68:71], v16 offset:1024
  v_mfma_f32_16x16x32_bf16 v[80:83], a[112:115], a[92:95], v[80:83]
  buffer_load_dwordx4 v12, s[12:15], s71 offen offset:2048 lds
  ds_read_b128 a[72:75], v17 offset:0
  v_mfma_f32_16x16x32_bf16 v[36:39], a[116:119], a[80:83], v[36:39]
  ds_read_b128 a[76:79], v17 offset:1024
  ds_read_b64_tr_b16 a[100:101], v19 offset:16384
  v_mfma_f32_16x16x32_bf16 v[52:55], a[116:119], a[84:87], v[52:55]
  buffer_load_dwordx4 v13, s[12:15], s71 offen offset:3072 lds
  ds_read_b64_tr_b16 a[102:103], v19 offset:18432
  v_mfma_f32_16x16x32_bf16 v[68:71], a[116:119], a[88:91], v[68:71]
  s_add_u32 s71, s71, 131072
  s_mov_b32 m0, s64
  ds_read_b64_tr_b16 a[104:105], v20 offset:16384
  v_mfma_f32_16x16x32_bf16 v[84:87], a[116:119], a[92:95], v[84:87]
  buffer_load_dwordx4 v2, s[8:11], s70 offen offset:0 sc1 lds
  ds_read_b64_tr_b16 a[106:107], v20 offset:18432
  v_mfma_f32_16x16x32_bf16 v[40:43], a[120:123], a[80:83], v[40:43]
  ds_read_b64_tr_b16 a[108:109], v21 offset:16384
  ds_read_b64_tr_b16 a[110:111], v21 offset:18432
  v_mfma_f32_16x16x32_bf16 v[56:59], a[120:123], a[84:87], v[56:59]
  buffer_load_dwordx4 v2, s[8:11], s70 offen offset:1024 sc1 lds
  v_mfma_f32_16x16x32_bf16 v[72:75], a[120:123], a[88:91], v[72:75]
  v_mfma_f32_16x16x32_bf16 v[88:91], a[120:123], a[92:95], v[88:91]
  buffer_load_dwordx4 v2, s[8:11], s70 offen offset:2048 sc1 lds
  v_mfma_f32_16x16x32_bf16 v[44:47], a[124:127], a[80:83], v[44:47]
  v_mfma_f32_16x16x32_bf16 v[60:63], a[124:127], a[84:87], v[60:63]
  buffer_load_dwordx4 v2, s[8:11], s70 offen offset:3072 sc1 lds
  v_mfma_f32_16x16x32_bf16 v[76:79], a[124:127], a[88:91], v[76:79]
  s_add_u32 s70, s70, 16384
  v_mfma_f32_16x16x32_bf16 v[92:95], a[124:127], a[92:95], v[92:95]
  s_waitcnt lgkmcnt(0)
  s_lshl_b32 s6, s78, 1
  s_add_u32 s6, s6, s77
  s_xor_b32 s6, s6, 1
  s_lshl_b32 s6, s6, 2
  s_add_u32 s6, s6, s3
  s_lshl_b32 s6, s6, 13
  s_add_u32 s6, s6, 8388608
  s_add_u32 s7, s6, 4096
  v_mfma_f32_16x16x32_bf16 v[96:99], a[96:99], a[64:67], 0
  s_add_u32 s64, s64, s66
  ds_read_b128 a[80:83], v16 offset:8192
  ds_read_b64_tr_b16 a[112:113], v18 offset:20480
  v_mfma_f32_16x16x32_bf16 v[112:115], a[96:99], a[68:71], 0
  s_add_u32 s65, s65, 1
  ds_read_b64_tr_b16 a[114:115], v18 offset:22528
  ds_read_b128 a[84:87], v16 offset:9216
  v_mfma_f32_16x16x32_bf16 v[128:131], a[96:99], a[72:75], 0
  s_cmp_eq_u32 s65, 4
  s_cselect_b32 s65, 0, s65
  s_cselect_b32 s66, s67, s68
  ds_read_b128 a[88:91], v17 offset:8192
  ds_read_b128 a[92:95], v17 offset:9216
  v_mfma_f32_16x16x32_bf16 v[144:147], a[96:99], a[76:79], 0
  ds_read_b64_tr_b16 a[116:117], v19 offset:20480
  v_mfma_f32_16x16x32_bf16 v[100:103], a[100:103], a[64:67], 0
  ds_read_b64_tr_b16 a[118:119], v19 offset:22528
  ds_read_b64_tr_b16 a[120:121], v20 offset:20480
  v_mfma_f32_16x16x32_bf16 v[116:119], a[100:103], a[68:71], 0
  ds_read_b64_tr_b16 a[122:123], v20 offset:22528
  ds_read_b64_tr_b16 a[124:125], v21 offset:20480
  v_mfma_f32_16x16x32_bf16 v[132:135], a[100:103], a[72:75], 0
  buffer_store_dwordx4 v[64:67], v2, s[16:19], s6 offen offset:0 sc1
  ds_read_b64_tr_b16 a[126:127], v21 offset:22528
  v_mfma_f32_16x16x32_bf16 v[148:151], a[100:103], a[76:79], 0
  v_add_u32 v16, s66, v16
  v_add_u32 v17, s66, v17
  v_mfma_f32_16x16x32_bf16 v[104:107], a[104:107], a[64:67], 0
  v_add_u32 v18, s66, v18
  v_add_u32 v19, s66, v19
  v_mfma_f32_16x16x32_bf16 v[120:123], a[104:107], a[68:71], 0
  v_add_u32 v20, s66, v20
  v_add_u32 v21, s66, v21
  v_mfma_f32_16x16x32_bf16 v[136:139], a[104:107], a[72:75], 0
  buffer_store_dwordx4 v[68:71], v2, s[16:19], s6 offen offset:1024 sc1
  v_mfma_f32_16x16x32_bf16 v[152:155], a[104:107], a[76:79], 0
  buffer_store_dwordx4 v[72:75], v2, s[16:19], s6 offen offset:2048 sc1
  v_mfma_f32_16x16x32_bf16 v[108:111], a[108:111], a[64:67], 0
  buffer_store_dwordx4 v[76:79], v2, s[16:19], s6 offen offset:3072 sc1
  v_mfma_f32_16x16x32_bf16 v[124:127], a[108:111], a[68:71], 0
  buffer_store_dwordx4 v[80:83], v2, s[16:19], s7 offen offset:0 sc1
  v_mfma_f32_16x16x32_bf16 v[140:143], a[108:111], a[72:75], 0
  buffer_store_dwordx4 v[84:87], v2, s[16:19], s7 offen offset:1024 sc1
  v_mfma_f32_16x16x32_bf16 v[156:159], a[108:111], a[76:79], 0
  buffer_store_dwordx4 v[88:91], v2, s[16:19], s7 offen offset:2048 sc1
  buffer_store_dwordx4 v[92:95], v2, s[16:19], s7 offen offset:3072 sc1
  s_branch Lp7
Lp6_late:
  v_mfma_f32_16x16x32_bf16 v[32:35], a[112:115], a[80:83], v[32:35]
  s_add_u32 m0, s64, 16384
  ds_read_b128 a[64:67], v16 offset:0
  ds_read_b64_tr_b16 a[96:97], v18 offset:16384
  v_mfma_f32_16x16x32_bf16 v[48:51], a[112:115], a[84:87], v[48:51]
  buffer_load_dwordx4 v10, s[12:15], s71 offen offset:0 lds
  ds_read_b64_tr_b16 a[98:99], v18 offset:18432
  v_mfma_f32_16x16x32_bf16 v[64:67], a[112:115], a[88:91], v[64:67]
  ds_read_b128 a[68:71], v16 offset:1024
  ds_read_b128 a[72:75], v17 offset:0
  v_mfma_f32_16x16x32_bf16 v[80:83], a[112:115], a[92:95], v[80:83]
  ds_read_b128 a[76:79], v17 offset:1024
  ds_read_b64_tr_b16 a[100:101], v19 offset:16384
  v_mfma_f32_16x16x32_bf16 v[36:39], a[116:119], a[80:83], v[36:39]
  ds_read_b64_tr_b16 a[102:103], v19 offset:18432
  ds_read_b64_tr_b16 a[104:105], v20 offset:16384
  v_mfma_f32_16x16x32_bf16 v[52:55], a[116:119], a[84:87], v[52:55]
  ds_read_b64_tr_b16 a[106:107], v20 offset:18432
  ds_read_b64_tr_b16 a[108:109], v21 offset:16384
  v_mfma_f32_16x16x32_bf16 v[68:71], a[116:119], a[88:91], v[68:71]
  ds_read_b64_tr_b16 a[110:111], v21 offset:18432
  v_mfma_f32_16x16x32_bf16 v[84:87], a[116:119], a[92:95], v[84:87]
  buffer_load_dwordx4 v11, s[12:15], s71 offen offset:1024 lds
  v_mfma_f32_16x16x32_bf16 v[40:43], a[120:123], a[80:83], v[40:43]
  v_mfma_f32_16x16x32_bf16 v[56:59], a[120:123], a[84:87], v[56:59]
  v_mfma_f32_16x16x32_bf16 v[72:75], a[120:123], a[88:91], v[72:75]
  v_mfma_f32_16x16x32_bf16 v[88:91], a[120:123], a[92:95], v[88:91]
  v_mfma_f32_16x16x32_bf16 v[44:47], a[124:127], a[80:83], v[44:47]
  v_mfma_f32_16x16x32_bf16 v[60:63], a[124:127], a[84:87], v[60:63]
  v_mfma_f32_16x16x32_bf16 v[76:79], a[124:127], a[88:91], v[76:79]
  v_mfma_f32_16x16x32_bf16 v[92:95], a[124:127], a[92:95], v[92:95]
  s_waitcnt lgkmcnt(0)
  v_mfma_f32_16x16x32_bf16 v[32:35], a[96:99], a[64:67], v[32:35]
  buffer_load_dwordx4 v12, s[12:15], s71 offen offset:2048 lds
  ds_read_b128 a[80:83], v16 offset:8192
  v_mfma_f32_16x16x32_bf16 v[48:51], a[96:99], a[68:71], v[48:51]
  ds_read_b64_tr_b16 a[112:113], v18 offset:20480
  ds_read_b64_tr_b16 a[114:115], v18 offset:22528
  v_mfma_f32_16x16x32_bf16 v[64:67], a[96:99], a[72:75], v[64:67]
  ds_read_b128 a[84:87], v16 offset:9216
  ds_read_b128 a[88:91], v17 offset:8192
  v_mfma_f32_16x16x32_bf16 v[80:83], a[96:99], a[76:79], v[80:83]
  ds_read_b128 a[92:95], v17 offset:9216
  ds_read_b64_tr_b16 a[116:117], v19 offset:20480
  v_mfma_f32_16x16x32_bf16 v[36:39], a[100:103], a[64:67], v[36:39]
  ds_read_b64_tr_b16 a[118:119], v19 offset:22528
  ds_read_b64_tr_b16 a[120:121], v20 offset:20480
  v_mfma_f32_16x16x32_bf16 v[52:55], a[100:103], a[68:71], v[52:55]
  ds_read_b64_tr_b16 a[122:123], v20 offset:22528
  ds_read_b64_tr_b16 a[124:125], v21 offset:20480
  v_mfma_f32_16x16x32_bf16 v[68:71], a[100:103], a[72:75], v[68:71]
  ds_read_b64_tr_b16 a[126:127], v21 offset:22528
  v_mfma_f32_16x16x32_bf16 v[84:87], a[100:103], a[76:79], v[84:87]
  buffer_load_dwordx4 v13, s[12:15], s71 offen offset:3072 lds
  v_mfma_f32_16x16x32_bf16 v[40:43], a[104:107], a[64:67], v[40:43]
  s_add_u32 s71, s71, 131072
  v_mfma_f32_16x16x32_bf16 v[56:59], a[104:107], a[68:71], v[56:59]
  s_add_u32 s64, s64, s66
  s_add_u32 s65, s65, 1
  s_cmp_eq_u32 s65, 4
  s_cselect_b32 s65, 0, s65
  s_cselect_b32 s66, s67, s68
  v_mfma_f32_16x16x32_bf16 v[72:75], a[104:107], a[72:75], v[72:75]
  v_add_u32 v16, s66, v16
  v_add_u32 v17, s66, v17
  v_mfma_f32_16x16x32_bf16 v[88:91], a[104:107], a[76:79], v[88:91]
  v_add_u32 v18, s66, v18
  v_add_u32 v19, s66, v19
  v_mfma_f32_16x16x32_bf16 v[44:47], a[108:111], a[64:67], v[44:47]
  v_add_u32 v20, s66, v20
  v_add_u32 v21, s66, v21
  v_mfma_f32_16x16x32_bf16 v[60:63], a[108:111], a[68:71], v[60:63]
  v_mfma_f32_16x16x32_bf16 v[76:79], a[108:111], a[72:75], v[76:79]
  v_mfma_f32_16x16x32_bf16 v[92:95], a[108:111], a[76:79], v[92:95]
  s_waitcnt vmcnt(4) lgkmcnt(0)
  s_barrier
  v_mfma_f32_16x16x32_bf16 v[32:35], a[112:115], a[80:83], v[32:35]
  s_add_u32 m0, s64, 16384
  ds_read_b128 a[64:67], v16 offset:0
  ds_read_b64_tr_b16 a[96:97], v18 offset:16384
  v_mfma_f32_16x16x32_bf16 v[48:51], a[112:115], a[84:87], v[48:51]
  buffer_load_dwordx4 v10, s[12:15], s71 offen offset:0 lds
  ds_read_b64_tr_b16 a[98:99], v18 offset:18432
  v_mfma_f32_16x16x32_bf16 v[64:67], a[112:115], a[88:91], v[64:67]
  ds_read_b128 a[68:71], v16 offset:1024
  ds_read_b128 a[72:75], v17 offset:0
  v_mfma_f32_16x16x32_bf16 v[80:83], a[112:115], a[92:95], v[80:83]
  ds_read_b128 a[76:79], v17 offset:1024
  ds_read_b64_tr_b16 a[100:101], v19 offset:16384
  v_mfma_f32_16x16x32_bf16 v[36:39], a[116:119], a[80:83], v[36:39]
  ds_read_b64_tr_b16 a[102:103], v19 offset:18432
  ds_read_b64_tr_b16 a[104:105], v20 offset:16384
  v_mfma_f32_16x16x32_bf16 v[52:55], a[116:119], a[84:87], v[52:55]
  buffer_load_dwordx4 v11, s[12:15], s71 offen offset:1024 lds
  ds_read_b64_tr_b16 a[106:107], v20 offset:18432
  v_mfma_f32_16x16x32_bf16 v[68:71], a[116:119], a[88:91], v[68:71]
  ds_read_b64_tr_b16 a[108:109], v21 offset:16384
  ds_read_b64_tr_b16 a[110:111], v21 offset:18432
  v_mfma_f32_16x16x32_bf16 v[84:87], a[116:119], a[92:95], v[84:87]
  v_mfma_f32_16x16x32_bf16 v[40:43], a[120:123], a[80:83], v[40:43]
  v_mfma_f32_16x16x32_bf16 v[56:59], a[120:123], a[84:87], v[56:59]
  v_mfma_f32_16x16x32_bf16 v[72:75], a[120:123], a[88:91], v[72:75]
  buffer_load_dwordx4 v12, s[12:15], s71 offen offset:2048 lds
  v_mfma_f32_16x16x32_bf16 v[88:91], a[120:123], a[92:95], v[88:91]
  v_mfma_f32_16x16x32_bf16 v[44:47], a[124:127], a[80:83], v[44:47]
  v_mfma_f32_16x16x32_bf16 v[60:63], a[124:127], a[84:87], v[60:63]
  v_mfma_f32_16x16x32_bf16 v[76:79], a[124:127], a[88:91], v[76:79]
  v_mfma_f32_16x16x32_bf16 v[92:95], a[124:127], a[92:95], v[92:95]
  s_waitcnt lgkmcnt(0)
  v_mfma_f32_16x16x32_bf16 v[32:35], a[96:99], a[64:67], v[32:35]
  buffer_load_dwordx4 v13, s[12:15], s71 offen offset:3072 lds
  ds_read_b128 a[80:83], v16 offset:8192
  v_mfma_f32_16x16x32_bf16 v[48:51], a[96:99], a[68:71], v[48:51]
  s_add_u32 s71, s71, 131072
  ds_read_b64_tr_b16 a[112:113], v18 offset:20480
  ds_read_b64_tr_b16 a[114:115], v18 offset:22528
  v_mfma_f32_16x16x32_bf16 v[64:67], a[96:99], a[72:75], v[64:67]
  ds_read_b128 a[84:87], v16 offset:9216
  ds_read_b128 a[88:91], v17 offset:8192
  v_mfma_f32_16x16x32_bf16 v[80:83], a[96:99], a[76:79], v[80:83]
  ds_read_b128 a[92:95], v17 offset:9216
  ds_read_b64_tr_b16 a[116:117], v19 offset:20480
  v_mfma_f32_16x16x32_bf16 v[36:39], a[100:103], a[64:67], v[36:39]
  ds_read_b64_tr_b16 a[118:119], v19 offset:22528
  ds_read_b64_tr_b16 a[120:121], v20 offset:20480
  v_mfma_f32_16x16x32_bf16 v[52:55], a[100:103], a[68:71], v[52:55]
  ds_read_b64_tr_b16 a[122:123], v20 offset:22528
  ds_read_b64_tr_b16 a[124:125], v21 offset:20480
  v_mfma_f32_16x16x32_bf16 v[68:71], a[100:103], a[72:75], v[68:71]
  ds_read_b64_tr_b16 a[126:127], v21 offset:22528
  v_mfma_f32_16x16x32_bf16 v[84:87], a[100:103], a[76:79], v[84:87]
  buffer_load_dwordx2 v[6:7], v14, s[96:99], s91 offen sc1
  v_mfma_f32_16x16x32_bf16 v[40:43], a[104:107], a[64:67], v[40:43]
  s_add_u32 s64, s64, s66
  s_add_u32 s65, s65, 1
  s_cmp_eq_u32 s65, 4
  s_cselect_b32 s65, 0, s65
  s_cselect_b32 s66, s67, s68
  v_mfma_f32_16x16x32_bf16 v[56:59], a[104:107], a[68:71], v[56:59]
  v_add_u32 v16, s66, v16
  v_add_u32 v17, s66, v17
  v_mfma_f32_16x16x32_bf16 v[72:75], a[104:107], a[72:75], v[72:75]
  v_add_u32 v18, s66, v18
  v_add_u32 v19, s66, v19
  v_mfma_f32_16x16x32_bf16 v[88:91], a[104:107], a[76:79], v[88:91]
  v_add_u32 v20, s66, v20
  v_add_u32 v21, s66, v21
  v_mfma_f32_16x16x32_bf16 v[44:47], a[108:111], a[64:67], v[44:47]
  v_mfma_f32_16x16x32_bf16 v[60:63], a[108:111], a[68:71], v[60:63]
  v_mfma_f32_16x16x32_bf16 v[76:79], a[108:111], a[72:75], v[76:79]
  v_mfma_f32_16x16x32_bf16 v[92:95], a[108:111], a[76:79], v[92:95]
  s_waitcnt vmcnt(0) lgkmcnt(0)
  s_barrier
  s_mov_b32 s5, 0x40000
Lpoll_15:
  v_cmp_ne_u64 vcc, s[94:95], v[6:7]
  s_nop 0
  s_cbranch_vccz Lpolld_16
  s_sleep 4
  buffer_load_dwordx2 v[6:7], v14, s[96:99], s91 offen sc1
  s_sub_u32 s5, s5, 1
  s_waitcnt vmcnt(0)
  s_cbranch_scc0 Lpoll_15
Lpolld_16:
  s_add_u32 s8, s86, 67108864
  s_addc_u32 s9, s87, 0
  s_mov_b32 s10, 16777216
  s_mov_b32 s11, 0x00020000
  s_lshl_b32 s70, s73, 1
  s_add_u32 s70, s70, s77
  s_lshl_b32 s70, s70, 19
  s_add_u32 s70, s70, s79
  v_mfma_f32_16x16x32_bf16 v[32:35], a[112:115], a[80:83], v[32:35]
  s_add_u32 m0, s79, 131072
  v_mfma_f32_16x16x32_bf16 v[48:51], a[112:115], a[84:87], v[48:51]
  buffer_load_dwordx4 v2, s[8:11], s70 offen offset:0 sc1 lds
  v_mfma_f32_16x16x32_bf16 v[64:67], a[112:115], a[88:91], v[64:67]
  buffer_load_dwordx4 v2, s[8:11], s70 offen offset:1024 sc1 lds
  v_mfma_f32_16x16x32_bf16 v[80:83], a[112:115], a[92:95], v[80:83]
  buffer_load_dwordx4 v2, s[8:11], s70 offen offset:2048 sc1 lds
  v_mfma_f32_16x16x32_bf16 v[36:39], a[116:119], a[80:83], v[36:39]
  buffer_load_dwordx4 v2, s[8:11], s70 offen offset:3072 sc1 lds
  v_mfma_f32_16x16x32_bf16 v[52:55], a[116:119], a[84:87], v[52:55]
  s_add_u32 s70, s70, 16384
  s_add_u32 m0, s79, 32768
  v_mfma_f32_16x16x32_bf16 v[68:71], a[116:119], a[88:91], v[68:71]
  buffer_load_dwordx4 v2, s[8:11], s70 offen offset:0 sc1 lds
  v_mfma_f32_16x16x32_bf16 v[84:87], a[116:119], a[92:95], v[84:87]
  buffer_load_dwordx4 v2, s[8:11], s70 offen offset:1024 sc1 lds
  v_mfma_f32_16x16x32_bf16 v[40:43], a[120:123], a[80:83], v[40:43]
  buffer_load_dwordx4 v2, s[8:11], s70 offen offset:2048 sc1 lds
  v_mfma_f32_16x16x32_bf16 v[56:59], a[120:123], a[84:87], v[56:59]
  buffer_load_dwordx4 v2, s[8:11], s70 offen offset:3072 sc1 lds
  v_mfma_f32_16x16x32_bf16 v[72:75], a[120:123], a[88:91], v[72:75]
  s_add_u32 s70, s70, 16384
  s_add_u32 m0, s79, 65536
  v_mfma_f32_16x16x32_bf16 v[88:91], a[120:123], a[92:95], v[88:91]
  buffer_load_dwordx4 v2, s[8:11], s70 offen offset:0 sc1 lds
  v_mfma_f32_16x16x32_bf16 v[44:47], a[124:127], a[80:83], v[44:47]
  buffer_load_dwordx4 v2, s[8:11], s70 offen offset:1024 sc1 lds
  v_mfma_f32_16x16x32_bf16 v[60:63], a[124:127], a[84:87], v[60:63]
  buffer_load_dwordx4 v2, s[8:11], s70 offen offset:2048 sc1 lds
  v_mfma_f32_16x16x32_bf16 v[76:79], a[124:127], a[88:91], v[76:79]
  buffer_load_dwordx4 v2, s[8:11], s70 offen offset:3072 sc1 lds
  v_mfma_f32_16x16x32_bf16 v[92:95], a[124:127], a[92:95], v[92:95]
  s_add_u32 s70, s70, 16384
  s_add_u32 m0, s79, 114688
  s_nop 0
  buffer_load_dwordx4 v10, s[12:15], s71 offen offset:0 lds
  buffer_load_dwordx4 v11, s[12:15], s71 offen offset:1024 lds
  buffer_load_dwordx4 v12, s[12:15], s71 offen offset:2048 lds
  buffer_load_dwordx4 v13, s[12:15], s71 offen offset:3072 lds
  s_add_u32 s71, s71, 131072
  s_add_u32 m0, s79, 98304
  s_nop 0
  buffer_load_dwordx4 v2, s[8:11], s70 offen offset:0 sc1 lds
  buffer_load_dwordx4 v2, s[8:11], s70 offen offset:1024 sc1 lds
  buffer_load_dwordx4 v2, s[8:11], s70 offen offset:2048 sc1 lds
  buffer_load_dwordx4 v2, s[8:11], s70 offen offset:3072 sc1 lds
  s_add_u32 s70, s70, 16384
  s_lshl_b32 s6, s78, 1
  s_add_u32 s6, s6, s77
  s_xor_b32 s6, s6, 1
  s_lshl_b32 s6, s6, 2
  s_add_u32 s6, s6, s3
  s_lshl_b32 s6, s6, 13
  s_add_u32 s6, s6, 8388608
  s_add_u32 s7, s6, 4096
  buffer_store_dwordx4 v[64:67], v2, s[16:19], s6 offen offset:0 sc1
  buffer_store_dwordx4 v[68:71], v2, s[16:19], s6 offen offset:1024 sc1
  buffer_store_dwordx4 v[72:75], v2, s[16:19], s6 offen offset:2048 sc1
  buffer_store_dwordx4 v[76:79], v2, s[16:19], s6 offen offset:3072 sc1
  buffer_store_dwordx4 v[80:83], v2, s[16:19], s7 offen offset:0 sc1
  buffer_store_dwordx4 v[84:87], v2, s[16:19], s7 offen offset:1024 sc1
  buffer_store_dwordx4 v[88:91], v2, s[16:19], s7 offen offset:2048 sc1
  buffer_store_dwordx4 v[92:95], v2, s[16:19], s7 offen offset:3072 sc1
  s_waitcnt vmcnt(24)
  s_barrier
  ds_read_b128 a[64:67], v16 offset:0
  ds_read_b64_tr_b16 a[96:97], v18 offset:16384
  ds_read_b64_tr_b16 a[98:99], v18 offset:18432
  ds_read_b128 a[68:71], v16 offset:1024
  ds_read_b128 a[72:75], v17 offset:0
  ds_read_b128 a[76:79], v17 offset:1024
  ds_read_b64_tr_b16 a[100:101], v19 offset:16384
  ds_read_b64_tr_b16 a[102:103], v19 offset:18432
  ds_read_b64_tr_b16 a[104:105], v20 offset:16384
  ds_read_b64_tr_b16 a[106:107], v20 offset:18432
  ds_read_b64_tr_b16 a[108:109], v21 offset:16384
  ds_read_b64_tr_b16 a[110:111], v21 offset:18432
  s_waitcnt lgkmcnt(0)
  v_mfma_f32_16x16x32_bf16 v[96:99], a[96:99], a[64:67], 0
  s_add_u32 s64, s64, s66
  ds_read_b128 a[80:83], v16 offset:8192
  ds_read_b64_tr_b16 a[112:113], v18 offset:20480
  v_mfma_f32_16x16x32_bf16 v[112:115], a[96:99], a[68:71], 0
  s_add_u32 s65, s65, 1
  ds_read_b64_tr_b16 a[114:115], v18 offset:22528
  ds_read_b128 a[84:87], v16 offset:9216
  v_mfma_f32_16x16x32_bf16 v[128:131], a[96:99], a[72:75], 0
  s_cmp_eq_u32 s65, 4
  s_cselect_b32 s65, 0, s65
  s_cselect_b32 s66, s67, s68
  ds_read_b128 a[88:91], v17 offset:8192
  ds_read_b128 a[92:95], v17 offset:9216
  v_mfma_f32_16x16x32_bf16 v[144:147], a[96:99], a[76:79], 0
  ds_read_b64_tr_b16 a[116:117], v19 offset:20480
  v_mfma_f32_16x16x32_bf16 v[100:103], a[100:103], a[64:67], 0
  ds_read_b64_tr_b16 a[118:119], v19 offset:22528
  ds_read_b64_tr_b16 a[120:121], v20 offset:20480
  v_mfma_f32_16x16x32_bf16 v[116:119], a[100:103], a[68:71], 0
  ds_read_b64_tr_b16 a[122:123], v20 offset:22528
  ds_read_b64_tr_b16 a[124:125], v21 offset:20480
  v_mfma_f32_16x16x32_bf16 v[132:135], a[100:103], a[72:75], 0
  ds_read_b64_tr_b16 a[126:127], v21 offset:22528
  v_mfma_f32_16x16x32_bf16 v[148:151], a[100:103], a[76:79], 0
  v_add_u32 v16, s66, v16
  v_add_u32 v17, s66, v17
  v_mfma_f32_16x16x32_bf16 v[104:107], a[104:107], a[64:67], 0
  v_add_u32 v18, s66, v18
  v_add_u32 v19, s66, v19
  v_mfma_f32_16x16x32_bf16 v[120:123], a[104:107], a[68:71], 0
  v_add_u32 v20, s66, v20
  v_add_u32 v21, s66, v21
  v_mfma_f32_16x16x32_bf16 v[136:139], a[104:107], a[72:75], 0
  v_mfma_f32_16x16x32_bf16 v[152:155], a[104:107], a[76:79], 0
  v_mfma_f32_16x16x32_bf16 v[108:111], a[108:111], a[64:67], 0
  v_mfma_f32_16x16x32_bf16 v[124:127], a[108:111], a[68:71], 0
  v_mfma_f32_16x16x32_bf16 v[140:143], a[108:111], a[72:75], 0
  v_mfma_f32_16x16x32_bf16 v[156:159], a[108:111], a[76:79], 0
Lp7:
  s_mov_b32 s69, 23
  .p2align 6
Lp7_loop:
  s_waitcnt vmcnt(16) lgkmcnt(0)
  s_barrier
  v_mfma_f32_16x16x32_bf16 v[96:99], a[112:115], a[80:83], v[96:99]
  s_add_u32 m0, s64, 16384
  ds_read_b128 a[64:67], v16 offset:0
  ds_read_b64_tr_b16 a[96:97], v18 offset:16384
  v_mfma_f32_16x16x32_bf16 v[112:115], a[112:115], a[84:87], v[112:115]
  buffer_load_dwordx4 v10, s[12:15], s71 offen offset:0 lds
  ds_read_b64_tr_b16 a[98:99], v18 offset:18432
  v_mfma_f32_16x16x32_bf16 v[128:131], a[112:115], a[88:91], v[128:131]
  ds_read_b128 a[68:71], v16 offset:1024
  ds_read_b128 a[72:75], v17 offset:0
  v_mfma_f32_16x16x32_bf16 v[144:147], a[112:115], a[92:95], v[144:147]
  buffer_load_dwordx4 v11, s[12:15], s71 offen offset:1024 lds
  ds_read_b128 a[76:79], v17 offset:1024
  v_mfma_f32_16x16x32_bf16 v[100:103], a[116:119], a[80:83], v[100:103]
  ds_read_b64_tr_b16 a[100:101], v19 offset:16384
  ds_read_b64_tr_b16 a[102:103], v19 offset:18432
  v_mfma_f32_16x16x32_bf16 v[116:119], a[116:119], a[84:87], v[116:119]
  ds_read_b64_tr_b16 a[104:105], v20 offset:16384
  ds_read_b64_tr_b16 a[106:107], v20 offset:18432
  v_mfma_f32_16x16x32_bf16 v[132:135], a[116:119], a[88:91], v[132:135]
  ds_read_b64_tr_b16 a[108:109], v21 offset:16384
  ds_read_b64_tr_b16 a[110:111], v21 offset:18432
  v_mfma_f32_16x16x32_bf16 v[148:151], a[116:119], a[92:95], v[148:151]
  buffer_load_dwordx4 v12, s[12:15], s71 offen offset:2048 lds
  v_mfma_f32_16x16x32_bf16 v[104:107], a[120:123], a[80:83], v[104:107]
  v_mfma_f32_16x16x32_bf16 v[120:123], a[120:123], a[84:87], v[120:123]
  v_mfma_f32_16x16x32_bf16 v[136:139], a[120:123], a[88:91], v[136:139]
  v_mfma_f32_16x16x32_bf16 v[152:155], a[120:123], a[92:95], v[152:155]
  buffer_load_dwordx4 v13, s[12:15], s71 offen offset:3072 lds
  v_mfma_f32_16x16x32_bf16 v[108:111], a[124:127], a[80:83], v[108:111]
  s_add_u32 s71, s71, 131072
  v_mfma_f32_16x16x32_bf16 v[124:127], a[124:127], a[84:87], v[124:127]
  v_mfma_f32_16x16x32_bf16 v[140:143], a[124:127], a[88:91], v[140:143]
  v_mfma_f32_16x16x32_bf16 v[156:159], a[124:127], a[92:95], v[156:159]
  s_waitcnt lgkmcnt(0)
  v_mfma_f32_16x16x32_bf16 v[96:99], a[96:99], a[64:67], v[96:99]
  s_mov_b32 m0, s64
  ds_read_b128 a[80:83], v16 offset:8192
  ds_read_b64_tr_b16 a[112:113], v18 offset:20480
  v_mfma_f32_16x16x32_bf16 v[112:115], a[96:99], a[68:71], v[112:115]
  buffer_load_dwordx4 v2, s[8:11], s70 offen offset:0 sc1 lds
  ds_read_b64_tr_b16 a[114:115], v18 offset:22528
  v_mfma_f32_16x16x32_bf16 v[128:131], a[96:99], a[72:75], v[128:131]
  ds_read_b128 a[84:87], v16 offset:9216
  ds_read_b128 a[88:91], v17 offset:8192
  v_mfma_f32_16x16x32_bf16 v[144:147], a[96:99], a[76:79], v[144:147]
  buffer_load_dwordx4 v2, s[8:11], s70 offen offset:1024 sc1 lds
  ds_read_b128 a[92:95], v17 offset:9216
  v_mfma_f32_16x16x32_bf16 v[100:103], a[100:103], a[64:67], v[100:103]
  ds_read_b64_tr_b16 a[116:117], v19 offset:20480
  ds_read_b64_tr_b16 a[118:119], v19 offset:22528
  v_mfma_f32_16x16x32_bf16 v[116:119], a[100:103], a[68:71], v[116:119]
  ds_read_b64_tr_b16 a[120:121], v20 offset:20480
  ds_read_b64_tr_b16 a[122:123], v20 offset:22528
  v_mfma_f32_16x16x32_bf16 v[132:135], a[100:103], a[72:75], v[132:135]
  ds_read_b64_tr_b16 a[124:125], v21 offset:20480
  ds_read_b64_tr_b16 a[126:127], v21 offset:22528
  v_mfma_f32_16x16x32_bf16 v[148:151], a[100:103], a[76:79], v[148:151]
  buffer_load_dwordx4 v2, s[8:11], s70 offen offset:2048 sc1 lds
  v_mfma_f32_16x16x32_bf16 v[104:107], a[104:107], a[64:67], v[104:107]
  v_mfma_f32_16x16x32_bf16 v[120:123], a[104:107], a[68:71], v[120:123]
  v_mfma_f32_16x16x32_bf16 v[136:139], a[104:107], a[72:75], v[136:139]
  v_mfma_f32_16x16x32_bf16 v[152:155], a[104:107], a[76:79], v[152:155]
  buffer_load_dwordx4 v2, s[8:11], s70 offen offset:3072 sc1 lds
  v_mfma_f32_16x16x32_bf16 v[108:111], a[108:111], a[64:67], v[108:111]
  s_add_u32 s70, s70, 16384
  v_mfma_f32_16x16x32_bf16 v[124:127], a[108:111], a[68:71], v[124:127]
  s_add_u32 s64, s64, s66
  s_add_u32 s65, s65, 1
  s_cmp_eq_u32 s65, 4
  s_cselect_b32 s65, 0, s65
  s_cselect_b32 s66, s67, s68
  v_mfma_f32_16x16x32_bf16 v[140:143], a[108:111], a[72:75], v[140:143]
  s_sub_u32 s69, s69, 1
  v_add_u32 v16, s66, v16
  v_add_u32 v17, s66, v17
  v_add_u32 v20, s66, v20
  v_mfma_f32_16x16x32_bf16 v[156:159], a[108:111], a[76:79], v[156:159]
  v_add_u32 v18, s66, v18
  v_add_u32 v19, s66, v19
  v_add_u32 v21, s66, v21
  s_cmp_lg_u32 s69, 0
  s_cbranch_scc1 Lp7_loop
  s_waitcnt vmcnt(16) lgkmcnt(0)
  s_barrier
  s_lshl_b32 s6, s78, 1
  s_add_u32 s6, s6, s77
  s_lshl_b32 s6, s6, 7
  s_add_u32 s6, s6, 163840
  v_mov_b32 v8, 0x40000000
  v_mov_b32 v6, s94
  v_cmp_eq_u32 vcc, 0, v0
  v_mov_b32 v7, s95
  s_nop 0
  v_cndmask_b32_e64 v8, v8, 0, vcc
  buffer_store_dwordx2 v[6:7], v8, s[96:99], s6 offen sc1
  s_lshl_b32 s90, s78, 1
  s_add_u32 s90, s90, s77
  s_xor_b32 s90, s90, 1
  s_lshl_b32 s90, s90, 7
  s_add_u32 s90, s90, 163840
  s_mov_b32 s20, s82
  s_mov_b32 s21, s83
  s_mov_b32 s22, 8388608
  s_mov_b32 s23, 0x00020000
  v_bfe_u32 v25, v1, 4, 1
  v_lshrrev_b32 v26, 5, v1
  v_lshl_or_b32 v25, v25, 1, v26
  v_lshlrev_b32 v25, 4, v25
  v_and_b32 v24, 15, v1
  v_lshl_add_u32 v26, v24, 14, v25
  v_lshl_add_u32 v27, v24, 12, v25
  v_mfma_f32_16x16x32_bf16 v[96:99], a[112:115], a[80:83], v[96:99]
  s_add_u32 m0, s64, 16384
  ds_read_b128 a[64:67], v16 offset:0
  ds_read_b64_tr_b16 a[96:97], v18 offset:16384
  v_mfma_f32_16x16x32_bf16 v[112:115], a[112:115], a[84:87], v[112:115]
  buffer_load_dwordx4 v10, s[12:15], s71 offen offset:0 lds
  ds_read_b64_tr_b16 a[98:99], v18 offset:18432
  v_mfma_f32_16x16x32_bf16 v[128:131], a[112:115], a[88:91], v[128:131]
  ds_read_b128 a[68:71], v16 offset:1024
  ds_read_b128 a[72:75], v17 offset:0
  v_mfma_f32_16x16x32_bf16 v[144:147], a[112:115], a[92:95], v[144:147]
  buffer_load_dwordx4 v11, s[12:15], s71 offen offset:1024 lds
  ds_read_b128 a[76:79], v17 offset:1024
  v_mfma_f32_16x16x32_bf16 v[100:103], a[116:119], a[80:83], v[100:103]
  ds_read_b64_tr_b16 a[100:101], v19 offset:16384
  ds_read_b64_tr_b16 a[102:103], v19 offset:18432
  v_mfma_f32_16x16x32_bf16 v[116:119], a[116:119], a[84:87], v[116:119]
  ds_read_b64_tr_b16 a[104:105], v20 offset:16384
  ds_read_b64_tr_b16 a[106:107], v20 offset:18432
  v_mfma_f32_16x16x32_bf16 v[132:135], a[116:119], a[88:91], v[132:135]
  ds_read_b64_tr_b16 a[108:109], v21 offset:16384
  ds_read_b64_tr_b16 a[110:111], v21 offset:18432
  v_mfma_f32_16x16x32_bf16 v[148:151], a[116:119], a[92:95], v[148:151]
  buffer_load_dwordx4 v12, s[12:15], s71 offen offset:2048 lds
  v_mfma_f32_16x16x32_bf16 v[104:107], a[120:123], a[80:83], v[104:107]
  v_mfma_f32_16x16x32_bf16 v[120:123], a[120:123], a[84:87], v[120:123]
  v_mfma_f32_16x16x32_bf16 v[136:139], a[120:123], a[88:91], v[136:139]
  v_mfma_f32_16x16x32_bf16 v[152:155], a[120:123], a[92:95], v[152:155]
  buffer_load_dwordx4 v13, s[12:15], s71 offen offset:3072 lds
  v_mfma_f32_16x16x32_bf16 v[108:111], a[124:127], a[80:83], v[108:111]
  s_add_u32 s71, s71, 131072
  v_mfma_f32_16x16x32_bf16 v[124:127], a[124:127], a[84:87], v[124:127]
  v_mfma_f32_16x16x32_bf16 v[140:143], a[124:127], a[88:91], v[140:143]
  v_mfma_f32_16x16x32_bf16 v[156:159], a[124:127], a[92:95], v[156:159]
  s_waitcnt lgkmcnt(0)
  v_mfma_f32_16x16x32_bf16 v[96:99], a[96:99], a[64:67], v[96:99]
  s_mov_b32 m0, s64
  ds_read_b128 a[80:83], v16 offset:8192
  ds_read_b64_tr_b16 a[112:113], v18 offset:20480
  v_mfma_f32_16x16x32_bf16 v[112:115], a[96:99], a[68:71], v[112:115]
  buffer_load_dwordx4 v2, s[8:11], s70 offen offset:0 sc1 lds
  ds_read_b64_tr_b16 a[114:115], v18 offset:22528
  v_mfma_f32_16x16x32_bf16 v[128:131], a[96:99], a[72:75], v[128:131]
  ds_read_b128 a[84:87], v16 offset:9216
  ds_read_b128 a[88:91], v17 offset:8192
  v_mfma_f32_16x16x32_bf16 v[144:147], a[96:99], a[76:79], v[144:147]
  buffer_load_dwordx4 v2, s[8:11], s70 offen offset:1024 sc1 lds
  ds_read_b128 a[92:95], v17 offset:9216
  v_mfma_f32_16x16x32_bf16 v[100:103], a[100:103], a[64:67], v[100:103]
  ds_read_b64_tr_b16 a[116:117], v19 offset:20480
  ds_read_b64_tr_b16 a[118:119], v19 offset:22528
  v_mfma_f32_16x16x32_bf16 v[116:119], a[100:103], a[68:71], v[116:119]
  ds_read_b64_tr_b16 a[120:121], v20 offset:20480
  ds_read_b64_tr_b16 a[122:123], v20 offset:22528
  v_mfma_f32_16x16x32_bf16 v[132:135], a[100:103], a[72:75], v[132:135]
  ds_read_b64_tr_b16 a[124:125], v21 offset:20480
  ds_read_b64_tr_b16 a[126:127], v21 offset:22528
  v_mfma_f32_16x16x32_bf16 v[148:151], a[100:103], a[76:79], v[148:151]
  buffer_load_dwordx4 v2, s[8:11], s70 offen offset:2048 sc1 lds
  v_mfma_f32_16x16x32_bf16 v[104:107], a[104:107], a[64:67], v[104:107]
  v_mfma_f32_16x16x32_bf16 v[120:123], a[104:107], a[68:71], v[120:123]
  v_mfma_f32_16x16x32_bf16 v[136:139], a[104:107], a[72:75], v[136:139]
  v_mfma_f32_16x16x32_bf16 v[152:155], a[104:107], a[76:79], v[152:155]
  buffer_load_dwordx4 v2, s[8:11], s70 offen offset:3072 sc1 lds
  v_mfma_f32_16x16x32_bf16 v[108:111], a[108:111], a[64:67], v[108:111]
  s_add_u32 s70, s70, 16384
  v_mfma_f32_16x16x32_bf16 v[124:127], a[108:111], a[68:71], v[124:127]
  s_add_u32 s64, s64, s66
  s_add_u32 s65, s65, 1
  s_cmp_eq_u32 s65, 4
  s_cselect_b32 s65, 0, s65
  s_cselect_b32 s66, s67, s68
  v_mfma_f32_16x16x32_bf16 v[140:143], a[108:111], a[72:75], v[140:143]
  v_add_u32 v16, s66, v16
  v_add_u32 v17, s66, v17
  v_add_u32 v20, s66, v20
  v_mfma_f32_16x16x32_bf16 v[156:159], a[108:111], a[76:79], v[156:159]
  v_add_u32 v18, s66, v18
  v_add_u32 v19, s66, v19
  v_add_u32 v21, s66, v21
  s_waitcnt vmcnt(17) lgkmcnt(0)
  s_barrier
  v_mfma_f32_16x16x32_bf16 v[96:99], a[112:115], a[80:83], v[96:99]
  buffer_load_dwordx2 v[6:7], off, s[96:99], s90 sc1
  ds_read_b128 a[64:67], v16 offset:0
  v_mfma_f32_16x16x32_bf16 v[112:115], a[112:115], a[84:87], v[112:115]
  s_and_b32 s88, s3, 1
  s_lshl_b32 s88, s88, 12
  s_lshr_b32 s72, s3, 1
  v_mfma_f32_16x16x32_bf16 v[128:131], a[112:115], a[88:91], v[128:131]
  s_lshl_b32 s72, s72, 13
  s_add_u32 s88, s88, s72
  s_lshl_b32 s72, s77, 11
  v_mfma_f32_16x16x32_bf16 v[144:147], a[112:115], a[92:95], v[144:147]
  s_add_u32 s88, s88, s72
  s_sub_u32 s88, s88, s79
  s_add_u32 s70, s70, s88
  v_mfma_f32_16x16x32_bf16 v[100:103], a[116:119], a[80:83], v[100:103]
  s_add_u32 m0, s64, 16384
  ds_read_b64_tr_b16 a[96:97], v18 offset:16384
  ds_read_b64_tr_b16 a[98:99], v18 offset:18432
  v_mfma_f32_16x16x32_bf16 v[116:119], a[116:119], a[84:87], v[116:119]
  buffer_load_dwordx4 v10, s[12:15], s71 offen offset:0 lds
  ds_read_b128 a[68:71], v16 offset:1024
  v_mfma_f32_16x16x32_bf16 v[132:135], a[116:119], a[88:91], v[132:135]
  ds_read_b128 a[72:75], v17 offset:0
  ds_read_b128 a[76:79], v17 offset:1024
  v_mfma_f32_16x16x32_bf16 v[148:151], a[116:119], a[92:95], v[148:151]
  buffer_load_dwordx4 v11, s[12:15], s71 offen offset:1024 lds
  ds_read_b64_tr_b16 a[100:101], v19 offset:16384
  v_mfma_f32_16x16x32_bf16 v[104:107], a[120:123], a[80:83], v[104:107]
  ds_read_b64_tr_b16 a[102:103], v19 offset:18432
  ds_read_b64_tr_b16 a[104:105], v20 offset:16384
  v_mfma_f32_16x16x32_bf16 v[120:123], a[120:123], a[84:87], v[120:123]
  ds_read_b64_tr_b16 a[106:107], v20 offset:18432
  ds_read_b64_tr_b16 a[108:109], v21 offset:16384
  v_mfma_f32_16x16x32_bf16 v[136:139], a[120:123], a[88:91], v[136:139]
  ds_read_b64_tr_b16 a[110:111], v21 offset:18432
  v_mfma_f32_16x16x32_bf16 v[152:155], a[120:123], a[92:95], v[152:155]
  buffer_load_dwordx4 v12, s[12:15], s71 offen offset:2048 lds
  v_mfma_f32_16x16x32_bf16 v[108:111], a[124:127], a[80:83], v[108:111]
  v_mfma_f32_16x16x32_bf16 v[124:127], a[124:127], a[84:87], v[124:127]
  v_mfma_f32_16x16x32_bf16 v[140:143], a[124:127], a[88:91], v[140:143]
  v_mfma_f32_16x16x32_bf16 v[156:159], a[124:127], a[92:95], v[156:159]
  s_waitcnt lgkmcnt(0)
  v_mfma_f32_16x16x32_bf16 v[96:99], a[96:99], a[64:67], v[96:99]
  buffer_load_dwordx4 v13, s[12:15], s71 offen offset:3072 lds
  ds_read_b128 a[80:83], v16 offset:8192
  v_mfma_f32_16x16x32_bf16 v[112:115], a[96:99], a[68:71], v[112:115]
  s_add_u32 s71, s71, 131072
  s_add_u32 m0, s64, s88
  ds_read_b64_tr_b16 a[112:113], v18 offset:20480
  v_mfma_f32_16x16x32_bf16 v[128:131], a[96:99], a[72:75], v[128:131]
  ds_read_b64_tr_b16 a[114:115], v18 offset:22528
  ds_read_b128 a[84:87], v16 offset:9216
  v_mfma_f32_16x16x32_bf16 v[144:147], a[96:99], a[76:79], v[144:147]
  ds_read_b128 a[88:91], v17 offset:8192
  ds_read_b128 a[92:95], v17 offset:9216
  v_mfma_f32_16x16x32_bf16 v[100:103], a[100:103], a[64:67], v[100:103]
  ds_read_b64_tr_b16 a[116:117], v19 offset:20480
  ds_read_b64_tr_b16 a[118:119], v19 offset:22528
  v_mfma_f32_16x16x32_bf16 v[116:119], a[100:103], a[68:71], v[116:119]
  buffer_load_dwordx4 v2, s[8:11], s70 offen offset:0 sc1 lds
  ds_read_b64_tr_b16 a[120:121], v20 offset:20480
  v_mfma_f32_16x16x32_bf16 v[132:135], a[100:103], a[72:75], v[132:135]
  ds_read_b64_tr_b16 a[122:123], v20 offset:22528
  ds_read_b64_tr_b16 a[124:125], v21 offset:20480
  v_mfma_f32_16x16x32_bf16 v[148:151], a[100:103], a[76:79], v[148:151]
  ds_read_b64_tr_b16 a[126:127], v21 offset:22528
  v_mfma_f32_16x16x32_bf16 v[104:107], a[104:107], a[64:67], v[104:107]
  v_mfma_f32_16x16x32_bf16 v[120:123], a[104:107], a[68:71], v[120:123]
  v_mfma_f32_16x16x32_bf16 v[136:139], a[104:107], a[72:75], v[136:139]
  buffer_load_dwordx4 v2, s[8:11], s70 offen offset:1024 sc1 lds
  v_mfma_f32_16x16x32_bf16 v[152:155], a[104:107], a[76:79], v[152:155]
  s_add_u32 s70, s70, 16384
  v_mfma_f32_16x16x32_bf16 v[108:111], a[108:111], a[64:67], v[108:111]
  s_add_u32 s64, s64, s66
  s_add_u32 s65, s65, 1
  s_cmp_eq_u32 s65, 4
  s_cselect_b32 s65, 0, s65
  s_cselect_b32 s66, s67, s68
  v_mfma_f32_16x16x32_bf16 v[124:127], a[108:111], a[68:71], v[124:127]
  v_add_u32 v16, s66, v16
  v_add_u32 v17, s66, v17
  v_mfma_f32_16x16x32_bf16 v[140:143], a[108:111], a[72:75], v[140:143]
  v_add_u32 v18, s66, v18
  v_add_u32 v19, s66, v19
  v_mfma_f32_16x16x32_bf16 v[156:159], a[108:111], a[76:79], v[156:159]
  v_add_u32 v20, s66, v20
  v_add_u32 v21, s66, v21
  s_waitcnt vmcnt(6) lgkmcnt(0)
  s_barrier
  s_mov_b32 s5, 0x40000
Lpoll_17:
  v_cmp_ne_u64 vcc, s[94:95], v[6:7]
  s_nop 0
  s_cbranch_vccz Lpolld_18
  s_sleep 4
  buffer_load_dwordx2 v[6:7], off, s[96:99], s90 sc1
  s_sub_u32 s5, s5, 1
  s_waitcnt vmcnt(0)
  s_cbranch_scc0 Lpoll_17
Lpolld_18:
  v_mfma_f32_16x16x32_bf16 v[96:99], a[112:115], a[80:83], v[96:99]
  s_lshl_b32 s6, s78, 1
  s_add_u32 s6, s6, s77
  s_lshl_b32 s6, s6, 2
  v_mfma_f32_16x16x32_bf16 v[112:115], a[112:115], a[84:87], v[112:115]
  s_add_u32 s6, s6, s3
  s_lshl_b32 s6, s6, 13
  s_add_u32 s6, s6, 8388608
  v_mfma_f32_16x16x32_bf16 v[128:131], a[112:115], a[88:91], v[128:131]
  s_add_u32 s7, s6, 4096
  buffer_load_dwordx4 v[160:163], v2, s[16:19], s6 offen offset:0 sc1
  ds_read_b128 a[64:67], v16 offset:0
  v_mfma_f32_16x16x32_bf16 v[144:147], a[112:115], a[92:95], v[144:147]
  buffer_load_dwordx4 v[164:167], v2, s[16:19], s6 offen offset:1024 sc1
  ds_read_b64_tr_b16 a[96:97], v18 offset:16384
  v_mfma_f32_16x16x32_bf16 v[100:103], a[116:119], a[80:83], v[100:103]
  buffer_load_dwordx4 v[168:171], v2, s[16:19], s6 offen offset:2048 sc1
  ds_read_b64_tr_b16 a[98:99], v18 offset:18432
  v_mfma_f32_16x16x32_bf16 v[116:119], a[116:119], a[84:87], v[116:119]
  ds_read_b128 a[68:71], v16 offset:1024
  ds_read_b128 a[72:75], v17 offset:0
  v_mfma_f32_16x16x32_bf16 v[132:135], a[116:119], a[88:91], v[132:135]
  buffer_load_dwordx4 v[172:175], v2, s[16:19], s6 offen offset:3072 sc1
  ds_read_b128 a[76:79], v17 offset:1024
  v_mfma_f32_16x16x32_bf16 v[148:151], a[116:119], a[92:95], v[148:151]
  ds_read_b64_tr_b16 a[100:101], v19 offset:16384
  ds_read_b64_tr_b16 a[102:103], v19 offset:18432
  v_mfma_f32_16x16x32_bf16 v[104:107], a[120:123], a[80:83], v[104:107]
  buffer_load_dwordx4 v[176:179], v2, s[16:19], s7 offen offset:0 sc1
  ds_read_b64_tr_b16 a[104:105], v20 offset:16384
  v_mfma_f32_16x16x32_bf16 v[120:123], a[120:123], a[84:87], v[120:123]
  ds_read_b64_tr_b16 a[106:107], v20 offset:18432
  ds_read_b64_tr_b16 a[108:109], v21 offset:16384
  v_mfma_f32_16x16x32_bf16 v[136:139], a[120:123], a[88:91], v[136:139]
  buffer_load_dwordx4 v[180:183], v2, s[16:19], s7 offen offset:1024 sc1
  ds_read_b64_tr_b16 a[110:111], v21 offset:18432
  v_mfma_f32_16x16x32_bf16 v[152:155], a[120:123], a[92:95], v[152:155]
  v_mfma_f32_16x16x32_bf16 v[108:111], a[124:127], a[80:83], v[108:111]
  buffer_load_dwordx4 v[184:187], v2, s[16:19], s7 offen offset:2048 sc1
  v_mfma_f32_16x16x32_bf16 v[124:127], a[124:127], a[84:87], v[124:127]
  v_mfma_f32_16x16x32_bf16 v[140:143], a[124:127], a[88:91], v[140:143]
  v_mfma_f32_16x16x32_bf16 v[156:159], a[124:127], a[92:95], v[156:159]
  s_waitcnt lgkmcnt(0)
  v_mfma_f32_16x16x32_bf16 v[96:99], a[96:99], a[64:67], v[96:99]
  buffer_load_dwordx4 v[188:191], v2, s[16:19], s7 offen offset:3072 sc1
  ds_read_b128 a[80:83], v16 offset:8192
  v_mfma_f32_16x16x32_bf16 v[112:115], a[96:99], a[68:71], v[112:115]
  s_add_u32 m0, s64, 16384
  ds_read_b64_tr_b16 a[112:113], v18 offset:20480
  ds_read_b64_tr_b16 a[114:115], v18 offset:22528
  v_mfma_f32_16x16x32_bf16 v[128:131], a[96:99], a[72:75], v[128:131]
  buffer_load_dwordx4 v10, s[12:15], s71 offen offset:0 lds
  ds_read_b128 a[84:87], v16 offset:9216
  v_mfma_f32_16x16x32_bf16 v[144:147], a[96:99], a[76:79], v[144:147]
  ds_read_b128 a[88:91], v17 offset:8192
  ds_read_b128 a[92:95], v17 offset:9216
  v_mfma_f32_16x16x32_bf16 v[100:103], a[100:103], a[64:67], v[100:103]
  buffer_load_dwordx4 v11, s[12:15], s71 offen offset:1024 lds
  ds_read_b64_tr_b16 a[116:117], v19 offset:20480
  v_mfma_f32_16x16x32_bf16 v[116:119], a[100:103], a[68:71], v[116:119]
  ds_read_b64_tr_b16 a[118:119], v19 offset:22528
  ds_read_b64_tr_b16 a[120:121], v20 offset:20480
  v_mfma_f32_16x16x32_bf16 v[132:135], a[100:103], a[72:75], v[132:135]
  buffer_load_dwordx4 v12, s[12:15], s71 offen offset:2048 lds
  ds_read_b64_tr_b16 a[122:123], v20 offset:22528
  v_mfma_f32_16x16x32_bf16 v[148:151], a[100:103], a[76:79], v[148:151]
  ds_read_b64_tr_b16 a[124:125], v21 offset:20480
  ds_read_b64_tr_b16 a[126:127], v21 offset:22528
  v_mfma_f32_16x16x32_bf16 v[104:107], a[104:107], a[64:67], v[104:107]
  buffer_load_dwordx4 v13, s[12:15], s71 offen offset:3072 lds
  v_mfma_f32_16x16x32_bf16 v[120:123], a[104:107], a[68:71], v[120:123]
  s_add_u32 s71, s71, 131072
  s_add_u32 m0, s64, s88
  v_mfma_f32_16x16x32_bf16 v[136:139], a[104:107], a[72:75], v[136:139]
  buffer_load_dwordx4 v2, s[8:11], s70 offen offset:0 sc1 lds
  v_mfma_f32_16x16x32_bf16 v[152:155], a[104:107], a[76:79], v[152:155]
  v_mfma_f32_16x16x32_bf16 v[108:111], a[108:111], a[64:67], v[108:111]
  buffer_load_dwordx4 v2, s[8:11], s70 offen offset:1024 sc1 lds
  v_mfma_f32_16x16x32_bf16 v[124:127], a[108:111], a[68:71], v[124:127]
  s_add_u32 s70, s70, 16384
  v_mfma_f32_16x16x32_bf16 v[140:143], a[108:111], a[72:75], v[140:143]
  s_add_u32 s64, s64, s66
  s_add_u32 s65, s65, 1
  s_cmp_eq_u32 s65, 4
  s_cselect_b32 s65, 0, s65
  s_cselect_b32 s66, s67, s68
  v_mfma_f32_16x16x32_bf16 v[156:159], a[108:111], a[76:79], v[156:159]
  v_add_u32 v16, s66, v16
  v_add_u32 v17, s66, v17
  v_add_u32 v18, s66, v18
  v_add_u32 v19, s66, v19
  v_add_u32 v20, s66, v20
  v_add_u32 v21, s66, v21
  s_waitcnt vmcnt(20) lgkmcnt(0)
  s_barrier
  v_mfma_f32_16x16x32_bf16 v[96:99], a[112:115], a[80:83], v[96:99]
  s_add_u32 m0, s64, 16384
  ds_read_b128 a[64:67], v16 offset:0
  ds_read_b64_tr_b16 a[96:97], v18 offset:16384
  v_mfma_f32_16x16x32_bf16 v[112:115], a[112:115], a[84:87], v[112:115]
  buffer_load_dwordx4 v10, s[12:15], s71 offen offset:0 lds
  ds_read_b64_tr_b16 a[98:99], v18 offset:18432
  v_mfma_f32_16x16x32_bf16 v[128:131], a[112:115], a[88:91], v[128:131]
  ds_read_b128 a[68:71], v16 offset:1024
  ds_read_b128 a[72:75], v17 offset:0
  v_mfma_f32_16x16x32_bf16 v[144:147], a[112:115], a[92:95], v[144:147]
  ds_read_b128 a[76:79], v17 offset:1024
  ds_read_b64_tr_b16 a[100:101], v19 offset:16384
  v_mfma_f32_16x16x32_bf16 v[100:103], a[116:119], a[80:83], v[100:103]
  ds_read_b64_tr_b16 a[102:103], v19 offset:18432
  ds_read_b64_tr_b16 a[104:105], v20 offset:16384
  v_mfma_f32_16x16x32_bf16 v[116:119], a[116:119], a[84:87], v[116:119]
  buffer_load_dwordx4 v11, s[12:15], s71 offen offset:1024 lds
  ds_read_b64_tr_b16 a[106:107], v20 offset:18432
  v_mfma_f32_16x16x32_bf16 v[132:135], a[116:119], a[88:91], v[132:135]
  ds_read_b64_tr_b16 a[108:109], v21 offset:16384
  ds_read_b64_tr_b16 a[110:111], v21 offset:18432
  v_mfma_f32_16x16x32_bf16 v[148:151], a[116:119], a[92:95], v[148:151]
  v_mfma_f32_16x16x32_bf16 v[104:107], a[120:123], a[80:83], v[104:107]
  v_mfma_f32_16x16x32_bf16 v[120:123], a[120:123], a[84:87], v[120:123]
  v_mfma_f32_16x16x32_bf16 v[136:139], a[120:123], a[88:91], v[136:139]
  buffer_load_dwordx4 v12, s[12:15], s71 offen offset:2048 lds
  v_mfma_f32_16x16x32_bf16 v[152:155], a[120:123], a[92:95], v[152:155]
  v_mfma_f32_16x16x32_bf16 v[108:111], a[124:127], a[80:83], v[108:111]
  v_mfma_f32_16x16x32_bf16 v[124:127], a[124:127], a[84:87], v[124:127]
  v_mfma_f32_16x16x32_bf16 v[140:143], a[124:127], a[88:91], v[140:143]
  v_mfma_f32_16x16x32_bf16 v[156:159], a[124:127], a[92:95], v[156:159]
  s_waitcnt lgkmcnt(0)
  v_mfma_f32_16x16x32_bf16 v[96:99], a[96:99], a[64:67], v[96:99]
  buffer_load_dwordx4 v13, s[12:15], s71 offen offset:3072 lds
  ds_read_b128 a[80:83], v16 offset:8192
  v_mfma_f32_16x16x32_bf16 v[112:115], a[96:99], a[68:71], v[112:115]
  s_add_u32 s71, s71, 131072
  s_add_u32 m0, s64, s88
  ds_read_b64_tr_b16 a[112:113], v18 offset:20480
  v_mfma_f32_16x16x32_bf16 v[128:131], a[96:99], a[72:75], v[128:131]
  ds_read_b64_tr_b16 a[114:115], v18 offset:22528
  ds_read_b128 a[84:87], v16 offset:9216
  v_mfma_f32_16x16x32_bf16 v[144:147], a[96:99], a[76:79], v[144:147]
  ds_read_b128 a[88:91], v17 offset:8192
  ds_read_b128 a[92:95], v17 offset:9216
  v_mfma_f32_16x16x32_bf16 v[100:103], a[100:103], a[64:67], v[100:103]
  ds_read_b64_tr_b16 a[116:117], v19 offset:20480
  ds_read_b64_tr_b16 a[118:119], v19 offset:22528
  v_mfma_f32_16x16x32_bf16 v[116:119], a[100:103], a[68:71], v[116:119]
  buffer_load_dwordx4 v2, s[8:11], s70 offen offset:0 sc1 lds
  ds_read_b64_tr_b16 a[120:121], v20 offset:20480
  v_mfma_f32_16x16x32_bf16 v[132:135], a[100:103], a[72:75], v[132:135]
  ds_read_b64_tr_b16 a[122:123], v20 offset:22528
  ds_read_b64_tr_b16 a[124:125], v21 offset:20480
  v_mfma_f32_16x16x32_bf16 v[148:151], a[100:103], a[76:79], v[148:151]
  ds_read_b64_tr_b16 a[126:127], v21 offset:22528
  v_mfma_f32_16x16x32_bf16 v[104:107], a[104:107], a[64:67], v[104:107]
  v_mfma_f32_16x16x32_bf16 v[120:123], a[104:107], a[68:71], v[120:123]
  v_mfma_f32_16x16x32_bf16 v[136:139], a[104:107], a[72:75], v[136:139]
  buffer_load_dwordx4 v2, s[8:11], s70 offen offset:1024 sc1 lds
  v_mfma_f32_16x16x32_bf16 v[152:155], a[104:107], a[76:79], v[152:155]
  s_add_u32 s70, s70, 16384
  v_mfma_f32_16x16x32_bf16 v[108:111], a[108:111], a[64:67], v[108:111]
  s_add_u32 s64, s64, s66
  s_add_u32 s65, s65, 1
  s_cmp_eq_u32 s65, 4
  s_cselect_b32 s65, 0, s65
  s_cselect_b32 s66, s67, s68
  v_mfma_f32_16x16x32_bf16 v[124:127], a[108:111], a[68:71], v[124:127]
  v_add_u32 v16, s66, v16
  v_add_u32 v17, s66, v17
  v_mfma_f32_16x16x32_bf16 v[140:143], a[108:111], a[72:75], v[140:143]
  v_add_u32 v18, s66, v18
  v_add_u32 v19, s66, v19
  v_mfma_f32_16x16x32_bf16 v[156:159], a[108:111], a[76:79], v[156:159]
  v_add_u32 v20, s66, v20
  v_add_u32 v21, s66, v21
  s_waitcnt vmcnt(12) lgkmcnt(0)
  s_barrier
  s_lshl_b32 s4, s73, 19
  s_lshl_b32 s72, s76, 8
  s_add_u32 s4, s4, s72
  s_and_b32 s72, s3, 1
  s_lshl_b32 s72, s72, 7
  s_add_u32 s4, s4, s72
  s_lshr_b32 s72, s3, 1
  s_lshl_b32 s72, s72, 1
  s_add_u32 s72, s72, s77
  s_lshl_b32 s72, s72, 17
  s_add_u32 s4, s4, s72
  s_add_u32 s4, s4, 2048
  s_add_u32 s5, s4, 65536
  s_lshl_b32 s89, s78, 1
  s_add_u32 s89, s89, s77
  s_lshl_b32 s89, s89, 7
  s_add_u32 s89, s89, 131072
  s_lshl_b32 s90, s78, 1
  s_add_u32 s90, s90, s77
  s_xor_b32 s90, s90, 1
  s_lshl_b32 s90, s90, 7
  s_add_u32 s90, s90, 131072
  v_mfma_f32_16x16x32_bf16 v[96:99], a[112:115], a[80:83], v[96:99]
  s_add_u32 m0, s64, 16384
  ds_read_b128 a[64:67], v16 offset:0
  ds_read_b64_tr_b16 a[96:97], v18 offset:16384
  v_mfma_f32_16x16x32_bf16 v[112:115], a[112:115], a[84:87], v[112:115]
  buffer_load_dwordx4 v10, s[12:15], s71 offen offset:0 lds
  ds_read_b64_tr_b16 a[98:99], v18 offset:18432
  v_mfma_f32_16x16x32_bf16 v[128:131], a[112:115], a[88:91], v[128:131]
  buffer_load_dwordx4 v11, s[12:15], s71 offen offset:1024 lds
  ds_read_b128 a[68:71], v16 offset:1024
  v_mfma_f32_16x16x32_bf16 v[144:147], a[112:115], a[92:95], v[144:147]
  ds_read_b64_tr_b16 a[100:101], v19 offset:16384
  ds_read_b64_tr_b16 a[102:103], v19 offset:18432
  v_mfma_f32_16x16x32_bf16 v[100:103], a[116:119], a[80:83], v[100:103]
  ds_read_b64_tr_b16 a[104:105], v20 offset:16384
  ds_read_b64_tr_b16 a[106:107], v20 offset:18432
  v_mfma_f32_16x16x32_bf16 v[116:119], a[116:119], a[84:87], v[116:119]
  buffer_load_dwordx4 v12, s[12:15], s71 offen offset:2048 lds
  ds_read_b64_tr_b16 a[108:109], v21 offset:16384
  v_mfma_f32_16x16x32_bf16 v[132:135], a[116:119], a[88:91], v[132:135]
  ds_read_b64_tr_b16 a[110:111], v21 offset:18432
  v_mfma_f32_16x16x32_bf16 v[148:151], a[116:119], a[92:95], v[148:151]
  buffer_load_dwordx4 v13, s[12:15], s71 offen offset:3072 lds
  v_mfma_f32_16x16x32_bf16 v[104:107], a[120:123], a[80:83], v[104:107]
  s_add_u32 s71, s71, 131072
  s_add_u32 m0, s64, s88
  v_mfma_f32_16x16x32_bf16 v[120:123], a[120:123], a[84:87], v[120:123]
  v_mfma_f32_16x16x32_bf16 v[136:139], a[120:123], a[88:91], v[136:139]
  buffer_load_dwordx4 v2, s[8:11], s70 offen offset:0 sc1 lds
  v_mfma_f32_16x16x32_bf16 v[152:155], a[120:123], a[92:95], v[152:155]
  v_mfma_f32_16x16x32_bf16 v[108:111], a[124:127], a[80:83], v[108:111]
  buffer_load_dwordx4 v2, s[8:11], s70 offen offset:1024 sc1 lds
  v_mfma_f32_16x16x32_bf16 v[124:127], a[124:127], a[84:87], v[124:127]
  s_add_u32 s70, s70, 16384
  s_lshl_b32 s6, s78, 1
  s_add_u32 s6, s6, s77
  v_mfma_f32_16x16x32_bf16 v[140:143], a[124:127], a[88:91], v[140:143]
  s_xor_b32 s6, s6, 1
  s_lshl_b32 s6, s6, 2
  s_add_u32 s6, s6, s3
  v_mfma_f32_16x16x32_bf16 v[156:159], a[124:127], a[92:95], v[156:159]
  s_lshl_b32 s6, s6, 13
  s_add_u32 s7, s6, 4096
  s_waitcnt lgkmcnt(0)
  v_mfma_f32_16x16x32_bf16 v[96:99], a[96:99], a[64:67], v[96:99]
  buffer_store_dwordx4 v[128:131], v2, s[16:19], s6 offen offset:0 sc1
  ds_read_b128 a[80:83], v16 offset:8192
  v_mfma_f32_16x16x32_bf16 v[112:115], a[96:99], a[68:71], v[112:115]
  buffer_store_dwordx4 v[132:135], v2, s[16:19], s6 offen offset:1024 sc1
  ds_read_b64_tr_b16 a[112:113], v18 offset:20480
  v_mfma_f32_16x16x32_bf16 v[100:103], a[100:103], a[64:67], v[100:103]
  ds_read_b64_tr_b16 a[114:115], v18 offset:22528
  ds_read_b128 a[84:87], v16 offset:9216
  v_mfma_f32_16x16x32_bf16 v[116:119], a[100:103], a[68:71], v[116:119]
  buffer_store_dwordx4 v[136:139], v2, s[16:19], s6 offen offset:2048 sc1
  ds_read_b64_tr_b16 a[116:117], v19 offset:20480
  v_mfma_f32_16x16x32_bf16 v[104:107], a[104:107], a[64:67], v[104:107]
  ds_read_b64_tr_b16 a[118:119], v19 offset:22528
  ds_read_b64_tr_b16 a[120:121], v20 offset:20480
  v_mfma_f32_16x16x32_bf16 v[120:123], a[104:107], a[68:71], v[120:123]
  buffer_store_dwordx4 v[140:143], v2, s[16:19], s6 offen offset:3072 sc1
  ds_read_b64_tr_b16 a[122:123], v20 offset:22528
  v_mfma_f32_16x16x32_bf16 v[108:111], a[108:111], a[64:67], v[108:111]
  s_add_u32 s64, s64, s66
  ds_read_b64_tr_b16 a[124:125], v21 offset:20480
  ds_read_b64_tr_b16 a[126:127], v21 offset:22528
  v_mfma_f32_16x16x32_bf16 v[124:127], a[108:111], a[68:71], v[124:127]
  s_add_u32 s65, s65, 1
  s_cmp_eq_u32 s65, 4
  s_cselect_b32 s65, 0, s65
  s_cselect_b32 s66, s67, s68
  v_add_u32 v16, s66, v16
  v_add_u32 v17, s66, v17
  v_add_u32 v18, s66, v18
  v_add_u32 v19, s66, v19
  v_add_u32 v20, s66, v20
  v_add_u32 v21, s66, v21
  s_waitcnt vmcnt(16) lgkmcnt(0)
  s_barrier
  v_mfma_f32_16x16x32_bf16 v[96:99], a[112:115], a[80:83], v[96:99]
  buffer_store_dwordx4 v[144:147], v2, s[16:19], s7 offen offset:0 sc1
  ds_read_b128 a[64:67], v16 offset:0
  v_mfma_f32_16x16x32_bf16 v[112:115], a[112:115], a[84:87], v[112:115]
  buffer_store_dwordx4 v[148:151], v2, s[16:19], s7 offen offset:1024 sc1
  ds_read_b64_tr_b16 a[96:97], v18 offset:16384
  v_mfma_f32_16x16x32_bf16 v[100:103], a[116:119], a[80:83], v[100:103]
  ds_read_b64_tr_b16 a[98:99], v18 offset:18432
  ds_read_b128 a[68:71], v16 offset:1024
  v_mfma_f32_16x16x32_bf16 v[116:119], a[116:119], a[84:87], v[116:119]
  buffer_store_dwordx4 v[152:155], v2, s[16:19], s7 offen offset:2048 sc1
  ds_read_b64_tr_b16 a[100:101], v19 offset:16384
  v_mfma_f32_16x16x32_bf16 v[104:107], a[120:123], a[80:83], v[104:107]
  ds_read_b64_tr_b16 a[102:103], v19 offset:18432
  ds_read_b64_tr_b16 a[104:105], v20 offset:16384
  v_mfma_f32_16x16x32_bf16 v[120:123], a[120:123], a[84:87], v[120:123]
  buffer_store_dwordx4 v[156:159], v2, s[16:19], s7 offen offset:3072 sc1
  ds_read_b64_tr_b16 a[106:107], v20 offset:18432
  v_mfma_f32_16x16x32_bf16 v[108:111], a[124:127], a[80:83], v[108:111]
  ds_read_b64_tr_b16 a[108:109], v21 offset:16384
  ds_read_b64_tr_b16 a[110:111], v21 offset:18432
  v_mfma_f32_16x16x32_bf16 v[124:127], a[124:127], a[84:87], v[124:127]
  v_pk_add_f32 v[160:161], v[160:161], v[32:33]
  v_pk_add_f32 v[162:163], v[162:163], v[34:35]
  v_pk_add_f32 v[164:165], v[164:165], v[36:37]
  v_pk_add_f32 v[166:167], v[166:167], v[38:39]
  v_cvt_pk_bf16_f32 v160, v160, v161
  v_cvt_pk_bf16_f32 v161, v162, v163
  v_cvt_pk_bf16_f32 v162, v164, v165
  v_cvt_pk_bf16_f32 v163, v166, v167
  s_nop 0
  v_permlane16_swap_b32 v160, v162
  v_permlane16_swap_b32 v161, v163
  s_waitcnt lgkmcnt(0)
  v_mfma_f32_16x16x32_bf16 v[96:99], a[96:99], a[64:67], v[96:99]
  s_sub_u32 s70, s70, 65536
  s_xor_b32 s70, s70, 524288
  s_sub_u32 s71, s71, 524288
  v_mfma_f32_16x16x32_bf16 v[112:115], a[96:99], a[68:71], v[112:115]
  s_xor_b32 s71, s71, 4194304
  s_add_u32 m0, s64, 16384
  ds_read_b128 a[80:83], v16 offset:8192
  v_mfma_f32_16x16x32_bf16 v[100:103], a[100:103], a[64:67], v[100:103]
  buffer_load_dwordx4 v10, s[12:15], s71 offen offset:0 lds
  ds_read_b64_tr_b16 a[112:113], v18 offset:20480
  v_mfma_f32_16x16x32_bf16 v[116:119], a[100:103], a[68:71], v[116:119]
  buffer_load_dwordx4 v11, s[12:15], s71 offen offset:1024 lds
  ds_read_b64_tr_b16 a[114:115], v18 offset:22528
  v_mfma_f32_16x16x32_bf16 v[104:107], a[104:107], a[64:67], v[104:107]
  buffer_load_dwordx4 v12, s[12:15], s71 offen offset:2048 lds
  ds_read_b128 a[84:87], v16 offset:9216
  v_mfma_f32_16x16x32_bf16 v[120:123], a[104:107], a[68:71], v[120:123]
  buffer_load_dwordx4 v13, s[12:15], s71 offen offset:3072 lds
  ds_read_b64_tr_b16 a[116:117], v19 offset:20480
  v_mfma_f32_16x16x32_bf16 v[108:111], a[108:111], a[64:67], v[108:111]
  s_add_u32 s71, s71, 131072
  s_add_u32 m0, s64, s88
  ds_read_b64_tr_b16 a[118:119], v19 offset:22528
  ds_read_b64_tr_b16 a[120:121], v20 offset:20480
  v_mfma_f32_16x16x32_bf16 v[124:127], a[108:111], a[68:71], v[124:127]
  buffer_load_dwordx4 v2, s[8:11], s70 offen offset:0 sc1 lds
  buffer_load_dwordx4 v2, s[8:11], s70 offen offset:1024 sc1 lds
  ds_read_b64_tr_b16 a[122:123], v20 offset:22528
  ds_read_b64_tr_b16 a[124:125], v21 offset:20480
  ds_read_b64_tr_b16 a[126:127], v21 offset:22528
  s_add_u32 s70, s70, 16384
  s_add_u32 s64, s64, s66
  s_add_u32 s65, s65, 1
  s_cmp_eq_u32 s65, 4
  s_cselect_b32 s65, 0, s65
  s_cselect_b32 s66, s67, s68
  v_add_u32 v16, s66, v16
  v_add_u32 v17, s66, v17
  v_add_u32 v18, s66, v18
  v_add_u32 v19, s66, v19
  v_add_u32 v20, s66, v20
  v_add_u32 v21, s66, v21
  buffer_store_dwordx4 v[160:163], v27, s[20:23], s4 offen offset:0
  s_waitcnt vmcnt(21) lgkmcnt(0)
  s_barrier
  v_mfma_f32_16x16x32_bf16 v[96:99], a[112:115], a[80:83], v[96:99]
  s_add_u32 m0, s64, 16384
  ds_read_b128 a[64:67], v16 offset:0
  ds_read_b64_tr_b16 a[96:97], v18 offset:16384
  v_mfma_f32_16x16x32_bf16 v[112:115], a[112:115], a[84:87], v[112:115]
  buffer_load_dwordx4 v10, s[12:15], s71 offen offset:0 lds
  ds_read_b64_tr_b16 a[98:99], v18 offset:18432
  v_mfma_f32_16x16x32_bf16 v[100:103], a[116:119], a[80:83], v[100:103]
  buffer_load_dwordx4 v11, s[12:15], s71 offen offset:1024 lds
  ds_read_b128 a[68:71], v16 offset:1024
  v_mfma_f32_16x16x32_bf16 v[116:119], a[116:119], a[84:87], v[116:119]
  ds_read_b64_tr_b16 a[100:101], v19 offset:16384
  ds_read_b64_tr_b16 a[102:103], v19 offset:18432
  v_mfma_f32_16x16x32_bf16 v[104:107], a[120:123], a[80:83], v[104:107]
  buffer_load_dwordx4 v12, s[12:15], s71 offen offset:2048 lds
  ds_read_b64_tr_b16 a[104:105], v20 offset:16384
  v_mfma_f32_16x16x32_bf16 v[120:123], a[120:123], a[84:87], v[120:123]
  ds_read_b64_tr_b16 a[106:107], v20 offset:18432
  ds_read_b64_tr_b16 a[108:109], v21 offset:16384
  v_mfma_f32_16x16x32_bf16 v[108:111], a[124:127], a[80:83], v[108:111]
  ds_read_b64_tr_b16 a[110:111], v21 offset:18432
  v_pk_add_f32 v[168:169], v[168:169], v[40:41]
  v_mfma_f32_16x16x32_bf16 v[124:127], a[124:127], a[84:87], v[124:127]
  v_pk_add_f32 v[170:171], v[170:171], v[42:43]
  v_pk_add_f32 v[172:173], v[172:173], v[44:45]
  v_pk_add_f32 v[174:175], v[174:175], v[46:47]
  v_cvt_pk_bf16_f32 v168, v168, v169
  v_cvt_pk_bf16_f32 v169, v170, v171
  v_cvt_pk_bf16_f32 v170, v172, v173
  v_cvt_pk_bf16_f32 v171, v174, v175
  s_nop 0
  v_permlane16_swap_b32 v168, v170
  v_permlane16_swap_b32 v169, v171
  s_waitcnt lgkmcnt(0)
  v_mfma_f32_16x16x32_bf16 v[96:99], a[96:99], a[64:67], v[96:99]
  buffer_load_dwordx4 v13, s[12:15], s71 offen offset:3072 lds
  ds_read_b128 a[80:83], v16 offset:8192
  v_mfma_f32_16x16x32_bf16 v[112:115], a[96:99], a[68:71], v[112:115]
  s_add_u32 s71, s71, 131072
  s_add_u32 m0, s64, s88
  ds_read_b64_tr_b16 a[112:113], v18 offset:20480
  v_mfma_f32_16x16x32_bf16 v[100:103], a[100:103], a[64:67], v[100:103]
  buffer_load_dwordx4 v2, s[8:11], s70 offen offset:0 sc1 lds
  ds_read_b64_tr_b16 a[114:115], v18 offset:22528
  v_mfma_f32_16x16x32_bf16 v[116:119], a[100:103], a[68:71], v[116:119]
  ds_read_b128 a[84:87], v16 offset:9216
  ds_read_b64_tr_b16 a[116:117], v19 offset:20480
  v_mfma_f32_16x16x32_bf16 v[104:107], a[104:107], a[64:67], v[104:107]
  buffer_load_dwordx4 v2, s[8:11], s70 offen offset:1024 sc1 lds
  ds_read_b64_tr_b16 a[118:119], v19 offset:22528
  v_mfma_f32_16x16x32_bf16 v[120:123], a[104:107], a[68:71], v[120:123]
  s_add_u32 s70, s70, 16384
  ds_read_b64_tr_b16 a[120:121], v20 offset:20480
  ds_read_b64_tr_b16 a[122:123], v20 offset:22528
  v_mfma_f32_16x16x32_bf16 v[108:111], a[108:111], a[64:67], v[108:111]
  s_add_u32 s64, s64, s66
  ds_read_b64_tr_b16 a[124:125], v21 offset:20480
  ds_read_b64_tr_b16 a[126:127], v21 offset:22528
  v_mfma_f32_16x16x32_bf16 v[124:127], a[108:111], a[68:71], v[124:127]
  s_add_u32 s65, s65, 1
  s_cmp_eq_u32 s65, 4
  s_cselect_b32 s65, 0, s65
  s_cselect_b32 s66, s67, s68
  v_add_u32 v16, s66, v16
  v_add_u32 v17, s66, v17
  v_add_u32 v18, s66, v18
  v_add_u32 v19, s66, v19
  v_add_u32 v20, s66, v20
  v_add_u32 v21, s66, v21
  buffer_store_dwordx4 v[168:171], v27, s[20:23], s4 offen offset:64
  s_waitcnt vmcnt(14) lgkmcnt(0)
  s_barrier
  v_mov_b32 v8, 0x40000000
  v_mov_b32 v6, s94
  v_cmp_eq_u32 vcc, 0, v0
  v_mov_b32 v7, s95
  s_nop 0
  v_cndmask_b32_e64 v8, v8, 0, vcc
  buffer_store_dwordx2 v[6:7], v8, s[96:99], s89 offen sc1
  v_mfma_f32_16x16x32_bf16 v[96:99], a[112:115], a[80:83], v[96:99]
  s_add_u32 m0, s64, 16384
  ds_read_b128 a[64:67], v16 offset:0
  ds_read_b64_tr_b16 a[96:97], v18 offset:16384
  v_mfma_f32_16x16x32_bf16 v[112:115], a[112:115], a[84:87], v[112:115]
  buffer_load_dwordx4 v10, s[12:15], s71 offen offset:0 lds
  ds_read_b64_tr_b16 a[98:99], v18 offset:18432
  v_mfma_f32_16x16x32_bf16 v[100:103], a[116:119], a[80:83], v[100:103]
  buffer_load_dwordx4 v11, s[12:15], s71 offen offset:1024 lds
  ds_read_b128 a[68:71], v16 offset:1024
  v_mfma_f32_16x16x32_bf16 v[116:119], a[116:119], a[84:87], v[116:119]
  ds_read_b64_tr_b16 a[100:101], v19 offset:16384
  ds_read_b64_tr_b16 a[102:103], v19 offset:18432
  v_mfma_f32_16x16x32_bf16 v[104:107], a[120:123], a[80:83], v[104:107]
  buffer_load_dwordx4 v12, s[12:15], s71 offen offset:2048 lds
  ds_read_b64_tr_b16 a[104:105], v20 offset:16384
  v_mfma_f32_16x16x32_bf16 v[120:123], a[120:123], a[84:87], v[120:123]
  ds_read_b64_tr_b16 a[106:107], v20 offset:18432
  ds_read_b64_tr_b16 a[108:109], v21 offset:16384
  v_mfma_f32_16x16x32_bf16 v[108:111], a[124:127], a[80:83], v[108:111]
  ds_read_b64_tr_b16 a[110:111], v21 offset:18432
  v_pk_add_f32 v[176:177], v[176:177], v[48:49]
  v_mfma_f32_16x16x32_bf16 v[124:127], a[124:127], a[84:87], v[124:127]
  v_pk_add_f32 v[178:179], v[178:179], v[50:51]
  v_pk_add_f32 v[180:181], v[180:181], v[52:53]
  v_pk_add_f32 v[182:183], v[182:183], v[54:55]
  v_cvt_pk_bf16_f32 v176, v176, v177
  v_cvt_pk_bf16_f32 v177, v178, v179
  v_cvt_pk_bf16_f32 v178, v180, v181
  v_cvt_pk_bf16_f32 v179, v182, v183
  s_nop 0
  v_permlane16_swap_b32 v176, v178
  v_permlane16_swap_b32 v177, v179
  s_waitcnt lgkmcnt(0)
  v_mfma_f32_16x16x32_bf16 v[96:99], a[96:99], a[64:67], v[96:99]
  buffer_load_dwordx4 v13, s[12:15], s71 offen offset:3072 lds
  ds_read_b128 a[80:83], v16 offset:8192
  v_mfma_f32_16x16x32_bf16 v[112:115], a[96:99], a[68:71], v[112:115]
  s_add_u32 s71, s71, 131072
  s_add_u32 m0, s64, s88
  ds_read_b64_tr_b16 a[112:113], v18 offset:20480
  v_mfma_f32_16x16x32_bf16 v[100:103], a[100:103], a[64:67], v[100:103]
  buffer_load_dwordx4 v2, s[8:11], s70 offen offset:0 sc1 lds
  ds_read_b64_tr_b16 a[114:115], v18 offset:22528
  v_mfma_f32_16x16x32_bf16 v[116:119], a[100:103], a[68:71], v[116:119]
  ds_read_b128 a[84:87], v16 offset:9216
  ds_read_b64_tr_b16 a[116:117], v19 offset:20480
  v_mfma_f32_16x16x32_bf16 v[104:107], a[104:107], a[64:67], v[104:107]
  buffer_load_dwordx4 v2, s[8:11], s70 offen offset:1024 sc1 lds
  ds_read_b64_tr_b16 a[118:119], v19 offset:22528
  v_mfma_f32_16x16x32_bf16 v[120:123], a[104:107], a[68:71], v[120:123]
  s_add_u32 s70, s70, 16384
  ds_read_b64_tr_b16 a[120:121], v20 offset:20480
  ds_read_b64_tr_b16 a[122:123], v20 offset:22528
  v_mfma_f32_16x16x32_bf16 v[108:111], a[108:111], a[64:67], v[108:111]
  s_add_u32 s64, s64, s66
  ds_read_b64_tr_b16 a[124:125], v21 offset:20480
  ds_read_b64_tr_b16 a[126:127], v21 offset:22528
  v_mfma_f32_16x16x32_bf16 v[124:127], a[108:111], a[68:71], v[124:127]
  s_add_u32 s65, s65, 1
  s_cmp_eq_u32 s65, 4
  s_cselect_b32 s65, 0, s65
  s_cselect_b32 s66, s67, s68
  v_add_u32 v16, s66, v16
  v_add_u32 v17, s66, v17
  v_add_u32 v18, s66, v18
  v_add_u32 v19, s66, v19
  v_add_u32 v20, s66, v20
  v_add_u32 v21, s66, v21
  buffer_store_dwordx4 v[176:179], v27, s[20:23], s5 offen offset:0
  s_waitcnt vmcnt(16) lgkmcnt(0)
  s_barrier
  v_mfma_f32_16x16x32_bf16 v[96:99], a[112:115], a[80:83], v[96:99]
  s_add_u32 m0, s64, 16384
  ds_read_b128 a[64:67], v16 offset:0
  ds_read_b64_tr_b16 a[96:97], v18 offset:16384
  v_mfma_f32_16x16x32_bf16 v[112:115], a[112:115], a[84:87], v[112:115]
  buffer_load_dwordx4 v10, s[12:15], s71 offen offset:0 lds
  ds_read_b64_tr_b16 a[98:99], v18 offset:18432
  v_mfma_f32_16x16x32_bf16 v[100:103], a[116:119], a[80:83], v[100:103]
  buffer_load_dwordx4 v11, s[12:15], s71 offen offset:1024 lds
  ds_read_b128 a[68:71], v16 offset:1024
  v_mfma_f32_16x16x32_bf16 v[116:119], a[116:119], a[84:87], v[116:119]
  ds_read_b64_tr_b16 a[100:101], v19 offset:16384
  ds_read_b64_tr_b16 a[102:103], v19 offset:18432
  v_mfma_f32_16x16x32_bf16 v[104:107], a[120:123], a[80:83], v[104:107]
  buffer_load_dwordx4 v12, s[12:15], s71 offen offset:2048 lds
  ds_read_b64_tr_b16 a[104:105], v20 offset:16384
  v_mfma_f32_16x16x32_bf16 v[120:123], a[120:123], a[84:87], v[120:123]
  ds_read_b64_tr_b16 a[106:107], v20 offset:18432
  ds_read_b64_tr_b16 a[108:109], v21 offset:16384
  v_mfma_f32_16x16x32_bf16 v[108:111], a[124:127], a[80:83], v[108:111]
  ds_read_b64_tr_b16 a[110:111], v21 offset:18432
  v_pk_add_f32 v[184:185], v[184:185], v[56:57]
  v_mfma_f32_16x16x32_bf16 v[124:127], a[124:127], a[84:87], v[124:127]
  v_pk_add_f32 v[186:187], v[186:187], v[58:59]
  v_pk_add_f32 v[188:189], v[188:189], v[60:61]
  v_pk_add_f32 v[190:191], v[190:191], v[62:63]
  v_cvt_pk_bf16_f32 v184, v184, v185
  v_cvt_pk_bf16_f32 v185, v186, v187
  v_cvt_pk_bf16_f32 v186, v188, v189
  v_cvt_pk_bf16_f32 v187, v190, v191
  s_nop 0
  v_permlane16_swap_b32 v184, v186
  v_permlane16_swap_b32 v185, v187
  s_waitcnt lgkmcnt(0)
  v_mfma_f32_16x16x32_bf16 v[96:99], a[96:99], a[64:67], v[96:99]
  buffer_load_dwordx4 v13, s[12:15], s71 offen offset:3072 lds
  ds_read_b128 a[80:83], v16 offset:8192
  v_mfma_f32_16x16x32_bf16 v[112:115], a[96:99], a[68:71], v[112:115]
  s_add_u32 s71, s71, 131072
  s_add_u32 m0, s64, s88
  ds_read_b64_tr_b16 a[112:113], v18 offset:20480
  v_mfma_f32_16x16x32_bf16 v[100:103], a[100:103], a[64:67], v[100:103]
  buffer_load_dwordx4 v2, s[8:11], s70 offen offset:0 sc1 lds
  ds_read_b64_tr_b16 a[114:115], v18 offset:22528
  v_mfma_f32_16x16x32_bf16 v[116:119], a[100:103], a[68:71], v[116:119]
  ds_read_b128 a[84:87], v16 offset:9216
  ds_read_b64_tr_b16 a[116:117], v19 offset:20480
  v_mfma_f32_16x16x32_bf16 v[104:107], a[104:107], a[64:67], v[104:107]
  buffer_load_dwordx4 v2, s[8:11], s70 offen offset:1024 sc1 lds
  ds_read_b64_tr_b16 a[118:119], v19 offset:22528
  v_mfma_f32_16x16x32_bf16 v[120:123], a[104:107], a[68:71], v[120:123]
  s_add_u32 s70, s70, 16384
  ds_read_b64_tr_b16 a[120:121], v20 offset:20480
  ds_read_b64_tr_b16 a[122:123], v20 offset:22528
  v_mfma_f32_16x16x32_bf16 v[108:111], a[108:111], a[64:67], v[108:111]
  s_add_u32 s64, s64, s66
  ds_read_b64_tr_b16 a[124:125], v21 offset:20480
  ds_read_b64_tr_b16 a[126:127], v21 offset:22528
  v_mfma_f32_16x16x32_bf16 v[124:127], a[108:111], a[68:71], v[124:127]
  s_add_u32 s65, s65, 1
  s_cmp_eq_u32 s65, 4
  s_cselect_b32 s65, 0, s65
  s_cselect_b32 s66, s67, s68
  v_add_u32 v16, s66, v16
  v_add_u32 v17, s66, v17
  v_add_u32 v18, s66, v18
  v_add_u32 v19, s66, v19
  v_add_u32 v20, s66, v20
  v_add_u32 v21, s66, v21
  buffer_store_dwordx4 v[184:187], v27, s[20:23], s5 offen offset:64
  s_waitcnt vmcnt(16) lgkmcnt(0)
  s_barrier
  v_mfma_f32_16x16x32_bf16 v[96:99], a[112:115], a[80:83], v[96:99]
  buffer_load_dwordx2 v[6:7], off, s[96:99], s90 sc1
  ds_read_b128 a[64:67], v16 offset:0
  v_mfma_f32_16x16x32_bf16 v[112:115], a[112:115], a[84:87], v[112:115]
  ds_read_b64_tr_b16 a[96:97], v18 offset:16384
  ds_read_b64_tr_b16 a[98:99], v18 offset:18432
  v_mfma_f32_16x16x32_bf16 v[100:103], a[116:119], a[80:83], v[100:103]
  ds_read_b128 a[68:71], v16 offset:1024
  ds_read_b64_tr_b16 a[100:101], v19 offset:16384
  v_mfma_f32_16x16x32_bf16 v[116:119], a[116:119], a[84:87], v[116:119]
  ds_read_b64_tr_b16 a[102:103], v19 offset:18432
  ds_read_b64_tr_b16 a[104:105], v20 offset:16384
  v_mfma_f32_16x16x32_bf16 v[104:107], a[120:123], a[80:83], v[104:107]
  ds_read_b64_tr_b16 a[106:107], v20 offset:18432
  ds_read_b64_tr_b16 a[108:109], v21 offset:16384
  v_mfma_f32_16x16x32_bf16 v[120:123], a[120:123], a[84:87], v[120:123]
  ds_read_b64_tr_b16 a[110:111], v21 offset:18432
  v_mfma_f32_16x16x32_bf16 v[108:111], a[124:127], a[80:83], v[108:111]
  v_mfma_f32_16x16x32_bf16 v[124:127], a[124:127], a[84:87], v[124:127]
  s_waitcnt lgkmcnt(0)
  v_mfma_f32_16x16x32_bf16 v[96:99], a[96:99], a[64:67], v[96:99]
  s_add_u32 s64, s64, s66
  ds_read_b128 a[80:83], v16 offset:8192
  ds_read_b64_tr_b16 a[112:113], v18 offset:20480
  v_mfma_f32_16x16x32_bf16 v[112:115], a[96:99], a[68:71], v[112:115]
  s_add_u32 s65, s65, 1
  ds_read_b64_tr_b16 a[114:115], v18 offset:22528
  ds_read_b128 a[84:87], v16 offset:9216
  v_mfma_f32_16x16x32_bf16 v[100:103], a[100:103], a[64:67], v[100:103]
  s_cmp_eq_u32 s65, 4
  s_cselect_b32 s65, 0, s65
  s_cselect_b32 s66, s67, s68
  ds_read_b64_tr_b16 a[116:117], v19 offset:20480
  v_mfma_f32_16x16x32_bf16 v[116:119], a[100:103], a[68:71], v[116:119]
  ds_read_b64_tr_b16 a[118:119], v19 offset:22528
  ds_read_b64_tr_b16 a[120:121], v20 offset:20480
  v_mfma_f32_16x16x32_bf16 v[104:107], a[104:107], a[64:67], v[104:107]
  ds_read_b64_tr_b16 a[122:123], v20 offset:22528
  ds_read_b64_tr_b16 a[124:125], v21 offset:20480
  v_mfma_f32_16x16x32_bf16 v[120:123], a[104:107], a[68:71], v[120:123]
  ds_read_b64_tr_b16 a[126:127], v21 offset:22528
  v_mfma_f32_16x16x32_bf16 v[108:111], a[108:111], a[64:67], v[108:111]
  v_add_u32 v16, s66, v16
  v_add_u32 v17, s66, v17
  v_add_u32 v20, s66, v20
  v_mfma_f32_16x16x32_bf16 v[124:127], a[108:111], a[68:71], v[124:127]
  v_add_u32 v18, s66, v18
  v_add_u32 v19, s66, v19
  v_add_u32 v21, s66, v21
  s_waitcnt vmcnt(0) lgkmcnt(0)
  s_barrier
  s_mov_b32 s5, 0x40000
Lpoll_19:
  v_cmp_ne_u64 vcc, s[94:95], v[6:7]
  s_nop 0
  s_cbranch_vccz Lpolld_20
  s_sleep 4
  buffer_load_dwordx2 v[6:7], off, s[96:99], s90 sc1
  s_sub_u32 s5, s5, 1
  s_waitcnt vmcnt(0)
  s_cbranch_scc0 Lpoll_19
Lpolld_20:
  v_mfma_f32_16x16x32_bf16 v[96:99], a[112:115], a[80:83], v[96:99]
  s_lshl_b32 s6, s78, 1
  s_add_u32 s6, s6, s77
  s_lshl_b32 s6, s6, 2
  v_mfma_f32_16x16x32_bf16 v[112:115], a[112:115], a[84:87], v[112:115]
  s_add_u32 s6, s6, s3
  s_lshl_b32 s6, s6, 13
  s_add_u32 s7, s6, 4096
  v_mfma_f32_16x16x32_bf16 v[100:103], a[116:119], a[80:83], v[100:103]
  buffer_load_dwordx4 v[192:195], v2, s[16:19], s6 offen offset:0 sc1
  ds_read_b128 a[64:67], v16 offset:0
  v_mfma_f32_16x16x32_bf16 v[116:119], a[116:119], a[84:87], v[116:119]
  buffer_load_dwordx4 v[196:199], v2, s[16:19], s6 offen offset:1024 sc1
  ds_read_b64_tr_b16 a[96:97], v18 offset:16384
  v_mfma_f32_16x16x32_bf16 v[104:107], a[120:123], a[80:83], v[104:107]
  buffer_load_dwordx4 v[200:203], v2, s[16:19], s6 offen offset:2048 sc1
  ds_read_b64_tr_b16 a[98:99], v18 offset:18432
  v_mfma_f32_16x16x32_bf16 v[120:123], a[120:123], a[84:87], v[120:123]
  buffer_load_dwordx4 v[204:207], v2, s[16:19], s6 offen offset:3072 sc1
  ds_read_b128 a[68:71], v16 offset:1024
  v_mfma_f32_16x16x32_bf16 v[108:111], a[124:127], a[80:83], v[108:111]
  ds_read_b64_tr_b16 a[100:101], v19 offset:16384
  ds_read_b64_tr_b16 a[102:103], v19 offset:18432
  v_mfma_f32_16x16x32_bf16 v[124:127], a[124:127], a[84:87], v[124:127]
  ds_read_b64_tr_b16 a[104:105], v20 offset:16384
  ds_read_b64_tr_b16 a[106:107], v20 offset:18432
  ds_read_b64_tr_b16 a[108:109], v21 offset:16384
  ds_read_b64_tr_b16 a[110:111], v21 offset:18432
  s_waitcnt lgkmcnt(0)
  v_mfma_f32_16x16x32_bf16 v[96:99], a[96:99], a[64:67], v[96:99]
  buffer_load_dwordx4 v[208:211], v2, s[16:19], s7 offen offset:0 sc1
  ds_read_b128 a[80:83], v16 offset:8192
  v_mfma_f32_16x16x32_bf16 v[112:115], a[96:99], a[68:71], v[112:115]
  buffer_load_dwordx4 v[212:215], v2, s[16:19], s7 offen offset:1024 sc1
  ds_read_b64_tr_b16 a[112:113], v18 offset:20480
  v_mfma_f32_16x16x32_bf16 v[100:103], a[100:103], a[64:67], v[100:103]
  ds_read_b64_tr_b16 a[114:115], v18 offset:22528
  ds_read_b128 a[84:87], v16 offset:9216
  v_mfma_f32_16x16x32_bf16 v[116:119], a[100:103], a[68:71], v[116:119]
  buffer_load_dwordx4 v[216:219], v2, s[16:19], s7 offen offset:2048 sc1
  ds_read_b64_tr_b16 a[116:117], v19 offset:20480
  v_mfma_f32_16x16x32_bf16 v[104:107], a[104:107], a[64:67], v[104:107]
  ds_read_b64_tr_b16 a[118:119], v19 offset:22528
  ds_read_b64_tr_b16 a[120:121], v20 offset:20480
  v_mfma_f32_16x16x32_bf16 v[120:123], a[104:107], a[68:71], v[120:123]
  buffer_load_dwordx4 v[220:223], v2, s[16:19], s7 offen offset:3072 sc1
  ds_read_b64_tr_b16 a[122:123], v20 offset:22528
  v_mfma_f32_16x16x32_bf16 v[108:111], a[108:111], a[64:67], v[108:111]
  s_add_u32 s64, s64, s66
  ds_read_b64_tr_b16 a[124:125], v21 offset:20480
  ds_read_b64_tr_b16 a[126:127], v21 offset:22528
  v_mfma_f32_16x16x32_bf16 v[124:127], a[108:111], a[68:71], v[124:127]
  s_add_u32 s65, s65, 1
  s_cmp_eq_u32 s65, 4
  s_cselect_b32 s65, 0, s65
  s_cselect_b32 s66, s67, s68
  v_add_u32 v16, s66, v16
  v_add_u32 v17, s66, v17
  v_add_u32 v18, s66, v18
  v_add_u32 v19, s66, v19
  v_add_u32 v20, s66, v20
  v_add_u32 v21, s66, v21
  s_waitcnt vmcnt(8) lgkmcnt(0)
  s_barrier
  v_mfma_f32_16x16x32_bf16 v[96:99], a[112:115], a[80:83], v[96:99]
  ds_read_b128 a[64:67], v16 offset:0
  ds_read_b64_tr_b16 a[96:97], v18 offset:16384
  v_mfma_f32_16x16x32_bf16 v[112:115], a[112:115], a[84:87], v[112:115]
  ds_read_b64_tr_b16 a[98:99], v18 offset:18432
  ds_read_b128 a[68:71], v16 offset:1024
  v_mfma_f32_16x16x32_bf16 v[100:103], a[116:119], a[80:83], v[100:103]
  ds_read_b64_tr_b16 a[100:101], v19 offset:16384
  v_mfma_f32_16x16x32_bf16 v[116:119], a[116:119], a[84:87], v[116:119]
  ds_read_b64_tr_b16 a[102:103], v19 offset:18432
  ds_read_b64_tr_b16 a[104:105], v20 offset:16384
  v_mfma_f32_16x16x32_bf16 v[104:107], a[120:123], a[80:83], v[104:107]
  ds_read_b64_tr_b16 a[106:107], v20 offset:18432
  ds_read_b64_tr_b16 a[108:109], v21 offset:16384
  v_mfma_f32_16x16x32_bf16 v[120:123], a[120:123], a[84:87], v[120:123]
  ds_read_b64_tr_b16 a[110:111], v21 offset:18432
  v_mfma_f32_16x16x32_bf16 v[108:111], a[124:127], a[80:83], v[108:111]
  v_mfma_f32_16x16x32_bf16 v[124:127], a[124:127], a[84:87], v[124:127]
  s_waitcnt lgkmcnt(0)
  v_mfma_f32_16x16x32_bf16 v[96:99], a[96:99], a[64:67], v[96:99]
  ds_read_b128 a[80:83], v16 offset:8192
  ds_read_b64_tr_b16 a[112:113], v18 offset:20480
  v_mfma_f32_16x16x32_bf16 v[112:115], a[96:99], a[68:71], v[112:115]
  ds_read_b64_tr_b16 a[114:115], v18 offset:22528
  ds_read_b128 a[84:87], v16 offset:9216
  v_mfma_f32_16x16x32_bf16 v[100:103], a[100:103], a[64:67], v[100:103]
  ds_read_b64_tr_b16 a[116:117], v19 offset:20480
  v_mfma_f32_16x16x32_bf16 v[116:119], a[100:103], a[68:71], v[116:119]
  ds_read_b64_tr_b16 a[118:119], v19 offset:22528
  ds_read_b64_tr_b16 a[120:121], v20 offset:20480
  v_mfma_f32_16x16x32_bf16 v[104:107], a[104:107], a[64:67], v[104:107]
  ds_read_b64_tr_b16 a[122:123], v20 offset:22528
  ds_read_b64_tr_b16 a[124:125], v21 offset:20480
  v_mfma_f32_16x16x32_bf16 v[120:123], a[104:107], a[68:71], v[120:123]
  ds_read_b64_tr_b16 a[126:127], v21 offset:22528
  v_mfma_f32_16x16x32_bf16 v[108:111], a[108:111], a[64:67], v[108:111]
  v_mfma_f32_16x16x32_bf16 v[124:127], a[108:111], a[68:71], v[124:127]
  s_lshl_b32 s4, s73, 19
  s_lshl_b32 s72, s76, 8
  s_add_u32 s4, s4, s72
  s_and_b32 s72, s3, 1
  s_lshl_b32 s72, s72, 7
  s_add_u32 s4, s4, s72
  s_lshr_b32 s72, s3, 1
  s_lshl_b32 s72, s72, 1
  s_add_u32 s72, s72, s77
  s_lshl_b32 s72, s72, 12
  s_add_u32 s4, s4, s72
  s_add_u32 s5, s4, 262144
  s_waitcnt lgkmcnt(0)
  v_mfma_f32_16x16x32_bf16 v[96:99], a[112:115], a[80:83], v[96:99]
  v_mfma_f32_16x16x32_bf16 v[112:115], a[112:115], a[84:87], v[112:115]
  v_mfma_f32_16x16x32_bf16 v[100:103], a[116:119], a[80:83], v[100:103]
  v_mfma_f32_16x16x32_bf16 v[116:119], a[116:119], a[84:87], v[116:119]
  v_mfma_f32_16x16x32_bf16 v[104:107], a[120:123], a[80:83], v[104:107]
  v_mfma_f32_16x16x32_bf16 v[120:123], a[120:123], a[84:87], v[120:123]
  v_mfma_f32_16x16x32_bf16 v[108:111], a[124:127], a[80:83], v[108:111]
  v_mfma_f32_16x16x32_bf16 v[124:127], a[124:127], a[84:87], v[124:127]
  s_waitcnt vmcnt(0)
  v_pk_add_f32 v[192:193], v[192:193], v[96:97]
  s_nop 2
  v_pk_add_f32 v[200:201], v[200:201], v[104:105]
  v_pk_add_f32 v[208:209], v[208:209], v[112:113]
  v_pk_add_f32 v[216:217], v[216:217], v[120:121]
  v_pk_add_f32 v[194:195], v[194:195], v[98:99]
  v_pk_add_f32 v[202:203], v[202:203], v[106:107]
  v_pk_add_f32 v[210:211], v[210:211], v[114:115]
  v_pk_add_f32 v[218:219], v[218:219], v[122:123]
  v_pk_add_f32 v[196:197], v[196:197], v[100:101]
  v_pk_add_f32 v[204:205], v[204:205], v[108:109]
  v_pk_add_f32 v[212:213], v[212:213], v[116:117]
  v_pk_add_f32 v[220:221], v[220:221], v[124:125]
  v_pk_add_f32 v[198:199], v[198:199], v[102:103]
  v_pk_add_f32 v[206:207], v[206:207], v[110:111]
  v_pk_add_f32 v[214:215], v[214:215], v[118:119]
  v_pk_add_f32 v[222:223], v[222:223], v[126:127]
  v_cvt_pk_bf16_f32 v192, v192, v193
  v_cvt_pk_bf16_f32 v200, v200, v201
  v_cvt_pk_bf16_f32 v208, v208, v209
  v_cvt_pk_bf16_f32 v216, v216, v217
  v_cvt_pk_bf16_f32 v193, v194, v195
  v_cvt_pk_bf16_f32 v201, v202, v203
  v_cvt_pk_bf16_f32 v209, v210, v211
  v_cvt_pk_bf16_f32 v217, v218, v219
  v_cvt_pk_bf16_f32 v194, v196, v197
  v_cvt_pk_bf16_f32 v202, v204, v205
  v_cvt_pk_bf16_f32 v210, v212, v213
  v_cvt_pk_bf16_f32 v218, v220, v221
  v_cvt_pk_bf16_f32 v195, v198, v199
  v_cvt_pk_bf16_f32 v203, v206, v207
  v_cvt_pk_bf16_f32 v211, v214, v215
  v_cvt_pk_bf16_f32 v219, v222, v223
  v_permlane16_swap_b32 v192, v194
  v_permlane16_swap_b32 v200, v202
  v_permlane16_swap_b32 v208, v210
  v_permlane16_swap_b32 v216, v218
  v_permlane16_swap_b32 v193, v195
  v_permlane16_swap_b32 v201, v203
  v_permlane16_swap_b32 v209, v211
  v_permlane16_swap_b32 v217, v219
  buffer_store_dwordx4 v[192:195], v26, s[20:23], s4 offen offset:0
  buffer_store_dwordx4 v[200:203], v26, s[20:23], s4 offen offset:64
  buffer_store_dwordx4 v[208:211], v26, s[20:23], s5 offen offset:0
  buffer_store_dwordx4 v[216:219], v26, s[20:23], s5 offen offset:64
Lend:
  s_endpgm
.section .rodata,"a"
.p2align 6
.amdhsa_kernel concat_heads__compressed_kv_cla__sliding_local_dilated__prompt_kernel
  .amdhsa_next_free_vgpr 512
  .amdhsa_next_free_sgpr 102
  .amdhsa_accum_offset 256
  .amdhsa_group_segment_fixed_size 0
  .amdhsa_kernarg_size 96
  .amdhsa_user_sgpr_count 2
  .amdhsa_user_sgpr_kernarg_segment_ptr 1
  .amdhsa_system_sgpr_workgroup_id_x 1
.end_amdhsa_kernel
```

```asm
; @launch grid=(256,1,1) block=(256,1,1) lds=163840
.amdgcn_target "amdgcn-amd-amdhsa--gfx950"
.text
.globl concat_heads__compressed_kv_cla__sliding_local_dilated__prompt_kernel
.p2align 8
.type concat_heads__compressed_kv_cla__sliding_local_dilated__prompt_kernel,@function
concat_heads__compressed_kv_cla__sliding_local_dilated__prompt_kernel:
  s_cmp_ge_u32 s2, 256
  s_cbranch_scc1 Lend
  s_load_dwordx16 s[64:79], s[0:1], 0
  s_load_dwordx8 s[80:87], s[0:1], 64
  v_lshrrev_b32 v2, 6, v0
  v_and_b32 v1, 63, v0
  v_readfirstlane_b32 s3, v2
  v_lshlrev_b32 v2, 4, v1
  s_and_b32 s4, s2, 1
  s_lshl_b32 s4, s4, 2
  s_bfe_u32 s5, s2, 0x20003
  s_add_u32 s61, s4, s5
  s_bfe_u32 s4, s2, 0x20001
  s_lshl_b32 s4, s4, 2
  s_bfe_u32 s5, s2, 0x20005
  s_add_u32 s62, s4, s5
  s_lshl_b32 s4, s3, 13
  s_add_u32 s36, s4, 65536
  s_add_u32 s41, s4, 98304
  v_lshrrev_b32 v32, 3, v1
  v_and_b32 v33, 6, v32
  v_and_b32 v34, 7, v1
  v_xor_b32 v33, v33, v34
  v_lshlrev_b32 v33, 4, v33
  s_lshl_b32 s4, s61, 2
  s_add_u32 s4, s4, s3
  s_lshl_b32 s4, s4, 6
  v_add_u32 v34, s4, v32
  v_lshl_add_u32 v34, v34, 10, v33
  v_add_u32 v48, 0, v34
  v_add_u32 v49, 7168, v34
  v_add_u32 v50, 14336, v34
  v_add_u32 v51, 21504, v34
  v_add_u32 v52, 32768, v34
  v_add_u32 v53, 39936, v34
  v_add_u32 v54, 47104, v34
  v_add_u32 v55, 54272, v34
  v_lshrrev_b32 v34, 2, v32
  v_and_b32 v35, 3, v32
  v_lshl_add_u32 v34, v34, 3, v35
  s_lshl_b32 s4, s62, 2
  s_add_u32 s4, s4, s3
  s_lshl_b32 s4, s4, 7
  v_lshl_add_u32 v34, v34, 13, v33
  v_add_u32 v34, s4, v34
  v_add_u32 v56, 0, v34
  v_add_u32 v57, 130048, v34
  v_add_u32 v58, 30720, v34
  v_add_u32 v59, 160768, v34
  v_add_u32 v60, 262144, v34
  v_add_u32 v61, 392192, v34
  v_add_u32 v62, 292864, v34
  v_add_u32 v63, 422912, v34
  s_and_b32 s6, s2, 7
  s_add_u32 s4, s61, s62
  s_and_b32 s49, s4, 3
  s_lshl_b32 s49, s49, 3
  s_or_b32 s49, s49, 0x80000
  s_bfe_u32 s48, 0x70702, s49
  s_add_u32 s48, s48, s6
  s_and_b32 s48, s48, 7
  s_lshl_b32 s46, s48, 7
  s_waitcnt lgkmcnt(0)
  s_mov_b32 s8, s66
  s_mov_b32 s9, s67
  s_mov_b32 s10, 2097152
  s_mov_b32 s11, 0x00020000
  s_cmp_lt_u32 s2, 128
  s_cselect_b32 s12, s70, s72
  s_cselect_b32 s13, s71, s73
  s_mov_b32 s14, 4194304
  s_mov_b32 s15, 0x00020000
  s_add_u32 s96, s86, 125829120
  s_addc_u32 s97, s87, 0
  s_mov_b32 s98, 262144
  s_mov_b32 s99, 0x00020000
  s_or_b32 s4, s2, s3
  s_cbranch_scc1 Ltag_1
  s_mov_b32 s4, 196608
  buffer_load_dwordx2 v[22:23], off, s[96:99], s4 sc1
Ltag_1:
  s_mov_b32 m0, s36
  s_nop 0
  buffer_load_dwordx4 v48, s[8:11], s46 offen offset:0 lds
  buffer_load_dwordx4 v49, s[8:11], s46 offen offset:1024 lds
  buffer_load_dwordx4 v50, s[8:11], s46 offen offset:2048 lds
  buffer_load_dwordx4 v51, s[8:11], s46 offen offset:3072 lds
  s_add_u32 m0, s36, 4096
  s_nop 0
  buffer_load_dwordx4 v52, s[8:11], s46 offen offset:0 lds
  buffer_load_dwordx4 v53, s[8:11], s46 offen offset:1024 lds
  buffer_load_dwordx4 v54, s[8:11], s46 offen offset:2048 lds
  buffer_load_dwordx4 v55, s[8:11], s46 offen offset:3072 lds
  s_lshl_b32 s47, s48, 19
  s_bfe_u32 s34, 0x3020106, s49
  s_add_u32 s48, s48, s34
  s_add_u32 s49, s49, 8
  s_and_b32 s49, s49, 0x8001f
  s_and_b32 s48, s48, 7
  s_lshl_b32 s46, s48, 7
  s_mov_b32 m0, s41
  s_nop 0
  buffer_load_dwordx4 v56, s[12:15], s47 offen offset:0 lds
  buffer_load_dwordx4 v57, s[12:15], s47 offen offset:1024 lds
  buffer_load_dwordx4 v58, s[12:15], s47 offen offset:2048 lds
  buffer_load_dwordx4 v59, s[12:15], s47 offen offset:3072 lds
  s_add_u32 m0, s41, 4096
  s_nop 0
  buffer_load_dwordx4 v60, s[12:15], s47 offen offset:0 lds
  buffer_load_dwordx4 v61, s[12:15], s47 offen offset:1024 lds
  buffer_load_dwordx4 v62, s[12:15], s47 offen offset:2048 lds
  buffer_load_dwordx4 v63, s[12:15], s47 offen offset:3072 lds
  s_lshr_b32 s4, s3, 1
  s_lshl_b32 s4, s4, 14
  s_add_u32 s4, s4, 65536
  v_and_b32 v32, 15, v1
  v_lshlrev_b32 v32, 7, v32
  v_lshrrev_b32 v33, 4, v1
  v_and_b32 v34, 6, v1
  v_xor_b32 v33, v33, v34
  v_lshl_add_u32 v32, v33, 4, v32
  v_add_u32 v16, s4, v32
  v_xor_b32 v17, 64, v16
  s_and_b32 s4, s3, 1
  s_lshl_b32 s4, s4, 14
  s_add_u32 s4, s4, 98304
  v_lshrrev_b32 v32, 2, v1
  v_and_b32 v33, 6, v32
  v_lshlrev_b32 v32, 7, v32
  v_and_b32 v34, 1, v1
  v_lshl_add_u32 v32, v34, 3, v32
  v_add_u32 v32, s4, v32
  v_bfe_u32 v34, v1, 1, 1
  v_xor_b32 v33, v33, v34
  v_xor_b32 v34, 0, v33
  v_lshl_add_u32 v18, v34, 4, v32
  v_xor_b32 v34, 2, v33
  v_lshl_add_u32 v19, v34, 4, v32
  v_xor_b32 v34, 4, v33
  v_lshl_add_u32 v20, v34, 4, v32
  v_xor_b32 v34, 6, v33
  v_lshl_add_u32 v21, v34, 4, v32
  s_cmp_lt_u32 s2, 154
  s_cselect_b32 s56, s78, s76
  s_cselect_b32 s57, s79, s77
  s_cselect_b32 s50, 0, 154
  s_mov_b32 s58, 4194304
  s_cselect_b32 s58, 6291456, s58
  s_mov_b32 s59, 0x00020000
  s_sub_u32 s50, s2, s50
  s_lshl_b32 s50, s50, 2
  s_add_u32 s50, s50, s3
  s_mul_i32 s50, s50, 10240
  s_cmp_lt_u32 s2, 171
  s_cselect_b32 s52, s68, s64
  s_cselect_b32 s53, s69, s65
  s_cselect_b32 s51, 0, 171
  s_mov_b32 s54, 4194304
  s_cselect_b32 s54, 8388608, s54
  s_mov_b32 s55, 0x00020000
  s_sub_u32 s51, s2, s51
  s_lshl_b32 s51, s51, 2
  s_add_u32 s51, s51, s3
  s_mul_i32 s51, s51, 12288
  s_and_b32 s24, s2, 7
  s_lshr_b32 s4, s2, 6
  s_lshl_b32 s4, s4, 3
  s_add_u32 s24, s24, s4
  s_lshr_b32 s25, s2, 3
  s_and_b32 s25, s25, 7
  s_and_b32 s4, s2, 1
  s_lshl_b32 s4, s4, 3
  s_bfe_u32 s5, s2, 0x30003
  s_add_u32 s32, s4, s5
  s_bfe_u32 s4, s2, 0x20001
  s_lshl_b32 s4, s4, 2
  s_lshr_b32 s5, s2, 6
  s_add_u32 s33, s4, s5
  s_mov_b32 s20, s78
  s_mov_b32 s21, s79
  s_mov_b32 s22, 6291456
  s_mov_b32 s23, 0x00020000
  s_and_b32 s4, s2, 7
  s_lshl_b32 s4, s4, 1
  s_add_u32 s5, s32, s33
  s_and_b32 s1, s5, 3
  s_lshl_b32 s1, s1, 3
  s_or_b32 s1, s1, 0x80000
  s_bfe_u32 s0, 0xf0f02, s1
  s_add_u32 s0, s0, s4
  s_and_b32 s0, s0, 15
  s_lshl_b32 s30, s0, 7
  s_lshl_b32 s88, s3, 12
  s_add_u32 s88, s88, 32768
  s_lshl_b32 s4, s3, 11
  s_add_u32 s26, s4, 18432
  s_add_u32 s27, s26, 3072
  s_mul_i32 s4, s3, 3072
  s_sub_u32 s28, 16384, s4
  v_lshrrev_b32 v32, 3, v1
  v_and_b32 v33, 6, v32
  v_and_b32 v34, 7, v1
  v_xor_b32 v33, v33, v34
  v_lshlrev_b32 v33, 4, v33
  s_lshl_b32 s4, s3, 5
  s_add_u32 s4, s4, 16
  v_add_u32 v34, s4, v32
  v_lshl_add_u32 v34, v34, 11, v33
  v_add_u32 v4, 0, v34
  v_add_u32 v5, 15360, v34
  v_add_u32 v6, 30720, v34
  s_add_u32 m0, s36, -65536
  s_nop 0
  buffer_load_dwordx4 v48, s[8:11], s46 offen offset:0 lds
  v_add_u32 v7, 46080, v34
  s_lshl_b32 s4, s3, 14
  s_cmp_eq_u32 s32, 0
  s_cselect_b32 s4, 0x40000000, s4
  v_lshl_add_u32 v34, v32, 11, v33
  v_add_u32 v14, s4, v34
  v_lshrrev_b32 v34, 2, v32
  v_and_b32 v35, 3, v32
  v_lshl_add_u32 v34, v34, 3, v35
  v_mul_u32_u24 v34, 6144, v34
  v_add_u32 v34, v34, v33
  s_lshl_b32 s4, s33, 7
  v_add_u32 v34, s4, v34
  s_mul_i32 s6, s3, 6
  s_add_u32 s7, s6, 0
  s_bfe_u32 s4, s7, 0x10002
  s_lshl_b32 s4, s4, 5
  s_and_b32 s5, s7, 1
  s_lshl_b32 s5, s5, 4
  s_add_u32 s4, s4, s5
  s_bfe_u32 s5, s7, 0x10001
  s_lshl_b32 s5, s5, 2
  s_add_u32 s4, s4, s5
  s_mul_i32 s4, s4, 6144
  s_lshr_b32 s5, s7, 3
  s_lshl_b32 s5, s5, 11
  s_add_u32 s4, s4, s5
  s_add_u32 s4, s4, 2048
  v_add_u32 v8, s4, v34
  s_add_u32 s7, s6, 1
  s_bfe_u32 s4, s7, 0x10002
  s_lshl_b32 s4, s4, 5
  s_and_b32 s5, s7, 1
  s_lshl_b32 s5, s5, 4
  s_add_u32 s4, s4, s5
  s_bfe_u32 s5, s7, 0x10001
  s_lshl_b32 s5, s5, 2
  s_add_u32 s4, s4, s5
  s_mul_i32 s4, s4, 6144
  s_lshr_b32 s5, s7, 3
  s_lshl_b32 s5, s5, 11
  s_add_u32 s4, s4, s5
  s_add_u32 s4, s4, 1024
  v_add_u32 v9, s4, v34
  s_add_u32 s7, s6, 2
  s_bfe_u32 s4, s7, 0x10002
  s_lshl_b32 s4, s4, 5
  s_and_b32 s5, s7, 1
  s_lshl_b32 s5, s5, 4
  s_add_u32 s4, s4, s5
  s_bfe_u32 s5, s7, 0x10001
  s_lshl_b32 s5, s5, 2
  s_add_u32 s4, s4, s5
  s_mul_i32 s4, s4, 6144
  s_lshr_b32 s5, s7, 3
  s_lshl_b32 s5, s5, 11
  s_add_u32 s4, s4, s5
  s_add_u32 s4, s4, 0
  v_add_u32 v10, s4, v34
  s_add_u32 s7, s6, 3
  s_bfe_u32 s4, s7, 0x10002
  s_lshl_b32 s4, s4, 5
  s_and_b32 s5, s7, 1
  s_lshl_b32 s5, s5, 4
  s_add_u32 s4, s4, s5
  s_bfe_u32 s5, s7, 0x10001
  s_lshl_b32 s5, s5, 2
  s_add_u32 s4, s4, s5
  s_mul_i32 s4, s4, 6144
  s_lshr_b32 s5, s7, 3
  s_lshl_b32 s5, s5, 11
  s_add_u32 s4, s4, s5
  s_add_u32 s4, s4, 2048
  v_add_u32 v11, s4, v34
  s_add_u32 s7, s6, 4
  s_bfe_u32 s4, s7, 0x10002
  s_lshl_b32 s4, s4, 5
  s_and_b32 s5, s7, 1
  s_lshl_b32 s5, s5, 4
  s_add_u32 s4, s4, s5
  s_bfe_u32 s5, s7, 0x10001
  s_lshl_b32 s5, s5, 2
  s_add_u32 s4, s4, s5
  s_mul_i32 s4, s4, 6144
  s_lshr_b32 s5, s7, 3
  s_lshl_b32 s5, s5, 11
  s_add_u32 s4, s4, s5
  s_add_u32 s4, s4, 1024
  v_add_u32 v12, s4, v34
  s_add_u32 s7, s6, 5
  s_bfe_u32 s4, s7, 0x10002
  s_lshl_b32 s4, s4, 5
  s_and_b32 s5, s7, 1
  s_lshl_b32 s5, s5, 4
  s_add_u32 s4, s4, s5
  s_bfe_u32 s5, s7, 0x10001
  s_lshl_b32 s5, s5, 2
  s_add_u32 s4, s4, s5
  s_mul_i32 s4, s4, 6144
  s_lshr_b32 s5, s7, 3
  s_lshl_b32 s5, s5, 11
  s_add_u32 s4, s4, s5
  s_add_u32 s4, s4, 0
  v_add_u32 v13, s4, v34
  s_sub_u32 s20, s20, 2048
  s_subb_u32 s21, s21, 0
  s_add_u32 s22, s22, 2048
  s_lshr_b32 s4, s3, 1
  s_lshl_b32 s4, s4, 13
  s_add_u32 s4, s4, 32768
  v_and_b32 v32, 15, v1
  buffer_load_dwordx4 v49, s[8:11], s46 offen offset:1024 lds
  v_lshlrev_b32 v32, 7, v32
  v_lshrrev_b32 v33, 4, v1
  v_and_b32 v34, 6, v1
  v_xor_b32 v33, v33, v34
  v_lshl_add_u32 v32, v33, 4, v32
  v_add_u32 v40, s4, v32
  v_xor_b32 v41, 64, v40
  v_and_b32 v32, 15, v1
  buffer_load_dwordx4 v50, s[8:11], s46 offen offset:2048 lds
  v_lshlrev_b32 v32, 7, v32
  v_lshrrev_b32 v33, 4, v1
  v_and_b32 v34, 6, v1
  v_xor_b32 v33, v33, v34
  v_lshl_add_u32 v32, v33, 4, v32
  v_add_u32 v42, 49152, v32
  v_xor_b32 v43, 64, v42
  buffer_load_dwordx4 v51, s[8:11], s46 offen offset:3072 lds
  v_lshrrev_b32 v32, 2, v1
  v_and_b32 v33, 6, v32
  v_lshlrev_b32 v32, 7, v32
  v_and_b32 v34, 1, v1
  v_lshl_add_u32 v32, v34, 3, v32
  v_add_u32 v32, 32768, v32
  v_bfe_u32 v34, v1, 1, 1
  v_xor_b32 v33, v33, v34
  s_add_u32 m0, s36, -61440
  s_nop 0
  buffer_load_dwordx4 v52, s[8:11], s46 offen offset:0 lds
  v_xor_b32 v34, 0, v33
  v_lshl_add_u32 v44, v34, 4, v32
  v_xor_b32 v34, 2, v33
  v_lshl_add_u32 v45, v34, 4, v32
  s_and_b32 s4, s3, 1
  s_lshl_b32 s4, s4, 6
  v_xor_b32 v44, s4, v44
  v_xor_b32 v45, s4, v45
  v_accvgpr_write_b32 a216, v40
  v_accvgpr_write_b32 a217, v41
  buffer_load_dwordx4 v53, s[8:11], s46 offen offset:1024 lds
  v_accvgpr_write_b32 a218, v42
  v_accvgpr_write_b32 a219, v43
  v_accvgpr_write_b32 a220, v44
  v_accvgpr_write_b32 a221, v45
  v_lshrrev_b32 v28, 3, v1
  v_and_b32 v29, 6, v28
  v_and_b32 v30, 7, v1
  v_xor_b32 v29, v29, v30
  buffer_load_dwordx4 v54, s[8:11], s46 offen offset:2048 lds
  v_lshlrev_b32 v29, 4, v29
  s_and_b32 s4, s3, 1
  s_lshl_b32 s4, s4, 16
  s_lshr_b32 s5, s3, 1
  s_lshl_b32 s5, s5, 7
  s_add_u32 s4, s4, s5
  v_lshl_add_u32 v28, v28, 11, v29
  v_add_u32 v28, s4, v28
  v_add_u32 v29, 0, v28
  v_accvgpr_write_b32 a212, v29
  v_add_u32 v29, 15360, v28
  v_accvgpr_write_b32 a213, v29
  v_add_u32 v29, 30720, v28
  buffer_load_dwordx4 v55, s[8:11], s46 offen offset:3072 lds
  v_accvgpr_write_b32 a214, v29
  v_add_u32 v29, 46080, v28
  v_accvgpr_write_b32 a215, v29
  v_accvgpr_write_b32 a236, 0
  v_mov_b32 v31, 0x3f803f80
  v_accvgpr_write_b32 a208, v31
  v_accvgpr_write_b32 a237, 0
  v_accvgpr_write_b32 a209, v31
  s_lshl_b32 s47, s48, 19
  s_bfe_u32 s34, 0x3020106, s49
  s_add_u32 s48, s48, s34
  s_add_u32 s49, s49, 8
  s_and_b32 s49, s49, 0x8001f
  s_and_b32 s48, s48, 7
  s_lshl_b32 s46, s48, 7
  s_add_u32 m0, s41, 32768
  s_nop 0
  buffer_load_dwordx4 v56, s[12:15], s47 offen offset:0 lds
  v_accvgpr_write_b32 a238, 0
  v_accvgpr_write_b32 a210, v31
  v_accvgpr_write_b32 a239, 0
  v_accvgpr_write_b32 a211, v31
  v_lshrrev_b32 v28, 3, v1
  v_and_b32 v29, 6, v28
  v_and_b32 v30, 7, v1
  v_xor_b32 v29, v29, v30
  buffer_load_dwordx4 v57, s[12:15], s47 offen offset:1024 lds
  v_lshlrev_b32 v29, 4, v29
  v_lshlrev_b32 v30, 2, v28
  v_add_u32 v30, s3, v30
  v_lshl_add_u32 v30, v30, 11, v29
  v_add_u32 v31, 0, v30
  v_accvgpr_write_b32 a222, v31
  v_add_u32 v31, 64512, v30
  buffer_load_dwordx4 v58, s[12:15], s47 offen offset:2048 lds
  v_accvgpr_write_b32 a223, v31
  v_add_u32 v31, 129024, v30
  v_accvgpr_write_b32 a224, v31
  v_add_u32 v31, 193536, v30
  v_accvgpr_write_b32 a225, v31
  v_lshrrev_b32 v30, 2, v28
  v_and_b32 v31, 3, v28
  v_lshl_add_u32 v30, v30, 3, v31
  s_and_b32 s4, s3, 1
  s_lshl_b32 s4, s4, 18
  s_lshr_b32 s5, s3, 1
  s_lshl_b32 s5, s5, 7
  s_add_u32 s4, s4, s5
  s_lshl_b32 s5, s24, 8
  s_add_u32 s4, s4, s5
  v_lshl_add_u32 v30, v30, 13, v29
  buffer_load_dwordx4 v59, s[12:15], s47 offen offset:3072 lds
  v_add_u32 v30, s4, v30
  v_add_u32 v31, 0, v30
  v_accvgpr_write_b32 a226, v31
  v_add_u32 v31, 130048, v30
  v_accvgpr_write_b32 a227, v31
  v_add_u32 v31, 30720, v30
  v_accvgpr_write_b32 a228, v31
  s_add_u32 m0, s41, 36864
  s_nop 0
  buffer_load_dwordx4 v60, s[12:15], s47 offen offset:0 lds
  v_add_u32 v31, 160768, v30
  v_accvgpr_write_b32 a229, v31
  s_lshl_b32 s4, s3, 13
  s_add_u32 s4, s4, 98304
  v_and_b32 v28, 15, v1
  v_lshlrev_b32 v28, 7, v28
  v_lshrrev_b32 v29, 4, v1
  v_and_b32 v30, 6, v1
  v_xor_b32 v29, v29, v30
  v_lshl_add_u32 v28, v29, 4, v28
  v_add_u32 v32, s4, v28
  buffer_load_dwordx4 v61, s[12:15], s47 offen offset:1024 lds
  v_xor_b32 v33, 64, v32
  v_lshrrev_b32 v28, 2, v1
  v_and_b32 v29, 6, v28
  v_lshlrev_b32 v28, 7, v28
  v_and_b32 v30, 1, v1
  v_lshl_add_u32 v28, v30, 3, v28
  v_add_u32 v28, 0, v28
  buffer_load_dwordx4 v62, s[12:15], s47 offen offset:2048 lds
  v_bfe_u32 v30, v1, 1, 1
  v_xor_b32 v29, v29, v30
  v_xor_b32 v30, 0, v29
  v_lshl_add_u32 v34, v30, 4, v28
  v_xor_b32 v30, 2, v29
  v_lshl_add_u32 v35, v30, 4, v28
  v_xor_b32 v30, 4, v29
  v_lshl_add_u32 v36, v30, 4, v28
  buffer_load_dwordx4 v63, s[12:15], s47 offen offset:3072 lds
  v_xor_b32 v30, 6, v29
  v_lshl_add_u32 v37, v30, 4, v28
  v_accvgpr_write_b32 a230, v32
  v_accvgpr_write_b32 a231, v33
  v_accvgpr_write_b32 a232, v34
  v_accvgpr_write_b32 a233, v35
  v_accvgpr_write_b32 a234, v36
  v_accvgpr_write_b32 a235, v37
  s_and_b32 s4, s3, 1
  s_lshl_b32 s5, s62, 1
  s_add_u32 s4, s4, s5
  s_lshr_b32 s5, s3, 1
  s_lshl_b32 s6, s61, 1
  s_add_u32 s5, s5, s6
  s_add_u32 s16, s86, 16777216
  s_addc_u32 s17, s87, 0
  s_mov_b32 s18, 33554432
  s_mov_b32 s19, 0x00020000
  s_lshl_b32 s4, s4, 20
  s_lshl_b32 s5, s5, 16
  s_add_u32 s63, s4, s5
  s_lshr_b32 s4, s2, 7
  s_lshl_b32 s4, s4, 14
  s_add_u32 s63, s63, s4
  s_mov_b32 s37, 0
  s_mov_b32 s39, 4294901760
  s_mov_b32 s40, 32768
  s_mov_b32 s37, 2
  s_mov_b32 s42, 0
  s_mov_b32 s44, 4294934528
  s_mov_b32 s45, 32768
  s_mov_b32 s43, s44
  s_or_b32 s4, s2, s3
  s_cbranch_scc1 Ltag_2
  s_mov_b32 s4, 196608
  s_mov_b32 s92, s84
  s_mov_b32 s93, s85
  s_mov_b32 s94, 256
  s_mov_b32 s95, 0x00020000
  s_waitcnt vmcnt(32)
  v_add_u32 v22, 1, v22
  v_or_b32 v23, 0x80000000, v23
  buffer_store_dwordx2 v[22:23], off, s[96:99], s4 sc1
  buffer_store_dwordx2 v[22:23], off, s[92:95], 0 sc1
Ltag_2:
  s_cmp_lt_u32 s2, 128
  s_cbranch_scc1 Lp1_k
  s_waitcnt vmcnt(16)
  s_barrier
  ds_read_b128 a[0:3], v16 offset:0
  ds_read_b64_tr_b16 a[64:65], v18 offset:0
  ds_read_b64_tr_b16 a[66:67], v18 offset:2048
  ds_read_b128 a[4:7], v16 offset:2048
  ds_read_b128 a[8:11], v16 offset:4096
  ds_read_b128 a[12:15], v16 offset:6144
  ds_read_b128 a[16:19], v16 offset:8192
  ds_read_b128 a[20:23], v16 offset:10240
  ds_read_b128 a[24:27], v16 offset:12288
  ds_read_b128 a[28:31], v16 offset:14336
  ds_read_b64_tr_b16 a[68:69], v19 offset:0
  ds_read_b64_tr_b16 a[70:71], v19 offset:2048
  ds_read_b64_tr_b16 a[72:73], v20 offset:0
  ds_read_b64_tr_b16 a[74:75], v20 offset:2048
  ds_read_b64_tr_b16 a[76:77], v21 offset:0
  ds_read_b64_tr_b16 a[78:79], v21 offset:2048
  ds_read_b64_tr_b16 a[80:81], v18 offset:8192
  ds_read_b64_tr_b16 a[82:83], v18 offset:10240
  ds_read_b64_tr_b16 a[84:85], v19 offset:8192
  ds_read_b64_tr_b16 a[86:87], v19 offset:10240
  ds_read_b64_tr_b16 a[88:89], v20 offset:8192
  ds_read_b64_tr_b16 a[90:91], v20 offset:10240
  ds_read_b64_tr_b16 a[92:93], v21 offset:8192
  ds_read_b64_tr_b16 a[94:95], v21 offset:10240
  s_waitcnt lgkmcnt(0)
  v_mfma_f32_16x16x32_bf16 v[64:67], a[0:3], a[64:67], 0
  s_add_u32 m0, s36, -32768
  ds_read_b128 a[32:35], v17 offset:0
  v_mfma_f32_16x16x32_bf16 v[96:99], a[4:7], a[64:67], 0
  buffer_load_dwordx4 v48, s[8:11], s46 offen offset:0 lds
  v_mfma_f32_16x16x32_bf16 v[128:131], a[8:11], a[64:67], 0
  ds_read_b64_tr_b16 a[96:97], v18 offset:4096
  v_mfma_f32_16x16x32_bf16 v[160:163], a[12:15], a[64:67], 0
  v_mfma_f32_16x16x32_bf16 v[192:195], a[16:19], a[64:67], 0
  ds_read_b64_tr_b16 a[98:99], v18 offset:6144
  v_mfma_f32_16x16x32_bf16 v[224:227], a[20:23], a[64:67], 0
  v_mfma_f32_16x16x32_bf16 a[128:131], a[24:27], a[64:67], 0
  ds_read_b128 a[36:39], v17 offset:2048
  v_mfma_f32_16x16x32_bf16 a[160:163], a[28:31], a[64:67], 0
  buffer_load_dwordx4 v49, s[8:11], s46 offen offset:1024 lds
  v_mfma_f32_16x16x32_bf16 v[68:71], a[0:3], a[68:71], 0
  v_mfma_f32_16x16x32_bf16 v[100:103], a[4:7], a[68:71], 0
  ds_read_b128 a[40:43], v17 offset:4096
  v_mfma_f32_16x16x32_bf16 v[132:135], a[8:11], a[68:71], 0
  v_mfma_f32_16x16x32_bf16 v[164:167], a[12:15], a[68:71], 0
  ds_read_b128 a[44:47], v17 offset:6144
  v_mfma_f32_16x16x32_bf16 v[196:199], a[16:19], a[68:71], 0
  v_mfma_f32_16x16x32_bf16 v[228:231], a[20:23], a[68:71], 0
  ds_read_b128 a[48:51], v17 offset:8192
  v_mfma_f32_16x16x32_bf16 a[132:135], a[24:27], a[68:71], 0
  buffer_load_dwordx4 v50, s[8:11], s46 offen offset:2048 lds
  v_mfma_f32_16x16x32_bf16 a[164:167], a[28:31], a[68:71], 0
  ds_read_b128 a[52:55], v17 offset:10240
  v_mfma_f32_16x16x32_bf16 v[72:75], a[0:3], a[72:75], 0
  v_mfma_f32_16x16x32_bf16 v[104:107], a[4:7], a[72:75], 0
  v_mfma_f32_16x16x32_bf16 v[136:139], a[8:11], a[72:75], 0
  ds_read_b128 a[56:59], v17 offset:12288
  v_mfma_f32_16x16x32_bf16 v[168:171], a[12:15], a[72:75], 0
  v_mfma_f32_16x16x32_bf16 v[200:203], a[16:19], a[72:75], 0
  ds_read_b128 a[60:63], v17 offset:14336
  v_mfma_f32_16x16x32_bf16 v[232:235], a[20:23], a[72:75], 0
  buffer_load_dwordx4 v51, s[8:11], s46 offen offset:3072 lds
  v_mfma_f32_16x16x32_bf16 a[136:139], a[24:27], a[72:75], 0
  s_add_u32 m0, s36, -28672
  ds_read_b64_tr_b16 a[100:101], v19 offset:4096
  v_mfma_f32_16x16x32_bf16 a[168:171], a[28:31], a[72:75], 0
  v_mfma_f32_16x16x32_bf16 v[76:79], a[0:3], a[76:79], 0
  ds_read_b64_tr_b16 a[102:103], v19 offset:6144
  v_mfma_f32_16x16x32_bf16 v[108:111], a[4:7], a[76:79], 0
  v_mfma_f32_16x16x32_bf16 v[140:143], a[8:11], a[76:79], 0
  v_mfma_f32_16x16x32_bf16 v[172:175], a[12:15], a[76:79], 0
  ds_read_b64_tr_b16 a[104:105], v20 offset:4096
  v_mfma_f32_16x16x32_bf16 v[204:207], a[16:19], a[76:79], 0
  buffer_load_dwordx4 v52, s[8:11], s46 offen offset:0 lds
  v_mfma_f32_16x16x32_bf16 v[236:239], a[20:23], a[76:79], 0
  ds_read_b64_tr_b16 a[106:107], v20 offset:6144
  v_mfma_f32_16x16x32_bf16 a[140:143], a[24:27], a[76:79], 0
  v_mfma_f32_16x16x32_bf16 a[172:175], a[28:31], a[76:79], 0
  ds_read_b64_tr_b16 a[108:109], v21 offset:4096
  v_mfma_f32_16x16x32_bf16 v[80:83], a[0:3], a[80:83], 0
  v_mfma_f32_16x16x32_bf16 v[112:115], a[4:7], a[80:83], 0
  ds_read_b64_tr_b16 a[110:111], v21 offset:6144
  v_mfma_f32_16x16x32_bf16 v[144:147], a[8:11], a[80:83], 0
  v_mfma_f32_16x16x32_bf16 v[176:179], a[12:15], a[80:83], 0
  buffer_load_dwordx4 v53, s[8:11], s46 offen offset:1024 lds
  v_mfma_f32_16x16x32_bf16 v[208:211], a[16:19], a[80:83], 0
  ds_read_b64_tr_b16 a[112:113], v18 offset:12288
  v_mfma_f32_16x16x32_bf16 v[240:243], a[20:23], a[80:83], 0
  v_mfma_f32_16x16x32_bf16 a[144:147], a[24:27], a[80:83], 0
  ds_read_b64_tr_b16 a[114:115], v18 offset:14336
  v_mfma_f32_16x16x32_bf16 a[176:179], a[28:31], a[80:83], 0
  v_mfma_f32_16x16x32_bf16 v[84:87], a[0:3], a[84:87], 0
  ds_read_b64_tr_b16 a[116:117], v19 offset:12288
  v_mfma_f32_16x16x32_bf16 v[116:119], a[4:7], a[84:87], 0
  v_mfma_f32_16x16x32_bf16 v[148:151], a[8:11], a[84:87], 0
  buffer_load_dwordx4 v54, s[8:11], s46 offen offset:2048 lds
  ds_read_b64_tr_b16 a[118:119], v19 offset:14336
  v_mfma_f32_16x16x32_bf16 v[180:183], a[12:15], a[84:87], 0
  v_mfma_f32_16x16x32_bf16 v[212:215], a[16:19], a[84:87], 0
  v_mfma_f32_16x16x32_bf16 v[244:247], a[20:23], a[84:87], 0
  ds_read_b64_tr_b16 a[120:121], v20 offset:12288
  v_mfma_f32_16x16x32_bf16 a[148:151], a[24:27], a[84:87], 0
  v_mfma_f32_16x16x32_bf16 a[180:183], a[28:31], a[84:87], 0
  ds_read_b64_tr_b16 a[122:123], v20 offset:14336
  v_mfma_f32_16x16x32_bf16 v[88:91], a[0:3], a[88:91], 0
  v_mfma_f32_16x16x32_bf16 v[120:123], a[4:7], a[88:91], 0
  buffer_load_dwordx4 v55, s[8:11], s46 offen offset:3072 lds
  ds_read_b64_tr_b16 a[124:125], v21 offset:12288
  v_mfma_f32_16x16x32_bf16 v[152:155], a[8:11], a[88:91], 0
  s_lshl_b32 s47, s48, 19
  s_bfe_u32 s34, 0x3020106, s49
  s_add_u32 s48, s48, s34
  v_mfma_f32_16x16x32_bf16 v[184:187], a[12:15], a[88:91], 0
  s_add_u32 s49, s49, 8
  s_and_b32 s49, s49, 0x8001f
  s_and_b32 s48, s48, 7
  v_mfma_f32_16x16x32_bf16 v[216:219], a[16:19], a[88:91], 0
  s_lshl_b32 s46, s48, 7
  ds_read_b64_tr_b16 a[126:127], v21 offset:14336
  v_mfma_f32_16x16x32_bf16 v[248:251], a[20:23], a[88:91], 0
  s_add_u32 s37, s37, 1
  s_cmp_eq_u32 s37, 3
  s_cselect_b32 s37, 0, s37
  s_cselect_b32 s38, s39, s40
  v_mfma_f32_16x16x32_bf16 a[152:155], a[24:27], a[88:91], 0
  s_sub_u32 s43, 0, s43
  v_mfma_f32_16x16x32_bf16 a[184:187], a[28:31], a[88:91], 0
  v_add_u32 v16, s38, v16
  v_add_u32 v17, s38, v17
  v_mfma_f32_16x16x32_bf16 v[92:95], a[0:3], a[92:95], 0
  v_add_u32 v18, s43, v18
  v_add_u32 v19, s43, v19
  v_mfma_f32_16x16x32_bf16 v[124:127], a[4:7], a[92:95], 0
  v_add_u32 v20, s43, v20
  v_add_u32 v21, s43, v21
  v_mfma_f32_16x16x32_bf16 v[156:159], a[8:11], a[92:95], 0
  v_mfma_f32_16x16x32_bf16 v[188:191], a[12:15], a[92:95], 0
  v_mfma_f32_16x16x32_bf16 v[220:223], a[16:19], a[92:95], 0
  v_mfma_f32_16x16x32_bf16 v[252:255], a[20:23], a[92:95], 0
  v_mfma_f32_16x16x32_bf16 a[156:159], a[24:27], a[92:95], 0
  v_mfma_f32_16x16x32_bf16 a[188:191], a[28:31], a[92:95], 0
  s_mov_b32 s35, 5
  s_waitcnt vmcnt(8) lgkmcnt(0)
  s_barrier
  .p2align 6
Lp1xw_loop:
  v_mfma_f32_16x16x32_bf16 v[64:67], a[32:35], a[96:99], v[64:67]
  buffer_load_dwordx4 a[192:195], v2, s[56:59], s50 offen offset:0
  ds_read_b128 a[0:3], v16 offset:0
  v_mfma_f32_16x16x32_bf16 v[96:99], a[36:39], a[96:99], v[96:99]
  v_mfma_f32_16x16x32_bf16 v[128:131], a[40:43], a[96:99], v[128:131]
  ds_read_b64_tr_b16 a[64:65], v18 offset:0
  v_mfma_f32_16x16x32_bf16 v[160:163], a[44:47], a[96:99], v[160:163]
  v_mfma_f32_16x16x32_bf16 v[192:195], a[48:51], a[96:99], v[192:195]
  ds_read_b64_tr_b16 a[66:67], v18 offset:2048
  v_mfma_f32_16x16x32_bf16 v[224:227], a[52:55], a[96:99], v[224:227]
  v_mfma_f32_16x16x32_bf16 a[128:131], a[56:59], a[96:99], a[128:131]
  buffer_load_dwordx4 a[192:195], v2, s[56:59], s50 offen offset:1024
  ds_read_b128 a[4:7], v16 offset:2048
  v_mfma_f32_16x16x32_bf16 a[160:163], a[60:63], a[96:99], a[160:163]
  s_add_u32 s50, s50, 2048
  v_mfma_f32_16x16x32_bf16 v[68:71], a[32:35], a[100:103], v[68:71]
  v_mfma_f32_16x16x32_bf16 v[100:103], a[36:39], a[100:103], v[100:103]
  ds_read_b128 a[8:11], v16 offset:4096
  v_mfma_f32_16x16x32_bf16 v[132:135], a[40:43], a[100:103], v[132:135]
  v_mfma_f32_16x16x32_bf16 v[164:167], a[44:47], a[100:103], v[164:167]
  ds_read_b128 a[12:15], v16 offset:6144
  v_mfma_f32_16x16x32_bf16 v[196:199], a[48:51], a[100:103], v[196:199]
  buffer_load_dwordx4 a[192:195], v2, s[52:55], s51 offen offset:0
  v_mfma_f32_16x16x32_bf16 v[228:231], a[52:55], a[100:103], v[228:231]
  ds_read_b128 a[16:19], v16 offset:8192
  v_mfma_f32_16x16x32_bf16 a[132:135], a[56:59], a[100:103], a[132:135]
  v_mfma_f32_16x16x32_bf16 a[164:167], a[60:63], a[100:103], a[164:167]
  ds_read_b128 a[20:23], v16 offset:10240
  v_mfma_f32_16x16x32_bf16 v[72:75], a[32:35], a[104:107], v[72:75]
  v_mfma_f32_16x16x32_bf16 v[104:107], a[36:39], a[104:107], v[104:107]
  v_mfma_f32_16x16x32_bf16 v[136:139], a[40:43], a[104:107], v[136:139]
  buffer_load_dwordx4 a[192:195], v2, s[52:55], s51 offen offset:1024
  ds_read_b128 a[24:27], v16 offset:12288
  v_mfma_f32_16x16x32_bf16 v[168:171], a[44:47], a[104:107], v[168:171]
  s_add_u32 s51, s51, 2048
  s_mov_b32 m0, s41
  v_mfma_f32_16x16x32_bf16 v[200:203], a[48:51], a[104:107], v[200:203]
  ds_read_b128 a[28:31], v16 offset:14336
  v_mfma_f32_16x16x32_bf16 v[232:235], a[52:55], a[104:107], v[232:235]
  v_mfma_f32_16x16x32_bf16 a[136:139], a[56:59], a[104:107], a[136:139]
  ds_read_b64_tr_b16 a[68:69], v19 offset:0
  v_mfma_f32_16x16x32_bf16 a[168:171], a[60:63], a[104:107], a[168:171]
  v_mfma_f32_16x16x32_bf16 v[76:79], a[32:35], a[108:111], v[76:79]
  ds_read_b64_tr_b16 a[70:71], v19 offset:2048
  v_mfma_f32_16x16x32_bf16 v[108:111], a[36:39], a[108:111], v[108:111]
  buffer_load_dwordx4 v56, s[12:15], s47 offen offset:0 lds
  v_mfma_f32_16x16x32_bf16 v[140:143], a[40:43], a[108:111], v[140:143]
  v_mfma_f32_16x16x32_bf16 v[172:175], a[44:47], a[108:111], v[172:175]
  ds_read_b64_tr_b16 a[72:73], v20 offset:0
  v_mfma_f32_16x16x32_bf16 v[204:207], a[48:51], a[108:111], v[204:207]
  v_mfma_f32_16x16x32_bf16 v[236:239], a[52:55], a[108:111], v[236:239]
  ds_read_b64_tr_b16 a[74:75], v20 offset:2048
  v_mfma_f32_16x16x32_bf16 a[140:143], a[56:59], a[108:111], a[140:143]
  v_mfma_f32_16x16x32_bf16 a[172:175], a[60:63], a[108:111], a[172:175]
  buffer_load_dwordx4 v57, s[12:15], s47 offen offset:1024 lds
  ds_read_b64_tr_b16 a[76:77], v21 offset:0
  v_mfma_f32_16x16x32_bf16 v[80:83], a[32:35], a[112:115], v[80:83]
  v_mfma_f32_16x16x32_bf16 v[112:115], a[36:39], a[112:115], v[112:115]
  ds_read_b64_tr_b16 a[78:79], v21 offset:2048
  v_mfma_f32_16x16x32_bf16 v[144:147], a[40:43], a[112:115], v[144:147]
  v_mfma_f32_16x16x32_bf16 v[176:179], a[44:47], a[112:115], v[176:179]
  v_mfma_f32_16x16x32_bf16 v[208:211], a[48:51], a[112:115], v[208:211]
  ds_read_b64_tr_b16 a[80:81], v18 offset:8192
  v_mfma_f32_16x16x32_bf16 v[240:243], a[52:55], a[112:115], v[240:243]
  buffer_load_dwordx4 v58, s[12:15], s47 offen offset:2048 lds
  v_mfma_f32_16x16x32_bf16 a[144:147], a[56:59], a[112:115], a[144:147]
  ds_read_b64_tr_b16 a[82:83], v18 offset:10240
  v_mfma_f32_16x16x32_bf16 a[176:179], a[60:63], a[112:115], a[176:179]
  v_mfma_f32_16x16x32_bf16 v[84:87], a[32:35], a[116:119], v[84:87]
  ds_read_b64_tr_b16 a[84:85], v19 offset:8192
  v_mfma_f32_16x16x32_bf16 v[116:119], a[36:39], a[116:119], v[116:119]
  v_mfma_f32_16x16x32_bf16 v[148:151], a[40:43], a[116:119], v[148:151]
  ds_read_b64_tr_b16 a[86:87], v19 offset:10240
  v_mfma_f32_16x16x32_bf16 v[180:183], a[44:47], a[116:119], v[180:183]
  v_mfma_f32_16x16x32_bf16 v[212:215], a[48:51], a[116:119], v[212:215]
  buffer_load_dwordx4 v59, s[12:15], s47 offen offset:3072 lds
  v_mfma_f32_16x16x32_bf16 v[244:247], a[52:55], a[116:119], v[244:247]
  s_add_u32 m0, s41, 4096
  ds_read_b64_tr_b16 a[88:89], v20 offset:8192
  v_mfma_f32_16x16x32_bf16 a[148:151], a[56:59], a[116:119], a[148:151]
  v_mfma_f32_16x16x32_bf16 a[180:183], a[60:63], a[116:119], a[180:183]
  ds_read_b64_tr_b16 a[90:91], v20 offset:10240
  v_mfma_f32_16x16x32_bf16 v[88:91], a[32:35], a[120:123], v[88:91]
  v_mfma_f32_16x16x32_bf16 v[120:123], a[36:39], a[120:123], v[120:123]
  ds_read_b64_tr_b16 a[92:93], v21 offset:8192
  v_mfma_f32_16x16x32_bf16 v[152:155], a[40:43], a[120:123], v[152:155]
  buffer_load_dwordx4 v60, s[12:15], s47 offen offset:0 lds
  v_mfma_f32_16x16x32_bf16 v[184:187], a[44:47], a[120:123], v[184:187]
  ds_read_b64_tr_b16 a[94:95], v21 offset:10240
  v_mfma_f32_16x16x32_bf16 v[216:219], a[48:51], a[120:123], v[216:219]
  v_mfma_f32_16x16x32_bf16 v[248:251], a[52:55], a[120:123], v[248:251]
  v_mfma_f32_16x16x32_bf16 a[152:155], a[56:59], a[120:123], a[152:155]
  v_mfma_f32_16x16x32_bf16 a[184:187], a[60:63], a[120:123], a[184:187]
  v_mfma_f32_16x16x32_bf16 v[92:95], a[32:35], a[124:127], v[92:95]
  buffer_load_dwordx4 v61, s[12:15], s47 offen offset:1024 lds
  v_mfma_f32_16x16x32_bf16 v[124:127], a[36:39], a[124:127], v[124:127]
  v_mfma_f32_16x16x32_bf16 v[156:159], a[40:43], a[124:127], v[156:159]
  v_mfma_f32_16x16x32_bf16 v[188:191], a[44:47], a[124:127], v[188:191]
  v_mfma_f32_16x16x32_bf16 v[220:223], a[48:51], a[124:127], v[220:223]
  v_mfma_f32_16x16x32_bf16 v[252:255], a[52:55], a[124:127], v[252:255]
  v_mfma_f32_16x16x32_bf16 a[156:159], a[56:59], a[124:127], a[156:159]
  v_mfma_f32_16x16x32_bf16 a[188:191], a[60:63], a[124:127], a[188:191]
  s_waitcnt lgkmcnt(0)
  v_mfma_f32_16x16x32_bf16 v[64:67], a[0:3], a[64:67], v[64:67]
  buffer_load_dwordx4 v62, s[12:15], s47 offen offset:2048 lds
  ds_read_b128 a[32:35], v17 offset:0
  v_mfma_f32_16x16x32_bf16 v[96:99], a[4:7], a[64:67], v[96:99]
  v_mfma_f32_16x16x32_bf16 v[128:131], a[8:11], a[64:67], v[128:131]
  ds_read_b64_tr_b16 a[96:97], v18 offset:4096
  v_mfma_f32_16x16x32_bf16 v[160:163], a[12:15], a[64:67], v[160:163]
  v_mfma_f32_16x16x32_bf16 v[192:195], a[16:19], a[64:67], v[192:195]
  ds_read_b64_tr_b16 a[98:99], v18 offset:6144
  v_mfma_f32_16x16x32_bf16 v[224:227], a[20:23], a[64:67], v[224:227]
  buffer_load_dwordx4 v63, s[12:15], s47 offen offset:3072 lds
  v_mfma_f32_16x16x32_bf16 a[128:131], a[24:27], a[64:67], a[128:131]
  s_mov_b32 m0, s36
  ds_read_b128 a[36:39], v17 offset:2048
  v_mfma_f32_16x16x32_bf16 a[160:163], a[28:31], a[64:67], a[160:163]
  v_mfma_f32_16x16x32_bf16 v[68:71], a[0:3], a[68:71], v[68:71]
  v_mfma_f32_16x16x32_bf16 v[100:103], a[4:7], a[68:71], v[100:103]
  ds_read_b128 a[40:43], v17 offset:4096
  v_mfma_f32_16x16x32_bf16 v[132:135], a[8:11], a[68:71], v[132:135]
  v_mfma_f32_16x16x32_bf16 v[164:167], a[12:15], a[68:71], v[164:167]
  buffer_load_dwordx4 v48, s[8:11], s46 offen offset:0 lds
  ds_read_b128 a[44:47], v17 offset:6144
  v_mfma_f32_16x16x32_bf16 v[196:199], a[16:19], a[68:71], v[196:199]
  v_mfma_f32_16x16x32_bf16 v[228:231], a[20:23], a[68:71], v[228:231]
  ds_read_b128 a[48:51], v17 offset:8192
  v_mfma_f32_16x16x32_bf16 a[132:135], a[24:27], a[68:71], a[132:135]
  v_mfma_f32_16x16x32_bf16 a[164:167], a[28:31], a[68:71], a[164:167]
  ds_read_b128 a[52:55], v17 offset:10240
  v_mfma_f32_16x16x32_bf16 v[72:75], a[0:3], a[72:75], v[72:75]
  v_mfma_f32_16x16x32_bf16 v[104:107], a[4:7], a[72:75], v[104:107]
  buffer_load_dwordx4 v49, s[8:11], s46 offen offset:1024 lds
  v_mfma_f32_16x16x32_bf16 v[136:139], a[8:11], a[72:75], v[136:139]
  ds_read_b128 a[56:59], v17 offset:12288
  v_mfma_f32_16x16x32_bf16 v[168:171], a[12:15], a[72:75], v[168:171]
  v_mfma_f32_16x16x32_bf16 v[200:203], a[16:19], a[72:75], v[200:203]
  ds_read_b128 a[60:63], v17 offset:14336
  v_mfma_f32_16x16x32_bf16 v[232:235], a[20:23], a[72:75], v[232:235]
  v_mfma_f32_16x16x32_bf16 a[136:139], a[24:27], a[72:75], a[136:139]
  buffer_load_dwordx4 v50, s[8:11], s46 offen offset:2048 lds
  ds_read_b64_tr_b16 a[100:101], v19 offset:4096
  v_mfma_f32_16x16x32_bf16 a[168:171], a[28:31], a[72:75], a[168:171]
  v_mfma_f32_16x16x32_bf16 v[76:79], a[0:3], a[76:79], v[76:79]
  ds_read_b64_tr_b16 a[102:103], v19 offset:6144
  v_mfma_f32_16x16x32_bf16 v[108:111], a[4:7], a[76:79], v[108:111]
  v_mfma_f32_16x16x32_bf16 v[140:143], a[8:11], a[76:79], v[140:143]
  v_mfma_f32_16x16x32_bf16 v[172:175], a[12:15], a[76:79], v[172:175]
  ds_read_b64_tr_b16 a[104:105], v20 offset:4096
  v_mfma_f32_16x16x32_bf16 v[204:207], a[16:19], a[76:79], v[204:207]
  buffer_load_dwordx4 v51, s[8:11], s46 offen offset:3072 lds
  v_mfma_f32_16x16x32_bf16 v[236:239], a[20:23], a[76:79], v[236:239]
  s_add_u32 m0, s36, 4096
  ds_read_b64_tr_b16 a[106:107], v20 offset:6144
  v_mfma_f32_16x16x32_bf16 a[140:143], a[24:27], a[76:79], a[140:143]
  v_mfma_f32_16x16x32_bf16 a[172:175], a[28:31], a[76:79], a[172:175]
  ds_read_b64_tr_b16 a[108:109], v21 offset:4096
  v_mfma_f32_16x16x32_bf16 v[80:83], a[0:3], a[80:83], v[80:83]
  v_mfma_f32_16x16x32_bf16 v[112:115], a[4:7], a[80:83], v[112:115]
  ds_read_b64_tr_b16 a[110:111], v21 offset:6144
  v_mfma_f32_16x16x32_bf16 v[144:147], a[8:11], a[80:83], v[144:147]
  buffer_load_dwordx4 v52, s[8:11], s46 offen offset:0 lds
  v_mfma_f32_16x16x32_bf16 v[176:179], a[12:15], a[80:83], v[176:179]
  v_mfma_f32_16x16x32_bf16 v[208:211], a[16:19], a[80:83], v[208:211]
  ds_read_b64_tr_b16 a[112:113], v18 offset:12288
  v_mfma_f32_16x16x32_bf16 v[240:243], a[20:23], a[80:83], v[240:243]
  v_mfma_f32_16x16x32_bf16 a[144:147], a[24:27], a[80:83], a[144:147]
  ds_read_b64_tr_b16 a[114:115], v18 offset:14336
  v_mfma_f32_16x16x32_bf16 a[176:179], a[28:31], a[80:83], a[176:179]
  buffer_load_dwordx4 v53, s[8:11], s46 offen offset:1024 lds
  v_mfma_f32_16x16x32_bf16 v[84:87], a[0:3], a[84:87], v[84:87]
  ds_read_b64_tr_b16 a[116:117], v19 offset:12288
  v_mfma_f32_16x16x32_bf16 v[116:119], a[4:7], a[84:87], v[116:119]
  v_mfma_f32_16x16x32_bf16 v[148:151], a[8:11], a[84:87], v[148:151]
  ds_read_b64_tr_b16 a[118:119], v19 offset:14336
  v_mfma_f32_16x16x32_bf16 v[180:183], a[12:15], a[84:87], v[180:183]
  v_mfma_f32_16x16x32_bf16 v[212:215], a[16:19], a[84:87], v[212:215]
  v_mfma_f32_16x16x32_bf16 v[244:247], a[20:23], a[84:87], v[244:247]
  buffer_load_dwordx4 v54, s[8:11], s46 offen offset:2048 lds
  ds_read_b64_tr_b16 a[120:121], v20 offset:12288
  v_mfma_f32_16x16x32_bf16 a[148:151], a[24:27], a[84:87], a[148:151]
  v_mfma_f32_16x16x32_bf16 a[180:183], a[28:31], a[84:87], a[180:183]
  ds_read_b64_tr_b16 a[122:123], v20 offset:14336
  v_mfma_f32_16x16x32_bf16 v[88:91], a[0:3], a[88:91], v[88:91]
  v_mfma_f32_16x16x32_bf16 v[120:123], a[4:7], a[88:91], v[120:123]
  ds_read_b64_tr_b16 a[124:125], v21 offset:12288
  v_mfma_f32_16x16x32_bf16 v[152:155], a[8:11], a[88:91], v[152:155]
  v_mfma_f32_16x16x32_bf16 v[184:187], a[12:15], a[88:91], v[184:187]
  buffer_load_dwordx4 v55, s[8:11], s46 offen offset:3072 lds
  ds_read_b64_tr_b16 a[126:127], v21 offset:14336
  v_mfma_f32_16x16x32_bf16 v[216:219], a[16:19], a[88:91], v[216:219]
  s_lshl_b32 s47, s48, 19
  s_bfe_u32 s34, 0x3020106, s49
  s_add_u32 s48, s48, s34
  v_mfma_f32_16x16x32_bf16 v[248:251], a[20:23], a[88:91], v[248:251]
  s_add_u32 s49, s49, 8
  s_and_b32 s49, s49, 0x8001f
  s_and_b32 s48, s48, 7
  v_mfma_f32_16x16x32_bf16 a[152:155], a[24:27], a[88:91], a[152:155]
  s_lshl_b32 s46, s48, 7
  v_mfma_f32_16x16x32_bf16 a[184:187], a[28:31], a[88:91], a[184:187]
  s_add_u32 s36, s36, s38
  s_add_u32 s37, s37, 1
  s_cmp_eq_u32 s37, 3
  s_cselect_b32 s37, 0, s37
  s_cselect_b32 s38, s39, s40
  v_mfma_f32_16x16x32_bf16 v[92:95], a[0:3], a[92:95], v[92:95]
  s_add_u32 s41, s41, s43
  s_sub_u32 s43, 0, s43
  v_mfma_f32_16x16x32_bf16 v[124:127], a[4:7], a[92:95], v[124:127]
  v_add_u32 v16, s38, v16
  v_add_u32 v17, s38, v17
  v_mfma_f32_16x16x32_bf16 v[156:159], a[8:11], a[92:95], v[156:159]
  v_add_u32 v18, s43, v18
  v_add_u32 v19, s43, v19
  v_mfma_f32_16x16x32_bf16 v[188:191], a[12:15], a[92:95], v[188:191]
  v_add_u32 v20, s43, v20
  v_add_u32 v21, s43, v21
  v_mfma_f32_16x16x32_bf16 v[220:223], a[16:19], a[92:95], v[220:223]
  v_mfma_f32_16x16x32_bf16 v[252:255], a[20:23], a[92:95], v[252:255]
  s_waitcnt vmcnt(8) lgkmcnt(0)
  s_barrier
  v_mfma_f32_16x16x32_bf16 a[156:159], a[24:27], a[92:95], a[156:159]
  s_sub_u32 s35, s35, 1
  v_mfma_f32_16x16x32_bf16 a[188:191], a[28:31], a[92:95], a[188:191]
  s_cmp_lg_u32 s35, 0
  s_cbranch_scc1 Lp1xw_loop
  v_mfma_f32_16x16x32_bf16 v[64:67], a[32:35], a[96:99], v[64:67]
  s_mov_b32 m0, s41
  ds_read_b128 a[0:3], v16 offset:0
  v_mfma_f32_16x16x32_bf16 v[96:99], a[36:39], a[96:99], v[96:99]
  buffer_load_dwordx4 v56, s[12:15], s47 offen offset:0 lds
  v_mfma_f32_16x16x32_bf16 v[128:131], a[40:43], a[96:99], v[128:131]
  ds_read_b64_tr_b16 a[64:65], v18 offset:0
  v_mfma_f32_16x16x32_bf16 v[160:163], a[44:47], a[96:99], v[160:163]
  v_mfma_f32_16x16x32_bf16 v[192:195], a[48:51], a[96:99], v[192:195]
  ds_read_b64_tr_b16 a[66:67], v18 offset:2048
  v_mfma_f32_16x16x32_bf16 v[224:227], a[52:55], a[96:99], v[224:227]
  v_mfma_f32_16x16x32_bf16 a[128:131], a[56:59], a[96:99], a[128:131]
  ds_read_b128 a[4:7], v16 offset:2048
  v_mfma_f32_16x16x32_bf16 a[160:163], a[60:63], a[96:99], a[160:163]
  v_mfma_f32_16x16x32_bf16 v[68:71], a[32:35], a[100:103], v[68:71]
  v_mfma_f32_16x16x32_bf16 v[100:103], a[36:39], a[100:103], v[100:103]
  ds_read_b128 a[8:11], v16 offset:4096
  v_mfma_f32_16x16x32_bf16 v[132:135], a[40:43], a[100:103], v[132:135]
  buffer_load_dwordx4 v57, s[12:15], s47 offen offset:1024 lds
  v_mfma_f32_16x16x32_bf16 v[164:167], a[44:47], a[100:103], v[164:167]
  ds_read_b128 a[12:15], v16 offset:6144
  v_mfma_f32_16x16x32_bf16 v[196:199], a[48:51], a[100:103], v[196:199]
  v_mfma_f32_16x16x32_bf16 v[228:231], a[52:55], a[100:103], v[228:231]
  ds_read_b128 a[16:19], v16 offset:8192
  v_mfma_f32_16x16x32_bf16 a[132:135], a[56:59], a[100:103], a[132:135]
  v_mfma_f32_16x16x32_bf16 a[164:167], a[60:63], a[100:103], a[164:167]
  ds_read_b128 a[20:23], v16 offset:10240
  v_mfma_f32_16x16x32_bf16 v[72:75], a[32:35], a[104:107], v[72:75]
  v_mfma_f32_16x16x32_bf16 v[104:107], a[36:39], a[104:107], v[104:107]
  v_mfma_f32_16x16x32_bf16 v[136:139], a[40:43], a[104:107], v[136:139]
  ds_read_b128 a[24:27], v16 offset:12288
  v_mfma_f32_16x16x32_bf16 v[168:171], a[44:47], a[104:107], v[168:171]
  v_mfma_f32_16x16x32_bf16 v[200:203], a[48:51], a[104:107], v[200:203]
  ds_read_b128 a[28:31], v16 offset:14336
  v_mfma_f32_16x16x32_bf16 v[232:235], a[52:55], a[104:107], v[232:235]
  buffer_load_dwordx4 v58, s[12:15], s47 offen offset:2048 lds
  v_mfma_f32_16x16x32_bf16 a[136:139], a[56:59], a[104:107], a[136:139]
  ds_read_b64_tr_b16 a[68:69], v19 offset:0
  v_mfma_f32_16x16x32_bf16 a[168:171], a[60:63], a[104:107], a[168:171]
  v_mfma_f32_16x16x32_bf16 v[76:79], a[32:35], a[108:111], v[76:79]
  ds_read_b64_tr_b16 a[70:71], v19 offset:2048
  v_mfma_f32_16x16x32_bf16 v[108:111], a[36:39], a[108:111], v[108:111]
  v_mfma_f32_16x16x32_bf16 v[140:143], a[40:43], a[108:111], v[140:143]
  v_mfma_f32_16x16x32_bf16 v[172:175], a[44:47], a[108:111], v[172:175]
  ds_read_b64_tr_b16 a[72:73], v20 offset:0
  v_mfma_f32_16x16x32_bf16 v[204:207], a[48:51], a[108:111], v[204:207]
  v_mfma_f32_16x16x32_bf16 v[236:239], a[52:55], a[108:111], v[236:239]
  ds_read_b64_tr_b16 a[74:75], v20 offset:2048
  v_mfma_f32_16x16x32_bf16 a[140:143], a[56:59], a[108:111], a[140:143]
  v_mfma_f32_16x16x32_bf16 a[172:175], a[60:63], a[108:111], a[172:175]
  buffer_load_dwordx4 v59, s[12:15], s47 offen offset:3072 lds
  ds_read_b64_tr_b16 a[76:77], v21 offset:0
  v_mfma_f32_16x16x32_bf16 v[80:83], a[32:35], a[112:115], v[80:83]
  s_add_u32 m0, s41, 4096
  v_mfma_f32_16x16x32_bf16 v[112:115], a[36:39], a[112:115], v[112:115]
  ds_read_b64_tr_b16 a[78:79], v21 offset:2048
  v_mfma_f32_16x16x32_bf16 v[144:147], a[40:43], a[112:115], v[144:147]
  v_mfma_f32_16x16x32_bf16 v[176:179], a[44:47], a[112:115], v[176:179]
  v_mfma_f32_16x16x32_bf16 v[208:211], a[48:51], a[112:115], v[208:211]
  ds_read_b64_tr_b16 a[80:81], v18 offset:8192
  v_mfma_f32_16x16x32_bf16 v[240:243], a[52:55], a[112:115], v[240:243]
  v_mfma_f32_16x16x32_bf16 a[144:147], a[56:59], a[112:115], a[144:147]
  ds_read_b64_tr_b16 a[82:83], v18 offset:10240
  v_mfma_f32_16x16x32_bf16 a[176:179], a[60:63], a[112:115], a[176:179]
  v_mfma_f32_16x16x32_bf16 v[84:87], a[32:35], a[116:119], v[84:87]
  ds_read_b64_tr_b16 a[84:85], v19 offset:8192
  v_mfma_f32_16x16x32_bf16 v[116:119], a[36:39], a[116:119], v[116:119]
  v_mfma_f32_16x16x32_bf16 v[148:151], a[40:43], a[116:119], v[148:151]
  buffer_load_dwordx4 v60, s[12:15], s47 offen offset:0 lds
  ds_read_b64_tr_b16 a[86:87], v19 offset:10240
  v_mfma_f32_16x16x32_bf16 v[180:183], a[44:47], a[116:119], v[180:183]
  v_mfma_f32_16x16x32_bf16 v[212:215], a[48:51], a[116:119], v[212:215]
  v_mfma_f32_16x16x32_bf16 v[244:247], a[52:55], a[116:119], v[244:247]
  ds_read_b64_tr_b16 a[88:89], v20 offset:8192
  v_mfma_f32_16x16x32_bf16 a[148:151], a[56:59], a[116:119], a[148:151]
  v_mfma_f32_16x16x32_bf16 a[180:183], a[60:63], a[116:119], a[180:183]
  ds_read_b64_tr_b16 a[90:91], v20 offset:10240
  v_mfma_f32_16x16x32_bf16 v[88:91], a[32:35], a[120:123], v[88:91]
  v_mfma_f32_16x16x32_bf16 v[120:123], a[36:39], a[120:123], v[120:123]
  ds_read_b64_tr_b16 a[92:93], v21 offset:8192
  v_mfma_f32_16x16x32_bf16 v[152:155], a[40:43], a[120:123], v[152:155]
  v_mfma_f32_16x16x32_bf16 v[184:187], a[44:47], a[120:123], v[184:187]
  ds_read_b64_tr_b16 a[94:95], v21 offset:10240
  v_mfma_f32_16x16x32_bf16 v[216:219], a[48:51], a[120:123], v[216:219]
  buffer_load_dwordx4 v61, s[12:15], s47 offen offset:1024 lds
  v_mfma_f32_16x16x32_bf16 v[248:251], a[52:55], a[120:123], v[248:251]
  v_mfma_f32_16x16x32_bf16 a[152:155], a[56:59], a[120:123], a[152:155]
  v_mfma_f32_16x16x32_bf16 a[184:187], a[60:63], a[120:123], a[184:187]
  v_mfma_f32_16x16x32_bf16 v[92:95], a[32:35], a[124:127], v[92:95]
  v_mfma_f32_16x16x32_bf16 v[124:127], a[36:39], a[124:127], v[124:127]
  v_mfma_f32_16x16x32_bf16 v[156:159], a[40:43], a[124:127], v[156:159]
  v_mfma_f32_16x16x32_bf16 v[188:191], a[44:47], a[124:127], v[188:191]
  v_mfma_f32_16x16x32_bf16 v[220:223], a[48:51], a[124:127], v[220:223]
  v_mfma_f32_16x16x32_bf16 v[252:255], a[52:55], a[124:127], v[252:255]
  v_mfma_f32_16x16x32_bf16 a[156:159], a[56:59], a[124:127], a[156:159]
  v_mfma_f32_16x16x32_bf16 a[188:191], a[60:63], a[124:127], a[188:191]
  s_waitcnt lgkmcnt(0)
  v_mfma_f32_16x16x32_bf16 v[64:67], a[0:3], a[64:67], v[64:67]
  buffer_load_dwordx4 v62, s[12:15], s47 offen offset:2048 lds
  ds_read_b128 a[32:35], v17 offset:0
  v_mfma_f32_16x16x32_bf16 v[96:99], a[4:7], a[64:67], v[96:99]
  v_mfma_f32_16x16x32_bf16 v[128:131], a[8:11], a[64:67], v[128:131]
  ds_read_b64_tr_b16 a[96:97], v18 offset:4096
  v_mfma_f32_16x16x32_bf16 v[160:163], a[12:15], a[64:67], v[160:163]
  v_mfma_f32_16x16x32_bf16 v[192:195], a[16:19], a[64:67], v[192:195]
  ds_read_b64_tr_b16 a[98:99], v18 offset:6144
  v_mfma_f32_16x16x32_bf16 v[224:227], a[20:23], a[64:67], v[224:227]
  v_mfma_f32_16x16x32_bf16 a[128:131], a[24:27], a[64:67], a[128:131]
  ds_read_b128 a[36:39], v17 offset:2048
  v_mfma_f32_16x16x32_bf16 a[160:163], a[28:31], a[64:67], a[160:163]
  v_mfma_f32_16x16x32_bf16 v[68:71], a[0:3], a[68:71], v[68:71]
  v_mfma_f32_16x16x32_bf16 v[100:103], a[4:7], a[68:71], v[100:103]
  buffer_load_dwordx4 v63, s[12:15], s47 offen offset:3072 lds
  ds_read_b128 a[40:43], v17 offset:4096
  v_mfma_f32_16x16x32_bf16 v[132:135], a[8:11], a[68:71], v[132:135]
  s_lshl_b32 s10, s32, 18
  s_add_u32 s8, s76, s10
  s_addc_u32 s9, s77, 0
  v_mfma_f32_16x16x32_bf16 v[164:167], a[12:15], a[68:71], v[164:167]
  s_sub_u32 s8, s8, 32768
  s_subb_u32 s9, s9, 0
  s_mov_b32 s10, 294912
  v_mfma_f32_16x16x32_bf16 v[196:199], a[16:19], a[68:71], v[196:199]
  s_mov_b32 s11, 0x00020000
  s_cmp_ge_u32 s3, 2
  s_cbranch_scc1 Lh_3
  s_add_u32 m0, s88, s28
  s_nop 0
  buffer_load_dwordx4 v14, s[8:11], s30 offen offset:0 lds
Lh_3:
  v_mfma_f32_16x16x32_bf16 v[228:231], a[20:23], a[68:71], v[228:231]
  s_mov_b32 m0, s88
  ds_read_b128 a[44:47], v17 offset:6144
  ds_read_b128 a[48:51], v17 offset:8192
  v_mfma_f32_16x16x32_bf16 a[132:135], a[24:27], a[68:71], a[132:135]
  v_mfma_f32_16x16x32_bf16 a[164:167], a[28:31], a[68:71], a[164:167]
  ds_read_b128 a[52:55], v17 offset:10240
  v_mfma_f32_16x16x32_bf16 v[72:75], a[0:3], a[72:75], v[72:75]
  v_mfma_f32_16x16x32_bf16 v[104:107], a[4:7], a[72:75], v[104:107]
  v_mfma_f32_16x16x32_bf16 v[136:139], a[8:11], a[72:75], v[136:139]
  ds_read_b128 a[56:59], v17 offset:12288
  v_mfma_f32_16x16x32_bf16 v[168:171], a[12:15], a[72:75], v[168:171]
  buffer_load_dwordx4 v4, s[8:11], s30 offen offset:0 lds
  v_mfma_f32_16x16x32_bf16 v[200:203], a[16:19], a[72:75], v[200:203]
  ds_read_b128 a[60:63], v17 offset:14336
  v_mfma_f32_16x16x32_bf16 v[232:235], a[20:23], a[72:75], v[232:235]
  v_mfma_f32_16x16x32_bf16 a[136:139], a[24:27], a[72:75], a[136:139]
  ds_read_b64_tr_b16 a[100:101], v19 offset:4096
  v_mfma_f32_16x16x32_bf16 a[168:171], a[28:31], a[72:75], a[168:171]
  v_mfma_f32_16x16x32_bf16 v[76:79], a[0:3], a[76:79], v[76:79]
  ds_read_b64_tr_b16 a[102:103], v19 offset:6144
  v_mfma_f32_16x16x32_bf16 v[108:111], a[4:7], a[76:79], v[108:111]
  v_mfma_f32_16x16x32_bf16 v[140:143], a[8:11], a[76:79], v[140:143]
  v_mfma_f32_16x16x32_bf16 v[172:175], a[12:15], a[76:79], v[172:175]
  ds_read_b64_tr_b16 a[104:105], v20 offset:4096
  v_mfma_f32_16x16x32_bf16 v[204:207], a[16:19], a[76:79], v[204:207]
  buffer_load_dwordx4 v5, s[8:11], s30 offen offset:1024 lds
  v_mfma_f32_16x16x32_bf16 v[236:239], a[20:23], a[76:79], v[236:239]
  ds_read_b64_tr_b16 a[106:107], v20 offset:6144
  v_mfma_f32_16x16x32_bf16 a[140:143], a[24:27], a[76:79], a[140:143]
  v_mfma_f32_16x16x32_bf16 a[172:175], a[28:31], a[76:79], a[172:175]
  ds_read_b64_tr_b16 a[108:109], v21 offset:4096
  v_mfma_f32_16x16x32_bf16 v[80:83], a[0:3], a[80:83], v[80:83]
  v_mfma_f32_16x16x32_bf16 v[112:115], a[4:7], a[80:83], v[112:115]
  ds_read_b64_tr_b16 a[110:111], v21 offset:6144
  v_mfma_f32_16x16x32_bf16 v[144:147], a[8:11], a[80:83], v[144:147]
  v_mfma_f32_16x16x32_bf16 v[176:179], a[12:15], a[80:83], v[176:179]
  v_mfma_f32_16x16x32_bf16 v[208:211], a[16:19], a[80:83], v[208:211]
  ds_read_b64_tr_b16 a[112:113], v18 offset:12288
  v_mfma_f32_16x16x32_bf16 v[240:243], a[20:23], a[80:83], v[240:243]
  v_mfma_f32_16x16x32_bf16 a[144:147], a[24:27], a[80:83], a[144:147]
  buffer_load_dwordx4 v6, s[8:11], s30 offen offset:2048 lds
  ds_read_b64_tr_b16 a[114:115], v18 offset:14336
  v_mfma_f32_16x16x32_bf16 a[176:179], a[28:31], a[80:83], a[176:179]
  v_mfma_f32_16x16x32_bf16 v[84:87], a[0:3], a[84:87], v[84:87]
  ds_read_b64_tr_b16 a[116:117], v19 offset:12288
  v_mfma_f32_16x16x32_bf16 v[116:119], a[4:7], a[84:87], v[116:119]
  v_mfma_f32_16x16x32_bf16 v[148:151], a[8:11], a[84:87], v[148:151]
  ds_read_b64_tr_b16 a[118:119], v19 offset:14336
  v_mfma_f32_16x16x32_bf16 v[180:183], a[12:15], a[84:87], v[180:183]
  v_mfma_f32_16x16x32_bf16 v[212:215], a[16:19], a[84:87], v[212:215]
  v_mfma_f32_16x16x32_bf16 v[244:247], a[20:23], a[84:87], v[244:247]
  ds_read_b64_tr_b16 a[120:121], v20 offset:12288
  v_mfma_f32_16x16x32_bf16 a[148:151], a[24:27], a[84:87], a[148:151]
  v_mfma_f32_16x16x32_bf16 a[180:183], a[28:31], a[84:87], a[180:183]
  buffer_load_dwordx4 v7, s[8:11], s30 offen offset:3072 lds
  ds_read_b64_tr_b16 a[122:123], v20 offset:14336
  v_mfma_f32_16x16x32_bf16 v[88:91], a[0:3], a[88:91], v[88:91]
  s_mul_i32 s31, s0, 393216
  s_bfe_u32 s29, 0x302010e, s1
  s_add_u32 s0, s0, s29
  v_mfma_f32_16x16x32_bf16 v[120:123], a[4:7], a[88:91], v[120:123]
  s_add_u32 s1, s1, 8
  s_and_b32 s1, s1, 0x8001f
  s_and_b32 s0, s0, 15
  v_mfma_f32_16x16x32_bf16 v[152:155], a[8:11], a[88:91], v[152:155]
  s_lshl_b32 s30, s0, 7
  ds_read_b64_tr_b16 a[124:125], v21 offset:12288
  v_mfma_f32_16x16x32_bf16 v[184:187], a[12:15], a[88:91], v[184:187]
  s_add_u32 s36, s36, s38
  s_add_u32 s37, s37, 1
  ds_read_b64_tr_b16 a[126:127], v21 offset:14336
  v_mfma_f32_16x16x32_bf16 v[216:219], a[16:19], a[88:91], v[216:219]
  s_cmp_eq_u32 s37, 3
  s_cselect_b32 s37, 0, s37
  s_cselect_b32 s38, s39, s40
  v_mfma_f32_16x16x32_bf16 v[248:251], a[20:23], a[88:91], v[248:251]
  s_add_u32 s41, s41, s43
  s_sub_u32 s43, 0, s43
  v_mfma_f32_16x16x32_bf16 a[152:155], a[24:27], a[88:91], a[152:155]
  v_add_u32 v16, s38, v16
  v_add_u32 v17, s38, v17
  v_mfma_f32_16x16x32_bf16 a[184:187], a[28:31], a[88:91], a[184:187]
  v_add_u32 v18, s43, v18
  v_add_u32 v19, s43, v19
  v_mfma_f32_16x16x32_bf16 v[92:95], a[0:3], a[92:95], v[92:95]
  v_add_u32 v20, s43, v20
  v_add_u32 v21, s43, v21
  v_mfma_f32_16x16x32_bf16 v[124:127], a[4:7], a[92:95], v[124:127]
  v_mfma_f32_16x16x32_bf16 v[156:159], a[8:11], a[92:95], v[156:159]
  v_mfma_f32_16x16x32_bf16 v[188:191], a[12:15], a[92:95], v[188:191]
  v_mfma_f32_16x16x32_bf16 v[220:223], a[16:19], a[92:95], v[220:223]
  v_mfma_f32_16x16x32_bf16 v[252:255], a[20:23], a[92:95], v[252:255]
  v_mfma_f32_16x16x32_bf16 a[156:159], a[24:27], a[92:95], a[156:159]
  v_mfma_f32_16x16x32_bf16 a[188:191], a[28:31], a[92:95], a[188:191]
  s_waitcnt vmcnt(4) lgkmcnt(0)
  s_barrier
  v_mfma_f32_16x16x32_bf16 v[64:67], a[32:35], a[96:99], v[64:67]
  s_add_u32 m0, s88, s26
  ds_read_b128 a[0:3], v16 offset:0
  v_mfma_f32_16x16x32_bf16 v[96:99], a[36:39], a[96:99], v[96:99]
  buffer_load_dwordx4 v8, s[20:23], s31 offen offset:0 lds
  v_mfma_f32_16x16x32_bf16 v[128:131], a[40:43], a[96:99], v[128:131]
  ds_read_b64_tr_b16 a[64:65], v18 offset:0
  v_mfma_f32_16x16x32_bf16 v[160:163], a[44:47], a[96:99], v[160:163]
  buffer_load_dwordx4 v9, s[20:23], s31 offen offset:1024 lds
  v_mfma_f32_16x16x32_bf16 v[192:195], a[48:51], a[96:99], v[192:195]
  ds_read_b64_tr_b16 a[66:67], v18 offset:2048
  v_mfma_f32_16x16x32_bf16 v[224:227], a[52:55], a[96:99], v[224:227]
  v_mfma_f32_16x16x32_bf16 a[128:131], a[56:59], a[96:99], a[128:131]
  ds_read_b128 a[4:7], v16 offset:2048
  v_mfma_f32_16x16x32_bf16 a[160:163], a[60:63], a[96:99], a[160:163]
  buffer_load_dwordx4 v10, s[20:23], s31 offen offset:2048 lds
  v_mfma_f32_16x16x32_bf16 v[68:71], a[32:35], a[100:103], v[68:71]
  s_add_u32 m0, s88, s27
  v_mfma_f32_16x16x32_bf16 v[100:103], a[36:39], a[100:103], v[100:103]
  ds_read_b128 a[8:11], v16 offset:4096
  v_mfma_f32_16x16x32_bf16 v[132:135], a[40:43], a[100:103], v[132:135]
  v_mfma_f32_16x16x32_bf16 v[164:167], a[44:47], a[100:103], v[164:167]
  buffer_load_dwordx4 v11, s[20:23], s31 offen offset:0 lds
  ds_read_b128 a[12:15], v16 offset:6144
  v_mfma_f32_16x16x32_bf16 v[196:199], a[48:51], a[100:103], v[196:199]
  v_mfma_f32_16x16x32_bf16 v[228:231], a[52:55], a[100:103], v[228:231]
  ds_read_b128 a[16:19], v16 offset:8192
  v_mfma_f32_16x16x32_bf16 a[132:135], a[56:59], a[100:103], a[132:135]
  v_mfma_f32_16x16x32_bf16 a[164:167], a[60:63], a[100:103], a[164:167]
  buffer_load_dwordx4 v12, s[20:23], s31 offen offset:1024 lds
  ds_read_b128 a[20:23], v16 offset:10240
  v_mfma_f32_16x16x32_bf16 v[72:75], a[32:35], a[104:107], v[72:75]
  v_mfma_f32_16x16x32_bf16 v[104:107], a[36:39], a[104:107], v[104:107]
  v_mfma_f32_16x16x32_bf16 v[136:139], a[40:43], a[104:107], v[136:139]
  ds_read_b128 a[24:27], v16 offset:12288
  v_mfma_f32_16x16x32_bf16 v[168:171], a[44:47], a[104:107], v[168:171]
  buffer_load_dwordx4 v13, s[20:23], s31 offen offset:2048 lds
  v_mfma_f32_16x16x32_bf16 v[200:203], a[48:51], a[104:107], v[200:203]
  s_cmp_ge_u32 s3, 2
  s_cbranch_scc1 Lh_4
  s_add_u32 m0, s88, s28
  s_add_u32 m0, m0, 43008
  s_nop 0
  buffer_load_dwordx4 v14, s[8:11], s30 offen offset:0 lds
Lh_4:
  v_mfma_f32_16x16x32_bf16 v[232:235], a[52:55], a[104:107], v[232:235]
  s_add_u32 m0, s88, 43008
  ds_read_b128 a[28:31], v16 offset:14336
  v_mfma_f32_16x16x32_bf16 a[136:139], a[56:59], a[104:107], a[136:139]
  ds_read_b64_tr_b16 a[68:69], v19 offset:0
  v_mfma_f32_16x16x32_bf16 a[168:171], a[60:63], a[104:107], a[168:171]
  buffer_load_dwordx4 v4, s[8:11], s30 offen offset:0 lds
  v_mfma_f32_16x16x32_bf16 v[76:79], a[32:35], a[108:111], v[76:79]
  ds_read_b64_tr_b16 a[70:71], v19 offset:2048
  v_mfma_f32_16x16x32_bf16 v[108:111], a[36:39], a[108:111], v[108:111]
  v_mfma_f32_16x16x32_bf16 v[140:143], a[40:43], a[108:111], v[140:143]
  v_mfma_f32_16x16x32_bf16 v[172:175], a[44:47], a[108:111], v[172:175]
  buffer_load_dwordx4 v5, s[8:11], s30 offen offset:1024 lds
  ds_read_b64_tr_b16 a[72:73], v20 offset:0
  v_mfma_f32_16x16x32_bf16 v[204:207], a[48:51], a[108:111], v[204:207]
  v_mfma_f32_16x16x32_bf16 v[236:239], a[52:55], a[108:111], v[236:239]
  ds_read_b64_tr_b16 a[74:75], v20 offset:2048
  v_mfma_f32_16x16x32_bf16 a[140:143], a[56:59], a[108:111], a[140:143]
  v_mfma_f32_16x16x32_bf16 a[172:175], a[60:63], a[108:111], a[172:175]
  buffer_load_dwordx4 v6, s[8:11], s30 offen offset:2048 lds
  ds_read_b64_tr_b16 a[76:77], v21 offset:0
  v_mfma_f32_16x16x32_bf16 v[80:83], a[32:35], a[112:115], v[80:83]
  v_mfma_f32_16x16x32_bf16 v[112:115], a[36:39], a[112:115], v[112:115]
  ds_read_b64_tr_b16 a[78:79], v21 offset:2048
  v_mfma_f32_16x16x32_bf16 v[144:147], a[40:43], a[112:115], v[144:147]
  v_mfma_f32_16x16x32_bf16 v[176:179], a[44:47], a[112:115], v[176:179]
  buffer_load_dwordx4 v7, s[8:11], s30 offen offset:3072 lds
  v_mfma_f32_16x16x32_bf16 v[208:211], a[48:51], a[112:115], v[208:211]
  s_mul_i32 s31, s0, 393216
  s_bfe_u32 s29, 0x302010e, s1
  s_add_u32 s0, s0, s29
  v_mfma_f32_16x16x32_bf16 v[240:243], a[52:55], a[112:115], v[240:243]
  s_add_u32 s1, s1, 8
  s_and_b32 s1, s1, 0x8001f
  s_and_b32 s0, s0, 15
  v_mfma_f32_16x16x32_bf16 a[144:147], a[56:59], a[112:115], a[144:147]
  s_lshl_b32 s30, s0, 7
  s_add_u32 m0, s88, s26
  s_add_u32 m0, m0, 43008
  v_mfma_f32_16x16x32_bf16 a[176:179], a[60:63], a[112:115], a[176:179]
  buffer_load_dwordx4 v8, s[20:23], s31 offen offset:0 lds
  ds_read_b64_tr_b16 a[80:81], v18 offset:8192
  v_mfma_f32_16x16x32_bf16 v[84:87], a[32:35], a[116:119], v[84:87]
  ds_read_b64_tr_b16 a[82:83], v18 offset:10240
  ds_read_b64_tr_b16 a[84:85], v19 offset:8192
  v_mfma_f32_16x16x32_bf16 v[116:119], a[36:39], a[116:119], v[116:119]
  v_mfma_f32_16x16x32_bf16 v[148:151], a[40:43], a[116:119], v[148:151]
  ds_read_b64_tr_b16 a[86:87], v19 offset:10240
  v_mfma_f32_16x16x32_bf16 v[180:183], a[44:47], a[116:119], v[180:183]
  buffer_load_dwordx4 v9, s[20:23], s31 offen offset:1024 lds
  v_mfma_f32_16x16x32_bf16 v[212:215], a[48:51], a[116:119], v[212:215]
  v_mfma_f32_16x16x32_bf16 v[244:247], a[52:55], a[116:119], v[244:247]
  ds_read_b64_tr_b16 a[88:89], v20 offset:8192
  v_mfma_f32_16x16x32_bf16 a[148:151], a[56:59], a[116:119], a[148:151]
  v_mfma_f32_16x16x32_bf16 a[180:183], a[60:63], a[116:119], a[180:183]
  buffer_load_dwordx4 v10, s[20:23], s31 offen offset:2048 lds
  ds_read_b64_tr_b16 a[90:91], v20 offset:10240
  v_mfma_f32_16x16x32_bf16 v[88:91], a[32:35], a[120:123], v[88:91]
  s_add_u32 m0, s88, s27
  s_add_u32 m0, m0, 43008
  v_mfma_f32_16x16x32_bf16 v[120:123], a[36:39], a[120:123], v[120:123]
  ds_read_b64_tr_b16 a[92:93], v21 offset:8192
  v_mfma_f32_16x16x32_bf16 v[152:155], a[40:43], a[120:123], v[152:155]
  v_mfma_f32_16x16x32_bf16 v[184:187], a[44:47], a[120:123], v[184:187]
  buffer_load_dwordx4 v11, s[20:23], s31 offen offset:0 lds
  ds_read_b64_tr_b16 a[94:95], v21 offset:10240
  v_mfma_f32_16x16x32_bf16 v[216:219], a[48:51], a[120:123], v[216:219]
  v_mfma_f32_16x16x32_bf16 v[248:251], a[52:55], a[120:123], v[248:251]
  v_mfma_f32_16x16x32_bf16 a[152:155], a[56:59], a[120:123], a[152:155]
  v_mfma_f32_16x16x32_bf16 a[184:187], a[60:63], a[120:123], a[184:187]
  buffer_load_dwordx4 v12, s[20:23], s31 offen offset:1024 lds
  v_mfma_f32_16x16x32_bf16 v[92:95], a[32:35], a[124:127], v[92:95]
  v_mfma_f32_16x16x32_bf16 v[124:127], a[36:39], a[124:127], v[124:127]
  v_mfma_f32_16x16x32_bf16 v[156:159], a[40:43], a[124:127], v[156:159]
  v_mfma_f32_16x16x32_bf16 v[188:191], a[44:47], a[124:127], v[188:191]
  buffer_load_dwordx4 v13, s[20:23], s31 offen offset:2048 lds
  v_mfma_f32_16x16x32_bf16 v[220:223], a[48:51], a[124:127], v[220:223]
  v_mfma_f32_16x16x32_bf16 v[252:255], a[52:55], a[124:127], v[252:255]
  v_mfma_f32_16x16x32_bf16 a[156:159], a[56:59], a[124:127], a[156:159]
  v_mfma_f32_16x16x32_bf16 a[188:191], a[60:63], a[124:127], a[188:191]
  s_waitcnt lgkmcnt(0)
  v_mfma_f32_16x16x32_bf16 v[128:131], a[8:11], a[64:67], v[128:131]
  ds_read_b128 a[32:35], v17 offset:0
  ds_read_b64_tr_b16 a[96:97], v18 offset:4096
  v_mfma_f32_16x16x32_bf16 v[160:163], a[12:15], a[64:67], v[160:163]
  ds_read_b64_tr_b16 a[98:99], v18 offset:6144
  ds_read_b128 a[36:39], v17 offset:2048
  v_mfma_f32_16x16x32_bf16 v[132:135], a[8:11], a[68:71], v[132:135]
  ds_read_b128 a[40:43], v17 offset:4096
  ds_read_b128 a[44:47], v17 offset:6144
  v_mfma_f32_16x16x32_bf16 v[164:167], a[12:15], a[68:71], v[164:167]
  ds_read_b128 a[48:51], v17 offset:8192
  ds_read_b128 a[52:55], v17 offset:10240
  v_mfma_f32_16x16x32_bf16 v[136:139], a[8:11], a[72:75], v[136:139]
  ds_read_b128 a[56:59], v17 offset:12288
  ds_read_b128 a[60:63], v17 offset:14336
  v_mfma_f32_16x16x32_bf16 v[168:171], a[12:15], a[72:75], v[168:171]
  ds_read_b64_tr_b16 a[100:101], v19 offset:4096
  ds_read_b64_tr_b16 a[102:103], v19 offset:6144
  v_mfma_f32_16x16x32_bf16 v[140:143], a[8:11], a[76:79], v[140:143]
  ds_read_b64_tr_b16 a[104:105], v20 offset:4096
  v_mfma_f32_16x16x32_bf16 v[172:175], a[12:15], a[76:79], v[172:175]
  ds_read_b64_tr_b16 a[106:107], v20 offset:6144
  ds_read_b64_tr_b16 a[108:109], v21 offset:4096
  v_mfma_f32_16x16x32_bf16 v[144:147], a[8:11], a[80:83], v[144:147]
  ds_read_b64_tr_b16 a[110:111], v21 offset:6144
  ds_read_b64_tr_b16 a[112:113], v18 offset:12288
  v_mfma_f32_16x16x32_bf16 v[176:179], a[12:15], a[80:83], v[176:179]
  ds_read_b64_tr_b16 a[114:115], v18 offset:14336
  ds_read_b64_tr_b16 a[116:117], v19 offset:12288
  v_mfma_f32_16x16x32_bf16 v[148:151], a[8:11], a[84:87], v[148:151]
  ds_read_b64_tr_b16 a[118:119], v19 offset:14336
  ds_read_b64_tr_b16 a[120:121], v20 offset:12288
  v_mfma_f32_16x16x32_bf16 v[180:183], a[12:15], a[84:87], v[180:183]
  ds_read_b64_tr_b16 a[122:123], v20 offset:14336
  ds_read_b64_tr_b16 a[124:125], v21 offset:12288
  v_mfma_f32_16x16x32_bf16 v[152:155], a[8:11], a[88:91], v[152:155]
  ds_read_b64_tr_b16 a[126:127], v21 offset:14336
  v_mfma_f32_16x16x32_bf16 v[184:187], a[12:15], a[88:91], v[184:187]
  v_mfma_f32_16x16x32_bf16 v[156:159], a[8:11], a[92:95], v[156:159]
  v_mfma_f32_16x16x32_bf16 v[188:191], a[12:15], a[92:95], v[188:191]
  v_mfma_f32_16x16x32_bf16 v[192:195], a[16:19], a[64:67], v[192:195]
  v_mfma_f32_16x16x32_bf16 v[224:227], a[20:23], a[64:67], v[224:227]
  v_mfma_f32_16x16x32_bf16 v[196:199], a[16:19], a[68:71], v[196:199]
  v_mfma_f32_16x16x32_bf16 v[228:231], a[20:23], a[68:71], v[228:231]
  s_waitcnt lgkmcnt(0)
  s_barrier
  s_mov_b32 s12, s84
  s_mov_b32 s13, s85
  s_mov_b32 s14, 256
  s_mov_b32 s15, 0x00020000
  buffer_load_dwordx2 v[22:23], off, s[12:15], 0 sc1
  v_mfma_f32_16x16x32_bf16 v[128:131], a[40:43], a[96:99], v[128:131]
  s_cmp_ge_u32 s3, 2
  s_cbranch_scc1 Lh_5
  s_add_u32 m0, s88, s28
  s_add_u32 m0, m0, 86016
  s_nop 0
  buffer_load_dwordx4 v14, s[8:11], s30 offen offset:0 lds
Lh_5:
  v_mfma_f32_16x16x32_bf16 v[160:163], a[44:47], a[96:99], v[160:163]
  s_add_u32 m0, s88, 86016
  v_mfma_f32_16x16x32_bf16 v[132:135], a[40:43], a[100:103], v[132:135]
  buffer_load_dwordx4 v4, s[8:11], s30 offen offset:0 lds
  v_mfma_f32_16x16x32_bf16 v[164:167], a[44:47], a[100:103], v[164:167]
  v_mfma_f32_16x16x32_bf16 v[136:139], a[40:43], a[104:107], v[136:139]
  v_mfma_f32_16x16x32_bf16 v[168:171], a[44:47], a[104:107], v[168:171]
  v_cvt_pk_bf16_f32 v128, v128, v129
  v_cvt_pk_bf16_f32 v129, v130, v131
  v_mfma_f32_16x16x32_bf16 v[140:143], a[40:43], a[108:111], v[140:143]
  v_cvt_pk_bf16_f32 v130, v160, v161
  v_cvt_pk_bf16_f32 v131, v162, v163
  v_mfma_f32_16x16x32_bf16 v[172:175], a[44:47], a[108:111], v[172:175]
  v_cvt_pk_bf16_f32 v132, v132, v133
  v_cvt_pk_bf16_f32 v133, v134, v135
  v_mfma_f32_16x16x32_bf16 v[144:147], a[40:43], a[112:115], v[144:147]
  v_cvt_pk_bf16_f32 v134, v164, v165
  v_cvt_pk_bf16_f32 v135, v166, v167
  v_mfma_f32_16x16x32_bf16 v[176:179], a[44:47], a[112:115], v[176:179]
  v_cvt_pk_bf16_f32 v136, v136, v137
  v_cvt_pk_bf16_f32 v137, v138, v139
  v_mfma_f32_16x16x32_bf16 v[148:151], a[40:43], a[116:119], v[148:151]
  buffer_load_dwordx4 v5, s[8:11], s30 offen offset:1024 lds
  v_cvt_pk_bf16_f32 v138, v168, v169
  v_mfma_f32_16x16x32_bf16 v[180:183], a[44:47], a[116:119], v[180:183]
  v_cvt_pk_bf16_f32 v139, v170, v171
  v_mfma_f32_16x16x32_bf16 v[152:155], a[40:43], a[120:123], v[152:155]
  s_add_u32 s60, s63, 8192
  buffer_store_dwordx4 v[128:131], v2, s[16:19], s60 offen offset:0 sc1
  v_cvt_pk_bf16_f32 v140, v140, v141
  v_mfma_f32_16x16x32_bf16 v[184:187], a[44:47], a[120:123], v[184:187]
  v_cvt_pk_bf16_f32 v141, v142, v143
  v_cvt_pk_bf16_f32 v142, v172, v173
  v_mfma_f32_16x16x32_bf16 v[156:159], a[40:43], a[124:127], v[156:159]
  v_cvt_pk_bf16_f32 v143, v174, v175
  v_cvt_pk_bf16_f32 v144, v144, v145
  v_mfma_f32_16x16x32_bf16 v[188:191], a[44:47], a[124:127], v[188:191]
  v_cvt_pk_bf16_f32 v145, v146, v147
  v_cvt_pk_bf16_f32 v146, v176, v177
  v_mfma_f32_16x16x32_bf16 v[192:195], a[48:51], a[96:99], v[192:195]
  v_cvt_pk_bf16_f32 v147, v178, v179
  v_cvt_pk_bf16_f32 v148, v148, v149
  v_mfma_f32_16x16x32_bf16 v[224:227], a[52:55], a[96:99], v[224:227]
  v_cvt_pk_bf16_f32 v149, v150, v151
  v_cvt_pk_bf16_f32 v150, v180, v181
  v_mfma_f32_16x16x32_bf16 v[196:199], a[48:51], a[100:103], v[196:199]
  v_cvt_pk_bf16_f32 v151, v182, v183
  v_mfma_f32_16x16x32_bf16 v[228:231], a[52:55], a[100:103], v[228:231]
  s_add_u32 s60, s63, 8192
  buffer_store_dwordx4 v[132:135], v2, s[16:19], s60 offen offset:1024 sc1
  v_cvt_pk_bf16_f32 v152, v152, v153
  v_mfma_f32_16x16x32_bf16 v[200:203], a[16:19], a[72:75], v[200:203]
  v_cvt_pk_bf16_f32 v153, v154, v155
  v_cvt_pk_bf16_f32 v154, v184, v185
  v_mfma_f32_16x16x32_bf16 v[232:235], a[20:23], a[72:75], v[232:235]
  buffer_load_dwordx4 v6, s[8:11], s30 offen offset:2048 lds
  v_cvt_pk_bf16_f32 v155, v186, v187
  v_mfma_f32_16x16x32_bf16 v[200:203], a[48:51], a[104:107], v[200:203]
  v_cvt_pk_bf16_f32 v156, v156, v157
  v_cvt_pk_bf16_f32 v157, v158, v159
  v_mfma_f32_16x16x32_bf16 v[232:235], a[52:55], a[104:107], v[232:235]
  v_cvt_pk_bf16_f32 v158, v188, v189
  v_cvt_pk_bf16_f32 v159, v190, v191
  v_mfma_f32_16x16x32_bf16 v[204:207], a[16:19], a[76:79], v[204:207]
  v_cvt_pk_bf16_f32 v192, v192, v193
  v_cvt_pk_bf16_f32 v193, v194, v195
  v_mfma_f32_16x16x32_bf16 v[236:239], a[20:23], a[76:79], v[236:239]
  v_cvt_pk_bf16_f32 v194, v224, v225
  v_cvt_pk_bf16_f32 v195, v226, v227
  v_mfma_f32_16x16x32_bf16 v[204:207], a[48:51], a[108:111], v[204:207]
  v_cvt_pk_bf16_f32 v196, v196, v197
  v_cvt_pk_bf16_f32 v197, v198, v199
  v_mfma_f32_16x16x32_bf16 v[236:239], a[52:55], a[108:111], v[236:239]
  v_cvt_pk_bf16_f32 v198, v228, v229
  v_cvt_pk_bf16_f32 v199, v230, v231
  v_mfma_f32_16x16x32_bf16 v[208:211], a[16:19], a[80:83], v[208:211]
  s_add_u32 s60, s63, 8192
  buffer_store_dwordx4 v[136:139], v2, s[16:19], s60 offen offset:2048 sc1
  v_cvt_pk_bf16_f32 v200, v200, v201
  v_mfma_f32_16x16x32_bf16 v[240:243], a[20:23], a[80:83], v[240:243]
  v_cvt_pk_bf16_f32 v201, v202, v203
  v_cvt_pk_bf16_f32 v202, v232, v233
  v_mfma_f32_16x16x32_bf16 v[208:211], a[48:51], a[112:115], v[208:211]
  v_cvt_pk_bf16_f32 v203, v234, v235
  v_mfma_f32_16x16x32_bf16 v[240:243], a[52:55], a[112:115], v[240:243]
  v_cvt_pk_bf16_f32 v204, v204, v205
  v_cvt_pk_bf16_f32 v205, v206, v207
  v_mfma_f32_16x16x32_bf16 v[212:215], a[16:19], a[84:87], v[212:215]
  buffer_load_dwordx4 v7, s[8:11], s30 offen offset:3072 lds
  v_cvt_pk_bf16_f32 v206, v236, v237
  v_mfma_f32_16x16x32_bf16 v[244:247], a[20:23], a[84:87], v[244:247]
  s_mul_i32 s31, s0, 393216
  s_bfe_u32 s29, 0x302010e, s1
  s_add_u32 s0, s0, s29
  v_mfma_f32_16x16x32_bf16 v[212:215], a[48:51], a[116:119], v[212:215]
  s_add_u32 s1, s1, 8
  s_and_b32 s1, s1, 0x8001f
  s_and_b32 s0, s0, 15
  v_mfma_f32_16x16x32_bf16 v[244:247], a[52:55], a[116:119], v[244:247]
  s_lshl_b32 s30, s0, 7
  s_add_u32 m0, s88, s26
  s_add_u32 m0, m0, 86016
  v_mfma_f32_16x16x32_bf16 v[216:219], a[16:19], a[88:91], v[216:219]
  v_cvt_pk_bf16_f32 v207, v238, v239
  v_cvt_pk_bf16_f32 v208, v208, v209
  v_mfma_f32_16x16x32_bf16 v[248:251], a[20:23], a[88:91], v[248:251]
  v_cvt_pk_bf16_f32 v209, v210, v211
  v_cvt_pk_bf16_f32 v210, v240, v241
  v_mfma_f32_16x16x32_bf16 v[216:219], a[48:51], a[120:123], v[216:219]
  v_cvt_pk_bf16_f32 v211, v242, v243
  v_mfma_f32_16x16x32_bf16 v[248:251], a[52:55], a[120:123], v[248:251]
  s_add_u32 s60, s63, 8192
  buffer_store_dwordx4 v[140:143], v2, s[16:19], s60 offen offset:3072 sc1
  v_cvt_pk_bf16_f32 v212, v212, v213
  v_mfma_f32_16x16x32_bf16 v[220:223], a[16:19], a[92:95], v[220:223]
  v_cvt_pk_bf16_f32 v213, v214, v215
  v_cvt_pk_bf16_f32 v214, v244, v245
  v_mfma_f32_16x16x32_bf16 v[252:255], a[20:23], a[92:95], v[252:255]
  v_cvt_pk_bf16_f32 v215, v246, v247
  v_mfma_f32_16x16x32_bf16 v[220:223], a[48:51], a[124:127], v[220:223]
  buffer_load_dwordx4 v8, s[20:23], s31 offen offset:0 lds
  v_mfma_f32_16x16x32_bf16 v[252:255], a[52:55], a[124:127], v[252:255]
  v_cvt_pk_bf16_f32 v216, v216, v217
  v_cvt_pk_bf16_f32 v217, v218, v219
  v_mfma_f32_16x16x32_bf16 v[64:67], a[0:3], a[64:67], v[64:67]
  v_cvt_pk_bf16_f32 v218, v248, v249
  v_cvt_pk_bf16_f32 v219, v250, v251
  v_mfma_f32_16x16x32_bf16 v[96:99], a[4:7], a[64:67], v[96:99]
  v_mfma_f32_16x16x32_bf16 v[64:67], a[32:35], a[96:99], v[64:67]
  v_mfma_f32_16x16x32_bf16 v[96:99], a[36:39], a[96:99], v[96:99]
  v_cvt_pk_bf16_f32 v220, v220, v221
  v_cvt_pk_bf16_f32 v221, v222, v223
  v_mfma_f32_16x16x32_bf16 v[68:71], a[0:3], a[68:71], v[68:71]
  v_cvt_pk_bf16_f32 v222, v252, v253
  v_cvt_pk_bf16_f32 v223, v254, v255
  v_mfma_f32_16x16x32_bf16 v[100:103], a[4:7], a[68:71], v[100:103]
  v_mfma_f32_16x16x32_bf16 v[68:71], a[32:35], a[100:103], v[68:71]
  v_mfma_f32_16x16x32_bf16 v[100:103], a[36:39], a[100:103], v[100:103]
  v_cvt_pk_bf16_f32 v160, v64, v65
  v_cvt_pk_bf16_f32 v161, v66, v67
  v_mfma_f32_16x16x32_bf16 v[72:75], a[0:3], a[72:75], v[72:75]
  v_cvt_pk_bf16_f32 v162, v96, v97
  v_cvt_pk_bf16_f32 v163, v98, v99
  v_mfma_f32_16x16x32_bf16 v[104:107], a[4:7], a[72:75], v[104:107]
  buffer_load_dwordx4 v9, s[20:23], s31 offen offset:1024 lds
  v_mfma_f32_16x16x32_bf16 v[72:75], a[32:35], a[104:107], v[72:75]
  s_add_u32 s60, s63, 12288
  buffer_store_dwordx4 v[144:147], v2, s[16:19], s60 offen offset:0 sc1
  v_mfma_f32_16x16x32_bf16 v[104:107], a[36:39], a[104:107], v[104:107]
  v_cvt_pk_bf16_f32 v164, v68, v69
  v_cvt_pk_bf16_f32 v165, v70, v71
  v_mfma_f32_16x16x32_bf16 v[76:79], a[0:3], a[76:79], v[76:79]
  v_cvt_pk_bf16_f32 v166, v100, v101
  v_cvt_pk_bf16_f32 v167, v102, v103
  v_mfma_f32_16x16x32_bf16 v[108:111], a[4:7], a[76:79], v[108:111]
  v_mfma_f32_16x16x32_bf16 v[76:79], a[32:35], a[108:111], v[76:79]
  v_mfma_f32_16x16x32_bf16 v[108:111], a[36:39], a[108:111], v[108:111]
  v_cvt_pk_bf16_f32 v168, v72, v73
  v_cvt_pk_bf16_f32 v169, v74, v75
  v_mfma_f32_16x16x32_bf16 v[80:83], a[0:3], a[80:83], v[80:83]
  v_cvt_pk_bf16_f32 v170, v104, v105
  v_cvt_pk_bf16_f32 v171, v106, v107
  v_mfma_f32_16x16x32_bf16 v[112:115], a[4:7], a[80:83], v[112:115]
  v_mfma_f32_16x16x32_bf16 v[80:83], a[32:35], a[112:115], v[80:83]
  v_mfma_f32_16x16x32_bf16 v[112:115], a[36:39], a[112:115], v[112:115]
  v_cvt_pk_bf16_f32 v172, v76, v77
  v_cvt_pk_bf16_f32 v173, v78, v79
  v_mfma_f32_16x16x32_bf16 v[84:87], a[0:3], a[84:87], v[84:87]
  buffer_load_dwordx4 v10, s[20:23], s31 offen offset:2048 lds
  v_cvt_pk_bf16_f32 v174, v108, v109
  v_mfma_f32_16x16x32_bf16 v[116:119], a[4:7], a[84:87], v[116:119]
  s_add_u32 m0, s88, s27
  s_add_u32 m0, m0, 86016
  v_cvt_pk_bf16_f32 v175, v110, v111
  v_mfma_f32_16x16x32_bf16 v[84:87], a[32:35], a[116:119], v[84:87]
  s_add_u32 s60, s63, 12288
  buffer_store_dwordx4 v[148:151], v2, s[16:19], s60 offen offset:1024 sc1
  v_mfma_f32_16x16x32_bf16 v[116:119], a[36:39], a[116:119], v[116:119]
  v_cvt_pk_bf16_f32 v176, v80, v81
  v_cvt_pk_bf16_f32 v177, v82, v83
  v_mfma_f32_16x16x32_bf16 v[88:91], a[0:3], a[88:91], v[88:91]
  v_cvt_pk_bf16_f32 v178, v112, v113
  v_cvt_pk_bf16_f32 v179, v114, v115
  v_mfma_f32_16x16x32_bf16 v[120:123], a[4:7], a[88:91], v[120:123]
  v_mfma_f32_16x16x32_bf16 v[88:91], a[32:35], a[120:123], v[88:91]
  v_mfma_f32_16x16x32_bf16 v[120:123], a[36:39], a[120:123], v[120:123]
  v_cvt_pk_bf16_f32 v180, v84, v85
  v_cvt_pk_bf16_f32 v181, v86, v87
  v_mfma_f32_16x16x32_bf16 v[92:95], a[0:3], a[92:95], v[92:95]
  v_cvt_pk_bf16_f32 v182, v116, v117
  v_cvt_pk_bf16_f32 v183, v118, v119
  v_mfma_f32_16x16x32_bf16 v[124:127], a[4:7], a[92:95], v[124:127]
  v_mfma_f32_16x16x32_bf16 v[92:95], a[32:35], a[124:127], v[92:95]
  buffer_load_dwordx4 v11, s[20:23], s31 offen offset:0 lds
  v_mfma_f32_16x16x32_bf16 v[124:127], a[36:39], a[124:127], v[124:127]
  v_cvt_pk_bf16_f32 v184, v88, v89
  v_cvt_pk_bf16_f32 v185, v90, v91
  v_mfma_f32_16x16x32_bf16 a[128:131], a[24:27], a[64:67], a[128:131]
  v_cvt_pk_bf16_f32 v186, v120, v121
  v_cvt_pk_bf16_f32 v187, v122, v123
  v_mfma_f32_16x16x32_bf16 a[160:163], a[28:31], a[64:67], a[160:163]
  v_mfma_f32_16x16x32_bf16 a[128:131], a[56:59], a[96:99], a[128:131]
  v_mfma_f32_16x16x32_bf16 a[160:163], a[60:63], a[96:99], a[160:163]
  v_cvt_pk_bf16_f32 v188, v92, v93
  v_cvt_pk_bf16_f32 v189, v94, v95
  v_mfma_f32_16x16x32_bf16 a[132:135], a[24:27], a[68:71], a[132:135]
  v_cvt_pk_bf16_f32 v190, v124, v125
  v_cvt_pk_bf16_f32 v191, v126, v127
  v_mfma_f32_16x16x32_bf16 a[164:167], a[28:31], a[68:71], a[164:167]
  s_add_u32 s60, s63, 12288
  buffer_store_dwordx4 v[152:155], v2, s[16:19], s60 offen offset:2048 sc1
  v_mfma_f32_16x16x32_bf16 a[132:135], a[56:59], a[100:103], a[132:135]
  v_mfma_f32_16x16x32_bf16 a[164:167], a[60:63], a[100:103], a[164:167]
  v_accvgpr_read_b32 v64, a128
  v_accvgpr_read_b32 v65, a129
  v_mfma_f32_16x16x32_bf16 a[136:139], a[24:27], a[72:75], a[136:139]
  v_accvgpr_read_b32 v66, a130
  v_accvgpr_read_b32 v67, a131
  v_mfma_f32_16x16x32_bf16 a[168:171], a[28:31], a[72:75], a[168:171]
  buffer_load_dwordx4 v12, s[20:23], s31 offen offset:1024 lds
  v_accvgpr_read_b32 v68, a160
  v_mfma_f32_16x16x32_bf16 a[136:139], a[56:59], a[104:107], a[136:139]
  v_accvgpr_read_b32 v69, a161
  v_accvgpr_read_b32 v70, a162
  v_mfma_f32_16x16x32_bf16 a[168:171], a[60:63], a[104:107], a[168:171]
  v_accvgpr_read_b32 v71, a163
  v_cvt_pk_bf16_f32 v224, v64, v65
  v_mfma_f32_16x16x32_bf16 a[140:143], a[24:27], a[76:79], a[140:143]
  v_cvt_pk_bf16_f32 v225, v66, v67
  v_cvt_pk_bf16_f32 v226, v68, v69
  v_mfma_f32_16x16x32_bf16 a[172:175], a[28:31], a[76:79], a[172:175]
  v_cvt_pk_bf16_f32 v227, v70, v71
  v_accvgpr_read_b32 v72, a132
  v_mfma_f32_16x16x32_bf16 a[140:143], a[56:59], a[108:111], a[140:143]
  v_accvgpr_read_b32 v73, a133
  v_accvgpr_read_b32 v74, a134
  v_mfma_f32_16x16x32_bf16 a[172:175], a[60:63], a[108:111], a[172:175]
  v_accvgpr_read_b32 v75, a135
  v_accvgpr_read_b32 v76, a164
  v_mfma_f32_16x16x32_bf16 a[144:147], a[24:27], a[80:83], a[144:147]
  v_accvgpr_read_b32 v77, a165
  v_accvgpr_read_b32 v78, a166
  v_mfma_f32_16x16x32_bf16 a[176:179], a[28:31], a[80:83], a[176:179]
  v_accvgpr_read_b32 v79, a167
  v_cvt_pk_bf16_f32 v228, v72, v73
  v_mfma_f32_16x16x32_bf16 a[144:147], a[56:59], a[112:115], a[144:147]
  v_cvt_pk_bf16_f32 v229, v74, v75
  v_cvt_pk_bf16_f32 v230, v76, v77
  v_mfma_f32_16x16x32_bf16 a[176:179], a[60:63], a[112:115], a[176:179]
  v_cvt_pk_bf16_f32 v231, v78, v79
  v_accvgpr_read_b32 v80, a136
  v_mfma_f32_16x16x32_bf16 a[148:151], a[24:27], a[84:87], a[148:151]
  buffer_load_dwordx4 v13, s[20:23], s31 offen offset:2048 lds
  v_accvgpr_read_b32 v81, a137
  v_mfma_f32_16x16x32_bf16 a[180:183], a[28:31], a[84:87], a[180:183]
  v_accvgpr_read_b32 v82, a138
  v_accvgpr_read_b32 v83, a139
  v_mfma_f32_16x16x32_bf16 a[148:151], a[56:59], a[116:119], a[148:151]
  v_accvgpr_read_b32 v84, a168
  v_accvgpr_read_b32 v85, a169
  v_mfma_f32_16x16x32_bf16 a[180:183], a[60:63], a[116:119], a[180:183]
  v_accvgpr_read_b32 v86, a170
  v_accvgpr_read_b32 v87, a171
  v_mfma_f32_16x16x32_bf16 a[152:155], a[24:27], a[88:91], a[152:155]
  v_cvt_pk_bf16_f32 v232, v80, v81
  v_cvt_pk_bf16_f32 v233, v82, v83
  v_mfma_f32_16x16x32_bf16 a[184:187], a[28:31], a[88:91], a[184:187]
  v_cvt_pk_bf16_f32 v234, v84, v85
  v_cvt_pk_bf16_f32 v235, v86, v87
  v_mfma_f32_16x16x32_bf16 a[152:155], a[56:59], a[120:123], a[152:155]
  s_add_u32 s60, s63, 12288
  buffer_store_dwordx4 v[156:159], v2, s[16:19], s60 offen offset:3072 sc1
  v_accvgpr_read_b32 v88, a140
  v_mfma_f32_16x16x32_bf16 a[184:187], a[60:63], a[120:123], a[184:187]
  v_accvgpr_read_b32 v89, a141
  v_accvgpr_read_b32 v90, a142
  v_mfma_f32_16x16x32_bf16 a[156:159], a[24:27], a[92:95], a[156:159]
  v_accvgpr_read_b32 v91, a143
  v_accvgpr_read_b32 v92, a172
  v_mfma_f32_16x16x32_bf16 a[188:191], a[28:31], a[92:95], a[188:191]
  v_accvgpr_read_b32 v93, a173
  v_accvgpr_read_b32 v94, a174
  v_mfma_f32_16x16x32_bf16 a[156:159], a[56:59], a[124:127], a[156:159]
  v_accvgpr_read_b32 v95, a175
  v_cvt_pk_bf16_f32 v236, v88, v89
  v_mfma_f32_16x16x32_bf16 a[188:191], a[60:63], a[124:127], a[188:191]
  v_cvt_pk_bf16_f32 v237, v90, v91
  v_cvt_pk_bf16_f32 v238, v92, v93
  v_cvt_pk_bf16_f32 v239, v94, v95
  v_accvgpr_read_b32 v96, a144
  v_accvgpr_read_b32 v97, a145
  v_accvgpr_read_b32 v98, a146
  v_accvgpr_read_b32 v99, a147
  v_accvgpr_read_b32 v100, a176
  v_accvgpr_read_b32 v101, a177
  v_accvgpr_read_b32 v102, a178
  v_accvgpr_read_b32 v103, a179
  v_cvt_pk_bf16_f32 v240, v96, v97
  v_cvt_pk_bf16_f32 v241, v98, v99
  v_cvt_pk_bf16_f32 v242, v100, v101
  v_cvt_pk_bf16_f32 v243, v102, v103
  v_accvgpr_read_b32 v104, a148
  v_accvgpr_read_b32 v105, a149
  v_accvgpr_read_b32 v106, a150
  v_accvgpr_read_b32 v107, a151
  v_accvgpr_read_b32 v108, a180
  v_accvgpr_read_b32 v109, a181
  v_accvgpr_read_b32 v110, a182
  v_accvgpr_read_b32 v111, a183
  v_cvt_pk_bf16_f32 v244, v104, v105
  v_cvt_pk_bf16_f32 v245, v106, v107
  v_cvt_pk_bf16_f32 v246, v108, v109
  v_cvt_pk_bf16_f32 v247, v110, v111
  v_accvgpr_read_b32 v112, a152
  v_accvgpr_read_b32 v113, a153
  v_accvgpr_read_b32 v114, a154
  v_accvgpr_read_b32 v115, a155
  v_accvgpr_read_b32 v116, a184
  v_accvgpr_read_b32 v117, a185
  v_accvgpr_read_b32 v118, a186
  v_accvgpr_read_b32 v119, a187
  v_cvt_pk_bf16_f32 v248, v112, v113
  v_cvt_pk_bf16_f32 v249, v114, v115
  v_cvt_pk_bf16_f32 v250, v116, v117
  v_cvt_pk_bf16_f32 v251, v118, v119
  v_accvgpr_read_b32 v120, a156
  v_accvgpr_read_b32 v121, a157
  v_accvgpr_read_b32 v122, a158
  v_accvgpr_read_b32 v123, a159
  v_accvgpr_read_b32 v124, a188
  v_accvgpr_read_b32 v125, a189
  v_accvgpr_read_b32 v126, a190
  v_accvgpr_read_b32 v127, a191
  v_cvt_pk_bf16_f32 v252, v120, v121
  v_cvt_pk_bf16_f32 v253, v122, v123
  v_cvt_pk_bf16_f32 v254, v124, v125
  v_cvt_pk_bf16_f32 v255, v126, v127
  s_branch Lp2
Lp1_k:
  s_waitcnt vmcnt(16)
  s_barrier
  ds_read_b128 a[0:3], v16 offset:0
  ds_read_b64_tr_b16 a[64:65], v18 offset:0
  ds_read_b64_tr_b16 a[66:67], v18 offset:2048
  ds_read_b128 a[4:7], v16 offset:2048
  ds_read_b128 a[8:11], v16 offset:4096
  ds_read_b128 a[12:15], v16 offset:6144
  ds_read_b128 a[16:19], v16 offset:8192
  ds_read_b128 a[20:23], v16 offset:10240
  ds_read_b128 a[24:27], v16 offset:12288
  ds_read_b128 a[28:31], v16 offset:14336
  ds_read_b64_tr_b16 a[68:69], v19 offset:0
  ds_read_b64_tr_b16 a[70:71], v19 offset:2048
  ds_read_b64_tr_b16 a[72:73], v20 offset:0
  ds_read_b64_tr_b16 a[74:75], v20 offset:2048
  ds_read_b64_tr_b16 a[76:77], v21 offset:0
  ds_read_b64_tr_b16 a[78:79], v21 offset:2048
  ds_read_b64_tr_b16 a[80:81], v18 offset:8192
  ds_read_b64_tr_b16 a[82:83], v18 offset:10240
  ds_read_b64_tr_b16 a[84:85], v19 offset:8192
  ds_read_b64_tr_b16 a[86:87], v19 offset:10240
  ds_read_b64_tr_b16 a[88:89], v20 offset:8192
  ds_read_b64_tr_b16 a[90:91], v20 offset:10240
  ds_read_b64_tr_b16 a[92:93], v21 offset:8192
  ds_read_b64_tr_b16 a[94:95], v21 offset:10240
  s_waitcnt lgkmcnt(0)
  v_mfma_f32_16x16x32_bf16 v[64:67], a[64:67], a[0:3], 0
  s_add_u32 m0, s36, -32768
  ds_read_b128 a[32:35], v17 offset:0
  v_mfma_f32_16x16x32_bf16 v[96:99], a[64:67], a[4:7], 0
  buffer_load_dwordx4 v48, s[8:11], s46 offen offset:0 lds
  v_mfma_f32_16x16x32_bf16 v[128:131], a[64:67], a[8:11], 0
  ds_read_b64_tr_b16 a[96:97], v18 offset:4096
  v_mfma_f32_16x16x32_bf16 v[160:163], a[64:67], a[12:15], 0
  v_mfma_f32_16x16x32_bf16 v[192:195], a[64:67], a[16:19], 0
  ds_read_b64_tr_b16 a[98:99], v18 offset:6144
  v_mfma_f32_16x16x32_bf16 v[224:227], a[64:67], a[20:23], 0
  v_mfma_f32_16x16x32_bf16 a[128:131], a[64:67], a[24:27], 0
  ds_read_b128 a[36:39], v17 offset:2048
  v_mfma_f32_16x16x32_bf16 a[160:163], a[64:67], a[28:31], 0
  buffer_load_dwordx4 v49, s[8:11], s46 offen offset:1024 lds
  v_mfma_f32_16x16x32_bf16 v[68:71], a[68:71], a[0:3], 0
  v_mfma_f32_16x16x32_bf16 v[100:103], a[68:71], a[4:7], 0
  ds_read_b128 a[40:43], v17 offset:4096
  v_mfma_f32_16x16x32_bf16 v[132:135], a[68:71], a[8:11], 0
  v_mfma_f32_16x16x32_bf16 v[164:167], a[68:71], a[12:15], 0
  ds_read_b128 a[44:47], v17 offset:6144
  v_mfma_f32_16x16x32_bf16 v[196:199], a[68:71], a[16:19], 0
  v_mfma_f32_16x16x32_bf16 v[228:231], a[68:71], a[20:23], 0
  ds_read_b128 a[48:51], v17 offset:8192
  v_mfma_f32_16x16x32_bf16 a[132:135], a[68:71], a[24:27], 0
  buffer_load_dwordx4 v50, s[8:11], s46 offen offset:2048 lds
  v_mfma_f32_16x16x32_bf16 a[164:167], a[68:71], a[28:31], 0
  ds_read_b128 a[52:55], v17 offset:10240
  v_mfma_f32_16x16x32_bf16 v[72:75], a[72:75], a[0:3], 0
  v_mfma_f32_16x16x32_bf16 v[104:107], a[72:75], a[4:7], 0
  v_mfma_f32_16x16x32_bf16 v[136:139], a[72:75], a[8:11], 0
  ds_read_b128 a[56:59], v17 offset:12288
  v_mfma_f32_16x16x32_bf16 v[168:171], a[72:75], a[12:15], 0
  v_mfma_f32_16x16x32_bf16 v[200:203], a[72:75], a[16:19], 0
  ds_read_b128 a[60:63], v17 offset:14336
  v_mfma_f32_16x16x32_bf16 v[232:235], a[72:75], a[20:23], 0
  buffer_load_dwordx4 v51, s[8:11], s46 offen offset:3072 lds
  v_mfma_f32_16x16x32_bf16 a[136:139], a[72:75], a[24:27], 0
  s_add_u32 m0, s36, -28672
  ds_read_b64_tr_b16 a[100:101], v19 offset:4096
  v_mfma_f32_16x16x32_bf16 a[168:171], a[72:75], a[28:31], 0
  v_mfma_f32_16x16x32_bf16 v[76:79], a[76:79], a[0:3], 0
  ds_read_b64_tr_b16 a[102:103], v19 offset:6144
  v_mfma_f32_16x16x32_bf16 v[108:111], a[76:79], a[4:7], 0
  v_mfma_f32_16x16x32_bf16 v[140:143], a[76:79], a[8:11], 0
  v_mfma_f32_16x16x32_bf16 v[172:175], a[76:79], a[12:15], 0
  ds_read_b64_tr_b16 a[104:105], v20 offset:4096
  v_mfma_f32_16x16x32_bf16 v[204:207], a[76:79], a[16:19], 0
  buffer_load_dwordx4 v52, s[8:11], s46 offen offset:0 lds
  v_mfma_f32_16x16x32_bf16 v[236:239], a[76:79], a[20:23], 0
  ds_read_b64_tr_b16 a[106:107], v20 offset:6144
  v_mfma_f32_16x16x32_bf16 a[140:143], a[76:79], a[24:27], 0
  v_mfma_f32_16x16x32_bf16 a[172:175], a[76:79], a[28:31], 0
  ds_read_b64_tr_b16 a[108:109], v21 offset:4096
  v_mfma_f32_16x16x32_bf16 v[80:83], a[80:83], a[0:3], 0
  v_mfma_f32_16x16x32_bf16 v[112:115], a[80:83], a[4:7], 0
  ds_read_b64_tr_b16 a[110:111], v21 offset:6144
  v_mfma_f32_16x16x32_bf16 v[144:147], a[80:83], a[8:11], 0
  v_mfma_f32_16x16x32_bf16 v[176:179], a[80:83], a[12:15], 0
  buffer_load_dwordx4 v53, s[8:11], s46 offen offset:1024 lds
  v_mfma_f32_16x16x32_bf16 v[208:211], a[80:83], a[16:19], 0
  ds_read_b64_tr_b16 a[112:113], v18 offset:12288
  v_mfma_f32_16x16x32_bf16 v[240:243], a[80:83], a[20:23], 0
  v_mfma_f32_16x16x32_bf16 a[144:147], a[80:83], a[24:27], 0
  ds_read_b64_tr_b16 a[114:115], v18 offset:14336
  v_mfma_f32_16x16x32_bf16 a[176:179], a[80:83], a[28:31], 0
  v_mfma_f32_16x16x32_bf16 v[84:87], a[84:87], a[0:3], 0
  ds_read_b64_tr_b16 a[116:117], v19 offset:12288
  v_mfma_f32_16x16x32_bf16 v[116:119], a[84:87], a[4:7], 0
  v_mfma_f32_16x16x32_bf16 v[148:151], a[84:87], a[8:11], 0
  buffer_load_dwordx4 v54, s[8:11], s46 offen offset:2048 lds
  ds_read_b64_tr_b16 a[118:119], v19 offset:14336
  v_mfma_f32_16x16x32_bf16 v[180:183], a[84:87], a[12:15], 0
  v_mfma_f32_16x16x32_bf16 v[212:215], a[84:87], a[16:19], 0
  v_mfma_f32_16x16x32_bf16 v[244:247], a[84:87], a[20:23], 0
  ds_read_b64_tr_b16 a[120:121], v20 offset:12288
  v_mfma_f32_16x16x32_bf16 a[148:151], a[84:87], a[24:27], 0
  v_mfma_f32_16x16x32_bf16 a[180:183], a[84:87], a[28:31], 0
  ds_read_b64_tr_b16 a[122:123], v20 offset:14336
  v_mfma_f32_16x16x32_bf16 v[88:91], a[88:91], a[0:3], 0
  v_mfma_f32_16x16x32_bf16 v[120:123], a[88:91], a[4:7], 0
  buffer_load_dwordx4 v55, s[8:11], s46 offen offset:3072 lds
  ds_read_b64_tr_b16 a[124:125], v21 offset:12288
  v_mfma_f32_16x16x32_bf16 v[152:155], a[88:91], a[8:11], 0
  s_lshl_b32 s47, s48, 19
  s_bfe_u32 s34, 0x3020106, s49
  s_add_u32 s48, s48, s34
  v_mfma_f32_16x16x32_bf16 v[184:187], a[88:91], a[12:15], 0
  s_add_u32 s49, s49, 8
  s_and_b32 s49, s49, 0x8001f
  s_and_b32 s48, s48, 7
  v_mfma_f32_16x16x32_bf16 v[216:219], a[88:91], a[16:19], 0
  s_lshl_b32 s46, s48, 7
  ds_read_b64_tr_b16 a[126:127], v21 offset:14336
  v_mfma_f32_16x16x32_bf16 v[248:251], a[88:91], a[20:23], 0
  s_add_u32 s37, s37, 1
  s_cmp_eq_u32 s37, 3
  s_cselect_b32 s37, 0, s37
  s_cselect_b32 s38, s39, s40
  v_mfma_f32_16x16x32_bf16 a[152:155], a[88:91], a[24:27], 0
  s_sub_u32 s43, 0, s43
  v_mfma_f32_16x16x32_bf16 a[184:187], a[88:91], a[28:31], 0
  v_add_u32 v16, s38, v16
  v_add_u32 v17, s38, v17
  v_mfma_f32_16x16x32_bf16 v[92:95], a[92:95], a[0:3], 0
  v_add_u32 v18, s43, v18
  v_add_u32 v19, s43, v19
  v_mfma_f32_16x16x32_bf16 v[124:127], a[92:95], a[4:7], 0
  v_add_u32 v20, s43, v20
  v_add_u32 v21, s43, v21
  v_mfma_f32_16x16x32_bf16 v[156:159], a[92:95], a[8:11], 0
  v_mfma_f32_16x16x32_bf16 v[188:191], a[92:95], a[12:15], 0
  v_mfma_f32_16x16x32_bf16 v[220:223], a[92:95], a[16:19], 0
  v_mfma_f32_16x16x32_bf16 v[252:255], a[92:95], a[20:23], 0
  v_mfma_f32_16x16x32_bf16 a[156:159], a[92:95], a[24:27], 0
  v_mfma_f32_16x16x32_bf16 a[188:191], a[92:95], a[28:31], 0
  s_mov_b32 s35, 5
  s_waitcnt vmcnt(8) lgkmcnt(0)
  s_barrier
  .p2align 6
Lp1wx_loop:
  v_mfma_f32_16x16x32_bf16 v[64:67], a[96:99], a[32:35], v[64:67]
  buffer_load_dwordx4 a[192:195], v2, s[56:59], s50 offen offset:0
  ds_read_b128 a[0:3], v16 offset:0
  v_mfma_f32_16x16x32_bf16 v[96:99], a[96:99], a[36:39], v[96:99]
  v_mfma_f32_16x16x32_bf16 v[128:131], a[96:99], a[40:43], v[128:131]
  ds_read_b64_tr_b16 a[64:65], v18 offset:0
  v_mfma_f32_16x16x32_bf16 v[160:163], a[96:99], a[44:47], v[160:163]
  v_mfma_f32_16x16x32_bf16 v[192:195], a[96:99], a[48:51], v[192:195]
  ds_read_b64_tr_b16 a[66:67], v18 offset:2048
  v_mfma_f32_16x16x32_bf16 v[224:227], a[96:99], a[52:55], v[224:227]
  v_mfma_f32_16x16x32_bf16 a[128:131], a[96:99], a[56:59], a[128:131]
  buffer_load_dwordx4 a[192:195], v2, s[56:59], s50 offen offset:1024
  ds_read_b128 a[4:7], v16 offset:2048
  v_mfma_f32_16x16x32_bf16 a[160:163], a[96:99], a[60:63], a[160:163]
  s_add_u32 s50, s50, 2048
  v_mfma_f32_16x16x32_bf16 v[68:71], a[100:103], a[32:35], v[68:71]
  v_mfma_f32_16x16x32_bf16 v[100:103], a[100:103], a[36:39], v[100:103]
  ds_read_b128 a[8:11], v16 offset:4096
  v_mfma_f32_16x16x32_bf16 v[132:135], a[100:103], a[40:43], v[132:135]
  v_mfma_f32_16x16x32_bf16 v[164:167], a[100:103], a[44:47], v[164:167]
  ds_read_b128 a[12:15], v16 offset:6144
  v_mfma_f32_16x16x32_bf16 v[196:199], a[100:103], a[48:51], v[196:199]
  buffer_load_dwordx4 a[192:195], v2, s[52:55], s51 offen offset:0
  v_mfma_f32_16x16x32_bf16 v[228:231], a[100:103], a[52:55], v[228:231]
  ds_read_b128 a[16:19], v16 offset:8192
  v_mfma_f32_16x16x32_bf16 a[132:135], a[100:103], a[56:59], a[132:135]
  v_mfma_f32_16x16x32_bf16 a[164:167], a[100:103], a[60:63], a[164:167]
  ds_read_b128 a[20:23], v16 offset:10240
  v_mfma_f32_16x16x32_bf16 v[72:75], a[104:107], a[32:35], v[72:75]
  v_mfma_f32_16x16x32_bf16 v[104:107], a[104:107], a[36:39], v[104:107]
  v_mfma_f32_16x16x32_bf16 v[136:139], a[104:107], a[40:43], v[136:139]
  buffer_load_dwordx4 a[192:195], v2, s[52:55], s51 offen offset:1024
  ds_read_b128 a[24:27], v16 offset:12288
  v_mfma_f32_16x16x32_bf16 v[168:171], a[104:107], a[44:47], v[168:171]
  s_add_u32 s51, s51, 2048
  s_mov_b32 m0, s41
  v_mfma_f32_16x16x32_bf16 v[200:203], a[104:107], a[48:51], v[200:203]
  ds_read_b128 a[28:31], v16 offset:14336
  v_mfma_f32_16x16x32_bf16 v[232:235], a[104:107], a[52:55], v[232:235]
  v_mfma_f32_16x16x32_bf16 a[136:139], a[104:107], a[56:59], a[136:139]
  ds_read_b64_tr_b16 a[68:69], v19 offset:0
  v_mfma_f32_16x16x32_bf16 a[168:171], a[104:107], a[60:63], a[168:171]
  v_mfma_f32_16x16x32_bf16 v[76:79], a[108:111], a[32:35], v[76:79]
  ds_read_b64_tr_b16 a[70:71], v19 offset:2048
  v_mfma_f32_16x16x32_bf16 v[108:111], a[108:111], a[36:39], v[108:111]
  buffer_load_dwordx4 v56, s[12:15], s47 offen offset:0 lds
  v_mfma_f32_16x16x32_bf16 v[140:143], a[108:111], a[40:43], v[140:143]
  v_mfma_f32_16x16x32_bf16 v[172:175], a[108:111], a[44:47], v[172:175]
  ds_read_b64_tr_b16 a[72:73], v20 offset:0
  v_mfma_f32_16x16x32_bf16 v[204:207], a[108:111], a[48:51], v[204:207]
  v_mfma_f32_16x16x32_bf16 v[236:239], a[108:111], a[52:55], v[236:239]
  ds_read_b64_tr_b16 a[74:75], v20 offset:2048
  v_mfma_f32_16x16x32_bf16 a[140:143], a[108:111], a[56:59], a[140:143]
  v_mfma_f32_16x16x32_bf16 a[172:175], a[108:111], a[60:63], a[172:175]
  buffer_load_dwordx4 v57, s[12:15], s47 offen offset:1024 lds
  ds_read_b64_tr_b16 a[76:77], v21 offset:0
  v_mfma_f32_16x16x32_bf16 v[80:83], a[112:115], a[32:35], v[80:83]
  v_mfma_f32_16x16x32_bf16 v[112:115], a[112:115], a[36:39], v[112:115]
  ds_read_b64_tr_b16 a[78:79], v21 offset:2048
  v_mfma_f32_16x16x32_bf16 v[144:147], a[112:115], a[40:43], v[144:147]
  v_mfma_f32_16x16x32_bf16 v[176:179], a[112:115], a[44:47], v[176:179]
  v_mfma_f32_16x16x32_bf16 v[208:211], a[112:115], a[48:51], v[208:211]
  ds_read_b64_tr_b16 a[80:81], v18 offset:8192
  v_mfma_f32_16x16x32_bf16 v[240:243], a[112:115], a[52:55], v[240:243]
  buffer_load_dwordx4 v58, s[12:15], s47 offen offset:2048 lds
  v_mfma_f32_16x16x32_bf16 a[144:147], a[112:115], a[56:59], a[144:147]
  ds_read_b64_tr_b16 a[82:83], v18 offset:10240
  v_mfma_f32_16x16x32_bf16 a[176:179], a[112:115], a[60:63], a[176:179]
  v_mfma_f32_16x16x32_bf16 v[84:87], a[116:119], a[32:35], v[84:87]
  ds_read_b64_tr_b16 a[84:85], v19 offset:8192
  v_mfma_f32_16x16x32_bf16 v[116:119], a[116:119], a[36:39], v[116:119]
  v_mfma_f32_16x16x32_bf16 v[148:151], a[116:119], a[40:43], v[148:151]
  ds_read_b64_tr_b16 a[86:87], v19 offset:10240
  v_mfma_f32_16x16x32_bf16 v[180:183], a[116:119], a[44:47], v[180:183]
  v_mfma_f32_16x16x32_bf16 v[212:215], a[116:119], a[48:51], v[212:215]
  buffer_load_dwordx4 v59, s[12:15], s47 offen offset:3072 lds
  v_mfma_f32_16x16x32_bf16 v[244:247], a[116:119], a[52:55], v[244:247]
  s_add_u32 m0, s41, 4096
  ds_read_b64_tr_b16 a[88:89], v20 offset:8192
  v_mfma_f32_16x16x32_bf16 a[148:151], a[116:119], a[56:59], a[148:151]
  v_mfma_f32_16x16x32_bf16 a[180:183], a[116:119], a[60:63], a[180:183]
  ds_read_b64_tr_b16 a[90:91], v20 offset:10240
  v_mfma_f32_16x16x32_bf16 v[88:91], a[120:123], a[32:35], v[88:91]
  v_mfma_f32_16x16x32_bf16 v[120:123], a[120:123], a[36:39], v[120:123]
  ds_read_b64_tr_b16 a[92:93], v21 offset:8192
  v_mfma_f32_16x16x32_bf16 v[152:155], a[120:123], a[40:43], v[152:155]
  buffer_load_dwordx4 v60, s[12:15], s47 offen offset:0 lds
  v_mfma_f32_16x16x32_bf16 v[184:187], a[120:123], a[44:47], v[184:187]
  ds_read_b64_tr_b16 a[94:95], v21 offset:10240
  v_mfma_f32_16x16x32_bf16 v[216:219], a[120:123], a[48:51], v[216:219]
  v_mfma_f32_16x16x32_bf16 v[248:251], a[120:123], a[52:55], v[248:251]
  v_mfma_f32_16x16x32_bf16 a[152:155], a[120:123], a[56:59], a[152:155]
  v_mfma_f32_16x16x32_bf16 a[184:187], a[120:123], a[60:63], a[184:187]
  v_mfma_f32_16x16x32_bf16 v[92:95], a[124:127], a[32:35], v[92:95]
  buffer_load_dwordx4 v61, s[12:15], s47 offen offset:1024 lds
  v_mfma_f32_16x16x32_bf16 v[124:127], a[124:127], a[36:39], v[124:127]
  v_mfma_f32_16x16x32_bf16 v[156:159], a[124:127], a[40:43], v[156:159]
  v_mfma_f32_16x16x32_bf16 v[188:191], a[124:127], a[44:47], v[188:191]
  v_mfma_f32_16x16x32_bf16 v[220:223], a[124:127], a[48:51], v[220:223]
  v_mfma_f32_16x16x32_bf16 v[252:255], a[124:127], a[52:55], v[252:255]
  v_mfma_f32_16x16x32_bf16 a[156:159], a[124:127], a[56:59], a[156:159]
  v_mfma_f32_16x16x32_bf16 a[188:191], a[124:127], a[60:63], a[188:191]
  s_waitcnt lgkmcnt(0)
  v_mfma_f32_16x16x32_bf16 v[64:67], a[64:67], a[0:3], v[64:67]
  buffer_load_dwordx4 v62, s[12:15], s47 offen offset:2048 lds
  ds_read_b128 a[32:35], v17 offset:0
  v_mfma_f32_16x16x32_bf16 v[96:99], a[64:67], a[4:7], v[96:99]
  v_mfma_f32_16x16x32_bf16 v[128:131], a[64:67], a[8:11], v[128:131]
  ds_read_b64_tr_b16 a[96:97], v18 offset:4096
  v_mfma_f32_16x16x32_bf16 v[160:163], a[64:67], a[12:15], v[160:163]
  v_mfma_f32_16x16x32_bf16 v[192:195], a[64:67], a[16:19], v[192:195]
  ds_read_b64_tr_b16 a[98:99], v18 offset:6144
  v_mfma_f32_16x16x32_bf16 v[224:227], a[64:67], a[20:23], v[224:227]
  buffer_load_dwordx4 v63, s[12:15], s47 offen offset:3072 lds
  v_mfma_f32_16x16x32_bf16 a[128:131], a[64:67], a[24:27], a[128:131]
  s_mov_b32 m0, s36
  ds_read_b128 a[36:39], v17 offset:2048
  v_mfma_f32_16x16x32_bf16 a[160:163], a[64:67], a[28:31], a[160:163]
  v_mfma_f32_16x16x32_bf16 v[68:71], a[68:71], a[0:3], v[68:71]
  v_mfma_f32_16x16x32_bf16 v[100:103], a[68:71], a[4:7], v[100:103]
  ds_read_b128 a[40:43], v17 offset:4096
  v_mfma_f32_16x16x32_bf16 v[132:135], a[68:71], a[8:11], v[132:135]
  v_mfma_f32_16x16x32_bf16 v[164:167], a[68:71], a[12:15], v[164:167]
  buffer_load_dwordx4 v48, s[8:11], s46 offen offset:0 lds
  ds_read_b128 a[44:47], v17 offset:6144
  v_mfma_f32_16x16x32_bf16 v[196:199], a[68:71], a[16:19], v[196:199]
  v_mfma_f32_16x16x32_bf16 v[228:231], a[68:71], a[20:23], v[228:231]
  ds_read_b128 a[48:51], v17 offset:8192
  v_mfma_f32_16x16x32_bf16 a[132:135], a[68:71], a[24:27], a[132:135]
  v_mfma_f32_16x16x32_bf16 a[164:167], a[68:71], a[28:31], a[164:167]
  ds_read_b128 a[52:55], v17 offset:10240
  v_mfma_f32_16x16x32_bf16 v[72:75], a[72:75], a[0:3], v[72:75]
  v_mfma_f32_16x16x32_bf16 v[104:107], a[72:75], a[4:7], v[104:107]
  buffer_load_dwordx4 v49, s[8:11], s46 offen offset:1024 lds
  v_mfma_f32_16x16x32_bf16 v[136:139], a[72:75], a[8:11], v[136:139]
  ds_read_b128 a[56:59], v17 offset:12288
  v_mfma_f32_16x16x32_bf16 v[168:171], a[72:75], a[12:15], v[168:171]
  v_mfma_f32_16x16x32_bf16 v[200:203], a[72:75], a[16:19], v[200:203]
  ds_read_b128 a[60:63], v17 offset:14336
  v_mfma_f32_16x16x32_bf16 v[232:235], a[72:75], a[20:23], v[232:235]
  v_mfma_f32_16x16x32_bf16 a[136:139], a[72:75], a[24:27], a[136:139]
  buffer_load_dwordx4 v50, s[8:11], s46 offen offset:2048 lds
  ds_read_b64_tr_b16 a[100:101], v19 offset:4096
  v_mfma_f32_16x16x32_bf16 a[168:171], a[72:75], a[28:31], a[168:171]
  v_mfma_f32_16x16x32_bf16 v[76:79], a[76:79], a[0:3], v[76:79]
  ds_read_b64_tr_b16 a[102:103], v19 offset:6144
  v_mfma_f32_16x16x32_bf16 v[108:111], a[76:79], a[4:7], v[108:111]
  v_mfma_f32_16x16x32_bf16 v[140:143], a[76:79], a[8:11], v[140:143]
  v_mfma_f32_16x16x32_bf16 v[172:175], a[76:79], a[12:15], v[172:175]
  ds_read_b64_tr_b16 a[104:105], v20 offset:4096
  v_mfma_f32_16x16x32_bf16 v[204:207], a[76:79], a[16:19], v[204:207]
  buffer_load_dwordx4 v51, s[8:11], s46 offen offset:3072 lds
  v_mfma_f32_16x16x32_bf16 v[236:239], a[76:79], a[20:23], v[236:239]
  s_add_u32 m0, s36, 4096
  ds_read_b64_tr_b16 a[106:107], v20 offset:6144
  v_mfma_f32_16x16x32_bf16 a[140:143], a[76:79], a[24:27], a[140:143]
  v_mfma_f32_16x16x32_bf16 a[172:175], a[76:79], a[28:31], a[172:175]
  ds_read_b64_tr_b16 a[108:109], v21 offset:4096
  v_mfma_f32_16x16x32_bf16 v[80:83], a[80:83], a[0:3], v[80:83]
  v_mfma_f32_16x16x32_bf16 v[112:115], a[80:83], a[4:7], v[112:115]
  ds_read_b64_tr_b16 a[110:111], v21 offset:6144
  v_mfma_f32_16x16x32_bf16 v[144:147], a[80:83], a[8:11], v[144:147]
  buffer_load_dwordx4 v52, s[8:11], s46 offen offset:0 lds
  v_mfma_f32_16x16x32_bf16 v[176:179], a[80:83], a[12:15], v[176:179]
  v_mfma_f32_16x16x32_bf16 v[208:211], a[80:83], a[16:19], v[208:211]
  ds_read_b64_tr_b16 a[112:113], v18 offset:12288
  v_mfma_f32_16x16x32_bf16 v[240:243], a[80:83], a[20:23], v[240:243]
  v_mfma_f32_16x16x32_bf16 a[144:147], a[80:83], a[24:27], a[144:147]
  ds_read_b64_tr_b16 a[114:115], v18 offset:14336
  v_mfma_f32_16x16x32_bf16 a[176:179], a[80:83], a[28:31], a[176:179]
  buffer_load_dwordx4 v53, s[8:11], s46 offen offset:1024 lds
  v_mfma_f32_16x16x32_bf16 v[84:87], a[84:87], a[0:3], v[84:87]
  ds_read_b64_tr_b16 a[116:117], v19 offset:12288
  v_mfma_f32_16x16x32_bf16 v[116:119], a[84:87], a[4:7], v[116:119]
  v_mfma_f32_16x16x32_bf16 v[148:151], a[84:87], a[8:11], v[148:151]
  ds_read_b64_tr_b16 a[118:119], v19 offset:14336
  v_mfma_f32_16x16x32_bf16 v[180:183], a[84:87], a[12:15], v[180:183]
  v_mfma_f32_16x16x32_bf16 v[212:215], a[84:87], a[16:19], v[212:215]
  v_mfma_f32_16x16x32_bf16 v[244:247], a[84:87], a[20:23], v[244:247]
  buffer_load_dwordx4 v54, s[8:11], s46 offen offset:2048 lds
  ds_read_b64_tr_b16 a[120:121], v20 offset:12288
  v_mfma_f32_16x16x32_bf16 a[148:151], a[84:87], a[24:27], a[148:151]
  v_mfma_f32_16x16x32_bf16 a[180:183], a[84:87], a[28:31], a[180:183]
  ds_read_b64_tr_b16 a[122:123], v20 offset:14336
  v_mfma_f32_16x16x32_bf16 v[88:91], a[88:91], a[0:3], v[88:91]
  v_mfma_f32_16x16x32_bf16 v[120:123], a[88:91], a[4:7], v[120:123]
  ds_read_b64_tr_b16 a[124:125], v21 offset:12288
  v_mfma_f32_16x16x32_bf16 v[152:155], a[88:91], a[8:11], v[152:155]
  v_mfma_f32_16x16x32_bf16 v[184:187], a[88:91], a[12:15], v[184:187]
  buffer_load_dwordx4 v55, s[8:11], s46 offen offset:3072 lds
  ds_read_b64_tr_b16 a[126:127], v21 offset:14336
  v_mfma_f32_16x16x32_bf16 v[216:219], a[88:91], a[16:19], v[216:219]
  s_lshl_b32 s47, s48, 19
  s_bfe_u32 s34, 0x3020106, s49
  s_add_u32 s48, s48, s34
  v_mfma_f32_16x16x32_bf16 v[248:251], a[88:91], a[20:23], v[248:251]
  s_add_u32 s49, s49, 8
  s_and_b32 s49, s49, 0x8001f
  s_and_b32 s48, s48, 7
  v_mfma_f32_16x16x32_bf16 a[152:155], a[88:91], a[24:27], a[152:155]
  s_lshl_b32 s46, s48, 7
  v_mfma_f32_16x16x32_bf16 a[184:187], a[88:91], a[28:31], a[184:187]
  s_add_u32 s36, s36, s38
  s_add_u32 s37, s37, 1
  s_cmp_eq_u32 s37, 3
  s_cselect_b32 s37, 0, s37
  s_cselect_b32 s38, s39, s40
  v_mfma_f32_16x16x32_bf16 v[92:95], a[92:95], a[0:3], v[92:95]
  s_add_u32 s41, s41, s43
  s_sub_u32 s43, 0, s43
  v_mfma_f32_16x16x32_bf16 v[124:127], a[92:95], a[4:7], v[124:127]
  v_add_u32 v16, s38, v16
  v_add_u32 v17, s38, v17
  v_mfma_f32_16x16x32_bf16 v[156:159], a[92:95], a[8:11], v[156:159]
  v_add_u32 v18, s43, v18
  v_add_u32 v19, s43, v19
  v_mfma_f32_16x16x32_bf16 v[188:191], a[92:95], a[12:15], v[188:191]
  v_add_u32 v20, s43, v20
  v_add_u32 v21, s43, v21
  v_mfma_f32_16x16x32_bf16 v[220:223], a[92:95], a[16:19], v[220:223]
  v_mfma_f32_16x16x32_bf16 v[252:255], a[92:95], a[20:23], v[252:255]
  s_waitcnt vmcnt(8) lgkmcnt(0)
  s_barrier
  v_mfma_f32_16x16x32_bf16 a[156:159], a[92:95], a[24:27], a[156:159]
  s_sub_u32 s35, s35, 1
  v_mfma_f32_16x16x32_bf16 a[188:191], a[92:95], a[28:31], a[188:191]
  s_cmp_lg_u32 s35, 0
  s_cbranch_scc1 Lp1wx_loop
  v_mfma_f32_16x16x32_bf16 v[64:67], a[96:99], a[32:35], v[64:67]
  s_mov_b32 m0, s41
  ds_read_b128 a[0:3], v16 offset:0
  v_mfma_f32_16x16x32_bf16 v[96:99], a[96:99], a[36:39], v[96:99]
  buffer_load_dwordx4 v56, s[12:15], s47 offen offset:0 lds
  v_mfma_f32_16x16x32_bf16 v[128:131], a[96:99], a[40:43], v[128:131]
  ds_read_b64_tr_b16 a[64:65], v18 offset:0
  v_mfma_f32_16x16x32_bf16 v[160:163], a[96:99], a[44:47], v[160:163]
  v_mfma_f32_16x16x32_bf16 v[192:195], a[96:99], a[48:51], v[192:195]
  ds_read_b64_tr_b16 a[66:67], v18 offset:2048
  v_mfma_f32_16x16x32_bf16 v[224:227], a[96:99], a[52:55], v[224:227]
  v_mfma_f32_16x16x32_bf16 a[128:131], a[96:99], a[56:59], a[128:131]
  ds_read_b128 a[4:7], v16 offset:2048
  v_mfma_f32_16x16x32_bf16 a[160:163], a[96:99], a[60:63], a[160:163]
  v_mfma_f32_16x16x32_bf16 v[68:71], a[100:103], a[32:35], v[68:71]
  v_mfma_f32_16x16x32_bf16 v[100:103], a[100:103], a[36:39], v[100:103]
  ds_read_b128 a[8:11], v16 offset:4096
  v_mfma_f32_16x16x32_bf16 v[132:135], a[100:103], a[40:43], v[132:135]
  buffer_load_dwordx4 v57, s[12:15], s47 offen offset:1024 lds
  v_mfma_f32_16x16x32_bf16 v[164:167], a[100:103], a[44:47], v[164:167]
  ds_read_b128 a[12:15], v16 offset:6144
  v_mfma_f32_16x16x32_bf16 v[196:199], a[100:103], a[48:51], v[196:199]
  v_mfma_f32_16x16x32_bf16 v[228:231], a[100:103], a[52:55], v[228:231]
  ds_read_b128 a[16:19], v16 offset:8192
  v_mfma_f32_16x16x32_bf16 a[132:135], a[100:103], a[56:59], a[132:135]
  v_mfma_f32_16x16x32_bf16 a[164:167], a[100:103], a[60:63], a[164:167]
  ds_read_b128 a[20:23], v16 offset:10240
  v_mfma_f32_16x16x32_bf16 v[72:75], a[104:107], a[32:35], v[72:75]
  v_mfma_f32_16x16x32_bf16 v[104:107], a[104:107], a[36:39], v[104:107]
  v_mfma_f32_16x16x32_bf16 v[136:139], a[104:107], a[40:43], v[136:139]
  ds_read_b128 a[24:27], v16 offset:12288
  v_mfma_f32_16x16x32_bf16 v[168:171], a[104:107], a[44:47], v[168:171]
  v_mfma_f32_16x16x32_bf16 v[200:203], a[104:107], a[48:51], v[200:203]
  ds_read_b128 a[28:31], v16 offset:14336
  v_mfma_f32_16x16x32_bf16 v[232:235], a[104:107], a[52:55], v[232:235]
  buffer_load_dwordx4 v58, s[12:15], s47 offen offset:2048 lds
  v_mfma_f32_16x16x32_bf16 a[136:139], a[104:107], a[56:59], a[136:139]
  ds_read_b64_tr_b16 a[68:69], v19 offset:0
  v_mfma_f32_16x16x32_bf16 a[168:171], a[104:107], a[60:63], a[168:171]
  v_mfma_f32_16x16x32_bf16 v[76:79], a[108:111], a[32:35], v[76:79]
  ds_read_b64_tr_b16 a[70:71], v19 offset:2048
  v_mfma_f32_16x16x32_bf16 v[108:111], a[108:111], a[36:39], v[108:111]
  v_mfma_f32_16x16x32_bf16 v[140:143], a[108:111], a[40:43], v[140:143]
  v_mfma_f32_16x16x32_bf16 v[172:175], a[108:111], a[44:47], v[172:175]
  ds_read_b64_tr_b16 a[72:73], v20 offset:0
  v_mfma_f32_16x16x32_bf16 v[204:207], a[108:111], a[48:51], v[204:207]
  v_mfma_f32_16x16x32_bf16 v[236:239], a[108:111], a[52:55], v[236:239]
  ds_read_b64_tr_b16 a[74:75], v20 offset:2048
  v_mfma_f32_16x16x32_bf16 a[140:143], a[108:111], a[56:59], a[140:143]
  v_mfma_f32_16x16x32_bf16 a[172:175], a[108:111], a[60:63], a[172:175]
  buffer_load_dwordx4 v59, s[12:15], s47 offen offset:3072 lds
  ds_read_b64_tr_b16 a[76:77], v21 offset:0
  v_mfma_f32_16x16x32_bf16 v[80:83], a[112:115], a[32:35], v[80:83]
  s_add_u32 m0, s41, 4096
  v_mfma_f32_16x16x32_bf16 v[112:115], a[112:115], a[36:39], v[112:115]
  ds_read_b64_tr_b16 a[78:79], v21 offset:2048
  v_mfma_f32_16x16x32_bf16 v[144:147], a[112:115], a[40:43], v[144:147]
  v_mfma_f32_16x16x32_bf16 v[176:179], a[112:115], a[44:47], v[176:179]
  v_mfma_f32_16x16x32_bf16 v[208:211], a[112:115], a[48:51], v[208:211]
  ds_read_b64_tr_b16 a[80:81], v18 offset:8192
  v_mfma_f32_16x16x32_bf16 v[240:243], a[112:115], a[52:55], v[240:243]
  v_mfma_f32_16x16x32_bf16 a[144:147], a[112:115], a[56:59], a[144:147]
  ds_read_b64_tr_b16 a[82:83], v18 offset:10240
  v_mfma_f32_16x16x32_bf16 a[176:179], a[112:115], a[60:63], a[176:179]
  v_mfma_f32_16x16x32_bf16 v[84:87], a[116:119], a[32:35], v[84:87]
  ds_read_b64_tr_b16 a[84:85], v19 offset:8192
  v_mfma_f32_16x16x32_bf16 v[116:119], a[116:119], a[36:39], v[116:119]
  v_mfma_f32_16x16x32_bf16 v[148:151], a[116:119], a[40:43], v[148:151]
  buffer_load_dwordx4 v60, s[12:15], s47 offen offset:0 lds
  ds_read_b64_tr_b16 a[86:87], v19 offset:10240
  v_mfma_f32_16x16x32_bf16 v[180:183], a[116:119], a[44:47], v[180:183]
  v_mfma_f32_16x16x32_bf16 v[212:215], a[116:119], a[48:51], v[212:215]
  v_mfma_f32_16x16x32_bf16 v[244:247], a[116:119], a[52:55], v[244:247]
  ds_read_b64_tr_b16 a[88:89], v20 offset:8192
  v_mfma_f32_16x16x32_bf16 a[148:151], a[116:119], a[56:59], a[148:151]
  v_mfma_f32_16x16x32_bf16 a[180:183], a[116:119], a[60:63], a[180:183]
  ds_read_b64_tr_b16 a[90:91], v20 offset:10240
  v_mfma_f32_16x16x32_bf16 v[88:91], a[120:123], a[32:35], v[88:91]
  v_mfma_f32_16x16x32_bf16 v[120:123], a[120:123], a[36:39], v[120:123]
  ds_read_b64_tr_b16 a[92:93], v21 offset:8192
  v_mfma_f32_16x16x32_bf16 v[152:155], a[120:123], a[40:43], v[152:155]
  v_mfma_f32_16x16x32_bf16 v[184:187], a[120:123], a[44:47], v[184:187]
  ds_read_b64_tr_b16 a[94:95], v21 offset:10240
  v_mfma_f32_16x16x32_bf16 v[216:219], a[120:123], a[48:51], v[216:219]
  buffer_load_dwordx4 v61, s[12:15], s47 offen offset:1024 lds
  v_mfma_f32_16x16x32_bf16 v[248:251], a[120:123], a[52:55], v[248:251]
  v_mfma_f32_16x16x32_bf16 a[152:155], a[120:123], a[56:59], a[152:155]
  v_mfma_f32_16x16x32_bf16 a[184:187], a[120:123], a[60:63], a[184:187]
  v_mfma_f32_16x16x32_bf16 v[92:95], a[124:127], a[32:35], v[92:95]
  v_mfma_f32_16x16x32_bf16 v[124:127], a[124:127], a[36:39], v[124:127]
  v_mfma_f32_16x16x32_bf16 v[156:159], a[124:127], a[40:43], v[156:159]
  v_mfma_f32_16x16x32_bf16 v[188:191], a[124:127], a[44:47], v[188:191]
  v_mfma_f32_16x16x32_bf16 v[220:223], a[124:127], a[48:51], v[220:223]
  v_mfma_f32_16x16x32_bf16 v[252:255], a[124:127], a[52:55], v[252:255]
  v_mfma_f32_16x16x32_bf16 a[156:159], a[124:127], a[56:59], a[156:159]
  v_mfma_f32_16x16x32_bf16 a[188:191], a[124:127], a[60:63], a[188:191]
  s_waitcnt lgkmcnt(0)
  v_mfma_f32_16x16x32_bf16 v[64:67], a[64:67], a[0:3], v[64:67]
  buffer_load_dwordx4 v62, s[12:15], s47 offen offset:2048 lds
  ds_read_b128 a[32:35], v17 offset:0
  v_mfma_f32_16x16x32_bf16 v[96:99], a[64:67], a[4:7], v[96:99]
  v_mfma_f32_16x16x32_bf16 v[128:131], a[64:67], a[8:11], v[128:131]
  ds_read_b64_tr_b16 a[96:97], v18 offset:4096
  v_mfma_f32_16x16x32_bf16 v[160:163], a[64:67], a[12:15], v[160:163]
  v_mfma_f32_16x16x32_bf16 v[192:195], a[64:67], a[16:19], v[192:195]
  ds_read_b64_tr_b16 a[98:99], v18 offset:6144
  v_mfma_f32_16x16x32_bf16 v[224:227], a[64:67], a[20:23], v[224:227]
  v_mfma_f32_16x16x32_bf16 a[128:131], a[64:67], a[24:27], a[128:131]
  ds_read_b128 a[36:39], v17 offset:2048
  v_mfma_f32_16x16x32_bf16 a[160:163], a[64:67], a[28:31], a[160:163]
  v_mfma_f32_16x16x32_bf16 v[68:71], a[68:71], a[0:3], v[68:71]
  v_mfma_f32_16x16x32_bf16 v[100:103], a[68:71], a[4:7], v[100:103]
  buffer_load_dwordx4 v63, s[12:15], s47 offen offset:3072 lds
  ds_read_b128 a[40:43], v17 offset:4096
  v_mfma_f32_16x16x32_bf16 v[132:135], a[68:71], a[8:11], v[132:135]
  s_lshl_b32 s10, s32, 18
  s_add_u32 s8, s76, s10
  s_addc_u32 s9, s77, 0
  v_mfma_f32_16x16x32_bf16 v[164:167], a[68:71], a[12:15], v[164:167]
  s_sub_u32 s8, s8, 32768
  s_subb_u32 s9, s9, 0
  s_mov_b32 s10, 294912
  v_mfma_f32_16x16x32_bf16 v[196:199], a[68:71], a[16:19], v[196:199]
  s_mov_b32 s11, 0x00020000
  s_cmp_ge_u32 s3, 2
  s_cbranch_scc1 Lh_6
  s_add_u32 m0, s88, s28
  s_nop 0
  buffer_load_dwordx4 v14, s[8:11], s30 offen offset:0 lds
Lh_6:
  v_mfma_f32_16x16x32_bf16 v[228:231], a[68:71], a[20:23], v[228:231]
  s_mov_b32 m0, s88
  ds_read_b128 a[44:47], v17 offset:6144
  ds_read_b128 a[48:51], v17 offset:8192
  v_mfma_f32_16x16x32_bf16 a[132:135], a[68:71], a[24:27], a[132:135]
  v_mfma_f32_16x16x32_bf16 a[164:167], a[68:71], a[28:31], a[164:167]
  ds_read_b128 a[52:55], v17 offset:10240
  v_mfma_f32_16x16x32_bf16 v[72:75], a[72:75], a[0:3], v[72:75]
  v_mfma_f32_16x16x32_bf16 v[104:107], a[72:75], a[4:7], v[104:107]
  v_mfma_f32_16x16x32_bf16 v[136:139], a[72:75], a[8:11], v[136:139]
  ds_read_b128 a[56:59], v17 offset:12288
  v_mfma_f32_16x16x32_bf16 v[168:171], a[72:75], a[12:15], v[168:171]
  buffer_load_dwordx4 v4, s[8:11], s30 offen offset:0 lds
  v_mfma_f32_16x16x32_bf16 v[200:203], a[72:75], a[16:19], v[200:203]
  ds_read_b128 a[60:63], v17 offset:14336
  v_mfma_f32_16x16x32_bf16 v[232:235], a[72:75], a[20:23], v[232:235]
  v_mfma_f32_16x16x32_bf16 a[136:139], a[72:75], a[24:27], a[136:139]
  ds_read_b64_tr_b16 a[100:101], v19 offset:4096
  v_mfma_f32_16x16x32_bf16 a[168:171], a[72:75], a[28:31], a[168:171]
  v_mfma_f32_16x16x32_bf16 v[76:79], a[76:79], a[0:3], v[76:79]
  ds_read_b64_tr_b16 a[102:103], v19 offset:6144
  v_mfma_f32_16x16x32_bf16 v[108:111], a[76:79], a[4:7], v[108:111]
  v_mfma_f32_16x16x32_bf16 v[140:143], a[76:79], a[8:11], v[140:143]
  v_mfma_f32_16x16x32_bf16 v[172:175], a[76:79], a[12:15], v[172:175]
  ds_read_b64_tr_b16 a[104:105], v20 offset:4096
  v_mfma_f32_16x16x32_bf16 v[204:207], a[76:79], a[16:19], v[204:207]
  buffer_load_dwordx4 v5, s[8:11], s30 offen offset:1024 lds
  v_mfma_f32_16x16x32_bf16 v[236:239], a[76:79], a[20:23], v[236:239]
  ds_read_b64_tr_b16 a[106:107], v20 offset:6144
  v_mfma_f32_16x16x32_bf16 a[140:143], a[76:79], a[24:27], a[140:143]
  v_mfma_f32_16x16x32_bf16 a[172:175], a[76:79], a[28:31], a[172:175]
  ds_read_b64_tr_b16 a[108:109], v21 offset:4096
  v_mfma_f32_16x16x32_bf16 v[80:83], a[80:83], a[0:3], v[80:83]
  v_mfma_f32_16x16x32_bf16 v[112:115], a[80:83], a[4:7], v[112:115]
  ds_read_b64_tr_b16 a[110:111], v21 offset:6144
  v_mfma_f32_16x16x32_bf16 v[144:147], a[80:83], a[8:11], v[144:147]
  v_mfma_f32_16x16x32_bf16 v[176:179], a[80:83], a[12:15], v[176:179]
  v_mfma_f32_16x16x32_bf16 v[208:211], a[80:83], a[16:19], v[208:211]
  ds_read_b64_tr_b16 a[112:113], v18 offset:12288
  v_mfma_f32_16x16x32_bf16 v[240:243], a[80:83], a[20:23], v[240:243]
  v_mfma_f32_16x16x32_bf16 a[144:147], a[80:83], a[24:27], a[144:147]
  buffer_load_dwordx4 v6, s[8:11], s30 offen offset:2048 lds
  ds_read_b64_tr_b16 a[114:115], v18 offset:14336
  v_mfma_f32_16x16x32_bf16 a[176:179], a[80:83], a[28:31], a[176:179]
  v_mfma_f32_16x16x32_bf16 v[84:87], a[84:87], a[0:3], v[84:87]
  ds_read_b64_tr_b16 a[116:117], v19 offset:12288
  v_mfma_f32_16x16x32_bf16 v[116:119], a[84:87], a[4:7], v[116:119]
  v_mfma_f32_16x16x32_bf16 v[148:151], a[84:87], a[8:11], v[148:151]
  ds_read_b64_tr_b16 a[118:119], v19 offset:14336
  v_mfma_f32_16x16x32_bf16 v[180:183], a[84:87], a[12:15], v[180:183]
  v_mfma_f32_16x16x32_bf16 v[212:215], a[84:87], a[16:19], v[212:215]
  v_mfma_f32_16x16x32_bf16 v[244:247], a[84:87], a[20:23], v[244:247]
  ds_read_b64_tr_b16 a[120:121], v20 offset:12288
  v_mfma_f32_16x16x32_bf16 a[148:151], a[84:87], a[24:27], a[148:151]
  v_mfma_f32_16x16x32_bf16 a[180:183], a[84:87], a[28:31], a[180:183]
  buffer_load_dwordx4 v7, s[8:11], s30 offen offset:3072 lds
  ds_read_b64_tr_b16 a[122:123], v20 offset:14336
  v_mfma_f32_16x16x32_bf16 v[88:91], a[88:91], a[0:3], v[88:91]
  s_mul_i32 s31, s0, 393216
  s_bfe_u32 s29, 0x302010e, s1
  s_add_u32 s0, s0, s29
  v_mfma_f32_16x16x32_bf16 v[120:123], a[88:91], a[4:7], v[120:123]
  s_add_u32 s1, s1, 8
  s_and_b32 s1, s1, 0x8001f
  s_and_b32 s0, s0, 15
  v_mfma_f32_16x16x32_bf16 v[152:155], a[88:91], a[8:11], v[152:155]
  s_lshl_b32 s30, s0, 7
  ds_read_b64_tr_b16 a[124:125], v21 offset:12288
  v_mfma_f32_16x16x32_bf16 v[184:187], a[88:91], a[12:15], v[184:187]
  s_add_u32 s36, s36, s38
  s_add_u32 s37, s37, 1
  ds_read_b64_tr_b16 a[126:127], v21 offset:14336
  v_mfma_f32_16x16x32_bf16 v[216:219], a[88:91], a[16:19], v[216:219]
  s_cmp_eq_u32 s37, 3
  s_cselect_b32 s37, 0, s37
  s_cselect_b32 s38, s39, s40
  v_mfma_f32_16x16x32_bf16 v[248:251], a[88:91], a[20:23], v[248:251]
  s_add_u32 s41, s41, s43
  s_sub_u32 s43, 0, s43
  v_mfma_f32_16x16x32_bf16 a[152:155], a[88:91], a[24:27], a[152:155]
  v_add_u32 v16, s38, v16
  v_add_u32 v17, s38, v17
  v_mfma_f32_16x16x32_bf16 a[184:187], a[88:91], a[28:31], a[184:187]
  v_add_u32 v18, s43, v18
  v_add_u32 v19, s43, v19
  v_mfma_f32_16x16x32_bf16 v[92:95], a[92:95], a[0:3], v[92:95]
  v_add_u32 v20, s43, v20
  v_add_u32 v21, s43, v21
  v_mfma_f32_16x16x32_bf16 v[124:127], a[92:95], a[4:7], v[124:127]
  v_mfma_f32_16x16x32_bf16 v[156:159], a[92:95], a[8:11], v[156:159]
  v_mfma_f32_16x16x32_bf16 v[188:191], a[92:95], a[12:15], v[188:191]
  v_mfma_f32_16x16x32_bf16 v[220:223], a[92:95], a[16:19], v[220:223]
  v_mfma_f32_16x16x32_bf16 v[252:255], a[92:95], a[20:23], v[252:255]
  v_mfma_f32_16x16x32_bf16 a[156:159], a[92:95], a[24:27], a[156:159]
  v_mfma_f32_16x16x32_bf16 a[188:191], a[92:95], a[28:31], a[188:191]
  s_waitcnt vmcnt(4) lgkmcnt(0)
  s_barrier
  v_mfma_f32_16x16x32_bf16 v[64:67], a[96:99], a[32:35], v[64:67]
  s_add_u32 m0, s88, s26
  ds_read_b128 a[0:3], v16 offset:0
  v_mfma_f32_16x16x32_bf16 v[96:99], a[96:99], a[36:39], v[96:99]
  buffer_load_dwordx4 v8, s[20:23], s31 offen offset:0 lds
  v_mfma_f32_16x16x32_bf16 v[128:131], a[96:99], a[40:43], v[128:131]
  ds_read_b64_tr_b16 a[64:65], v18 offset:0
  v_mfma_f32_16x16x32_bf16 v[160:163], a[96:99], a[44:47], v[160:163]
  buffer_load_dwordx4 v9, s[20:23], s31 offen offset:1024 lds
  v_mfma_f32_16x16x32_bf16 v[192:195], a[96:99], a[48:51], v[192:195]
  ds_read_b64_tr_b16 a[66:67], v18 offset:2048
  v_mfma_f32_16x16x32_bf16 v[224:227], a[96:99], a[52:55], v[224:227]
  v_mfma_f32_16x16x32_bf16 a[128:131], a[96:99], a[56:59], a[128:131]
  ds_read_b128 a[4:7], v16 offset:2048
  v_mfma_f32_16x16x32_bf16 a[160:163], a[96:99], a[60:63], a[160:163]
  buffer_load_dwordx4 v10, s[20:23], s31 offen offset:2048 lds
  v_mfma_f32_16x16x32_bf16 v[68:71], a[100:103], a[32:35], v[68:71]
  s_add_u32 m0, s88, s27
  v_mfma_f32_16x16x32_bf16 v[100:103], a[100:103], a[36:39], v[100:103]
  ds_read_b128 a[8:11], v16 offset:4096
  v_mfma_f32_16x16x32_bf16 v[132:135], a[100:103], a[40:43], v[132:135]
  v_mfma_f32_16x16x32_bf16 v[164:167], a[100:103], a[44:47], v[164:167]
  buffer_load_dwordx4 v11, s[20:23], s31 offen offset:0 lds
  ds_read_b128 a[12:15], v16 offset:6144
  v_mfma_f32_16x16x32_bf16 v[196:199], a[100:103], a[48:51], v[196:199]
  v_mfma_f32_16x16x32_bf16 v[228:231], a[100:103], a[52:55], v[228:231]
  ds_read_b128 a[16:19], v16 offset:8192
  v_mfma_f32_16x16x32_bf16 a[132:135], a[100:103], a[56:59], a[132:135]
  v_mfma_f32_16x16x32_bf16 a[164:167], a[100:103], a[60:63], a[164:167]
  buffer_load_dwordx4 v12, s[20:23], s31 offen offset:1024 lds
  ds_read_b128 a[20:23], v16 offset:10240
  v_mfma_f32_16x16x32_bf16 v[72:75], a[104:107], a[32:35], v[72:75]
  v_mfma_f32_16x16x32_bf16 v[104:107], a[104:107], a[36:39], v[104:107]
  v_mfma_f32_16x16x32_bf16 v[136:139], a[104:107], a[40:43], v[136:139]
  ds_read_b128 a[24:27], v16 offset:12288
  v_mfma_f32_16x16x32_bf16 v[168:171], a[104:107], a[44:47], v[168:171]
  buffer_load_dwordx4 v13, s[20:23], s31 offen offset:2048 lds
  v_mfma_f32_16x16x32_bf16 v[200:203], a[104:107], a[48:51], v[200:203]
  s_cmp_ge_u32 s3, 2
  s_cbranch_scc1 Lh_7
  s_add_u32 m0, s88, s28
  s_add_u32 m0, m0, 43008
  s_nop 0
  buffer_load_dwordx4 v14, s[8:11], s30 offen offset:0 lds
Lh_7:
  v_mfma_f32_16x16x32_bf16 v[232:235], a[104:107], a[52:55], v[232:235]
  s_add_u32 m0, s88, 43008
  ds_read_b128 a[28:31], v16 offset:14336
  v_mfma_f32_16x16x32_bf16 a[136:139], a[104:107], a[56:59], a[136:139]
  ds_read_b64_tr_b16 a[68:69], v19 offset:0
  v_mfma_f32_16x16x32_bf16 a[168:171], a[104:107], a[60:63], a[168:171]
  buffer_load_dwordx4 v4, s[8:11], s30 offen offset:0 lds
  v_mfma_f32_16x16x32_bf16 v[76:79], a[108:111], a[32:35], v[76:79]
  ds_read_b64_tr_b16 a[70:71], v19 offset:2048
  v_mfma_f32_16x16x32_bf16 v[108:111], a[108:111], a[36:39], v[108:111]
  v_mfma_f32_16x16x32_bf16 v[140:143], a[108:111], a[40:43], v[140:143]
  v_mfma_f32_16x16x32_bf16 v[172:175], a[108:111], a[44:47], v[172:175]
  buffer_load_dwordx4 v5, s[8:11], s30 offen offset:1024 lds
  ds_read_b64_tr_b16 a[72:73], v20 offset:0
  v_mfma_f32_16x16x32_bf16 v[204:207], a[108:111], a[48:51], v[204:207]
  v_mfma_f32_16x16x32_bf16 v[236:239], a[108:111], a[52:55], v[236:239]
  ds_read_b64_tr_b16 a[74:75], v20 offset:2048
  v_mfma_f32_16x16x32_bf16 a[140:143], a[108:111], a[56:59], a[140:143]
  v_mfma_f32_16x16x32_bf16 a[172:175], a[108:111], a[60:63], a[172:175]
  buffer_load_dwordx4 v6, s[8:11], s30 offen offset:2048 lds
  ds_read_b64_tr_b16 a[76:77], v21 offset:0
  v_mfma_f32_16x16x32_bf16 v[80:83], a[112:115], a[32:35], v[80:83]
  v_mfma_f32_16x16x32_bf16 v[112:115], a[112:115], a[36:39], v[112:115]
  ds_read_b64_tr_b16 a[78:79], v21 offset:2048
  v_mfma_f32_16x16x32_bf16 v[144:147], a[112:115], a[40:43], v[144:147]
  v_mfma_f32_16x16x32_bf16 v[176:179], a[112:115], a[44:47], v[176:179]
  buffer_load_dwordx4 v7, s[8:11], s30 offen offset:3072 lds
  v_mfma_f32_16x16x32_bf16 v[208:211], a[112:115], a[48:51], v[208:211]
  s_mul_i32 s31, s0, 393216
  s_bfe_u32 s29, 0x302010e, s1
  s_add_u32 s0, s0, s29
  v_mfma_f32_16x16x32_bf16 v[240:243], a[112:115], a[52:55], v[240:243]
  s_add_u32 s1, s1, 8
  s_and_b32 s1, s1, 0x8001f
  s_and_b32 s0, s0, 15
  v_mfma_f32_16x16x32_bf16 a[144:147], a[112:115], a[56:59], a[144:147]
  s_lshl_b32 s30, s0, 7
  s_add_u32 m0, s88, s26
  s_add_u32 m0, m0, 43008
  v_mfma_f32_16x16x32_bf16 a[176:179], a[112:115], a[60:63], a[176:179]
  buffer_load_dwordx4 v8, s[20:23], s31 offen offset:0 lds
  ds_read_b64_tr_b16 a[80:81], v18 offset:8192
  v_mfma_f32_16x16x32_bf16 v[84:87], a[116:119], a[32:35], v[84:87]
  ds_read_b64_tr_b16 a[82:83], v18 offset:10240
  ds_read_b64_tr_b16 a[84:85], v19 offset:8192
  v_mfma_f32_16x16x32_bf16 v[116:119], a[116:119], a[36:39], v[116:119]
  v_mfma_f32_16x16x32_bf16 v[148:151], a[116:119], a[40:43], v[148:151]
  ds_read_b64_tr_b16 a[86:87], v19 offset:10240
  v_mfma_f32_16x16x32_bf16 v[180:183], a[116:119], a[44:47], v[180:183]
  buffer_load_dwordx4 v9, s[20:23], s31 offen offset:1024 lds
  v_mfma_f32_16x16x32_bf16 v[212:215], a[116:119], a[48:51], v[212:215]
  v_mfma_f32_16x16x32_bf16 v[244:247], a[116:119], a[52:55], v[244:247]
  ds_read_b64_tr_b16 a[88:89], v20 offset:8192
  v_mfma_f32_16x16x32_bf16 a[148:151], a[116:119], a[56:59], a[148:151]
  v_mfma_f32_16x16x32_bf16 a[180:183], a[116:119], a[60:63], a[180:183]
  buffer_load_dwordx4 v10, s[20:23], s31 offen offset:2048 lds
  ds_read_b64_tr_b16 a[90:91], v20 offset:10240
  v_mfma_f32_16x16x32_bf16 v[88:91], a[120:123], a[32:35], v[88:91]
  s_add_u32 m0, s88, s27
  s_add_u32 m0, m0, 43008
  v_mfma_f32_16x16x32_bf16 v[120:123], a[120:123], a[36:39], v[120:123]
  ds_read_b64_tr_b16 a[92:93], v21 offset:8192
  v_mfma_f32_16x16x32_bf16 v[152:155], a[120:123], a[40:43], v[152:155]
  v_mfma_f32_16x16x32_bf16 v[184:187], a[120:123], a[44:47], v[184:187]
  buffer_load_dwordx4 v11, s[20:23], s31 offen offset:0 lds
  ds_read_b64_tr_b16 a[94:95], v21 offset:10240
  v_mfma_f32_16x16x32_bf16 v[216:219], a[120:123], a[48:51], v[216:219]
  v_mfma_f32_16x16x32_bf16 v[248:251], a[120:123], a[52:55], v[248:251]
  v_mfma_f32_16x16x32_bf16 a[152:155], a[120:123], a[56:59], a[152:155]
  v_mfma_f32_16x16x32_bf16 a[184:187], a[120:123], a[60:63], a[184:187]
  buffer_load_dwordx4 v12, s[20:23], s31 offen offset:1024 lds
  v_mfma_f32_16x16x32_bf16 v[92:95], a[124:127], a[32:35], v[92:95]
  v_mfma_f32_16x16x32_bf16 v[124:127], a[124:127], a[36:39], v[124:127]
  v_mfma_f32_16x16x32_bf16 v[156:159], a[124:127], a[40:43], v[156:159]
  v_mfma_f32_16x16x32_bf16 v[188:191], a[124:127], a[44:47], v[188:191]
  buffer_load_dwordx4 v13, s[20:23], s31 offen offset:2048 lds
  v_mfma_f32_16x16x32_bf16 v[220:223], a[124:127], a[48:51], v[220:223]
  v_mfma_f32_16x16x32_bf16 v[252:255], a[124:127], a[52:55], v[252:255]
  v_mfma_f32_16x16x32_bf16 a[156:159], a[124:127], a[56:59], a[156:159]
  v_mfma_f32_16x16x32_bf16 a[188:191], a[124:127], a[60:63], a[188:191]
  s_waitcnt lgkmcnt(0)
  v_mfma_f32_16x16x32_bf16 v[128:131], a[64:67], a[8:11], v[128:131]
  ds_read_b128 a[32:35], v17 offset:0
  ds_read_b64_tr_b16 a[96:97], v18 offset:4096
  v_mfma_f32_16x16x32_bf16 v[132:135], a[68:71], a[8:11], v[132:135]
  ds_read_b64_tr_b16 a[98:99], v18 offset:6144
  ds_read_b128 a[36:39], v17 offset:2048
  v_mfma_f32_16x16x32_bf16 v[136:139], a[72:75], a[8:11], v[136:139]
  ds_read_b128 a[40:43], v17 offset:4096
  ds_read_b128 a[44:47], v17 offset:6144
  v_mfma_f32_16x16x32_bf16 v[140:143], a[76:79], a[8:11], v[140:143]
  ds_read_b128 a[48:51], v17 offset:8192
  ds_read_b128 a[52:55], v17 offset:10240
  v_mfma_f32_16x16x32_bf16 v[144:147], a[80:83], a[8:11], v[144:147]
  ds_read_b128 a[56:59], v17 offset:12288
  ds_read_b128 a[60:63], v17 offset:14336
  v_mfma_f32_16x16x32_bf16 v[148:151], a[84:87], a[8:11], v[148:151]
  ds_read_b64_tr_b16 a[100:101], v19 offset:4096
  ds_read_b64_tr_b16 a[102:103], v19 offset:6144
  v_mfma_f32_16x16x32_bf16 v[152:155], a[88:91], a[8:11], v[152:155]
  ds_read_b64_tr_b16 a[104:105], v20 offset:4096
  v_mfma_f32_16x16x32_bf16 v[156:159], a[92:95], a[8:11], v[156:159]
  ds_read_b64_tr_b16 a[106:107], v20 offset:6144
  ds_read_b64_tr_b16 a[108:109], v21 offset:4096
  v_mfma_f32_16x16x32_bf16 v[160:163], a[64:67], a[12:15], v[160:163]
  ds_read_b64_tr_b16 a[110:111], v21 offset:6144
  ds_read_b64_tr_b16 a[112:113], v18 offset:12288
  v_mfma_f32_16x16x32_bf16 v[164:167], a[68:71], a[12:15], v[164:167]
  ds_read_b64_tr_b16 a[114:115], v18 offset:14336
  ds_read_b64_tr_b16 a[116:117], v19 offset:12288
  v_mfma_f32_16x16x32_bf16 v[168:171], a[72:75], a[12:15], v[168:171]
  ds_read_b64_tr_b16 a[118:119], v19 offset:14336
  ds_read_b64_tr_b16 a[120:121], v20 offset:12288
  v_mfma_f32_16x16x32_bf16 v[172:175], a[76:79], a[12:15], v[172:175]
  ds_read_b64_tr_b16 a[122:123], v20 offset:14336
  ds_read_b64_tr_b16 a[124:125], v21 offset:12288
  v_mfma_f32_16x16x32_bf16 v[176:179], a[80:83], a[12:15], v[176:179]
  ds_read_b64_tr_b16 a[126:127], v21 offset:14336
  v_mfma_f32_16x16x32_bf16 v[180:183], a[84:87], a[12:15], v[180:183]
  v_mfma_f32_16x16x32_bf16 v[184:187], a[88:91], a[12:15], v[184:187]
  v_mfma_f32_16x16x32_bf16 v[188:191], a[92:95], a[12:15], v[188:191]
  v_mfma_f32_16x16x32_bf16 v[192:195], a[64:67], a[16:19], v[192:195]
  v_mfma_f32_16x16x32_bf16 v[196:199], a[68:71], a[16:19], v[196:199]
  v_mfma_f32_16x16x32_bf16 v[200:203], a[72:75], a[16:19], v[200:203]
  v_mfma_f32_16x16x32_bf16 v[204:207], a[76:79], a[16:19], v[204:207]
  s_waitcnt lgkmcnt(0)
  s_barrier
  s_mov_b32 s12, s84
  s_mov_b32 s13, s85
  s_mov_b32 s14, 256
  s_mov_b32 s15, 0x00020000
  buffer_load_dwordx2 v[22:23], off, s[12:15], 0 sc1
  v_mfma_f32_16x16x32_bf16 v[128:131], a[96:99], a[40:43], v[128:131]
  s_cmp_ge_u32 s3, 2
  s_cbranch_scc1 Lh_8
  s_add_u32 m0, s88, s28
  s_add_u32 m0, m0, 86016
  s_nop 0
  buffer_load_dwordx4 v14, s[8:11], s30 offen offset:0 lds
Lh_8:
  v_mfma_f32_16x16x32_bf16 v[132:135], a[100:103], a[40:43], v[132:135]
  s_add_u32 m0, s88, 86016
  v_mfma_f32_16x16x32_bf16 v[136:139], a[104:107], a[40:43], v[136:139]
  buffer_load_dwordx4 v4, s[8:11], s30 offen offset:0 lds
  v_mfma_f32_16x16x32_bf16 v[140:143], a[108:111], a[40:43], v[140:143]
  v_mfma_f32_16x16x32_bf16 v[144:147], a[112:115], a[40:43], v[144:147]
  v_mfma_f32_16x16x32_bf16 v[148:151], a[116:119], a[40:43], v[148:151]
  v_cvt_pk_bf16_f32 v128, v128, v129
  v_cvt_pk_bf16_f32 v129, v130, v131
  v_mfma_f32_16x16x32_bf16 v[152:155], a[120:123], a[40:43], v[152:155]
  v_cvt_pk_bf16_f32 v130, v132, v133
  v_cvt_pk_bf16_f32 v131, v134, v135
  v_mfma_f32_16x16x32_bf16 v[156:159], a[124:127], a[40:43], v[156:159]
  v_cvt_pk_bf16_f32 v132, v136, v137
  v_cvt_pk_bf16_f32 v133, v138, v139
  v_mfma_f32_16x16x32_bf16 v[160:163], a[96:99], a[44:47], v[160:163]
  v_cvt_pk_bf16_f32 v134, v140, v141
  v_cvt_pk_bf16_f32 v135, v142, v143
  v_mfma_f32_16x16x32_bf16 v[164:167], a[100:103], a[44:47], v[164:167]
  v_cvt_pk_bf16_f32 v136, v144, v145
  v_cvt_pk_bf16_f32 v137, v146, v147
  v_mfma_f32_16x16x32_bf16 v[168:171], a[104:107], a[44:47], v[168:171]
  buffer_load_dwordx4 v5, s[8:11], s30 offen offset:1024 lds
  v_cvt_pk_bf16_f32 v138, v148, v149
  v_mfma_f32_16x16x32_bf16 v[172:175], a[108:111], a[44:47], v[172:175]
  v_cvt_pk_bf16_f32 v139, v150, v151
  v_mfma_f32_16x16x32_bf16 v[176:179], a[112:115], a[44:47], v[176:179]
  s_add_u32 s60, s63, 8192
  buffer_store_dwordx4 v[128:131], v2, s[16:19], s60 offen offset:0 sc1
  v_cvt_pk_bf16_f32 v140, v152, v153
  v_mfma_f32_16x16x32_bf16 v[180:183], a[116:119], a[44:47], v[180:183]
  v_cvt_pk_bf16_f32 v141, v154, v155
  v_cvt_pk_bf16_f32 v142, v156, v157
  v_mfma_f32_16x16x32_bf16 v[184:187], a[120:123], a[44:47], v[184:187]
  v_cvt_pk_bf16_f32 v143, v158, v159
  v_cvt_pk_bf16_f32 v144, v160, v161
  v_mfma_f32_16x16x32_bf16 v[188:191], a[124:127], a[44:47], v[188:191]
  v_cvt_pk_bf16_f32 v145, v162, v163
  v_cvt_pk_bf16_f32 v146, v164, v165
  v_mfma_f32_16x16x32_bf16 v[192:195], a[96:99], a[48:51], v[192:195]
  v_cvt_pk_bf16_f32 v147, v166, v167
  v_cvt_pk_bf16_f32 v148, v168, v169
  v_mfma_f32_16x16x32_bf16 v[196:199], a[100:103], a[48:51], v[196:199]
  v_cvt_pk_bf16_f32 v149, v170, v171
  v_cvt_pk_bf16_f32 v150, v172, v173
  v_mfma_f32_16x16x32_bf16 v[200:203], a[104:107], a[48:51], v[200:203]
  v_cvt_pk_bf16_f32 v151, v174, v175
  v_mfma_f32_16x16x32_bf16 v[204:207], a[108:111], a[48:51], v[204:207]
  s_add_u32 s60, s63, 8192
  buffer_store_dwordx4 v[132:135], v2, s[16:19], s60 offen offset:1024 sc1
  v_cvt_pk_bf16_f32 v152, v176, v177
  v_mfma_f32_16x16x32_bf16 v[208:211], a[80:83], a[16:19], v[208:211]
  v_cvt_pk_bf16_f32 v153, v178, v179
  v_cvt_pk_bf16_f32 v154, v180, v181
  v_mfma_f32_16x16x32_bf16 v[212:215], a[84:87], a[16:19], v[212:215]
  buffer_load_dwordx4 v6, s[8:11], s30 offen offset:2048 lds
  v_cvt_pk_bf16_f32 v155, v182, v183
  v_mfma_f32_16x16x32_bf16 v[208:211], a[112:115], a[48:51], v[208:211]
  v_cvt_pk_bf16_f32 v156, v184, v185
  v_cvt_pk_bf16_f32 v157, v186, v187
  v_mfma_f32_16x16x32_bf16 v[212:215], a[116:119], a[48:51], v[212:215]
  v_cvt_pk_bf16_f32 v158, v188, v189
  v_cvt_pk_bf16_f32 v159, v190, v191
  v_mfma_f32_16x16x32_bf16 v[216:219], a[88:91], a[16:19], v[216:219]
  v_cvt_pk_bf16_f32 v192, v192, v193
  v_cvt_pk_bf16_f32 v193, v194, v195
  v_mfma_f32_16x16x32_bf16 v[220:223], a[92:95], a[16:19], v[220:223]
  v_cvt_pk_bf16_f32 v194, v196, v197
  v_cvt_pk_bf16_f32 v195, v198, v199
  v_mfma_f32_16x16x32_bf16 v[216:219], a[120:123], a[48:51], v[216:219]
  v_cvt_pk_bf16_f32 v196, v200, v201
  v_cvt_pk_bf16_f32 v197, v202, v203
  v_mfma_f32_16x16x32_bf16 v[220:223], a[124:127], a[48:51], v[220:223]
  v_cvt_pk_bf16_f32 v198, v204, v205
  v_cvt_pk_bf16_f32 v199, v206, v207
  v_mfma_f32_16x16x32_bf16 v[224:227], a[64:67], a[20:23], v[224:227]
  s_add_u32 s60, s63, 8192
  buffer_store_dwordx4 v[136:139], v2, s[16:19], s60 offen offset:2048 sc1
  v_cvt_pk_bf16_f32 v200, v208, v209
  v_mfma_f32_16x16x32_bf16 v[228:231], a[68:71], a[20:23], v[228:231]
  v_cvt_pk_bf16_f32 v201, v210, v211
  v_cvt_pk_bf16_f32 v202, v212, v213
  v_mfma_f32_16x16x32_bf16 v[224:227], a[96:99], a[52:55], v[224:227]
  v_cvt_pk_bf16_f32 v203, v214, v215
  v_mfma_f32_16x16x32_bf16 v[228:231], a[100:103], a[52:55], v[228:231]
  v_cvt_pk_bf16_f32 v204, v216, v217
  v_cvt_pk_bf16_f32 v205, v218, v219
  v_mfma_f32_16x16x32_bf16 v[232:235], a[72:75], a[20:23], v[232:235]
  buffer_load_dwordx4 v7, s[8:11], s30 offen offset:3072 lds
  v_cvt_pk_bf16_f32 v206, v220, v221
  v_mfma_f32_16x16x32_bf16 v[236:239], a[76:79], a[20:23], v[236:239]
  s_mul_i32 s31, s0, 393216
  s_bfe_u32 s29, 0x302010e, s1
  s_add_u32 s0, s0, s29
  v_mfma_f32_16x16x32_bf16 v[232:235], a[104:107], a[52:55], v[232:235]
  s_add_u32 s1, s1, 8
  s_and_b32 s1, s1, 0x8001f
  s_and_b32 s0, s0, 15
  v_mfma_f32_16x16x32_bf16 v[236:239], a[108:111], a[52:55], v[236:239]
  s_lshl_b32 s30, s0, 7
  s_add_u32 m0, s88, s26
  s_add_u32 m0, m0, 86016
  v_mfma_f32_16x16x32_bf16 v[240:243], a[80:83], a[20:23], v[240:243]
  v_cvt_pk_bf16_f32 v207, v222, v223
  v_cvt_pk_bf16_f32 v208, v224, v225
  v_mfma_f32_16x16x32_bf16 v[244:247], a[84:87], a[20:23], v[244:247]
  v_cvt_pk_bf16_f32 v209, v226, v227
  v_cvt_pk_bf16_f32 v210, v228, v229
  v_mfma_f32_16x16x32_bf16 v[240:243], a[112:115], a[52:55], v[240:243]
  v_cvt_pk_bf16_f32 v211, v230, v231
  v_mfma_f32_16x16x32_bf16 v[244:247], a[116:119], a[52:55], v[244:247]
  s_add_u32 s60, s63, 8192
  buffer_store_dwordx4 v[140:143], v2, s[16:19], s60 offen offset:3072 sc1
  v_cvt_pk_bf16_f32 v212, v232, v233
  v_mfma_f32_16x16x32_bf16 v[248:251], a[88:91], a[20:23], v[248:251]
  v_cvt_pk_bf16_f32 v213, v234, v235
  v_cvt_pk_bf16_f32 v214, v236, v237
  v_mfma_f32_16x16x32_bf16 v[252:255], a[92:95], a[20:23], v[252:255]
  v_cvt_pk_bf16_f32 v215, v238, v239
  v_mfma_f32_16x16x32_bf16 v[248:251], a[120:123], a[52:55], v[248:251]
  buffer_load_dwordx4 v8, s[20:23], s31 offen offset:0 lds
  v_mfma_f32_16x16x32_bf16 v[252:255], a[124:127], a[52:55], v[252:255]
  v_cvt_pk_bf16_f32 v216, v240, v241
  v_cvt_pk_bf16_f32 v217, v242, v243
  v_mfma_f32_16x16x32_bf16 v[64:67], a[64:67], a[0:3], v[64:67]
  v_cvt_pk_bf16_f32 v218, v244, v245
  v_cvt_pk_bf16_f32 v219, v246, v247
  v_mfma_f32_16x16x32_bf16 v[68:71], a[68:71], a[0:3], v[68:71]
  v_mfma_f32_16x16x32_bf16 v[64:67], a[96:99], a[32:35], v[64:67]
  v_mfma_f32_16x16x32_bf16 v[68:71], a[100:103], a[32:35], v[68:71]
  v_cvt_pk_bf16_f32 v220, v248, v249
  v_cvt_pk_bf16_f32 v221, v250, v251
  v_mfma_f32_16x16x32_bf16 v[72:75], a[72:75], a[0:3], v[72:75]
  v_cvt_pk_bf16_f32 v222, v252, v253
  v_cvt_pk_bf16_f32 v223, v254, v255
  v_mfma_f32_16x16x32_bf16 v[76:79], a[76:79], a[0:3], v[76:79]
  v_mfma_f32_16x16x32_bf16 v[72:75], a[104:107], a[32:35], v[72:75]
  v_mfma_f32_16x16x32_bf16 v[76:79], a[108:111], a[32:35], v[76:79]
  v_cvt_pk_bf16_f32 v160, v64, v65
  v_cvt_pk_bf16_f32 v161, v66, v67
  v_mfma_f32_16x16x32_bf16 v[80:83], a[80:83], a[0:3], v[80:83]
  v_cvt_pk_bf16_f32 v162, v68, v69
  v_cvt_pk_bf16_f32 v163, v70, v71
  v_mfma_f32_16x16x32_bf16 v[84:87], a[84:87], a[0:3], v[84:87]
  buffer_load_dwordx4 v9, s[20:23], s31 offen offset:1024 lds
  v_mfma_f32_16x16x32_bf16 v[80:83], a[112:115], a[32:35], v[80:83]
  s_add_u32 s60, s63, 12288
  buffer_store_dwordx4 v[144:147], v2, s[16:19], s60 offen offset:0 sc1
  v_mfma_f32_16x16x32_bf16 v[84:87], a[116:119], a[32:35], v[84:87]
  v_cvt_pk_bf16_f32 v164, v72, v73
  v_cvt_pk_bf16_f32 v165, v74, v75
  v_mfma_f32_16x16x32_bf16 v[88:91], a[88:91], a[0:3], v[88:91]
  v_cvt_pk_bf16_f32 v166, v76, v77
  v_cvt_pk_bf16_f32 v167, v78, v79
  v_mfma_f32_16x16x32_bf16 v[92:95], a[92:95], a[0:3], v[92:95]
  v_mfma_f32_16x16x32_bf16 v[88:91], a[120:123], a[32:35], v[88:91]
  v_mfma_f32_16x16x32_bf16 v[92:95], a[124:127], a[32:35], v[92:95]
  v_cvt_pk_bf16_f32 v168, v80, v81
  v_cvt_pk_bf16_f32 v169, v82, v83
  v_mfma_f32_16x16x32_bf16 v[96:99], a[64:67], a[4:7], v[96:99]
  v_cvt_pk_bf16_f32 v170, v84, v85
  v_cvt_pk_bf16_f32 v171, v86, v87
  v_mfma_f32_16x16x32_bf16 v[100:103], a[68:71], a[4:7], v[100:103]
  v_mfma_f32_16x16x32_bf16 v[96:99], a[96:99], a[36:39], v[96:99]
  v_mfma_f32_16x16x32_bf16 v[100:103], a[100:103], a[36:39], v[100:103]
  v_cvt_pk_bf16_f32 v172, v88, v89
  v_cvt_pk_bf16_f32 v173, v90, v91
  v_mfma_f32_16x16x32_bf16 v[104:107], a[72:75], a[4:7], v[104:107]
  buffer_load_dwordx4 v10, s[20:23], s31 offen offset:2048 lds
  v_cvt_pk_bf16_f32 v174, v92, v93
  v_mfma_f32_16x16x32_bf16 v[108:111], a[76:79], a[4:7], v[108:111]
  s_add_u32 m0, s88, s27
  s_add_u32 m0, m0, 86016
  v_cvt_pk_bf16_f32 v175, v94, v95
  v_mfma_f32_16x16x32_bf16 v[104:107], a[104:107], a[36:39], v[104:107]
  s_add_u32 s60, s63, 12288
  buffer_store_dwordx4 v[148:151], v2, s[16:19], s60 offen offset:1024 sc1
  v_mfma_f32_16x16x32_bf16 v[108:111], a[108:111], a[36:39], v[108:111]
  v_cvt_pk_bf16_f32 v176, v96, v97
  v_cvt_pk_bf16_f32 v177, v98, v99
  v_mfma_f32_16x16x32_bf16 v[112:115], a[80:83], a[4:7], v[112:115]
  v_cvt_pk_bf16_f32 v178, v100, v101
  v_cvt_pk_bf16_f32 v179, v102, v103
  v_mfma_f32_16x16x32_bf16 v[116:119], a[84:87], a[4:7], v[116:119]
  v_mfma_f32_16x16x32_bf16 v[112:115], a[112:115], a[36:39], v[112:115]
  v_mfma_f32_16x16x32_bf16 v[116:119], a[116:119], a[36:39], v[116:119]
  v_cvt_pk_bf16_f32 v180, v104, v105
  v_cvt_pk_bf16_f32 v181, v106, v107
  v_mfma_f32_16x16x32_bf16 v[120:123], a[88:91], a[4:7], v[120:123]
  v_cvt_pk_bf16_f32 v182, v108, v109
  v_cvt_pk_bf16_f32 v183, v110, v111
  v_mfma_f32_16x16x32_bf16 v[124:127], a[92:95], a[4:7], v[124:127]
  v_mfma_f32_16x16x32_bf16 v[120:123], a[120:123], a[36:39], v[120:123]
  buffer_load_dwordx4 v11, s[20:23], s31 offen offset:0 lds
  v_mfma_f32_16x16x32_bf16 v[124:127], a[124:127], a[36:39], v[124:127]
  v_cvt_pk_bf16_f32 v184, v112, v113
  v_cvt_pk_bf16_f32 v185, v114, v115
  v_mfma_f32_16x16x32_bf16 a[128:131], a[64:67], a[24:27], a[128:131]
  v_cvt_pk_bf16_f32 v186, v116, v117
  v_cvt_pk_bf16_f32 v187, v118, v119
  v_mfma_f32_16x16x32_bf16 a[132:135], a[68:71], a[24:27], a[132:135]
  v_mfma_f32_16x16x32_bf16 a[128:131], a[96:99], a[56:59], a[128:131]
  v_mfma_f32_16x16x32_bf16 a[132:135], a[100:103], a[56:59], a[132:135]
  v_cvt_pk_bf16_f32 v188, v120, v121
  v_cvt_pk_bf16_f32 v189, v122, v123
  v_mfma_f32_16x16x32_bf16 a[136:139], a[72:75], a[24:27], a[136:139]
  v_cvt_pk_bf16_f32 v190, v124, v125
  v_cvt_pk_bf16_f32 v191, v126, v127
  v_mfma_f32_16x16x32_bf16 a[140:143], a[76:79], a[24:27], a[140:143]
  s_add_u32 s60, s63, 12288
  buffer_store_dwordx4 v[152:155], v2, s[16:19], s60 offen offset:2048 sc1
  v_mfma_f32_16x16x32_bf16 a[136:139], a[104:107], a[56:59], a[136:139]
  v_mfma_f32_16x16x32_bf16 a[140:143], a[108:111], a[56:59], a[140:143]
  v_accvgpr_read_b32 v64, a128
  v_accvgpr_read_b32 v65, a129
  v_mfma_f32_16x16x32_bf16 a[144:147], a[80:83], a[24:27], a[144:147]
  v_accvgpr_read_b32 v66, a130
  v_accvgpr_read_b32 v67, a131
  v_mfma_f32_16x16x32_bf16 a[148:151], a[84:87], a[24:27], a[148:151]
  buffer_load_dwordx4 v12, s[20:23], s31 offen offset:1024 lds
  v_accvgpr_read_b32 v68, a132
  v_mfma_f32_16x16x32_bf16 a[144:147], a[112:115], a[56:59], a[144:147]
  v_accvgpr_read_b32 v69, a133
  v_accvgpr_read_b32 v70, a134
  v_mfma_f32_16x16x32_bf16 a[148:151], a[116:119], a[56:59], a[148:151]
  v_accvgpr_read_b32 v71, a135
  v_cvt_pk_bf16_f32 v224, v64, v65
  v_mfma_f32_16x16x32_bf16 a[152:155], a[88:91], a[24:27], a[152:155]
  v_cvt_pk_bf16_f32 v225, v66, v67
  v_cvt_pk_bf16_f32 v226, v68, v69
  v_mfma_f32_16x16x32_bf16 a[156:159], a[92:95], a[24:27], a[156:159]
  v_cvt_pk_bf16_f32 v227, v70, v71
  v_accvgpr_read_b32 v72, a136
  v_mfma_f32_16x16x32_bf16 a[152:155], a[120:123], a[56:59], a[152:155]
  v_accvgpr_read_b32 v73, a137
  v_accvgpr_read_b32 v74, a138
  v_mfma_f32_16x16x32_bf16 a[156:159], a[124:127], a[56:59], a[156:159]
  v_accvgpr_read_b32 v75, a139
  v_accvgpr_read_b32 v76, a140
  v_mfma_f32_16x16x32_bf16 a[160:163], a[64:67], a[28:31], a[160:163]
  v_accvgpr_read_b32 v77, a141
  v_accvgpr_read_b32 v78, a142
  v_mfma_f32_16x16x32_bf16 a[164:167], a[68:71], a[28:31], a[164:167]
  v_accvgpr_read_b32 v79, a143
  v_cvt_pk_bf16_f32 v228, v72, v73
  v_mfma_f32_16x16x32_bf16 a[160:163], a[96:99], a[60:63], a[160:163]
  v_cvt_pk_bf16_f32 v229, v74, v75
  v_cvt_pk_bf16_f32 v230, v76, v77
  v_mfma_f32_16x16x32_bf16 a[164:167], a[100:103], a[60:63], a[164:167]
  v_cvt_pk_bf16_f32 v231, v78, v79
  v_accvgpr_read_b32 v80, a144
  v_mfma_f32_16x16x32_bf16 a[168:171], a[72:75], a[28:31], a[168:171]
  buffer_load_dwordx4 v13, s[20:23], s31 offen offset:2048 lds
  v_accvgpr_read_b32 v81, a145
  v_mfma_f32_16x16x32_bf16 a[172:175], a[76:79], a[28:31], a[172:175]
  v_accvgpr_read_b32 v82, a146
  v_accvgpr_read_b32 v83, a147
  v_mfma_f32_16x16x32_bf16 a[168:171], a[104:107], a[60:63], a[168:171]
  v_accvgpr_read_b32 v84, a148
  v_accvgpr_read_b32 v85, a149
  v_mfma_f32_16x16x32_bf16 a[172:175], a[108:111], a[60:63], a[172:175]
  v_accvgpr_read_b32 v86, a150
  v_accvgpr_read_b32 v87, a151
  v_mfma_f32_16x16x32_bf16 a[176:179], a[80:83], a[28:31], a[176:179]
  v_cvt_pk_bf16_f32 v232, v80, v81
  v_cvt_pk_bf16_f32 v233, v82, v83
  v_mfma_f32_16x16x32_bf16 a[180:183], a[84:87], a[28:31], a[180:183]
  v_cvt_pk_bf16_f32 v234, v84, v85
  v_cvt_pk_bf16_f32 v235, v86, v87
  v_mfma_f32_16x16x32_bf16 a[176:179], a[112:115], a[60:63], a[176:179]
  s_add_u32 s60, s63, 12288
  buffer_store_dwordx4 v[156:159], v2, s[16:19], s60 offen offset:3072 sc1
  v_accvgpr_read_b32 v88, a152
  v_mfma_f32_16x16x32_bf16 a[180:183], a[116:119], a[60:63], a[180:183]
  v_accvgpr_read_b32 v89, a153
  v_accvgpr_read_b32 v90, a154
  v_mfma_f32_16x16x32_bf16 a[184:187], a[88:91], a[28:31], a[184:187]
  v_accvgpr_read_b32 v91, a155
  v_accvgpr_read_b32 v92, a156
  v_mfma_f32_16x16x32_bf16 a[188:191], a[92:95], a[28:31], a[188:191]
  v_accvgpr_read_b32 v93, a157
  v_accvgpr_read_b32 v94, a158
  v_mfma_f32_16x16x32_bf16 a[184:187], a[120:123], a[60:63], a[184:187]
  v_accvgpr_read_b32 v95, a159
  v_cvt_pk_bf16_f32 v236, v88, v89
  v_mfma_f32_16x16x32_bf16 a[188:191], a[124:127], a[60:63], a[188:191]
  v_cvt_pk_bf16_f32 v237, v90, v91
  v_cvt_pk_bf16_f32 v238, v92, v93
  v_cvt_pk_bf16_f32 v239, v94, v95
  v_accvgpr_read_b32 v96, a160
  v_accvgpr_read_b32 v97, a161
  v_accvgpr_read_b32 v98, a162
  v_accvgpr_read_b32 v99, a163
  v_accvgpr_read_b32 v100, a164
  v_accvgpr_read_b32 v101, a165
  v_accvgpr_read_b32 v102, a166
  v_accvgpr_read_b32 v103, a167
  v_cvt_pk_bf16_f32 v240, v96, v97
  v_cvt_pk_bf16_f32 v241, v98, v99
  v_cvt_pk_bf16_f32 v242, v100, v101
  v_cvt_pk_bf16_f32 v243, v102, v103
  v_accvgpr_read_b32 v104, a168
  v_accvgpr_read_b32 v105, a169
  v_accvgpr_read_b32 v106, a170
  v_accvgpr_read_b32 v107, a171
  v_accvgpr_read_b32 v108, a172
  v_accvgpr_read_b32 v109, a173
  v_accvgpr_read_b32 v110, a174
  v_accvgpr_read_b32 v111, a175
  v_cvt_pk_bf16_f32 v244, v104, v105
  v_cvt_pk_bf16_f32 v245, v106, v107
  v_cvt_pk_bf16_f32 v246, v108, v109
  v_cvt_pk_bf16_f32 v247, v110, v111
  v_accvgpr_read_b32 v112, a176
  v_accvgpr_read_b32 v113, a177
  v_accvgpr_read_b32 v114, a178
  v_accvgpr_read_b32 v115, a179
  v_accvgpr_read_b32 v116, a180
  v_accvgpr_read_b32 v117, a181
  v_accvgpr_read_b32 v118, a182
  v_accvgpr_read_b32 v119, a183
  v_cvt_pk_bf16_f32 v248, v112, v113
  v_cvt_pk_bf16_f32 v249, v114, v115
  v_cvt_pk_bf16_f32 v250, v116, v117
  v_cvt_pk_bf16_f32 v251, v118, v119
  v_accvgpr_read_b32 v120, a184
  v_accvgpr_read_b32 v121, a185
  v_accvgpr_read_b32 v122, a186
  v_accvgpr_read_b32 v123, a187
  v_accvgpr_read_b32 v124, a188
  v_accvgpr_read_b32 v125, a189
  v_accvgpr_read_b32 v126, a190
  v_accvgpr_read_b32 v127, a191
  v_cvt_pk_bf16_f32 v252, v120, v121
  v_cvt_pk_bf16_f32 v253, v122, v123
  v_cvt_pk_bf16_f32 v254, v124, v125
  v_cvt_pk_bf16_f32 v255, v126, v127
Lp2:
  s_mov_b32 s89, 0
  s_mov_b32 s91, 4294881280
  s_mov_b32 s92, 43008
  v_accvgpr_read_b32 v16, a216
  v_accvgpr_read_b32 v17, a217
  v_accvgpr_read_b32 v18, a218
  v_accvgpr_read_b32 v19, a219
  v_accvgpr_read_b32 v20, a220
  v_accvgpr_read_b32 v21, a221
  s_cmp_ge_u32 s3, 2
  s_cbranch_scc1 Lp2_r1
  s_waitcnt vmcnt(31)
  s_barrier
  ds_read_b128 a[0:3], v16 offset:0
  ds_read_b64_tr_b16 a[40:41], v20 offset:18432
  ds_read_b64_tr_b16 a[42:43], v20 offset:20480
  ds_read_b128 a[4:7], v16 offset:2048
  ds_read_b128 a[8:11], v16 offset:4096
  ds_read_b128 a[12:15], v16 offset:6144
  ds_read_b64_tr_b16 a[44:45], v21 offset:18432
  ds_read_b64_tr_b16 a[46:47], v21 offset:20480
  ds_read_b64_tr_b16 a[48:49], v20 offset:26624
  ds_read_b64_tr_b16 a[50:51], v20 offset:28672
  ds_read_b128 a[16:19], v18 offset:0
  ds_read_b64_tr_b16 a[52:53], v21 offset:26624
  ds_read_b64_tr_b16 a[54:55], v21 offset:28672
  ds_read_b64_tr_b16 a[56:57], v20 offset:34816
  ds_read_b64_tr_b16 a[58:59], v20 offset:36864
  ds_read_b64_tr_b16 a[60:61], v21 offset:34816
  ds_read_b64_tr_b16 a[62:63], v21 offset:36864
  s_waitcnt lgkmcnt(0)
  v_mfma_f32_16x16x32_bf16 v[24:27], a[40:43], a[0:3], 0
  s_add_u32 s60, s63, 32768
  buffer_store_dwordx4 v[192:195], v2, s[16:19], s60 offen offset:0 sc1
  ds_read_b128 a[20:23], v17 offset:0
  v_mfma_f32_16x16x32_bf16 v[32:35], a[40:43], a[4:7], 0
  s_add_u32 s89, s89, 1
  ds_read_b64_tr_b16 a[64:65], v20 offset:22528
  ds_read_b64_tr_b16 a[66:67], v20 offset:24576
  v_mfma_f32_16x16x32_bf16 v[40:43], a[40:43], a[8:11], 0
  s_cmp_eq_u32 s89, 3
  s_cselect_b32 s89, 0, s89
  s_cselect_b32 s90, s91, s92
  ds_read_b128 a[24:27], v17 offset:2048
  v_mfma_f32_16x16x32_bf16 v[48:51], a[40:43], a[12:15], 0
  ds_read_b128 a[28:31], v17 offset:4096
  v_mfma_f32_16x16x32_bf16 v[28:31], a[44:47], a[0:3], 0
  ds_read_b128 a[32:35], v17 offset:6144
  v_mfma_f32_16x16x32_bf16 v[36:39], a[44:47], a[4:7], 0
  ds_read_b64_tr_b16 a[68:69], v21 offset:22528
  v_mfma_f32_16x16x32_bf16 v[44:47], a[44:47], a[8:11], 0
  ds_read_b64_tr_b16 a[70:71], v21 offset:24576
  v_mfma_f32_16x16x32_bf16 v[52:55], a[44:47], a[12:15], 0
  ds_read_b64_tr_b16 a[72:73], v20 offset:30720
  v_mfma_f32_16x16x32_bf16 v[56:59], a[48:51], a[0:3], 0
  ds_read_b64_tr_b16 a[74:75], v20 offset:32768
  v_mfma_f32_16x16x32_bf16 v[64:67], a[48:51], a[4:7], 0
  ds_read_b128 a[36:39], v19 offset:0
  v_mfma_f32_16x16x32_bf16 v[72:75], a[48:51], a[8:11], 0
  ds_read_b64_tr_b16 a[76:77], v21 offset:30720
  v_mfma_f32_16x16x32_bf16 v[80:83], a[48:51], a[12:15], 0
  ds_read_b64_tr_b16 a[78:79], v21 offset:32768
  v_mfma_f32_16x16x32_bf16 v[120:123], a[48:51], a[16:19], 0
  ds_read_b64_tr_b16 a[80:81], v20 offset:38912
  v_mfma_f32_16x16x32_bf16 v[60:63], a[52:55], a[0:3], 0
  ds_read_b64_tr_b16 a[82:83], v20 offset:40960
  v_mfma_f32_16x16x32_bf16 v[68:71], a[52:55], a[4:7], 0
  ds_read_b64_tr_b16 a[84:85], v21 offset:38912
  v_mfma_f32_16x16x32_bf16 v[76:79], a[52:55], a[8:11], 0
  ds_read_b64_tr_b16 a[86:87], v21 offset:40960
  v_mfma_f32_16x16x32_bf16 v[84:87], a[52:55], a[12:15], 0
  v_add_u32 v16, s90, v16
  v_add_u32 v17, s90, v17
  v_mfma_f32_16x16x32_bf16 v[124:127], a[52:55], a[16:19], 0
  v_add_u32 v18, s90, v18
  v_add_u32 v19, s90, v19
  v_mfma_f32_16x16x32_bf16 v[88:91], a[0:3], a[56:59], 0
  v_add_u32 v20, s90, v20
  v_add_u32 v21, s90, v21
  v_mfma_f32_16x16x32_bf16 v[96:99], a[4:7], a[56:59], 0
  v_mfma_f32_16x16x32_bf16 v[104:107], a[8:11], a[56:59], 0
  v_mfma_f32_16x16x32_bf16 v[112:115], a[12:15], a[56:59], 0
  v_mfma_f32_16x16x32_bf16 v[92:95], a[0:3], a[60:63], 0
  v_mfma_f32_16x16x32_bf16 v[100:103], a[4:7], a[60:63], 0
  v_mfma_f32_16x16x32_bf16 v[108:111], a[8:11], a[60:63], 0
  v_mfma_f32_16x16x32_bf16 v[116:119], a[12:15], a[60:63], 0
  s_waitcnt vmcnt(21) lgkmcnt(0)
  s_barrier
  v_mfma_f32_16x16x32_bf16 v[24:27], a[64:67], a[20:23], v[24:27]
  buffer_load_dwordx4 a[192:195], v2, s[52:55], s51 offen offset:0
  ds_read_b128 a[0:3], v16 offset:0
  v_mfma_f32_16x16x32_bf16 v[32:35], a[64:67], a[24:27], v[32:35]
  s_add_u32 s51, s51, 1024
  s_add_u32 m0, s88, s28
  ds_read_b64_tr_b16 a[40:41], v20 offset:18432
  v_mfma_f32_16x16x32_bf16 v[40:43], a[64:67], a[28:31], v[40:43]
  ds_read_b64_tr_b16 a[42:43], v20 offset:20480
  ds_read_b128 a[4:7], v16 offset:2048
  v_mfma_f32_16x16x32_bf16 v[48:51], a[64:67], a[32:35], v[48:51]
  buffer_load_dwordx4 v14, s[8:11], s30 offen offset:0 lds
  ds_read_b128 a[8:11], v16 offset:4096
  v_mfma_f32_16x16x32_bf16 v[28:31], a[68:71], a[20:23], v[28:31]
  s_mov_b32 m0, s88
  ds_read_b128 a[12:15], v16 offset:6144
  v_mfma_f32_16x16x32_bf16 v[36:39], a[68:71], a[24:27], v[36:39]
  ds_read_b64_tr_b16 a[44:45], v21 offset:18432
  v_mfma_f32_16x16x32_bf16 v[44:47], a[68:71], a[28:31], v[44:47]
  ds_read_b64_tr_b16 a[46:47], v21 offset:20480
  v_mfma_f32_16x16x32_bf16 v[52:55], a[68:71], a[32:35], v[52:55]
  buffer_load_dwordx4 v4, s[8:11], s30 offen offset:0 lds
  ds_read_b64_tr_b16 a[48:49], v20 offset:26624
  v_mfma_f32_16x16x32_bf16 v[56:59], a[72:75], a[20:23], v[56:59]
  ds_read_b64_tr_b16 a[50:51], v20 offset:28672
  v_mfma_f32_16x16x32_bf16 v[64:67], a[72:75], a[24:27], v[64:67]
  ds_read_b128 a[16:19], v18 offset:0
  v_mfma_f32_16x16x32_bf16 v[72:75], a[72:75], a[28:31], v[72:75]
  buffer_load_dwordx4 v5, s[8:11], s30 offen offset:1024 lds
  ds_read_b64_tr_b16 a[52:53], v21 offset:26624
  v_mfma_f32_16x16x32_bf16 v[80:83], a[72:75], a[32:35], v[80:83]
  ds_read_b64_tr_b16 a[54:55], v21 offset:28672
  v_mfma_f32_16x16x32_bf16 v[120:123], a[72:75], a[36:39], v[120:123]
  ds_read_b64_tr_b16 a[56:57], v20 offset:34816
  v_mfma_f32_16x16x32_bf16 v[60:63], a[76:79], a[20:23], v[60:63]
  ds_read_b64_tr_b16 a[58:59], v20 offset:36864
  v_mfma_f32_16x16x32_bf16 v[68:71], a[76:79], a[24:27], v[68:71]
  buffer_load_dwordx4 v6, s[8:11], s30 offen offset:2048 lds
  ds_read_b64_tr_b16 a[60:61], v21 offset:34816
  v_mfma_f32_16x16x32_bf16 v[76:79], a[76:79], a[28:31], v[76:79]
  ds_read_b64_tr_b16 a[62:63], v21 offset:36864
  v_mfma_f32_16x16x32_bf16 v[84:87], a[76:79], a[32:35], v[84:87]
  v_mfma_f32_16x16x32_bf16 v[124:127], a[76:79], a[36:39], v[124:127]
  buffer_load_dwordx4 v7, s[8:11], s30 offen offset:3072 lds
  v_mfma_f32_16x16x32_bf16 v[88:91], a[20:23], a[80:83], v[88:91]
  s_mul_i32 s31, s0, 393216
  s_bfe_u32 s29, 0x302010e, s1
  s_add_u32 s0, s0, s29
  v_mfma_f32_16x16x32_bf16 v[96:99], a[24:27], a[80:83], v[96:99]
  s_add_u32 s1, s1, 8
  s_and_b32 s1, s1, 0x8001f
  s_and_b32 s0, s0, 15
  v_mfma_f32_16x16x32_bf16 v[104:107], a[28:31], a[80:83], v[104:107]
  s_lshl_b32 s30, s0, 7
  s_add_u32 m0, s88, s26
  v_mfma_f32_16x16x32_bf16 v[112:115], a[32:35], a[80:83], v[112:115]
  buffer_load_dwordx4 v8, s[20:23], s31 offen offset:0 lds
  v_mfma_f32_16x16x32_bf16 v[92:95], a[20:23], a[84:87], v[92:95]
  v_mfma_f32_16x16x32_bf16 v[100:103], a[24:27], a[84:87], v[100:103]
  v_mfma_f32_16x16x32_bf16 v[108:111], a[28:31], a[84:87], v[108:111]
  v_mfma_f32_16x16x32_bf16 v[116:119], a[32:35], a[84:87], v[116:119]
  s_waitcnt lgkmcnt(0)
  v_mfma_f32_16x16x32_bf16 v[24:27], a[40:43], a[0:3], v[24:27]
  buffer_load_dwordx4 v9, s[20:23], s31 offen offset:1024 lds
  ds_read_b128 a[20:23], v17 offset:0
  v_mfma_f32_16x16x32_bf16 v[32:35], a[40:43], a[4:7], v[32:35]
  ds_read_b64_tr_b16 a[64:65], v20 offset:22528
  ds_read_b64_tr_b16 a[66:67], v20 offset:24576
  v_mfma_f32_16x16x32_bf16 v[40:43], a[40:43], a[8:11], v[40:43]
  ds_read_b128 a[24:27], v17 offset:2048
  v_mfma_f32_16x16x32_bf16 v[48:51], a[40:43], a[12:15], v[48:51]
  buffer_load_dwordx4 v10, s[20:23], s31 offen offset:2048 lds
  ds_read_b128 a[28:31], v17 offset:4096
  v_mfma_f32_16x16x32_bf16 v[28:31], a[44:47], a[0:3], v[28:31]
  s_add_u32 m0, s88, s27
  ds_read_b128 a[32:35], v17 offset:6144
  v_mfma_f32_16x16x32_bf16 v[36:39], a[44:47], a[4:7], v[36:39]
  ds_read_b64_tr_b16 a[68:69], v21 offset:22528
  v_mfma_f32_16x16x32_bf16 v[44:47], a[44:47], a[8:11], v[44:47]
  buffer_load_dwordx4 v11, s[20:23], s31 offen offset:0 lds
  ds_read_b64_tr_b16 a[70:71], v21 offset:24576
  v_mfma_f32_16x16x32_bf16 v[52:55], a[44:47], a[12:15], v[52:55]
  ds_read_b64_tr_b16 a[72:73], v20 offset:30720
  v_mfma_f32_16x16x32_bf16 v[56:59], a[48:51], a[0:3], v[56:59]
  ds_read_b64_tr_b16 a[74:75], v20 offset:32768
  v_mfma_f32_16x16x32_bf16 v[64:67], a[48:51], a[4:7], v[64:67]
  buffer_load_dwordx4 v12, s[20:23], s31 offen offset:1024 lds
  ds_read_b128 a[36:39], v19 offset:0
  v_mfma_f32_16x16x32_bf16 v[72:75], a[48:51], a[8:11], v[72:75]
  ds_read_b64_tr_b16 a[76:77], v21 offset:30720
  v_mfma_f32_16x16x32_bf16 v[80:83], a[48:51], a[12:15], v[80:83]
  ds_read_b64_tr_b16 a[78:79], v21 offset:32768
  v_mfma_f32_16x16x32_bf16 v[120:123], a[48:51], a[16:19], v[120:123]
  buffer_load_dwordx4 v13, s[20:23], s31 offen offset:2048 lds
  ds_read_b64_tr_b16 a[80:81], v20 offset:38912
  v_mfma_f32_16x16x32_bf16 v[60:63], a[52:55], a[0:3], v[60:63]
  s_add_u32 s60, s63, 32768
  ds_read_b64_tr_b16 a[82:83], v20 offset:40960
  v_mfma_f32_16x16x32_bf16 v[68:71], a[52:55], a[4:7], v[68:71]
  ds_read_b64_tr_b16 a[84:85], v21 offset:38912
  v_mfma_f32_16x16x32_bf16 v[76:79], a[52:55], a[8:11], v[76:79]
  buffer_store_dwordx4 v[196:199], v2, s[16:19], s60 offen offset:1024 sc1
  ds_read_b64_tr_b16 a[86:87], v21 offset:40960
  v_mfma_f32_16x16x32_bf16 v[84:87], a[52:55], a[12:15], v[84:87]
  s_add_u32 s88, s88, s90
  s_add_u32 s89, s89, 1
  s_cmp_eq_u32 s89, 3
  s_cselect_b32 s89, 0, s89
  s_cselect_b32 s90, s91, s92
  v_mfma_f32_16x16x32_bf16 v[124:127], a[52:55], a[16:19], v[124:127]
  v_add_u32 v16, s90, v16
  v_add_u32 v17, s90, v17
  v_mfma_f32_16x16x32_bf16 v[88:91], a[0:3], a[56:59], v[88:91]
  v_add_u32 v18, s90, v18
  v_add_u32 v19, s90, v19
  v_mfma_f32_16x16x32_bf16 v[96:99], a[4:7], a[56:59], v[96:99]
  v_add_u32 v20, s90, v20
  v_add_u32 v21, s90, v21
  v_mfma_f32_16x16x32_bf16 v[104:107], a[8:11], a[56:59], v[104:107]
  v_mfma_f32_16x16x32_bf16 v[112:115], a[12:15], a[56:59], v[112:115]
  v_mfma_f32_16x16x32_bf16 v[92:95], a[0:3], a[60:63], v[92:95]
  v_mfma_f32_16x16x32_bf16 v[100:103], a[4:7], a[60:63], v[100:103]
  v_mfma_f32_16x16x32_bf16 v[108:111], a[8:11], a[60:63], v[108:111]
  v_mfma_f32_16x16x32_bf16 v[116:119], a[12:15], a[60:63], v[116:119]
  s_waitcnt vmcnt(14) lgkmcnt(0)
  s_barrier
  v_mfma_f32_16x16x32_bf16 v[24:27], a[64:67], a[20:23], v[24:27]
  buffer_load_dwordx4 a[192:195], v2, s[52:55], s51 offen offset:0
  ds_read_b128 a[0:3], v16 offset:0
  v_mfma_f32_16x16x32_bf16 v[32:35], a[64:67], a[24:27], v[32:35]
  s_add_u32 s51, s51, 1024
  s_add_u32 m0, s88, s28
  ds_read_b64_tr_b16 a[40:41], v20 offset:18432
  v_mfma_f32_16x16x32_bf16 v[40:43], a[64:67], a[28:31], v[40:43]
  ds_read_b64_tr_b16 a[42:43], v20 offset:20480
  ds_read_b128 a[4:7], v16 offset:2048
  v_mfma_f32_16x16x32_bf16 v[48:51], a[64:67], a[32:35], v[48:51]
  buffer_load_dwordx4 v14, s[8:11], s30 offen offset:0 lds
  ds_read_b128 a[8:11], v16 offset:4096
  v_mfma_f32_16x16x32_bf16 v[28:31], a[68:71], a[20:23], v[28:31]
  s_mov_b32 m0, s88
  ds_read_b128 a[12:15], v16 offset:6144
  v_mfma_f32_16x16x32_bf16 v[36:39], a[68:71], a[24:27], v[36:39]
  ds_read_b64_tr_b16 a[44:45], v21 offset:18432
  v_mfma_f32_16x16x32_bf16 v[44:47], a[68:71], a[28:31], v[44:47]
  ds_read_b64_tr_b16 a[46:47], v21 offset:20480
  v_mfma_f32_16x16x32_bf16 v[52:55], a[68:71], a[32:35], v[52:55]
  buffer_load_dwordx4 v4, s[8:11], s30 offen offset:0 lds
  ds_read_b64_tr_b16 a[48:49], v20 offset:26624
  v_mfma_f32_16x16x32_bf16 v[56:59], a[72:75], a[20:23], v[56:59]
  ds_read_b64_tr_b16 a[50:51], v20 offset:28672
  v_mfma_f32_16x16x32_bf16 v[64:67], a[72:75], a[24:27], v[64:67]
  ds_read_b128 a[16:19], v18 offset:0
  v_mfma_f32_16x16x32_bf16 v[72:75], a[72:75], a[28:31], v[72:75]
  buffer_load_dwordx4 v5, s[8:11], s30 offen offset:1024 lds
  ds_read_b64_tr_b16 a[52:53], v21 offset:26624
  v_mfma_f32_16x16x32_bf16 v[80:83], a[72:75], a[32:35], v[80:83]
  ds_read_b64_tr_b16 a[54:55], v21 offset:28672
  v_mfma_f32_16x16x32_bf16 v[120:123], a[72:75], a[36:39], v[120:123]
  ds_read_b64_tr_b16 a[56:57], v20 offset:34816
  v_mfma_f32_16x16x32_bf16 v[60:63], a[76:79], a[20:23], v[60:63]
  ds_read_b64_tr_b16 a[58:59], v20 offset:36864
  v_mfma_f32_16x16x32_bf16 v[68:71], a[76:79], a[24:27], v[68:71]
  buffer_load_dwordx4 v6, s[8:11], s30 offen offset:2048 lds
  ds_read_b64_tr_b16 a[60:61], v21 offset:34816
  v_mfma_f32_16x16x32_bf16 v[76:79], a[76:79], a[28:31], v[76:79]
  ds_read_b64_tr_b16 a[62:63], v21 offset:36864
  v_mfma_f32_16x16x32_bf16 v[84:87], a[76:79], a[32:35], v[84:87]
  v_mfma_f32_16x16x32_bf16 v[124:127], a[76:79], a[36:39], v[124:127]
  buffer_load_dwordx4 v7, s[8:11], s30 offen offset:3072 lds
  v_mfma_f32_16x16x32_bf16 v[88:91], a[20:23], a[80:83], v[88:91]
  s_mul_i32 s31, s0, 393216
  s_bfe_u32 s29, 0x302010e, s1
  s_add_u32 s0, s0, s29
  v_mfma_f32_16x16x32_bf16 v[96:99], a[24:27], a[80:83], v[96:99]
  s_add_u32 s1, s1, 8
  s_and_b32 s1, s1, 0x8001f
  s_and_b32 s0, s0, 15
  v_mfma_f32_16x16x32_bf16 v[104:107], a[28:31], a[80:83], v[104:107]
  s_lshl_b32 s30, s0, 7
  s_add_u32 m0, s88, s26
  v_mfma_f32_16x16x32_bf16 v[112:115], a[32:35], a[80:83], v[112:115]
  buffer_load_dwordx4 v8, s[20:23], s31 offen offset:0 lds
  v_mfma_f32_16x16x32_bf16 v[92:95], a[20:23], a[84:87], v[92:95]
  v_mfma_f32_16x16x32_bf16 v[100:103], a[24:27], a[84:87], v[100:103]
  v_mfma_f32_16x16x32_bf16 v[108:111], a[28:31], a[84:87], v[108:111]
  v_mfma_f32_16x16x32_bf16 v[116:119], a[32:35], a[84:87], v[116:119]
  s_waitcnt lgkmcnt(0)
  v_mfma_f32_16x16x32_bf16 v[24:27], a[40:43], a[0:3], v[24:27]
  buffer_load_dwordx4 v9, s[20:23], s31 offen offset:1024 lds
  ds_read_b128 a[20:23], v17 offset:0
  v_mfma_f32_16x16x32_bf16 v[32:35], a[40:43], a[4:7], v[32:35]
  ds_read_b64_tr_b16 a[64:65], v20 offset:22528
  ds_read_b64_tr_b16 a[66:67], v20 offset:24576
  v_mfma_f32_16x16x32_bf16 v[40:43], a[40:43], a[8:11], v[40:43]
  ds_read_b128 a[24:27], v17 offset:2048
  v_mfma_f32_16x16x32_bf16 v[48:51], a[40:43], a[12:15], v[48:51]
  buffer_load_dwordx4 v10, s[20:23], s31 offen offset:2048 lds
  ds_read_b128 a[28:31], v17 offset:4096
  v_mfma_f32_16x16x32_bf16 v[28:31], a[44:47], a[0:3], v[28:31]
  s_add_u32 m0, s88, s27
  ds_read_b128 a[32:35], v17 offset:6144
  v_mfma_f32_16x16x32_bf16 v[36:39], a[44:47], a[4:7], v[36:39]
  ds_read_b64_tr_b16 a[68:69], v21 offset:22528
  v_mfma_f32_16x16x32_bf16 v[44:47], a[44:47], a[8:11], v[44:47]
  buffer_load_dwordx4 v11, s[20:23], s31 offen offset:0 lds
  ds_read_b64_tr_b16 a[70:71], v21 offset:24576
  v_mfma_f32_16x16x32_bf16 v[52:55], a[44:47], a[12:15], v[52:55]
  ds_read_b64_tr_b16 a[72:73], v20 offset:30720
  v_mfma_f32_16x16x32_bf16 v[56:59], a[48:51], a[0:3], v[56:59]
  ds_read_b64_tr_b16 a[74:75], v20 offset:32768
  v_mfma_f32_16x16x32_bf16 v[64:67], a[48:51], a[4:7], v[64:67]
  buffer_load_dwordx4 v12, s[20:23], s31 offen offset:1024 lds
  ds_read_b128 a[36:39], v19 offset:0
  v_mfma_f32_16x16x32_bf16 v[72:75], a[48:51], a[8:11], v[72:75]
  ds_read_b64_tr_b16 a[76:77], v21 offset:30720
  v_mfma_f32_16x16x32_bf16 v[80:83], a[48:51], a[12:15], v[80:83]
  ds_read_b64_tr_b16 a[78:79], v21 offset:32768
  v_mfma_f32_16x16x32_bf16 v[120:123], a[48:51], a[16:19], v[120:123]
  buffer_load_dwordx4 v13, s[20:23], s31 offen offset:2048 lds
  ds_read_b64_tr_b16 a[80:81], v20 offset:38912
  v_mfma_f32_16x16x32_bf16 v[60:63], a[52:55], a[0:3], v[60:63]
  s_add_u32 s60, s63, 32768
  ds_read_b64_tr_b16 a[82:83], v20 offset:40960
  v_mfma_f32_16x16x32_bf16 v[68:71], a[52:55], a[4:7], v[68:71]
  ds_read_b64_tr_b16 a[84:85], v21 offset:38912
  v_mfma_f32_16x16x32_bf16 v[76:79], a[52:55], a[8:11], v[76:79]
  buffer_store_dwordx4 v[200:203], v2, s[16:19], s60 offen offset:2048 sc1
  ds_read_b64_tr_b16 a[86:87], v21 offset:40960
  v_mfma_f32_16x16x32_bf16 v[84:87], a[52:55], a[12:15], v[84:87]
  s_add_u32 s88, s88, s90
  s_add_u32 s89, s89, 1
  s_cmp_eq_u32 s89, 3
  s_cselect_b32 s89, 0, s89
  s_cselect_b32 s90, s91, s92
  v_mfma_f32_16x16x32_bf16 v[124:127], a[52:55], a[16:19], v[124:127]
  v_add_u32 v16, s90, v16
  v_add_u32 v17, s90, v17
  v_mfma_f32_16x16x32_bf16 v[88:91], a[0:3], a[56:59], v[88:91]
  v_add_u32 v18, s90, v18
  v_add_u32 v19, s90, v19
  v_mfma_f32_16x16x32_bf16 v[96:99], a[4:7], a[56:59], v[96:99]
  v_add_u32 v20, s90, v20
  v_add_u32 v21, s90, v21
  v_mfma_f32_16x16x32_bf16 v[104:107], a[8:11], a[56:59], v[104:107]
  v_mfma_f32_16x16x32_bf16 v[112:115], a[12:15], a[56:59], v[112:115]
  v_mfma_f32_16x16x32_bf16 v[92:95], a[0:3], a[60:63], v[92:95]
  v_mfma_f32_16x16x32_bf16 v[100:103], a[4:7], a[60:63], v[100:103]
  v_mfma_f32_16x16x32_bf16 v[108:111], a[8:11], a[60:63], v[108:111]
  v_mfma_f32_16x16x32_bf16 v[116:119], a[12:15], a[60:63], v[116:119]
  s_waitcnt vmcnt(14) lgkmcnt(0)
  s_barrier
  v_mfma_f32_16x16x32_bf16 v[24:27], a[64:67], a[20:23], v[24:27]
  s_add_u32 m0, s88, s28
  ds_read_b128 a[0:3], v16 offset:0
  ds_read_b64_tr_b16 a[40:41], v20 offset:18432
  v_mfma_f32_16x16x32_bf16 v[32:35], a[64:67], a[24:27], v[32:35]
  buffer_load_dwordx4 v14, s[8:11], s30 offen offset:0 lds
  ds_read_b64_tr_b16 a[42:43], v20 offset:20480
  v_mfma_f32_16x16x32_bf16 v[40:43], a[64:67], a[28:31], v[40:43]
  s_mov_b32 m0, s88
  ds_read_b128 a[4:7], v16 offset:2048
  v_mfma_f32_16x16x32_bf16 v[48:51], a[64:67], a[32:35], v[48:51]
  ds_read_b128 a[8:11], v16 offset:4096
  v_mfma_f32_16x16x32_bf16 v[28:31], a[68:71], a[20:23], v[28:31]
  buffer_load_dwordx4 v4, s[8:11], s30 offen offset:0 lds
  ds_read_b128 a[12:15], v16 offset:6144
  v_mfma_f32_16x16x32_bf16 v[36:39], a[68:71], a[24:27], v[36:39]
  ds_read_b64_tr_b16 a[44:45], v21 offset:18432
  v_mfma_f32_16x16x32_bf16 v[44:47], a[68:71], a[28:31], v[44:47]
  ds_read_b64_tr_b16 a[46:47], v21 offset:20480
  v_mfma_f32_16x16x32_bf16 v[52:55], a[68:71], a[32:35], v[52:55]
  ds_read_b64_tr_b16 a[48:49], v20 offset:26624
  v_mfma_f32_16x16x32_bf16 v[56:59], a[72:75], a[20:23], v[56:59]
  buffer_load_dwordx4 v5, s[8:11], s30 offen offset:1024 lds
  ds_read_b64_tr_b16 a[50:51], v20 offset:28672
  v_mfma_f32_16x16x32_bf16 v[64:67], a[72:75], a[24:27], v[64:67]
  ds_read_b128 a[16:19], v18 offset:0
  v_mfma_f32_16x16x32_bf16 v[72:75], a[72:75], a[28:31], v[72:75]
  ds_read_b64_tr_b16 a[52:53], v21 offset:26624
  v_mfma_f32_16x16x32_bf16 v[80:83], a[72:75], a[32:35], v[80:83]
  ds_read_b64_tr_b16 a[54:55], v21 offset:28672
  v_mfma_f32_16x16x32_bf16 v[120:123], a[72:75], a[36:39], v[120:123]
  buffer_load_dwordx4 v6, s[8:11], s30 offen offset:2048 lds
  ds_read_b64_tr_b16 a[56:57], v20 offset:34816
  v_mfma_f32_16x16x32_bf16 v[60:63], a[76:79], a[20:23], v[60:63]
  ds_read_b64_tr_b16 a[58:59], v20 offset:36864
  v_mfma_f32_16x16x32_bf16 v[68:71], a[76:79], a[24:27], v[68:71]
  ds_read_b64_tr_b16 a[60:61], v21 offset:34816
  v_mfma_f32_16x16x32_bf16 v[76:79], a[76:79], a[28:31], v[76:79]
  ds_read_b64_tr_b16 a[62:63], v21 offset:36864
  v_mfma_f32_16x16x32_bf16 v[84:87], a[76:79], a[32:35], v[84:87]
  buffer_load_dwordx4 v7, s[8:11], s30 offen offset:3072 lds
  v_mfma_f32_16x16x32_bf16 v[124:127], a[76:79], a[36:39], v[124:127]
  s_mul_i32 s31, s0, 393216
  s_bfe_u32 s29, 0x302010e, s1
  s_add_u32 s0, s0, s29
  v_mfma_f32_16x16x32_bf16 v[88:91], a[20:23], a[80:83], v[88:91]
  s_add_u32 s1, s1, 8
  s_and_b32 s1, s1, 0x8001f
  s_and_b32 s0, s0, 15
  v_mfma_f32_16x16x32_bf16 v[96:99], a[24:27], a[80:83], v[96:99]
  s_lshl_b32 s30, s0, 7
  s_add_u32 m0, s88, s26
  v_mfma_f32_16x16x32_bf16 v[104:107], a[28:31], a[80:83], v[104:107]
  buffer_load_dwordx4 v8, s[20:23], s31 offen offset:0 lds
  v_mfma_f32_16x16x32_bf16 v[112:115], a[32:35], a[80:83], v[112:115]
  v_mfma_f32_16x16x32_bf16 v[92:95], a[20:23], a[84:87], v[92:95]
  v_mfma_f32_16x16x32_bf16 v[100:103], a[24:27], a[84:87], v[100:103]
  v_mfma_f32_16x16x32_bf16 v[108:111], a[28:31], a[84:87], v[108:111]
  v_mfma_f32_16x16x32_bf16 v[116:119], a[32:35], a[84:87], v[116:119]
  s_waitcnt lgkmcnt(0)
  v_mfma_f32_16x16x32_bf16 v[24:27], a[40:43], a[0:3], v[24:27]
  buffer_load_dwordx4 v9, s[20:23], s31 offen offset:1024 lds
  ds_read_b128 a[20:23], v17 offset:0
  v_mfma_f32_16x16x32_bf16 v[32:35], a[40:43], a[4:7], v[32:35]
  ds_read_b64_tr_b16 a[64:65], v20 offset:22528
  ds_read_b64_tr_b16 a[66:67], v20 offset:24576
  v_mfma_f32_16x16x32_bf16 v[40:43], a[40:43], a[8:11], v[40:43]
  ds_read_b128 a[24:27], v17 offset:2048
  v_mfma_f32_16x16x32_bf16 v[48:51], a[40:43], a[12:15], v[48:51]
  buffer_load_dwordx4 v10, s[20:23], s31 offen offset:2048 lds
  ds_read_b128 a[28:31], v17 offset:4096
  v_mfma_f32_16x16x32_bf16 v[28:31], a[44:47], a[0:3], v[28:31]
  s_add_u32 m0, s88, s27
  ds_read_b128 a[32:35], v17 offset:6144
  v_mfma_f32_16x16x32_bf16 v[36:39], a[44:47], a[4:7], v[36:39]
  ds_read_b64_tr_b16 a[68:69], v21 offset:22528
  v_mfma_f32_16x16x32_bf16 v[44:47], a[44:47], a[8:11], v[44:47]
  buffer_load_dwordx4 v11, s[20:23], s31 offen offset:0 lds
  ds_read_b64_tr_b16 a[70:71], v21 offset:24576
  v_mfma_f32_16x16x32_bf16 v[52:55], a[44:47], a[12:15], v[52:55]
  ds_read_b64_tr_b16 a[72:73], v20 offset:30720
  v_mfma_f32_16x16x32_bf16 v[56:59], a[48:51], a[0:3], v[56:59]
  ds_read_b64_tr_b16 a[74:75], v20 offset:32768
  v_mfma_f32_16x16x32_bf16 v[64:67], a[48:51], a[4:7], v[64:67]
  buffer_load_dwordx4 v12, s[20:23], s31 offen offset:1024 lds
  ds_read_b128 a[36:39], v19 offset:0
  v_mfma_f32_16x16x32_bf16 v[72:75], a[48:51], a[8:11], v[72:75]
  ds_read_b64_tr_b16 a[76:77], v21 offset:30720
  v_mfma_f32_16x16x32_bf16 v[80:83], a[48:51], a[12:15], v[80:83]
  ds_read_b64_tr_b16 a[78:79], v21 offset:32768
  v_mfma_f32_16x16x32_bf16 v[120:123], a[48:51], a[16:19], v[120:123]
  buffer_load_dwordx4 v13, s[20:23], s31 offen offset:2048 lds
  ds_read_b64_tr_b16 a[80:81], v20 offset:38912
  v_mfma_f32_16x16x32_bf16 v[60:63], a[52:55], a[0:3], v[60:63]
  s_add_u32 s60, s63, 0
  ds_read_b64_tr_b16 a[82:83], v20 offset:40960
  v_mfma_f32_16x16x32_bf16 v[68:71], a[52:55], a[4:7], v[68:71]
  ds_read_b64_tr_b16 a[84:85], v21 offset:38912
  v_mfma_f32_16x16x32_bf16 v[76:79], a[52:55], a[8:11], v[76:79]
  buffer_store_dwordx4 v[160:163], v2, s[16:19], s60 offen offset:0 sc1
  ds_read_b64_tr_b16 a[86:87], v21 offset:40960
  v_mfma_f32_16x16x32_bf16 v[84:87], a[52:55], a[12:15], v[84:87]
  s_add_u32 s88, s88, s90
  s_add_u32 s89, s89, 1
  s_cmp_eq_u32 s89, 3
  s_cselect_b32 s89, 0, s89
  s_cselect_b32 s90, s91, s92
  v_mfma_f32_16x16x32_bf16 v[124:127], a[52:55], a[16:19], v[124:127]
  v_add_u32 v16, s90, v16
  v_add_u32 v17, s90, v17
  v_mfma_f32_16x16x32_bf16 v[88:91], a[0:3], a[56:59], v[88:91]
  v_add_u32 v18, s90, v18
  v_add_u32 v19, s90, v19
  v_mfma_f32_16x16x32_bf16 v[96:99], a[4:7], a[56:59], v[96:99]
  v_add_u32 v20, s90, v20
  v_add_u32 v21, s90, v21
  v_mfma_f32_16x16x32_bf16 v[104:107], a[8:11], a[56:59], v[104:107]
  v_mfma_f32_16x16x32_bf16 v[112:115], a[12:15], a[56:59], v[112:115]
  v_mfma_f32_16x16x32_bf16 v[92:95], a[0:3], a[60:63], v[92:95]
  v_mfma_f32_16x16x32_bf16 v[100:103], a[4:7], a[60:63], v[100:103]
  v_mfma_f32_16x16x32_bf16 v[108:111], a[8:11], a[60:63], v[108:111]
  v_mfma_f32_16x16x32_bf16 v[116:119], a[12:15], a[60:63], v[116:119]
  s_waitcnt vmcnt(13) lgkmcnt(0)
  s_barrier
  v_mfma_f32_16x16x32_bf16 v[24:27], a[64:67], a[20:23], v[24:27]
  s_add_u32 m0, s88, s28
  ds_read_b128 a[0:3], v16 offset:0
  ds_read_b64_tr_b16 a[40:41], v20 offset:18432
  v_mfma_f32_16x16x32_bf16 v[32:35], a[64:67], a[24:27], v[32:35]
  buffer_load_dwordx4 v14, s[8:11], s30 offen offset:0 lds
  ds_read_b64_tr_b16 a[42:43], v20 offset:20480
  v_mfma_f32_16x16x32_bf16 v[40:43], a[64:67], a[28:31], v[40:43]
  s_mov_b32 m0, s88
  ds_read_b128 a[4:7], v16 offset:2048
  v_mfma_f32_16x16x32_bf16 v[48:51], a[64:67], a[32:35], v[48:51]
  ds_read_b128 a[8:11], v16 offset:4096
  v_mfma_f32_16x16x32_bf16 v[28:31], a[68:71], a[20:23], v[28:31]
  buffer_load_dwordx4 v4, s[8:11], s30 offen offset:0 lds
  ds_read_b128 a[12:15], v16 offset:6144
  v_mfma_f32_16x16x32_bf16 v[36:39], a[68:71], a[24:27], v[36:39]
  ds_read_b64_tr_b16 a[44:45], v21 offset:18432
  v_mfma_f32_16x16x32_bf16 v[44:47], a[68:71], a[28:31], v[44:47]
  ds_read_b64_tr_b16 a[46:47], v21 offset:20480
  v_mfma_f32_16x16x32_bf16 v[52:55], a[68:71], a[32:35], v[52:55]
  ds_read_b64_tr_b16 a[48:49], v20 offset:26624
  v_mfma_f32_16x16x32_bf16 v[56:59], a[72:75], a[20:23], v[56:59]
  buffer_load_dwordx4 v5, s[8:11], s30 offen offset:1024 lds
  ds_read_b64_tr_b16 a[50:51], v20 offset:28672
  v_mfma_f32_16x16x32_bf16 v[64:67], a[72:75], a[24:27], v[64:67]
  ds_read_b128 a[16:19], v18 offset:0
  v_mfma_f32_16x16x32_bf16 v[72:75], a[72:75], a[28:31], v[72:75]
  ds_read_b64_tr_b16 a[52:53], v21 offset:26624
  v_mfma_f32_16x16x32_bf16 v[80:83], a[72:75], a[32:35], v[80:83]
  ds_read_b64_tr_b16 a[54:55], v21 offset:28672
  v_mfma_f32_16x16x32_bf16 v[120:123], a[72:75], a[36:39], v[120:123]
  buffer_load_dwordx4 v6, s[8:11], s30 offen offset:2048 lds
  ds_read_b64_tr_b16 a[56:57], v20 offset:34816
  v_mfma_f32_16x16x32_bf16 v[60:63], a[76:79], a[20:23], v[60:63]
  ds_read_b64_tr_b16 a[58:59], v20 offset:36864
  v_mfma_f32_16x16x32_bf16 v[68:71], a[76:79], a[24:27], v[68:71]
  ds_read_b64_tr_b16 a[60:61], v21 offset:34816
  v_mfma_f32_16x16x32_bf16 v[76:79], a[76:79], a[28:31], v[76:79]
  ds_read_b64_tr_b16 a[62:63], v21 offset:36864
  v_mfma_f32_16x16x32_bf16 v[84:87], a[76:79], a[32:35], v[84:87]
  buffer_load_dwordx4 v7, s[8:11], s30 offen offset:3072 lds
  v_mfma_f32_16x16x32_bf16 v[124:127], a[76:79], a[36:39], v[124:127]
  s_mul_i32 s31, s0, 393216
  s_bfe_u32 s29, 0x302010e, s1
  s_add_u32 s0, s0, s29
  v_mfma_f32_16x16x32_bf16 v[88:91], a[20:23], a[80:83], v[88:91]
  s_add_u32 s1, s1, 8
  s_and_b32 s1, s1, 0x8001f
  s_and_b32 s0, s0, 15
  v_mfma_f32_16x16x32_bf16 v[96:99], a[24:27], a[80:83], v[96:99]
  s_lshl_b32 s30, s0, 7
  s_add_u32 m0, s88, s26
  v_mfma_f32_16x16x32_bf16 v[104:107], a[28:31], a[80:83], v[104:107]
  buffer_load_dwordx4 v8, s[20:23], s31 offen offset:0 lds
  v_mfma_f32_16x16x32_bf16 v[112:115], a[32:35], a[80:83], v[112:115]
  v_mfma_f32_16x16x32_bf16 v[92:95], a[20:23], a[84:87], v[92:95]
  v_mfma_f32_16x16x32_bf16 v[100:103], a[24:27], a[84:87], v[100:103]
  v_mfma_f32_16x16x32_bf16 v[108:111], a[28:31], a[84:87], v[108:111]
  v_mfma_f32_16x16x32_bf16 v[116:119], a[32:35], a[84:87], v[116:119]
  s_waitcnt lgkmcnt(0)
  v_mfma_f32_16x16x32_bf16 v[24:27], a[40:43], a[0:3], v[24:27]
  buffer_load_dwordx4 v9, s[20:23], s31 offen offset:1024 lds
  ds_read_b128 a[20:23], v17 offset:0
  v_mfma_f32_16x16x32_bf16 v[32:35], a[40:43], a[4:7], v[32:35]
  ds_read_b64_tr_b16 a[64:65], v20 offset:22528
  ds_read_b64_tr_b16 a[66:67], v20 offset:24576
  v_mfma_f32_16x16x32_bf16 v[40:43], a[40:43], a[8:11], v[40:43]
  ds_read_b128 a[24:27], v17 offset:2048
  v_mfma_f32_16x16x32_bf16 v[48:51], a[40:43], a[12:15], v[48:51]
  buffer_load_dwordx4 v10, s[20:23], s31 offen offset:2048 lds
  ds_read_b128 a[28:31], v17 offset:4096
  v_mfma_f32_16x16x32_bf16 v[28:31], a[44:47], a[0:3], v[28:31]
  s_add_u32 m0, s88, s27
  ds_read_b128 a[32:35], v17 offset:6144
  v_mfma_f32_16x16x32_bf16 v[36:39], a[44:47], a[4:7], v[36:39]
  ds_read_b64_tr_b16 a[68:69], v21 offset:22528
  v_mfma_f32_16x16x32_bf16 v[44:47], a[44:47], a[8:11], v[44:47]
  buffer_load_dwordx4 v11, s[20:23], s31 offen offset:0 lds
  ds_read_b64_tr_b16 a[70:71], v21 offset:24576
  v_mfma_f32_16x16x32_bf16 v[52:55], a[44:47], a[12:15], v[52:55]
  ds_read_b64_tr_b16 a[72:73], v20 offset:30720
  v_mfma_f32_16x16x32_bf16 v[56:59], a[48:51], a[0:3], v[56:59]
  ds_read_b64_tr_b16 a[74:75], v20 offset:32768
  v_mfma_f32_16x16x32_bf16 v[64:67], a[48:51], a[4:7], v[64:67]
  buffer_load_dwordx4 v12, s[20:23], s31 offen offset:1024 lds
  ds_read_b128 a[36:39], v19 offset:0
  v_mfma_f32_16x16x32_bf16 v[72:75], a[48:51], a[8:11], v[72:75]
  ds_read_b64_tr_b16 a[76:77], v21 offset:30720
  v_mfma_f32_16x16x32_bf16 v[80:83], a[48:51], a[12:15], v[80:83]
  ds_read_b64_tr_b16 a[78:79], v21 offset:32768
  v_mfma_f32_16x16x32_bf16 v[120:123], a[48:51], a[16:19], v[120:123]
  buffer_load_dwordx4 v13, s[20:23], s31 offen offset:2048 lds
  ds_read_b64_tr_b16 a[80:81], v20 offset:38912
  v_mfma_f32_16x16x32_bf16 v[60:63], a[52:55], a[0:3], v[60:63]
  s_add_u32 s60, s63, 0
  ds_read_b64_tr_b16 a[82:83], v20 offset:40960
  v_mfma_f32_16x16x32_bf16 v[68:71], a[52:55], a[4:7], v[68:71]
  ds_read_b64_tr_b16 a[84:85], v21 offset:38912
  v_mfma_f32_16x16x32_bf16 v[76:79], a[52:55], a[8:11], v[76:79]
  buffer_store_dwordx4 v[164:167], v2, s[16:19], s60 offen offset:1024 sc1
  ds_read_b64_tr_b16 a[86:87], v21 offset:40960
  v_mfma_f32_16x16x32_bf16 v[84:87], a[52:55], a[12:15], v[84:87]
  s_add_u32 s88, s88, s90
  s_add_u32 s89, s89, 1
  s_cmp_eq_u32 s89, 3
  s_cselect_b32 s89, 0, s89
  s_cselect_b32 s90, s91, s92
  v_mfma_f32_16x16x32_bf16 v[124:127], a[52:55], a[16:19], v[124:127]
  v_add_u32 v16, s90, v16
  v_add_u32 v17, s90, v17
  v_mfma_f32_16x16x32_bf16 v[88:91], a[0:3], a[56:59], v[88:91]
  v_add_u32 v18, s90, v18
  v_add_u32 v19, s90, v19
  v_mfma_f32_16x16x32_bf16 v[96:99], a[4:7], a[56:59], v[96:99]
  v_add_u32 v20, s90, v20
  v_add_u32 v21, s90, v21
  v_mfma_f32_16x16x32_bf16 v[104:107], a[8:11], a[56:59], v[104:107]
  v_mfma_f32_16x16x32_bf16 v[112:115], a[12:15], a[56:59], v[112:115]
  v_mfma_f32_16x16x32_bf16 v[92:95], a[0:3], a[60:63], v[92:95]
  v_mfma_f32_16x16x32_bf16 v[100:103], a[4:7], a[60:63], v[100:103]
  v_mfma_f32_16x16x32_bf16 v[108:111], a[8:11], a[60:63], v[108:111]
  v_mfma_f32_16x16x32_bf16 v[116:119], a[12:15], a[60:63], v[116:119]
  s_waitcnt vmcnt(13) lgkmcnt(0)
  s_barrier
  v_mfma_f32_16x16x32_bf16 v[24:27], a[64:67], a[20:23], v[24:27]
  s_add_u32 m0, s88, s28
  ds_read_b128 a[0:3], v16 offset:0
  ds_read_b64_tr_b16 a[40:41], v20 offset:18432
  v_mfma_f32_16x16x32_bf16 v[32:35], a[64:67], a[24:27], v[32:35]
  buffer_load_dwordx4 v14, s[8:11], s30 offen offset:0 lds
  ds_read_b64_tr_b16 a[42:43], v20 offset:20480
  v_mfma_f32_16x16x32_bf16 v[40:43], a[64:67], a[28:31], v[40:43]
  s_mov_b32 m0, s88
  ds_read_b128 a[4:7], v16 offset:2048
  v_mfma_f32_16x16x32_bf16 v[48:51], a[64:67], a[32:35], v[48:51]
  ds_read_b128 a[8:11], v16 offset:4096
  v_mfma_f32_16x16x32_bf16 v[28:31], a[68:71], a[20:23], v[28:31]
  buffer_load_dwordx4 v4, s[8:11], s30 offen offset:0 lds
  ds_read_b128 a[12:15], v16 offset:6144
  v_mfma_f32_16x16x32_bf16 v[36:39], a[68:71], a[24:27], v[36:39]
  ds_read_b64_tr_b16 a[44:45], v21 offset:18432
  v_mfma_f32_16x16x32_bf16 v[44:47], a[68:71], a[28:31], v[44:47]
  ds_read_b64_tr_b16 a[46:47], v21 offset:20480
  v_mfma_f32_16x16x32_bf16 v[52:55], a[68:71], a[32:35], v[52:55]
  ds_read_b64_tr_b16 a[48:49], v20 offset:26624
  v_mfma_f32_16x16x32_bf16 v[56:59], a[72:75], a[20:23], v[56:59]
  buffer_load_dwordx4 v5, s[8:11], s30 offen offset:1024 lds
  ds_read_b64_tr_b16 a[50:51], v20 offset:28672
  v_mfma_f32_16x16x32_bf16 v[64:67], a[72:75], a[24:27], v[64:67]
  ds_read_b128 a[16:19], v18 offset:0
  v_mfma_f32_16x16x32_bf16 v[72:75], a[72:75], a[28:31], v[72:75]
  ds_read_b64_tr_b16 a[52:53], v21 offset:26624
  v_mfma_f32_16x16x32_bf16 v[80:83], a[72:75], a[32:35], v[80:83]
  ds_read_b64_tr_b16 a[54:55], v21 offset:28672
  v_mfma_f32_16x16x32_bf16 v[120:123], a[72:75], a[36:39], v[120:123]
  buffer_load_dwordx4 v6, s[8:11], s30 offen offset:2048 lds
  ds_read_b64_tr_b16 a[56:57], v20 offset:34816
  v_mfma_f32_16x16x32_bf16 v[60:63], a[76:79], a[20:23], v[60:63]
  ds_read_b64_tr_b16 a[58:59], v20 offset:36864
  v_mfma_f32_16x16x32_bf16 v[68:71], a[76:79], a[24:27], v[68:71]
  ds_read_b64_tr_b16 a[60:61], v21 offset:34816
  v_mfma_f32_16x16x32_bf16 v[76:79], a[76:79], a[28:31], v[76:79]
  ds_read_b64_tr_b16 a[62:63], v21 offset:36864
  v_mfma_f32_16x16x32_bf16 v[84:87], a[76:79], a[32:35], v[84:87]
  buffer_load_dwordx4 v7, s[8:11], s30 offen offset:3072 lds
  v_mfma_f32_16x16x32_bf16 v[124:127], a[76:79], a[36:39], v[124:127]
  s_mul_i32 s31, s0, 393216
  s_bfe_u32 s29, 0x302010e, s1
  s_add_u32 s0, s0, s29
  v_mfma_f32_16x16x32_bf16 v[88:91], a[20:23], a[80:83], v[88:91]
  s_add_u32 s1, s1, 8
  s_and_b32 s1, s1, 0x8001f
  s_and_b32 s0, s0, 15
  v_mfma_f32_16x16x32_bf16 v[96:99], a[24:27], a[80:83], v[96:99]
  s_lshl_b32 s30, s0, 7
  s_add_u32 m0, s88, s26
  v_mfma_f32_16x16x32_bf16 v[104:107], a[28:31], a[80:83], v[104:107]
  buffer_load_dwordx4 v8, s[20:23], s31 offen offset:0 lds
  v_mfma_f32_16x16x32_bf16 v[112:115], a[32:35], a[80:83], v[112:115]
  v_mfma_f32_16x16x32_bf16 v[92:95], a[20:23], a[84:87], v[92:95]
  v_mfma_f32_16x16x32_bf16 v[100:103], a[24:27], a[84:87], v[100:103]
  v_mfma_f32_16x16x32_bf16 v[108:111], a[28:31], a[84:87], v[108:111]
  v_mfma_f32_16x16x32_bf16 v[116:119], a[32:35], a[84:87], v[116:119]
  s_waitcnt lgkmcnt(0)
  v_mfma_f32_16x16x32_bf16 v[24:27], a[40:43], a[0:3], v[24:27]
  buffer_load_dwordx4 v9, s[20:23], s31 offen offset:1024 lds
  ds_read_b128 a[20:23], v17 offset:0
  v_mfma_f32_16x16x32_bf16 v[32:35], a[40:43], a[4:7], v[32:35]
  ds_read_b64_tr_b16 a[64:65], v20 offset:22528
  ds_read_b64_tr_b16 a[66:67], v20 offset:24576
  v_mfma_f32_16x16x32_bf16 v[40:43], a[40:43], a[8:11], v[40:43]
  ds_read_b128 a[24:27], v17 offset:2048
  v_mfma_f32_16x16x32_bf16 v[48:51], a[40:43], a[12:15], v[48:51]
  buffer_load_dwordx4 v10, s[20:23], s31 offen offset:2048 lds
  ds_read_b128 a[28:31], v17 offset:4096
  v_mfma_f32_16x16x32_bf16 v[28:31], a[44:47], a[0:3], v[28:31]
  s_add_u32 m0, s88, s27
  ds_read_b128 a[32:35], v17 offset:6144
  v_mfma_f32_16x16x32_bf16 v[36:39], a[44:47], a[4:7], v[36:39]
  ds_read_b64_tr_b16 a[68:69], v21 offset:22528
  v_mfma_f32_16x16x32_bf16 v[44:47], a[44:47], a[8:11], v[44:47]
  buffer_load_dwordx4 v11, s[20:23], s31 offen offset:0 lds
  ds_read_b64_tr_b16 a[70:71], v21 offset:24576
  v_mfma_f32_16x16x32_bf16 v[52:55], a[44:47], a[12:15], v[52:55]
  ds_read_b64_tr_b16 a[72:73], v20 offset:30720
  v_mfma_f32_16x16x32_bf16 v[56:59], a[48:51], a[0:3], v[56:59]
  ds_read_b64_tr_b16 a[74:75], v20 offset:32768
  v_mfma_f32_16x16x32_bf16 v[64:67], a[48:51], a[4:7], v[64:67]
  buffer_load_dwordx4 v12, s[20:23], s31 offen offset:1024 lds
  ds_read_b128 a[36:39], v19 offset:0
  v_mfma_f32_16x16x32_bf16 v[72:75], a[48:51], a[8:11], v[72:75]
  ds_read_b64_tr_b16 a[76:77], v21 offset:30720
  v_mfma_f32_16x16x32_bf16 v[80:83], a[48:51], a[12:15], v[80:83]
  ds_read_b64_tr_b16 a[78:79], v21 offset:32768
  v_mfma_f32_16x16x32_bf16 v[120:123], a[48:51], a[16:19], v[120:123]
  buffer_load_dwordx4 v13, s[20:23], s31 offen offset:2048 lds
  ds_read_b64_tr_b16 a[80:81], v20 offset:38912
  v_mfma_f32_16x16x32_bf16 v[60:63], a[52:55], a[0:3], v[60:63]
  s_add_u32 s60, s63, 0
  ds_read_b64_tr_b16 a[82:83], v20 offset:40960
  v_mfma_f32_16x16x32_bf16 v[68:71], a[52:55], a[4:7], v[68:71]
  ds_read_b64_tr_b16 a[84:85], v21 offset:38912
  v_mfma_f32_16x16x32_bf16 v[76:79], a[52:55], a[8:11], v[76:79]
  buffer_store_dwordx4 v[168:171], v2, s[16:19], s60 offen offset:2048 sc1
  ds_read_b64_tr_b16 a[86:87], v21 offset:40960
  v_mfma_f32_16x16x32_bf16 v[84:87], a[52:55], a[12:15], v[84:87]
  s_add_u32 s88, s88, s90
  s_add_u32 s89, s89, 1
  s_cmp_eq_u32 s89, 3
  s_cselect_b32 s89, 0, s89
  s_cselect_b32 s90, s91, s92
  v_mfma_f32_16x16x32_bf16 v[124:127], a[52:55], a[16:19], v[124:127]
  v_add_u32 v16, s90, v16
  v_add_u32 v17, s90, v17
  v_mfma_f32_16x16x32_bf16 v[88:91], a[0:3], a[56:59], v[88:91]
  v_add_u32 v18, s90, v18
  v_add_u32 v19, s90, v19
  v_mfma_f32_16x16x32_bf16 v[96:99], a[4:7], a[56:59], v[96:99]
  v_add_u32 v20, s90, v20
  v_add_u32 v21, s90, v21
  v_mfma_f32_16x16x32_bf16 v[104:107], a[8:11], a[56:59], v[104:107]
  v_mfma_f32_16x16x32_bf16 v[112:115], a[12:15], a[56:59], v[112:115]
  v_mfma_f32_16x16x32_bf16 v[92:95], a[0:3], a[60:63], v[92:95]
  v_mfma_f32_16x16x32_bf16 v[100:103], a[4:7], a[60:63], v[100:103]
  v_mfma_f32_16x16x32_bf16 v[108:111], a[8:11], a[60:63], v[108:111]
  v_mfma_f32_16x16x32_bf16 v[116:119], a[12:15], a[60:63], v[116:119]
  s_waitcnt vmcnt(13) lgkmcnt(0)
  s_barrier
  v_mfma_f32_16x16x32_bf16 v[24:27], a[64:67], a[20:23], v[24:27]
  s_add_u32 m0, s88, s28
  ds_read_b128 a[0:3], v16 offset:0
  ds_read_b64_tr_b16 a[40:41], v20 offset:18432
  v_mfma_f32_16x16x32_bf16 v[32:35], a[64:67], a[24:27], v[32:35]
  buffer_load_dwordx4 v14, s[8:11], s30 offen offset:0 lds
  ds_read_b64_tr_b16 a[42:43], v20 offset:20480
  v_mfma_f32_16x16x32_bf16 v[40:43], a[64:67], a[28:31], v[40:43]
  s_mov_b32 m0, s88
  ds_read_b128 a[4:7], v16 offset:2048
  v_mfma_f32_16x16x32_bf16 v[48:51], a[64:67], a[32:35], v[48:51]
  ds_read_b128 a[8:11], v16 offset:4096
  v_mfma_f32_16x16x32_bf16 v[28:31], a[68:71], a[20:23], v[28:31]
  buffer_load_dwordx4 v4, s[8:11], s30 offen offset:0 lds
  ds_read_b128 a[12:15], v16 offset:6144
  v_mfma_f32_16x16x32_bf16 v[36:39], a[68:71], a[24:27], v[36:39]
  ds_read_b64_tr_b16 a[44:45], v21 offset:18432
  v_mfma_f32_16x16x32_bf16 v[44:47], a[68:71], a[28:31], v[44:47]
  ds_read_b64_tr_b16 a[46:47], v21 offset:20480
  v_mfma_f32_16x16x32_bf16 v[52:55], a[68:71], a[32:35], v[52:55]
  ds_read_b64_tr_b16 a[48:49], v20 offset:26624
  v_mfma_f32_16x16x32_bf16 v[56:59], a[72:75], a[20:23], v[56:59]
  buffer_load_dwordx4 v5, s[8:11], s30 offen offset:1024 lds
  ds_read_b64_tr_b16 a[50:51], v20 offset:28672
  v_mfma_f32_16x16x32_bf16 v[64:67], a[72:75], a[24:27], v[64:67]
  ds_read_b128 a[16:19], v18 offset:0
  v_mfma_f32_16x16x32_bf16 v[72:75], a[72:75], a[28:31], v[72:75]
  ds_read_b64_tr_b16 a[52:53], v21 offset:26624
  v_mfma_f32_16x16x32_bf16 v[80:83], a[72:75], a[32:35], v[80:83]
  ds_read_b64_tr_b16 a[54:55], v21 offset:28672
  v_mfma_f32_16x16x32_bf16 v[120:123], a[72:75], a[36:39], v[120:123]
  buffer_load_dwordx4 v6, s[8:11], s30 offen offset:2048 lds
  ds_read_b64_tr_b16 a[56:57], v20 offset:34816
  v_mfma_f32_16x16x32_bf16 v[60:63], a[76:79], a[20:23], v[60:63]
  ds_read_b64_tr_b16 a[58:59], v20 offset:36864
  v_mfma_f32_16x16x32_bf16 v[68:71], a[76:79], a[24:27], v[68:71]
  ds_read_b64_tr_b16 a[60:61], v21 offset:34816
  v_mfma_f32_16x16x32_bf16 v[76:79], a[76:79], a[28:31], v[76:79]
  ds_read_b64_tr_b16 a[62:63], v21 offset:36864
  v_mfma_f32_16x16x32_bf16 v[84:87], a[76:79], a[32:35], v[84:87]
  buffer_load_dwordx4 v7, s[8:11], s30 offen offset:3072 lds
  v_mfma_f32_16x16x32_bf16 v[124:127], a[76:79], a[36:39], v[124:127]
  s_mul_i32 s31, s0, 393216
  s_bfe_u32 s29, 0x302010e, s1
  s_add_u32 s0, s0, s29
  v_mfma_f32_16x16x32_bf16 v[88:91], a[20:23], a[80:83], v[88:91]
  s_add_u32 s1, s1, 8
  s_and_b32 s1, s1, 0x8001f
  s_and_b32 s0, s0, 15
  v_mfma_f32_16x16x32_bf16 v[96:99], a[24:27], a[80:83], v[96:99]
  s_lshl_b32 s30, s0, 7
  s_add_u32 m0, s88, s26
  v_mfma_f32_16x16x32_bf16 v[104:107], a[28:31], a[80:83], v[104:107]
  buffer_load_dwordx4 v8, s[20:23], s31 offen offset:0 lds
  v_mfma_f32_16x16x32_bf16 v[112:115], a[32:35], a[80:83], v[112:115]
  v_mfma_f32_16x16x32_bf16 v[92:95], a[20:23], a[84:87], v[92:95]
  v_mfma_f32_16x16x32_bf16 v[100:103], a[24:27], a[84:87], v[100:103]
  v_mfma_f32_16x16x32_bf16 v[108:111], a[28:31], a[84:87], v[108:111]
  v_mfma_f32_16x16x32_bf16 v[116:119], a[32:35], a[84:87], v[116:119]
  s_waitcnt lgkmcnt(0)
  v_mfma_f32_16x16x32_bf16 v[24:27], a[40:43], a[0:3], v[24:27]
  buffer_load_dwordx4 v9, s[20:23], s31 offen offset:1024 lds
  ds_read_b128 a[20:23], v17 offset:0
  v_mfma_f32_16x16x32_bf16 v[32:35], a[40:43], a[4:7], v[32:35]
  ds_read_b64_tr_b16 a[64:65], v20 offset:22528
  ds_read_b64_tr_b16 a[66:67], v20 offset:24576
  v_mfma_f32_16x16x32_bf16 v[40:43], a[40:43], a[8:11], v[40:43]
  ds_read_b128 a[24:27], v17 offset:2048
  v_mfma_f32_16x16x32_bf16 v[48:51], a[40:43], a[12:15], v[48:51]
  buffer_load_dwordx4 v10, s[20:23], s31 offen offset:2048 lds
  ds_read_b128 a[28:31], v17 offset:4096
  v_mfma_f32_16x16x32_bf16 v[28:31], a[44:47], a[0:3], v[28:31]
  s_add_u32 m0, s88, s27
  ds_read_b128 a[32:35], v17 offset:6144
  v_mfma_f32_16x16x32_bf16 v[36:39], a[44:47], a[4:7], v[36:39]
  ds_read_b64_tr_b16 a[68:69], v21 offset:22528
  v_mfma_f32_16x16x32_bf16 v[44:47], a[44:47], a[8:11], v[44:47]
  buffer_load_dwordx4 v11, s[20:23], s31 offen offset:0 lds
  ds_read_b64_tr_b16 a[70:71], v21 offset:24576
  v_mfma_f32_16x16x32_bf16 v[52:55], a[44:47], a[12:15], v[52:55]
  ds_read_b64_tr_b16 a[72:73], v20 offset:30720
  v_mfma_f32_16x16x32_bf16 v[56:59], a[48:51], a[0:3], v[56:59]
  ds_read_b64_tr_b16 a[74:75], v20 offset:32768
  v_mfma_f32_16x16x32_bf16 v[64:67], a[48:51], a[4:7], v[64:67]
  buffer_load_dwordx4 v12, s[20:23], s31 offen offset:1024 lds
  ds_read_b128 a[36:39], v19 offset:0
  v_mfma_f32_16x16x32_bf16 v[72:75], a[48:51], a[8:11], v[72:75]
  ds_read_b64_tr_b16 a[76:77], v21 offset:30720
  v_mfma_f32_16x16x32_bf16 v[80:83], a[48:51], a[12:15], v[80:83]
  ds_read_b64_tr_b16 a[78:79], v21 offset:32768
  v_mfma_f32_16x16x32_bf16 v[120:123], a[48:51], a[16:19], v[120:123]
  buffer_load_dwordx4 v13, s[20:23], s31 offen offset:2048 lds
  ds_read_b64_tr_b16 a[80:81], v20 offset:38912
  v_mfma_f32_16x16x32_bf16 v[60:63], a[52:55], a[0:3], v[60:63]
  s_add_u32 s60, s63, 0
  ds_read_b64_tr_b16 a[82:83], v20 offset:40960
  v_mfma_f32_16x16x32_bf16 v[68:71], a[52:55], a[4:7], v[68:71]
  ds_read_b64_tr_b16 a[84:85], v21 offset:38912
  v_mfma_f32_16x16x32_bf16 v[76:79], a[52:55], a[8:11], v[76:79]
  buffer_store_dwordx4 v[172:175], v2, s[16:19], s60 offen offset:3072 sc1
  ds_read_b64_tr_b16 a[86:87], v21 offset:40960
  v_mfma_f32_16x16x32_bf16 v[84:87], a[52:55], a[12:15], v[84:87]
  s_add_u32 s88, s88, s90
  s_add_u32 s89, s89, 1
  s_cmp_eq_u32 s89, 3
  s_cselect_b32 s89, 0, s89
  s_cselect_b32 s90, s91, s92
  v_mfma_f32_16x16x32_bf16 v[124:127], a[52:55], a[16:19], v[124:127]
  v_add_u32 v16, s90, v16
  v_add_u32 v17, s90, v17
  v_mfma_f32_16x16x32_bf16 v[88:91], a[0:3], a[56:59], v[88:91]
  v_add_u32 v18, s90, v18
  v_add_u32 v19, s90, v19
  v_mfma_f32_16x16x32_bf16 v[96:99], a[4:7], a[56:59], v[96:99]
  v_add_u32 v20, s90, v20
  v_add_u32 v21, s90, v21
  v_mfma_f32_16x16x32_bf16 v[104:107], a[8:11], a[56:59], v[104:107]
  v_mfma_f32_16x16x32_bf16 v[112:115], a[12:15], a[56:59], v[112:115]
  v_mfma_f32_16x16x32_bf16 v[92:95], a[0:3], a[60:63], v[92:95]
  v_mfma_f32_16x16x32_bf16 v[100:103], a[4:7], a[60:63], v[100:103]
  v_mfma_f32_16x16x32_bf16 v[108:111], a[8:11], a[60:63], v[108:111]
  v_mfma_f32_16x16x32_bf16 v[116:119], a[12:15], a[60:63], v[116:119]
  s_waitcnt vmcnt(13) lgkmcnt(0)
  s_barrier
  v_mfma_f32_16x16x32_bf16 v[24:27], a[64:67], a[20:23], v[24:27]
  s_add_u32 m0, s88, s28
  ds_read_b128 a[0:3], v16 offset:0
  ds_read_b64_tr_b16 a[40:41], v20 offset:18432
  v_mfma_f32_16x16x32_bf16 v[32:35], a[64:67], a[24:27], v[32:35]
  buffer_load_dwordx4 v14, s[8:11], s30 offen offset:0 lds
  ds_read_b64_tr_b16 a[42:43], v20 offset:20480
  v_mfma_f32_16x16x32_bf16 v[40:43], a[64:67], a[28:31], v[40:43]
  s_mov_b32 m0, s88
  ds_read_b128 a[4:7], v16 offset:2048
  v_mfma_f32_16x16x32_bf16 v[48:51], a[64:67], a[32:35], v[48:51]
  buffer_load_dwordx4 v4, s[8:11], s30 offen offset:0 lds
  ds_read_b128 a[8:11], v16 offset:4096
  v_mfma_f32_16x16x32_bf16 v[28:31], a[68:71], a[20:23], v[28:31]
  ds_read_b128 a[12:15], v16 offset:6144
  v_mfma_f32_16x16x32_bf16 v[36:39], a[68:71], a[24:27], v[36:39]
  ds_read_b64_tr_b16 a[44:45], v21 offset:18432
  v_mfma_f32_16x16x32_bf16 v[44:47], a[68:71], a[28:31], v[44:47]
  ds_read_b64_tr_b16 a[46:47], v21 offset:20480
  v_mfma_f32_16x16x32_bf16 v[52:55], a[68:71], a[32:35], v[52:55]
  buffer_load_dwordx4 v5, s[8:11], s30 offen offset:1024 lds
  ds_read_b64_tr_b16 a[48:49], v20 offset:26624
  v_mfma_f32_16x16x32_bf16 v[56:59], a[72:75], a[20:23], v[56:59]
  ds_read_b64_tr_b16 a[50:51], v20 offset:28672
  v_mfma_f32_16x16x32_bf16 v[64:67], a[72:75], a[24:27], v[64:67]
  ds_read_b128 a[16:19], v18 offset:0
  v_mfma_f32_16x16x32_bf16 v[72:75], a[72:75], a[28:31], v[72:75]
  buffer_load_dwordx4 v6, s[8:11], s30 offen offset:2048 lds
  ds_read_b64_tr_b16 a[52:53], v21 offset:26624
  v_mfma_f32_16x16x32_bf16 v[80:83], a[72:75], a[32:35], v[80:83]
  ds_read_b64_tr_b16 a[54:55], v21 offset:28672
  v_mfma_f32_16x16x32_bf16 v[120:123], a[72:75], a[36:39], v[120:123]
  ds_read_b64_tr_b16 a[56:57], v20 offset:34816
  v_mfma_f32_16x16x32_bf16 v[60:63], a[76:79], a[20:23], v[60:63]
  ds_read_b64_tr_b16 a[58:59], v20 offset:36864
  v_mfma_f32_16x16x32_bf16 v[68:71], a[76:79], a[24:27], v[68:71]
  buffer_load_dwordx4 v7, s[8:11], s30 offen offset:3072 lds
  ds_read_b64_tr_b16 a[60:61], v21 offset:34816
  v_mfma_f32_16x16x32_bf16 v[76:79], a[76:79], a[28:31], v[76:79]
  s_mul_i32 s31, s0, 393216
  s_bfe_u32 s29, 0x302010e, s1
  s_add_u32 s0, s0, s29
  v_mfma_f32_16x16x32_bf16 v[84:87], a[76:79], a[32:35], v[84:87]
  s_add_u32 s1, s1, 8
  s_and_b32 s1, s1, 0x8001f
  s_and_b32 s0, s0, 15
  v_mfma_f32_16x16x32_bf16 v[124:127], a[76:79], a[36:39], v[124:127]
  s_lshl_b32 s30, s0, 7
  s_add_u32 m0, s88, s26
  ds_read_b64_tr_b16 a[62:63], v21 offset:36864
  v_mfma_f32_16x16x32_bf16 v[88:91], a[20:23], a[80:83], v[88:91]
  buffer_load_dwordx4 v8, s[20:23], s31 offen offset:0 lds
  v_mfma_f32_16x16x32_bf16 v[96:99], a[24:27], a[80:83], v[96:99]
  v_mfma_f32_16x16x32_bf16 v[104:107], a[28:31], a[80:83], v[104:107]
  v_mfma_f32_16x16x32_bf16 v[112:115], a[32:35], a[80:83], v[112:115]
  buffer_load_dwordx4 v9, s[20:23], s31 offen offset:1024 lds
  v_mfma_f32_16x16x32_bf16 v[92:95], a[20:23], a[84:87], v[92:95]
  v_mfma_f32_16x16x32_bf16 v[100:103], a[24:27], a[84:87], v[100:103]
  v_mfma_f32_16x16x32_bf16 v[108:111], a[28:31], a[84:87], v[108:111]
  v_mfma_f32_16x16x32_bf16 v[116:119], a[32:35], a[84:87], v[116:119]
  s_waitcnt lgkmcnt(0)
  v_mfma_f32_16x16x32_bf16 v[24:27], a[40:43], a[0:3], v[24:27]
  buffer_load_dwordx4 v10, s[20:23], s31 offen offset:2048 lds
  ds_read_b128 a[20:23], v17 offset:0
  v_mfma_f32_16x16x32_bf16 v[32:35], a[40:43], a[4:7], v[32:35]
  s_add_u32 m0, s88, s27
  ds_read_b64_tr_b16 a[64:65], v20 offset:22528
  ds_read_b64_tr_b16 a[66:67], v20 offset:24576
  v_mfma_f32_16x16x32_bf16 v[40:43], a[40:43], a[8:11], v[40:43]
  ds_read_b128 a[24:27], v17 offset:2048
  v_mfma_f32_16x16x32_bf16 v[48:51], a[40:43], a[12:15], v[48:51]
  buffer_load_dwordx4 v11, s[20:23], s31 offen offset:0 lds
  ds_read_b128 a[28:31], v17 offset:4096
  v_mfma_f32_16x16x32_bf16 v[28:31], a[44:47], a[0:3], v[28:31]
  ds_read_b128 a[32:35], v17 offset:6144
  v_mfma_f32_16x16x32_bf16 v[36:39], a[44:47], a[4:7], v[36:39]
  ds_read_b64_tr_b16 a[68:69], v21 offset:22528
  v_mfma_f32_16x16x32_bf16 v[44:47], a[44:47], a[8:11], v[44:47]
  buffer_load_dwordx4 v12, s[20:23], s31 offen offset:1024 lds
  ds_read_b64_tr_b16 a[70:71], v21 offset:24576
  v_mfma_f32_16x16x32_bf16 v[52:55], a[44:47], a[12:15], v[52:55]
  ds_read_b64_tr_b16 a[72:73], v20 offset:30720
  v_mfma_f32_16x16x32_bf16 v[56:59], a[48:51], a[0:3], v[56:59]
  ds_read_b64_tr_b16 a[74:75], v20 offset:32768
  v_mfma_f32_16x16x32_bf16 v[64:67], a[48:51], a[4:7], v[64:67]
  buffer_load_dwordx4 v13, s[20:23], s31 offen offset:2048 lds
  ds_read_b128 a[36:39], v19 offset:0
  v_mfma_f32_16x16x32_bf16 v[72:75], a[48:51], a[8:11], v[72:75]
  s_add_u32 s60, s63, 4096
  ds_read_b64_tr_b16 a[76:77], v21 offset:30720
  v_mfma_f32_16x16x32_bf16 v[80:83], a[48:51], a[12:15], v[80:83]
  ds_read_b64_tr_b16 a[78:79], v21 offset:32768
  v_mfma_f32_16x16x32_bf16 v[120:123], a[48:51], a[16:19], v[120:123]
  buffer_store_dwordx4 v[176:179], v2, s[16:19], s60 offen offset:0 sc1
  ds_read_b64_tr_b16 a[80:81], v20 offset:38912
  v_mfma_f32_16x16x32_bf16 v[60:63], a[52:55], a[0:3], v[60:63]
  ds_read_b64_tr_b16 a[82:83], v20 offset:40960
  v_mfma_f32_16x16x32_bf16 v[68:71], a[52:55], a[4:7], v[68:71]
  ds_read_b64_tr_b16 a[84:85], v21 offset:38912
  v_mfma_f32_16x16x32_bf16 v[76:79], a[52:55], a[8:11], v[76:79]
  buffer_store_dwordx4 v[180:183], v2, s[16:19], s60 offen offset:1024 sc1
  ds_read_b64_tr_b16 a[86:87], v21 offset:40960
  v_mfma_f32_16x16x32_bf16 v[84:87], a[52:55], a[12:15], v[84:87]
  s_add_u32 s88, s88, s90
  s_add_u32 s89, s89, 1
  s_cmp_eq_u32 s89, 3
  s_cselect_b32 s89, 0, s89
  s_cselect_b32 s90, s91, s92
  v_mfma_f32_16x16x32_bf16 v[124:127], a[52:55], a[16:19], v[124:127]
  v_add_u32 v16, s90, v16
  v_add_u32 v17, s90, v17
  v_mfma_f32_16x16x32_bf16 v[88:91], a[0:3], a[56:59], v[88:91]
  v_add_u32 v18, s90, v18
  v_add_u32 v19, s90, v19
  v_mfma_f32_16x16x32_bf16 v[96:99], a[4:7], a[56:59], v[96:99]
  v_add_u32 v20, s90, v20
  v_add_u32 v21, s90, v21
  v_mfma_f32_16x16x32_bf16 v[104:107], a[8:11], a[56:59], v[104:107]
  v_mfma_f32_16x16x32_bf16 v[112:115], a[12:15], a[56:59], v[112:115]
  v_mfma_f32_16x16x32_bf16 v[92:95], a[0:3], a[60:63], v[92:95]
  v_mfma_f32_16x16x32_bf16 v[100:103], a[4:7], a[60:63], v[100:103]
  v_mfma_f32_16x16x32_bf16 v[108:111], a[8:11], a[60:63], v[108:111]
  v_mfma_f32_16x16x32_bf16 v[116:119], a[12:15], a[60:63], v[116:119]
  s_waitcnt vmcnt(14) lgkmcnt(0)
  s_barrier
  v_mfma_f32_16x16x32_bf16 v[24:27], a[64:67], a[20:23], v[24:27]
  s_add_u32 m0, s88, s28
  ds_read_b128 a[0:3], v16 offset:0
  ds_read_b64_tr_b16 a[40:41], v20 offset:18432
  v_mfma_f32_16x16x32_bf16 v[32:35], a[64:67], a[24:27], v[32:35]
  buffer_load_dwordx4 v14, s[8:11], s30 offen offset:0 lds
  ds_read_b64_tr_b16 a[42:43], v20 offset:20480
  v_mfma_f32_16x16x32_bf16 v[40:43], a[64:67], a[28:31], v[40:43]
  s_mov_b32 m0, s88
  ds_read_b128 a[4:7], v16 offset:2048
  v_mfma_f32_16x16x32_bf16 v[48:51], a[64:67], a[32:35], v[48:51]
  ds_read_b128 a[8:11], v16 offset:4096
  v_mfma_f32_16x16x32_bf16 v[28:31], a[68:71], a[20:23], v[28:31]
  buffer_load_dwordx4 v4, s[8:11], s30 offen offset:0 lds
  ds_read_b128 a[12:15], v16 offset:6144
  v_mfma_f32_16x16x32_bf16 v[36:39], a[68:71], a[24:27], v[36:39]
  ds_read_b64_tr_b16 a[44:45], v21 offset:18432
  v_mfma_f32_16x16x32_bf16 v[44:47], a[68:71], a[28:31], v[44:47]
  ds_read_b64_tr_b16 a[46:47], v21 offset:20480
  v_mfma_f32_16x16x32_bf16 v[52:55], a[68:71], a[32:35], v[52:55]
  ds_read_b64_tr_b16 a[48:49], v20 offset:26624
  v_mfma_f32_16x16x32_bf16 v[56:59], a[72:75], a[20:23], v[56:59]
  buffer_load_dwordx4 v5, s[8:11], s30 offen offset:1024 lds
  ds_read_b64_tr_b16 a[50:51], v20 offset:28672
  v_mfma_f32_16x16x32_bf16 v[64:67], a[72:75], a[24:27], v[64:67]
  ds_read_b128 a[16:19], v18 offset:0
  v_mfma_f32_16x16x32_bf16 v[72:75], a[72:75], a[28:31], v[72:75]
  ds_read_b64_tr_b16 a[52:53], v21 offset:26624
  v_mfma_f32_16x16x32_bf16 v[80:83], a[72:75], a[32:35], v[80:83]
  ds_read_b64_tr_b16 a[54:55], v21 offset:28672
  v_mfma_f32_16x16x32_bf16 v[120:123], a[72:75], a[36:39], v[120:123]
  buffer_load_dwordx4 v6, s[8:11], s30 offen offset:2048 lds
  ds_read_b64_tr_b16 a[56:57], v20 offset:34816
  v_mfma_f32_16x16x32_bf16 v[60:63], a[76:79], a[20:23], v[60:63]
  ds_read_b64_tr_b16 a[58:59], v20 offset:36864
  v_mfma_f32_16x16x32_bf16 v[68:71], a[76:79], a[24:27], v[68:71]
  ds_read_b64_tr_b16 a[60:61], v21 offset:34816
  v_mfma_f32_16x16x32_bf16 v[76:79], a[76:79], a[28:31], v[76:79]
  ds_read_b64_tr_b16 a[62:63], v21 offset:36864
  v_mfma_f32_16x16x32_bf16 v[84:87], a[76:79], a[32:35], v[84:87]
  buffer_load_dwordx4 v7, s[8:11], s30 offen offset:3072 lds
  v_mfma_f32_16x16x32_bf16 v[124:127], a[76:79], a[36:39], v[124:127]
  s_mul_i32 s31, s0, 393216
  s_bfe_u32 s29, 0x302010e, s1
  s_add_u32 s0, s0, s29
  v_mfma_f32_16x16x32_bf16 v[88:91], a[20:23], a[80:83], v[88:91]
  s_add_u32 s1, s1, 8
  s_and_b32 s1, s1, 0x8001f
  s_and_b32 s0, s0, 15
  v_mfma_f32_16x16x32_bf16 v[96:99], a[24:27], a[80:83], v[96:99]
  s_lshl_b32 s30, s0, 7
  s_add_u32 m0, s88, s26
  v_mfma_f32_16x16x32_bf16 v[104:107], a[28:31], a[80:83], v[104:107]
  buffer_load_dwordx4 v8, s[20:23], s31 offen offset:0 lds
  v_mfma_f32_16x16x32_bf16 v[112:115], a[32:35], a[80:83], v[112:115]
  v_mfma_f32_16x16x32_bf16 v[92:95], a[20:23], a[84:87], v[92:95]
  v_mfma_f32_16x16x32_bf16 v[100:103], a[24:27], a[84:87], v[100:103]
  v_mfma_f32_16x16x32_bf16 v[108:111], a[28:31], a[84:87], v[108:111]
  v_mfma_f32_16x16x32_bf16 v[116:119], a[32:35], a[84:87], v[116:119]
  s_waitcnt lgkmcnt(0)
  v_mfma_f32_16x16x32_bf16 v[24:27], a[40:43], a[0:3], v[24:27]
  buffer_load_dwordx4 v9, s[20:23], s31 offen offset:1024 lds
  ds_read_b128 a[20:23], v17 offset:0
  v_mfma_f32_16x16x32_bf16 v[32:35], a[40:43], a[4:7], v[32:35]
  ds_read_b64_tr_b16 a[64:65], v20 offset:22528
  ds_read_b64_tr_b16 a[66:67], v20 offset:24576
  v_mfma_f32_16x16x32_bf16 v[40:43], a[40:43], a[8:11], v[40:43]
  ds_read_b128 a[24:27], v17 offset:2048
  v_mfma_f32_16x16x32_bf16 v[48:51], a[40:43], a[12:15], v[48:51]
  buffer_load_dwordx4 v10, s[20:23], s31 offen offset:2048 lds
  ds_read_b128 a[28:31], v17 offset:4096
  v_mfma_f32_16x16x32_bf16 v[28:31], a[44:47], a[0:3], v[28:31]
  s_add_u32 m0, s88, s27
  ds_read_b128 a[32:35], v17 offset:6144
  v_mfma_f32_16x16x32_bf16 v[36:39], a[44:47], a[4:7], v[36:39]
  ds_read_b64_tr_b16 a[68:69], v21 offset:22528
  v_mfma_f32_16x16x32_bf16 v[44:47], a[44:47], a[8:11], v[44:47]
  buffer_load_dwordx4 v11, s[20:23], s31 offen offset:0 lds
  ds_read_b64_tr_b16 a[70:71], v21 offset:24576
  v_mfma_f32_16x16x32_bf16 v[52:55], a[44:47], a[12:15], v[52:55]
  ds_read_b64_tr_b16 a[72:73], v20 offset:30720
  v_mfma_f32_16x16x32_bf16 v[56:59], a[48:51], a[0:3], v[56:59]
  ds_read_b64_tr_b16 a[74:75], v20 offset:32768
  v_mfma_f32_16x16x32_bf16 v[64:67], a[48:51], a[4:7], v[64:67]
  buffer_load_dwordx4 v12, s[20:23], s31 offen offset:1024 lds
  ds_read_b128 a[36:39], v19 offset:0
  v_mfma_f32_16x16x32_bf16 v[72:75], a[48:51], a[8:11], v[72:75]
  ds_read_b64_tr_b16 a[76:77], v21 offset:30720
  v_mfma_f32_16x16x32_bf16 v[80:83], a[48:51], a[12:15], v[80:83]
  ds_read_b64_tr_b16 a[78:79], v21 offset:32768
  v_mfma_f32_16x16x32_bf16 v[120:123], a[48:51], a[16:19], v[120:123]
  buffer_load_dwordx4 v13, s[20:23], s31 offen offset:2048 lds
  ds_read_b64_tr_b16 a[80:81], v20 offset:38912
  v_mfma_f32_16x16x32_bf16 v[60:63], a[52:55], a[0:3], v[60:63]
  s_add_u32 s60, s63, 4096
  ds_read_b64_tr_b16 a[82:83], v20 offset:40960
  v_mfma_f32_16x16x32_bf16 v[68:71], a[52:55], a[4:7], v[68:71]
  ds_read_b64_tr_b16 a[84:85], v21 offset:38912
  v_mfma_f32_16x16x32_bf16 v[76:79], a[52:55], a[8:11], v[76:79]
  buffer_store_dwordx4 v[184:187], v2, s[16:19], s60 offen offset:2048 sc1
  ds_read_b64_tr_b16 a[86:87], v21 offset:40960
  v_mfma_f32_16x16x32_bf16 v[84:87], a[52:55], a[12:15], v[84:87]
  s_add_u32 s88, s88, s90
  s_add_u32 s89, s89, 1
  s_cmp_eq_u32 s89, 3
  s_cselect_b32 s89, 0, s89
  s_cselect_b32 s90, s91, s92
  v_mfma_f32_16x16x32_bf16 v[124:127], a[52:55], a[16:19], v[124:127]
  v_add_u32 v16, s90, v16
  v_add_u32 v17, s90, v17
  v_mfma_f32_16x16x32_bf16 v[88:91], a[0:3], a[56:59], v[88:91]
  v_add_u32 v18, s90, v18
  v_add_u32 v19, s90, v19
  v_mfma_f32_16x16x32_bf16 v[96:99], a[4:7], a[56:59], v[96:99]
  v_add_u32 v20, s90, v20
  v_add_u32 v21, s90, v21
  v_mfma_f32_16x16x32_bf16 v[104:107], a[8:11], a[56:59], v[104:107]
  v_mfma_f32_16x16x32_bf16 v[112:115], a[12:15], a[56:59], v[112:115]
  v_mfma_f32_16x16x32_bf16 v[92:95], a[0:3], a[60:63], v[92:95]
  v_mfma_f32_16x16x32_bf16 v[100:103], a[4:7], a[60:63], v[100:103]
  v_mfma_f32_16x16x32_bf16 v[108:111], a[8:11], a[60:63], v[108:111]
  v_mfma_f32_16x16x32_bf16 v[116:119], a[12:15], a[60:63], v[116:119]
  s_waitcnt vmcnt(14) lgkmcnt(0)
  s_barrier
  v_mfma_f32_16x16x32_bf16 v[24:27], a[64:67], a[20:23], v[24:27]
  s_add_u32 m0, s88, s28
  ds_read_b128 a[0:3], v16 offset:0
  ds_read_b64_tr_b16 a[40:41], v20 offset:18432
  v_mfma_f32_16x16x32_bf16 v[32:35], a[64:67], a[24:27], v[32:35]
  buffer_load_dwordx4 v14, s[8:11], s30 offen offset:0 lds
  ds_read_b64_tr_b16 a[42:43], v20 offset:20480
  v_mfma_f32_16x16x32_bf16 v[40:43], a[64:67], a[28:31], v[40:43]
  s_mov_b32 m0, s88
  ds_read_b128 a[4:7], v16 offset:2048
  v_mfma_f32_16x16x32_bf16 v[48:51], a[64:67], a[32:35], v[48:51]
  ds_read_b128 a[8:11], v16 offset:4096
  v_mfma_f32_16x16x32_bf16 v[28:31], a[68:71], a[20:23], v[28:31]
  buffer_load_dwordx4 v4, s[8:11], s30 offen offset:0 lds
  ds_read_b128 a[12:15], v16 offset:6144
  v_mfma_f32_16x16x32_bf16 v[36:39], a[68:71], a[24:27], v[36:39]
  ds_read_b64_tr_b16 a[44:45], v21 offset:18432
  v_mfma_f32_16x16x32_bf16 v[44:47], a[68:71], a[28:31], v[44:47]
  ds_read_b64_tr_b16 a[46:47], v21 offset:20480
  v_mfma_f32_16x16x32_bf16 v[52:55], a[68:71], a[32:35], v[52:55]
  ds_read_b64_tr_b16 a[48:49], v20 offset:26624
  v_mfma_f32_16x16x32_bf16 v[56:59], a[72:75], a[20:23], v[56:59]
  buffer_load_dwordx4 v5, s[8:11], s30 offen offset:1024 lds
  ds_read_b64_tr_b16 a[50:51], v20 offset:28672
  v_mfma_f32_16x16x32_bf16 v[64:67], a[72:75], a[24:27], v[64:67]
  ds_read_b128 a[16:19], v18 offset:0
  v_mfma_f32_16x16x32_bf16 v[72:75], a[72:75], a[28:31], v[72:75]
  ds_read_b64_tr_b16 a[52:53], v21 offset:26624
  v_mfma_f32_16x16x32_bf16 v[80:83], a[72:75], a[32:35], v[80:83]
  ds_read_b64_tr_b16 a[54:55], v21 offset:28672
  v_mfma_f32_16x16x32_bf16 v[120:123], a[72:75], a[36:39], v[120:123]
  buffer_load_dwordx4 v6, s[8:11], s30 offen offset:2048 lds
  ds_read_b64_tr_b16 a[56:57], v20 offset:34816
  v_mfma_f32_16x16x32_bf16 v[60:63], a[76:79], a[20:23], v[60:63]
  ds_read_b64_tr_b16 a[58:59], v20 offset:36864
  v_mfma_f32_16x16x32_bf16 v[68:71], a[76:79], a[24:27], v[68:71]
  ds_read_b64_tr_b16 a[60:61], v21 offset:34816
  v_mfma_f32_16x16x32_bf16 v[76:79], a[76:79], a[28:31], v[76:79]
  ds_read_b64_tr_b16 a[62:63], v21 offset:36864
  v_mfma_f32_16x16x32_bf16 v[84:87], a[76:79], a[32:35], v[84:87]
  buffer_load_dwordx4 v7, s[8:11], s30 offen offset:3072 lds
  v_mfma_f32_16x16x32_bf16 v[124:127], a[76:79], a[36:39], v[124:127]
  s_mul_i32 s31, s0, 393216
  s_bfe_u32 s29, 0x302010e, s1
  s_add_u32 s0, s0, s29
  v_mfma_f32_16x16x32_bf16 v[88:91], a[20:23], a[80:83], v[88:91]
  s_add_u32 s1, s1, 8
  s_and_b32 s1, s1, 0x8001f
  s_and_b32 s0, s0, 15
  v_mfma_f32_16x16x32_bf16 v[96:99], a[24:27], a[80:83], v[96:99]
  s_lshl_b32 s30, s0, 7
  s_add_u32 m0, s88, s26
  v_mfma_f32_16x16x32_bf16 v[104:107], a[28:31], a[80:83], v[104:107]
  buffer_load_dwordx4 v8, s[20:23], s31 offen offset:0 lds
  v_mfma_f32_16x16x32_bf16 v[112:115], a[32:35], a[80:83], v[112:115]
  v_mfma_f32_16x16x32_bf16 v[92:95], a[20:23], a[84:87], v[92:95]
  v_mfma_f32_16x16x32_bf16 v[100:103], a[24:27], a[84:87], v[100:103]
  v_mfma_f32_16x16x32_bf16 v[108:111], a[28:31], a[84:87], v[108:111]
  v_mfma_f32_16x16x32_bf16 v[116:119], a[32:35], a[84:87], v[116:119]
  s_waitcnt lgkmcnt(0)
  v_mfma_f32_16x16x32_bf16 v[24:27], a[40:43], a[0:3], v[24:27]
  buffer_load_dwordx4 v9, s[20:23], s31 offen offset:1024 lds
  ds_read_b128 a[20:23], v17 offset:0
  v_mfma_f32_16x16x32_bf16 v[32:35], a[40:43], a[4:7], v[32:35]
  ds_read_b64_tr_b16 a[64:65], v20 offset:22528
  ds_read_b64_tr_b16 a[66:67], v20 offset:24576
  v_mfma_f32_16x16x32_bf16 v[40:43], a[40:43], a[8:11], v[40:43]
  ds_read_b128 a[24:27], v17 offset:2048
  v_mfma_f32_16x16x32_bf16 v[48:51], a[40:43], a[12:15], v[48:51]
  buffer_load_dwordx4 v10, s[20:23], s31 offen offset:2048 lds
  ds_read_b128 a[28:31], v17 offset:4096
  v_mfma_f32_16x16x32_bf16 v[28:31], a[44:47], a[0:3], v[28:31]
  s_add_u32 m0, s88, s27
  ds_read_b128 a[32:35], v17 offset:6144
  v_mfma_f32_16x16x32_bf16 v[36:39], a[44:47], a[4:7], v[36:39]
  ds_read_b64_tr_b16 a[68:69], v21 offset:22528
  v_mfma_f32_16x16x32_bf16 v[44:47], a[44:47], a[8:11], v[44:47]
  buffer_load_dwordx4 v11, s[20:23], s31 offen offset:0 lds
  ds_read_b64_tr_b16 a[70:71], v21 offset:24576
  v_mfma_f32_16x16x32_bf16 v[52:55], a[44:47], a[12:15], v[52:55]
  ds_read_b64_tr_b16 a[72:73], v20 offset:30720
  v_mfma_f32_16x16x32_bf16 v[56:59], a[48:51], a[0:3], v[56:59]
  ds_read_b64_tr_b16 a[74:75], v20 offset:32768
  v_mfma_f32_16x16x32_bf16 v[64:67], a[48:51], a[4:7], v[64:67]
  buffer_load_dwordx4 v12, s[20:23], s31 offen offset:1024 lds
  ds_read_b128 a[36:39], v19 offset:0
  v_mfma_f32_16x16x32_bf16 v[72:75], a[48:51], a[8:11], v[72:75]
  ds_read_b64_tr_b16 a[76:77], v21 offset:30720
  v_mfma_f32_16x16x32_bf16 v[80:83], a[48:51], a[12:15], v[80:83]
  ds_read_b64_tr_b16 a[78:79], v21 offset:32768
  v_mfma_f32_16x16x32_bf16 v[120:123], a[48:51], a[16:19], v[120:123]
  buffer_load_dwordx4 v13, s[20:23], s31 offen offset:2048 lds
  ds_read_b64_tr_b16 a[80:81], v20 offset:38912
  v_mfma_f32_16x16x32_bf16 v[60:63], a[52:55], a[0:3], v[60:63]
  s_add_u32 s60, s63, 4096
  ds_read_b64_tr_b16 a[82:83], v20 offset:40960
  v_mfma_f32_16x16x32_bf16 v[68:71], a[52:55], a[4:7], v[68:71]
  ds_read_b64_tr_b16 a[84:85], v21 offset:38912
  v_mfma_f32_16x16x32_bf16 v[76:79], a[52:55], a[8:11], v[76:79]
  buffer_store_dwordx4 v[188:191], v2, s[16:19], s60 offen offset:3072 sc1
  ds_read_b64_tr_b16 a[86:87], v21 offset:40960
  v_mfma_f32_16x16x32_bf16 v[84:87], a[52:55], a[12:15], v[84:87]
  s_add_u32 s88, s88, s90
  s_add_u32 s89, s89, 1
  s_cmp_eq_u32 s89, 3
  s_cselect_b32 s89, 0, s89
  s_cselect_b32 s90, s91, s92
  v_mfma_f32_16x16x32_bf16 v[124:127], a[52:55], a[16:19], v[124:127]
  v_add_u32 v16, s90, v16
  v_add_u32 v17, s90, v17
  v_mfma_f32_16x16x32_bf16 v[88:91], a[0:3], a[56:59], v[88:91]
  v_add_u32 v18, s90, v18
  v_add_u32 v19, s90, v19
  v_mfma_f32_16x16x32_bf16 v[96:99], a[4:7], a[56:59], v[96:99]
  v_add_u32 v20, s90, v20
  v_add_u32 v21, s90, v21
  v_mfma_f32_16x16x32_bf16 v[104:107], a[8:11], a[56:59], v[104:107]
  v_mfma_f32_16x16x32_bf16 v[112:115], a[12:15], a[56:59], v[112:115]
  v_mfma_f32_16x16x32_bf16 v[92:95], a[0:3], a[60:63], v[92:95]
  v_mfma_f32_16x16x32_bf16 v[100:103], a[4:7], a[60:63], v[100:103]
  v_mfma_f32_16x16x32_bf16 v[108:111], a[8:11], a[60:63], v[108:111]
  v_mfma_f32_16x16x32_bf16 v[116:119], a[12:15], a[60:63], v[116:119]
  s_waitcnt vmcnt(13) lgkmcnt(0)
  s_barrier
  v_mfma_f32_16x16x32_bf16 v[24:27], a[64:67], a[20:23], v[24:27]
  s_add_u32 m0, s88, s28
  ds_read_b128 a[0:3], v16 offset:0
  ds_read_b64_tr_b16 a[40:41], v20 offset:18432
  v_mfma_f32_16x16x32_bf16 v[32:35], a[64:67], a[24:27], v[32:35]
  buffer_load_dwordx4 v14, s[8:11], s30 offen offset:0 lds
  ds_read_b64_tr_b16 a[42:43], v20 offset:20480
  v_mfma_f32_16x16x32_bf16 v[40:43], a[64:67], a[28:31], v[40:43]
  s_mov_b32 m0, s88
  ds_read_b128 a[4:7], v16 offset:2048
  v_mfma_f32_16x16x32_bf16 v[48:51], a[64:67], a[32:35], v[48:51]
  ds_read_b128 a[8:11], v16 offset:4096
  v_mfma_f32_16x16x32_bf16 v[28:31], a[68:71], a[20:23], v[28:31]
  buffer_load_dwordx4 v4, s[8:11], s30 offen offset:0 lds
  ds_read_b128 a[12:15], v16 offset:6144
  v_mfma_f32_16x16x32_bf16 v[36:39], a[68:71], a[24:27], v[36:39]
  ds_read_b64_tr_b16 a[44:45], v21 offset:18432
  v_mfma_f32_16x16x32_bf16 v[44:47], a[68:71], a[28:31], v[44:47]
  ds_read_b64_tr_b16 a[46:47], v21 offset:20480
  v_mfma_f32_16x16x32_bf16 v[52:55], a[68:71], a[32:35], v[52:55]
  ds_read_b64_tr_b16 a[48:49], v20 offset:26624
  v_mfma_f32_16x16x32_bf16 v[56:59], a[72:75], a[20:23], v[56:59]
  buffer_load_dwordx4 v5, s[8:11], s30 offen offset:1024 lds
  ds_read_b64_tr_b16 a[50:51], v20 offset:28672
  v_mfma_f32_16x16x32_bf16 v[64:67], a[72:75], a[24:27], v[64:67]
  ds_read_b128 a[16:19], v18 offset:0
  v_mfma_f32_16x16x32_bf16 v[72:75], a[72:75], a[28:31], v[72:75]
  ds_read_b64_tr_b16 a[52:53], v21 offset:26624
  v_mfma_f32_16x16x32_bf16 v[80:83], a[72:75], a[32:35], v[80:83]
  ds_read_b64_tr_b16 a[54:55], v21 offset:28672
  v_mfma_f32_16x16x32_bf16 v[120:123], a[72:75], a[36:39], v[120:123]
  buffer_load_dwordx4 v6, s[8:11], s30 offen offset:2048 lds
  ds_read_b64_tr_b16 a[56:57], v20 offset:34816
  v_mfma_f32_16x16x32_bf16 v[60:63], a[76:79], a[20:23], v[60:63]
  ds_read_b64_tr_b16 a[58:59], v20 offset:36864
  v_mfma_f32_16x16x32_bf16 v[68:71], a[76:79], a[24:27], v[68:71]
  ds_read_b64_tr_b16 a[60:61], v21 offset:34816
  v_mfma_f32_16x16x32_bf16 v[76:79], a[76:79], a[28:31], v[76:79]
  ds_read_b64_tr_b16 a[62:63], v21 offset:36864
  v_mfma_f32_16x16x32_bf16 v[84:87], a[76:79], a[32:35], v[84:87]
  buffer_load_dwordx4 v7, s[8:11], s30 offen offset:3072 lds
  v_mfma_f32_16x16x32_bf16 v[124:127], a[76:79], a[36:39], v[124:127]
  s_mul_i32 s31, s0, 393216
  s_bfe_u32 s29, 0x302010e, s1
  s_add_u32 s0, s0, s29
  v_mfma_f32_16x16x32_bf16 v[88:91], a[20:23], a[80:83], v[88:91]
  s_add_u32 s1, s1, 8
  s_and_b32 s1, s1, 0x8001f
  s_and_b32 s0, s0, 15
  v_mfma_f32_16x16x32_bf16 v[96:99], a[24:27], a[80:83], v[96:99]
  s_lshl_b32 s30, s0, 7
  s_add_u32 m0, s88, s26
  v_mfma_f32_16x16x32_bf16 v[104:107], a[28:31], a[80:83], v[104:107]
  buffer_load_dwordx4 v8, s[20:23], s31 offen offset:0 lds
  v_mfma_f32_16x16x32_bf16 v[112:115], a[32:35], a[80:83], v[112:115]
  v_mfma_f32_16x16x32_bf16 v[92:95], a[20:23], a[84:87], v[92:95]
  v_mfma_f32_16x16x32_bf16 v[100:103], a[24:27], a[84:87], v[100:103]
  v_mfma_f32_16x16x32_bf16 v[108:111], a[28:31], a[84:87], v[108:111]
  v_mfma_f32_16x16x32_bf16 v[116:119], a[32:35], a[84:87], v[116:119]
  s_waitcnt lgkmcnt(0)
  v_mfma_f32_16x16x32_bf16 v[24:27], a[40:43], a[0:3], v[24:27]
  buffer_load_dwordx4 v9, s[20:23], s31 offen offset:1024 lds
  ds_read_b128 a[20:23], v17 offset:0
  v_mfma_f32_16x16x32_bf16 v[32:35], a[40:43], a[4:7], v[32:35]
  ds_read_b64_tr_b16 a[64:65], v20 offset:22528
  ds_read_b64_tr_b16 a[66:67], v20 offset:24576
  v_mfma_f32_16x16x32_bf16 v[40:43], a[40:43], a[8:11], v[40:43]
  ds_read_b128 a[24:27], v17 offset:2048
  v_mfma_f32_16x16x32_bf16 v[48:51], a[40:43], a[12:15], v[48:51]
  buffer_load_dwordx4 v10, s[20:23], s31 offen offset:2048 lds
  ds_read_b128 a[28:31], v17 offset:4096
  v_mfma_f32_16x16x32_bf16 v[28:31], a[44:47], a[0:3], v[28:31]
  s_add_u32 m0, s88, s27
  ds_read_b128 a[32:35], v17 offset:6144
  v_mfma_f32_16x16x32_bf16 v[36:39], a[44:47], a[4:7], v[36:39]
  ds_read_b64_tr_b16 a[68:69], v21 offset:22528
  v_mfma_f32_16x16x32_bf16 v[44:47], a[44:47], a[8:11], v[44:47]
  buffer_load_dwordx4 v11, s[20:23], s31 offen offset:0 lds
  ds_read_b64_tr_b16 a[70:71], v21 offset:24576
  v_mfma_f32_16x16x32_bf16 v[52:55], a[44:47], a[12:15], v[52:55]
  ds_read_b64_tr_b16 a[72:73], v20 offset:30720
  v_mfma_f32_16x16x32_bf16 v[56:59], a[48:51], a[0:3], v[56:59]
  ds_read_b64_tr_b16 a[74:75], v20 offset:32768
  v_mfma_f32_16x16x32_bf16 v[64:67], a[48:51], a[4:7], v[64:67]
  buffer_load_dwordx4 v12, s[20:23], s31 offen offset:1024 lds
  ds_read_b128 a[36:39], v19 offset:0
  v_mfma_f32_16x16x32_bf16 v[72:75], a[48:51], a[8:11], v[72:75]
  ds_read_b64_tr_b16 a[76:77], v21 offset:30720
  v_mfma_f32_16x16x32_bf16 v[80:83], a[48:51], a[12:15], v[80:83]
  ds_read_b64_tr_b16 a[78:79], v21 offset:32768
  v_mfma_f32_16x16x32_bf16 v[120:123], a[48:51], a[16:19], v[120:123]
  buffer_load_dwordx4 v13, s[20:23], s31 offen offset:2048 lds
  ds_read_b64_tr_b16 a[80:81], v20 offset:38912
  v_mfma_f32_16x16x32_bf16 v[60:63], a[52:55], a[0:3], v[60:63]
  s_add_u32 s60, s63, 32768
  ds_read_b64_tr_b16 a[82:83], v20 offset:40960
  v_mfma_f32_16x16x32_bf16 v[68:71], a[52:55], a[4:7], v[68:71]
  ds_read_b64_tr_b16 a[84:85], v21 offset:38912
  v_mfma_f32_16x16x32_bf16 v[76:79], a[52:55], a[8:11], v[76:79]
  buffer_store_dwordx4 v[204:207], v2, s[16:19], s60 offen offset:3072 sc1
  ds_read_b64_tr_b16 a[86:87], v21 offset:40960
  v_mfma_f32_16x16x32_bf16 v[84:87], a[52:55], a[12:15], v[84:87]
  s_add_u32 s88, s88, s90
  s_add_u32 s89, s89, 1
  s_cmp_eq_u32 s89, 3
  s_cselect_b32 s89, 0, s89
  s_cselect_b32 s90, s91, s92
  v_mfma_f32_16x16x32_bf16 v[124:127], a[52:55], a[16:19], v[124:127]
  v_add_u32 v16, s90, v16
  v_add_u32 v17, s90, v17
  v_mfma_f32_16x16x32_bf16 v[88:91], a[0:3], a[56:59], v[88:91]
  v_add_u32 v18, s90, v18
  v_add_u32 v19, s90, v19
  v_mfma_f32_16x16x32_bf16 v[96:99], a[4:7], a[56:59], v[96:99]
  v_add_u32 v20, s90, v20
  v_add_u32 v21, s90, v21
  v_mfma_f32_16x16x32_bf16 v[104:107], a[8:11], a[56:59], v[104:107]
  v_mfma_f32_16x16x32_bf16 v[112:115], a[12:15], a[56:59], v[112:115]
  v_mfma_f32_16x16x32_bf16 v[92:95], a[0:3], a[60:63], v[92:95]
  v_mfma_f32_16x16x32_bf16 v[100:103], a[4:7], a[60:63], v[100:103]
  v_mfma_f32_16x16x32_bf16 v[108:111], a[8:11], a[60:63], v[108:111]
  v_mfma_f32_16x16x32_bf16 v[116:119], a[12:15], a[60:63], v[116:119]
  s_waitcnt vmcnt(13) lgkmcnt(0)
  s_barrier
  v_mfma_f32_16x16x32_bf16 v[24:27], a[64:67], a[20:23], v[24:27]
  s_add_u32 m0, s88, s28
  ds_read_b128 a[0:3], v16 offset:0
  ds_read_b64_tr_b16 a[40:41], v20 offset:18432
  v_mfma_f32_16x16x32_bf16 v[32:35], a[64:67], a[24:27], v[32:35]
  buffer_load_dwordx4 v14, s[8:11], s30 offen offset:0 lds
  ds_read_b64_tr_b16 a[42:43], v20 offset:20480
  v_mfma_f32_16x16x32_bf16 v[40:43], a[64:67], a[28:31], v[40:43]
  s_mov_b32 m0, s88
  ds_read_b128 a[4:7], v16 offset:2048
  v_mfma_f32_16x16x32_bf16 v[48:51], a[64:67], a[32:35], v[48:51]
  ds_read_b128 a[8:11], v16 offset:4096
  v_mfma_f32_16x16x32_bf16 v[28:31], a[68:71], a[20:23], v[28:31]
  buffer_load_dwordx4 v4, s[8:11], s30 offen offset:0 lds
  ds_read_b128 a[12:15], v16 offset:6144
  v_mfma_f32_16x16x32_bf16 v[36:39], a[68:71], a[24:27], v[36:39]
  ds_read_b64_tr_b16 a[44:45], v21 offset:18432
  v_mfma_f32_16x16x32_bf16 v[44:47], a[68:71], a[28:31], v[44:47]
  ds_read_b64_tr_b16 a[46:47], v21 offset:20480
  v_mfma_f32_16x16x32_bf16 v[52:55], a[68:71], a[32:35], v[52:55]
  ds_read_b64_tr_b16 a[48:49], v20 offset:26624
  v_mfma_f32_16x16x32_bf16 v[56:59], a[72:75], a[20:23], v[56:59]
  buffer_load_dwordx4 v5, s[8:11], s30 offen offset:1024 lds
  ds_read_b64_tr_b16 a[50:51], v20 offset:28672
  v_mfma_f32_16x16x32_bf16 v[64:67], a[72:75], a[24:27], v[64:67]
  ds_read_b128 a[16:19], v18 offset:0
  v_mfma_f32_16x16x32_bf16 v[72:75], a[72:75], a[28:31], v[72:75]
  ds_read_b64_tr_b16 a[52:53], v21 offset:26624
  v_mfma_f32_16x16x32_bf16 v[80:83], a[72:75], a[32:35], v[80:83]
  ds_read_b64_tr_b16 a[54:55], v21 offset:28672
  v_mfma_f32_16x16x32_bf16 v[120:123], a[72:75], a[36:39], v[120:123]
  buffer_load_dwordx4 v6, s[8:11], s30 offen offset:2048 lds
  ds_read_b64_tr_b16 a[56:57], v20 offset:34816
  v_mfma_f32_16x16x32_bf16 v[60:63], a[76:79], a[20:23], v[60:63]
  ds_read_b64_tr_b16 a[58:59], v20 offset:36864
  v_mfma_f32_16x16x32_bf16 v[68:71], a[76:79], a[24:27], v[68:71]
  ds_read_b64_tr_b16 a[60:61], v21 offset:34816
  v_mfma_f32_16x16x32_bf16 v[76:79], a[76:79], a[28:31], v[76:79]
  ds_read_b64_tr_b16 a[62:63], v21 offset:36864
  v_mfma_f32_16x16x32_bf16 v[84:87], a[76:79], a[32:35], v[84:87]
  buffer_load_dwordx4 v7, s[8:11], s30 offen offset:3072 lds
  v_mfma_f32_16x16x32_bf16 v[124:127], a[76:79], a[36:39], v[124:127]
  s_mul_i32 s31, s0, 393216
  s_bfe_u32 s29, 0x302010e, s1
  s_add_u32 s0, s0, s29
  v_mfma_f32_16x16x32_bf16 v[88:91], a[20:23], a[80:83], v[88:91]
  s_add_u32 s1, s1, 8
  s_and_b32 s1, s1, 0x8001f
  s_and_b32 s0, s0, 15
  v_mfma_f32_16x16x32_bf16 v[96:99], a[24:27], a[80:83], v[96:99]
  s_lshl_b32 s30, s0, 7
  s_add_u32 m0, s88, s26
  v_mfma_f32_16x16x32_bf16 v[104:107], a[28:31], a[80:83], v[104:107]
  buffer_load_dwordx4 v8, s[20:23], s31 offen offset:0 lds
  v_mfma_f32_16x16x32_bf16 v[112:115], a[32:35], a[80:83], v[112:115]
  v_mfma_f32_16x16x32_bf16 v[92:95], a[20:23], a[84:87], v[92:95]
  v_mfma_f32_16x16x32_bf16 v[100:103], a[24:27], a[84:87], v[100:103]
  v_mfma_f32_16x16x32_bf16 v[108:111], a[28:31], a[84:87], v[108:111]
  v_mfma_f32_16x16x32_bf16 v[116:119], a[32:35], a[84:87], v[116:119]
  s_waitcnt lgkmcnt(0)
  v_mfma_f32_16x16x32_bf16 v[24:27], a[40:43], a[0:3], v[24:27]
  buffer_load_dwordx4 v9, s[20:23], s31 offen offset:1024 lds
  ds_read_b128 a[20:23], v17 offset:0
  v_mfma_f32_16x16x32_bf16 v[32:35], a[40:43], a[4:7], v[32:35]
  ds_read_b64_tr_b16 a[64:65], v20 offset:22528
  ds_read_b64_tr_b16 a[66:67], v20 offset:24576
  v_mfma_f32_16x16x32_bf16 v[40:43], a[40:43], a[8:11], v[40:43]
  ds_read_b128 a[24:27], v17 offset:2048
  v_mfma_f32_16x16x32_bf16 v[48:51], a[40:43], a[12:15], v[48:51]
  buffer_load_dwordx4 v10, s[20:23], s31 offen offset:2048 lds
  ds_read_b128 a[28:31], v17 offset:4096
  v_mfma_f32_16x16x32_bf16 v[28:31], a[44:47], a[0:3], v[28:31]
  s_add_u32 m0, s88, s27
  ds_read_b128 a[32:35], v17 offset:6144
  v_mfma_f32_16x16x32_bf16 v[36:39], a[44:47], a[4:7], v[36:39]
  ds_read_b64_tr_b16 a[68:69], v21 offset:22528
  v_mfma_f32_16x16x32_bf16 v[44:47], a[44:47], a[8:11], v[44:47]
  buffer_load_dwordx4 v11, s[20:23], s31 offen offset:0 lds
  ds_read_b64_tr_b16 a[70:71], v21 offset:24576
  v_mfma_f32_16x16x32_bf16 v[52:55], a[44:47], a[12:15], v[52:55]
  ds_read_b64_tr_b16 a[72:73], v20 offset:30720
  v_mfma_f32_16x16x32_bf16 v[56:59], a[48:51], a[0:3], v[56:59]
  ds_read_b64_tr_b16 a[74:75], v20 offset:32768
  v_mfma_f32_16x16x32_bf16 v[64:67], a[48:51], a[4:7], v[64:67]
  buffer_load_dwordx4 v12, s[20:23], s31 offen offset:1024 lds
  ds_read_b128 a[36:39], v19 offset:0
  v_mfma_f32_16x16x32_bf16 v[72:75], a[48:51], a[8:11], v[72:75]
  ds_read_b64_tr_b16 a[76:77], v21 offset:30720
  v_mfma_f32_16x16x32_bf16 v[80:83], a[48:51], a[12:15], v[80:83]
  ds_read_b64_tr_b16 a[78:79], v21 offset:32768
  v_mfma_f32_16x16x32_bf16 v[120:123], a[48:51], a[16:19], v[120:123]
  buffer_load_dwordx4 v13, s[20:23], s31 offen offset:2048 lds
  ds_read_b64_tr_b16 a[80:81], v20 offset:38912
  v_mfma_f32_16x16x32_bf16 v[60:63], a[52:55], a[0:3], v[60:63]
  s_add_u32 s60, s63, 36864
  ds_read_b64_tr_b16 a[82:83], v20 offset:40960
  v_mfma_f32_16x16x32_bf16 v[68:71], a[52:55], a[4:7], v[68:71]
  ds_read_b64_tr_b16 a[84:85], v21 offset:38912
  v_mfma_f32_16x16x32_bf16 v[76:79], a[52:55], a[8:11], v[76:79]
  buffer_store_dwordx4 v[208:211], v2, s[16:19], s60 offen offset:0 sc1
  ds_read_b64_tr_b16 a[86:87], v21 offset:40960
  v_mfma_f32_16x16x32_bf16 v[84:87], a[52:55], a[12:15], v[84:87]
  s_add_u32 s88, s88, s90
  s_add_u32 s89, s89, 1
  s_cmp_eq_u32 s89, 3
  s_cselect_b32 s89, 0, s89
  s_cselect_b32 s90, s91, s92
  v_mfma_f32_16x16x32_bf16 v[124:127], a[52:55], a[16:19], v[124:127]
  v_add_u32 v16, s90, v16
  v_add_u32 v17, s90, v17
  v_mfma_f32_16x16x32_bf16 v[88:91], a[0:3], a[56:59], v[88:91]
  v_add_u32 v18, s90, v18
  v_add_u32 v19, s90, v19
  v_mfma_f32_16x16x32_bf16 v[96:99], a[4:7], a[56:59], v[96:99]
  v_add_u32 v20, s90, v20
  v_add_u32 v21, s90, v21
  v_mfma_f32_16x16x32_bf16 v[104:107], a[8:11], a[56:59], v[104:107]
  v_mfma_f32_16x16x32_bf16 v[112:115], a[12:15], a[56:59], v[112:115]
  v_mfma_f32_16x16x32_bf16 v[92:95], a[0:3], a[60:63], v[92:95]
  v_mfma_f32_16x16x32_bf16 v[100:103], a[4:7], a[60:63], v[100:103]
  v_mfma_f32_16x16x32_bf16 v[108:111], a[8:11], a[60:63], v[108:111]
  v_mfma_f32_16x16x32_bf16 v[116:119], a[12:15], a[60:63], v[116:119]
  s_waitcnt vmcnt(13) lgkmcnt(0)
  s_barrier
  v_mfma_f32_16x16x32_bf16 v[24:27], a[64:67], a[20:23], v[24:27]
  s_add_u32 m0, s88, s28
  ds_read_b128 a[0:3], v16 offset:0
  ds_read_b64_tr_b16 a[40:41], v20 offset:18432
  v_mfma_f32_16x16x32_bf16 v[32:35], a[64:67], a[24:27], v[32:35]
  buffer_load_dwordx4 v14, s[8:11], s30 offen offset:0 lds
  ds_read_b64_tr_b16 a[42:43], v20 offset:20480
  v_mfma_f32_16x16x32_bf16 v[40:43], a[64:67], a[28:31], v[40:43]
  s_mov_b32 m0, s88
  ds_read_b128 a[4:7], v16 offset:2048
  v_mfma_f32_16x16x32_bf16 v[48:51], a[64:67], a[32:35], v[48:51]
  ds_read_b128 a[8:11], v16 offset:4096
  v_mfma_f32_16x16x32_bf16 v[28:31], a[68:71], a[20:23], v[28:31]
  buffer_load_dwordx4 v4, s[8:11], s30 offen offset:0 lds
  ds_read_b128 a[12:15], v16 offset:6144
  v_mfma_f32_16x16x32_bf16 v[36:39], a[68:71], a[24:27], v[36:39]
  ds_read_b64_tr_b16 a[44:45], v21 offset:18432
  v_mfma_f32_16x16x32_bf16 v[44:47], a[68:71], a[28:31], v[44:47]
  ds_read_b64_tr_b16 a[46:47], v21 offset:20480
  v_mfma_f32_16x16x32_bf16 v[52:55], a[68:71], a[32:35], v[52:55]
  ds_read_b64_tr_b16 a[48:49], v20 offset:26624
  v_mfma_f32_16x16x32_bf16 v[56:59], a[72:75], a[20:23], v[56:59]
  buffer_load_dwordx4 v5, s[8:11], s30 offen offset:1024 lds
  ds_read_b64_tr_b16 a[50:51], v20 offset:28672
  v_mfma_f32_16x16x32_bf16 v[64:67], a[72:75], a[24:27], v[64:67]
  ds_read_b128 a[16:19], v18 offset:0
  v_mfma_f32_16x16x32_bf16 v[72:75], a[72:75], a[28:31], v[72:75]
  ds_read_b64_tr_b16 a[52:53], v21 offset:26624
  v_mfma_f32_16x16x32_bf16 v[80:83], a[72:75], a[32:35], v[80:83]
  ds_read_b64_tr_b16 a[54:55], v21 offset:28672
  v_mfma_f32_16x16x32_bf16 v[120:123], a[72:75], a[36:39], v[120:123]
  buffer_load_dwordx4 v6, s[8:11], s30 offen offset:2048 lds
  ds_read_b64_tr_b16 a[56:57], v20 offset:34816
  v_mfma_f32_16x16x32_bf16 v[60:63], a[76:79], a[20:23], v[60:63]
  ds_read_b64_tr_b16 a[58:59], v20 offset:36864
  v_mfma_f32_16x16x32_bf16 v[68:71], a[76:79], a[24:27], v[68:71]
  ds_read_b64_tr_b16 a[60:61], v21 offset:34816
  v_mfma_f32_16x16x32_bf16 v[76:79], a[76:79], a[28:31], v[76:79]
  ds_read_b64_tr_b16 a[62:63], v21 offset:36864
  v_mfma_f32_16x16x32_bf16 v[84:87], a[76:79], a[32:35], v[84:87]
  buffer_load_dwordx4 v7, s[8:11], s30 offen offset:3072 lds
  v_mfma_f32_16x16x32_bf16 v[124:127], a[76:79], a[36:39], v[124:127]
  s_mul_i32 s31, s0, 393216
  s_bfe_u32 s29, 0x302010e, s1
  s_add_u32 s0, s0, s29
  v_mfma_f32_16x16x32_bf16 v[88:91], a[20:23], a[80:83], v[88:91]
  s_add_u32 s1, s1, 8
  s_and_b32 s1, s1, 0x8001f
  s_and_b32 s0, s0, 15
  v_mfma_f32_16x16x32_bf16 v[96:99], a[24:27], a[80:83], v[96:99]
  s_lshl_b32 s30, s0, 7
  s_add_u32 m0, s88, s26
  v_mfma_f32_16x16x32_bf16 v[104:107], a[28:31], a[80:83], v[104:107]
  buffer_load_dwordx4 v8, s[20:23], s31 offen offset:0 lds
  v_mfma_f32_16x16x32_bf16 v[112:115], a[32:35], a[80:83], v[112:115]
  v_mfma_f32_16x16x32_bf16 v[92:95], a[20:23], a[84:87], v[92:95]
  v_mfma_f32_16x16x32_bf16 v[100:103], a[24:27], a[84:87], v[100:103]
  v_mfma_f32_16x16x32_bf16 v[108:111], a[28:31], a[84:87], v[108:111]
  v_mfma_f32_16x16x32_bf16 v[116:119], a[32:35], a[84:87], v[116:119]
  s_waitcnt lgkmcnt(0)
  v_mfma_f32_16x16x32_bf16 v[24:27], a[40:43], a[0:3], v[24:27]
  buffer_load_dwordx4 v9, s[20:23], s31 offen offset:1024 lds
  ds_read_b128 a[20:23], v17 offset:0
  v_mfma_f32_16x16x32_bf16 v[32:35], a[40:43], a[4:7], v[32:35]
  ds_read_b64_tr_b16 a[64:65], v20 offset:22528
  ds_read_b64_tr_b16 a[66:67], v20 offset:24576
  v_mfma_f32_16x16x32_bf16 v[40:43], a[40:43], a[8:11], v[40:43]
  ds_read_b128 a[24:27], v17 offset:2048
  v_mfma_f32_16x16x32_bf16 v[48:51], a[40:43], a[12:15], v[48:51]
  buffer_load_dwordx4 v10, s[20:23], s31 offen offset:2048 lds
  ds_read_b128 a[28:31], v17 offset:4096
  v_mfma_f32_16x16x32_bf16 v[28:31], a[44:47], a[0:3], v[28:31]
  s_add_u32 m0, s88, s27
  ds_read_b128 a[32:35], v17 offset:6144
  v_mfma_f32_16x16x32_bf16 v[36:39], a[44:47], a[4:7], v[36:39]
  ds_read_b64_tr_b16 a[68:69], v21 offset:22528
  v_mfma_f32_16x16x32_bf16 v[44:47], a[44:47], a[8:11], v[44:47]
  buffer_load_dwordx4 v11, s[20:23], s31 offen offset:0 lds
  ds_read_b64_tr_b16 a[70:71], v21 offset:24576
  v_mfma_f32_16x16x32_bf16 v[52:55], a[44:47], a[12:15], v[52:55]
  ds_read_b64_tr_b16 a[72:73], v20 offset:30720
  v_mfma_f32_16x16x32_bf16 v[56:59], a[48:51], a[0:3], v[56:59]
  ds_read_b64_tr_b16 a[74:75], v20 offset:32768
  v_mfma_f32_16x16x32_bf16 v[64:67], a[48:51], a[4:7], v[64:67]
  buffer_load_dwordx4 v12, s[20:23], s31 offen offset:1024 lds
  ds_read_b128 a[36:39], v19 offset:0
  v_mfma_f32_16x16x32_bf16 v[72:75], a[48:51], a[8:11], v[72:75]
  ds_read_b64_tr_b16 a[76:77], v21 offset:30720
  v_mfma_f32_16x16x32_bf16 v[80:83], a[48:51], a[12:15], v[80:83]
  ds_read_b64_tr_b16 a[78:79], v21 offset:32768
  v_mfma_f32_16x16x32_bf16 v[120:123], a[48:51], a[16:19], v[120:123]
  buffer_load_dwordx4 v13, s[20:23], s31 offen offset:2048 lds
  ds_read_b64_tr_b16 a[80:81], v20 offset:38912
  v_mfma_f32_16x16x32_bf16 v[60:63], a[52:55], a[0:3], v[60:63]
  s_add_u32 s60, s63, 36864
  ds_read_b64_tr_b16 a[82:83], v20 offset:40960
  v_mfma_f32_16x16x32_bf16 v[68:71], a[52:55], a[4:7], v[68:71]
  ds_read_b64_tr_b16 a[84:85], v21 offset:38912
  v_mfma_f32_16x16x32_bf16 v[76:79], a[52:55], a[8:11], v[76:79]
  buffer_store_dwordx4 v[212:215], v2, s[16:19], s60 offen offset:1024 sc1
  ds_read_b64_tr_b16 a[86:87], v21 offset:40960
  v_mfma_f32_16x16x32_bf16 v[84:87], a[52:55], a[12:15], v[84:87]
  s_add_u32 s88, s88, s90
  s_add_u32 s89, s89, 1
  s_cmp_eq_u32 s89, 3
  s_cselect_b32 s89, 0, s89
  s_cselect_b32 s90, s91, s92
  v_mfma_f32_16x16x32_bf16 v[124:127], a[52:55], a[16:19], v[124:127]
  v_add_u32 v16, s90, v16
  v_add_u32 v17, s90, v17
  v_mfma_f32_16x16x32_bf16 v[88:91], a[0:3], a[56:59], v[88:91]
  v_add_u32 v18, s90, v18
  v_add_u32 v19, s90, v19
  v_mfma_f32_16x16x32_bf16 v[96:99], a[4:7], a[56:59], v[96:99]
  v_add_u32 v20, s90, v20
  v_add_u32 v21, s90, v21
  v_mfma_f32_16x16x32_bf16 v[104:107], a[8:11], a[56:59], v[104:107]
  v_mfma_f32_16x16x32_bf16 v[112:115], a[12:15], a[56:59], v[112:115]
  v_mfma_f32_16x16x32_bf16 v[92:95], a[0:3], a[60:63], v[92:95]
  v_mfma_f32_16x16x32_bf16 v[100:103], a[4:7], a[60:63], v[100:103]
  v_mfma_f32_16x16x32_bf16 v[108:111], a[8:11], a[60:63], v[108:111]
  v_mfma_f32_16x16x32_bf16 v[116:119], a[12:15], a[60:63], v[116:119]
  s_waitcnt vmcnt(13) lgkmcnt(0)
  s_barrier
  v_mfma_f32_16x16x32_bf16 v[24:27], a[64:67], a[20:23], v[24:27]
  s_add_u32 m0, s88, s28
  ds_read_b128 a[0:3], v16 offset:0
  ds_read_b64_tr_b16 a[40:41], v20 offset:18432
  v_mfma_f32_16x16x32_bf16 v[32:35], a[64:67], a[24:27], v[32:35]
  buffer_load_dwordx4 v14, s[8:11], s30 offen offset:0 lds
  ds_read_b64_tr_b16 a[42:43], v20 offset:20480
  v_mfma_f32_16x16x32_bf16 v[40:43], a[64:67], a[28:31], v[40:43]
  s_mov_b32 m0, s88
  ds_read_b128 a[4:7], v16 offset:2048
  v_mfma_f32_16x16x32_bf16 v[48:51], a[64:67], a[32:35], v[48:51]
  ds_read_b128 a[8:11], v16 offset:4096
  v_mfma_f32_16x16x32_bf16 v[28:31], a[68:71], a[20:23], v[28:31]
  buffer_load_dwordx4 v4, s[8:11], s30 offen offset:0 lds
  ds_read_b128 a[12:15], v16 offset:6144
  v_mfma_f32_16x16x32_bf16 v[36:39], a[68:71], a[24:27], v[36:39]
  ds_read_b64_tr_b16 a[44:45], v21 offset:18432
  v_mfma_f32_16x16x32_bf16 v[44:47], a[68:71], a[28:31], v[44:47]
  ds_read_b64_tr_b16 a[46:47], v21 offset:20480
  v_mfma_f32_16x16x32_bf16 v[52:55], a[68:71], a[32:35], v[52:55]
  ds_read_b64_tr_b16 a[48:49], v20 offset:26624
  v_mfma_f32_16x16x32_bf16 v[56:59], a[72:75], a[20:23], v[56:59]
  buffer_load_dwordx4 v5, s[8:11], s30 offen offset:1024 lds
  ds_read_b64_tr_b16 a[50:51], v20 offset:28672
  v_mfma_f32_16x16x32_bf16 v[64:67], a[72:75], a[24:27], v[64:67]
  ds_read_b128 a[16:19], v18 offset:0
  v_mfma_f32_16x16x32_bf16 v[72:75], a[72:75], a[28:31], v[72:75]
  ds_read_b64_tr_b16 a[52:53], v21 offset:26624
  v_mfma_f32_16x16x32_bf16 v[80:83], a[72:75], a[32:35], v[80:83]
  ds_read_b64_tr_b16 a[54:55], v21 offset:28672
  v_mfma_f32_16x16x32_bf16 v[120:123], a[72:75], a[36:39], v[120:123]
  buffer_load_dwordx4 v6, s[8:11], s30 offen offset:2048 lds
  ds_read_b64_tr_b16 a[56:57], v20 offset:34816
  v_mfma_f32_16x16x32_bf16 v[60:63], a[76:79], a[20:23], v[60:63]
  ds_read_b64_tr_b16 a[58:59], v20 offset:36864
  v_mfma_f32_16x16x32_bf16 v[68:71], a[76:79], a[24:27], v[68:71]
  ds_read_b64_tr_b16 a[60:61], v21 offset:34816
  v_mfma_f32_16x16x32_bf16 v[76:79], a[76:79], a[28:31], v[76:79]
  ds_read_b64_tr_b16 a[62:63], v21 offset:36864
  v_mfma_f32_16x16x32_bf16 v[84:87], a[76:79], a[32:35], v[84:87]
  buffer_load_dwordx4 v7, s[8:11], s30 offen offset:3072 lds
  v_mfma_f32_16x16x32_bf16 v[124:127], a[76:79], a[36:39], v[124:127]
  s_mul_i32 s31, s0, 393216
  s_bfe_u32 s29, 0x302010e, s1
  s_add_u32 s0, s0, s29
  v_mfma_f32_16x16x32_bf16 v[88:91], a[20:23], a[80:83], v[88:91]
  s_add_u32 s1, s1, 8
  s_and_b32 s1, s1, 0x8001f
  s_and_b32 s0, s0, 15
  v_mfma_f32_16x16x32_bf16 v[96:99], a[24:27], a[80:83], v[96:99]
  s_lshl_b32 s30, s0, 7
  s_add_u32 m0, s88, s26
  v_mfma_f32_16x16x32_bf16 v[104:107], a[28:31], a[80:83], v[104:107]
  buffer_load_dwordx4 v8, s[20:23], s31 offen offset:0 lds
  v_mfma_f32_16x16x32_bf16 v[112:115], a[32:35], a[80:83], v[112:115]
  v_mfma_f32_16x16x32_bf16 v[92:95], a[20:23], a[84:87], v[92:95]
  v_mfma_f32_16x16x32_bf16 v[100:103], a[24:27], a[84:87], v[100:103]
  v_mfma_f32_16x16x32_bf16 v[108:111], a[28:31], a[84:87], v[108:111]
  v_mfma_f32_16x16x32_bf16 v[116:119], a[32:35], a[84:87], v[116:119]
  s_waitcnt lgkmcnt(0)
  v_mfma_f32_16x16x32_bf16 v[24:27], a[40:43], a[0:3], v[24:27]
  buffer_load_dwordx4 v9, s[20:23], s31 offen offset:1024 lds
  ds_read_b128 a[20:23], v17 offset:0
  v_mfma_f32_16x16x32_bf16 v[32:35], a[40:43], a[4:7], v[32:35]
  ds_read_b64_tr_b16 a[64:65], v20 offset:22528
  ds_read_b64_tr_b16 a[66:67], v20 offset:24576
  v_mfma_f32_16x16x32_bf16 v[40:43], a[40:43], a[8:11], v[40:43]
  ds_read_b128 a[24:27], v17 offset:2048
  v_mfma_f32_16x16x32_bf16 v[48:51], a[40:43], a[12:15], v[48:51]
  buffer_load_dwordx4 v10, s[20:23], s31 offen offset:2048 lds
  ds_read_b128 a[28:31], v17 offset:4096
  v_mfma_f32_16x16x32_bf16 v[28:31], a[44:47], a[0:3], v[28:31]
  s_add_u32 m0, s88, s27
  ds_read_b128 a[32:35], v17 offset:6144
  v_mfma_f32_16x16x32_bf16 v[36:39], a[44:47], a[4:7], v[36:39]
  ds_read_b64_tr_b16 a[68:69], v21 offset:22528
  v_mfma_f32_16x16x32_bf16 v[44:47], a[44:47], a[8:11], v[44:47]
  buffer_load_dwordx4 v11, s[20:23], s31 offen offset:0 lds
  ds_read_b64_tr_b16 a[70:71], v21 offset:24576
  v_mfma_f32_16x16x32_bf16 v[52:55], a[44:47], a[12:15], v[52:55]
  ds_read_b64_tr_b16 a[72:73], v20 offset:30720
  v_mfma_f32_16x16x32_bf16 v[56:59], a[48:51], a[0:3], v[56:59]
  ds_read_b64_tr_b16 a[74:75], v20 offset:32768
  v_mfma_f32_16x16x32_bf16 v[64:67], a[48:51], a[4:7], v[64:67]
  buffer_load_dwordx4 v12, s[20:23], s31 offen offset:1024 lds
  ds_read_b128 a[36:39], v19 offset:0
  v_mfma_f32_16x16x32_bf16 v[72:75], a[48:51], a[8:11], v[72:75]
  ds_read_b64_tr_b16 a[76:77], v21 offset:30720
  v_mfma_f32_16x16x32_bf16 v[80:83], a[48:51], a[12:15], v[80:83]
  ds_read_b64_tr_b16 a[78:79], v21 offset:32768
  v_mfma_f32_16x16x32_bf16 v[120:123], a[48:51], a[16:19], v[120:123]
  buffer_load_dwordx4 v13, s[20:23], s31 offen offset:2048 lds
  ds_read_b64_tr_b16 a[80:81], v20 offset:38912
  v_mfma_f32_16x16x32_bf16 v[60:63], a[52:55], a[0:3], v[60:63]
  s_add_u32 s60, s63, 36864
  ds_read_b64_tr_b16 a[82:83], v20 offset:40960
  v_mfma_f32_16x16x32_bf16 v[68:71], a[52:55], a[4:7], v[68:71]
  ds_read_b64_tr_b16 a[84:85], v21 offset:38912
  v_mfma_f32_16x16x32_bf16 v[76:79], a[52:55], a[8:11], v[76:79]
  buffer_store_dwordx4 v[216:219], v2, s[16:19], s60 offen offset:2048 sc1
  ds_read_b64_tr_b16 a[86:87], v21 offset:40960
  v_mfma_f32_16x16x32_bf16 v[84:87], a[52:55], a[12:15], v[84:87]
  s_add_u32 s88, s88, s90
  s_add_u32 s89, s89, 1
  s_cmp_eq_u32 s89, 3
  s_cselect_b32 s89, 0, s89
  s_cselect_b32 s90, s91, s92
  v_mfma_f32_16x16x32_bf16 v[124:127], a[52:55], a[16:19], v[124:127]
  v_add_u32 v16, s90, v16
  v_add_u32 v17, s90, v17
  v_mfma_f32_16x16x32_bf16 v[88:91], a[0:3], a[56:59], v[88:91]
  v_add_u32 v18, s90, v18
  v_add_u32 v19, s90, v19
  v_mfma_f32_16x16x32_bf16 v[96:99], a[4:7], a[56:59], v[96:99]
  v_add_u32 v20, s90, v20
  v_add_u32 v21, s90, v21
  v_mfma_f32_16x16x32_bf16 v[104:107], a[8:11], a[56:59], v[104:107]
  v_mfma_f32_16x16x32_bf16 v[112:115], a[12:15], a[56:59], v[112:115]
  v_mfma_f32_16x16x32_bf16 v[92:95], a[0:3], a[60:63], v[92:95]
  v_mfma_f32_16x16x32_bf16 v[100:103], a[4:7], a[60:63], v[100:103]
  v_mfma_f32_16x16x32_bf16 v[108:111], a[8:11], a[60:63], v[108:111]
  v_mfma_f32_16x16x32_bf16 v[116:119], a[12:15], a[60:63], v[116:119]
  s_waitcnt vmcnt(13) lgkmcnt(0)
  s_barrier
  v_accvgpr_read_b32 v4, a222
  v_accvgpr_read_b32 v5, a223
  v_accvgpr_read_b32 v6, a224
  v_accvgpr_read_b32 v7, a225
  v_accvgpr_read_b32 v8, a226
  v_accvgpr_read_b32 v9, a227
  v_accvgpr_read_b32 v10, a228
  v_accvgpr_read_b32 v11, a229
  s_mov_b32 s8, s64
  s_mov_b32 s9, s65
  s_mov_b32 s10, 4194304
  s_mov_b32 s11, 0x00020000
  s_mov_b32 s12, s68
  s_mov_b32 s13, s69
  s_mov_b32 s14, 8388608
  s_mov_b32 s15, 0x00020000
  s_and_b32 s4, s2, 7
  s_lshl_b32 s4, s4, 1
  s_lshr_b32 s5, s2, 6
  s_add_u32 s5, s5, s25
  s_and_b32 s53, s5, 3
  s_lshl_b32 s53, s53, 3
  s_or_b32 s53, s53, 0x80000
  s_bfe_u32 s52, 0xf0f02, s53
  s_add_u32 s52, s52, s4
  s_and_b32 s52, s52, 15
  s_mov_b32 s54, s52
  s_mov_b32 s55, s53
  s_lshl_b32 s49, s52, 7
  s_lshl_b32 s48, s54, 19
  s_lshl_b32 s50, s25, 18
  s_sub_u32 s51, 3932160, s50
  s_or_b32 s46, s50, s49
  s_or_b32 s47, s51, s49
  s_lshl_b32 s41, s3, 12
  s_lshl_b32 s36, s3, 13
  s_add_u32 s36, s36, 98304
  v_mfma_f32_16x16x32_bf16 v[24:27], a[64:67], a[20:23], v[24:27]
  s_mov_b32 m0, s41
  ds_read_b128 a[0:3], v16 offset:0
  ds_read_b64_tr_b16 a[40:41], v20 offset:18432
  v_mfma_f32_16x16x32_bf16 v[32:35], a[64:67], a[24:27], v[32:35]
  buffer_load_dwordx4 v8, s[12:15], s48 offen offset:0 lds
  ds_read_b64_tr_b16 a[42:43], v20 offset:20480
  v_mfma_f32_16x16x32_bf16 v[40:43], a[64:67], a[28:31], v[40:43]
  ds_read_b128 a[4:7], v16 offset:2048
  v_mfma_f32_16x16x32_bf16 v[48:51], a[64:67], a[32:35], v[48:51]
  ds_read_b128 a[8:11], v16 offset:4096
  v_mfma_f32_16x16x32_bf16 v[28:31], a[68:71], a[20:23], v[28:31]
  ds_read_b128 a[12:15], v16 offset:6144
  v_mfma_f32_16x16x32_bf16 v[36:39], a[68:71], a[24:27], v[36:39]
  buffer_load_dwordx4 v9, s[12:15], s48 offen offset:1024 lds
  ds_read_b64_tr_b16 a[44:45], v21 offset:18432
  v_mfma_f32_16x16x32_bf16 v[44:47], a[68:71], a[28:31], v[44:47]
  ds_read_b64_tr_b16 a[46:47], v21 offset:20480
  v_mfma_f32_16x16x32_bf16 v[52:55], a[68:71], a[32:35], v[52:55]
  ds_read_b64_tr_b16 a[48:49], v20 offset:26624
  v_mfma_f32_16x16x32_bf16 v[56:59], a[72:75], a[20:23], v[56:59]
  ds_read_b64_tr_b16 a[50:51], v20 offset:28672
  v_mfma_f32_16x16x32_bf16 v[64:67], a[72:75], a[24:27], v[64:67]
  ds_read_b128 a[16:19], v18 offset:0
  v_mfma_f32_16x16x32_bf16 v[72:75], a[72:75], a[28:31], v[72:75]
  buffer_load_dwordx4 v10, s[12:15], s48 offen offset:2048 lds
  ds_read_b64_tr_b16 a[52:53], v21 offset:26624
  v_mfma_f32_16x16x32_bf16 v[80:83], a[72:75], a[32:35], v[80:83]
  ds_read_b64_tr_b16 a[54:55], v21 offset:28672
  v_mfma_f32_16x16x32_bf16 v[120:123], a[72:75], a[36:39], v[120:123]
  ds_read_b64_tr_b16 a[56:57], v20 offset:34816
  v_mfma_f32_16x16x32_bf16 v[60:63], a[76:79], a[20:23], v[60:63]
  ds_read_b64_tr_b16 a[58:59], v20 offset:36864
  v_mfma_f32_16x16x32_bf16 v[68:71], a[76:79], a[24:27], v[68:71]
  ds_read_b64_tr_b16 a[60:61], v21 offset:34816
  v_mfma_f32_16x16x32_bf16 v[76:79], a[76:79], a[28:31], v[76:79]
  buffer_load_dwordx4 v11, s[12:15], s48 offen offset:3072 lds
  ds_read_b64_tr_b16 a[62:63], v21 offset:36864
  v_mfma_f32_16x16x32_bf16 v[84:87], a[76:79], a[32:35], v[84:87]
  s_bfe_u32 s56, 0x302010e, s55
  s_add_u32 s54, s54, s56
  s_add_u32 s55, s55, 8
  v_mfma_f32_16x16x32_bf16 v[124:127], a[76:79], a[36:39], v[124:127]
  s_and_b32 s55, s55, 0x8001f
  s_and_b32 s54, s54, 15
  s_lshl_b32 s48, s54, 19
  v_mfma_f32_16x16x32_bf16 v[88:91], a[20:23], a[80:83], v[88:91]
  s_add_u32 m0, s41, 16384
  v_mfma_f32_16x16x32_bf16 v[96:99], a[24:27], a[80:83], v[96:99]
  v_mfma_f32_16x16x32_bf16 v[104:107], a[28:31], a[80:83], v[104:107]
  buffer_load_dwordx4 v8, s[12:15], s48 offen offset:0 lds
  v_mfma_f32_16x16x32_bf16 v[112:115], a[32:35], a[80:83], v[112:115]
  v_mfma_f32_16x16x32_bf16 v[92:95], a[20:23], a[84:87], v[92:95]
  v_mfma_f32_16x16x32_bf16 v[100:103], a[24:27], a[84:87], v[100:103]
  v_mfma_f32_16x16x32_bf16 v[108:111], a[28:31], a[84:87], v[108:111]
  v_mfma_f32_16x16x32_bf16 v[116:119], a[32:35], a[84:87], v[116:119]
  s_waitcnt lgkmcnt(0)
  v_mfma_f32_16x16x32_bf16 v[24:27], a[40:43], a[0:3], v[24:27]
  buffer_load_dwordx4 v9, s[12:15], s48 offen offset:1024 lds
  ds_read_b128 a[20:23], v17 offset:0
  v_mfma_f32_16x16x32_bf16 v[32:35], a[40:43], a[4:7], v[32:35]
  ds_read_b64_tr_b16 a[64:65], v20 offset:22528
  ds_read_b64_tr_b16 a[66:67], v20 offset:24576
  v_mfma_f32_16x16x32_bf16 v[40:43], a[40:43], a[8:11], v[40:43]
  ds_read_b128 a[24:27], v17 offset:2048
  v_mfma_f32_16x16x32_bf16 v[48:51], a[40:43], a[12:15], v[48:51]
  ds_read_b128 a[28:31], v17 offset:4096
  v_mfma_f32_16x16x32_bf16 v[28:31], a[44:47], a[0:3], v[28:31]
  buffer_load_dwordx4 v10, s[12:15], s48 offen offset:2048 lds
  ds_read_b128 a[32:35], v17 offset:6144
  v_mfma_f32_16x16x32_bf16 v[36:39], a[44:47], a[4:7], v[36:39]
  ds_read_b64_tr_b16 a[68:69], v21 offset:22528
  v_mfma_f32_16x16x32_bf16 v[44:47], a[44:47], a[8:11], v[44:47]
  ds_read_b64_tr_b16 a[70:71], v21 offset:24576
  v_mfma_f32_16x16x32_bf16 v[52:55], a[44:47], a[12:15], v[52:55]
  ds_read_b64_tr_b16 a[72:73], v20 offset:30720
  v_mfma_f32_16x16x32_bf16 v[56:59], a[48:51], a[0:3], v[56:59]
  ds_read_b64_tr_b16 a[74:75], v20 offset:32768
  v_mfma_f32_16x16x32_bf16 v[64:67], a[48:51], a[4:7], v[64:67]
  buffer_load_dwordx4 v11, s[12:15], s48 offen offset:3072 lds
  ds_read_b128 a[36:39], v19 offset:0
  v_mfma_f32_16x16x32_bf16 v[72:75], a[48:51], a[8:11], v[72:75]
  s_bfe_u32 s56, 0x302010e, s55
  s_add_u32 s54, s54, s56
  s_add_u32 s55, s55, 8
  v_mfma_f32_16x16x32_bf16 v[80:83], a[48:51], a[12:15], v[80:83]
  s_and_b32 s55, s55, 0x8001f
  s_and_b32 s54, s54, 15
  s_lshl_b32 s48, s54, 19
  v_mfma_f32_16x16x32_bf16 v[120:123], a[48:51], a[16:19], v[120:123]
  s_add_u32 s60, s63, 36864
  ds_read_b64_tr_b16 a[76:77], v21 offset:30720
  ds_read_b64_tr_b16 a[78:79], v21 offset:32768
  v_mfma_f32_16x16x32_bf16 v[60:63], a[52:55], a[0:3], v[60:63]
  ds_read_b64_tr_b16 a[80:81], v20 offset:38912
  ds_read_b64_tr_b16 a[82:83], v20 offset:40960
  v_mfma_f32_16x16x32_bf16 v[68:71], a[52:55], a[4:7], v[68:71]
  buffer_store_dwordx4 v[220:223], v2, s[16:19], s60 offen offset:3072 sc1
  ds_read_b64_tr_b16 a[84:85], v21 offset:38912
  v_mfma_f32_16x16x32_bf16 v[76:79], a[52:55], a[8:11], v[76:79]
  s_add_u32 s88, s88, s90
  s_add_u32 s89, s89, 1
  ds_read_b64_tr_b16 a[86:87], v21 offset:40960
  v_mfma_f32_16x16x32_bf16 v[84:87], a[52:55], a[12:15], v[84:87]
  s_cmp_eq_u32 s89, 3
  s_cselect_b32 s89, 0, s89
  s_cselect_b32 s90, s91, s92
  v_mfma_f32_16x16x32_bf16 v[124:127], a[52:55], a[16:19], v[124:127]
  v_add_u32 v16, s90, v16
  v_add_u32 v17, s90, v17
  v_mfma_f32_16x16x32_bf16 v[88:91], a[0:3], a[56:59], v[88:91]
  v_add_u32 v18, s90, v18
  v_add_u32 v19, s90, v19
  v_mfma_f32_16x16x32_bf16 v[96:99], a[4:7], a[56:59], v[96:99]
  v_add_u32 v20, s90, v20
  v_add_u32 v21, s90, v21
  v_mfma_f32_16x16x32_bf16 v[104:107], a[8:11], a[56:59], v[104:107]
  v_mfma_f32_16x16x32_bf16 v[112:115], a[12:15], a[56:59], v[112:115]
  v_mfma_f32_16x16x32_bf16 v[92:95], a[0:3], a[60:63], v[92:95]
  v_mfma_f32_16x16x32_bf16 v[100:103], a[4:7], a[60:63], v[100:103]
  v_mfma_f32_16x16x32_bf16 v[108:111], a[8:11], a[60:63], v[108:111]
  v_mfma_f32_16x16x32_bf16 v[116:119], a[12:15], a[60:63], v[116:119]
  s_waitcnt vmcnt(10) lgkmcnt(0)
  s_barrier
  v_mfma_f32_16x16x32_bf16 v[24:27], a[64:67], a[20:23], v[24:27]
  s_mov_b32 m0, s36
  ds_read_b128 a[0:3], v16 offset:0
  ds_read_b64_tr_b16 a[40:41], v20 offset:18432
  v_mfma_f32_16x16x32_bf16 v[32:35], a[64:67], a[24:27], v[32:35]
  buffer_load_dwordx4 v4, s[8:11], s46 offen offset:0 lds
  ds_read_b64_tr_b16 a[42:43], v20 offset:20480
  v_mfma_f32_16x16x32_bf16 v[40:43], a[64:67], a[28:31], v[40:43]
  ds_read_b128 a[4:7], v16 offset:2048
  v_mfma_f32_16x16x32_bf16 v[48:51], a[64:67], a[32:35], v[48:51]
  ds_read_b128 a[8:11], v16 offset:4096
  v_mfma_f32_16x16x32_bf16 v[28:31], a[68:71], a[20:23], v[28:31]
  ds_read_b128 a[12:15], v16 offset:6144
  v_mfma_f32_16x16x32_bf16 v[36:39], a[68:71], a[24:27], v[36:39]
  buffer_load_dwordx4 v5, s[8:11], s46 offen offset:1024 lds
  ds_read_b64_tr_b16 a[44:45], v21 offset:18432
  v_mfma_f32_16x16x32_bf16 v[44:47], a[68:71], a[28:31], v[44:47]
  ds_read_b64_tr_b16 a[46:47], v21 offset:20480
  v_mfma_f32_16x16x32_bf16 v[52:55], a[68:71], a[32:35], v[52:55]
  ds_read_b64_tr_b16 a[48:49], v20 offset:26624
  v_mfma_f32_16x16x32_bf16 v[56:59], a[72:75], a[20:23], v[56:59]
  ds_read_b64_tr_b16 a[50:51], v20 offset:28672
  v_mfma_f32_16x16x32_bf16 v[64:67], a[72:75], a[24:27], v[64:67]
  ds_read_b128 a[16:19], v18 offset:0
  v_mfma_f32_16x16x32_bf16 v[72:75], a[72:75], a[28:31], v[72:75]
  buffer_load_dwordx4 v6, s[8:11], s46 offen offset:2048 lds
  ds_read_b64_tr_b16 a[52:53], v21 offset:26624
  v_mfma_f32_16x16x32_bf16 v[80:83], a[72:75], a[32:35], v[80:83]
  ds_read_b64_tr_b16 a[54:55], v21 offset:28672
  v_mfma_f32_16x16x32_bf16 v[120:123], a[72:75], a[36:39], v[120:123]
  ds_read_b64_tr_b16 a[56:57], v20 offset:34816
  v_mfma_f32_16x16x32_bf16 v[60:63], a[76:79], a[20:23], v[60:63]
  ds_read_b64_tr_b16 a[58:59], v20 offset:36864
  v_mfma_f32_16x16x32_bf16 v[68:71], a[76:79], a[24:27], v[68:71]
  ds_read_b64_tr_b16 a[60:61], v21 offset:34816
  v_mfma_f32_16x16x32_bf16 v[76:79], a[76:79], a[28:31], v[76:79]
  buffer_load_dwordx4 v7, s[8:11], s46 offen offset:3072 lds
  ds_read_b64_tr_b16 a[62:63], v21 offset:36864
  v_mfma_f32_16x16x32_bf16 v[84:87], a[76:79], a[32:35], v[84:87]
  s_add_u32 m0, s36, 4096
  v_mfma_f32_16x16x32_bf16 v[124:127], a[76:79], a[36:39], v[124:127]
  v_mfma_f32_16x16x32_bf16 v[88:91], a[20:23], a[80:83], v[88:91]
  v_mfma_f32_16x16x32_bf16 v[96:99], a[24:27], a[80:83], v[96:99]
  v_mfma_f32_16x16x32_bf16 v[104:107], a[28:31], a[80:83], v[104:107]
  buffer_load_dwordx4 v4, s[8:11], s47 offen offset:0 lds
  v_mfma_f32_16x16x32_bf16 v[112:115], a[32:35], a[80:83], v[112:115]
  v_mfma_f32_16x16x32_bf16 v[92:95], a[20:23], a[84:87], v[92:95]
  v_mfma_f32_16x16x32_bf16 v[100:103], a[24:27], a[84:87], v[100:103]
  v_mfma_f32_16x16x32_bf16 v[108:111], a[28:31], a[84:87], v[108:111]
  v_mfma_f32_16x16x32_bf16 v[116:119], a[32:35], a[84:87], v[116:119]
  s_waitcnt lgkmcnt(0)
  v_mfma_f32_16x16x32_bf16 v[24:27], a[40:43], a[0:3], v[24:27]
  buffer_load_dwordx4 v5, s[8:11], s47 offen offset:1024 lds
  ds_read_b128 a[20:23], v17 offset:0
  v_mfma_f32_16x16x32_bf16 v[32:35], a[40:43], a[4:7], v[32:35]
  ds_read_b64_tr_b16 a[64:65], v20 offset:22528
  ds_read_b64_tr_b16 a[66:67], v20 offset:24576
  v_mfma_f32_16x16x32_bf16 v[40:43], a[40:43], a[8:11], v[40:43]
  ds_read_b128 a[24:27], v17 offset:2048
  v_mfma_f32_16x16x32_bf16 v[48:51], a[40:43], a[12:15], v[48:51]
  ds_read_b128 a[28:31], v17 offset:4096
  v_mfma_f32_16x16x32_bf16 v[28:31], a[44:47], a[0:3], v[28:31]
  ds_read_b128 a[32:35], v17 offset:6144
  v_mfma_f32_16x16x32_bf16 v[36:39], a[44:47], a[4:7], v[36:39]
  buffer_load_dwordx4 v6, s[8:11], s47 offen offset:2048 lds
  ds_read_b64_tr_b16 a[68:69], v21 offset:22528
  v_mfma_f32_16x16x32_bf16 v[44:47], a[44:47], a[8:11], v[44:47]
  ds_read_b64_tr_b16 a[70:71], v21 offset:24576
  v_mfma_f32_16x16x32_bf16 v[52:55], a[44:47], a[12:15], v[52:55]
  ds_read_b64_tr_b16 a[72:73], v20 offset:30720
  v_mfma_f32_16x16x32_bf16 v[56:59], a[48:51], a[0:3], v[56:59]
  ds_read_b64_tr_b16 a[74:75], v20 offset:32768
  v_mfma_f32_16x16x32_bf16 v[64:67], a[48:51], a[4:7], v[64:67]
  ds_read_b128 a[36:39], v19 offset:0
  v_mfma_f32_16x16x32_bf16 v[72:75], a[48:51], a[8:11], v[72:75]
  buffer_load_dwordx4 v7, s[8:11], s47 offen offset:3072 lds
  ds_read_b64_tr_b16 a[76:77], v21 offset:30720
  v_mfma_f32_16x16x32_bf16 v[80:83], a[48:51], a[12:15], v[80:83]
  s_bfe_u32 s49, 0x302010e, s53
  s_add_u32 s52, s52, s49
  s_add_u32 s53, s53, 8
  v_mfma_f32_16x16x32_bf16 v[120:123], a[48:51], a[16:19], v[120:123]
  s_and_b32 s53, s53, 0x8001f
  s_and_b32 s52, s52, 15
  s_lshl_b32 s49, s52, 7
  v_mfma_f32_16x16x32_bf16 v[60:63], a[52:55], a[0:3], v[60:63]
  s_or_b32 s46, s50, s49
  s_or_b32 s47, s51, s49
  s_add_u32 s60, s63, 40960
  v_mfma_f32_16x16x32_bf16 v[68:71], a[52:55], a[4:7], v[68:71]
  ds_read_b64_tr_b16 a[78:79], v21 offset:32768
  ds_read_b64_tr_b16 a[80:81], v20 offset:38912
  v_mfma_f32_16x16x32_bf16 v[76:79], a[52:55], a[8:11], v[76:79]
  buffer_store_dwordx4 v[224:227], v2, s[16:19], s60 offen offset:0 sc1
  ds_read_b64_tr_b16 a[82:83], v20 offset:40960
  v_mfma_f32_16x16x32_bf16 v[84:87], a[52:55], a[12:15], v[84:87]
  ds_read_b64_tr_b16 a[84:85], v21 offset:38912
  ds_read_b64_tr_b16 a[86:87], v21 offset:40960
  v_mfma_f32_16x16x32_bf16 v[124:127], a[52:55], a[16:19], v[124:127]
  v_mfma_f32_16x16x32_bf16 v[88:91], a[0:3], a[56:59], v[88:91]
  v_mfma_f32_16x16x32_bf16 v[96:99], a[4:7], a[56:59], v[96:99]
  v_mfma_f32_16x16x32_bf16 v[104:107], a[8:11], a[56:59], v[104:107]
  buffer_store_dwordx4 v[228:231], v2, s[16:19], s60 offen offset:1024 sc1
  v_mfma_f32_16x16x32_bf16 v[112:115], a[12:15], a[56:59], v[112:115]
  v_mfma_f32_16x16x32_bf16 v[92:95], a[0:3], a[60:63], v[92:95]
  v_mfma_f32_16x16x32_bf16 v[100:103], a[4:7], a[60:63], v[100:103]
  v_mfma_f32_16x16x32_bf16 v[108:111], a[8:11], a[60:63], v[108:111]
  v_mfma_f32_16x16x32_bf16 v[116:119], a[12:15], a[60:63], v[116:119]
  s_waitcnt lgkmcnt(0)
  s_barrier
  v_mfma_f32_16x16x32_bf16 v[24:27], a[64:67], a[20:23], v[24:27]
  s_add_u32 m0, s36, 32768
  v_mfma_f32_16x16x32_bf16 v[32:35], a[64:67], a[24:27], v[32:35]
  buffer_load_dwordx4 v4, s[8:11], s46 offen offset:0 lds
  v_mfma_f32_16x16x32_bf16 v[40:43], a[64:67], a[28:31], v[40:43]
  v_mfma_f32_16x16x32_bf16 v[48:51], a[64:67], a[32:35], v[48:51]
  buffer_load_dwordx4 v5, s[8:11], s46 offen offset:1024 lds
  v_mfma_f32_16x16x32_bf16 v[28:31], a[68:71], a[20:23], v[28:31]
  v_mfma_f32_16x16x32_bf16 v[36:39], a[68:71], a[24:27], v[36:39]
  v_mfma_f32_16x16x32_bf16 v[44:47], a[68:71], a[28:31], v[44:47]
  buffer_load_dwordx4 v6, s[8:11], s46 offen offset:2048 lds
  v_mfma_f32_16x16x32_bf16 v[52:55], a[68:71], a[32:35], v[52:55]
  v_mfma_f32_16x16x32_bf16 v[56:59], a[72:75], a[20:23], v[56:59]
  v_mfma_f32_16x16x32_bf16 v[64:67], a[72:75], a[24:27], v[64:67]
  buffer_load_dwordx4 v7, s[8:11], s46 offen offset:3072 lds
  v_mfma_f32_16x16x32_bf16 v[72:75], a[72:75], a[28:31], v[72:75]
  s_add_u32 m0, s36, 36864
  v_mfma_f32_16x16x32_bf16 v[80:83], a[72:75], a[32:35], v[80:83]
  v_mfma_f32_16x16x32_bf16 v[120:123], a[72:75], a[36:39], v[120:123]
  buffer_load_dwordx4 v4, s[8:11], s47 offen offset:0 lds
  v_mfma_f32_16x16x32_bf16 v[60:63], a[76:79], a[20:23], v[60:63]
  v_mfma_f32_16x16x32_bf16 v[68:71], a[76:79], a[24:27], v[68:71]
  v_mfma_f32_16x16x32_bf16 v[76:79], a[76:79], a[28:31], v[76:79]
  buffer_load_dwordx4 v5, s[8:11], s47 offen offset:1024 lds
  v_mfma_f32_16x16x32_bf16 v[84:87], a[76:79], a[32:35], v[84:87]
  v_mfma_f32_16x16x32_bf16 v[124:127], a[76:79], a[36:39], v[124:127]
  v_mfma_f32_16x16x32_bf16 v[88:91], a[20:23], a[80:83], v[88:91]
  buffer_load_dwordx4 v6, s[8:11], s47 offen offset:2048 lds
  v_mfma_f32_16x16x32_bf16 v[96:99], a[24:27], a[80:83], v[96:99]
  v_mfma_f32_16x16x32_bf16 v[104:107], a[28:31], a[80:83], v[104:107]
  v_mfma_f32_16x16x32_bf16 v[112:115], a[32:35], a[80:83], v[112:115]
  buffer_load_dwordx4 v7, s[8:11], s47 offen offset:3072 lds
  v_mfma_f32_16x16x32_bf16 v[92:95], a[20:23], a[84:87], v[92:95]
  s_bfe_u32 s49, 0x302010e, s53
  s_add_u32 s52, s52, s49
  s_add_u32 s53, s53, 8
  v_mfma_f32_16x16x32_bf16 v[100:103], a[24:27], a[84:87], v[100:103]
  s_and_b32 s53, s53, 0x8001f
  s_and_b32 s52, s52, 15
  s_lshl_b32 s49, s52, 7
  v_mfma_f32_16x16x32_bf16 v[108:111], a[28:31], a[84:87], v[108:111]
  s_or_b32 s46, s50, s49
  s_or_b32 s47, s51, s49
  v_mfma_f32_16x16x32_bf16 v[116:119], a[32:35], a[84:87], v[116:119]
  s_and_b32 s4, s3, 1
  s_mul_i32 s4, s4, 3072
  s_add_u32 s4, s4, 49152
  v_add_u32 v196, s4, v2
  s_add_u32 s60, s63, 40960
  buffer_store_dwordx4 v[232:235], v2, s[16:19], s60 offen offset:2048 sc1
  v_cvt_pk_bf16_f32 v160, v80, v81
  v_cvt_pk_bf16_f32 v161, v82, v83
  v_cvt_pk_bf16_f32 v172, v112, v113
  v_cvt_pk_bf16_f32 v173, v114, v115
  v_cvt_pk_bf16_f32 v162, v84, v85
  v_cvt_pk_bf16_f32 v163, v86, v87
  v_cvt_pk_bf16_f32 v182, v116, v117
  v_cvt_pk_bf16_f32 v183, v118, v119
  ds_write_b128 v196, v[160:163]
  ds_write_b64 v196, v[172:173] offset:1024
  ds_write_b64 v196, v[182:183] offset:1032
  v_and_b32 v197, 15, v1
  v_lshrrev_b32 v198, 4, v1
  v_lshlrev_b32 v198, 2, v198
  v_sub_u32 v197, v197, v198
  v_mov_b32 v198, 0xf149f2ca
  buffer_store_dwordx4 v[236:239], v2, s[16:19], s60 offen offset:3072 sc1
  v_subrev_u32 v199, 0, v197
  v_and_b32 v184, 0x80000001, v199
  v_cmp_ne_u32 vcc, 0, v184
  s_nop 1
  v_cndmask_b32 v184, 0, v198, vcc
  v_add_u32 v199, 1, v199
  v_and_b32 v188, 0x80000001, v199
  v_cmp_ne_u32 vcc, 0x80000001, v188
  s_nop 1
  v_cndmask_b32 v188, 0, v198, vcc
  v_subrev_u32 v199, 1, v197
  v_and_b32 v185, 0x80000001, v199
  v_cmp_ne_u32 vcc, 0, v185
  s_nop 1
  v_cndmask_b32 v185, 0, v198, vcc
  v_add_u32 v199, 1, v199
  v_and_b32 v189, 0x80000001, v199
  v_cmp_ne_u32 vcc, 0x80000001, v189
  s_nop 1
  v_cndmask_b32 v189, 0, v198, vcc
  v_subrev_u32 v199, 2, v197
  v_and_b32 v186, 0x80000001, v199
  v_cmp_ne_u32 vcc, 0, v186
  s_nop 1
  v_cndmask_b32 v186, 0, v198, vcc
  v_add_u32 v199, 1, v199
  v_and_b32 v190, 0x80000001, v199
  v_cmp_ne_u32 vcc, 0x80000001, v190
  s_nop 1
  v_cndmask_b32 v190, 0, v198, vcc
  v_subrev_u32 v199, 3, v197
  s_add_u32 s60, s63, 45056
  buffer_store_dwordx4 v[240:243], v2, s[16:19], s60 offen offset:0 sc1
  v_and_b32 v187, 0x80000001, v199
  v_cmp_ne_u32 vcc, 0, v187
  s_nop 1
  v_cndmask_b32 v187, 0, v198, vcc
  v_add_u32 v199, 1, v199
  v_and_b32 v191, 0x80000001, v199
  v_cmp_ne_u32 vcc, 0x80000001, v191
  s_nop 1
  v_cndmask_b32 v191, 0, v198, vcc
  s_cmp_eq_u32 s32, 0
  s_cselect_b64 vcc, -1, 0
  v_cndmask_b32 v192, v188, v198, vcc
  v_cndmask_b32 v193, v189, v198, vcc
  v_cndmask_b32 v194, v190, v198, vcc
  v_cndmask_b32 v195, v191, v198, vcc
  s_mov_b32 s6, 0x3e8293ee
  s_mov_b32 s7, s6
  v_pk_mul_f32 v[24:25], v[24:25], s[6:7]
  v_pk_mul_f32 v[26:27], v[26:27], s[6:7]
  v_pk_mul_f32 v[28:29], v[28:29], s[6:7]
  v_pk_mul_f32 v[30:31], v[30:31], s[6:7]
  v_cvt_pk_bf16_f32 v128, v24, v25
  v_cvt_pk_bf16_f32 v129, v26, v27
  v_cvt_pk_bf16_f32 v130, v28, v29
  v_cvt_pk_bf16_f32 v131, v30, v31
  v_pk_mul_f32 v[32:33], v[32:33], s[6:7]
  v_pk_mul_f32 v[34:35], v[34:35], s[6:7]
  buffer_store_dwordx4 v[244:247], v2, s[16:19], s60 offen offset:1024 sc1
  v_pk_mul_f32 v[36:37], v[36:37], s[6:7]
  v_pk_mul_f32 v[38:39], v[38:39], s[6:7]
  v_cvt_pk_bf16_f32 v132, v32, v33
  v_cvt_pk_bf16_f32 v133, v34, v35
  v_cvt_pk_bf16_f32 v134, v36, v37
  v_cvt_pk_bf16_f32 v135, v38, v39
  v_pk_mul_f32 v[40:41], v[40:41], s[6:7]
  v_pk_mul_f32 v[42:43], v[42:43], s[6:7]
  v_pk_mul_f32 v[44:45], v[44:45], s[6:7]
  v_pk_mul_f32 v[46:47], v[46:47], s[6:7]
  v_cvt_pk_bf16_f32 v136, v40, v41
  v_cvt_pk_bf16_f32 v137, v42, v43
  v_cvt_pk_bf16_f32 v138, v44, v45
  buffer_store_dwordx4 v[248:251], v2, s[16:19], s60 offen offset:2048 sc1
  v_cvt_pk_bf16_f32 v139, v46, v47
  v_pk_mul_f32 v[48:49], v[48:49], s[6:7]
  v_pk_mul_f32 v[50:51], v[50:51], s[6:7]
  v_pk_mul_f32 v[52:53], v[52:53], s[6:7]
  v_pk_mul_f32 v[54:55], v[54:55], s[6:7]
  v_cvt_pk_bf16_f32 v140, v48, v49
  v_cvt_pk_bf16_f32 v141, v50, v51
  v_cvt_pk_bf16_f32 v142, v52, v53
  v_cvt_pk_bf16_f32 v143, v54, v55
  v_cvt_pk_bf16_f32 v148, v56, v57
  v_cvt_pk_bf16_f32 v149, v58, v59
  v_cvt_pk_bf16_f32 v166, v88, v89
  buffer_store_dwordx4 v[252:255], v2, s[16:19], s60 offen offset:3072 sc1
  v_cvt_pk_bf16_f32 v167, v90, v91
  v_cvt_pk_bf16_f32 v150, v60, v61
  v_cvt_pk_bf16_f32 v151, v62, v63
  v_cvt_pk_bf16_f32 v176, v92, v93
  v_cvt_pk_bf16_f32 v177, v94, v95
  v_cvt_pk_bf16_f32 v152, v64, v65
  v_cvt_pk_bf16_f32 v153, v66, v67
  v_cvt_pk_bf16_f32 v168, v96, v97
  v_cvt_pk_bf16_f32 v169, v98, v99
  v_cvt_pk_bf16_f32 v154, v68, v69
  v_cvt_pk_bf16_f32 v155, v70, v71
  v_cvt_pk_bf16_f32 v178, v100, v101
  v_cvt_pk_bf16_f32 v179, v102, v103
  s_add_u32 m0, s41, 32768
  s_nop 0
  buffer_load_dwordx4 v8, s[12:15], s48 offen offset:0 lds
  v_cvt_pk_bf16_f32 v156, v72, v73
  v_cvt_pk_bf16_f32 v157, v74, v75
  v_cvt_pk_bf16_f32 v170, v104, v105
  v_cvt_pk_bf16_f32 v171, v106, v107
  v_cvt_pk_bf16_f32 v158, v76, v77
  v_cvt_pk_bf16_f32 v159, v78, v79
  v_cvt_pk_bf16_f32 v180, v108, v109
  v_cvt_pk_bf16_f32 v181, v110, v111
  v_cvt_pk_bf16_f32 v144, v120, v121
  v_cvt_pk_bf16_f32 v145, v122, v123
  v_cvt_pk_bf16_f32 v146, v124, v125
  v_cvt_pk_bf16_f32 v147, v126, v127
  buffer_load_dwordx4 v9, s[12:15], s48 offen offset:1024 lds
  v_mov_b32 v200, 0x3f803f80
  v_mov_b32 v201, v200
  v_mov_b32 v202, v200
  v_mov_b32 v203, v200
  s_waitcnt lgkmcnt(0)
  s_barrier
  ds_read_b64 v[164:165], v196 offset:2048
  ds_read_b64 v[174:175], v196 offset:2056
  v_mfma_f32_16x16x32_bf16 v[48:51], v[156:159], v[140:143], v[188:191]
  v_mfma_f32_16x16x32_bf16 v[52:55], v[160:163], v[140:143], v[184:187]
  v_mfma_f32_16x16x32_bf16 v[40:43], v[152:155], v[136:139], v[188:191]
  v_mfma_f32_16x16x32_bf16 v[44:47], v[156:159], v[136:139], v[184:187]
  v_mfma_f32_16x16x32_bf16 v[32:35], v[148:151], v[132:135], v[188:191]
  v_mfma_f32_16x16x32_bf16 v[36:39], v[152:155], v[132:135], v[184:187]
  s_waitcnt lgkmcnt(0)
  v_mfma_f32_16x16x32_bf16 v[24:27], v[144:147], v[128:131], v[192:195]
  v_mfma_f32_16x16x32_bf16 v[28:31], v[148:151], v[128:131], v[184:187]
  v_max3_f32 v62, v48, v49, v50
  v_max3_f32 v63, v51, v52, v53
  v_max3_f32 v62, v62, v54, v55
  buffer_load_dwordx4 v10, s[12:15], s48 offen offset:2048 lds
  v_max_f32 v62, v62, v63
  v_max3_f32 v60, v40, v41, v42
  v_max3_f32 v61, v43, v44, v45
  v_max3_f32 v60, v60, v46, v47
  v_max_f32 v60, v60, v61
  v_max3_f32 v58, v32, v33, v34
  v_max3_f32 v59, v35, v36, v37
  v_max3_f32 v58, v58, v38, v39
  v_max_f32 v58, v58, v59
  v_max3_f32 v56, v24, v25, v26
  v_max3_f32 v57, v27, v28, v29
  v_max3_f32 v56, v56, v30, v31
  buffer_load_dwordx4 v11, s[12:15], s48 offen offset:3072 lds
  v_max_f32 v56, v56, v57
  v_mov_b32 v63, v62
  v_mov_b32 v61, v60
  v_mov_b32 v59, v58
  v_mov_b32 v57, v56
  v_permlane32_swap_b32 v62, v63
  v_permlane32_swap_b32 v60, v61
  v_permlane32_swap_b32 v58, v59
  v_permlane32_swap_b32 v56, v57
  v_max_f32 v62, v62, v63
  v_max_f32 v60, v60, v61
  v_max_f32 v58, v58, v59
  v_max_f32 v56, v56, v57
  s_bfe_u32 s56, 0x302010e, s55
  s_add_u32 s54, s54, s56
  s_add_u32 s55, s55, 8
  s_and_b32 s55, s55, 0x8001f
  s_and_b32 s54, s54, 15
  s_lshl_b32 s48, s54, 19
  s_add_u32 m0, s36, -32768
  s_nop 0
  buffer_load_dwordx4 v4, s[8:11], s46 offen offset:0 lds
  v_mov_b32 v63, v62
  v_mov_b32 v61, v60
  v_mov_b32 v59, v58
  v_mov_b32 v57, v56
  v_permlane16_swap_b32 v62, v63
  v_permlane16_swap_b32 v60, v61
  v_permlane16_swap_b32 v58, v59
  v_permlane16_swap_b32 v56, v57
  v_max_f32 v62, v62, v63
  v_max_f32 v60, v60, v61
  v_max_f32 v58, v58, v59
  v_max_f32 v56, v56, v57
  buffer_load_dwordx4 v5, s[8:11], s46 offen offset:1024 lds
  v_sub_f32 v48, v48, v62
  v_sub_f32 v49, v49, v62
  v_sub_f32 v50, v50, v62
  v_sub_f32 v51, v51, v62
  v_sub_f32 v52, v52, v62
  v_sub_f32 v53, v53, v62
  v_sub_f32 v54, v54, v62
  v_sub_f32 v55, v55, v62
  v_exp_f32 v48, v48
  v_exp_f32 v49, v49
  v_exp_f32 v50, v50
  v_exp_f32 v51, v51
  v_exp_f32 v52, v52
  buffer_load_dwordx4 v6, s[8:11], s46 offen offset:2048 lds
  v_exp_f32 v53, v53
  v_exp_f32 v54, v54
  v_exp_f32 v55, v55
  v_sub_f32 v40, v40, v60
  v_sub_f32 v41, v41, v60
  v_sub_f32 v42, v42, v60
  v_sub_f32 v43, v43, v60
  v_sub_f32 v44, v44, v60
  v_sub_f32 v45, v45, v60
  v_sub_f32 v46, v46, v60
  v_sub_f32 v47, v47, v60
  v_exp_f32 v40, v40
  buffer_load_dwordx4 v7, s[8:11], s46 offen offset:3072 lds
  v_exp_f32 v41, v41
  v_exp_f32 v42, v42
  v_exp_f32 v43, v43
  v_exp_f32 v44, v44
  v_exp_f32 v45, v45
  v_exp_f32 v46, v46
  v_exp_f32 v47, v47
  v_sub_f32 v32, v32, v58
  v_sub_f32 v33, v33, v58
  v_sub_f32 v34, v34, v58
  v_sub_f32 v35, v35, v58
  v_sub_f32 v36, v36, v58
  v_sub_f32 v37, v37, v58
  s_add_u32 m0, s36, -28672
  s_nop 0
  buffer_load_dwordx4 v4, s[8:11], s47 offen offset:0 lds
  v_sub_f32 v38, v38, v58
  v_sub_f32 v39, v39, v58
  v_exp_f32 v32, v32
  v_exp_f32 v33, v33
  v_exp_f32 v34, v34
  v_exp_f32 v35, v35
  v_exp_f32 v36, v36
  v_exp_f32 v37, v37
  v_exp_f32 v38, v38
  v_exp_f32 v39, v39
  v_sub_f32 v24, v24, v56
  v_sub_f32 v25, v25, v56
  buffer_load_dwordx4 v5, s[8:11], s47 offen offset:1024 lds
  v_sub_f32 v26, v26, v56
  v_sub_f32 v27, v27, v56
  v_sub_f32 v28, v28, v56
  v_sub_f32 v29, v29, v56
  v_sub_f32 v30, v30, v56
  v_sub_f32 v31, v31, v56
  v_exp_f32 v24, v24
  v_exp_f32 v25, v25
  v_exp_f32 v26, v26
  v_exp_f32 v27, v27
  v_exp_f32 v28, v28
  v_exp_f32 v29, v29
  v_exp_f32 v30, v30
  buffer_load_dwordx4 v6, s[8:11], s47 offen offset:2048 lds
  v_exp_f32 v31, v31
  v_cvt_pk_bf16_f32 v76, v48, v49
  v_cvt_pk_bf16_f32 v77, v50, v51
  v_cvt_pk_bf16_f32 v78, v52, v53
  v_cvt_pk_bf16_f32 v79, v54, v55
  v_cvt_pk_bf16_f32 v72, v40, v41
  v_cvt_pk_bf16_f32 v73, v42, v43
  v_cvt_pk_bf16_f32 v74, v44, v45
  v_cvt_pk_bf16_f32 v75, v46, v47
  v_cvt_pk_bf16_f32 v68, v32, v33
  v_cvt_pk_bf16_f32 v69, v34, v35
  v_cvt_pk_bf16_f32 v70, v36, v37
  buffer_load_dwordx4 v7, s[8:11], s47 offen offset:3072 lds
  s_bfe_u32 s49, 0x302010e, s53
  s_add_u32 s52, s52, s49
  s_add_u32 s53, s53, 8
  s_and_b32 s53, s53, 0x8001f
  s_and_b32 s52, s52, 15
  s_lshl_b32 s49, s52, 7
  s_or_b32 s46, s50, s49
  s_or_b32 s47, s51, s49
  v_cvt_pk_bf16_f32 v71, v38, v39
  v_cvt_pk_bf16_f32 v64, v24, v25
  v_cvt_pk_bf16_f32 v65, v26, v27
  v_cvt_pk_bf16_f32 v66, v28, v29
  v_cvt_pk_bf16_f32 v67, v30, v31
  v_mfma_f32_16x16x32_bf16 v[92:95], v[200:203], v[76:79], 0
  v_mfma_f32_16x16x32_bf16 v[120:123], v[170:173], v[76:79], 0
  v_mfma_f32_16x16x32_bf16 v[124:127], v[180:183], v[76:79], 0
  v_mfma_f32_16x16x32_bf16 v[88:91], v[200:203], v[72:75], 0
  v_mfma_f32_16x16x32_bf16 v[112:115], v[168:171], v[72:75], 0
  v_mfma_f32_16x16x32_bf16 v[116:119], v[178:181], v[72:75], 0
  v_mfma_f32_16x16x32_bf16 v[84:87], v[200:203], v[68:71], 0
  v_mfma_f32_16x16x32_bf16 v[104:107], v[166:169], v[68:71], 0
  v_mfma_f32_16x16x32_bf16 v[108:111], v[176:179], v[68:71], 0
  v_mfma_f32_16x16x32_bf16 v[80:83], v[200:203], v[64:67], 0
  v_mfma_f32_16x16x32_bf16 v[96:99], v[164:167], v[64:67], 0
  v_mfma_f32_16x16x32_bf16 v[100:103], v[174:177], v[64:67], 0
  s_add_u32 s20, s86, 83886080
  s_addc_u32 s21, s87, 0
  s_mov_b32 s22, 4194304
  s_mov_b32 s23, 0x00020000
  s_lshl_b32 s4, s32, 18
  s_lshl_b32 s5, s33, 14
  s_add_u32 s4, s4, s5
  s_and_b32 s5, s3, 1
  s_lshl_b32 s5, s5, 13
  s_add_u32 s4, s4, s5
  v_rcp_f32 v92, v92
  v_rcp_f32 v88, v88
  v_rcp_f32 v84, v84
  v_rcp_f32 v80, v80
  v_mov_b32 v93, v92
  v_mov_b32 v89, v88
  v_mov_b32 v85, v84
  v_mov_b32 v81, v80
  v_pk_mul_f32 v[120:121], v[120:121], v[92:93]
  v_pk_mul_f32 v[122:123], v[122:123], v[92:93]
  v_pk_mul_f32 v[124:125], v[124:125], v[92:93]
  v_pk_mul_f32 v[126:127], v[126:127], v[92:93]
  v_cvt_pk_bf16_f32 v120, v120, v121
  v_cvt_pk_bf16_f32 v121, v122, v123
  v_cvt_pk_bf16_f32 v122, v124, v125
  v_cvt_pk_bf16_f32 v123, v126, v127
  buffer_store_dwordx4 v[120:123], v2, s[20:23], s4 offen offset:3072 sc1
  v_pk_mul_f32 v[112:113], v[112:113], v[88:89]
  v_pk_mul_f32 v[114:115], v[114:115], v[88:89]
  v_pk_mul_f32 v[116:117], v[116:117], v[88:89]
  v_pk_mul_f32 v[118:119], v[118:119], v[88:89]
  v_cvt_pk_bf16_f32 v112, v112, v113
  v_cvt_pk_bf16_f32 v113, v114, v115
  v_cvt_pk_bf16_f32 v114, v116, v117
  v_cvt_pk_bf16_f32 v115, v118, v119
  buffer_store_dwordx4 v[112:115], v2, s[20:23], s4 offen offset:2048 sc1
  v_pk_mul_f32 v[104:105], v[104:105], v[84:85]
  v_pk_mul_f32 v[106:107], v[106:107], v[84:85]
  v_pk_mul_f32 v[108:109], v[108:109], v[84:85]
  v_pk_mul_f32 v[110:111], v[110:111], v[84:85]
  v_cvt_pk_bf16_f32 v104, v104, v105
  v_cvt_pk_bf16_f32 v105, v106, v107
  v_cvt_pk_bf16_f32 v106, v108, v109
  v_cvt_pk_bf16_f32 v107, v110, v111
  buffer_store_dwordx4 v[104:107], v2, s[20:23], s4 offen offset:1024 sc1
  v_pk_mul_f32 v[96:97], v[96:97], v[80:81]
  v_pk_mul_f32 v[98:99], v[98:99], v[80:81]
  v_pk_mul_f32 v[100:101], v[100:101], v[80:81]
  v_pk_mul_f32 v[102:103], v[102:103], v[80:81]
  v_cvt_pk_bf16_f32 v96, v96, v97
  v_cvt_pk_bf16_f32 v97, v98, v99
  v_cvt_pk_bf16_f32 v98, v100, v101
  v_cvt_pk_bf16_f32 v99, v102, v103
  buffer_store_dwordx4 v[96:99], v2, s[20:23], s4 offen offset:0 sc1
  s_branch Lp3
Lp2_r1:
  s_waitcnt vmcnt(29)
  s_barrier
  ds_read_b128 a[0:3], v16 offset:0
  ds_read_b64_tr_b16 a[40:41], v20 offset:18432
  ds_read_b64_tr_b16 a[42:43], v20 offset:20480
  ds_read_b128 a[4:7], v16 offset:2048
  ds_read_b128 a[8:11], v16 offset:4096
  ds_read_b128 a[12:15], v16 offset:6144
  ds_read_b64_tr_b16 a[44:45], v21 offset:18432
  ds_read_b64_tr_b16 a[46:47], v21 offset:20480
  ds_read_b64_tr_b16 a[48:49], v20 offset:26624
  ds_read_b64_tr_b16 a[50:51], v20 offset:28672
  ds_read_b64_tr_b16 a[52:53], v21 offset:26624
  ds_read_b64_tr_b16 a[54:55], v21 offset:28672
  ds_read_b64_tr_b16 a[56:57], v20 offset:34816
  ds_read_b64_tr_b16 a[58:59], v20 offset:36864
  ds_read_b128 a[16:19], v18 offset:0
  ds_read_b64_tr_b16 a[60:61], v21 offset:34816
  ds_read_b64_tr_b16 a[62:63], v21 offset:36864
  s_waitcnt lgkmcnt(0)
  v_mfma_f32_16x16x32_bf16 v[24:27], a[40:43], a[0:3], 0
  s_add_u32 s60, s63, 32768
  buffer_store_dwordx4 v[192:195], v2, s[16:19], s60 offen offset:0 sc1
  ds_read_b128 a[20:23], v17 offset:0
  v_mfma_f32_16x16x32_bf16 v[32:35], a[40:43], a[4:7], 0
  s_add_u32 s89, s89, 1
  ds_read_b64_tr_b16 a[64:65], v20 offset:22528
  ds_read_b64_tr_b16 a[66:67], v20 offset:24576
  v_mfma_f32_16x16x32_bf16 v[40:43], a[40:43], a[8:11], 0
  s_cmp_eq_u32 s89, 3
  s_cselect_b32 s89, 0, s89
  s_cselect_b32 s90, s91, s92
  ds_read_b128 a[24:27], v17 offset:2048
  v_mfma_f32_16x16x32_bf16 v[48:51], a[40:43], a[12:15], 0
  ds_read_b128 a[28:31], v17 offset:4096
  v_mfma_f32_16x16x32_bf16 v[28:31], a[44:47], a[0:3], 0
  ds_read_b128 a[32:35], v17 offset:6144
  v_mfma_f32_16x16x32_bf16 v[36:39], a[44:47], a[4:7], 0
  ds_read_b64_tr_b16 a[68:69], v21 offset:22528
  v_mfma_f32_16x16x32_bf16 v[44:47], a[44:47], a[8:11], 0
  ds_read_b64_tr_b16 a[70:71], v21 offset:24576
  v_mfma_f32_16x16x32_bf16 v[52:55], a[44:47], a[12:15], 0
  ds_read_b64_tr_b16 a[72:73], v20 offset:30720
  v_mfma_f32_16x16x32_bf16 v[56:59], a[48:51], a[0:3], 0
  ds_read_b64_tr_b16 a[74:75], v20 offset:32768
  v_mfma_f32_16x16x32_bf16 v[64:67], a[48:51], a[4:7], 0
  ds_read_b64_tr_b16 a[76:77], v21 offset:30720
  v_mfma_f32_16x16x32_bf16 v[72:75], a[48:51], a[8:11], 0
  ds_read_b64_tr_b16 a[78:79], v21 offset:32768
  v_mfma_f32_16x16x32_bf16 v[80:83], a[48:51], a[12:15], 0
  ds_read_b64_tr_b16 a[80:81], v20 offset:38912
  v_mfma_f32_16x16x32_bf16 v[60:63], a[52:55], a[0:3], 0
  ds_read_b64_tr_b16 a[82:83], v20 offset:40960
  v_mfma_f32_16x16x32_bf16 v[68:71], a[52:55], a[4:7], 0
  ds_read_b128 a[36:39], v19 offset:0
  v_mfma_f32_16x16x32_bf16 v[76:79], a[52:55], a[8:11], 0
  ds_read_b64_tr_b16 a[84:85], v21 offset:38912
  v_mfma_f32_16x16x32_bf16 v[84:87], a[52:55], a[12:15], 0
  ds_read_b64_tr_b16 a[86:87], v21 offset:40960
  v_mfma_f32_16x16x32_bf16 v[88:91], a[0:3], a[56:59], 0
  v_add_u32 v16, s90, v16
  v_add_u32 v17, s90, v17
  v_mfma_f32_16x16x32_bf16 v[96:99], a[4:7], a[56:59], 0
  v_add_u32 v18, s90, v18
  v_add_u32 v19, s90, v19
  v_mfma_f32_16x16x32_bf16 v[104:107], a[8:11], a[56:59], 0
  v_add_u32 v20, s90, v20
  v_add_u32 v21, s90, v21
  v_mfma_f32_16x16x32_bf16 v[112:115], a[12:15], a[56:59], 0
  v_mfma_f32_16x16x32_bf16 v[120:123], a[16:19], a[56:59], 0
  v_mfma_f32_16x16x32_bf16 v[92:95], a[0:3], a[60:63], 0
  v_mfma_f32_16x16x32_bf16 v[100:103], a[4:7], a[60:63], 0
  v_mfma_f32_16x16x32_bf16 v[108:111], a[8:11], a[60:63], 0
  v_mfma_f32_16x16x32_bf16 v[116:119], a[12:15], a[60:63], 0
  v_mfma_f32_16x16x32_bf16 v[124:127], a[16:19], a[60:63], 0
  s_waitcnt vmcnt(20) lgkmcnt(0)
  s_barrier
  v_mfma_f32_16x16x32_bf16 v[24:27], a[64:67], a[20:23], v[24:27]
  buffer_load_dwordx4 a[192:195], v2, s[52:55], s51 offen offset:0
  ds_read_b128 a[0:3], v16 offset:0
  v_mfma_f32_16x16x32_bf16 v[32:35], a[64:67], a[24:27], v[32:35]
  s_add_u32 s51, s51, 1024
  s_mov_b32 m0, s88
  ds_read_b64_tr_b16 a[40:41], v20 offset:18432
  v_mfma_f32_16x16x32_bf16 v[40:43], a[64:67], a[28:31], v[40:43]
  ds_read_b64_tr_b16 a[42:43], v20 offset:20480
  ds_read_b128 a[4:7], v16 offset:2048
  v_mfma_f32_16x16x32_bf16 v[48:51], a[64:67], a[32:35], v[48:51]
  ds_read_b128 a[8:11], v16 offset:4096
  v_mfma_f32_16x16x32_bf16 v[28:31], a[68:71], a[20:23], v[28:31]
  buffer_load_dwordx4 v4, s[8:11], s30 offen offset:0 lds
  ds_read_b128 a[12:15], v16 offset:6144
  v_mfma_f32_16x16x32_bf16 v[36:39], a[68:71], a[24:27], v[36:39]
  ds_read_b64_tr_b16 a[44:45], v21 offset:18432
  v_mfma_f32_16x16x32_bf16 v[44:47], a[68:71], a[28:31], v[44:47]
  ds_read_b64_tr_b16 a[46:47], v21 offset:20480
  v_mfma_f32_16x16x32_bf16 v[52:55], a[68:71], a[32:35], v[52:55]
  ds_read_b64_tr_b16 a[48:49], v20 offset:26624
  v_mfma_f32_16x16x32_bf16 v[56:59], a[72:75], a[20:23], v[56:59]
  buffer_load_dwordx4 v5, s[8:11], s30 offen offset:1024 lds
  ds_read_b64_tr_b16 a[50:51], v20 offset:28672
  v_mfma_f32_16x16x32_bf16 v[64:67], a[72:75], a[24:27], v[64:67]
  ds_read_b64_tr_b16 a[52:53], v21 offset:26624
  v_mfma_f32_16x16x32_bf16 v[72:75], a[72:75], a[28:31], v[72:75]
  ds_read_b64_tr_b16 a[54:55], v21 offset:28672
  v_mfma_f32_16x16x32_bf16 v[80:83], a[72:75], a[32:35], v[80:83]
  ds_read_b64_tr_b16 a[56:57], v20 offset:34816
  v_mfma_f32_16x16x32_bf16 v[60:63], a[76:79], a[20:23], v[60:63]
  buffer_load_dwordx4 v6, s[8:11], s30 offen offset:2048 lds
  ds_read_b64_tr_b16 a[58:59], v20 offset:36864
  v_mfma_f32_16x16x32_bf16 v[68:71], a[76:79], a[24:27], v[68:71]
  ds_read_b128 a[16:19], v18 offset:0
  v_mfma_f32_16x16x32_bf16 v[76:79], a[76:79], a[28:31], v[76:79]
  ds_read_b64_tr_b16 a[60:61], v21 offset:34816
  v_mfma_f32_16x16x32_bf16 v[84:87], a[76:79], a[32:35], v[84:87]
  ds_read_b64_tr_b16 a[62:63], v21 offset:36864
  v_mfma_f32_16x16x32_bf16 v[88:91], a[20:23], a[80:83], v[88:91]
  buffer_load_dwordx4 v7, s[8:11], s30 offen offset:3072 lds
  v_mfma_f32_16x16x32_bf16 v[96:99], a[24:27], a[80:83], v[96:99]
  s_mul_i32 s31, s0, 393216
  s_bfe_u32 s29, 0x302010e, s1
  s_add_u32 s0, s0, s29
  v_mfma_f32_16x16x32_bf16 v[104:107], a[28:31], a[80:83], v[104:107]
  s_add_u32 s1, s1, 8
  s_and_b32 s1, s1, 0x8001f
  s_and_b32 s0, s0, 15
  v_mfma_f32_16x16x32_bf16 v[112:115], a[32:35], a[80:83], v[112:115]
  s_lshl_b32 s30, s0, 7
  s_add_u32 m0, s88, s26
  v_mfma_f32_16x16x32_bf16 v[120:123], a[36:39], a[80:83], v[120:123]
  buffer_load_dwordx4 v8, s[20:23], s31 offen offset:0 lds
  v_mfma_f32_16x16x32_bf16 v[92:95], a[20:23], a[84:87], v[92:95]
  v_mfma_f32_16x16x32_bf16 v[100:103], a[24:27], a[84:87], v[100:103]
  v_mfma_f32_16x16x32_bf16 v[108:111], a[28:31], a[84:87], v[108:111]
  v_mfma_f32_16x16x32_bf16 v[116:119], a[32:35], a[84:87], v[116:119]
  v_mfma_f32_16x16x32_bf16 v[124:127], a[36:39], a[84:87], v[124:127]
  s_waitcnt lgkmcnt(0)
  v_mfma_f32_16x16x32_bf16 v[24:27], a[40:43], a[0:3], v[24:27]
  buffer_load_dwordx4 v9, s[20:23], s31 offen offset:1024 lds
  ds_read_b128 a[20:23], v17 offset:0
  v_mfma_f32_16x16x32_bf16 v[32:35], a[40:43], a[4:7], v[32:35]
  ds_read_b64_tr_b16 a[64:65], v20 offset:22528
  ds_read_b64_tr_b16 a[66:67], v20 offset:24576
  v_mfma_f32_16x16x32_bf16 v[40:43], a[40:43], a[8:11], v[40:43]
  ds_read_b128 a[24:27], v17 offset:2048
  v_mfma_f32_16x16x32_bf16 v[48:51], a[40:43], a[12:15], v[48:51]
  buffer_load_dwordx4 v10, s[20:23], s31 offen offset:2048 lds
  ds_read_b128 a[28:31], v17 offset:4096
  v_mfma_f32_16x16x32_bf16 v[28:31], a[44:47], a[0:3], v[28:31]
  s_add_u32 m0, s88, s27
  ds_read_b128 a[32:35], v17 offset:6144
  v_mfma_f32_16x16x32_bf16 v[36:39], a[44:47], a[4:7], v[36:39]
  ds_read_b64_tr_b16 a[68:69], v21 offset:22528
  v_mfma_f32_16x16x32_bf16 v[44:47], a[44:47], a[8:11], v[44:47]
  buffer_load_dwordx4 v11, s[20:23], s31 offen offset:0 lds
  ds_read_b64_tr_b16 a[70:71], v21 offset:24576
  v_mfma_f32_16x16x32_bf16 v[52:55], a[44:47], a[12:15], v[52:55]
  ds_read_b64_tr_b16 a[72:73], v20 offset:30720
  v_mfma_f32_16x16x32_bf16 v[56:59], a[48:51], a[0:3], v[56:59]
  ds_read_b64_tr_b16 a[74:75], v20 offset:32768
  v_mfma_f32_16x16x32_bf16 v[64:67], a[48:51], a[4:7], v[64:67]
  buffer_load_dwordx4 v12, s[20:23], s31 offen offset:1024 lds
  ds_read_b64_tr_b16 a[76:77], v21 offset:30720
  v_mfma_f32_16x16x32_bf16 v[72:75], a[48:51], a[8:11], v[72:75]
  ds_read_b64_tr_b16 a[78:79], v21 offset:32768
  v_mfma_f32_16x16x32_bf16 v[80:83], a[48:51], a[12:15], v[80:83]
  ds_read_b64_tr_b16 a[80:81], v20 offset:38912
  v_mfma_f32_16x16x32_bf16 v[60:63], a[52:55], a[0:3], v[60:63]
  buffer_load_dwordx4 v13, s[20:23], s31 offen offset:2048 lds
  ds_read_b64_tr_b16 a[82:83], v20 offset:40960
  v_mfma_f32_16x16x32_bf16 v[68:71], a[52:55], a[4:7], v[68:71]
  s_add_u32 s60, s63, 32768
  ds_read_b128 a[36:39], v19 offset:0
  v_mfma_f32_16x16x32_bf16 v[76:79], a[52:55], a[8:11], v[76:79]
  ds_read_b64_tr_b16 a[84:85], v21 offset:38912
  v_mfma_f32_16x16x32_bf16 v[84:87], a[52:55], a[12:15], v[84:87]
  buffer_store_dwordx4 v[196:199], v2, s[16:19], s60 offen offset:1024 sc1
  ds_read_b64_tr_b16 a[86:87], v21 offset:40960
  v_mfma_f32_16x16x32_bf16 v[88:91], a[0:3], a[56:59], v[88:91]
  s_add_u32 s88, s88, s90
  s_add_u32 s89, s89, 1
  s_cmp_eq_u32 s89, 3
  s_cselect_b32 s89, 0, s89
  s_cselect_b32 s90, s91, s92
  v_mfma_f32_16x16x32_bf16 v[96:99], a[4:7], a[56:59], v[96:99]
  v_add_u32 v16, s90, v16
  v_add_u32 v17, s90, v17
  v_mfma_f32_16x16x32_bf16 v[104:107], a[8:11], a[56:59], v[104:107]
  v_add_u32 v18, s90, v18
  v_add_u32 v19, s90, v19
  v_mfma_f32_16x16x32_bf16 v[112:115], a[12:15], a[56:59], v[112:115]
  v_add_u32 v20, s90, v20
  v_add_u32 v21, s90, v21
  v_mfma_f32_16x16x32_bf16 v[120:123], a[16:19], a[56:59], v[120:123]
  v_mfma_f32_16x16x32_bf16 v[92:95], a[0:3], a[60:63], v[92:95]
  v_mfma_f32_16x16x32_bf16 v[100:103], a[4:7], a[60:63], v[100:103]
  v_mfma_f32_16x16x32_bf16 v[108:111], a[8:11], a[60:63], v[108:111]
  v_mfma_f32_16x16x32_bf16 v[116:119], a[12:15], a[60:63], v[116:119]
  v_mfma_f32_16x16x32_bf16 v[124:127], a[16:19], a[60:63], v[124:127]
  s_waitcnt vmcnt(13) lgkmcnt(0)
  s_barrier
  v_mfma_f32_16x16x32_bf16 v[24:27], a[64:67], a[20:23], v[24:27]
  buffer_load_dwordx4 a[192:195], v2, s[52:55], s51 offen offset:0
  ds_read_b128 a[0:3], v16 offset:0
  v_mfma_f32_16x16x32_bf16 v[32:35], a[64:67], a[24:27], v[32:35]
  s_add_u32 s51, s51, 1024
  s_mov_b32 m0, s88
  ds_read_b64_tr_b16 a[40:41], v20 offset:18432
  v_mfma_f32_16x16x32_bf16 v[40:43], a[64:67], a[28:31], v[40:43]
  ds_read_b64_tr_b16 a[42:43], v20 offset:20480
  ds_read_b128 a[4:7], v16 offset:2048
  v_mfma_f32_16x16x32_bf16 v[48:51], a[64:67], a[32:35], v[48:51]
  ds_read_b128 a[8:11], v16 offset:4096
  v_mfma_f32_16x16x32_bf16 v[28:31], a[68:71], a[20:23], v[28:31]
  buffer_load_dwordx4 v4, s[8:11], s30 offen offset:0 lds
  ds_read_b128 a[12:15], v16 offset:6144
  v_mfma_f32_16x16x32_bf16 v[36:39], a[68:71], a[24:27], v[36:39]
  ds_read_b64_tr_b16 a[44:45], v21 offset:18432
  v_mfma_f32_16x16x32_bf16 v[44:47], a[68:71], a[28:31], v[44:47]
  ds_read_b64_tr_b16 a[46:47], v21 offset:20480
  v_mfma_f32_16x16x32_bf16 v[52:55], a[68:71], a[32:35], v[52:55]
  ds_read_b64_tr_b16 a[48:49], v20 offset:26624
  v_mfma_f32_16x16x32_bf16 v[56:59], a[72:75], a[20:23], v[56:59]
  buffer_load_dwordx4 v5, s[8:11], s30 offen offset:1024 lds
  ds_read_b64_tr_b16 a[50:51], v20 offset:28672
  v_mfma_f32_16x16x32_bf16 v[64:67], a[72:75], a[24:27], v[64:67]
  ds_read_b64_tr_b16 a[52:53], v21 offset:26624
  v_mfma_f32_16x16x32_bf16 v[72:75], a[72:75], a[28:31], v[72:75]
  ds_read_b64_tr_b16 a[54:55], v21 offset:28672
  v_mfma_f32_16x16x32_bf16 v[80:83], a[72:75], a[32:35], v[80:83]
  ds_read_b64_tr_b16 a[56:57], v20 offset:34816
  v_mfma_f32_16x16x32_bf16 v[60:63], a[76:79], a[20:23], v[60:63]
  buffer_load_dwordx4 v6, s[8:11], s30 offen offset:2048 lds
  ds_read_b64_tr_b16 a[58:59], v20 offset:36864
  v_mfma_f32_16x16x32_bf16 v[68:71], a[76:79], a[24:27], v[68:71]
  ds_read_b128 a[16:19], v18 offset:0
  v_mfma_f32_16x16x32_bf16 v[76:79], a[76:79], a[28:31], v[76:79]
  ds_read_b64_tr_b16 a[60:61], v21 offset:34816
  v_mfma_f32_16x16x32_bf16 v[84:87], a[76:79], a[32:35], v[84:87]
  ds_read_b64_tr_b16 a[62:63], v21 offset:36864
  v_mfma_f32_16x16x32_bf16 v[88:91], a[20:23], a[80:83], v[88:91]
  buffer_load_dwordx4 v7, s[8:11], s30 offen offset:3072 lds
  v_mfma_f32_16x16x32_bf16 v[96:99], a[24:27], a[80:83], v[96:99]
  s_mul_i32 s31, s0, 393216
  s_bfe_u32 s29, 0x302010e, s1
  s_add_u32 s0, s0, s29
  v_mfma_f32_16x16x32_bf16 v[104:107], a[28:31], a[80:83], v[104:107]
  s_add_u32 s1, s1, 8
  s_and_b32 s1, s1, 0x8001f
  s_and_b32 s0, s0, 15
  v_mfma_f32_16x16x32_bf16 v[112:115], a[32:35], a[80:83], v[112:115]
  s_lshl_b32 s30, s0, 7
  s_add_u32 m0, s88, s26
  v_mfma_f32_16x16x32_bf16 v[120:123], a[36:39], a[80:83], v[120:123]
  buffer_load_dwordx4 v8, s[20:23], s31 offen offset:0 lds
  v_mfma_f32_16x16x32_bf16 v[92:95], a[20:23], a[84:87], v[92:95]
  v_mfma_f32_16x16x32_bf16 v[100:103], a[24:27], a[84:87], v[100:103]
  v_mfma_f32_16x16x32_bf16 v[108:111], a[28:31], a[84:87], v[108:111]
  v_mfma_f32_16x16x32_bf16 v[116:119], a[32:35], a[84:87], v[116:119]
  v_mfma_f32_16x16x32_bf16 v[124:127], a[36:39], a[84:87], v[124:127]
  s_waitcnt lgkmcnt(0)
  v_mfma_f32_16x16x32_bf16 v[24:27], a[40:43], a[0:3], v[24:27]
  buffer_load_dwordx4 v9, s[20:23], s31 offen offset:1024 lds
  ds_read_b128 a[20:23], v17 offset:0
  v_mfma_f32_16x16x32_bf16 v[32:35], a[40:43], a[4:7], v[32:35]
  ds_read_b64_tr_b16 a[64:65], v20 offset:22528
  ds_read_b64_tr_b16 a[66:67], v20 offset:24576
  v_mfma_f32_16x16x32_bf16 v[40:43], a[40:43], a[8:11], v[40:43]
  ds_read_b128 a[24:27], v17 offset:2048
  v_mfma_f32_16x16x32_bf16 v[48:51], a[40:43], a[12:15], v[48:51]
  buffer_load_dwordx4 v10, s[20:23], s31 offen offset:2048 lds
  ds_read_b128 a[28:31], v17 offset:4096
  v_mfma_f32_16x16x32_bf16 v[28:31], a[44:47], a[0:3], v[28:31]
  s_add_u32 m0, s88, s27
  ds_read_b128 a[32:35], v17 offset:6144
  v_mfma_f32_16x16x32_bf16 v[36:39], a[44:47], a[4:7], v[36:39]
  ds_read_b64_tr_b16 a[68:69], v21 offset:22528
  v_mfma_f32_16x16x32_bf16 v[44:47], a[44:47], a[8:11], v[44:47]
  buffer_load_dwordx4 v11, s[20:23], s31 offen offset:0 lds
  ds_read_b64_tr_b16 a[70:71], v21 offset:24576
  v_mfma_f32_16x16x32_bf16 v[52:55], a[44:47], a[12:15], v[52:55]
  ds_read_b64_tr_b16 a[72:73], v20 offset:30720
  v_mfma_f32_16x16x32_bf16 v[56:59], a[48:51], a[0:3], v[56:59]
  ds_read_b64_tr_b16 a[74:75], v20 offset:32768
  v_mfma_f32_16x16x32_bf16 v[64:67], a[48:51], a[4:7], v[64:67]
  buffer_load_dwordx4 v12, s[20:23], s31 offen offset:1024 lds
  ds_read_b64_tr_b16 a[76:77], v21 offset:30720
  v_mfma_f32_16x16x32_bf16 v[72:75], a[48:51], a[8:11], v[72:75]
  ds_read_b64_tr_b16 a[78:79], v21 offset:32768
  v_mfma_f32_16x16x32_bf16 v[80:83], a[48:51], a[12:15], v[80:83]
  ds_read_b64_tr_b16 a[80:81], v20 offset:38912
  v_mfma_f32_16x16x32_bf16 v[60:63], a[52:55], a[0:3], v[60:63]
  buffer_load_dwordx4 v13, s[20:23], s31 offen offset:2048 lds
  ds_read_b64_tr_b16 a[82:83], v20 offset:40960
  v_mfma_f32_16x16x32_bf16 v[68:71], a[52:55], a[4:7], v[68:71]
  s_add_u32 s60, s63, 32768
  ds_read_b128 a[36:39], v19 offset:0
  v_mfma_f32_16x16x32_bf16 v[76:79], a[52:55], a[8:11], v[76:79]
  ds_read_b64_tr_b16 a[84:85], v21 offset:38912
  v_mfma_f32_16x16x32_bf16 v[84:87], a[52:55], a[12:15], v[84:87]
  buffer_store_dwordx4 v[200:203], v2, s[16:19], s60 offen offset:2048 sc1
  ds_read_b64_tr_b16 a[86:87], v21 offset:40960
  v_mfma_f32_16x16x32_bf16 v[88:91], a[0:3], a[56:59], v[88:91]
  s_add_u32 s88, s88, s90
  s_add_u32 s89, s89, 1
  s_cmp_eq_u32 s89, 3
  s_cselect_b32 s89, 0, s89
  s_cselect_b32 s90, s91, s92
  v_mfma_f32_16x16x32_bf16 v[96:99], a[4:7], a[56:59], v[96:99]
  v_add_u32 v16, s90, v16
  v_add_u32 v17, s90, v17
  v_mfma_f32_16x16x32_bf16 v[104:107], a[8:11], a[56:59], v[104:107]
  v_add_u32 v18, s90, v18
  v_add_u32 v19, s90, v19
  v_mfma_f32_16x16x32_bf16 v[112:115], a[12:15], a[56:59], v[112:115]
  v_add_u32 v20, s90, v20
  v_add_u32 v21, s90, v21
  v_mfma_f32_16x16x32_bf16 v[120:123], a[16:19], a[56:59], v[120:123]
  v_mfma_f32_16x16x32_bf16 v[92:95], a[0:3], a[60:63], v[92:95]
  v_mfma_f32_16x16x32_bf16 v[100:103], a[4:7], a[60:63], v[100:103]
  v_mfma_f32_16x16x32_bf16 v[108:111], a[8:11], a[60:63], v[108:111]
  v_mfma_f32_16x16x32_bf16 v[116:119], a[12:15], a[60:63], v[116:119]
  v_mfma_f32_16x16x32_bf16 v[124:127], a[16:19], a[60:63], v[124:127]
  s_waitcnt vmcnt(13) lgkmcnt(0)
  s_barrier
  v_mfma_f32_16x16x32_bf16 v[24:27], a[64:67], a[20:23], v[24:27]
  s_mov_b32 m0, s88
  ds_read_b128 a[0:3], v16 offset:0
  ds_read_b64_tr_b16 a[40:41], v20 offset:18432
  v_mfma_f32_16x16x32_bf16 v[32:35], a[64:67], a[24:27], v[32:35]
  buffer_load_dwordx4 v4, s[8:11], s30 offen offset:0 lds
  ds_read_b64_tr_b16 a[42:43], v20 offset:20480
  v_mfma_f32_16x16x32_bf16 v[40:43], a[64:67], a[28:31], v[40:43]
  ds_read_b128 a[4:7], v16 offset:2048
  v_mfma_f32_16x16x32_bf16 v[48:51], a[64:67], a[32:35], v[48:51]
  ds_read_b128 a[8:11], v16 offset:4096
  v_mfma_f32_16x16x32_bf16 v[28:31], a[68:71], a[20:23], v[28:31]
  buffer_load_dwordx4 v5, s[8:11], s30 offen offset:1024 lds
  ds_read_b128 a[12:15], v16 offset:6144
  v_mfma_f32_16x16x32_bf16 v[36:39], a[68:71], a[24:27], v[36:39]
  ds_read_b64_tr_b16 a[44:45], v21 offset:18432
  v_mfma_f32_16x16x32_bf16 v[44:47], a[68:71], a[28:31], v[44:47]
  ds_read_b64_tr_b16 a[46:47], v21 offset:20480
  v_mfma_f32_16x16x32_bf16 v[52:55], a[68:71], a[32:35], v[52:55]
  ds_read_b64_tr_b16 a[48:49], v20 offset:26624
  v_mfma_f32_16x16x32_bf16 v[56:59], a[72:75], a[20:23], v[56:59]
  buffer_load_dwordx4 v6, s[8:11], s30 offen offset:2048 lds
  ds_read_b64_tr_b16 a[50:51], v20 offset:28672
  v_mfma_f32_16x16x32_bf16 v[64:67], a[72:75], a[24:27], v[64:67]
  ds_read_b64_tr_b16 a[52:53], v21 offset:26624
  v_mfma_f32_16x16x32_bf16 v[72:75], a[72:75], a[28:31], v[72:75]
  ds_read_b64_tr_b16 a[54:55], v21 offset:28672
  v_mfma_f32_16x16x32_bf16 v[80:83], a[72:75], a[32:35], v[80:83]
  ds_read_b64_tr_b16 a[56:57], v20 offset:34816
  v_mfma_f32_16x16x32_bf16 v[60:63], a[76:79], a[20:23], v[60:63]
  buffer_load_dwordx4 v7, s[8:11], s30 offen offset:3072 lds
  ds_read_b64_tr_b16 a[58:59], v20 offset:36864
  v_mfma_f32_16x16x32_bf16 v[68:71], a[76:79], a[24:27], v[68:71]
  s_mul_i32 s31, s0, 393216
  s_bfe_u32 s29, 0x302010e, s1
  s_add_u32 s0, s0, s29
  v_mfma_f32_16x16x32_bf16 v[76:79], a[76:79], a[28:31], v[76:79]
  s_add_u32 s1, s1, 8
  s_and_b32 s1, s1, 0x8001f
  s_and_b32 s0, s0, 15
  v_mfma_f32_16x16x32_bf16 v[84:87], a[76:79], a[32:35], v[84:87]
  s_lshl_b32 s30, s0, 7
  s_add_u32 m0, s88, s26
  ds_read_b128 a[16:19], v18 offset:0
  v_mfma_f32_16x16x32_bf16 v[88:91], a[20:23], a[80:83], v[88:91]
  buffer_load_dwordx4 v8, s[20:23], s31 offen offset:0 lds
  ds_read_b64_tr_b16 a[60:61], v21 offset:34816
  v_mfma_f32_16x16x32_bf16 v[96:99], a[24:27], a[80:83], v[96:99]
  ds_read_b64_tr_b16 a[62:63], v21 offset:36864
  v_mfma_f32_16x16x32_bf16 v[104:107], a[28:31], a[80:83], v[104:107]
  v_mfma_f32_16x16x32_bf16 v[112:115], a[32:35], a[80:83], v[112:115]
  v_mfma_f32_16x16x32_bf16 v[120:123], a[36:39], a[80:83], v[120:123]
  buffer_load_dwordx4 v9, s[20:23], s31 offen offset:1024 lds
  v_mfma_f32_16x16x32_bf16 v[92:95], a[20:23], a[84:87], v[92:95]
  v_mfma_f32_16x16x32_bf16 v[100:103], a[24:27], a[84:87], v[100:103]
  v_mfma_f32_16x16x32_bf16 v[108:111], a[28:31], a[84:87], v[108:111]
  v_mfma_f32_16x16x32_bf16 v[116:119], a[32:35], a[84:87], v[116:119]
  v_mfma_f32_16x16x32_bf16 v[124:127], a[36:39], a[84:87], v[124:127]
  s_waitcnt lgkmcnt(0)
  v_mfma_f32_16x16x32_bf16 v[24:27], a[40:43], a[0:3], v[24:27]
  buffer_load_dwordx4 v10, s[20:23], s31 offen offset:2048 lds
  ds_read_b128 a[20:23], v17 offset:0
  v_mfma_f32_16x16x32_bf16 v[32:35], a[40:43], a[4:7], v[32:35]
  s_add_u32 m0, s88, s27
  ds_read_b64_tr_b16 a[64:65], v20 offset:22528
  ds_read_b64_tr_b16 a[66:67], v20 offset:24576
  v_mfma_f32_16x16x32_bf16 v[40:43], a[40:43], a[8:11], v[40:43]
  ds_read_b128 a[24:27], v17 offset:2048
  v_mfma_f32_16x16x32_bf16 v[48:51], a[40:43], a[12:15], v[48:51]
  buffer_load_dwordx4 v11, s[20:23], s31 offen offset:0 lds
  ds_read_b128 a[28:31], v17 offset:4096
  v_mfma_f32_16x16x32_bf16 v[28:31], a[44:47], a[0:3], v[28:31]
  ds_read_b128 a[32:35], v17 offset:6144
  v_mfma_f32_16x16x32_bf16 v[36:39], a[44:47], a[4:7], v[36:39]
  ds_read_b64_tr_b16 a[68:69], v21 offset:22528
  v_mfma_f32_16x16x32_bf16 v[44:47], a[44:47], a[8:11], v[44:47]
  ds_read_b64_tr_b16 a[70:71], v21 offset:24576
  v_mfma_f32_16x16x32_bf16 v[52:55], a[44:47], a[12:15], v[52:55]
  buffer_load_dwordx4 v12, s[20:23], s31 offen offset:1024 lds
  ds_read_b64_tr_b16 a[72:73], v20 offset:30720
  v_mfma_f32_16x16x32_bf16 v[56:59], a[48:51], a[0:3], v[56:59]
  ds_read_b64_tr_b16 a[74:75], v20 offset:32768
  v_mfma_f32_16x16x32_bf16 v[64:67], a[48:51], a[4:7], v[64:67]
  ds_read_b64_tr_b16 a[76:77], v21 offset:30720
  v_mfma_f32_16x16x32_bf16 v[72:75], a[48:51], a[8:11], v[72:75]
  ds_read_b64_tr_b16 a[78:79], v21 offset:32768
  v_mfma_f32_16x16x32_bf16 v[80:83], a[48:51], a[12:15], v[80:83]
  buffer_load_dwordx4 v13, s[20:23], s31 offen offset:2048 lds
  ds_read_b64_tr_b16 a[80:81], v20 offset:38912
  v_mfma_f32_16x16x32_bf16 v[60:63], a[52:55], a[0:3], v[60:63]
  s_add_u32 s60, s63, 0
  ds_read_b64_tr_b16 a[82:83], v20 offset:40960
  v_mfma_f32_16x16x32_bf16 v[68:71], a[52:55], a[4:7], v[68:71]
  ds_read_b128 a[36:39], v19 offset:0
  v_mfma_f32_16x16x32_bf16 v[76:79], a[52:55], a[8:11], v[76:79]
  ds_read_b64_tr_b16 a[84:85], v21 offset:38912
  v_mfma_f32_16x16x32_bf16 v[84:87], a[52:55], a[12:15], v[84:87]
  buffer_store_dwordx4 v[160:163], v2, s[16:19], s60 offen offset:0 sc1
  ds_read_b64_tr_b16 a[86:87], v21 offset:40960
  v_mfma_f32_16x16x32_bf16 v[88:91], a[0:3], a[56:59], v[88:91]
  s_add_u32 s88, s88, s90
  s_add_u32 s89, s89, 1
  s_cmp_eq_u32 s89, 3
  s_cselect_b32 s89, 0, s89
  s_cselect_b32 s90, s91, s92
  v_mfma_f32_16x16x32_bf16 v[96:99], a[4:7], a[56:59], v[96:99]
  v_add_u32 v16, s90, v16
  v_add_u32 v17, s90, v17
  v_mfma_f32_16x16x32_bf16 v[104:107], a[8:11], a[56:59], v[104:107]
  v_add_u32 v18, s90, v18
  v_add_u32 v19, s90, v19
  v_mfma_f32_16x16x32_bf16 v[112:115], a[12:15], a[56:59], v[112:115]
  v_add_u32 v20, s90, v20
  v_add_u32 v21, s90, v21
  v_mfma_f32_16x16x32_bf16 v[120:123], a[16:19], a[56:59], v[120:123]
  v_mfma_f32_16x16x32_bf16 v[92:95], a[0:3], a[60:63], v[92:95]
  v_mfma_f32_16x16x32_bf16 v[100:103], a[4:7], a[60:63], v[100:103]
  v_mfma_f32_16x16x32_bf16 v[108:111], a[8:11], a[60:63], v[108:111]
  v_mfma_f32_16x16x32_bf16 v[116:119], a[12:15], a[60:63], v[116:119]
  v_mfma_f32_16x16x32_bf16 v[124:127], a[16:19], a[60:63], v[124:127]
  s_waitcnt vmcnt(12) lgkmcnt(0)
  s_barrier
  v_mfma_f32_16x16x32_bf16 v[24:27], a[64:67], a[20:23], v[24:27]
  s_mov_b32 m0, s88
  ds_read_b128 a[0:3], v16 offset:0
  ds_read_b64_tr_b16 a[40:41], v20 offset:18432
  v_mfma_f32_16x16x32_bf16 v[32:35], a[64:67], a[24:27], v[32:35]
  buffer_load_dwordx4 v4, s[8:11], s30 offen offset:0 lds
  ds_read_b64_tr_b16 a[42:43], v20 offset:20480
  v_mfma_f32_16x16x32_bf16 v[40:43], a[64:67], a[28:31], v[40:43]
  ds_read_b128 a[4:7], v16 offset:2048
  v_mfma_f32_16x16x32_bf16 v[48:51], a[64:67], a[32:35], v[48:51]
  ds_read_b128 a[8:11], v16 offset:4096
  v_mfma_f32_16x16x32_bf16 v[28:31], a[68:71], a[20:23], v[28:31]
  buffer_load_dwordx4 v5, s[8:11], s30 offen offset:1024 lds
  ds_read_b128 a[12:15], v16 offset:6144
  v_mfma_f32_16x16x32_bf16 v[36:39], a[68:71], a[24:27], v[36:39]
  ds_read_b64_tr_b16 a[44:45], v21 offset:18432
  v_mfma_f32_16x16x32_bf16 v[44:47], a[68:71], a[28:31], v[44:47]
  ds_read_b64_tr_b16 a[46:47], v21 offset:20480
  v_mfma_f32_16x16x32_bf16 v[52:55], a[68:71], a[32:35], v[52:55]
  ds_read_b64_tr_b16 a[48:49], v20 offset:26624
  v_mfma_f32_16x16x32_bf16 v[56:59], a[72:75], a[20:23], v[56:59]
  buffer_load_dwordx4 v6, s[8:11], s30 offen offset:2048 lds
  ds_read_b64_tr_b16 a[50:51], v20 offset:28672
  v_mfma_f32_16x16x32_bf16 v[64:67], a[72:75], a[24:27], v[64:67]
  ds_read_b64_tr_b16 a[52:53], v21 offset:26624
  v_mfma_f32_16x16x32_bf16 v[72:75], a[72:75], a[28:31], v[72:75]
  ds_read_b64_tr_b16 a[54:55], v21 offset:28672
  v_mfma_f32_16x16x32_bf16 v[80:83], a[72:75], a[32:35], v[80:83]
  ds_read_b64_tr_b16 a[56:57], v20 offset:34816
  v_mfma_f32_16x16x32_bf16 v[60:63], a[76:79], a[20:23], v[60:63]
  buffer_load_dwordx4 v7, s[8:11], s30 offen offset:3072 lds
  ds_read_b64_tr_b16 a[58:59], v20 offset:36864
  v_mfma_f32_16x16x32_bf16 v[68:71], a[76:79], a[24:27], v[68:71]
  s_mul_i32 s31, s0, 393216
  s_bfe_u32 s29, 0x302010e, s1
  s_add_u32 s0, s0, s29
  v_mfma_f32_16x16x32_bf16 v[76:79], a[76:79], a[28:31], v[76:79]
  s_add_u32 s1, s1, 8
  s_and_b32 s1, s1, 0x8001f
  s_and_b32 s0, s0, 15
  v_mfma_f32_16x16x32_bf16 v[84:87], a[76:79], a[32:35], v[84:87]
  s_lshl_b32 s30, s0, 7
  s_add_u32 m0, s88, s26
  ds_read_b128 a[16:19], v18 offset:0
  v_mfma_f32_16x16x32_bf16 v[88:91], a[20:23], a[80:83], v[88:91]
  buffer_load_dwordx4 v8, s[20:23], s31 offen offset:0 lds
  ds_read_b64_tr_b16 a[60:61], v21 offset:34816
  v_mfma_f32_16x16x32_bf16 v[96:99], a[24:27], a[80:83], v[96:99]
  ds_read_b64_tr_b16 a[62:63], v21 offset:36864
  v_mfma_f32_16x16x32_bf16 v[104:107], a[28:31], a[80:83], v[104:107]
  v_mfma_f32_16x16x32_bf16 v[112:115], a[32:35], a[80:83], v[112:115]
  v_mfma_f32_16x16x32_bf16 v[120:123], a[36:39], a[80:83], v[120:123]
  buffer_load_dwordx4 v9, s[20:23], s31 offen offset:1024 lds
  v_mfma_f32_16x16x32_bf16 v[92:95], a[20:23], a[84:87], v[92:95]
  v_mfma_f32_16x16x32_bf16 v[100:103], a[24:27], a[84:87], v[100:103]
  v_mfma_f32_16x16x32_bf16 v[108:111], a[28:31], a[84:87], v[108:111]
  v_mfma_f32_16x16x32_bf16 v[116:119], a[32:35], a[84:87], v[116:119]
  v_mfma_f32_16x16x32_bf16 v[124:127], a[36:39], a[84:87], v[124:127]
  s_waitcnt lgkmcnt(0)
  v_mfma_f32_16x16x32_bf16 v[24:27], a[40:43], a[0:3], v[24:27]
  buffer_load_dwordx4 v10, s[20:23], s31 offen offset:2048 lds
  ds_read_b128 a[20:23], v17 offset:0
  v_mfma_f32_16x16x32_bf16 v[32:35], a[40:43], a[4:7], v[32:35]
  s_add_u32 m0, s88, s27
  ds_read_b64_tr_b16 a[64:65], v20 offset:22528
  ds_read_b64_tr_b16 a[66:67], v20 offset:24576
  v_mfma_f32_16x16x32_bf16 v[40:43], a[40:43], a[8:11], v[40:43]
  ds_read_b128 a[24:27], v17 offset:2048
  v_mfma_f32_16x16x32_bf16 v[48:51], a[40:43], a[12:15], v[48:51]
  buffer_load_dwordx4 v11, s[20:23], s31 offen offset:0 lds
  ds_read_b128 a[28:31], v17 offset:4096
  v_mfma_f32_16x16x32_bf16 v[28:31], a[44:47], a[0:3], v[28:31]
  ds_read_b128 a[32:35], v17 offset:6144
  v_mfma_f32_16x16x32_bf16 v[36:39], a[44:47], a[4:7], v[36:39]
  ds_read_b64_tr_b16 a[68:69], v21 offset:22528
  v_mfma_f32_16x16x32_bf16 v[44:47], a[44:47], a[8:11], v[44:47]
  ds_read_b64_tr_b16 a[70:71], v21 offset:24576
  v_mfma_f32_16x16x32_bf16 v[52:55], a[44:47], a[12:15], v[52:55]
  buffer_load_dwordx4 v12, s[20:23], s31 offen offset:1024 lds
  ds_read_b64_tr_b16 a[72:73], v20 offset:30720
  v_mfma_f32_16x16x32_bf16 v[56:59], a[48:51], a[0:3], v[56:59]
  ds_read_b64_tr_b16 a[74:75], v20 offset:32768
  v_mfma_f32_16x16x32_bf16 v[64:67], a[48:51], a[4:7], v[64:67]
  ds_read_b64_tr_b16 a[76:77], v21 offset:30720
  v_mfma_f32_16x16x32_bf16 v[72:75], a[48:51], a[8:11], v[72:75]
  ds_read_b64_tr_b16 a[78:79], v21 offset:32768
  v_mfma_f32_16x16x32_bf16 v[80:83], a[48:51], a[12:15], v[80:83]
  buffer_load_dwordx4 v13, s[20:23], s31 offen offset:2048 lds
  ds_read_b64_tr_b16 a[80:81], v20 offset:38912
  v_mfma_f32_16x16x32_bf16 v[60:63], a[52:55], a[0:3], v[60:63]
  s_add_u32 s60, s63, 0
  ds_read_b64_tr_b16 a[82:83], v20 offset:40960
  v_mfma_f32_16x16x32_bf16 v[68:71], a[52:55], a[4:7], v[68:71]
  ds_read_b128 a[36:39], v19 offset:0
  v_mfma_f32_16x16x32_bf16 v[76:79], a[52:55], a[8:11], v[76:79]
  ds_read_b64_tr_b16 a[84:85], v21 offset:38912
  v_mfma_f32_16x16x32_bf16 v[84:87], a[52:55], a[12:15], v[84:87]
  buffer_store_dwordx4 v[164:167], v2, s[16:19], s60 offen offset:1024 sc1
  ds_read_b64_tr_b16 a[86:87], v21 offset:40960
  v_mfma_f32_16x16x32_bf16 v[88:91], a[0:3], a[56:59], v[88:91]
  s_add_u32 s88, s88, s90
  s_add_u32 s89, s89, 1
  s_cmp_eq_u32 s89, 3
  s_cselect_b32 s89, 0, s89
  s_cselect_b32 s90, s91, s92
  v_mfma_f32_16x16x32_bf16 v[96:99], a[4:7], a[56:59], v[96:99]
  v_add_u32 v16, s90, v16
  v_add_u32 v17, s90, v17
  v_mfma_f32_16x16x32_bf16 v[104:107], a[8:11], a[56:59], v[104:107]
  v_add_u32 v18, s90, v18
  v_add_u32 v19, s90, v19
  v_mfma_f32_16x16x32_bf16 v[112:115], a[12:15], a[56:59], v[112:115]
  v_add_u32 v20, s90, v20
  v_add_u32 v21, s90, v21
  v_mfma_f32_16x16x32_bf16 v[120:123], a[16:19], a[56:59], v[120:123]
  v_mfma_f32_16x16x32_bf16 v[92:95], a[0:3], a[60:63], v[92:95]
  v_mfma_f32_16x16x32_bf16 v[100:103], a[4:7], a[60:63], v[100:103]
  v_mfma_f32_16x16x32_bf16 v[108:111], a[8:11], a[60:63], v[108:111]
  v_mfma_f32_16x16x32_bf16 v[116:119], a[12:15], a[60:63], v[116:119]
  v_mfma_f32_16x16x32_bf16 v[124:127], a[16:19], a[60:63], v[124:127]
  s_waitcnt vmcnt(12) lgkmcnt(0)
  s_barrier
  v_mfma_f32_16x16x32_bf16 v[24:27], a[64:67], a[20:23], v[24:27]
  s_mov_b32 m0, s88
  ds_read_b128 a[0:3], v16 offset:0
  ds_read_b64_tr_b16 a[40:41], v20 offset:18432
  v_mfma_f32_16x16x32_bf16 v[32:35], a[64:67], a[24:27], v[32:35]
  buffer_load_dwordx4 v4, s[8:11], s30 offen offset:0 lds
  ds_read_b64_tr_b16 a[42:43], v20 offset:20480
  v_mfma_f32_16x16x32_bf16 v[40:43], a[64:67], a[28:31], v[40:43]
  ds_read_b128 a[4:7], v16 offset:2048
  v_mfma_f32_16x16x32_bf16 v[48:51], a[64:67], a[32:35], v[48:51]
  ds_read_b128 a[8:11], v16 offset:4096
  v_mfma_f32_16x16x32_bf16 v[28:31], a[68:71], a[20:23], v[28:31]
  buffer_load_dwordx4 v5, s[8:11], s30 offen offset:1024 lds
  ds_read_b128 a[12:15], v16 offset:6144
  v_mfma_f32_16x16x32_bf16 v[36:39], a[68:71], a[24:27], v[36:39]
  ds_read_b64_tr_b16 a[44:45], v21 offset:18432
  v_mfma_f32_16x16x32_bf16 v[44:47], a[68:71], a[28:31], v[44:47]
  ds_read_b64_tr_b16 a[46:47], v21 offset:20480
  v_mfma_f32_16x16x32_bf16 v[52:55], a[68:71], a[32:35], v[52:55]
  ds_read_b64_tr_b16 a[48:49], v20 offset:26624
  v_mfma_f32_16x16x32_bf16 v[56:59], a[72:75], a[20:23], v[56:59]
  buffer_load_dwordx4 v6, s[8:11], s30 offen offset:2048 lds
  ds_read_b64_tr_b16 a[50:51], v20 offset:28672
  v_mfma_f32_16x16x32_bf16 v[64:67], a[72:75], a[24:27], v[64:67]
  ds_read_b64_tr_b16 a[52:53], v21 offset:26624
  v_mfma_f32_16x16x32_bf16 v[72:75], a[72:75], a[28:31], v[72:75]
  ds_read_b64_tr_b16 a[54:55], v21 offset:28672
  v_mfma_f32_16x16x32_bf16 v[80:83], a[72:75], a[32:35], v[80:83]
  ds_read_b64_tr_b16 a[56:57], v20 offset:34816
  v_mfma_f32_16x16x32_bf16 v[60:63], a[76:79], a[20:23], v[60:63]
  buffer_load_dwordx4 v7, s[8:11], s30 offen offset:3072 lds
  ds_read_b64_tr_b16 a[58:59], v20 offset:36864
  v_mfma_f32_16x16x32_bf16 v[68:71], a[76:79], a[24:27], v[68:71]
  s_mul_i32 s31, s0, 393216
  s_bfe_u32 s29, 0x302010e, s1
  s_add_u32 s0, s0, s29
  v_mfma_f32_16x16x32_bf16 v[76:79], a[76:79], a[28:31], v[76:79]
  s_add_u32 s1, s1, 8
  s_and_b32 s1, s1, 0x8001f
  s_and_b32 s0, s0, 15
  v_mfma_f32_16x16x32_bf16 v[84:87], a[76:79], a[32:35], v[84:87]
  s_lshl_b32 s30, s0, 7
  s_add_u32 m0, s88, s26
  ds_read_b128 a[16:19], v18 offset:0
  v_mfma_f32_16x16x32_bf16 v[88:91], a[20:23], a[80:83], v[88:91]
  buffer_load_dwordx4 v8, s[20:23], s31 offen offset:0 lds
  ds_read_b64_tr_b16 a[60:61], v21 offset:34816
  v_mfma_f32_16x16x32_bf16 v[96:99], a[24:27], a[80:83], v[96:99]
  ds_read_b64_tr_b16 a[62:63], v21 offset:36864
  v_mfma_f32_16x16x32_bf16 v[104:107], a[28:31], a[80:83], v[104:107]
  v_mfma_f32_16x16x32_bf16 v[112:115], a[32:35], a[80:83], v[112:115]
  v_mfma_f32_16x16x32_bf16 v[120:123], a[36:39], a[80:83], v[120:123]
  buffer_load_dwordx4 v9, s[20:23], s31 offen offset:1024 lds
  v_mfma_f32_16x16x32_bf16 v[92:95], a[20:23], a[84:87], v[92:95]
  v_mfma_f32_16x16x32_bf16 v[100:103], a[24:27], a[84:87], v[100:103]
  v_mfma_f32_16x16x32_bf16 v[108:111], a[28:31], a[84:87], v[108:111]
  v_mfma_f32_16x16x32_bf16 v[116:119], a[32:35], a[84:87], v[116:119]
  v_mfma_f32_16x16x32_bf16 v[124:127], a[36:39], a[84:87], v[124:127]
  s_waitcnt lgkmcnt(0)
  v_mfma_f32_16x16x32_bf16 v[24:27], a[40:43], a[0:3], v[24:27]
  buffer_load_dwordx4 v10, s[20:23], s31 offen offset:2048 lds
  ds_read_b128 a[20:23], v17 offset:0
  v_mfma_f32_16x16x32_bf16 v[32:35], a[40:43], a[4:7], v[32:35]
  s_add_u32 m0, s88, s27
  ds_read_b64_tr_b16 a[64:65], v20 offset:22528
  ds_read_b64_tr_b16 a[66:67], v20 offset:24576
  v_mfma_f32_16x16x32_bf16 v[40:43], a[40:43], a[8:11], v[40:43]
  ds_read_b128 a[24:27], v17 offset:2048
  v_mfma_f32_16x16x32_bf16 v[48:51], a[40:43], a[12:15], v[48:51]
  buffer_load_dwordx4 v11, s[20:23], s31 offen offset:0 lds
  ds_read_b128 a[28:31], v17 offset:4096
  v_mfma_f32_16x16x32_bf16 v[28:31], a[44:47], a[0:3], v[28:31]
  ds_read_b128 a[32:35], v17 offset:6144
  v_mfma_f32_16x16x32_bf16 v[36:39], a[44:47], a[4:7], v[36:39]
  ds_read_b64_tr_b16 a[68:69], v21 offset:22528
  v_mfma_f32_16x16x32_bf16 v[44:47], a[44:47], a[8:11], v[44:47]
  ds_read_b64_tr_b16 a[70:71], v21 offset:24576
  v_mfma_f32_16x16x32_bf16 v[52:55], a[44:47], a[12:15], v[52:55]
  buffer_load_dwordx4 v12, s[20:23], s31 offen offset:1024 lds
  ds_read_b64_tr_b16 a[72:73], v20 offset:30720
  v_mfma_f32_16x16x32_bf16 v[56:59], a[48:51], a[0:3], v[56:59]
  ds_read_b64_tr_b16 a[74:75], v20 offset:32768
  v_mfma_f32_16x16x32_bf16 v[64:67], a[48:51], a[4:7], v[64:67]
  ds_read_b64_tr_b16 a[76:77], v21 offset:30720
  v_mfma_f32_16x16x32_bf16 v[72:75], a[48:51], a[8:11], v[72:75]
  ds_read_b64_tr_b16 a[78:79], v21 offset:32768
  v_mfma_f32_16x16x32_bf16 v[80:83], a[48:51], a[12:15], v[80:83]
  buffer_load_dwordx4 v13, s[20:23], s31 offen offset:2048 lds
  ds_read_b64_tr_b16 a[80:81], v20 offset:38912
  v_mfma_f32_16x16x32_bf16 v[60:63], a[52:55], a[0:3], v[60:63]
  s_add_u32 s60, s63, 0
  ds_read_b64_tr_b16 a[82:83], v20 offset:40960
  v_mfma_f32_16x16x32_bf16 v[68:71], a[52:55], a[4:7], v[68:71]
  ds_read_b128 a[36:39], v19 offset:0
  v_mfma_f32_16x16x32_bf16 v[76:79], a[52:55], a[8:11], v[76:79]
  ds_read_b64_tr_b16 a[84:85], v21 offset:38912
  v_mfma_f32_16x16x32_bf16 v[84:87], a[52:55], a[12:15], v[84:87]
  buffer_store_dwordx4 v[168:171], v2, s[16:19], s60 offen offset:2048 sc1
  ds_read_b64_tr_b16 a[86:87], v21 offset:40960
  v_mfma_f32_16x16x32_bf16 v[88:91], a[0:3], a[56:59], v[88:91]
  s_add_u32 s88, s88, s90
  s_add_u32 s89, s89, 1
  s_cmp_eq_u32 s89, 3
  s_cselect_b32 s89, 0, s89
  s_cselect_b32 s90, s91, s92
  v_mfma_f32_16x16x32_bf16 v[96:99], a[4:7], a[56:59], v[96:99]
  v_add_u32 v16, s90, v16
  v_add_u32 v17, s90, v17
  v_mfma_f32_16x16x32_bf16 v[104:107], a[8:11], a[56:59], v[104:107]
  v_add_u32 v18, s90, v18
  v_add_u32 v19, s90, v19
  v_mfma_f32_16x16x32_bf16 v[112:115], a[12:15], a[56:59], v[112:115]
  v_add_u32 v20, s90, v20
  v_add_u32 v21, s90, v21
  v_mfma_f32_16x16x32_bf16 v[120:123], a[16:19], a[56:59], v[120:123]
  v_mfma_f32_16x16x32_bf16 v[92:95], a[0:3], a[60:63], v[92:95]
  v_mfma_f32_16x16x32_bf16 v[100:103], a[4:7], a[60:63], v[100:103]
  v_mfma_f32_16x16x32_bf16 v[108:111], a[8:11], a[60:63], v[108:111]
  v_mfma_f32_16x16x32_bf16 v[116:119], a[12:15], a[60:63], v[116:119]
  v_mfma_f32_16x16x32_bf16 v[124:127], a[16:19], a[60:63], v[124:127]
  s_waitcnt vmcnt(12) lgkmcnt(0)
  s_barrier
  v_mfma_f32_16x16x32_bf16 v[24:27], a[64:67], a[20:23], v[24:27]
  s_mov_b32 m0, s88
  ds_read_b128 a[0:3], v16 offset:0
  ds_read_b64_tr_b16 a[40:41], v20 offset:18432
  v_mfma_f32_16x16x32_bf16 v[32:35], a[64:67], a[24:27], v[32:35]
  buffer_load_dwordx4 v4, s[8:11], s30 offen offset:0 lds
  ds_read_b64_tr_b16 a[42:43], v20 offset:20480
  v_mfma_f32_16x16x32_bf16 v[40:43], a[64:67], a[28:31], v[40:43]
  ds_read_b128 a[4:7], v16 offset:2048
  v_mfma_f32_16x16x32_bf16 v[48:51], a[64:67], a[32:35], v[48:51]
  ds_read_b128 a[8:11], v16 offset:4096
  v_mfma_f32_16x16x32_bf16 v[28:31], a[68:71], a[20:23], v[28:31]
  buffer_load_dwordx4 v5, s[8:11], s30 offen offset:1024 lds
  ds_read_b128 a[12:15], v16 offset:6144
  v_mfma_f32_16x16x32_bf16 v[36:39], a[68:71], a[24:27], v[36:39]
  ds_read_b64_tr_b16 a[44:45], v21 offset:18432
  v_mfma_f32_16x16x32_bf16 v[44:47], a[68:71], a[28:31], v[44:47]
  ds_read_b64_tr_b16 a[46:47], v21 offset:20480
  v_mfma_f32_16x16x32_bf16 v[52:55], a[68:71], a[32:35], v[52:55]
  ds_read_b64_tr_b16 a[48:49], v20 offset:26624
  v_mfma_f32_16x16x32_bf16 v[56:59], a[72:75], a[20:23], v[56:59]
  buffer_load_dwordx4 v6, s[8:11], s30 offen offset:2048 lds
  ds_read_b64_tr_b16 a[50:51], v20 offset:28672
  v_mfma_f32_16x16x32_bf16 v[64:67], a[72:75], a[24:27], v[64:67]
  ds_read_b64_tr_b16 a[52:53], v21 offset:26624
  v_mfma_f32_16x16x32_bf16 v[72:75], a[72:75], a[28:31], v[72:75]
  ds_read_b64_tr_b16 a[54:55], v21 offset:28672
  v_mfma_f32_16x16x32_bf16 v[80:83], a[72:75], a[32:35], v[80:83]
  ds_read_b64_tr_b16 a[56:57], v20 offset:34816
  v_mfma_f32_16x16x32_bf16 v[60:63], a[76:79], a[20:23], v[60:63]
  buffer_load_dwordx4 v7, s[8:11], s30 offen offset:3072 lds
  ds_read_b64_tr_b16 a[58:59], v20 offset:36864
  v_mfma_f32_16x16x32_bf16 v[68:71], a[76:79], a[24:27], v[68:71]
  s_mul_i32 s31, s0, 393216
  s_bfe_u32 s29, 0x302010e, s1
  s_add_u32 s0, s0, s29
  v_mfma_f32_16x16x32_bf16 v[76:79], a[76:79], a[28:31], v[76:79]
  s_add_u32 s1, s1, 8
  s_and_b32 s1, s1, 0x8001f
  s_and_b32 s0, s0, 15
  v_mfma_f32_16x16x32_bf16 v[84:87], a[76:79], a[32:35], v[84:87]
  s_lshl_b32 s30, s0, 7
  s_add_u32 m0, s88, s26
  ds_read_b128 a[16:19], v18 offset:0
  v_mfma_f32_16x16x32_bf16 v[88:91], a[20:23], a[80:83], v[88:91]
  buffer_load_dwordx4 v8, s[20:23], s31 offen offset:0 lds
  ds_read_b64_tr_b16 a[60:61], v21 offset:34816
  v_mfma_f32_16x16x32_bf16 v[96:99], a[24:27], a[80:83], v[96:99]
  ds_read_b64_tr_b16 a[62:63], v21 offset:36864
  v_mfma_f32_16x16x32_bf16 v[104:107], a[28:31], a[80:83], v[104:107]
  v_mfma_f32_16x16x32_bf16 v[112:115], a[32:35], a[80:83], v[112:115]
  v_mfma_f32_16x16x32_bf16 v[120:123], a[36:39], a[80:83], v[120:123]
  buffer_load_dwordx4 v9, s[20:23], s31 offen offset:1024 lds
  v_mfma_f32_16x16x32_bf16 v[92:95], a[20:23], a[84:87], v[92:95]
  v_mfma_f32_16x16x32_bf16 v[100:103], a[24:27], a[84:87], v[100:103]
  v_mfma_f32_16x16x32_bf16 v[108:111], a[28:31], a[84:87], v[108:111]
  v_mfma_f32_16x16x32_bf16 v[116:119], a[32:35], a[84:87], v[116:119]
  v_mfma_f32_16x16x32_bf16 v[124:127], a[36:39], a[84:87], v[124:127]
  s_waitcnt lgkmcnt(0)
  v_mfma_f32_16x16x32_bf16 v[24:27], a[40:43], a[0:3], v[24:27]
  buffer_load_dwordx4 v10, s[20:23], s31 offen offset:2048 lds
  ds_read_b128 a[20:23], v17 offset:0
  v_mfma_f32_16x16x32_bf16 v[32:35], a[40:43], a[4:7], v[32:35]
  s_add_u32 m0, s88, s27
  ds_read_b64_tr_b16 a[64:65], v20 offset:22528
  ds_read_b64_tr_b16 a[66:67], v20 offset:24576
  v_mfma_f32_16x16x32_bf16 v[40:43], a[40:43], a[8:11], v[40:43]
  ds_read_b128 a[24:27], v17 offset:2048
  v_mfma_f32_16x16x32_bf16 v[48:51], a[40:43], a[12:15], v[48:51]
  buffer_load_dwordx4 v11, s[20:23], s31 offen offset:0 lds
  ds_read_b128 a[28:31], v17 offset:4096
  v_mfma_f32_16x16x32_bf16 v[28:31], a[44:47], a[0:3], v[28:31]
  ds_read_b128 a[32:35], v17 offset:6144
  v_mfma_f32_16x16x32_bf16 v[36:39], a[44:47], a[4:7], v[36:39]
  ds_read_b64_tr_b16 a[68:69], v21 offset:22528
  v_mfma_f32_16x16x32_bf16 v[44:47], a[44:47], a[8:11], v[44:47]
  ds_read_b64_tr_b16 a[70:71], v21 offset:24576
  v_mfma_f32_16x16x32_bf16 v[52:55], a[44:47], a[12:15], v[52:55]
  buffer_load_dwordx4 v12, s[20:23], s31 offen offset:1024 lds
  ds_read_b64_tr_b16 a[72:73], v20 offset:30720
  v_mfma_f32_16x16x32_bf16 v[56:59], a[48:51], a[0:3], v[56:59]
  ds_read_b64_tr_b16 a[74:75], v20 offset:32768
  v_mfma_f32_16x16x32_bf16 v[64:67], a[48:51], a[4:7], v[64:67]
  ds_read_b64_tr_b16 a[76:77], v21 offset:30720
  v_mfma_f32_16x16x32_bf16 v[72:75], a[48:51], a[8:11], v[72:75]
  ds_read_b64_tr_b16 a[78:79], v21 offset:32768
  v_mfma_f32_16x16x32_bf16 v[80:83], a[48:51], a[12:15], v[80:83]
  buffer_load_dwordx4 v13, s[20:23], s31 offen offset:2048 lds
  ds_read_b64_tr_b16 a[80:81], v20 offset:38912
  v_mfma_f32_16x16x32_bf16 v[60:63], a[52:55], a[0:3], v[60:63]
  s_add_u32 s60, s63, 0
  ds_read_b64_tr_b16 a[82:83], v20 offset:40960
  v_mfma_f32_16x16x32_bf16 v[68:71], a[52:55], a[4:7], v[68:71]
  ds_read_b128 a[36:39], v19 offset:0
  v_mfma_f32_16x16x32_bf16 v[76:79], a[52:55], a[8:11], v[76:79]
  ds_read_b64_tr_b16 a[84:85], v21 offset:38912
  v_mfma_f32_16x16x32_bf16 v[84:87], a[52:55], a[12:15], v[84:87]
  buffer_store_dwordx4 v[172:175], v2, s[16:19], s60 offen offset:3072 sc1
  ds_read_b64_tr_b16 a[86:87], v21 offset:40960
  v_mfma_f32_16x16x32_bf16 v[88:91], a[0:3], a[56:59], v[88:91]
  s_add_u32 s88, s88, s90
  s_add_u32 s89, s89, 1
  s_cmp_eq_u32 s89, 3
  s_cselect_b32 s89, 0, s89
  s_cselect_b32 s90, s91, s92
  v_mfma_f32_16x16x32_bf16 v[96:99], a[4:7], a[56:59], v[96:99]
  v_add_u32 v16, s90, v16
  v_add_u32 v17, s90, v17
  v_mfma_f32_16x16x32_bf16 v[104:107], a[8:11], a[56:59], v[104:107]
  v_add_u32 v18, s90, v18
  v_add_u32 v19, s90, v19
  v_mfma_f32_16x16x32_bf16 v[112:115], a[12:15], a[56:59], v[112:115]
  v_add_u32 v20, s90, v20
  v_add_u32 v21, s90, v21
  v_mfma_f32_16x16x32_bf16 v[120:123], a[16:19], a[56:59], v[120:123]
  v_mfma_f32_16x16x32_bf16 v[92:95], a[0:3], a[60:63], v[92:95]
  v_mfma_f32_16x16x32_bf16 v[100:103], a[4:7], a[60:63], v[100:103]
  v_mfma_f32_16x16x32_bf16 v[108:111], a[8:11], a[60:63], v[108:111]
  v_mfma_f32_16x16x32_bf16 v[116:119], a[12:15], a[60:63], v[116:119]
  v_mfma_f32_16x16x32_bf16 v[124:127], a[16:19], a[60:63], v[124:127]
  s_waitcnt vmcnt(12) lgkmcnt(0)
  s_barrier
  v_mfma_f32_16x16x32_bf16 v[24:27], a[64:67], a[20:23], v[24:27]
  s_mov_b32 m0, s88
  ds_read_b128 a[0:3], v16 offset:0
  ds_read_b64_tr_b16 a[40:41], v20 offset:18432
  v_mfma_f32_16x16x32_bf16 v[32:35], a[64:67], a[24:27], v[32:35]
  buffer_load_dwordx4 v4, s[8:11], s30 offen offset:0 lds
  ds_read_b64_tr_b16 a[42:43], v20 offset:20480
  v_mfma_f32_16x16x32_bf16 v[40:43], a[64:67], a[28:31], v[40:43]
  ds_read_b128 a[4:7], v16 offset:2048
  v_mfma_f32_16x16x32_bf16 v[48:51], a[64:67], a[32:35], v[48:51]
  ds_read_b128 a[8:11], v16 offset:4096
  v_mfma_f32_16x16x32_bf16 v[28:31], a[68:71], a[20:23], v[28:31]
  buffer_load_dwordx4 v5, s[8:11], s30 offen offset:1024 lds
  ds_read_b128 a[12:15], v16 offset:6144
  v_mfma_f32_16x16x32_bf16 v[36:39], a[68:71], a[24:27], v[36:39]
  ds_read_b64_tr_b16 a[44:45], v21 offset:18432
  v_mfma_f32_16x16x32_bf16 v[44:47], a[68:71], a[28:31], v[44:47]
  ds_read_b64_tr_b16 a[46:47], v21 offset:20480
  v_mfma_f32_16x16x32_bf16 v[52:55], a[68:71], a[32:35], v[52:55]
  ds_read_b64_tr_b16 a[48:49], v20 offset:26624
  v_mfma_f32_16x16x32_bf16 v[56:59], a[72:75], a[20:23], v[56:59]
  buffer_load_dwordx4 v6, s[8:11], s30 offen offset:2048 lds
  ds_read_b64_tr_b16 a[50:51], v20 offset:28672
  v_mfma_f32_16x16x32_bf16 v[64:67], a[72:75], a[24:27], v[64:67]
  ds_read_b64_tr_b16 a[52:53], v21 offset:26624
  v_mfma_f32_16x16x32_bf16 v[72:75], a[72:75], a[28:31], v[72:75]
  ds_read_b64_tr_b16 a[54:55], v21 offset:28672
  v_mfma_f32_16x16x32_bf16 v[80:83], a[72:75], a[32:35], v[80:83]
  ds_read_b64_tr_b16 a[56:57], v20 offset:34816
  v_mfma_f32_16x16x32_bf16 v[60:63], a[76:79], a[20:23], v[60:63]
  buffer_load_dwordx4 v7, s[8:11], s30 offen offset:3072 lds
  ds_read_b64_tr_b16 a[58:59], v20 offset:36864
  v_mfma_f32_16x16x32_bf16 v[68:71], a[76:79], a[24:27], v[68:71]
  s_mul_i32 s31, s0, 393216
  s_bfe_u32 s29, 0x302010e, s1
  s_add_u32 s0, s0, s29
  v_mfma_f32_16x16x32_bf16 v[76:79], a[76:79], a[28:31], v[76:79]
  s_add_u32 s1, s1, 8
  s_and_b32 s1, s1, 0x8001f
  s_and_b32 s0, s0, 15
  v_mfma_f32_16x16x32_bf16 v[84:87], a[76:79], a[32:35], v[84:87]
  s_lshl_b32 s30, s0, 7
  s_add_u32 m0, s88, s26
  ds_read_b128 a[16:19], v18 offset:0
  v_mfma_f32_16x16x32_bf16 v[88:91], a[20:23], a[80:83], v[88:91]
  buffer_load_dwordx4 v8, s[20:23], s31 offen offset:0 lds
  ds_read_b64_tr_b16 a[60:61], v21 offset:34816
  v_mfma_f32_16x16x32_bf16 v[96:99], a[24:27], a[80:83], v[96:99]
  ds_read_b64_tr_b16 a[62:63], v21 offset:36864
  v_mfma_f32_16x16x32_bf16 v[104:107], a[28:31], a[80:83], v[104:107]
  v_mfma_f32_16x16x32_bf16 v[112:115], a[32:35], a[80:83], v[112:115]
  v_mfma_f32_16x16x32_bf16 v[120:123], a[36:39], a[80:83], v[120:123]
  buffer_load_dwordx4 v9, s[20:23], s31 offen offset:1024 lds
  v_mfma_f32_16x16x32_bf16 v[92:95], a[20:23], a[84:87], v[92:95]
  v_mfma_f32_16x16x32_bf16 v[100:103], a[24:27], a[84:87], v[100:103]
  v_mfma_f32_16x16x32_bf16 v[108:111], a[28:31], a[84:87], v[108:111]
  v_mfma_f32_16x16x32_bf16 v[116:119], a[32:35], a[84:87], v[116:119]
  v_mfma_f32_16x16x32_bf16 v[124:127], a[36:39], a[84:87], v[124:127]
  s_waitcnt lgkmcnt(0)
  v_mfma_f32_16x16x32_bf16 v[24:27], a[40:43], a[0:3], v[24:27]
  buffer_load_dwordx4 v10, s[20:23], s31 offen offset:2048 lds
  ds_read_b128 a[20:23], v17 offset:0
  v_mfma_f32_16x16x32_bf16 v[32:35], a[40:43], a[4:7], v[32:35]
  s_add_u32 m0, s88, s27
  ds_read_b64_tr_b16 a[64:65], v20 offset:22528
  ds_read_b64_tr_b16 a[66:67], v20 offset:24576
  v_mfma_f32_16x16x32_bf16 v[40:43], a[40:43], a[8:11], v[40:43]
  ds_read_b128 a[24:27], v17 offset:2048
  v_mfma_f32_16x16x32_bf16 v[48:51], a[40:43], a[12:15], v[48:51]
  buffer_load_dwordx4 v11, s[20:23], s31 offen offset:0 lds
  ds_read_b128 a[28:31], v17 offset:4096
  v_mfma_f32_16x16x32_bf16 v[28:31], a[44:47], a[0:3], v[28:31]
  ds_read_b128 a[32:35], v17 offset:6144
  v_mfma_f32_16x16x32_bf16 v[36:39], a[44:47], a[4:7], v[36:39]
  ds_read_b64_tr_b16 a[68:69], v21 offset:22528
  v_mfma_f32_16x16x32_bf16 v[44:47], a[44:47], a[8:11], v[44:47]
  buffer_load_dwordx4 v12, s[20:23], s31 offen offset:1024 lds
  ds_read_b64_tr_b16 a[70:71], v21 offset:24576
  v_mfma_f32_16x16x32_bf16 v[52:55], a[44:47], a[12:15], v[52:55]
  ds_read_b64_tr_b16 a[72:73], v20 offset:30720
  v_mfma_f32_16x16x32_bf16 v[56:59], a[48:51], a[0:3], v[56:59]
  ds_read_b64_tr_b16 a[74:75], v20 offset:32768
  v_mfma_f32_16x16x32_bf16 v[64:67], a[48:51], a[4:7], v[64:67]
  buffer_load_dwordx4 v13, s[20:23], s31 offen offset:2048 lds
  ds_read_b64_tr_b16 a[76:77], v21 offset:30720
  v_mfma_f32_16x16x32_bf16 v[72:75], a[48:51], a[8:11], v[72:75]
  s_add_u32 s60, s63, 4096
  ds_read_b64_tr_b16 a[78:79], v21 offset:32768
  v_mfma_f32_16x16x32_bf16 v[80:83], a[48:51], a[12:15], v[80:83]
  ds_read_b64_tr_b16 a[80:81], v20 offset:38912
  v_mfma_f32_16x16x32_bf16 v[60:63], a[52:55], a[0:3], v[60:63]
  buffer_store_dwordx4 v[176:179], v2, s[16:19], s60 offen offset:0 sc1
  ds_read_b64_tr_b16 a[82:83], v20 offset:40960
  v_mfma_f32_16x16x32_bf16 v[68:71], a[52:55], a[4:7], v[68:71]
  ds_read_b128 a[36:39], v19 offset:0
  v_mfma_f32_16x16x32_bf16 v[76:79], a[52:55], a[8:11], v[76:79]
  ds_read_b64_tr_b16 a[84:85], v21 offset:38912
  v_mfma_f32_16x16x32_bf16 v[84:87], a[52:55], a[12:15], v[84:87]
  buffer_store_dwordx4 v[180:183], v2, s[16:19], s60 offen offset:1024 sc1
  ds_read_b64_tr_b16 a[86:87], v21 offset:40960
  v_mfma_f32_16x16x32_bf16 v[88:91], a[0:3], a[56:59], v[88:91]
  s_add_u32 s88, s88, s90
  s_add_u32 s89, s89, 1
  s_cmp_eq_u32 s89, 3
  s_cselect_b32 s89, 0, s89
  s_cselect_b32 s90, s91, s92
  v_mfma_f32_16x16x32_bf16 v[96:99], a[4:7], a[56:59], v[96:99]
  v_add_u32 v16, s90, v16
  v_add_u32 v17, s90, v17
  v_mfma_f32_16x16x32_bf16 v[104:107], a[8:11], a[56:59], v[104:107]
  v_add_u32 v18, s90, v18
  v_add_u32 v19, s90, v19
  v_mfma_f32_16x16x32_bf16 v[112:115], a[12:15], a[56:59], v[112:115]
  v_add_u32 v20, s90, v20
  v_add_u32 v21, s90, v21
  v_mfma_f32_16x16x32_bf16 v[120:123], a[16:19], a[56:59], v[120:123]
  v_mfma_f32_16x16x32_bf16 v[92:95], a[0:3], a[60:63], v[92:95]
  v_mfma_f32_16x16x32_bf16 v[100:103], a[4:7], a[60:63], v[100:103]
  v_mfma_f32_16x16x32_bf16 v[108:111], a[8:11], a[60:63], v[108:111]
  v_mfma_f32_16x16x32_bf16 v[116:119], a[12:15], a[60:63], v[116:119]
  v_mfma_f32_16x16x32_bf16 v[124:127], a[16:19], a[60:63], v[124:127]
  s_waitcnt vmcnt(13) lgkmcnt(0)
  s_barrier
  v_mfma_f32_16x16x32_bf16 v[24:27], a[64:67], a[20:23], v[24:27]
  s_mov_b32 m0, s88
  ds_read_b128 a[0:3], v16 offset:0
  ds_read_b64_tr_b16 a[40:41], v20 offset:18432
  v_mfma_f32_16x16x32_bf16 v[32:35], a[64:67], a[24:27], v[32:35]
  buffer_load_dwordx4 v4, s[8:11], s30 offen offset:0 lds
  ds_read_b64_tr_b16 a[42:43], v20 offset:20480
  v_mfma_f32_16x16x32_bf16 v[40:43], a[64:67], a[28:31], v[40:43]
  ds_read_b128 a[4:7], v16 offset:2048
  v_mfma_f32_16x16x32_bf16 v[48:51], a[64:67], a[32:35], v[48:51]
  ds_read_b128 a[8:11], v16 offset:4096
  v_mfma_f32_16x16x32_bf16 v[28:31], a[68:71], a[20:23], v[28:31]
  buffer_load_dwordx4 v5, s[8:11], s30 offen offset:1024 lds
  ds_read_b128 a[12:15], v16 offset:6144
  v_mfma_f32_16x16x32_bf16 v[36:39], a[68:71], a[24:27], v[36:39]
  ds_read_b64_tr_b16 a[44:45], v21 offset:18432
  v_mfma_f32_16x16x32_bf16 v[44:47], a[68:71], a[28:31], v[44:47]
  ds_read_b64_tr_b16 a[46:47], v21 offset:20480
  v_mfma_f32_16x16x32_bf16 v[52:55], a[68:71], a[32:35], v[52:55]
  ds_read_b64_tr_b16 a[48:49], v20 offset:26624
  v_mfma_f32_16x16x32_bf16 v[56:59], a[72:75], a[20:23], v[56:59]
  buffer_load_dwordx4 v6, s[8:11], s30 offen offset:2048 lds
  ds_read_b64_tr_b16 a[50:51], v20 offset:28672
  v_mfma_f32_16x16x32_bf16 v[64:67], a[72:75], a[24:27], v[64:67]
  ds_read_b64_tr_b16 a[52:53], v21 offset:26624
  v_mfma_f32_16x16x32_bf16 v[72:75], a[72:75], a[28:31], v[72:75]
  ds_read_b64_tr_b16 a[54:55], v21 offset:28672
  v_mfma_f32_16x16x32_bf16 v[80:83], a[72:75], a[32:35], v[80:83]
  ds_read_b64_tr_b16 a[56:57], v20 offset:34816
  v_mfma_f32_16x16x32_bf16 v[60:63], a[76:79], a[20:23], v[60:63]
  buffer_load_dwordx4 v7, s[8:11], s30 offen offset:3072 lds
  ds_read_b64_tr_b16 a[58:59], v20 offset:36864
  v_mfma_f32_16x16x32_bf16 v[68:71], a[76:79], a[24:27], v[68:71]
  s_mul_i32 s31, s0, 393216
  s_bfe_u32 s29, 0x302010e, s1
  s_add_u32 s0, s0, s29
  v_mfma_f32_16x16x32_bf16 v[76:79], a[76:79], a[28:31], v[76:79]
  s_add_u32 s1, s1, 8
  s_and_b32 s1, s1, 0x8001f
  s_and_b32 s0, s0, 15
  v_mfma_f32_16x16x32_bf16 v[84:87], a[76:79], a[32:35], v[84:87]
  s_lshl_b32 s30, s0, 7
  s_add_u32 m0, s88, s26
  ds_read_b128 a[16:19], v18 offset:0
  v_mfma_f32_16x16x32_bf16 v[88:91], a[20:23], a[80:83], v[88:91]
  buffer_load_dwordx4 v8, s[20:23], s31 offen offset:0 lds
  ds_read_b64_tr_b16 a[60:61], v21 offset:34816
  v_mfma_f32_16x16x32_bf16 v[96:99], a[24:27], a[80:83], v[96:99]
  ds_read_b64_tr_b16 a[62:63], v21 offset:36864
  v_mfma_f32_16x16x32_bf16 v[104:107], a[28:31], a[80:83], v[104:107]
  v_mfma_f32_16x16x32_bf16 v[112:115], a[32:35], a[80:83], v[112:115]
  v_mfma_f32_16x16x32_bf16 v[120:123], a[36:39], a[80:83], v[120:123]
  buffer_load_dwordx4 v9, s[20:23], s31 offen offset:1024 lds
  v_mfma_f32_16x16x32_bf16 v[92:95], a[20:23], a[84:87], v[92:95]
  v_mfma_f32_16x16x32_bf16 v[100:103], a[24:27], a[84:87], v[100:103]
  v_mfma_f32_16x16x32_bf16 v[108:111], a[28:31], a[84:87], v[108:111]
  v_mfma_f32_16x16x32_bf16 v[116:119], a[32:35], a[84:87], v[116:119]
  v_mfma_f32_16x16x32_bf16 v[124:127], a[36:39], a[84:87], v[124:127]
  s_waitcnt lgkmcnt(0)
  v_mfma_f32_16x16x32_bf16 v[24:27], a[40:43], a[0:3], v[24:27]
  buffer_load_dwordx4 v10, s[20:23], s31 offen offset:2048 lds
  ds_read_b128 a[20:23], v17 offset:0
  v_mfma_f32_16x16x32_bf16 v[32:35], a[40:43], a[4:7], v[32:35]
  s_add_u32 m0, s88, s27
  ds_read_b64_tr_b16 a[64:65], v20 offset:22528
  ds_read_b64_tr_b16 a[66:67], v20 offset:24576
  v_mfma_f32_16x16x32_bf16 v[40:43], a[40:43], a[8:11], v[40:43]
  ds_read_b128 a[24:27], v17 offset:2048
  v_mfma_f32_16x16x32_bf16 v[48:51], a[40:43], a[12:15], v[48:51]
  buffer_load_dwordx4 v11, s[20:23], s31 offen offset:0 lds
  ds_read_b128 a[28:31], v17 offset:4096
  v_mfma_f32_16x16x32_bf16 v[28:31], a[44:47], a[0:3], v[28:31]
  ds_read_b128 a[32:35], v17 offset:6144
  v_mfma_f32_16x16x32_bf16 v[36:39], a[44:47], a[4:7], v[36:39]
  ds_read_b64_tr_b16 a[68:69], v21 offset:22528
  v_mfma_f32_16x16x32_bf16 v[44:47], a[44:47], a[8:11], v[44:47]
  ds_read_b64_tr_b16 a[70:71], v21 offset:24576
  v_mfma_f32_16x16x32_bf16 v[52:55], a[44:47], a[12:15], v[52:55]
  buffer_load_dwordx4 v12, s[20:23], s31 offen offset:1024 lds
  ds_read_b64_tr_b16 a[72:73], v20 offset:30720
  v_mfma_f32_16x16x32_bf16 v[56:59], a[48:51], a[0:3], v[56:59]
  ds_read_b64_tr_b16 a[74:75], v20 offset:32768
  v_mfma_f32_16x16x32_bf16 v[64:67], a[48:51], a[4:7], v[64:67]
  ds_read_b64_tr_b16 a[76:77], v21 offset:30720
  v_mfma_f32_16x16x32_bf16 v[72:75], a[48:51], a[8:11], v[72:75]
  ds_read_b64_tr_b16 a[78:79], v21 offset:32768
  v_mfma_f32_16x16x32_bf16 v[80:83], a[48:51], a[12:15], v[80:83]
  buffer_load_dwordx4 v13, s[20:23], s31 offen offset:2048 lds
  ds_read_b64_tr_b16 a[80:81], v20 offset:38912
  v_mfma_f32_16x16x32_bf16 v[60:63], a[52:55], a[0:3], v[60:63]
  s_add_u32 s60, s63, 4096
  ds_read_b64_tr_b16 a[82:83], v20 offset:40960
  v_mfma_f32_16x16x32_bf16 v[68:71], a[52:55], a[4:7], v[68:71]
  ds_read_b128 a[36:39], v19 offset:0
  v_mfma_f32_16x16x32_bf16 v[76:79], a[52:55], a[8:11], v[76:79]
  ds_read_b64_tr_b16 a[84:85], v21 offset:38912
  v_mfma_f32_16x16x32_bf16 v[84:87], a[52:55], a[12:15], v[84:87]
  buffer_store_dwordx4 v[184:187], v2, s[16:19], s60 offen offset:2048 sc1
  ds_read_b64_tr_b16 a[86:87], v21 offset:40960
  v_mfma_f32_16x16x32_bf16 v[88:91], a[0:3], a[56:59], v[88:91]
  s_add_u32 s88, s88, s90
  s_add_u32 s89, s89, 1
  s_cmp_eq_u32 s89, 3
  s_cselect_b32 s89, 0, s89
  s_cselect_b32 s90, s91, s92
  v_mfma_f32_16x16x32_bf16 v[96:99], a[4:7], a[56:59], v[96:99]
  v_add_u32 v16, s90, v16
  v_add_u32 v17, s90, v17
  v_mfma_f32_16x16x32_bf16 v[104:107], a[8:11], a[56:59], v[104:107]
  v_add_u32 v18, s90, v18
  v_add_u32 v19, s90, v19
  v_mfma_f32_16x16x32_bf16 v[112:115], a[12:15], a[56:59], v[112:115]
  v_add_u32 v20, s90, v20
  v_add_u32 v21, s90, v21
  v_mfma_f32_16x16x32_bf16 v[120:123], a[16:19], a[56:59], v[120:123]
  v_mfma_f32_16x16x32_bf16 v[92:95], a[0:3], a[60:63], v[92:95]
  v_mfma_f32_16x16x32_bf16 v[100:103], a[4:7], a[60:63], v[100:103]
  v_mfma_f32_16x16x32_bf16 v[108:111], a[8:11], a[60:63], v[108:111]
  v_mfma_f32_16x16x32_bf16 v[116:119], a[12:15], a[60:63], v[116:119]
  v_mfma_f32_16x16x32_bf16 v[124:127], a[16:19], a[60:63], v[124:127]
  s_waitcnt vmcnt(13) lgkmcnt(0)
  s_barrier
  v_mfma_f32_16x16x32_bf16 v[24:27], a[64:67], a[20:23], v[24:27]
  s_mov_b32 m0, s88
  ds_read_b128 a[0:3], v16 offset:0
  ds_read_b64_tr_b16 a[40:41], v20 offset:18432
  v_mfma_f32_16x16x32_bf16 v[32:35], a[64:67], a[24:27], v[32:35]
  buffer_load_dwordx4 v4, s[8:11], s30 offen offset:0 lds
  ds_read_b64_tr_b16 a[42:43], v20 offset:20480
  v_mfma_f32_16x16x32_bf16 v[40:43], a[64:67], a[28:31], v[40:43]
  ds_read_b128 a[4:7], v16 offset:2048
  v_mfma_f32_16x16x32_bf16 v[48:51], a[64:67], a[32:35], v[48:51]
  ds_read_b128 a[8:11], v16 offset:4096
  v_mfma_f32_16x16x32_bf16 v[28:31], a[68:71], a[20:23], v[28:31]
  buffer_load_dwordx4 v5, s[8:11], s30 offen offset:1024 lds
  ds_read_b128 a[12:15], v16 offset:6144
  v_mfma_f32_16x16x32_bf16 v[36:39], a[68:71], a[24:27], v[36:39]
  ds_read_b64_tr_b16 a[44:45], v21 offset:18432
  v_mfma_f32_16x16x32_bf16 v[44:47], a[68:71], a[28:31], v[44:47]
  ds_read_b64_tr_b16 a[46:47], v21 offset:20480
  v_mfma_f32_16x16x32_bf16 v[52:55], a[68:71], a[32:35], v[52:55]
  ds_read_b64_tr_b16 a[48:49], v20 offset:26624
  v_mfma_f32_16x16x32_bf16 v[56:59], a[72:75], a[20:23], v[56:59]
  buffer_load_dwordx4 v6, s[8:11], s30 offen offset:2048 lds
  ds_read_b64_tr_b16 a[50:51], v20 offset:28672
  v_mfma_f32_16x16x32_bf16 v[64:67], a[72:75], a[24:27], v[64:67]
  ds_read_b64_tr_b16 a[52:53], v21 offset:26624
  v_mfma_f32_16x16x32_bf16 v[72:75], a[72:75], a[28:31], v[72:75]
  ds_read_b64_tr_b16 a[54:55], v21 offset:28672
  v_mfma_f32_16x16x32_bf16 v[80:83], a[72:75], a[32:35], v[80:83]
  ds_read_b64_tr_b16 a[56:57], v20 offset:34816
  v_mfma_f32_16x16x32_bf16 v[60:63], a[76:79], a[20:23], v[60:63]
  buffer_load_dwordx4 v7, s[8:11], s30 offen offset:3072 lds
  ds_read_b64_tr_b16 a[58:59], v20 offset:36864
  v_mfma_f32_16x16x32_bf16 v[68:71], a[76:79], a[24:27], v[68:71]
  s_mul_i32 s31, s0, 393216
  s_bfe_u32 s29, 0x302010e, s1
  s_add_u32 s0, s0, s29
  v_mfma_f32_16x16x32_bf16 v[76:79], a[76:79], a[28:31], v[76:79]
  s_add_u32 s1, s1, 8
  s_and_b32 s1, s1, 0x8001f
  s_and_b32 s0, s0, 15
  v_mfma_f32_16x16x32_bf16 v[84:87], a[76:79], a[32:35], v[84:87]
  s_lshl_b32 s30, s0, 7
  s_add_u32 m0, s88, s26
  ds_read_b128 a[16:19], v18 offset:0
  v_mfma_f32_16x16x32_bf16 v[88:91], a[20:23], a[80:83], v[88:91]
  buffer_load_dwordx4 v8, s[20:23], s31 offen offset:0 lds
  ds_read_b64_tr_b16 a[60:61], v21 offset:34816
  v_mfma_f32_16x16x32_bf16 v[96:99], a[24:27], a[80:83], v[96:99]
  ds_read_b64_tr_b16 a[62:63], v21 offset:36864
  v_mfma_f32_16x16x32_bf16 v[104:107], a[28:31], a[80:83], v[104:107]
  v_mfma_f32_16x16x32_bf16 v[112:115], a[32:35], a[80:83], v[112:115]
  v_mfma_f32_16x16x32_bf16 v[120:123], a[36:39], a[80:83], v[120:123]
  buffer_load_dwordx4 v9, s[20:23], s31 offen offset:1024 lds
  v_mfma_f32_16x16x32_bf16 v[92:95], a[20:23], a[84:87], v[92:95]
  v_mfma_f32_16x16x32_bf16 v[100:103], a[24:27], a[84:87], v[100:103]
  v_mfma_f32_16x16x32_bf16 v[108:111], a[28:31], a[84:87], v[108:111]
  v_mfma_f32_16x16x32_bf16 v[116:119], a[32:35], a[84:87], v[116:119]
  v_mfma_f32_16x16x32_bf16 v[124:127], a[36:39], a[84:87], v[124:127]
  s_waitcnt lgkmcnt(0)
  v_mfma_f32_16x16x32_bf16 v[24:27], a[40:43], a[0:3], v[24:27]
  buffer_load_dwordx4 v10, s[20:23], s31 offen offset:2048 lds
  ds_read_b128 a[20:23], v17 offset:0
  v_mfma_f32_16x16x32_bf16 v[32:35], a[40:43], a[4:7], v[32:35]
  s_add_u32 m0, s88, s27
  ds_read_b64_tr_b16 a[64:65], v20 offset:22528
  ds_read_b64_tr_b16 a[66:67], v20 offset:24576
  v_mfma_f32_16x16x32_bf16 v[40:43], a[40:43], a[8:11], v[40:43]
  ds_read_b128 a[24:27], v17 offset:2048
  v_mfma_f32_16x16x32_bf16 v[48:51], a[40:43], a[12:15], v[48:51]
  buffer_load_dwordx4 v11, s[20:23], s31 offen offset:0 lds
  ds_read_b128 a[28:31], v17 offset:4096
  v_mfma_f32_16x16x32_bf16 v[28:31], a[44:47], a[0:3], v[28:31]
  ds_read_b128 a[32:35], v17 offset:6144
  v_mfma_f32_16x16x32_bf16 v[36:39], a[44:47], a[4:7], v[36:39]
  ds_read_b64_tr_b16 a[68:69], v21 offset:22528
  v_mfma_f32_16x16x32_bf16 v[44:47], a[44:47], a[8:11], v[44:47]
  ds_read_b64_tr_b16 a[70:71], v21 offset:24576
  v_mfma_f32_16x16x32_bf16 v[52:55], a[44:47], a[12:15], v[52:55]
  buffer_load_dwordx4 v12, s[20:23], s31 offen offset:1024 lds
  ds_read_b64_tr_b16 a[72:73], v20 offset:30720
  v_mfma_f32_16x16x32_bf16 v[56:59], a[48:51], a[0:3], v[56:59]
  ds_read_b64_tr_b16 a[74:75], v20 offset:32768
  v_mfma_f32_16x16x32_bf16 v[64:67], a[48:51], a[4:7], v[64:67]
  ds_read_b64_tr_b16 a[76:77], v21 offset:30720
  v_mfma_f32_16x16x32_bf16 v[72:75], a[48:51], a[8:11], v[72:75]
  ds_read_b64_tr_b16 a[78:79], v21 offset:32768
  v_mfma_f32_16x16x32_bf16 v[80:83], a[48:51], a[12:15], v[80:83]
  buffer_load_dwordx4 v13, s[20:23], s31 offen offset:2048 lds
  ds_read_b64_tr_b16 a[80:81], v20 offset:38912
  v_mfma_f32_16x16x32_bf16 v[60:63], a[52:55], a[0:3], v[60:63]
  s_add_u32 s60, s63, 4096
  ds_read_b64_tr_b16 a[82:83], v20 offset:40960
  v_mfma_f32_16x16x32_bf16 v[68:71], a[52:55], a[4:7], v[68:71]
  ds_read_b128 a[36:39], v19 offset:0
  v_mfma_f32_16x16x32_bf16 v[76:79], a[52:55], a[8:11], v[76:79]
  ds_read_b64_tr_b16 a[84:85], v21 offset:38912
  v_mfma_f32_16x16x32_bf16 v[84:87], a[52:55], a[12:15], v[84:87]
  buffer_store_dwordx4 v[188:191], v2, s[16:19], s60 offen offset:3072 sc1
  ds_read_b64_tr_b16 a[86:87], v21 offset:40960
  v_mfma_f32_16x16x32_bf16 v[88:91], a[0:3], a[56:59], v[88:91]
  s_add_u32 s88, s88, s90
  s_add_u32 s89, s89, 1
  s_cmp_eq_u32 s89, 3
  s_cselect_b32 s89, 0, s89
  s_cselect_b32 s90, s91, s92
  v_mfma_f32_16x16x32_bf16 v[96:99], a[4:7], a[56:59], v[96:99]
  v_add_u32 v16, s90, v16
  v_add_u32 v17, s90, v17
  v_mfma_f32_16x16x32_bf16 v[104:107], a[8:11], a[56:59], v[104:107]
  v_add_u32 v18, s90, v18
  v_add_u32 v19, s90, v19
  v_mfma_f32_16x16x32_bf16 v[112:115], a[12:15], a[56:59], v[112:115]
  v_add_u32 v20, s90, v20
  v_add_u32 v21, s90, v21
  v_mfma_f32_16x16x32_bf16 v[120:123], a[16:19], a[56:59], v[120:123]
  v_mfma_f32_16x16x32_bf16 v[92:95], a[0:3], a[60:63], v[92:95]
  v_mfma_f32_16x16x32_bf16 v[100:103], a[4:7], a[60:63], v[100:103]
  v_mfma_f32_16x16x32_bf16 v[108:111], a[8:11], a[60:63], v[108:111]
  v_mfma_f32_16x16x32_bf16 v[116:119], a[12:15], a[60:63], v[116:119]
  v_mfma_f32_16x16x32_bf16 v[124:127], a[16:19], a[60:63], v[124:127]
  s_waitcnt vmcnt(12) lgkmcnt(0)
  s_barrier
  v_mfma_f32_16x16x32_bf16 v[24:27], a[64:67], a[20:23], v[24:27]
  s_mov_b32 m0, s88
  ds_read_b128 a[0:3], v16 offset:0
  ds_read_b64_tr_b16 a[40:41], v20 offset:18432
  v_mfma_f32_16x16x32_bf16 v[32:35], a[64:67], a[24:27], v[32:35]
  buffer_load_dwordx4 v4, s[8:11], s30 offen offset:0 lds
  ds_read_b64_tr_b16 a[42:43], v20 offset:20480
  v_mfma_f32_16x16x32_bf16 v[40:43], a[64:67], a[28:31], v[40:43]
  ds_read_b128 a[4:7], v16 offset:2048
  v_mfma_f32_16x16x32_bf16 v[48:51], a[64:67], a[32:35], v[48:51]
  ds_read_b128 a[8:11], v16 offset:4096
  v_mfma_f32_16x16x32_bf16 v[28:31], a[68:71], a[20:23], v[28:31]
  buffer_load_dwordx4 v5, s[8:11], s30 offen offset:1024 lds
  ds_read_b128 a[12:15], v16 offset:6144
  v_mfma_f32_16x16x32_bf16 v[36:39], a[68:71], a[24:27], v[36:39]
  ds_read_b64_tr_b16 a[44:45], v21 offset:18432
  v_mfma_f32_16x16x32_bf16 v[44:47], a[68:71], a[28:31], v[44:47]
  ds_read_b64_tr_b16 a[46:47], v21 offset:20480
  v_mfma_f32_16x16x32_bf16 v[52:55], a[68:71], a[32:35], v[52:55]
  ds_read_b64_tr_b16 a[48:49], v20 offset:26624
  v_mfma_f32_16x16x32_bf16 v[56:59], a[72:75], a[20:23], v[56:59]
  buffer_load_dwordx4 v6, s[8:11], s30 offen offset:2048 lds
  ds_read_b64_tr_b16 a[50:51], v20 offset:28672
  v_mfma_f32_16x16x32_bf16 v[64:67], a[72:75], a[24:27], v[64:67]
  ds_read_b64_tr_b16 a[52:53], v21 offset:26624
  v_mfma_f32_16x16x32_bf16 v[72:75], a[72:75], a[28:31], v[72:75]
  ds_read_b64_tr_b16 a[54:55], v21 offset:28672
  v_mfma_f32_16x16x32_bf16 v[80:83], a[72:75], a[32:35], v[80:83]
  ds_read_b64_tr_b16 a[56:57], v20 offset:34816
  v_mfma_f32_16x16x32_bf16 v[60:63], a[76:79], a[20:23], v[60:63]
  buffer_load_dwordx4 v7, s[8:11], s30 offen offset:3072 lds
  ds_read_b64_tr_b16 a[58:59], v20 offset:36864
  v_mfma_f32_16x16x32_bf16 v[68:71], a[76:79], a[24:27], v[68:71]
  s_mul_i32 s31, s0, 393216
  s_bfe_u32 s29, 0x302010e, s1
  s_add_u32 s0, s0, s29
  v_mfma_f32_16x16x32_bf16 v[76:79], a[76:79], a[28:31], v[76:79]
  s_add_u32 s1, s1, 8
  s_and_b32 s1, s1, 0x8001f
  s_and_b32 s0, s0, 15
  v_mfma_f32_16x16x32_bf16 v[84:87], a[76:79], a[32:35], v[84:87]
  s_lshl_b32 s30, s0, 7
  s_add_u32 m0, s88, s26
  ds_read_b128 a[16:19], v18 offset:0
  v_mfma_f32_16x16x32_bf16 v[88:91], a[20:23], a[80:83], v[88:91]
  buffer_load_dwordx4 v8, s[20:23], s31 offen offset:0 lds
  ds_read_b64_tr_b16 a[60:61], v21 offset:34816
  v_mfma_f32_16x16x32_bf16 v[96:99], a[24:27], a[80:83], v[96:99]
  ds_read_b64_tr_b16 a[62:63], v21 offset:36864
  v_mfma_f32_16x16x32_bf16 v[104:107], a[28:31], a[80:83], v[104:107]
  v_mfma_f32_16x16x32_bf16 v[112:115], a[32:35], a[80:83], v[112:115]
  v_mfma_f32_16x16x32_bf16 v[120:123], a[36:39], a[80:83], v[120:123]
  buffer_load_dwordx4 v9, s[20:23], s31 offen offset:1024 lds
  v_mfma_f32_16x16x32_bf16 v[92:95], a[20:23], a[84:87], v[92:95]
  v_mfma_f32_16x16x32_bf16 v[100:103], a[24:27], a[84:87], v[100:103]
  v_mfma_f32_16x16x32_bf16 v[108:111], a[28:31], a[84:87], v[108:111]
  v_mfma_f32_16x16x32_bf16 v[116:119], a[32:35], a[84:87], v[116:119]
  v_mfma_f32_16x16x32_bf16 v[124:127], a[36:39], a[84:87], v[124:127]
  s_waitcnt lgkmcnt(0)
  v_mfma_f32_16x16x32_bf16 v[24:27], a[40:43], a[0:3], v[24:27]
  buffer_load_dwordx4 v10, s[20:23], s31 offen offset:2048 lds
  ds_read_b128 a[20:23], v17 offset:0
  v_mfma_f32_16x16x32_bf16 v[32:35], a[40:43], a[4:7], v[32:35]
  s_add_u32 m0, s88, s27
  ds_read_b64_tr_b16 a[64:65], v20 offset:22528
  ds_read_b64_tr_b16 a[66:67], v20 offset:24576
  v_mfma_f32_16x16x32_bf16 v[40:43], a[40:43], a[8:11], v[40:43]
  ds_read_b128 a[24:27], v17 offset:2048
  v_mfma_f32_16x16x32_bf16 v[48:51], a[40:43], a[12:15], v[48:51]
  buffer_load_dwordx4 v11, s[20:23], s31 offen offset:0 lds
  ds_read_b128 a[28:31], v17 offset:4096
  v_mfma_f32_16x16x32_bf16 v[28:31], a[44:47], a[0:3], v[28:31]
  ds_read_b128 a[32:35], v17 offset:6144
  v_mfma_f32_16x16x32_bf16 v[36:39], a[44:47], a[4:7], v[36:39]
  ds_read_b64_tr_b16 a[68:69], v21 offset:22528
  v_mfma_f32_16x16x32_bf16 v[44:47], a[44:47], a[8:11], v[44:47]
  ds_read_b64_tr_b16 a[70:71], v21 offset:24576
  v_mfma_f32_16x16x32_bf16 v[52:55], a[44:47], a[12:15], v[52:55]
  buffer_load_dwordx4 v12, s[20:23], s31 offen offset:1024 lds
  ds_read_b64_tr_b16 a[72:73], v20 offset:30720
  v_mfma_f32_16x16x32_bf16 v[56:59], a[48:51], a[0:3], v[56:59]
  ds_read_b64_tr_b16 a[74:75], v20 offset:32768
  v_mfma_f32_16x16x32_bf16 v[64:67], a[48:51], a[4:7], v[64:67]
  ds_read_b64_tr_b16 a[76:77], v21 offset:30720
  v_mfma_f32_16x16x32_bf16 v[72:75], a[48:51], a[8:11], v[72:75]
  ds_read_b64_tr_b16 a[78:79], v21 offset:32768
  v_mfma_f32_16x16x32_bf16 v[80:83], a[48:51], a[12:15], v[80:83]
  buffer_load_dwordx4 v13, s[20:23], s31 offen offset:2048 lds
  ds_read_b64_tr_b16 a[80:81], v20 offset:38912
  v_mfma_f32_16x16x32_bf16 v[60:63], a[52:55], a[0:3], v[60:63]
  s_add_u32 s60, s63, 32768
  ds_read_b64_tr_b16 a[82:83], v20 offset:40960
  v_mfma_f32_16x16x32_bf16 v[68:71], a[52:55], a[4:7], v[68:71]
  ds_read_b128 a[36:39], v19 offset:0
  v_mfma_f32_16x16x32_bf16 v[76:79], a[52:55], a[8:11], v[76:79]
  ds_read_b64_tr_b16 a[84:85], v21 offset:38912
  v_mfma_f32_16x16x32_bf16 v[84:87], a[52:55], a[12:15], v[84:87]
  buffer_store_dwordx4 v[204:207], v2, s[16:19], s60 offen offset:3072 sc1
  ds_read_b64_tr_b16 a[86:87], v21 offset:40960
  v_mfma_f32_16x16x32_bf16 v[88:91], a[0:3], a[56:59], v[88:91]
  s_add_u32 s88, s88, s90
  s_add_u32 s89, s89, 1
  s_cmp_eq_u32 s89, 3
  s_cselect_b32 s89, 0, s89
  s_cselect_b32 s90, s91, s92
  v_mfma_f32_16x16x32_bf16 v[96:99], a[4:7], a[56:59], v[96:99]
  v_add_u32 v16, s90, v16
  v_add_u32 v17, s90, v17
  v_mfma_f32_16x16x32_bf16 v[104:107], a[8:11], a[56:59], v[104:107]
  v_add_u32 v18, s90, v18
  v_add_u32 v19, s90, v19
  v_mfma_f32_16x16x32_bf16 v[112:115], a[12:15], a[56:59], v[112:115]
  v_add_u32 v20, s90, v20
  v_add_u32 v21, s90, v21
  v_mfma_f32_16x16x32_bf16 v[120:123], a[16:19], a[56:59], v[120:123]
  v_mfma_f32_16x16x32_bf16 v[92:95], a[0:3], a[60:63], v[92:95]
  v_mfma_f32_16x16x32_bf16 v[100:103], a[4:7], a[60:63], v[100:103]
  v_mfma_f32_16x16x32_bf16 v[108:111], a[8:11], a[60:63], v[108:111]
  v_mfma_f32_16x16x32_bf16 v[116:119], a[12:15], a[60:63], v[116:119]
  v_mfma_f32_16x16x32_bf16 v[124:127], a[16:19], a[60:63], v[124:127]
  s_waitcnt vmcnt(12) lgkmcnt(0)
  s_barrier
  v_mfma_f32_16x16x32_bf16 v[24:27], a[64:67], a[20:23], v[24:27]
  s_mov_b32 m0, s88
  ds_read_b128 a[0:3], v16 offset:0
  ds_read_b64_tr_b16 a[40:41], v20 offset:18432
  v_mfma_f32_16x16x32_bf16 v[32:35], a[64:67], a[24:27], v[32:35]
  buffer_load_dwordx4 v4, s[8:11], s30 offen offset:0 lds
  ds_read_b64_tr_b16 a[42:43], v20 offset:20480
  v_mfma_f32_16x16x32_bf16 v[40:43], a[64:67], a[28:31], v[40:43]
  ds_read_b128 a[4:7], v16 offset:2048
  v_mfma_f32_16x16x32_bf16 v[48:51], a[64:67], a[32:35], v[48:51]
  ds_read_b128 a[8:11], v16 offset:4096
  v_mfma_f32_16x16x32_bf16 v[28:31], a[68:71], a[20:23], v[28:31]
  buffer_load_dwordx4 v5, s[8:11], s30 offen offset:1024 lds
  ds_read_b128 a[12:15], v16 offset:6144
  v_mfma_f32_16x16x32_bf16 v[36:39], a[68:71], a[24:27], v[36:39]
  ds_read_b64_tr_b16 a[44:45], v21 offset:18432
  v_mfma_f32_16x16x32_bf16 v[44:47], a[68:71], a[28:31], v[44:47]
  ds_read_b64_tr_b16 a[46:47], v21 offset:20480
  v_mfma_f32_16x16x32_bf16 v[52:55], a[68:71], a[32:35], v[52:55]
  ds_read_b64_tr_b16 a[48:49], v20 offset:26624
  v_mfma_f32_16x16x32_bf16 v[56:59], a[72:75], a[20:23], v[56:59]
  buffer_load_dwordx4 v6, s[8:11], s30 offen offset:2048 lds
  ds_read_b64_tr_b16 a[50:51], v20 offset:28672
  v_mfma_f32_16x16x32_bf16 v[64:67], a[72:75], a[24:27], v[64:67]
  ds_read_b64_tr_b16 a[52:53], v21 offset:26624
  v_mfma_f32_16x16x32_bf16 v[72:75], a[72:75], a[28:31], v[72:75]
  ds_read_b64_tr_b16 a[54:55], v21 offset:28672
  v_mfma_f32_16x16x32_bf16 v[80:83], a[72:75], a[32:35], v[80:83]
  ds_read_b64_tr_b16 a[56:57], v20 offset:34816
  v_mfma_f32_16x16x32_bf16 v[60:63], a[76:79], a[20:23], v[60:63]
  buffer_load_dwordx4 v7, s[8:11], s30 offen offset:3072 lds
  ds_read_b64_tr_b16 a[58:59], v20 offset:36864
  v_mfma_f32_16x16x32_bf16 v[68:71], a[76:79], a[24:27], v[68:71]
  s_mul_i32 s31, s0, 393216
  s_bfe_u32 s29, 0x302010e, s1
  s_add_u32 s0, s0, s29
  v_mfma_f32_16x16x32_bf16 v[76:79], a[76:79], a[28:31], v[76:79]
  s_add_u32 s1, s1, 8
  s_and_b32 s1, s1, 0x8001f
  s_and_b32 s0, s0, 15
  v_mfma_f32_16x16x32_bf16 v[84:87], a[76:79], a[32:35], v[84:87]
  s_lshl_b32 s30, s0, 7
  s_add_u32 m0, s88, s26
  ds_read_b128 a[16:19], v18 offset:0
  v_mfma_f32_16x16x32_bf16 v[88:91], a[20:23], a[80:83], v[88:91]
  buffer_load_dwordx4 v8, s[20:23], s31 offen offset:0 lds
  ds_read_b64_tr_b16 a[60:61], v21 offset:34816
  v_mfma_f32_16x16x32_bf16 v[96:99], a[24:27], a[80:83], v[96:99]
  ds_read_b64_tr_b16 a[62:63], v21 offset:36864
  v_mfma_f32_16x16x32_bf16 v[104:107], a[28:31], a[80:83], v[104:107]
  v_mfma_f32_16x16x32_bf16 v[112:115], a[32:35], a[80:83], v[112:115]
  v_mfma_f32_16x16x32_bf16 v[120:123], a[36:39], a[80:83], v[120:123]
  buffer_load_dwordx4 v9, s[20:23], s31 offen offset:1024 lds
  v_mfma_f32_16x16x32_bf16 v[92:95], a[20:23], a[84:87], v[92:95]
  v_mfma_f32_16x16x32_bf16 v[100:103], a[24:27], a[84:87], v[100:103]
  v_mfma_f32_16x16x32_bf16 v[108:111], a[28:31], a[84:87], v[108:111]
  v_mfma_f32_16x16x32_bf16 v[116:119], a[32:35], a[84:87], v[116:119]
  v_mfma_f32_16x16x32_bf16 v[124:127], a[36:39], a[84:87], v[124:127]
  s_waitcnt lgkmcnt(0)
  v_mfma_f32_16x16x32_bf16 v[24:27], a[40:43], a[0:3], v[24:27]
  buffer_load_dwordx4 v10, s[20:23], s31 offen offset:2048 lds
  ds_read_b128 a[20:23], v17 offset:0
  v_mfma_f32_16x16x32_bf16 v[32:35], a[40:43], a[4:7], v[32:35]
  s_add_u32 m0, s88, s27
  ds_read_b64_tr_b16 a[64:65], v20 offset:22528
  ds_read_b64_tr_b16 a[66:67], v20 offset:24576
  v_mfma_f32_16x16x32_bf16 v[40:43], a[40:43], a[8:11], v[40:43]
  ds_read_b128 a[24:27], v17 offset:2048
  v_mfma_f32_16x16x32_bf16 v[48:51], a[40:43], a[12:15], v[48:51]
  buffer_load_dwordx4 v11, s[20:23], s31 offen offset:0 lds
  ds_read_b128 a[28:31], v17 offset:4096
  v_mfma_f32_16x16x32_bf16 v[28:31], a[44:47], a[0:3], v[28:31]
  ds_read_b128 a[32:35], v17 offset:6144
  v_mfma_f32_16x16x32_bf16 v[36:39], a[44:47], a[4:7], v[36:39]
  ds_read_b64_tr_b16 a[68:69], v21 offset:22528
  v_mfma_f32_16x16x32_bf16 v[44:47], a[44:47], a[8:11], v[44:47]
  ds_read_b64_tr_b16 a[70:71], v21 offset:24576
  v_mfma_f32_16x16x32_bf16 v[52:55], a[44:47], a[12:15], v[52:55]
  buffer_load_dwordx4 v12, s[20:23], s31 offen offset:1024 lds
  ds_read_b64_tr_b16 a[72:73], v20 offset:30720
  v_mfma_f32_16x16x32_bf16 v[56:59], a[48:51], a[0:3], v[56:59]
  ds_read_b64_tr_b16 a[74:75], v20 offset:32768
  v_mfma_f32_16x16x32_bf16 v[64:67], a[48:51], a[4:7], v[64:67]
  ds_read_b64_tr_b16 a[76:77], v21 offset:30720
  v_mfma_f32_16x16x32_bf16 v[72:75], a[48:51], a[8:11], v[72:75]
  ds_read_b64_tr_b16 a[78:79], v21 offset:32768
  v_mfma_f32_16x16x32_bf16 v[80:83], a[48:51], a[12:15], v[80:83]
  buffer_load_dwordx4 v13, s[20:23], s31 offen offset:2048 lds
  ds_read_b64_tr_b16 a[80:81], v20 offset:38912
  v_mfma_f32_16x16x32_bf16 v[60:63], a[52:55], a[0:3], v[60:63]
  s_add_u32 s60, s63, 36864
  ds_read_b64_tr_b16 a[82:83], v20 offset:40960
  v_mfma_f32_16x16x32_bf16 v[68:71], a[52:55], a[4:7], v[68:71]
  ds_read_b128 a[36:39], v19 offset:0
  v_mfma_f32_16x16x32_bf16 v[76:79], a[52:55], a[8:11], v[76:79]
  ds_read_b64_tr_b16 a[84:85], v21 offset:38912
  v_mfma_f32_16x16x32_bf16 v[84:87], a[52:55], a[12:15], v[84:87]
  buffer_store_dwordx4 v[208:211], v2, s[16:19], s60 offen offset:0 sc1
  ds_read_b64_tr_b16 a[86:87], v21 offset:40960
  v_mfma_f32_16x16x32_bf16 v[88:91], a[0:3], a[56:59], v[88:91]
  s_add_u32 s88, s88, s90
  s_add_u32 s89, s89, 1
  s_cmp_eq_u32 s89, 3
  s_cselect_b32 s89, 0, s89
  s_cselect_b32 s90, s91, s92
  v_mfma_f32_16x16x32_bf16 v[96:99], a[4:7], a[56:59], v[96:99]
  v_add_u32 v16, s90, v16
  v_add_u32 v17, s90, v17
  v_mfma_f32_16x16x32_bf16 v[104:107], a[8:11], a[56:59], v[104:107]
  v_add_u32 v18, s90, v18
  v_add_u32 v19, s90, v19
  v_mfma_f32_16x16x32_bf16 v[112:115], a[12:15], a[56:59], v[112:115]
  v_add_u32 v20, s90, v20
  v_add_u32 v21, s90, v21
  v_mfma_f32_16x16x32_bf16 v[120:123], a[16:19], a[56:59], v[120:123]
  v_mfma_f32_16x16x32_bf16 v[92:95], a[0:3], a[60:63], v[92:95]
  v_mfma_f32_16x16x32_bf16 v[100:103], a[4:7], a[60:63], v[100:103]
  v_mfma_f32_16x16x32_bf16 v[108:111], a[8:11], a[60:63], v[108:111]
  v_mfma_f32_16x16x32_bf16 v[116:119], a[12:15], a[60:63], v[116:119]
  v_mfma_f32_16x16x32_bf16 v[124:127], a[16:19], a[60:63], v[124:127]
  s_waitcnt vmcnt(12) lgkmcnt(0)
  s_barrier
  v_mfma_f32_16x16x32_bf16 v[24:27], a[64:67], a[20:23], v[24:27]
  s_mov_b32 m0, s88
  ds_read_b128 a[0:3], v16 offset:0
  ds_read_b64_tr_b16 a[40:41], v20 offset:18432
  v_mfma_f32_16x16x32_bf16 v[32:35], a[64:67], a[24:27], v[32:35]
  buffer_load_dwordx4 v4, s[8:11], s30 offen offset:0 lds
  ds_read_b64_tr_b16 a[42:43], v20 offset:20480
  v_mfma_f32_16x16x32_bf16 v[40:43], a[64:67], a[28:31], v[40:43]
  ds_read_b128 a[4:7], v16 offset:2048
  v_mfma_f32_16x16x32_bf16 v[48:51], a[64:67], a[32:35], v[48:51]
  ds_read_b128 a[8:11], v16 offset:4096
  v_mfma_f32_16x16x32_bf16 v[28:31], a[68:71], a[20:23], v[28:31]
  buffer_load_dwordx4 v5, s[8:11], s30 offen offset:1024 lds
  ds_read_b128 a[12:15], v16 offset:6144
  v_mfma_f32_16x16x32_bf16 v[36:39], a[68:71], a[24:27], v[36:39]
  ds_read_b64_tr_b16 a[44:45], v21 offset:18432
  v_mfma_f32_16x16x32_bf16 v[44:47], a[68:71], a[28:31], v[44:47]
  ds_read_b64_tr_b16 a[46:47], v21 offset:20480
  v_mfma_f32_16x16x32_bf16 v[52:55], a[68:71], a[32:35], v[52:55]
  ds_read_b64_tr_b16 a[48:49], v20 offset:26624
  v_mfma_f32_16x16x32_bf16 v[56:59], a[72:75], a[20:23], v[56:59]
  buffer_load_dwordx4 v6, s[8:11], s30 offen offset:2048 lds
  ds_read_b64_tr_b16 a[50:51], v20 offset:28672
  v_mfma_f32_16x16x32_bf16 v[64:67], a[72:75], a[24:27], v[64:67]
  ds_read_b64_tr_b16 a[52:53], v21 offset:26624
  v_mfma_f32_16x16x32_bf16 v[72:75], a[72:75], a[28:31], v[72:75]
  ds_read_b64_tr_b16 a[54:55], v21 offset:28672
  v_mfma_f32_16x16x32_bf16 v[80:83], a[72:75], a[32:35], v[80:83]
  ds_read_b64_tr_b16 a[56:57], v20 offset:34816
  v_mfma_f32_16x16x32_bf16 v[60:63], a[76:79], a[20:23], v[60:63]
  buffer_load_dwordx4 v7, s[8:11], s30 offen offset:3072 lds
  ds_read_b64_tr_b16 a[58:59], v20 offset:36864
  v_mfma_f32_16x16x32_bf16 v[68:71], a[76:79], a[24:27], v[68:71]
  s_mul_i32 s31, s0, 393216
  s_bfe_u32 s29, 0x302010e, s1
  s_add_u32 s0, s0, s29
  v_mfma_f32_16x16x32_bf16 v[76:79], a[76:79], a[28:31], v[76:79]
  s_add_u32 s1, s1, 8
  s_and_b32 s1, s1, 0x8001f
  s_and_b32 s0, s0, 15
  v_mfma_f32_16x16x32_bf16 v[84:87], a[76:79], a[32:35], v[84:87]
  s_lshl_b32 s30, s0, 7
  s_add_u32 m0, s88, s26
  ds_read_b128 a[16:19], v18 offset:0
  v_mfma_f32_16x16x32_bf16 v[88:91], a[20:23], a[80:83], v[88:91]
  buffer_load_dwordx4 v8, s[20:23], s31 offen offset:0 lds
  ds_read_b64_tr_b16 a[60:61], v21 offset:34816
  v_mfma_f32_16x16x32_bf16 v[96:99], a[24:27], a[80:83], v[96:99]
  ds_read_b64_tr_b16 a[62:63], v21 offset:36864
  v_mfma_f32_16x16x32_bf16 v[104:107], a[28:31], a[80:83], v[104:107]
  v_mfma_f32_16x16x32_bf16 v[112:115], a[32:35], a[80:83], v[112:115]
  v_mfma_f32_16x16x32_bf16 v[120:123], a[36:39], a[80:83], v[120:123]
  buffer_load_dwordx4 v9, s[20:23], s31 offen offset:1024 lds
  v_mfma_f32_16x16x32_bf16 v[92:95], a[20:23], a[84:87], v[92:95]
  v_mfma_f32_16x16x32_bf16 v[100:103], a[24:27], a[84:87], v[100:103]
  v_mfma_f32_16x16x32_bf16 v[108:111], a[28:31], a[84:87], v[108:111]
  v_mfma_f32_16x16x32_bf16 v[116:119], a[32:35], a[84:87], v[116:119]
  v_mfma_f32_16x16x32_bf16 v[124:127], a[36:39], a[84:87], v[124:127]
  s_waitcnt lgkmcnt(0)
  v_mfma_f32_16x16x32_bf16 v[24:27], a[40:43], a[0:3], v[24:27]
  buffer_load_dwordx4 v10, s[20:23], s31 offen offset:2048 lds
  ds_read_b128 a[20:23], v17 offset:0
  v_mfma_f32_16x16x32_bf16 v[32:35], a[40:43], a[4:7], v[32:35]
  s_add_u32 m0, s88, s27
  ds_read_b64_tr_b16 a[64:65], v20 offset:22528
  ds_read_b64_tr_b16 a[66:67], v20 offset:24576
  v_mfma_f32_16x16x32_bf16 v[40:43], a[40:43], a[8:11], v[40:43]
  ds_read_b128 a[24:27], v17 offset:2048
  v_mfma_f32_16x16x32_bf16 v[48:51], a[40:43], a[12:15], v[48:51]
  buffer_load_dwordx4 v11, s[20:23], s31 offen offset:0 lds
  ds_read_b128 a[28:31], v17 offset:4096
  v_mfma_f32_16x16x32_bf16 v[28:31], a[44:47], a[0:3], v[28:31]
  ds_read_b128 a[32:35], v17 offset:6144
  v_mfma_f32_16x16x32_bf16 v[36:39], a[44:47], a[4:7], v[36:39]
  ds_read_b64_tr_b16 a[68:69], v21 offset:22528
  v_mfma_f32_16x16x32_bf16 v[44:47], a[44:47], a[8:11], v[44:47]
  ds_read_b64_tr_b16 a[70:71], v21 offset:24576
  v_mfma_f32_16x16x32_bf16 v[52:55], a[44:47], a[12:15], v[52:55]
  buffer_load_dwordx4 v12, s[20:23], s31 offen offset:1024 lds
  ds_read_b64_tr_b16 a[72:73], v20 offset:30720
  v_mfma_f32_16x16x32_bf16 v[56:59], a[48:51], a[0:3], v[56:59]
  ds_read_b64_tr_b16 a[74:75], v20 offset:32768
  v_mfma_f32_16x16x32_bf16 v[64:67], a[48:51], a[4:7], v[64:67]
  ds_read_b64_tr_b16 a[76:77], v21 offset:30720
  v_mfma_f32_16x16x32_bf16 v[72:75], a[48:51], a[8:11], v[72:75]
  ds_read_b64_tr_b16 a[78:79], v21 offset:32768
  v_mfma_f32_16x16x32_bf16 v[80:83], a[48:51], a[12:15], v[80:83]
  buffer_load_dwordx4 v13, s[20:23], s31 offen offset:2048 lds
  ds_read_b64_tr_b16 a[80:81], v20 offset:38912
  v_mfma_f32_16x16x32_bf16 v[60:63], a[52:55], a[0:3], v[60:63]
  s_add_u32 s60, s63, 36864
  ds_read_b64_tr_b16 a[82:83], v20 offset:40960
  v_mfma_f32_16x16x32_bf16 v[68:71], a[52:55], a[4:7], v[68:71]
  ds_read_b128 a[36:39], v19 offset:0
  v_mfma_f32_16x16x32_bf16 v[76:79], a[52:55], a[8:11], v[76:79]
  ds_read_b64_tr_b16 a[84:85], v21 offset:38912
  v_mfma_f32_16x16x32_bf16 v[84:87], a[52:55], a[12:15], v[84:87]
  buffer_store_dwordx4 v[212:215], v2, s[16:19], s60 offen offset:1024 sc1
  ds_read_b64_tr_b16 a[86:87], v21 offset:40960
  v_mfma_f32_16x16x32_bf16 v[88:91], a[0:3], a[56:59], v[88:91]
  s_add_u32 s88, s88, s90
  s_add_u32 s89, s89, 1
  s_cmp_eq_u32 s89, 3
  s_cselect_b32 s89, 0, s89
  s_cselect_b32 s90, s91, s92
  v_mfma_f32_16x16x32_bf16 v[96:99], a[4:7], a[56:59], v[96:99]
  v_add_u32 v16, s90, v16
  v_add_u32 v17, s90, v17
  v_mfma_f32_16x16x32_bf16 v[104:107], a[8:11], a[56:59], v[104:107]
  v_add_u32 v18, s90, v18
  v_add_u32 v19, s90, v19
  v_mfma_f32_16x16x32_bf16 v[112:115], a[12:15], a[56:59], v[112:115]
  v_add_u32 v20, s90, v20
  v_add_u32 v21, s90, v21
  v_mfma_f32_16x16x32_bf16 v[120:123], a[16:19], a[56:59], v[120:123]
  v_mfma_f32_16x16x32_bf16 v[92:95], a[0:3], a[60:63], v[92:95]
  v_mfma_f32_16x16x32_bf16 v[100:103], a[4:7], a[60:63], v[100:103]
  v_mfma_f32_16x16x32_bf16 v[108:111], a[8:11], a[60:63], v[108:111]
  v_mfma_f32_16x16x32_bf16 v[116:119], a[12:15], a[60:63], v[116:119]
  v_mfma_f32_16x16x32_bf16 v[124:127], a[16:19], a[60:63], v[124:127]
  s_waitcnt vmcnt(12) lgkmcnt(0)
  s_barrier
  v_mfma_f32_16x16x32_bf16 v[24:27], a[64:67], a[20:23], v[24:27]
  s_mov_b32 m0, s88
  ds_read_b128 a[0:3], v16 offset:0
  ds_read_b64_tr_b16 a[40:41], v20 offset:18432
  v_mfma_f32_16x16x32_bf16 v[32:35], a[64:67], a[24:27], v[32:35]
  buffer_load_dwordx4 v4, s[8:11], s30 offen offset:0 lds
  ds_read_b64_tr_b16 a[42:43], v20 offset:20480
  v_mfma_f32_16x16x32_bf16 v[40:43], a[64:67], a[28:31], v[40:43]
  ds_read_b128 a[4:7], v16 offset:2048
  v_mfma_f32_16x16x32_bf16 v[48:51], a[64:67], a[32:35], v[48:51]
  ds_read_b128 a[8:11], v16 offset:4096
  v_mfma_f32_16x16x32_bf16 v[28:31], a[68:71], a[20:23], v[28:31]
  buffer_load_dwordx4 v5, s[8:11], s30 offen offset:1024 lds
  ds_read_b128 a[12:15], v16 offset:6144
  v_mfma_f32_16x16x32_bf16 v[36:39], a[68:71], a[24:27], v[36:39]
  ds_read_b64_tr_b16 a[44:45], v21 offset:18432
  v_mfma_f32_16x16x32_bf16 v[44:47], a[68:71], a[28:31], v[44:47]
  ds_read_b64_tr_b16 a[46:47], v21 offset:20480
  v_mfma_f32_16x16x32_bf16 v[52:55], a[68:71], a[32:35], v[52:55]
  ds_read_b64_tr_b16 a[48:49], v20 offset:26624
  v_mfma_f32_16x16x32_bf16 v[56:59], a[72:75], a[20:23], v[56:59]
  buffer_load_dwordx4 v6, s[8:11], s30 offen offset:2048 lds
  ds_read_b64_tr_b16 a[50:51], v20 offset:28672
  v_mfma_f32_16x16x32_bf16 v[64:67], a[72:75], a[24:27], v[64:67]
  ds_read_b64_tr_b16 a[52:53], v21 offset:26624
  v_mfma_f32_16x16x32_bf16 v[72:75], a[72:75], a[28:31], v[72:75]
  ds_read_b64_tr_b16 a[54:55], v21 offset:28672
  v_mfma_f32_16x16x32_bf16 v[80:83], a[72:75], a[32:35], v[80:83]
  ds_read_b64_tr_b16 a[56:57], v20 offset:34816
  v_mfma_f32_16x16x32_bf16 v[60:63], a[76:79], a[20:23], v[60:63]
  buffer_load_dwordx4 v7, s[8:11], s30 offen offset:3072 lds
  ds_read_b64_tr_b16 a[58:59], v20 offset:36864
  v_mfma_f32_16x16x32_bf16 v[68:71], a[76:79], a[24:27], v[68:71]
  s_mul_i32 s31, s0, 393216
  s_bfe_u32 s29, 0x302010e, s1
  s_add_u32 s0, s0, s29
  v_mfma_f32_16x16x32_bf16 v[76:79], a[76:79], a[28:31], v[76:79]
  s_add_u32 s1, s1, 8
  s_and_b32 s1, s1, 0x8001f
  s_and_b32 s0, s0, 15
  v_mfma_f32_16x16x32_bf16 v[84:87], a[76:79], a[32:35], v[84:87]
  s_lshl_b32 s30, s0, 7
  s_add_u32 m0, s88, s26
  ds_read_b128 a[16:19], v18 offset:0
  v_mfma_f32_16x16x32_bf16 v[88:91], a[20:23], a[80:83], v[88:91]
  buffer_load_dwordx4 v8, s[20:23], s31 offen offset:0 lds
  ds_read_b64_tr_b16 a[60:61], v21 offset:34816
  v_mfma_f32_16x16x32_bf16 v[96:99], a[24:27], a[80:83], v[96:99]
  ds_read_b64_tr_b16 a[62:63], v21 offset:36864
  v_mfma_f32_16x16x32_bf16 v[104:107], a[28:31], a[80:83], v[104:107]
  v_mfma_f32_16x16x32_bf16 v[112:115], a[32:35], a[80:83], v[112:115]
  v_mfma_f32_16x16x32_bf16 v[120:123], a[36:39], a[80:83], v[120:123]
  buffer_load_dwordx4 v9, s[20:23], s31 offen offset:1024 lds
  v_mfma_f32_16x16x32_bf16 v[92:95], a[20:23], a[84:87], v[92:95]
  v_mfma_f32_16x16x32_bf16 v[100:103], a[24:27], a[84:87], v[100:103]
  v_mfma_f32_16x16x32_bf16 v[108:111], a[28:31], a[84:87], v[108:111]
  v_mfma_f32_16x16x32_bf16 v[116:119], a[32:35], a[84:87], v[116:119]
  v_mfma_f32_16x16x32_bf16 v[124:127], a[36:39], a[84:87], v[124:127]
  s_waitcnt lgkmcnt(0)
  v_mfma_f32_16x16x32_bf16 v[24:27], a[40:43], a[0:3], v[24:27]
  buffer_load_dwordx4 v10, s[20:23], s31 offen offset:2048 lds
  ds_read_b128 a[20:23], v17 offset:0
  v_mfma_f32_16x16x32_bf16 v[32:35], a[40:43], a[4:7], v[32:35]
  s_add_u32 m0, s88, s27
  ds_read_b64_tr_b16 a[64:65], v20 offset:22528
  ds_read_b64_tr_b16 a[66:67], v20 offset:24576
  v_mfma_f32_16x16x32_bf16 v[40:43], a[40:43], a[8:11], v[40:43]
  ds_read_b128 a[24:27], v17 offset:2048
  v_mfma_f32_16x16x32_bf16 v[48:51], a[40:43], a[12:15], v[48:51]
  buffer_load_dwordx4 v11, s[20:23], s31 offen offset:0 lds
  ds_read_b128 a[28:31], v17 offset:4096
  v_mfma_f32_16x16x32_bf16 v[28:31], a[44:47], a[0:3], v[28:31]
  ds_read_b128 a[32:35], v17 offset:6144
  v_mfma_f32_16x16x32_bf16 v[36:39], a[44:47], a[4:7], v[36:39]
  ds_read_b64_tr_b16 a[68:69], v21 offset:22528
  v_mfma_f32_16x16x32_bf16 v[44:47], a[44:47], a[8:11], v[44:47]
  ds_read_b64_tr_b16 a[70:71], v21 offset:24576
  v_mfma_f32_16x16x32_bf16 v[52:55], a[44:47], a[12:15], v[52:55]
  buffer_load_dwordx4 v12, s[20:23], s31 offen offset:1024 lds
  ds_read_b64_tr_b16 a[72:73], v20 offset:30720
  v_mfma_f32_16x16x32_bf16 v[56:59], a[48:51], a[0:3], v[56:59]
  ds_read_b64_tr_b16 a[74:75], v20 offset:32768
  v_mfma_f32_16x16x32_bf16 v[64:67], a[48:51], a[4:7], v[64:67]
  ds_read_b64_tr_b16 a[76:77], v21 offset:30720
  v_mfma_f32_16x16x32_bf16 v[72:75], a[48:51], a[8:11], v[72:75]
  ds_read_b64_tr_b16 a[78:79], v21 offset:32768
  v_mfma_f32_16x16x32_bf16 v[80:83], a[48:51], a[12:15], v[80:83]
  buffer_load_dwordx4 v13, s[20:23], s31 offen offset:2048 lds
  ds_read_b64_tr_b16 a[80:81], v20 offset:38912
  v_mfma_f32_16x16x32_bf16 v[60:63], a[52:55], a[0:3], v[60:63]
  s_add_u32 s60, s63, 36864
  ds_read_b64_tr_b16 a[82:83], v20 offset:40960
  v_mfma_f32_16x16x32_bf16 v[68:71], a[52:55], a[4:7], v[68:71]
  ds_read_b128 a[36:39], v19 offset:0
  v_mfma_f32_16x16x32_bf16 v[76:79], a[52:55], a[8:11], v[76:79]
  ds_read_b64_tr_b16 a[84:85], v21 offset:38912
  v_mfma_f32_16x16x32_bf16 v[84:87], a[52:55], a[12:15], v[84:87]
  buffer_store_dwordx4 v[216:219], v2, s[16:19], s60 offen offset:2048 sc1
  ds_read_b64_tr_b16 a[86:87], v21 offset:40960
  v_mfma_f32_16x16x32_bf16 v[88:91], a[0:3], a[56:59], v[88:91]
  s_add_u32 s88, s88, s90
  s_add_u32 s89, s89, 1
  s_cmp_eq_u32 s89, 3
  s_cselect_b32 s89, 0, s89
  s_cselect_b32 s90, s91, s92
  v_mfma_f32_16x16x32_bf16 v[96:99], a[4:7], a[56:59], v[96:99]
  v_add_u32 v16, s90, v16
  v_add_u32 v17, s90, v17
  v_mfma_f32_16x16x32_bf16 v[104:107], a[8:11], a[56:59], v[104:107]
  v_add_u32 v18, s90, v18
  v_add_u32 v19, s90, v19
  v_mfma_f32_16x16x32_bf16 v[112:115], a[12:15], a[56:59], v[112:115]
  v_add_u32 v20, s90, v20
  v_add_u32 v21, s90, v21
  v_mfma_f32_16x16x32_bf16 v[120:123], a[16:19], a[56:59], v[120:123]
  v_mfma_f32_16x16x32_bf16 v[92:95], a[0:3], a[60:63], v[92:95]
  v_mfma_f32_16x16x32_bf16 v[100:103], a[4:7], a[60:63], v[100:103]
  v_mfma_f32_16x16x32_bf16 v[108:111], a[8:11], a[60:63], v[108:111]
  v_mfma_f32_16x16x32_bf16 v[116:119], a[12:15], a[60:63], v[116:119]
  v_mfma_f32_16x16x32_bf16 v[124:127], a[16:19], a[60:63], v[124:127]
  s_waitcnt vmcnt(12) lgkmcnt(0)
  s_barrier
  v_accvgpr_read_b32 v4, a222
  v_accvgpr_read_b32 v5, a223
  v_accvgpr_read_b32 v6, a224
  v_accvgpr_read_b32 v7, a225
  v_accvgpr_read_b32 v8, a226
  v_accvgpr_read_b32 v9, a227
  v_accvgpr_read_b32 v10, a228
  v_accvgpr_read_b32 v11, a229
  s_mov_b32 s8, s64
  s_mov_b32 s9, s65
  s_mov_b32 s10, 4194304
  s_mov_b32 s11, 0x00020000
  s_mov_b32 s12, s68
  s_mov_b32 s13, s69
  s_mov_b32 s14, 8388608
  s_mov_b32 s15, 0x00020000
  s_and_b32 s4, s2, 7
  s_lshl_b32 s4, s4, 1
  s_lshr_b32 s5, s2, 6
  s_add_u32 s5, s5, s25
  s_and_b32 s53, s5, 3
  s_lshl_b32 s53, s53, 3
  s_or_b32 s53, s53, 0x80000
  s_bfe_u32 s52, 0xf0f02, s53
  s_add_u32 s52, s52, s4
  s_and_b32 s52, s52, 15
  s_mov_b32 s54, s52
  s_mov_b32 s55, s53
  s_lshl_b32 s49, s52, 7
  s_lshl_b32 s48, s54, 19
  s_lshl_b32 s50, s25, 18
  s_sub_u32 s51, 3932160, s50
  s_or_b32 s46, s50, s49
  s_or_b32 s47, s51, s49
  s_lshl_b32 s41, s3, 12
  s_lshl_b32 s36, s3, 13
  s_add_u32 s36, s36, 98304
  v_mfma_f32_16x16x32_bf16 v[24:27], a[64:67], a[20:23], v[24:27]
  s_mov_b32 m0, s41
  ds_read_b128 a[0:3], v16 offset:0
  ds_read_b64_tr_b16 a[40:41], v20 offset:18432
  v_mfma_f32_16x16x32_bf16 v[32:35], a[64:67], a[24:27], v[32:35]
  buffer_load_dwordx4 v8, s[12:15], s48 offen offset:0 lds
  ds_read_b64_tr_b16 a[42:43], v20 offset:20480
  v_mfma_f32_16x16x32_bf16 v[40:43], a[64:67], a[28:31], v[40:43]
  ds_read_b128 a[4:7], v16 offset:2048
  v_mfma_f32_16x16x32_bf16 v[48:51], a[64:67], a[32:35], v[48:51]
  ds_read_b128 a[8:11], v16 offset:4096
  v_mfma_f32_16x16x32_bf16 v[28:31], a[68:71], a[20:23], v[28:31]
  ds_read_b128 a[12:15], v16 offset:6144
  v_mfma_f32_16x16x32_bf16 v[36:39], a[68:71], a[24:27], v[36:39]
  buffer_load_dwordx4 v9, s[12:15], s48 offen offset:1024 lds
  ds_read_b64_tr_b16 a[44:45], v21 offset:18432
  v_mfma_f32_16x16x32_bf16 v[44:47], a[68:71], a[28:31], v[44:47]
  ds_read_b64_tr_b16 a[46:47], v21 offset:20480
  v_mfma_f32_16x16x32_bf16 v[52:55], a[68:71], a[32:35], v[52:55]
  ds_read_b64_tr_b16 a[48:49], v20 offset:26624
  v_mfma_f32_16x16x32_bf16 v[56:59], a[72:75], a[20:23], v[56:59]
  ds_read_b64_tr_b16 a[50:51], v20 offset:28672
  v_mfma_f32_16x16x32_bf16 v[64:67], a[72:75], a[24:27], v[64:67]
  ds_read_b64_tr_b16 a[52:53], v21 offset:26624
  v_mfma_f32_16x16x32_bf16 v[72:75], a[72:75], a[28:31], v[72:75]
  buffer_load_dwordx4 v10, s[12:15], s48 offen offset:2048 lds
  ds_read_b64_tr_b16 a[54:55], v21 offset:28672
  v_mfma_f32_16x16x32_bf16 v[80:83], a[72:75], a[32:35], v[80:83]
  ds_read_b64_tr_b16 a[56:57], v20 offset:34816
  v_mfma_f32_16x16x32_bf16 v[60:63], a[76:79], a[20:23], v[60:63]
  ds_read_b64_tr_b16 a[58:59], v20 offset:36864
  v_mfma_f32_16x16x32_bf16 v[68:71], a[76:79], a[24:27], v[68:71]
  ds_read_b128 a[16:19], v18 offset:0
  v_mfma_f32_16x16x32_bf16 v[76:79], a[76:79], a[28:31], v[76:79]
  ds_read_b64_tr_b16 a[60:61], v21 offset:34816
  v_mfma_f32_16x16x32_bf16 v[84:87], a[76:79], a[32:35], v[84:87]
  buffer_load_dwordx4 v11, s[12:15], s48 offen offset:3072 lds
  ds_read_b64_tr_b16 a[62:63], v21 offset:36864
  v_mfma_f32_16x16x32_bf16 v[88:91], a[20:23], a[80:83], v[88:91]
  s_bfe_u32 s56, 0x302010e, s55
  s_add_u32 s54, s54, s56
  s_add_u32 s55, s55, 8
  v_mfma_f32_16x16x32_bf16 v[96:99], a[24:27], a[80:83], v[96:99]
  s_and_b32 s55, s55, 0x8001f
  s_and_b32 s54, s54, 15
  s_lshl_b32 s48, s54, 19
  v_mfma_f32_16x16x32_bf16 v[104:107], a[28:31], a[80:83], v[104:107]
  s_add_u32 m0, s41, 16384
  v_mfma_f32_16x16x32_bf16 v[112:115], a[32:35], a[80:83], v[112:115]
  v_mfma_f32_16x16x32_bf16 v[120:123], a[36:39], a[80:83], v[120:123]
  buffer_load_dwordx4 v8, s[12:15], s48 offen offset:0 lds
  v_mfma_f32_16x16x32_bf16 v[92:95], a[20:23], a[84:87], v[92:95]
  v_mfma_f32_16x16x32_bf16 v[100:103], a[24:27], a[84:87], v[100:103]
  v_mfma_f32_16x16x32_bf16 v[108:111], a[28:31], a[84:87], v[108:111]
  v_mfma_f32_16x16x32_bf16 v[116:119], a[32:35], a[84:87], v[116:119]
  v_mfma_f32_16x16x32_bf16 v[124:127], a[36:39], a[84:87], v[124:127]
  s_waitcnt lgkmcnt(0)
  v_mfma_f32_16x16x32_bf16 v[24:27], a[40:43], a[0:3], v[24:27]
  buffer_load_dwordx4 v9, s[12:15], s48 offen offset:1024 lds
  ds_read_b128 a[20:23], v17 offset:0
  v_mfma_f32_16x16x32_bf16 v[32:35], a[40:43], a[4:7], v[32:35]
  ds_read_b64_tr_b16 a[64:65], v20 offset:22528
  ds_read_b64_tr_b16 a[66:67], v20 offset:24576
  v_mfma_f32_16x16x32_bf16 v[40:43], a[40:43], a[8:11], v[40:43]
  ds_read_b128 a[24:27], v17 offset:2048
  v_mfma_f32_16x16x32_bf16 v[48:51], a[40:43], a[12:15], v[48:51]
  ds_read_b128 a[28:31], v17 offset:4096
  v_mfma_f32_16x16x32_bf16 v[28:31], a[44:47], a[0:3], v[28:31]
  buffer_load_dwordx4 v10, s[12:15], s48 offen offset:2048 lds
  ds_read_b128 a[32:35], v17 offset:6144
  v_mfma_f32_16x16x32_bf16 v[36:39], a[44:47], a[4:7], v[36:39]
  ds_read_b64_tr_b16 a[68:69], v21 offset:22528
  v_mfma_f32_16x16x32_bf16 v[44:47], a[44:47], a[8:11], v[44:47]
  ds_read_b64_tr_b16 a[70:71], v21 offset:24576
  v_mfma_f32_16x16x32_bf16 v[52:55], a[44:47], a[12:15], v[52:55]
  ds_read_b64_tr_b16 a[72:73], v20 offset:30720
  v_mfma_f32_16x16x32_bf16 v[56:59], a[48:51], a[0:3], v[56:59]
  ds_read_b64_tr_b16 a[74:75], v20 offset:32768
  v_mfma_f32_16x16x32_bf16 v[64:67], a[48:51], a[4:7], v[64:67]
  buffer_load_dwordx4 v11, s[12:15], s48 offen offset:3072 lds
  ds_read_b64_tr_b16 a[76:77], v21 offset:30720
  v_mfma_f32_16x16x32_bf16 v[72:75], a[48:51], a[8:11], v[72:75]
  s_bfe_u32 s56, 0x302010e, s55
  s_add_u32 s54, s54, s56
  s_add_u32 s55, s55, 8
  v_mfma_f32_16x16x32_bf16 v[80:83], a[48:51], a[12:15], v[80:83]
  s_and_b32 s55, s55, 0x8001f
  s_and_b32 s54, s54, 15
  s_lshl_b32 s48, s54, 19
  v_mfma_f32_16x16x32_bf16 v[60:63], a[52:55], a[0:3], v[60:63]
  s_add_u32 s60, s63, 36864
  ds_read_b64_tr_b16 a[78:79], v21 offset:32768
  ds_read_b64_tr_b16 a[80:81], v20 offset:38912
  v_mfma_f32_16x16x32_bf16 v[68:71], a[52:55], a[4:7], v[68:71]
  ds_read_b64_tr_b16 a[82:83], v20 offset:40960
  ds_read_b128 a[36:39], v19 offset:0
  v_mfma_f32_16x16x32_bf16 v[76:79], a[52:55], a[8:11], v[76:79]
  buffer_store_dwordx4 v[220:223], v2, s[16:19], s60 offen offset:3072 sc1
  ds_read_b64_tr_b16 a[84:85], v21 offset:38912
  v_mfma_f32_16x16x32_bf16 v[84:87], a[52:55], a[12:15], v[84:87]
  s_add_u32 s88, s88, s90
  s_add_u32 s89, s89, 1
  ds_read_b64_tr_b16 a[86:87], v21 offset:40960
  v_mfma_f32_16x16x32_bf16 v[88:91], a[0:3], a[56:59], v[88:91]
  s_cmp_eq_u32 s89, 3
  s_cselect_b32 s89, 0, s89
  s_cselect_b32 s90, s91, s92
  v_mfma_f32_16x16x32_bf16 v[96:99], a[4:7], a[56:59], v[96:99]
  v_add_u32 v16, s90, v16
  v_add_u32 v17, s90, v17
  v_mfma_f32_16x16x32_bf16 v[104:107], a[8:11], a[56:59], v[104:107]
  v_add_u32 v18, s90, v18
  v_add_u32 v19, s90, v19
  v_mfma_f32_16x16x32_bf16 v[112:115], a[12:15], a[56:59], v[112:115]
  v_add_u32 v20, s90, v20
  v_add_u32 v21, s90, v21
  v_mfma_f32_16x16x32_bf16 v[120:123], a[16:19], a[56:59], v[120:123]
  v_mfma_f32_16x16x32_bf16 v[92:95], a[0:3], a[60:63], v[92:95]
  v_mfma_f32_16x16x32_bf16 v[100:103], a[4:7], a[60:63], v[100:103]
  v_mfma_f32_16x16x32_bf16 v[108:111], a[8:11], a[60:63], v[108:111]
  v_mfma_f32_16x16x32_bf16 v[116:119], a[12:15], a[60:63], v[116:119]
  v_mfma_f32_16x16x32_bf16 v[124:127], a[16:19], a[60:63], v[124:127]
  s_waitcnt vmcnt(10) lgkmcnt(0)
  s_barrier
  v_mfma_f32_16x16x32_bf16 v[24:27], a[64:67], a[20:23], v[24:27]
  s_mov_b32 m0, s36
  ds_read_b128 a[0:3], v16 offset:0
  ds_read_b64_tr_b16 a[40:41], v20 offset:18432
  v_mfma_f32_16x16x32_bf16 v[32:35], a[64:67], a[24:27], v[32:35]
  buffer_load_dwordx4 v4, s[8:11], s46 offen offset:0 lds
  ds_read_b64_tr_b16 a[42:43], v20 offset:20480
  v_mfma_f32_16x16x32_bf16 v[40:43], a[64:67], a[28:31], v[40:43]
  ds_read_b128 a[4:7], v16 offset:2048
  v_mfma_f32_16x16x32_bf16 v[48:51], a[64:67], a[32:35], v[48:51]
  ds_read_b128 a[8:11], v16 offset:4096
  v_mfma_f32_16x16x32_bf16 v[28:31], a[68:71], a[20:23], v[28:31]
  ds_read_b128 a[12:15], v16 offset:6144
  v_mfma_f32_16x16x32_bf16 v[36:39], a[68:71], a[24:27], v[36:39]
  buffer_load_dwordx4 v5, s[8:11], s46 offen offset:1024 lds
  ds_read_b64_tr_b16 a[44:45], v21 offset:18432
  v_mfma_f32_16x16x32_bf16 v[44:47], a[68:71], a[28:31], v[44:47]
  ds_read_b64_tr_b16 a[46:47], v21 offset:20480
  v_mfma_f32_16x16x32_bf16 v[52:55], a[68:71], a[32:35], v[52:55]
  ds_read_b64_tr_b16 a[48:49], v20 offset:26624
  v_mfma_f32_16x16x32_bf16 v[56:59], a[72:75], a[20:23], v[56:59]
  ds_read_b64_tr_b16 a[50:51], v20 offset:28672
  v_mfma_f32_16x16x32_bf16 v[64:67], a[72:75], a[24:27], v[64:67]
  ds_read_b64_tr_b16 a[52:53], v21 offset:26624
  v_mfma_f32_16x16x32_bf16 v[72:75], a[72:75], a[28:31], v[72:75]
  buffer_load_dwordx4 v6, s[8:11], s46 offen offset:2048 lds
  ds_read_b64_tr_b16 a[54:55], v21 offset:28672
  v_mfma_f32_16x16x32_bf16 v[80:83], a[72:75], a[32:35], v[80:83]
  ds_read_b64_tr_b16 a[56:57], v20 offset:34816
  v_mfma_f32_16x16x32_bf16 v[60:63], a[76:79], a[20:23], v[60:63]
  ds_read_b64_tr_b16 a[58:59], v20 offset:36864
  v_mfma_f32_16x16x32_bf16 v[68:71], a[76:79], a[24:27], v[68:71]
  ds_read_b128 a[16:19], v18 offset:0
  v_mfma_f32_16x16x32_bf16 v[76:79], a[76:79], a[28:31], v[76:79]
  ds_read_b64_tr_b16 a[60:61], v21 offset:34816
  v_mfma_f32_16x16x32_bf16 v[84:87], a[76:79], a[32:35], v[84:87]
  buffer_load_dwordx4 v7, s[8:11], s46 offen offset:3072 lds
  ds_read_b64_tr_b16 a[62:63], v21 offset:36864
  v_mfma_f32_16x16x32_bf16 v[88:91], a[20:23], a[80:83], v[88:91]
  s_add_u32 m0, s36, 4096
  v_mfma_f32_16x16x32_bf16 v[96:99], a[24:27], a[80:83], v[96:99]
  v_mfma_f32_16x16x32_bf16 v[104:107], a[28:31], a[80:83], v[104:107]
  v_mfma_f32_16x16x32_bf16 v[112:115], a[32:35], a[80:83], v[112:115]
  v_mfma_f32_16x16x32_bf16 v[120:123], a[36:39], a[80:83], v[120:123]
  buffer_load_dwordx4 v4, s[8:11], s47 offen offset:0 lds
  v_mfma_f32_16x16x32_bf16 v[92:95], a[20:23], a[84:87], v[92:95]
  v_mfma_f32_16x16x32_bf16 v[100:103], a[24:27], a[84:87], v[100:103]
  v_mfma_f32_16x16x32_bf16 v[108:111], a[28:31], a[84:87], v[108:111]
  v_mfma_f32_16x16x32_bf16 v[116:119], a[32:35], a[84:87], v[116:119]
  v_mfma_f32_16x16x32_bf16 v[124:127], a[36:39], a[84:87], v[124:127]
  s_waitcnt lgkmcnt(0)
  v_mfma_f32_16x16x32_bf16 v[24:27], a[40:43], a[0:3], v[24:27]
  buffer_load_dwordx4 v5, s[8:11], s47 offen offset:1024 lds
  ds_read_b128 a[20:23], v17 offset:0
  v_mfma_f32_16x16x32_bf16 v[32:35], a[40:43], a[4:7], v[32:35]
  ds_read_b64_tr_b16 a[64:65], v20 offset:22528
  ds_read_b64_tr_b16 a[66:67], v20 offset:24576
  v_mfma_f32_16x16x32_bf16 v[40:43], a[40:43], a[8:11], v[40:43]
  ds_read_b128 a[24:27], v17 offset:2048
  v_mfma_f32_16x16x32_bf16 v[48:51], a[40:43], a[12:15], v[48:51]
  ds_read_b128 a[28:31], v17 offset:4096
  v_mfma_f32_16x16x32_bf16 v[28:31], a[44:47], a[0:3], v[28:31]
  ds_read_b128 a[32:35], v17 offset:6144
  v_mfma_f32_16x16x32_bf16 v[36:39], a[44:47], a[4:7], v[36:39]
  buffer_load_dwordx4 v6, s[8:11], s47 offen offset:2048 lds
  ds_read_b64_tr_b16 a[68:69], v21 offset:22528
  v_mfma_f32_16x16x32_bf16 v[44:47], a[44:47], a[8:11], v[44:47]
  ds_read_b64_tr_b16 a[70:71], v21 offset:24576
  v_mfma_f32_16x16x32_bf16 v[52:55], a[44:47], a[12:15], v[52:55]
  ds_read_b64_tr_b16 a[72:73], v20 offset:30720
  v_mfma_f32_16x16x32_bf16 v[56:59], a[48:51], a[0:3], v[56:59]
  ds_read_b64_tr_b16 a[74:75], v20 offset:32768
  v_mfma_f32_16x16x32_bf16 v[64:67], a[48:51], a[4:7], v[64:67]
  ds_read_b64_tr_b16 a[76:77], v21 offset:30720
  v_mfma_f32_16x16x32_bf16 v[72:75], a[48:51], a[8:11], v[72:75]
  buffer_load_dwordx4 v7, s[8:11], s47 offen offset:3072 lds
  ds_read_b64_tr_b16 a[78:79], v21 offset:32768
  v_mfma_f32_16x16x32_bf16 v[80:83], a[48:51], a[12:15], v[80:83]
  s_bfe_u32 s49, 0x302010e, s53
  s_add_u32 s52, s52, s49
  s_add_u32 s53, s53, 8
  v_mfma_f32_16x16x32_bf16 v[60:63], a[52:55], a[0:3], v[60:63]
  s_and_b32 s53, s53, 0x8001f
  s_and_b32 s52, s52, 15
  s_lshl_b32 s49, s52, 7
  v_mfma_f32_16x16x32_bf16 v[68:71], a[52:55], a[4:7], v[68:71]
  s_or_b32 s46, s50, s49
  s_or_b32 s47, s51, s49
  s_add_u32 s60, s63, 40960
  v_mfma_f32_16x16x32_bf16 v[76:79], a[52:55], a[8:11], v[76:79]
  ds_read_b64_tr_b16 a[80:81], v20 offset:38912
  ds_read_b64_tr_b16 a[82:83], v20 offset:40960
  v_mfma_f32_16x16x32_bf16 v[84:87], a[52:55], a[12:15], v[84:87]
  buffer_store_dwordx4 v[224:227], v2, s[16:19], s60 offen offset:0 sc1
  ds_read_b128 a[36:39], v19 offset:0
  v_mfma_f32_16x16x32_bf16 v[88:91], a[0:3], a[56:59], v[88:91]
  ds_read_b64_tr_b16 a[84:85], v21 offset:38912
  ds_read_b64_tr_b16 a[86:87], v21 offset:40960
  v_mfma_f32_16x16x32_bf16 v[96:99], a[4:7], a[56:59], v[96:99]
  v_mfma_f32_16x16x32_bf16 v[104:107], a[8:11], a[56:59], v[104:107]
  v_mfma_f32_16x16x32_bf16 v[112:115], a[12:15], a[56:59], v[112:115]
  v_mfma_f32_16x16x32_bf16 v[120:123], a[16:19], a[56:59], v[120:123]
  buffer_store_dwordx4 v[228:231], v2, s[16:19], s60 offen offset:1024 sc1
  v_mfma_f32_16x16x32_bf16 v[92:95], a[0:3], a[60:63], v[92:95]
  v_mfma_f32_16x16x32_bf16 v[100:103], a[4:7], a[60:63], v[100:103]
  v_mfma_f32_16x16x32_bf16 v[108:111], a[8:11], a[60:63], v[108:111]
  v_mfma_f32_16x16x32_bf16 v[116:119], a[12:15], a[60:63], v[116:119]
  v_mfma_f32_16x16x32_bf16 v[124:127], a[16:19], a[60:63], v[124:127]
  s_waitcnt lgkmcnt(0)
  s_barrier
  v_mfma_f32_16x16x32_bf16 v[24:27], a[64:67], a[20:23], v[24:27]
  s_add_u32 m0, s36, 32768
  v_mfma_f32_16x16x32_bf16 v[32:35], a[64:67], a[24:27], v[32:35]
  buffer_load_dwordx4 v4, s[8:11], s46 offen offset:0 lds
  v_mfma_f32_16x16x32_bf16 v[40:43], a[64:67], a[28:31], v[40:43]
  v_mfma_f32_16x16x32_bf16 v[48:51], a[64:67], a[32:35], v[48:51]
  buffer_load_dwordx4 v5, s[8:11], s46 offen offset:1024 lds
  v_mfma_f32_16x16x32_bf16 v[28:31], a[68:71], a[20:23], v[28:31]
  v_mfma_f32_16x16x32_bf16 v[36:39], a[68:71], a[24:27], v[36:39]
  v_mfma_f32_16x16x32_bf16 v[44:47], a[68:71], a[28:31], v[44:47]
  buffer_load_dwordx4 v6, s[8:11], s46 offen offset:2048 lds
  v_mfma_f32_16x16x32_bf16 v[52:55], a[68:71], a[32:35], v[52:55]
  v_mfma_f32_16x16x32_bf16 v[56:59], a[72:75], a[20:23], v[56:59]
  v_mfma_f32_16x16x32_bf16 v[64:67], a[72:75], a[24:27], v[64:67]
  buffer_load_dwordx4 v7, s[8:11], s46 offen offset:3072 lds
  v_mfma_f32_16x16x32_bf16 v[72:75], a[72:75], a[28:31], v[72:75]
  s_add_u32 m0, s36, 36864
  v_mfma_f32_16x16x32_bf16 v[80:83], a[72:75], a[32:35], v[80:83]
  v_mfma_f32_16x16x32_bf16 v[60:63], a[76:79], a[20:23], v[60:63]
  buffer_load_dwordx4 v4, s[8:11], s47 offen offset:0 lds
  v_mfma_f32_16x16x32_bf16 v[68:71], a[76:79], a[24:27], v[68:71]
  v_mfma_f32_16x16x32_bf16 v[76:79], a[76:79], a[28:31], v[76:79]
  v_mfma_f32_16x16x32_bf16 v[84:87], a[76:79], a[32:35], v[84:87]
  buffer_load_dwordx4 v5, s[8:11], s47 offen offset:1024 lds
  v_mfma_f32_16x16x32_bf16 v[88:91], a[20:23], a[80:83], v[88:91]
  v_mfma_f32_16x16x32_bf16 v[96:99], a[24:27], a[80:83], v[96:99]
  v_mfma_f32_16x16x32_bf16 v[104:107], a[28:31], a[80:83], v[104:107]
  buffer_load_dwordx4 v6, s[8:11], s47 offen offset:2048 lds
  v_mfma_f32_16x16x32_bf16 v[112:115], a[32:35], a[80:83], v[112:115]
  v_mfma_f32_16x16x32_bf16 v[120:123], a[36:39], a[80:83], v[120:123]
  v_mfma_f32_16x16x32_bf16 v[92:95], a[20:23], a[84:87], v[92:95]
  buffer_load_dwordx4 v7, s[8:11], s47 offen offset:3072 lds
  v_mfma_f32_16x16x32_bf16 v[100:103], a[24:27], a[84:87], v[100:103]
  s_bfe_u32 s49, 0x302010e, s53
  s_add_u32 s52, s52, s49
  s_add_u32 s53, s53, 8
  v_mfma_f32_16x16x32_bf16 v[108:111], a[28:31], a[84:87], v[108:111]
  s_and_b32 s53, s53, 0x8001f
  s_and_b32 s52, s52, 15
  s_lshl_b32 s49, s52, 7
  v_mfma_f32_16x16x32_bf16 v[116:119], a[32:35], a[84:87], v[116:119]
  s_or_b32 s46, s50, s49
  s_or_b32 s47, s51, s49
  v_mfma_f32_16x16x32_bf16 v[124:127], a[36:39], a[84:87], v[124:127]
  s_and_b32 s4, s3, 1
  s_mul_i32 s4, s4, 3072
  s_add_u32 s4, s4, 49152
  v_add_u32 v196, s4, v2
  s_add_u32 s60, s63, 40960
  buffer_store_dwordx4 v[232:235], v2, s[16:19], s60 offen offset:2048 sc1
  v_cvt_pk_bf16_f32 v200, v120, v121
  v_cvt_pk_bf16_f32 v201, v122, v123
  v_cvt_pk_bf16_f32 v202, v124, v125
  v_cvt_pk_bf16_f32 v203, v126, v127
  ds_write_b128 v196, v[200:203] offset:2048
  v_and_b32 v197, 15, v1
  v_lshrrev_b32 v198, 4, v1
  v_lshlrev_b32 v198, 2, v198
  v_sub_u32 v197, v197, v198
  v_mov_b32 v198, 0xf149f2ca
  v_subrev_u32 v199, 0, v197
  v_and_b32 v184, 0x80000001, v199
  v_cmp_ne_u32 vcc, 0, v184
  s_nop 1
  v_cndmask_b32 v184, 0, v198, vcc
  v_add_u32 v199, 1, v199
  v_and_b32 v188, 0x80000001, v199
  v_cmp_ne_u32 vcc, 0x80000001, v188
  s_nop 1
  v_cndmask_b32 v188, 0, v198, vcc
  buffer_store_dwordx4 v[236:239], v2, s[16:19], s60 offen offset:3072 sc1
  v_subrev_u32 v199, 1, v197
  v_and_b32 v185, 0x80000001, v199
  v_cmp_ne_u32 vcc, 0, v185
  s_nop 1
  v_cndmask_b32 v185, 0, v198, vcc
  v_add_u32 v199, 1, v199
  v_and_b32 v189, 0x80000001, v199
  v_cmp_ne_u32 vcc, 0x80000001, v189
  s_nop 1
  v_cndmask_b32 v189, 0, v198, vcc
  v_subrev_u32 v199, 2, v197
  v_and_b32 v186, 0x80000001, v199
  v_cmp_ne_u32 vcc, 0, v186
  s_nop 1
  v_cndmask_b32 v186, 0, v198, vcc
  v_add_u32 v199, 1, v199
  v_and_b32 v190, 0x80000001, v199
  v_cmp_ne_u32 vcc, 0x80000001, v190
  s_nop 1
  v_cndmask_b32 v190, 0, v198, vcc
  v_subrev_u32 v199, 3, v197
  v_and_b32 v187, 0x80000001, v199
  v_cmp_ne_u32 vcc, 0, v187
  s_nop 1
  v_cndmask_b32 v187, 0, v198, vcc
  v_add_u32 v199, 1, v199
  v_and_b32 v191, 0x80000001, v199
  v_cmp_ne_u32 vcc, 0x80000001, v191
  s_nop 1
  v_cndmask_b32 v191, 0, v198, vcc
  s_mov_b32 s6, 0x3e8293ee
  s_mov_b32 s7, s6
  v_pk_mul_f32 v[24:25], v[24:25], s[6:7]
  v_pk_mul_f32 v[26:27], v[26:27], s[6:7]
  s_add_u32 s60, s63, 45056
  buffer_store_dwordx4 v[240:243], v2, s[16:19], s60 offen offset:0 sc1
  v_pk_mul_f32 v[28:29], v[28:29], s[6:7]
  v_pk_mul_f32 v[30:31], v[30:31], s[6:7]
  v_cvt_pk_bf16_f32 v128, v24, v25
  v_cvt_pk_bf16_f32 v129, v26, v27
  v_cvt_pk_bf16_f32 v130, v28, v29
  v_cvt_pk_bf16_f32 v131, v30, v31
  v_pk_mul_f32 v[32:33], v[32:33], s[6:7]
  v_pk_mul_f32 v[34:35], v[34:35], s[6:7]
  v_pk_mul_f32 v[36:37], v[36:37], s[6:7]
  v_pk_mul_f32 v[38:39], v[38:39], s[6:7]
  v_cvt_pk_bf16_f32 v132, v32, v33
  v_cvt_pk_bf16_f32 v133, v34, v35
  buffer_store_dwordx4 v[244:247], v2, s[16:19], s60 offen offset:1024 sc1
  v_cvt_pk_bf16_f32 v134, v36, v37
  v_cvt_pk_bf16_f32 v135, v38, v39
  v_pk_mul_f32 v[40:41], v[40:41], s[6:7]
  v_pk_mul_f32 v[42:43], v[42:43], s[6:7]
  v_pk_mul_f32 v[44:45], v[44:45], s[6:7]
  v_pk_mul_f32 v[46:47], v[46:47], s[6:7]
  v_cvt_pk_bf16_f32 v136, v40, v41
  v_cvt_pk_bf16_f32 v137, v42, v43
  v_cvt_pk_bf16_f32 v138, v44, v45
  v_cvt_pk_bf16_f32 v139, v46, v47
  v_pk_mul_f32 v[48:49], v[48:49], s[6:7]
  v_pk_mul_f32 v[50:51], v[50:51], s[6:7]
  v_pk_mul_f32 v[52:53], v[52:53], s[6:7]
  buffer_store_dwordx4 v[248:251], v2, s[16:19], s60 offen offset:2048 sc1
  v_pk_mul_f32 v[54:55], v[54:55], s[6:7]
  v_cvt_pk_bf16_f32 v140, v48, v49
  v_cvt_pk_bf16_f32 v141, v50, v51
  v_cvt_pk_bf16_f32 v142, v52, v53
  v_cvt_pk_bf16_f32 v143, v54, v55
  v_cvt_pk_bf16_f32 v148, v56, v57
  v_cvt_pk_bf16_f32 v149, v58, v59
  v_cvt_pk_bf16_f32 v166, v88, v89
  v_cvt_pk_bf16_f32 v167, v90, v91
  v_cvt_pk_bf16_f32 v150, v60, v61
  v_cvt_pk_bf16_f32 v151, v62, v63
  v_cvt_pk_bf16_f32 v176, v92, v93
  buffer_store_dwordx4 v[252:255], v2, s[16:19], s60 offen offset:3072 sc1
  v_cvt_pk_bf16_f32 v177, v94, v95
  v_cvt_pk_bf16_f32 v152, v64, v65
  v_cvt_pk_bf16_f32 v153, v66, v67
  v_cvt_pk_bf16_f32 v168, v96, v97
  v_cvt_pk_bf16_f32 v169, v98, v99
  v_cvt_pk_bf16_f32 v154, v68, v69
  v_cvt_pk_bf16_f32 v155, v70, v71
  v_cvt_pk_bf16_f32 v178, v100, v101
  v_cvt_pk_bf16_f32 v179, v102, v103
  v_cvt_pk_bf16_f32 v156, v72, v73
  v_cvt_pk_bf16_f32 v157, v74, v75
  v_cvt_pk_bf16_f32 v170, v104, v105
  v_cvt_pk_bf16_f32 v171, v106, v107
  s_add_u32 m0, s41, 32768
  s_nop 0
  buffer_load_dwordx4 v8, s[12:15], s48 offen offset:0 lds
  v_cvt_pk_bf16_f32 v158, v76, v77
  v_cvt_pk_bf16_f32 v159, v78, v79
  v_cvt_pk_bf16_f32 v180, v108, v109
  v_cvt_pk_bf16_f32 v181, v110, v111
  v_cvt_pk_bf16_f32 v160, v80, v81
  v_cvt_pk_bf16_f32 v161, v82, v83
  v_cvt_pk_bf16_f32 v172, v112, v113
  v_cvt_pk_bf16_f32 v173, v114, v115
  v_cvt_pk_bf16_f32 v162, v84, v85
  v_cvt_pk_bf16_f32 v163, v86, v87
  v_cvt_pk_bf16_f32 v182, v116, v117
  v_cvt_pk_bf16_f32 v183, v118, v119
  buffer_load_dwordx4 v9, s[12:15], s48 offen offset:1024 lds
  v_mov_b32 v200, 0x3f803f80
  v_mov_b32 v201, v200
  v_mov_b32 v202, v200
  v_mov_b32 v203, v200
  s_waitcnt lgkmcnt(0)
  s_barrier
  ds_read_b128 v[144:147], v196
  ds_read_b64 v[164:165], v196 offset:1024
  ds_read_b64 v[174:175], v196 offset:1032
  v_mfma_f32_16x16x32_bf16 v[48:51], v[156:159], v[140:143], v[188:191]
  v_mfma_f32_16x16x32_bf16 v[52:55], v[160:163], v[140:143], v[184:187]
  v_mfma_f32_16x16x32_bf16 v[40:43], v[152:155], v[136:139], v[188:191]
  v_mfma_f32_16x16x32_bf16 v[44:47], v[156:159], v[136:139], v[184:187]
  v_mfma_f32_16x16x32_bf16 v[32:35], v[148:151], v[132:135], v[188:191]
  v_mfma_f32_16x16x32_bf16 v[36:39], v[152:155], v[132:135], v[184:187]
  s_waitcnt lgkmcnt(0)
  v_mfma_f32_16x16x32_bf16 v[24:27], v[144:147], v[128:131], v[188:191]
  v_mfma_f32_16x16x32_bf16 v[28:31], v[148:151], v[128:131], v[184:187]
  v_max3_f32 v62, v48, v49, v50
  v_max3_f32 v63, v51, v52, v53
  v_max3_f32 v62, v62, v54, v55
  buffer_load_dwordx4 v10, s[12:15], s48 offen offset:2048 lds
  v_max_f32 v62, v62, v63
  v_max3_f32 v60, v40, v41, v42
  v_max3_f32 v61, v43, v44, v45
  v_max3_f32 v60, v60, v46, v47
  v_max_f32 v60, v60, v61
  v_max3_f32 v58, v32, v33, v34
  v_max3_f32 v59, v35, v36, v37
  v_max3_f32 v58, v58, v38, v39
  v_max_f32 v58, v58, v59
  v_max3_f32 v56, v24, v25, v26
  v_max3_f32 v57, v27, v28, v29
  v_max3_f32 v56, v56, v30, v31
  buffer_load_dwordx4 v11, s[12:15], s48 offen offset:3072 lds
  v_max_f32 v56, v56, v57
  v_mov_b32 v63, v62
  v_mov_b32 v61, v60
  v_mov_b32 v59, v58
  v_mov_b32 v57, v56
  v_permlane32_swap_b32 v62, v63
  v_permlane32_swap_b32 v60, v61
  v_permlane32_swap_b32 v58, v59
  v_permlane32_swap_b32 v56, v57
  v_max_f32 v62, v62, v63
  v_max_f32 v60, v60, v61
  v_max_f32 v58, v58, v59
  v_max_f32 v56, v56, v57
  s_bfe_u32 s56, 0x302010e, s55
  s_add_u32 s54, s54, s56
  s_add_u32 s55, s55, 8
  s_and_b32 s55, s55, 0x8001f
  s_and_b32 s54, s54, 15
  s_lshl_b32 s48, s54, 19
  s_add_u32 m0, s36, -32768
  s_nop 0
  buffer_load_dwordx4 v4, s[8:11], s46 offen offset:0 lds
  v_mov_b32 v63, v62
  v_mov_b32 v61, v60
  v_mov_b32 v59, v58
  v_mov_b32 v57, v56
  v_permlane16_swap_b32 v62, v63
  v_permlane16_swap_b32 v60, v61
  v_permlane16_swap_b32 v58, v59
  v_permlane16_swap_b32 v56, v57
  v_max_f32 v62, v62, v63
  v_max_f32 v60, v60, v61
  v_max_f32 v58, v58, v59
  v_max_f32 v56, v56, v57
  buffer_load_dwordx4 v5, s[8:11], s46 offen offset:1024 lds
  v_sub_f32 v48, v48, v62
  v_sub_f32 v49, v49, v62
  v_sub_f32 v50, v50, v62
  v_sub_f32 v51, v51, v62
  v_sub_f32 v52, v52, v62
  v_sub_f32 v53, v53, v62
  v_sub_f32 v54, v54, v62
  v_sub_f32 v55, v55, v62
  v_exp_f32 v48, v48
  v_exp_f32 v49, v49
  v_exp_f32 v50, v50
  v_exp_f32 v51, v51
  v_exp_f32 v52, v52
  buffer_load_dwordx4 v6, s[8:11], s46 offen offset:2048 lds
  v_exp_f32 v53, v53
  v_exp_f32 v54, v54
  v_exp_f32 v55, v55
  v_sub_f32 v40, v40, v60
  v_sub_f32 v41, v41, v60
  v_sub_f32 v42, v42, v60
  v_sub_f32 v43, v43, v60
  v_sub_f32 v44, v44, v60
  v_sub_f32 v45, v45, v60
  v_sub_f32 v46, v46, v60
  v_sub_f32 v47, v47, v60
  v_exp_f32 v40, v40
  buffer_load_dwordx4 v7, s[8:11], s46 offen offset:3072 lds
  v_exp_f32 v41, v41
  v_exp_f32 v42, v42
  v_exp_f32 v43, v43
  v_exp_f32 v44, v44
  v_exp_f32 v45, v45
  v_exp_f32 v46, v46
  v_exp_f32 v47, v47
  v_sub_f32 v32, v32, v58
  v_sub_f32 v33, v33, v58
  v_sub_f32 v34, v34, v58
  v_sub_f32 v35, v35, v58
  v_sub_f32 v36, v36, v58
  v_sub_f32 v37, v37, v58
  s_add_u32 m0, s36, -28672
  s_nop 0
  buffer_load_dwordx4 v4, s[8:11], s47 offen offset:0 lds
  v_sub_f32 v38, v38, v58
  v_sub_f32 v39, v39, v58
  v_exp_f32 v32, v32
  v_exp_f32 v33, v33
  v_exp_f32 v34, v34
  v_exp_f32 v35, v35
  v_exp_f32 v36, v36
  v_exp_f32 v37, v37
  v_exp_f32 v38, v38
  v_exp_f32 v39, v39
  v_sub_f32 v24, v24, v56
  v_sub_f32 v25, v25, v56
  buffer_load_dwordx4 v5, s[8:11], s47 offen offset:1024 lds
  v_sub_f32 v26, v26, v56
  v_sub_f32 v27, v27, v56
  v_sub_f32 v28, v28, v56
  v_sub_f32 v29, v29, v56
  v_sub_f32 v30, v30, v56
  v_sub_f32 v31, v31, v56
  v_exp_f32 v24, v24
  v_exp_f32 v25, v25
  v_exp_f32 v26, v26
  v_exp_f32 v27, v27
  v_exp_f32 v28, v28
  v_exp_f32 v29, v29
  v_exp_f32 v30, v30
  buffer_load_dwordx4 v6, s[8:11], s47 offen offset:2048 lds
  v_exp_f32 v31, v31
  v_cvt_pk_bf16_f32 v76, v48, v49
  v_cvt_pk_bf16_f32 v77, v50, v51
  v_cvt_pk_bf16_f32 v78, v52, v53
  v_cvt_pk_bf16_f32 v79, v54, v55
  v_cvt_pk_bf16_f32 v72, v40, v41
  v_cvt_pk_bf16_f32 v73, v42, v43
  v_cvt_pk_bf16_f32 v74, v44, v45
  v_cvt_pk_bf16_f32 v75, v46, v47
  v_cvt_pk_bf16_f32 v68, v32, v33
  v_cvt_pk_bf16_f32 v69, v34, v35
  v_cvt_pk_bf16_f32 v70, v36, v37
  buffer_load_dwordx4 v7, s[8:11], s47 offen offset:3072 lds
  s_bfe_u32 s49, 0x302010e, s53
  s_add_u32 s52, s52, s49
  s_add_u32 s53, s53, 8
  s_and_b32 s53, s53, 0x8001f
  s_and_b32 s52, s52, 15
  s_lshl_b32 s49, s52, 7
  s_or_b32 s46, s50, s49
  s_or_b32 s47, s51, s49
  v_cvt_pk_bf16_f32 v71, v38, v39
  v_cvt_pk_bf16_f32 v64, v24, v25
  v_cvt_pk_bf16_f32 v65, v26, v27
  v_cvt_pk_bf16_f32 v66, v28, v29
  v_cvt_pk_bf16_f32 v67, v30, v31
  v_mfma_f32_16x16x32_bf16 v[92:95], v[200:203], v[76:79], 0
  v_mfma_f32_16x16x32_bf16 v[120:123], v[170:173], v[76:79], 0
  v_mfma_f32_16x16x32_bf16 v[124:127], v[180:183], v[76:79], 0
  v_mfma_f32_16x16x32_bf16 v[88:91], v[200:203], v[72:75], 0
  v_mfma_f32_16x16x32_bf16 v[112:115], v[168:171], v[72:75], 0
  v_mfma_f32_16x16x32_bf16 v[116:119], v[178:181], v[72:75], 0
  v_mfma_f32_16x16x32_bf16 v[84:87], v[200:203], v[68:71], 0
  v_mfma_f32_16x16x32_bf16 v[104:107], v[166:169], v[68:71], 0
  v_mfma_f32_16x16x32_bf16 v[108:111], v[176:179], v[68:71], 0
  v_mfma_f32_16x16x32_bf16 v[80:83], v[200:203], v[64:67], 0
  v_mfma_f32_16x16x32_bf16 v[96:99], v[164:167], v[64:67], 0
  v_mfma_f32_16x16x32_bf16 v[100:103], v[174:177], v[64:67], 0
  s_add_u32 s20, s86, 83886080
  s_addc_u32 s21, s87, 0
  s_mov_b32 s22, 4194304
  s_mov_b32 s23, 0x00020000
  s_lshl_b32 s4, s32, 18
  s_lshl_b32 s5, s33, 14
  s_add_u32 s4, s4, s5
  s_and_b32 s5, s3, 1
  s_lshl_b32 s5, s5, 13
  s_add_u32 s4, s4, s5
  s_add_u32 s4, s4, 4096
  v_rcp_f32 v92, v92
  v_rcp_f32 v88, v88
  v_rcp_f32 v84, v84
  v_rcp_f32 v80, v80
  v_mov_b32 v93, v92
  v_mov_b32 v89, v88
  v_mov_b32 v85, v84
  v_mov_b32 v81, v80
  v_pk_mul_f32 v[120:121], v[120:121], v[92:93]
  v_pk_mul_f32 v[122:123], v[122:123], v[92:93]
  v_pk_mul_f32 v[124:125], v[124:125], v[92:93]
  v_pk_mul_f32 v[126:127], v[126:127], v[92:93]
  v_cvt_pk_bf16_f32 v120, v120, v121
  v_cvt_pk_bf16_f32 v121, v122, v123
  v_cvt_pk_bf16_f32 v122, v124, v125
  v_cvt_pk_bf16_f32 v123, v126, v127
  buffer_store_dwordx4 v[120:123], v2, s[20:23], s4 offen offset:3072 sc1
  v_pk_mul_f32 v[112:113], v[112:113], v[88:89]
  v_pk_mul_f32 v[114:115], v[114:115], v[88:89]
  v_pk_mul_f32 v[116:117], v[116:117], v[88:89]
  v_pk_mul_f32 v[118:119], v[118:119], v[88:89]
  v_cvt_pk_bf16_f32 v112, v112, v113
  v_cvt_pk_bf16_f32 v113, v114, v115
  v_cvt_pk_bf16_f32 v114, v116, v117
  v_cvt_pk_bf16_f32 v115, v118, v119
  buffer_store_dwordx4 v[112:115], v2, s[20:23], s4 offen offset:2048 sc1
  v_pk_mul_f32 v[104:105], v[104:105], v[84:85]
  v_pk_mul_f32 v[106:107], v[106:107], v[84:85]
  v_pk_mul_f32 v[108:109], v[108:109], v[84:85]
  v_pk_mul_f32 v[110:111], v[110:111], v[84:85]
  v_cvt_pk_bf16_f32 v104, v104, v105
  v_cvt_pk_bf16_f32 v105, v106, v107
  v_cvt_pk_bf16_f32 v106, v108, v109
  v_cvt_pk_bf16_f32 v107, v110, v111
  buffer_store_dwordx4 v[104:107], v2, s[20:23], s4 offen offset:1024 sc1
  v_pk_mul_f32 v[96:97], v[96:97], v[80:81]
  v_pk_mul_f32 v[98:99], v[98:99], v[80:81]
  v_pk_mul_f32 v[100:101], v[100:101], v[80:81]
  v_pk_mul_f32 v[102:103], v[102:103], v[80:81]
  v_cvt_pk_bf16_f32 v96, v96, v97
  v_cvt_pk_bf16_f32 v97, v98, v99
  v_cvt_pk_bf16_f32 v98, v100, v101
  v_cvt_pk_bf16_f32 v99, v102, v103
  buffer_store_dwordx4 v[96:99], v2, s[20:23], s4 offen offset:0 sc1
Lp3:
  v_accvgpr_read_b32 v16, a230
  v_accvgpr_read_b32 v17, a231
  v_accvgpr_read_b32 v18, a232
  v_accvgpr_read_b32 v19, a233
  v_accvgpr_read_b32 v20, a234
  v_accvgpr_read_b32 v21, a235
  s_mov_b32 s37, 0
  s_mov_b32 s39, 4294901760
  s_mov_b32 s40, 32768
  s_mov_b32 s37, 1
  s_mov_b32 s42, 0
  s_mov_b32 s44, 4294934528
  s_mov_b32 s45, 16384
  s_lshl_b32 s34, s62, 4
  s_add_u32 s34, s34, s61
  s_lshr_b32 s4, s2, 7
  s_lshl_b32 s4, s4, 3
  s_add_u32 s34, s34, s4
  s_lshl_b32 s34, s34, 7
  s_lshl_b32 s91, s32, 4
  s_add_u32 s91, s91, s33
  s_lshl_b32 s91, s91, 7
  s_add_u32 s91, s91, 32768
  s_waitcnt vmcnt(32)
  s_barrier
  ds_read_b128 a[0:3], v16 offset:0
  ds_read_b64_tr_b16 a[32:33], v18 offset:0
  ds_read_b64_tr_b16 a[34:35], v18 offset:2048
  ds_read_b128 a[4:7], v16 offset:2048
  ds_read_b128 a[8:11], v16 offset:4096
  ds_read_b128 a[12:15], v16 offset:6144
  ds_read_b64_tr_b16 a[36:37], v19 offset:0
  ds_read_b64_tr_b16 a[38:39], v19 offset:2048
  ds_read_b64_tr_b16 a[40:41], v20 offset:0
  ds_read_b64_tr_b16 a[42:43], v20 offset:2048
  ds_read_b64_tr_b16 a[44:45], v21 offset:0
  ds_read_b64_tr_b16 a[46:47], v21 offset:2048
  ds_read_b64_tr_b16 a[48:49], v18 offset:8192
  ds_read_b64_tr_b16 a[50:51], v18 offset:10240
  ds_read_b64_tr_b16 a[52:53], v19 offset:8192
  ds_read_b64_tr_b16 a[54:55], v19 offset:10240
  ds_read_b64_tr_b16 a[56:57], v20 offset:8192
  ds_read_b64_tr_b16 a[58:59], v20 offset:10240
  ds_read_b64_tr_b16 a[60:61], v21 offset:8192
  ds_read_b64_tr_b16 a[62:63], v21 offset:10240
  s_waitcnt lgkmcnt(0)
  v_mfma_f32_16x16x32_bf16 v[128:131], a[32:35], a[0:3], 0
  s_add_u32 s37, s37, 1
  s_cmp_eq_u32 s37, 3
  s_cselect_b32 s37, 0, s37
  s_cselect_b32 s38, s39, s40
  ds_read_b128 a[16:19], v17 offset:0
  v_mfma_f32_16x16x32_bf16 v[160:163], a[32:35], a[4:7], 0
  s_add_u32 s42, s42, 1
  s_cmp_eq_u32 s42, 3
  s_cselect_b32 s42, 0, s42
  s_cselect_b32 s43, s44, s45
  ds_read_b64_tr_b16 a[64:65], v18 offset:4096
  v_mfma_f32_16x16x32_bf16 v[192:195], a[32:35], a[8:11], 0
  ds_read_b64_tr_b16 a[66:67], v18 offset:6144
  v_mfma_f32_16x16x32_bf16 v[224:227], a[32:35], a[12:15], 0
  ds_read_b128 a[20:23], v17 offset:2048
  v_mfma_f32_16x16x32_bf16 v[132:135], a[36:39], a[0:3], 0
  ds_read_b128 a[24:27], v17 offset:4096
  v_mfma_f32_16x16x32_bf16 v[164:167], a[36:39], a[4:7], 0
  ds_read_b128 a[28:31], v17 offset:6144
  v_mfma_f32_16x16x32_bf16 v[196:199], a[36:39], a[8:11], 0
  ds_read_b64_tr_b16 a[68:69], v19 offset:4096
  v_mfma_f32_16x16x32_bf16 v[228:231], a[36:39], a[12:15], 0
  ds_read_b64_tr_b16 a[70:71], v19 offset:6144
  v_mfma_f32_16x16x32_bf16 v[136:139], a[40:43], a[0:3], 0
  ds_read_b64_tr_b16 a[72:73], v20 offset:4096
  v_mfma_f32_16x16x32_bf16 v[168:171], a[40:43], a[4:7], 0
  ds_read_b64_tr_b16 a[74:75], v20 offset:6144
  v_mfma_f32_16x16x32_bf16 v[200:203], a[40:43], a[8:11], 0
  v_mfma_f32_16x16x32_bf16 v[232:235], a[40:43], a[12:15], 0
  ds_read_b64_tr_b16 a[76:77], v21 offset:4096
  v_mfma_f32_16x16x32_bf16 v[140:143], a[44:47], a[0:3], 0
  ds_read_b64_tr_b16 a[78:79], v21 offset:6144
  v_mfma_f32_16x16x32_bf16 v[172:175], a[44:47], a[4:7], 0
  ds_read_b64_tr_b16 a[80:81], v18 offset:12288
  v_mfma_f32_16x16x32_bf16 v[204:207], a[44:47], a[8:11], 0
  ds_read_b64_tr_b16 a[82:83], v18 offset:14336
  v_mfma_f32_16x16x32_bf16 v[236:239], a[44:47], a[12:15], 0
  ds_read_b64_tr_b16 a[84:85], v19 offset:12288
  v_mfma_f32_16x16x32_bf16 v[144:147], a[48:51], a[0:3], 0
  ds_read_b64_tr_b16 a[86:87], v19 offset:14336
  v_mfma_f32_16x16x32_bf16 v[176:179], a[48:51], a[4:7], 0
  ds_read_b64_tr_b16 a[88:89], v20 offset:12288
  v_mfma_f32_16x16x32_bf16 v[208:211], a[48:51], a[8:11], 0
  ds_read_b64_tr_b16 a[90:91], v20 offset:14336
  v_mfma_f32_16x16x32_bf16 v[240:243], a[48:51], a[12:15], 0
  ds_read_b64_tr_b16 a[92:93], v21 offset:12288
  v_mfma_f32_16x16x32_bf16 v[148:151], a[52:55], a[0:3], 0
  ds_read_b64_tr_b16 a[94:95], v21 offset:14336
  v_mfma_f32_16x16x32_bf16 v[180:183], a[52:55], a[4:7], 0
  v_add_u32 v16, s38, v16
  v_add_u32 v17, s38, v17
  v_mfma_f32_16x16x32_bf16 v[212:215], a[52:55], a[8:11], 0
  v_add_u32 v18, s43, v18
  v_add_u32 v19, s43, v19
  v_mfma_f32_16x16x32_bf16 v[244:247], a[52:55], a[12:15], 0
  v_add_u32 v20, s43, v20
  v_add_u32 v21, s43, v21
  v_mfma_f32_16x16x32_bf16 v[152:155], a[56:59], a[0:3], 0
  v_mfma_f32_16x16x32_bf16 v[184:187], a[56:59], a[4:7], 0
  v_mfma_f32_16x16x32_bf16 v[216:219], a[56:59], a[8:11], 0
  v_mfma_f32_16x16x32_bf16 v[248:251], a[56:59], a[12:15], 0
  v_mfma_f32_16x16x32_bf16 v[156:159], a[60:63], a[0:3], 0
  v_mfma_f32_16x16x32_bf16 v[188:191], a[60:63], a[4:7], 0
  v_mfma_f32_16x16x32_bf16 v[220:223], a[60:63], a[8:11], 0
  v_mfma_f32_16x16x32_bf16 v[252:255], a[60:63], a[12:15], 0
  s_waitcnt vmcnt(22) lgkmcnt(0)
  s_barrier
  v_mfma_f32_16x16x32_bf16 v[128:131], a[64:67], a[16:19], v[128:131]
  s_mov_b32 m0, s41
  ds_read_b128 a[0:3], v16 offset:0
  v_mfma_f32_16x16x32_bf16 v[160:163], a[64:67], a[20:23], v[160:163]
  buffer_load_dwordx4 v8, s[12:15], s48 offen offset:0 lds
  ds_read_b64_tr_b16 a[32:33], v18 offset:0
  v_mfma_f32_16x16x32_bf16 v[192:195], a[64:67], a[24:27], v[192:195]
  ds_read_b64_tr_b16 a[34:35], v18 offset:2048
  v_mfma_f32_16x16x32_bf16 v[224:227], a[64:67], a[28:31], v[224:227]
  ds_read_b128 a[4:7], v16 offset:2048
  v_mfma_f32_16x16x32_bf16 v[132:135], a[68:71], a[16:19], v[132:135]
  ds_read_b128 a[8:11], v16 offset:4096
  v_mfma_f32_16x16x32_bf16 v[164:167], a[68:71], a[20:23], v[164:167]
  buffer_load_dwordx4 v9, s[12:15], s48 offen offset:1024 lds
  ds_read_b128 a[12:15], v16 offset:6144
  v_mfma_f32_16x16x32_bf16 v[196:199], a[68:71], a[24:27], v[196:199]
  ds_read_b64_tr_b16 a[36:37], v19 offset:0
  v_mfma_f32_16x16x32_bf16 v[228:231], a[68:71], a[28:31], v[228:231]
  ds_read_b64_tr_b16 a[38:39], v19 offset:2048
  v_mfma_f32_16x16x32_bf16 v[136:139], a[72:75], a[16:19], v[136:139]
  ds_read_b64_tr_b16 a[40:41], v20 offset:0
  v_mfma_f32_16x16x32_bf16 v[168:171], a[72:75], a[20:23], v[168:171]
  ds_read_b64_tr_b16 a[42:43], v20 offset:2048
  v_mfma_f32_16x16x32_bf16 v[200:203], a[72:75], a[24:27], v[200:203]
  buffer_load_dwordx4 v10, s[12:15], s48 offen offset:2048 lds
  v_mfma_f32_16x16x32_bf16 v[232:235], a[72:75], a[28:31], v[232:235]
  ds_read_b64_tr_b16 a[44:45], v21 offset:0
  v_mfma_f32_16x16x32_bf16 v[140:143], a[76:79], a[16:19], v[140:143]
  ds_read_b64_tr_b16 a[46:47], v21 offset:2048
  v_mfma_f32_16x16x32_bf16 v[172:175], a[76:79], a[20:23], v[172:175]
  ds_read_b64_tr_b16 a[48:49], v18 offset:8192
  v_mfma_f32_16x16x32_bf16 v[204:207], a[76:79], a[24:27], v[204:207]
  ds_read_b64_tr_b16 a[50:51], v18 offset:10240
  v_mfma_f32_16x16x32_bf16 v[236:239], a[76:79], a[28:31], v[236:239]
  buffer_load_dwordx4 v11, s[12:15], s48 offen offset:3072 lds
  ds_read_b64_tr_b16 a[52:53], v19 offset:8192
  v_mfma_f32_16x16x32_bf16 v[144:147], a[80:83], a[16:19], v[144:147]
  s_bfe_u32 s56, 0x302010e, s55
  s_add_u32 s54, s54, s56
  s_add_u32 s55, s55, 8
  v_mfma_f32_16x16x32_bf16 v[176:179], a[80:83], a[20:23], v[176:179]
  s_and_b32 s55, s55, 0x8001f
  s_and_b32 s54, s54, 15
  s_lshl_b32 s48, s54, 19
  v_mfma_f32_16x16x32_bf16 v[208:211], a[80:83], a[24:27], v[208:211]
  s_mov_b32 m0, s36
  ds_read_b64_tr_b16 a[54:55], v19 offset:10240
  ds_read_b64_tr_b16 a[56:57], v20 offset:8192
  v_mfma_f32_16x16x32_bf16 v[240:243], a[80:83], a[28:31], v[240:243]
  ds_read_b64_tr_b16 a[58:59], v20 offset:10240
  ds_read_b64_tr_b16 a[60:61], v21 offset:8192
  v_mfma_f32_16x16x32_bf16 v[148:151], a[84:87], a[16:19], v[148:151]
  buffer_load_dwordx4 v4, s[8:11], s46 offen offset:0 lds
  ds_read_b64_tr_b16 a[62:63], v21 offset:10240
  v_mfma_f32_16x16x32_bf16 v[180:183], a[84:87], a[20:23], v[180:183]
  v_mfma_f32_16x16x32_bf16 v[212:215], a[84:87], a[24:27], v[212:215]
  v_mfma_f32_16x16x32_bf16 v[244:247], a[84:87], a[28:31], v[244:247]
  v_mfma_f32_16x16x32_bf16 v[152:155], a[88:91], a[16:19], v[152:155]
  v_mfma_f32_16x16x32_bf16 v[184:187], a[88:91], a[20:23], v[184:187]
  buffer_load_dwordx4 v5, s[8:11], s46 offen offset:1024 lds
  v_mfma_f32_16x16x32_bf16 v[216:219], a[88:91], a[24:27], v[216:219]
  v_mfma_f32_16x16x32_bf16 v[248:251], a[88:91], a[28:31], v[248:251]
  v_mfma_f32_16x16x32_bf16 v[156:159], a[92:95], a[16:19], v[156:159]
  v_mfma_f32_16x16x32_bf16 v[188:191], a[92:95], a[20:23], v[188:191]
  v_mfma_f32_16x16x32_bf16 v[220:223], a[92:95], a[24:27], v[220:223]
  v_mfma_f32_16x16x32_bf16 v[252:255], a[92:95], a[28:31], v[252:255]
  s_waitcnt lgkmcnt(0)
  v_mfma_f32_16x16x32_bf16 v[128:131], a[32:35], a[0:3], v[128:131]
  buffer_load_dwordx4 v6, s[8:11], s46 offen offset:2048 lds
  ds_read_b128 a[16:19], v17 offset:0
  v_mfma_f32_16x16x32_bf16 v[160:163], a[32:35], a[4:7], v[160:163]
  ds_read_b64_tr_b16 a[64:65], v18 offset:4096
  v_mfma_f32_16x16x32_bf16 v[192:195], a[32:35], a[8:11], v[192:195]
  ds_read_b64_tr_b16 a[66:67], v18 offset:6144
  v_mfma_f32_16x16x32_bf16 v[224:227], a[32:35], a[12:15], v[224:227]
  ds_read_b128 a[20:23], v17 offset:2048
  v_mfma_f32_16x16x32_bf16 v[132:135], a[36:39], a[0:3], v[132:135]
  buffer_load_dwordx4 v7, s[8:11], s46 offen offset:3072 lds
  ds_read_b128 a[24:27], v17 offset:4096
  v_mfma_f32_16x16x32_bf16 v[164:167], a[36:39], a[4:7], v[164:167]
  s_add_u32 m0, s36, 4096
  ds_read_b128 a[28:31], v17 offset:6144
  v_mfma_f32_16x16x32_bf16 v[196:199], a[36:39], a[8:11], v[196:199]
  ds_read_b64_tr_b16 a[68:69], v19 offset:4096
  v_mfma_f32_16x16x32_bf16 v[228:231], a[36:39], a[12:15], v[228:231]
  ds_read_b64_tr_b16 a[70:71], v19 offset:6144
  v_mfma_f32_16x16x32_bf16 v[136:139], a[40:43], a[0:3], v[136:139]
  buffer_load_dwordx4 v4, s[8:11], s47 offen offset:0 lds
  ds_read_b64_tr_b16 a[72:73], v20 offset:4096
  v_mfma_f32_16x16x32_bf16 v[168:171], a[40:43], a[4:7], v[168:171]
  ds_read_b64_tr_b16 a[74:75], v20 offset:6144
  v_mfma_f32_16x16x32_bf16 v[200:203], a[40:43], a[8:11], v[200:203]
  v_mfma_f32_16x16x32_bf16 v[232:235], a[40:43], a[12:15], v[232:235]
  ds_read_b64_tr_b16 a[76:77], v21 offset:4096
  v_mfma_f32_16x16x32_bf16 v[140:143], a[44:47], a[0:3], v[140:143]
  buffer_load_dwordx4 v5, s[8:11], s47 offen offset:1024 lds
  ds_read_b64_tr_b16 a[78:79], v21 offset:6144
  v_mfma_f32_16x16x32_bf16 v[172:175], a[44:47], a[4:7], v[172:175]
  ds_read_b64_tr_b16 a[80:81], v18 offset:12288
  v_mfma_f32_16x16x32_bf16 v[204:207], a[44:47], a[8:11], v[204:207]
  ds_read_b64_tr_b16 a[82:83], v18 offset:14336
  v_mfma_f32_16x16x32_bf16 v[236:239], a[44:47], a[12:15], v[236:239]
  ds_read_b64_tr_b16 a[84:85], v19 offset:12288
  v_mfma_f32_16x16x32_bf16 v[144:147], a[48:51], a[0:3], v[144:147]
  buffer_load_dwordx4 v6, s[8:11], s47 offen offset:2048 lds
  ds_read_b64_tr_b16 a[86:87], v19 offset:14336
  v_mfma_f32_16x16x32_bf16 v[176:179], a[48:51], a[4:7], v[176:179]
  ds_read_b64_tr_b16 a[88:89], v20 offset:12288
  v_mfma_f32_16x16x32_bf16 v[208:211], a[48:51], a[8:11], v[208:211]
  ds_read_b64_tr_b16 a[90:91], v20 offset:14336
  v_mfma_f32_16x16x32_bf16 v[240:243], a[48:51], a[12:15], v[240:243]
  ds_read_b64_tr_b16 a[92:93], v21 offset:12288
  v_mfma_f32_16x16x32_bf16 v[148:151], a[52:55], a[0:3], v[148:151]
  buffer_load_dwordx4 v7, s[8:11], s47 offen offset:3072 lds
  ds_read_b64_tr_b16 a[94:95], v21 offset:14336
  v_mfma_f32_16x16x32_bf16 v[180:183], a[52:55], a[4:7], v[180:183]
  s_bfe_u32 s49, 0x302010e, s53
  s_add_u32 s52, s52, s49
  s_add_u32 s53, s53, 8
  v_mfma_f32_16x16x32_bf16 v[212:215], a[52:55], a[8:11], v[212:215]
  s_and_b32 s53, s53, 0x8001f
  s_and_b32 s52, s52, 15
  s_lshl_b32 s49, s52, 7
  v_mfma_f32_16x16x32_bf16 v[244:247], a[52:55], a[12:15], v[244:247]
  s_or_b32 s46, s50, s49
  s_or_b32 s47, s51, s49
  v_mfma_f32_16x16x32_bf16 v[152:155], a[56:59], a[0:3], v[152:155]
  s_add_u32 s36, s36, s38
  s_add_u32 s37, s37, 1
  s_cmp_eq_u32 s37, 3
  s_cselect_b32 s37, 0, s37
  s_cselect_b32 s38, s39, s40
  v_mfma_f32_16x16x32_bf16 v[184:187], a[56:59], a[4:7], v[184:187]
  s_add_u32 s41, s41, s43
  s_add_u32 s42, s42, 1
  s_cmp_eq_u32 s42, 3
  s_cselect_b32 s42, 0, s42
  s_cselect_b32 s43, s44, s45
  v_mfma_f32_16x16x32_bf16 v[216:219], a[56:59], a[8:11], v[216:219]
  v_add_u32 v16, s38, v16
  v_add_u32 v17, s38, v17
  v_mfma_f32_16x16x32_bf16 v[248:251], a[56:59], a[12:15], v[248:251]
  v_add_u32 v18, s43, v18
  v_add_u32 v19, s43, v19
  v_mfma_f32_16x16x32_bf16 v[156:159], a[60:63], a[0:3], v[156:159]
  v_add_u32 v20, s43, v20
  v_add_u32 v21, s43, v21
  v_mfma_f32_16x16x32_bf16 v[188:191], a[60:63], a[4:7], v[188:191]
  v_mfma_f32_16x16x32_bf16 v[220:223], a[60:63], a[8:11], v[220:223]
  v_mfma_f32_16x16x32_bf16 v[252:255], a[60:63], a[12:15], v[252:255]
  s_waitcnt vmcnt(12) lgkmcnt(0)
  s_barrier
  s_mov_b32 s5, 0x40000
Ltg_9:
  v_readfirstlane_b32 s94, v22
  v_readfirstlane_b32 s95, v23
  s_nop 0
  s_cmp_lg_u32 s95, 0
  s_cbranch_scc1 Lpolld_10
  s_sleep 4
  s_mov_b32 s20, s84
  s_mov_b32 s21, s85
  s_mov_b32 s22, 256
  s_mov_b32 s23, 0x00020000
  buffer_load_dwordx2 v[22:23], off, s[20:23], 0 sc1
  s_sub_u32 s5, s5, 1
  s_waitcnt vmcnt(0)
  s_cbranch_scc0 Ltg_9
Lpolld_10:
  v_mov_b32 v3, 0x40000000
  v_mov_b32 v22, s94
  v_cmp_eq_u32 vcc, 0, v0
  v_mov_b32 v23, s95
  s_nop 0
  v_cndmask_b32_e64 v3, v3, 0, vcc
  buffer_store_dwordx2 v[22:23], v3, s[96:99], s34 offen sc1
  buffer_store_dwordx2 v[22:23], v3, s[96:99], s91 offen sc1
  v_mfma_f32_16x16x32_bf16 v[128:131], a[64:67], a[16:19], v[128:131]
  s_mov_b32 m0, s41
  ds_read_b128 a[0:3], v16 offset:0
  v_mfma_f32_16x16x32_bf16 v[160:163], a[64:67], a[20:23], v[160:163]
  buffer_load_dwordx4 v8, s[12:15], s48 offen offset:0 lds
  ds_read_b64_tr_b16 a[32:33], v18 offset:0
  v_mfma_f32_16x16x32_bf16 v[192:195], a[64:67], a[24:27], v[192:195]
  ds_read_b64_tr_b16 a[34:35], v18 offset:2048
  v_mfma_f32_16x16x32_bf16 v[224:227], a[64:67], a[28:31], v[224:227]
  ds_read_b128 a[4:7], v16 offset:2048
  v_mfma_f32_16x16x32_bf16 v[132:135], a[68:71], a[16:19], v[132:135]
  ds_read_b128 a[8:11], v16 offset:4096
  v_mfma_f32_16x16x32_bf16 v[164:167], a[68:71], a[20:23], v[164:167]
  buffer_load_dwordx4 v9, s[12:15], s48 offen offset:1024 lds
  ds_read_b128 a[12:15], v16 offset:6144
  v_mfma_f32_16x16x32_bf16 v[196:199], a[68:71], a[24:27], v[196:199]
  ds_read_b64_tr_b16 a[36:37], v19 offset:0
  v_mfma_f32_16x16x32_bf16 v[228:231], a[68:71], a[28:31], v[228:231]
  ds_read_b64_tr_b16 a[38:39], v19 offset:2048
  v_mfma_f32_16x16x32_bf16 v[136:139], a[72:75], a[16:19], v[136:139]
  ds_read_b64_tr_b16 a[40:41], v20 offset:0
  v_mfma_f32_16x16x32_bf16 v[168:171], a[72:75], a[20:23], v[168:171]
  ds_read_b64_tr_b16 a[42:43], v20 offset:2048
  v_mfma_f32_16x16x32_bf16 v[200:203], a[72:75], a[24:27], v[200:203]
  buffer_load_dwordx4 v10, s[12:15], s48 offen offset:2048 lds
  v_mfma_f32_16x16x32_bf16 v[232:235], a[72:75], a[28:31], v[232:235]
  ds_read_b64_tr_b16 a[44:45], v21 offset:0
  v_mfma_f32_16x16x32_bf16 v[140:143], a[76:79], a[16:19], v[140:143]
  ds_read_b64_tr_b16 a[46:47], v21 offset:2048
  v_mfma_f32_16x16x32_bf16 v[172:175], a[76:79], a[20:23], v[172:175]
  ds_read_b64_tr_b16 a[48:49], v18 offset:8192
  v_mfma_f32_16x16x32_bf16 v[204:207], a[76:79], a[24:27], v[204:207]
  ds_read_b64_tr_b16 a[50:51], v18 offset:10240
  v_mfma_f32_16x16x32_bf16 v[236:239], a[76:79], a[28:31], v[236:239]
  buffer_load_dwordx4 v11, s[12:15], s48 offen offset:3072 lds
  ds_read_b64_tr_b16 a[52:53], v19 offset:8192
  v_mfma_f32_16x16x32_bf16 v[144:147], a[80:83], a[16:19], v[144:147]
  s_bfe_u32 s56, 0x302010e, s55
  s_add_u32 s54, s54, s56
  s_add_u32 s55, s55, 8
  v_mfma_f32_16x16x32_bf16 v[176:179], a[80:83], a[20:23], v[176:179]
  s_and_b32 s55, s55, 0x8001f
  s_and_b32 s54, s54, 15
  s_lshl_b32 s48, s54, 19
  v_mfma_f32_16x16x32_bf16 v[208:211], a[80:83], a[24:27], v[208:211]
  s_mov_b32 m0, s36
  ds_read_b64_tr_b16 a[54:55], v19 offset:10240
  ds_read_b64_tr_b16 a[56:57], v20 offset:8192
  v_mfma_f32_16x16x32_bf16 v[240:243], a[80:83], a[28:31], v[240:243]
  ds_read_b64_tr_b16 a[58:59], v20 offset:10240
  ds_read_b64_tr_b16 a[60:61], v21 offset:8192
  v_mfma_f32_16x16x32_bf16 v[148:151], a[84:87], a[16:19], v[148:151]
  buffer_load_dwordx4 v4, s[8:11], s46 offen offset:0 lds
  ds_read_b64_tr_b16 a[62:63], v21 offset:10240
  v_mfma_f32_16x16x32_bf16 v[180:183], a[84:87], a[20:23], v[180:183]
  v_mfma_f32_16x16x32_bf16 v[212:215], a[84:87], a[24:27], v[212:215]
  v_mfma_f32_16x16x32_bf16 v[244:247], a[84:87], a[28:31], v[244:247]
  v_mfma_f32_16x16x32_bf16 v[152:155], a[88:91], a[16:19], v[152:155]
  v_mfma_f32_16x16x32_bf16 v[184:187], a[88:91], a[20:23], v[184:187]
  buffer_load_dwordx4 v5, s[8:11], s46 offen offset:1024 lds
  v_mfma_f32_16x16x32_bf16 v[216:219], a[88:91], a[24:27], v[216:219]
  v_mfma_f32_16x16x32_bf16 v[248:251], a[88:91], a[28:31], v[248:251]
  v_mfma_f32_16x16x32_bf16 v[156:159], a[92:95], a[16:19], v[156:159]
  v_mfma_f32_16x16x32_bf16 v[188:191], a[92:95], a[20:23], v[188:191]
  v_mfma_f32_16x16x32_bf16 v[220:223], a[92:95], a[24:27], v[220:223]
  v_mfma_f32_16x16x32_bf16 v[252:255], a[92:95], a[28:31], v[252:255]
  s_waitcnt lgkmcnt(0)
  v_mfma_f32_16x16x32_bf16 v[128:131], a[32:35], a[0:3], v[128:131]
  buffer_load_dwordx4 v6, s[8:11], s46 offen offset:2048 lds
  ds_read_b128 a[16:19], v17 offset:0
  v_mfma_f32_16x16x32_bf16 v[160:163], a[32:35], a[4:7], v[160:163]
  ds_read_b64_tr_b16 a[64:65], v18 offset:4096
  v_mfma_f32_16x16x32_bf16 v[192:195], a[32:35], a[8:11], v[192:195]
  ds_read_b64_tr_b16 a[66:67], v18 offset:6144
  v_mfma_f32_16x16x32_bf16 v[224:227], a[32:35], a[12:15], v[224:227]
  ds_read_b128 a[20:23], v17 offset:2048
  v_mfma_f32_16x16x32_bf16 v[132:135], a[36:39], a[0:3], v[132:135]
  buffer_load_dwordx4 v7, s[8:11], s46 offen offset:3072 lds
  ds_read_b128 a[24:27], v17 offset:4096
  v_mfma_f32_16x16x32_bf16 v[164:167], a[36:39], a[4:7], v[164:167]
  s_add_u32 m0, s36, 4096
  ds_read_b128 a[28:31], v17 offset:6144
  v_mfma_f32_16x16x32_bf16 v[196:199], a[36:39], a[8:11], v[196:199]
  ds_read_b64_tr_b16 a[68:69], v19 offset:4096
  v_mfma_f32_16x16x32_bf16 v[228:231], a[36:39], a[12:15], v[228:231]
  ds_read_b64_tr_b16 a[70:71], v19 offset:6144
  v_mfma_f32_16x16x32_bf16 v[136:139], a[40:43], a[0:3], v[136:139]
  buffer_load_dwordx4 v4, s[8:11], s47 offen offset:0 lds
  ds_read_b64_tr_b16 a[72:73], v20 offset:4096
  v_mfma_f32_16x16x32_bf16 v[168:171], a[40:43], a[4:7], v[168:171]
  ds_read_b64_tr_b16 a[74:75], v20 offset:6144
  v_mfma_f32_16x16x32_bf16 v[200:203], a[40:43], a[8:11], v[200:203]
  v_mfma_f32_16x16x32_bf16 v[232:235], a[40:43], a[12:15], v[232:235]
  ds_read_b64_tr_b16 a[76:77], v21 offset:4096
  v_mfma_f32_16x16x32_bf16 v[140:143], a[44:47], a[0:3], v[140:143]
  buffer_load_dwordx4 v5, s[8:11], s47 offen offset:1024 lds
  ds_read_b64_tr_b16 a[78:79], v21 offset:6144
  v_mfma_f32_16x16x32_bf16 v[172:175], a[44:47], a[4:7], v[172:175]
  ds_read_b64_tr_b16 a[80:81], v18 offset:12288
  v_mfma_f32_16x16x32_bf16 v[204:207], a[44:47], a[8:11], v[204:207]
  ds_read_b64_tr_b16 a[82:83], v18 offset:14336
  v_mfma_f32_16x16x32_bf16 v[236:239], a[44:47], a[12:15], v[236:239]
  ds_read_b64_tr_b16 a[84:85], v19 offset:12288
  v_mfma_f32_16x16x32_bf16 v[144:147], a[48:51], a[0:3], v[144:147]
  buffer_load_dwordx4 v6, s[8:11], s47 offen offset:2048 lds
  ds_read_b64_tr_b16 a[86:87], v19 offset:14336
  v_mfma_f32_16x16x32_bf16 v[176:179], a[48:51], a[4:7], v[176:179]
  ds_read_b64_tr_b16 a[88:89], v20 offset:12288
  v_mfma_f32_16x16x32_bf16 v[208:211], a[48:51], a[8:11], v[208:211]
  ds_read_b64_tr_b16 a[90:91], v20 offset:14336
  v_mfma_f32_16x16x32_bf16 v[240:243], a[48:51], a[12:15], v[240:243]
  ds_read_b64_tr_b16 a[92:93], v21 offset:12288
  v_mfma_f32_16x16x32_bf16 v[148:151], a[52:55], a[0:3], v[148:151]
  buffer_load_dwordx4 v7, s[8:11], s47 offen offset:3072 lds
  ds_read_b64_tr_b16 a[94:95], v21 offset:14336
  v_mfma_f32_16x16x32_bf16 v[180:183], a[52:55], a[4:7], v[180:183]
  s_bfe_u32 s49, 0x302010e, s53
  s_add_u32 s52, s52, s49
  s_add_u32 s53, s53, 8
  v_mfma_f32_16x16x32_bf16 v[212:215], a[52:55], a[8:11], v[212:215]
  s_and_b32 s53, s53, 0x8001f
  s_and_b32 s52, s52, 15
  s_lshl_b32 s49, s52, 7
  v_mfma_f32_16x16x32_bf16 v[244:247], a[52:55], a[12:15], v[244:247]
  s_or_b32 s46, s50, s49
  s_or_b32 s47, s51, s49
  v_mfma_f32_16x16x32_bf16 v[152:155], a[56:59], a[0:3], v[152:155]
  s_add_u32 s36, s36, s38
  s_add_u32 s37, s37, 1
  s_cmp_eq_u32 s37, 3
  s_cselect_b32 s37, 0, s37
  s_cselect_b32 s38, s39, s40
  v_mfma_f32_16x16x32_bf16 v[184:187], a[56:59], a[4:7], v[184:187]
  s_add_u32 s41, s41, s43
  s_add_u32 s42, s42, 1
  s_cmp_eq_u32 s42, 3
  s_cselect_b32 s42, 0, s42
  s_cselect_b32 s43, s44, s45
  v_mfma_f32_16x16x32_bf16 v[216:219], a[56:59], a[8:11], v[216:219]
  v_add_u32 v16, s38, v16
  v_add_u32 v17, s38, v17
  v_mfma_f32_16x16x32_bf16 v[248:251], a[56:59], a[12:15], v[248:251]
  v_add_u32 v18, s43, v18
  v_add_u32 v19, s43, v19
  v_mfma_f32_16x16x32_bf16 v[156:159], a[60:63], a[0:3], v[156:159]
  v_add_u32 v20, s43, v20
  v_add_u32 v21, s43, v21
  v_mfma_f32_16x16x32_bf16 v[188:191], a[60:63], a[4:7], v[188:191]
  v_mfma_f32_16x16x32_bf16 v[220:223], a[60:63], a[8:11], v[220:223]
  v_mfma_f32_16x16x32_bf16 v[252:255], a[60:63], a[12:15], v[252:255]
  s_mov_b32 s35, 10
  s_waitcnt vmcnt(12) lgkmcnt(0)
  s_barrier
  .p2align 6
Lp3_loop:
  v_mfma_f32_16x16x32_bf16 v[128:131], a[64:67], a[16:19], v[128:131]
  s_mov_b32 m0, s41
  ds_read_b128 a[0:3], v16 offset:0
  v_mfma_f32_16x16x32_bf16 v[160:163], a[64:67], a[20:23], v[160:163]
  buffer_load_dwordx4 v8, s[12:15], s48 offen offset:0 lds
  ds_read_b64_tr_b16 a[32:33], v18 offset:0
  v_mfma_f32_16x16x32_bf16 v[192:195], a[64:67], a[24:27], v[192:195]
  ds_read_b64_tr_b16 a[34:35], v18 offset:2048
  v_mfma_f32_16x16x32_bf16 v[224:227], a[64:67], a[28:31], v[224:227]
  ds_read_b128 a[4:7], v16 offset:2048
  v_mfma_f32_16x16x32_bf16 v[132:135], a[68:71], a[16:19], v[132:135]
  ds_read_b128 a[8:11], v16 offset:4096
  v_mfma_f32_16x16x32_bf16 v[164:167], a[68:71], a[20:23], v[164:167]
  buffer_load_dwordx4 v9, s[12:15], s48 offen offset:1024 lds
  ds_read_b128 a[12:15], v16 offset:6144
  v_mfma_f32_16x16x32_bf16 v[196:199], a[68:71], a[24:27], v[196:199]
  ds_read_b64_tr_b16 a[36:37], v19 offset:0
  v_mfma_f32_16x16x32_bf16 v[228:231], a[68:71], a[28:31], v[228:231]
  ds_read_b64_tr_b16 a[38:39], v19 offset:2048
  v_mfma_f32_16x16x32_bf16 v[136:139], a[72:75], a[16:19], v[136:139]
  ds_read_b64_tr_b16 a[40:41], v20 offset:0
  v_mfma_f32_16x16x32_bf16 v[168:171], a[72:75], a[20:23], v[168:171]
  ds_read_b64_tr_b16 a[42:43], v20 offset:2048
  v_mfma_f32_16x16x32_bf16 v[200:203], a[72:75], a[24:27], v[200:203]
  buffer_load_dwordx4 v10, s[12:15], s48 offen offset:2048 lds
  v_mfma_f32_16x16x32_bf16 v[232:235], a[72:75], a[28:31], v[232:235]
  ds_read_b64_tr_b16 a[44:45], v21 offset:0
  v_mfma_f32_16x16x32_bf16 v[140:143], a[76:79], a[16:19], v[140:143]
  ds_read_b64_tr_b16 a[46:47], v21 offset:2048
  v_mfma_f32_16x16x32_bf16 v[172:175], a[76:79], a[20:23], v[172:175]
  ds_read_b64_tr_b16 a[48:49], v18 offset:8192
  v_mfma_f32_16x16x32_bf16 v[204:207], a[76:79], a[24:27], v[204:207]
  ds_read_b64_tr_b16 a[50:51], v18 offset:10240
  v_mfma_f32_16x16x32_bf16 v[236:239], a[76:79], a[28:31], v[236:239]
  buffer_load_dwordx4 v11, s[12:15], s48 offen offset:3072 lds
  ds_read_b64_tr_b16 a[52:53], v19 offset:8192
  v_mfma_f32_16x16x32_bf16 v[144:147], a[80:83], a[16:19], v[144:147]
  s_bfe_u32 s56, 0x302010e, s55
  s_add_u32 s54, s54, s56
  s_add_u32 s55, s55, 8
  v_mfma_f32_16x16x32_bf16 v[176:179], a[80:83], a[20:23], v[176:179]
  s_and_b32 s55, s55, 0x8001f
  s_and_b32 s54, s54, 15
  s_lshl_b32 s48, s54, 19
  v_mfma_f32_16x16x32_bf16 v[208:211], a[80:83], a[24:27], v[208:211]
  s_mov_b32 m0, s36
  ds_read_b64_tr_b16 a[54:55], v19 offset:10240
  ds_read_b64_tr_b16 a[56:57], v20 offset:8192
  v_mfma_f32_16x16x32_bf16 v[240:243], a[80:83], a[28:31], v[240:243]
  ds_read_b64_tr_b16 a[58:59], v20 offset:10240
  ds_read_b64_tr_b16 a[60:61], v21 offset:8192
  v_mfma_f32_16x16x32_bf16 v[148:151], a[84:87], a[16:19], v[148:151]
  buffer_load_dwordx4 v4, s[8:11], s46 offen offset:0 lds
  ds_read_b64_tr_b16 a[62:63], v21 offset:10240
  v_mfma_f32_16x16x32_bf16 v[180:183], a[84:87], a[20:23], v[180:183]
  v_mfma_f32_16x16x32_bf16 v[212:215], a[84:87], a[24:27], v[212:215]
  v_mfma_f32_16x16x32_bf16 v[244:247], a[84:87], a[28:31], v[244:247]
  v_mfma_f32_16x16x32_bf16 v[152:155], a[88:91], a[16:19], v[152:155]
  v_mfma_f32_16x16x32_bf16 v[184:187], a[88:91], a[20:23], v[184:187]
  buffer_load_dwordx4 v5, s[8:11], s46 offen offset:1024 lds
  v_mfma_f32_16x16x32_bf16 v[216:219], a[88:91], a[24:27], v[216:219]
  v_mfma_f32_16x16x32_bf16 v[248:251], a[88:91], a[28:31], v[248:251]
  v_mfma_f32_16x16x32_bf16 v[156:159], a[92:95], a[16:19], v[156:159]
  v_mfma_f32_16x16x32_bf16 v[188:191], a[92:95], a[20:23], v[188:191]
  v_mfma_f32_16x16x32_bf16 v[220:223], a[92:95], a[24:27], v[220:223]
  v_mfma_f32_16x16x32_bf16 v[252:255], a[92:95], a[28:31], v[252:255]
  s_waitcnt lgkmcnt(0)
  v_mfma_f32_16x16x32_bf16 v[128:131], a[32:35], a[0:3], v[128:131]
  buffer_load_dwordx4 v6, s[8:11], s46 offen offset:2048 lds
  ds_read_b128 a[16:19], v17 offset:0
  v_mfma_f32_16x16x32_bf16 v[160:163], a[32:35], a[4:7], v[160:163]
  ds_read_b64_tr_b16 a[64:65], v18 offset:4096
  v_mfma_f32_16x16x32_bf16 v[192:195], a[32:35], a[8:11], v[192:195]
  ds_read_b64_tr_b16 a[66:67], v18 offset:6144
  v_mfma_f32_16x16x32_bf16 v[224:227], a[32:35], a[12:15], v[224:227]
  ds_read_b128 a[20:23], v17 offset:2048
  v_mfma_f32_16x16x32_bf16 v[132:135], a[36:39], a[0:3], v[132:135]
  buffer_load_dwordx4 v7, s[8:11], s46 offen offset:3072 lds
  ds_read_b128 a[24:27], v17 offset:4096
  v_mfma_f32_16x16x32_bf16 v[164:167], a[36:39], a[4:7], v[164:167]
  s_add_u32 m0, s36, 4096
  ds_read_b128 a[28:31], v17 offset:6144
  v_mfma_f32_16x16x32_bf16 v[196:199], a[36:39], a[8:11], v[196:199]
  ds_read_b64_tr_b16 a[68:69], v19 offset:4096
  v_mfma_f32_16x16x32_bf16 v[228:231], a[36:39], a[12:15], v[228:231]
  ds_read_b64_tr_b16 a[70:71], v19 offset:6144
  v_mfma_f32_16x16x32_bf16 v[136:139], a[40:43], a[0:3], v[136:139]
  buffer_load_dwordx4 v4, s[8:11], s47 offen offset:0 lds
  ds_read_b64_tr_b16 a[72:73], v20 offset:4096
  v_mfma_f32_16x16x32_bf16 v[168:171], a[40:43], a[4:7], v[168:171]
  ds_read_b64_tr_b16 a[74:75], v20 offset:6144
  v_mfma_f32_16x16x32_bf16 v[200:203], a[40:43], a[8:11], v[200:203]
  v_mfma_f32_16x16x32_bf16 v[232:235], a[40:43], a[12:15], v[232:235]
  ds_read_b64_tr_b16 a[76:77], v21 offset:4096
  v_mfma_f32_16x16x32_bf16 v[140:143], a[44:47], a[0:3], v[140:143]
  buffer_load_dwordx4 v5, s[8:11], s47 offen offset:1024 lds
  ds_read_b64_tr_b16 a[78:79], v21 offset:6144
  v_mfma_f32_16x16x32_bf16 v[172:175], a[44:47], a[4:7], v[172:175]
  ds_read_b64_tr_b16 a[80:81], v18 offset:12288
  v_mfma_f32_16x16x32_bf16 v[204:207], a[44:47], a[8:11], v[204:207]
  ds_read_b64_tr_b16 a[82:83], v18 offset:14336
  v_mfma_f32_16x16x32_bf16 v[236:239], a[44:47], a[12:15], v[236:239]
  ds_read_b64_tr_b16 a[84:85], v19 offset:12288
  v_mfma_f32_16x16x32_bf16 v[144:147], a[48:51], a[0:3], v[144:147]
  buffer_load_dwordx4 v6, s[8:11], s47 offen offset:2048 lds
  ds_read_b64_tr_b16 a[86:87], v19 offset:14336
  v_mfma_f32_16x16x32_bf16 v[176:179], a[48:51], a[4:7], v[176:179]
  ds_read_b64_tr_b16 a[88:89], v20 offset:12288
  v_mfma_f32_16x16x32_bf16 v[208:211], a[48:51], a[8:11], v[208:211]
  ds_read_b64_tr_b16 a[90:91], v20 offset:14336
  v_mfma_f32_16x16x32_bf16 v[240:243], a[48:51], a[12:15], v[240:243]
  ds_read_b64_tr_b16 a[92:93], v21 offset:12288
  v_mfma_f32_16x16x32_bf16 v[148:151], a[52:55], a[0:3], v[148:151]
  buffer_load_dwordx4 v7, s[8:11], s47 offen offset:3072 lds
  ds_read_b64_tr_b16 a[94:95], v21 offset:14336
  v_mfma_f32_16x16x32_bf16 v[180:183], a[52:55], a[4:7], v[180:183]
  s_bfe_u32 s49, 0x302010e, s53
  s_add_u32 s52, s52, s49
  s_add_u32 s53, s53, 8
  v_mfma_f32_16x16x32_bf16 v[212:215], a[52:55], a[8:11], v[212:215]
  s_and_b32 s53, s53, 0x8001f
  s_and_b32 s52, s52, 15
  s_lshl_b32 s49, s52, 7
  v_mfma_f32_16x16x32_bf16 v[244:247], a[52:55], a[12:15], v[244:247]
  s_or_b32 s46, s50, s49
  s_or_b32 s47, s51, s49
  v_mfma_f32_16x16x32_bf16 v[152:155], a[56:59], a[0:3], v[152:155]
  s_add_u32 s36, s36, s38
  s_add_u32 s37, s37, 1
  s_cmp_eq_u32 s37, 3
  s_cselect_b32 s37, 0, s37
  s_cselect_b32 s38, s39, s40
  v_mfma_f32_16x16x32_bf16 v[184:187], a[56:59], a[4:7], v[184:187]
  s_add_u32 s41, s41, s43
  s_add_u32 s42, s42, 1
  s_cmp_eq_u32 s42, 3
  s_cselect_b32 s42, 0, s42
  s_cselect_b32 s43, s44, s45
  v_mfma_f32_16x16x32_bf16 v[216:219], a[56:59], a[8:11], v[216:219]
  v_add_u32 v16, s38, v16
  v_add_u32 v17, s38, v17
  v_mfma_f32_16x16x32_bf16 v[248:251], a[56:59], a[12:15], v[248:251]
  v_add_u32 v18, s43, v18
  v_add_u32 v19, s43, v19
  v_mfma_f32_16x16x32_bf16 v[156:159], a[60:63], a[0:3], v[156:159]
  v_add_u32 v20, s43, v20
  v_add_u32 v21, s43, v21
  v_mfma_f32_16x16x32_bf16 v[188:191], a[60:63], a[4:7], v[188:191]
  s_waitcnt vmcnt(12) lgkmcnt(0)
  s_barrier
  v_mfma_f32_16x16x32_bf16 v[220:223], a[60:63], a[8:11], v[220:223]
  s_sub_u32 s35, s35, 1
  v_mfma_f32_16x16x32_bf16 v[252:255], a[60:63], a[12:15], v[252:255]
  s_cmp_lg_u32 s35, 0
  s_cbranch_scc1 Lp3_loop
  s_lshr_b32 s34, s24, 1
  s_lshl_b32 s34, s34, 11
  v_and_b32 v3, 15, v1
  v_lshlrev_b32 v3, 7, v3
  v_mfma_f32_16x16x32_bf16 v[128:131], a[64:67], a[16:19], v[128:131]
  buffer_load_dwordx2 v[22:23], v3, s[96:99], s34 offen sc1
  ds_read_b128 a[0:3], v16 offset:0
  v_mfma_f32_16x16x32_bf16 v[160:163], a[64:67], a[20:23], v[160:163]
  s_mov_b32 m0, s41
  ds_read_b64_tr_b16 a[32:33], v18 offset:0
  v_mfma_f32_16x16x32_bf16 v[192:195], a[64:67], a[24:27], v[192:195]
  ds_read_b64_tr_b16 a[34:35], v18 offset:2048
  v_mfma_f32_16x16x32_bf16 v[224:227], a[64:67], a[28:31], v[224:227]
  ds_read_b128 a[4:7], v16 offset:2048
  v_mfma_f32_16x16x32_bf16 v[132:135], a[68:71], a[16:19], v[132:135]
  buffer_load_dwordx4 v8, s[12:15], s48 offen offset:0 lds
  ds_read_b128 a[8:11], v16 offset:4096
  v_mfma_f32_16x16x32_bf16 v[164:167], a[68:71], a[20:23], v[164:167]
  ds_read_b128 a[12:15], v16 offset:6144
  v_mfma_f32_16x16x32_bf16 v[196:199], a[68:71], a[24:27], v[196:199]
  ds_read_b64_tr_b16 a[36:37], v19 offset:0
  v_mfma_f32_16x16x32_bf16 v[228:231], a[68:71], a[28:31], v[228:231]
  ds_read_b64_tr_b16 a[38:39], v19 offset:2048
  v_mfma_f32_16x16x32_bf16 v[136:139], a[72:75], a[16:19], v[136:139]
  buffer_load_dwordx4 v9, s[12:15], s48 offen offset:1024 lds
  ds_read_b64_tr_b16 a[40:41], v20 offset:0
  v_mfma_f32_16x16x32_bf16 v[168:171], a[72:75], a[20:23], v[168:171]
  ds_read_b64_tr_b16 a[42:43], v20 offset:2048
  v_mfma_f32_16x16x32_bf16 v[200:203], a[72:75], a[24:27], v[200:203]
  v_mfma_f32_16x16x32_bf16 v[232:235], a[72:75], a[28:31], v[232:235]
  ds_read_b64_tr_b16 a[44:45], v21 offset:0
  v_mfma_f32_16x16x32_bf16 v[140:143], a[76:79], a[16:19], v[140:143]
  ds_read_b64_tr_b16 a[46:47], v21 offset:2048
  v_mfma_f32_16x16x32_bf16 v[172:175], a[76:79], a[20:23], v[172:175]
  buffer_load_dwordx4 v10, s[12:15], s48 offen offset:2048 lds
  ds_read_b64_tr_b16 a[48:49], v18 offset:8192
  v_mfma_f32_16x16x32_bf16 v[204:207], a[76:79], a[24:27], v[204:207]
  ds_read_b64_tr_b16 a[50:51], v18 offset:10240
  v_mfma_f32_16x16x32_bf16 v[236:239], a[76:79], a[28:31], v[236:239]
  ds_read_b64_tr_b16 a[52:53], v19 offset:8192
  v_mfma_f32_16x16x32_bf16 v[144:147], a[80:83], a[16:19], v[144:147]
  ds_read_b64_tr_b16 a[54:55], v19 offset:10240
  v_mfma_f32_16x16x32_bf16 v[176:179], a[80:83], a[20:23], v[176:179]
  buffer_load_dwordx4 v11, s[12:15], s48 offen offset:3072 lds
  ds_read_b64_tr_b16 a[56:57], v20 offset:8192
  v_mfma_f32_16x16x32_bf16 v[208:211], a[80:83], a[24:27], v[208:211]
  s_bfe_u32 s56, 0x302010e, s55
  s_add_u32 s54, s54, s56
  s_add_u32 s55, s55, 8
  v_mfma_f32_16x16x32_bf16 v[240:243], a[80:83], a[28:31], v[240:243]
  s_and_b32 s55, s55, 0x8001f
  s_and_b32 s54, s54, 15
  s_lshl_b32 s48, s54, 19
  v_mfma_f32_16x16x32_bf16 v[148:151], a[84:87], a[16:19], v[148:151]
  s_mov_b32 m0, s36
  ds_read_b64_tr_b16 a[58:59], v20 offset:10240
  ds_read_b64_tr_b16 a[60:61], v21 offset:8192
  v_mfma_f32_16x16x32_bf16 v[180:183], a[84:87], a[20:23], v[180:183]
  ds_read_b64_tr_b16 a[62:63], v21 offset:10240
  v_mfma_f32_16x16x32_bf16 v[212:215], a[84:87], a[24:27], v[212:215]
  buffer_load_dwordx4 v4, s[8:11], s46 offen offset:0 lds
  v_mfma_f32_16x16x32_bf16 v[244:247], a[84:87], a[28:31], v[244:247]
  v_mfma_f32_16x16x32_bf16 v[152:155], a[88:91], a[16:19], v[152:155]
  v_mfma_f32_16x16x32_bf16 v[184:187], a[88:91], a[20:23], v[184:187]
  v_mfma_f32_16x16x32_bf16 v[216:219], a[88:91], a[24:27], v[216:219]
  buffer_load_dwordx4 v5, s[8:11], s46 offen offset:1024 lds
  v_mfma_f32_16x16x32_bf16 v[248:251], a[88:91], a[28:31], v[248:251]
  v_mfma_f32_16x16x32_bf16 v[156:159], a[92:95], a[16:19], v[156:159]
  v_mfma_f32_16x16x32_bf16 v[188:191], a[92:95], a[20:23], v[188:191]
  v_mfma_f32_16x16x32_bf16 v[220:223], a[92:95], a[24:27], v[220:223]
  v_mfma_f32_16x16x32_bf16 v[252:255], a[92:95], a[28:31], v[252:255]
  s_waitcnt lgkmcnt(0)
  v_mfma_f32_16x16x32_bf16 v[128:131], a[32:35], a[0:3], v[128:131]
  buffer_load_dwordx4 v6, s[8:11], s46 offen offset:2048 lds
  ds_read_b128 a[16:19], v17 offset:0
  v_mfma_f32_16x16x32_bf16 v[160:163], a[32:35], a[4:7], v[160:163]
  ds_read_b64_tr_b16 a[64:65], v18 offset:4096
  v_mfma_f32_16x16x32_bf16 v[192:195], a[32:35], a[8:11], v[192:195]
  ds_read_b64_tr_b16 a[66:67], v18 offset:6144
  v_mfma_f32_16x16x32_bf16 v[224:227], a[32:35], a[12:15], v[224:227]
  ds_read_b128 a[20:23], v17 offset:2048
  v_mfma_f32_16x16x32_bf16 v[132:135], a[36:39], a[0:3], v[132:135]
  buffer_load_dwordx4 v7, s[8:11], s46 offen offset:3072 lds
  ds_read_b128 a[24:27], v17 offset:4096
  v_mfma_f32_16x16x32_bf16 v[164:167], a[36:39], a[4:7], v[164:167]
  s_add_u32 m0, s36, 4096
  ds_read_b128 a[28:31], v17 offset:6144
  v_mfma_f32_16x16x32_bf16 v[196:199], a[36:39], a[8:11], v[196:199]
  ds_read_b64_tr_b16 a[68:69], v19 offset:4096
  v_mfma_f32_16x16x32_bf16 v[228:231], a[36:39], a[12:15], v[228:231]
  ds_read_b64_tr_b16 a[70:71], v19 offset:6144
  v_mfma_f32_16x16x32_bf16 v[136:139], a[40:43], a[0:3], v[136:139]
  buffer_load_dwordx4 v4, s[8:11], s47 offen offset:0 lds
  ds_read_b64_tr_b16 a[72:73], v20 offset:4096
  v_mfma_f32_16x16x32_bf16 v[168:171], a[40:43], a[4:7], v[168:171]
  ds_read_b64_tr_b16 a[74:75], v20 offset:6144
  v_mfma_f32_16x16x32_bf16 v[200:203], a[40:43], a[8:11], v[200:203]
  v_mfma_f32_16x16x32_bf16 v[232:235], a[40:43], a[12:15], v[232:235]
  ds_read_b64_tr_b16 a[76:77], v21 offset:4096
  v_mfma_f32_16x16x32_bf16 v[140:143], a[44:47], a[0:3], v[140:143]
  buffer_load_dwordx4 v5, s[8:11], s47 offen offset:1024 lds
  ds_read_b64_tr_b16 a[78:79], v21 offset:6144
  v_mfma_f32_16x16x32_bf16 v[172:175], a[44:47], a[4:7], v[172:175]
  ds_read_b64_tr_b16 a[80:81], v18 offset:12288
  v_mfma_f32_16x16x32_bf16 v[204:207], a[44:47], a[8:11], v[204:207]
  ds_read_b64_tr_b16 a[82:83], v18 offset:14336
  v_mfma_f32_16x16x32_bf16 v[236:239], a[44:47], a[12:15], v[236:239]
  ds_read_b64_tr_b16 a[84:85], v19 offset:12288
  v_mfma_f32_16x16x32_bf16 v[144:147], a[48:51], a[0:3], v[144:147]
  buffer_load_dwordx4 v6, s[8:11], s47 offen offset:2048 lds
  ds_read_b64_tr_b16 a[86:87], v19 offset:14336
  v_mfma_f32_16x16x32_bf16 v[176:179], a[48:51], a[4:7], v[176:179]
  ds_read_b64_tr_b16 a[88:89], v20 offset:12288
  v_mfma_f32_16x16x32_bf16 v[208:211], a[48:51], a[8:11], v[208:211]
  ds_read_b64_tr_b16 a[90:91], v20 offset:14336
  v_mfma_f32_16x16x32_bf16 v[240:243], a[48:51], a[12:15], v[240:243]
  ds_read_b64_tr_b16 a[92:93], v21 offset:12288
  v_mfma_f32_16x16x32_bf16 v[148:151], a[52:55], a[0:3], v[148:151]
  buffer_load_dwordx4 v7, s[8:11], s47 offen offset:3072 lds
  ds_read_b64_tr_b16 a[94:95], v21 offset:14336
  v_mfma_f32_16x16x32_bf16 v[180:183], a[52:55], a[4:7], v[180:183]
  s_bfe_u32 s49, 0x302010e, s53
  s_add_u32 s52, s52, s49
  s_add_u32 s53, s53, 8
  v_mfma_f32_16x16x32_bf16 v[212:215], a[52:55], a[8:11], v[212:215]
  s_and_b32 s53, s53, 0x8001f
  s_and_b32 s52, s52, 15
  s_lshl_b32 s49, s52, 7
  v_mfma_f32_16x16x32_bf16 v[244:247], a[52:55], a[12:15], v[244:247]
  s_or_b32 s46, s50, s49
  s_or_b32 s47, s51, s49
  v_mfma_f32_16x16x32_bf16 v[152:155], a[56:59], a[0:3], v[152:155]
  s_add_u32 s36, s36, s38
  s_add_u32 s37, s37, 1
  s_cmp_eq_u32 s37, 3
  s_cselect_b32 s37, 0, s37
  s_cselect_b32 s38, s39, s40
  v_mfma_f32_16x16x32_bf16 v[184:187], a[56:59], a[4:7], v[184:187]
  s_add_u32 s41, s41, s43
  s_add_u32 s42, s42, 1
  s_cmp_eq_u32 s42, 3
  s_cselect_b32 s42, 0, s42
  s_cselect_b32 s43, s44, s45
  v_mfma_f32_16x16x32_bf16 v[216:219], a[56:59], a[8:11], v[216:219]
  v_add_u32 v16, s38, v16
  v_add_u32 v17, s38, v17
  v_mfma_f32_16x16x32_bf16 v[248:251], a[56:59], a[12:15], v[248:251]
  v_add_u32 v18, s43, v18
  v_add_u32 v19, s43, v19
  v_mfma_f32_16x16x32_bf16 v[156:159], a[60:63], a[0:3], v[156:159]
  v_add_u32 v20, s43, v20
  v_add_u32 v21, s43, v21
  v_mfma_f32_16x16x32_bf16 v[188:191], a[60:63], a[4:7], v[188:191]
  v_mfma_f32_16x16x32_bf16 v[220:223], a[60:63], a[8:11], v[220:223]
  v_mfma_f32_16x16x32_bf16 v[252:255], a[60:63], a[12:15], v[252:255]
  s_waitcnt vmcnt(12) lgkmcnt(0)
  s_barrier
  s_mov_b32 s5, 0x40000
Lpoll_11:
  v_cmp_ne_u64 vcc, s[94:95], v[22:23]
  s_nop 0
  s_cbranch_vccz Lpolld_12
  s_sleep 4
  buffer_load_dwordx2 v[22:23], v3, s[96:99], s34 offen sc1
  s_sub_u32 s5, s5, 1
  s_waitcnt vmcnt(0)
  s_cbranch_scc0 Lpoll_11
Lpolld_12:
  s_lshl_b32 s4, s24, 20
  s_lshl_b32 s5, s25, 16
  s_sub_u32 s5, 1048576, s5
  s_add_u32 s20, s86, 16777216
  s_addc_u32 s21, s87, 0
  s_add_u32 s20, s20, s4
  s_addc_u32 s21, s21, 0
  s_mov_b32 s22, s5
  s_mov_b32 s23, 0x00020000
  s_lshl_b32 s28, s3, 12
  s_add_u32 s26, s28, 0xc000
  s_add_u32 s27, s28, 0x10000
  s_add_u32 s29, s28, 0x4000
  s_and_b32 s4, s2, 1
  s_lshl_b32 s4, s4, 3
  s_bfe_u32 s5, s2, 0x30003
  s_add_u32 s73, s4, s5
  s_bfe_u32 s4, s2, 0x10001
  s_lshl_b32 s4, s4, 2
  s_lshr_b32 s5, s2, 6
  s_add_u32 s76, s4, s5
  s_bfe_u32 s77, s2, 0x10002
  s_lshl_b32 s78, s73, 3
  s_add_u32 s78, s78, s76
  s_lshl_b32 s79, s3, 12
  s_add_u32 s64, s79, 131072
  v_mfma_f32_16x16x32_bf16 v[128:131], a[64:67], a[16:19], v[128:131]
  s_mov_b32 m0, s26
  ds_read_b128 a[0:3], v16 offset:0
  v_mfma_f32_16x16x32_bf16 v[160:163], a[64:67], a[20:23], v[160:163]
  buffer_load_dwordx4 v2, s[20:23], s28 offen offset:0 sc1 lds
  ds_read_b64_tr_b16 a[32:33], v18 offset:0
  v_mfma_f32_16x16x32_bf16 v[192:195], a[64:67], a[24:27], v[192:195]
  ds_read_b64_tr_b16 a[34:35], v18 offset:2048
  v_mfma_f32_16x16x32_bf16 v[224:227], a[64:67], a[28:31], v[224:227]
  ds_read_b128 a[4:7], v16 offset:2048
  v_mfma_f32_16x16x32_bf16 v[132:135], a[68:71], a[16:19], v[132:135]
  ds_read_b128 a[8:11], v16 offset:4096
  v_mfma_f32_16x16x32_bf16 v[164:167], a[68:71], a[20:23], v[164:167]
  ds_read_b128 a[12:15], v16 offset:6144
  v_mfma_f32_16x16x32_bf16 v[196:199], a[68:71], a[24:27], v[196:199]
  ds_read_b64_tr_b16 a[36:37], v19 offset:0
  v_mfma_f32_16x16x32_bf16 v[228:231], a[68:71], a[28:31], v[228:231]
  ds_read_b64_tr_b16 a[38:39], v19 offset:2048
  v_mfma_f32_16x16x32_bf16 v[136:139], a[72:75], a[16:19], v[136:139]
  ds_read_b64_tr_b16 a[40:41], v20 offset:0
  v_mfma_f32_16x16x32_bf16 v[168:171], a[72:75], a[20:23], v[168:171]
  ds_read_b64_tr_b16 a[42:43], v20 offset:2048
  v_mfma_f32_16x16x32_bf16 v[200:203], a[72:75], a[24:27], v[200:203]
  v_mfma_f32_16x16x32_bf16 v[232:235], a[72:75], a[28:31], v[232:235]
  ds_read_b64_tr_b16 a[44:45], v21 offset:0
  v_mfma_f32_16x16x32_bf16 v[140:143], a[76:79], a[16:19], v[140:143]
  ds_read_b64_tr_b16 a[46:47], v21 offset:2048
  v_mfma_f32_16x16x32_bf16 v[172:175], a[76:79], a[20:23], v[172:175]
  ds_read_b64_tr_b16 a[48:49], v18 offset:8192
  v_mfma_f32_16x16x32_bf16 v[204:207], a[76:79], a[24:27], v[204:207]
  ds_read_b64_tr_b16 a[50:51], v18 offset:10240
  v_mfma_f32_16x16x32_bf16 v[236:239], a[76:79], a[28:31], v[236:239]
  buffer_load_dwordx4 v2, s[20:23], s28 offen offset:1024 sc1 lds
  ds_read_b64_tr_b16 a[52:53], v19 offset:8192
  v_mfma_f32_16x16x32_bf16 v[144:147], a[80:83], a[16:19], v[144:147]
  ds_read_b64_tr_b16 a[54:55], v19 offset:10240
  v_mfma_f32_16x16x32_bf16 v[176:179], a[80:83], a[20:23], v[176:179]
  ds_read_b64_tr_b16 a[56:57], v20 offset:8192
  v_mfma_f32_16x16x32_bf16 v[208:211], a[80:83], a[24:27], v[208:211]
  ds_read_b64_tr_b16 a[58:59], v20 offset:10240
  v_mfma_f32_16x16x32_bf16 v[240:243], a[80:83], a[28:31], v[240:243]
  ds_read_b64_tr_b16 a[60:61], v21 offset:8192
  v_mfma_f32_16x16x32_bf16 v[148:151], a[84:87], a[16:19], v[148:151]
  ds_read_b64_tr_b16 a[62:63], v21 offset:10240
  v_mfma_f32_16x16x32_bf16 v[180:183], a[84:87], a[20:23], v[180:183]
  v_mfma_f32_16x16x32_bf16 v[212:215], a[84:87], a[24:27], v[212:215]
  v_mfma_f32_16x16x32_bf16 v[244:247], a[84:87], a[28:31], v[244:247]
  v_mfma_f32_16x16x32_bf16 v[152:155], a[88:91], a[16:19], v[152:155]
  v_mfma_f32_16x16x32_bf16 v[184:187], a[88:91], a[20:23], v[184:187]
  v_mfma_f32_16x16x32_bf16 v[216:219], a[88:91], a[24:27], v[216:219]
  v_mfma_f32_16x16x32_bf16 v[248:251], a[88:91], a[28:31], v[248:251]
  v_mfma_f32_16x16x32_bf16 v[156:159], a[92:95], a[16:19], v[156:159]
  v_mfma_f32_16x16x32_bf16 v[188:191], a[92:95], a[20:23], v[188:191]
  v_mfma_f32_16x16x32_bf16 v[220:223], a[92:95], a[24:27], v[220:223]
  v_mfma_f32_16x16x32_bf16 v[252:255], a[92:95], a[28:31], v[252:255]
  s_waitcnt lgkmcnt(0)
  v_mfma_f32_16x16x32_bf16 v[128:131], a[32:35], a[0:3], v[128:131]
  buffer_load_dwordx4 v2, s[20:23], s28 offen offset:2048 sc1 lds
  ds_read_b128 a[16:19], v17 offset:0
  v_mfma_f32_16x16x32_bf16 v[160:163], a[32:35], a[4:7], v[160:163]
  ds_read_b64_tr_b16 a[64:65], v18 offset:4096
  v_mfma_f32_16x16x32_bf16 v[192:195], a[32:35], a[8:11], v[192:195]
  ds_read_b64_tr_b16 a[66:67], v18 offset:6144
  v_mfma_f32_16x16x32_bf16 v[224:227], a[32:35], a[12:15], v[224:227]
  ds_read_b128 a[20:23], v17 offset:2048
  v_mfma_f32_16x16x32_bf16 v[132:135], a[36:39], a[0:3], v[132:135]
  ds_read_b128 a[24:27], v17 offset:4096
  v_mfma_f32_16x16x32_bf16 v[164:167], a[36:39], a[4:7], v[164:167]
  ds_read_b128 a[28:31], v17 offset:6144
  v_mfma_f32_16x16x32_bf16 v[196:199], a[36:39], a[8:11], v[196:199]
  ds_read_b64_tr_b16 a[68:69], v19 offset:4096
  v_mfma_f32_16x16x32_bf16 v[228:231], a[36:39], a[12:15], v[228:231]
  ds_read_b64_tr_b16 a[70:71], v19 offset:6144
  v_mfma_f32_16x16x32_bf16 v[136:139], a[40:43], a[0:3], v[136:139]
  ds_read_b64_tr_b16 a[72:73], v20 offset:4096
  v_mfma_f32_16x16x32_bf16 v[168:171], a[40:43], a[4:7], v[168:171]
  ds_read_b64_tr_b16 a[74:75], v20 offset:6144
  v_mfma_f32_16x16x32_bf16 v[200:203], a[40:43], a[8:11], v[200:203]
  v_mfma_f32_16x16x32_bf16 v[232:235], a[40:43], a[12:15], v[232:235]
  ds_read_b64_tr_b16 a[76:77], v21 offset:4096
  v_mfma_f32_16x16x32_bf16 v[140:143], a[44:47], a[0:3], v[140:143]
  buffer_load_dwordx4 v2, s[20:23], s28 offen offset:3072 sc1 lds
  ds_read_b64_tr_b16 a[78:79], v21 offset:6144
  v_mfma_f32_16x16x32_bf16 v[172:175], a[44:47], a[4:7], v[172:175]
  s_xor_b32 s26, s26, 0x4000
  s_add_u32 s28, s28, 0x8000
  ds_read_b64_tr_b16 a[80:81], v18 offset:12288
  v_mfma_f32_16x16x32_bf16 v[204:207], a[44:47], a[8:11], v[204:207]
  s_add_u32 s36, s36, s38
  s_add_u32 s37, s37, 1
  ds_read_b64_tr_b16 a[82:83], v18 offset:14336
  v_mfma_f32_16x16x32_bf16 v[236:239], a[44:47], a[12:15], v[236:239]
  s_cmp_eq_u32 s37, 3
  s_cselect_b32 s37, 0, s37
  s_cselect_b32 s38, s39, s40
  ds_read_b64_tr_b16 a[84:85], v19 offset:12288
  v_mfma_f32_16x16x32_bf16 v[144:147], a[48:51], a[0:3], v[144:147]
  s_add_u32 s41, s41, s43
  s_add_u32 s42, s42, 1
  ds_read_b64_tr_b16 a[86:87], v19 offset:14336
  v_mfma_f32_16x16x32_bf16 v[176:179], a[48:51], a[4:7], v[176:179]
  s_cmp_eq_u32 s42, 3
  s_cselect_b32 s42, 0, s42
  s_cselect_b32 s43, s44, s45
  ds_read_b64_tr_b16 a[88:89], v20 offset:12288
  v_mfma_f32_16x16x32_bf16 v[208:211], a[48:51], a[8:11], v[208:211]
  ds_read_b64_tr_b16 a[90:91], v20 offset:14336
  v_mfma_f32_16x16x32_bf16 v[240:243], a[48:51], a[12:15], v[240:243]
  ds_read_b64_tr_b16 a[92:93], v21 offset:12288
  v_mfma_f32_16x16x32_bf16 v[148:151], a[52:55], a[0:3], v[148:151]
  ds_read_b64_tr_b16 a[94:95], v21 offset:14336
  v_mfma_f32_16x16x32_bf16 v[180:183], a[52:55], a[4:7], v[180:183]
  v_add_u32 v16, s38, v16
  v_add_u32 v17, s38, v17
  v_mfma_f32_16x16x32_bf16 v[212:215], a[52:55], a[8:11], v[212:215]
  v_add_u32 v18, s43, v18
  v_add_u32 v19, s43, v19
  v_mfma_f32_16x16x32_bf16 v[244:247], a[52:55], a[12:15], v[244:247]
  v_add_u32 v20, s43, v20
  v_add_u32 v21, s43, v21
  v_mfma_f32_16x16x32_bf16 v[152:155], a[56:59], a[0:3], v[152:155]
  v_mfma_f32_16x16x32_bf16 v[184:187], a[56:59], a[4:7], v[184:187]
  v_mfma_f32_16x16x32_bf16 v[216:219], a[56:59], a[8:11], v[216:219]
  v_mfma_f32_16x16x32_bf16 v[248:251], a[56:59], a[12:15], v[248:251]
  v_mfma_f32_16x16x32_bf16 v[156:159], a[60:63], a[0:3], v[156:159]
  v_mfma_f32_16x16x32_bf16 v[188:191], a[60:63], a[4:7], v[188:191]
  v_mfma_f32_16x16x32_bf16 v[220:223], a[60:63], a[8:11], v[220:223]
  v_mfma_f32_16x16x32_bf16 v[252:255], a[60:63], a[12:15], v[252:255]
  s_waitcnt vmcnt(4) lgkmcnt(0)
  s_barrier
  s_mov_b32 s6, 0x3e0293ee
  s_mov_b32 s7, s6
  v_mfma_f32_16x16x32_bf16 v[128:131], a[64:67], a[16:19], v[128:131]
  s_mov_b32 m0, s26
  ds_read_b128 a[0:3], v16 offset:0
  v_mfma_f32_16x16x32_bf16 v[160:163], a[64:67], a[20:23], v[160:163]
  buffer_load_dwordx4 v2, s[20:23], s28 offen offset:0 sc1 lds
  ds_read_b64_tr_b16 a[32:33], v18 offset:0
  v_mfma_f32_16x16x32_bf16 v[192:195], a[64:67], a[24:27], v[192:195]
  ds_read_b64_tr_b16 a[34:35], v18 offset:2048
  v_mfma_f32_16x16x32_bf16 v[224:227], a[64:67], a[28:31], v[224:227]
  buffer_load_dwordx4 v2, s[20:23], s28 offen offset:1024 sc1 lds
  ds_read_b128 a[4:7], v16 offset:2048
  v_mfma_f32_16x16x32_bf16 v[132:135], a[68:71], a[16:19], v[132:135]
  ds_read_b128 a[8:11], v16 offset:4096
  v_mfma_f32_16x16x32_bf16 v[164:167], a[68:71], a[20:23], v[164:167]
  ds_read_b128 a[12:15], v16 offset:6144
  v_mfma_f32_16x16x32_bf16 v[196:199], a[68:71], a[24:27], v[196:199]
  ds_read_b64_tr_b16 a[36:37], v19 offset:0
  v_mfma_f32_16x16x32_bf16 v[228:231], a[68:71], a[28:31], v[228:231]
  buffer_load_dwordx4 v2, s[20:23], s28 offen offset:2048 sc1 lds
  ds_read_b64_tr_b16 a[38:39], v19 offset:2048
  v_mfma_f32_16x16x32_bf16 v[136:139], a[72:75], a[16:19], v[136:139]
  ds_read_b64_tr_b16 a[40:41], v20 offset:0
  v_mfma_f32_16x16x32_bf16 v[168:171], a[72:75], a[20:23], v[168:171]
  ds_read_b64_tr_b16 a[42:43], v20 offset:2048
  v_mfma_f32_16x16x32_bf16 v[200:203], a[72:75], a[24:27], v[200:203]
  v_mfma_f32_16x16x32_bf16 v[232:235], a[72:75], a[28:31], v[232:235]
  buffer_load_dwordx4 v2, s[20:23], s28 offen offset:3072 sc1 lds
  ds_read_b64_tr_b16 a[44:45], v21 offset:0
  v_mfma_f32_16x16x32_bf16 v[140:143], a[76:79], a[16:19], v[140:143]
  s_xor_b32 s26, s26, 0x8000
  s_add_u32 s28, s28, 0x8000
  s_mov_b32 m0, s27
  v_mfma_f32_16x16x32_bf16 v[172:175], a[76:79], a[20:23], v[172:175]
  ds_read_b64_tr_b16 a[46:47], v21 offset:2048
  ds_read_b64_tr_b16 a[48:49], v18 offset:8192
  v_mfma_f32_16x16x32_bf16 v[204:207], a[76:79], a[24:27], v[204:207]
  ds_read_b64_tr_b16 a[50:51], v18 offset:10240
  v_mfma_f32_16x16x32_bf16 v[236:239], a[76:79], a[28:31], v[236:239]
  buffer_load_dwordx4 v2, s[20:23], s29 offen offset:0 sc1 lds
  ds_read_b64_tr_b16 a[52:53], v19 offset:8192
  v_mfma_f32_16x16x32_bf16 v[144:147], a[80:83], a[16:19], v[144:147]
  ds_read_b64_tr_b16 a[54:55], v19 offset:10240
  v_mfma_f32_16x16x32_bf16 v[176:179], a[80:83], a[20:23], v[176:179]
  ds_read_b64_tr_b16 a[56:57], v20 offset:8192
  v_mfma_f32_16x16x32_bf16 v[208:211], a[80:83], a[24:27], v[208:211]
  ds_read_b64_tr_b16 a[58:59], v20 offset:10240
  v_mfma_f32_16x16x32_bf16 v[240:243], a[80:83], a[28:31], v[240:243]
  buffer_load_dwordx4 v2, s[20:23], s29 offen offset:1024 sc1 lds
  ds_read_b64_tr_b16 a[60:61], v21 offset:8192
  v_mfma_f32_16x16x32_bf16 v[148:151], a[84:87], a[16:19], v[148:151]
  ds_read_b64_tr_b16 a[62:63], v21 offset:10240
  v_mfma_f32_16x16x32_bf16 v[180:183], a[84:87], a[20:23], v[180:183]
  v_mfma_f32_16x16x32_bf16 v[212:215], a[84:87], a[24:27], v[212:215]
  v_mfma_f32_16x16x32_bf16 v[244:247], a[84:87], a[28:31], v[244:247]
  buffer_load_dwordx4 v2, s[20:23], s29 offen offset:2048 sc1 lds
  v_mfma_f32_16x16x32_bf16 v[152:155], a[88:91], a[16:19], v[152:155]
  v_mfma_f32_16x16x32_bf16 v[184:187], a[88:91], a[20:23], v[184:187]
  v_mfma_f32_16x16x32_bf16 v[216:219], a[88:91], a[24:27], v[216:219]
  v_mfma_f32_16x16x32_bf16 v[248:251], a[88:91], a[28:31], v[248:251]
  buffer_load_dwordx4 v2, s[20:23], s29 offen offset:3072 sc1 lds
  v_mfma_f32_16x16x32_bf16 v[156:159], a[92:95], a[16:19], v[156:159]
  s_xor_b32 s27, s27, 0x4000
  s_add_u32 s29, s29, 0x8000
  v_mfma_f32_16x16x32_bf16 v[188:191], a[92:95], a[20:23], v[188:191]
  v_mfma_f32_16x16x32_bf16 v[220:223], a[92:95], a[24:27], v[220:223]
  v_mfma_f32_16x16x32_bf16 v[252:255], a[92:95], a[28:31], v[252:255]
  s_waitcnt lgkmcnt(0)
  v_mfma_f32_16x16x32_bf16 v[128:131], a[32:35], a[0:3], v[128:131]
  ds_read_b128 a[16:19], v17 offset:0
  ds_read_b64_tr_b16 a[64:65], v18 offset:4096
  v_mfma_f32_16x16x32_bf16 v[132:135], a[36:39], a[0:3], v[132:135]
  ds_read_b64_tr_b16 a[66:67], v18 offset:6144
  ds_read_b128 a[20:23], v17 offset:2048
  v_mfma_f32_16x16x32_bf16 v[136:139], a[40:43], a[0:3], v[136:139]
  ds_read_b128 a[24:27], v17 offset:4096
  ds_read_b128 a[28:31], v17 offset:6144
  v_mfma_f32_16x16x32_bf16 v[140:143], a[44:47], a[0:3], v[140:143]
  ds_read_b64_tr_b16 a[68:69], v19 offset:4096
  ds_read_b64_tr_b16 a[70:71], v19 offset:6144
  v_mfma_f32_16x16x32_bf16 v[144:147], a[48:51], a[0:3], v[144:147]
  ds_read_b64_tr_b16 a[72:73], v20 offset:4096
  ds_read_b64_tr_b16 a[74:75], v20 offset:6144
  v_mfma_f32_16x16x32_bf16 v[148:151], a[52:55], a[0:3], v[148:151]
  ds_read_b64_tr_b16 a[76:77], v21 offset:4096
  v_mfma_f32_16x16x32_bf16 v[152:155], a[56:59], a[0:3], v[152:155]
  ds_read_b64_tr_b16 a[78:79], v21 offset:6144
  ds_read_b64_tr_b16 a[80:81], v18 offset:12288
  v_mfma_f32_16x16x32_bf16 v[156:159], a[60:63], a[0:3], v[156:159]
  ds_read_b64_tr_b16 a[82:83], v18 offset:14336
  ds_read_b64_tr_b16 a[84:85], v19 offset:12288
  v_mfma_f32_16x16x32_bf16 v[160:163], a[32:35], a[4:7], v[160:163]
  ds_read_b64_tr_b16 a[86:87], v19 offset:14336
  ds_read_b64_tr_b16 a[88:89], v20 offset:12288
  v_mfma_f32_16x16x32_bf16 v[164:167], a[36:39], a[4:7], v[164:167]
  ds_read_b64_tr_b16 a[90:91], v20 offset:14336
  ds_read_b64_tr_b16 a[92:93], v21 offset:12288
  v_mfma_f32_16x16x32_bf16 v[168:171], a[40:43], a[4:7], v[168:171]
  ds_read_b64_tr_b16 a[94:95], v21 offset:14336
  v_mfma_f32_16x16x32_bf16 v[172:175], a[44:47], a[4:7], v[172:175]
  v_mfma_f32_16x16x32_bf16 v[176:179], a[48:51], a[4:7], v[176:179]
  v_mfma_f32_16x16x32_bf16 v[180:183], a[52:55], a[4:7], v[180:183]
  v_mfma_f32_16x16x32_bf16 v[184:187], a[56:59], a[4:7], v[184:187]
  v_mfma_f32_16x16x32_bf16 v[188:191], a[60:63], a[4:7], v[188:191]
  s_waitcnt lgkmcnt(0)
  v_mfma_f32_16x16x32_bf16 v[128:131], a[64:67], a[16:19], v[128:131]
  v_mfma_f32_16x16x32_bf16 v[132:135], a[68:71], a[16:19], v[132:135]
  v_mfma_f32_16x16x32_bf16 v[136:139], a[72:75], a[16:19], v[136:139]
  v_mfma_f32_16x16x32_bf16 v[140:143], a[76:79], a[16:19], v[140:143]
  v_mfma_f32_16x16x32_bf16 v[144:147], a[80:83], a[16:19], v[144:147]
  v_mfma_f32_16x16x32_bf16 v[148:151], a[84:87], a[16:19], v[148:151]
  s_nop 2
  v_pk_mul_f32 v[128:129], v[128:129], s[6:7]
  v_pk_mul_f32 v[130:131], v[130:131], s[6:7]
  v_mfma_f32_16x16x32_bf16 v[152:155], a[88:91], a[16:19], v[152:155]
  v_pk_mul_f32 v[132:133], v[132:133], s[6:7]
  v_pk_mul_f32 v[134:135], v[134:135], s[6:7]
  v_mfma_f32_16x16x32_bf16 v[156:159], a[92:95], a[16:19], v[156:159]
  v_cvt_pk_bf16_f32 v128, v128, v129
  v_cvt_pk_bf16_f32 v129, v130, v131
  v_mfma_f32_16x16x32_bf16 v[160:163], a[64:67], a[20:23], v[160:163]
  v_cvt_pk_bf16_f32 v130, v132, v133
  v_cvt_pk_bf16_f32 v131, v134, v135
  v_mfma_f32_16x16x32_bf16 v[164:167], a[68:71], a[20:23], v[164:167]
  v_accvgpr_write_b32 a128, v128
  v_accvgpr_write_b32 a129, v129
  v_mfma_f32_16x16x32_bf16 v[168:171], a[72:75], a[20:23], v[168:171]
  v_accvgpr_write_b32 a130, v130
  v_accvgpr_write_b32 a131, v131
  v_mfma_f32_16x16x32_bf16 v[172:175], a[76:79], a[20:23], v[172:175]
  v_pk_mul_f32 v[136:137], v[136:137], s[6:7]
  v_pk_mul_f32 v[138:139], v[138:139], s[6:7]
  v_mfma_f32_16x16x32_bf16 v[176:179], a[80:83], a[20:23], v[176:179]
  v_pk_mul_f32 v[140:141], v[140:141], s[6:7]
  v_pk_mul_f32 v[142:143], v[142:143], s[6:7]
  v_mfma_f32_16x16x32_bf16 v[180:183], a[84:87], a[20:23], v[180:183]
  v_cvt_pk_bf16_f32 v136, v136, v137
  v_cvt_pk_bf16_f32 v137, v138, v139
  v_mfma_f32_16x16x32_bf16 v[184:187], a[88:91], a[20:23], v[184:187]
  v_cvt_pk_bf16_f32 v138, v140, v141
  v_cvt_pk_bf16_f32 v139, v142, v143
  v_mfma_f32_16x16x32_bf16 v[188:191], a[92:95], a[20:23], v[188:191]
  v_accvgpr_write_b32 a132, v136
  v_accvgpr_write_b32 a133, v137
  v_mfma_f32_16x16x32_bf16 v[192:195], a[32:35], a[8:11], v[192:195]
  v_accvgpr_write_b32 a134, v138
  v_accvgpr_write_b32 a135, v139
  v_mfma_f32_16x16x32_bf16 v[196:199], a[36:39], a[8:11], v[196:199]
  v_mfma_f32_32x32x16_bf16 v[128:143], a[236:239], a[236:239], 0
  v_pk_mul_f32 v[144:145], v[144:145], s[6:7]
  v_mfma_f32_16x16x32_bf16 v[192:195], a[64:67], a[24:27], v[192:195]
  v_pk_mul_f32 v[146:147], v[146:147], s[6:7]
  v_pk_mul_f32 v[148:149], v[148:149], s[6:7]
  v_mfma_f32_16x16x32_bf16 v[196:199], a[68:71], a[24:27], v[196:199]
  v_pk_mul_f32 v[150:151], v[150:151], s[6:7]
  v_cvt_pk_bf16_f32 v144, v144, v145
  v_mfma_f32_16x16x32_bf16 v[200:203], a[40:43], a[8:11], v[200:203]
  v_cvt_pk_bf16_f32 v145, v146, v147
  v_cvt_pk_bf16_f32 v146, v148, v149
  v_mfma_f32_16x16x32_bf16 v[204:207], a[44:47], a[8:11], v[204:207]
  v_cvt_pk_bf16_f32 v147, v150, v151
  v_accvgpr_write_b32 a136, v144
  v_mfma_f32_16x16x32_bf16 v[200:203], a[72:75], a[24:27], v[200:203]
  v_accvgpr_write_b32 a137, v145
  v_accvgpr_write_b32 a138, v146
  v_mfma_f32_16x16x32_bf16 v[204:207], a[76:79], a[24:27], v[204:207]
  v_accvgpr_write_b32 a139, v147
  v_pk_mul_f32 v[152:153], v[152:153], s[6:7]
  v_mfma_f32_16x16x32_bf16 v[208:211], a[48:51], a[8:11], v[208:211]
  v_pk_mul_f32 v[154:155], v[154:155], s[6:7]
  v_pk_mul_f32 v[156:157], v[156:157], s[6:7]
  v_mfma_f32_16x16x32_bf16 v[212:215], a[52:55], a[8:11], v[212:215]
  v_pk_mul_f32 v[158:159], v[158:159], s[6:7]
  v_cvt_pk_bf16_f32 v152, v152, v153
  v_mfma_f32_16x16x32_bf16 v[208:211], a[80:83], a[24:27], v[208:211]
  v_cvt_pk_bf16_f32 v153, v154, v155
  v_cvt_pk_bf16_f32 v154, v156, v157
  v_mfma_f32_16x16x32_bf16 v[212:215], a[84:87], a[24:27], v[212:215]
  v_cvt_pk_bf16_f32 v155, v158, v159
  v_accvgpr_write_b32 a140, v152
  v_mfma_f32_16x16x32_bf16 v[216:219], a[56:59], a[8:11], v[216:219]
  v_accvgpr_write_b32 a141, v153
  v_accvgpr_write_b32 a142, v154
  v_mfma_f32_16x16x32_bf16 v[220:223], a[60:63], a[8:11], v[220:223]
  v_accvgpr_write_b32 a143, v155
  v_mfma_f32_32x32x16_bf16 v[144:159], a[236:239], a[236:239], 0
  v_mfma_f32_16x16x32_bf16 v[216:219], a[88:91], a[24:27], v[216:219]
  v_pk_mul_f32 v[160:161], v[160:161], s[6:7]
  v_pk_mul_f32 v[162:163], v[162:163], s[6:7]
  v_mfma_f32_16x16x32_bf16 v[220:223], a[92:95], a[24:27], v[220:223]
  v_pk_mul_f32 v[164:165], v[164:165], s[6:7]
  v_pk_mul_f32 v[166:167], v[166:167], s[6:7]
  v_mfma_f32_16x16x32_bf16 v[224:227], a[32:35], a[12:15], v[224:227]
  v_cvt_pk_bf16_f32 v160, v160, v161
  v_cvt_pk_bf16_f32 v161, v162, v163
  v_mfma_f32_16x16x32_bf16 v[228:231], a[36:39], a[12:15], v[228:231]
  v_cvt_pk_bf16_f32 v162, v164, v165
  v_cvt_pk_bf16_f32 v163, v166, v167
  v_mfma_f32_16x16x32_bf16 v[224:227], a[64:67], a[28:31], v[224:227]
  v_accvgpr_write_b32 a144, v160
  v_accvgpr_write_b32 a145, v161
  v_mfma_f32_16x16x32_bf16 v[228:231], a[68:71], a[28:31], v[228:231]
  v_accvgpr_write_b32 a146, v162
  v_accvgpr_write_b32 a147, v163
  v_mfma_f32_16x16x32_bf16 v[232:235], a[40:43], a[12:15], v[232:235]
  v_pk_mul_f32 v[168:169], v[168:169], s[6:7]
  v_pk_mul_f32 v[170:171], v[170:171], s[6:7]
  v_mfma_f32_16x16x32_bf16 v[236:239], a[44:47], a[12:15], v[236:239]
  v_pk_mul_f32 v[172:173], v[172:173], s[6:7]
  v_pk_mul_f32 v[174:175], v[174:175], s[6:7]
  v_mfma_f32_16x16x32_bf16 v[232:235], a[72:75], a[28:31], v[232:235]
  v_cvt_pk_bf16_f32 v168, v168, v169
  v_cvt_pk_bf16_f32 v169, v170, v171
  v_mfma_f32_16x16x32_bf16 v[236:239], a[76:79], a[28:31], v[236:239]
  v_cvt_pk_bf16_f32 v170, v172, v173
  v_cvt_pk_bf16_f32 v171, v174, v175
  v_mfma_f32_16x16x32_bf16 v[240:243], a[48:51], a[12:15], v[240:243]
  v_accvgpr_write_b32 a148, v168
  v_accvgpr_write_b32 a149, v169
  v_mfma_f32_16x16x32_bf16 v[244:247], a[52:55], a[12:15], v[244:247]
  v_accvgpr_write_b32 a150, v170
  v_accvgpr_write_b32 a151, v171
  v_mfma_f32_16x16x32_bf16 v[240:243], a[80:83], a[28:31], v[240:243]
  v_mfma_f32_32x32x16_bf16 v[160:175], a[236:239], a[236:239], 0
  v_pk_mul_f32 v[176:177], v[176:177], s[6:7]
  v_mfma_f32_16x16x32_bf16 v[244:247], a[84:87], a[28:31], v[244:247]
  v_pk_mul_f32 v[178:179], v[178:179], s[6:7]
  v_pk_mul_f32 v[180:181], v[180:181], s[6:7]
  v_mfma_f32_16x16x32_bf16 v[248:251], a[56:59], a[12:15], v[248:251]
  v_pk_mul_f32 v[182:183], v[182:183], s[6:7]
  v_cvt_pk_bf16_f32 v176, v176, v177
  v_mfma_f32_16x16x32_bf16 v[252:255], a[60:63], a[12:15], v[252:255]
  v_cvt_pk_bf16_f32 v177, v178, v179
  v_cvt_pk_bf16_f32 v178, v180, v181
  v_mfma_f32_16x16x32_bf16 v[248:251], a[88:91], a[28:31], v[248:251]
  v_cvt_pk_bf16_f32 v179, v182, v183
  v_accvgpr_write_b32 a152, v176
  v_mfma_f32_16x16x32_bf16 v[252:255], a[92:95], a[28:31], v[252:255]
  v_accvgpr_write_b32 a153, v177
  v_accvgpr_write_b32 a154, v178
  v_accvgpr_write_b32 a155, v179
  v_pk_mul_f32 v[184:185], v[184:185], s[6:7]
  v_pk_mul_f32 v[186:187], v[186:187], s[6:7]
  v_pk_mul_f32 v[188:189], v[188:189], s[6:7]
  v_pk_mul_f32 v[190:191], v[190:191], s[6:7]
  v_cvt_pk_bf16_f32 v184, v184, v185
  v_cvt_pk_bf16_f32 v185, v186, v187
  v_cvt_pk_bf16_f32 v186, v188, v189
  v_cvt_pk_bf16_f32 v187, v190, v191
  v_accvgpr_write_b32 a156, v184
  v_accvgpr_write_b32 a157, v185
  v_accvgpr_write_b32 a158, v186
  v_accvgpr_write_b32 a159, v187
  v_mfma_f32_32x32x16_bf16 v[176:191], a[236:239], a[236:239], 0
  v_pk_mul_f32 v[192:193], v[192:193], s[6:7]
  v_pk_mul_f32 v[194:195], v[194:195], s[6:7]
  v_pk_mul_f32 v[196:197], v[196:197], s[6:7]
  v_pk_mul_f32 v[198:199], v[198:199], s[6:7]
  v_cvt_pk_bf16_f32 v192, v192, v193
  v_cvt_pk_bf16_f32 v193, v194, v195
  v_cvt_pk_bf16_f32 v194, v196, v197
  v_cvt_pk_bf16_f32 v195, v198, v199
  v_accvgpr_write_b32 a160, v192
  v_accvgpr_write_b32 a161, v193
  v_accvgpr_write_b32 a162, v194
  v_accvgpr_write_b32 a163, v195
  v_pk_mul_f32 v[200:201], v[200:201], s[6:7]
  v_pk_mul_f32 v[202:203], v[202:203], s[6:7]
  v_pk_mul_f32 v[204:205], v[204:205], s[6:7]
  v_pk_mul_f32 v[206:207], v[206:207], s[6:7]
  v_cvt_pk_bf16_f32 v200, v200, v201
  v_cvt_pk_bf16_f32 v201, v202, v203
  v_cvt_pk_bf16_f32 v202, v204, v205
  v_cvt_pk_bf16_f32 v203, v206, v207
  v_accvgpr_write_b32 a164, v200
  v_accvgpr_write_b32 a165, v201
  v_accvgpr_write_b32 a166, v202
  v_accvgpr_write_b32 a167, v203
  v_mfma_f32_32x32x16_bf16 v[192:207], a[236:239], a[236:239], 0
  v_pk_mul_f32 v[208:209], v[208:209], s[6:7]
  v_pk_mul_f32 v[210:211], v[210:211], s[6:7]
  v_pk_mul_f32 v[212:213], v[212:213], s[6:7]
  v_pk_mul_f32 v[214:215], v[214:215], s[6:7]
  v_cvt_pk_bf16_f32 v208, v208, v209
  v_cvt_pk_bf16_f32 v209, v210, v211
  v_cvt_pk_bf16_f32 v210, v212, v213
  v_cvt_pk_bf16_f32 v211, v214, v215
  v_accvgpr_write_b32 a168, v208
  v_accvgpr_write_b32 a169, v209
  v_accvgpr_write_b32 a170, v210
  v_accvgpr_write_b32 a171, v211
  v_pk_mul_f32 v[216:217], v[216:217], s[6:7]
  v_pk_mul_f32 v[218:219], v[218:219], s[6:7]
  v_pk_mul_f32 v[220:221], v[220:221], s[6:7]
  v_pk_mul_f32 v[222:223], v[222:223], s[6:7]
  v_cvt_pk_bf16_f32 v216, v216, v217
  v_cvt_pk_bf16_f32 v217, v218, v219
  v_cvt_pk_bf16_f32 v218, v220, v221
  v_cvt_pk_bf16_f32 v219, v222, v223
  v_accvgpr_write_b32 a172, v216
  v_accvgpr_write_b32 a173, v217
  v_accvgpr_write_b32 a174, v218
  v_accvgpr_write_b32 a175, v219
  v_mfma_f32_32x32x16_bf16 v[208:223], a[236:239], a[236:239], 0
  v_pk_mul_f32 v[224:225], v[224:225], s[6:7]
  v_pk_mul_f32 v[226:227], v[226:227], s[6:7]
  v_pk_mul_f32 v[228:229], v[228:229], s[6:7]
  v_pk_mul_f32 v[230:231], v[230:231], s[6:7]
  v_cvt_pk_bf16_f32 v224, v224, v225
  v_cvt_pk_bf16_f32 v225, v226, v227
  v_cvt_pk_bf16_f32 v226, v228, v229
  v_cvt_pk_bf16_f32 v227, v230, v231
  v_accvgpr_write_b32 a176, v224
  v_accvgpr_write_b32 a177, v225
  v_accvgpr_write_b32 a178, v226
  v_accvgpr_write_b32 a179, v227
  v_pk_mul_f32 v[232:233], v[232:233], s[6:7]
  v_pk_mul_f32 v[234:235], v[234:235], s[6:7]
  v_pk_mul_f32 v[236:237], v[236:237], s[6:7]
  v_pk_mul_f32 v[238:239], v[238:239], s[6:7]
  v_cvt_pk_bf16_f32 v232, v232, v233
  v_cvt_pk_bf16_f32 v233, v234, v235
  v_cvt_pk_bf16_f32 v234, v236, v237
  v_cvt_pk_bf16_f32 v235, v238, v239
  v_accvgpr_write_b32 a180, v232
  v_accvgpr_write_b32 a181, v233
  v_accvgpr_write_b32 a182, v234
  v_accvgpr_write_b32 a183, v235
  v_mfma_f32_32x32x16_bf16 v[224:239], a[236:239], a[236:239], 0
  v_pk_mul_f32 v[240:241], v[240:241], s[6:7]
  v_pk_mul_f32 v[242:243], v[242:243], s[6:7]
  v_pk_mul_f32 v[244:245], v[244:245], s[6:7]
  v_pk_mul_f32 v[246:247], v[246:247], s[6:7]
  v_cvt_pk_bf16_f32 v240, v240, v241
  v_cvt_pk_bf16_f32 v241, v242, v243
  v_cvt_pk_bf16_f32 v242, v244, v245
  v_cvt_pk_bf16_f32 v243, v246, v247
  v_accvgpr_write_b32 a184, v240
  v_accvgpr_write_b32 a185, v241
  v_accvgpr_write_b32 a186, v242
  v_accvgpr_write_b32 a187, v243
  v_pk_mul_f32 v[248:249], v[248:249], s[6:7]
  v_pk_mul_f32 v[250:251], v[250:251], s[6:7]
  v_pk_mul_f32 v[252:253], v[252:253], s[6:7]
  v_pk_mul_f32 v[254:255], v[254:255], s[6:7]
  v_cvt_pk_bf16_f32 v248, v248, v249
  v_cvt_pk_bf16_f32 v249, v250, v251
  v_cvt_pk_bf16_f32 v250, v252, v253
  v_cvt_pk_bf16_f32 v251, v254, v255
  v_accvgpr_write_b32 a188, v248
  v_accvgpr_write_b32 a189, v249
  v_accvgpr_write_b32 a190, v250
  v_accvgpr_write_b32 a191, v251
  v_mfma_f32_32x32x16_bf16 v[240:255], a[236:239], a[236:239], 0
  v_add_u32 v3, 0xc000, v2
  v_add_u32 v4, 0x10000, v2
  v_mov_b32 v5, 0xf149f2ca
  s_mov_b32 s89, 0
  v_mfma_f32_32x32x16_bf16 a[192:207], a[236:239], a[236:239], 0
  s_waitcnt vmcnt(8)
  s_barrier
  ds_read_b128 a[32:35], v3 offset:0
  ds_read_b128 a[36:39], v3 offset:1024
  ds_read_b128 a[40:43], v3 offset:2048
  ds_read_b128 a[44:47], v3 offset:3072
  ds_read_b128 a[48:51], v3 offset:4096
  ds_read_b128 a[52:55], v3 offset:5120
  ds_read_b128 a[56:59], v3 offset:6144
  ds_read_b128 a[60:63], v3 offset:7168
  s_waitcnt lgkmcnt(6)
  v_mfma_f32_16x16x32_bf16 v[64:67], a[32:35], a[128:131], 0
  s_lshl_b32 s4, s2, 2
  s_add_u32 s4, s4, s3
  s_lshl_b32 s6, s4, 13
  v_mfma_f32_16x16x32_bf16 v[72:75], a[32:35], a[144:147], 0
  s_lshl_b32 s7, s4, 11
  s_mov_b32 s8, s74
  s_mov_b32 s9, s75
  v_mfma_f32_16x16x32_bf16 v[80:83], a[32:35], a[160:163], 0
  s_mov_b32 s10, 8388608
  s_mov_b32 s11, 0x00020000
  s_mov_b32 s12, s80
  v_mfma_f32_16x16x32_bf16 v[88:91], a[32:35], a[176:179], 0
  s_mov_b32 s13, s81
  s_mov_b32 s14, 2097152
  ds_read_b128 a[0:3], v3 offset:8192
  v_mfma_f32_16x16x32_bf16 v[64:67], a[36:39], a[132:135], v[64:67]
  s_mov_b32 s15, 0x00020000
  s_add_u32 s16, s86, 67108864
  s_addc_u32 s17, s87, 0
  v_mfma_f32_16x16x32_bf16 v[72:75], a[36:39], a[148:151], v[72:75]
  s_mov_b32 s18, 16777216
  s_mov_b32 s19, 0x00020000
  v_mfma_f32_16x16x32_bf16 v[80:83], a[36:39], a[164:167], v[80:83]
  v_and_b32 v6, 15, v1
  v_lshrrev_b32 v7, 4, v1
  v_mfma_f32_16x16x32_bf16 v[88:91], a[36:39], a[180:183], v[88:91]
  s_waitcnt lgkmcnt(5)
  ds_read_b128 a[4:7], v3 offset:9216
  v_sub_u32 v6, v6, v7
  v_mfma_f32_16x16x32_bf16 v[64:67], a[40:43], a[136:139], v[64:67]
  v_lshlrev_b32 v6, 2, v6
  v_add_u32 v6, s3, v6
  v_mfma_f32_16x16x32_bf16 v[72:75], a[40:43], a[152:155], v[72:75]
  v_cmp_gt_i32 s[32:33], 0, v6
  v_cmp_gt_i32 s[34:35], 1, v6
  v_mfma_f32_16x16x32_bf16 v[80:83], a[40:43], a[168:171], v[80:83]
  v_cmp_gt_i32 s[36:37], 2, v6
  v_cmp_gt_i32 s[38:39], 3, v6
  v_mfma_f32_16x16x32_bf16 v[88:91], a[40:43], a[184:187], v[88:91]
  ds_read_b128 a[8:11], v3 offset:10240
  v_cmp_gt_i32 s[40:41], 16, v6
  v_mfma_f32_16x16x32_bf16 v[64:67], a[44:47], a[140:143], v[64:67]
  v_cmp_gt_i32 s[42:43], 17, v6
  v_cmp_gt_i32 s[44:45], 18, v6
  v_mfma_f32_16x16x32_bf16 v[72:75], a[44:47], a[156:159], v[72:75]
  v_cmp_gt_i32 s[46:47], 19, v6
  v_cmp_gt_i32 s[48:49], 32, v6
  v_mfma_f32_16x16x32_bf16 v[80:83], a[44:47], a[172:175], v[80:83]
  v_cmp_gt_i32 s[50:51], 33, v6
  v_cmp_gt_i32 s[52:53], 34, v6
  v_mfma_f32_16x16x32_bf16 v[88:91], a[44:47], a[188:191], v[88:91]
  s_waitcnt lgkmcnt(5)
  ds_read_b128 a[12:15], v3 offset:11264
  v_cmp_gt_i32 s[54:55], 35, v6
  v_mfma_f32_16x16x32_bf16 v[68:71], a[48:51], a[128:131], 0
  v_cmp_gt_i32 s[56:57], 48, v6
  v_cmp_gt_i32 s[58:59], 49, v6
  v_mfma_f32_16x16x32_bf16 v[76:79], a[48:51], a[144:147], 0
  s_mov_b32 s30, 0x8000
  v_cmp_gt_i32 s[60:61], 50, v6
  v_cmp_gt_i32 s[62:63], 51, v6
  v_mfma_f32_16x16x32_bf16 v[84:87], a[48:51], a[160:163], 0
  s_mov_b32 s31, 0x4000
  v_mfma_f32_16x16x32_bf16 v[92:95], a[48:51], a[176:179], 0
  ds_read_b128 a[16:19], v3 offset:12288
  v_mfma_f32_16x16x32_bf16 v[68:71], a[52:55], a[132:135], v[68:71]
  v_mfma_f32_16x16x32_bf16 v[76:79], a[52:55], a[148:151], v[76:79]
  v_mfma_f32_16x16x32_bf16 v[84:87], a[52:55], a[164:167], v[84:87]
  v_mfma_f32_16x16x32_bf16 v[92:95], a[52:55], a[180:183], v[92:95]
  s_waitcnt lgkmcnt(5)
  ds_read_b128 a[20:23], v3 offset:13312
  v_mfma_f32_16x16x32_bf16 v[68:71], a[56:59], a[136:139], v[68:71]
  v_mfma_f32_16x16x32_bf16 v[76:79], a[56:59], a[152:155], v[76:79]
  v_mfma_f32_16x16x32_bf16 v[84:87], a[56:59], a[168:171], v[84:87]
  v_mfma_f32_16x16x32_bf16 v[92:95], a[56:59], a[184:187], v[92:95]
  ds_read_b128 a[24:27], v3 offset:14336
  v_mfma_f32_16x16x32_bf16 v[68:71], a[60:63], a[140:143], v[68:71]
  v_mfma_f32_16x16x32_bf16 v[76:79], a[60:63], a[156:159], v[76:79]
  v_mfma_f32_16x16x32_bf16 v[84:87], a[60:63], a[172:175], v[84:87]
  v_mfma_f32_16x16x32_bf16 v[92:95], a[60:63], a[188:191], v[92:95]
  ds_read_b128 a[28:31], v3 offset:15360
  s_cmp_lg_u32 s25, 0
  s_nop 0
  s_cbranch_scc1 La_nomask0
  v_cndmask_b32 v64, v64, v5, s[32:33]
  v_cndmask_b32 v65, v65, v5, s[34:35]
  v_cndmask_b32 v66, v66, v5, s[36:37]
  v_cndmask_b32 v67, v67, v5, s[38:39]
  v_cndmask_b32 v68, v68, v5, s[40:41]
  v_cndmask_b32 v69, v69, v5, s[42:43]
  v_cndmask_b32 v70, v70, v5, s[44:45]
  v_cndmask_b32 v71, v71, v5, s[46:47]
La_nomask0:
  v_max3_f32 v6, v64, v65, v66
  v_max3_f32 v7, v67, v68, v69
  v_max3_f32 v6, v6, v70, v71
  v_max_f32 v6, v6, v7
  v_max3_f32 v8, v72, v73, v74
  v_max3_f32 v9, v75, v76, v77
  v_max3_f32 v8, v8, v78, v79
  v_max_f32 v8, v8, v9
  v_max3_f32 v10, v80, v81, v82
  v_max3_f32 v11, v83, v84, v85
  v_max3_f32 v10, v10, v86, v87
  v_max_f32 v10, v10, v11
  v_max3_f32 v12, v88, v89, v90
  v_max3_f32 v13, v91, v92, v93
  v_max3_f32 v12, v12, v94, v95
  v_max_f32 v12, v12, v13
  v_mov_b32 v7, v6
  v_mov_b32 v9, v8
  v_mov_b32 v11, v10
  v_mov_b32 v13, v12
  v_permlane32_swap_b32 v6, v7
  v_permlane32_swap_b32 v8, v9
  v_permlane32_swap_b32 v10, v11
  v_permlane32_swap_b32 v12, v13
  v_max_f32 v6, v6, v7
  v_max_f32 v8, v8, v9
  v_max_f32 v10, v10, v11
  v_max_f32 v12, v12, v13
  v_mov_b32 v7, v6
  v_mov_b32 v9, v8
  v_mov_b32 v11, v10
  v_mov_b32 v13, v12
  v_permlane16_swap_b32 v6, v7
  v_permlane16_swap_b32 v8, v9
  v_permlane16_swap_b32 v10, v11
  v_permlane16_swap_b32 v12, v13
  v_max_f32 v6, v6, v7
  v_max_f32 v8, v8, v9
  v_max_f32 v10, v10, v11
  v_max_f32 v12, v12, v13
  v_sub_f32 v16, 0, v6
  v_sub_f32 v17, 0, v6
  v_sub_f32 v18, 0, v6
  v_sub_f32 v19, 0, v6
  v_sub_f32 v20, 0, v8
  v_sub_f32 v21, 0, v8
  v_sub_f32 v22, 0, v8
  v_sub_f32 v23, 0, v8
  v_sub_f32 v24, 0, v10
  v_sub_f32 v25, 0, v10
  v_sub_f32 v26, 0, v10
  v_sub_f32 v27, 0, v10
  v_sub_f32 v28, 0, v12
  v_sub_f32 v29, 0, v12
  v_sub_f32 v30, 0, v12
  v_sub_f32 v31, 0, v12
  v_pk_add_f32 v[64:65], v[64:65], v[16:17]
  v_pk_add_f32 v[66:67], v[66:67], v[16:17]
  v_pk_add_f32 v[68:69], v[68:69], v[16:17]
  v_pk_add_f32 v[70:71], v[70:71], v[16:17]
  v_pk_add_f32 v[72:73], v[72:73], v[20:21]
  v_pk_add_f32 v[74:75], v[74:75], v[20:21]
  v_pk_add_f32 v[76:77], v[76:77], v[20:21]
  v_pk_add_f32 v[78:79], v[78:79], v[20:21]
  v_pk_add_f32 v[80:81], v[80:81], v[24:25]
  v_pk_add_f32 v[82:83], v[82:83], v[24:25]
  v_pk_add_f32 v[84:85], v[84:85], v[24:25]
  v_pk_add_f32 v[86:87], v[86:87], v[24:25]
  v_pk_add_f32 v[88:89], v[88:89], v[28:29]
  v_pk_add_f32 v[90:91], v[90:91], v[28:29]
  v_pk_add_f32 v[92:93], v[92:93], v[28:29]
  v_pk_add_f32 v[94:95], v[94:95], v[28:29]
  s_lshl_b32 s88, s25, 1
  s_waitcnt vmcnt(0)
  s_barrier
  s_waitcnt lgkmcnt(4)
  v_mfma_f32_16x16x32_bf16 v[96:99], a[0:3], a[128:131], v[16:19]
  s_mov_b32 m0, s26
  v_exp_f32 v64, v64
  v_mfma_f32_16x16x32_bf16 v[96:99], a[4:7], a[132:135], v[96:99]
  buffer_load_dwordx4 v2, s[20:23], s28 offen offset:0 sc1 lds
  v_exp_f32 v65, v65
  v_mfma_f32_16x16x32_bf16 v[96:99], a[8:11], a[136:139], v[96:99]
  buffer_load_dwordx4 v2, s[20:23], s28 offen offset:1024 sc1 lds
  v_exp_f32 v66, v66
  v_mfma_f32_16x16x32_bf16 v[96:99], a[12:15], a[140:143], v[96:99]
  buffer_load_dwordx4 v2, s[20:23], s28 offen offset:2048 sc1 lds
  v_exp_f32 v67, v67
  v_mfma_f32_16x16x32_bf16 v[104:107], a[0:3], a[144:147], v[20:23]
  v_exp_f32 v68, v68
  v_cvt_pk_bf16_f32 v32, v64, v65
  v_mfma_f32_16x16x32_bf16 v[104:107], a[4:7], a[148:151], v[104:107]
  buffer_load_dwordx4 v2, s[20:23], s28 offen offset:3072 sc1 lds
  v_exp_f32 v69, v69
  v_mfma_f32_16x16x32_bf16 v[104:107], a[8:11], a[152:155], v[104:107]
  s_xor_b32 s26, s26, 0x4000
  v_exp_f32 v70, v70
  v_cvt_pk_bf16_f32 v33, v66, v67
  v_mfma_f32_16x16x32_bf16 v[104:107], a[12:15], a[156:159], v[104:107]
  s_add_u32 s28, s28, 0x8000
  v_exp_f32 v71, v71
  v_cvt_pk_bf16_f32 v34, v68, v69
  v_mfma_f32_16x16x32_bf16 v[112:115], a[0:3], a[160:163], v[24:27]
  s_mov_b32 m0, s27
  v_exp_f32 v72, v72
  v_cvt_pk_bf16_f32 v35, v70, v71
  v_mfma_f32_16x16x32_bf16 v[112:115], a[4:7], a[164:167], v[112:115]
  buffer_load_dwordx4 v2, s[20:23], s29 offen offset:0 sc1 lds
  v_exp_f32 v73, v73
  v_mfma_f32_16x16x32_bf16 v[112:115], a[8:11], a[168:171], v[112:115]
  buffer_load_dwordx4 v2, s[20:23], s29 offen offset:1024 sc1 lds
  v_exp_f32 v74, v74
  v_mfma_f32_16x16x32_bf16 v[112:115], a[12:15], a[172:175], v[112:115]
  buffer_load_dwordx4 v2, s[20:23], s29 offen offset:2048 sc1 lds
  v_exp_f32 v75, v75
  v_mfma_f32_16x16x32_bf16 v[120:123], a[0:3], a[176:179], v[28:31]
  buffer_load_dwordx4 v2, s[20:23], s29 offen offset:3072 sc1 lds
  v_exp_f32 v76, v76
  v_mfma_f32_16x16x32_bf16 v[120:123], a[4:7], a[180:183], v[120:123]
  s_xor_b32 s27, s27, 0x8000
  v_exp_f32 v77, v77
  v_cvt_pk_bf16_f32 v36, v72, v73
  v_mfma_f32_16x16x32_bf16 v[120:123], a[8:11], a[184:187], v[120:123]
  s_add_u32 s29, s29, 0x8000
  v_exp_f32 v78, v78
  v_cvt_pk_bf16_f32 v37, v74, v75
  v_mfma_f32_16x16x32_bf16 v[120:123], a[12:15], a[188:191], v[120:123]
  s_waitcnt lgkmcnt(0)
  v_exp_f32 v79, v79
  v_cvt_pk_bf16_f32 v38, v76, v77
  v_mfma_f32_16x16x32_bf16 v[100:103], a[16:19], a[128:131], v[16:19]
  s_mov_b32 m0, s26
  v_exp_f32 v80, v80
  v_cvt_pk_bf16_f32 v39, v78, v79
  v_mfma_f32_16x16x32_bf16 v[100:103], a[20:23], a[132:135], v[100:103]
  buffer_load_dwordx4 v2, s[20:23], s28 offen offset:0 sc1 lds
  v_exp_f32 v81, v81
  v_mfma_f32_16x16x32_bf16 v[100:103], a[24:27], a[136:139], v[100:103]
  buffer_load_dwordx4 v2, s[20:23], s28 offen offset:1024 sc1 lds
  v_exp_f32 v82, v82
  v_cvt_pk_bf16_f32 v40, v80, v81
  v_mfma_f32_16x16x32_bf16 v[100:103], a[28:31], a[140:143], v[100:103]
  buffer_load_dwordx4 v2, s[20:23], s28 offen offset:2048 sc1 lds
  v_exp_f32 v83, v83
  v_mfma_f32_16x16x32_bf16 v[108:111], a[16:19], a[144:147], v[20:23]
  buffer_load_dwordx4 v2, s[20:23], s28 offen offset:3072 sc1 lds
  v_exp_f32 v84, v84
  v_cvt_pk_bf16_f32 v41, v82, v83
  v_mfma_f32_16x16x32_bf16 v[108:111], a[20:23], a[148:151], v[108:111]
  s_xor_b32 s26, s26, 0x8000
  v_exp_f32 v85, v85
  v_xor_b32 v3, 0x4000, v3
  v_mfma_f32_16x16x32_bf16 v[108:111], a[24:27], a[152:155], v[108:111]
  s_add_u32 s28, s28, 0x8000
  ds_read_b128 a[32:35], v3 offset:0
  v_exp_f32 v86, v86
  v_cvt_pk_bf16_f32 v42, v84, v85
  v_mfma_f32_16x16x32_bf16 v[108:111], a[28:31], a[156:159], v[108:111]
  s_mov_b32 m0, s27
  ds_read_b128 a[36:39], v3 offset:1024
  v_exp_f32 v87, v87
  v_mfma_f32_16x16x32_bf16 v[116:119], a[16:19], a[160:163], v[24:27]
  buffer_load_dwordx4 v2, s[20:23], s29 offen offset:0 sc1 lds
  v_exp_f32 v88, v88
  v_cvt_pk_bf16_f32 v43, v86, v87
  v_mfma_f32_16x16x32_bf16 v[116:119], a[20:23], a[164:167], v[116:119]
  buffer_load_dwordx4 v2, s[20:23], s29 offen offset:1024 sc1 lds
  v_exp_f32 v89, v89
  v_mfma_f32_16x16x32_bf16 v[116:119], a[24:27], a[168:171], v[116:119]
  buffer_load_dwordx4 v2, s[20:23], s29 offen offset:2048 sc1 lds
  v_exp_f32 v90, v90
  v_cvt_pk_bf16_f32 v44, v88, v89
  v_mfma_f32_16x16x32_bf16 v[116:119], a[28:31], a[172:175], v[116:119]
  buffer_load_dwordx4 v2, s[20:23], s29 offen offset:3072 sc1 lds
  v_exp_f32 v91, v91
  v_mfma_f32_16x16x32_bf16 v[124:127], a[16:19], a[176:179], v[28:31]
  s_xor_b32 s27, s27, 0x4000
  ds_read_b128 a[40:43], v3 offset:2048
  v_exp_f32 v92, v92
  v_cvt_pk_bf16_f32 v45, v90, v91
  v_mfma_f32_16x16x32_bf16 v[124:127], a[20:23], a[180:183], v[124:127]
  s_add_u32 s29, s29, 0x8000
  ds_read_b128 a[44:47], v3 offset:3072
  v_exp_f32 v93, v93
  v_mfma_f32_16x16x32_bf16 v[124:127], a[24:27], a[184:187], v[124:127]
  ds_read_b128 a[48:51], v3 offset:4096
  v_exp_f32 v94, v94
  v_cvt_pk_bf16_f32 v46, v92, v93
  v_mfma_f32_16x16x32_bf16 v[124:127], a[28:31], a[188:191], v[124:127]
  ds_read_b128 a[52:55], v3 offset:5120
  ds_read_b128 a[56:59], v3 offset:6144
  ds_read_b128 a[60:63], v3 offset:7168
  ds_read_b128 a[0:3], v4 offset:0
  ds_read_b128 a[4:7], v4 offset:1024
  ds_read_b128 a[8:11], v4 offset:2048
  v_exp_f32 v95, v95
  s_nop 0
  v_cvt_pk_bf16_f32 v47, v94, v95
  s_cmp_eq_u32 s25, 0
  s_cbranch_scc1 La_d1
  .p2align 6
La_lo:
  s_waitcnt lgkmcnt(7)
  v_mfma_f32_16x16x32_bf16 v[64:67], a[32:35], a[128:131], v[16:19]
  v_exp_f32 v96, v96
  v_mfma_f32_16x16x32_bf16 v[64:67], a[36:39], a[132:135], v[64:67]
  ds_read_b128 a[12:15], v4 offset:3072
  v_mfma_f32_16x16x32_bf16 v[64:67], a[40:43], a[136:139], v[64:67]
  v_exp_f32 v97, v97
  v_mfma_f32_16x16x32_bf16 v[64:67], a[44:47], a[140:143], v[64:67]
  v_cvt_pk_bf16_f32 v48, v96, v97
  v_mfma_f32_16x16x32_bf16 v[72:75], a[32:35], a[144:147], v[20:23]
  v_exp_f32 v98, v98
  v_mfma_f32_16x16x32_bf16 v[72:75], a[36:39], a[148:151], v[72:75]
  ds_read_b128 a[16:19], v4 offset:4096
  v_mfma_f32_16x16x32_bf16 v[72:75], a[40:43], a[152:155], v[72:75]
  v_exp_f32 v99, v99
  v_mfma_f32_16x16x32_bf16 v[72:75], a[44:47], a[156:159], v[72:75]
  v_cvt_pk_bf16_f32 v49, v98, v99
  v_mfma_f32_16x16x32_bf16 v[80:83], a[32:35], a[160:163], v[24:27]
  v_exp_f32 v100, v100
  v_mfma_f32_16x16x32_bf16 v[80:83], a[36:39], a[164:167], v[80:83]
  ds_read_b128 a[20:23], v4 offset:5120
  v_mfma_f32_16x16x32_bf16 v[80:83], a[40:43], a[168:171], v[80:83]
  v_exp_f32 v101, v101
  v_mfma_f32_16x16x32_bf16 v[80:83], a[44:47], a[172:175], v[80:83]
  v_cvt_pk_bf16_f32 v50, v100, v101
  v_mfma_f32_16x16x32_bf16 v[88:91], a[32:35], a[176:179], v[28:31]
  v_exp_f32 v102, v102
  v_mfma_f32_16x16x32_bf16 v[88:91], a[36:39], a[180:183], v[88:91]
  ds_read_b128 a[24:27], v4 offset:6144
  v_mfma_f32_16x16x32_bf16 v[88:91], a[40:43], a[184:187], v[88:91]
  v_exp_f32 v103, v103
  v_mfma_f32_16x16x32_bf16 v[88:91], a[44:47], a[188:191], v[88:91]
  s_waitcnt lgkmcnt(7)
  v_cvt_pk_bf16_f32 v51, v102, v103
  v_mfma_f32_16x16x32_bf16 v[68:71], a[48:51], a[128:131], v[16:19]
  v_exp_f32 v104, v104
  v_mfma_f32_16x16x32_bf16 v[68:71], a[52:55], a[132:135], v[68:71]
  ds_read_b128 a[28:31], v4 offset:7168
  v_mfma_f32_16x16x32_bf16 v[68:71], a[56:59], a[136:139], v[68:71]
  v_exp_f32 v105, v105
  v_mfma_f32_16x16x32_bf16 v[68:71], a[60:63], a[140:143], v[68:71]
  v_cvt_pk_bf16_f32 v52, v104, v105
  v_mfma_f32_16x16x32_bf16 v[76:79], a[48:51], a[144:147], v[20:23]
  v_exp_f32 v106, v106
  v_mfma_f32_16x16x32_bf16 v[76:79], a[52:55], a[148:151], v[76:79]
  ds_read_b128 a[32:35], v3 offset:8192
  v_mfma_f32_16x16x32_bf16 v[76:79], a[56:59], a[152:155], v[76:79]
  v_exp_f32 v107, v107
  v_mfma_f32_16x16x32_bf16 v[76:79], a[60:63], a[156:159], v[76:79]
  v_cvt_pk_bf16_f32 v53, v106, v107
  v_mfma_f32_16x16x32_bf16 v[84:87], a[48:51], a[160:163], v[24:27]
  v_exp_f32 v108, v108
  v_mfma_f32_16x16x32_bf16 v[84:87], a[52:55], a[164:167], v[84:87]
  ds_read_b128 a[36:39], v3 offset:9216
  v_mfma_f32_16x16x32_bf16 v[84:87], a[56:59], a[168:171], v[84:87]
  v_exp_f32 v109, v109
  v_mfma_f32_16x16x32_bf16 v[84:87], a[60:63], a[172:175], v[84:87]
  v_cvt_pk_bf16_f32 v54, v108, v109
  v_mfma_f32_16x16x32_bf16 v[92:95], a[48:51], a[176:179], v[28:31]
  v_exp_f32 v110, v110
  v_mfma_f32_16x16x32_bf16 v[92:95], a[52:55], a[180:183], v[92:95]
  ds_read_b128 a[40:43], v3 offset:10240
  v_mfma_f32_16x16x32_bf16 v[92:95], a[56:59], a[184:187], v[92:95]
  v_exp_f32 v111, v111
  v_mfma_f32_16x16x32_bf16 v[92:95], a[60:63], a[188:191], v[92:95]
  s_waitcnt lgkmcnt(7)
  v_cvt_pk_bf16_f32 v55, v110, v111
  v_mfma_f32_16x16x32_bf16 v[128:131], a[0:3], v[32:35], v[128:131]
  ds_read_b128 a[44:47], v3 offset:11264
  v_mfma_f32_16x16x32_bf16 v[160:163], a[0:3], v[36:39], v[160:163]
  v_exp_f32 v112, v112
  v_mfma_f32_16x16x32_bf16 v[192:195], a[0:3], v[40:43], v[192:195]
  s_sub_u32 s88, s88, 1
  v_mfma_f32_16x16x32_bf16 v[224:227], a[0:3], v[44:47], v[224:227]
  v_exp_f32 v113, v113
  v_mfma_f32_16x16x32_bf16 a[192:195], a[208:211], v[32:35], a[192:195]
  v_cvt_pk_bf16_f32 v56, v112, v113
  v_mfma_f32_16x16x32_bf16 v[132:135], a[4:7], v[32:35], v[132:135]
  v_exp_f32 v114, v114
  v_mfma_f32_16x16x32_bf16 v[164:167], a[4:7], v[36:39], v[164:167]
  ds_read_b128 a[48:51], v3 offset:12288
  v_mfma_f32_16x16x32_bf16 v[196:199], a[4:7], v[40:43], v[196:199]
  v_exp_f32 v115, v115
  v_mfma_f32_16x16x32_bf16 v[228:231], a[4:7], v[44:47], v[228:231]
  v_cvt_pk_bf16_f32 v57, v114, v115
  v_mfma_f32_16x16x32_bf16 a[196:199], a[208:211], v[36:39], a[196:199]
  v_exp_f32 v116, v116
  v_mfma_f32_16x16x32_bf16 v[136:139], a[8:11], v[32:35], v[136:139]
  ds_read_b128 a[52:55], v3 offset:13312
  v_mfma_f32_16x16x32_bf16 v[168:171], a[8:11], v[36:39], v[168:171]
  v_exp_f32 v117, v117
  v_mfma_f32_16x16x32_bf16 v[200:203], a[8:11], v[40:43], v[200:203]
  v_cvt_pk_bf16_f32 v58, v116, v117
  v_mfma_f32_16x16x32_bf16 v[232:235], a[8:11], v[44:47], v[232:235]
  v_exp_f32 v118, v118
  v_mfma_f32_16x16x32_bf16 a[200:203], a[208:211], v[40:43], a[200:203]
  v_mfma_f32_16x16x32_bf16 v[140:143], a[12:15], v[32:35], v[140:143]
  v_exp_f32 v119, v119
  v_mfma_f32_16x16x32_bf16 v[172:175], a[12:15], v[36:39], v[172:175]
  ds_read_b128 a[56:59], v3 offset:14336
  v_cvt_pk_bf16_f32 v59, v118, v119
  v_mfma_f32_16x16x32_bf16 v[204:207], a[12:15], v[40:43], v[204:207]
  v_exp_f32 v120, v120
  v_mfma_f32_16x16x32_bf16 v[236:239], a[12:15], v[44:47], v[236:239]
  v_mfma_f32_16x16x32_bf16 a[204:207], a[208:211], v[44:47], a[204:207]
  s_waitcnt lgkmcnt(7)
  v_exp_f32 v121, v121
  v_mfma_f32_16x16x32_bf16 v[144:147], a[16:19], v[32:35], v[144:147]
  ds_read_b128 a[60:63], v3 offset:15360
  v_cvt_pk_bf16_f32 v60, v120, v121
  v_mfma_f32_16x16x32_bf16 v[176:179], a[16:19], v[36:39], v[176:179]
  v_exp_f32 v122, v122
  v_mfma_f32_16x16x32_bf16 v[208:211], a[16:19], v[40:43], v[208:211]
  v_mfma_f32_16x16x32_bf16 v[240:243], a[16:19], v[44:47], v[240:243]
  v_exp_f32 v123, v123
  v_mfma_f32_16x16x32_bf16 v[148:151], a[20:23], v[32:35], v[148:151]
  ds_read_b128 a[0:3], v4 offset:8192
  v_cvt_pk_bf16_f32 v61, v122, v123
  v_mfma_f32_16x16x32_bf16 v[180:183], a[20:23], v[36:39], v[180:183]
  v_exp_f32 v124, v124
  v_mfma_f32_16x16x32_bf16 v[212:215], a[20:23], v[40:43], v[212:215]
  v_mfma_f32_16x16x32_bf16 v[244:247], a[20:23], v[44:47], v[244:247]
  v_exp_f32 v125, v125
  v_mfma_f32_16x16x32_bf16 v[152:155], a[24:27], v[32:35], v[152:155]
  ds_read_b128 a[4:7], v4 offset:9216
  v_cvt_pk_bf16_f32 v62, v124, v125
  v_mfma_f32_16x16x32_bf16 v[184:187], a[24:27], v[36:39], v[184:187]
  v_exp_f32 v126, v126
  v_mfma_f32_16x16x32_bf16 v[216:219], a[24:27], v[40:43], v[216:219]
  v_mfma_f32_16x16x32_bf16 v[248:251], a[24:27], v[44:47], v[248:251]
  v_exp_f32 v127, v127
  v_mfma_f32_16x16x32_bf16 v[156:159], a[28:31], v[32:35], v[156:159]
  ds_read_b128 a[8:11], v4 offset:10240
  v_cvt_pk_bf16_f32 v63, v126, v127
  v_mfma_f32_16x16x32_bf16 v[188:191], a[28:31], v[36:39], v[188:191]
  v_mfma_f32_16x16x32_bf16 v[220:223], a[28:31], v[40:43], v[220:223]
  s_waitcnt vmcnt(8)
  s_barrier
  v_mfma_f32_16x16x32_bf16 v[252:255], a[28:31], v[44:47], v[252:255]
  s_cmp_eq_u32 s88, 0
  s_cbranch_scc1 La_d0
  s_waitcnt lgkmcnt(7)
  v_mfma_f32_16x16x32_bf16 v[96:99], a[32:35], a[128:131], v[16:19]
  s_mov_b32 m0, s26
  v_exp_f32 v64, v64
  v_mfma_f32_16x16x32_bf16 v[96:99], a[36:39], a[132:135], v[96:99]
  buffer_load_dwordx4 v2, s[20:23], s28 offen offset:0 sc1 lds
  ds_read_b128 a[12:15], v4 offset:11264
  v_mfma_f32_16x16x32_bf16 v[96:99], a[40:43], a[136:139], v[96:99]
  v_exp_f32 v65, v65
  v_mfma_f32_16x16x32_bf16 v[96:99], a[44:47], a[140:143], v[96:99]
  v_cvt_pk_bf16_f32 v32, v64, v65
  v_mfma_f32_16x16x32_bf16 v[104:107], a[32:35], a[144:147], v[20:23]
  v_exp_f32 v66, v66
  v_mfma_f32_16x16x32_bf16 v[104:107], a[36:39], a[148:151], v[104:107]
  ds_read_b128 a[16:19], v4 offset:12288
  v_mfma_f32_16x16x32_bf16 v[104:107], a[40:43], a[152:155], v[104:107]
  v_exp_f32 v67, v67
  v_mfma_f32_16x16x32_bf16 v[104:107], a[44:47], a[156:159], v[104:107]
  v_cvt_pk_bf16_f32 v33, v66, v67
  v_mfma_f32_16x16x32_bf16 v[112:115], a[32:35], a[160:163], v[24:27]
  v_exp_f32 v68, v68
  v_mfma_f32_16x16x32_bf16 v[112:115], a[36:39], a[164:167], v[112:115]
  buffer_load_dwordx4 v2, s[20:23], s28 offen offset:1024 sc1 lds
  ds_read_b128 a[20:23], v4 offset:13312
  v_mfma_f32_16x16x32_bf16 v[112:115], a[40:43], a[168:171], v[112:115]
  v_exp_f32 v69, v69
  v_mfma_f32_16x16x32_bf16 v[112:115], a[44:47], a[172:175], v[112:115]
  v_cvt_pk_bf16_f32 v34, v68, v69
  v_mfma_f32_16x16x32_bf16 v[120:123], a[32:35], a[176:179], v[28:31]
  v_exp_f32 v70, v70
  v_mfma_f32_16x16x32_bf16 v[120:123], a[36:39], a[180:183], v[120:123]
  ds_read_b128 a[24:27], v4 offset:14336
  v_mfma_f32_16x16x32_bf16 v[120:123], a[40:43], a[184:187], v[120:123]
  v_exp_f32 v71, v71
  v_mfma_f32_16x16x32_bf16 v[120:123], a[44:47], a[188:191], v[120:123]
  s_waitcnt lgkmcnt(7)
  v_cvt_pk_bf16_f32 v35, v70, v71
  v_mfma_f32_16x16x32_bf16 v[100:103], a[48:51], a[128:131], v[16:19]
  v_exp_f32 v72, v72
  v_mfma_f32_16x16x32_bf16 v[100:103], a[52:55], a[132:135], v[100:103]
  buffer_load_dwordx4 v2, s[20:23], s28 offen offset:2048 sc1 lds
  ds_read_b128 a[28:31], v4 offset:15360
  v_mfma_f32_16x16x32_bf16 v[100:103], a[56:59], a[136:139], v[100:103]
  v_exp_f32 v73, v73
  v_mfma_f32_16x16x32_bf16 v[100:103], a[60:63], a[140:143], v[100:103]
  v_xor_b32 v3, s30, v3
  v_cvt_pk_bf16_f32 v36, v72, v73
  v_mfma_f32_16x16x32_bf16 v[108:111], a[48:51], a[144:147], v[20:23]
  v_exp_f32 v74, v74
  v_mfma_f32_16x16x32_bf16 v[108:111], a[52:55], a[148:151], v[108:111]
  ds_read_b128 a[32:35], v3 offset:0
  v_mfma_f32_16x16x32_bf16 v[108:111], a[56:59], a[152:155], v[108:111]
  v_exp_f32 v75, v75
  v_mfma_f32_16x16x32_bf16 v[108:111], a[60:63], a[156:159], v[108:111]
  v_cvt_pk_bf16_f32 v37, v74, v75
  v_mfma_f32_16x16x32_bf16 v[116:119], a[48:51], a[160:163], v[24:27]
  v_exp_f32 v76, v76
  v_mfma_f32_16x16x32_bf16 v[116:119], a[52:55], a[164:167], v[116:119]
  buffer_load_dwordx4 v2, s[20:23], s28 offen offset:3072 sc1 lds
  ds_read_b128 a[36:39], v3 offset:1024
  v_mfma_f32_16x16x32_bf16 v[116:119], a[56:59], a[168:171], v[116:119]
  s_xor_b32 s26, s26, s31
  v_exp_f32 v77, v77
  v_mfma_f32_16x16x32_bf16 v[116:119], a[60:63], a[172:175], v[116:119]
  s_add_u32 s28, s28, 0x8000
  s_mov_b32 m0, s27
  v_cvt_pk_bf16_f32 v38, v76, v77
  v_mfma_f32_16x16x32_bf16 v[124:127], a[48:51], a[176:179], v[28:31]
  v_exp_f32 v78, v78
  v_mfma_f32_16x16x32_bf16 v[124:127], a[52:55], a[180:183], v[124:127]
  ds_read_b128 a[40:43], v3 offset:2048
  v_mfma_f32_16x16x32_bf16 v[124:127], a[56:59], a[184:187], v[124:127]
  v_exp_f32 v79, v79
  v_mfma_f32_16x16x32_bf16 v[124:127], a[60:63], a[188:191], v[124:127]
  s_waitcnt lgkmcnt(7)
  v_cvt_pk_bf16_f32 v39, v78, v79
  v_mfma_f32_16x16x32_bf16 v[128:131], a[0:3], v[48:51], v[128:131]
  buffer_load_dwordx4 v2, s[20:23], s29 offen offset:0 sc1 lds
  ds_read_b128 a[44:47], v3 offset:3072
  v_mfma_f32_16x16x32_bf16 v[160:163], a[0:3], v[52:55], v[160:163]
  v_exp_f32 v80, v80
  v_mfma_f32_16x16x32_bf16 v[192:195], a[0:3], v[56:59], v[192:195]
  v_mfma_f32_16x16x32_bf16 v[224:227], a[0:3], v[60:63], v[224:227]
  v_exp_f32 v81, v81
  v_mfma_f32_16x16x32_bf16 a[192:195], a[208:211], v[48:51], a[192:195]
  v_cvt_pk_bf16_f32 v40, v80, v81
  v_mfma_f32_16x16x32_bf16 v[132:135], a[4:7], v[48:51], v[132:135]
  v_exp_f32 v82, v82
  v_mfma_f32_16x16x32_bf16 v[164:167], a[4:7], v[52:55], v[164:167]
  ds_read_b128 a[48:51], v3 offset:4096
  v_mfma_f32_16x16x32_bf16 v[196:199], a[4:7], v[56:59], v[196:199]
  v_exp_f32 v83, v83
  v_mfma_f32_16x16x32_bf16 v[228:231], a[4:7], v[60:63], v[228:231]
  buffer_load_dwordx4 v2, s[20:23], s29 offen offset:1024 sc1 lds
  v_cvt_pk_bf16_f32 v41, v82, v83
  v_mfma_f32_16x16x32_bf16 a[196:199], a[208:211], v[52:55], a[196:199]
  v_exp_f32 v84, v84
  v_mfma_f32_16x16x32_bf16 v[136:139], a[8:11], v[48:51], v[136:139]
  ds_read_b128 a[52:55], v3 offset:5120
  v_mfma_f32_16x16x32_bf16 v[168:171], a[8:11], v[52:55], v[168:171]
  v_exp_f32 v85, v85
  v_mfma_f32_16x16x32_bf16 v[200:203], a[8:11], v[56:59], v[200:203]
  v_cvt_pk_bf16_f32 v42, v84, v85
  v_mfma_f32_16x16x32_bf16 v[232:235], a[8:11], v[60:63], v[232:235]
  v_exp_f32 v86, v86
  v_mfma_f32_16x16x32_bf16 a[200:203], a[208:211], v[56:59], a[200:203]
  v_mfma_f32_16x16x32_bf16 v[140:143], a[12:15], v[48:51], v[140:143]
  v_exp_f32 v87, v87
  v_mfma_f32_16x16x32_bf16 v[172:175], a[12:15], v[52:55], v[172:175]
  buffer_load_dwordx4 v2, s[20:23], s29 offen offset:2048 sc1 lds
  ds_read_b128 a[56:59], v3 offset:6144
  v_mfma_f32_16x16x32_bf16 v[204:207], a[12:15], v[56:59], v[204:207]
  v_exp_f32 v88, v88
  v_mfma_f32_16x16x32_bf16 v[236:239], a[12:15], v[60:63], v[236:239]
  v_cvt_pk_bf16_f32 v43, v86, v87
  v_mfma_f32_16x16x32_bf16 a[204:207], a[208:211], v[60:63], a[204:207]
  s_waitcnt lgkmcnt(7)
  v_exp_f32 v89, v89
  v_mfma_f32_16x16x32_bf16 v[144:147], a[16:19], v[48:51], v[144:147]
  ds_read_b128 a[60:63], v3 offset:7168
  v_cvt_pk_bf16_f32 v44, v88, v89
  v_mfma_f32_16x16x32_bf16 v[176:179], a[16:19], v[52:55], v[176:179]
  v_exp_f32 v90, v90
  v_mfma_f32_16x16x32_bf16 v[208:211], a[16:19], v[56:59], v[208:211]
  v_mfma_f32_16x16x32_bf16 v[240:243], a[16:19], v[60:63], v[240:243]
  v_exp_f32 v91, v91
  v_mfma_f32_16x16x32_bf16 v[148:151], a[20:23], v[48:51], v[148:151]
  buffer_load_dwordx4 v2, s[20:23], s29 offen offset:3072 sc1 lds
  v_xor_b32 v4, s31, v4
  v_mfma_f32_16x16x32_bf16 v[180:183], a[20:23], v[52:55], v[180:183]
  s_xor_b32 s27, s27, s30
  v_exp_f32 v92, v92
  v_mfma_f32_16x16x32_bf16 v[212:215], a[20:23], v[56:59], v[212:215]
  s_add_u32 s29, s29, 0x8000
  ds_read_b128 a[0:3], v4 offset:0
  v_cvt_pk_bf16_f32 v45, v90, v91
  v_mfma_f32_16x16x32_bf16 v[244:247], a[20:23], v[60:63], v[244:247]
  v_exp_f32 v93, v93
  v_mfma_f32_16x16x32_bf16 v[152:155], a[24:27], v[48:51], v[152:155]
  ds_read_b128 a[4:7], v4 offset:1024
  v_cvt_pk_bf16_f32 v46, v92, v93
  v_mfma_f32_16x16x32_bf16 v[184:187], a[24:27], v[52:55], v[184:187]
  v_exp_f32 v94, v94
  v_mfma_f32_16x16x32_bf16 v[216:219], a[24:27], v[56:59], v[216:219]
  v_mfma_f32_16x16x32_bf16 v[248:251], a[24:27], v[60:63], v[248:251]
  v_exp_f32 v95, v95
  v_mfma_f32_16x16x32_bf16 v[156:159], a[28:31], v[48:51], v[156:159]
  ds_read_b128 a[8:11], v4 offset:2048
  v_cvt_pk_bf16_f32 v47, v94, v95
  v_mfma_f32_16x16x32_bf16 v[188:191], a[28:31], v[52:55], v[188:191]
  v_mfma_f32_16x16x32_bf16 v[220:223], a[28:31], v[56:59], v[220:223]
  v_mfma_f32_16x16x32_bf16 v[252:255], a[28:31], v[60:63], v[252:255]
  s_xor_b32 s30, s30, 0xc000
  s_xor_b32 s31, s31, 0xc000
  s_branch La_lo
La_d0:
  s_waitcnt lgkmcnt(7)
  v_mfma_f32_16x16x32_bf16 v[96:99], a[32:35], a[128:131], v[16:19]
  s_mov_b32 m0, s26
  ds_read_b128 a[12:15], v4 offset:11264
  v_cndmask_b32 v64, v64, v5, s[32:33]
  v_mfma_f32_16x16x32_bf16 v[96:99], a[36:39], a[132:135], v[96:99]
  v_exp_f32 v64, v64
  v_mfma_f32_16x16x32_bf16 v[96:99], a[40:43], a[136:139], v[96:99]
  v_cndmask_b32 v65, v65, v5, s[34:35]
  v_exp_f32 v65, v65
  v_mfma_f32_16x16x32_bf16 v[96:99], a[44:47], a[140:143], v[96:99]
  buffer_load_dwordx4 v2, s[20:23], s28 offen offset:0 sc1 lds
  v_cndmask_b32 v66, v66, v5, s[36:37]
  v_mfma_f32_16x16x32_bf16 v[104:107], a[32:35], a[144:147], v[20:23]
  v_exp_f32 v66, v66
  v_mfma_f32_16x16x32_bf16 v[104:107], a[36:39], a[148:151], v[104:107]
  ds_read_b128 a[16:19], v4 offset:12288
  v_cndmask_b32 v67, v67, v5, s[38:39]
  v_mfma_f32_16x16x32_bf16 v[104:107], a[40:43], a[152:155], v[104:107]
  v_exp_f32 v67, v67
  v_mfma_f32_16x16x32_bf16 v[104:107], a[44:47], a[156:159], v[104:107]
  v_cndmask_b32 v68, v68, v5, s[40:41]
  v_cndmask_b32 v69, v69, v5, s[42:43]
  v_mfma_f32_16x16x32_bf16 v[112:115], a[32:35], a[160:163], v[24:27]
  v_exp_f32 v68, v68
  v_mfma_f32_16x16x32_bf16 v[112:115], a[36:39], a[164:167], v[112:115]
  buffer_load_dwordx4 v2, s[20:23], s28 offen offset:1024 sc1 lds
  ds_read_b128 a[20:23], v4 offset:13312
  v_mfma_f32_16x16x32_bf16 v[112:115], a[40:43], a[168:171], v[112:115]
  v_exp_f32 v69, v69
  v_mfma_f32_16x16x32_bf16 v[112:115], a[44:47], a[172:175], v[112:115]
  v_cndmask_b32 v70, v70, v5, s[44:45]
  v_cvt_pk_bf16_f32 v32, v64, v65
  v_mfma_f32_16x16x32_bf16 v[120:123], a[32:35], a[176:179], v[28:31]
  v_exp_f32 v70, v70
  v_mfma_f32_16x16x32_bf16 v[120:123], a[36:39], a[180:183], v[120:123]
  ds_read_b128 a[24:27], v4 offset:14336
  v_cndmask_b32 v71, v71, v5, s[46:47]
  v_mfma_f32_16x16x32_bf16 v[120:123], a[40:43], a[184:187], v[120:123]
  v_exp_f32 v71, v71
  v_mfma_f32_16x16x32_bf16 v[120:123], a[44:47], a[188:191], v[120:123]
  s_waitcnt lgkmcnt(7)
  v_cvt_pk_bf16_f32 v33, v66, v67
  v_cvt_pk_bf16_f32 v34, v68, v69
  v_mfma_f32_16x16x32_bf16 v[100:103], a[48:51], a[128:131], v[16:19]
  v_exp_f32 v72, v72
  v_mfma_f32_16x16x32_bf16 v[100:103], a[52:55], a[132:135], v[100:103]
  buffer_load_dwordx4 v2, s[20:23], s28 offen offset:2048 sc1 lds
  ds_read_b128 a[28:31], v4 offset:15360
  v_mfma_f32_16x16x32_bf16 v[100:103], a[56:59], a[136:139], v[100:103]
  v_exp_f32 v73, v73
  v_mfma_f32_16x16x32_bf16 v[100:103], a[60:63], a[140:143], v[100:103]
  v_xor_b32 v3, 0x4000, v3
  v_cvt_pk_bf16_f32 v35, v70, v71
  v_mfma_f32_16x16x32_bf16 v[108:111], a[48:51], a[144:147], v[20:23]
  v_exp_f32 v74, v74
  v_mfma_f32_16x16x32_bf16 v[108:111], a[52:55], a[148:151], v[108:111]
  ds_read_b128 a[32:35], v3 offset:0
  v_cvt_pk_bf16_f32 v36, v72, v73
  v_mfma_f32_16x16x32_bf16 v[108:111], a[56:59], a[152:155], v[108:111]
  v_exp_f32 v75, v75
  v_mfma_f32_16x16x32_bf16 v[108:111], a[60:63], a[156:159], v[108:111]
  v_cvt_pk_bf16_f32 v37, v74, v75
  v_mfma_f32_16x16x32_bf16 v[116:119], a[48:51], a[160:163], v[24:27]
  v_exp_f32 v76, v76
  v_mfma_f32_16x16x32_bf16 v[116:119], a[52:55], a[164:167], v[116:119]
  buffer_load_dwordx4 v2, s[20:23], s28 offen offset:3072 sc1 lds
  ds_read_b128 a[36:39], v3 offset:1024
  v_mfma_f32_16x16x32_bf16 v[116:119], a[56:59], a[168:171], v[116:119]
  s_xor_b32 s26, s26, 0x8000
  v_exp_f32 v77, v77
  v_mfma_f32_16x16x32_bf16 v[116:119], a[60:63], a[172:175], v[116:119]
  s_add_u32 s28, s28, 0x8000
  s_mov_b32 m0, s27
  v_cvt_pk_bf16_f32 v38, v76, v77
  v_mfma_f32_16x16x32_bf16 v[124:127], a[48:51], a[176:179], v[28:31]
  v_exp_f32 v78, v78
  v_mfma_f32_16x16x32_bf16 v[124:127], a[52:55], a[180:183], v[124:127]
  ds_read_b128 a[40:43], v3 offset:2048
  v_mfma_f32_16x16x32_bf16 v[124:127], a[56:59], a[184:187], v[124:127]
  v_exp_f32 v79, v79
  v_mfma_f32_16x16x32_bf16 v[124:127], a[60:63], a[188:191], v[124:127]
  s_waitcnt lgkmcnt(7)
  v_cvt_pk_bf16_f32 v39, v78, v79
  v_mfma_f32_16x16x32_bf16 v[128:131], a[0:3], v[48:51], v[128:131]
  buffer_load_dwordx4 v2, s[20:23], s29 offen offset:0 sc1 lds
  ds_read_b128 a[44:47], v3 offset:3072
  v_mfma_f32_16x16x32_bf16 v[160:163], a[0:3], v[52:55], v[160:163]
  v_exp_f32 v80, v80
  v_mfma_f32_16x16x32_bf16 v[192:195], a[0:3], v[56:59], v[192:195]
  v_mfma_f32_16x16x32_bf16 v[224:227], a[0:3], v[60:63], v[224:227]
  v_exp_f32 v81, v81
  v_mfma_f32_16x16x32_bf16 a[192:195], a[208:211], v[48:51], a[192:195]
  v_cvt_pk_bf16_f32 v40, v80, v81
  v_mfma_f32_16x16x32_bf16 v[132:135], a[4:7], v[48:51], v[132:135]
  v_exp_f32 v82, v82
  v_mfma_f32_16x16x32_bf16 v[164:167], a[4:7], v[52:55], v[164:167]
  ds_read_b128 a[48:51], v3 offset:4096
  v_mfma_f32_16x16x32_bf16 v[196:199], a[4:7], v[56:59], v[196:199]
  v_exp_f32 v83, v83
  v_mfma_f32_16x16x32_bf16 v[228:231], a[4:7], v[60:63], v[228:231]
  buffer_load_dwordx4 v2, s[20:23], s29 offen offset:1024 sc1 lds
  v_cvt_pk_bf16_f32 v41, v82, v83
  v_mfma_f32_16x16x32_bf16 a[196:199], a[208:211], v[52:55], a[196:199]
  v_exp_f32 v84, v84
  v_mfma_f32_16x16x32_bf16 v[136:139], a[8:11], v[48:51], v[136:139]
  ds_read_b128 a[52:55], v3 offset:5120
  v_mfma_f32_16x16x32_bf16 v[168:171], a[8:11], v[52:55], v[168:171]
  v_exp_f32 v85, v85
  v_mfma_f32_16x16x32_bf16 v[200:203], a[8:11], v[56:59], v[200:203]
  v_cvt_pk_bf16_f32 v42, v84, v85
  v_mfma_f32_16x16x32_bf16 v[232:235], a[8:11], v[60:63], v[232:235]
  v_exp_f32 v86, v86
  v_mfma_f32_16x16x32_bf16 a[200:203], a[208:211], v[56:59], a[200:203]
  v_mfma_f32_16x16x32_bf16 v[140:143], a[12:15], v[48:51], v[140:143]
  v_exp_f32 v87, v87
  v_mfma_f32_16x16x32_bf16 v[172:175], a[12:15], v[52:55], v[172:175]
  buffer_load_dwordx4 v2, s[20:23], s29 offen offset:2048 sc1 lds
  ds_read_b128 a[56:59], v3 offset:6144
  v_mfma_f32_16x16x32_bf16 v[204:207], a[12:15], v[56:59], v[204:207]
  v_exp_f32 v88, v88
  v_mfma_f32_16x16x32_bf16 v[236:239], a[12:15], v[60:63], v[236:239]
  v_cvt_pk_bf16_f32 v43, v86, v87
  v_mfma_f32_16x16x32_bf16 a[204:207], a[208:211], v[60:63], a[204:207]
  s_waitcnt lgkmcnt(7)
  v_exp_f32 v89, v89
  v_mfma_f32_16x16x32_bf16 v[144:147], a[16:19], v[48:51], v[144:147]
  ds_read_b128 a[60:63], v3 offset:7168
  v_cvt_pk_bf16_f32 v44, v88, v89
  v_mfma_f32_16x16x32_bf16 v[176:179], a[16:19], v[52:55], v[176:179]
  v_exp_f32 v90, v90
  v_mfma_f32_16x16x32_bf16 v[208:211], a[16:19], v[56:59], v[208:211]
  v_mfma_f32_16x16x32_bf16 v[240:243], a[16:19], v[60:63], v[240:243]
  v_exp_f32 v91, v91
  v_mfma_f32_16x16x32_bf16 v[148:151], a[20:23], v[48:51], v[148:151]
  buffer_load_dwordx4 v2, s[20:23], s29 offen offset:3072 sc1 lds
  v_xor_b32 v4, 0x8000, v4
  v_mfma_f32_16x16x32_bf16 v[180:183], a[20:23], v[52:55], v[180:183]
  s_xor_b32 s27, s27, 0x4000
  v_exp_f32 v92, v92
  v_mfma_f32_16x16x32_bf16 v[212:215], a[20:23], v[56:59], v[212:215]
  s_add_u32 s29, s29, 0x8000
  ds_read_b128 a[0:3], v4 offset:0
  v_cvt_pk_bf16_f32 v45, v90, v91
  v_mfma_f32_16x16x32_bf16 v[244:247], a[20:23], v[60:63], v[244:247]
  v_exp_f32 v93, v93
  v_mfma_f32_16x16x32_bf16 v[152:155], a[24:27], v[48:51], v[152:155]
  ds_read_b128 a[4:7], v4 offset:1024
  v_cvt_pk_bf16_f32 v46, v92, v93
  v_mfma_f32_16x16x32_bf16 v[184:187], a[24:27], v[52:55], v[184:187]
  v_exp_f32 v94, v94
  v_mfma_f32_16x16x32_bf16 v[216:219], a[24:27], v[56:59], v[216:219]
  v_mfma_f32_16x16x32_bf16 v[248:251], a[24:27], v[60:63], v[248:251]
  v_exp_f32 v95, v95
  v_mfma_f32_16x16x32_bf16 v[156:159], a[28:31], v[48:51], v[156:159]
  ds_read_b128 a[8:11], v4 offset:2048
  v_cvt_pk_bf16_f32 v47, v94, v95
  v_mfma_f32_16x16x32_bf16 v[188:191], a[28:31], v[52:55], v[188:191]
  v_mfma_f32_16x16x32_bf16 v[220:223], a[28:31], v[56:59], v[220:223]
  v_mfma_f32_16x16x32_bf16 v[252:255], a[28:31], v[60:63], v[252:255]
La_d1:
  s_waitcnt lgkmcnt(7)
  v_mfma_f32_16x16x32_bf16 v[72:75], a[32:35], a[144:147], v[20:23]
  buffer_load_dwordx4 a[64:67], v2, s[8:11], s6 offen offset:0
  ds_read_b128 a[12:15], v4 offset:3072
  v_mfma_f32_16x16x32_bf16 v[72:75], a[36:39], a[148:151], v[72:75]
  v_cndmask_b32 v96, v96, v5, s[48:49]
  v_exp_f32 v96, v96
  v_mfma_f32_16x16x32_bf16 v[72:75], a[40:43], a[152:155], v[72:75]
  v_cndmask_b32 v97, v97, v5, s[50:51]
  v_exp_f32 v97, v97
  v_mfma_f32_16x16x32_bf16 v[72:75], a[44:47], a[156:159], v[72:75]
  v_cndmask_b32 v98, v98, v5, s[52:53]
  v_exp_f32 v98, v98
  v_mfma_f32_16x16x32_bf16 v[80:83], a[32:35], a[160:163], v[24:27]
  ds_read_b128 a[16:19], v4 offset:4096
  v_cndmask_b32 v99, v99, v5, s[54:55]
  v_mfma_f32_16x16x32_bf16 v[80:83], a[36:39], a[164:167], v[80:83]
  v_exp_f32 v99, v99
  v_mfma_f32_16x16x32_bf16 v[80:83], a[40:43], a[168:171], v[80:83]
  buffer_load_dwordx4 a[64:67], v2, s[8:11], s6 offen offset:1024
  ds_read_b128 a[20:23], v4 offset:5120
  v_mfma_f32_16x16x32_bf16 v[80:83], a[44:47], a[172:175], v[80:83]
  v_cndmask_b32 v100, v100, v5, s[56:57]
  v_exp_f32 v100, v100
  v_mfma_f32_16x16x32_bf16 v[88:91], a[32:35], a[176:179], v[28:31]
  v_cndmask_b32 v101, v101, v5, s[58:59]
  v_cndmask_b32 v102, v102, v5, s[60:61]
  v_mfma_f32_16x16x32_bf16 v[88:91], a[36:39], a[180:183], v[88:91]
  v_exp_f32 v101, v101
  v_mfma_f32_16x16x32_bf16 v[88:91], a[40:43], a[184:187], v[88:91]
  v_exp_f32 v102, v102
  v_mfma_f32_16x16x32_bf16 v[88:91], a[44:47], a[188:191], v[88:91]
  s_waitcnt lgkmcnt(6)
  buffer_load_dwordx4 a[64:67], v2, s[8:11], s6 offen offset:2048
  ds_read_b128 a[24:27], v4 offset:6144
  v_mfma_f32_16x16x32_bf16 v[76:79], a[48:51], a[144:147], v[20:23]
  v_cndmask_b32 v103, v103, v5, s[62:63]
  v_exp_f32 v103, v103
  v_mfma_f32_16x16x32_bf16 v[76:79], a[52:55], a[148:151], v[76:79]
  ds_read_b128 a[28:31], v4 offset:7168
  v_cvt_pk_bf16_f32 v48, v96, v97
  v_mfma_f32_16x16x32_bf16 v[76:79], a[56:59], a[152:155], v[76:79]
  v_exp_f32 v104, v104
  v_mfma_f32_16x16x32_bf16 v[76:79], a[60:63], a[156:159], v[76:79]
  ds_read_b128 a[32:35], v3 offset:8192
  v_cvt_pk_bf16_f32 v49, v98, v99
  v_mfma_f32_16x16x32_bf16 v[84:87], a[48:51], a[160:163], v[24:27]
  v_exp_f32 v105, v105
  v_mfma_f32_16x16x32_bf16 v[84:87], a[52:55], a[164:167], v[84:87]
  buffer_load_dwordx4 a[64:67], v2, s[8:11], s6 offen offset:3072
  v_cvt_pk_bf16_f32 v50, v100, v101
  v_mfma_f32_16x16x32_bf16 v[84:87], a[56:59], a[168:171], v[84:87]
  s_add_u32 s6, s6, 4096
  v_exp_f32 v106, v106
  v_mfma_f32_16x16x32_bf16 v[84:87], a[60:63], a[172:175], v[84:87]
  v_exp_f32 v107, v107
  v_mfma_f32_16x16x32_bf16 v[92:95], a[48:51], a[176:179], v[28:31]
  ds_read_b128 a[36:39], v3 offset:9216
  v_cvt_pk_bf16_f32 v51, v102, v103
  v_mfma_f32_16x16x32_bf16 v[92:95], a[52:55], a[180:183], v[92:95]
  v_exp_f32 v108, v108
  v_mfma_f32_16x16x32_bf16 v[92:95], a[56:59], a[184:187], v[92:95]
  buffer_load_dwordx4 a[64:67], v2, s[8:11], s6 offen offset:0
  ds_read_b128 a[40:43], v3 offset:10240
  v_mfma_f32_16x16x32_bf16 v[92:95], a[60:63], a[188:191], v[92:95]
  s_waitcnt lgkmcnt(7)
  v_exp_f32 v109, v109
  v_mfma_f32_16x16x32_bf16 v[128:131], a[0:3], v[32:35], v[128:131]
  ds_read_b128 a[44:47], v3 offset:11264
  v_cvt_pk_bf16_f32 v52, v104, v105
  v_mfma_f32_16x16x32_bf16 v[160:163], a[0:3], v[36:39], v[160:163]
  v_exp_f32 v110, v110
  v_mfma_f32_16x16x32_bf16 v[192:195], a[0:3], v[40:43], v[192:195]
  v_cvt_pk_bf16_f32 v53, v106, v107
  v_cvt_pk_bf16_f32 v54, v108, v109
  v_mfma_f32_16x16x32_bf16 v[224:227], a[0:3], v[44:47], v[224:227]
  v_exp_f32 v111, v111
  v_mfma_f32_16x16x32_bf16 a[192:195], a[208:211], v[32:35], a[192:195]
  buffer_load_dwordx4 a[64:67], v2, s[8:11], s6 offen offset:1024
  v_cvt_pk_bf16_f32 v55, v110, v111
  v_mfma_f32_16x16x32_bf16 v[132:135], a[4:7], v[32:35], v[132:135]
  v_exp_f32 v112, v112
  v_mfma_f32_16x16x32_bf16 v[164:167], a[4:7], v[36:39], v[164:167]
  v_exp_f32 v113, v113
  v_mfma_f32_16x16x32_bf16 v[196:199], a[4:7], v[40:43], v[196:199]
  ds_read_b128 a[48:51], v3 offset:12288
  v_cvt_pk_bf16_f32 v56, v112, v113
  v_mfma_f32_16x16x32_bf16 v[228:231], a[4:7], v[44:47], v[228:231]
  v_exp_f32 v114, v114
  v_mfma_f32_16x16x32_bf16 a[196:199], a[208:211], v[36:39], a[196:199]
  buffer_load_dwordx4 a[64:67], v2, s[8:11], s6 offen offset:2048
  v_mfma_f32_16x16x32_bf16 v[136:139], a[8:11], v[32:35], v[136:139]
  v_exp_f32 v115, v115
  v_mfma_f32_16x16x32_bf16 v[168:171], a[8:11], v[36:39], v[168:171]
  ds_read_b128 a[52:55], v3 offset:13312
  v_cvt_pk_bf16_f32 v57, v114, v115
  v_mfma_f32_16x16x32_bf16 v[200:203], a[8:11], v[40:43], v[200:203]
  v_exp_f32 v116, v116
  v_mfma_f32_16x16x32_bf16 v[232:235], a[8:11], v[44:47], v[232:235]
  v_mfma_f32_16x16x32_bf16 a[200:203], a[208:211], v[40:43], a[200:203]
  v_exp_f32 v117, v117
  v_mfma_f32_16x16x32_bf16 v[140:143], a[12:15], v[32:35], v[140:143]
  v_exp_f32 v118, v118
  v_mfma_f32_16x16x32_bf16 v[172:175], a[12:15], v[36:39], v[172:175]
  buffer_load_dwordx4 a[64:67], v2, s[8:11], s6 offen offset:3072
  ds_read_b128 a[56:59], v3 offset:14336
  v_mfma_f32_16x16x32_bf16 v[204:207], a[12:15], v[40:43], v[204:207]
  v_exp_f32 v119, v119
  v_mfma_f32_16x16x32_bf16 v[236:239], a[12:15], v[44:47], v[236:239]
  v_cvt_pk_bf16_f32 v58, v116, v117
  v_cvt_pk_bf16_f32 v59, v118, v119
  v_mfma_f32_16x16x32_bf16 a[204:207], a[208:211], v[44:47], a[204:207]
  s_waitcnt lgkmcnt(7)
  v_exp_f32 v120, v120
  v_mfma_f32_16x16x32_bf16 v[144:147], a[16:19], v[32:35], v[144:147]
  buffer_load_dwordx4 a[64:67], v2, s[12:15], s7 offen offset:0
  ds_read_b128 a[60:63], v3 offset:15360
  v_mfma_f32_16x16x32_bf16 v[176:179], a[16:19], v[36:39], v[176:179]
  v_exp_f32 v121, v121
  v_mfma_f32_16x16x32_bf16 v[208:211], a[16:19], v[40:43], v[208:211]
  v_cvt_pk_bf16_f32 v60, v120, v121
  v_mfma_f32_16x16x32_bf16 v[240:243], a[16:19], v[44:47], v[240:243]
  v_exp_f32 v122, v122
  v_mfma_f32_16x16x32_bf16 v[148:151], a[20:23], v[32:35], v[148:151]
  v_exp_f32 v123, v123
  v_mfma_f32_16x16x32_bf16 v[180:183], a[20:23], v[36:39], v[180:183]
  ds_read_b128 a[0:3], v4 offset:8192
  v_cvt_pk_bf16_f32 v61, v122, v123
  v_mfma_f32_16x16x32_bf16 v[212:215], a[20:23], v[40:43], v[212:215]
  v_exp_f32 v124, v124
  v_mfma_f32_16x16x32_bf16 v[244:247], a[20:23], v[44:47], v[244:247]
  buffer_load_dwordx4 a[64:67], v2, s[12:15], s7 offen offset:1024
  v_mfma_f32_16x16x32_bf16 v[152:155], a[24:27], v[32:35], v[152:155]
  v_exp_f32 v125, v125
  v_mfma_f32_16x16x32_bf16 v[184:187], a[24:27], v[36:39], v[184:187]
  ds_read_b128 a[4:7], v4 offset:9216
  v_cvt_pk_bf16_f32 v62, v124, v125
  v_mfma_f32_16x16x32_bf16 v[216:219], a[24:27], v[40:43], v[216:219]
  v_exp_f32 v126, v126
  v_mfma_f32_16x16x32_bf16 v[248:251], a[24:27], v[44:47], v[248:251]
  v_mfma_f32_16x16x32_bf16 v[156:159], a[28:31], v[32:35], v[156:159]
  v_exp_f32 v127, v127
  v_mfma_f32_16x16x32_bf16 v[188:191], a[28:31], v[36:39], v[188:191]
  ds_read_b128 a[8:11], v4 offset:10240
  v_cvt_pk_bf16_f32 v63, v126, v127
  v_mfma_f32_16x16x32_bf16 v[220:223], a[28:31], v[40:43], v[220:223]
  s_waitcnt vmcnt(22)
  s_barrier
  v_mfma_f32_16x16x32_bf16 v[252:255], a[28:31], v[44:47], v[252:255]
  s_waitcnt lgkmcnt(7)
  v_mfma_f32_16x16x32_bf16 v[104:107], a[32:35], a[144:147], v[20:23]
  s_mov_b32 m0, s26
  ds_read_b128 a[12:15], v4 offset:11264
  v_cndmask_b32 v72, v72, v5, s[32:33]
  v_mfma_f32_16x16x32_bf16 v[104:107], a[36:39], a[148:151], v[104:107]
  v_exp_f32 v72, v72
  v_mfma_f32_16x16x32_bf16 v[104:107], a[40:43], a[152:155], v[104:107]
  v_cndmask_b32 v73, v73, v5, s[34:35]
  v_exp_f32 v73, v73
  v_mfma_f32_16x16x32_bf16 v[104:107], a[44:47], a[156:159], v[104:107]
  buffer_load_dwordx4 v2, s[20:23], s28 offen offset:0 sc1 lds
  ds_read_b128 a[16:19], v4 offset:12288
  v_mfma_f32_16x16x32_bf16 v[112:115], a[32:35], a[160:163], v[24:27]
  v_cndmask_b32 v74, v74, v5, s[36:37]
  v_exp_f32 v74, v74
  v_mfma_f32_16x16x32_bf16 v[112:115], a[36:39], a[164:167], v[112:115]
  v_cvt_pk_bf16_f32 v36, v72, v73
  v_mfma_f32_16x16x32_bf16 v[112:115], a[40:43], a[168:171], v[112:115]
  ds_read_b128 a[20:23], v4 offset:13312
  v_cndmask_b32 v75, v75, v5, s[38:39]
  v_mfma_f32_16x16x32_bf16 v[112:115], a[44:47], a[172:175], v[112:115]
  v_exp_f32 v75, v75
  v_mfma_f32_16x16x32_bf16 v[120:123], a[32:35], a[176:179], v[28:31]
  buffer_load_dwordx4 v2, s[20:23], s28 offen offset:1024 sc1 lds
  v_cndmask_b32 v76, v76, v5, s[40:41]
  v_mfma_f32_16x16x32_bf16 v[120:123], a[36:39], a[180:183], v[120:123]
  v_exp_f32 v76, v76
  v_mfma_f32_16x16x32_bf16 v[120:123], a[40:43], a[184:187], v[120:123]
  ds_read_b128 a[24:27], v4 offset:14336
  v_cndmask_b32 v79, v79, v5, s[46:47]
  v_mfma_f32_16x16x32_bf16 v[120:123], a[44:47], a[188:191], v[120:123]
  s_waitcnt lgkmcnt(7)
  v_cndmask_b32 v77, v77, v5, s[42:43]
  v_cndmask_b32 v78, v78, v5, s[44:45]
  v_mfma_f32_16x16x32_bf16 v[108:111], a[48:51], a[144:147], v[20:23]
  v_exp_f32 v77, v77
  v_mfma_f32_16x16x32_bf16 v[108:111], a[52:55], a[148:151], v[108:111]
  ds_read_b128 a[28:31], v4 offset:15360
  v_xor_b32 v4, 0x4000, v4
  v_mfma_f32_16x16x32_bf16 v[108:111], a[56:59], a[152:155], v[108:111]
  v_exp_f32 v78, v78
  v_mfma_f32_16x16x32_bf16 v[108:111], a[60:63], a[156:159], v[108:111]
  buffer_load_dwordx4 v2, s[20:23], s28 offen offset:2048 sc1 lds
  v_xor_b32 v3, 0x8000, v3
  v_mfma_f32_16x16x32_bf16 v[116:119], a[48:51], a[160:163], v[24:27]
  v_exp_f32 v79, v79
  v_mfma_f32_16x16x32_bf16 v[116:119], a[52:55], a[164:167], v[116:119]
  ds_read_b128 a[32:35], v3 offset:0
  v_cvt_pk_bf16_f32 v37, v74, v75
  v_mfma_f32_16x16x32_bf16 v[116:119], a[56:59], a[168:171], v[116:119]
  ds_read_b128 a[36:39], v3 offset:1024
  v_cvt_pk_bf16_f32 v38, v76, v77
  v_mfma_f32_16x16x32_bf16 v[116:119], a[60:63], a[172:175], v[116:119]
  v_exp_f32 v80, v80
  v_mfma_f32_16x16x32_bf16 v[124:127], a[48:51], a[176:179], v[28:31]
  v_cvt_pk_bf16_f32 v39, v78, v79
  v_mfma_f32_16x16x32_bf16 v[124:127], a[52:55], a[180:183], v[124:127]
  v_exp_f32 v81, v81
  v_mfma_f32_16x16x32_bf16 v[124:127], a[56:59], a[184:187], v[124:127]
  buffer_load_dwordx4 v2, s[20:23], s28 offen offset:3072 sc1 lds
  ds_read_b128 a[40:43], v3 offset:2048
  v_mfma_f32_16x16x32_bf16 v[124:127], a[60:63], a[188:191], v[124:127]
  s_waitcnt lgkmcnt(7)
  s_xor_b32 s26, s26, 0x4000
  s_add_u32 s28, s28, 0x8000
  v_mfma_f32_16x16x32_bf16 v[128:131], a[0:3], v[48:51], v[128:131]
  s_mov_b32 m0, s27
  v_exp_f32 v82, v82
  v_mfma_f32_16x16x32_bf16 v[160:163], a[0:3], v[52:55], v[160:163]
  ds_read_b128 a[44:47], v3 offset:3072
  v_cvt_pk_bf16_f32 v40, v80, v81
  v_mfma_f32_16x16x32_bf16 v[192:195], a[0:3], v[56:59], v[192:195]
  v_exp_f32 v83, v83
  v_mfma_f32_16x16x32_bf16 v[224:227], a[0:3], v[60:63], v[224:227]
  v_cvt_pk_bf16_f32 v41, v82, v83
  v_mfma_f32_16x16x32_bf16 a[192:195], a[208:211], v[48:51], a[192:195]
  buffer_load_dwordx4 v2, s[20:23], s29 offen offset:0 sc1 lds
  v_mfma_f32_16x16x32_bf16 v[132:135], a[4:7], v[48:51], v[132:135]
  v_exp_f32 v84, v84
  v_mfma_f32_16x16x32_bf16 v[164:167], a[4:7], v[52:55], v[164:167]
  ds_read_b128 a[48:51], v3 offset:4096
  v_mfma_f32_16x16x32_bf16 v[196:199], a[4:7], v[56:59], v[196:199]
  v_exp_f32 v85, v85
  v_mfma_f32_16x16x32_bf16 v[228:231], a[4:7], v[60:63], v[228:231]
  v_cvt_pk_bf16_f32 v42, v84, v85
  v_mfma_f32_16x16x32_bf16 a[196:199], a[208:211], v[52:55], a[196:199]
  v_exp_f32 v86, v86
  v_mfma_f32_16x16x32_bf16 v[136:139], a[8:11], v[48:51], v[136:139]
  ds_read_b128 a[52:55], v3 offset:5120
  v_mfma_f32_16x16x32_bf16 v[168:171], a[8:11], v[52:55], v[168:171]
  buffer_load_dwordx4 v2, s[20:23], s29 offen offset:1024 sc1 lds
  v_mfma_f32_16x16x32_bf16 v[200:203], a[8:11], v[56:59], v[200:203]
  v_exp_f32 v87, v87
  v_mfma_f32_16x16x32_bf16 v[232:235], a[8:11], v[60:63], v[232:235]
  v_cvt_pk_bf16_f32 v43, v86, v87
  v_mfma_f32_16x16x32_bf16 a[200:203], a[208:211], v[56:59], a[200:203]
  v_exp_f32 v88, v88
  v_mfma_f32_16x16x32_bf16 v[140:143], a[12:15], v[48:51], v[140:143]
  ds_read_b128 a[56:59], v3 offset:6144
  v_mfma_f32_16x16x32_bf16 v[172:175], a[12:15], v[52:55], v[172:175]
  v_mfma_f32_16x16x32_bf16 v[204:207], a[12:15], v[56:59], v[204:207]
  v_exp_f32 v89, v89
  v_mfma_f32_16x16x32_bf16 v[236:239], a[12:15], v[60:63], v[236:239]
  buffer_load_dwordx4 v2, s[20:23], s29 offen offset:2048 sc1 lds
  v_cvt_pk_bf16_f32 v44, v88, v89
  v_mfma_f32_16x16x32_bf16 a[204:207], a[208:211], v[60:63], a[204:207]
  s_waitcnt lgkmcnt(7)
  v_exp_f32 v90, v90
  v_mfma_f32_16x16x32_bf16 v[144:147], a[16:19], v[48:51], v[144:147]
  ds_read_b128 a[60:63], v3 offset:7168
  v_mfma_f32_16x16x32_bf16 v[176:179], a[16:19], v[52:55], v[176:179]
  v_exp_f32 v91, v91
  v_mfma_f32_16x16x32_bf16 v[208:211], a[16:19], v[56:59], v[208:211]
  v_cvt_pk_bf16_f32 v45, v90, v91
  v_mfma_f32_16x16x32_bf16 v[240:243], a[16:19], v[60:63], v[240:243]
  v_mfma_f32_16x16x32_bf16 v[148:151], a[20:23], v[48:51], v[148:151]
  v_exp_f32 v92, v92
  v_mfma_f32_16x16x32_bf16 v[180:183], a[20:23], v[52:55], v[180:183]
  buffer_load_dwordx4 v2, s[20:23], s29 offen offset:3072 sc1 lds
  ds_read_b128 a[0:3], v3 offset:8192
  v_mfma_f32_16x16x32_bf16 v[212:215], a[20:23], v[56:59], v[212:215]
  s_xor_b32 s27, s27, 0x8000
  v_exp_f32 v93, v93
  v_mfma_f32_16x16x32_bf16 v[244:247], a[20:23], v[60:63], v[244:247]
  s_add_u32 s29, s29, 0x8000
  v_cvt_pk_bf16_f32 v46, v92, v93
  v_mfma_f32_16x16x32_bf16 v[152:155], a[24:27], v[48:51], v[152:155]
  ds_read_b128 a[4:7], v3 offset:9216
  v_mfma_f32_16x16x32_bf16 v[184:187], a[24:27], v[52:55], v[184:187]
  v_exp_f32 v94, v94
  v_mfma_f32_16x16x32_bf16 v[216:219], a[24:27], v[56:59], v[216:219]
  v_mfma_f32_16x16x32_bf16 v[248:251], a[24:27], v[60:63], v[248:251]
  v_exp_f32 v95, v95
  v_mfma_f32_16x16x32_bf16 v[156:159], a[28:31], v[48:51], v[156:159]
  ds_read_b128 a[8:11], v3 offset:10240
  v_cvt_pk_bf16_f32 v47, v94, v95
  v_mfma_f32_16x16x32_bf16 v[188:191], a[28:31], v[52:55], v[188:191]
  v_mfma_f32_16x16x32_bf16 v[220:223], a[28:31], v[56:59], v[220:223]
  s_waitcnt vmcnt(22)
  s_barrier
  v_mfma_f32_16x16x32_bf16 v[252:255], a[28:31], v[60:63], v[252:255]
  s_lshl_b32 s91, s73, 11
  s_add_u32 s91, s91, 32768
  v_and_b32 v14, 15, v1
  v_lshlrev_b32 v14, 7, v14
  s_waitcnt lgkmcnt(3)
  v_mfma_f32_16x16x32_bf16 v[64:67], a[32:35], a[160:163], v[24:27]
  s_mov_b32 m0, s26
  ds_read_b128 a[12:15], v3 offset:11264
  v_cndmask_b32 v104, v104, v5, s[48:49]
  v_mfma_f32_16x16x32_bf16 v[64:67], a[36:39], a[164:167], v[64:67]
  v_exp_f32 v104, v104
  v_mfma_f32_16x16x32_bf16 v[64:67], a[40:43], a[168:171], v[64:67]
  v_cndmask_b32 v105, v105, v5, s[50:51]
  v_exp_f32 v105, v105
  v_mfma_f32_16x16x32_bf16 v[64:67], a[44:47], a[172:175], v[64:67]
  buffer_load_dwordx4 v2, s[20:23], s28 offen offset:0 sc1 lds
  ds_read_b128 a[16:19], v3 offset:12288
  v_mfma_f32_16x16x32_bf16 v[72:75], a[32:35], a[176:179], v[28:31]
  v_cndmask_b32 v106, v106, v5, s[52:53]
  v_exp_f32 v106, v106
  v_mfma_f32_16x16x32_bf16 v[72:75], a[36:39], a[180:183], v[72:75]
  ds_read_b128 a[20:23], v3 offset:13312
  v_cndmask_b32 v107, v107, v5, s[54:55]
  v_mfma_f32_16x16x32_bf16 v[72:75], a[40:43], a[184:187], v[72:75]
  buffer_load_dwordx4 v2, s[20:23], s28 offen offset:1024 sc1 lds
  ds_read_b128 a[24:27], v3 offset:14336
  v_mfma_f32_16x16x32_bf16 v[72:75], a[44:47], a[188:191], v[72:75]
  v_exp_f32 v107, v107
  v_mfma_f32_16x16x32_bf16 v[68:71], a[48:51], a[160:163], v[24:27]
  ds_read_b128 a[28:31], v3 offset:15360
  v_cndmask_b32 v108, v108, v5, s[56:57]
  v_mfma_f32_16x16x32_bf16 v[68:71], a[52:55], a[164:167], v[68:71]
  v_exp_f32 v108, v108
  v_mfma_f32_16x16x32_bf16 v[68:71], a[56:59], a[168:171], v[68:71]
  ds_read_b128 a[32:35], v4 offset:0
  v_cndmask_b32 v109, v109, v5, s[58:59]
  v_mfma_f32_16x16x32_bf16 v[68:71], a[60:63], a[172:175], v[68:71]
  v_exp_f32 v109, v109
  v_mfma_f32_16x16x32_bf16 v[76:79], a[48:51], a[176:179], v[28:31]
  ds_read_b128 a[36:39], v4 offset:1024
  v_cvt_pk_bf16_f32 v52, v104, v105
  v_mfma_f32_16x16x32_bf16 v[76:79], a[52:55], a[180:183], v[76:79]
  buffer_load_dwordx4 v2, s[20:23], s28 offen offset:2048 sc1 lds
  v_cndmask_b32 v110, v110, v5, s[60:61]
  v_mfma_f32_16x16x32_bf16 v[76:79], a[56:59], a[184:187], v[76:79]
  v_exp_f32 v110, v110
  v_mfma_f32_16x16x32_bf16 v[76:79], a[60:63], a[188:191], v[76:79]
  s_waitcnt lgkmcnt(2)
  ds_read_b128 a[40:43], v4 offset:2048
  v_cndmask_b32 v111, v111, v5, s[62:63]
  v_mfma_f32_16x16x32_bf16 v[80:83], a[0:3], a[160:163], v[24:27]
  v_exp_f32 v111, v111
  v_mfma_f32_16x16x32_bf16 v[80:83], a[4:7], a[164:167], v[80:83]
  ds_read_b128 a[44:47], v4 offset:3072
  v_cvt_pk_bf16_f32 v53, v106, v107
  v_mfma_f32_16x16x32_bf16 v[80:83], a[8:11], a[168:171], v[80:83]
  ds_read_b128 a[48:51], v4 offset:4096
  v_cvt_pk_bf16_f32 v54, v108, v109
  v_mfma_f32_16x16x32_bf16 v[80:83], a[12:15], a[172:175], v[80:83]
  v_exp_f32 v112, v112
  v_mfma_f32_16x16x32_bf16 v[88:91], a[0:3], a[176:179], v[28:31]
  buffer_load_dwordx4 v2, s[20:23], s28 offen offset:3072 sc1 lds
  ds_read_b128 a[52:55], v4 offset:5120
  v_mfma_f32_16x16x32_bf16 v[88:91], a[4:7], a[180:183], v[88:91]
  s_xor_b32 s26, s26, 0x8000
  v_exp_f32 v113, v113
  v_mfma_f32_16x16x32_bf16 v[88:91], a[8:11], a[184:187], v[88:91]
  s_add_u32 s28, s28, 0x8000
  s_mov_b32 m0, s27
  ds_read_b128 a[56:59], v4 offset:6144
  v_mfma_f32_16x16x32_bf16 v[88:91], a[12:15], a[188:191], v[88:91]
  v_exp_f32 v114, v114
  v_mfma_f32_16x16x32_bf16 v[84:87], a[16:19], a[160:163], v[24:27]
  ds_read_b128 a[60:63], v4 offset:7168
  v_cvt_pk_bf16_f32 v55, v110, v111
  v_mfma_f32_16x16x32_bf16 v[84:87], a[20:23], a[164:167], v[84:87]
  v_xor_b32 v3, 0x4000, v3
  v_cvt_pk_bf16_f32 v56, v112, v113
  v_mfma_f32_16x16x32_bf16 v[84:87], a[24:27], a[168:171], v[84:87]
  v_exp_f32 v115, v115
  v_mfma_f32_16x16x32_bf16 v[84:87], a[28:31], a[172:175], v[84:87]
  buffer_load_dwordx4 v2, s[20:23], s29 offen offset:0 sc1 lds
  ds_read_b128 a[0:3], v3 offset:0
  v_mfma_f32_16x16x32_bf16 v[92:95], a[16:19], a[176:179], v[28:31]
  v_exp_f32 v116, v116
  v_mfma_f32_16x16x32_bf16 v[92:95], a[20:23], a[180:183], v[92:95]
  ds_read_b128 a[4:7], v3 offset:1024
  v_cvt_pk_bf16_f32 v57, v114, v115
  v_mfma_f32_16x16x32_bf16 v[92:95], a[24:27], a[184:187], v[92:95]
  v_exp_f32 v117, v117
  v_mfma_f32_16x16x32_bf16 v[92:95], a[28:31], a[188:191], v[92:95]
  s_waitcnt lgkmcnt(6)
  ds_read_b128 a[8:11], v3 offset:2048
  v_cvt_pk_bf16_f32 v58, v116, v117
  v_mfma_f32_16x16x32_bf16 v[160:163], a[32:35], v[36:39], v[160:163]
  ds_read_b128 a[12:15], v3 offset:3072
  v_mfma_f32_16x16x32_bf16 v[192:195], a[32:35], v[40:43], v[192:195]
  v_exp_f32 v118, v118
  v_mfma_f32_16x16x32_bf16 v[224:227], a[32:35], v[44:47], v[224:227]
  buffer_load_dwordx4 v2, s[20:23], s29 offen offset:1024 sc1 lds
  v_mfma_f32_16x16x32_bf16 a[196:199], a[208:211], v[36:39], a[196:199]
  v_exp_f32 v119, v119
  v_mfma_f32_16x16x32_bf16 v[164:167], a[36:39], v[36:39], v[164:167]
  ds_read_b128 a[16:19], v3 offset:4096
  v_cvt_pk_bf16_f32 v59, v118, v119
  v_mfma_f32_16x16x32_bf16 v[196:199], a[36:39], v[40:43], v[196:199]
  v_mfma_f32_16x16x32_bf16 v[228:231], a[36:39], v[44:47], v[228:231]
  v_exp_f32 v120, v120
  v_mfma_f32_16x16x32_bf16 a[200:203], a[208:211], v[40:43], a[200:203]
  v_mfma_f32_16x16x32_bf16 v[168:171], a[40:43], v[36:39], v[168:171]
  v_exp_f32 v121, v121
  v_mfma_f32_16x16x32_bf16 v[200:203], a[40:43], v[40:43], v[200:203]
  buffer_load_dwordx4 v2, s[20:23], s29 offen offset:2048 sc1 lds
  ds_read_b128 a[20:23], v3 offset:5120
  v_mfma_f32_16x16x32_bf16 v[232:235], a[40:43], v[44:47], v[232:235]
  v_exp_f32 v122, v122
  v_mfma_f32_16x16x32_bf16 a[204:207], a[208:211], v[44:47], a[204:207]
  v_cvt_pk_bf16_f32 v60, v120, v121
  v_mfma_f32_16x16x32_bf16 v[172:175], a[44:47], v[36:39], v[172:175]
  ds_read_b128 a[24:27], v3 offset:6144
  v_mfma_f32_16x16x32_bf16 v[204:207], a[44:47], v[40:43], v[204:207]
  v_exp_f32 v123, v123
  v_mfma_f32_16x16x32_bf16 v[236:239], a[44:47], v[44:47], v[236:239]
  s_waitcnt lgkmcnt(7)
  v_cvt_pk_bf16_f32 v61, v122, v123
  v_mfma_f32_16x16x32_bf16 v[176:179], a[48:51], v[36:39], v[176:179]
  v_exp_f32 v124, v124
  v_mfma_f32_16x16x32_bf16 v[208:211], a[48:51], v[40:43], v[208:211]
  buffer_load_dwordx4 v2, s[20:23], s29 offen offset:3072 sc1 lds
  ds_read_b128 a[28:31], v3 offset:7168
  v_mfma_f32_16x16x32_bf16 v[240:243], a[48:51], v[44:47], v[240:243]
  s_xor_b32 s27, s27, 0x4000
  v_exp_f32 v125, v125
  v_mfma_f32_16x16x32_bf16 v[180:183], a[52:55], v[36:39], v[180:183]
  s_add_u32 s29, s29, 0x8000
  ds_read_b128 a[32:35], v3 offset:8192
  v_cvt_pk_bf16_f32 v62, v124, v125
  v_mfma_f32_16x16x32_bf16 v[212:215], a[52:55], v[40:43], v[212:215]
  v_mfma_f32_16x16x32_bf16 v[244:247], a[52:55], v[44:47], v[244:247]
  v_exp_f32 v126, v126
  v_mfma_f32_16x16x32_bf16 v[184:187], a[56:59], v[36:39], v[184:187]
  ds_read_b128 a[36:39], v3 offset:9216
  v_mfma_f32_16x16x32_bf16 v[216:219], a[56:59], v[40:43], v[216:219]
  v_exp_f32 v127, v127
  v_mfma_f32_16x16x32_bf16 v[248:251], a[56:59], v[44:47], v[248:251]
  v_cvt_pk_bf16_f32 v63, v126, v127
  v_mfma_f32_16x16x32_bf16 v[188:191], a[60:63], v[36:39], v[188:191]
  ds_read_b128 a[40:43], v3 offset:10240
  v_mfma_f32_16x16x32_bf16 v[220:223], a[60:63], v[40:43], v[220:223]
  s_waitcnt vmcnt(12)
  s_barrier
  v_mfma_f32_16x16x32_bf16 v[252:255], a[60:63], v[44:47], v[252:255]
  s_cmp_eq_u32 s25, 7
  s_cbranch_scc1 La_t7
  s_waitcnt lgkmcnt(3)
  v_mfma_f32_16x16x32_bf16 v[96:99], a[0:3], a[160:163], v[24:27]
  s_mov_b32 m0, s26
  v_exp_f32 v64, v64
  v_mfma_f32_16x16x32_bf16 v[96:99], a[4:7], a[164:167], v[96:99]
  v_exp_f32 v65, v65
  v_mfma_f32_16x16x32_bf16 v[96:99], a[8:11], a[168:171], v[96:99]
  buffer_load_dwordx4 v2, s[20:23], s28 offen offset:0 sc1 lds
  ds_read_b128 a[44:47], v3 offset:11264
  v_mfma_f32_16x16x32_bf16 v[96:99], a[12:15], a[172:175], v[96:99]
  v_exp_f32 v66, v66
  v_mfma_f32_16x16x32_bf16 v[104:107], a[0:3], a[176:179], v[28:31]
  ds_read_b128 a[48:51], v3 offset:12288
  ds_read_b128 a[52:55], v3 offset:13312
  v_mfma_f32_16x16x32_bf16 v[104:107], a[4:7], a[180:183], v[104:107]
  v_exp_f32 v67, v67
  v_mfma_f32_16x16x32_bf16 v[104:107], a[8:11], a[184:187], v[104:107]
  ds_read_b128 a[56:59], v3 offset:14336
  v_cvt_pk_bf16_f32 v32, v64, v65
  v_mfma_f32_16x16x32_bf16 v[104:107], a[12:15], a[188:191], v[104:107]
  v_exp_f32 v68, v68
  v_mfma_f32_16x16x32_bf16 v[100:103], a[16:19], a[160:163], v[24:27]
  v_exp_f32 v69, v69
  v_mfma_f32_16x16x32_bf16 v[100:103], a[20:23], a[164:167], v[100:103]
  ds_read_b128 a[60:63], v3 offset:15360
  v_cvt_pk_bf16_f32 v33, v66, v67
  v_mfma_f32_16x16x32_bf16 v[100:103], a[24:27], a[168:171], v[100:103]
  v_exp_f32 v70, v70
  v_mfma_f32_16x16x32_bf16 v[100:103], a[28:31], a[172:175], v[100:103]
  ds_read_b128 a[0:3], v4 offset:8192
  v_cvt_pk_bf16_f32 v34, v68, v69
  v_mfma_f32_16x16x32_bf16 v[108:111], a[16:19], a[176:179], v[28:31]
  v_exp_f32 v71, v71
  v_mfma_f32_16x16x32_bf16 v[108:111], a[20:23], a[180:183], v[108:111]
  buffer_load_dwordx4 v2, s[20:23], s28 offen offset:1024 sc1 lds
  ds_read_b128 a[4:7], v4 offset:9216
  v_mfma_f32_16x16x32_bf16 v[108:111], a[24:27], a[184:187], v[108:111]
  v_exp_f32 v72, v72
  v_mfma_f32_16x16x32_bf16 v[108:111], a[28:31], a[188:191], v[108:111]
  s_waitcnt lgkmcnt(2)
  ds_read_b128 a[8:11], v4 offset:10240
  v_cvt_pk_bf16_f32 v35, v70, v71
  v_mfma_f32_16x16x32_bf16 v[112:115], a[32:35], a[160:163], v[24:27]
  v_exp_f32 v73, v73
  v_mfma_f32_16x16x32_bf16 v[112:115], a[36:39], a[164:167], v[112:115]
  v_exp_f32 v74, v74
  v_mfma_f32_16x16x32_bf16 v[112:115], a[40:43], a[168:171], v[112:115]
  ds_read_b128 a[12:15], v4 offset:11264
  ds_read_b128 a[16:19], v4 offset:12288
  v_mfma_f32_16x16x32_bf16 v[112:115], a[44:47], a[172:175], v[112:115]
  v_exp_f32 v75, v75
  v_mfma_f32_16x16x32_bf16 v[120:123], a[32:35], a[176:179], v[28:31]
  ds_read_b128 a[20:23], v4 offset:13312
  v_cvt_pk_bf16_f32 v36, v72, v73
  v_mfma_f32_16x16x32_bf16 v[120:123], a[36:39], a[180:183], v[120:123]
  v_exp_f32 v76, v76
  v_mfma_f32_16x16x32_bf16 v[120:123], a[40:43], a[184:187], v[120:123]
  ds_read_b128 a[24:27], v4 offset:14336
  v_cvt_pk_bf16_f32 v37, v74, v75
  v_mfma_f32_16x16x32_bf16 v[120:123], a[44:47], a[188:191], v[120:123]
  v_exp_f32 v77, v77
  v_mfma_f32_16x16x32_bf16 v[116:119], a[48:51], a[160:163], v[24:27]
  v_exp_f32 v78, v78
  v_mfma_f32_16x16x32_bf16 v[116:119], a[52:55], a[164:167], v[116:119]
  ds_read_b128 a[28:31], v4 offset:15360
  v_xor_b32 v4, 0x8000, v4
  v_mfma_f32_16x16x32_bf16 v[116:119], a[56:59], a[168:171], v[116:119]
  v_exp_f32 v79, v79
  v_mfma_f32_16x16x32_bf16 v[116:119], a[60:63], a[172:175], v[116:119]
  buffer_load_dwordx4 v2, s[20:23], s28 offen offset:2048 sc1 lds
  v_xor_b32 v3, 0x8000, v3
  v_mfma_f32_16x16x32_bf16 v[124:127], a[48:51], a[176:179], v[28:31]
  v_exp_f32 v80, v80
  v_mfma_f32_16x16x32_bf16 v[124:127], a[52:55], a[180:183], v[124:127]
  ds_read_b128 a[32:35], v3 offset:0
  ds_read_b128 a[36:39], v3 offset:1024
  v_mfma_f32_16x16x32_bf16 v[124:127], a[56:59], a[184:187], v[124:127]
  v_exp_f32 v81, v81
  v_mfma_f32_16x16x32_bf16 v[124:127], a[60:63], a[188:191], v[124:127]
  s_waitcnt lgkmcnt(6)
  ds_read_b128 a[40:43], v3 offset:2048
  v_cvt_pk_bf16_f32 v38, v76, v77
  v_mfma_f32_16x16x32_bf16 v[160:163], a[0:3], v[52:55], v[160:163]
  v_exp_f32 v82, v82
  v_mfma_f32_16x16x32_bf16 v[192:195], a[0:3], v[56:59], v[192:195]
  v_exp_f32 v83, v83
  v_mfma_f32_16x16x32_bf16 v[224:227], a[0:3], v[60:63], v[224:227]
  ds_read_b128 a[44:47], v3 offset:3072
  v_cvt_pk_bf16_f32 v39, v78, v79
  v_mfma_f32_16x16x32_bf16 a[196:199], a[208:211], v[52:55], a[196:199]
  v_exp_f32 v84, v84
  v_mfma_f32_16x16x32_bf16 v[164:167], a[4:7], v[52:55], v[164:167]
  ds_read_b128 a[48:51], v3 offset:4096
  v_cvt_pk_bf16_f32 v40, v80, v81
  v_mfma_f32_16x16x32_bf16 v[196:199], a[4:7], v[56:59], v[196:199]
  v_exp_f32 v85, v85
  v_mfma_f32_16x16x32_bf16 v[228:231], a[4:7], v[60:63], v[228:231]
  v_cvt_pk_bf16_f32 v41, v82, v83
  v_cvt_pk_bf16_f32 v42, v84, v85
  v_mfma_f32_16x16x32_bf16 a[200:203], a[208:211], v[56:59], a[200:203]
  v_exp_f32 v86, v86
  v_mfma_f32_16x16x32_bf16 v[168:171], a[8:11], v[52:55], v[168:171]
  v_exp_f32 v87, v87
  v_mfma_f32_16x16x32_bf16 v[200:203], a[8:11], v[56:59], v[200:203]
  buffer_load_dwordx4 v2, s[20:23], s28 offen offset:3072 sc1 lds
  ds_read_b128 a[52:55], v3 offset:5120
  v_mfma_f32_16x16x32_bf16 v[232:235], a[8:11], v[60:63], v[232:235]
  s_xor_b32 s26, s26, 0x4000
  v_exp_f32 v88, v88
  v_mfma_f32_16x16x32_bf16 a[204:207], a[208:211], v[60:63], a[204:207]
  s_add_u32 s28, s28, 0x8000
  v_cvt_pk_bf16_f32 v43, v86, v87
  v_mfma_f32_16x16x32_bf16 v[172:175], a[12:15], v[52:55], v[172:175]
  v_exp_f32 v89, v89
  v_mfma_f32_16x16x32_bf16 v[204:207], a[12:15], v[56:59], v[204:207]
  ds_read_b128 a[56:59], v3 offset:6144
  v_cvt_pk_bf16_f32 v44, v88, v89
  v_mfma_f32_16x16x32_bf16 v[236:239], a[12:15], v[60:63], v[236:239]
  s_waitcnt lgkmcnt(7)
  v_exp_f32 v90, v90
  v_mfma_f32_16x16x32_bf16 v[176:179], a[16:19], v[52:55], v[176:179]
  ds_read_b128 a[60:63], v3 offset:7168
  v_mfma_f32_16x16x32_bf16 v[208:211], a[16:19], v[56:59], v[208:211]
  v_exp_f32 v91, v91
  v_mfma_f32_16x16x32_bf16 v[240:243], a[16:19], v[60:63], v[240:243]
  v_exp_f32 v92, v92
  v_mfma_f32_16x16x32_bf16 v[180:183], a[20:23], v[52:55], v[180:183]
  ds_read_b128 a[0:3], v3 offset:8192
  v_cvt_pk_bf16_f32 v45, v90, v91
  v_mfma_f32_16x16x32_bf16 v[212:215], a[20:23], v[56:59], v[212:215]
  v_exp_f32 v93, v93
  v_mfma_f32_16x16x32_bf16 v[244:247], a[20:23], v[60:63], v[244:247]
  v_cvt_pk_bf16_f32 v46, v92, v93
  v_mfma_f32_16x16x32_bf16 v[184:187], a[24:27], v[52:55], v[184:187]
  v_exp_f32 v94, v94
  v_mfma_f32_16x16x32_bf16 v[216:219], a[24:27], v[56:59], v[216:219]
  ds_read_b128 a[4:7], v3 offset:9216
  v_mfma_f32_16x16x32_bf16 v[248:251], a[24:27], v[60:63], v[248:251]
  v_exp_f32 v95, v95
  v_mfma_f32_16x16x32_bf16 v[188:191], a[28:31], v[52:55], v[188:191]
  ds_read_b128 a[8:11], v3 offset:10240
  v_cvt_pk_bf16_f32 v47, v94, v95
  v_mfma_f32_16x16x32_bf16 v[220:223], a[28:31], v[56:59], v[220:223]
  s_waitcnt vmcnt(8)
  s_barrier
  v_mfma_f32_16x16x32_bf16 v[252:255], a[28:31], v[60:63], v[252:255]
  s_lshl_b32 s4, s25, 20
  s_lshl_b32 s5, s24, 15
  s_add_u32 s4, s4, s5
  s_lshl_b32 s5, s3, 11
  s_add_u32 s4, s4, s5
  v_accvgpr_read_b32 v6, a192
  v_accvgpr_read_b32 v8, a196
  s_mov_b32 s5, 0x5f800000
  v_cmp_ngt_f32 vcc, s5, v6
  v_rcp_f32 v6, v6
  s_or_b32 s89, s89, vcc_lo
  s_or_b32 s89, s89, vcc_hi
  v_mov_b32 v7, v6
  v_cmp_ngt_f32 vcc, s5, v8
  v_rcp_f32 v8, v8
  s_or_b32 s89, s89, vcc_lo
  s_or_b32 s89, s89, vcc_hi
  v_mov_b32 v9, v8
  v_pk_mul_f32 v[128:129], v[128:129], v[6:7]
  v_pk_mul_f32 v[130:131], v[130:131], v[6:7]
  v_pk_mul_f32 v[132:133], v[132:133], v[6:7]
  v_pk_mul_f32 v[134:135], v[134:135], v[6:7]
  v_cvt_pk_bf16_f32 v128, v128, v129
  v_cvt_pk_bf16_f32 v129, v130, v131
  v_cvt_pk_bf16_f32 v130, v132, v133
  v_cvt_pk_bf16_f32 v131, v134, v135
  buffer_store_dwordx4 v[128:131], v2, s[16:19], s4 offen offset:0 sc1
  v_pk_mul_f32 v[160:161], v[160:161], v[8:9]
  v_pk_mul_f32 v[162:163], v[162:163], v[8:9]
  v_pk_mul_f32 v[164:165], v[164:165], v[8:9]
  v_pk_mul_f32 v[166:167], v[166:167], v[8:9]
  v_cvt_pk_bf16_f32 v160, v160, v161
  v_cvt_pk_bf16_f32 v161, v162, v163
  v_cvt_pk_bf16_f32 v162, v164, v165
  v_cvt_pk_bf16_f32 v163, v166, v167
  buffer_store_dwordx4 v[160:163], v2, s[16:19], s4 offen offset:1024 sc1
  s_add_u32 s4, s4, 8192
  v_pk_mul_f32 v[136:137], v[136:137], v[6:7]
  v_pk_mul_f32 v[138:139], v[138:139], v[6:7]
  v_pk_mul_f32 v[140:141], v[140:141], v[6:7]
  v_pk_mul_f32 v[142:143], v[142:143], v[6:7]
  v_cvt_pk_bf16_f32 v136, v136, v137
  v_cvt_pk_bf16_f32 v137, v138, v139
  v_cvt_pk_bf16_f32 v138, v140, v141
  v_cvt_pk_bf16_f32 v139, v142, v143
  buffer_store_dwordx4 v[136:139], v2, s[16:19], s4 offen offset:0 sc1
  v_pk_mul_f32 v[168:169], v[168:169], v[8:9]
  v_pk_mul_f32 v[170:171], v[170:171], v[8:9]
  v_pk_mul_f32 v[172:173], v[172:173], v[8:9]
  v_pk_mul_f32 v[174:175], v[174:175], v[8:9]
  v_cvt_pk_bf16_f32 v168, v168, v169
  v_cvt_pk_bf16_f32 v169, v170, v171
  v_cvt_pk_bf16_f32 v170, v172, v173
  v_cvt_pk_bf16_f32 v171, v174, v175
  buffer_store_dwordx4 v[168:171], v2, s[16:19], s4 offen offset:1024 sc1
  s_add_u32 s4, s4, 8192
  v_pk_mul_f32 v[144:145], v[144:145], v[6:7]
  v_pk_mul_f32 v[146:147], v[146:147], v[6:7]
  v_pk_mul_f32 v[148:149], v[148:149], v[6:7]
  v_pk_mul_f32 v[150:151], v[150:151], v[6:7]
  v_cvt_pk_bf16_f32 v144, v144, v145
  v_cvt_pk_bf16_f32 v145, v146, v147
  v_cvt_pk_bf16_f32 v146, v148, v149
  v_cvt_pk_bf16_f32 v147, v150, v151
  buffer_store_dwordx4 v[144:147], v2, s[16:19], s4 offen offset:0 sc1
  v_pk_mul_f32 v[176:177], v[176:177], v[8:9]
  v_pk_mul_f32 v[178:179], v[178:179], v[8:9]
  v_pk_mul_f32 v[180:181], v[180:181], v[8:9]
  v_pk_mul_f32 v[182:183], v[182:183], v[8:9]
  v_cvt_pk_bf16_f32 v176, v176, v177
  v_cvt_pk_bf16_f32 v177, v178, v179
  v_cvt_pk_bf16_f32 v178, v180, v181
  v_cvt_pk_bf16_f32 v179, v182, v183
  buffer_store_dwordx4 v[176:179], v2, s[16:19], s4 offen offset:1024 sc1
  s_add_u32 s4, s4, 8192
  v_pk_mul_f32 v[152:153], v[152:153], v[6:7]
  v_pk_mul_f32 v[154:155], v[154:155], v[6:7]
  v_pk_mul_f32 v[156:157], v[156:157], v[6:7]
  v_pk_mul_f32 v[158:159], v[158:159], v[6:7]
  v_cvt_pk_bf16_f32 v152, v152, v153
  v_cvt_pk_bf16_f32 v153, v154, v155
  v_cvt_pk_bf16_f32 v154, v156, v157
  v_cvt_pk_bf16_f32 v155, v158, v159
  buffer_store_dwordx4 v[152:155], v2, s[16:19], s4 offen offset:0 sc1
  v_pk_mul_f32 v[184:185], v[184:185], v[8:9]
  v_pk_mul_f32 v[186:187], v[186:187], v[8:9]
  v_pk_mul_f32 v[188:189], v[188:189], v[8:9]
  v_pk_mul_f32 v[190:191], v[190:191], v[8:9]
  v_cvt_pk_bf16_f32 v184, v184, v185
  v_cvt_pk_bf16_f32 v185, v186, v187
  v_cvt_pk_bf16_f32 v186, v188, v189
  v_cvt_pk_bf16_f32 v187, v190, v191
  buffer_store_dwordx4 v[184:187], v2, s[16:19], s4 offen offset:1024 sc1
  s_lshl_b32 s88, s25, 1
  s_sub_u32 s88, 14, s88
  .p2align 6
La_so:
  s_waitcnt lgkmcnt(3)
  v_mfma_f32_16x16x32_bf16 v[64:67], a[32:35], a[160:163], v[24:27]
  s_mov_b32 m0, s26
  v_exp_f32 v96, v96
  v_mfma_f32_16x16x32_bf16 v[64:67], a[36:39], a[164:167], v[64:67]
  buffer_load_dwordx4 v2, s[20:23], s28 offen offset:0 sc1 lds
  ds_read_b128 a[12:15], v3 offset:11264
  v_mfma_f32_16x16x32_bf16 v[64:67], a[40:43], a[168:171], v[64:67]
  v_exp_f32 v97, v97
  v_mfma_f32_16x16x32_bf16 v[64:67], a[44:47], a[172:175], v[64:67]
  ds_read_b128 a[16:19], v3 offset:12288
  v_cvt_pk_bf16_f32 v48, v96, v97
  v_mfma_f32_16x16x32_bf16 v[72:75], a[32:35], a[176:179], v[28:31]
  v_exp_f32 v98, v98
  v_mfma_f32_16x16x32_bf16 v[72:75], a[36:39], a[180:183], v[72:75]
  ds_read_b128 a[20:23], v3 offset:13312
  v_mfma_f32_16x16x32_bf16 v[72:75], a[40:43], a[184:187], v[72:75]
  v_exp_f32 v99, v99
  v_mfma_f32_16x16x32_bf16 v[72:75], a[44:47], a[188:191], v[72:75]
  ds_read_b128 a[24:27], v3 offset:14336
  v_cvt_pk_bf16_f32 v49, v98, v99
  v_mfma_f32_16x16x32_bf16 v[68:71], a[48:51], a[160:163], v[24:27]
  v_exp_f32 v100, v100
  v_mfma_f32_16x16x32_bf16 v[68:71], a[52:55], a[164:167], v[68:71]
  buffer_load_dwordx4 v2, s[20:23], s28 offen offset:1024 sc1 lds
  ds_read_b128 a[28:31], v3 offset:15360
  v_mfma_f32_16x16x32_bf16 v[68:71], a[56:59], a[168:171], v[68:71]
  v_exp_f32 v101, v101
  v_mfma_f32_16x16x32_bf16 v[68:71], a[60:63], a[172:175], v[68:71]
  ds_read_b128 a[32:35], v4 offset:0
  v_cvt_pk_bf16_f32 v50, v100, v101
  v_mfma_f32_16x16x32_bf16 v[76:79], a[48:51], a[176:179], v[28:31]
  v_exp_f32 v102, v102
  v_mfma_f32_16x16x32_bf16 v[76:79], a[52:55], a[180:183], v[76:79]
  ds_read_b128 a[36:39], v4 offset:1024
  v_mfma_f32_16x16x32_bf16 v[76:79], a[56:59], a[184:187], v[76:79]
  v_exp_f32 v103, v103
  v_mfma_f32_16x16x32_bf16 v[76:79], a[60:63], a[188:191], v[76:79]
  s_waitcnt lgkmcnt(2)
  ds_read_b128 a[40:43], v4 offset:2048
  v_cvt_pk_bf16_f32 v51, v102, v103
  v_mfma_f32_16x16x32_bf16 v[80:83], a[0:3], a[160:163], v[24:27]
  v_exp_f32 v104, v104
  v_mfma_f32_16x16x32_bf16 v[80:83], a[4:7], a[164:167], v[80:83]
  buffer_load_dwordx4 v2, s[20:23], s28 offen offset:2048 sc1 lds
  ds_read_b128 a[44:47], v4 offset:3072
  v_mfma_f32_16x16x32_bf16 v[80:83], a[8:11], a[168:171], v[80:83]
  v_exp_f32 v105, v105
  v_mfma_f32_16x16x32_bf16 v[80:83], a[12:15], a[172:175], v[80:83]
  ds_read_b128 a[48:51], v4 offset:4096
  v_cvt_pk_bf16_f32 v52, v104, v105
  v_mfma_f32_16x16x32_bf16 v[88:91], a[0:3], a[176:179], v[28:31]
  v_exp_f32 v106, v106
  v_mfma_f32_16x16x32_bf16 v[88:91], a[4:7], a[180:183], v[88:91]
  ds_read_b128 a[52:55], v4 offset:5120
  v_mfma_f32_16x16x32_bf16 v[88:91], a[8:11], a[184:187], v[88:91]
  v_exp_f32 v107, v107
  v_mfma_f32_16x16x32_bf16 v[88:91], a[12:15], a[188:191], v[88:91]
  ds_read_b128 a[56:59], v4 offset:6144
  v_cvt_pk_bf16_f32 v53, v106, v107
  v_mfma_f32_16x16x32_bf16 v[84:87], a[16:19], a[160:163], v[24:27]
  v_exp_f32 v108, v108
  v_mfma_f32_16x16x32_bf16 v[84:87], a[20:23], a[164:167], v[84:87]
  buffer_load_dwordx4 v2, s[20:23], s28 offen offset:3072 sc1 lds
  ds_read_b128 a[60:63], v4 offset:7168
  v_mfma_f32_16x16x32_bf16 v[84:87], a[24:27], a[168:171], v[84:87]
  s_xor_b32 s26, s26, 0x8000
  v_exp_f32 v109, v109
  v_mfma_f32_16x16x32_bf16 v[84:87], a[28:31], a[172:175], v[84:87]
  s_add_u32 s28, s28, 0x8000
  s_mov_b32 m0, s27
  ds_read_b128 a[0:3], v4 offset:8192
  v_mfma_f32_16x16x32_bf16 v[92:95], a[16:19], a[176:179], v[28:31]
  v_exp_f32 v110, v110
  v_mfma_f32_16x16x32_bf16 v[92:95], a[20:23], a[180:183], v[92:95]
  ds_read_b128 a[4:7], v4 offset:9216
  v_cvt_pk_bf16_f32 v54, v108, v109
  v_mfma_f32_16x16x32_bf16 v[92:95], a[24:27], a[184:187], v[92:95]
  v_exp_f32 v111, v111
  v_mfma_f32_16x16x32_bf16 v[92:95], a[28:31], a[188:191], v[92:95]
  s_waitcnt lgkmcnt(2)
  ds_read_b128 a[8:11], v4 offset:10240
  v_cvt_pk_bf16_f32 v55, v110, v111
  v_mfma_f32_16x16x32_bf16 v[192:195], a[32:35], v[32:35], v[192:195]
  buffer_load_dwordx4 v2, s[20:23], s29 offen offset:0 sc1 lds
  ds_read_b128 a[12:15], v4 offset:11264
  v_mfma_f32_16x16x32_bf16 v[224:227], a[32:35], v[36:39], v[224:227]
  v_exp_f32 v112, v112
  v_mfma_f32_16x16x32_bf16 a[200:203], a[208:211], v[32:35], a[200:203]
  s_sub_u32 s88, s88, 1
  v_mfma_f32_16x16x32_bf16 v[196:199], a[36:39], v[32:35], v[196:199]
  v_exp_f32 v113, v113
  v_mfma_f32_16x16x32_bf16 v[228:231], a[36:39], v[36:39], v[228:231]
  ds_read_b128 a[16:19], v4 offset:12288
  v_cvt_pk_bf16_f32 v56, v112, v113
  v_mfma_f32_16x16x32_bf16 a[204:207], a[208:211], v[36:39], a[204:207]
  v_exp_f32 v114, v114
  v_mfma_f32_16x16x32_bf16 v[200:203], a[40:43], v[32:35], v[200:203]
  ds_read_b128 a[20:23], v4 offset:13312
  v_mfma_f32_16x16x32_bf16 v[232:235], a[40:43], v[36:39], v[232:235]
  v_exp_f32 v115, v115
  v_mfma_f32_16x16x32_bf16 v[204:207], a[44:47], v[32:35], v[204:207]
  buffer_load_dwordx4 v2, s[20:23], s29 offen offset:1024 sc1 lds
  ds_read_b128 a[24:27], v4 offset:14336
  v_mfma_f32_16x16x32_bf16 v[236:239], a[44:47], v[36:39], v[236:239]
  v_exp_f32 v116, v116
  v_mfma_f32_16x16x32_bf16 v[208:211], a[48:51], v[32:35], v[208:211]
  ds_read_b128 a[28:31], v4 offset:15360
  v_xor_b32 v4, 0x4000, v4
  v_mfma_f32_16x16x32_bf16 v[240:243], a[48:51], v[36:39], v[240:243]
  v_exp_f32 v117, v117
  v_mfma_f32_16x16x32_bf16 v[212:215], a[52:55], v[32:35], v[212:215]
  v_xor_b32 v3, 0x4000, v3
  v_cvt_pk_bf16_f32 v57, v114, v115
  v_mfma_f32_16x16x32_bf16 v[244:247], a[52:55], v[36:39], v[244:247]
  v_exp_f32 v118, v118
  v_mfma_f32_16x16x32_bf16 v[216:219], a[56:59], v[32:35], v[216:219]
  ds_read_b128 a[32:35], v3 offset:0
  ds_read_b128 a[36:39], v3 offset:1024
  v_mfma_f32_16x16x32_bf16 v[248:251], a[56:59], v[36:39], v[248:251]
  v_exp_f32 v119, v119
  v_mfma_f32_16x16x32_bf16 v[220:223], a[60:63], v[32:35], v[220:223]
  buffer_load_dwordx4 v2, s[20:23], s29 offen offset:2048 sc1 lds
  ds_read_b128 a[40:43], v3 offset:2048
  v_mfma_f32_16x16x32_bf16 v[252:255], a[60:63], v[36:39], v[252:255]
  s_waitcnt lgkmcnt(3)
  v_exp_f32 v120, v120
  v_mfma_f32_16x16x32_bf16 v[192:195], a[0:3], v[40:43], v[192:195]
  ds_read_b128 a[44:47], v3 offset:3072
  v_cvt_pk_bf16_f32 v58, v116, v117
  v_mfma_f32_16x16x32_bf16 v[224:227], a[0:3], v[44:47], v[224:227]
  v_exp_f32 v121, v121
  v_mfma_f32_16x16x32_bf16 a[200:203], a[208:211], v[40:43], a[200:203]
  v_cvt_pk_bf16_f32 v59, v118, v119
  v_cvt_pk_bf16_f32 v60, v120, v121
  v_mfma_f32_16x16x32_bf16 v[196:199], a[4:7], v[40:43], v[196:199]
  v_exp_f32 v122, v122
  v_mfma_f32_16x16x32_bf16 v[228:231], a[4:7], v[44:47], v[228:231]
  ds_read_b128 a[48:51], v3 offset:4096
  v_mfma_f32_16x16x32_bf16 a[204:207], a[208:211], v[44:47], a[204:207]
  v_exp_f32 v123, v123
  v_mfma_f32_16x16x32_bf16 v[200:203], a[8:11], v[40:43], v[200:203]
  buffer_load_dwordx4 v2, s[20:23], s29 offen offset:3072 sc1 lds
  ds_read_b128 a[52:55], v3 offset:5120
  v_mfma_f32_16x16x32_bf16 v[232:235], a[8:11], v[44:47], v[232:235]
  s_xor_b32 s27, s27, 0x8000
  v_exp_f32 v124, v124
  v_mfma_f32_16x16x32_bf16 v[204:207], a[12:15], v[40:43], v[204:207]
  s_add_u32 s29, s29, 0x8000
  ds_read_b128 a[56:59], v3 offset:6144
  v_cvt_pk_bf16_f32 v61, v122, v123
  v_mfma_f32_16x16x32_bf16 v[236:239], a[12:15], v[44:47], v[236:239]
  v_exp_f32 v125, v125
  v_mfma_f32_16x16x32_bf16 v[208:211], a[16:19], v[40:43], v[208:211]
  ds_read_b128 a[60:63], v3 offset:7168
  v_cvt_pk_bf16_f32 v62, v124, v125
  v_mfma_f32_16x16x32_bf16 v[240:243], a[16:19], v[44:47], v[240:243]
  v_exp_f32 v126, v126
  v_mfma_f32_16x16x32_bf16 v[212:215], a[20:23], v[40:43], v[212:215]
  ds_read_b128 a[0:3], v3 offset:8192
  v_mfma_f32_16x16x32_bf16 v[244:247], a[20:23], v[44:47], v[244:247]
  v_exp_f32 v127, v127
  v_mfma_f32_16x16x32_bf16 v[216:219], a[24:27], v[40:43], v[216:219]
  ds_read_b128 a[4:7], v3 offset:9216
  v_cvt_pk_bf16_f32 v63, v126, v127
  v_mfma_f32_16x16x32_bf16 v[248:251], a[24:27], v[44:47], v[248:251]
  v_mfma_f32_16x16x32_bf16 v[220:223], a[28:31], v[40:43], v[220:223]
  s_waitcnt vmcnt(8)
  s_barrier
  v_mfma_f32_16x16x32_bf16 v[252:255], a[28:31], v[44:47], v[252:255]
  ds_read_b128 a[8:11], v3 offset:10240
  s_cmp_eq_u32 s88, 0
  s_cbranch_scc1 La_e0
  s_waitcnt lgkmcnt(3)
  v_mfma_f32_16x16x32_bf16 v[96:99], a[32:35], a[160:163], v[24:27]
  s_mov_b32 m0, s26
  v_exp_f32 v64, v64
  v_mfma_f32_16x16x32_bf16 v[96:99], a[36:39], a[164:167], v[96:99]
  buffer_load_dwordx4 v2, s[20:23], s28 offen offset:0 sc1 lds
  ds_read_b128 a[12:15], v3 offset:11264
  v_mfma_f32_16x16x32_bf16 v[96:99], a[40:43], a[168:171], v[96:99]
  v_exp_f32 v65, v65
  v_mfma_f32_16x16x32_bf16 v[96:99], a[44:47], a[172:175], v[96:99]
  ds_read_b128 a[16:19], v3 offset:12288
  v_cvt_pk_bf16_f32 v32, v64, v65
  v_mfma_f32_16x16x32_bf16 v[104:107], a[32:35], a[176:179], v[28:31]
  v_exp_f32 v66, v66
  v_mfma_f32_16x16x32_bf16 v[104:107], a[36:39], a[180:183], v[104:107]
  ds_read_b128 a[20:23], v3 offset:13312
  v_mfma_f32_16x16x32_bf16 v[104:107], a[40:43], a[184:187], v[104:107]
  v_exp_f32 v67, v67
  v_mfma_f32_16x16x32_bf16 v[104:107], a[44:47], a[188:191], v[104:107]
  ds_read_b128 a[24:27], v3 offset:14336
  v_cvt_pk_bf16_f32 v33, v66, v67
  v_mfma_f32_16x16x32_bf16 v[100:103], a[48:51], a[160:163], v[24:27]
  v_exp_f32 v68, v68
  v_mfma_f32_16x16x32_bf16 v[100:103], a[52:55], a[164:167], v[100:103]
  buffer_load_dwordx4 v2, s[20:23], s28 offen offset:1024 sc1 lds
  ds_read_b128 a[28:31], v3 offset:15360
  v_mfma_f32_16x16x32_bf16 v[100:103], a[56:59], a[168:171], v[100:103]
  v_exp_f32 v69, v69
  v_mfma_f32_16x16x32_bf16 v[100:103], a[60:63], a[172:175], v[100:103]
  ds_read_b128 a[32:35], v4 offset:0
  v_cvt_pk_bf16_f32 v34, v68, v69
  v_mfma_f32_16x16x32_bf16 v[108:111], a[48:51], a[176:179], v[28:31]
  v_exp_f32 v70, v70
  v_mfma_f32_16x16x32_bf16 v[108:111], a[52:55], a[180:183], v[108:111]
  ds_read_b128 a[36:39], v4 offset:1024
  v_mfma_f32_16x16x32_bf16 v[108:111], a[56:59], a[184:187], v[108:111]
  v_exp_f32 v71, v71
  v_mfma_f32_16x16x32_bf16 v[108:111], a[60:63], a[188:191], v[108:111]
  s_waitcnt lgkmcnt(2)
  ds_read_b128 a[40:43], v4 offset:2048
  v_cvt_pk_bf16_f32 v35, v70, v71
  v_mfma_f32_16x16x32_bf16 v[112:115], a[0:3], a[160:163], v[24:27]
  v_exp_f32 v72, v72
  v_mfma_f32_16x16x32_bf16 v[112:115], a[4:7], a[164:167], v[112:115]
  buffer_load_dwordx4 v2, s[20:23], s28 offen offset:2048 sc1 lds
  ds_read_b128 a[44:47], v4 offset:3072
  v_mfma_f32_16x16x32_bf16 v[112:115], a[8:11], a[168:171], v[112:115]
  v_exp_f32 v73, v73
  v_mfma_f32_16x16x32_bf16 v[112:115], a[12:15], a[172:175], v[112:115]
  ds_read_b128 a[48:51], v4 offset:4096
  v_cvt_pk_bf16_f32 v36, v72, v73
  v_mfma_f32_16x16x32_bf16 v[120:123], a[0:3], a[176:179], v[28:31]
  v_exp_f32 v74, v74
  v_mfma_f32_16x16x32_bf16 v[120:123], a[4:7], a[180:183], v[120:123]
  ds_read_b128 a[52:55], v4 offset:5120
  v_mfma_f32_16x16x32_bf16 v[120:123], a[8:11], a[184:187], v[120:123]
  v_exp_f32 v75, v75
  v_mfma_f32_16x16x32_bf16 v[120:123], a[12:15], a[188:191], v[120:123]
  ds_read_b128 a[56:59], v4 offset:6144
  v_cvt_pk_bf16_f32 v37, v74, v75
  v_mfma_f32_16x16x32_bf16 v[116:119], a[16:19], a[160:163], v[24:27]
  v_exp_f32 v76, v76
  v_mfma_f32_16x16x32_bf16 v[116:119], a[20:23], a[164:167], v[116:119]
  buffer_load_dwordx4 v2, s[20:23], s28 offen offset:3072 sc1 lds
  ds_read_b128 a[60:63], v4 offset:7168
  v_mfma_f32_16x16x32_bf16 v[116:119], a[24:27], a[168:171], v[116:119]
  s_xor_b32 s26, s26, 0x4000
  v_exp_f32 v77, v77
  v_mfma_f32_16x16x32_bf16 v[116:119], a[28:31], a[172:175], v[116:119]
  s_add_u32 s28, s28, 0x8000
  s_mov_b32 m0, s27
  ds_read_b128 a[0:3], v4 offset:8192
  v_mfma_f32_16x16x32_bf16 v[124:127], a[16:19], a[176:179], v[28:31]
  v_exp_f32 v78, v78
  v_mfma_f32_16x16x32_bf16 v[124:127], a[20:23], a[180:183], v[124:127]
  ds_read_b128 a[4:7], v4 offset:9216
  v_cvt_pk_bf16_f32 v38, v76, v77
  v_mfma_f32_16x16x32_bf16 v[124:127], a[24:27], a[184:187], v[124:127]
  v_exp_f32 v79, v79
  v_mfma_f32_16x16x32_bf16 v[124:127], a[28:31], a[188:191], v[124:127]
  s_waitcnt lgkmcnt(2)
  ds_read_b128 a[8:11], v4 offset:10240
  v_cvt_pk_bf16_f32 v39, v78, v79
  v_mfma_f32_16x16x32_bf16 v[192:195], a[32:35], v[48:51], v[192:195]
  buffer_load_dwordx4 v2, s[20:23], s29 offen offset:0 sc1 lds
  ds_read_b128 a[12:15], v4 offset:11264
  v_mfma_f32_16x16x32_bf16 v[224:227], a[32:35], v[52:55], v[224:227]
  v_exp_f32 v80, v80
  v_mfma_f32_16x16x32_bf16 a[200:203], a[208:211], v[48:51], a[200:203]
  v_mfma_f32_16x16x32_bf16 v[196:199], a[36:39], v[48:51], v[196:199]
  v_exp_f32 v81, v81
  v_mfma_f32_16x16x32_bf16 v[228:231], a[36:39], v[52:55], v[228:231]
  ds_read_b128 a[16:19], v4 offset:12288
  v_cvt_pk_bf16_f32 v40, v80, v81
  v_mfma_f32_16x16x32_bf16 a[204:207], a[208:211], v[52:55], a[204:207]
  v_exp_f32 v82, v82
  v_mfma_f32_16x16x32_bf16 v[200:203], a[40:43], v[48:51], v[200:203]
  ds_read_b128 a[20:23], v4 offset:13312
  v_mfma_f32_16x16x32_bf16 v[232:235], a[40:43], v[52:55], v[232:235]
  v_exp_f32 v83, v83
  v_mfma_f32_16x16x32_bf16 v[204:207], a[44:47], v[48:51], v[204:207]
  buffer_load_dwordx4 v2, s[20:23], s29 offen offset:1024 sc1 lds
  ds_read_b128 a[24:27], v4 offset:14336
  v_mfma_f32_16x16x32_bf16 v[236:239], a[44:47], v[52:55], v[236:239]
  v_exp_f32 v84, v84
  v_mfma_f32_16x16x32_bf16 v[208:211], a[48:51], v[48:51], v[208:211]
  ds_read_b128 a[28:31], v4 offset:15360
  v_xor_b32 v4, 0x8000, v4
  v_mfma_f32_16x16x32_bf16 v[240:243], a[48:51], v[52:55], v[240:243]
  v_exp_f32 v85, v85
  v_mfma_f32_16x16x32_bf16 v[212:215], a[52:55], v[48:51], v[212:215]
  v_xor_b32 v3, 0x8000, v3
  v_cvt_pk_bf16_f32 v41, v82, v83
  v_mfma_f32_16x16x32_bf16 v[244:247], a[52:55], v[52:55], v[244:247]
  v_exp_f32 v86, v86
  v_mfma_f32_16x16x32_bf16 v[216:219], a[56:59], v[48:51], v[216:219]
  ds_read_b128 a[32:35], v3 offset:0
  ds_read_b128 a[36:39], v3 offset:1024
  v_mfma_f32_16x16x32_bf16 v[248:251], a[56:59], v[52:55], v[248:251]
  v_exp_f32 v87, v87
  v_mfma_f32_16x16x32_bf16 v[220:223], a[60:63], v[48:51], v[220:223]
  buffer_load_dwordx4 v2, s[20:23], s29 offen offset:2048 sc1 lds
  ds_read_b128 a[40:43], v3 offset:2048
  v_mfma_f32_16x16x32_bf16 v[252:255], a[60:63], v[52:55], v[252:255]
  s_waitcnt lgkmcnt(3)
  v_exp_f32 v88, v88
  v_mfma_f32_16x16x32_bf16 v[192:195], a[0:3], v[56:59], v[192:195]
  ds_read_b128 a[44:47], v3 offset:3072
  v_cvt_pk_bf16_f32 v42, v84, v85
  v_mfma_f32_16x16x32_bf16 v[224:227], a[0:3], v[60:63], v[224:227]
  v_exp_f32 v89, v89
  v_mfma_f32_16x16x32_bf16 a[200:203], a[208:211], v[56:59], a[200:203]
  v_cvt_pk_bf16_f32 v43, v86, v87
  v_cvt_pk_bf16_f32 v44, v88, v89
  v_mfma_f32_16x16x32_bf16 v[196:199], a[4:7], v[56:59], v[196:199]
  v_exp_f32 v90, v90
  v_mfma_f32_16x16x32_bf16 v[228:231], a[4:7], v[60:63], v[228:231]
  ds_read_b128 a[48:51], v3 offset:4096
  v_mfma_f32_16x16x32_bf16 a[204:207], a[208:211], v[60:63], a[204:207]
  v_exp_f32 v91, v91
  v_mfma_f32_16x16x32_bf16 v[200:203], a[8:11], v[56:59], v[200:203]
  buffer_load_dwordx4 v2, s[20:23], s29 offen offset:3072 sc1 lds
  ds_read_b128 a[52:55], v3 offset:5120
  v_mfma_f32_16x16x32_bf16 v[232:235], a[8:11], v[60:63], v[232:235]
  s_xor_b32 s27, s27, 0x4000
  v_exp_f32 v92, v92
  v_mfma_f32_16x16x32_bf16 v[204:207], a[12:15], v[56:59], v[204:207]
  s_add_u32 s29, s29, 0x8000
  ds_read_b128 a[56:59], v3 offset:6144
  v_cvt_pk_bf16_f32 v45, v90, v91
  v_mfma_f32_16x16x32_bf16 v[236:239], a[12:15], v[60:63], v[236:239]
  v_exp_f32 v93, v93
  v_mfma_f32_16x16x32_bf16 v[208:211], a[16:19], v[56:59], v[208:211]
  ds_read_b128 a[60:63], v3 offset:7168
  v_cvt_pk_bf16_f32 v46, v92, v93
  v_mfma_f32_16x16x32_bf16 v[240:243], a[16:19], v[60:63], v[240:243]
  v_exp_f32 v94, v94
  v_mfma_f32_16x16x32_bf16 v[212:215], a[20:23], v[56:59], v[212:215]
  ds_read_b128 a[0:3], v3 offset:8192
  v_mfma_f32_16x16x32_bf16 v[244:247], a[20:23], v[60:63], v[244:247]
  v_exp_f32 v95, v95
  v_mfma_f32_16x16x32_bf16 v[216:219], a[24:27], v[56:59], v[216:219]
  ds_read_b128 a[4:7], v3 offset:9216
  v_cvt_pk_bf16_f32 v47, v94, v95
  v_mfma_f32_16x16x32_bf16 v[248:251], a[24:27], v[60:63], v[248:251]
  v_mfma_f32_16x16x32_bf16 v[220:223], a[28:31], v[56:59], v[220:223]
  s_waitcnt vmcnt(12)
  s_barrier
  v_mfma_f32_16x16x32_bf16 v[252:255], a[28:31], v[60:63], v[252:255]
  ds_read_b128 a[8:11], v3 offset:10240
  s_branch La_so
La_t7:
  s_waitcnt lgkmcnt(7)
  v_mfma_f32_16x16x32_bf16 v[104:107], a[0:3], a[176:179], v[28:31]
  buffer_load_dwordx2 v[12:13], v14, s[96:99], s91 offen sc1
  ds_read_b128 a[44:47], v3 offset:11264
  v_mfma_f32_16x16x32_bf16 v[104:107], a[4:7], a[180:183], v[104:107]
  v_cndmask_b32 v64, v64, v5, s[32:33]
  v_exp_f32 v64, v64
  v_mfma_f32_16x16x32_bf16 v[104:107], a[8:11], a[184:187], v[104:107]
  v_cndmask_b32 v65, v65, v5, s[34:35]
  v_exp_f32 v65, v65
  v_mfma_f32_16x16x32_bf16 v[104:107], a[12:15], a[188:191], v[104:107]
  s_waitcnt lgkmcnt(4)
  v_cndmask_b32 v66, v66, v5, s[36:37]
  v_exp_f32 v66, v66
  v_mfma_f32_16x16x32_bf16 v[108:111], a[16:19], a[176:179], v[28:31]
  v_cndmask_b32 v67, v67, v5, s[38:39]
  v_exp_f32 v67, v67
  v_mfma_f32_16x16x32_bf16 v[108:111], a[20:23], a[180:183], v[108:111]
  v_cndmask_b32 v68, v68, v5, s[40:41]
  v_exp_f32 v68, v68
  v_mfma_f32_16x16x32_bf16 v[108:111], a[24:27], a[184:187], v[108:111]
  v_cndmask_b32 v69, v69, v5, s[42:43]
  v_exp_f32 v69, v69
  v_mfma_f32_16x16x32_bf16 v[108:111], a[28:31], a[188:191], v[108:111]
  s_waitcnt lgkmcnt(0)
  v_cndmask_b32 v70, v70, v5, s[44:45]
  v_exp_f32 v70, v70
  v_mfma_f32_16x16x32_bf16 v[120:123], a[32:35], a[176:179], v[28:31]
  v_cndmask_b32 v71, v71, v5, s[46:47]
  v_exp_f32 v71, v71
  v_mfma_f32_16x16x32_bf16 v[120:123], a[36:39], a[180:183], v[120:123]
  ds_read_b128 a[48:51], v3 offset:12288
  ds_read_b128 a[52:55], v3 offset:13312
  ds_read_b128 a[56:59], v3 offset:14336
  v_mfma_f32_16x16x32_bf16 v[120:123], a[40:43], a[184:187], v[120:123]
  ds_read_b128 a[60:63], v3 offset:15360
  v_exp_f32 v72, v72
  v_mfma_f32_16x16x32_bf16 v[120:123], a[44:47], a[188:191], v[120:123]
  s_waitcnt lgkmcnt(0)
  v_exp_f32 v73, v73
  v_cvt_pk_bf16_f32 v33, v66, v67
  v_mfma_f32_16x16x32_bf16 v[124:127], a[48:51], a[176:179], v[28:31]
  v_exp_f32 v74, v74
  v_cvt_pk_bf16_f32 v34, v68, v69
  v_mfma_f32_16x16x32_bf16 v[124:127], a[52:55], a[180:183], v[124:127]
  ds_read_b128 a[0:3], v4 offset:8192
  ds_read_b128 a[4:7], v4 offset:9216
  ds_read_b128 a[8:11], v4 offset:10240
  v_mfma_f32_16x16x32_bf16 v[124:127], a[56:59], a[184:187], v[124:127]
  ds_read_b128 a[12:15], v4 offset:11264
  v_exp_f32 v75, v75
  v_mfma_f32_16x16x32_bf16 v[124:127], a[60:63], a[188:191], v[124:127]
  s_waitcnt lgkmcnt(0)
  v_exp_f32 v76, v76
  v_cvt_pk_bf16_f32 v35, v70, v71
  v_mfma_f32_16x16x32_bf16 v[160:163], a[0:3], v[52:55], v[160:163]
  v_exp_f32 v77, v77
  v_cvt_pk_bf16_f32 v36, v72, v73
  v_mfma_f32_16x16x32_bf16 v[192:195], a[0:3], v[56:59], v[192:195]
  v_exp_f32 v78, v78
  v_cvt_pk_bf16_f32 v37, v74, v75
  v_mfma_f32_16x16x32_bf16 v[224:227], a[0:3], v[60:63], v[224:227]
  ds_read_b128 a[16:19], v4 offset:12288
  ds_read_b128 a[20:23], v4 offset:13312
  v_cvt_pk_bf16_f32 v38, v76, v77
  v_mfma_f32_16x16x32_bf16 a[196:199], a[208:211], v[52:55], a[196:199]
  v_exp_f32 v79, v79
  v_mfma_f32_16x16x32_bf16 v[164:167], a[4:7], v[52:55], v[164:167]
  v_cndmask_b32 v80, v80, v5, s[48:49]
  v_exp_f32 v80, v80
  v_cvt_pk_bf16_f32 v39, v78, v79
  v_mfma_f32_16x16x32_bf16 v[196:199], a[4:7], v[56:59], v[196:199]
  v_cndmask_b32 v81, v81, v5, s[50:51]
  v_exp_f32 v81, v81
  v_mfma_f32_16x16x32_bf16 v[228:231], a[4:7], v[60:63], v[228:231]
  ds_read_b128 a[24:27], v4 offset:14336
  ds_read_b128 a[28:31], v4 offset:15360
  v_cvt_pk_bf16_f32 v40, v80, v81
  v_mfma_f32_16x16x32_bf16 a[200:203], a[208:211], v[56:59], a[200:203]
  v_cndmask_b32 v82, v82, v5, s[52:53]
  v_exp_f32 v82, v82
  v_mfma_f32_16x16x32_bf16 v[168:171], a[8:11], v[52:55], v[168:171]
  v_cndmask_b32 v83, v83, v5, s[54:55]
  v_exp_f32 v83, v83
  v_mfma_f32_16x16x32_bf16 v[200:203], a[8:11], v[56:59], v[200:203]
  v_cndmask_b32 v84, v84, v5, s[56:57]
  v_exp_f32 v84, v84
  v_mfma_f32_16x16x32_bf16 v[232:235], a[8:11], v[60:63], v[232:235]
  v_cndmask_b32 v85, v85, v5, s[58:59]
  v_exp_f32 v85, v85
  v_mfma_f32_16x16x32_bf16 a[204:207], a[208:211], v[60:63], a[204:207]
  v_xor_b32 v4, 0x8000, v4
  v_cvt_pk_bf16_f32 v32, v64, v65
  v_cvt_pk_bf16_f32 v41, v82, v83
  v_mfma_f32_16x16x32_bf16 v[172:175], a[12:15], v[52:55], v[172:175]
  v_cndmask_b32 v86, v86, v5, s[60:61]
  v_exp_f32 v86, v86
  v_mfma_f32_16x16x32_bf16 v[204:207], a[12:15], v[56:59], v[204:207]
  v_cndmask_b32 v87, v87, v5, s[62:63]
  v_exp_f32 v87, v87
  v_mfma_f32_16x16x32_bf16 v[236:239], a[12:15], v[60:63], v[236:239]
  s_waitcnt lgkmcnt(0)
  v_exp_f32 v88, v88
  v_cvt_pk_bf16_f32 v42, v84, v85
  v_mfma_f32_16x16x32_bf16 v[176:179], a[16:19], v[52:55], v[176:179]
  ds_read_b128 a[32:35], v4 offset:0
  ds_read_b128 a[36:39], v4 offset:1024
  v_cvt_pk_bf16_f32 v43, v86, v87
  v_mfma_f32_16x16x32_bf16 v[208:211], a[16:19], v[56:59], v[208:211]
  v_exp_f32 v89, v89
  v_mfma_f32_16x16x32_bf16 v[240:243], a[16:19], v[60:63], v[240:243]
  v_exp_f32 v90, v90
  v_cvt_pk_bf16_f32 v44, v88, v89
  v_mfma_f32_16x16x32_bf16 v[180:183], a[20:23], v[52:55], v[180:183]
  v_exp_f32 v91, v91
  v_mfma_f32_16x16x32_bf16 v[212:215], a[20:23], v[56:59], v[212:215]
  v_exp_f32 v92, v92
  v_cvt_pk_bf16_f32 v45, v90, v91
  v_mfma_f32_16x16x32_bf16 v[244:247], a[20:23], v[60:63], v[244:247]
  ds_read_b128 a[40:43], v4 offset:2048
  ds_read_b128 a[44:47], v4 offset:3072
  v_mfma_f32_16x16x32_bf16 v[184:187], a[24:27], v[52:55], v[184:187]
  v_exp_f32 v93, v93
  v_mfma_f32_16x16x32_bf16 v[216:219], a[24:27], v[56:59], v[216:219]
  v_exp_f32 v94, v94
  v_cvt_pk_bf16_f32 v46, v92, v93
  v_mfma_f32_16x16x32_bf16 v[248:251], a[24:27], v[60:63], v[248:251]
  v_exp_f32 v95, v95
  v_mfma_f32_16x16x32_bf16 v[188:191], a[28:31], v[52:55], v[188:191]
  ds_read_b128 a[48:51], v4 offset:4096
  ds_read_b128 a[52:55], v4 offset:5120
  v_cvt_pk_bf16_f32 v47, v94, v95
  v_mfma_f32_16x16x32_bf16 v[220:223], a[28:31], v[56:59], v[220:223]
  s_waitcnt vmcnt(0)
  s_barrier
  v_mfma_f32_16x16x32_bf16 v[252:255], a[28:31], v[60:63], v[252:255]
  ds_read_b128 a[56:59], v4 offset:6144
  ds_read_b128 a[60:63], v4 offset:7168
  ds_read_b128 a[0:3], v4 offset:8192
  ds_read_b128 a[4:7], v4 offset:9216
  ds_read_b128 a[8:11], v4 offset:10240
  s_lshl_b32 s4, s25, 20
  s_lshl_b32 s5, s24, 15
  s_add_u32 s4, s4, s5
  s_lshl_b32 s5, s3, 11
  s_add_u32 s4, s4, s5
  v_accvgpr_read_b32 v6, a192
  v_accvgpr_read_b32 v8, a196
  s_mov_b32 s5, 0x5f800000
  v_cmp_ngt_f32 vcc, s5, v6
  v_rcp_f32 v6, v6
  s_or_b32 s89, s89, vcc_lo
  s_or_b32 s89, s89, vcc_hi
  v_mov_b32 v7, v6
  v_cmp_ngt_f32 vcc, s5, v8
  v_rcp_f32 v8, v8
  s_or_b32 s89, s89, vcc_lo
  s_or_b32 s89, s89, vcc_hi
  v_mov_b32 v9, v8
  v_pk_mul_f32 v[128:129], v[128:129], v[6:7]
  v_pk_mul_f32 v[130:131], v[130:131], v[6:7]
  v_pk_mul_f32 v[132:133], v[132:133], v[6:7]
  v_pk_mul_f32 v[134:135], v[134:135], v[6:7]
  v_cvt_pk_bf16_f32 v128, v128, v129
  v_cvt_pk_bf16_f32 v129, v130, v131
  v_cvt_pk_bf16_f32 v130, v132, v133
  v_cvt_pk_bf16_f32 v131, v134, v135
  buffer_store_dwordx4 v[128:131], v2, s[16:19], s4 offen offset:0 sc1
  v_pk_mul_f32 v[160:161], v[160:161], v[8:9]
  v_pk_mul_f32 v[162:163], v[162:163], v[8:9]
  v_pk_mul_f32 v[164:165], v[164:165], v[8:9]
  v_pk_mul_f32 v[166:167], v[166:167], v[8:9]
  v_cvt_pk_bf16_f32 v160, v160, v161
  v_cvt_pk_bf16_f32 v161, v162, v163
  v_cvt_pk_bf16_f32 v162, v164, v165
  v_cvt_pk_bf16_f32 v163, v166, v167
  buffer_store_dwordx4 v[160:163], v2, s[16:19], s4 offen offset:1024 sc1
  s_add_u32 s4, s4, 8192
  v_pk_mul_f32 v[136:137], v[136:137], v[6:7]
  v_pk_mul_f32 v[138:139], v[138:139], v[6:7]
  v_pk_mul_f32 v[140:141], v[140:141], v[6:7]
  v_pk_mul_f32 v[142:143], v[142:143], v[6:7]
  v_cvt_pk_bf16_f32 v136, v136, v137
  v_cvt_pk_bf16_f32 v137, v138, v139
  v_cvt_pk_bf16_f32 v138, v140, v141
  v_cvt_pk_bf16_f32 v139, v142, v143
  buffer_store_dwordx4 v[136:139], v2, s[16:19], s4 offen offset:0 sc1
  v_pk_mul_f32 v[168:169], v[168:169], v[8:9]
  v_pk_mul_f32 v[170:171], v[170:171], v[8:9]
  v_pk_mul_f32 v[172:173], v[172:173], v[8:9]
  v_pk_mul_f32 v[174:175], v[174:175], v[8:9]
  v_cvt_pk_bf16_f32 v168, v168, v169
  v_cvt_pk_bf16_f32 v169, v170, v171
  v_cvt_pk_bf16_f32 v170, v172, v173
  v_cvt_pk_bf16_f32 v171, v174, v175
  buffer_store_dwordx4 v[168:171], v2, s[16:19], s4 offen offset:1024 sc1
  s_add_u32 s4, s4, 8192
  v_pk_mul_f32 v[144:145], v[144:145], v[6:7]
  v_pk_mul_f32 v[146:147], v[146:147], v[6:7]
  v_pk_mul_f32 v[148:149], v[148:149], v[6:7]
  v_pk_mul_f32 v[150:151], v[150:151], v[6:7]
  v_cvt_pk_bf16_f32 v144, v144, v145
  v_cvt_pk_bf16_f32 v145, v146, v147
  v_cvt_pk_bf16_f32 v146, v148, v149
  v_cvt_pk_bf16_f32 v147, v150, v151
  buffer_store_dwordx4 v[144:147], v2, s[16:19], s4 offen offset:0 sc1
  v_pk_mul_f32 v[176:177], v[176:177], v[8:9]
  v_pk_mul_f32 v[178:179], v[178:179], v[8:9]
  v_pk_mul_f32 v[180:181], v[180:181], v[8:9]
  v_pk_mul_f32 v[182:183], v[182:183], v[8:9]
  v_cvt_pk_bf16_f32 v176, v176, v177
  v_cvt_pk_bf16_f32 v177, v178, v179
  v_cvt_pk_bf16_f32 v178, v180, v181
  v_cvt_pk_bf16_f32 v179, v182, v183
  buffer_store_dwordx4 v[176:179], v2, s[16:19], s4 offen offset:1024 sc1
  s_add_u32 s4, s4, 8192
  v_pk_mul_f32 v[152:153], v[152:153], v[6:7]
  v_pk_mul_f32 v[154:155], v[154:155], v[6:7]
  v_pk_mul_f32 v[156:157], v[156:157], v[6:7]
  v_pk_mul_f32 v[158:159], v[158:159], v[6:7]
  v_cvt_pk_bf16_f32 v152, v152, v153
  v_cvt_pk_bf16_f32 v153, v154, v155
  v_cvt_pk_bf16_f32 v154, v156, v157
  v_cvt_pk_bf16_f32 v155, v158, v159
  buffer_store_dwordx4 v[152:155], v2, s[16:19], s4 offen offset:0 sc1
  v_pk_mul_f32 v[184:185], v[184:185], v[8:9]
  v_pk_mul_f32 v[186:187], v[186:187], v[8:9]
  v_pk_mul_f32 v[188:189], v[188:189], v[8:9]
  v_pk_mul_f32 v[190:191], v[190:191], v[8:9]
  v_cvt_pk_bf16_f32 v184, v184, v185
  v_cvt_pk_bf16_f32 v185, v186, v187
  v_cvt_pk_bf16_f32 v186, v188, v189
  v_cvt_pk_bf16_f32 v187, v190, v191
  buffer_store_dwordx4 v[184:187], v2, s[16:19], s4 offen offset:1024 sc1
  s_branch La_e1
La_e0:
  s_waitcnt lgkmcnt(7)
  v_mfma_f32_16x16x32_bf16 v[104:107], a[32:35], a[176:179], v[28:31]
  buffer_load_dwordx2 v[12:13], v14, s[96:99], s91 offen sc1
  ds_read_b128 a[12:15], v3 offset:11264
  v_mfma_f32_16x16x32_bf16 v[104:107], a[36:39], a[180:183], v[104:107]
  v_cndmask_b32 v64, v64, v5, s[32:33]
  v_exp_f32 v64, v64
  v_mfma_f32_16x16x32_bf16 v[104:107], a[40:43], a[184:187], v[104:107]
  v_cndmask_b32 v65, v65, v5, s[34:35]
  v_exp_f32 v65, v65
  v_mfma_f32_16x16x32_bf16 v[104:107], a[44:47], a[188:191], v[104:107]
  s_waitcnt lgkmcnt(4)
  v_cndmask_b32 v66, v66, v5, s[36:37]
  v_exp_f32 v66, v66
  v_mfma_f32_16x16x32_bf16 v[108:111], a[48:51], a[176:179], v[28:31]
  v_cndmask_b32 v67, v67, v5, s[38:39]
  v_exp_f32 v67, v67
  v_mfma_f32_16x16x32_bf16 v[108:111], a[52:55], a[180:183], v[108:111]
  ds_read_b128 a[16:19], v3 offset:12288
  ds_read_b128 a[20:23], v3 offset:13312
  v_mfma_f32_16x16x32_bf16 v[108:111], a[56:59], a[184:187], v[108:111]
  v_cndmask_b32 v68, v68, v5, s[40:41]
  v_exp_f32 v68, v68
  v_mfma_f32_16x16x32_bf16 v[108:111], a[60:63], a[188:191], v[108:111]
  s_waitcnt lgkmcnt(2)
  v_cndmask_b32 v69, v69, v5, s[42:43]
  v_exp_f32 v69, v69
  v_mfma_f32_16x16x32_bf16 v[120:123], a[0:3], a[176:179], v[28:31]
  ds_read_b128 a[24:27], v3 offset:14336
  ds_read_b128 a[28:31], v3 offset:15360
  v_mfma_f32_16x16x32_bf16 v[120:123], a[4:7], a[180:183], v[120:123]
  v_cndmask_b32 v70, v70, v5, s[44:45]
  v_exp_f32 v70, v70
  v_mfma_f32_16x16x32_bf16 v[120:123], a[8:11], a[184:187], v[120:123]
  v_cndmask_b32 v71, v71, v5, s[46:47]
  v_exp_f32 v71, v71
  v_mfma_f32_16x16x32_bf16 v[120:123], a[12:15], a[188:191], v[120:123]
  s_waitcnt lgkmcnt(0)
  ds_read_b128 a[32:35], v4 offset:0
  ds_read_b128 a[36:39], v4 offset:1024
  v_mfma_f32_16x16x32_bf16 v[124:127], a[16:19], a[176:179], v[28:31]
  v_exp_f32 v72, v72
  v_mfma_f32_16x16x32_bf16 v[124:127], a[20:23], a[180:183], v[124:127]
  ds_read_b128 a[40:43], v4 offset:2048
  ds_read_b128 a[44:47], v4 offset:3072
  ds_read_b128 a[48:51], v4 offset:4096
  v_mfma_f32_16x16x32_bf16 v[124:127], a[24:27], a[184:187], v[124:127]
  ds_read_b128 a[52:55], v4 offset:5120
  ds_read_b128 a[56:59], v4 offset:6144
  ds_read_b128 a[60:63], v4 offset:7168
  v_exp_f32 v73, v73
  v_mfma_f32_16x16x32_bf16 v[124:127], a[28:31], a[188:191], v[124:127]
  s_waitcnt lgkmcnt(0)
  v_exp_f32 v74, v74
  v_mfma_f32_16x16x32_bf16 v[192:195], a[32:35], v[48:51], v[192:195]
  ds_read_b128 a[0:3], v4 offset:8192
  ds_read_b128 a[4:7], v4 offset:9216
  v_mfma_f32_16x16x32_bf16 v[224:227], a[32:35], v[52:55], v[224:227]
  v_exp_f32 v75, v75
  v_mfma_f32_16x16x32_bf16 a[200:203], a[208:211], v[48:51], a[200:203]
  v_exp_f32 v76, v76
  v_mfma_f32_16x16x32_bf16 v[196:199], a[36:39], v[48:51], v[196:199]
  ds_read_b128 a[8:11], v4 offset:10240
  ds_read_b128 a[12:15], v4 offset:11264
  v_mfma_f32_16x16x32_bf16 v[228:231], a[36:39], v[52:55], v[228:231]
  v_exp_f32 v77, v77
  v_mfma_f32_16x16x32_bf16 a[204:207], a[208:211], v[52:55], a[204:207]
  v_exp_f32 v78, v78
  v_mfma_f32_16x16x32_bf16 v[200:203], a[40:43], v[48:51], v[200:203]
  ds_read_b128 a[16:19], v4 offset:12288
  ds_read_b128 a[20:23], v4 offset:13312
  v_mfma_f32_16x16x32_bf16 v[232:235], a[40:43], v[52:55], v[232:235]
  v_exp_f32 v79, v79
  v_mfma_f32_16x16x32_bf16 v[204:207], a[44:47], v[48:51], v[204:207]
  ds_read_b128 a[24:27], v4 offset:14336
  v_cvt_pk_bf16_f32 v32, v64, v65
  v_mfma_f32_16x16x32_bf16 v[236:239], a[44:47], v[52:55], v[236:239]
  v_cndmask_b32 v80, v80, v5, s[48:49]
  v_exp_f32 v80, v80
  v_mfma_f32_16x16x32_bf16 v[208:211], a[48:51], v[48:51], v[208:211]
  v_cndmask_b32 v81, v81, v5, s[50:51]
  v_exp_f32 v81, v81
  v_mfma_f32_16x16x32_bf16 v[240:243], a[48:51], v[52:55], v[240:243]
  ds_read_b128 a[28:31], v4 offset:15360
  v_xor_b32 v4, 0x8000, v4
  v_cvt_pk_bf16_f32 v40, v80, v81
  v_mfma_f32_16x16x32_bf16 v[212:215], a[52:55], v[48:51], v[212:215]
  v_cndmask_b32 v82, v82, v5, s[52:53]
  v_exp_f32 v82, v82
  v_mfma_f32_16x16x32_bf16 v[244:247], a[52:55], v[52:55], v[244:247]
  v_cndmask_b32 v83, v83, v5, s[54:55]
  v_exp_f32 v83, v83
  v_mfma_f32_16x16x32_bf16 v[216:219], a[56:59], v[48:51], v[216:219]
  ds_read_b128 a[32:35], v4 offset:0
  ds_read_b128 a[36:39], v4 offset:1024
  v_cvt_pk_bf16_f32 v41, v82, v83
  v_mfma_f32_16x16x32_bf16 v[248:251], a[56:59], v[52:55], v[248:251]
  v_cndmask_b32 v84, v84, v5, s[56:57]
  v_exp_f32 v84, v84
  v_mfma_f32_16x16x32_bf16 v[220:223], a[60:63], v[48:51], v[220:223]
  v_cndmask_b32 v85, v85, v5, s[58:59]
  v_exp_f32 v85, v85
  v_mfma_f32_16x16x32_bf16 v[252:255], a[60:63], v[52:55], v[252:255]
  s_waitcnt lgkmcnt(2)
  ds_read_b128 a[40:43], v4 offset:2048
  v_cvt_pk_bf16_f32 v33, v66, v67
  v_cvt_pk_bf16_f32 v42, v84, v85
  v_mfma_f32_16x16x32_bf16 v[192:195], a[0:3], v[56:59], v[192:195]
  v_cndmask_b32 v86, v86, v5, s[60:61]
  v_exp_f32 v86, v86
  v_mfma_f32_16x16x32_bf16 v[224:227], a[0:3], v[60:63], v[224:227]
  v_cndmask_b32 v87, v87, v5, s[62:63]
  v_exp_f32 v87, v87
  v_mfma_f32_16x16x32_bf16 a[200:203], a[208:211], v[56:59], a[200:203]
  ds_read_b128 a[44:47], v4 offset:3072
  v_cvt_pk_bf16_f32 v34, v68, v69
  v_cvt_pk_bf16_f32 v43, v86, v87
  v_mfma_f32_16x16x32_bf16 v[196:199], a[4:7], v[56:59], v[196:199]
  v_exp_f32 v88, v88
  v_mfma_f32_16x16x32_bf16 v[228:231], a[4:7], v[60:63], v[228:231]
  ds_read_b128 a[48:51], v4 offset:4096
  v_cvt_pk_bf16_f32 v35, v70, v71
  v_mfma_f32_16x16x32_bf16 a[204:207], a[208:211], v[60:63], a[204:207]
  v_exp_f32 v89, v89
  v_mfma_f32_16x16x32_bf16 v[200:203], a[8:11], v[56:59], v[200:203]
  v_exp_f32 v90, v90
  v_cvt_pk_bf16_f32 v44, v88, v89
  v_mfma_f32_16x16x32_bf16 v[232:235], a[8:11], v[60:63], v[232:235]
  ds_read_b128 a[52:55], v4 offset:5120
  v_cvt_pk_bf16_f32 v36, v72, v73
  v_mfma_f32_16x16x32_bf16 v[204:207], a[12:15], v[56:59], v[204:207]
  v_exp_f32 v91, v91
  v_mfma_f32_16x16x32_bf16 v[236:239], a[12:15], v[60:63], v[236:239]
  v_exp_f32 v92, v92
  v_cvt_pk_bf16_f32 v45, v90, v91
  v_mfma_f32_16x16x32_bf16 v[208:211], a[16:19], v[56:59], v[208:211]
  ds_read_b128 a[56:59], v4 offset:6144
  ds_read_b128 a[60:63], v4 offset:7168
  v_mfma_f32_16x16x32_bf16 v[240:243], a[16:19], v[60:63], v[240:243]
  v_exp_f32 v93, v93
  v_mfma_f32_16x16x32_bf16 v[212:215], a[20:23], v[56:59], v[212:215]
  v_exp_f32 v94, v94
  v_cvt_pk_bf16_f32 v46, v92, v93
  v_mfma_f32_16x16x32_bf16 v[244:247], a[20:23], v[60:63], v[244:247]
  ds_read_b128 a[0:3], v4 offset:8192
  v_cvt_pk_bf16_f32 v37, v74, v75
  v_mfma_f32_16x16x32_bf16 v[216:219], a[24:27], v[56:59], v[216:219]
  v_exp_f32 v95, v95
  v_mfma_f32_16x16x32_bf16 v[248:251], a[24:27], v[60:63], v[248:251]
  ds_read_b128 a[4:7], v4 offset:9216
  v_cvt_pk_bf16_f32 v38, v76, v77
  v_cvt_pk_bf16_f32 v47, v94, v95
  v_mfma_f32_16x16x32_bf16 v[220:223], a[28:31], v[56:59], v[220:223]
  s_waitcnt vmcnt(0)
  s_barrier
  v_mfma_f32_16x16x32_bf16 v[252:255], a[28:31], v[60:63], v[252:255]
  ds_read_b128 a[8:11], v4 offset:10240
  v_cvt_pk_bf16_f32 v39, v78, v79
La_e1:
  s_mov_b32 s5, 0x40000
Lpoll_13:
  v_cmp_ne_u64 vcc, s[94:95], v[12:13]
  s_nop 0
  s_cbranch_vccz Lpolld_14
  s_sleep 4
  buffer_load_dwordx2 v[12:13], v14, s[96:99], s91 offen sc1
  s_sub_u32 s5, s5, 1
  s_waitcnt vmcnt(0)
  s_cbranch_scc0 Lpoll_13
Lpolld_14:
  v_accvgpr_read_b32 v10, a212
  v_accvgpr_read_b32 v11, a213
  v_accvgpr_read_b32 v12, a214
  v_accvgpr_read_b32 v13, a215
  s_mov_b32 s12, s80
  s_mov_b32 s13, s81
  s_mov_b32 s14, 2097152
  s_mov_b32 s15, 0x00020000
  s_lshl_b32 s93, s77, 20
  s_lshl_b32 s72, s76, 8
  s_add_u32 s93, s93, s72
  s_add_u32 s72, s73, s76
  s_and_b32 s31, s72, 3
  s_lshl_b32 s31, s31, 3
  s_or_b32 s31, s31, 0x80000
  s_bfe_u32 s30, 0x70702, s31
  s_add_u32 s30, s30, 0
  s_and_b32 s30, s30, 7
  s_lshl_b32 s72, s30, 17
  s_add_u32 s71, s93, s72
  s_add_u32 s8, s86, 83886080
  s_addc_u32 s9, s87, 0
  s_mov_b32 s10, 4194304
  s_mov_b32 s11, 0x00020000
  s_lshl_b32 s92, s73, 1
  s_add_u32 s92, s92, s77
  s_lshl_b32 s92, s92, 17
  s_add_u32 s92, s92, s79
  s_add_u32 s72, s73, s76
  s_and_b32 s1, s72, 3
  s_lshl_b32 s1, s1, 3
  s_or_b32 s1, s1, 0x80000
  s_bfe_u32 s0, 0x70702, s1
  s_add_u32 s0, s0, 0
  s_and_b32 s0, s0, 7
  s_lshl_b32 s72, s0, 14
  s_add_u32 s70, s92, s72
  s_waitcnt lgkmcnt(3)
  v_mfma_f32_16x16x32_bf16 v[192:195], a[32:35], v[32:35], v[192:195]
  s_add_u32 m0, s79, 147456
  ds_read_b128 a[12:15], v4 offset:11264
  v_cndmask_b32 v104, v104, v5, s[32:33]
  v_mfma_f32_16x16x32_bf16 v[224:227], a[32:35], v[36:39], v[224:227]
  v_exp_f32 v104, v104
  v_mfma_f32_16x16x32_bf16 a[200:203], a[208:211], v[32:35], a[200:203]
  v_cndmask_b32 v105, v105, v5, s[34:35]
  v_exp_f32 v105, v105
  v_mfma_f32_16x16x32_bf16 v[196:199], a[36:39], v[32:35], v[196:199]
  buffer_load_dwordx4 v10, s[12:15], s71 offen offset:0 lds
  ds_read_b128 a[16:19], v4 offset:12288
  v_mfma_f32_16x16x32_bf16 v[228:231], a[36:39], v[36:39], v[228:231]
  v_cndmask_b32 v106, v106, v5, s[36:37]
  v_exp_f32 v106, v106
  v_mfma_f32_16x16x32_bf16 a[204:207], a[208:211], v[36:39], a[204:207]
  buffer_load_dwordx4 v11, s[12:15], s71 offen offset:1024 lds
  v_cndmask_b32 v107, v107, v5, s[38:39]
  v_mfma_f32_16x16x32_bf16 v[200:203], a[40:43], v[32:35], v[200:203]
  v_exp_f32 v107, v107
  v_mfma_f32_16x16x32_bf16 v[232:235], a[40:43], v[36:39], v[232:235]
  ds_read_b128 a[20:23], v4 offset:13312
  v_cndmask_b32 v108, v108, v5, s[40:41]
  v_mfma_f32_16x16x32_bf16 v[204:207], a[44:47], v[32:35], v[204:207]
  v_exp_f32 v108, v108
  v_mfma_f32_16x16x32_bf16 v[236:239], a[44:47], v[36:39], v[236:239]
  buffer_load_dwordx4 v12, s[12:15], s71 offen offset:2048 lds
  ds_read_b128 a[24:27], v4 offset:14336
  v_mfma_f32_16x16x32_bf16 v[208:211], a[48:51], v[32:35], v[208:211]
  v_cndmask_b32 v109, v109, v5, s[42:43]
  v_exp_f32 v109, v109
  v_mfma_f32_16x16x32_bf16 v[240:243], a[48:51], v[36:39], v[240:243]
  ds_read_b128 a[28:31], v4 offset:15360
  v_xor_b32 v4, 0x4000, v4
  v_mfma_f32_16x16x32_bf16 v[212:215], a[52:55], v[32:35], v[212:215]
  v_cndmask_b32 v110, v110, v5, s[44:45]
  v_exp_f32 v110, v110
  v_mfma_f32_16x16x32_bf16 v[244:247], a[52:55], v[36:39], v[244:247]
  buffer_load_dwordx4 v13, s[12:15], s71 offen offset:3072 lds
  ds_read_b128 a[32:35], v4 offset:0
  v_mfma_f32_16x16x32_bf16 v[216:219], a[56:59], v[32:35], v[216:219]
  s_bfe_u32 s72, 0x3020106, s31
  v_cndmask_b32 v111, v111, v5, s[46:47]
  v_exp_f32 v111, v111
  v_mfma_f32_16x16x32_bf16 v[248:251], a[56:59], v[36:39], v[248:251]
  s_add_u32 s30, s30, s72
  s_add_u32 s31, s31, 8
  s_and_b32 s31, s31, 0x8001f
  v_mfma_f32_16x16x32_bf16 v[220:223], a[60:63], v[32:35], v[220:223]
  s_and_b32 s30, s30, 7
  s_lshl_b32 s72, s30, 17
  s_add_u32 s71, s93, s72
  v_mfma_f32_16x16x32_bf16 v[252:255], a[60:63], v[36:39], v[252:255]
  s_waitcnt lgkmcnt(1)
  v_cndmask_b32 v120, v120, v5, s[48:49]
  v_exp_f32 v120, v120
  v_mfma_f32_16x16x32_bf16 v[192:195], a[0:3], v[40:43], v[192:195]
  s_add_u32 m0, s79, 131072
  ds_read_b128 a[36:39], v4 offset:1024
  ds_read_b128 a[40:43], v4 offset:2048
  v_mfma_f32_16x16x32_bf16 v[224:227], a[0:3], v[44:47], v[224:227]
  v_cndmask_b32 v121, v121, v5, s[50:51]
  v_exp_f32 v121, v121
  v_mfma_f32_16x16x32_bf16 a[200:203], a[208:211], v[40:43], a[200:203]
  buffer_load_dwordx4 v2, s[8:11], s70 offen offset:0 sc1 lds
  ds_read_b128 a[44:47], v4 offset:3072
  v_mfma_f32_16x16x32_bf16 v[196:199], a[4:7], v[40:43], v[196:199]
  v_cndmask_b32 v122, v122, v5, s[52:53]
  v_exp_f32 v122, v122
  v_mfma_f32_16x16x32_bf16 v[228:231], a[4:7], v[44:47], v[228:231]
  buffer_load_dwordx4 v2, s[8:11], s70 offen offset:1024 sc1 lds
  ds_read_b128 a[48:51], v4 offset:4096
  v_mfma_f32_16x16x32_bf16 a[204:207], a[208:211], v[44:47], a[204:207]
  v_cndmask_b32 v123, v123, v5, s[54:55]
  v_exp_f32 v123, v123
  v_mfma_f32_16x16x32_bf16 v[200:203], a[8:11], v[40:43], v[200:203]
  buffer_load_dwordx4 v2, s[8:11], s70 offen offset:2048 sc1 lds
  ds_read_b128 a[52:55], v4 offset:5120
  v_cvt_pk_bf16_f32 v61, v122, v123
  v_mfma_f32_16x16x32_bf16 v[232:235], a[8:11], v[44:47], v[232:235]
  v_cndmask_b32 v124, v124, v5, s[56:57]
  v_exp_f32 v124, v124
  v_mfma_f32_16x16x32_bf16 v[204:207], a[12:15], v[40:43], v[204:207]
  ds_read_b128 a[56:59], v4 offset:6144
  v_cvt_pk_bf16_f32 v52, v104, v105
  v_mfma_f32_16x16x32_bf16 v[236:239], a[12:15], v[44:47], v[236:239]
  v_cndmask_b32 v125, v125, v5, s[58:59]
  v_exp_f32 v125, v125
  v_mfma_f32_16x16x32_bf16 v[208:211], a[16:19], v[40:43], v[208:211]
  buffer_load_dwordx4 v2, s[8:11], s70 offen offset:3072 sc1 lds
  ds_read_b128 a[60:63], v4 offset:7168
  v_cvt_pk_bf16_f32 v62, v124, v125
  v_mfma_f32_16x16x32_bf16 v[240:243], a[16:19], v[44:47], v[240:243]
  s_bfe_u32 s72, 0x3020106, s1
  v_cndmask_b32 v126, v126, v5, s[60:61]
  v_exp_f32 v126, v126
  v_mfma_f32_16x16x32_bf16 v[212:215], a[20:23], v[40:43], v[212:215]
  s_add_u32 s0, s0, s72
  s_add_u32 s1, s1, 8
  s_and_b32 s1, s1, 0x8001f
  v_mfma_f32_16x16x32_bf16 v[244:247], a[20:23], v[44:47], v[244:247]
  s_and_b32 s0, s0, 7
  v_cndmask_b32 v127, v127, v5, s[62:63]
  v_exp_f32 v127, v127
  v_mfma_f32_16x16x32_bf16 v[216:219], a[24:27], v[40:43], v[216:219]
  s_lshl_b32 s72, s0, 14
  s_add_u32 s70, s92, s72
  ds_read_b128 a[0:3], v4 offset:8192
  v_cvt_pk_bf16_f32 v63, v126, v127
  v_mfma_f32_16x16x32_bf16 v[248:251], a[24:27], v[44:47], v[248:251]
  ds_read_b128 a[4:7], v4 offset:9216
  v_cvt_pk_bf16_f32 v53, v106, v107
  v_mfma_f32_16x16x32_bf16 v[220:223], a[28:31], v[40:43], v[220:223]
  ds_read_b128 a[8:11], v4 offset:10240
  v_cvt_pk_bf16_f32 v54, v108, v109
  v_mfma_f32_16x16x32_bf16 v[252:255], a[28:31], v[44:47], v[252:255]
  v_cvt_pk_bf16_f32 v55, v110, v111
  v_cvt_pk_bf16_f32 v60, v120, v121
  s_waitcnt lgkmcnt(7)
  v_mfma_f32_16x16x32_bf16 v[224:227], a[32:35], v[52:55], v[224:227]
  s_add_u32 m0, s79, 49152
  ds_read_b128 a[12:15], v4 offset:11264
  v_mfma_f32_16x16x32_bf16 a[204:207], a[208:211], v[52:55], a[204:207]
  buffer_load_dwordx4 v10, s[12:15], s71 offen offset:0 lds
  v_mfma_f32_16x16x32_bf16 v[228:231], a[36:39], v[52:55], v[228:231]
  buffer_load_dwordx4 v11, s[12:15], s71 offen offset:1024 lds
  ds_read_b128 a[16:19], v4 offset:12288
  v_mfma_f32_16x16x32_bf16 v[232:235], a[40:43], v[52:55], v[232:235]
  buffer_load_dwordx4 v12, s[12:15], s71 offen offset:2048 lds
  ds_read_b128 a[20:23], v4 offset:13312
  v_mfma_f32_16x16x32_bf16 v[236:239], a[44:47], v[52:55], v[236:239]
  s_waitcnt lgkmcnt(6)
  ds_read_b128 a[24:27], v4 offset:14336
  v_mfma_f32_16x16x32_bf16 v[240:243], a[48:51], v[52:55], v[240:243]
  buffer_load_dwordx4 v13, s[12:15], s71 offen offset:3072 lds
  ds_read_b128 a[28:31], v4 offset:15360
  v_mfma_f32_16x16x32_bf16 v[244:247], a[52:55], v[52:55], v[244:247]
  s_bfe_u32 s72, 0x3020106, s31
  s_add_u32 s30, s30, s72
  s_add_u32 s31, s31, 8
  v_mfma_f32_16x16x32_bf16 v[248:251], a[56:59], v[52:55], v[248:251]
  s_and_b32 s31, s31, 0x8001f
  s_and_b32 s30, s30, 7
  s_lshl_b32 s72, s30, 17
  v_mfma_f32_16x16x32_bf16 v[252:255], a[60:63], v[52:55], v[252:255]
  s_waitcnt lgkmcnt(4)
  s_add_u32 s71, s93, s72
  s_add_u32 m0, s79, 32768
  v_mfma_f32_16x16x32_bf16 v[224:227], a[0:3], v[60:63], v[224:227]
  buffer_load_dwordx4 v2, s[8:11], s70 offen offset:0 sc1 lds
  v_mfma_f32_16x16x32_bf16 a[204:207], a[208:211], v[60:63], a[204:207]
  buffer_load_dwordx4 v2, s[8:11], s70 offen offset:1024 sc1 lds
  v_mfma_f32_16x16x32_bf16 v[228:231], a[4:7], v[60:63], v[228:231]
  buffer_load_dwordx4 v2, s[8:11], s70 offen offset:2048 sc1 lds
  v_mfma_f32_16x16x32_bf16 v[232:235], a[8:11], v[60:63], v[232:235]
  buffer_load_dwordx4 v2, s[8:11], s70 offen offset:3072 sc1 lds
  v_mfma_f32_16x16x32_bf16 v[236:239], a[12:15], v[60:63], v[236:239]
  s_waitcnt lgkmcnt(0)
  s_bfe_u32 s72, 0x3020106, s1
  s_add_u32 s0, s0, s72
  v_mfma_f32_16x16x32_bf16 v[240:243], a[16:19], v[60:63], v[240:243]
  s_add_u32 s1, s1, 8
  s_and_b32 s1, s1, 0x8001f
  s_and_b32 s0, s0, 7
  v_mfma_f32_16x16x32_bf16 v[244:247], a[20:23], v[60:63], v[244:247]
  s_lshl_b32 s72, s0, 14
  s_add_u32 s70, s92, s72
  v_mfma_f32_16x16x32_bf16 v[248:251], a[24:27], v[60:63], v[248:251]
  v_mfma_f32_16x16x32_bf16 v[252:255], a[28:31], v[60:63], v[252:255]
  s_sub_u32 s88, 15, s25
  s_lshl_b32 s4, s88, 20
  s_lshl_b32 s5, s24, 15
  s_add_u32 s4, s4, s5
  s_lshl_b32 s5, s3, 11
  s_add_u32 s4, s4, s5
  v_accvgpr_read_b32 v6, a200
  v_accvgpr_read_b32 v8, a204
  s_mov_b32 s5, 0x5f800000
  v_cmp_ngt_f32 vcc, s5, v6
  v_rcp_f32 v6, v6
  s_or_b32 s89, s89, vcc_lo
  s_or_b32 s89, s89, vcc_hi
  v_mov_b32 v7, v6
  v_cmp_ngt_f32 vcc, s5, v8
  v_rcp_f32 v8, v8
  s_or_b32 s89, s89, vcc_lo
  s_or_b32 s89, s89, vcc_hi
  v_mov_b32 v9, v8
  v_pk_mul_f32 v[192:193], v[192:193], v[6:7]
  v_pk_mul_f32 v[194:195], v[194:195], v[6:7]
  v_pk_mul_f32 v[196:197], v[196:197], v[6:7]
  v_pk_mul_f32 v[198:199], v[198:199], v[6:7]
  v_cvt_pk_bf16_f32 v192, v192, v193
  v_cvt_pk_bf16_f32 v193, v194, v195
  v_cvt_pk_bf16_f32 v194, v196, v197
  v_cvt_pk_bf16_f32 v195, v198, v199
  buffer_store_dwordx4 v[192:195], v2, s[16:19], s4 offen offset:0 sc1
  v_pk_mul_f32 v[224:225], v[224:225], v[8:9]
  v_pk_mul_f32 v[226:227], v[226:227], v[8:9]
  v_pk_mul_f32 v[228:229], v[228:229], v[8:9]
  v_pk_mul_f32 v[230:231], v[230:231], v[8:9]
  v_cvt_pk_bf16_f32 v224, v224, v225
  v_cvt_pk_bf16_f32 v225, v226, v227
  v_cvt_pk_bf16_f32 v226, v228, v229
  v_cvt_pk_bf16_f32 v227, v230, v231
  buffer_store_dwordx4 v[224:227], v2, s[16:19], s4 offen offset:1024 sc1
  s_add_u32 s4, s4, 8192
  v_pk_mul_f32 v[200:201], v[200:201], v[6:7]
  v_pk_mul_f32 v[202:203], v[202:203], v[6:7]
  v_pk_mul_f32 v[204:205], v[204:205], v[6:7]
  v_pk_mul_f32 v[206:207], v[206:207], v[6:7]
  v_cvt_pk_bf16_f32 v200, v200, v201
  v_cvt_pk_bf16_f32 v201, v202, v203
  v_cvt_pk_bf16_f32 v202, v204, v205
  v_cvt_pk_bf16_f32 v203, v206, v207
  buffer_store_dwordx4 v[200:203], v2, s[16:19], s4 offen offset:0 sc1
  v_pk_mul_f32 v[232:233], v[232:233], v[8:9]
  v_pk_mul_f32 v[234:235], v[234:235], v[8:9]
  v_pk_mul_f32 v[236:237], v[236:237], v[8:9]
  v_pk_mul_f32 v[238:239], v[238:239], v[8:9]
  v_cvt_pk_bf16_f32 v232, v232, v233
  v_cvt_pk_bf16_f32 v233, v234, v235
  v_cvt_pk_bf16_f32 v234, v236, v237
  v_cvt_pk_bf16_f32 v235, v238, v239
  buffer_store_dwordx4 v[232:235], v2, s[16:19], s4 offen offset:1024 sc1
  s_add_u32 s4, s4, 8192
  v_pk_mul_f32 v[208:209], v[208:209], v[6:7]
  v_pk_mul_f32 v[210:211], v[210:211], v[6:7]
  v_pk_mul_f32 v[212:213], v[212:213], v[6:7]
  v_pk_mul_f32 v[214:215], v[214:215], v[6:7]
  v_cvt_pk_bf16_f32 v208, v208, v209
  v_cvt_pk_bf16_f32 v209, v210, v211
  v_cvt_pk_bf16_f32 v210, v212, v213
  v_cvt_pk_bf16_f32 v211, v214, v215
  buffer_store_dwordx4 v[208:211], v2, s[16:19], s4 offen offset:0 sc1
  v_pk_mul_f32 v[240:241], v[240:241], v[8:9]
  v_pk_mul_f32 v[242:243], v[242:243], v[8:9]
  v_pk_mul_f32 v[244:245], v[244:245], v[8:9]
  v_pk_mul_f32 v[246:247], v[246:247], v[8:9]
  v_cvt_pk_bf16_f32 v240, v240, v241
  v_cvt_pk_bf16_f32 v241, v242, v243
  v_cvt_pk_bf16_f32 v242, v244, v245
  v_cvt_pk_bf16_f32 v243, v246, v247
  buffer_store_dwordx4 v[240:243], v2, s[16:19], s4 offen offset:1024 sc1
  s_add_u32 s4, s4, 8192
  v_pk_mul_f32 v[216:217], v[216:217], v[6:7]
  v_pk_mul_f32 v[218:219], v[218:219], v[6:7]
  v_pk_mul_f32 v[220:221], v[220:221], v[6:7]
  v_pk_mul_f32 v[222:223], v[222:223], v[6:7]
  v_cvt_pk_bf16_f32 v216, v216, v217
  v_cvt_pk_bf16_f32 v217, v218, v219
  v_cvt_pk_bf16_f32 v218, v220, v221
  v_cvt_pk_bf16_f32 v219, v222, v223
  buffer_store_dwordx4 v[216:219], v2, s[16:19], s4 offen offset:0 sc1
  v_pk_mul_f32 v[248:249], v[248:249], v[8:9]
  v_pk_mul_f32 v[250:251], v[250:251], v[8:9]
  v_pk_mul_f32 v[252:253], v[252:253], v[8:9]
  v_pk_mul_f32 v[254:255], v[254:255], v[8:9]
  v_cvt_pk_bf16_f32 v248, v248, v249
  v_cvt_pk_bf16_f32 v249, v250, v251
  v_cvt_pk_bf16_f32 v250, v252, v253
  v_cvt_pk_bf16_f32 v251, v254, v255
  buffer_store_dwordx4 v[248:251], v2, s[16:19], s4 offen offset:1024 sc1
  s_cmp_eq_u32 s89, 0
  s_cbranch_scc1 La_done
  s_waitcnt vmcnt(0)
  s_sub_u32 s6, 15, s25
La_sl_blk:
  v_mov_b32 v192, 0
  v_mov_b32 v193, 0
  v_mov_b32 v194, 0
  v_mov_b32 v195, 0
  v_mov_b32 v196, 0
  v_mov_b32 v197, 0
  v_mov_b32 v198, 0
  v_mov_b32 v199, 0
  v_mov_b32 v200, 0
  v_mov_b32 v201, 0
  v_mov_b32 v202, 0
  v_mov_b32 v203, 0
  v_mov_b32 v204, 0
  v_mov_b32 v205, 0
  v_mov_b32 v206, 0
  v_mov_b32 v207, 0
  v_mov_b32 v208, 0
  v_mov_b32 v209, 0
  v_mov_b32 v210, 0
  v_mov_b32 v211, 0
  v_mov_b32 v212, 0
  v_mov_b32 v213, 0
  v_mov_b32 v214, 0
  v_mov_b32 v215, 0
  v_mov_b32 v216, 0
  v_mov_b32 v217, 0
  v_mov_b32 v218, 0
  v_mov_b32 v219, 0
  v_mov_b32 v220, 0
  v_mov_b32 v221, 0
  v_mov_b32 v222, 0
  v_mov_b32 v223, 0
  v_mov_b32 v224, 0
  v_mov_b32 v225, 0
  v_mov_b32 v226, 0
  v_mov_b32 v227, 0
  v_mov_b32 v228, 0
  v_mov_b32 v229, 0
  v_mov_b32 v230, 0
  v_mov_b32 v231, 0
  v_mov_b32 v232, 0
  v_mov_b32 v233, 0
  v_mov_b32 v234, 0
  v_mov_b32 v235, 0
  v_mov_b32 v236, 0
  v_mov_b32 v237, 0
  v_mov_b32 v238, 0
  v_mov_b32 v239, 0
  v_mov_b32 v240, 0
  v_mov_b32 v241, 0
  v_mov_b32 v242, 0
  v_mov_b32 v243, 0
  v_mov_b32 v244, 0
  v_mov_b32 v245, 0
  v_mov_b32 v246, 0
  v_mov_b32 v247, 0
  v_mov_b32 v248, 0
  v_mov_b32 v249, 0
  v_mov_b32 v250, 0
  v_mov_b32 v251, 0
  v_mov_b32 v252, 0
  v_mov_b32 v253, 0
  v_mov_b32 v254, 0
  v_mov_b32 v255, 0
  v_mov_b32 v24, 0
  v_mov_b32 v25, 0
  v_mov_b32 v26, 0
  v_mov_b32 v27, 0
  v_mov_b32 v28, 0
  v_mov_b32 v29, 0
  v_mov_b32 v30, 0
  v_mov_b32 v31, 0
  v_mov_b32 v16, v5
  v_mov_b32 v17, v5
  v_and_b32 v20, 15, v1
  v_lshrrev_b32 v21, 4, v1
  v_sub_u32 v20, v20, v21
  v_lshlrev_b32 v20, 2, v20
  s_lshl_b32 s4, s6, 7
  s_add_u32 s4, s4, s3
  v_add_u32 v20, s4, v20
  v_add_u32 v21, 64, v20
  s_add_u32 s7, s6, 1
  s_lshl_b32 s7, s7, 2
  s_mov_b32 s90, 0
La_sl_loop:
  s_add_u32 s4, s90, 0
  buffer_load_dwordx4 a[0:3], v2, s[20:23], s4 offen offset:0 sc1
  buffer_load_dwordx4 a[4:7], v2, s[20:23], s4 offen offset:1024 sc1
  buffer_load_dwordx4 a[8:11], v2, s[20:23], s4 offen offset:2048 sc1
  buffer_load_dwordx4 a[12:15], v2, s[20:23], s4 offen offset:3072 sc1
  s_add_u32 s4, s90, 4096
  buffer_load_dwordx4 a[16:19], v2, s[20:23], s4 offen offset:0 sc1
  buffer_load_dwordx4 a[20:23], v2, s[20:23], s4 offen offset:1024 sc1
  buffer_load_dwordx4 a[24:27], v2, s[20:23], s4 offen offset:2048 sc1
  buffer_load_dwordx4 a[28:31], v2, s[20:23], s4 offen offset:3072 sc1
  s_add_u32 s4, s90, 16384
  buffer_load_dwordx4 a[32:35], v2, s[20:23], s4 offen offset:0 sc1
  buffer_load_dwordx4 a[36:39], v2, s[20:23], s4 offen offset:1024 sc1
  buffer_load_dwordx4 a[40:43], v2, s[20:23], s4 offen offset:2048 sc1
  buffer_load_dwordx4 a[44:47], v2, s[20:23], s4 offen offset:3072 sc1
  s_add_u32 s4, s90, 20480
  buffer_load_dwordx4 a[48:51], v2, s[20:23], s4 offen offset:0 sc1
  buffer_load_dwordx4 a[52:55], v2, s[20:23], s4 offen offset:1024 sc1
  buffer_load_dwordx4 a[56:59], v2, s[20:23], s4 offen offset:2048 sc1
  buffer_load_dwordx4 a[60:63], v2, s[20:23], s4 offen offset:3072 sc1
  s_waitcnt vmcnt(0)
  v_mfma_f32_16x16x32_bf16 v[64:67], a[0:3], a[160:163], 0
  v_mfma_f32_16x16x32_bf16 v[72:75], a[0:3], a[176:179], 0
  v_mfma_f32_16x16x32_bf16 v[64:67], a[4:7], a[164:167], v[64:67]
  v_mfma_f32_16x16x32_bf16 v[72:75], a[4:7], a[180:183], v[72:75]
  v_mfma_f32_16x16x32_bf16 v[64:67], a[8:11], a[168:171], v[64:67]
  v_mfma_f32_16x16x32_bf16 v[72:75], a[8:11], a[184:187], v[72:75]
  v_mfma_f32_16x16x32_bf16 v[64:67], a[12:15], a[172:175], v[64:67]
  v_mfma_f32_16x16x32_bf16 v[72:75], a[12:15], a[188:191], v[72:75]
  v_mfma_f32_16x16x32_bf16 v[68:71], a[16:19], a[160:163], 0
  v_mfma_f32_16x16x32_bf16 v[76:79], a[16:19], a[176:179], 0
  v_mfma_f32_16x16x32_bf16 v[68:71], a[20:23], a[164:167], v[68:71]
  v_mfma_f32_16x16x32_bf16 v[76:79], a[20:23], a[180:183], v[76:79]
  v_mfma_f32_16x16x32_bf16 v[68:71], a[24:27], a[168:171], v[68:71]
  v_mfma_f32_16x16x32_bf16 v[76:79], a[24:27], a[184:187], v[76:79]
  v_mfma_f32_16x16x32_bf16 v[68:71], a[28:31], a[172:175], v[68:71]
  v_mfma_f32_16x16x32_bf16 v[76:79], a[28:31], a[188:191], v[76:79]
  v_cmp_gt_i32 vcc, 0, v20
  s_nop 1
  v_cndmask_b32 v64, v64, v5, vcc
  v_cmp_gt_i32 vcc, 1, v20
  s_nop 1
  v_cndmask_b32 v65, v65, v5, vcc
  v_cmp_gt_i32 vcc, 2, v20
  s_nop 1
  v_cndmask_b32 v66, v66, v5, vcc
  v_cmp_gt_i32 vcc, 3, v20
  s_nop 1
  v_cndmask_b32 v67, v67, v5, vcc
  v_cmp_gt_i32 vcc, 16, v20
  s_nop 1
  v_cndmask_b32 v68, v68, v5, vcc
  v_cmp_gt_i32 vcc, 17, v20
  s_nop 1
  v_cndmask_b32 v69, v69, v5, vcc
  v_cmp_gt_i32 vcc, 18, v20
  s_nop 1
  v_cndmask_b32 v70, v70, v5, vcc
  v_cmp_gt_i32 vcc, 19, v20
  s_nop 1
  v_cndmask_b32 v71, v71, v5, vcc
  v_subrev_u32 v20, 32, v20
  v_max3_f32 v6, v64, v65, v66
  v_max3_f32 v7, v67, v68, v69
  v_max3_f32 v6, v6, v70, v71
  v_max_f32 v6, v6, v7
  v_cmp_gt_i32 vcc, 0, v21
  s_nop 1
  v_cndmask_b32 v72, v72, v5, vcc
  v_cmp_gt_i32 vcc, 1, v21
  s_nop 1
  v_cndmask_b32 v73, v73, v5, vcc
  v_cmp_gt_i32 vcc, 2, v21
  s_nop 1
  v_cndmask_b32 v74, v74, v5, vcc
  v_cmp_gt_i32 vcc, 3, v21
  s_nop 1
  v_cndmask_b32 v75, v75, v5, vcc
  v_cmp_gt_i32 vcc, 16, v21
  s_nop 1
  v_cndmask_b32 v76, v76, v5, vcc
  v_cmp_gt_i32 vcc, 17, v21
  s_nop 1
  v_cndmask_b32 v77, v77, v5, vcc
  v_cmp_gt_i32 vcc, 18, v21
  s_nop 1
  v_cndmask_b32 v78, v78, v5, vcc
  v_cmp_gt_i32 vcc, 19, v21
  s_nop 1
  v_cndmask_b32 v79, v79, v5, vcc
  v_subrev_u32 v21, 32, v21
  v_max3_f32 v8, v72, v73, v74
  v_max3_f32 v9, v75, v76, v77
  v_max3_f32 v8, v8, v78, v79
  v_max_f32 v8, v8, v9
  v_mov_b32 v7, v6
  v_mov_b32 v9, v8
  s_nop 0
  v_permlane32_swap_b32 v6, v7
  v_permlane32_swap_b32 v8, v9
  v_max_f32 v6, v6, v7
  v_max_f32 v8, v8, v9
  v_mov_b32 v7, v6
  v_mov_b32 v9, v8
  s_nop 0
  v_permlane16_swap_b32 v6, v7
  v_permlane16_swap_b32 v8, v9
  v_max_f32 v6, v6, v7
  v_max_f32 v8, v8, v9
  v_max_f32 v6, v6, v16
  v_sub_f32 v7, v16, v6
  v_exp_f32 v7, v7
  v_mov_b32 v16, v6
  v_sub_f32 v64, v64, v16
  v_sub_f32 v65, v65, v16
  v_sub_f32 v66, v66, v16
  v_sub_f32 v67, v67, v16
  v_sub_f32 v68, v68, v16
  v_sub_f32 v69, v69, v16
  v_sub_f32 v70, v70, v16
  v_sub_f32 v71, v71, v16
  v_exp_f32 v64, v64
  v_exp_f32 v65, v65
  v_exp_f32 v66, v66
  v_exp_f32 v67, v67
  v_exp_f32 v68, v68
  v_exp_f32 v69, v69
  v_exp_f32 v70, v70
  v_exp_f32 v71, v71
  v_mul_f32 v24, v24, v7
  v_mul_f32 v25, v25, v7
  v_mul_f32 v26, v26, v7
  v_mul_f32 v27, v27, v7
  v_mul_f32 v192, v192, v7
  v_mul_f32 v193, v193, v7
  v_mul_f32 v194, v194, v7
  v_mul_f32 v195, v195, v7
  v_mul_f32 v196, v196, v7
  v_mul_f32 v197, v197, v7
  v_mul_f32 v198, v198, v7
  v_mul_f32 v199, v199, v7
  v_mul_f32 v200, v200, v7
  v_mul_f32 v201, v201, v7
  v_mul_f32 v202, v202, v7
  v_mul_f32 v203, v203, v7
  v_mul_f32 v204, v204, v7
  v_mul_f32 v205, v205, v7
  v_mul_f32 v206, v206, v7
  v_mul_f32 v207, v207, v7
  v_mul_f32 v208, v208, v7
  v_mul_f32 v209, v209, v7
  v_mul_f32 v210, v210, v7
  v_mul_f32 v211, v211, v7
  v_mul_f32 v212, v212, v7
  v_mul_f32 v213, v213, v7
  v_mul_f32 v214, v214, v7
  v_mul_f32 v215, v215, v7
  v_mul_f32 v216, v216, v7
  v_mul_f32 v217, v217, v7
  v_mul_f32 v218, v218, v7
  v_mul_f32 v219, v219, v7
  v_mul_f32 v220, v220, v7
  v_mul_f32 v221, v221, v7
  v_mul_f32 v222, v222, v7
  v_mul_f32 v223, v223, v7
  v_cvt_pk_bf16_f32 v32, v64, v65
  v_cvt_pk_bf16_f32 v33, v66, v67
  v_cvt_pk_bf16_f32 v34, v68, v69
  v_cvt_pk_bf16_f32 v35, v70, v71
  v_max_f32 v8, v8, v17
  v_sub_f32 v9, v17, v8
  v_exp_f32 v9, v9
  v_mov_b32 v17, v8
  v_sub_f32 v72, v72, v17
  v_sub_f32 v73, v73, v17
  v_sub_f32 v74, v74, v17
  v_sub_f32 v75, v75, v17
  v_sub_f32 v76, v76, v17
  v_sub_f32 v77, v77, v17
  v_sub_f32 v78, v78, v17
  v_sub_f32 v79, v79, v17
  v_exp_f32 v72, v72
  v_exp_f32 v73, v73
  v_exp_f32 v74, v74
  v_exp_f32 v75, v75
  v_exp_f32 v76, v76
  v_exp_f32 v77, v77
  v_exp_f32 v78, v78
  v_exp_f32 v79, v79
  v_mul_f32 v28, v28, v9
  v_mul_f32 v29, v29, v9
  v_mul_f32 v30, v30, v9
  v_mul_f32 v31, v31, v9
  v_mul_f32 v224, v224, v9
  v_mul_f32 v225, v225, v9
  v_mul_f32 v226, v226, v9
  v_mul_f32 v227, v227, v9
  v_mul_f32 v228, v228, v9
  v_mul_f32 v229, v229, v9
  v_mul_f32 v230, v230, v9
  v_mul_f32 v231, v231, v9
  v_mul_f32 v232, v232, v9
  v_mul_f32 v233, v233, v9
  v_mul_f32 v234, v234, v9
  v_mul_f32 v235, v235, v9
  v_mul_f32 v236, v236, v9
  v_mul_f32 v237, v237, v9
  v_mul_f32 v238, v238, v9
  v_mul_f32 v239, v239, v9
  v_mul_f32 v240, v240, v9
  v_mul_f32 v241, v241, v9
  v_mul_f32 v242, v242, v9
  v_mul_f32 v243, v243, v9
  v_mul_f32 v244, v244, v9
  v_mul_f32 v245, v245, v9
  v_mul_f32 v246, v246, v9
  v_mul_f32 v247, v247, v9
  v_mul_f32 v248, v248, v9
  v_mul_f32 v249, v249, v9
  v_mul_f32 v250, v250, v9
  v_mul_f32 v251, v251, v9
  v_mul_f32 v252, v252, v9
  v_mul_f32 v253, v253, v9
  v_mul_f32 v254, v254, v9
  v_mul_f32 v255, v255, v9
  v_cvt_pk_bf16_f32 v36, v72, v73
  v_cvt_pk_bf16_f32 v37, v74, v75
  v_cvt_pk_bf16_f32 v38, v76, v77
  v_cvt_pk_bf16_f32 v39, v78, v79
  v_mfma_f32_16x16x32_bf16 v[24:27], a[208:211], v[32:35], v[24:27]
  v_mfma_f32_16x16x32_bf16 v[192:195], a[32:35], v[32:35], v[192:195]
  v_mfma_f32_16x16x32_bf16 v[196:199], a[36:39], v[32:35], v[196:199]
  v_mfma_f32_16x16x32_bf16 v[200:203], a[40:43], v[32:35], v[200:203]
  v_mfma_f32_16x16x32_bf16 v[204:207], a[44:47], v[32:35], v[204:207]
  v_mfma_f32_16x16x32_bf16 v[208:211], a[48:51], v[32:35], v[208:211]
  v_mfma_f32_16x16x32_bf16 v[212:215], a[52:55], v[32:35], v[212:215]
  v_mfma_f32_16x16x32_bf16 v[216:219], a[56:59], v[32:35], v[216:219]
  v_mfma_f32_16x16x32_bf16 v[220:223], a[60:63], v[32:35], v[220:223]
  v_mfma_f32_16x16x32_bf16 v[28:31], a[208:211], v[36:39], v[28:31]
  v_mfma_f32_16x16x32_bf16 v[224:227], a[32:35], v[36:39], v[224:227]
  v_mfma_f32_16x16x32_bf16 v[228:231], a[36:39], v[36:39], v[228:231]
  v_mfma_f32_16x16x32_bf16 v[232:235], a[40:43], v[36:39], v[232:235]
  v_mfma_f32_16x16x32_bf16 v[236:239], a[44:47], v[36:39], v[236:239]
  v_mfma_f32_16x16x32_bf16 v[240:243], a[48:51], v[36:39], v[240:243]
  v_mfma_f32_16x16x32_bf16 v[244:247], a[52:55], v[36:39], v[244:247]
  v_mfma_f32_16x16x32_bf16 v[248:251], a[56:59], v[36:39], v[248:251]
  v_mfma_f32_16x16x32_bf16 v[252:255], a[60:63], v[36:39], v[252:255]
  s_add_u32 s90, s90, 8192
  s_and_b32 s4, s90, 0x4000
  s_add_u32 s90, s90, s4
  s_sub_u32 s7, s7, 1
  s_cmp_lg_u32 s7, 0
  s_cbranch_scc1 La_sl_loop
  s_lshl_b32 s4, s6, 20
  s_lshl_b32 s5, s24, 15
  s_add_u32 s4, s4, s5
  s_lshl_b32 s5, s3, 11
  s_add_u32 s4, s4, s5
  v_rcp_f32 v6, v24
  s_nop 0
  v_mov_b32 v7, v6
  v_rcp_f32 v8, v28
  s_nop 0
  v_mov_b32 v9, v8
  v_pk_mul_f32 v[192:193], v[192:193], v[6:7]
  v_pk_mul_f32 v[194:195], v[194:195], v[6:7]
  v_pk_mul_f32 v[196:197], v[196:197], v[6:7]
  v_pk_mul_f32 v[198:199], v[198:199], v[6:7]
  v_cvt_pk_bf16_f32 v192, v192, v193
  v_cvt_pk_bf16_f32 v193, v194, v195
  v_cvt_pk_bf16_f32 v194, v196, v197
  v_cvt_pk_bf16_f32 v195, v198, v199
  buffer_store_dwordx4 v[192:195], v2, s[16:19], s4 offen offset:0 sc1
  v_pk_mul_f32 v[224:225], v[224:225], v[8:9]
  v_pk_mul_f32 v[226:227], v[226:227], v[8:9]
  v_pk_mul_f32 v[228:229], v[228:229], v[8:9]
  v_pk_mul_f32 v[230:231], v[230:231], v[8:9]
  v_cvt_pk_bf16_f32 v224, v224, v225
  v_cvt_pk_bf16_f32 v225, v226, v227
  v_cvt_pk_bf16_f32 v226, v228, v229
  v_cvt_pk_bf16_f32 v227, v230, v231
  buffer_store_dwordx4 v[224:227], v2, s[16:19], s4 offen offset:1024 sc1
  s_add_u32 s4, s4, 8192
  v_pk_mul_f32 v[200:201], v[200:201], v[6:7]
  v_pk_mul_f32 v[202:203], v[202:203], v[6:7]
  v_pk_mul_f32 v[204:205], v[204:205], v[6:7]
  v_pk_mul_f32 v[206:207], v[206:207], v[6:7]
  v_cvt_pk_bf16_f32 v200, v200, v201
  v_cvt_pk_bf16_f32 v201, v202, v203
  v_cvt_pk_bf16_f32 v202, v204, v205
  v_cvt_pk_bf16_f32 v203, v206, v207
  buffer_store_dwordx4 v[200:203], v2, s[16:19], s4 offen offset:0 sc1
  v_pk_mul_f32 v[232:233], v[232:233], v[8:9]
  v_pk_mul_f32 v[234:235], v[234:235], v[8:9]
  v_pk_mul_f32 v[236:237], v[236:237], v[8:9]
  v_pk_mul_f32 v[238:239], v[238:239], v[8:9]
  v_cvt_pk_bf16_f32 v232, v232, v233
  v_cvt_pk_bf16_f32 v233, v234, v235
  v_cvt_pk_bf16_f32 v234, v236, v237
  v_cvt_pk_bf16_f32 v235, v238, v239
  buffer_store_dwordx4 v[232:235], v2, s[16:19], s4 offen offset:1024 sc1
  s_add_u32 s4, s4, 8192
  v_pk_mul_f32 v[208:209], v[208:209], v[6:7]
  v_pk_mul_f32 v[210:211], v[210:211], v[6:7]
  v_pk_mul_f32 v[212:213], v[212:213], v[6:7]
  v_pk_mul_f32 v[214:215], v[214:215], v[6:7]
  v_cvt_pk_bf16_f32 v208, v208, v209
  v_cvt_pk_bf16_f32 v209, v210, v211
  v_cvt_pk_bf16_f32 v210, v212, v213
  v_cvt_pk_bf16_f32 v211, v214, v215
  buffer_store_dwordx4 v[208:211], v2, s[16:19], s4 offen offset:0 sc1
  v_pk_mul_f32 v[240:241], v[240:241], v[8:9]
  v_pk_mul_f32 v[242:243], v[242:243], v[8:9]
  v_pk_mul_f32 v[244:245], v[244:245], v[8:9]
  v_pk_mul_f32 v[246:247], v[246:247], v[8:9]
  v_cvt_pk_bf16_f32 v240, v240, v241
  v_cvt_pk_bf16_f32 v241, v242, v243
  v_cvt_pk_bf16_f32 v242, v244, v245
  v_cvt_pk_bf16_f32 v243, v246, v247
  buffer_store_dwordx4 v[240:243], v2, s[16:19], s4 offen offset:1024 sc1
  s_add_u32 s4, s4, 8192
  v_pk_mul_f32 v[216:217], v[216:217], v[6:7]
  v_pk_mul_f32 v[218:219], v[218:219], v[6:7]
  v_pk_mul_f32 v[220:221], v[220:221], v[6:7]
  v_pk_mul_f32 v[222:223], v[222:223], v[6:7]
  v_cvt_pk_bf16_f32 v216, v216, v217
  v_cvt_pk_bf16_f32 v217, v218, v219
  v_cvt_pk_bf16_f32 v218, v220, v221
  v_cvt_pk_bf16_f32 v219, v222, v223
  buffer_store_dwordx4 v[216:219], v2, s[16:19], s4 offen offset:0 sc1
  v_pk_mul_f32 v[248:249], v[248:249], v[8:9]
  v_pk_mul_f32 v[250:251], v[250:251], v[8:9]
  v_pk_mul_f32 v[252:253], v[252:253], v[8:9]
  v_pk_mul_f32 v[254:255], v[254:255], v[8:9]
  v_cvt_pk_bf16_f32 v248, v248, v249
  v_cvt_pk_bf16_f32 v249, v250, v251
  v_cvt_pk_bf16_f32 v250, v252, v253
  v_cvt_pk_bf16_f32 v251, v254, v255
  buffer_store_dwordx4 v[248:251], v2, s[16:19], s4 offen offset:1024 sc1
  s_cmp_eq_u32 s6, s25
  s_cbranch_scc1 La_done
  v_accvgpr_read_b32 v64, a128
  v_accvgpr_read_b32 v65, a129
  v_accvgpr_read_b32 v66, a130
  v_accvgpr_read_b32 v67, a131
  v_accvgpr_read_b32 v68, a132
  v_accvgpr_read_b32 v69, a133
  v_accvgpr_read_b32 v70, a134
  v_accvgpr_read_b32 v71, a135
  v_accvgpr_read_b32 v72, a136
  v_accvgpr_read_b32 v73, a137
  v_accvgpr_read_b32 v74, a138
  v_accvgpr_read_b32 v75, a139
  v_accvgpr_read_b32 v76, a140
  v_accvgpr_read_b32 v77, a141
  v_accvgpr_read_b32 v78, a142
  v_accvgpr_read_b32 v79, a143
  v_accvgpr_read_b32 v80, a144
  v_accvgpr_read_b32 v81, a145
  v_accvgpr_read_b32 v82, a146
  v_accvgpr_read_b32 v83, a147
  v_accvgpr_read_b32 v84, a148
  v_accvgpr_read_b32 v85, a149
  v_accvgpr_read_b32 v86, a150
  v_accvgpr_read_b32 v87, a151
  v_accvgpr_read_b32 v88, a152
  v_accvgpr_read_b32 v89, a153
  v_accvgpr_read_b32 v90, a154
  v_accvgpr_read_b32 v91, a155
  v_accvgpr_read_b32 v92, a156
  v_accvgpr_read_b32 v93, a157
  v_accvgpr_read_b32 v94, a158
  v_accvgpr_read_b32 v95, a159
  v_accvgpr_write_b32 a160, v64
  v_accvgpr_write_b32 a161, v65
  v_accvgpr_write_b32 a162, v66
  v_accvgpr_write_b32 a163, v67
  v_accvgpr_write_b32 a164, v68
  v_accvgpr_write_b32 a165, v69
  v_accvgpr_write_b32 a166, v70
  v_accvgpr_write_b32 a167, v71
  v_accvgpr_write_b32 a168, v72
  v_accvgpr_write_b32 a169, v73
  v_accvgpr_write_b32 a170, v74
  v_accvgpr_write_b32 a171, v75
  v_accvgpr_write_b32 a172, v76
  v_accvgpr_write_b32 a173, v77
  v_accvgpr_write_b32 a174, v78
  v_accvgpr_write_b32 a175, v79
  v_accvgpr_write_b32 a176, v80
  v_accvgpr_write_b32 a177, v81
  v_accvgpr_write_b32 a178, v82
  v_accvgpr_write_b32 a179, v83
  v_accvgpr_write_b32 a180, v84
  v_accvgpr_write_b32 a181, v85
  v_accvgpr_write_b32 a182, v86
  v_accvgpr_write_b32 a183, v87
  v_accvgpr_write_b32 a184, v88
  v_accvgpr_write_b32 a185, v89
  v_accvgpr_write_b32 a186, v90
  v_accvgpr_write_b32 a187, v91
  v_accvgpr_write_b32 a188, v92
  v_accvgpr_write_b32 a189, v93
  v_accvgpr_write_b32 a190, v94
  v_accvgpr_write_b32 a191, v95
  s_mov_b32 s6, s25
  s_branch La_sl_blk
La_done:
  s_lshr_b32 s4, s3, 1
  s_lshl_b32 s4, s4, 12
  s_add_u32 s4, s4, 131072
  s_lshl_b32 s5, s77, 11
  s_add_u32 s4, s4, s5
  v_add_u32 v16, s4, v2
  v_xor_b32 v17, 0x800, v16
  s_and_b32 s4, s3, 1
  s_lshl_b32 s4, s4, 13
  s_add_u32 s4, s4, 131072
  v_lshrrev_b32 v24, 2, v1
  v_and_b32 v25, 6, v24
  v_lshlrev_b32 v24, 7, v24
  v_and_b32 v26, 1, v1
  v_lshl_add_u32 v24, v26, 3, v24
  v_add_u32 v24, s4, v24
  v_bfe_u32 v26, v1, 1, 1
  v_xor_b32 v25, v25, v26
  v_xor_b32 v26, 0, v25
  v_lshl_add_u32 v18, v26, 4, v24
  v_xor_b32 v26, 2, v25
  v_lshl_add_u32 v19, v26, 4, v24
  v_xor_b32 v26, 4, v25
  v_lshl_add_u32 v20, v26, 4, v24
  v_xor_b32 v26, 6, v25
  v_lshl_add_u32 v21, v26, 4, v24
  s_mov_b32 s65, 0
  s_mov_b32 s67, 4294868992
  s_mov_b32 s68, 32768
  s_mov_b32 s65, 3
  s_waitcnt vmcnt(16)
  s_barrier
  ds_read_b128 a[64:67], v16 offset:0
  ds_read_b64_tr_b16 a[96:97], v18 offset:16384
  ds_read_b64_tr_b16 a[98:99], v18 offset:18432
  ds_read_b128 a[68:71], v16 offset:1024
  ds_read_b128 a[72:75], v17 offset:0
  ds_read_b128 a[76:79], v17 offset:1024
  ds_read_b64_tr_b16 a[100:101], v19 offset:16384
  ds_read_b64_tr_b16 a[102:103], v19 offset:18432
  ds_read_b64_tr_b16 a[104:105], v20 offset:16384
  ds_read_b64_tr_b16 a[106:107], v20 offset:18432
  ds_read_b64_tr_b16 a[108:109], v21 offset:16384
  ds_read_b64_tr_b16 a[110:111], v21 offset:18432
  s_waitcnt lgkmcnt(0)
  v_mfma_f32_16x16x32_bf16 v[32:35], a[96:99], a[64:67], 0
  s_add_u32 m0, s79, 81920
  ds_read_b128 a[80:83], v16 offset:8192
  ds_read_b64_tr_b16 a[112:113], v18 offset:20480
  v_mfma_f32_16x16x32_bf16 v[48:51], a[96:99], a[68:71], 0
  buffer_load_dwordx4 v10, s[12:15], s71 offen offset:0 lds
  ds_read_b64_tr_b16 a[114:115], v18 offset:22528
  v_mfma_f32_16x16x32_bf16 v[64:67], a[96:99], a[72:75], 0
  buffer_load_dwordx4 v11, s[12:15], s71 offen offset:1024 lds
  ds_read_b128 a[84:87], v16 offset:9216
  v_mfma_f32_16x16x32_bf16 v[80:83], a[96:99], a[76:79], 0
  buffer_load_dwordx4 v12, s[12:15], s71 offen offset:2048 lds
  ds_read_b128 a[88:91], v17 offset:8192
  v_mfma_f32_16x16x32_bf16 v[36:39], a[100:103], a[64:67], 0
  buffer_load_dwordx4 v13, s[12:15], s71 offen offset:3072 lds
  ds_read_b128 a[92:95], v17 offset:9216
  v_mfma_f32_16x16x32_bf16 v[52:55], a[100:103], a[68:71], 0
  s_bfe_u32 s72, 0x3020106, s31
  s_add_u32 s30, s30, s72
  s_add_u32 s31, s31, 8
  v_mfma_f32_16x16x32_bf16 v[68:71], a[100:103], a[72:75], 0
  s_and_b32 s31, s31, 0x8001f
  s_and_b32 s30, s30, 7
  s_lshl_b32 s72, s30, 17
  v_mfma_f32_16x16x32_bf16 v[84:87], a[100:103], a[76:79], 0
  s_add_u32 s71, s93, s72
  s_add_u32 m0, s79, 65536
  ds_read_b64_tr_b16 a[116:117], v19 offset:20480
  v_mfma_f32_16x16x32_bf16 v[40:43], a[104:107], a[64:67], 0
  buffer_load_dwordx4 v2, s[8:11], s70 offen offset:0 sc1 lds
  ds_read_b64_tr_b16 a[118:119], v19 offset:22528
  v_mfma_f32_16x16x32_bf16 v[56:59], a[104:107], a[68:71], 0
  buffer_load_dwordx4 v2, s[8:11], s70 offen offset:1024 sc1 lds
  ds_read_b64_tr_b16 a[120:121], v20 offset:20480
  v_mfma_f32_16x16x32_bf16 v[72:75], a[104:107], a[72:75], 0
  buffer_load_dwordx4 v2, s[8:11], s70 offen offset:2048 sc1 lds
  ds_read_b64_tr_b16 a[122:123], v20 offset:22528
  v_mfma_f32_16x16x32_bf16 v[88:91], a[104:107], a[76:79], 0
  buffer_load_dwordx4 v2, s[8:11], s70 offen offset:3072 sc1 lds
  ds_read_b64_tr_b16 a[124:125], v21 offset:20480
  v_mfma_f32_16x16x32_bf16 v[44:47], a[108:111], a[64:67], 0
  s_bfe_u32 s72, 0x3020106, s1
  s_add_u32 s0, s0, s72
  s_add_u32 s1, s1, 8
  v_mfma_f32_16x16x32_bf16 v[60:63], a[108:111], a[68:71], 0
  s_and_b32 s1, s1, 0x8001f
  s_and_b32 s0, s0, 7
  s_lshl_b32 s72, s0, 14
  v_mfma_f32_16x16x32_bf16 v[76:79], a[108:111], a[72:75], 0
  s_add_u32 s70, s92, s72
  s_add_u32 m0, s79, 114688
  ds_read_b64_tr_b16 a[126:127], v21 offset:22528
  v_mfma_f32_16x16x32_bf16 v[92:95], a[108:111], a[76:79], 0
  buffer_load_dwordx4 v10, s[12:15], s71 offen offset:0 lds
  buffer_load_dwordx4 v11, s[12:15], s71 offen offset:1024 lds
  buffer_load_dwordx4 v12, s[12:15], s71 offen offset:2048 lds
  buffer_load_dwordx4 v13, s[12:15], s71 offen offset:3072 lds
  s_bfe_u32 s72, 0x3020106, s31
  s_add_u32 s30, s30, s72
  s_add_u32 s31, s31, 8
  s_and_b32 s31, s31, 0x8001f
  s_and_b32 s30, s30, 7
  s_lshl_b32 s72, s30, 17
  s_add_u32 s71, s93, s72
  s_add_u32 m0, s79, 98304
  s_nop 0
  buffer_load_dwordx4 v2, s[8:11], s70 offen offset:0 sc1 lds
  buffer_load_dwordx4 v2, s[8:11], s70 offen offset:1024 sc1 lds
  buffer_load_dwordx4 v2, s[8:11], s70 offen offset:2048 sc1 lds
  buffer_load_dwordx4 v2, s[8:11], s70 offen offset:3072 sc1 lds
  s_bfe_u32 s72, 0x3020106, s1
  s_add_u32 s0, s0, s72
  s_add_u32 s1, s1, 8
  s_and_b32 s1, s1, 0x8001f
  s_and_b32 s0, s0, 7
  s_lshl_b32 s72, s0, 14
  s_add_u32 s70, s92, s72
  s_add_u32 s65, s65, 1
  s_cmp_eq_u32 s65, 4
  s_cselect_b32 s65, 0, s65
  s_cselect_b32 s66, s67, s68
  v_add_u32 v16, s66, v16
  v_add_u32 v17, s66, v17
  v_add_u32 v18, s66, v18
  v_add_u32 v19, s66, v19
  v_add_u32 v20, s66, v20
  v_add_u32 v21, s66, v21
  s_waitcnt vmcnt(16) lgkmcnt(0)
  s_barrier
  s_lshl_b32 s4, s24, 7
  s_lshl_b32 s5, s25, 12
  s_add_u32 s6, s4, 65536
  s_add_u32 s7, s6, 61440
  s_add_u32 s6, s6, s5
  s_sub_u32 s7, s7, s5
  v_mov_b32 v8, 0x40000000
  v_mov_b32 v6, s94
  v_cmp_eq_u32 vcc, 0, v0
  v_mov_b32 v7, s95
  s_nop 0
  v_cndmask_b32_e64 v8, v8, 0, vcc
  buffer_store_dwordx2 v[6:7], v8, s[96:99], s6 offen sc1
  buffer_store_dwordx2 v[6:7], v8, s[96:99], s7 offen sc1
  s_lshl_b32 s91, s73, 12
  s_add_u32 s91, s91, 65536
  v_and_b32 v14, 31, v1
  v_lshlrev_b32 v14, 7, v14
  s_add_u32 s16, s86, 100663296
  s_addc_u32 s17, s87, 0
  s_mov_b32 s18, 16777216
  s_mov_b32 s19, 0x00020000
  v_mfma_f32_16x16x32_bf16 v[32:35], a[112:115], a[80:83], v[32:35]
  s_add_u32 m0, s64, 16384
  ds_read_b128 a[64:67], v16 offset:0
  ds_read_b64_tr_b16 a[96:97], v18 offset:16384
  v_mfma_f32_16x16x32_bf16 v[48:51], a[112:115], a[84:87], v[48:51]
  buffer_load_dwordx4 v10, s[12:15], s71 offen offset:0 lds
  ds_read_b64_tr_b16 a[98:99], v18 offset:18432
  v_mfma_f32_16x16x32_bf16 v[64:67], a[112:115], a[88:91], v[64:67]
  ds_read_b128 a[68:71], v16 offset:1024
  ds_read_b128 a[72:75], v17 offset:0
  v_mfma_f32_16x16x32_bf16 v[80:83], a[112:115], a[92:95], v[80:83]
  buffer_load_dwordx4 v11, s[12:15], s71 offen offset:1024 lds
  ds_read_b128 a[76:79], v17 offset:1024
  v_mfma_f32_16x16x32_bf16 v[36:39], a[116:119], a[80:83], v[36:39]
  ds_read_b64_tr_b16 a[100:101], v19 offset:16384
  ds_read_b64_tr_b16 a[102:103], v19 offset:18432
  v_mfma_f32_16x16x32_bf16 v[52:55], a[116:119], a[84:87], v[52:55]
  ds_read_b64_tr_b16 a[104:105], v20 offset:16384
  ds_read_b64_tr_b16 a[106:107], v20 offset:18432
  v_mfma_f32_16x16x32_bf16 v[68:71], a[116:119], a[88:91], v[68:71]
  ds_read_b64_tr_b16 a[108:109], v21 offset:16384
  ds_read_b64_tr_b16 a[110:111], v21 offset:18432
  v_mfma_f32_16x16x32_bf16 v[84:87], a[116:119], a[92:95], v[84:87]
  buffer_load_dwordx4 v12, s[12:15], s71 offen offset:2048 lds
  v_mfma_f32_16x16x32_bf16 v[40:43], a[120:123], a[80:83], v[40:43]
  v_mfma_f32_16x16x32_bf16 v[56:59], a[120:123], a[84:87], v[56:59]
  v_mfma_f32_16x16x32_bf16 v[72:75], a[120:123], a[88:91], v[72:75]
  v_mfma_f32_16x16x32_bf16 v[88:91], a[120:123], a[92:95], v[88:91]
  buffer_load_dwordx4 v13, s[12:15], s71 offen offset:3072 lds
  v_mfma_f32_16x16x32_bf16 v[44:47], a[124:127], a[80:83], v[44:47]
  s_bfe_u32 s72, 0x3020106, s31
  s_add_u32 s30, s30, s72
  s_add_u32 s31, s31, 8
  v_mfma_f32_16x16x32_bf16 v[60:63], a[124:127], a[84:87], v[60:63]
  s_and_b32 s31, s31, 0x8001f
  s_and_b32 s30, s30, 7
  s_lshl_b32 s72, s30, 17
  v_mfma_f32_16x16x32_bf16 v[76:79], a[124:127], a[88:91], v[76:79]
  s_add_u32 s71, s93, s72
  v_mfma_f32_16x16x32_bf16 v[92:95], a[124:127], a[92:95], v[92:95]
  s_waitcnt lgkmcnt(0)
  v_mfma_f32_16x16x32_bf16 v[32:35], a[96:99], a[64:67], v[32:35]
  s_mov_b32 m0, s64
  ds_read_b128 a[80:83], v16 offset:8192
  ds_read_b64_tr_b16 a[112:113], v18 offset:20480
  v_mfma_f32_16x16x32_bf16 v[48:51], a[96:99], a[68:71], v[48:51]
  buffer_load_dwordx4 v2, s[8:11], s70 offen offset:0 sc1 lds
  ds_read_b64_tr_b16 a[114:115], v18 offset:22528
  v_mfma_f32_16x16x32_bf16 v[64:67], a[96:99], a[72:75], v[64:67]
  buffer_load_dwordx4 v2, s[8:11], s70 offen offset:1024 sc1 lds
  ds_read_b128 a[84:87], v16 offset:9216
  v_mfma_f32_16x16x32_bf16 v[80:83], a[96:99], a[76:79], v[80:83]
  ds_read_b128 a[88:91], v17 offset:8192
  ds_read_b128 a[92:95], v17 offset:9216
  v_mfma_f32_16x16x32_bf16 v[36:39], a[100:103], a[64:67], v[36:39]
  buffer_load_dwordx4 v2, s[8:11], s70 offen offset:2048 sc1 lds
  ds_read_b64_tr_b16 a[116:117], v19 offset:20480
  v_mfma_f32_16x16x32_bf16 v[52:55], a[100:103], a[68:71], v[52:55]
  ds_read_b64_tr_b16 a[118:119], v19 offset:22528
  ds_read_b64_tr_b16 a[120:121], v20 offset:20480
  v_mfma_f32_16x16x32_bf16 v[68:71], a[100:103], a[72:75], v[68:71]
  buffer_load_dwordx4 v2, s[8:11], s70 offen offset:3072 sc1 lds
  ds_read_b64_tr_b16 a[122:123], v20 offset:22528
  v_mfma_f32_16x16x32_bf16 v[84:87], a[100:103], a[76:79], v[84:87]
  s_bfe_u32 s72, 0x3020106, s1
  s_add_u32 s0, s0, s72
  s_add_u32 s1, s1, 8
  v_mfma_f32_16x16x32_bf16 v[40:43], a[104:107], a[64:67], v[40:43]
  s_and_b32 s1, s1, 0x8001f
  s_and_b32 s0, s0, 7
  s_lshl_b32 s72, s0, 14
  v_mfma_f32_16x16x32_bf16 v[56:59], a[104:107], a[68:71], v[56:59]
  s_add_u32 s70, s92, s72
  ds_read_b64_tr_b16 a[124:125], v21 offset:20480
  ds_read_b64_tr_b16 a[126:127], v21 offset:22528
  v_mfma_f32_16x16x32_bf16 v[72:75], a[104:107], a[72:75], v[72:75]
  s_add_u32 s64, s64, s66
  s_add_u32 s65, s65, 1
  s_cmp_eq_u32 s65, 4
  s_cselect_b32 s65, 0, s65
  s_cselect_b32 s66, s67, s68
  v_mfma_f32_16x16x32_bf16 v[88:91], a[104:107], a[76:79], v[88:91]
  v_add_u32 v16, s66, v16
  v_add_u32 v17, s66, v17
  v_mfma_f32_16x16x32_bf16 v[44:47], a[108:111], a[64:67], v[44:47]
  v_add_u32 v18, s66, v18
  v_add_u32 v19, s66, v19
  v_mfma_f32_16x16x32_bf16 v[60:63], a[108:111], a[68:71], v[60:63]
  v_add_u32 v20, s66, v20
  v_add_u32 v21, s66, v21
  v_mfma_f32_16x16x32_bf16 v[76:79], a[108:111], a[72:75], v[76:79]
  v_mfma_f32_16x16x32_bf16 v[92:95], a[108:111], a[76:79], v[92:95]
  s_waitcnt vmcnt(18) lgkmcnt(0)
  s_barrier
  v_mfma_f32_16x16x32_bf16 v[32:35], a[112:115], a[80:83], v[32:35]
  s_add_u32 m0, s64, 16384
  ds_read_b128 a[64:67], v16 offset:0
  ds_read_b64_tr_b16 a[96:97], v18 offset:16384
  v_mfma_f32_16x16x32_bf16 v[48:51], a[112:115], a[84:87], v[48:51]
  buffer_load_dwordx4 v10, s[12:15], s71 offen offset:0 lds
  ds_read_b64_tr_b16 a[98:99], v18 offset:18432
  v_mfma_f32_16x16x32_bf16 v[64:67], a[112:115], a[88:91], v[64:67]
  ds_read_b128 a[68:71], v16 offset:1024
  ds_read_b128 a[72:75], v17 offset:0
  v_mfma_f32_16x16x32_bf16 v[80:83], a[112:115], a[92:95], v[80:83]
  buffer_load_dwordx4 v11, s[12:15], s71 offen offset:1024 lds
  ds_read_b128 a[76:79], v17 offset:1024
  v_mfma_f32_16x16x32_bf16 v[36:39], a[116:119], a[80:83], v[36:39]
  ds_read_b64_tr_b16 a[100:101], v19 offset:16384
  ds_read_b64_tr_b16 a[102:103], v19 offset:18432
  v_mfma_f32_16x16x32_bf16 v[52:55], a[116:119], a[84:87], v[52:55]
  ds_read_b64_tr_b16 a[104:105], v20 offset:16384
  ds_read_b64_tr_b16 a[106:107], v20 offset:18432
  v_mfma_f32_16x16x32_bf16 v[68:71], a[116:119], a[88:91], v[68:71]
  ds_read_b64_tr_b16 a[108:109], v21 offset:16384
  ds_read_b64_tr_b16 a[110:111], v21 offset:18432
  v_mfma_f32_16x16x32_bf16 v[84:87], a[116:119], a[92:95], v[84:87]
  buffer_load_dwordx4 v12, s[12:15], s71 offen offset:2048 lds
  v_mfma_f32_16x16x32_bf16 v[40:43], a[120:123], a[80:83], v[40:43]
  v_mfma_f32_16x16x32_bf16 v[56:59], a[120:123], a[84:87], v[56:59]
  v_mfma_f32_16x16x32_bf16 v[72:75], a[120:123], a[88:91], v[72:75]
  v_mfma_f32_16x16x32_bf16 v[88:91], a[120:123], a[92:95], v[88:91]
  buffer_load_dwordx4 v13, s[12:15], s71 offen offset:3072 lds
  v_mfma_f32_16x16x32_bf16 v[44:47], a[124:127], a[80:83], v[44:47]
  s_bfe_u32 s72, 0x3020106, s31
  s_add_u32 s30, s30, s72
  s_add_u32 s31, s31, 8
  v_mfma_f32_16x16x32_bf16 v[60:63], a[124:127], a[84:87], v[60:63]
  s_and_b32 s31, s31, 0x8001f
  s_and_b32 s30, s30, 7
  s_lshl_b32 s72, s30, 17
  v_mfma_f32_16x16x32_bf16 v[76:79], a[124:127], a[88:91], v[76:79]
  s_add_u32 s71, s93, s72
  v_mfma_f32_16x16x32_bf16 v[92:95], a[124:127], a[92:95], v[92:95]
  s_waitcnt lgkmcnt(0)
  v_mfma_f32_16x16x32_bf16 v[32:35], a[96:99], a[64:67], v[32:35]
  s_mov_b32 m0, s64
  ds_read_b128 a[80:83], v16 offset:8192
  ds_read_b64_tr_b16 a[112:113], v18 offset:20480
  v_mfma_f32_16x16x32_bf16 v[48:51], a[96:99], a[68:71], v[48:51]
  buffer_load_dwordx4 v2, s[8:11], s70 offen offset:0 sc1 lds
  ds_read_b64_tr_b16 a[114:115], v18 offset:22528
  v_mfma_f32_16x16x32_bf16 v[64:67], a[96:99], a[72:75], v[64:67]
  buffer_load_dwordx4 v2, s[8:11], s70 offen offset:1024 sc1 lds
  ds_read_b128 a[84:87], v16 offset:9216
  v_mfma_f32_16x16x32_bf16 v[80:83], a[96:99], a[76:79], v[80:83]
  ds_read_b128 a[88:91], v17 offset:8192
  ds_read_b128 a[92:95], v17 offset:9216
  v_mfma_f32_16x16x32_bf16 v[36:39], a[100:103], a[64:67], v[36:39]
  buffer_load_dwordx4 v2, s[8:11], s70 offen offset:2048 sc1 lds
  ds_read_b64_tr_b16 a[116:117], v19 offset:20480
  v_mfma_f32_16x16x32_bf16 v[52:55], a[100:103], a[68:71], v[52:55]
  ds_read_b64_tr_b16 a[118:119], v19 offset:22528
  ds_read_b64_tr_b16 a[120:121], v20 offset:20480
  v_mfma_f32_16x16x32_bf16 v[68:71], a[100:103], a[72:75], v[68:71]
  buffer_load_dwordx4 v2, s[8:11], s70 offen offset:3072 sc1 lds
  ds_read_b64_tr_b16 a[122:123], v20 offset:22528
  v_mfma_f32_16x16x32_bf16 v[84:87], a[100:103], a[76:79], v[84:87]
  s_bfe_u32 s72, 0x3020106, s1
  s_add_u32 s0, s0, s72
  s_add_u32 s1, s1, 8
  v_mfma_f32_16x16x32_bf16 v[40:43], a[104:107], a[64:67], v[40:43]
  s_and_b32 s1, s1, 0x8001f
  s_and_b32 s0, s0, 7
  s_lshl_b32 s72, s0, 14
  v_mfma_f32_16x16x32_bf16 v[56:59], a[104:107], a[68:71], v[56:59]
  s_add_u32 s70, s92, s72
  ds_read_b64_tr_b16 a[124:125], v21 offset:20480
  ds_read_b64_tr_b16 a[126:127], v21 offset:22528
  v_mfma_f32_16x16x32_bf16 v[72:75], a[104:107], a[72:75], v[72:75]
  s_add_u32 s64, s64, s66
  s_add_u32 s65, s65, 1
  s_cmp_eq_u32 s65, 4
  s_cselect_b32 s65, 0, s65
  s_cselect_b32 s66, s67, s68
  v_mfma_f32_16x16x32_bf16 v[88:91], a[104:107], a[76:79], v[88:91]
  v_add_u32 v16, s66, v16
  v_add_u32 v17, s66, v17
  v_mfma_f32_16x16x32_bf16 v[44:47], a[108:111], a[64:67], v[44:47]
  v_add_u32 v18, s66, v18
  v_add_u32 v19, s66, v19
  v_mfma_f32_16x16x32_bf16 v[60:63], a[108:111], a[68:71], v[60:63]
  v_add_u32 v20, s66, v20
  v_add_u32 v21, s66, v21
  v_mfma_f32_16x16x32_bf16 v[76:79], a[108:111], a[72:75], v[76:79]
  v_mfma_f32_16x16x32_bf16 v[92:95], a[108:111], a[76:79], v[92:95]
  s_waitcnt vmcnt(18) lgkmcnt(0)
  s_barrier
  v_mfma_f32_16x16x32_bf16 v[32:35], a[112:115], a[80:83], v[32:35]
  s_add_u32 m0, s64, 16384
  ds_read_b128 a[64:67], v16 offset:0
  ds_read_b64_tr_b16 a[96:97], v18 offset:16384
  v_mfma_f32_16x16x32_bf16 v[48:51], a[112:115], a[84:87], v[48:51]
  buffer_load_dwordx4 v10, s[12:15], s71 offen offset:0 lds
  ds_read_b64_tr_b16 a[98:99], v18 offset:18432
  v_mfma_f32_16x16x32_bf16 v[64:67], a[112:115], a[88:91], v[64:67]
  ds_read_b128 a[68:71], v16 offset:1024
  ds_read_b128 a[72:75], v17 offset:0
  v_mfma_f32_16x16x32_bf16 v[80:83], a[112:115], a[92:95], v[80:83]
  buffer_load_dwordx4 v11, s[12:15], s71 offen offset:1024 lds
  ds_read_b128 a[76:79], v17 offset:1024
  v_mfma_f32_16x16x32_bf16 v[36:39], a[116:119], a[80:83], v[36:39]
  ds_read_b64_tr_b16 a[100:101], v19 offset:16384
  ds_read_b64_tr_b16 a[102:103], v19 offset:18432
  v_mfma_f32_16x16x32_bf16 v[52:55], a[116:119], a[84:87], v[52:55]
  ds_read_b64_tr_b16 a[104:105], v20 offset:16384
  ds_read_b64_tr_b16 a[106:107], v20 offset:18432
  v_mfma_f32_16x16x32_bf16 v[68:71], a[116:119], a[88:91], v[68:71]
  ds_read_b64_tr_b16 a[108:109], v21 offset:16384
  ds_read_b64_tr_b16 a[110:111], v21 offset:18432
  v_mfma_f32_16x16x32_bf16 v[84:87], a[116:119], a[92:95], v[84:87]
  buffer_load_dwordx4 v12, s[12:15], s71 offen offset:2048 lds
  v_mfma_f32_16x16x32_bf16 v[40:43], a[120:123], a[80:83], v[40:43]
  v_mfma_f32_16x16x32_bf16 v[56:59], a[120:123], a[84:87], v[56:59]
  v_mfma_f32_16x16x32_bf16 v[72:75], a[120:123], a[88:91], v[72:75]
  v_mfma_f32_16x16x32_bf16 v[88:91], a[120:123], a[92:95], v[88:91]
  buffer_load_dwordx4 v13, s[12:15], s71 offen offset:3072 lds
  v_mfma_f32_16x16x32_bf16 v[44:47], a[124:127], a[80:83], v[44:47]
  s_bfe_u32 s72, 0x3020106, s31
  s_add_u32 s30, s30, s72
  s_add_u32 s31, s31, 8
  v_mfma_f32_16x16x32_bf16 v[60:63], a[124:127], a[84:87], v[60:63]
  s_and_b32 s31, s31, 0x8001f
  s_and_b32 s30, s30, 7
  s_lshl_b32 s72, s30, 17
  v_mfma_f32_16x16x32_bf16 v[76:79], a[124:127], a[88:91], v[76:79]
  s_add_u32 s71, s93, s72
  v_mfma_f32_16x16x32_bf16 v[92:95], a[124:127], a[92:95], v[92:95]
  s_waitcnt lgkmcnt(0)
  v_mfma_f32_16x16x32_bf16 v[32:35], a[96:99], a[64:67], v[32:35]
  s_mov_b32 m0, s64
  ds_read_b128 a[80:83], v16 offset:8192
  ds_read_b64_tr_b16 a[112:113], v18 offset:20480
  v_mfma_f32_16x16x32_bf16 v[48:51], a[96:99], a[68:71], v[48:51]
  buffer_load_dwordx4 v2, s[8:11], s70 offen offset:0 sc1 lds
  ds_read_b64_tr_b16 a[114:115], v18 offset:22528
  v_mfma_f32_16x16x32_bf16 v[64:67], a[96:99], a[72:75], v[64:67]
  buffer_load_dwordx4 v2, s[8:11], s70 offen offset:1024 sc1 lds
  ds_read_b128 a[84:87], v16 offset:9216
  v_mfma_f32_16x16x32_bf16 v[80:83], a[96:99], a[76:79], v[80:83]
  ds_read_b128 a[88:91], v17 offset:8192
  ds_read_b128 a[92:95], v17 offset:9216
  v_mfma_f32_16x16x32_bf16 v[36:39], a[100:103], a[64:67], v[36:39]
  buffer_load_dwordx4 v2, s[8:11], s70 offen offset:2048 sc1 lds
  ds_read_b64_tr_b16 a[116:117], v19 offset:20480
  v_mfma_f32_16x16x32_bf16 v[52:55], a[100:103], a[68:71], v[52:55]
  ds_read_b64_tr_b16 a[118:119], v19 offset:22528
  ds_read_b64_tr_b16 a[120:121], v20 offset:20480
  v_mfma_f32_16x16x32_bf16 v[68:71], a[100:103], a[72:75], v[68:71]
  buffer_load_dwordx4 v2, s[8:11], s70 offen offset:3072 sc1 lds
  ds_read_b64_tr_b16 a[122:123], v20 offset:22528
  v_mfma_f32_16x16x32_bf16 v[84:87], a[100:103], a[76:79], v[84:87]
  s_bfe_u32 s72, 0x3020106, s1
  s_add_u32 s0, s0, s72
  s_add_u32 s1, s1, 8
  v_mfma_f32_16x16x32_bf16 v[40:43], a[104:107], a[64:67], v[40:43]
  s_and_b32 s1, s1, 0x8001f
  s_and_b32 s0, s0, 7
  s_lshl_b32 s72, s0, 14
  v_mfma_f32_16x16x32_bf16 v[56:59], a[104:107], a[68:71], v[56:59]
  s_add_u32 s70, s92, s72
  ds_read_b64_tr_b16 a[124:125], v21 offset:20480
  ds_read_b64_tr_b16 a[126:127], v21 offset:22528
  v_mfma_f32_16x16x32_bf16 v[72:75], a[104:107], a[72:75], v[72:75]
  s_add_u32 s64, s64, s66
  s_add_u32 s65, s65, 1
  s_cmp_eq_u32 s65, 4
  s_cselect_b32 s65, 0, s65
  s_cselect_b32 s66, s67, s68
  v_mfma_f32_16x16x32_bf16 v[88:91], a[104:107], a[76:79], v[88:91]
  v_add_u32 v16, s66, v16
  v_add_u32 v17, s66, v17
  v_mfma_f32_16x16x32_bf16 v[44:47], a[108:111], a[64:67], v[44:47]
  v_add_u32 v18, s66, v18
  v_add_u32 v19, s66, v19
  v_mfma_f32_16x16x32_bf16 v[60:63], a[108:111], a[68:71], v[60:63]
  v_add_u32 v20, s66, v20
  v_add_u32 v21, s66, v21
  v_mfma_f32_16x16x32_bf16 v[76:79], a[108:111], a[72:75], v[76:79]
  v_mfma_f32_16x16x32_bf16 v[92:95], a[108:111], a[76:79], v[92:95]
  s_waitcnt vmcnt(16) lgkmcnt(0)
  s_barrier
  v_mfma_f32_16x16x32_bf16 v[32:35], a[112:115], a[80:83], v[32:35]
  s_add_u32 m0, s64, 16384
  ds_read_b128 a[64:67], v16 offset:0
  ds_read_b64_tr_b16 a[96:97], v18 offset:16384
  v_mfma_f32_16x16x32_bf16 v[48:51], a[112:115], a[84:87], v[48:51]
  buffer_load_dwordx4 v10, s[12:15], s71 offen offset:0 lds
  ds_read_b64_tr_b16 a[98:99], v18 offset:18432
  v_mfma_f32_16x16x32_bf16 v[64:67], a[112:115], a[88:91], v[64:67]
  ds_read_b128 a[68:71], v16 offset:1024
  ds_read_b128 a[72:75], v17 offset:0
  v_mfma_f32_16x16x32_bf16 v[80:83], a[112:115], a[92:95], v[80:83]
  buffer_load_dwordx4 v11, s[12:15], s71 offen offset:1024 lds
  ds_read_b128 a[76:79], v17 offset:1024
  v_mfma_f32_16x16x32_bf16 v[36:39], a[116:119], a[80:83], v[36:39]
  ds_read_b64_tr_b16 a[100:101], v19 offset:16384
  ds_read_b64_tr_b16 a[102:103], v19 offset:18432
  v_mfma_f32_16x16x32_bf16 v[52:55], a[116:119], a[84:87], v[52:55]
  ds_read_b64_tr_b16 a[104:105], v20 offset:16384
  ds_read_b64_tr_b16 a[106:107], v20 offset:18432
  v_mfma_f32_16x16x32_bf16 v[68:71], a[116:119], a[88:91], v[68:71]
  ds_read_b64_tr_b16 a[108:109], v21 offset:16384
  ds_read_b64_tr_b16 a[110:111], v21 offset:18432
  v_mfma_f32_16x16x32_bf16 v[84:87], a[116:119], a[92:95], v[84:87]
  buffer_load_dwordx4 v12, s[12:15], s71 offen offset:2048 lds
  v_mfma_f32_16x16x32_bf16 v[40:43], a[120:123], a[80:83], v[40:43]
  v_mfma_f32_16x16x32_bf16 v[56:59], a[120:123], a[84:87], v[56:59]
  v_mfma_f32_16x16x32_bf16 v[72:75], a[120:123], a[88:91], v[72:75]
  v_mfma_f32_16x16x32_bf16 v[88:91], a[120:123], a[92:95], v[88:91]
  buffer_load_dwordx4 v13, s[12:15], s71 offen offset:3072 lds
  v_mfma_f32_16x16x32_bf16 v[44:47], a[124:127], a[80:83], v[44:47]
  s_bfe_u32 s72, 0x3020106, s31
  s_add_u32 s30, s30, s72
  s_add_u32 s31, s31, 8
  v_mfma_f32_16x16x32_bf16 v[60:63], a[124:127], a[84:87], v[60:63]
  s_and_b32 s31, s31, 0x8001f
  s_and_b32 s30, s30, 7
  s_lshl_b32 s72, s30, 17
  v_mfma_f32_16x16x32_bf16 v[76:79], a[124:127], a[88:91], v[76:79]
  s_add_u32 s71, s93, s72
  v_mfma_f32_16x16x32_bf16 v[92:95], a[124:127], a[92:95], v[92:95]
  s_waitcnt lgkmcnt(0)
  v_mfma_f32_16x16x32_bf16 v[32:35], a[96:99], a[64:67], v[32:35]
  s_mov_b32 m0, s64
  ds_read_b128 a[80:83], v16 offset:8192
  ds_read_b64_tr_b16 a[112:113], v18 offset:20480
  v_mfma_f32_16x16x32_bf16 v[48:51], a[96:99], a[68:71], v[48:51]
  buffer_load_dwordx4 v2, s[8:11], s70 offen offset:0 sc1 lds
  ds_read_b64_tr_b16 a[114:115], v18 offset:22528
  v_mfma_f32_16x16x32_bf16 v[64:67], a[96:99], a[72:75], v[64:67]
  buffer_load_dwordx4 v2, s[8:11], s70 offen offset:1024 sc1 lds
  ds_read_b128 a[84:87], v16 offset:9216
  v_mfma_f32_16x16x32_bf16 v[80:83], a[96:99], a[76:79], v[80:83]
  ds_read_b128 a[88:91], v17 offset:8192
  ds_read_b128 a[92:95], v17 offset:9216
  v_mfma_f32_16x16x32_bf16 v[36:39], a[100:103], a[64:67], v[36:39]
  buffer_load_dwordx4 v2, s[8:11], s70 offen offset:2048 sc1 lds
  ds_read_b64_tr_b16 a[116:117], v19 offset:20480
  v_mfma_f32_16x16x32_bf16 v[52:55], a[100:103], a[68:71], v[52:55]
  ds_read_b64_tr_b16 a[118:119], v19 offset:22528
  ds_read_b64_tr_b16 a[120:121], v20 offset:20480
  v_mfma_f32_16x16x32_bf16 v[68:71], a[100:103], a[72:75], v[68:71]
  buffer_load_dwordx4 v2, s[8:11], s70 offen offset:3072 sc1 lds
  ds_read_b64_tr_b16 a[122:123], v20 offset:22528
  v_mfma_f32_16x16x32_bf16 v[84:87], a[100:103], a[76:79], v[84:87]
  s_bfe_u32 s72, 0x3020106, s1
  s_add_u32 s0, s0, s72
  s_add_u32 s1, s1, 8
  v_mfma_f32_16x16x32_bf16 v[40:43], a[104:107], a[64:67], v[40:43]
  s_and_b32 s1, s1, 0x8001f
  s_and_b32 s0, s0, 7
  s_lshl_b32 s72, s0, 14
  v_mfma_f32_16x16x32_bf16 v[56:59], a[104:107], a[68:71], v[56:59]
  s_add_u32 s70, s92, s72
  ds_read_b64_tr_b16 a[124:125], v21 offset:20480
  ds_read_b64_tr_b16 a[126:127], v21 offset:22528
  v_mfma_f32_16x16x32_bf16 v[72:75], a[104:107], a[72:75], v[72:75]
  s_add_u32 s64, s64, s66
  s_add_u32 s65, s65, 1
  s_cmp_eq_u32 s65, 4
  s_cselect_b32 s65, 0, s65
  s_cselect_b32 s66, s67, s68
  v_mfma_f32_16x16x32_bf16 v[88:91], a[104:107], a[76:79], v[88:91]
  v_add_u32 v16, s66, v16
  v_add_u32 v17, s66, v17
  v_mfma_f32_16x16x32_bf16 v[44:47], a[108:111], a[64:67], v[44:47]
  v_add_u32 v18, s66, v18
  v_add_u32 v19, s66, v19
  v_mfma_f32_16x16x32_bf16 v[60:63], a[108:111], a[68:71], v[60:63]
  v_add_u32 v20, s66, v20
  v_add_u32 v21, s66, v21
  v_mfma_f32_16x16x32_bf16 v[76:79], a[108:111], a[72:75], v[76:79]
  v_mfma_f32_16x16x32_bf16 v[92:95], a[108:111], a[76:79], v[92:95]
  s_waitcnt vmcnt(16) lgkmcnt(0)
  s_barrier
  v_mfma_f32_16x16x32_bf16 v[32:35], a[112:115], a[80:83], v[32:35]
  s_mov_b32 s12, s74
  s_mov_b32 s13, s75
  s_mov_b32 s14, 8388608
  v_mfma_f32_16x16x32_bf16 v[48:51], a[112:115], a[84:87], v[48:51]
  s_mov_b32 s15, 0x00020000
  s_lshl_b32 s93, s77, 22
  s_lshl_b32 s72, s76, 8
  v_mfma_f32_16x16x32_bf16 v[64:67], a[112:115], a[88:91], v[64:67]
  s_add_u32 s93, s93, s72
  s_add_u32 s72, s73, s76
  s_and_b32 s31, s72, 3
  v_mfma_f32_16x16x32_bf16 v[80:83], a[112:115], a[92:95], v[80:83]
  s_lshl_b32 s31, s31, 3
  s_or_b32 s31, s31, 0x80000
  s_bfe_u32 s30, 0x1b1b02, s31
  v_mfma_f32_16x16x32_bf16 v[36:39], a[116:119], a[80:83], v[36:39]
  s_add_u32 s30, s30, 0
  s_cmp_ge_u32 s30, 28
  s_cselect_b32 s72, 28, 0
  v_mfma_f32_16x16x32_bf16 v[52:55], a[116:119], a[84:87], v[52:55]
  s_sub_u32 s30, s30, s72
  s_lshl_b32 s72, s30, 17
  s_add_u32 s71, s93, s72
  v_mfma_f32_16x16x32_bf16 v[68:71], a[116:119], a[88:91], v[68:71]
  s_add_u32 m0, s64, 16384
  ds_read_b128 a[64:67], v16 offset:0
  ds_read_b64_tr_b16 a[96:97], v18 offset:16384
  v_mfma_f32_16x16x32_bf16 v[84:87], a[116:119], a[92:95], v[84:87]
  buffer_load_dwordx4 v10, s[12:15], s71 offen offset:0 lds
  ds_read_b64_tr_b16 a[98:99], v18 offset:18432
  v_mfma_f32_16x16x32_bf16 v[40:43], a[120:123], a[80:83], v[40:43]
  buffer_load_dwordx4 v11, s[12:15], s71 offen offset:1024 lds
  ds_read_b128 a[68:71], v16 offset:1024
  v_mfma_f32_16x16x32_bf16 v[56:59], a[120:123], a[84:87], v[56:59]
  ds_read_b128 a[72:75], v17 offset:0
  ds_read_b128 a[76:79], v17 offset:1024
  v_mfma_f32_16x16x32_bf16 v[72:75], a[120:123], a[88:91], v[72:75]
  buffer_load_dwordx4 v12, s[12:15], s71 offen offset:2048 lds
  ds_read_b64_tr_b16 a[100:101], v19 offset:16384
  v_mfma_f32_16x16x32_bf16 v[88:91], a[120:123], a[92:95], v[88:91]
  ds_read_b64_tr_b16 a[102:103], v19 offset:18432
  ds_read_b64_tr_b16 a[104:105], v20 offset:16384
  v_mfma_f32_16x16x32_bf16 v[44:47], a[124:127], a[80:83], v[44:47]
  ds_read_b64_tr_b16 a[106:107], v20 offset:18432
  ds_read_b64_tr_b16 a[108:109], v21 offset:16384
  v_mfma_f32_16x16x32_bf16 v[60:63], a[124:127], a[84:87], v[60:63]
  ds_read_b64_tr_b16 a[110:111], v21 offset:18432
  v_mfma_f32_16x16x32_bf16 v[76:79], a[124:127], a[88:91], v[76:79]
  v_mfma_f32_16x16x32_bf16 v[92:95], a[124:127], a[92:95], v[92:95]
  s_waitcnt lgkmcnt(0)
  v_mfma_f32_16x16x32_bf16 v[32:35], a[96:99], a[64:67], v[32:35]
  buffer_load_dwordx4 v13, s[12:15], s71 offen offset:3072 lds
  ds_read_b128 a[80:83], v16 offset:8192
  v_mfma_f32_16x16x32_bf16 v[48:51], a[96:99], a[68:71], v[48:51]
  s_bfe_u32 s72, 0x302011a, s31
  s_add_u32 s30, s30, s72
  s_add_u32 s31, s31, 8
  v_mfma_f32_16x16x32_bf16 v[64:67], a[96:99], a[72:75], v[64:67]
  s_and_b32 s31, s31, 0x8001f
  s_cmp_ge_u32 s30, 28
  s_cselect_b32 s72, 28, 0
  v_mfma_f32_16x16x32_bf16 v[80:83], a[96:99], a[76:79], v[80:83]
  s_sub_u32 s30, s30, s72
  s_lshl_b32 s72, s30, 17
  s_add_u32 s71, s93, s72
  v_mfma_f32_16x16x32_bf16 v[36:39], a[100:103], a[64:67], v[36:39]
  buffer_load_dwordx2 v[6:7], v14, s[96:99], s91 offen sc1
  ds_read_b64_tr_b16 a[112:113], v18 offset:20480
  v_mfma_f32_16x16x32_bf16 v[52:55], a[100:103], a[68:71], v[52:55]
  s_add_u32 s64, s64, s66
  ds_read_b64_tr_b16 a[114:115], v18 offset:22528
  ds_read_b128 a[84:87], v16 offset:9216
  v_mfma_f32_16x16x32_bf16 v[68:71], a[100:103], a[72:75], v[68:71]
  s_add_u32 s65, s65, 1
  ds_read_b128 a[88:91], v17 offset:8192
  ds_read_b128 a[92:95], v17 offset:9216
  v_mfma_f32_16x16x32_bf16 v[84:87], a[100:103], a[76:79], v[84:87]
  s_cmp_eq_u32 s65, 4
  s_cselect_b32 s65, 0, s65
  s_cselect_b32 s66, s67, s68
  ds_read_b64_tr_b16 a[116:117], v19 offset:20480
  ds_read_b64_tr_b16 a[118:119], v19 offset:22528
  v_mfma_f32_16x16x32_bf16 v[40:43], a[104:107], a[64:67], v[40:43]
  ds_read_b64_tr_b16 a[120:121], v20 offset:20480
  ds_read_b64_tr_b16 a[122:123], v20 offset:22528
  v_mfma_f32_16x16x32_bf16 v[56:59], a[104:107], a[68:71], v[56:59]
  ds_read_b64_tr_b16 a[124:125], v21 offset:20480
  ds_read_b64_tr_b16 a[126:127], v21 offset:22528
  v_mfma_f32_16x16x32_bf16 v[72:75], a[104:107], a[72:75], v[72:75]
  v_add_u32 v16, s66, v16
  v_add_u32 v17, s66, v17
  v_mfma_f32_16x16x32_bf16 v[88:91], a[104:107], a[76:79], v[88:91]
  v_add_u32 v18, s66, v18
  v_add_u32 v19, s66, v19
  v_mfma_f32_16x16x32_bf16 v[44:47], a[108:111], a[64:67], v[44:47]
  v_add_u32 v20, s66, v20
  v_add_u32 v21, s66, v21
  v_mfma_f32_16x16x32_bf16 v[60:63], a[108:111], a[68:71], v[60:63]
  v_mfma_f32_16x16x32_bf16 v[76:79], a[108:111], a[72:75], v[76:79]
  v_mfma_f32_16x16x32_bf16 v[92:95], a[108:111], a[76:79], v[92:95]
  s_waitcnt vmcnt(0)
  v_cmp_ne_u64 vcc, s[94:95], v[6:7]
  s_nop 1
  v_cndmask_b32_e64 v8, 0, 1, vcc
  v_lshlrev_b32 v9, 2, v0
  ds_write_b32 v9, v8
  v_lshlrev_b32 v9, 4, v1
  s_waitcnt lgkmcnt(0)
  s_barrier
  ds_read_b128 v[160:163], v9
  s_waitcnt lgkmcnt(0)
  v_or3_b32 v160, v160, v161, v162
  v_or_b32 v160, v160, v163
  v_cmp_ne_u32 vcc, 0, v160
  s_nop 0
  s_cbranch_vccnz Lp6_late
  s_add_u32 s8, s86, 67108864
  s_addc_u32 s9, s87, 0
  s_mov_b32 s10, 16777216
  s_mov_b32 s11, 0x00020000
  s_lshl_b32 s92, s73, 1
  s_add_u32 s92, s92, s77
  s_lshl_b32 s92, s92, 19
  s_add_u32 s92, s92, s79
  s_add_u32 s72, s73, s76
  s_and_b32 s1, s72, 3
  s_lshl_b32 s1, s1, 3
  s_or_b32 s1, s1, 0x80000
  s_bfe_u32 s0, 0x1b1b02, s1
  s_add_u32 s0, s0, 0
  s_cmp_ge_u32 s0, 28
  s_cselect_b32 s72, 28, 0
  s_sub_u32 s0, s0, s72
  s_lshl_b32 s72, s0, 14
  s_add_u32 s70, s92, s72
  v_mfma_f32_16x16x32_bf16 v[32:35], a[112:115], a[80:83], v[32:35]
  s_add_u32 m0, s79, 131072
  ds_read_b128 a[64:67], v16 offset:0
  ds_read_b64_tr_b16 a[96:97], v18 offset:16384
  v_mfma_f32_16x16x32_bf16 v[48:51], a[112:115], a[84:87], v[48:51]
  buffer_load_dwordx4 v2, s[8:11], s70 offen offset:0 sc1 lds
  ds_read_b64_tr_b16 a[98:99], v18 offset:18432
  v_mfma_f32_16x16x32_bf16 v[64:67], a[112:115], a[88:91], v[64:67]
  buffer_load_dwordx4 v2, s[8:11], s70 offen offset:1024 sc1 lds
  ds_read_b128 a[68:71], v16 offset:1024
  v_mfma_f32_16x16x32_bf16 v[80:83], a[112:115], a[92:95], v[80:83]
  ds_read_b128 a[72:75], v17 offset:0
  ds_read_b128 a[76:79], v17 offset:1024
  v_mfma_f32_16x16x32_bf16 v[36:39], a[116:119], a[80:83], v[36:39]
  ds_read_b64_tr_b16 a[100:101], v19 offset:16384
  ds_read_b64_tr_b16 a[102:103], v19 offset:18432
  v_mfma_f32_16x16x32_bf16 v[52:55], a[116:119], a[84:87], v[52:55]
  buffer_load_dwordx4 v2, s[8:11], s70 offen offset:2048 sc1 lds
  ds_read_b64_tr_b16 a[104:105], v20 offset:16384
  v_mfma_f32_16x16x32_bf16 v[68:71], a[116:119], a[88:91], v[68:71]
  ds_read_b64_tr_b16 a[106:107], v20 offset:18432
  ds_read_b64_tr_b16 a[108:109], v21 offset:16384
  v_mfma_f32_16x16x32_bf16 v[84:87], a[116:119], a[92:95], v[84:87]
  buffer_load_dwordx4 v2, s[8:11], s70 offen offset:3072 sc1 lds
  ds_read_b64_tr_b16 a[110:111], v21 offset:18432
  v_mfma_f32_16x16x32_bf16 v[40:43], a[120:123], a[80:83], v[40:43]
  s_bfe_u32 s72, 0x302011a, s1
  s_add_u32 s0, s0, s72
  s_add_u32 s1, s1, 8
  v_mfma_f32_16x16x32_bf16 v[56:59], a[120:123], a[84:87], v[56:59]
  s_and_b32 s1, s1, 0x8001f
  s_cmp_ge_u32 s0, 28
  s_cselect_b32 s72, 28, 0
  v_mfma_f32_16x16x32_bf16 v[72:75], a[120:123], a[88:91], v[72:75]
  s_sub_u32 s0, s0, s72
  s_lshl_b32 s72, s0, 14
  s_add_u32 s70, s92, s72
  v_mfma_f32_16x16x32_bf16 v[88:91], a[120:123], a[92:95], v[88:91]
  s_add_u32 m0, s64, 16384
  v_mfma_f32_16x16x32_bf16 v[44:47], a[124:127], a[80:83], v[44:47]
  buffer_load_dwordx4 v10, s[12:15], s71 offen offset:0 lds
  v_mfma_f32_16x16x32_bf16 v[60:63], a[124:127], a[84:87], v[60:63]
  buffer_load_dwordx4 v11, s[12:15], s71 offen offset:1024 lds
  v_mfma_f32_16x16x32_bf16 v[76:79], a[124:127], a[88:91], v[76:79]
  v_mfma_f32_16x16x32_bf16 v[92:95], a[124:127], a[92:95], v[92:95]
  s_waitcnt lgkmcnt(0)
  v_mfma_f32_16x16x32_bf16 v[32:35], a[96:99], a[64:67], v[32:35]
  buffer_load_dwordx4 v12, s[12:15], s71 offen offset:2048 lds
  ds_read_b128 a[80:83], v16 offset:8192
  v_mfma_f32_16x16x32_bf16 v[48:51], a[96:99], a[68:71], v[48:51]
  buffer_load_dwordx4 v13, s[12:15], s71 offen offset:3072 lds
  ds_read_b64_tr_b16 a[112:113], v18 offset:20480
  v_mfma_f32_16x16x32_bf16 v[64:67], a[96:99], a[72:75], v[64:67]
  s_bfe_u32 s72, 0x302011a, s31
  s_add_u32 s30, s30, s72
  s_add_u32 s31, s31, 8
  v_mfma_f32_16x16x32_bf16 v[80:83], a[96:99], a[76:79], v[80:83]
  s_and_b32 s31, s31, 0x8001f
  s_cmp_ge_u32 s30, 28
  s_cselect_b32 s72, 28, 0
  v_mfma_f32_16x16x32_bf16 v[36:39], a[100:103], a[64:67], v[36:39]
  s_sub_u32 s30, s30, s72
  s_lshl_b32 s72, s30, 17
  s_add_u32 s71, s93, s72
  v_mfma_f32_16x16x32_bf16 v[52:55], a[100:103], a[68:71], v[52:55]
  s_mov_b32 m0, s64
  ds_read_b64_tr_b16 a[114:115], v18 offset:22528
  ds_read_b128 a[84:87], v16 offset:9216
  v_mfma_f32_16x16x32_bf16 v[68:71], a[100:103], a[72:75], v[68:71]
  buffer_load_dwordx4 v2, s[8:11], s70 offen offset:0 sc1 lds
  ds_read_b128 a[88:91], v17 offset:8192
  v_mfma_f32_16x16x32_bf16 v[84:87], a[100:103], a[76:79], v[84:87]
  buffer_load_dwordx4 v2, s[8:11], s70 offen offset:1024 sc1 lds
  ds_read_b128 a[92:95], v17 offset:9216
  v_mfma_f32_16x16x32_bf16 v[40:43], a[104:107], a[64:67], v[40:43]
  buffer_load_dwordx4 v2, s[8:11], s70 offen offset:2048 sc1 lds
  ds_read_b64_tr_b16 a[116:117], v19 offset:20480
  v_mfma_f32_16x16x32_bf16 v[56:59], a[104:107], a[68:71], v[56:59]
  buffer_load_dwordx4 v2, s[8:11], s70 offen offset:3072 sc1 lds
  ds_read_b64_tr_b16 a[118:119], v19 offset:22528
  v_mfma_f32_16x16x32_bf16 v[72:75], a[104:107], a[72:75], v[72:75]
  s_bfe_u32 s72, 0x302011a, s1
  s_add_u32 s0, s0, s72
  s_add_u32 s1, s1, 8
  v_mfma_f32_16x16x32_bf16 v[88:91], a[104:107], a[76:79], v[88:91]
  s_and_b32 s1, s1, 0x8001f
  s_cmp_ge_u32 s0, 28
  s_cselect_b32 s72, 28, 0
  v_mfma_f32_16x16x32_bf16 v[44:47], a[108:111], a[64:67], v[44:47]
  s_sub_u32 s0, s0, s72
  s_lshl_b32 s72, s0, 14
  s_add_u32 s70, s92, s72
  v_mfma_f32_16x16x32_bf16 v[60:63], a[108:111], a[68:71], v[60:63]
  s_add_u32 s64, s64, s66
  ds_read_b64_tr_b16 a[120:121], v20 offset:20480
  ds_read_b64_tr_b16 a[122:123], v20 offset:22528
  v_mfma_f32_16x16x32_bf16 v[76:79], a[108:111], a[72:75], v[76:79]
  s_add_u32 s65, s65, 1
  ds_read_b64_tr_b16 a[124:125], v21 offset:20480
  ds_read_b64_tr_b16 a[126:127], v21 offset:22528
  v_mfma_f32_16x16x32_bf16 v[92:95], a[108:111], a[76:79], v[92:95]
  s_cmp_eq_u32 s65, 4
  s_cselect_b32 s65, 0, s65
  s_cselect_b32 s66, s67, s68
  v_add_u32 v16, s66, v16
  v_add_u32 v17, s66, v17
  v_add_u32 v18, s66, v18
  v_add_u32 v19, s66, v19
  v_add_u32 v20, s66, v20
  v_add_u32 v21, s66, v21
  s_waitcnt vmcnt(12) lgkmcnt(0)
  s_barrier
  v_mfma_f32_16x16x32_bf16 v[32:35], a[112:115], a[80:83], v[32:35]
  s_add_u32 m0, s64, 16384
  ds_read_b128 a[64:67], v16 offset:0
  ds_read_b64_tr_b16 a[96:97], v18 offset:16384
  v_mfma_f32_16x16x32_bf16 v[48:51], a[112:115], a[84:87], v[48:51]
  buffer_load_dwordx4 v10, s[12:15], s71 offen offset:0 lds
  ds_read_b64_tr_b16 a[98:99], v18 offset:18432
  v_mfma_f32_16x16x32_bf16 v[64:67], a[112:115], a[88:91], v[64:67]
  ds_read_b128 a[68:71], v16 offset:1024
  ds_read_b128 a[72:75], v17 offset:0
  v_mfma_f32_16x16x32_bf16 v[80:83], a[112:115], a[92:95], v[80:83]
  buffer_load_dwordx4 v11, s[12:15], s71 offen offset:1024 lds
  ds_read_b128 a[76:79], v17 offset:1024
  v_mfma_f32_16x16x32_bf16 v[36:39], a[116:119], a[80:83], v[36:39]
  ds_read_b64_tr_b16 a[100:101], v19 offset:16384
  ds_read_b64_tr_b16 a[102:103], v19 offset:18432
  v_mfma_f32_16x16x32_bf16 v[52:55], a[116:119], a[84:87], v[52:55]
  ds_read_b64_tr_b16 a[104:105], v20 offset:16384
  ds_read_b64_tr_b16 a[106:107], v20 offset:18432
  v_mfma_f32_16x16x32_bf16 v[68:71], a[116:119], a[88:91], v[68:71]
  ds_read_b64_tr_b16 a[108:109], v21 offset:16384
  ds_read_b64_tr_b16 a[110:111], v21 offset:18432
  v_mfma_f32_16x16x32_bf16 v[84:87], a[116:119], a[92:95], v[84:87]
  buffer_load_dwordx4 v12, s[12:15], s71 offen offset:2048 lds
  v_mfma_f32_16x16x32_bf16 v[40:43], a[120:123], a[80:83], v[40:43]
  v_mfma_f32_16x16x32_bf16 v[56:59], a[120:123], a[84:87], v[56:59]
  v_mfma_f32_16x16x32_bf16 v[72:75], a[120:123], a[88:91], v[72:75]
  v_mfma_f32_16x16x32_bf16 v[88:91], a[120:123], a[92:95], v[88:91]
  buffer_load_dwordx4 v13, s[12:15], s71 offen offset:3072 lds
  v_mfma_f32_16x16x32_bf16 v[44:47], a[124:127], a[80:83], v[44:47]
  s_bfe_u32 s72, 0x302011a, s31
  s_add_u32 s30, s30, s72
  s_add_u32 s31, s31, 8
  v_mfma_f32_16x16x32_bf16 v[60:63], a[124:127], a[84:87], v[60:63]
  s_and_b32 s31, s31, 0x8001f
  s_cmp_ge_u32 s30, 28
  s_cselect_b32 s72, 28, 0
  v_mfma_f32_16x16x32_bf16 v[76:79], a[124:127], a[88:91], v[76:79]
  s_sub_u32 s30, s30, s72
  s_lshl_b32 s72, s30, 17
  s_add_u32 s71, s93, s72
  v_mfma_f32_16x16x32_bf16 v[92:95], a[124:127], a[92:95], v[92:95]
  s_waitcnt lgkmcnt(0)
  v_mfma_f32_16x16x32_bf16 v[32:35], a[96:99], a[64:67], v[32:35]
  s_mov_b32 m0, s64
  ds_read_b128 a[80:83], v16 offset:8192
  ds_read_b64_tr_b16 a[112:113], v18 offset:20480
  v_mfma_f32_16x16x32_bf16 v[48:51], a[96:99], a[68:71], v[48:51]
  buffer_load_dwordx4 v2, s[8:11], s70 offen offset:0 sc1 lds
  ds_read_b64_tr_b16 a[114:115], v18 offset:22528
  v_mfma_f32_16x16x32_bf16 v[64:67], a[96:99], a[72:75], v[64:67]
  buffer_load_dwordx4 v2, s[8:11], s70 offen offset:1024 sc1 lds
  ds_read_b128 a[84:87], v16 offset:9216
  v_mfma_f32_16x16x32_bf16 v[80:83], a[96:99], a[76:79], v[80:83]
  ds_read_b128 a[88:91], v17 offset:8192
  ds_read_b128 a[92:95], v17 offset:9216
  v_mfma_f32_16x16x32_bf16 v[36:39], a[100:103], a[64:67], v[36:39]
  buffer_load_dwordx4 v2, s[8:11], s70 offen offset:2048 sc1 lds
  ds_read_b64_tr_b16 a[116:117], v19 offset:20480
  v_mfma_f32_16x16x32_bf16 v[52:55], a[100:103], a[68:71], v[52:55]
  ds_read_b64_tr_b16 a[118:119], v19 offset:22528
  ds_read_b64_tr_b16 a[120:121], v20 offset:20480
  v_mfma_f32_16x16x32_bf16 v[68:71], a[100:103], a[72:75], v[68:71]
  buffer_load_dwordx4 v2, s[8:11], s70 offen offset:3072 sc1 lds
  ds_read_b64_tr_b16 a[122:123], v20 offset:22528
  v_mfma_f32_16x16x32_bf16 v[84:87], a[100:103], a[76:79], v[84:87]
  s_bfe_u32 s72, 0x302011a, s1
  s_add_u32 s0, s0, s72
  s_add_u32 s1, s1, 8
  v_mfma_f32_16x16x32_bf16 v[40:43], a[104:107], a[64:67], v[40:43]
  s_and_b32 s1, s1, 0x8001f
  s_cmp_ge_u32 s0, 28
  s_cselect_b32 s72, 28, 0
  v_mfma_f32_16x16x32_bf16 v[56:59], a[104:107], a[68:71], v[56:59]
  s_sub_u32 s0, s0, s72
  s_lshl_b32 s72, s0, 14
  s_add_u32 s70, s92, s72
  v_mfma_f32_16x16x32_bf16 v[72:75], a[104:107], a[72:75], v[72:75]
  s_add_u32 s64, s64, s66
  ds_read_b64_tr_b16 a[124:125], v21 offset:20480
  ds_read_b64_tr_b16 a[126:127], v21 offset:22528
  v_mfma_f32_16x16x32_bf16 v[88:91], a[104:107], a[76:79], v[88:91]
  s_add_u32 s65, s65, 1
  s_cmp_eq_u32 s65, 4
  s_cselect_b32 s65, 0, s65
  s_cselect_b32 s66, s67, s68
  v_mfma_f32_16x16x32_bf16 v[44:47], a[108:111], a[64:67], v[44:47]
  v_add_u32 v16, s66, v16
  v_add_u32 v17, s66, v17
  v_mfma_f32_16x16x32_bf16 v[60:63], a[108:111], a[68:71], v[60:63]
  v_add_u32 v18, s66, v18
  v_add_u32 v19, s66, v19
  v_mfma_f32_16x16x32_bf16 v[76:79], a[108:111], a[72:75], v[76:79]
  v_add_u32 v20, s66, v20
  v_add_u32 v21, s66, v21
  v_mfma_f32_16x16x32_bf16 v[92:95], a[108:111], a[76:79], v[92:95]
  s_waitcnt vmcnt(16) lgkmcnt(0)
  s_barrier
  v_mfma_f32_16x16x32_bf16 v[32:35], a[112:115], a[80:83], v[32:35]
  s_add_u32 m0, s64, 16384
  ds_read_b128 a[64:67], v16 offset:0
  ds_read_b64_tr_b16 a[96:97], v18 offset:16384
  v_mfma_f32_16x16x32_bf16 v[48:51], a[112:115], a[84:87], v[48:51]
  buffer_load_dwordx4 v10, s[12:15], s71 offen offset:0 lds
  ds_read_b64_tr_b16 a[98:99], v18 offset:18432
  v_mfma_f32_16x16x32_bf16 v[64:67], a[112:115], a[88:91], v[64:67]
  buffer_load_dwordx4 v11, s[12:15], s71 offen offset:1024 lds
  ds_read_b128 a[68:71], v16 offset:1024
  v_mfma_f32_16x16x32_bf16 v[80:83], a[112:115], a[92:95], v[80:83]
  buffer_load_dwordx4 v12, s[12:15], s71 offen offset:2048 lds
  ds_read_b128 a[72:75], v17 offset:0
  v_mfma_f32_16x16x32_bf16 v[36:39], a[116:119], a[80:83], v[36:39]
  ds_read_b128 a[76:79], v17 offset:1024
  ds_read_b64_tr_b16 a[100:101], v19 offset:16384
  v_mfma_f32_16x16x32_bf16 v[52:55], a[116:119], a[84:87], v[52:55]
  buffer_load_dwordx4 v13, s[12:15], s71 offen offset:3072 lds
  ds_read_b64_tr_b16 a[102:103], v19 offset:18432
  v_mfma_f32_16x16x32_bf16 v[68:71], a[116:119], a[88:91], v[68:71]
  s_bfe_u32 s72, 0x302011a, s31
  s_add_u32 s30, s30, s72
  s_add_u32 s31, s31, 8
  v_mfma_f32_16x16x32_bf16 v[84:87], a[116:119], a[92:95], v[84:87]
  s_and_b32 s31, s31, 0x8001f
  s_cmp_ge_u32 s30, 28
  s_cselect_b32 s72, 28, 0
  v_mfma_f32_16x16x32_bf16 v[40:43], a[120:123], a[80:83], v[40:43]
  s_sub_u32 s30, s30, s72
  s_lshl_b32 s72, s30, 17
  s_add_u32 s71, s93, s72
  v_mfma_f32_16x16x32_bf16 v[56:59], a[120:123], a[84:87], v[56:59]
  s_mov_b32 m0, s64
  ds_read_b64_tr_b16 a[104:105], v20 offset:16384
  ds_read_b64_tr_b16 a[106:107], v20 offset:18432
  v_mfma_f32_16x16x32_bf16 v[72:75], a[120:123], a[88:91], v[72:75]
  buffer_load_dwordx4 v2, s[8:11], s70 offen offset:0 sc1 lds
  ds_read_b64_tr_b16 a[108:109], v21 offset:16384
  v_mfma_f32_16x16x32_bf16 v[88:91], a[120:123], a[92:95], v[88:91]
  buffer_load_dwordx4 v2, s[8:11], s70 offen offset:1024 sc1 lds
  ds_read_b64_tr_b16 a[110:111], v21 offset:18432
  v_mfma_f32_16x16x32_bf16 v[44:47], a[124:127], a[80:83], v[44:47]
  buffer_load_dwordx4 v2, s[8:11], s70 offen offset:2048 sc1 lds
  v_mfma_f32_16x16x32_bf16 v[60:63], a[124:127], a[84:87], v[60:63]
  buffer_load_dwordx4 v2, s[8:11], s70 offen offset:3072 sc1 lds
  v_mfma_f32_16x16x32_bf16 v[76:79], a[124:127], a[88:91], v[76:79]
  s_bfe_u32 s72, 0x302011a, s1
  s_add_u32 s0, s0, s72
  s_add_u32 s1, s1, 8
  v_mfma_f32_16x16x32_bf16 v[92:95], a[124:127], a[92:95], v[92:95]
  s_and_b32 s1, s1, 0x8001f
  s_cmp_ge_u32 s0, 28
  s_cselect_b32 s72, 28, 0
  s_sub_u32 s0, s0, s72
  s_lshl_b32 s72, s0, 14
  s_add_u32 s70, s92, s72
  s_waitcnt lgkmcnt(0)
  s_lshl_b32 s6, s78, 1
  s_add_u32 s6, s6, s77
  s_xor_b32 s6, s6, 1
  s_lshl_b32 s6, s6, 2
  s_add_u32 s6, s6, s3
  s_lshl_b32 s6, s6, 13
  s_add_u32 s6, s6, 8388608
  s_add_u32 s7, s6, 4096
  v_mfma_f32_16x16x32_bf16 v[96:99], a[96:99], a[64:67], 0
  s_add_u32 s64, s64, s66
  ds_read_b128 a[80:83], v16 offset:8192
  ds_read_b64_tr_b16 a[112:113], v18 offset:20480
  v_mfma_f32_16x16x32_bf16 v[112:115], a[96:99], a[68:71], 0
  s_add_u32 s65, s65, 1
  ds_read_b64_tr_b16 a[114:115], v18 offset:22528
  ds_read_b128 a[84:87], v16 offset:9216
  v_mfma_f32_16x16x32_bf16 v[128:131], a[96:99], a[72:75], 0
  s_cmp_eq_u32 s65, 4
  s_cselect_b32 s65, 0, s65
  s_cselect_b32 s66, s67, s68
  ds_read_b128 a[88:91], v17 offset:8192
  ds_read_b128 a[92:95], v17 offset:9216
  v_mfma_f32_16x16x32_bf16 v[144:147], a[96:99], a[76:79], 0
  ds_read_b64_tr_b16 a[116:117], v19 offset:20480
  v_mfma_f32_16x16x32_bf16 v[100:103], a[100:103], a[64:67], 0
  ds_read_b64_tr_b16 a[118:119], v19 offset:22528
  ds_read_b64_tr_b16 a[120:121], v20 offset:20480
  v_mfma_f32_16x16x32_bf16 v[116:119], a[100:103], a[68:71], 0
  ds_read_b64_tr_b16 a[122:123], v20 offset:22528
  ds_read_b64_tr_b16 a[124:125], v21 offset:20480
  v_mfma_f32_16x16x32_bf16 v[132:135], a[100:103], a[72:75], 0
  buffer_store_dwordx4 v[64:67], v2, s[16:19], s6 offen offset:0 sc1
  ds_read_b64_tr_b16 a[126:127], v21 offset:22528
  v_mfma_f32_16x16x32_bf16 v[148:151], a[100:103], a[76:79], 0
  v_add_u32 v16, s66, v16
  v_add_u32 v17, s66, v17
  v_mfma_f32_16x16x32_bf16 v[104:107], a[104:107], a[64:67], 0
  v_add_u32 v18, s66, v18
  v_add_u32 v19, s66, v19
  v_mfma_f32_16x16x32_bf16 v[120:123], a[104:107], a[68:71], 0
  v_add_u32 v20, s66, v20
  v_add_u32 v21, s66, v21
  v_mfma_f32_16x16x32_bf16 v[136:139], a[104:107], a[72:75], 0
  buffer_store_dwordx4 v[68:71], v2, s[16:19], s6 offen offset:1024 sc1
  v_mfma_f32_16x16x32_bf16 v[152:155], a[104:107], a[76:79], 0
  buffer_store_dwordx4 v[72:75], v2, s[16:19], s6 offen offset:2048 sc1
  v_mfma_f32_16x16x32_bf16 v[108:111], a[108:111], a[64:67], 0
  buffer_store_dwordx4 v[76:79], v2, s[16:19], s6 offen offset:3072 sc1
  v_mfma_f32_16x16x32_bf16 v[124:127], a[108:111], a[68:71], 0
  buffer_store_dwordx4 v[80:83], v2, s[16:19], s7 offen offset:0 sc1
  v_mfma_f32_16x16x32_bf16 v[140:143], a[108:111], a[72:75], 0
  buffer_store_dwordx4 v[84:87], v2, s[16:19], s7 offen offset:1024 sc1
  v_mfma_f32_16x16x32_bf16 v[156:159], a[108:111], a[76:79], 0
  buffer_store_dwordx4 v[88:91], v2, s[16:19], s7 offen offset:2048 sc1
  buffer_store_dwordx4 v[92:95], v2, s[16:19], s7 offen offset:3072 sc1
  s_branch Lp7
Lp6_late:
  v_mfma_f32_16x16x32_bf16 v[32:35], a[112:115], a[80:83], v[32:35]
  s_add_u32 m0, s64, 16384
  ds_read_b128 a[64:67], v16 offset:0
  ds_read_b64_tr_b16 a[96:97], v18 offset:16384
  v_mfma_f32_16x16x32_bf16 v[48:51], a[112:115], a[84:87], v[48:51]
  buffer_load_dwordx4 v10, s[12:15], s71 offen offset:0 lds
  ds_read_b64_tr_b16 a[98:99], v18 offset:18432
  v_mfma_f32_16x16x32_bf16 v[64:67], a[112:115], a[88:91], v[64:67]
  ds_read_b128 a[68:71], v16 offset:1024
  ds_read_b128 a[72:75], v17 offset:0
  v_mfma_f32_16x16x32_bf16 v[80:83], a[112:115], a[92:95], v[80:83]
  ds_read_b128 a[76:79], v17 offset:1024
  ds_read_b64_tr_b16 a[100:101], v19 offset:16384
  v_mfma_f32_16x16x32_bf16 v[36:39], a[116:119], a[80:83], v[36:39]
  ds_read_b64_tr_b16 a[102:103], v19 offset:18432
  ds_read_b64_tr_b16 a[104:105], v20 offset:16384
  v_mfma_f32_16x16x32_bf16 v[52:55], a[116:119], a[84:87], v[52:55]
  ds_read_b64_tr_b16 a[106:107], v20 offset:18432
  ds_read_b64_tr_b16 a[108:109], v21 offset:16384
  v_mfma_f32_16x16x32_bf16 v[68:71], a[116:119], a[88:91], v[68:71]
  ds_read_b64_tr_b16 a[110:111], v21 offset:18432
  v_mfma_f32_16x16x32_bf16 v[84:87], a[116:119], a[92:95], v[84:87]
  buffer_load_dwordx4 v11, s[12:15], s71 offen offset:1024 lds
  v_mfma_f32_16x16x32_bf16 v[40:43], a[120:123], a[80:83], v[40:43]
  v_mfma_f32_16x16x32_bf16 v[56:59], a[120:123], a[84:87], v[56:59]
  v_mfma_f32_16x16x32_bf16 v[72:75], a[120:123], a[88:91], v[72:75]
  v_mfma_f32_16x16x32_bf16 v[88:91], a[120:123], a[92:95], v[88:91]
  v_mfma_f32_16x16x32_bf16 v[44:47], a[124:127], a[80:83], v[44:47]
  v_mfma_f32_16x16x32_bf16 v[60:63], a[124:127], a[84:87], v[60:63]
  v_mfma_f32_16x16x32_bf16 v[76:79], a[124:127], a[88:91], v[76:79]
  v_mfma_f32_16x16x32_bf16 v[92:95], a[124:127], a[92:95], v[92:95]
  s_waitcnt lgkmcnt(0)
  v_mfma_f32_16x16x32_bf16 v[32:35], a[96:99], a[64:67], v[32:35]
  buffer_load_dwordx4 v12, s[12:15], s71 offen offset:2048 lds
  ds_read_b128 a[80:83], v16 offset:8192
  v_mfma_f32_16x16x32_bf16 v[48:51], a[96:99], a[68:71], v[48:51]
  ds_read_b64_tr_b16 a[112:113], v18 offset:20480
  ds_read_b64_tr_b16 a[114:115], v18 offset:22528
  v_mfma_f32_16x16x32_bf16 v[64:67], a[96:99], a[72:75], v[64:67]
  ds_read_b128 a[84:87], v16 offset:9216
  ds_read_b128 a[88:91], v17 offset:8192
  v_mfma_f32_16x16x32_bf16 v[80:83], a[96:99], a[76:79], v[80:83]
  ds_read_b128 a[92:95], v17 offset:9216
  ds_read_b64_tr_b16 a[116:117], v19 offset:20480
  v_mfma_f32_16x16x32_bf16 v[36:39], a[100:103], a[64:67], v[36:39]
  buffer_load_dwordx4 v13, s[12:15], s71 offen offset:3072 lds
  ds_read_b64_tr_b16 a[118:119], v19 offset:22528
  v_mfma_f32_16x16x32_bf16 v[52:55], a[100:103], a[68:71], v[52:55]
  s_bfe_u32 s72, 0x302011a, s31
  s_add_u32 s30, s30, s72
  s_add_u32 s31, s31, 8
  v_mfma_f32_16x16x32_bf16 v[68:71], a[100:103], a[72:75], v[68:71]
  s_and_b32 s31, s31, 0x8001f
  s_cmp_ge_u32 s30, 28
  s_cselect_b32 s72, 28, 0
  v_mfma_f32_16x16x32_bf16 v[84:87], a[100:103], a[76:79], v[84:87]
  s_sub_u32 s30, s30, s72
  s_lshl_b32 s72, s30, 17
  s_add_u32 s71, s93, s72
  v_mfma_f32_16x16x32_bf16 v[40:43], a[104:107], a[64:67], v[40:43]
  s_add_u32 s64, s64, s66
  ds_read_b64_tr_b16 a[120:121], v20 offset:20480
  ds_read_b64_tr_b16 a[122:123], v20 offset:22528
  v_mfma_f32_16x16x32_bf16 v[56:59], a[104:107], a[68:71], v[56:59]
  s_add_u32 s65, s65, 1
  ds_read_b64_tr_b16 a[124:125], v21 offset:20480
  ds_read_b64_tr_b16 a[126:127], v21 offset:22528
  v_mfma_f32_16x16x32_bf16 v[72:75], a[104:107], a[72:75], v[72:75]
  s_cmp_eq_u32 s65, 4
  s_cselect_b32 s65, 0, s65
  s_cselect_b32 s66, s67, s68
  v_mfma_f32_16x16x32_bf16 v[88:91], a[104:107], a[76:79], v[88:91]
  v_add_u32 v16, s66, v16
  v_add_u32 v17, s66, v17
  v_mfma_f32_16x16x32_bf16 v[44:47], a[108:111], a[64:67], v[44:47]
  v_add_u32 v18, s66, v18
  v_add_u32 v19, s66, v19
  v_mfma_f32_16x16x32_bf16 v[60:63], a[108:111], a[68:71], v[60:63]
  v_add_u32 v20, s66, v20
  v_add_u32 v21, s66, v21
  v_mfma_f32_16x16x32_bf16 v[76:79], a[108:111], a[72:75], v[76:79]
  v_mfma_f32_16x16x32_bf16 v[92:95], a[108:111], a[76:79], v[92:95]
  s_waitcnt vmcnt(4) lgkmcnt(0)
  s_barrier
  v_mfma_f32_16x16x32_bf16 v[32:35], a[112:115], a[80:83], v[32:35]
  s_add_u32 m0, s64, 16384
  ds_read_b128 a[64:67], v16 offset:0
  ds_read_b64_tr_b16 a[96:97], v18 offset:16384
  v_mfma_f32_16x16x32_bf16 v[48:51], a[112:115], a[84:87], v[48:51]
  buffer_load_dwordx4 v10, s[12:15], s71 offen offset:0 lds
  ds_read_b64_tr_b16 a[98:99], v18 offset:18432
  v_mfma_f32_16x16x32_bf16 v[64:67], a[112:115], a[88:91], v[64:67]
  ds_read_b128 a[68:71], v16 offset:1024
  ds_read_b128 a[72:75], v17 offset:0
  v_mfma_f32_16x16x32_bf16 v[80:83], a[112:115], a[92:95], v[80:83]
  ds_read_b128 a[76:79], v17 offset:1024
  ds_read_b64_tr_b16 a[100:101], v19 offset:16384
  v_mfma_f32_16x16x32_bf16 v[36:39], a[116:119], a[80:83], v[36:39]
  ds_read_b64_tr_b16 a[102:103], v19 offset:18432
  ds_read_b64_tr_b16 a[104:105], v20 offset:16384
  v_mfma_f32_16x16x32_bf16 v[52:55], a[116:119], a[84:87], v[52:55]
  buffer_load_dwordx4 v11, s[12:15], s71 offen offset:1024 lds
  ds_read_b64_tr_b16 a[106:107], v20 offset:18432
  v_mfma_f32_16x16x32_bf16 v[68:71], a[116:119], a[88:91], v[68:71]
  ds_read_b64_tr_b16 a[108:109], v21 offset:16384
  ds_read_b64_tr_b16 a[110:111], v21 offset:18432
  v_mfma_f32_16x16x32_bf16 v[84:87], a[116:119], a[92:95], v[84:87]
  v_mfma_f32_16x16x32_bf16 v[40:43], a[120:123], a[80:83], v[40:43]
  v_mfma_f32_16x16x32_bf16 v[56:59], a[120:123], a[84:87], v[56:59]
  v_mfma_f32_16x16x32_bf16 v[72:75], a[120:123], a[88:91], v[72:75]
  buffer_load_dwordx4 v12, s[12:15], s71 offen offset:2048 lds
  v_mfma_f32_16x16x32_bf16 v[88:91], a[120:123], a[92:95], v[88:91]
  v_mfma_f32_16x16x32_bf16 v[44:47], a[124:127], a[80:83], v[44:47]
  v_mfma_f32_16x16x32_bf16 v[60:63], a[124:127], a[84:87], v[60:63]
  v_mfma_f32_16x16x32_bf16 v[76:79], a[124:127], a[88:91], v[76:79]
  v_mfma_f32_16x16x32_bf16 v[92:95], a[124:127], a[92:95], v[92:95]
  s_waitcnt lgkmcnt(0)
  v_mfma_f32_16x16x32_bf16 v[32:35], a[96:99], a[64:67], v[32:35]
  buffer_load_dwordx4 v13, s[12:15], s71 offen offset:3072 lds
  ds_read_b128 a[80:83], v16 offset:8192
  v_mfma_f32_16x16x32_bf16 v[48:51], a[96:99], a[68:71], v[48:51]
  s_bfe_u32 s72, 0x302011a, s31
  s_add_u32 s30, s30, s72
  s_add_u32 s31, s31, 8
  v_mfma_f32_16x16x32_bf16 v[64:67], a[96:99], a[72:75], v[64:67]
  s_and_b32 s31, s31, 0x8001f
  s_cmp_ge_u32 s30, 28
  s_cselect_b32 s72, 28, 0
  v_mfma_f32_16x16x32_bf16 v[80:83], a[96:99], a[76:79], v[80:83]
  s_sub_u32 s30, s30, s72
  s_lshl_b32 s72, s30, 17
  s_add_u32 s71, s93, s72
  v_mfma_f32_16x16x32_bf16 v[36:39], a[100:103], a[64:67], v[36:39]
  buffer_load_dwordx2 v[6:7], v14, s[96:99], s91 offen sc1
  ds_read_b64_tr_b16 a[112:113], v18 offset:20480
  v_mfma_f32_16x16x32_bf16 v[52:55], a[100:103], a[68:71], v[52:55]
  s_add_u32 s64, s64, s66
  ds_read_b64_tr_b16 a[114:115], v18 offset:22528
  ds_read_b128 a[84:87], v16 offset:9216
  v_mfma_f32_16x16x32_bf16 v[68:71], a[100:103], a[72:75], v[68:71]
  s_add_u32 s65, s65, 1
  ds_read_b128 a[88:91], v17 offset:8192
  ds_read_b128 a[92:95], v17 offset:9216
  v_mfma_f32_16x16x32_bf16 v[84:87], a[100:103], a[76:79], v[84:87]
  s_cmp_eq_u32 s65, 4
  s_cselect_b32 s65, 0, s65
  s_cselect_b32 s66, s67, s68
  ds_read_b64_tr_b16 a[116:117], v19 offset:20480
  ds_read_b64_tr_b16 a[118:119], v19 offset:22528
  v_mfma_f32_16x16x32_bf16 v[40:43], a[104:107], a[64:67], v[40:43]
  ds_read_b64_tr_b16 a[120:121], v20 offset:20480
  ds_read_b64_tr_b16 a[122:123], v20 offset:22528
  v_mfma_f32_16x16x32_bf16 v[56:59], a[104:107], a[68:71], v[56:59]
  ds_read_b64_tr_b16 a[124:125], v21 offset:20480
  ds_read_b64_tr_b16 a[126:127], v21 offset:22528
  v_mfma_f32_16x16x32_bf16 v[72:75], a[104:107], a[72:75], v[72:75]
  v_add_u32 v16, s66, v16
  v_add_u32 v17, s66, v17
  v_mfma_f32_16x16x32_bf16 v[88:91], a[104:107], a[76:79], v[88:91]
  v_add_u32 v18, s66, v18
  v_add_u32 v19, s66, v19
  v_mfma_f32_16x16x32_bf16 v[44:47], a[108:111], a[64:67], v[44:47]
  v_add_u32 v20, s66, v20
  v_add_u32 v21, s66, v21
  v_mfma_f32_16x16x32_bf16 v[60:63], a[108:111], a[68:71], v[60:63]
  v_mfma_f32_16x16x32_bf16 v[76:79], a[108:111], a[72:75], v[76:79]
  v_mfma_f32_16x16x32_bf16 v[92:95], a[108:111], a[76:79], v[92:95]
  s_waitcnt vmcnt(0) lgkmcnt(0)
  s_barrier
  s_mov_b32 s5, 0x40000
Lpoll_15:
  v_cmp_ne_u64 vcc, s[94:95], v[6:7]
  s_nop 0
  s_cbranch_vccz Lpolld_16
  s_sleep 4
  buffer_load_dwordx2 v[6:7], v14, s[96:99], s91 offen sc1
  s_sub_u32 s5, s5, 1
  s_waitcnt vmcnt(0)
  s_cbranch_scc0 Lpoll_15
Lpolld_16:
  s_add_u32 s8, s86, 67108864
  s_addc_u32 s9, s87, 0
  s_mov_b32 s10, 16777216
  s_mov_b32 s11, 0x00020000
  s_lshl_b32 s92, s73, 1
  s_add_u32 s92, s92, s77
  s_lshl_b32 s92, s92, 19
  s_add_u32 s92, s92, s79
  s_add_u32 s72, s73, s76
  s_and_b32 s1, s72, 3
  s_lshl_b32 s1, s1, 3
  s_or_b32 s1, s1, 0x80000
  s_bfe_u32 s0, 0x1b1b02, s1
  s_add_u32 s0, s0, 0
  s_cmp_ge_u32 s0, 28
  s_cselect_b32 s72, 28, 0
  s_sub_u32 s0, s0, s72
  s_lshl_b32 s72, s0, 14
  s_add_u32 s70, s92, s72
  v_mfma_f32_16x16x32_bf16 v[32:35], a[112:115], a[80:83], v[32:35]
  s_add_u32 m0, s79, 131072
  v_mfma_f32_16x16x32_bf16 v[48:51], a[112:115], a[84:87], v[48:51]
  buffer_load_dwordx4 v2, s[8:11], s70 offen offset:0 sc1 lds
  v_mfma_f32_16x16x32_bf16 v[64:67], a[112:115], a[88:91], v[64:67]
  buffer_load_dwordx4 v2, s[8:11], s70 offen offset:1024 sc1 lds
  v_mfma_f32_16x16x32_bf16 v[80:83], a[112:115], a[92:95], v[80:83]
  buffer_load_dwordx4 v2, s[8:11], s70 offen offset:2048 sc1 lds
  v_mfma_f32_16x16x32_bf16 v[36:39], a[116:119], a[80:83], v[36:39]
  buffer_load_dwordx4 v2, s[8:11], s70 offen offset:3072 sc1 lds
  v_mfma_f32_16x16x32_bf16 v[52:55], a[116:119], a[84:87], v[52:55]
  s_bfe_u32 s72, 0x302011a, s1
  s_add_u32 s0, s0, s72
  s_add_u32 s1, s1, 8
  v_mfma_f32_16x16x32_bf16 v[68:71], a[116:119], a[88:91], v[68:71]
  s_and_b32 s1, s1, 0x8001f
  s_cmp_ge_u32 s0, 28
  s_cselect_b32 s72, 28, 0
  v_mfma_f32_16x16x32_bf16 v[84:87], a[116:119], a[92:95], v[84:87]
  s_sub_u32 s0, s0, s72
  s_lshl_b32 s72, s0, 14
  s_add_u32 s70, s92, s72
  v_mfma_f32_16x16x32_bf16 v[40:43], a[120:123], a[80:83], v[40:43]
  s_add_u32 m0, s79, 32768
  v_mfma_f32_16x16x32_bf16 v[56:59], a[120:123], a[84:87], v[56:59]
  buffer_load_dwordx4 v2, s[8:11], s70 offen offset:0 sc1 lds
  v_mfma_f32_16x16x32_bf16 v[72:75], a[120:123], a[88:91], v[72:75]
  buffer_load_dwordx4 v2, s[8:11], s70 offen offset:1024 sc1 lds
  v_mfma_f32_16x16x32_bf16 v[88:91], a[120:123], a[92:95], v[88:91]
  buffer_load_dwordx4 v2, s[8:11], s70 offen offset:2048 sc1 lds
  v_mfma_f32_16x16x32_bf16 v[44:47], a[124:127], a[80:83], v[44:47]
  buffer_load_dwordx4 v2, s[8:11], s70 offen offset:3072 sc1 lds
  v_mfma_f32_16x16x32_bf16 v[60:63], a[124:127], a[84:87], v[60:63]
  s_bfe_u32 s72, 0x302011a, s1
  s_add_u32 s0, s0, s72
  s_add_u32 s1, s1, 8
  v_mfma_f32_16x16x32_bf16 v[76:79], a[124:127], a[88:91], v[76:79]
  s_and_b32 s1, s1, 0x8001f
  s_cmp_ge_u32 s0, 28
  s_cselect_b32 s72, 28, 0
  v_mfma_f32_16x16x32_bf16 v[92:95], a[124:127], a[92:95], v[92:95]
  s_sub_u32 s0, s0, s72
  s_lshl_b32 s72, s0, 14
  s_add_u32 s70, s92, s72
  s_add_u32 m0, s79, 65536
  s_nop 0
  buffer_load_dwordx4 v2, s[8:11], s70 offen offset:0 sc1 lds
  buffer_load_dwordx4 v2, s[8:11], s70 offen offset:1024 sc1 lds
  buffer_load_dwordx4 v2, s[8:11], s70 offen offset:2048 sc1 lds
  buffer_load_dwordx4 v2, s[8:11], s70 offen offset:3072 sc1 lds
  s_bfe_u32 s72, 0x302011a, s1
  s_add_u32 s0, s0, s72
  s_add_u32 s1, s1, 8
  s_and_b32 s1, s1, 0x8001f
  s_cmp_ge_u32 s0, 28
  s_cselect_b32 s72, 28, 0
  s_sub_u32 s0, s0, s72
  s_lshl_b32 s72, s0, 14
  s_add_u32 s70, s92, s72
  s_add_u32 m0, s79, 114688
  s_nop 0
  buffer_load_dwordx4 v10, s[12:15], s71 offen offset:0 lds
  buffer_load_dwordx4 v11, s[12:15], s71 offen offset:1024 lds
  buffer_load_dwordx4 v12, s[12:15], s71 offen offset:2048 lds
  buffer_load_dwordx4 v13, s[12:15], s71 offen offset:3072 lds
  s_bfe_u32 s72, 0x302011a, s31
  s_add_u32 s30, s30, s72
  s_add_u32 s31, s31, 8
  s_and_b32 s31, s31, 0x8001f
  s_cmp_ge_u32 s30, 28
  s_cselect_b32 s72, 28, 0
  s_sub_u32 s30, s30, s72
  s_lshl_b32 s72, s30, 17
  s_add_u32 s71, s93, s72
  s_add_u32 m0, s79, 98304
  s_nop 0
  buffer_load_dwordx4 v2, s[8:11], s70 offen offset:0 sc1 lds
  buffer_load_dwordx4 v2, s[8:11], s70 offen offset:1024 sc1 lds
  buffer_load_dwordx4 v2, s[8:11], s70 offen offset:2048 sc1 lds
  buffer_load_dwordx4 v2, s[8:11], s70 offen offset:3072 sc1 lds
  s_bfe_u32 s72, 0x302011a, s1
  s_add_u32 s0, s0, s72
  s_add_u32 s1, s1, 8
  s_and_b32 s1, s1, 0x8001f
  s_cmp_ge_u32 s0, 28
  s_cselect_b32 s72, 28, 0
  s_sub_u32 s0, s0, s72
  s_lshl_b32 s72, s0, 14
  s_add_u32 s70, s92, s72
  s_lshl_b32 s6, s78, 1
  s_add_u32 s6, s6, s77
  s_xor_b32 s6, s6, 1
  s_lshl_b32 s6, s6, 2
  s_add_u32 s6, s6, s3
  s_lshl_b32 s6, s6, 13
  s_add_u32 s6, s6, 8388608
  s_add_u32 s7, s6, 4096
  buffer_store_dwordx4 v[64:67], v2, s[16:19], s6 offen offset:0 sc1
  buffer_store_dwordx4 v[68:71], v2, s[16:19], s6 offen offset:1024 sc1
  buffer_store_dwordx4 v[72:75], v2, s[16:19], s6 offen offset:2048 sc1
  buffer_store_dwordx4 v[76:79], v2, s[16:19], s6 offen offset:3072 sc1
  buffer_store_dwordx4 v[80:83], v2, s[16:19], s7 offen offset:0 sc1
  buffer_store_dwordx4 v[84:87], v2, s[16:19], s7 offen offset:1024 sc1
  buffer_store_dwordx4 v[88:91], v2, s[16:19], s7 offen offset:2048 sc1
  buffer_store_dwordx4 v[92:95], v2, s[16:19], s7 offen offset:3072 sc1
  s_waitcnt vmcnt(24)
  s_barrier
  ds_read_b128 a[64:67], v16 offset:0
  ds_read_b64_tr_b16 a[96:97], v18 offset:16384
  ds_read_b64_tr_b16 a[98:99], v18 offset:18432
  ds_read_b128 a[68:71], v16 offset:1024
  ds_read_b128 a[72:75], v17 offset:0
  ds_read_b128 a[76:79], v17 offset:1024
  ds_read_b64_tr_b16 a[100:101], v19 offset:16384
  ds_read_b64_tr_b16 a[102:103], v19 offset:18432
  ds_read_b64_tr_b16 a[104:105], v20 offset:16384
  ds_read_b64_tr_b16 a[106:107], v20 offset:18432
  ds_read_b64_tr_b16 a[108:109], v21 offset:16384
  ds_read_b64_tr_b16 a[110:111], v21 offset:18432
  s_waitcnt lgkmcnt(0)
  v_mfma_f32_16x16x32_bf16 v[96:99], a[96:99], a[64:67], 0
  s_add_u32 s64, s64, s66
  ds_read_b128 a[80:83], v16 offset:8192
  ds_read_b64_tr_b16 a[112:113], v18 offset:20480
  v_mfma_f32_16x16x32_bf16 v[112:115], a[96:99], a[68:71], 0
  s_add_u32 s65, s65, 1
  ds_read_b64_tr_b16 a[114:115], v18 offset:22528
  ds_read_b128 a[84:87], v16 offset:9216
  v_mfma_f32_16x16x32_bf16 v[128:131], a[96:99], a[72:75], 0
  s_cmp_eq_u32 s65, 4
  s_cselect_b32 s65, 0, s65
  s_cselect_b32 s66, s67, s68
  ds_read_b128 a[88:91], v17 offset:8192
  ds_read_b128 a[92:95], v17 offset:9216
  v_mfma_f32_16x16x32_bf16 v[144:147], a[96:99], a[76:79], 0
  ds_read_b64_tr_b16 a[116:117], v19 offset:20480
  v_mfma_f32_16x16x32_bf16 v[100:103], a[100:103], a[64:67], 0
  ds_read_b64_tr_b16 a[118:119], v19 offset:22528
  ds_read_b64_tr_b16 a[120:121], v20 offset:20480
  v_mfma_f32_16x16x32_bf16 v[116:119], a[100:103], a[68:71], 0
  ds_read_b64_tr_b16 a[122:123], v20 offset:22528
  ds_read_b64_tr_b16 a[124:125], v21 offset:20480
  v_mfma_f32_16x16x32_bf16 v[132:135], a[100:103], a[72:75], 0
  ds_read_b64_tr_b16 a[126:127], v21 offset:22528
  v_mfma_f32_16x16x32_bf16 v[148:151], a[100:103], a[76:79], 0
  v_add_u32 v16, s66, v16
  v_add_u32 v17, s66, v17
  v_mfma_f32_16x16x32_bf16 v[104:107], a[104:107], a[64:67], 0
  v_add_u32 v18, s66, v18
  v_add_u32 v19, s66, v19
  v_mfma_f32_16x16x32_bf16 v[120:123], a[104:107], a[68:71], 0
  v_add_u32 v20, s66, v20
  v_add_u32 v21, s66, v21
  v_mfma_f32_16x16x32_bf16 v[136:139], a[104:107], a[72:75], 0
  v_mfma_f32_16x16x32_bf16 v[152:155], a[104:107], a[76:79], 0
  v_mfma_f32_16x16x32_bf16 v[108:111], a[108:111], a[64:67], 0
  v_mfma_f32_16x16x32_bf16 v[124:127], a[108:111], a[68:71], 0
  v_mfma_f32_16x16x32_bf16 v[140:143], a[108:111], a[72:75], 0
  v_mfma_f32_16x16x32_bf16 v[156:159], a[108:111], a[76:79], 0
Lp7:
  s_mov_b32 s69, 23
  s_waitcnt vmcnt(16) lgkmcnt(0)
  s_barrier
  .p2align 6
Lp7_loop:
  v_mfma_f32_16x16x32_bf16 v[96:99], a[112:115], a[80:83], v[96:99]
  s_add_u32 m0, s64, 16384
  ds_read_b128 a[64:67], v16 offset:0
  ds_read_b64_tr_b16 a[96:97], v18 offset:16384
  v_mfma_f32_16x16x32_bf16 v[112:115], a[112:115], a[84:87], v[112:115]
  buffer_load_dwordx4 v10, s[12:15], s71 offen offset:0 lds
  ds_read_b64_tr_b16 a[98:99], v18 offset:18432
  v_mfma_f32_16x16x32_bf16 v[128:131], a[112:115], a[88:91], v[128:131]
  ds_read_b128 a[68:71], v16 offset:1024
  ds_read_b128 a[72:75], v17 offset:0
  v_mfma_f32_16x16x32_bf16 v[144:147], a[112:115], a[92:95], v[144:147]
  buffer_load_dwordx4 v11, s[12:15], s71 offen offset:1024 lds
  ds_read_b128 a[76:79], v17 offset:1024
  v_mfma_f32_16x16x32_bf16 v[100:103], a[116:119], a[80:83], v[100:103]
  ds_read_b64_tr_b16 a[100:101], v19 offset:16384
  ds_read_b64_tr_b16 a[102:103], v19 offset:18432
  v_mfma_f32_16x16x32_bf16 v[116:119], a[116:119], a[84:87], v[116:119]
  ds_read_b64_tr_b16 a[104:105], v20 offset:16384
  ds_read_b64_tr_b16 a[106:107], v20 offset:18432
  v_mfma_f32_16x16x32_bf16 v[132:135], a[116:119], a[88:91], v[132:135]
  ds_read_b64_tr_b16 a[108:109], v21 offset:16384
  ds_read_b64_tr_b16 a[110:111], v21 offset:18432
  v_mfma_f32_16x16x32_bf16 v[148:151], a[116:119], a[92:95], v[148:151]
  buffer_load_dwordx4 v12, s[12:15], s71 offen offset:2048 lds
  v_mfma_f32_16x16x32_bf16 v[104:107], a[120:123], a[80:83], v[104:107]
  v_mfma_f32_16x16x32_bf16 v[120:123], a[120:123], a[84:87], v[120:123]
  v_mfma_f32_16x16x32_bf16 v[136:139], a[120:123], a[88:91], v[136:139]
  v_mfma_f32_16x16x32_bf16 v[152:155], a[120:123], a[92:95], v[152:155]
  buffer_load_dwordx4 v13, s[12:15], s71 offen offset:3072 lds
  v_mfma_f32_16x16x32_bf16 v[108:111], a[124:127], a[80:83], v[108:111]
  s_bfe_u32 s72, 0x302011a, s31
  s_add_u32 s30, s30, s72
  s_add_u32 s31, s31, 8
  v_mfma_f32_16x16x32_bf16 v[124:127], a[124:127], a[84:87], v[124:127]
  s_and_b32 s31, s31, 0x8001f
  s_cmp_ge_u32 s30, 28
  s_cselect_b32 s72, 28, 0
  v_mfma_f32_16x16x32_bf16 v[140:143], a[124:127], a[88:91], v[140:143]
  s_sub_u32 s30, s30, s72
  s_lshl_b32 s72, s30, 17
  s_add_u32 s71, s93, s72
  v_mfma_f32_16x16x32_bf16 v[156:159], a[124:127], a[92:95], v[156:159]
  s_waitcnt lgkmcnt(0)
  v_mfma_f32_16x16x32_bf16 v[96:99], a[96:99], a[64:67], v[96:99]
  s_mov_b32 m0, s64
  ds_read_b128 a[80:83], v16 offset:8192
  ds_read_b64_tr_b16 a[112:113], v18 offset:20480
  v_mfma_f32_16x16x32_bf16 v[112:115], a[96:99], a[68:71], v[112:115]
  buffer_load_dwordx4 v2, s[8:11], s70 offen offset:0 sc1 lds
  ds_read_b64_tr_b16 a[114:115], v18 offset:22528
  v_mfma_f32_16x16x32_bf16 v[128:131], a[96:99], a[72:75], v[128:131]
  buffer_load_dwordx4 v2, s[8:11], s70 offen offset:1024 sc1 lds
  ds_read_b128 a[84:87], v16 offset:9216
  v_mfma_f32_16x16x32_bf16 v[144:147], a[96:99], a[76:79], v[144:147]
  ds_read_b128 a[88:91], v17 offset:8192
  ds_read_b128 a[92:95], v17 offset:9216
  v_mfma_f32_16x16x32_bf16 v[100:103], a[100:103], a[64:67], v[100:103]
  buffer_load_dwordx4 v2, s[8:11], s70 offen offset:2048 sc1 lds
  ds_read_b64_tr_b16 a[116:117], v19 offset:20480
  v_mfma_f32_16x16x32_bf16 v[116:119], a[100:103], a[68:71], v[116:119]
  ds_read_b64_tr_b16 a[118:119], v19 offset:22528
  ds_read_b64_tr_b16 a[120:121], v20 offset:20480
  v_mfma_f32_16x16x32_bf16 v[132:135], a[100:103], a[72:75], v[132:135]
  buffer_load_dwordx4 v2, s[8:11], s70 offen offset:3072 sc1 lds
  ds_read_b64_tr_b16 a[122:123], v20 offset:22528
  v_mfma_f32_16x16x32_bf16 v[148:151], a[100:103], a[76:79], v[148:151]
  s_bfe_u32 s72, 0x302011a, s1
  s_add_u32 s0, s0, s72
  s_add_u32 s1, s1, 8
  v_mfma_f32_16x16x32_bf16 v[104:107], a[104:107], a[64:67], v[104:107]
  s_and_b32 s1, s1, 0x8001f
  s_cmp_ge_u32 s0, 28
  s_cselect_b32 s72, 28, 0
  v_mfma_f32_16x16x32_bf16 v[120:123], a[104:107], a[68:71], v[120:123]
  s_sub_u32 s0, s0, s72
  s_lshl_b32 s72, s0, 14
  s_add_u32 s70, s92, s72
  v_mfma_f32_16x16x32_bf16 v[136:139], a[104:107], a[72:75], v[136:139]
  s_add_u32 s64, s64, s66
  ds_read_b64_tr_b16 a[124:125], v21 offset:20480
  ds_read_b64_tr_b16 a[126:127], v21 offset:22528
  v_mfma_f32_16x16x32_bf16 v[152:155], a[104:107], a[76:79], v[152:155]
  s_add_u32 s65, s65, 1
  s_cmp_eq_u32 s65, 4
  s_cselect_b32 s65, 0, s65
  s_cselect_b32 s66, s67, s68
  v_mfma_f32_16x16x32_bf16 v[108:111], a[108:111], a[64:67], v[108:111]
  v_add_u32 v16, s66, v16
  v_add_u32 v17, s66, v17
  v_mfma_f32_16x16x32_bf16 v[124:127], a[108:111], a[68:71], v[124:127]
  s_waitcnt vmcnt(16) lgkmcnt(0)
  s_barrier
  v_add_u32 v18, s66, v18
  v_add_u32 v19, s66, v19
  v_mfma_f32_16x16x32_bf16 v[140:143], a[108:111], a[72:75], v[140:143]
  s_sub_u32 s69, s69, 1
  v_add_u32 v20, s66, v20
  v_add_u32 v21, s66, v21
  v_mfma_f32_16x16x32_bf16 v[156:159], a[108:111], a[76:79], v[156:159]
  s_cmp_lg_u32 s69, 0
  s_cbranch_scc1 Lp7_loop
  s_lshl_b32 s6, s78, 1
  s_add_u32 s6, s6, s77
  s_lshl_b32 s6, s6, 7
  s_add_u32 s6, s6, 163840
  v_mov_b32 v8, 0x40000000
  v_mov_b32 v6, s94
  v_cmp_eq_u32 vcc, 0, v0
  v_mov_b32 v7, s95
  s_nop 0
  v_cndmask_b32_e64 v8, v8, 0, vcc
  buffer_store_dwordx2 v[6:7], v8, s[96:99], s6 offen sc1
  s_lshl_b32 s90, s78, 1
  s_add_u32 s90, s90, s77
  s_xor_b32 s90, s90, 1
  s_lshl_b32 s90, s90, 7
  s_add_u32 s90, s90, 163840
  s_mov_b32 s20, s82
  s_mov_b32 s21, s83
  s_mov_b32 s22, 8388608
  s_mov_b32 s23, 0x00020000
  v_bfe_u32 v25, v1, 4, 1
  v_lshrrev_b32 v26, 5, v1
  v_lshl_or_b32 v25, v25, 1, v26
  v_lshlrev_b32 v25, 4, v25
  v_and_b32 v24, 15, v1
  v_lshl_add_u32 v26, v24, 14, v25
  v_lshl_add_u32 v27, v24, 12, v25
  v_mfma_f32_16x16x32_bf16 v[96:99], a[112:115], a[80:83], v[96:99]
  s_add_u32 m0, s64, 16384
  ds_read_b128 a[64:67], v16 offset:0
  ds_read_b64_tr_b16 a[96:97], v18 offset:16384
  v_mfma_f32_16x16x32_bf16 v[112:115], a[112:115], a[84:87], v[112:115]
  buffer_load_dwordx4 v10, s[12:15], s71 offen offset:0 lds
  ds_read_b64_tr_b16 a[98:99], v18 offset:18432
  v_mfma_f32_16x16x32_bf16 v[128:131], a[112:115], a[88:91], v[128:131]
  ds_read_b128 a[68:71], v16 offset:1024
  ds_read_b128 a[72:75], v17 offset:0
  v_mfma_f32_16x16x32_bf16 v[144:147], a[112:115], a[92:95], v[144:147]
  buffer_load_dwordx4 v11, s[12:15], s71 offen offset:1024 lds
  ds_read_b128 a[76:79], v17 offset:1024
  v_mfma_f32_16x16x32_bf16 v[100:103], a[116:119], a[80:83], v[100:103]
  ds_read_b64_tr_b16 a[100:101], v19 offset:16384
  ds_read_b64_tr_b16 a[102:103], v19 offset:18432
  v_mfma_f32_16x16x32_bf16 v[116:119], a[116:119], a[84:87], v[116:119]
  ds_read_b64_tr_b16 a[104:105], v20 offset:16384
  ds_read_b64_tr_b16 a[106:107], v20 offset:18432
  v_mfma_f32_16x16x32_bf16 v[132:135], a[116:119], a[88:91], v[132:135]
  ds_read_b64_tr_b16 a[108:109], v21 offset:16384
  ds_read_b64_tr_b16 a[110:111], v21 offset:18432
  v_mfma_f32_16x16x32_bf16 v[148:151], a[116:119], a[92:95], v[148:151]
  buffer_load_dwordx4 v12, s[12:15], s71 offen offset:2048 lds
  v_mfma_f32_16x16x32_bf16 v[104:107], a[120:123], a[80:83], v[104:107]
  v_mfma_f32_16x16x32_bf16 v[120:123], a[120:123], a[84:87], v[120:123]
  v_mfma_f32_16x16x32_bf16 v[136:139], a[120:123], a[88:91], v[136:139]
  v_mfma_f32_16x16x32_bf16 v[152:155], a[120:123], a[92:95], v[152:155]
  buffer_load_dwordx4 v13, s[12:15], s71 offen offset:3072 lds
  v_mfma_f32_16x16x32_bf16 v[108:111], a[124:127], a[80:83], v[108:111]
  s_bfe_u32 s72, 0x302011a, s31
  s_add_u32 s30, s30, s72
  s_add_u32 s31, s31, 8
  v_mfma_f32_16x16x32_bf16 v[124:127], a[124:127], a[84:87], v[124:127]
  s_and_b32 s31, s31, 0x8001f
  s_cmp_ge_u32 s30, 28
  s_cselect_b32 s72, 28, 0
  v_mfma_f32_16x16x32_bf16 v[140:143], a[124:127], a[88:91], v[140:143]
  s_sub_u32 s30, s30, s72
  s_lshl_b32 s72, s30, 17
  s_add_u32 s71, s93, s72
  v_mfma_f32_16x16x32_bf16 v[156:159], a[124:127], a[92:95], v[156:159]
  s_waitcnt lgkmcnt(0)
  v_mfma_f32_16x16x32_bf16 v[96:99], a[96:99], a[64:67], v[96:99]
  s_mov_b32 m0, s64
  ds_read_b128 a[80:83], v16 offset:8192
  ds_read_b64_tr_b16 a[112:113], v18 offset:20480
  v_mfma_f32_16x16x32_bf16 v[112:115], a[96:99], a[68:71], v[112:115]
  buffer_load_dwordx4 v2, s[8:11], s70 offen offset:0 sc1 lds
  ds_read_b64_tr_b16 a[114:115], v18 offset:22528
  v_mfma_f32_16x16x32_bf16 v[128:131], a[96:99], a[72:75], v[128:131]
  buffer_load_dwordx4 v2, s[8:11], s70 offen offset:1024 sc1 lds
  ds_read_b128 a[84:87], v16 offset:9216
  v_mfma_f32_16x16x32_bf16 v[144:147], a[96:99], a[76:79], v[144:147]
  ds_read_b128 a[88:91], v17 offset:8192
  ds_read_b128 a[92:95], v17 offset:9216
  v_mfma_f32_16x16x32_bf16 v[100:103], a[100:103], a[64:67], v[100:103]
  buffer_load_dwordx4 v2, s[8:11], s70 offen offset:2048 sc1 lds
  ds_read_b64_tr_b16 a[116:117], v19 offset:20480
  v_mfma_f32_16x16x32_bf16 v[116:119], a[100:103], a[68:71], v[116:119]
  ds_read_b64_tr_b16 a[118:119], v19 offset:22528
  ds_read_b64_tr_b16 a[120:121], v20 offset:20480
  v_mfma_f32_16x16x32_bf16 v[132:135], a[100:103], a[72:75], v[132:135]
  buffer_load_dwordx4 v2, s[8:11], s70 offen offset:3072 sc1 lds
  ds_read_b64_tr_b16 a[122:123], v20 offset:22528
  v_mfma_f32_16x16x32_bf16 v[148:151], a[100:103], a[76:79], v[148:151]
  s_bfe_u32 s72, 0x302011a, s1
  s_add_u32 s0, s0, s72
  s_add_u32 s1, s1, 8
  v_mfma_f32_16x16x32_bf16 v[104:107], a[104:107], a[64:67], v[104:107]
  s_and_b32 s1, s1, 0x8001f
  s_cmp_ge_u32 s0, 28
  s_cselect_b32 s72, 28, 0
  v_mfma_f32_16x16x32_bf16 v[120:123], a[104:107], a[68:71], v[120:123]
  s_sub_u32 s0, s0, s72
  s_lshl_b32 s72, s0, 14
  s_add_u32 s70, s92, s72
  v_mfma_f32_16x16x32_bf16 v[136:139], a[104:107], a[72:75], v[136:139]
  s_add_u32 s64, s64, s66
  ds_read_b64_tr_b16 a[124:125], v21 offset:20480
  ds_read_b64_tr_b16 a[126:127], v21 offset:22528
  v_mfma_f32_16x16x32_bf16 v[152:155], a[104:107], a[76:79], v[152:155]
  s_add_u32 s65, s65, 1
  s_cmp_eq_u32 s65, 4
  s_cselect_b32 s65, 0, s65
  s_cselect_b32 s66, s67, s68
  v_mfma_f32_16x16x32_bf16 v[108:111], a[108:111], a[64:67], v[108:111]
  v_add_u32 v16, s66, v16
  v_add_u32 v17, s66, v17
  v_mfma_f32_16x16x32_bf16 v[124:127], a[108:111], a[68:71], v[124:127]
  v_add_u32 v18, s66, v18
  v_add_u32 v19, s66, v19
  v_mfma_f32_16x16x32_bf16 v[140:143], a[108:111], a[72:75], v[140:143]
  v_add_u32 v20, s66, v20
  v_add_u32 v21, s66, v21
  v_mfma_f32_16x16x32_bf16 v[156:159], a[108:111], a[76:79], v[156:159]
  s_waitcnt vmcnt(17) lgkmcnt(0)
  s_barrier
  v_mfma_f32_16x16x32_bf16 v[96:99], a[112:115], a[80:83], v[96:99]
  buffer_load_dwordx2 v[6:7], off, s[96:99], s90 sc1
  ds_read_b128 a[64:67], v16 offset:0
  v_mfma_f32_16x16x32_bf16 v[112:115], a[112:115], a[84:87], v[112:115]
  s_and_b32 s88, s3, 1
  s_lshl_b32 s88, s88, 12
  s_lshr_b32 s72, s3, 1
  v_mfma_f32_16x16x32_bf16 v[128:131], a[112:115], a[88:91], v[128:131]
  s_lshl_b32 s72, s72, 13
  s_add_u32 s88, s88, s72
  s_lshl_b32 s72, s77, 11
  v_mfma_f32_16x16x32_bf16 v[144:147], a[112:115], a[92:95], v[144:147]
  s_add_u32 s88, s88, s72
  s_sub_u32 s88, s88, s79
  s_add_u32 s70, s92, s88
  v_mfma_f32_16x16x32_bf16 v[100:103], a[116:119], a[80:83], v[100:103]
  s_add_u32 s70, s70, 458752
  s_add_u32 s71, s93, 3670016
  s_add_u32 m0, s64, 16384
  v_mfma_f32_16x16x32_bf16 v[116:119], a[116:119], a[84:87], v[116:119]
  buffer_load_dwordx4 v10, s[12:15], s71 offen offset:0 lds
  ds_read_b64_tr_b16 a[96:97], v18 offset:16384
  v_mfma_f32_16x16x32_bf16 v[132:135], a[116:119], a[88:91], v[132:135]
  ds_read_b64_tr_b16 a[98:99], v18 offset:18432
  ds_read_b128 a[68:71], v16 offset:1024
  v_mfma_f32_16x16x32_bf16 v[148:151], a[116:119], a[92:95], v[148:151]
  buffer_load_dwordx4 v11, s[12:15], s71 offen offset:1024 lds
  ds_read_b128 a[72:75], v17 offset:0
  v_mfma_f32_16x16x32_bf16 v[104:107], a[120:123], a[80:83], v[104:107]
  ds_read_b128 a[76:79], v17 offset:1024
  ds_read_b64_tr_b16 a[100:101], v19 offset:16384
  v_mfma_f32_16x16x32_bf16 v[120:123], a[120:123], a[84:87], v[120:123]
  ds_read_b64_tr_b16 a[102:103], v19 offset:18432
  ds_read_b64_tr_b16 a[104:105], v20 offset:16384
  v_mfma_f32_16x16x32_bf16 v[136:139], a[120:123], a[88:91], v[136:139]
  ds_read_b64_tr_b16 a[106:107], v20 offset:18432
  ds_read_b64_tr_b16 a[108:109], v21 offset:16384
  v_mfma_f32_16x16x32_bf16 v[152:155], a[120:123], a[92:95], v[152:155]
  buffer_load_dwordx4 v12, s[12:15], s71 offen offset:2048 lds
  ds_read_b64_tr_b16 a[110:111], v21 offset:18432
  v_mfma_f32_16x16x32_bf16 v[108:111], a[124:127], a[80:83], v[108:111]
  v_mfma_f32_16x16x32_bf16 v[124:127], a[124:127], a[84:87], v[124:127]
  v_mfma_f32_16x16x32_bf16 v[140:143], a[124:127], a[88:91], v[140:143]
  v_mfma_f32_16x16x32_bf16 v[156:159], a[124:127], a[92:95], v[156:159]
  s_waitcnt lgkmcnt(0)
  v_mfma_f32_16x16x32_bf16 v[96:99], a[96:99], a[64:67], v[96:99]
  buffer_load_dwordx4 v13, s[12:15], s71 offen offset:3072 lds
  ds_read_b128 a[80:83], v16 offset:8192
  v_mfma_f32_16x16x32_bf16 v[112:115], a[96:99], a[68:71], v[112:115]
  s_add_u32 s71, s71, 131072
  s_add_u32 m0, s64, s88
  ds_read_b64_tr_b16 a[112:113], v18 offset:20480
  v_mfma_f32_16x16x32_bf16 v[128:131], a[96:99], a[72:75], v[128:131]
  ds_read_b64_tr_b16 a[114:115], v18 offset:22528
  ds_read_b128 a[84:87], v16 offset:9216
  v_mfma_f32_16x16x32_bf16 v[144:147], a[96:99], a[76:79], v[144:147]
  buffer_load_dwordx4 v2, s[8:11], s70 offen offset:0 sc1 lds
  ds_read_b128 a[88:91], v17 offset:8192
  v_mfma_f32_16x16x32_bf16 v[100:103], a[100:103], a[64:67], v[100:103]
  ds_read_b128 a[92:95], v17 offset:9216
  ds_read_b64_tr_b16 a[116:117], v19 offset:20480
  v_mfma_f32_16x16x32_bf16 v[116:119], a[100:103], a[68:71], v[116:119]
  ds_read_b64_tr_b16 a[118:119], v19 offset:22528
  ds_read_b64_tr_b16 a[120:121], v20 offset:20480
  v_mfma_f32_16x16x32_bf16 v[132:135], a[100:103], a[72:75], v[132:135]
  buffer_load_dwordx4 v2, s[8:11], s70 offen offset:1024 sc1 lds
  ds_read_b64_tr_b16 a[122:123], v20 offset:22528
  v_mfma_f32_16x16x32_bf16 v[148:151], a[100:103], a[76:79], v[148:151]
  s_add_u32 s70, s70, 16384
  ds_read_b64_tr_b16 a[124:125], v21 offset:20480
  ds_read_b64_tr_b16 a[126:127], v21 offset:22528
  v_mfma_f32_16x16x32_bf16 v[104:107], a[104:107], a[64:67], v[104:107]
  s_add_u32 s64, s64, s66
  s_add_u32 s65, s65, 1
  s_cmp_eq_u32 s65, 4
  s_cselect_b32 s65, 0, s65
  s_cselect_b32 s66, s67, s68
  v_mfma_f32_16x16x32_bf16 v[120:123], a[104:107], a[68:71], v[120:123]
  v_add_u32 v16, s66, v16
  v_add_u32 v17, s66, v17
  v_mfma_f32_16x16x32_bf16 v[136:139], a[104:107], a[72:75], v[136:139]
  v_add_u32 v18, s66, v18
  v_add_u32 v19, s66, v19
  v_mfma_f32_16x16x32_bf16 v[152:155], a[104:107], a[76:79], v[152:155]
  v_add_u32 v20, s66, v20
  v_add_u32 v21, s66, v21
  v_mfma_f32_16x16x32_bf16 v[108:111], a[108:111], a[64:67], v[108:111]
  v_mfma_f32_16x16x32_bf16 v[124:127], a[108:111], a[68:71], v[124:127]
  v_mfma_f32_16x16x32_bf16 v[140:143], a[108:111], a[72:75], v[140:143]
  v_mfma_f32_16x16x32_bf16 v[156:159], a[108:111], a[76:79], v[156:159]
  s_waitcnt vmcnt(6) lgkmcnt(0)
  s_barrier
  s_mov_b32 s5, 0x40000
Lpoll_17:
  v_cmp_ne_u64 vcc, s[94:95], v[6:7]
  s_nop 0
  s_cbranch_vccz Lpolld_18
  s_sleep 4
  buffer_load_dwordx2 v[6:7], off, s[96:99], s90 sc1
  s_sub_u32 s5, s5, 1
  s_waitcnt vmcnt(0)
  s_cbranch_scc0 Lpoll_17
Lpolld_18:
  v_mfma_f32_16x16x32_bf16 v[96:99], a[112:115], a[80:83], v[96:99]
  s_lshl_b32 s6, s78, 1
  s_add_u32 s6, s6, s77
  s_lshl_b32 s6, s6, 2
  v_mfma_f32_16x16x32_bf16 v[112:115], a[112:115], a[84:87], v[112:115]
  s_add_u32 s6, s6, s3
  s_lshl_b32 s6, s6, 13
  s_add_u32 s6, s6, 8388608
  v_mfma_f32_16x16x32_bf16 v[128:131], a[112:115], a[88:91], v[128:131]
  s_add_u32 s7, s6, 4096
  buffer_load_dwordx4 v[160:163], v2, s[16:19], s6 offen offset:0 sc1
  ds_read_b128 a[64:67], v16 offset:0
  v_mfma_f32_16x16x32_bf16 v[144:147], a[112:115], a[92:95], v[144:147]
  buffer_load_dwordx4 v[164:167], v2, s[16:19], s6 offen offset:1024 sc1
  ds_read_b64_tr_b16 a[96:97], v18 offset:16384
  v_mfma_f32_16x16x32_bf16 v[100:103], a[116:119], a[80:83], v[100:103]
  buffer_load_dwordx4 v[168:171], v2, s[16:19], s6 offen offset:2048 sc1
  ds_read_b64_tr_b16 a[98:99], v18 offset:18432
  v_mfma_f32_16x16x32_bf16 v[116:119], a[116:119], a[84:87], v[116:119]
  ds_read_b128 a[68:71], v16 offset:1024
  ds_read_b128 a[72:75], v17 offset:0
  v_mfma_f32_16x16x32_bf16 v[132:135], a[116:119], a[88:91], v[132:135]
  buffer_load_dwordx4 v[172:175], v2, s[16:19], s6 offen offset:3072 sc1
  ds_read_b128 a[76:79], v17 offset:1024
  v_mfma_f32_16x16x32_bf16 v[148:151], a[116:119], a[92:95], v[148:151]
  ds_read_b64_tr_b16 a[100:101], v19 offset:16384
  ds_read_b64_tr_b16 a[102:103], v19 offset:18432
  v_mfma_f32_16x16x32_bf16 v[104:107], a[120:123], a[80:83], v[104:107]
  buffer_load_dwordx4 v[176:179], v2, s[16:19], s7 offen offset:0 sc1
  ds_read_b64_tr_b16 a[104:105], v20 offset:16384
  v_mfma_f32_16x16x32_bf16 v[120:123], a[120:123], a[84:87], v[120:123]
  ds_read_b64_tr_b16 a[106:107], v20 offset:18432
  ds_read_b64_tr_b16 a[108:109], v21 offset:16384
  v_mfma_f32_16x16x32_bf16 v[136:139], a[120:123], a[88:91], v[136:139]
  buffer_load_dwordx4 v[180:183], v2, s[16:19], s7 offen offset:1024 sc1
  ds_read_b64_tr_b16 a[110:111], v21 offset:18432
  v_mfma_f32_16x16x32_bf16 v[152:155], a[120:123], a[92:95], v[152:155]
  v_mfma_f32_16x16x32_bf16 v[108:111], a[124:127], a[80:83], v[108:111]
  buffer_load_dwordx4 v[184:187], v2, s[16:19], s7 offen offset:2048 sc1
  v_mfma_f32_16x16x32_bf16 v[124:127], a[124:127], a[84:87], v[124:127]
  v_mfma_f32_16x16x32_bf16 v[140:143], a[124:127], a[88:91], v[140:143]
  v_mfma_f32_16x16x32_bf16 v[156:159], a[124:127], a[92:95], v[156:159]
  s_waitcnt lgkmcnt(0)
  v_mfma_f32_16x16x32_bf16 v[96:99], a[96:99], a[64:67], v[96:99]
  buffer_load_dwordx4 v[188:191], v2, s[16:19], s7 offen offset:3072 sc1
  ds_read_b128 a[80:83], v16 offset:8192
  v_mfma_f32_16x16x32_bf16 v[112:115], a[96:99], a[68:71], v[112:115]
  s_add_u32 m0, s64, 16384
  ds_read_b64_tr_b16 a[112:113], v18 offset:20480
  ds_read_b64_tr_b16 a[114:115], v18 offset:22528
  v_mfma_f32_16x16x32_bf16 v[128:131], a[96:99], a[72:75], v[128:131]
  buffer_load_dwordx4 v10, s[12:15], s71 offen offset:0 lds
  ds_read_b128 a[84:87], v16 offset:9216
  v_mfma_f32_16x16x32_bf16 v[144:147], a[96:99], a[76:79], v[144:147]
  buffer_load_dwordx4 v11, s[12:15], s71 offen offset:1024 lds
  ds_read_b128 a[88:91], v17 offset:8192
  v_mfma_f32_16x16x32_bf16 v[100:103], a[100:103], a[64:67], v[100:103]
  buffer_load_dwordx4 v12, s[12:15], s71 offen offset:2048 lds
  ds_read_b128 a[92:95], v17 offset:9216
  v_mfma_f32_16x16x32_bf16 v[116:119], a[100:103], a[68:71], v[116:119]
  buffer_load_dwordx4 v13, s[12:15], s71 offen offset:3072 lds
  ds_read_b64_tr_b16 a[116:117], v19 offset:20480
  v_mfma_f32_16x16x32_bf16 v[132:135], a[100:103], a[72:75], v[132:135]
  s_add_u32 s71, s71, 131072
  s_add_u32 m0, s64, s88
  ds_read_b64_tr_b16 a[118:119], v19 offset:22528
  v_mfma_f32_16x16x32_bf16 v[148:151], a[100:103], a[76:79], v[148:151]
  buffer_load_dwordx4 v2, s[8:11], s70 offen offset:0 sc1 lds
  ds_read_b64_tr_b16 a[120:121], v20 offset:20480
  v_mfma_f32_16x16x32_bf16 v[104:107], a[104:107], a[64:67], v[104:107]
  buffer_load_dwordx4 v2, s[8:11], s70 offen offset:1024 sc1 lds
  ds_read_b64_tr_b16 a[122:123], v20 offset:22528
  v_mfma_f32_16x16x32_bf16 v[120:123], a[104:107], a[68:71], v[120:123]
  s_add_u32 s70, s70, 16384
  ds_read_b64_tr_b16 a[124:125], v21 offset:20480
  ds_read_b64_tr_b16 a[126:127], v21 offset:22528
  v_mfma_f32_16x16x32_bf16 v[136:139], a[104:107], a[72:75], v[136:139]
  s_add_u32 s64, s64, s66
  s_add_u32 s65, s65, 1
  s_cmp_eq_u32 s65, 4
  s_cselect_b32 s65, 0, s65
  s_cselect_b32 s66, s67, s68
  v_mfma_f32_16x16x32_bf16 v[152:155], a[104:107], a[76:79], v[152:155]
  v_add_u32 v16, s66, v16
  v_add_u32 v17, s66, v17
  v_mfma_f32_16x16x32_bf16 v[108:111], a[108:111], a[64:67], v[108:111]
  v_add_u32 v18, s66, v18
  v_add_u32 v19, s66, v19
  v_mfma_f32_16x16x32_bf16 v[124:127], a[108:111], a[68:71], v[124:127]
  v_add_u32 v20, s66, v20
  v_add_u32 v21, s66, v21
  v_mfma_f32_16x16x32_bf16 v[140:143], a[108:111], a[72:75], v[140:143]
  v_mfma_f32_16x16x32_bf16 v[156:159], a[108:111], a[76:79], v[156:159]
  s_waitcnt vmcnt(20) lgkmcnt(0)
  s_barrier
  v_mfma_f32_16x16x32_bf16 v[96:99], a[112:115], a[80:83], v[96:99]
  s_add_u32 m0, s64, 16384
  ds_read_b128 a[64:67], v16 offset:0
  ds_read_b64_tr_b16 a[96:97], v18 offset:16384
  v_mfma_f32_16x16x32_bf16 v[112:115], a[112:115], a[84:87], v[112:115]
  buffer_load_dwordx4 v10, s[12:15], s71 offen offset:0 lds
  ds_read_b64_tr_b16 a[98:99], v18 offset:18432
  v_mfma_f32_16x16x32_bf16 v[128:131], a[112:115], a[88:91], v[128:131]
  ds_read_b128 a[68:71], v16 offset:1024
  ds_read_b128 a[72:75], v17 offset:0
  v_mfma_f32_16x16x32_bf16 v[144:147], a[112:115], a[92:95], v[144:147]
  ds_read_b128 a[76:79], v17 offset:1024
  ds_read_b64_tr_b16 a[100:101], v19 offset:16384
  v_mfma_f32_16x16x32_bf16 v[100:103], a[116:119], a[80:83], v[100:103]
  ds_read_b64_tr_b16 a[102:103], v19 offset:18432
  ds_read_b64_tr_b16 a[104:105], v20 offset:16384
  v_mfma_f32_16x16x32_bf16 v[116:119], a[116:119], a[84:87], v[116:119]
  buffer_load_dwordx4 v11, s[12:15], s71 offen offset:1024 lds
  ds_read_b64_tr_b16 a[106:107], v20 offset:18432
  v_mfma_f32_16x16x32_bf16 v[132:135], a[116:119], a[88:91], v[132:135]
  ds_read_b64_tr_b16 a[108:109], v21 offset:16384
  ds_read_b64_tr_b16 a[110:111], v21 offset:18432
  v_mfma_f32_16x16x32_bf16 v[148:151], a[116:119], a[92:95], v[148:151]
  v_mfma_f32_16x16x32_bf16 v[104:107], a[120:123], a[80:83], v[104:107]
  v_mfma_f32_16x16x32_bf16 v[120:123], a[120:123], a[84:87], v[120:123]
  v_mfma_f32_16x16x32_bf16 v[136:139], a[120:123], a[88:91], v[136:139]
  buffer_load_dwordx4 v12, s[12:15], s71 offen offset:2048 lds
  v_mfma_f32_16x16x32_bf16 v[152:155], a[120:123], a[92:95], v[152:155]
  v_mfma_f32_16x16x32_bf16 v[108:111], a[124:127], a[80:83], v[108:111]
  v_mfma_f32_16x16x32_bf16 v[124:127], a[124:127], a[84:87], v[124:127]
  v_mfma_f32_16x16x32_bf16 v[140:143], a[124:127], a[88:91], v[140:143]
  v_mfma_f32_16x16x32_bf16 v[156:159], a[124:127], a[92:95], v[156:159]
  s_waitcnt lgkmcnt(0)
  v_mfma_f32_16x16x32_bf16 v[96:99], a[96:99], a[64:67], v[96:99]
  buffer_load_dwordx4 v13, s[12:15], s71 offen offset:3072 lds
  ds_read_b128 a[80:83], v16 offset:8192
  v_mfma_f32_16x16x32_bf16 v[112:115], a[96:99], a[68:71], v[112:115]
  s_add_u32 s71, s71, 131072
  s_add_u32 m0, s64, s88
  ds_read_b64_tr_b16 a[112:113], v18 offset:20480
  v_mfma_f32_16x16x32_bf16 v[128:131], a[96:99], a[72:75], v[128:131]
  ds_read_b64_tr_b16 a[114:115], v18 offset:22528
  ds_read_b128 a[84:87], v16 offset:9216
  v_mfma_f32_16x16x32_bf16 v[144:147], a[96:99], a[76:79], v[144:147]
  buffer_load_dwordx4 v2, s[8:11], s70 offen offset:0 sc1 lds
  ds_read_b128 a[88:91], v17 offset:8192
  v_mfma_f32_16x16x32_bf16 v[100:103], a[100:103], a[64:67], v[100:103]
  ds_read_b128 a[92:95], v17 offset:9216
  ds_read_b64_tr_b16 a[116:117], v19 offset:20480
  v_mfma_f32_16x16x32_bf16 v[116:119], a[100:103], a[68:71], v[116:119]
  ds_read_b64_tr_b16 a[118:119], v19 offset:22528
  ds_read_b64_tr_b16 a[120:121], v20 offset:20480
  v_mfma_f32_16x16x32_bf16 v[132:135], a[100:103], a[72:75], v[132:135]
  buffer_load_dwordx4 v2, s[8:11], s70 offen offset:1024 sc1 lds
  ds_read_b64_tr_b16 a[122:123], v20 offset:22528
  v_mfma_f32_16x16x32_bf16 v[148:151], a[100:103], a[76:79], v[148:151]
  s_add_u32 s70, s70, 16384
  ds_read_b64_tr_b16 a[124:125], v21 offset:20480
  ds_read_b64_tr_b16 a[126:127], v21 offset:22528
  v_mfma_f32_16x16x32_bf16 v[104:107], a[104:107], a[64:67], v[104:107]
  s_add_u32 s64, s64, s66
  s_add_u32 s65, s65, 1
  s_cmp_eq_u32 s65, 4
  s_cselect_b32 s65, 0, s65
  s_cselect_b32 s66, s67, s68
  v_mfma_f32_16x16x32_bf16 v[120:123], a[104:107], a[68:71], v[120:123]
  v_add_u32 v16, s66, v16
  v_add_u32 v17, s66, v17
  v_mfma_f32_16x16x32_bf16 v[136:139], a[104:107], a[72:75], v[136:139]
  v_add_u32 v18, s66, v18
  v_add_u32 v19, s66, v19
  v_mfma_f32_16x16x32_bf16 v[152:155], a[104:107], a[76:79], v[152:155]
  v_add_u32 v20, s66, v20
  v_add_u32 v21, s66, v21
  v_mfma_f32_16x16x32_bf16 v[108:111], a[108:111], a[64:67], v[108:111]
  v_mfma_f32_16x16x32_bf16 v[124:127], a[108:111], a[68:71], v[124:127]
  v_mfma_f32_16x16x32_bf16 v[140:143], a[108:111], a[72:75], v[140:143]
  v_mfma_f32_16x16x32_bf16 v[156:159], a[108:111], a[76:79], v[156:159]
  s_waitcnt vmcnt(12) lgkmcnt(0)
  s_barrier
  s_lshl_b32 s4, s73, 19
  s_lshl_b32 s72, s76, 8
  s_add_u32 s4, s4, s72
  s_and_b32 s72, s3, 1
  s_lshl_b32 s72, s72, 7
  s_add_u32 s4, s4, s72
  s_lshr_b32 s72, s3, 1
  s_lshl_b32 s72, s72, 1
  s_add_u32 s72, s72, s77
  s_lshl_b32 s72, s72, 17
  s_add_u32 s4, s4, s72
  s_add_u32 s4, s4, 2048
  s_add_u32 s5, s4, 65536
  s_lshl_b32 s89, s78, 1
  s_add_u32 s89, s89, s77
  s_lshl_b32 s89, s89, 7
  s_add_u32 s89, s89, 131072
  s_lshl_b32 s90, s78, 1
  s_add_u32 s90, s90, s77
  s_xor_b32 s90, s90, 1
  s_lshl_b32 s90, s90, 7
  s_add_u32 s90, s90, 131072
  v_mfma_f32_16x16x32_bf16 v[96:99], a[112:115], a[80:83], v[96:99]
  s_add_u32 m0, s64, 16384
  ds_read_b128 a[64:67], v16 offset:0
  ds_read_b64_tr_b16 a[96:97], v18 offset:16384
  v_mfma_f32_16x16x32_bf16 v[112:115], a[112:115], a[84:87], v[112:115]
  buffer_load_dwordx4 v10, s[12:15], s71 offen offset:0 lds
  ds_read_b64_tr_b16 a[98:99], v18 offset:18432
  v_mfma_f32_16x16x32_bf16 v[128:131], a[112:115], a[88:91], v[128:131]
  buffer_load_dwordx4 v11, s[12:15], s71 offen offset:1024 lds
  ds_read_b128 a[68:71], v16 offset:1024
  v_mfma_f32_16x16x32_bf16 v[144:147], a[112:115], a[92:95], v[144:147]
  ds_read_b64_tr_b16 a[100:101], v19 offset:16384
  ds_read_b64_tr_b16 a[102:103], v19 offset:18432
  v_mfma_f32_16x16x32_bf16 v[100:103], a[116:119], a[80:83], v[100:103]
  ds_read_b64_tr_b16 a[104:105], v20 offset:16384
  ds_read_b64_tr_b16 a[106:107], v20 offset:18432
  v_mfma_f32_16x16x32_bf16 v[116:119], a[116:119], a[84:87], v[116:119]
  buffer_load_dwordx4 v12, s[12:15], s71 offen offset:2048 lds
  ds_read_b64_tr_b16 a[108:109], v21 offset:16384
  v_mfma_f32_16x16x32_bf16 v[132:135], a[116:119], a[88:91], v[132:135]
  ds_read_b64_tr_b16 a[110:111], v21 offset:18432
  v_mfma_f32_16x16x32_bf16 v[148:151], a[116:119], a[92:95], v[148:151]
  buffer_load_dwordx4 v13, s[12:15], s71 offen offset:3072 lds
  v_mfma_f32_16x16x32_bf16 v[104:107], a[120:123], a[80:83], v[104:107]
  s_add_u32 s71, s71, 131072
  s_add_u32 m0, s64, s88
  v_mfma_f32_16x16x32_bf16 v[120:123], a[120:123], a[84:87], v[120:123]
  v_mfma_f32_16x16x32_bf16 v[136:139], a[120:123], a[88:91], v[136:139]
  buffer_load_dwordx4 v2, s[8:11], s70 offen offset:0 sc1 lds
  v_mfma_f32_16x16x32_bf16 v[152:155], a[120:123], a[92:95], v[152:155]
  v_mfma_f32_16x16x32_bf16 v[108:111], a[124:127], a[80:83], v[108:111]
  buffer_load_dwordx4 v2, s[8:11], s70 offen offset:1024 sc1 lds
  v_mfma_f32_16x16x32_bf16 v[124:127], a[124:127], a[84:87], v[124:127]
  s_add_u32 s70, s70, 16384
  s_lshl_b32 s6, s78, 1
  s_add_u32 s6, s6, s77
  v_mfma_f32_16x16x32_bf16 v[140:143], a[124:127], a[88:91], v[140:143]
  s_xor_b32 s6, s6, 1
  s_lshl_b32 s6, s6, 2
  s_add_u32 s6, s6, s3
  v_mfma_f32_16x16x32_bf16 v[156:159], a[124:127], a[92:95], v[156:159]
  s_lshl_b32 s6, s6, 13
  s_add_u32 s7, s6, 4096
  s_waitcnt lgkmcnt(0)
  v_mfma_f32_16x16x32_bf16 v[96:99], a[96:99], a[64:67], v[96:99]
  buffer_store_dwordx4 v[128:131], v2, s[16:19], s6 offen offset:0 sc1
  ds_read_b128 a[80:83], v16 offset:8192
  v_mfma_f32_16x16x32_bf16 v[112:115], a[96:99], a[68:71], v[112:115]
  buffer_store_dwordx4 v[132:135], v2, s[16:19], s6 offen offset:1024 sc1
  ds_read_b64_tr_b16 a[112:113], v18 offset:20480
  v_mfma_f32_16x16x32_bf16 v[100:103], a[100:103], a[64:67], v[100:103]
  ds_read_b64_tr_b16 a[114:115], v18 offset:22528
  ds_read_b128 a[84:87], v16 offset:9216
  v_mfma_f32_16x16x32_bf16 v[116:119], a[100:103], a[68:71], v[116:119]
  buffer_store_dwordx4 v[136:139], v2, s[16:19], s6 offen offset:2048 sc1
  ds_read_b64_tr_b16 a[116:117], v19 offset:20480
  v_mfma_f32_16x16x32_bf16 v[104:107], a[104:107], a[64:67], v[104:107]
  ds_read_b64_tr_b16 a[118:119], v19 offset:22528
  ds_read_b64_tr_b16 a[120:121], v20 offset:20480
  v_mfma_f32_16x16x32_bf16 v[120:123], a[104:107], a[68:71], v[120:123]
  buffer_store_dwordx4 v[140:143], v2, s[16:19], s6 offen offset:3072 sc1
  ds_read_b64_tr_b16 a[122:123], v20 offset:22528
  v_mfma_f32_16x16x32_bf16 v[108:111], a[108:111], a[64:67], v[108:111]
  s_add_u32 s64, s64, s66
  ds_read_b64_tr_b16 a[124:125], v21 offset:20480
  ds_read_b64_tr_b16 a[126:127], v21 offset:22528
  v_mfma_f32_16x16x32_bf16 v[124:127], a[108:111], a[68:71], v[124:127]
  s_add_u32 s65, s65, 1
  s_cmp_eq_u32 s65, 4
  s_cselect_b32 s65, 0, s65
  s_cselect_b32 s66, s67, s68
  v_add_u32 v16, s66, v16
  v_add_u32 v17, s66, v17
  v_add_u32 v18, s66, v18
  v_add_u32 v19, s66, v19
  v_add_u32 v20, s66, v20
  v_add_u32 v21, s66, v21
  s_waitcnt vmcnt(16) lgkmcnt(0)
  s_barrier
  v_mfma_f32_16x16x32_bf16 v[96:99], a[112:115], a[80:83], v[96:99]
  buffer_store_dwordx4 v[144:147], v2, s[16:19], s7 offen offset:0 sc1
  ds_read_b128 a[64:67], v16 offset:0
  v_mfma_f32_16x16x32_bf16 v[112:115], a[112:115], a[84:87], v[112:115]
  buffer_store_dwordx4 v[148:151], v2, s[16:19], s7 offen offset:1024 sc1
  ds_read_b64_tr_b16 a[96:97], v18 offset:16384
  v_mfma_f32_16x16x32_bf16 v[100:103], a[116:119], a[80:83], v[100:103]
  ds_read_b64_tr_b16 a[98:99], v18 offset:18432
  ds_read_b128 a[68:71], v16 offset:1024
  v_mfma_f32_16x16x32_bf16 v[116:119], a[116:119], a[84:87], v[116:119]
  buffer_store_dwordx4 v[152:155], v2, s[16:19], s7 offen offset:2048 sc1
  ds_read_b64_tr_b16 a[100:101], v19 offset:16384
  v_mfma_f32_16x16x32_bf16 v[104:107], a[120:123], a[80:83], v[104:107]
  ds_read_b64_tr_b16 a[102:103], v19 offset:18432
  ds_read_b64_tr_b16 a[104:105], v20 offset:16384
  v_mfma_f32_16x16x32_bf16 v[120:123], a[120:123], a[84:87], v[120:123]
  buffer_store_dwordx4 v[156:159], v2, s[16:19], s7 offen offset:3072 sc1
  ds_read_b64_tr_b16 a[106:107], v20 offset:18432
  v_mfma_f32_16x16x32_bf16 v[108:111], a[124:127], a[80:83], v[108:111]
  ds_read_b64_tr_b16 a[108:109], v21 offset:16384
  ds_read_b64_tr_b16 a[110:111], v21 offset:18432
  v_mfma_f32_16x16x32_bf16 v[124:127], a[124:127], a[84:87], v[124:127]
  v_pk_add_f32 v[160:161], v[160:161], v[32:33]
  v_pk_add_f32 v[162:163], v[162:163], v[34:35]
  v_pk_add_f32 v[164:165], v[164:165], v[36:37]
  v_pk_add_f32 v[166:167], v[166:167], v[38:39]
  v_cvt_pk_bf16_f32 v160, v160, v161
  v_cvt_pk_bf16_f32 v161, v162, v163
  v_cvt_pk_bf16_f32 v162, v164, v165
  v_cvt_pk_bf16_f32 v163, v166, v167
  s_nop 0
  v_permlane16_swap_b32 v160, v162
  v_permlane16_swap_b32 v161, v163
  s_waitcnt lgkmcnt(0)
  v_mfma_f32_16x16x32_bf16 v[96:99], a[96:99], a[64:67], v[96:99]
  s_sub_u32 s70, s70, 65536
  s_xor_b32 s70, s70, 524288
  s_sub_u32 s71, s71, 524288
  v_mfma_f32_16x16x32_bf16 v[112:115], a[96:99], a[68:71], v[112:115]
  s_xor_b32 s71, s71, 4194304
  s_add_u32 m0, s64, 16384
  ds_read_b128 a[80:83], v16 offset:8192
  v_mfma_f32_16x16x32_bf16 v[100:103], a[100:103], a[64:67], v[100:103]
  buffer_load_dwordx4 v10, s[12:15], s71 offen offset:0 lds
  ds_read_b64_tr_b16 a[112:113], v18 offset:20480
  v_mfma_f32_16x16x32_bf16 v[116:119], a[100:103], a[68:71], v[116:119]
  buffer_load_dwordx4 v11, s[12:15], s71 offen offset:1024 lds
  ds_read_b64_tr_b16 a[114:115], v18 offset:22528
  v_mfma_f32_16x16x32_bf16 v[104:107], a[104:107], a[64:67], v[104:107]
  buffer_load_dwordx4 v12, s[12:15], s71 offen offset:2048 lds
  ds_read_b128 a[84:87], v16 offset:9216
  v_mfma_f32_16x16x32_bf16 v[120:123], a[104:107], a[68:71], v[120:123]
  buffer_load_dwordx4 v13, s[12:15], s71 offen offset:3072 lds
  ds_read_b64_tr_b16 a[116:117], v19 offset:20480
  v_mfma_f32_16x16x32_bf16 v[108:111], a[108:111], a[64:67], v[108:111]
  s_add_u32 s71, s71, 131072
  s_add_u32 m0, s64, s88
  ds_read_b64_tr_b16 a[118:119], v19 offset:22528
  ds_read_b64_tr_b16 a[120:121], v20 offset:20480
  v_mfma_f32_16x16x32_bf16 v[124:127], a[108:111], a[68:71], v[124:127]
  buffer_load_dwordx4 v2, s[8:11], s70 offen offset:0 sc1 lds
  buffer_load_dwordx4 v2, s[8:11], s70 offen offset:1024 sc1 lds
  ds_read_b64_tr_b16 a[122:123], v20 offset:22528
  ds_read_b64_tr_b16 a[124:125], v21 offset:20480
  ds_read_b64_tr_b16 a[126:127], v21 offset:22528
  s_add_u32 s70, s70, 16384
  s_add_u32 s64, s64, s66
  s_add_u32 s65, s65, 1
  s_cmp_eq_u32 s65, 4
  s_cselect_b32 s65, 0, s65
  s_cselect_b32 s66, s67, s68
  v_add_u32 v16, s66, v16
  v_add_u32 v17, s66, v17
  v_add_u32 v18, s66, v18
  v_add_u32 v19, s66, v19
  v_add_u32 v20, s66, v20
  v_add_u32 v21, s66, v21
  buffer_store_dwordx4 v[160:163], v27, s[20:23], s4 offen offset:0
  s_waitcnt vmcnt(21) lgkmcnt(0)
  s_barrier
  v_mfma_f32_16x16x32_bf16 v[96:99], a[112:115], a[80:83], v[96:99]
  s_add_u32 m0, s64, 16384
  ds_read_b128 a[64:67], v16 offset:0
  ds_read_b64_tr_b16 a[96:97], v18 offset:16384
  v_mfma_f32_16x16x32_bf16 v[112:115], a[112:115], a[84:87], v[112:115]
  buffer_load_dwordx4 v10, s[12:15], s71 offen offset:0 lds
  ds_read_b64_tr_b16 a[98:99], v18 offset:18432
  v_mfma_f32_16x16x32_bf16 v[100:103], a[116:119], a[80:83], v[100:103]
  buffer_load_dwordx4 v11, s[12:15], s71 offen offset:1024 lds
  ds_read_b128 a[68:71], v16 offset:1024
  v_mfma_f32_16x16x32_bf16 v[116:119], a[116:119], a[84:87], v[116:119]
  ds_read_b64_tr_b16 a[100:101], v19 offset:16384
  ds_read_b64_tr_b16 a[102:103], v19 offset:18432
  v_mfma_f32_16x16x32_bf16 v[104:107], a[120:123], a[80:83], v[104:107]
  buffer_load_dwordx4 v12, s[12:15], s71 offen offset:2048 lds
  ds_read_b64_tr_b16 a[104:105], v20 offset:16384
  v_mfma_f32_16x16x32_bf16 v[120:123], a[120:123], a[84:87], v[120:123]
  ds_read_b64_tr_b16 a[106:107], v20 offset:18432
  ds_read_b64_tr_b16 a[108:109], v21 offset:16384
  v_mfma_f32_16x16x32_bf16 v[108:111], a[124:127], a[80:83], v[108:111]
  ds_read_b64_tr_b16 a[110:111], v21 offset:18432
  v_pk_add_f32 v[168:169], v[168:169], v[40:41]
  v_mfma_f32_16x16x32_bf16 v[124:127], a[124:127], a[84:87], v[124:127]
  v_pk_add_f32 v[170:171], v[170:171], v[42:43]
  v_pk_add_f32 v[172:173], v[172:173], v[44:45]
  v_pk_add_f32 v[174:175], v[174:175], v[46:47]
  v_cvt_pk_bf16_f32 v168, v168, v169
  v_cvt_pk_bf16_f32 v169, v170, v171
  v_cvt_pk_bf16_f32 v170, v172, v173
  v_cvt_pk_bf16_f32 v171, v174, v175
  s_nop 0
  v_permlane16_swap_b32 v168, v170
  v_permlane16_swap_b32 v169, v171
  s_waitcnt lgkmcnt(0)
  v_mfma_f32_16x16x32_bf16 v[96:99], a[96:99], a[64:67], v[96:99]
  buffer_load_dwordx4 v13, s[12:15], s71 offen offset:3072 lds
  ds_read_b128 a[80:83], v16 offset:8192
  v_mfma_f32_16x16x32_bf16 v[112:115], a[96:99], a[68:71], v[112:115]
  s_add_u32 s71, s71, 131072
  s_add_u32 m0, s64, s88
  ds_read_b64_tr_b16 a[112:113], v18 offset:20480
  v_mfma_f32_16x16x32_bf16 v[100:103], a[100:103], a[64:67], v[100:103]
  buffer_load_dwordx4 v2, s[8:11], s70 offen offset:0 sc1 lds
  ds_read_b64_tr_b16 a[114:115], v18 offset:22528
  v_mfma_f32_16x16x32_bf16 v[116:119], a[100:103], a[68:71], v[116:119]
  ds_read_b128 a[84:87], v16 offset:9216
  ds_read_b64_tr_b16 a[116:117], v19 offset:20480
  v_mfma_f32_16x16x32_bf16 v[104:107], a[104:107], a[64:67], v[104:107]
  buffer_load_dwordx4 v2, s[8:11], s70 offen offset:1024 sc1 lds
  ds_read_b64_tr_b16 a[118:119], v19 offset:22528
  v_mfma_f32_16x16x32_bf16 v[120:123], a[104:107], a[68:71], v[120:123]
  s_add_u32 s70, s70, 16384
  ds_read_b64_tr_b16 a[120:121], v20 offset:20480
  ds_read_b64_tr_b16 a[122:123], v20 offset:22528
  v_mfma_f32_16x16x32_bf16 v[108:111], a[108:111], a[64:67], v[108:111]
  s_add_u32 s64, s64, s66
  ds_read_b64_tr_b16 a[124:125], v21 offset:20480
  ds_read_b64_tr_b16 a[126:127], v21 offset:22528
  v_mfma_f32_16x16x32_bf16 v[124:127], a[108:111], a[68:71], v[124:127]
  s_add_u32 s65, s65, 1
  s_cmp_eq_u32 s65, 4
  s_cselect_b32 s65, 0, s65
  s_cselect_b32 s66, s67, s68
  v_add_u32 v16, s66, v16
  v_add_u32 v17, s66, v17
  v_add_u32 v18, s66, v18
  v_add_u32 v19, s66, v19
  v_add_u32 v20, s66, v20
  v_add_u32 v21, s66, v21
  buffer_store_dwordx4 v[168:171], v27, s[20:23], s4 offen offset:64
  s_waitcnt vmcnt(14) lgkmcnt(0)
  s_barrier
  v_mov_b32 v8, 0x40000000
  v_mov_b32 v6, s94
  v_cmp_eq_u32 vcc, 0, v0
  v_mov_b32 v7, s95
  s_nop 0
  v_cndmask_b32_e64 v8, v8, 0, vcc
  buffer_store_dwordx2 v[6:7], v8, s[96:99], s89 offen sc1
  v_mfma_f32_16x16x32_bf16 v[96:99], a[112:115], a[80:83], v[96:99]
  s_add_u32 m0, s64, 16384
  ds_read_b128 a[64:67], v16 offset:0
  ds_read_b64_tr_b16 a[96:97], v18 offset:16384
  v_mfma_f32_16x16x32_bf16 v[112:115], a[112:115], a[84:87], v[112:115]
  buffer_load_dwordx4 v10, s[12:15], s71 offen offset:0 lds
  ds_read_b64_tr_b16 a[98:99], v18 offset:18432
  v_mfma_f32_16x16x32_bf16 v[100:103], a[116:119], a[80:83], v[100:103]
  buffer_load_dwordx4 v11, s[12:15], s71 offen offset:1024 lds
  ds_read_b128 a[68:71], v16 offset:1024
  v_mfma_f32_16x16x32_bf16 v[116:119], a[116:119], a[84:87], v[116:119]
  ds_read_b64_tr_b16 a[100:101], v19 offset:16384
  ds_read_b64_tr_b16 a[102:103], v19 offset:18432
  v_mfma_f32_16x16x32_bf16 v[104:107], a[120:123], a[80:83], v[104:107]
  buffer_load_dwordx4 v12, s[12:15], s71 offen offset:2048 lds
  ds_read_b64_tr_b16 a[104:105], v20 offset:16384
  v_mfma_f32_16x16x32_bf16 v[120:123], a[120:123], a[84:87], v[120:123]
  ds_read_b64_tr_b16 a[106:107], v20 offset:18432
  ds_read_b64_tr_b16 a[108:109], v21 offset:16384
  v_mfma_f32_16x16x32_bf16 v[108:111], a[124:127], a[80:83], v[108:111]
  ds_read_b64_tr_b16 a[110:111], v21 offset:18432
  v_pk_add_f32 v[176:177], v[176:177], v[48:49]
  v_mfma_f32_16x16x32_bf16 v[124:127], a[124:127], a[84:87], v[124:127]
  v_pk_add_f32 v[178:179], v[178:179], v[50:51]
  v_pk_add_f32 v[180:181], v[180:181], v[52:53]
  v_pk_add_f32 v[182:183], v[182:183], v[54:55]
  v_cvt_pk_bf16_f32 v176, v176, v177
  v_cvt_pk_bf16_f32 v177, v178, v179
  v_cvt_pk_bf16_f32 v178, v180, v181
  v_cvt_pk_bf16_f32 v179, v182, v183
  s_nop 0
  v_permlane16_swap_b32 v176, v178
  v_permlane16_swap_b32 v177, v179
  s_waitcnt lgkmcnt(0)
  v_mfma_f32_16x16x32_bf16 v[96:99], a[96:99], a[64:67], v[96:99]
  buffer_load_dwordx4 v13, s[12:15], s71 offen offset:3072 lds
  ds_read_b128 a[80:83], v16 offset:8192
  v_mfma_f32_16x16x32_bf16 v[112:115], a[96:99], a[68:71], v[112:115]
  s_add_u32 s71, s71, 131072
  s_add_u32 m0, s64, s88
  ds_read_b64_tr_b16 a[112:113], v18 offset:20480
  v_mfma_f32_16x16x32_bf16 v[100:103], a[100:103], a[64:67], v[100:103]
  buffer_load_dwordx4 v2, s[8:11], s70 offen offset:0 sc1 lds
  ds_read_b64_tr_b16 a[114:115], v18 offset:22528
  v_mfma_f32_16x16x32_bf16 v[116:119], a[100:103], a[68:71], v[116:119]
  ds_read_b128 a[84:87], v16 offset:9216
  ds_read_b64_tr_b16 a[116:117], v19 offset:20480
  v_mfma_f32_16x16x32_bf16 v[104:107], a[104:107], a[64:67], v[104:107]
  buffer_load_dwordx4 v2, s[8:11], s70 offen offset:1024 sc1 lds
  ds_read_b64_tr_b16 a[118:119], v19 offset:22528
  v_mfma_f32_16x16x32_bf16 v[120:123], a[104:107], a[68:71], v[120:123]
  s_add_u32 s70, s70, 16384
  ds_read_b64_tr_b16 a[120:121], v20 offset:20480
  ds_read_b64_tr_b16 a[122:123], v20 offset:22528
  v_mfma_f32_16x16x32_bf16 v[108:111], a[108:111], a[64:67], v[108:111]
  s_add_u32 s64, s64, s66
  ds_read_b64_tr_b16 a[124:125], v21 offset:20480
  ds_read_b64_tr_b16 a[126:127], v21 offset:22528
  v_mfma_f32_16x16x32_bf16 v[124:127], a[108:111], a[68:71], v[124:127]
  s_add_u32 s65, s65, 1
  s_cmp_eq_u32 s65, 4
  s_cselect_b32 s65, 0, s65
  s_cselect_b32 s66, s67, s68
  v_add_u32 v16, s66, v16
  v_add_u32 v17, s66, v17
  v_add_u32 v18, s66, v18
  v_add_u32 v19, s66, v19
  v_add_u32 v20, s66, v20
  v_add_u32 v21, s66, v21
  buffer_store_dwordx4 v[176:179], v27, s[20:23], s5 offen offset:0
  s_waitcnt vmcnt(16) lgkmcnt(0)
  s_barrier
  v_mfma_f32_16x16x32_bf16 v[96:99], a[112:115], a[80:83], v[96:99]
  s_add_u32 m0, s64, 16384
  ds_read_b128 a[64:67], v16 offset:0
  ds_read_b64_tr_b16 a[96:97], v18 offset:16384
  v_mfma_f32_16x16x32_bf16 v[112:115], a[112:115], a[84:87], v[112:115]
  buffer_load_dwordx4 v10, s[12:15], s71 offen offset:0 lds
  ds_read_b64_tr_b16 a[98:99], v18 offset:18432
  v_mfma_f32_16x16x32_bf16 v[100:103], a[116:119], a[80:83], v[100:103]
  buffer_load_dwordx4 v11, s[12:15], s71 offen offset:1024 lds
  ds_read_b128 a[68:71], v16 offset:1024
  v_mfma_f32_16x16x32_bf16 v[116:119], a[116:119], a[84:87], v[116:119]
  ds_read_b64_tr_b16 a[100:101], v19 offset:16384
  ds_read_b64_tr_b16 a[102:103], v19 offset:18432
  v_mfma_f32_16x16x32_bf16 v[104:107], a[120:123], a[80:83], v[104:107]
  buffer_load_dwordx4 v12, s[12:15], s71 offen offset:2048 lds
  ds_read_b64_tr_b16 a[104:105], v20 offset:16384
  v_mfma_f32_16x16x32_bf16 v[120:123], a[120:123], a[84:87], v[120:123]
  ds_read_b64_tr_b16 a[106:107], v20 offset:18432
  ds_read_b64_tr_b16 a[108:109], v21 offset:16384
  v_mfma_f32_16x16x32_bf16 v[108:111], a[124:127], a[80:83], v[108:111]
  ds_read_b64_tr_b16 a[110:111], v21 offset:18432
  v_pk_add_f32 v[184:185], v[184:185], v[56:57]
  v_mfma_f32_16x16x32_bf16 v[124:127], a[124:127], a[84:87], v[124:127]
  v_pk_add_f32 v[186:187], v[186:187], v[58:59]
  v_pk_add_f32 v[188:189], v[188:189], v[60:61]
  v_pk_add_f32 v[190:191], v[190:191], v[62:63]
  v_cvt_pk_bf16_f32 v184, v184, v185
  v_cvt_pk_bf16_f32 v185, v186, v187
  v_cvt_pk_bf16_f32 v186, v188, v189
  v_cvt_pk_bf16_f32 v187, v190, v191
  s_nop 0
  v_permlane16_swap_b32 v184, v186
  v_permlane16_swap_b32 v185, v187
  s_waitcnt lgkmcnt(0)
  v_mfma_f32_16x16x32_bf16 v[96:99], a[96:99], a[64:67], v[96:99]
  buffer_load_dwordx4 v13, s[12:15], s71 offen offset:3072 lds
  ds_read_b128 a[80:83], v16 offset:8192
  v_mfma_f32_16x16x32_bf16 v[112:115], a[96:99], a[68:71], v[112:115]
  s_add_u32 s71, s71, 131072
  s_add_u32 m0, s64, s88
  ds_read_b64_tr_b16 a[112:113], v18 offset:20480
  v_mfma_f32_16x16x32_bf16 v[100:103], a[100:103], a[64:67], v[100:103]
  buffer_load_dwordx4 v2, s[8:11], s70 offen offset:0 sc1 lds
  ds_read_b64_tr_b16 a[114:115], v18 offset:22528
  v_mfma_f32_16x16x32_bf16 v[116:119], a[100:103], a[68:71], v[116:119]
  ds_read_b128 a[84:87], v16 offset:9216
  ds_read_b64_tr_b16 a[116:117], v19 offset:20480
  v_mfma_f32_16x16x32_bf16 v[104:107], a[104:107], a[64:67], v[104:107]
  buffer_load_dwordx4 v2, s[8:11], s70 offen offset:1024 sc1 lds
  ds_read_b64_tr_b16 a[118:119], v19 offset:22528
  v_mfma_f32_16x16x32_bf16 v[120:123], a[104:107], a[68:71], v[120:123]
  s_add_u32 s70, s70, 16384
  ds_read_b64_tr_b16 a[120:121], v20 offset:20480
  ds_read_b64_tr_b16 a[122:123], v20 offset:22528
  v_mfma_f32_16x16x32_bf16 v[108:111], a[108:111], a[64:67], v[108:111]
  s_add_u32 s64, s64, s66
  ds_read_b64_tr_b16 a[124:125], v21 offset:20480
  ds_read_b64_tr_b16 a[126:127], v21 offset:22528
  v_mfma_f32_16x16x32_bf16 v[124:127], a[108:111], a[68:71], v[124:127]
  s_add_u32 s65, s65, 1
  s_cmp_eq_u32 s65, 4
  s_cselect_b32 s65, 0, s65
  s_cselect_b32 s66, s67, s68
  v_add_u32 v16, s66, v16
  v_add_u32 v17, s66, v17
  v_add_u32 v18, s66, v18
  v_add_u32 v19, s66, v19
  v_add_u32 v20, s66, v20
  v_add_u32 v21, s66, v21
  buffer_store_dwordx4 v[184:187], v27, s[20:23], s5 offen offset:64
  s_waitcnt vmcnt(16) lgkmcnt(0)
  s_barrier
  v_mfma_f32_16x16x32_bf16 v[96:99], a[112:115], a[80:83], v[96:99]
  buffer_load_dwordx2 v[6:7], off, s[96:99], s90 sc1
  ds_read_b128 a[64:67], v16 offset:0
  v_mfma_f32_16x16x32_bf16 v[112:115], a[112:115], a[84:87], v[112:115]
  ds_read_b64_tr_b16 a[96:97], v18 offset:16384
  ds_read_b64_tr_b16 a[98:99], v18 offset:18432
  v_mfma_f32_16x16x32_bf16 v[100:103], a[116:119], a[80:83], v[100:103]
  ds_read_b128 a[68:71], v16 offset:1024
  ds_read_b64_tr_b16 a[100:101], v19 offset:16384
  v_mfma_f32_16x16x32_bf16 v[116:119], a[116:119], a[84:87], v[116:119]
  ds_read_b64_tr_b16 a[102:103], v19 offset:18432
  ds_read_b64_tr_b16 a[104:105], v20 offset:16384
  v_mfma_f32_16x16x32_bf16 v[104:107], a[120:123], a[80:83], v[104:107]
  ds_read_b64_tr_b16 a[106:107], v20 offset:18432
  ds_read_b64_tr_b16 a[108:109], v21 offset:16384
  v_mfma_f32_16x16x32_bf16 v[120:123], a[120:123], a[84:87], v[120:123]
  ds_read_b64_tr_b16 a[110:111], v21 offset:18432
  v_mfma_f32_16x16x32_bf16 v[108:111], a[124:127], a[80:83], v[108:111]
  v_mfma_f32_16x16x32_bf16 v[124:127], a[124:127], a[84:87], v[124:127]
  s_waitcnt lgkmcnt(0)
  v_mfma_f32_16x16x32_bf16 v[96:99], a[96:99], a[64:67], v[96:99]
  s_add_u32 s64, s64, s66
  ds_read_b128 a[80:83], v16 offset:8192
  ds_read_b64_tr_b16 a[112:113], v18 offset:20480
  v_mfma_f32_16x16x32_bf16 v[112:115], a[96:99], a[68:71], v[112:115]
  s_add_u32 s65, s65, 1
  ds_read_b64_tr_b16 a[114:115], v18 offset:22528
  ds_read_b128 a[84:87], v16 offset:9216
  v_mfma_f32_16x16x32_bf16 v[100:103], a[100:103], a[64:67], v[100:103]
  s_cmp_eq_u32 s65, 4
  s_cselect_b32 s65, 0, s65
  s_cselect_b32 s66, s67, s68
  ds_read_b64_tr_b16 a[116:117], v19 offset:20480
  v_mfma_f32_16x16x32_bf16 v[116:119], a[100:103], a[68:71], v[116:119]
  ds_read_b64_tr_b16 a[118:119], v19 offset:22528
  ds_read_b64_tr_b16 a[120:121], v20 offset:20480
  v_mfma_f32_16x16x32_bf16 v[104:107], a[104:107], a[64:67], v[104:107]
  ds_read_b64_tr_b16 a[122:123], v20 offset:22528
  ds_read_b64_tr_b16 a[124:125], v21 offset:20480
  v_mfma_f32_16x16x32_bf16 v[120:123], a[104:107], a[68:71], v[120:123]
  ds_read_b64_tr_b16 a[126:127], v21 offset:22528
  v_mfma_f32_16x16x32_bf16 v[108:111], a[108:111], a[64:67], v[108:111]
  v_add_u32 v16, s66, v16
  v_add_u32 v17, s66, v17
  v_add_u32 v20, s66, v20
  v_mfma_f32_16x16x32_bf16 v[124:127], a[108:111], a[68:71], v[124:127]
  v_add_u32 v18, s66, v18
  v_add_u32 v19, s66, v19
  v_add_u32 v21, s66, v21
  s_waitcnt vmcnt(0) lgkmcnt(0)
  s_barrier
  s_mov_b32 s5, 0x40000
Lpoll_19:
  v_cmp_ne_u64 vcc, s[94:95], v[6:7]
  s_nop 0
  s_cbranch_vccz Lpolld_20
  s_sleep 4
  buffer_load_dwordx2 v[6:7], off, s[96:99], s90 sc1
  s_sub_u32 s5, s5, 1
  s_waitcnt vmcnt(0)
  s_cbranch_scc0 Lpoll_19
Lpolld_20:
  v_mfma_f32_16x16x32_bf16 v[96:99], a[112:115], a[80:83], v[96:99]
  s_lshl_b32 s6, s78, 1
  s_add_u32 s6, s6, s77
  s_lshl_b32 s6, s6, 2
  v_mfma_f32_16x16x32_bf16 v[112:115], a[112:115], a[84:87], v[112:115]
  s_add_u32 s6, s6, s3
  s_lshl_b32 s6, s6, 13
  s_add_u32 s7, s6, 4096
  v_mfma_f32_16x16x32_bf16 v[100:103], a[116:119], a[80:83], v[100:103]
  buffer_load_dwordx4 v[192:195], v2, s[16:19], s6 offen offset:0 sc1
  ds_read_b128 a[64:67], v16 offset:0
  v_mfma_f32_16x16x32_bf16 v[116:119], a[116:119], a[84:87], v[116:119]
  buffer_load_dwordx4 v[196:199], v2, s[16:19], s6 offen offset:1024 sc1
  ds_read_b64_tr_b16 a[96:97], v18 offset:16384
  v_mfma_f32_16x16x32_bf16 v[104:107], a[120:123], a[80:83], v[104:107]
  buffer_load_dwordx4 v[200:203], v2, s[16:19], s6 offen offset:2048 sc1
  ds_read_b64_tr_b16 a[98:99], v18 offset:18432
  v_mfma_f32_16x16x32_bf16 v[120:123], a[120:123], a[84:87], v[120:123]
  buffer_load_dwordx4 v[204:207], v2, s[16:19], s6 offen offset:3072 sc1
  ds_read_b128 a[68:71], v16 offset:1024
  v_mfma_f32_16x16x32_bf16 v[108:111], a[124:127], a[80:83], v[108:111]
  ds_read_b64_tr_b16 a[100:101], v19 offset:16384
  ds_read_b64_tr_b16 a[102:103], v19 offset:18432
  v_mfma_f32_16x16x32_bf16 v[124:127], a[124:127], a[84:87], v[124:127]
  ds_read_b64_tr_b16 a[104:105], v20 offset:16384
  ds_read_b64_tr_b16 a[106:107], v20 offset:18432
  ds_read_b64_tr_b16 a[108:109], v21 offset:16384
  ds_read_b64_tr_b16 a[110:111], v21 offset:18432
  s_waitcnt lgkmcnt(0)
  v_mfma_f32_16x16x32_bf16 v[96:99], a[96:99], a[64:67], v[96:99]
  buffer_load_dwordx4 v[208:211], v2, s[16:19], s7 offen offset:0 sc1
  ds_read_b128 a[80:83], v16 offset:8192
  v_mfma_f32_16x16x32_bf16 v[112:115], a[96:99], a[68:71], v[112:115]
  buffer_load_dwordx4 v[212:215], v2, s[16:19], s7 offen offset:1024 sc1
  ds_read_b64_tr_b16 a[112:113], v18 offset:20480
  v_mfma_f32_16x16x32_bf16 v[100:103], a[100:103], a[64:67], v[100:103]
  ds_read_b64_tr_b16 a[114:115], v18 offset:22528
  ds_read_b128 a[84:87], v16 offset:9216
  v_mfma_f32_16x16x32_bf16 v[116:119], a[100:103], a[68:71], v[116:119]
  buffer_load_dwordx4 v[216:219], v2, s[16:19], s7 offen offset:2048 sc1
  ds_read_b64_tr_b16 a[116:117], v19 offset:20480
  v_mfma_f32_16x16x32_bf16 v[104:107], a[104:107], a[64:67], v[104:107]
  ds_read_b64_tr_b16 a[118:119], v19 offset:22528
  ds_read_b64_tr_b16 a[120:121], v20 offset:20480
  v_mfma_f32_16x16x32_bf16 v[120:123], a[104:107], a[68:71], v[120:123]
  buffer_load_dwordx4 v[220:223], v2, s[16:19], s7 offen offset:3072 sc1
  ds_read_b64_tr_b16 a[122:123], v20 offset:22528
  v_mfma_f32_16x16x32_bf16 v[108:111], a[108:111], a[64:67], v[108:111]
  s_add_u32 s64, s64, s66
  ds_read_b64_tr_b16 a[124:125], v21 offset:20480
  ds_read_b64_tr_b16 a[126:127], v21 offset:22528
  v_mfma_f32_16x16x32_bf16 v[124:127], a[108:111], a[68:71], v[124:127]
  s_add_u32 s65, s65, 1
  s_cmp_eq_u32 s65, 4
  s_cselect_b32 s65, 0, s65
  s_cselect_b32 s66, s67, s68
  v_add_u32 v16, s66, v16
  v_add_u32 v17, s66, v17
  v_add_u32 v18, s66, v18
  v_add_u32 v19, s66, v19
  v_add_u32 v20, s66, v20
  v_add_u32 v21, s66, v21
  s_waitcnt vmcnt(8) lgkmcnt(0)
  s_barrier
  v_mfma_f32_16x16x32_bf16 v[96:99], a[112:115], a[80:83], v[96:99]
  ds_read_b128 a[64:67], v16 offset:0
  ds_read_b64_tr_b16 a[96:97], v18 offset:16384
  v_mfma_f32_16x16x32_bf16 v[112:115], a[112:115], a[84:87], v[112:115]
  ds_read_b64_tr_b16 a[98:99], v18 offset:18432
  ds_read_b128 a[68:71], v16 offset:1024
  v_mfma_f32_16x16x32_bf16 v[100:103], a[116:119], a[80:83], v[100:103]
  ds_read_b64_tr_b16 a[100:101], v19 offset:16384
  v_mfma_f32_16x16x32_bf16 v[116:119], a[116:119], a[84:87], v[116:119]
  ds_read_b64_tr_b16 a[102:103], v19 offset:18432
  ds_read_b64_tr_b16 a[104:105], v20 offset:16384
  v_mfma_f32_16x16x32_bf16 v[104:107], a[120:123], a[80:83], v[104:107]
  ds_read_b64_tr_b16 a[106:107], v20 offset:18432
  ds_read_b64_tr_b16 a[108:109], v21 offset:16384
  v_mfma_f32_16x16x32_bf16 v[120:123], a[120:123], a[84:87], v[120:123]
  ds_read_b64_tr_b16 a[110:111], v21 offset:18432
  v_mfma_f32_16x16x32_bf16 v[108:111], a[124:127], a[80:83], v[108:111]
  v_mfma_f32_16x16x32_bf16 v[124:127], a[124:127], a[84:87], v[124:127]
  s_waitcnt lgkmcnt(0)
  v_mfma_f32_16x16x32_bf16 v[96:99], a[96:99], a[64:67], v[96:99]
  ds_read_b128 a[80:83], v16 offset:8192
  ds_read_b64_tr_b16 a[112:113], v18 offset:20480
  v_mfma_f32_16x16x32_bf16 v[112:115], a[96:99], a[68:71], v[112:115]
  ds_read_b64_tr_b16 a[114:115], v18 offset:22528
  ds_read_b128 a[84:87], v16 offset:9216
  v_mfma_f32_16x16x32_bf16 v[100:103], a[100:103], a[64:67], v[100:103]
  ds_read_b64_tr_b16 a[116:117], v19 offset:20480
  v_mfma_f32_16x16x32_bf16 v[116:119], a[100:103], a[68:71], v[116:119]
  ds_read_b64_tr_b16 a[118:119], v19 offset:22528
  ds_read_b64_tr_b16 a[120:121], v20 offset:20480
  v_mfma_f32_16x16x32_bf16 v[104:107], a[104:107], a[64:67], v[104:107]
  ds_read_b64_tr_b16 a[122:123], v20 offset:22528
  ds_read_b64_tr_b16 a[124:125], v21 offset:20480
  v_mfma_f32_16x16x32_bf16 v[120:123], a[104:107], a[68:71], v[120:123]
  ds_read_b64_tr_b16 a[126:127], v21 offset:22528
  v_mfma_f32_16x16x32_bf16 v[108:111], a[108:111], a[64:67], v[108:111]
  v_mfma_f32_16x16x32_bf16 v[124:127], a[108:111], a[68:71], v[124:127]
  s_lshl_b32 s4, s73, 19
  s_lshl_b32 s72, s76, 8
  s_add_u32 s4, s4, s72
  s_and_b32 s72, s3, 1
  s_lshl_b32 s72, s72, 7
  s_add_u32 s4, s4, s72
  s_lshr_b32 s72, s3, 1
  s_lshl_b32 s72, s72, 1
  s_add_u32 s72, s72, s77
  s_lshl_b32 s72, s72, 12
  s_add_u32 s4, s4, s72
  s_add_u32 s5, s4, 262144
  s_waitcnt lgkmcnt(0)
  v_mfma_f32_16x16x32_bf16 v[96:99], a[112:115], a[80:83], v[96:99]
  v_mfma_f32_16x16x32_bf16 v[112:115], a[112:115], a[84:87], v[112:115]
  v_mfma_f32_16x16x32_bf16 v[100:103], a[116:119], a[80:83], v[100:103]
  v_mfma_f32_16x16x32_bf16 v[116:119], a[116:119], a[84:87], v[116:119]
  v_mfma_f32_16x16x32_bf16 v[104:107], a[120:123], a[80:83], v[104:107]
  v_mfma_f32_16x16x32_bf16 v[120:123], a[120:123], a[84:87], v[120:123]
  v_mfma_f32_16x16x32_bf16 v[108:111], a[124:127], a[80:83], v[108:111]
  v_mfma_f32_16x16x32_bf16 v[124:127], a[124:127], a[84:87], v[124:127]
  s_waitcnt vmcnt(0)
  v_pk_add_f32 v[192:193], v[192:193], v[96:97]
  s_nop 2
  v_pk_add_f32 v[200:201], v[200:201], v[104:105]
  v_pk_add_f32 v[208:209], v[208:209], v[112:113]
  v_pk_add_f32 v[216:217], v[216:217], v[120:121]
  v_pk_add_f32 v[194:195], v[194:195], v[98:99]
  v_pk_add_f32 v[202:203], v[202:203], v[106:107]
  v_pk_add_f32 v[210:211], v[210:211], v[114:115]
  v_pk_add_f32 v[218:219], v[218:219], v[122:123]
  v_pk_add_f32 v[196:197], v[196:197], v[100:101]
  v_pk_add_f32 v[204:205], v[204:205], v[108:109]
  v_pk_add_f32 v[212:213], v[212:213], v[116:117]
  v_pk_add_f32 v[220:221], v[220:221], v[124:125]
  v_pk_add_f32 v[198:199], v[198:199], v[102:103]
  v_pk_add_f32 v[206:207], v[206:207], v[110:111]
  v_pk_add_f32 v[214:215], v[214:215], v[118:119]
  v_pk_add_f32 v[222:223], v[222:223], v[126:127]
  v_cvt_pk_bf16_f32 v192, v192, v193
  v_cvt_pk_bf16_f32 v200, v200, v201
  v_cvt_pk_bf16_f32 v208, v208, v209
  v_cvt_pk_bf16_f32 v216, v216, v217
  v_cvt_pk_bf16_f32 v193, v194, v195
  v_cvt_pk_bf16_f32 v201, v202, v203
  v_cvt_pk_bf16_f32 v209, v210, v211
  v_cvt_pk_bf16_f32 v217, v218, v219
  v_cvt_pk_bf16_f32 v194, v196, v197
  v_cvt_pk_bf16_f32 v202, v204, v205
  v_cvt_pk_bf16_f32 v210, v212, v213
  v_cvt_pk_bf16_f32 v218, v220, v221
  v_cvt_pk_bf16_f32 v195, v198, v199
  v_cvt_pk_bf16_f32 v203, v206, v207
  v_cvt_pk_bf16_f32 v211, v214, v215
  v_cvt_pk_bf16_f32 v219, v222, v223
  v_permlane16_swap_b32 v192, v194
  v_permlane16_swap_b32 v200, v202
  v_permlane16_swap_b32 v208, v210
  v_permlane16_swap_b32 v216, v218
  v_permlane16_swap_b32 v193, v195
  v_permlane16_swap_b32 v201, v203
  v_permlane16_swap_b32 v209, v211
  v_permlane16_swap_b32 v217, v219
  buffer_store_dwordx4 v[192:195], v26, s[20:23], s4 offen offset:0
  buffer_store_dwordx4 v[200:203], v26, s[20:23], s4 offen offset:64
  buffer_store_dwordx4 v[208:211], v26, s[20:23], s5 offen offset:0
  buffer_store_dwordx4 v[216:219], v26, s[20:23], s5 offen offset:64
Lend:
  s_endpgm
.section .rodata,"a"
.p2align 6
.amdhsa_kernel concat_heads__compressed_kv_cla__sliding_local_dilated__prompt_kernel
  .amdhsa_next_free_vgpr 512
  .amdhsa_next_free_sgpr 102
  .amdhsa_accum_offset 256
  .amdhsa_group_segment_fixed_size 0
  .amdhsa_kernarg_size 96
  .amdhsa_user_sgpr_count 2
  .amdhsa_user_sgpr_kernarg_segment_ptr 1
  .amdhsa_system_sgpr_workgroup_id_x 1
.end_amdhsa_kernel
```

```asm
; @launch grid=(256,1,1) block=(256,1,1) lds=163840
.amdgcn_target "amdgcn-amd-amdhsa--gfx950"
.text
.globl concat_heads__compressed_kv_cla__sliding_local_dilated__prompt_kernel
.p2align 8
.type concat_heads__compressed_kv_cla__sliding_local_dilated__prompt_kernel,@function
concat_heads__compressed_kv_cla__sliding_local_dilated__prompt_kernel:
  s_cmp_ge_u32 s2, 256
  s_cbranch_scc1 Lend
  s_load_dwordx16 s[64:79], s[0:1], 0
  s_load_dwordx8 s[80:87], s[0:1], 64
  v_lshrrev_b32 v2, 6, v0
  v_and_b32 v1, 63, v0
  v_readfirstlane_b32 s3, v2
  v_lshlrev_b32 v2, 4, v1
  s_bfe_u32 s59, s2, 0x30003
  s_lshr_b32 s4, s2, 7
  s_lshl_b32 s4, s4, 3
  s_add_u32 s59, s59, s4
  s_lshr_b32 s4, s2, 3
  s_xor_b32 s4, s4, s2
  s_bitcmp1_b32 s4, 3
  s_cbranch_scc1 Lp2
  s_and_b32 s4, s2, 1
  s_lshl_b32 s4, s4, 2
  s_and_b32 s5, s59, 3
  s_add_u32 s61, s4, s5
  s_bfe_u32 s4, s2, 0x20001
  s_lshl_b32 s4, s4, 2
  s_lshr_b32 s5, s59, 2
  s_add_u32 s62, s4, s5
  s_lshl_b32 s4, s3, 13
  s_add_u32 s36, s4, 65536
  s_add_u32 s41, s4, 98304
  v_lshrrev_b32 v32, 3, v1
  v_and_b32 v33, 6, v32
  v_and_b32 v34, 7, v1
  v_xor_b32 v33, v33, v34
  v_lshlrev_b32 v33, 4, v33
  s_lshl_b32 s4, s61, 2
  s_add_u32 s4, s4, s3
  s_lshl_b32 s4, s4, 6
  v_add_u32 v34, s4, v32
  v_lshl_add_u32 v34, v34, 10, v33
  v_add_u32 v48, 0, v34
  v_add_u32 v49, 7168, v34
  v_add_u32 v50, 14336, v34
  v_add_u32 v51, 21504, v34
  v_add_u32 v52, 32768, v34
  v_add_u32 v53, 39936, v34
  v_add_u32 v54, 47104, v34
  v_add_u32 v55, 54272, v34
  v_lshrrev_b32 v34, 2, v32
  v_and_b32 v35, 3, v32
  v_lshl_add_u32 v34, v34, 3, v35
  s_lshl_b32 s4, s62, 2
  s_add_u32 s4, s4, s3
  s_lshl_b32 s4, s4, 7
  v_lshl_add_u32 v34, v34, 13, v33
  v_add_u32 v34, s4, v34
  v_add_u32 v56, 0, v34
  v_add_u32 v57, 130048, v34
  v_add_u32 v58, 30720, v34
  v_add_u32 v59, 160768, v34
  v_add_u32 v60, 262144, v34
  v_add_u32 v61, 392192, v34
  v_add_u32 v62, 292864, v34
  v_add_u32 v63, 422912, v34
  s_and_b32 s6, s2, 7
  s_add_u32 s4, s61, s62
  s_and_b32 s49, s4, 3
  s_lshl_b32 s49, s49, 3
  s_or_b32 s49, s49, 0x80000
  s_bfe_u32 s48, 0x70702, s49
  s_add_u32 s48, s48, s6
  s_and_b32 s48, s48, 7
  s_lshl_b32 s46, s48, 7
  s_waitcnt lgkmcnt(0)
  s_mov_b32 s8, s66
  s_mov_b32 s9, s67
  s_mov_b32 s10, 2097152
  s_mov_b32 s11, 0x00020000
  s_mov_b32 s12, s70
  s_mov_b32 s13, s71
  s_mov_b32 s14, 4194304
  s_mov_b32 s15, 0x00020000
  s_mov_b32 s50, 9
  s_add_u32 s96, s86, 125829120
  s_addc_u32 s97, s87, 0
  s_mov_b32 s98, 262144
  s_mov_b32 s99, 0x00020000
  s_or_b32 s4, s2, s3
  s_cbranch_scc1 Ltag_1
  s_mov_b32 s4, 196608
  buffer_load_dwordx2 v[22:23], off, s[96:99], s4 sc1
Ltag_1:
  s_mov_b32 m0, s36
  s_nop 0
  buffer_load_dwordx4 v48, s[8:11], s46 offen offset:0 lds
  buffer_load_dwordx4 v49, s[8:11], s46 offen offset:1024 lds
  buffer_load_dwordx4 v50, s[8:11], s46 offen offset:2048 lds
  buffer_load_dwordx4 v51, s[8:11], s46 offen offset:3072 lds
  s_add_u32 m0, s36, 4096
  s_nop 0
  buffer_load_dwordx4 v52, s[8:11], s46 offen offset:0 lds
  buffer_load_dwordx4 v53, s[8:11], s46 offen offset:1024 lds
  buffer_load_dwordx4 v54, s[8:11], s46 offen offset:2048 lds
  buffer_load_dwordx4 v55, s[8:11], s46 offen offset:3072 lds
  s_sub_u32 s50, s50, 1
  s_cmp_eq_u32 s50, 0
  s_cselect_b32 s12, s72, s12
  s_cselect_b32 s13, s73, s13
  s_lshl_b32 s47, s48, 19
  s_bfe_u32 s34, 0x3020106, s49
  s_add_u32 s48, s48, s34
  s_add_u32 s49, s49, 8
  s_and_b32 s49, s49, 0x8001f
  s_and_b32 s48, s48, 7
  s_lshl_b32 s46, s48, 7
  s_mov_b32 m0, s41
  s_nop 0
  buffer_load_dwordx4 v56, s[12:15], s47 offen offset:0 lds
  buffer_load_dwordx4 v57, s[12:15], s47 offen offset:1024 lds
  buffer_load_dwordx4 v58, s[12:15], s47 offen offset:2048 lds
  buffer_load_dwordx4 v59, s[12:15], s47 offen offset:3072 lds
  s_add_u32 m0, s41, 4096
  s_nop 0
  buffer_load_dwordx4 v60, s[12:15], s47 offen offset:0 lds
  buffer_load_dwordx4 v61, s[12:15], s47 offen offset:1024 lds
  buffer_load_dwordx4 v62, s[12:15], s47 offen offset:2048 lds
  buffer_load_dwordx4 v63, s[12:15], s47 offen offset:3072 lds
  s_lshr_b32 s4, s3, 1
  s_lshl_b32 s4, s4, 14
  s_add_u32 s4, s4, 65536
  v_and_b32 v32, 15, v1
  v_lshlrev_b32 v32, 7, v32
  v_lshrrev_b32 v33, 4, v1
  v_and_b32 v34, 6, v1
  v_xor_b32 v33, v33, v34
  v_lshl_add_u32 v32, v33, 4, v32
  v_add_u32 v16, s4, v32
  v_xor_b32 v17, 64, v16
  s_and_b32 s4, s3, 1
  s_lshl_b32 s4, s4, 14
  s_add_u32 s4, s4, 98304
  v_lshrrev_b32 v32, 2, v1
  v_and_b32 v33, 6, v32
  v_lshlrev_b32 v32, 7, v32
  v_and_b32 v34, 1, v1
  v_lshl_add_u32 v32, v34, 3, v32
  v_add_u32 v32, s4, v32
  v_bfe_u32 v34, v1, 1, 1
  v_xor_b32 v33, v33, v34
  v_xor_b32 v34, 0, v33
  v_lshl_add_u32 v18, v34, 4, v32
  v_xor_b32 v34, 2, v33
  v_lshl_add_u32 v19, v34, 4, v32
  v_xor_b32 v34, 4, v33
  v_lshl_add_u32 v20, v34, 4, v32
  s_add_u32 m0, s36, -65536
  s_nop 0
  buffer_load_dwordx4 v48, s[8:11], s46 offen offset:0 lds
  v_xor_b32 v34, 6, v33
  v_lshl_add_u32 v21, v34, 4, v32
  s_and_b32 s24, s2, 7
  s_lshr_b32 s4, s2, 6
  s_lshl_b32 s4, s4, 3
  s_add_u32 s24, s24, s4
  s_lshr_b32 s25, s2, 3
  s_and_b32 s25, s25, 7
  v_lshrrev_b32 v24, 3, v1
  v_and_b32 v25, 6, v24
  v_and_b32 v26, 7, v1
  v_xor_b32 v25, v25, v26
  buffer_load_dwordx4 v49, s[8:11], s46 offen offset:1024 lds
  v_lshlrev_b32 v25, 4, v25
  s_and_b32 s4, s3, 1
  s_lshl_b32 s4, s4, 16
  s_lshr_b32 s5, s3, 1
  s_lshl_b32 s5, s5, 7
  s_add_u32 s4, s4, s5
  v_lshl_add_u32 v24, v24, 11, v25
  v_add_u32 v24, s4, v24
  v_add_u32 v25, 0, v24
  v_accvgpr_write_b32 a212, v25
  v_add_u32 v25, 15360, v24
  buffer_load_dwordx4 v50, s[8:11], s46 offen offset:2048 lds
  v_accvgpr_write_b32 a213, v25
  v_add_u32 v25, 30720, v24
  v_accvgpr_write_b32 a214, v25
  v_add_u32 v25, 46080, v24
  v_accvgpr_write_b32 a215, v25
  buffer_load_dwordx4 v51, s[8:11], s46 offen offset:3072 lds
  v_accvgpr_write_b32 a236, 0
  v_mov_b32 v27, 0x3f803f80
  v_accvgpr_write_b32 a208, v27
  v_accvgpr_write_b32 a237, 0
  v_accvgpr_write_b32 a209, v27
  s_add_u32 m0, s36, -61440
  s_nop 0
  buffer_load_dwordx4 v52, s[8:11], s46 offen offset:0 lds
  v_accvgpr_write_b32 a238, 0
  v_accvgpr_write_b32 a210, v27
  v_accvgpr_write_b32 a239, 0
  v_accvgpr_write_b32 a211, v27
  v_lshrrev_b32 v24, 3, v1
  buffer_load_dwordx4 v53, s[8:11], s46 offen offset:1024 lds
  v_and_b32 v25, 6, v24
  v_and_b32 v26, 7, v1
  v_xor_b32 v25, v25, v26
  v_lshlrev_b32 v25, 4, v25
  v_lshlrev_b32 v26, 2, v24
  buffer_load_dwordx4 v54, s[8:11], s46 offen offset:2048 lds
  v_add_u32 v26, s3, v26
  v_lshl_add_u32 v26, v26, 11, v25
  v_add_u32 v27, 0, v26
  v_accvgpr_write_b32 a222, v27
  v_add_u32 v27, 64512, v26
  buffer_load_dwordx4 v55, s[8:11], s46 offen offset:3072 lds
  v_accvgpr_write_b32 a223, v27
  v_add_u32 v27, 129024, v26
  v_accvgpr_write_b32 a224, v27
  v_add_u32 v27, 193536, v26
  v_accvgpr_write_b32 a225, v27
  s_sub_u32 s50, s50, 1
  s_cmp_eq_u32 s50, 0
  s_cselect_b32 s12, s72, s12
  s_cselect_b32 s13, s73, s13
  s_lshl_b32 s47, s48, 19
  s_bfe_u32 s34, 0x3020106, s49
  s_add_u32 s48, s48, s34
  s_add_u32 s49, s49, 8
  s_and_b32 s49, s49, 0x8001f
  s_and_b32 s48, s48, 7
  s_lshl_b32 s46, s48, 7
  s_add_u32 m0, s41, 32768
  s_nop 0
  buffer_load_dwordx4 v56, s[12:15], s47 offen offset:0 lds
  v_lshrrev_b32 v26, 2, v24
  v_and_b32 v27, 3, v24
  v_lshl_add_u32 v26, v26, 3, v27
  s_and_b32 s4, s3, 1
  s_lshl_b32 s4, s4, 18
  s_lshr_b32 s5, s3, 1
  s_lshl_b32 s5, s5, 7
  s_add_u32 s4, s4, s5
  s_lshl_b32 s5, s24, 8
  s_add_u32 s4, s4, s5
  v_lshl_add_u32 v26, v26, 13, v25
  v_add_u32 v26, s4, v26
  v_add_u32 v27, 0, v26
  buffer_load_dwordx4 v57, s[12:15], s47 offen offset:1024 lds
  v_accvgpr_write_b32 a226, v27
  v_add_u32 v27, 130048, v26
  v_accvgpr_write_b32 a227, v27
  v_add_u32 v27, 30720, v26
  v_accvgpr_write_b32 a228, v27
  buffer_load_dwordx4 v58, s[12:15], s47 offen offset:2048 lds
  v_add_u32 v27, 160768, v26
  v_accvgpr_write_b32 a229, v27
  s_lshl_b32 s4, s3, 13
  s_add_u32 s4, s4, 98304
  v_and_b32 v24, 15, v1
  v_lshlrev_b32 v24, 7, v24
  v_lshrrev_b32 v25, 4, v1
  v_and_b32 v26, 6, v1
  buffer_load_dwordx4 v59, s[12:15], s47 offen offset:3072 lds
  v_xor_b32 v25, v25, v26
  v_lshl_add_u32 v24, v25, 4, v24
  v_add_u32 v28, s4, v24
  v_xor_b32 v29, 64, v28
  v_lshrrev_b32 v24, 2, v1
  s_add_u32 m0, s41, 36864
  s_nop 0
  buffer_load_dwordx4 v60, s[12:15], s47 offen offset:0 lds
  v_and_b32 v25, 6, v24
  v_lshlrev_b32 v24, 7, v24
  v_and_b32 v26, 1, v1
  v_lshl_add_u32 v24, v26, 3, v24
  v_add_u32 v24, 0, v24
  buffer_load_dwordx4 v61, s[12:15], s47 offen offset:1024 lds
  v_bfe_u32 v26, v1, 1, 1
  v_xor_b32 v25, v25, v26
  v_xor_b32 v26, 0, v25
  v_lshl_add_u32 v30, v26, 4, v24
  v_xor_b32 v26, 2, v25
  buffer_load_dwordx4 v62, s[12:15], s47 offen offset:2048 lds
  v_lshl_add_u32 v31, v26, 4, v24
  v_xor_b32 v26, 4, v25
  v_lshl_add_u32 v32, v26, 4, v24
  v_xor_b32 v26, 6, v25
  v_lshl_add_u32 v33, v26, 4, v24
  buffer_load_dwordx4 v63, s[12:15], s47 offen offset:3072 lds
  v_accvgpr_write_b32 a230, v28
  v_accvgpr_write_b32 a231, v29
  v_accvgpr_write_b32 a232, v30
  v_accvgpr_write_b32 a233, v31
  v_accvgpr_write_b32 a234, v32
  v_accvgpr_write_b32 a235, v33
  s_and_b32 s4, s3, 1
  s_lshl_b32 s5, s62, 1
  s_add_u32 s4, s4, s5
  s_lshr_b32 s5, s3, 1
  s_lshl_b32 s6, s61, 1
  s_add_u32 s5, s5, s6
  s_add_u32 s16, s86, 16777216
  s_addc_u32 s17, s87, 0
  s_mov_b32 s18, 33554432
  s_mov_b32 s19, 0x00020000
  s_lshl_b32 s4, s4, 20
  s_lshl_b32 s5, s5, 16
  s_add_u32 s63, s4, s5
  s_mov_b32 s37, 0
  s_mov_b32 s39, 4294901760
  s_mov_b32 s40, 32768
  s_mov_b32 s37, 2
  s_mov_b32 s42, 0
  s_mov_b32 s44, 4294934528
  s_mov_b32 s45, 32768
  s_mov_b32 s43, s44
  s_or_b32 s4, s2, s3
  s_cbranch_scc1 Ltag_2
  s_mov_b32 s4, 196608
  s_mov_b32 s92, s84
  s_mov_b32 s93, s85
  s_mov_b32 s94, 256
  s_mov_b32 s95, 0x00020000
  s_waitcnt vmcnt(32)
  v_add_u32 v22, 1, v22
  v_or_b32 v23, 0x80000000, v23
  buffer_store_dwordx2 v[22:23], off, s[96:99], s4 sc1
  buffer_store_dwordx2 v[22:23], off, s[92:95], 0 sc1
Ltag_2:
  s_waitcnt vmcnt(16)
  s_barrier
  ds_read_b128 a[0:3], v16 offset:0
  ds_read_b64_tr_b16 a[64:65], v18 offset:0
  ds_read_b64_tr_b16 a[66:67], v18 offset:2048
  ds_read_b128 a[4:7], v16 offset:2048
  ds_read_b128 a[8:11], v16 offset:4096
  ds_read_b128 a[12:15], v16 offset:6144
  ds_read_b128 a[16:19], v16 offset:8192
  ds_read_b128 a[20:23], v16 offset:10240
  ds_read_b128 a[24:27], v16 offset:12288
  ds_read_b128 a[28:31], v16 offset:14336
  ds_read_b64_tr_b16 a[68:69], v19 offset:0
  ds_read_b64_tr_b16 a[70:71], v19 offset:2048
  ds_read_b64_tr_b16 a[72:73], v20 offset:0
  ds_read_b64_tr_b16 a[74:75], v20 offset:2048
  ds_read_b64_tr_b16 a[76:77], v21 offset:0
  ds_read_b64_tr_b16 a[78:79], v21 offset:2048
  ds_read_b64_tr_b16 a[80:81], v18 offset:8192
  ds_read_b64_tr_b16 a[82:83], v18 offset:10240
  ds_read_b64_tr_b16 a[84:85], v19 offset:8192
  ds_read_b64_tr_b16 a[86:87], v19 offset:10240
  ds_read_b64_tr_b16 a[88:89], v20 offset:8192
  ds_read_b64_tr_b16 a[90:91], v20 offset:10240
  ds_read_b64_tr_b16 a[92:93], v21 offset:8192
  ds_read_b64_tr_b16 a[94:95], v21 offset:10240
  s_waitcnt lgkmcnt(0)
  v_mfma_f32_16x16x32_bf16 v[64:67], a[64:67], a[0:3], 0
  s_add_u32 m0, s36, -32768
  ds_read_b128 a[32:35], v17 offset:0
  v_mfma_f32_16x16x32_bf16 v[96:99], a[64:67], a[4:7], 0
  buffer_load_dwordx4 v48, s[8:11], s46 offen offset:0 lds
  v_mfma_f32_16x16x32_bf16 v[128:131], a[64:67], a[8:11], 0
  ds_read_b64_tr_b16 a[96:97], v18 offset:4096
  v_mfma_f32_16x16x32_bf16 v[160:163], a[64:67], a[12:15], 0
  v_mfma_f32_16x16x32_bf16 v[192:195], a[64:67], a[16:19], 0
  ds_read_b64_tr_b16 a[98:99], v18 offset:6144
  v_mfma_f32_16x16x32_bf16 v[224:227], a[64:67], a[20:23], 0
  v_mfma_f32_16x16x32_bf16 a[128:131], a[64:67], a[24:27], 0
  ds_read_b128 a[36:39], v17 offset:2048
  v_mfma_f32_16x16x32_bf16 a[160:163], a[64:67], a[28:31], 0
  buffer_load_dwordx4 v49, s[8:11], s46 offen offset:1024 lds
  v_mfma_f32_16x16x32_bf16 v[68:71], a[68:71], a[0:3], 0
  v_mfma_f32_16x16x32_bf16 v[100:103], a[68:71], a[4:7], 0
  ds_read_b128 a[40:43], v17 offset:4096
  v_mfma_f32_16x16x32_bf16 v[132:135], a[68:71], a[8:11], 0
  v_mfma_f32_16x16x32_bf16 v[164:167], a[68:71], a[12:15], 0
  ds_read_b128 a[44:47], v17 offset:6144
  v_mfma_f32_16x16x32_bf16 v[196:199], a[68:71], a[16:19], 0
  v_mfma_f32_16x16x32_bf16 v[228:231], a[68:71], a[20:23], 0
  ds_read_b128 a[48:51], v17 offset:8192
  v_mfma_f32_16x16x32_bf16 a[132:135], a[68:71], a[24:27], 0
  buffer_load_dwordx4 v50, s[8:11], s46 offen offset:2048 lds
  v_mfma_f32_16x16x32_bf16 a[164:167], a[68:71], a[28:31], 0
  ds_read_b128 a[52:55], v17 offset:10240
  v_mfma_f32_16x16x32_bf16 v[72:75], a[72:75], a[0:3], 0
  v_mfma_f32_16x16x32_bf16 v[104:107], a[72:75], a[4:7], 0
  v_mfma_f32_16x16x32_bf16 v[136:139], a[72:75], a[8:11], 0
  ds_read_b128 a[56:59], v17 offset:12288
  v_mfma_f32_16x16x32_bf16 v[168:171], a[72:75], a[12:15], 0
  v_mfma_f32_16x16x32_bf16 v[200:203], a[72:75], a[16:19], 0
  ds_read_b128 a[60:63], v17 offset:14336
  v_mfma_f32_16x16x32_bf16 v[232:235], a[72:75], a[20:23], 0
  buffer_load_dwordx4 v51, s[8:11], s46 offen offset:3072 lds
  v_mfma_f32_16x16x32_bf16 a[136:139], a[72:75], a[24:27], 0
  s_add_u32 m0, s36, -28672
  ds_read_b64_tr_b16 a[100:101], v19 offset:4096
  v_mfma_f32_16x16x32_bf16 a[168:171], a[72:75], a[28:31], 0
  v_mfma_f32_16x16x32_bf16 v[76:79], a[76:79], a[0:3], 0
  ds_read_b64_tr_b16 a[102:103], v19 offset:6144
  v_mfma_f32_16x16x32_bf16 v[108:111], a[76:79], a[4:7], 0
  v_mfma_f32_16x16x32_bf16 v[140:143], a[76:79], a[8:11], 0
  v_mfma_f32_16x16x32_bf16 v[172:175], a[76:79], a[12:15], 0
  ds_read_b64_tr_b16 a[104:105], v20 offset:4096
  v_mfma_f32_16x16x32_bf16 v[204:207], a[76:79], a[16:19], 0
  buffer_load_dwordx4 v52, s[8:11], s46 offen offset:0 lds
  v_mfma_f32_16x16x32_bf16 v[236:239], a[76:79], a[20:23], 0
  ds_read_b64_tr_b16 a[106:107], v20 offset:6144
  v_mfma_f32_16x16x32_bf16 a[140:143], a[76:79], a[24:27], 0
  v_mfma_f32_16x16x32_bf16 a[172:175], a[76:79], a[28:31], 0
  ds_read_b64_tr_b16 a[108:109], v21 offset:4096
  v_mfma_f32_16x16x32_bf16 v[80:83], a[80:83], a[0:3], 0
  v_mfma_f32_16x16x32_bf16 v[112:115], a[80:83], a[4:7], 0
  ds_read_b64_tr_b16 a[110:111], v21 offset:6144
  v_mfma_f32_16x16x32_bf16 v[144:147], a[80:83], a[8:11], 0
  v_mfma_f32_16x16x32_bf16 v[176:179], a[80:83], a[12:15], 0
  buffer_load_dwordx4 v53, s[8:11], s46 offen offset:1024 lds
  v_mfma_f32_16x16x32_bf16 v[208:211], a[80:83], a[16:19], 0
  ds_read_b64_tr_b16 a[112:113], v18 offset:12288
  v_mfma_f32_16x16x32_bf16 v[240:243], a[80:83], a[20:23], 0
  v_mfma_f32_16x16x32_bf16 a[144:147], a[80:83], a[24:27], 0
  ds_read_b64_tr_b16 a[114:115], v18 offset:14336
  v_mfma_f32_16x16x32_bf16 a[176:179], a[80:83], a[28:31], 0
  v_mfma_f32_16x16x32_bf16 v[84:87], a[84:87], a[0:3], 0
  ds_read_b64_tr_b16 a[116:117], v19 offset:12288
  v_mfma_f32_16x16x32_bf16 v[116:119], a[84:87], a[4:7], 0
  v_mfma_f32_16x16x32_bf16 v[148:151], a[84:87], a[8:11], 0
  buffer_load_dwordx4 v54, s[8:11], s46 offen offset:2048 lds
  ds_read_b64_tr_b16 a[118:119], v19 offset:14336
  v_mfma_f32_16x16x32_bf16 v[180:183], a[84:87], a[12:15], 0
  v_mfma_f32_16x16x32_bf16 v[212:215], a[84:87], a[16:19], 0
  v_mfma_f32_16x16x32_bf16 v[244:247], a[84:87], a[20:23], 0
  ds_read_b64_tr_b16 a[120:121], v20 offset:12288
  v_mfma_f32_16x16x32_bf16 a[148:151], a[84:87], a[24:27], 0
  v_mfma_f32_16x16x32_bf16 a[180:183], a[84:87], a[28:31], 0
  ds_read_b64_tr_b16 a[122:123], v20 offset:14336
  v_mfma_f32_16x16x32_bf16 v[88:91], a[88:91], a[0:3], 0
  v_mfma_f32_16x16x32_bf16 v[120:123], a[88:91], a[4:7], 0
  buffer_load_dwordx4 v55, s[8:11], s46 offen offset:3072 lds
  ds_read_b64_tr_b16 a[124:125], v21 offset:12288
  v_mfma_f32_16x16x32_bf16 v[152:155], a[88:91], a[8:11], 0
  s_sub_u32 s50, s50, 1
  s_cmp_eq_u32 s50, 0
  s_cselect_b32 s12, s72, s12
  s_cselect_b32 s13, s73, s13
  v_mfma_f32_16x16x32_bf16 v[184:187], a[88:91], a[12:15], 0
  s_lshl_b32 s47, s48, 19
  s_bfe_u32 s34, 0x3020106, s49
  s_add_u32 s48, s48, s34
  v_mfma_f32_16x16x32_bf16 v[216:219], a[88:91], a[16:19], 0
  s_add_u32 s49, s49, 8
  s_and_b32 s49, s49, 0x8001f
  s_and_b32 s48, s48, 7
  v_mfma_f32_16x16x32_bf16 v[248:251], a[88:91], a[20:23], 0
  s_lshl_b32 s46, s48, 7
  ds_read_b64_tr_b16 a[126:127], v21 offset:14336
  v_mfma_f32_16x16x32_bf16 a[152:155], a[88:91], a[24:27], 0
  s_add_u32 s37, s37, 1
  s_cmp_eq_u32 s37, 3
  s_cselect_b32 s37, 0, s37
  s_cselect_b32 s38, s39, s40
  v_mfma_f32_16x16x32_bf16 a[184:187], a[88:91], a[28:31], 0
  s_sub_u32 s43, 0, s43
  v_mfma_f32_16x16x32_bf16 v[92:95], a[92:95], a[0:3], 0
  v_add_u32 v16, s38, v16
  v_add_u32 v17, s38, v17
  v_mfma_f32_16x16x32_bf16 v[124:127], a[92:95], a[4:7], 0
  v_add_u32 v18, s43, v18
  v_add_u32 v19, s43, v19
  v_mfma_f32_16x16x32_bf16 v[156:159], a[92:95], a[8:11], 0
  v_add_u32 v20, s43, v20
  v_add_u32 v21, s43, v21
  v_mfma_f32_16x16x32_bf16 v[188:191], a[92:95], a[12:15], 0
  v_mfma_f32_16x16x32_bf16 v[220:223], a[92:95], a[16:19], 0
  v_mfma_f32_16x16x32_bf16 v[252:255], a[92:95], a[20:23], 0
  v_mfma_f32_16x16x32_bf16 a[156:159], a[92:95], a[24:27], 0
  v_mfma_f32_16x16x32_bf16 a[188:191], a[92:95], a[28:31], 0
  s_mov_b32 s35, 6
  s_waitcnt vmcnt(8) lgkmcnt(0)
  s_barrier
  .p2align 6
Lp1wx_loop:
  v_mfma_f32_16x16x32_bf16 v[64:67], a[96:99], a[32:35], v[64:67]
  s_mov_b32 m0, s41
  ds_read_b128 a[0:3], v16 offset:0
  v_mfma_f32_16x16x32_bf16 v[96:99], a[96:99], a[36:39], v[96:99]
  buffer_load_dwordx4 v56, s[12:15], s47 offen offset:0 lds
  v_mfma_f32_16x16x32_bf16 v[128:131], a[96:99], a[40:43], v[128:131]
  ds_read_b64_tr_b16 a[64:65], v18 offset:0
  v_mfma_f32_16x16x32_bf16 v[160:163], a[96:99], a[44:47], v[160:163]
  v_mfma_f32_16x16x32_bf16 v[192:195], a[96:99], a[48:51], v[192:195]
  ds_read_b64_tr_b16 a[66:67], v18 offset:2048
  v_mfma_f32_16x16x32_bf16 v[224:227], a[96:99], a[52:55], v[224:227]
  v_mfma_f32_16x16x32_bf16 a[128:131], a[96:99], a[56:59], a[128:131]
  ds_read_b128 a[4:7], v16 offset:2048
  v_mfma_f32_16x16x32_bf16 a[160:163], a[96:99], a[60:63], a[160:163]
  buffer_load_dwordx4 v57, s[12:15], s47 offen offset:1024 lds
  v_mfma_f32_16x16x32_bf16 v[68:71], a[100:103], a[32:35], v[68:71]
  v_mfma_f32_16x16x32_bf16 v[100:103], a[100:103], a[36:39], v[100:103]
  ds_read_b128 a[8:11], v16 offset:4096
  v_mfma_f32_16x16x32_bf16 v[132:135], a[100:103], a[40:43], v[132:135]
  v_mfma_f32_16x16x32_bf16 v[164:167], a[100:103], a[44:47], v[164:167]
  ds_read_b128 a[12:15], v16 offset:6144
  v_mfma_f32_16x16x32_bf16 v[196:199], a[100:103], a[48:51], v[196:199]
  v_mfma_f32_16x16x32_bf16 v[228:231], a[100:103], a[52:55], v[228:231]
  ds_read_b128 a[16:19], v16 offset:8192
  v_mfma_f32_16x16x32_bf16 a[132:135], a[100:103], a[56:59], a[132:135]
  v_mfma_f32_16x16x32_bf16 a[164:167], a[100:103], a[60:63], a[164:167]
  buffer_load_dwordx4 v58, s[12:15], s47 offen offset:2048 lds
  ds_read_b128 a[20:23], v16 offset:10240
  v_mfma_f32_16x16x32_bf16 v[72:75], a[104:107], a[32:35], v[72:75]
  v_mfma_f32_16x16x32_bf16 v[104:107], a[104:107], a[36:39], v[104:107]
  v_mfma_f32_16x16x32_bf16 v[136:139], a[104:107], a[40:43], v[136:139]
  ds_read_b128 a[24:27], v16 offset:12288
  v_mfma_f32_16x16x32_bf16 v[168:171], a[104:107], a[44:47], v[168:171]
  v_mfma_f32_16x16x32_bf16 v[200:203], a[104:107], a[48:51], v[200:203]
  ds_read_b128 a[28:31], v16 offset:14336
  v_mfma_f32_16x16x32_bf16 v[232:235], a[104:107], a[52:55], v[232:235]
  v_mfma_f32_16x16x32_bf16 a[136:139], a[104:107], a[56:59], a[136:139]
  ds_read_b64_tr_b16 a[68:69], v19 offset:0
  v_mfma_f32_16x16x32_bf16 a[168:171], a[104:107], a[60:63], a[168:171]
  buffer_load_dwordx4 v59, s[12:15], s47 offen offset:3072 lds
  v_mfma_f32_16x16x32_bf16 v[76:79], a[108:111], a[32:35], v[76:79]
  s_add_u32 m0, s41, 4096
  ds_read_b64_tr_b16 a[70:71], v19 offset:2048
  v_mfma_f32_16x16x32_bf16 v[108:111], a[108:111], a[36:39], v[108:111]
  v_mfma_f32_16x16x32_bf16 v[140:143], a[108:111], a[40:43], v[140:143]
  v_mfma_f32_16x16x32_bf16 v[172:175], a[108:111], a[44:47], v[172:175]
  ds_read_b64_tr_b16 a[72:73], v20 offset:0
  v_mfma_f32_16x16x32_bf16 v[204:207], a[108:111], a[48:51], v[204:207]
  v_mfma_f32_16x16x32_bf16 v[236:239], a[108:111], a[52:55], v[236:239]
  ds_read_b64_tr_b16 a[74:75], v20 offset:2048
  v_mfma_f32_16x16x32_bf16 a[140:143], a[108:111], a[56:59], a[140:143]
  v_mfma_f32_16x16x32_bf16 a[172:175], a[108:111], a[60:63], a[172:175]
  buffer_load_dwordx4 v60, s[12:15], s47 offen offset:0 lds
  ds_read_b64_tr_b16 a[76:77], v21 offset:0
  v_mfma_f32_16x16x32_bf16 v[80:83], a[112:115], a[32:35], v[80:83]
  v_mfma_f32_16x16x32_bf16 v[112:115], a[112:115], a[36:39], v[112:115]
  ds_read_b64_tr_b16 a[78:79], v21 offset:2048
  v_mfma_f32_16x16x32_bf16 v[144:147], a[112:115], a[40:43], v[144:147]
  v_mfma_f32_16x16x32_bf16 v[176:179], a[112:115], a[44:47], v[176:179]
  v_mfma_f32_16x16x32_bf16 v[208:211], a[112:115], a[48:51], v[208:211]
  ds_read_b64_tr_b16 a[80:81], v18 offset:8192
  v_mfma_f32_16x16x32_bf16 v[240:243], a[112:115], a[52:55], v[240:243]
  v_mfma_f32_16x16x32_bf16 a[144:147], a[112:115], a[56:59], a[144:147]
  ds_read_b64_tr_b16 a[82:83], v18 offset:10240
  v_mfma_f32_16x16x32_bf16 a[176:179], a[112:115], a[60:63], a[176:179]
  buffer_load_dwordx4 v61, s[12:15], s47 offen offset:1024 lds
  v_mfma_f32_16x16x32_bf16 v[84:87], a[116:119], a[32:35], v[84:87]
  ds_read_b64_tr_b16 a[84:85], v19 offset:8192
  v_mfma_f32_16x16x32_bf16 v[116:119], a[116:119], a[36:39], v[116:119]
  v_mfma_f32_16x16x32_bf16 v[148:151], a[116:119], a[40:43], v[148:151]
  ds_read_b64_tr_b16 a[86:87], v19 offset:10240
  v_mfma_f32_16x16x32_bf16 v[180:183], a[116:119], a[44:47], v[180:183]
  v_mfma_f32_16x16x32_bf16 v[212:215], a[116:119], a[48:51], v[212:215]
  v_mfma_f32_16x16x32_bf16 v[244:247], a[116:119], a[52:55], v[244:247]
  ds_read_b64_tr_b16 a[88:89], v20 offset:8192
  v_mfma_f32_16x16x32_bf16 a[148:151], a[116:119], a[56:59], a[148:151]
  v_mfma_f32_16x16x32_bf16 a[180:183], a[116:119], a[60:63], a[180:183]
  buffer_load_dwordx4 v62, s[12:15], s47 offen offset:2048 lds
  ds_read_b64_tr_b16 a[90:91], v20 offset:10240
  v_mfma_f32_16x16x32_bf16 v[88:91], a[120:123], a[32:35], v[88:91]
  v_mfma_f32_16x16x32_bf16 v[120:123], a[120:123], a[36:39], v[120:123]
  ds_read_b64_tr_b16 a[92:93], v21 offset:8192
  v_mfma_f32_16x16x32_bf16 v[152:155], a[120:123], a[40:43], v[152:155]
  v_mfma_f32_16x16x32_bf16 v[184:187], a[120:123], a[44:47], v[184:187]
  ds_read_b64_tr_b16 a[94:95], v21 offset:10240
  v_mfma_f32_16x16x32_bf16 v[216:219], a[120:123], a[48:51], v[216:219]
  v_mfma_f32_16x16x32_bf16 v[248:251], a[120:123], a[52:55], v[248:251]
  v_mfma_f32_16x16x32_bf16 a[152:155], a[120:123], a[56:59], a[152:155]
  v_mfma_f32_16x16x32_bf16 a[184:187], a[120:123], a[60:63], a[184:187]
  buffer_load_dwordx4 v63, s[12:15], s47 offen offset:3072 lds
  v_mfma_f32_16x16x32_bf16 v[92:95], a[124:127], a[32:35], v[92:95]
  v_mfma_f32_16x16x32_bf16 v[124:127], a[124:127], a[36:39], v[124:127]
  v_mfma_f32_16x16x32_bf16 v[156:159], a[124:127], a[40:43], v[156:159]
  v_mfma_f32_16x16x32_bf16 v[188:191], a[124:127], a[44:47], v[188:191]
  v_mfma_f32_16x16x32_bf16 v[220:223], a[124:127], a[48:51], v[220:223]
  v_mfma_f32_16x16x32_bf16 v[252:255], a[124:127], a[52:55], v[252:255]
  v_mfma_f32_16x16x32_bf16 a[156:159], a[124:127], a[56:59], a[156:159]
  v_mfma_f32_16x16x32_bf16 a[188:191], a[124:127], a[60:63], a[188:191]
  s_waitcnt lgkmcnt(0)
  v_mfma_f32_16x16x32_bf16 v[64:67], a[64:67], a[0:3], v[64:67]
  s_mov_b32 m0, s36
  ds_read_b128 a[32:35], v17 offset:0
  v_mfma_f32_16x16x32_bf16 v[96:99], a[64:67], a[4:7], v[96:99]
  buffer_load_dwordx4 v48, s[8:11], s46 offen offset:0 lds
  v_mfma_f32_16x16x32_bf16 v[128:131], a[64:67], a[8:11], v[128:131]
  ds_read_b64_tr_b16 a[96:97], v18 offset:4096
  v_mfma_f32_16x16x32_bf16 v[160:163], a[64:67], a[12:15], v[160:163]
  v_mfma_f32_16x16x32_bf16 v[192:195], a[64:67], a[16:19], v[192:195]
  ds_read_b64_tr_b16 a[98:99], v18 offset:6144
  v_mfma_f32_16x16x32_bf16 v[224:227], a[64:67], a[20:23], v[224:227]
  v_mfma_f32_16x16x32_bf16 a[128:131], a[64:67], a[24:27], a[128:131]
  ds_read_b128 a[36:39], v17 offset:2048
  v_mfma_f32_16x16x32_bf16 a[160:163], a[64:67], a[28:31], a[160:163]
  buffer_load_dwordx4 v49, s[8:11], s46 offen offset:1024 lds
  v_mfma_f32_16x16x32_bf16 v[68:71], a[68:71], a[0:3], v[68:71]
  v_mfma_f32_16x16x32_bf16 v[100:103], a[68:71], a[4:7], v[100:103]
  ds_read_b128 a[40:43], v17 offset:4096
  v_mfma_f32_16x16x32_bf16 v[132:135], a[68:71], a[8:11], v[132:135]
  v_mfma_f32_16x16x32_bf16 v[164:167], a[68:71], a[12:15], v[164:167]
  ds_read_b128 a[44:47], v17 offset:6144
  v_mfma_f32_16x16x32_bf16 v[196:199], a[68:71], a[16:19], v[196:199]
  v_mfma_f32_16x16x32_bf16 v[228:231], a[68:71], a[20:23], v[228:231]
  ds_read_b128 a[48:51], v17 offset:8192
  v_mfma_f32_16x16x32_bf16 a[132:135], a[68:71], a[24:27], a[132:135]
  buffer_load_dwordx4 v50, s[8:11], s46 offen offset:2048 lds
  v_mfma_f32_16x16x32_bf16 a[164:167], a[68:71], a[28:31], a[164:167]
  ds_read_b128 a[52:55], v17 offset:10240
  v_mfma_f32_16x16x32_bf16 v[72:75], a[72:75], a[0:3], v[72:75]
  v_mfma_f32_16x16x32_bf16 v[104:107], a[72:75], a[4:7], v[104:107]
  v_mfma_f32_16x16x32_bf16 v[136:139], a[72:75], a[8:11], v[136:139]
  ds_read_b128 a[56:59], v17 offset:12288
  v_mfma_f32_16x16x32_bf16 v[168:171], a[72:75], a[12:15], v[168:171]
  v_mfma_f32_16x16x32_bf16 v[200:203], a[72:75], a[16:19], v[200:203]
  ds_read_b128 a[60:63], v17 offset:14336
  v_mfma_f32_16x16x32_bf16 v[232:235], a[72:75], a[20:23], v[232:235]
  buffer_load_dwordx4 v51, s[8:11], s46 offen offset:3072 lds
  v_mfma_f32_16x16x32_bf16 a[136:139], a[72:75], a[24:27], a[136:139]
  s_add_u32 m0, s36, 4096
  ds_read_b64_tr_b16 a[100:101], v19 offset:4096
  v_mfma_f32_16x16x32_bf16 a[168:171], a[72:75], a[28:31], a[168:171]
  v_mfma_f32_16x16x32_bf16 v[76:79], a[76:79], a[0:3], v[76:79]
  ds_read_b64_tr_b16 a[102:103], v19 offset:6144
  v_mfma_f32_16x16x32_bf16 v[108:111], a[76:79], a[4:7], v[108:111]
  v_mfma_f32_16x16x32_bf16 v[140:143], a[76:79], a[8:11], v[140:143]
  v_mfma_f32_16x16x32_bf16 v[172:175], a[76:79], a[12:15], v[172:175]
  ds_read_b64_tr_b16 a[104:105], v20 offset:4096
  v_mfma_f32_16x16x32_bf16 v[204:207], a[76:79], a[16:19], v[204:207]
  buffer_load_dwordx4 v52, s[8:11], s46 offen offset:0 lds
  v_mfma_f32_16x16x32_bf16 v[236:239], a[76:79], a[20:23], v[236:239]
  ds_read_b64_tr_b16 a[106:107], v20 offset:6144
  v_mfma_f32_16x16x32_bf16 a[140:143], a[76:79], a[24:27], a[140:143]
  v_mfma_f32_16x16x32_bf16 a[172:175], a[76:79], a[28:31], a[172:175]
  ds_read_b64_tr_b16 a[108:109], v21 offset:4096
  v_mfma_f32_16x16x32_bf16 v[80:83], a[80:83], a[0:3], v[80:83]
  v_mfma_f32_16x16x32_bf16 v[112:115], a[80:83], a[4:7], v[112:115]
  ds_read_b64_tr_b16 a[110:111], v21 offset:6144
  v_mfma_f32_16x16x32_bf16 v[144:147], a[80:83], a[8:11], v[144:147]
  v_mfma_f32_16x16x32_bf16 v[176:179], a[80:83], a[12:15], v[176:179]
  buffer_load_dwordx4 v53, s[8:11], s46 offen offset:1024 lds
  v_mfma_f32_16x16x32_bf16 v[208:211], a[80:83], a[16:19], v[208:211]
  ds_read_b64_tr_b16 a[112:113], v18 offset:12288
  v_mfma_f32_16x16x32_bf16 v[240:243], a[80:83], a[20:23], v[240:243]
  v_mfma_f32_16x16x32_bf16 a[144:147], a[80:83], a[24:27], a[144:147]
  ds_read_b64_tr_b16 a[114:115], v18 offset:14336
  v_mfma_f32_16x16x32_bf16 a[176:179], a[80:83], a[28:31], a[176:179]
  v_mfma_f32_16x16x32_bf16 v[84:87], a[84:87], a[0:3], v[84:87]
  ds_read_b64_tr_b16 a[116:117], v19 offset:12288
  v_mfma_f32_16x16x32_bf16 v[116:119], a[84:87], a[4:7], v[116:119]
  v_mfma_f32_16x16x32_bf16 v[148:151], a[84:87], a[8:11], v[148:151]
  buffer_load_dwordx4 v54, s[8:11], s46 offen offset:2048 lds
  ds_read_b64_tr_b16 a[118:119], v19 offset:14336
  v_mfma_f32_16x16x32_bf16 v[180:183], a[84:87], a[12:15], v[180:183]
  v_mfma_f32_16x16x32_bf16 v[212:215], a[84:87], a[16:19], v[212:215]
  v_mfma_f32_16x16x32_bf16 v[244:247], a[84:87], a[20:23], v[244:247]
  ds_read_b64_tr_b16 a[120:121], v20 offset:12288
  v_mfma_f32_16x16x32_bf16 a[148:151], a[84:87], a[24:27], a[148:151]
  v_mfma_f32_16x16x32_bf16 a[180:183], a[84:87], a[28:31], a[180:183]
  ds_read_b64_tr_b16 a[122:123], v20 offset:14336
  v_mfma_f32_16x16x32_bf16 v[88:91], a[88:91], a[0:3], v[88:91]
  v_mfma_f32_16x16x32_bf16 v[120:123], a[88:91], a[4:7], v[120:123]
  buffer_load_dwordx4 v55, s[8:11], s46 offen offset:3072 lds
  ds_read_b64_tr_b16 a[124:125], v21 offset:12288
  v_mfma_f32_16x16x32_bf16 v[152:155], a[88:91], a[8:11], v[152:155]
  s_sub_u32 s50, s50, 1
  s_cmp_eq_u32 s50, 0
  s_cselect_b32 s12, s72, s12
  s_cselect_b32 s13, s73, s13
  v_mfma_f32_16x16x32_bf16 v[184:187], a[88:91], a[12:15], v[184:187]
  s_lshl_b32 s47, s48, 19
  s_bfe_u32 s34, 0x3020106, s49
  s_add_u32 s48, s48, s34
  v_mfma_f32_16x16x32_bf16 v[216:219], a[88:91], a[16:19], v[216:219]
  s_add_u32 s49, s49, 8
  s_and_b32 s49, s49, 0x8001f
  s_and_b32 s48, s48, 7
  v_mfma_f32_16x16x32_bf16 v[248:251], a[88:91], a[20:23], v[248:251]
  s_lshl_b32 s46, s48, 7
  ds_read_b64_tr_b16 a[126:127], v21 offset:14336
  v_mfma_f32_16x16x32_bf16 a[152:155], a[88:91], a[24:27], a[152:155]
  s_add_u32 s36, s36, s38
  s_add_u32 s37, s37, 1
  s_cmp_eq_u32 s37, 3
  s_cselect_b32 s37, 0, s37
  s_cselect_b32 s38, s39, s40
  v_mfma_f32_16x16x32_bf16 a[184:187], a[88:91], a[28:31], a[184:187]
  s_add_u32 s41, s41, s43
  s_sub_u32 s43, 0, s43
  v_mfma_f32_16x16x32_bf16 v[92:95], a[92:95], a[0:3], v[92:95]
  v_add_u32 v16, s38, v16
  v_add_u32 v17, s38, v17
  v_mfma_f32_16x16x32_bf16 v[124:127], a[92:95], a[4:7], v[124:127]
  v_add_u32 v18, s43, v18
  v_add_u32 v19, s43, v19
  v_mfma_f32_16x16x32_bf16 v[156:159], a[92:95], a[8:11], v[156:159]
  v_add_u32 v20, s43, v20
  v_add_u32 v21, s43, v21
  v_mfma_f32_16x16x32_bf16 v[188:191], a[92:95], a[12:15], v[188:191]
  v_mfma_f32_16x16x32_bf16 v[220:223], a[92:95], a[16:19], v[220:223]
  v_mfma_f32_16x16x32_bf16 v[252:255], a[92:95], a[20:23], v[252:255]
  s_waitcnt vmcnt(8) lgkmcnt(0)
  s_barrier
  v_mfma_f32_16x16x32_bf16 a[156:159], a[92:95], a[24:27], a[156:159]
  s_sub_u32 s35, s35, 1
  v_mfma_f32_16x16x32_bf16 a[188:191], a[92:95], a[28:31], a[188:191]
  s_cmp_lg_u32 s35, 0
  s_cbranch_scc1 Lp1wx_loop
  v_mfma_f32_16x16x32_bf16 v[64:67], a[96:99], a[32:35], v[64:67]
  s_mov_b32 m0, s41
  ds_read_b128 a[0:3], v16 offset:0
  v_mfma_f32_16x16x32_bf16 v[96:99], a[96:99], a[36:39], v[96:99]
  buffer_load_dwordx4 v56, s[12:15], s47 offen offset:0 lds
  v_mfma_f32_16x16x32_bf16 v[128:131], a[96:99], a[40:43], v[128:131]
  ds_read_b64_tr_b16 a[64:65], v18 offset:0
  v_mfma_f32_16x16x32_bf16 v[160:163], a[96:99], a[44:47], v[160:163]
  buffer_load_dwordx4 v57, s[12:15], s47 offen offset:1024 lds
  v_mfma_f32_16x16x32_bf16 v[192:195], a[96:99], a[48:51], v[192:195]
  ds_read_b64_tr_b16 a[66:67], v18 offset:2048
  v_mfma_f32_16x16x32_bf16 v[224:227], a[96:99], a[52:55], v[224:227]
  v_mfma_f32_16x16x32_bf16 a[128:131], a[96:99], a[56:59], a[128:131]
  ds_read_b128 a[4:7], v16 offset:2048
  v_mfma_f32_16x16x32_bf16 a[160:163], a[96:99], a[60:63], a[160:163]
  buffer_load_dwordx4 v58, s[12:15], s47 offen offset:2048 lds
  v_mfma_f32_16x16x32_bf16 v[68:71], a[100:103], a[32:35], v[68:71]
  v_mfma_f32_16x16x32_bf16 v[100:103], a[100:103], a[36:39], v[100:103]
  ds_read_b128 a[8:11], v16 offset:4096
  v_mfma_f32_16x16x32_bf16 v[132:135], a[100:103], a[40:43], v[132:135]
  v_mfma_f32_16x16x32_bf16 v[164:167], a[100:103], a[44:47], v[164:167]
  buffer_load_dwordx4 v59, s[12:15], s47 offen offset:3072 lds
  ds_read_b128 a[12:15], v16 offset:6144
  v_mfma_f32_16x16x32_bf16 v[196:199], a[100:103], a[48:51], v[196:199]
  s_add_u32 m0, s41, 4096
  v_mfma_f32_16x16x32_bf16 v[228:231], a[100:103], a[52:55], v[228:231]
  ds_read_b128 a[16:19], v16 offset:8192
  v_mfma_f32_16x16x32_bf16 a[132:135], a[100:103], a[56:59], a[132:135]
  v_mfma_f32_16x16x32_bf16 a[164:167], a[100:103], a[60:63], a[164:167]
  buffer_load_dwordx4 v60, s[12:15], s47 offen offset:0 lds
  ds_read_b128 a[20:23], v16 offset:10240
  v_mfma_f32_16x16x32_bf16 v[72:75], a[104:107], a[32:35], v[72:75]
  v_mfma_f32_16x16x32_bf16 v[104:107], a[104:107], a[36:39], v[104:107]
  v_mfma_f32_16x16x32_bf16 v[136:139], a[104:107], a[40:43], v[136:139]
  ds_read_b128 a[24:27], v16 offset:12288
  v_mfma_f32_16x16x32_bf16 v[168:171], a[104:107], a[44:47], v[168:171]
  buffer_load_dwordx4 v61, s[12:15], s47 offen offset:1024 lds
  v_mfma_f32_16x16x32_bf16 v[200:203], a[104:107], a[48:51], v[200:203]
  ds_read_b128 a[28:31], v16 offset:14336
  v_mfma_f32_16x16x32_bf16 v[232:235], a[104:107], a[52:55], v[232:235]
  v_mfma_f32_16x16x32_bf16 a[136:139], a[104:107], a[56:59], a[136:139]
  ds_read_b64_tr_b16 a[68:69], v19 offset:0
  v_mfma_f32_16x16x32_bf16 a[168:171], a[104:107], a[60:63], a[168:171]
  buffer_load_dwordx4 v62, s[12:15], s47 offen offset:2048 lds
  v_mfma_f32_16x16x32_bf16 v[76:79], a[108:111], a[32:35], v[76:79]
  ds_read_b64_tr_b16 a[70:71], v19 offset:2048
  v_mfma_f32_16x16x32_bf16 v[108:111], a[108:111], a[36:39], v[108:111]
  v_mfma_f32_16x16x32_bf16 v[140:143], a[108:111], a[40:43], v[140:143]
  v_mfma_f32_16x16x32_bf16 v[172:175], a[108:111], a[44:47], v[172:175]
  buffer_load_dwordx4 v63, s[12:15], s47 offen offset:3072 lds
  ds_read_b64_tr_b16 a[72:73], v20 offset:0
  v_mfma_f32_16x16x32_bf16 v[204:207], a[108:111], a[48:51], v[204:207]
  s_mov_b32 m0, s36
  v_mfma_f32_16x16x32_bf16 v[236:239], a[108:111], a[52:55], v[236:239]
  ds_read_b64_tr_b16 a[74:75], v20 offset:2048
  v_mfma_f32_16x16x32_bf16 a[140:143], a[108:111], a[56:59], a[140:143]
  v_mfma_f32_16x16x32_bf16 a[172:175], a[108:111], a[60:63], a[172:175]
  buffer_load_dwordx4 v48, s[8:11], s46 offen offset:0 lds
  ds_read_b64_tr_b16 a[76:77], v21 offset:0
  v_mfma_f32_16x16x32_bf16 v[80:83], a[112:115], a[32:35], v[80:83]
  v_mfma_f32_16x16x32_bf16 v[112:115], a[112:115], a[36:39], v[112:115]
  ds_read_b64_tr_b16 a[78:79], v21 offset:2048
  v_mfma_f32_16x16x32_bf16 v[144:147], a[112:115], a[40:43], v[144:147]
  v_mfma_f32_16x16x32_bf16 v[176:179], a[112:115], a[44:47], v[176:179]
  buffer_load_dwordx4 v49, s[8:11], s46 offen offset:1024 lds
  v_mfma_f32_16x16x32_bf16 v[208:211], a[112:115], a[48:51], v[208:211]
  ds_read_b64_tr_b16 a[80:81], v18 offset:8192
  v_mfma_f32_16x16x32_bf16 v[240:243], a[112:115], a[52:55], v[240:243]
  v_mfma_f32_16x16x32_bf16 a[144:147], a[112:115], a[56:59], a[144:147]
  ds_read_b64_tr_b16 a[82:83], v18 offset:10240
  v_mfma_f32_16x16x32_bf16 a[176:179], a[112:115], a[60:63], a[176:179]
  buffer_load_dwordx4 v50, s[8:11], s46 offen offset:2048 lds
  v_mfma_f32_16x16x32_bf16 v[84:87], a[116:119], a[32:35], v[84:87]
  ds_read_b64_tr_b16 a[84:85], v19 offset:8192
  v_mfma_f32_16x16x32_bf16 v[116:119], a[116:119], a[36:39], v[116:119]
  v_mfma_f32_16x16x32_bf16 v[148:151], a[116:119], a[40:43], v[148:151]
  ds_read_b64_tr_b16 a[86:87], v19 offset:10240
  v_mfma_f32_16x16x32_bf16 v[180:183], a[116:119], a[44:47], v[180:183]
  buffer_load_dwordx4 v51, s[8:11], s46 offen offset:3072 lds
  v_mfma_f32_16x16x32_bf16 v[212:215], a[116:119], a[48:51], v[212:215]
  s_add_u32 m0, s36, 4096
  v_mfma_f32_16x16x32_bf16 v[244:247], a[116:119], a[52:55], v[244:247]
  ds_read_b64_tr_b16 a[88:89], v20 offset:8192
  v_mfma_f32_16x16x32_bf16 a[148:151], a[116:119], a[56:59], a[148:151]
  v_mfma_f32_16x16x32_bf16 a[180:183], a[116:119], a[60:63], a[180:183]
  buffer_load_dwordx4 v52, s[8:11], s46 offen offset:0 lds
  ds_read_b64_tr_b16 a[90:91], v20 offset:10240
  v_mfma_f32_16x16x32_bf16 v[88:91], a[120:123], a[32:35], v[88:91]
  v_mfma_f32_16x16x32_bf16 v[120:123], a[120:123], a[36:39], v[120:123]
  ds_read_b64_tr_b16 a[92:93], v21 offset:8192
  v_mfma_f32_16x16x32_bf16 v[152:155], a[120:123], a[40:43], v[152:155]
  v_mfma_f32_16x16x32_bf16 v[184:187], a[120:123], a[44:47], v[184:187]
  buffer_load_dwordx4 v53, s[8:11], s46 offen offset:1024 lds
  ds_read_b64_tr_b16 a[94:95], v21 offset:10240
  v_mfma_f32_16x16x32_bf16 v[216:219], a[120:123], a[48:51], v[216:219]
  v_mfma_f32_16x16x32_bf16 v[248:251], a[120:123], a[52:55], v[248:251]
  v_mfma_f32_16x16x32_bf16 a[152:155], a[120:123], a[56:59], a[152:155]
  v_mfma_f32_16x16x32_bf16 a[184:187], a[120:123], a[60:63], a[184:187]
  buffer_load_dwordx4 v54, s[8:11], s46 offen offset:2048 lds
  v_mfma_f32_16x16x32_bf16 v[92:95], a[124:127], a[32:35], v[92:95]
  v_mfma_f32_16x16x32_bf16 v[124:127], a[124:127], a[36:39], v[124:127]
  v_mfma_f32_16x16x32_bf16 v[156:159], a[124:127], a[40:43], v[156:159]
  v_mfma_f32_16x16x32_bf16 v[188:191], a[124:127], a[44:47], v[188:191]
  buffer_load_dwordx4 v55, s[8:11], s46 offen offset:3072 lds
  v_mfma_f32_16x16x32_bf16 v[220:223], a[124:127], a[48:51], v[220:223]
  s_sub_u32 s50, s50, 1
  s_cmp_eq_u32 s50, 0
  s_cselect_b32 s12, s72, s12
  s_cselect_b32 s13, s73, s13
  v_mfma_f32_16x16x32_bf16 v[252:255], a[124:127], a[52:55], v[252:255]
  s_lshl_b32 s47, s48, 19
  s_bfe_u32 s34, 0x3020106, s49
  s_add_u32 s48, s48, s34
  v_mfma_f32_16x16x32_bf16 a[156:159], a[124:127], a[56:59], a[156:159]
  s_add_u32 s49, s49, 8
  s_and_b32 s49, s49, 0x8001f
  s_and_b32 s48, s48, 7
  v_mfma_f32_16x16x32_bf16 a[188:191], a[124:127], a[60:63], a[188:191]
  s_lshl_b32 s46, s48, 7
  s_waitcnt lgkmcnt(0)
  v_mfma_f32_16x16x32_bf16 v[128:131], a[64:67], a[8:11], v[128:131]
  ds_read_b128 a[32:35], v17 offset:0
  ds_read_b64_tr_b16 a[96:97], v18 offset:4096
  v_mfma_f32_16x16x32_bf16 v[132:135], a[68:71], a[8:11], v[132:135]
  ds_read_b64_tr_b16 a[98:99], v18 offset:6144
  ds_read_b128 a[36:39], v17 offset:2048
  v_mfma_f32_16x16x32_bf16 a[128:131], a[64:67], a[24:27], a[128:131]
  ds_read_b128 a[40:43], v17 offset:4096
  ds_read_b128 a[44:47], v17 offset:6144
  v_mfma_f32_16x16x32_bf16 a[132:135], a[68:71], a[24:27], a[132:135]
  ds_read_b128 a[48:51], v17 offset:8192
  ds_read_b128 a[52:55], v17 offset:10240
  v_mfma_f32_16x16x32_bf16 v[136:139], a[72:75], a[8:11], v[136:139]
  ds_read_b128 a[56:59], v17 offset:12288
  ds_read_b128 a[60:63], v17 offset:14336
  v_mfma_f32_16x16x32_bf16 v[140:143], a[76:79], a[8:11], v[140:143]
  ds_read_b64_tr_b16 a[100:101], v19 offset:4096
  ds_read_b64_tr_b16 a[102:103], v19 offset:6144
  v_mfma_f32_16x16x32_bf16 a[136:139], a[72:75], a[24:27], a[136:139]
  ds_read_b64_tr_b16 a[104:105], v20 offset:4096
  v_mfma_f32_16x16x32_bf16 a[140:143], a[76:79], a[24:27], a[140:143]
  ds_read_b64_tr_b16 a[106:107], v20 offset:6144
  ds_read_b64_tr_b16 a[108:109], v21 offset:4096
  v_mfma_f32_16x16x32_bf16 v[144:147], a[80:83], a[8:11], v[144:147]
  ds_read_b64_tr_b16 a[110:111], v21 offset:6144
  ds_read_b64_tr_b16 a[112:113], v18 offset:12288
  v_mfma_f32_16x16x32_bf16 v[148:151], a[84:87], a[8:11], v[148:151]
  ds_read_b64_tr_b16 a[114:115], v18 offset:14336
  ds_read_b64_tr_b16 a[116:117], v19 offset:12288
  v_mfma_f32_16x16x32_bf16 a[144:147], a[80:83], a[24:27], a[144:147]
  ds_read_b64_tr_b16 a[118:119], v19 offset:14336
  ds_read_b64_tr_b16 a[120:121], v20 offset:12288
  v_mfma_f32_16x16x32_bf16 a[148:151], a[84:87], a[24:27], a[148:151]
  ds_read_b64_tr_b16 a[122:123], v20 offset:14336
  ds_read_b64_tr_b16 a[124:125], v21 offset:12288
  v_mfma_f32_16x16x32_bf16 v[152:155], a[88:91], a[8:11], v[152:155]
  ds_read_b64_tr_b16 a[126:127], v21 offset:14336
  v_mfma_f32_16x16x32_bf16 v[156:159], a[92:95], a[8:11], v[156:159]
  v_mfma_f32_16x16x32_bf16 a[152:155], a[88:91], a[24:27], a[152:155]
  v_mfma_f32_16x16x32_bf16 a[156:159], a[92:95], a[24:27], a[156:159]
  v_mfma_f32_16x16x32_bf16 v[160:163], a[64:67], a[12:15], v[160:163]
  v_mfma_f32_16x16x32_bf16 v[164:167], a[68:71], a[12:15], v[164:167]
  s_add_u32 s36, s36, s38
  s_add_u32 s37, s37, 1
  s_cmp_eq_u32 s37, 3
  s_cselect_b32 s37, 0, s37
  s_cselect_b32 s38, s39, s40
  v_add_u32 v16, s38, v16
  v_add_u32 v17, s38, v17
  s_add_u32 s41, s41, s43
  s_sub_u32 s43, 0, s43
  v_add_u32 v18, s43, v18
  v_add_u32 v19, s43, v19
  v_add_u32 v20, s43, v20
  v_add_u32 v21, s43, v21
  s_waitcnt vmcnt(8) lgkmcnt(0)
  s_barrier
  v_mfma_f32_16x16x32_bf16 v[128:131], a[96:99], a[40:43], v[128:131]
  s_mov_b32 m0, s41
  v_mfma_f32_16x16x32_bf16 v[132:135], a[100:103], a[40:43], v[132:135]
  buffer_load_dwordx4 v56, s[12:15], s47 offen offset:0 lds
  v_mfma_f32_16x16x32_bf16 a[128:131], a[96:99], a[56:59], a[128:131]
  v_mfma_f32_16x16x32_bf16 a[132:135], a[100:103], a[56:59], a[132:135]
  v_mfma_f32_16x16x32_bf16 v[136:139], a[104:107], a[40:43], v[136:139]
  v_mfma_f32_16x16x32_bf16 v[140:143], a[108:111], a[40:43], v[140:143]
  buffer_load_dwordx4 v57, s[12:15], s47 offen offset:1024 lds
  v_cvt_pk_bf16_f32 v128, v128, v129
  v_mfma_f32_16x16x32_bf16 a[136:139], a[104:107], a[56:59], a[136:139]
  v_cvt_pk_bf16_f32 v129, v130, v131
  v_cvt_pk_bf16_f32 v130, v132, v133
  v_mfma_f32_16x16x32_bf16 a[140:143], a[108:111], a[56:59], a[140:143]
  v_cvt_pk_bf16_f32 v131, v134, v135
  v_accvgpr_read_b32 v24, a128
  v_mfma_f32_16x16x32_bf16 v[144:147], a[112:115], a[40:43], v[144:147]
  v_accvgpr_read_b32 v25, a129
  v_accvgpr_read_b32 v26, a130
  v_mfma_f32_16x16x32_bf16 v[148:151], a[116:119], a[40:43], v[148:151]
  v_accvgpr_read_b32 v27, a131
  v_accvgpr_read_b32 v28, a132
  v_mfma_f32_16x16x32_bf16 a[144:147], a[112:115], a[56:59], a[144:147]
  v_accvgpr_read_b32 v29, a133
  v_accvgpr_read_b32 v30, a134
  v_mfma_f32_16x16x32_bf16 a[148:151], a[116:119], a[56:59], a[148:151]
  buffer_load_dwordx4 v58, s[12:15], s47 offen offset:2048 lds
  v_accvgpr_read_b32 v31, a135
  v_mfma_f32_16x16x32_bf16 v[152:155], a[120:123], a[40:43], v[152:155]
  v_cvt_pk_bf16_f32 v132, v24, v25
  v_cvt_pk_bf16_f32 v133, v26, v27
  v_mfma_f32_16x16x32_bf16 v[156:159], a[124:127], a[40:43], v[156:159]
  v_cvt_pk_bf16_f32 v134, v28, v29
  v_cvt_pk_bf16_f32 v135, v30, v31
  v_mfma_f32_16x16x32_bf16 a[152:155], a[120:123], a[56:59], a[152:155]
  s_add_u32 s60, s63, 8192
  buffer_store_dwordx4 v[128:131], v2, s[16:19], s60 offen offset:0 sc1
  v_cvt_pk_bf16_f32 v136, v136, v137
  v_mfma_f32_16x16x32_bf16 a[156:159], a[124:127], a[56:59], a[156:159]
  v_cvt_pk_bf16_f32 v137, v138, v139
  v_cvt_pk_bf16_f32 v138, v140, v141
  v_mfma_f32_16x16x32_bf16 v[160:163], a[96:99], a[44:47], v[160:163]
  v_cvt_pk_bf16_f32 v139, v142, v143
  v_mfma_f32_16x16x32_bf16 v[164:167], a[100:103], a[44:47], v[164:167]
  buffer_load_dwordx4 v59, s[12:15], s47 offen offset:3072 lds
  v_mfma_f32_16x16x32_bf16 a[160:163], a[64:67], a[28:31], a[160:163]
  s_add_u32 m0, s41, 4096
  v_mfma_f32_16x16x32_bf16 a[164:167], a[68:71], a[28:31], a[164:167]
  s_add_u32 s60, s63, 40960
  buffer_store_dwordx4 v[132:135], v2, s[16:19], s60 offen offset:0 sc1
  v_accvgpr_read_b32 v32, a136
  v_mfma_f32_16x16x32_bf16 a[160:163], a[96:99], a[60:63], a[160:163]
  v_accvgpr_read_b32 v33, a137
  v_accvgpr_read_b32 v34, a138
  v_mfma_f32_16x16x32_bf16 a[164:167], a[100:103], a[60:63], a[164:167]
  v_accvgpr_read_b32 v35, a139
  v_accvgpr_read_b32 v36, a140
  v_mfma_f32_16x16x32_bf16 v[168:171], a[72:75], a[12:15], v[168:171]
  buffer_load_dwordx4 v60, s[12:15], s47 offen offset:0 lds
  v_accvgpr_read_b32 v37, a141
  v_mfma_f32_16x16x32_bf16 v[172:175], a[76:79], a[12:15], v[172:175]
  v_accvgpr_read_b32 v38, a142
  v_accvgpr_read_b32 v39, a143
  v_mfma_f32_16x16x32_bf16 v[168:171], a[104:107], a[44:47], v[168:171]
  v_cvt_pk_bf16_f32 v140, v32, v33
  v_cvt_pk_bf16_f32 v141, v34, v35
  v_mfma_f32_16x16x32_bf16 v[172:175], a[108:111], a[44:47], v[172:175]
  v_cvt_pk_bf16_f32 v142, v36, v37
  v_cvt_pk_bf16_f32 v143, v38, v39
  v_mfma_f32_16x16x32_bf16 a[168:171], a[72:75], a[28:31], a[168:171]
  s_add_u32 s60, s63, 8192
  buffer_store_dwordx4 v[136:139], v2, s[16:19], s60 offen offset:1024 sc1
  v_cvt_pk_bf16_f32 v144, v144, v145
  v_mfma_f32_16x16x32_bf16 a[172:175], a[76:79], a[28:31], a[172:175]
  v_cvt_pk_bf16_f32 v145, v146, v147
  v_cvt_pk_bf16_f32 v146, v148, v149
  v_mfma_f32_16x16x32_bf16 a[168:171], a[104:107], a[60:63], a[168:171]
  buffer_load_dwordx4 v61, s[12:15], s47 offen offset:1024 lds
  v_cvt_pk_bf16_f32 v147, v150, v151
  v_mfma_f32_16x16x32_bf16 a[172:175], a[108:111], a[60:63], a[172:175]
  s_add_u32 s60, s63, 40960
  buffer_store_dwordx4 v[140:143], v2, s[16:19], s60 offen offset:1024 sc1
  v_accvgpr_read_b32 v40, a144
  v_mfma_f32_16x16x32_bf16 v[176:179], a[80:83], a[12:15], v[176:179]
  v_accvgpr_read_b32 v41, a145
  v_accvgpr_read_b32 v42, a146
  v_mfma_f32_16x16x32_bf16 v[180:183], a[84:87], a[12:15], v[180:183]
  v_accvgpr_read_b32 v43, a147
  v_accvgpr_read_b32 v44, a148
  v_mfma_f32_16x16x32_bf16 v[176:179], a[112:115], a[44:47], v[176:179]
  v_accvgpr_read_b32 v45, a149
  v_accvgpr_read_b32 v46, a150
  v_mfma_f32_16x16x32_bf16 v[180:183], a[116:119], a[44:47], v[180:183]
  v_accvgpr_read_b32 v47, a151
  v_cvt_pk_bf16_f32 v148, v40, v41
  v_mfma_f32_16x16x32_bf16 a[176:179], a[80:83], a[28:31], a[176:179]
  buffer_load_dwordx4 v62, s[12:15], s47 offen offset:2048 lds
  v_cvt_pk_bf16_f32 v149, v42, v43
  v_mfma_f32_16x16x32_bf16 a[180:183], a[84:87], a[28:31], a[180:183]
  v_cvt_pk_bf16_f32 v150, v44, v45
  v_cvt_pk_bf16_f32 v151, v46, v47
  v_mfma_f32_16x16x32_bf16 a[176:179], a[112:115], a[60:63], a[176:179]
  s_add_u32 s60, s63, 8192
  buffer_store_dwordx4 v[144:147], v2, s[16:19], s60 offen offset:2048 sc1
  v_cvt_pk_bf16_f32 v152, v152, v153
  v_mfma_f32_16x16x32_bf16 a[180:183], a[116:119], a[60:63], a[180:183]
  v_cvt_pk_bf16_f32 v153, v154, v155
  v_cvt_pk_bf16_f32 v154, v156, v157
  v_mfma_f32_16x16x32_bf16 v[184:187], a[88:91], a[12:15], v[184:187]
  v_cvt_pk_bf16_f32 v155, v158, v159
  v_mfma_f32_16x16x32_bf16 v[188:191], a[92:95], a[12:15], v[188:191]
  buffer_load_dwordx4 v63, s[12:15], s47 offen offset:3072 lds
  v_mfma_f32_16x16x32_bf16 v[184:187], a[120:123], a[44:47], v[184:187]
  s_mov_b32 m0, s36
  v_mfma_f32_16x16x32_bf16 v[188:191], a[124:127], a[44:47], v[188:191]
  s_add_u32 s60, s63, 40960
  buffer_store_dwordx4 v[148:151], v2, s[16:19], s60 offen offset:2048 sc1
  v_accvgpr_read_b32 v24, a152
  v_mfma_f32_16x16x32_bf16 a[184:187], a[88:91], a[28:31], a[184:187]
  v_accvgpr_read_b32 v25, a153
  v_accvgpr_read_b32 v26, a154
  v_mfma_f32_16x16x32_bf16 a[188:191], a[92:95], a[28:31], a[188:191]
  v_accvgpr_read_b32 v27, a155
  v_accvgpr_read_b32 v28, a156
  v_mfma_f32_16x16x32_bf16 a[184:187], a[120:123], a[60:63], a[184:187]
  v_accvgpr_read_b32 v29, a157
  v_accvgpr_read_b32 v30, a158
  v_mfma_f32_16x16x32_bf16 a[188:191], a[124:127], a[60:63], a[188:191]
  buffer_load_dwordx4 v48, s[8:11], s46 offen offset:0 lds
  v_accvgpr_read_b32 v31, a159
  v_mfma_f32_16x16x32_bf16 v[192:195], a[64:67], a[16:19], v[192:195]
  v_cvt_pk_bf16_f32 v156, v24, v25
  v_cvt_pk_bf16_f32 v157, v26, v27
  v_mfma_f32_16x16x32_bf16 v[196:199], a[68:71], a[16:19], v[196:199]
  v_cvt_pk_bf16_f32 v158, v28, v29
  v_cvt_pk_bf16_f32 v159, v30, v31
  v_mfma_f32_16x16x32_bf16 v[192:195], a[96:99], a[48:51], v[192:195]
  v_cvt_pk_bf16_f32 v160, v160, v161
  v_cvt_pk_bf16_f32 v161, v162, v163
  v_mfma_f32_16x16x32_bf16 v[196:199], a[100:103], a[48:51], v[196:199]
  v_cvt_pk_bf16_f32 v162, v164, v165
  v_cvt_pk_bf16_f32 v163, v166, v167
  v_mfma_f32_16x16x32_bf16 v[64:67], a[64:67], a[0:3], v[64:67]
  s_add_u32 s60, s63, 8192
  buffer_store_dwordx4 v[152:155], v2, s[16:19], s60 offen offset:3072 sc1
  v_accvgpr_read_b32 v32, a160
  v_mfma_f32_16x16x32_bf16 v[68:71], a[68:71], a[0:3], v[68:71]
  buffer_load_dwordx4 v49, s[8:11], s46 offen offset:1024 lds
  v_accvgpr_read_b32 v33, a161
  v_mfma_f32_16x16x32_bf16 v[64:67], a[96:99], a[32:35], v[64:67]
  v_accvgpr_read_b32 v34, a162
  v_accvgpr_read_b32 v35, a163
  v_mfma_f32_16x16x32_bf16 v[68:71], a[100:103], a[32:35], v[68:71]
  v_accvgpr_read_b32 v36, a164
  v_accvgpr_read_b32 v37, a165
  v_mfma_f32_16x16x32_bf16 v[200:203], a[72:75], a[16:19], v[200:203]
  v_accvgpr_read_b32 v38, a166
  v_accvgpr_read_b32 v39, a167
  v_mfma_f32_16x16x32_bf16 v[204:207], a[76:79], a[16:19], v[204:207]
  v_cvt_pk_bf16_f32 v164, v32, v33
  v_cvt_pk_bf16_f32 v165, v34, v35
  v_mfma_f32_16x16x32_bf16 v[200:203], a[104:107], a[48:51], v[200:203]
  buffer_load_dwordx4 v50, s[8:11], s46 offen offset:2048 lds
  v_cvt_pk_bf16_f32 v166, v36, v37
  v_mfma_f32_16x16x32_bf16 v[204:207], a[108:111], a[48:51], v[204:207]
  v_cvt_pk_bf16_f32 v167, v38, v39
  v_mfma_f32_16x16x32_bf16 v[72:75], a[72:75], a[0:3], v[72:75]
  s_add_u32 s60, s63, 40960
  buffer_store_dwordx4 v[156:159], v2, s[16:19], s60 offen offset:3072 sc1
  v_cvt_pk_bf16_f32 v168, v168, v169
  v_mfma_f32_16x16x32_bf16 v[76:79], a[76:79], a[0:3], v[76:79]
  v_cvt_pk_bf16_f32 v169, v170, v171
  v_cvt_pk_bf16_f32 v170, v172, v173
  v_mfma_f32_16x16x32_bf16 v[72:75], a[104:107], a[32:35], v[72:75]
  v_cvt_pk_bf16_f32 v171, v174, v175
  v_mfma_f32_16x16x32_bf16 v[76:79], a[108:111], a[32:35], v[76:79]
  s_add_u32 s60, s63, 12288
  buffer_store_dwordx4 v[160:163], v2, s[16:19], s60 offen offset:0 sc1
  v_accvgpr_read_b32 v40, a168
  v_mfma_f32_16x16x32_bf16 v[208:211], a[80:83], a[16:19], v[208:211]
  buffer_load_dwordx4 v51, s[8:11], s46 offen offset:3072 lds
  v_accvgpr_read_b32 v41, a169
  v_mfma_f32_16x16x32_bf16 v[212:215], a[84:87], a[16:19], v[212:215]
  s_add_u32 m0, s36, 4096
  v_accvgpr_read_b32 v42, a170
  v_accvgpr_read_b32 v43, a171
  v_mfma_f32_16x16x32_bf16 v[208:211], a[112:115], a[48:51], v[208:211]
  v_accvgpr_read_b32 v44, a172
  v_accvgpr_read_b32 v45, a173
  v_mfma_f32_16x16x32_bf16 v[212:215], a[116:119], a[48:51], v[212:215]
  v_accvgpr_read_b32 v46, a174
  v_accvgpr_read_b32 v47, a175
  v_mfma_f32_16x16x32_bf16 v[80:83], a[80:83], a[0:3], v[80:83]
  v_cvt_pk_bf16_f32 v172, v40, v41
  v_cvt_pk_bf16_f32 v173, v42, v43
  v_mfma_f32_16x16x32_bf16 v[84:87], a[84:87], a[0:3], v[84:87]
  v_cvt_pk_bf16_f32 v174, v44, v45
  v_cvt_pk_bf16_f32 v175, v46, v47
  v_mfma_f32_16x16x32_bf16 v[80:83], a[112:115], a[32:35], v[80:83]
  buffer_load_dwordx4 v52, s[8:11], s46 offen offset:0 lds
  v_mfma_f32_16x16x32_bf16 v[84:87], a[116:119], a[32:35], v[84:87]
  s_add_u32 s60, s63, 45056
  buffer_store_dwordx4 v[164:167], v2, s[16:19], s60 offen offset:0 sc1
  v_cvt_pk_bf16_f32 v176, v176, v177
  v_mfma_f32_16x16x32_bf16 v[216:219], a[88:91], a[16:19], v[216:219]
  v_cvt_pk_bf16_f32 v177, v178, v179
  v_cvt_pk_bf16_f32 v178, v180, v181
  v_mfma_f32_16x16x32_bf16 v[220:223], a[92:95], a[16:19], v[220:223]
  v_cvt_pk_bf16_f32 v179, v182, v183
  v_mfma_f32_16x16x32_bf16 v[216:219], a[120:123], a[48:51], v[216:219]
  s_add_u32 s60, s63, 12288
  buffer_store_dwordx4 v[168:171], v2, s[16:19], s60 offen offset:1024 sc1
  v_accvgpr_read_b32 v24, a176
  v_mfma_f32_16x16x32_bf16 v[220:223], a[124:127], a[48:51], v[220:223]
  buffer_load_dwordx4 v53, s[8:11], s46 offen offset:1024 lds
  v_accvgpr_read_b32 v25, a177
  v_mfma_f32_16x16x32_bf16 v[88:91], a[88:91], a[0:3], v[88:91]
  v_accvgpr_read_b32 v26, a178
  v_accvgpr_read_b32 v27, a179
  v_mfma_f32_16x16x32_bf16 v[92:95], a[92:95], a[0:3], v[92:95]
  v_accvgpr_read_b32 v28, a180
  v_accvgpr_read_b32 v29, a181
  v_mfma_f32_16x16x32_bf16 v[224:227], a[64:67], a[20:23], v[224:227]
  v_accvgpr_read_b32 v30, a182
  v_accvgpr_read_b32 v31, a183
  v_mfma_f32_16x16x32_bf16 v[228:231], a[68:71], a[20:23], v[228:231]
  v_cvt_pk_bf16_f32 v180, v24, v25
  v_cvt_pk_bf16_f32 v181, v26, v27
  v_mfma_f32_16x16x32_bf16 v[96:99], a[64:67], a[4:7], v[96:99]
  v_cvt_pk_bf16_f32 v182, v28, v29
  v_cvt_pk_bf16_f32 v183, v30, v31
  v_mfma_f32_16x16x32_bf16 v[100:103], a[68:71], a[4:7], v[100:103]
  buffer_load_dwordx4 v54, s[8:11], s46 offen offset:2048 lds
  v_mfma_f32_16x16x32_bf16 v[232:235], a[72:75], a[20:23], v[232:235]
  s_add_u32 s60, s63, 45056
  buffer_store_dwordx4 v[172:175], v2, s[16:19], s60 offen offset:1024 sc1
  v_cvt_pk_bf16_f32 v184, v184, v185
  v_mfma_f32_16x16x32_bf16 v[236:239], a[76:79], a[20:23], v[236:239]
  v_cvt_pk_bf16_f32 v185, v186, v187
  v_cvt_pk_bf16_f32 v186, v188, v189
  v_mfma_f32_16x16x32_bf16 v[104:107], a[72:75], a[4:7], v[104:107]
  v_cvt_pk_bf16_f32 v187, v190, v191
  v_accvgpr_read_b32 v32, a184
  v_mfma_f32_16x16x32_bf16 v[108:111], a[76:79], a[4:7], v[108:111]
  v_accvgpr_read_b32 v33, a185
  v_accvgpr_read_b32 v34, a186
  v_mfma_f32_16x16x32_bf16 v[240:243], a[80:83], a[20:23], v[240:243]
  v_accvgpr_read_b32 v35, a187
  v_accvgpr_read_b32 v36, a188
  v_mfma_f32_16x16x32_bf16 v[244:247], a[84:87], a[20:23], v[244:247]
  buffer_load_dwordx4 v55, s[8:11], s46 offen offset:3072 lds
  v_accvgpr_read_b32 v37, a189
  v_mfma_f32_16x16x32_bf16 v[112:115], a[80:83], a[4:7], v[112:115]
  s_sub_u32 s50, s50, 1
  s_cmp_eq_u32 s50, 0
  s_cselect_b32 s12, s72, s12
  s_cselect_b32 s13, s73, s13
  v_mfma_f32_16x16x32_bf16 v[116:119], a[84:87], a[4:7], v[116:119]
  s_lshl_b32 s47, s48, 19
  s_bfe_u32 s34, 0x3020106, s49
  s_add_u32 s48, s48, s34
  v_mfma_f32_16x16x32_bf16 v[248:251], a[88:91], a[20:23], v[248:251]
  s_add_u32 s49, s49, 8
  s_and_b32 s49, s49, 0x8001f
  s_and_b32 s48, s48, 7
  v_mfma_f32_16x16x32_bf16 v[252:255], a[92:95], a[20:23], v[252:255]
  s_lshl_b32 s46, s48, 7
  v_accvgpr_read_b32 v38, a190
  v_accvgpr_read_b32 v39, a191
  v_mfma_f32_16x16x32_bf16 v[120:123], a[88:91], a[4:7], v[120:123]
  v_cvt_pk_bf16_f32 v188, v32, v33
  v_cvt_pk_bf16_f32 v189, v34, v35
  v_mfma_f32_16x16x32_bf16 v[124:127], a[92:95], a[4:7], v[124:127]
  v_cvt_pk_bf16_f32 v190, v36, v37
  v_cvt_pk_bf16_f32 v191, v38, v39
  v_mfma_f32_16x16x32_bf16 v[88:91], a[120:123], a[32:35], v[88:91]
  ds_read_b128 a[0:3], v16 offset:0
  ds_read_b64_tr_b16 a[64:65], v18 offset:0
  v_mfma_f32_16x16x32_bf16 v[92:95], a[124:127], a[32:35], v[92:95]
  ds_read_b64_tr_b16 a[66:67], v18 offset:2048
  ds_read_b128 a[4:7], v16 offset:2048
  v_mfma_f32_16x16x32_bf16 v[224:227], a[96:99], a[52:55], v[224:227]
  ds_read_b128 a[8:11], v16 offset:4096
  ds_read_b128 a[12:15], v16 offset:6144
  v_mfma_f32_16x16x32_bf16 v[228:231], a[100:103], a[52:55], v[228:231]
  ds_read_b128 a[16:19], v16 offset:8192
  ds_read_b128 a[20:23], v16 offset:10240
  v_mfma_f32_16x16x32_bf16 v[96:99], a[96:99], a[36:39], v[96:99]
  ds_read_b128 a[24:27], v16 offset:12288
  ds_read_b128 a[28:31], v16 offset:14336
  v_mfma_f32_16x16x32_bf16 v[100:103], a[100:103], a[36:39], v[100:103]
  ds_read_b64_tr_b16 a[68:69], v19 offset:0
  ds_read_b64_tr_b16 a[70:71], v19 offset:2048
  v_mfma_f32_16x16x32_bf16 v[232:235], a[104:107], a[52:55], v[232:235]
  ds_read_b64_tr_b16 a[72:73], v20 offset:0
  ds_read_b64_tr_b16 a[74:75], v20 offset:2048
  v_mfma_f32_16x16x32_bf16 v[236:239], a[108:111], a[52:55], v[236:239]
  ds_read_b64_tr_b16 a[76:77], v21 offset:0
  ds_read_b64_tr_b16 a[78:79], v21 offset:2048
  v_mfma_f32_16x16x32_bf16 v[104:107], a[104:107], a[36:39], v[104:107]
  ds_read_b64_tr_b16 a[80:81], v18 offset:8192
  ds_read_b64_tr_b16 a[82:83], v18 offset:10240
  v_mfma_f32_16x16x32_bf16 v[108:111], a[108:111], a[36:39], v[108:111]
  ds_read_b64_tr_b16 a[84:85], v19 offset:8192
  ds_read_b64_tr_b16 a[86:87], v19 offset:10240
  v_mfma_f32_16x16x32_bf16 v[240:243], a[112:115], a[52:55], v[240:243]
  ds_read_b64_tr_b16 a[88:89], v20 offset:8192
  ds_read_b64_tr_b16 a[90:91], v20 offset:10240
  v_mfma_f32_16x16x32_bf16 v[244:247], a[116:119], a[52:55], v[244:247]
  ds_read_b64_tr_b16 a[92:93], v21 offset:8192
  ds_read_b64_tr_b16 a[94:95], v21 offset:10240
  v_mfma_f32_16x16x32_bf16 v[112:115], a[112:115], a[36:39], v[112:115]
  v_cvt_pk_bf16_f32 v192, v192, v193
  v_cvt_pk_bf16_f32 v193, v194, v195
  v_mfma_f32_16x16x32_bf16 v[116:119], a[116:119], a[36:39], v[116:119]
  v_cvt_pk_bf16_f32 v194, v196, v197
  v_cvt_pk_bf16_f32 v195, v198, v199
  v_mfma_f32_16x16x32_bf16 v[248:251], a[120:123], a[52:55], v[248:251]
  v_cvt_pk_bf16_f32 v196, v64, v65
  v_cvt_pk_bf16_f32 v197, v66, v67
  v_mfma_f32_16x16x32_bf16 v[252:255], a[124:127], a[52:55], v[252:255]
  v_cvt_pk_bf16_f32 v198, v68, v69
  v_cvt_pk_bf16_f32 v199, v70, v71
  v_mfma_f32_16x16x32_bf16 v[120:123], a[120:123], a[36:39], v[120:123]
  v_cvt_pk_bf16_f32 v200, v200, v201
  v_cvt_pk_bf16_f32 v201, v202, v203
  v_mfma_f32_16x16x32_bf16 v[124:127], a[124:127], a[36:39], v[124:127]
  v_cvt_pk_bf16_f32 v202, v204, v205
  v_cvt_pk_bf16_f32 v203, v206, v207
  s_waitcnt lgkmcnt(0)
  v_mfma_f32_16x16x32_bf16 a[128:131], a[24:27], a[64:67], 0
  ds_read_b128 a[32:35], v17 offset:0
  ds_read_b64_tr_b16 a[96:97], v18 offset:4096
  v_mfma_f32_16x16x32_bf16 a[132:135], a[24:27], a[68:71], 0
  ds_read_b64_tr_b16 a[98:99], v18 offset:6144
  ds_read_b128 a[36:39], v17 offset:2048
  v_mfma_f32_16x16x32_bf16 a[136:139], a[24:27], a[72:75], 0
  ds_read_b128 a[40:43], v17 offset:4096
  ds_read_b128 a[44:47], v17 offset:6144
  v_mfma_f32_16x16x32_bf16 a[140:143], a[24:27], a[76:79], 0
  ds_read_b128 a[48:51], v17 offset:8192
  ds_read_b128 a[52:55], v17 offset:10240
  v_mfma_f32_16x16x32_bf16 a[144:147], a[24:27], a[80:83], 0
  ds_read_b128 a[56:59], v17 offset:12288
  ds_read_b128 a[60:63], v17 offset:14336
  v_mfma_f32_16x16x32_bf16 a[148:151], a[24:27], a[84:87], 0
  ds_read_b64_tr_b16 a[100:101], v19 offset:4096
  ds_read_b64_tr_b16 a[102:103], v19 offset:6144
  v_mfma_f32_16x16x32_bf16 a[152:155], a[24:27], a[88:91], 0
  ds_read_b64_tr_b16 a[104:105], v20 offset:4096
  v_cvt_pk_bf16_f32 v204, v72, v73
  v_mfma_f32_16x16x32_bf16 a[156:159], a[24:27], a[92:95], 0
  ds_read_b64_tr_b16 a[106:107], v20 offset:6144
  ds_read_b64_tr_b16 a[108:109], v21 offset:4096
  v_mfma_f32_16x16x32_bf16 a[160:163], a[28:31], a[64:67], 0
  ds_read_b64_tr_b16 a[110:111], v21 offset:6144
  ds_read_b64_tr_b16 a[112:113], v18 offset:12288
  v_mfma_f32_16x16x32_bf16 a[164:167], a[28:31], a[68:71], 0
  ds_read_b64_tr_b16 a[114:115], v18 offset:14336
  ds_read_b64_tr_b16 a[116:117], v19 offset:12288
  v_mfma_f32_16x16x32_bf16 a[168:171], a[28:31], a[72:75], 0
  ds_read_b64_tr_b16 a[118:119], v19 offset:14336
  ds_read_b64_tr_b16 a[120:121], v20 offset:12288
  v_mfma_f32_16x16x32_bf16 a[172:175], a[28:31], a[76:79], 0
  ds_read_b64_tr_b16 a[122:123], v20 offset:14336
  ds_read_b64_tr_b16 a[124:125], v21 offset:12288
  v_mfma_f32_16x16x32_bf16 a[176:179], a[28:31], a[80:83], 0
  ds_read_b64_tr_b16 a[126:127], v21 offset:14336
  v_cvt_pk_bf16_f32 v205, v74, v75
  v_mfma_f32_16x16x32_bf16 a[180:183], a[28:31], a[84:87], 0
  v_cvt_pk_bf16_f32 v206, v76, v77
  v_cvt_pk_bf16_f32 v207, v78, v79
  v_mfma_f32_16x16x32_bf16 a[184:187], a[28:31], a[88:91], 0
  v_cvt_pk_bf16_f32 v208, v208, v209
  v_cvt_pk_bf16_f32 v209, v210, v211
  v_mfma_f32_16x16x32_bf16 a[188:191], a[28:31], a[92:95], 0
  v_cvt_pk_bf16_f32 v210, v212, v213
  v_cvt_pk_bf16_f32 v211, v214, v215
  v_mfma_f32_16x16x32_bf16 v[128:131], a[8:11], a[64:67], 0
  v_cvt_pk_bf16_f32 v212, v80, v81
  v_cvt_pk_bf16_f32 v213, v82, v83
  v_mfma_f32_16x16x32_bf16 v[132:135], a[8:11], a[68:71], 0
  v_cvt_pk_bf16_f32 v214, v84, v85
  v_cvt_pk_bf16_f32 v215, v86, v87
  v_mfma_f32_16x16x32_bf16 v[136:139], a[8:11], a[72:75], 0
  v_cvt_pk_bf16_f32 v216, v216, v217
  v_cvt_pk_bf16_f32 v217, v218, v219
  v_mfma_f32_16x16x32_bf16 v[140:143], a[8:11], a[76:79], 0
  s_add_u32 s36, s36, s38
  s_add_u32 s37, s37, 1
  s_cmp_eq_u32 s37, 3
  s_cselect_b32 s37, 0, s37
  s_cselect_b32 s38, s39, s40
  v_add_u32 v16, s38, v16
  v_add_u32 v17, s38, v17
  s_add_u32 s41, s41, s43
  s_sub_u32 s43, 0, s43
  v_add_u32 v18, s43, v18
  v_add_u32 v19, s43, v19
  v_add_u32 v20, s43, v20
  v_add_u32 v21, s43, v21
  s_waitcnt vmcnt(8) lgkmcnt(0)
  s_barrier
  v_mfma_f32_16x16x32_bf16 a[128:131], a[56:59], a[96:99], a[128:131]
  s_mov_b32 m0, s41
  v_cvt_pk_bf16_f32 v218, v220, v221
  v_cvt_pk_bf16_f32 v219, v222, v223
  v_mfma_f32_16x16x32_bf16 a[132:135], a[56:59], a[100:103], a[132:135]
  v_cvt_pk_bf16_f32 v220, v88, v89
  v_cvt_pk_bf16_f32 v221, v90, v91
  v_mfma_f32_16x16x32_bf16 a[136:139], a[56:59], a[104:107], a[136:139]
  v_cvt_pk_bf16_f32 v222, v92, v93
  v_cvt_pk_bf16_f32 v223, v94, v95
  v_mfma_f32_16x16x32_bf16 a[140:143], a[56:59], a[108:111], a[140:143]
  v_cvt_pk_bf16_f32 v224, v224, v225
  v_cvt_pk_bf16_f32 v225, v226, v227
  v_mfma_f32_16x16x32_bf16 a[144:147], a[56:59], a[112:115], a[144:147]
  v_cvt_pk_bf16_f32 v226, v228, v229
  v_cvt_pk_bf16_f32 v227, v230, v231
  v_mfma_f32_16x16x32_bf16 a[148:151], a[56:59], a[116:119], a[148:151]
  v_cvt_pk_bf16_f32 v228, v96, v97
  v_cvt_pk_bf16_f32 v229, v98, v99
  v_mfma_f32_16x16x32_bf16 a[152:155], a[56:59], a[120:123], a[152:155]
  v_cvt_pk_bf16_f32 v230, v100, v101
  v_cvt_pk_bf16_f32 v231, v102, v103
  v_mfma_f32_16x16x32_bf16 a[156:159], a[56:59], a[124:127], a[156:159]
  v_cvt_pk_bf16_f32 v232, v232, v233
  v_cvt_pk_bf16_f32 v233, v234, v235
  v_mfma_f32_16x16x32_bf16 a[160:163], a[60:63], a[96:99], a[160:163]
  v_cvt_pk_bf16_f32 v234, v236, v237
  v_cvt_pk_bf16_f32 v235, v238, v239
  v_mfma_f32_16x16x32_bf16 a[164:167], a[60:63], a[100:103], a[164:167]
  v_cvt_pk_bf16_f32 v236, v104, v105
  v_cvt_pk_bf16_f32 v237, v106, v107
  v_mfma_f32_16x16x32_bf16 a[168:171], a[60:63], a[104:107], a[168:171]
  v_cvt_pk_bf16_f32 v238, v108, v109
  v_cvt_pk_bf16_f32 v239, v110, v111
  v_mfma_f32_16x16x32_bf16 a[172:175], a[60:63], a[108:111], a[172:175]
  v_cvt_pk_bf16_f32 v240, v240, v241
  v_cvt_pk_bf16_f32 v241, v242, v243
  v_mfma_f32_16x16x32_bf16 a[176:179], a[60:63], a[112:115], a[176:179]
  v_cvt_pk_bf16_f32 v242, v244, v245
  v_cvt_pk_bf16_f32 v243, v246, v247
  v_mfma_f32_16x16x32_bf16 a[180:183], a[60:63], a[116:119], a[180:183]
  v_cvt_pk_bf16_f32 v244, v112, v113
  v_cvt_pk_bf16_f32 v245, v114, v115
  v_mfma_f32_16x16x32_bf16 a[184:187], a[60:63], a[120:123], a[184:187]
  v_cvt_pk_bf16_f32 v246, v116, v117
  v_cvt_pk_bf16_f32 v247, v118, v119
  v_mfma_f32_16x16x32_bf16 a[188:191], a[60:63], a[124:127], a[188:191]
  v_cvt_pk_bf16_f32 v248, v248, v249
  v_cvt_pk_bf16_f32 v249, v250, v251
  v_mfma_f32_16x16x32_bf16 v[128:131], a[40:43], a[96:99], v[128:131]
  v_cvt_pk_bf16_f32 v250, v252, v253
  v_cvt_pk_bf16_f32 v251, v254, v255
  v_mfma_f32_16x16x32_bf16 v[132:135], a[40:43], a[100:103], v[132:135]
  v_cvt_pk_bf16_f32 v252, v120, v121
  v_cvt_pk_bf16_f32 v253, v122, v123
  v_mfma_f32_16x16x32_bf16 v[136:139], a[40:43], a[104:107], v[136:139]
  v_cvt_pk_bf16_f32 v254, v124, v125
  v_cvt_pk_bf16_f32 v255, v126, v127
  v_mfma_f32_16x16x32_bf16 v[140:143], a[40:43], a[108:111], v[140:143]
  s_add_u32 s60, s63, 12288
  buffer_store_dwordx4 v[176:179], v2, s[16:19], s60 offen offset:2048 sc1
  v_mfma_f32_16x16x32_bf16 v[144:147], a[8:11], a[80:83], 0
  s_add_u32 s60, s63, 45056
  buffer_store_dwordx4 v[180:183], v2, s[16:19], s60 offen offset:2048 sc1
  v_mfma_f32_16x16x32_bf16 v[148:151], a[8:11], a[84:87], 0
  s_add_u32 s60, s63, 12288
  buffer_store_dwordx4 v[184:187], v2, s[16:19], s60 offen offset:3072 sc1
  v_mfma_f32_16x16x32_bf16 v[144:147], a[40:43], a[112:115], v[144:147]
  s_add_u32 s60, s63, 45056
  buffer_store_dwordx4 v[188:191], v2, s[16:19], s60 offen offset:3072 sc1
  v_mfma_f32_16x16x32_bf16 v[148:151], a[40:43], a[116:119], v[148:151]
  s_add_u32 s60, s63, 32768
  buffer_store_dwordx4 v[192:195], v2, s[16:19], s60 offen offset:0 sc1
  v_mfma_f32_16x16x32_bf16 v[152:155], a[8:11], a[88:91], 0
  s_add_u32 s60, s63, 0
  buffer_store_dwordx4 v[196:199], v2, s[16:19], s60 offen offset:0 sc1
  v_mfma_f32_16x16x32_bf16 v[156:159], a[8:11], a[92:95], 0
  buffer_load_dwordx4 v56, s[12:15], s47 offen offset:0 lds
  v_mfma_f32_16x16x32_bf16 v[152:155], a[40:43], a[120:123], v[152:155]
  s_add_u32 s60, s63, 32768
  buffer_store_dwordx4 v[200:203], v2, s[16:19], s60 offen offset:1024 sc1
  v_mfma_f32_16x16x32_bf16 v[156:159], a[40:43], a[124:127], v[156:159]
  buffer_load_dwordx4 v57, s[12:15], s47 offen offset:1024 lds
  v_mfma_f32_16x16x32_bf16 v[160:163], a[12:15], a[64:67], 0
  buffer_load_dwordx4 v58, s[12:15], s47 offen offset:2048 lds
  v_mfma_f32_16x16x32_bf16 v[164:167], a[12:15], a[68:71], 0
  buffer_load_dwordx4 v59, s[12:15], s47 offen offset:3072 lds
  v_mfma_f32_16x16x32_bf16 v[160:163], a[44:47], a[96:99], v[160:163]
  s_add_u32 m0, s41, 4096
  v_mfma_f32_16x16x32_bf16 v[164:167], a[44:47], a[100:103], v[164:167]
  s_add_u32 s60, s63, 0
  buffer_store_dwordx4 v[204:207], v2, s[16:19], s60 offen offset:1024 sc1
  v_mfma_f32_16x16x32_bf16 v[168:171], a[12:15], a[72:75], 0
  buffer_load_dwordx4 v60, s[12:15], s47 offen offset:0 lds
  v_mfma_f32_16x16x32_bf16 v[172:175], a[12:15], a[76:79], 0
  buffer_load_dwordx4 v61, s[12:15], s47 offen offset:1024 lds
  v_mfma_f32_16x16x32_bf16 v[168:171], a[44:47], a[104:107], v[168:171]
  buffer_load_dwordx4 v62, s[12:15], s47 offen offset:2048 lds
  v_mfma_f32_16x16x32_bf16 v[172:175], a[44:47], a[108:111], v[172:175]
  s_add_u32 s60, s63, 32768
  buffer_store_dwordx4 v[208:211], v2, s[16:19], s60 offen offset:2048 sc1
  v_mfma_f32_16x16x32_bf16 v[64:67], a[0:3], a[64:67], 0
  v_mfma_f32_16x16x32_bf16 v[68:71], a[0:3], a[68:71], 0
  v_mfma_f32_16x16x32_bf16 v[64:67], a[32:35], a[96:99], v[64:67]
  buffer_load_dwordx4 v63, s[12:15], s47 offen offset:3072 lds
  v_mfma_f32_16x16x32_bf16 v[68:71], a[32:35], a[100:103], v[68:71]
  s_add_u32 s60, s63, 0
  buffer_store_dwordx4 v[212:215], v2, s[16:19], s60 offen offset:2048 sc1
  s_mov_b32 m0, s36
  s_nop 0
  buffer_load_dwordx4 v48, s[8:11], s46 offen offset:0 lds
  buffer_load_dwordx4 v49, s[8:11], s46 offen offset:1024 lds
  buffer_load_dwordx4 v50, s[8:11], s46 offen offset:2048 lds
  buffer_load_dwordx4 v51, s[8:11], s46 offen offset:3072 lds
  v_mfma_f32_16x16x32_bf16 v[72:75], a[0:3], a[72:75], 0
  s_add_u32 m0, s36, 4096
  v_mfma_f32_16x16x32_bf16 v[76:79], a[0:3], a[76:79], 0
  v_mfma_f32_16x16x32_bf16 v[72:75], a[32:35], a[104:107], v[72:75]
  v_mfma_f32_16x16x32_bf16 v[76:79], a[32:35], a[108:111], v[76:79]
  v_mfma_f32_16x16x32_bf16 v[80:83], a[0:3], a[80:83], 0
  s_add_u32 s60, s63, 32768
  buffer_store_dwordx4 v[216:219], v2, s[16:19], s60 offen offset:3072 sc1
  v_mfma_f32_16x16x32_bf16 v[84:87], a[0:3], a[84:87], 0
  v_mfma_f32_16x16x32_bf16 v[80:83], a[32:35], a[112:115], v[80:83]
  v_mfma_f32_16x16x32_bf16 v[84:87], a[32:35], a[116:119], v[84:87]
  v_mfma_f32_16x16x32_bf16 v[88:91], a[0:3], a[88:91], 0
  s_add_u32 s60, s63, 0
  buffer_store_dwordx4 v[220:223], v2, s[16:19], s60 offen offset:3072 sc1
  v_mfma_f32_16x16x32_bf16 v[92:95], a[0:3], a[92:95], 0
  v_mfma_f32_16x16x32_bf16 v[88:91], a[32:35], a[120:123], v[88:91]
  v_mfma_f32_16x16x32_bf16 v[92:95], a[32:35], a[124:127], v[92:95]
  v_mfma_f32_16x16x32_bf16 v[96:99], a[4:7], a[64:67], 0
  s_add_u32 s60, s63, 36864
  buffer_store_dwordx4 v[224:227], v2, s[16:19], s60 offen offset:0 sc1
  v_mfma_f32_16x16x32_bf16 v[100:103], a[4:7], a[68:71], 0
  v_mfma_f32_16x16x32_bf16 v[96:99], a[36:39], a[96:99], v[96:99]
  v_mfma_f32_16x16x32_bf16 v[100:103], a[36:39], a[100:103], v[100:103]
  v_mfma_f32_16x16x32_bf16 v[104:107], a[4:7], a[72:75], 0
  s_add_u32 s60, s63, 4096
  buffer_store_dwordx4 v[228:231], v2, s[16:19], s60 offen offset:0 sc1
  v_mfma_f32_16x16x32_bf16 v[108:111], a[4:7], a[76:79], 0
  v_mfma_f32_16x16x32_bf16 v[104:107], a[36:39], a[104:107], v[104:107]
  v_mfma_f32_16x16x32_bf16 v[108:111], a[36:39], a[108:111], v[108:111]
  v_mfma_f32_16x16x32_bf16 v[112:115], a[4:7], a[80:83], 0
  v_mfma_f32_16x16x32_bf16 v[116:119], a[4:7], a[84:87], 0
  s_add_u32 s60, s63, 36864
  buffer_store_dwordx4 v[232:235], v2, s[16:19], s60 offen offset:1024 sc1
  v_mfma_f32_16x16x32_bf16 v[112:115], a[36:39], a[112:115], v[112:115]
  v_mfma_f32_16x16x32_bf16 v[116:119], a[36:39], a[116:119], v[116:119]
  v_mfma_f32_16x16x32_bf16 v[120:123], a[4:7], a[88:91], 0
  v_mfma_f32_16x16x32_bf16 v[124:127], a[4:7], a[92:95], 0
  s_add_u32 s60, s63, 4096
  buffer_store_dwordx4 v[236:239], v2, s[16:19], s60 offen offset:1024 sc1
  v_mfma_f32_16x16x32_bf16 v[120:123], a[36:39], a[120:123], v[120:123]
  buffer_load_dwordx4 v52, s[8:11], s46 offen offset:0 lds
  v_mfma_f32_16x16x32_bf16 v[124:127], a[36:39], a[124:127], v[124:127]
  v_mfma_f32_16x16x32_bf16 v[176:179], a[12:15], a[80:83], 0
  v_mfma_f32_16x16x32_bf16 v[180:183], a[12:15], a[84:87], 0
  s_add_u32 s60, s63, 36864
  buffer_store_dwordx4 v[240:243], v2, s[16:19], s60 offen offset:2048 sc1
  v_mfma_f32_16x16x32_bf16 v[176:179], a[44:47], a[112:115], v[176:179]
  v_mfma_f32_16x16x32_bf16 v[180:183], a[44:47], a[116:119], v[180:183]
  v_mfma_f32_16x16x32_bf16 v[184:187], a[12:15], a[88:91], 0
  buffer_load_dwordx4 v53, s[8:11], s46 offen offset:1024 lds
  v_mfma_f32_16x16x32_bf16 v[188:191], a[12:15], a[92:95], 0
  v_mfma_f32_16x16x32_bf16 v[192:195], a[16:19], a[64:67], 0
  s_add_u32 s60, s63, 4096
  buffer_store_dwordx4 v[244:247], v2, s[16:19], s60 offen offset:2048 sc1
  v_mfma_f32_16x16x32_bf16 v[196:199], a[16:19], a[68:71], 0
  v_mfma_f32_16x16x32_bf16 v[200:203], a[16:19], a[72:75], 0
  v_mfma_f32_16x16x32_bf16 v[204:207], a[16:19], a[76:79], 0
  buffer_load_dwordx4 v54, s[8:11], s46 offen offset:2048 lds
  v_mfma_f32_16x16x32_bf16 v[208:211], a[16:19], a[80:83], 0
  s_add_u32 s60, s63, 36864
  buffer_store_dwordx4 v[248:251], v2, s[16:19], s60 offen offset:3072 sc1
  v_mfma_f32_16x16x32_bf16 v[212:215], a[16:19], a[84:87], 0
  v_mfma_f32_16x16x32_bf16 v[216:219], a[16:19], a[88:91], 0
  v_mfma_f32_16x16x32_bf16 v[220:223], a[16:19], a[92:95], 0
  v_mfma_f32_16x16x32_bf16 v[224:227], a[20:23], a[64:67], 0
  s_add_u32 s60, s63, 4096
  buffer_store_dwordx4 v[252:255], v2, s[16:19], s60 offen offset:3072 sc1
  v_mfma_f32_16x16x32_bf16 v[228:231], a[20:23], a[68:71], 0
  buffer_load_dwordx4 v55, s[8:11], s46 offen offset:3072 lds
  v_mfma_f32_16x16x32_bf16 v[232:235], a[20:23], a[72:75], 0
  s_sub_u32 s50, s50, 1
  s_cmp_eq_u32 s50, 0
  s_cselect_b32 s12, s72, s12
  s_cselect_b32 s13, s73, s13
  v_mfma_f32_16x16x32_bf16 v[236:239], a[20:23], a[76:79], 0
  s_lshl_b32 s47, s48, 19
  s_bfe_u32 s34, 0x3020106, s49
  s_add_u32 s48, s48, s34
  v_mfma_f32_16x16x32_bf16 v[240:243], a[20:23], a[80:83], 0
  s_add_u32 s49, s49, 8
  s_and_b32 s49, s49, 0x8001f
  s_and_b32 s48, s48, 7
  v_mfma_f32_16x16x32_bf16 v[244:247], a[20:23], a[84:87], 0
  s_lshl_b32 s46, s48, 7
  v_mfma_f32_16x16x32_bf16 v[248:251], a[20:23], a[88:91], 0
  v_mfma_f32_16x16x32_bf16 v[252:255], a[20:23], a[92:95], 0
  v_mfma_f32_16x16x32_bf16 v[184:187], a[44:47], a[120:123], v[184:187]
  ds_read_b128 a[0:3], v16 offset:0
  ds_read_b64_tr_b16 a[64:65], v18 offset:0
  v_mfma_f32_16x16x32_bf16 v[188:191], a[44:47], a[124:127], v[188:191]
  ds_read_b64_tr_b16 a[66:67], v18 offset:2048
  ds_read_b128 a[4:7], v16 offset:2048
  v_mfma_f32_16x16x32_bf16 v[192:195], a[48:51], a[96:99], v[192:195]
  ds_read_b128 a[8:11], v16 offset:4096
  ds_read_b128 a[12:15], v16 offset:6144
  v_mfma_f32_16x16x32_bf16 v[196:199], a[48:51], a[100:103], v[196:199]
  ds_read_b128 a[16:19], v16 offset:8192
  ds_read_b128 a[20:23], v16 offset:10240
  v_mfma_f32_16x16x32_bf16 v[200:203], a[48:51], a[104:107], v[200:203]
  ds_read_b128 a[24:27], v16 offset:12288
  ds_read_b128 a[28:31], v16 offset:14336
  v_mfma_f32_16x16x32_bf16 v[204:207], a[48:51], a[108:111], v[204:207]
  ds_read_b64_tr_b16 a[68:69], v19 offset:0
  ds_read_b64_tr_b16 a[70:71], v19 offset:2048
  v_mfma_f32_16x16x32_bf16 v[208:211], a[48:51], a[112:115], v[208:211]
  ds_read_b64_tr_b16 a[72:73], v20 offset:0
  ds_read_b64_tr_b16 a[74:75], v20 offset:2048
  v_mfma_f32_16x16x32_bf16 v[212:215], a[48:51], a[116:119], v[212:215]
  ds_read_b64_tr_b16 a[76:77], v21 offset:0
  ds_read_b64_tr_b16 a[78:79], v21 offset:2048
  v_mfma_f32_16x16x32_bf16 v[216:219], a[48:51], a[120:123], v[216:219]
  ds_read_b64_tr_b16 a[80:81], v18 offset:8192
  ds_read_b64_tr_b16 a[82:83], v18 offset:10240
  v_mfma_f32_16x16x32_bf16 v[220:223], a[48:51], a[124:127], v[220:223]
  ds_read_b64_tr_b16 a[84:85], v19 offset:8192
  ds_read_b64_tr_b16 a[86:87], v19 offset:10240
  v_mfma_f32_16x16x32_bf16 v[224:227], a[52:55], a[96:99], v[224:227]
  ds_read_b64_tr_b16 a[88:89], v20 offset:8192
  ds_read_b64_tr_b16 a[90:91], v20 offset:10240
  v_mfma_f32_16x16x32_bf16 v[228:231], a[52:55], a[100:103], v[228:231]
  ds_read_b64_tr_b16 a[92:93], v21 offset:8192
  ds_read_b64_tr_b16 a[94:95], v21 offset:10240
  v_mfma_f32_16x16x32_bf16 v[232:235], a[52:55], a[104:107], v[232:235]
  v_mfma_f32_16x16x32_bf16 v[236:239], a[52:55], a[108:111], v[236:239]
  v_mfma_f32_16x16x32_bf16 v[240:243], a[52:55], a[112:115], v[240:243]
  v_mfma_f32_16x16x32_bf16 v[244:247], a[52:55], a[116:119], v[244:247]
  v_mfma_f32_16x16x32_bf16 v[248:251], a[52:55], a[120:123], v[248:251]
  v_mfma_f32_16x16x32_bf16 v[252:255], a[52:55], a[124:127], v[252:255]
  s_add_u32 s63, s63, 0x4000
  s_waitcnt lgkmcnt(0)
  v_mfma_f32_16x16x32_bf16 v[64:67], a[0:3], a[64:67], v[64:67]
  s_add_u32 s36, s36, s38
  s_add_u32 s37, s37, 1
  ds_read_b128 a[32:35], v17 offset:0
  v_mfma_f32_16x16x32_bf16 v[96:99], a[4:7], a[64:67], v[96:99]
  s_cmp_eq_u32 s37, 3
  s_cselect_b32 s37, 0, s37
  s_cselect_b32 s38, s39, s40
  v_mfma_f32_16x16x32_bf16 v[128:131], a[8:11], a[64:67], v[128:131]
  s_add_u32 s41, s41, s43
  s_sub_u32 s43, 0, s43
  ds_read_b64_tr_b16 a[96:97], v18 offset:4096
  v_mfma_f32_16x16x32_bf16 v[160:163], a[12:15], a[64:67], v[160:163]
  v_mfma_f32_16x16x32_bf16 v[192:195], a[16:19], a[64:67], v[192:195]
  ds_read_b64_tr_b16 a[98:99], v18 offset:6144
  v_mfma_f32_16x16x32_bf16 v[224:227], a[20:23], a[64:67], v[224:227]
  v_mfma_f32_16x16x32_bf16 a[128:131], a[24:27], a[64:67], a[128:131]
  ds_read_b128 a[36:39], v17 offset:2048
  v_mfma_f32_16x16x32_bf16 a[160:163], a[28:31], a[64:67], a[160:163]
  v_mfma_f32_16x16x32_bf16 v[68:71], a[0:3], a[68:71], v[68:71]
  v_mfma_f32_16x16x32_bf16 v[100:103], a[4:7], a[68:71], v[100:103]
  ds_read_b128 a[40:43], v17 offset:4096
  v_mfma_f32_16x16x32_bf16 v[132:135], a[8:11], a[68:71], v[132:135]
  v_mfma_f32_16x16x32_bf16 v[164:167], a[12:15], a[68:71], v[164:167]
  ds_read_b128 a[44:47], v17 offset:6144
  v_mfma_f32_16x16x32_bf16 v[196:199], a[16:19], a[68:71], v[196:199]
  v_mfma_f32_16x16x32_bf16 v[228:231], a[20:23], a[68:71], v[228:231]
  ds_read_b128 a[48:51], v17 offset:8192
  v_mfma_f32_16x16x32_bf16 a[132:135], a[24:27], a[68:71], a[132:135]
  v_mfma_f32_16x16x32_bf16 a[164:167], a[28:31], a[68:71], a[164:167]
  ds_read_b128 a[52:55], v17 offset:10240
  v_mfma_f32_16x16x32_bf16 v[72:75], a[0:3], a[72:75], v[72:75]
  v_mfma_f32_16x16x32_bf16 v[104:107], a[4:7], a[72:75], v[104:107]
  v_mfma_f32_16x16x32_bf16 v[136:139], a[8:11], a[72:75], v[136:139]
  ds_read_b128 a[56:59], v17 offset:12288
  v_mfma_f32_16x16x32_bf16 v[168:171], a[12:15], a[72:75], v[168:171]
  v_mfma_f32_16x16x32_bf16 v[200:203], a[16:19], a[72:75], v[200:203]
  ds_read_b128 a[60:63], v17 offset:14336
  v_mfma_f32_16x16x32_bf16 v[232:235], a[20:23], a[72:75], v[232:235]
  v_mfma_f32_16x16x32_bf16 a[136:139], a[24:27], a[72:75], a[136:139]
  ds_read_b64_tr_b16 a[100:101], v19 offset:4096
  v_mfma_f32_16x16x32_bf16 a[168:171], a[28:31], a[72:75], a[168:171]
  v_mfma_f32_16x16x32_bf16 v[76:79], a[0:3], a[76:79], v[76:79]
  ds_read_b64_tr_b16 a[102:103], v19 offset:6144
  v_mfma_f32_16x16x32_bf16 v[108:111], a[4:7], a[76:79], v[108:111]
  v_mfma_f32_16x16x32_bf16 v[140:143], a[8:11], a[76:79], v[140:143]
  v_mfma_f32_16x16x32_bf16 v[172:175], a[12:15], a[76:79], v[172:175]
  ds_read_b64_tr_b16 a[104:105], v20 offset:4096
  v_mfma_f32_16x16x32_bf16 v[204:207], a[16:19], a[76:79], v[204:207]
  v_mfma_f32_16x16x32_bf16 v[236:239], a[20:23], a[76:79], v[236:239]
  ds_read_b64_tr_b16 a[106:107], v20 offset:6144
  v_mfma_f32_16x16x32_bf16 a[140:143], a[24:27], a[76:79], a[140:143]
  v_mfma_f32_16x16x32_bf16 a[172:175], a[28:31], a[76:79], a[172:175]
  ds_read_b64_tr_b16 a[108:109], v21 offset:4096
  v_mfma_f32_16x16x32_bf16 v[80:83], a[0:3], a[80:83], v[80:83]
  v_mfma_f32_16x16x32_bf16 v[112:115], a[4:7], a[80:83], v[112:115]
  ds_read_b64_tr_b16 a[110:111], v21 offset:6144
  v_mfma_f32_16x16x32_bf16 v[144:147], a[8:11], a[80:83], v[144:147]
  v_mfma_f32_16x16x32_bf16 v[176:179], a[12:15], a[80:83], v[176:179]
  v_mfma_f32_16x16x32_bf16 v[208:211], a[16:19], a[80:83], v[208:211]
  ds_read_b64_tr_b16 a[112:113], v18 offset:12288
  v_mfma_f32_16x16x32_bf16 v[240:243], a[20:23], a[80:83], v[240:243]
  v_mfma_f32_16x16x32_bf16 a[144:147], a[24:27], a[80:83], a[144:147]
  ds_read_b64_tr_b16 a[114:115], v18 offset:14336
  v_mfma_f32_16x16x32_bf16 a[176:179], a[28:31], a[80:83], a[176:179]
  v_mfma_f32_16x16x32_bf16 v[84:87], a[0:3], a[84:87], v[84:87]
  ds_read_b64_tr_b16 a[116:117], v19 offset:12288
  v_mfma_f32_16x16x32_bf16 v[116:119], a[4:7], a[84:87], v[116:119]
  v_mfma_f32_16x16x32_bf16 v[148:151], a[8:11], a[84:87], v[148:151]
  ds_read_b64_tr_b16 a[118:119], v19 offset:14336
  v_mfma_f32_16x16x32_bf16 v[180:183], a[12:15], a[84:87], v[180:183]
  v_mfma_f32_16x16x32_bf16 v[212:215], a[16:19], a[84:87], v[212:215]
  v_mfma_f32_16x16x32_bf16 v[244:247], a[20:23], a[84:87], v[244:247]
  ds_read_b64_tr_b16 a[120:121], v20 offset:12288
  v_mfma_f32_16x16x32_bf16 a[148:151], a[24:27], a[84:87], a[148:151]
  v_mfma_f32_16x16x32_bf16 a[180:183], a[28:31], a[84:87], a[180:183]
  ds_read_b64_tr_b16 a[122:123], v20 offset:14336
  v_mfma_f32_16x16x32_bf16 v[88:91], a[0:3], a[88:91], v[88:91]
  v_mfma_f32_16x16x32_bf16 v[120:123], a[4:7], a[88:91], v[120:123]
  ds_read_b64_tr_b16 a[124:125], v21 offset:12288
  v_mfma_f32_16x16x32_bf16 v[152:155], a[8:11], a[88:91], v[152:155]
  v_mfma_f32_16x16x32_bf16 v[184:187], a[12:15], a[88:91], v[184:187]
  ds_read_b64_tr_b16 a[126:127], v21 offset:14336
  v_mfma_f32_16x16x32_bf16 v[216:219], a[16:19], a[88:91], v[216:219]
  v_add_u32 v16, s38, v16
  v_add_u32 v17, s38, v17
  v_mfma_f32_16x16x32_bf16 v[248:251], a[20:23], a[88:91], v[248:251]
  v_add_u32 v18, s43, v18
  v_add_u32 v19, s43, v19
  v_mfma_f32_16x16x32_bf16 a[152:155], a[24:27], a[88:91], a[152:155]
  v_add_u32 v20, s43, v20
  v_add_u32 v21, s43, v21
  v_mfma_f32_16x16x32_bf16 a[184:187], a[28:31], a[88:91], a[184:187]
  v_mfma_f32_16x16x32_bf16 v[92:95], a[0:3], a[92:95], v[92:95]
  v_mfma_f32_16x16x32_bf16 v[124:127], a[4:7], a[92:95], v[124:127]
  v_mfma_f32_16x16x32_bf16 v[156:159], a[8:11], a[92:95], v[156:159]
  v_mfma_f32_16x16x32_bf16 v[188:191], a[12:15], a[92:95], v[188:191]
  v_mfma_f32_16x16x32_bf16 v[220:223], a[16:19], a[92:95], v[220:223]
  v_mfma_f32_16x16x32_bf16 v[252:255], a[20:23], a[92:95], v[252:255]
  v_mfma_f32_16x16x32_bf16 a[156:159], a[24:27], a[92:95], a[156:159]
  v_mfma_f32_16x16x32_bf16 a[188:191], a[28:31], a[92:95], a[188:191]
  s_mov_b32 s35, 4
  s_waitcnt vmcnt(8) lgkmcnt(0)
  s_barrier
  .p2align 6
Lp1xw_loop:
  v_mfma_f32_16x16x32_bf16 v[64:67], a[32:35], a[96:99], v[64:67]
  s_mov_b32 m0, s41
  ds_read_b128 a[0:3], v16 offset:0
  v_mfma_f32_16x16x32_bf16 v[96:99], a[36:39], a[96:99], v[96:99]
  buffer_load_dwordx4 v56, s[12:15], s47 offen offset:0 lds
  v_mfma_f32_16x16x32_bf16 v[128:131], a[40:43], a[96:99], v[128:131]
  ds_read_b64_tr_b16 a[64:65], v18 offset:0
  v_mfma_f32_16x16x32_bf16 v[160:163], a[44:47], a[96:99], v[160:163]
  v_mfma_f32_16x16x32_bf16 v[192:195], a[48:51], a[96:99], v[192:195]
  ds_read_b64_tr_b16 a[66:67], v18 offset:2048
  v_mfma_f32_16x16x32_bf16 v[224:227], a[52:55], a[96:99], v[224:227]
  v_mfma_f32_16x16x32_bf16 a[128:131], a[56:59], a[96:99], a[128:131]
  ds_read_b128 a[4:7], v16 offset:2048
  v_mfma_f32_16x16x32_bf16 a[160:163], a[60:63], a[96:99], a[160:163]
  buffer_load_dwordx4 v57, s[12:15], s47 offen offset:1024 lds
  v_mfma_f32_16x16x32_bf16 v[68:71], a[32:35], a[100:103], v[68:71]
  v_mfma_f32_16x16x32_bf16 v[100:103], a[36:39], a[100:103], v[100:103]
  ds_read_b128 a[8:11], v16 offset:4096
  v_mfma_f32_16x16x32_bf16 v[132:135], a[40:43], a[100:103], v[132:135]
  v_mfma_f32_16x16x32_bf16 v[164:167], a[44:47], a[100:103], v[164:167]
  ds_read_b128 a[12:15], v16 offset:6144
  v_mfma_f32_16x16x32_bf16 v[196:199], a[48:51], a[100:103], v[196:199]
  v_mfma_f32_16x16x32_bf16 v[228:231], a[52:55], a[100:103], v[228:231]
  ds_read_b128 a[16:19], v16 offset:8192
  v_mfma_f32_16x16x32_bf16 a[132:135], a[56:59], a[100:103], a[132:135]
  v_mfma_f32_16x16x32_bf16 a[164:167], a[60:63], a[100:103], a[164:167]
  buffer_load_dwordx4 v58, s[12:15], s47 offen offset:2048 lds
  ds_read_b128 a[20:23], v16 offset:10240
  v_mfma_f32_16x16x32_bf16 v[72:75], a[32:35], a[104:107], v[72:75]
  v_mfma_f32_16x16x32_bf16 v[104:107], a[36:39], a[104:107], v[104:107]
  v_mfma_f32_16x16x32_bf16 v[136:139], a[40:43], a[104:107], v[136:139]
  ds_read_b128 a[24:27], v16 offset:12288
  v_mfma_f32_16x16x32_bf16 v[168:171], a[44:47], a[104:107], v[168:171]
  v_mfma_f32_16x16x32_bf16 v[200:203], a[48:51], a[104:107], v[200:203]
  ds_read_b128 a[28:31], v16 offset:14336
  v_mfma_f32_16x16x32_bf16 v[232:235], a[52:55], a[104:107], v[232:235]
  v_mfma_f32_16x16x32_bf16 a[136:139], a[56:59], a[104:107], a[136:139]
  ds_read_b64_tr_b16 a[68:69], v19 offset:0
  v_mfma_f32_16x16x32_bf16 a[168:171], a[60:63], a[104:107], a[168:171]
  buffer_load_dwordx4 v59, s[12:15], s47 offen offset:3072 lds
  v_mfma_f32_16x16x32_bf16 v[76:79], a[32:35], a[108:111], v[76:79]
  s_add_u32 m0, s41, 4096
  ds_read_b64_tr_b16 a[70:71], v19 offset:2048
  v_mfma_f32_16x16x32_bf16 v[108:111], a[36:39], a[108:111], v[108:111]
  v_mfma_f32_16x16x32_bf16 v[140:143], a[40:43], a[108:111], v[140:143]
  v_mfma_f32_16x16x32_bf16 v[172:175], a[44:47], a[108:111], v[172:175]
  ds_read_b64_tr_b16 a[72:73], v20 offset:0
  v_mfma_f32_16x16x32_bf16 v[204:207], a[48:51], a[108:111], v[204:207]
  v_mfma_f32_16x16x32_bf16 v[236:239], a[52:55], a[108:111], v[236:239]
  ds_read_b64_tr_b16 a[74:75], v20 offset:2048
  v_mfma_f32_16x16x32_bf16 a[140:143], a[56:59], a[108:111], a[140:143]
  v_mfma_f32_16x16x32_bf16 a[172:175], a[60:63], a[108:111], a[172:175]
  buffer_load_dwordx4 v60, s[12:15], s47 offen offset:0 lds
  ds_read_b64_tr_b16 a[76:77], v21 offset:0
  v_mfma_f32_16x16x32_bf16 v[80:83], a[32:35], a[112:115], v[80:83]
  v_mfma_f32_16x16x32_bf16 v[112:115], a[36:39], a[112:115], v[112:115]
  ds_read_b64_tr_b16 a[78:79], v21 offset:2048
  v_mfma_f32_16x16x32_bf16 v[144:147], a[40:43], a[112:115], v[144:147]
  v_mfma_f32_16x16x32_bf16 v[176:179], a[44:47], a[112:115], v[176:179]
  v_mfma_f32_16x16x32_bf16 v[208:211], a[48:51], a[112:115], v[208:211]
  ds_read_b64_tr_b16 a[80:81], v18 offset:8192
  v_mfma_f32_16x16x32_bf16 v[240:243], a[52:55], a[112:115], v[240:243]
  v_mfma_f32_16x16x32_bf16 a[144:147], a[56:59], a[112:115], a[144:147]
  ds_read_b64_tr_b16 a[82:83], v18 offset:10240
  v_mfma_f32_16x16x32_bf16 a[176:179], a[60:63], a[112:115], a[176:179]
  buffer_load_dwordx4 v61, s[12:15], s47 offen offset:1024 lds
  v_mfma_f32_16x16x32_bf16 v[84:87], a[32:35], a[116:119], v[84:87]
  ds_read_b64_tr_b16 a[84:85], v19 offset:8192
  v_mfma_f32_16x16x32_bf16 v[116:119], a[36:39], a[116:119], v[116:119]
  v_mfma_f32_16x16x32_bf16 v[148:151], a[40:43], a[116:119], v[148:151]
  ds_read_b64_tr_b16 a[86:87], v19 offset:10240
  v_mfma_f32_16x16x32_bf16 v[180:183], a[44:47], a[116:119], v[180:183]
  v_mfma_f32_16x16x32_bf16 v[212:215], a[48:51], a[116:119], v[212:215]
  v_mfma_f32_16x16x32_bf16 v[244:247], a[52:55], a[116:119], v[244:247]
  ds_read_b64_tr_b16 a[88:89], v20 offset:8192
  v_mfma_f32_16x16x32_bf16 a[148:151], a[56:59], a[116:119], a[148:151]
  v_mfma_f32_16x16x32_bf16 a[180:183], a[60:63], a[116:119], a[180:183]
  buffer_load_dwordx4 v62, s[12:15], s47 offen offset:2048 lds
  ds_read_b64_tr_b16 a[90:91], v20 offset:10240
  v_mfma_f32_16x16x32_bf16 v[88:91], a[32:35], a[120:123], v[88:91]
  v_mfma_f32_16x16x32_bf16 v[120:123], a[36:39], a[120:123], v[120:123]
  ds_read_b64_tr_b16 a[92:93], v21 offset:8192
  v_mfma_f32_16x16x32_bf16 v[152:155], a[40:43], a[120:123], v[152:155]
  v_mfma_f32_16x16x32_bf16 v[184:187], a[44:47], a[120:123], v[184:187]
  ds_read_b64_tr_b16 a[94:95], v21 offset:10240
  v_mfma_f32_16x16x32_bf16 v[216:219], a[48:51], a[120:123], v[216:219]
  v_mfma_f32_16x16x32_bf16 v[248:251], a[52:55], a[120:123], v[248:251]
  v_mfma_f32_16x16x32_bf16 a[152:155], a[56:59], a[120:123], a[152:155]
  v_mfma_f32_16x16x32_bf16 a[184:187], a[60:63], a[120:123], a[184:187]
  buffer_load_dwordx4 v63, s[12:15], s47 offen offset:3072 lds
  v_mfma_f32_16x16x32_bf16 v[92:95], a[32:35], a[124:127], v[92:95]
  v_mfma_f32_16x16x32_bf16 v[124:127], a[36:39], a[124:127], v[124:127]
  v_mfma_f32_16x16x32_bf16 v[156:159], a[40:43], a[124:127], v[156:159]
  v_mfma_f32_16x16x32_bf16 v[188:191], a[44:47], a[124:127], v[188:191]
  v_mfma_f32_16x16x32_bf16 v[220:223], a[48:51], a[124:127], v[220:223]
  v_mfma_f32_16x16x32_bf16 v[252:255], a[52:55], a[124:127], v[252:255]
  v_mfma_f32_16x16x32_bf16 a[156:159], a[56:59], a[124:127], a[156:159]
  v_mfma_f32_16x16x32_bf16 a[188:191], a[60:63], a[124:127], a[188:191]
  s_waitcnt lgkmcnt(0)
  v_mfma_f32_16x16x32_bf16 v[64:67], a[0:3], a[64:67], v[64:67]
  s_mov_b32 m0, s36
  ds_read_b128 a[32:35], v17 offset:0
  v_mfma_f32_16x16x32_bf16 v[96:99], a[4:7], a[64:67], v[96:99]
  buffer_load_dwordx4 v48, s[8:11], s46 offen offset:0 lds
  v_mfma_f32_16x16x32_bf16 v[128:131], a[8:11], a[64:67], v[128:131]
  ds_read_b64_tr_b16 a[96:97], v18 offset:4096
  v_mfma_f32_16x16x32_bf16 v[160:163], a[12:15], a[64:67], v[160:163]
  v_mfma_f32_16x16x32_bf16 v[192:195], a[16:19], a[64:67], v[192:195]
  ds_read_b64_tr_b16 a[98:99], v18 offset:6144
  v_mfma_f32_16x16x32_bf16 v[224:227], a[20:23], a[64:67], v[224:227]
  v_mfma_f32_16x16x32_bf16 a[128:131], a[24:27], a[64:67], a[128:131]
  ds_read_b128 a[36:39], v17 offset:2048
  v_mfma_f32_16x16x32_bf16 a[160:163], a[28:31], a[64:67], a[160:163]
  buffer_load_dwordx4 v49, s[8:11], s46 offen offset:1024 lds
  v_mfma_f32_16x16x32_bf16 v[68:71], a[0:3], a[68:71], v[68:71]
  v_mfma_f32_16x16x32_bf16 v[100:103], a[4:7], a[68:71], v[100:103]
  ds_read_b128 a[40:43], v17 offset:4096
  v_mfma_f32_16x16x32_bf16 v[132:135], a[8:11], a[68:71], v[132:135]
  v_mfma_f32_16x16x32_bf16 v[164:167], a[12:15], a[68:71], v[164:167]
  ds_read_b128 a[44:47], v17 offset:6144
  v_mfma_f32_16x16x32_bf16 v[196:199], a[16:19], a[68:71], v[196:199]
  v_mfma_f32_16x16x32_bf16 v[228:231], a[20:23], a[68:71], v[228:231]
  ds_read_b128 a[48:51], v17 offset:8192
  v_mfma_f32_16x16x32_bf16 a[132:135], a[24:27], a[68:71], a[132:135]
  buffer_load_dwordx4 v50, s[8:11], s46 offen offset:2048 lds
  v_mfma_f32_16x16x32_bf16 a[164:167], a[28:31], a[68:71], a[164:167]
  ds_read_b128 a[52:55], v17 offset:10240
  v_mfma_f32_16x16x32_bf16 v[72:75], a[0:3], a[72:75], v[72:75]
  v_mfma_f32_16x16x32_bf16 v[104:107], a[4:7], a[72:75], v[104:107]
  v_mfma_f32_16x16x32_bf16 v[136:139], a[8:11], a[72:75], v[136:139]
  ds_read_b128 a[56:59], v17 offset:12288
  v_mfma_f32_16x16x32_bf16 v[168:171], a[12:15], a[72:75], v[168:171]
  v_mfma_f32_16x16x32_bf16 v[200:203], a[16:19], a[72:75], v[200:203]
  ds_read_b128 a[60:63], v17 offset:14336
  v_mfma_f32_16x16x32_bf16 v[232:235], a[20:23], a[72:75], v[232:235]
  buffer_load_dwordx4 v51, s[8:11], s46 offen offset:3072 lds
  v_mfma_f32_16x16x32_bf16 a[136:139], a[24:27], a[72:75], a[136:139]
  s_add_u32 m0, s36, 4096
  ds_read_b64_tr_b16 a[100:101], v19 offset:4096
  v_mfma_f32_16x16x32_bf16 a[168:171], a[28:31], a[72:75], a[168:171]
  v_mfma_f32_16x16x32_bf16 v[76:79], a[0:3], a[76:79], v[76:79]
  ds_read_b64_tr_b16 a[102:103], v19 offset:6144
  v_mfma_f32_16x16x32_bf16 v[108:111], a[4:7], a[76:79], v[108:111]
  v_mfma_f32_16x16x32_bf16 v[140:143], a[8:11], a[76:79], v[140:143]
  v_mfma_f32_16x16x32_bf16 v[172:175], a[12:15], a[76:79], v[172:175]
  ds_read_b64_tr_b16 a[104:105], v20 offset:4096
  v_mfma_f32_16x16x32_bf16 v[204:207], a[16:19], a[76:79], v[204:207]
  buffer_load_dwordx4 v52, s[8:11], s46 offen offset:0 lds
  v_mfma_f32_16x16x32_bf16 v[236:239], a[20:23], a[76:79], v[236:239]
  ds_read_b64_tr_b16 a[106:107], v20 offset:6144
  v_mfma_f32_16x16x32_bf16 a[140:143], a[24:27], a[76:79], a[140:143]
  v_mfma_f32_16x16x32_bf16 a[172:175], a[28:31], a[76:79], a[172:175]
  ds_read_b64_tr_b16 a[108:109], v21 offset:4096
  v_mfma_f32_16x16x32_bf16 v[80:83], a[0:3], a[80:83], v[80:83]
  v_mfma_f32_16x16x32_bf16 v[112:115], a[4:7], a[80:83], v[112:115]
  ds_read_b64_tr_b16 a[110:111], v21 offset:6144
  v_mfma_f32_16x16x32_bf16 v[144:147], a[8:11], a[80:83], v[144:147]
  v_mfma_f32_16x16x32_bf16 v[176:179], a[12:15], a[80:83], v[176:179]
  buffer_load_dwordx4 v53, s[8:11], s46 offen offset:1024 lds
  v_mfma_f32_16x16x32_bf16 v[208:211], a[16:19], a[80:83], v[208:211]
  ds_read_b64_tr_b16 a[112:113], v18 offset:12288
  v_mfma_f32_16x16x32_bf16 v[240:243], a[20:23], a[80:83], v[240:243]
  v_mfma_f32_16x16x32_bf16 a[144:147], a[24:27], a[80:83], a[144:147]
  ds_read_b64_tr_b16 a[114:115], v18 offset:14336
  v_mfma_f32_16x16x32_bf16 a[176:179], a[28:31], a[80:83], a[176:179]
  v_mfma_f32_16x16x32_bf16 v[84:87], a[0:3], a[84:87], v[84:87]
  ds_read_b64_tr_b16 a[116:117], v19 offset:12288
  v_mfma_f32_16x16x32_bf16 v[116:119], a[4:7], a[84:87], v[116:119]
  v_mfma_f32_16x16x32_bf16 v[148:151], a[8:11], a[84:87], v[148:151]
  buffer_load_dwordx4 v54, s[8:11], s46 offen offset:2048 lds
  ds_read_b64_tr_b16 a[118:119], v19 offset:14336
  v_mfma_f32_16x16x32_bf16 v[180:183], a[12:15], a[84:87], v[180:183]
  v_mfma_f32_16x16x32_bf16 v[212:215], a[16:19], a[84:87], v[212:215]
  v_mfma_f32_16x16x32_bf16 v[244:247], a[20:23], a[84:87], v[244:247]
  ds_read_b64_tr_b16 a[120:121], v20 offset:12288
  v_mfma_f32_16x16x32_bf16 a[148:151], a[24:27], a[84:87], a[148:151]
  v_mfma_f32_16x16x32_bf16 a[180:183], a[28:31], a[84:87], a[180:183]
  ds_read_b64_tr_b16 a[122:123], v20 offset:14336
  v_mfma_f32_16x16x32_bf16 v[88:91], a[0:3], a[88:91], v[88:91]
  v_mfma_f32_16x16x32_bf16 v[120:123], a[4:7], a[88:91], v[120:123]
  buffer_load_dwordx4 v55, s[8:11], s46 offen offset:3072 lds
  ds_read_b64_tr_b16 a[124:125], v21 offset:12288
  v_mfma_f32_16x16x32_bf16 v[152:155], a[8:11], a[88:91], v[152:155]
  s_sub_u32 s50, s50, 1
  s_cmp_eq_u32 s50, 0
  s_cselect_b32 s12, s72, s12
  s_cselect_b32 s13, s73, s13
  v_mfma_f32_16x16x32_bf16 v[184:187], a[12:15], a[88:91], v[184:187]
  s_lshl_b32 s47, s48, 19
  s_bfe_u32 s34, 0x3020106, s49
  s_add_u32 s48, s48, s34
  v_mfma_f32_16x16x32_bf16 v[216:219], a[16:19], a[88:91], v[216:219]
  s_add_u32 s49, s49, 8
  s_and_b32 s49, s49, 0x8001f
  s_and_b32 s48, s48, 7
  v_mfma_f32_16x16x32_bf16 v[248:251], a[20:23], a[88:91], v[248:251]
  s_lshl_b32 s46, s48, 7
  ds_read_b64_tr_b16 a[126:127], v21 offset:14336
  v_mfma_f32_16x16x32_bf16 a[152:155], a[24:27], a[88:91], a[152:155]
  s_add_u32 s36, s36, s38
  s_add_u32 s37, s37, 1
  s_cmp_eq_u32 s37, 3
  s_cselect_b32 s37, 0, s37
  s_cselect_b32 s38, s39, s40
  v_mfma_f32_16x16x32_bf16 a[184:187], a[28:31], a[88:91], a[184:187]
  s_add_u32 s41, s41, s43
  s_sub_u32 s43, 0, s43
  v_mfma_f32_16x16x32_bf16 v[92:95], a[0:3], a[92:95], v[92:95]
  v_add_u32 v16, s38, v16
  v_add_u32 v17, s38, v17
  v_mfma_f32_16x16x32_bf16 v[124:127], a[4:7], a[92:95], v[124:127]
  v_add_u32 v18, s43, v18
  v_add_u32 v19, s43, v19
  v_mfma_f32_16x16x32_bf16 v[156:159], a[8:11], a[92:95], v[156:159]
  v_add_u32 v20, s43, v20
  v_add_u32 v21, s43, v21
  v_mfma_f32_16x16x32_bf16 v[188:191], a[12:15], a[92:95], v[188:191]
  v_mfma_f32_16x16x32_bf16 v[220:223], a[16:19], a[92:95], v[220:223]
  v_mfma_f32_16x16x32_bf16 v[252:255], a[20:23], a[92:95], v[252:255]
  s_waitcnt vmcnt(8) lgkmcnt(0)
  s_barrier
  v_mfma_f32_16x16x32_bf16 a[156:159], a[24:27], a[92:95], a[156:159]
  s_sub_u32 s35, s35, 1
  v_mfma_f32_16x16x32_bf16 a[188:191], a[28:31], a[92:95], a[188:191]
  s_cmp_lg_u32 s35, 0
  s_cbranch_scc1 Lp1xw_loop
  v_accvgpr_read_b32 v4, a222
  v_accvgpr_read_b32 v5, a223
  v_accvgpr_read_b32 v6, a224
  v_accvgpr_read_b32 v7, a225
  v_accvgpr_read_b32 v8, a226
  v_accvgpr_read_b32 v9, a227
  v_accvgpr_read_b32 v10, a228
  v_accvgpr_read_b32 v11, a229
  s_mov_b32 s8, s64
  s_mov_b32 s9, s65
  s_mov_b32 s10, 4194304
  s_mov_b32 s11, 0x00020000
  s_mov_b32 s20, s68
  s_mov_b32 s21, s69
  s_mov_b32 s22, 8388608
  s_mov_b32 s23, 0x00020000
  s_and_b32 s4, s2, 7
  s_lshl_b32 s4, s4, 1
  s_lshr_b32 s5, s2, 6
  s_add_u32 s5, s5, s25
  s_and_b32 s53, s5, 3
  s_lshl_b32 s53, s53, 3
  s_or_b32 s53, s53, 0x80000
  s_bfe_u32 s52, 0xf0f02, s53
  s_add_u32 s52, s52, s4
  s_and_b32 s52, s52, 15
  s_mov_b32 s54, s52
  s_mov_b32 s55, s53
  s_lshl_b32 s29, s52, 7
  s_lshl_b32 s28, s54, 19
  s_lshl_b32 s30, s25, 18
  s_sub_u32 s31, 3932160, s30
  s_or_b32 s26, s30, s29
  s_or_b32 s27, s31, s29
  s_lshl_b32 s68, s3, 12
  s_lshl_b32 s88, s3, 13
  s_add_u32 s88, s88, 98304
  v_mfma_f32_16x16x32_bf16 v[64:67], a[32:35], a[96:99], v[64:67]
  s_mov_b32 m0, s41
  ds_read_b128 a[0:3], v16 offset:0
  v_mfma_f32_16x16x32_bf16 v[96:99], a[36:39], a[96:99], v[96:99]
  buffer_load_dwordx4 v56, s[12:15], s47 offen offset:0 lds
  v_mfma_f32_16x16x32_bf16 v[128:131], a[40:43], a[96:99], v[128:131]
  ds_read_b64_tr_b16 a[64:65], v18 offset:0
  v_mfma_f32_16x16x32_bf16 v[160:163], a[44:47], a[96:99], v[160:163]
  v_mfma_f32_16x16x32_bf16 v[192:195], a[48:51], a[96:99], v[192:195]
  ds_read_b64_tr_b16 a[66:67], v18 offset:2048
  v_mfma_f32_16x16x32_bf16 v[224:227], a[52:55], a[96:99], v[224:227]
  v_mfma_f32_16x16x32_bf16 a[128:131], a[56:59], a[96:99], a[128:131]
  ds_read_b128 a[4:7], v16 offset:2048
  v_mfma_f32_16x16x32_bf16 a[160:163], a[60:63], a[96:99], a[160:163]
  buffer_load_dwordx4 v57, s[12:15], s47 offen offset:1024 lds
  v_mfma_f32_16x16x32_bf16 v[68:71], a[32:35], a[100:103], v[68:71]
  v_mfma_f32_16x16x32_bf16 v[100:103], a[36:39], a[100:103], v[100:103]
  ds_read_b128 a[8:11], v16 offset:4096
  v_mfma_f32_16x16x32_bf16 v[132:135], a[40:43], a[100:103], v[132:135]
  v_mfma_f32_16x16x32_bf16 v[164:167], a[44:47], a[100:103], v[164:167]
  ds_read_b128 a[12:15], v16 offset:6144
  v_mfma_f32_16x16x32_bf16 v[196:199], a[48:51], a[100:103], v[196:199]
  v_mfma_f32_16x16x32_bf16 v[228:231], a[52:55], a[100:103], v[228:231]
  ds_read_b128 a[16:19], v16 offset:8192
  v_mfma_f32_16x16x32_bf16 a[132:135], a[56:59], a[100:103], a[132:135]
  v_mfma_f32_16x16x32_bf16 a[164:167], a[60:63], a[100:103], a[164:167]
  buffer_load_dwordx4 v58, s[12:15], s47 offen offset:2048 lds
  ds_read_b128 a[20:23], v16 offset:10240
  v_mfma_f32_16x16x32_bf16 v[72:75], a[32:35], a[104:107], v[72:75]
  v_mfma_f32_16x16x32_bf16 v[104:107], a[36:39], a[104:107], v[104:107]
  v_mfma_f32_16x16x32_bf16 v[136:139], a[40:43], a[104:107], v[136:139]
  ds_read_b128 a[24:27], v16 offset:12288
  v_mfma_f32_16x16x32_bf16 v[168:171], a[44:47], a[104:107], v[168:171]
  v_mfma_f32_16x16x32_bf16 v[200:203], a[48:51], a[104:107], v[200:203]
  ds_read_b128 a[28:31], v16 offset:14336
  v_mfma_f32_16x16x32_bf16 v[232:235], a[52:55], a[104:107], v[232:235]
  v_mfma_f32_16x16x32_bf16 a[136:139], a[56:59], a[104:107], a[136:139]
  ds_read_b64_tr_b16 a[68:69], v19 offset:0
  v_mfma_f32_16x16x32_bf16 a[168:171], a[60:63], a[104:107], a[168:171]
  buffer_load_dwordx4 v59, s[12:15], s47 offen offset:3072 lds
  v_mfma_f32_16x16x32_bf16 v[76:79], a[32:35], a[108:111], v[76:79]
  s_add_u32 m0, s41, 4096
  ds_read_b64_tr_b16 a[70:71], v19 offset:2048
  v_mfma_f32_16x16x32_bf16 v[108:111], a[36:39], a[108:111], v[108:111]
  v_mfma_f32_16x16x32_bf16 v[140:143], a[40:43], a[108:111], v[140:143]
  v_mfma_f32_16x16x32_bf16 v[172:175], a[44:47], a[108:111], v[172:175]
  ds_read_b64_tr_b16 a[72:73], v20 offset:0
  v_mfma_f32_16x16x32_bf16 v[204:207], a[48:51], a[108:111], v[204:207]
  v_mfma_f32_16x16x32_bf16 v[236:239], a[52:55], a[108:111], v[236:239]
  ds_read_b64_tr_b16 a[74:75], v20 offset:2048
  v_mfma_f32_16x16x32_bf16 a[140:143], a[56:59], a[108:111], a[140:143]
  v_mfma_f32_16x16x32_bf16 a[172:175], a[60:63], a[108:111], a[172:175]
  buffer_load_dwordx4 v60, s[12:15], s47 offen offset:0 lds
  ds_read_b64_tr_b16 a[76:77], v21 offset:0
  v_mfma_f32_16x16x32_bf16 v[80:83], a[32:35], a[112:115], v[80:83]
  v_mfma_f32_16x16x32_bf16 v[112:115], a[36:39], a[112:115], v[112:115]
  ds_read_b64_tr_b16 a[78:79], v21 offset:2048
  v_mfma_f32_16x16x32_bf16 v[144:147], a[40:43], a[112:115], v[144:147]
  v_mfma_f32_16x16x32_bf16 v[176:179], a[44:47], a[112:115], v[176:179]
  v_mfma_f32_16x16x32_bf16 v[208:211], a[48:51], a[112:115], v[208:211]
  ds_read_b64_tr_b16 a[80:81], v18 offset:8192
  v_mfma_f32_16x16x32_bf16 v[240:243], a[52:55], a[112:115], v[240:243]
  v_mfma_f32_16x16x32_bf16 a[144:147], a[56:59], a[112:115], a[144:147]
  ds_read_b64_tr_b16 a[82:83], v18 offset:10240
  v_mfma_f32_16x16x32_bf16 a[176:179], a[60:63], a[112:115], a[176:179]
  buffer_load_dwordx4 v61, s[12:15], s47 offen offset:1024 lds
  v_mfma_f32_16x16x32_bf16 v[84:87], a[32:35], a[116:119], v[84:87]
  ds_read_b64_tr_b16 a[84:85], v19 offset:8192
  v_mfma_f32_16x16x32_bf16 v[116:119], a[36:39], a[116:119], v[116:119]
  v_mfma_f32_16x16x32_bf16 v[148:151], a[40:43], a[116:119], v[148:151]
  ds_read_b64_tr_b16 a[86:87], v19 offset:10240
  v_mfma_f32_16x16x32_bf16 v[180:183], a[44:47], a[116:119], v[180:183]
  v_mfma_f32_16x16x32_bf16 v[212:215], a[48:51], a[116:119], v[212:215]
  v_mfma_f32_16x16x32_bf16 v[244:247], a[52:55], a[116:119], v[244:247]
  ds_read_b64_tr_b16 a[88:89], v20 offset:8192
  v_mfma_f32_16x16x32_bf16 a[148:151], a[56:59], a[116:119], a[148:151]
  v_mfma_f32_16x16x32_bf16 a[180:183], a[60:63], a[116:119], a[180:183]
  buffer_load_dwordx4 v62, s[12:15], s47 offen offset:2048 lds
  ds_read_b64_tr_b16 a[90:91], v20 offset:10240
  v_mfma_f32_16x16x32_bf16 v[88:91], a[32:35], a[120:123], v[88:91]
  v_mfma_f32_16x16x32_bf16 v[120:123], a[36:39], a[120:123], v[120:123]
  ds_read_b64_tr_b16 a[92:93], v21 offset:8192
  v_mfma_f32_16x16x32_bf16 v[152:155], a[40:43], a[120:123], v[152:155]
  v_mfma_f32_16x16x32_bf16 v[184:187], a[44:47], a[120:123], v[184:187]
  ds_read_b64_tr_b16 a[94:95], v21 offset:10240
  v_mfma_f32_16x16x32_bf16 v[216:219], a[48:51], a[120:123], v[216:219]
  v_mfma_f32_16x16x32_bf16 v[248:251], a[52:55], a[120:123], v[248:251]
  v_mfma_f32_16x16x32_bf16 a[152:155], a[56:59], a[120:123], a[152:155]
  v_mfma_f32_16x16x32_bf16 a[184:187], a[60:63], a[120:123], a[184:187]
  buffer_load_dwordx4 v63, s[12:15], s47 offen offset:3072 lds
  v_mfma_f32_16x16x32_bf16 v[92:95], a[32:35], a[124:127], v[92:95]
  v_mfma_f32_16x16x32_bf16 v[124:127], a[36:39], a[124:127], v[124:127]
  v_mfma_f32_16x16x32_bf16 v[156:159], a[40:43], a[124:127], v[156:159]
  v_mfma_f32_16x16x32_bf16 v[188:191], a[44:47], a[124:127], v[188:191]
  v_mfma_f32_16x16x32_bf16 v[220:223], a[48:51], a[124:127], v[220:223]
  v_mfma_f32_16x16x32_bf16 v[252:255], a[52:55], a[124:127], v[252:255]
  v_mfma_f32_16x16x32_bf16 a[156:159], a[56:59], a[124:127], a[156:159]
  v_mfma_f32_16x16x32_bf16 a[188:191], a[60:63], a[124:127], a[188:191]
  s_waitcnt lgkmcnt(0)
  v_mfma_f32_16x16x32_bf16 v[64:67], a[0:3], a[64:67], v[64:67]
  s_mov_b32 m0, s68
  ds_read_b128 a[32:35], v17 offset:0
  v_mfma_f32_16x16x32_bf16 v[96:99], a[4:7], a[64:67], v[96:99]
  buffer_load_dwordx4 v8, s[20:23], s28 offen offset:0 lds
  v_mfma_f32_16x16x32_bf16 v[128:131], a[8:11], a[64:67], v[128:131]
  ds_read_b64_tr_b16 a[96:97], v18 offset:4096
  v_mfma_f32_16x16x32_bf16 v[160:163], a[12:15], a[64:67], v[160:163]
  v_mfma_f32_16x16x32_bf16 v[192:195], a[16:19], a[64:67], v[192:195]
  ds_read_b64_tr_b16 a[98:99], v18 offset:6144
  v_mfma_f32_16x16x32_bf16 v[224:227], a[20:23], a[64:67], v[224:227]
  v_mfma_f32_16x16x32_bf16 a[128:131], a[24:27], a[64:67], a[128:131]
  ds_read_b128 a[36:39], v17 offset:2048
  v_mfma_f32_16x16x32_bf16 a[160:163], a[28:31], a[64:67], a[160:163]
  buffer_load_dwordx4 v9, s[20:23], s28 offen offset:1024 lds
  v_mfma_f32_16x16x32_bf16 v[68:71], a[0:3], a[68:71], v[68:71]
  v_mfma_f32_16x16x32_bf16 v[100:103], a[4:7], a[68:71], v[100:103]
  ds_read_b128 a[40:43], v17 offset:4096
  v_mfma_f32_16x16x32_bf16 v[132:135], a[8:11], a[68:71], v[132:135]
  v_mfma_f32_16x16x32_bf16 v[164:167], a[12:15], a[68:71], v[164:167]
  ds_read_b128 a[44:47], v17 offset:6144
  v_mfma_f32_16x16x32_bf16 v[196:199], a[16:19], a[68:71], v[196:199]
  v_mfma_f32_16x16x32_bf16 v[228:231], a[20:23], a[68:71], v[228:231]
  ds_read_b128 a[48:51], v17 offset:8192
  v_mfma_f32_16x16x32_bf16 a[132:135], a[24:27], a[68:71], a[132:135]
  buffer_load_dwordx4 v10, s[20:23], s28 offen offset:2048 lds
  v_mfma_f32_16x16x32_bf16 a[164:167], a[28:31], a[68:71], a[164:167]
  ds_read_b128 a[52:55], v17 offset:10240
  v_mfma_f32_16x16x32_bf16 v[72:75], a[0:3], a[72:75], v[72:75]
  v_mfma_f32_16x16x32_bf16 v[104:107], a[4:7], a[72:75], v[104:107]
  v_mfma_f32_16x16x32_bf16 v[136:139], a[8:11], a[72:75], v[136:139]
  ds_read_b128 a[56:59], v17 offset:12288
  v_mfma_f32_16x16x32_bf16 v[168:171], a[12:15], a[72:75], v[168:171]
  v_mfma_f32_16x16x32_bf16 v[200:203], a[16:19], a[72:75], v[200:203]
  ds_read_b128 a[60:63], v17 offset:14336
  v_mfma_f32_16x16x32_bf16 v[232:235], a[20:23], a[72:75], v[232:235]
  buffer_load_dwordx4 v11, s[20:23], s28 offen offset:3072 lds
  v_mfma_f32_16x16x32_bf16 a[136:139], a[24:27], a[72:75], a[136:139]
  s_bfe_u32 s56, 0x302010e, s55
  s_add_u32 s54, s54, s56
  s_add_u32 s55, s55, 8
  v_mfma_f32_16x16x32_bf16 a[168:171], a[28:31], a[72:75], a[168:171]
  s_and_b32 s55, s55, 0x8001f
  s_and_b32 s54, s54, 15
  s_lshl_b32 s28, s54, 19
  v_mfma_f32_16x16x32_bf16 v[76:79], a[0:3], a[76:79], v[76:79]
  s_add_u32 m0, s68, 16384
  ds_read_b64_tr_b16 a[100:101], v19 offset:4096
  ds_read_b64_tr_b16 a[102:103], v19 offset:6144
  v_mfma_f32_16x16x32_bf16 v[108:111], a[4:7], a[76:79], v[108:111]
  v_mfma_f32_16x16x32_bf16 v[140:143], a[8:11], a[76:79], v[140:143]
  v_mfma_f32_16x16x32_bf16 v[172:175], a[12:15], a[76:79], v[172:175]
  ds_read_b64_tr_b16 a[104:105], v20 offset:4096
  v_mfma_f32_16x16x32_bf16 v[204:207], a[16:19], a[76:79], v[204:207]
  buffer_load_dwordx4 v8, s[20:23], s28 offen offset:0 lds
  v_mfma_f32_16x16x32_bf16 v[236:239], a[20:23], a[76:79], v[236:239]
  ds_read_b64_tr_b16 a[106:107], v20 offset:6144
  v_mfma_f32_16x16x32_bf16 a[140:143], a[24:27], a[76:79], a[140:143]
  v_mfma_f32_16x16x32_bf16 a[172:175], a[28:31], a[76:79], a[172:175]
  ds_read_b64_tr_b16 a[108:109], v21 offset:4096
  v_mfma_f32_16x16x32_bf16 v[80:83], a[0:3], a[80:83], v[80:83]
  v_mfma_f32_16x16x32_bf16 v[112:115], a[4:7], a[80:83], v[112:115]
  ds_read_b64_tr_b16 a[110:111], v21 offset:6144
  v_mfma_f32_16x16x32_bf16 v[144:147], a[8:11], a[80:83], v[144:147]
  v_mfma_f32_16x16x32_bf16 v[176:179], a[12:15], a[80:83], v[176:179]
  buffer_load_dwordx4 v9, s[20:23], s28 offen offset:1024 lds
  v_mfma_f32_16x16x32_bf16 v[208:211], a[16:19], a[80:83], v[208:211]
  ds_read_b64_tr_b16 a[112:113], v18 offset:12288
  v_mfma_f32_16x16x32_bf16 v[240:243], a[20:23], a[80:83], v[240:243]
  v_mfma_f32_16x16x32_bf16 a[144:147], a[24:27], a[80:83], a[144:147]
  ds_read_b64_tr_b16 a[114:115], v18 offset:14336
  v_mfma_f32_16x16x32_bf16 a[176:179], a[28:31], a[80:83], a[176:179]
  v_mfma_f32_16x16x32_bf16 v[84:87], a[0:3], a[84:87], v[84:87]
  ds_read_b64_tr_b16 a[116:117], v19 offset:12288
  v_mfma_f32_16x16x32_bf16 v[116:119], a[4:7], a[84:87], v[116:119]
  v_mfma_f32_16x16x32_bf16 v[148:151], a[8:11], a[84:87], v[148:151]
  buffer_load_dwordx4 v10, s[20:23], s28 offen offset:2048 lds
  ds_read_b64_tr_b16 a[118:119], v19 offset:14336
  v_mfma_f32_16x16x32_bf16 v[180:183], a[12:15], a[84:87], v[180:183]
  v_mfma_f32_16x16x32_bf16 v[212:215], a[16:19], a[84:87], v[212:215]
  v_mfma_f32_16x16x32_bf16 v[244:247], a[20:23], a[84:87], v[244:247]
  ds_read_b64_tr_b16 a[120:121], v20 offset:12288
  v_mfma_f32_16x16x32_bf16 a[148:151], a[24:27], a[84:87], a[148:151]
  v_mfma_f32_16x16x32_bf16 a[180:183], a[28:31], a[84:87], a[180:183]
  ds_read_b64_tr_b16 a[122:123], v20 offset:14336
  v_mfma_f32_16x16x32_bf16 v[88:91], a[0:3], a[88:91], v[88:91]
  v_mfma_f32_16x16x32_bf16 v[120:123], a[4:7], a[88:91], v[120:123]
  buffer_load_dwordx4 v11, s[20:23], s28 offen offset:3072 lds
  ds_read_b64_tr_b16 a[124:125], v21 offset:12288
  v_mfma_f32_16x16x32_bf16 v[152:155], a[8:11], a[88:91], v[152:155]
  s_bfe_u32 s56, 0x302010e, s55
  s_add_u32 s54, s54, s56
  s_add_u32 s55, s55, 8
  v_mfma_f32_16x16x32_bf16 v[184:187], a[12:15], a[88:91], v[184:187]
  s_and_b32 s55, s55, 0x8001f
  s_and_b32 s54, s54, 15
  s_lshl_b32 s28, s54, 19
  v_mfma_f32_16x16x32_bf16 v[216:219], a[16:19], a[88:91], v[216:219]
  s_add_u32 s36, s36, s38
  s_add_u32 s37, s37, 1
  ds_read_b64_tr_b16 a[126:127], v21 offset:14336
  v_mfma_f32_16x16x32_bf16 v[248:251], a[20:23], a[88:91], v[248:251]
  s_cmp_eq_u32 s37, 3
  s_cselect_b32 s37, 0, s37
  s_cselect_b32 s38, s39, s40
  v_mfma_f32_16x16x32_bf16 a[152:155], a[24:27], a[88:91], a[152:155]
  s_add_u32 s41, s41, s43
  s_sub_u32 s43, 0, s43
  v_mfma_f32_16x16x32_bf16 a[184:187], a[28:31], a[88:91], a[184:187]
  v_add_u32 v16, s38, v16
  v_add_u32 v17, s38, v17
  v_mfma_f32_16x16x32_bf16 v[92:95], a[0:3], a[92:95], v[92:95]
  v_add_u32 v18, s43, v18
  v_add_u32 v19, s43, v19
  v_mfma_f32_16x16x32_bf16 v[124:127], a[4:7], a[92:95], v[124:127]
  v_add_u32 v20, s43, v20
  v_add_u32 v21, s43, v21
  v_mfma_f32_16x16x32_bf16 v[156:159], a[8:11], a[92:95], v[156:159]
  v_mfma_f32_16x16x32_bf16 v[188:191], a[12:15], a[92:95], v[188:191]
  v_mfma_f32_16x16x32_bf16 v[220:223], a[16:19], a[92:95], v[220:223]
  v_mfma_f32_16x16x32_bf16 v[252:255], a[20:23], a[92:95], v[252:255]
  v_mfma_f32_16x16x32_bf16 a[156:159], a[24:27], a[92:95], a[156:159]
  v_mfma_f32_16x16x32_bf16 a[188:191], a[28:31], a[92:95], a[188:191]
  s_waitcnt vmcnt(8) lgkmcnt(0)
  s_barrier
  v_mfma_f32_16x16x32_bf16 v[64:67], a[32:35], a[96:99], v[64:67]
  s_mov_b32 m0, s88
  ds_read_b128 a[0:3], v16 offset:0
  v_mfma_f32_16x16x32_bf16 v[96:99], a[36:39], a[96:99], v[96:99]
  buffer_load_dwordx4 v4, s[8:11], s26 offen offset:0 lds
  v_mfma_f32_16x16x32_bf16 v[128:131], a[40:43], a[96:99], v[128:131]
  ds_read_b64_tr_b16 a[64:65], v18 offset:0
  v_mfma_f32_16x16x32_bf16 v[160:163], a[44:47], a[96:99], v[160:163]
  v_mfma_f32_16x16x32_bf16 v[192:195], a[48:51], a[96:99], v[192:195]
  ds_read_b64_tr_b16 a[66:67], v18 offset:2048
  v_mfma_f32_16x16x32_bf16 v[224:227], a[52:55], a[96:99], v[224:227]
  v_mfma_f32_16x16x32_bf16 a[128:131], a[56:59], a[96:99], a[128:131]
  ds_read_b128 a[4:7], v16 offset:2048
  v_mfma_f32_16x16x32_bf16 a[160:163], a[60:63], a[96:99], a[160:163]
  buffer_load_dwordx4 v5, s[8:11], s26 offen offset:1024 lds
  v_mfma_f32_16x16x32_bf16 v[68:71], a[32:35], a[100:103], v[68:71]
  v_mfma_f32_16x16x32_bf16 v[100:103], a[36:39], a[100:103], v[100:103]
  ds_read_b128 a[8:11], v16 offset:4096
  v_mfma_f32_16x16x32_bf16 v[132:135], a[40:43], a[100:103], v[132:135]
  v_mfma_f32_16x16x32_bf16 v[164:167], a[44:47], a[100:103], v[164:167]
  ds_read_b128 a[12:15], v16 offset:6144
  v_mfma_f32_16x16x32_bf16 v[196:199], a[48:51], a[100:103], v[196:199]
  v_mfma_f32_16x16x32_bf16 v[228:231], a[52:55], a[100:103], v[228:231]
  ds_read_b128 a[16:19], v16 offset:8192
  v_mfma_f32_16x16x32_bf16 a[132:135], a[56:59], a[100:103], a[132:135]
  v_mfma_f32_16x16x32_bf16 a[164:167], a[60:63], a[100:103], a[164:167]
  buffer_load_dwordx4 v6, s[8:11], s26 offen offset:2048 lds
  ds_read_b128 a[20:23], v16 offset:10240
  v_mfma_f32_16x16x32_bf16 v[72:75], a[32:35], a[104:107], v[72:75]
  v_mfma_f32_16x16x32_bf16 v[104:107], a[36:39], a[104:107], v[104:107]
  v_mfma_f32_16x16x32_bf16 v[136:139], a[40:43], a[104:107], v[136:139]
  ds_read_b128 a[24:27], v16 offset:12288
  v_mfma_f32_16x16x32_bf16 v[168:171], a[44:47], a[104:107], v[168:171]
  v_mfma_f32_16x16x32_bf16 v[200:203], a[48:51], a[104:107], v[200:203]
  ds_read_b128 a[28:31], v16 offset:14336
  v_mfma_f32_16x16x32_bf16 v[232:235], a[52:55], a[104:107], v[232:235]
  v_mfma_f32_16x16x32_bf16 a[136:139], a[56:59], a[104:107], a[136:139]
  ds_read_b64_tr_b16 a[68:69], v19 offset:0
  v_mfma_f32_16x16x32_bf16 a[168:171], a[60:63], a[104:107], a[168:171]
  buffer_load_dwordx4 v7, s[8:11], s26 offen offset:3072 lds
  v_mfma_f32_16x16x32_bf16 v[76:79], a[32:35], a[108:111], v[76:79]
  s_add_u32 m0, s88, 4096
  ds_read_b64_tr_b16 a[70:71], v19 offset:2048
  v_mfma_f32_16x16x32_bf16 v[108:111], a[36:39], a[108:111], v[108:111]
  v_mfma_f32_16x16x32_bf16 v[140:143], a[40:43], a[108:111], v[140:143]
  v_mfma_f32_16x16x32_bf16 v[172:175], a[44:47], a[108:111], v[172:175]
  ds_read_b64_tr_b16 a[72:73], v20 offset:0
  v_mfma_f32_16x16x32_bf16 v[204:207], a[48:51], a[108:111], v[204:207]
  v_mfma_f32_16x16x32_bf16 v[236:239], a[52:55], a[108:111], v[236:239]
  ds_read_b64_tr_b16 a[74:75], v20 offset:2048
  v_mfma_f32_16x16x32_bf16 a[140:143], a[56:59], a[108:111], a[140:143]
  v_mfma_f32_16x16x32_bf16 a[172:175], a[60:63], a[108:111], a[172:175]
  buffer_load_dwordx4 v4, s[8:11], s27 offen offset:0 lds
  ds_read_b64_tr_b16 a[76:77], v21 offset:0
  v_mfma_f32_16x16x32_bf16 v[80:83], a[32:35], a[112:115], v[80:83]
  v_mfma_f32_16x16x32_bf16 v[112:115], a[36:39], a[112:115], v[112:115]
  ds_read_b64_tr_b16 a[78:79], v21 offset:2048
  v_mfma_f32_16x16x32_bf16 v[144:147], a[40:43], a[112:115], v[144:147]
  v_mfma_f32_16x16x32_bf16 v[176:179], a[44:47], a[112:115], v[176:179]
  v_mfma_f32_16x16x32_bf16 v[208:211], a[48:51], a[112:115], v[208:211]
  ds_read_b64_tr_b16 a[80:81], v18 offset:8192
  v_mfma_f32_16x16x32_bf16 v[240:243], a[52:55], a[112:115], v[240:243]
  v_mfma_f32_16x16x32_bf16 a[144:147], a[56:59], a[112:115], a[144:147]
  ds_read_b64_tr_b16 a[82:83], v18 offset:10240
  v_mfma_f32_16x16x32_bf16 a[176:179], a[60:63], a[112:115], a[176:179]
  buffer_load_dwordx4 v5, s[8:11], s27 offen offset:1024 lds
  v_mfma_f32_16x16x32_bf16 v[84:87], a[32:35], a[116:119], v[84:87]
  ds_read_b64_tr_b16 a[84:85], v19 offset:8192
  v_mfma_f32_16x16x32_bf16 v[116:119], a[36:39], a[116:119], v[116:119]
  v_mfma_f32_16x16x32_bf16 v[148:151], a[40:43], a[116:119], v[148:151]
  ds_read_b64_tr_b16 a[86:87], v19 offset:10240
  v_mfma_f32_16x16x32_bf16 v[180:183], a[44:47], a[116:119], v[180:183]
  v_mfma_f32_16x16x32_bf16 v[212:215], a[48:51], a[116:119], v[212:215]
  v_mfma_f32_16x16x32_bf16 v[244:247], a[52:55], a[116:119], v[244:247]
  ds_read_b64_tr_b16 a[88:89], v20 offset:8192
  v_mfma_f32_16x16x32_bf16 a[148:151], a[56:59], a[116:119], a[148:151]
  v_mfma_f32_16x16x32_bf16 a[180:183], a[60:63], a[116:119], a[180:183]
  buffer_load_dwordx4 v6, s[8:11], s27 offen offset:2048 lds
  ds_read_b64_tr_b16 a[90:91], v20 offset:10240
  v_mfma_f32_16x16x32_bf16 v[88:91], a[32:35], a[120:123], v[88:91]
  v_mfma_f32_16x16x32_bf16 v[120:123], a[36:39], a[120:123], v[120:123]
  ds_read_b64_tr_b16 a[92:93], v21 offset:8192
  v_mfma_f32_16x16x32_bf16 v[152:155], a[40:43], a[120:123], v[152:155]
  v_mfma_f32_16x16x32_bf16 v[184:187], a[44:47], a[120:123], v[184:187]
  ds_read_b64_tr_b16 a[94:95], v21 offset:10240
  v_mfma_f32_16x16x32_bf16 v[216:219], a[48:51], a[120:123], v[216:219]
  v_mfma_f32_16x16x32_bf16 v[248:251], a[52:55], a[120:123], v[248:251]
  v_mfma_f32_16x16x32_bf16 a[152:155], a[56:59], a[120:123], a[152:155]
  v_mfma_f32_16x16x32_bf16 a[184:187], a[60:63], a[120:123], a[184:187]
  buffer_load_dwordx4 v7, s[8:11], s27 offen offset:3072 lds
  v_mfma_f32_16x16x32_bf16 v[92:95], a[32:35], a[124:127], v[92:95]
  s_bfe_u32 s29, 0x302010e, s53
  s_add_u32 s52, s52, s29
  s_add_u32 s53, s53, 8
  v_mfma_f32_16x16x32_bf16 v[124:127], a[36:39], a[124:127], v[124:127]
  s_and_b32 s53, s53, 0x8001f
  s_and_b32 s52, s52, 15
  s_lshl_b32 s29, s52, 7
  v_mfma_f32_16x16x32_bf16 v[156:159], a[40:43], a[124:127], v[156:159]
  s_or_b32 s26, s30, s29
  s_or_b32 s27, s31, s29
  v_mfma_f32_16x16x32_bf16 v[188:191], a[44:47], a[124:127], v[188:191]
  v_mfma_f32_16x16x32_bf16 v[220:223], a[48:51], a[124:127], v[220:223]
  v_mfma_f32_16x16x32_bf16 v[252:255], a[52:55], a[124:127], v[252:255]
  v_mfma_f32_16x16x32_bf16 a[156:159], a[56:59], a[124:127], a[156:159]
  v_mfma_f32_16x16x32_bf16 a[188:191], a[60:63], a[124:127], a[188:191]
  s_waitcnt lgkmcnt(0)
  v_mfma_f32_16x16x32_bf16 v[128:131], a[8:11], a[64:67], v[128:131]
  ds_read_b128 a[32:35], v17 offset:0
  ds_read_b64_tr_b16 a[96:97], v18 offset:4096
  v_mfma_f32_16x16x32_bf16 v[160:163], a[12:15], a[64:67], v[160:163]
  ds_read_b64_tr_b16 a[98:99], v18 offset:6144
  ds_read_b128 a[36:39], v17 offset:2048
  v_mfma_f32_16x16x32_bf16 v[132:135], a[8:11], a[68:71], v[132:135]
  ds_read_b128 a[40:43], v17 offset:4096
  ds_read_b128 a[44:47], v17 offset:6144
  v_mfma_f32_16x16x32_bf16 v[164:167], a[12:15], a[68:71], v[164:167]
  ds_read_b128 a[48:51], v17 offset:8192
  ds_read_b128 a[52:55], v17 offset:10240
  v_mfma_f32_16x16x32_bf16 v[136:139], a[8:11], a[72:75], v[136:139]
  ds_read_b128 a[56:59], v17 offset:12288
  ds_read_b128 a[60:63], v17 offset:14336
  v_mfma_f32_16x16x32_bf16 v[168:171], a[12:15], a[72:75], v[168:171]
  ds_read_b64_tr_b16 a[100:101], v19 offset:4096
  ds_read_b64_tr_b16 a[102:103], v19 offset:6144
  v_mfma_f32_16x16x32_bf16 v[140:143], a[8:11], a[76:79], v[140:143]
  ds_read_b64_tr_b16 a[104:105], v20 offset:4096
  v_mfma_f32_16x16x32_bf16 v[172:175], a[12:15], a[76:79], v[172:175]
  ds_read_b64_tr_b16 a[106:107], v20 offset:6144
  ds_read_b64_tr_b16 a[108:109], v21 offset:4096
  v_mfma_f32_16x16x32_bf16 v[144:147], a[8:11], a[80:83], v[144:147]
  ds_read_b64_tr_b16 a[110:111], v21 offset:6144
  ds_read_b64_tr_b16 a[112:113], v18 offset:12288
  v_mfma_f32_16x16x32_bf16 v[176:179], a[12:15], a[80:83], v[176:179]
  ds_read_b64_tr_b16 a[114:115], v18 offset:14336
  ds_read_b64_tr_b16 a[116:117], v19 offset:12288
  v_mfma_f32_16x16x32_bf16 v[148:151], a[8:11], a[84:87], v[148:151]
  ds_read_b64_tr_b16 a[118:119], v19 offset:14336
  ds_read_b64_tr_b16 a[120:121], v20 offset:12288
  v_mfma_f32_16x16x32_bf16 v[180:183], a[12:15], a[84:87], v[180:183]
  ds_read_b64_tr_b16 a[122:123], v20 offset:14336
  ds_read_b64_tr_b16 a[124:125], v21 offset:12288
  v_mfma_f32_16x16x32_bf16 v[152:155], a[8:11], a[88:91], v[152:155]
  ds_read_b64_tr_b16 a[126:127], v21 offset:14336
  v_mfma_f32_16x16x32_bf16 v[184:187], a[12:15], a[88:91], v[184:187]
  v_mfma_f32_16x16x32_bf16 v[156:159], a[8:11], a[92:95], v[156:159]
  v_mfma_f32_16x16x32_bf16 v[188:191], a[12:15], a[92:95], v[188:191]
  v_mfma_f32_16x16x32_bf16 v[192:195], a[16:19], a[64:67], v[192:195]
  v_mfma_f32_16x16x32_bf16 v[224:227], a[20:23], a[64:67], v[224:227]
  s_waitcnt lgkmcnt(0)
  s_barrier
  s_mov_b32 s12, s84
  s_mov_b32 s13, s85
  s_mov_b32 s14, 256
  s_mov_b32 s15, 0x00020000
  buffer_load_dwordx2 v[22:23], off, s[12:15], 0 sc1
  v_mfma_f32_16x16x32_bf16 v[128:131], a[40:43], a[96:99], v[128:131]
  s_add_u32 m0, s88, 32768
  v_mfma_f32_16x16x32_bf16 v[160:163], a[44:47], a[96:99], v[160:163]
  buffer_load_dwordx4 v4, s[8:11], s26 offen offset:0 lds
  v_mfma_f32_16x16x32_bf16 v[132:135], a[40:43], a[100:103], v[132:135]
  v_mfma_f32_16x16x32_bf16 v[164:167], a[44:47], a[100:103], v[164:167]
  v_mfma_f32_16x16x32_bf16 v[136:139], a[40:43], a[104:107], v[136:139]
  v_mfma_f32_16x16x32_bf16 v[168:171], a[44:47], a[104:107], v[168:171]
  buffer_load_dwordx4 v5, s[8:11], s26 offen offset:1024 lds
  v_cvt_pk_bf16_f32 v128, v128, v129
  v_mfma_f32_16x16x32_bf16 v[140:143], a[40:43], a[108:111], v[140:143]
  v_cvt_pk_bf16_f32 v129, v130, v131
  v_cvt_pk_bf16_f32 v130, v160, v161
  v_mfma_f32_16x16x32_bf16 v[172:175], a[44:47], a[108:111], v[172:175]
  v_cvt_pk_bf16_f32 v131, v162, v163
  v_cvt_pk_bf16_f32 v132, v132, v133
  v_mfma_f32_16x16x32_bf16 v[144:147], a[40:43], a[112:115], v[144:147]
  v_cvt_pk_bf16_f32 v133, v134, v135
  v_cvt_pk_bf16_f32 v134, v164, v165
  v_mfma_f32_16x16x32_bf16 v[176:179], a[44:47], a[112:115], v[176:179]
  v_cvt_pk_bf16_f32 v135, v166, v167
  v_mfma_f32_16x16x32_bf16 v[148:151], a[40:43], a[116:119], v[148:151]
  buffer_load_dwordx4 v6, s[8:11], s26 offen offset:2048 lds
  v_mfma_f32_16x16x32_bf16 v[180:183], a[44:47], a[116:119], v[180:183]
  s_add_u32 s60, s63, 8192
  buffer_store_dwordx4 v[128:131], v2, s[16:19], s60 offen offset:0 sc1
  v_cvt_pk_bf16_f32 v136, v136, v137
  v_mfma_f32_16x16x32_bf16 v[152:155], a[40:43], a[120:123], v[152:155]
  v_cvt_pk_bf16_f32 v137, v138, v139
  v_cvt_pk_bf16_f32 v138, v168, v169
  v_mfma_f32_16x16x32_bf16 v[184:187], a[44:47], a[120:123], v[184:187]
  v_cvt_pk_bf16_f32 v139, v170, v171
  v_cvt_pk_bf16_f32 v140, v140, v141
  v_mfma_f32_16x16x32_bf16 v[156:159], a[40:43], a[124:127], v[156:159]
  v_cvt_pk_bf16_f32 v141, v142, v143
  v_cvt_pk_bf16_f32 v142, v172, v173
  v_mfma_f32_16x16x32_bf16 v[188:191], a[44:47], a[124:127], v[188:191]
  v_cvt_pk_bf16_f32 v143, v174, v175
  v_cvt_pk_bf16_f32 v144, v144, v145
  v_mfma_f32_16x16x32_bf16 v[192:195], a[48:51], a[96:99], v[192:195]
  buffer_load_dwordx4 v7, s[8:11], s26 offen offset:3072 lds
  v_cvt_pk_bf16_f32 v145, v146, v147
  v_mfma_f32_16x16x32_bf16 v[224:227], a[52:55], a[96:99], v[224:227]
  s_add_u32 m0, s88, 36864
  v_cvt_pk_bf16_f32 v146, v176, v177
  v_cvt_pk_bf16_f32 v147, v178, v179
  v_mfma_f32_16x16x32_bf16 a[128:131], a[24:27], a[64:67], a[128:131]
  s_add_u32 s60, s63, 8192
  buffer_store_dwordx4 v[132:135], v2, s[16:19], s60 offen offset:1024 sc1
  v_cvt_pk_bf16_f32 v148, v148, v149
  v_mfma_f32_16x16x32_bf16 a[160:163], a[28:31], a[64:67], a[160:163]
  v_cvt_pk_bf16_f32 v149, v150, v151
  v_cvt_pk_bf16_f32 v150, v180, v181
  v_mfma_f32_16x16x32_bf16 a[128:131], a[56:59], a[96:99], a[128:131]
  v_cvt_pk_bf16_f32 v151, v182, v183
  v_cvt_pk_bf16_f32 v152, v152, v153
  v_mfma_f32_16x16x32_bf16 a[160:163], a[60:63], a[96:99], a[160:163]
  buffer_load_dwordx4 v4, s[8:11], s27 offen offset:0 lds
  v_cvt_pk_bf16_f32 v153, v154, v155
  v_mfma_f32_16x16x32_bf16 v[196:199], a[16:19], a[68:71], v[196:199]
  v_cvt_pk_bf16_f32 v154, v184, v185
  v_cvt_pk_bf16_f32 v155, v186, v187
  v_mfma_f32_16x16x32_bf16 v[228:231], a[20:23], a[68:71], v[228:231]
  v_cvt_pk_bf16_f32 v156, v156, v157
  v_cvt_pk_bf16_f32 v157, v158, v159
  v_mfma_f32_16x16x32_bf16 v[196:199], a[48:51], a[100:103], v[196:199]
  v_cvt_pk_bf16_f32 v158, v188, v189
  v_cvt_pk_bf16_f32 v159, v190, v191
  v_mfma_f32_16x16x32_bf16 v[228:231], a[52:55], a[100:103], v[228:231]
  v_cvt_pk_bf16_f32 v192, v192, v193
  v_cvt_pk_bf16_f32 v193, v194, v195
  v_mfma_f32_16x16x32_bf16 a[132:135], a[24:27], a[68:71], a[132:135]
  v_cvt_pk_bf16_f32 v194, v224, v225
  v_cvt_pk_bf16_f32 v195, v226, v227
  v_mfma_f32_16x16x32_bf16 a[164:167], a[28:31], a[68:71], a[164:167]
  buffer_load_dwordx4 v5, s[8:11], s27 offen offset:1024 lds
  v_mfma_f32_16x16x32_bf16 a[132:135], a[56:59], a[100:103], a[132:135]
  s_add_u32 s60, s63, 8192
  buffer_store_dwordx4 v[136:139], v2, s[16:19], s60 offen offset:2048 sc1
  v_accvgpr_read_b32 v24, a128
  v_mfma_f32_16x16x32_bf16 a[164:167], a[60:63], a[100:103], a[164:167]
  v_accvgpr_read_b32 v25, a129
  v_accvgpr_read_b32 v26, a130
  v_mfma_f32_16x16x32_bf16 v[200:203], a[16:19], a[72:75], v[200:203]
  v_accvgpr_read_b32 v27, a131
  v_accvgpr_read_b32 v28, a160
  v_mfma_f32_16x16x32_bf16 v[232:235], a[20:23], a[72:75], v[232:235]
  v_accvgpr_read_b32 v29, a161
  v_accvgpr_read_b32 v30, a162
  v_mfma_f32_16x16x32_bf16 v[200:203], a[48:51], a[104:107], v[200:203]
  buffer_load_dwordx4 v6, s[8:11], s27 offen offset:2048 lds
  v_accvgpr_read_b32 v31, a163
  v_mfma_f32_16x16x32_bf16 v[232:235], a[52:55], a[104:107], v[232:235]
  v_cvt_pk_bf16_f32 v224, v24, v25
  v_cvt_pk_bf16_f32 v225, v26, v27
  v_mfma_f32_16x16x32_bf16 a[136:139], a[24:27], a[72:75], a[136:139]
  v_cvt_pk_bf16_f32 v226, v28, v29
  v_cvt_pk_bf16_f32 v227, v30, v31
  v_mfma_f32_16x16x32_bf16 a[168:171], a[28:31], a[72:75], a[168:171]
  v_cvt_pk_bf16_f32 v196, v196, v197
  v_cvt_pk_bf16_f32 v197, v198, v199
  v_mfma_f32_16x16x32_bf16 a[136:139], a[56:59], a[104:107], a[136:139]
  v_cvt_pk_bf16_f32 v198, v228, v229
  v_cvt_pk_bf16_f32 v199, v230, v231
  v_mfma_f32_16x16x32_bf16 a[168:171], a[60:63], a[104:107], a[168:171]
  v_accvgpr_read_b32 v32, a132
  v_accvgpr_read_b32 v33, a133
  v_mfma_f32_16x16x32_bf16 v[204:207], a[16:19], a[76:79], v[204:207]
  buffer_load_dwordx4 v7, s[8:11], s27 offen offset:3072 lds
  v_accvgpr_read_b32 v34, a134
  v_mfma_f32_16x16x32_bf16 v[236:239], a[20:23], a[76:79], v[236:239]
  s_bfe_u32 s29, 0x302010e, s53
  s_add_u32 s52, s52, s29
  s_add_u32 s53, s53, 8
  v_mfma_f32_16x16x32_bf16 v[204:207], a[48:51], a[108:111], v[204:207]
  s_and_b32 s53, s53, 0x8001f
  s_and_b32 s52, s52, 15
  s_lshl_b32 s29, s52, 7
  v_mfma_f32_16x16x32_bf16 v[236:239], a[52:55], a[108:111], v[236:239]
  s_or_b32 s26, s30, s29
  s_or_b32 s27, s31, s29
  s_add_u32 m0, s68, 32768
  v_mfma_f32_16x16x32_bf16 a[140:143], a[24:27], a[76:79], a[140:143]
  v_accvgpr_read_b32 v35, a135
  v_accvgpr_read_b32 v36, a164
  v_mfma_f32_16x16x32_bf16 a[172:175], a[28:31], a[76:79], a[172:175]
  buffer_load_dwordx4 v8, s[20:23], s28 offen offset:0 lds
  v_accvgpr_read_b32 v37, a165
  v_mfma_f32_16x16x32_bf16 a[140:143], a[56:59], a[108:111], a[140:143]
  v_accvgpr_read_b32 v38, a166
  v_accvgpr_read_b32 v39, a167
  v_mfma_f32_16x16x32_bf16 a[172:175], a[60:63], a[108:111], a[172:175]
  v_cvt_pk_bf16_f32 v228, v32, v33
  v_cvt_pk_bf16_f32 v229, v34, v35
  v_mfma_f32_16x16x32_bf16 v[208:211], a[16:19], a[80:83], v[208:211]
  v_cvt_pk_bf16_f32 v230, v36, v37
  v_cvt_pk_bf16_f32 v231, v38, v39
  v_mfma_f32_16x16x32_bf16 v[240:243], a[20:23], a[80:83], v[240:243]
  s_add_u32 s60, s63, 8192
  buffer_store_dwordx4 v[140:143], v2, s[16:19], s60 offen offset:3072 sc1
  v_cvt_pk_bf16_f32 v200, v200, v201
  v_mfma_f32_16x16x32_bf16 v[208:211], a[48:51], a[112:115], v[208:211]
  v_cvt_pk_bf16_f32 v201, v202, v203
  v_cvt_pk_bf16_f32 v202, v232, v233
  v_mfma_f32_16x16x32_bf16 v[240:243], a[52:55], a[112:115], v[240:243]
  buffer_load_dwordx4 v9, s[20:23], s28 offen offset:1024 lds
  v_cvt_pk_bf16_f32 v203, v234, v235
  v_mfma_f32_16x16x32_bf16 a[144:147], a[24:27], a[80:83], a[144:147]
  v_accvgpr_read_b32 v40, a136
  v_accvgpr_read_b32 v41, a137
  v_mfma_f32_16x16x32_bf16 a[176:179], a[28:31], a[80:83], a[176:179]
  v_accvgpr_read_b32 v42, a138
  v_accvgpr_read_b32 v43, a139
  v_mfma_f32_16x16x32_bf16 a[144:147], a[56:59], a[112:115], a[144:147]
  v_accvgpr_read_b32 v44, a168
  v_accvgpr_read_b32 v45, a169
  v_mfma_f32_16x16x32_bf16 a[176:179], a[60:63], a[112:115], a[176:179]
  v_accvgpr_read_b32 v46, a170
  v_accvgpr_read_b32 v47, a171
  v_mfma_f32_16x16x32_bf16 v[212:215], a[16:19], a[84:87], v[212:215]
  buffer_load_dwordx4 v10, s[20:23], s28 offen offset:2048 lds
  v_cvt_pk_bf16_f32 v232, v40, v41
  v_mfma_f32_16x16x32_bf16 v[244:247], a[20:23], a[84:87], v[244:247]
  v_cvt_pk_bf16_f32 v233, v42, v43
  v_cvt_pk_bf16_f32 v234, v44, v45
  v_mfma_f32_16x16x32_bf16 v[212:215], a[48:51], a[116:119], v[212:215]
  v_cvt_pk_bf16_f32 v235, v46, v47
  v_cvt_pk_bf16_f32 v204, v204, v205
  v_mfma_f32_16x16x32_bf16 v[244:247], a[52:55], a[116:119], v[244:247]
  v_cvt_pk_bf16_f32 v205, v206, v207
  v_cvt_pk_bf16_f32 v206, v236, v237
  v_mfma_f32_16x16x32_bf16 a[148:151], a[24:27], a[84:87], a[148:151]
  v_cvt_pk_bf16_f32 v207, v238, v239
  v_accvgpr_read_b32 v24, a140
  v_mfma_f32_16x16x32_bf16 a[180:183], a[28:31], a[84:87], a[180:183]
  buffer_load_dwordx4 v11, s[20:23], s28 offen offset:3072 lds
  v_accvgpr_read_b32 v25, a141
  v_mfma_f32_16x16x32_bf16 a[148:151], a[56:59], a[116:119], a[148:151]
  s_bfe_u32 s56, 0x302010e, s55
  s_add_u32 s54, s54, s56
  s_add_u32 s55, s55, 8
  v_mfma_f32_16x16x32_bf16 a[180:183], a[60:63], a[116:119], a[180:183]
  s_and_b32 s55, s55, 0x8001f
  s_and_b32 s54, s54, 15
  s_lshl_b32 s28, s54, 19
  v_mfma_f32_16x16x32_bf16 v[216:219], a[16:19], a[88:91], v[216:219]
  s_add_u32 m0, s88, -32768
  v_accvgpr_read_b32 v26, a142
  v_accvgpr_read_b32 v27, a143
  v_mfma_f32_16x16x32_bf16 v[248:251], a[20:23], a[88:91], v[248:251]
  v_accvgpr_read_b32 v28, a172
  v_accvgpr_read_b32 v29, a173
  v_mfma_f32_16x16x32_bf16 v[216:219], a[48:51], a[120:123], v[216:219]
  v_accvgpr_read_b32 v30, a174
  v_accvgpr_read_b32 v31, a175
  v_mfma_f32_16x16x32_bf16 v[248:251], a[52:55], a[120:123], v[248:251]
  buffer_load_dwordx4 v4, s[8:11], s26 offen offset:0 lds
  v_cvt_pk_bf16_f32 v236, v24, v25
  v_mfma_f32_16x16x32_bf16 a[152:155], a[24:27], a[88:91], a[152:155]
  v_cvt_pk_bf16_f32 v237, v26, v27
  v_cvt_pk_bf16_f32 v238, v28, v29
  v_mfma_f32_16x16x32_bf16 a[184:187], a[28:31], a[88:91], a[184:187]
  v_cvt_pk_bf16_f32 v239, v30, v31
  v_mfma_f32_16x16x32_bf16 a[152:155], a[56:59], a[120:123], a[152:155]
  s_add_u32 s60, s63, 12288
  buffer_store_dwordx4 v[144:147], v2, s[16:19], s60 offen offset:0 sc1
  v_cvt_pk_bf16_f32 v208, v208, v209
  v_mfma_f32_16x16x32_bf16 a[184:187], a[60:63], a[120:123], a[184:187]
  v_cvt_pk_bf16_f32 v209, v210, v211
  v_cvt_pk_bf16_f32 v210, v240, v241
  v_mfma_f32_16x16x32_bf16 v[220:223], a[16:19], a[92:95], v[220:223]
  buffer_load_dwordx4 v5, s[8:11], s26 offen offset:1024 lds
  v_cvt_pk_bf16_f32 v211, v242, v243
  v_mfma_f32_16x16x32_bf16 v[252:255], a[20:23], a[92:95], v[252:255]
  v_accvgpr_read_b32 v32, a144
  v_accvgpr_read_b32 v33, a145
  v_mfma_f32_16x16x32_bf16 v[220:223], a[48:51], a[124:127], v[220:223]
  v_accvgpr_read_b32 v34, a146
  v_accvgpr_read_b32 v35, a147
  v_mfma_f32_16x16x32_bf16 v[252:255], a[52:55], a[124:127], v[252:255]
  v_accvgpr_read_b32 v36, a176
  v_accvgpr_read_b32 v37, a177
  v_mfma_f32_16x16x32_bf16 a[156:159], a[24:27], a[92:95], a[156:159]
  v_accvgpr_read_b32 v38, a178
  v_accvgpr_read_b32 v39, a179
  v_mfma_f32_16x16x32_bf16 a[188:191], a[28:31], a[92:95], a[188:191]
  v_cvt_pk_bf16_f32 v240, v32, v33
  v_cvt_pk_bf16_f32 v241, v34, v35
  v_mfma_f32_16x16x32_bf16 a[156:159], a[56:59], a[124:127], a[156:159]
  buffer_load_dwordx4 v6, s[8:11], s26 offen offset:2048 lds
  v_cvt_pk_bf16_f32 v242, v36, v37
  v_mfma_f32_16x16x32_bf16 a[188:191], a[60:63], a[124:127], a[188:191]
  v_cvt_pk_bf16_f32 v243, v38, v39
  v_cvt_pk_bf16_f32 v212, v212, v213
  v_mfma_f32_16x16x32_bf16 v[64:67], a[0:3], a[64:67], v[64:67]
  v_cvt_pk_bf16_f32 v213, v214, v215
  v_cvt_pk_bf16_f32 v214, v244, v245
  v_mfma_f32_16x16x32_bf16 v[96:99], a[4:7], a[64:67], v[96:99]
  v_cvt_pk_bf16_f32 v215, v246, v247
  v_mfma_f32_16x16x32_bf16 v[64:67], a[32:35], a[96:99], v[64:67]
  s_add_u32 s60, s63, 12288
  buffer_store_dwordx4 v[148:151], v2, s[16:19], s60 offen offset:1024 sc1
  v_accvgpr_read_b32 v40, a148
  v_mfma_f32_16x16x32_bf16 v[96:99], a[36:39], a[96:99], v[96:99]
  buffer_load_dwordx4 v7, s[8:11], s26 offen offset:3072 lds
  v_accvgpr_read_b32 v41, a149
  v_mfma_f32_16x16x32_bf16 v[68:71], a[0:3], a[68:71], v[68:71]
  s_add_u32 m0, s88, -28672
  v_accvgpr_read_b32 v42, a150
  v_accvgpr_read_b32 v43, a151
  v_mfma_f32_16x16x32_bf16 v[100:103], a[4:7], a[68:71], v[100:103]
  v_accvgpr_read_b32 v44, a180
  v_accvgpr_read_b32 v45, a181
  v_mfma_f32_16x16x32_bf16 v[68:71], a[32:35], a[100:103], v[68:71]
  v_accvgpr_read_b32 v46, a182
  v_accvgpr_read_b32 v47, a183
  v_mfma_f32_16x16x32_bf16 v[100:103], a[36:39], a[100:103], v[100:103]
  v_cvt_pk_bf16_f32 v244, v40, v41
  v_cvt_pk_bf16_f32 v245, v42, v43
  v_mfma_f32_16x16x32_bf16 v[72:75], a[0:3], a[72:75], v[72:75]
  v_cvt_pk_bf16_f32 v246, v44, v45
  v_cvt_pk_bf16_f32 v247, v46, v47
  v_mfma_f32_16x16x32_bf16 v[104:107], a[4:7], a[72:75], v[104:107]
  buffer_load_dwordx4 v4, s[8:11], s27 offen offset:0 lds
  v_cvt_pk_bf16_f32 v216, v216, v217
  v_mfma_f32_16x16x32_bf16 v[72:75], a[32:35], a[104:107], v[72:75]
  v_cvt_pk_bf16_f32 v217, v218, v219
  v_cvt_pk_bf16_f32 v218, v248, v249
  v_mfma_f32_16x16x32_bf16 v[104:107], a[36:39], a[104:107], v[104:107]
  v_cvt_pk_bf16_f32 v219, v250, v251
  v_accvgpr_read_b32 v24, a152
  v_mfma_f32_16x16x32_bf16 v[76:79], a[0:3], a[76:79], v[76:79]
  v_accvgpr_read_b32 v25, a153
  v_accvgpr_read_b32 v26, a154
  v_mfma_f32_16x16x32_bf16 v[108:111], a[4:7], a[76:79], v[108:111]
  v_accvgpr_read_b32 v27, a155
  v_accvgpr_read_b32 v28, a184
  v_mfma_f32_16x16x32_bf16 v[76:79], a[32:35], a[108:111], v[76:79]
  buffer_load_dwordx4 v5, s[8:11], s27 offen offset:1024 lds
  v_accvgpr_read_b32 v29, a185
  v_mfma_f32_16x16x32_bf16 v[108:111], a[36:39], a[108:111], v[108:111]
  v_accvgpr_read_b32 v30, a186
  v_accvgpr_read_b32 v31, a187
  v_mfma_f32_16x16x32_bf16 v[80:83], a[0:3], a[80:83], v[80:83]
  v_cvt_pk_bf16_f32 v248, v24, v25
  v_cvt_pk_bf16_f32 v249, v26, v27
  v_mfma_f32_16x16x32_bf16 v[112:115], a[4:7], a[80:83], v[112:115]
  v_cvt_pk_bf16_f32 v250, v28, v29
  v_cvt_pk_bf16_f32 v251, v30, v31
  v_mfma_f32_16x16x32_bf16 v[80:83], a[32:35], a[112:115], v[80:83]
  v_cvt_pk_bf16_f32 v220, v220, v221
  v_cvt_pk_bf16_f32 v221, v222, v223
  v_mfma_f32_16x16x32_bf16 v[112:115], a[36:39], a[112:115], v[112:115]
  v_cvt_pk_bf16_f32 v222, v252, v253
  v_cvt_pk_bf16_f32 v223, v254, v255
  v_mfma_f32_16x16x32_bf16 v[84:87], a[0:3], a[84:87], v[84:87]
  buffer_load_dwordx4 v6, s[8:11], s27 offen offset:2048 lds
  v_mfma_f32_16x16x32_bf16 v[116:119], a[4:7], a[84:87], v[116:119]
  s_add_u32 s60, s63, 12288
  buffer_store_dwordx4 v[152:155], v2, s[16:19], s60 offen offset:2048 sc1
  v_accvgpr_read_b32 v32, a156
  v_mfma_f32_16x16x32_bf16 v[84:87], a[32:35], a[116:119], v[84:87]
  v_accvgpr_read_b32 v33, a157
  v_accvgpr_read_b32 v34, a158
  v_mfma_f32_16x16x32_bf16 v[116:119], a[36:39], a[116:119], v[116:119]
  v_accvgpr_read_b32 v35, a159
  v_accvgpr_read_b32 v36, a188
  v_mfma_f32_16x16x32_bf16 v[88:91], a[0:3], a[88:91], v[88:91]
  v_accvgpr_read_b32 v37, a189
  v_accvgpr_read_b32 v38, a190
  v_mfma_f32_16x16x32_bf16 v[120:123], a[4:7], a[88:91], v[120:123]
  buffer_load_dwordx4 v7, s[8:11], s27 offen offset:3072 lds
  v_accvgpr_read_b32 v39, a191
  v_mfma_f32_16x16x32_bf16 v[88:91], a[32:35], a[120:123], v[88:91]
  s_bfe_u32 s29, 0x302010e, s53
  s_add_u32 s52, s52, s29
  s_add_u32 s53, s53, 8
  v_mfma_f32_16x16x32_bf16 v[120:123], a[36:39], a[120:123], v[120:123]
  s_and_b32 s53, s53, 0x8001f
  s_and_b32 s52, s52, 15
  s_lshl_b32 s29, s52, 7
  v_mfma_f32_16x16x32_bf16 v[92:95], a[0:3], a[92:95], v[92:95]
  s_or_b32 s26, s30, s29
  s_or_b32 s27, s31, s29
  v_cvt_pk_bf16_f32 v252, v32, v33
  v_mfma_f32_16x16x32_bf16 v[124:127], a[4:7], a[92:95], v[124:127]
  v_cvt_pk_bf16_f32 v253, v34, v35
  v_cvt_pk_bf16_f32 v254, v36, v37
  v_mfma_f32_16x16x32_bf16 v[92:95], a[32:35], a[124:127], v[92:95]
  v_cvt_pk_bf16_f32 v255, v38, v39
  v_cvt_pk_bf16_f32 v160, v64, v65
  v_mfma_f32_16x16x32_bf16 v[124:127], a[36:39], a[124:127], v[124:127]
  v_cvt_pk_bf16_f32 v161, v66, v67
  v_cvt_pk_bf16_f32 v162, v96, v97
  v_cvt_pk_bf16_f32 v163, v98, v99
  v_cvt_pk_bf16_f32 v164, v68, v69
  v_cvt_pk_bf16_f32 v165, v70, v71
  v_cvt_pk_bf16_f32 v166, v100, v101
  v_cvt_pk_bf16_f32 v167, v102, v103
  s_add_u32 s60, s63, 12288
  buffer_store_dwordx4 v[156:159], v2, s[16:19], s60 offen offset:3072 sc1
  v_cvt_pk_bf16_f32 v168, v72, v73
  v_cvt_pk_bf16_f32 v169, v74, v75
  v_cvt_pk_bf16_f32 v170, v104, v105
  v_cvt_pk_bf16_f32 v171, v106, v107
  v_cvt_pk_bf16_f32 v172, v76, v77
  v_cvt_pk_bf16_f32 v173, v78, v79
  v_cvt_pk_bf16_f32 v174, v108, v109
  v_cvt_pk_bf16_f32 v175, v110, v111
  v_cvt_pk_bf16_f32 v176, v80, v81
  v_cvt_pk_bf16_f32 v177, v82, v83
  v_cvt_pk_bf16_f32 v178, v112, v113
  v_cvt_pk_bf16_f32 v179, v114, v115
  v_cvt_pk_bf16_f32 v180, v84, v85
  v_cvt_pk_bf16_f32 v181, v86, v87
  v_cvt_pk_bf16_f32 v182, v116, v117
  v_cvt_pk_bf16_f32 v183, v118, v119
  v_cvt_pk_bf16_f32 v184, v88, v89
  v_cvt_pk_bf16_f32 v185, v90, v91
  v_cvt_pk_bf16_f32 v186, v120, v121
  v_cvt_pk_bf16_f32 v187, v122, v123
  v_cvt_pk_bf16_f32 v188, v92, v93
  v_cvt_pk_bf16_f32 v189, v94, v95
  v_cvt_pk_bf16_f32 v190, v124, v125
  v_cvt_pk_bf16_f32 v191, v126, v127
  s_lshl_b32 s34, s62, 4
  s_add_u32 s34, s34, s61
  s_lshl_b32 s34, s34, 7
  s_branch Lp3
Lp2:
  s_and_b32 s4, s2, 1
  s_lshl_b32 s4, s4, 2
  s_and_b32 s5, s59, 3
  s_add_u32 s32, s4, s5
  s_bfe_u32 s4, s2, 0x20001
  s_lshl_b32 s4, s4, 2
  s_lshr_b32 s5, s59, 2
  s_add_u32 s33, s4, s5
  s_and_b32 s4, s2, 7
  s_lshl_b32 s4, s4, 1
  s_add_u32 s5, s32, s33
  s_and_b32 s49, s5, 3
  s_lshl_b32 s49, s49, 3
  s_or_b32 s49, s49, 0x80000
  s_bfe_u32 s48, 0xf0f02, s49
  s_add_u32 s48, s48, s4
  s_and_b32 s48, s48, 15
  s_lshl_b32 s46, s48, 7
  s_lshl_b32 s36, s3, 13
  s_mul_i32 s41, s3, 6144
  s_add_u32 s41, s41, 104448
  s_mul_i32 s4, s3, 7168
  s_sub_u32 s50, 32768, s4
  v_lshrrev_b32 v240, 3, v1
  v_and_b32 v241, 6, v240
  v_and_b32 v242, 7, v1
  v_xor_b32 v241, v241, v242
  v_lshlrev_b32 v241, 4, v241
  s_lshl_b32 s4, s3, 6
  s_add_u32 s4, s4, 16
  v_add_u32 v242, s4, v240
  v_lshl_add_u32 v242, v242, 11, v241
  v_add_u32 v224, 0, v242
  v_add_u32 v225, 15360, v242
  v_add_u32 v226, 30720, v242
  v_add_u32 v227, 46080, v242
  v_add_u32 v228, 65536, v242
  v_add_u32 v229, 80896, v242
  v_add_u32 v230, 96256, v242
  v_add_u32 v231, 111616, v242
  s_lshl_b32 s4, s3, 14
  s_cmp_eq_u32 s32, 0
  s_cselect_b32 s4, 0x40000000, s4
  v_lshl_add_u32 v242, v240, 11, v241
  v_add_u32 v232, s4, v242
  v_lshrrev_b32 v242, 2, v240
  v_and_b32 v243, 3, v240
  v_lshl_add_u32 v242, v242, 3, v243
  v_mul_u32_u24 v242, 6144, v242
  v_add_u32 v242, v242, v241
  s_lshl_b32 s4, s33, 7
  v_add_u32 v242, s4, v242
  s_mul_i32 s6, s3, 6
  s_add_u32 s7, s6, 0
  s_bfe_u32 s4, s7, 0x10002
  s_lshl_b32 s4, s4, 5
  s_and_b32 s5, s7, 1
  s_lshl_b32 s5, s5, 4
  s_add_u32 s4, s4, s5
  s_bfe_u32 s5, s7, 0x10001
  s_lshl_b32 s5, s5, 2
  s_add_u32 s4, s4, s5
  s_mul_i32 s4, s4, 6144
  s_lshr_b32 s5, s7, 3
  s_lshl_b32 s5, s5, 11
  s_add_u32 s4, s4, s5
  s_add_u32 s4, s4, 2048
  v_add_u32 v233, s4, v242
  s_add_u32 s7, s6, 1
  s_bfe_u32 s4, s7, 0x10002
  s_lshl_b32 s4, s4, 5
  s_and_b32 s5, s7, 1
  s_lshl_b32 s5, s5, 4
  s_add_u32 s4, s4, s5
  s_bfe_u32 s5, s7, 0x10001
  s_lshl_b32 s5, s5, 2
  s_add_u32 s4, s4, s5
  s_mul_i32 s4, s4, 6144
  s_lshr_b32 s5, s7, 3
  s_lshl_b32 s5, s5, 11
  s_add_u32 s4, s4, s5
  s_add_u32 s4, s4, 1024
  v_add_u32 v234, s4, v242
  s_add_u32 s7, s6, 2
  s_bfe_u32 s4, s7, 0x10002
  s_lshl_b32 s4, s4, 5
  s_and_b32 s5, s7, 1
  s_lshl_b32 s5, s5, 4
  s_add_u32 s4, s4, s5
  s_bfe_u32 s5, s7, 0x10001
  s_lshl_b32 s5, s5, 2
  s_add_u32 s4, s4, s5
  s_mul_i32 s4, s4, 6144
  s_lshr_b32 s5, s7, 3
  s_lshl_b32 s5, s5, 11
  s_add_u32 s4, s4, s5
  s_add_u32 s4, s4, 0
  v_add_u32 v235, s4, v242
  s_add_u32 s7, s6, 3
  s_bfe_u32 s4, s7, 0x10002
  s_lshl_b32 s4, s4, 5
  s_and_b32 s5, s7, 1
  s_lshl_b32 s5, s5, 4
  s_add_u32 s4, s4, s5
  s_bfe_u32 s5, s7, 0x10001
  s_lshl_b32 s5, s5, 2
  s_add_u32 s4, s4, s5
  s_mul_i32 s4, s4, 6144
  s_lshr_b32 s5, s7, 3
  s_lshl_b32 s5, s5, 11
  s_add_u32 s4, s4, s5
  s_add_u32 s4, s4, 2048
  v_add_u32 v236, s4, v242
  s_add_u32 s7, s6, 4
  s_bfe_u32 s4, s7, 0x10002
  s_lshl_b32 s4, s4, 5
  s_and_b32 s5, s7, 1
  s_lshl_b32 s5, s5, 4
  s_add_u32 s4, s4, s5
  s_bfe_u32 s5, s7, 0x10001
  s_lshl_b32 s5, s5, 2
  s_add_u32 s4, s4, s5
  s_mul_i32 s4, s4, 6144
  s_lshr_b32 s5, s7, 3
  s_lshl_b32 s5, s5, 11
  s_add_u32 s4, s4, s5
  s_add_u32 s4, s4, 1024
  v_add_u32 v237, s4, v242
  s_add_u32 s7, s6, 5
  s_bfe_u32 s4, s7, 0x10002
  s_lshl_b32 s4, s4, 5
  s_and_b32 s5, s7, 1
  s_lshl_b32 s5, s5, 4
  s_add_u32 s4, s4, s5
  s_bfe_u32 s5, s7, 0x10001
  s_lshl_b32 s5, s5, 2
  s_add_u32 s4, s4, s5
  s_mul_i32 s4, s4, 6144
  s_lshr_b32 s5, s7, 3
  s_lshl_b32 s5, s5, 11
  s_add_u32 s4, s4, s5
  s_add_u32 s4, s4, 0
  v_add_u32 v238, s4, v242
  s_waitcnt lgkmcnt(0)
  s_lshl_b32 s10, s32, 19
  s_add_u32 s8, s76, s10
  s_addc_u32 s9, s77, 0
  s_sub_u32 s8, s8, 32768
  s_subb_u32 s9, s9, 0
  s_mov_b32 s10, 557056
  s_mov_b32 s11, 0x00020000
  s_sub_u32 s12, s78, 2048
  s_subb_u32 s13, s79, 0
  s_mov_b32 s14, 6293504
  s_mov_b32 s15, 0x00020000
  s_add_u32 s96, s86, 125829120
  s_addc_u32 s97, s87, 0
  s_mov_b32 s98, 262144
  s_mov_b32 s99, 0x00020000
  s_cmp_ge_u32 s3, 2
  s_cbranch_scc1 Lp2_r1
  s_add_u32 m0, s36, s50
  s_nop 0
  buffer_load_dwordx4 v232, s[8:11], s46 offen offset:0 lds
  s_mov_b32 m0, s36
  s_nop 0
  buffer_load_dwordx4 v224, s[8:11], s46 offen offset:0 lds
  buffer_load_dwordx4 v225, s[8:11], s46 offen offset:1024 lds
  buffer_load_dwordx4 v226, s[8:11], s46 offen offset:2048 lds
  buffer_load_dwordx4 v227, s[8:11], s46 offen offset:3072 lds
  s_add_u32 m0, s36, 4096
  s_nop 0
  buffer_load_dwordx4 v228, s[8:11], s46 offen offset:0 lds
  buffer_load_dwordx4 v229, s[8:11], s46 offen offset:1024 lds
  buffer_load_dwordx4 v230, s[8:11], s46 offen offset:2048 lds
  buffer_load_dwordx4 v231, s[8:11], s46 offen offset:3072 lds
  s_mul_i32 s47, s48, 393216
  s_bfe_u32 s34, 0x302010e, s49
  s_add_u32 s48, s48, s34
  s_add_u32 s49, s49, 8
  s_and_b32 s49, s49, 0x8001f
  s_and_b32 s48, s48, 15
  s_lshl_b32 s46, s48, 7
  s_mov_b32 m0, s41
  s_nop 0
  buffer_load_dwordx4 v233, s[12:15], s47 offen offset:0 lds
  buffer_load_dwordx4 v234, s[12:15], s47 offen offset:1024 lds
  buffer_load_dwordx4 v235, s[12:15], s47 offen offset:2048 lds
  s_add_u32 m0, s41, 3072
  s_nop 0
  buffer_load_dwordx4 v236, s[12:15], s47 offen offset:0 lds
  buffer_load_dwordx4 v237, s[12:15], s47 offen offset:1024 lds
  buffer_load_dwordx4 v238, s[12:15], s47 offen offset:2048 lds
  s_lshr_b32 s4, s3, 1
  s_lshl_b32 s4, s4, 14
  v_and_b32 v240, 15, v1
  v_lshlrev_b32 v240, 7, v240
  v_lshrrev_b32 v241, 4, v1
  v_and_b32 v242, 6, v1
  v_xor_b32 v241, v241, v242
  v_lshl_add_u32 v240, v241, 4, v240
  v_add_u32 v16, s4, v240
  v_xor_b32 v17, 64, v16
  v_and_b32 v240, 15, v1
  v_lshlrev_b32 v240, 7, v240
  v_lshrrev_b32 v241, 4, v1
  v_and_b32 v242, 6, v1
  v_xor_b32 v241, v241, v242
  v_lshl_add_u32 v240, v241, 4, v240
  v_add_u32 v18, 32768, v240
  v_xor_b32 v19, 64, v18
  v_lshrrev_b32 v240, 2, v1
  v_and_b32 v241, 6, v240
  v_lshlrev_b32 v240, 7, v240
  v_and_b32 v242, 1, v1
  v_lshl_add_u32 v240, v242, 3, v240
  v_add_u32 v240, 104448, v240
  v_bfe_u32 v242, v1, 1, 1
  v_xor_b32 v241, v241, v242
  v_xor_b32 v242, 0, v241
  v_lshl_add_u32 v20, v242, 4, v240
  v_xor_b32 v242, 2, v241
  s_add_u32 m0, s36, s50
  s_add_u32 m0, m0, 34816
  s_nop 0
  buffer_load_dwordx4 v232, s[8:11], s46 offen offset:0 lds
  v_lshl_add_u32 v21, v242, 4, v240
  s_and_b32 s4, s3, 1
  s_lshl_b32 s4, s4, 6
  v_xor_b32 v20, s4, v20
  v_xor_b32 v21, s4, v21
  s_and_b32 s24, s2, 7
  s_lshr_b32 s4, s2, 6
  s_lshl_b32 s4, s4, 3
  s_add_u32 s24, s24, s4
  s_lshr_b32 s25, s2, 3
  s_and_b32 s25, s25, 7
  v_lshrrev_b32 v24, 3, v1
  v_and_b32 v25, 6, v24
  v_and_b32 v26, 7, v1
  v_xor_b32 v25, v25, v26
  v_lshlrev_b32 v25, 4, v25
  s_and_b32 s4, s3, 1
  s_lshl_b32 s4, s4, 16
  s_lshr_b32 s5, s3, 1
  s_lshl_b32 s5, s5, 7
  s_add_u32 s4, s4, s5
  v_lshl_add_u32 v24, v24, 11, v25
  v_add_u32 v24, s4, v24
  s_add_u32 m0, s36, 34816
  s_nop 0
  buffer_load_dwordx4 v224, s[8:11], s46 offen offset:0 lds
  v_add_u32 v25, 0, v24
  v_accvgpr_write_b32 a212, v25
  v_add_u32 v25, 15360, v24
  v_accvgpr_write_b32 a213, v25
  v_add_u32 v25, 30720, v24
  v_accvgpr_write_b32 a214, v25
  v_add_u32 v25, 46080, v24
  buffer_load_dwordx4 v225, s[8:11], s46 offen offset:1024 lds
  v_accvgpr_write_b32 a215, v25
  v_accvgpr_write_b32 a236, 0
  v_mov_b32 v27, 0x3f803f80
  v_accvgpr_write_b32 a208, v27
  v_accvgpr_write_b32 a237, 0
  v_accvgpr_write_b32 a209, v27
  v_accvgpr_write_b32 a238, 0
  buffer_load_dwordx4 v226, s[8:11], s46 offen offset:2048 lds
  v_accvgpr_write_b32 a210, v27
  v_accvgpr_write_b32 a239, 0
  v_accvgpr_write_b32 a211, v27
  v_lshrrev_b32 v24, 3, v1
  v_and_b32 v25, 6, v24
  v_and_b32 v26, 7, v1
  v_xor_b32 v25, v25, v26
  buffer_load_dwordx4 v227, s[8:11], s46 offen offset:3072 lds
  v_lshlrev_b32 v25, 4, v25
  v_lshlrev_b32 v26, 2, v24
  v_add_u32 v26, s3, v26
  v_lshl_add_u32 v26, v26, 11, v25
  v_add_u32 v27, 0, v26
  v_accvgpr_write_b32 a222, v27
  v_add_u32 v27, 64512, v26
  s_add_u32 m0, s36, 38912
  s_nop 0
  buffer_load_dwordx4 v228, s[8:11], s46 offen offset:0 lds
  v_accvgpr_write_b32 a223, v27
  v_add_u32 v27, 129024, v26
  v_accvgpr_write_b32 a224, v27
  v_add_u32 v27, 193536, v26
  v_accvgpr_write_b32 a225, v27
  v_lshrrev_b32 v26, 2, v24
  v_and_b32 v27, 3, v24
  buffer_load_dwordx4 v229, s[8:11], s46 offen offset:1024 lds
  v_lshl_add_u32 v26, v26, 3, v27
  s_and_b32 s4, s3, 1
  s_lshl_b32 s4, s4, 18
  s_lshr_b32 s5, s3, 1
  s_lshl_b32 s5, s5, 7
  s_add_u32 s4, s4, s5
  s_lshl_b32 s5, s24, 8
  s_add_u32 s4, s4, s5
  v_lshl_add_u32 v26, v26, 13, v25
  v_add_u32 v26, s4, v26
  v_add_u32 v27, 0, v26
  v_accvgpr_write_b32 a226, v27
  v_add_u32 v27, 130048, v26
  v_accvgpr_write_b32 a227, v27
  v_add_u32 v27, 30720, v26
  buffer_load_dwordx4 v230, s[8:11], s46 offen offset:2048 lds
  v_accvgpr_write_b32 a228, v27
  v_add_u32 v27, 160768, v26
  v_accvgpr_write_b32 a229, v27
  s_lshl_b32 s4, s3, 13
  s_add_u32 s4, s4, 98304
  v_and_b32 v24, 15, v1
  v_lshlrev_b32 v24, 7, v24
  v_lshrrev_b32 v25, 4, v1
  v_and_b32 v26, 6, v1
  v_xor_b32 v25, v25, v26
  buffer_load_dwordx4 v231, s[8:11], s46 offen offset:3072 lds
  v_lshl_add_u32 v24, v25, 4, v24
  v_add_u32 v28, s4, v24
  v_xor_b32 v29, 64, v28
  v_lshrrev_b32 v24, 2, v1
  v_and_b32 v25, 6, v24
  v_lshlrev_b32 v24, 7, v24
  v_and_b32 v26, 1, v1
  s_mul_i32 s47, s48, 393216
  s_bfe_u32 s34, 0x302010e, s49
  s_add_u32 s48, s48, s34
  s_add_u32 s49, s49, 8
  s_and_b32 s49, s49, 0x8001f
  s_and_b32 s48, s48, 15
  s_lshl_b32 s46, s48, 7
  s_add_u32 m0, s41, 24576
  s_nop 0
  buffer_load_dwordx4 v233, s[12:15], s47 offen offset:0 lds
  v_lshl_add_u32 v24, v26, 3, v24
  v_add_u32 v24, 0, v24
  v_bfe_u32 v26, v1, 1, 1
  v_xor_b32 v25, v25, v26
  v_xor_b32 v26, 0, v25
  v_lshl_add_u32 v30, v26, 4, v24
  v_xor_b32 v26, 2, v25
  buffer_load_dwordx4 v234, s[12:15], s47 offen offset:1024 lds
  v_lshl_add_u32 v31, v26, 4, v24
  v_xor_b32 v26, 4, v25
  v_lshl_add_u32 v32, v26, 4, v24
  v_xor_b32 v26, 6, v25
  v_lshl_add_u32 v33, v26, 4, v24
  v_accvgpr_write_b32 a230, v28
  v_accvgpr_write_b32 a231, v29
  buffer_load_dwordx4 v235, s[12:15], s47 offen offset:2048 lds
  v_accvgpr_write_b32 a232, v30
  v_accvgpr_write_b32 a233, v31
  v_accvgpr_write_b32 a234, v32
  v_accvgpr_write_b32 a235, v33
  v_and_b32 v253, 15, v1
  v_lshrrev_b32 v254, 4, v1
  v_lshlrev_b32 v254, 2, v254
  s_add_u32 m0, s41, 27648
  s_nop 0
  buffer_load_dwordx4 v236, s[12:15], s47 offen offset:0 lds
  v_sub_u32 v253, v253, v254
  v_mov_b32 v254, 0xf149f2ca
  s_lshr_b32 s4, s3, 1
  s_or_b32 s4, s4, s32
  s_cselect_b64 s[6:7], 0, -1
  v_subrev_u32 v255, 0, v253
  v_and_b32 v252, 0x80000001, v255
  v_cmp_ne_u32 vcc, 0, v252
  s_nop 1
  v_cndmask_b32 v244, 0, v254, vcc
  v_add_u32 v255, 1, v255
  v_and_b32 v252, 0x80000001, v255
  v_cmp_ne_u32 vcc, 0x80000001, v252
  s_nop 1
  v_cndmask_b32 v240, 0, v254, vcc
  v_cndmask_b32 v248, v240, v254, s[6:7]
  v_subrev_u32 v255, 1, v253
  buffer_load_dwordx4 v237, s[12:15], s47 offen offset:1024 lds
  v_and_b32 v252, 0x80000001, v255
  v_cmp_ne_u32 vcc, 0, v252
  s_nop 1
  v_cndmask_b32 v245, 0, v254, vcc
  v_add_u32 v255, 1, v255
  v_and_b32 v252, 0x80000001, v255
  v_cmp_ne_u32 vcc, 0x80000001, v252
  s_nop 1
  v_cndmask_b32 v241, 0, v254, vcc
  v_cndmask_b32 v249, v241, v254, s[6:7]
  v_subrev_u32 v255, 2, v253
  v_and_b32 v252, 0x80000001, v255
  v_cmp_ne_u32 vcc, 0, v252
  s_nop 1
  v_cndmask_b32 v246, 0, v254, vcc
  v_add_u32 v255, 1, v255
  buffer_load_dwordx4 v238, s[12:15], s47 offen offset:2048 lds
  v_and_b32 v252, 0x80000001, v255
  v_cmp_ne_u32 vcc, 0x80000001, v252
  s_nop 1
  v_cndmask_b32 v242, 0, v254, vcc
  v_cndmask_b32 v250, v242, v254, s[6:7]
  v_subrev_u32 v255, 3, v253
  v_and_b32 v252, 0x80000001, v255
  v_cmp_ne_u32 vcc, 0, v252
  s_nop 1
  v_cndmask_b32 v247, 0, v254, vcc
  v_add_u32 v255, 1, v255
  v_and_b32 v252, 0x80000001, v255
  v_cmp_ne_u32 vcc, 0x80000001, v252
  s_nop 1
  v_cndmask_b32 v243, 0, v254, vcc
  v_cndmask_b32 v251, v243, v254, s[6:7]
  s_and_b32 s4, s3, 1
  s_lshl_b32 s4, s4, 12
  s_add_u32 s4, s4, 49152
  v_add_u32 v252, s4, v2
  s_lshr_b32 s5, s3, 1
  s_lshl_b32 s5, s5, 11
  v_add_u32 v253, s5, v252
  s_add_u32 s16, s86, 83886080
  s_addc_u32 s17, s87, 0
  s_mov_b32 s18, 4194304
  s_mov_b32 s19, 0x00020000
  s_lshl_b32 s57, s32, 19
  s_lshl_b32 s5, s5, 7
  s_add_u32 s57, s57, s5
  s_lshl_b32 s4, s33, 14
  s_add_u32 s57, s57, s4
  s_and_b32 s4, s3, 1
  s_lshl_b32 s4, s4, 13
  s_add_u32 s57, s57, s4
  s_add_u32 s58, s57, 4096
  s_mov_b32 s37, 0
  s_mov_b32 s39, 4294897664
  s_mov_b32 s40, 34816
  s_mov_b32 s42, 0
  s_mov_b32 s44, 4294942720
  s_mov_b32 s45, 24576
  s_mov_b32 s43, s44
  s_waitcnt vmcnt(15)
  s_barrier
  ds_read_b128 a[0:3], v16 offset:0
  ds_read_b64_tr_b16 a[72:73], v20 offset:0
  ds_read_b64_tr_b16 a[74:75], v20 offset:2048
  ds_read_b128 a[4:7], v16 offset:2048
  ds_read_b128 a[8:11], v16 offset:4096
  ds_read_b128 a[12:15], v16 offset:6144
  ds_read_b128 a[16:19], v16 offset:8192
  ds_read_b128 a[20:23], v16 offset:10240
  ds_read_b128 a[24:27], v16 offset:12288
  ds_read_b128 a[28:31], v16 offset:14336
  ds_read_b64_tr_b16 a[76:77], v21 offset:0
  ds_read_b64_tr_b16 a[78:79], v21 offset:2048
  ds_read_b64_tr_b16 a[80:81], v20 offset:8192
  ds_read_b64_tr_b16 a[82:83], v20 offset:10240
  ds_read_b128 a[32:35], v18 offset:0
  ds_read_b64_tr_b16 a[84:85], v21 offset:8192
  ds_read_b64_tr_b16 a[86:87], v21 offset:10240
  ds_read_b64_tr_b16 a[88:89], v20 offset:16384
  ds_read_b64_tr_b16 a[90:91], v20 offset:18432
  ds_read_b64_tr_b16 a[92:93], v21 offset:16384
  ds_read_b64_tr_b16 a[94:95], v21 offset:18432
  s_waitcnt lgkmcnt(0)
  v_mfma_f32_16x16x32_bf16 v[24:27], a[72:75], a[0:3], 0
  s_add_u32 m0, s36, s50
  s_add_u32 m0, m0, 69632
  ds_read_b128 a[36:39], v17 offset:0
  v_mfma_f32_16x16x32_bf16 v[28:31], a[72:75], a[4:7], 0
  buffer_load_dwordx4 v232, s[8:11], s46 offen offset:0 lds
  ds_read_b64_tr_b16 a[96:97], v20 offset:4096
  v_mfma_f32_16x16x32_bf16 v[32:35], a[72:75], a[8:11], 0
  s_add_u32 m0, s36, 69632
  v_mfma_f32_16x16x32_bf16 v[36:39], a[72:75], a[12:15], 0
  ds_read_b64_tr_b16 a[98:99], v20 offset:6144
  v_mfma_f32_16x16x32_bf16 v[40:43], a[72:75], a[16:19], 0
  buffer_load_dwordx4 v224, s[8:11], s46 offen offset:0 lds
  v_mfma_f32_16x16x32_bf16 v[44:47], a[72:75], a[20:23], 0
  ds_read_b128 a[40:43], v17 offset:2048
  v_mfma_f32_16x16x32_bf16 v[48:51], a[72:75], a[24:27], 0
  v_mfma_f32_16x16x32_bf16 v[52:55], a[72:75], a[28:31], 0
  ds_read_b128 a[44:47], v17 offset:4096
  v_mfma_f32_16x16x32_bf16 v[56:59], a[76:79], a[0:3], 0
  v_mfma_f32_16x16x32_bf16 v[60:63], a[76:79], a[4:7], 0
  buffer_load_dwordx4 v225, s[8:11], s46 offen offset:1024 lds
  ds_read_b128 a[48:51], v17 offset:6144
  v_mfma_f32_16x16x32_bf16 v[64:67], a[76:79], a[8:11], 0
  v_mfma_f32_16x16x32_bf16 v[68:71], a[76:79], a[12:15], 0
  ds_read_b128 a[52:55], v17 offset:8192
  v_mfma_f32_16x16x32_bf16 v[72:75], a[76:79], a[16:19], 0
  v_mfma_f32_16x16x32_bf16 v[76:79], a[76:79], a[20:23], 0
  ds_read_b128 a[56:59], v17 offset:10240
  v_mfma_f32_16x16x32_bf16 v[80:83], a[76:79], a[24:27], 0
  buffer_load_dwordx4 v226, s[8:11], s46 offen offset:2048 lds
  v_mfma_f32_16x16x32_bf16 v[84:87], a[76:79], a[28:31], 0
  ds_read_b128 a[60:63], v17 offset:12288
  v_mfma_f32_16x16x32_bf16 v[88:91], a[80:83], a[0:3], 0
  v_mfma_f32_16x16x32_bf16 v[92:95], a[80:83], a[4:7], 0
  ds_read_b128 a[64:67], v17 offset:14336
  v_mfma_f32_16x16x32_bf16 v[96:99], a[80:83], a[8:11], 0
  v_mfma_f32_16x16x32_bf16 v[100:103], a[80:83], a[12:15], 0
  buffer_load_dwordx4 v227, s[8:11], s46 offen offset:3072 lds
  ds_read_b64_tr_b16 a[100:101], v21 offset:4096
  v_mfma_f32_16x16x32_bf16 v[104:107], a[80:83], a[16:19], 0
  s_add_u32 m0, s36, 73728
  ds_read_b64_tr_b16 a[102:103], v21 offset:6144
  v_mfma_f32_16x16x32_bf16 v[108:111], a[80:83], a[20:23], 0
  v_mfma_f32_16x16x32_bf16 v[112:115], a[80:83], a[24:27], 0
  ds_read_b64_tr_b16 a[104:105], v20 offset:12288
  v_mfma_f32_16x16x32_bf16 v[116:119], a[80:83], a[28:31], 0
  buffer_load_dwordx4 v228, s[8:11], s46 offen offset:0 lds
  v_mfma_f32_16x16x32_bf16 v[216:219], a[80:83], a[32:35], 0
  ds_read_b64_tr_b16 a[106:107], v20 offset:14336
  v_mfma_f32_16x16x32_bf16 v[120:123], a[84:87], a[0:3], 0
  v_mfma_f32_16x16x32_bf16 v[124:127], a[84:87], a[4:7], 0
  ds_read_b128 a[68:71], v19 offset:0
  v_mfma_f32_16x16x32_bf16 v[128:131], a[84:87], a[8:11], 0
  v_mfma_f32_16x16x32_bf16 v[132:135], a[84:87], a[12:15], 0
  buffer_load_dwordx4 v229, s[8:11], s46 offen offset:1024 lds
  ds_read_b64_tr_b16 a[108:109], v21 offset:12288
  v_mfma_f32_16x16x32_bf16 v[136:139], a[84:87], a[16:19], 0
  v_mfma_f32_16x16x32_bf16 v[140:143], a[84:87], a[20:23], 0
  ds_read_b64_tr_b16 a[110:111], v21 offset:14336
  v_mfma_f32_16x16x32_bf16 v[144:147], a[84:87], a[24:27], 0
  v_mfma_f32_16x16x32_bf16 v[148:151], a[84:87], a[28:31], 0
  ds_read_b64_tr_b16 a[112:113], v20 offset:20480
  v_mfma_f32_16x16x32_bf16 v[220:223], a[84:87], a[32:35], 0
  buffer_load_dwordx4 v230, s[8:11], s46 offen offset:2048 lds
  v_mfma_f32_16x16x32_bf16 v[152:155], a[0:3], a[88:91], 0
  ds_read_b64_tr_b16 a[114:115], v20 offset:22528
  v_mfma_f32_16x16x32_bf16 v[156:159], a[4:7], a[88:91], 0
  v_mfma_f32_16x16x32_bf16 v[160:163], a[8:11], a[88:91], 0
  ds_read_b64_tr_b16 a[116:117], v21 offset:20480
  v_mfma_f32_16x16x32_bf16 v[164:167], a[12:15], a[88:91], 0
  v_mfma_f32_16x16x32_bf16 v[168:171], a[16:19], a[88:91], 0
  buffer_load_dwordx4 v231, s[8:11], s46 offen offset:3072 lds
  ds_read_b64_tr_b16 a[118:119], v21 offset:22528
  v_mfma_f32_16x16x32_bf16 v[172:175], a[20:23], a[88:91], 0
  s_mul_i32 s47, s48, 393216
  s_bfe_u32 s34, 0x302010e, s49
  s_add_u32 s48, s48, s34
  v_mfma_f32_16x16x32_bf16 v[176:179], a[24:27], a[88:91], 0
  s_add_u32 s49, s49, 8
  s_and_b32 s49, s49, 0x8001f
  s_and_b32 s48, s48, 15
  v_mfma_f32_16x16x32_bf16 v[180:183], a[28:31], a[88:91], 0
  s_lshl_b32 s46, s48, 7
  v_mfma_f32_16x16x32_bf16 v[184:187], a[0:3], a[92:95], 0
  s_add_u32 s37, s37, 1
  s_cmp_eq_u32 s37, 3
  s_cselect_b32 s37, 0, s37
  s_cselect_b32 s38, s39, s40
  v_mfma_f32_16x16x32_bf16 v[188:191], a[4:7], a[92:95], 0
  s_sub_u32 s43, 0, s43
  v_mfma_f32_16x16x32_bf16 v[192:195], a[8:11], a[92:95], 0
  v_add_u32 v16, s38, v16
  v_add_u32 v17, s38, v17
  v_mfma_f32_16x16x32_bf16 v[196:199], a[12:15], a[92:95], 0
  v_add_u32 v18, s38, v18
  v_add_u32 v19, s38, v19
  v_mfma_f32_16x16x32_bf16 v[200:203], a[16:19], a[92:95], 0
  v_add_u32 v20, s43, v20
  v_add_u32 v21, s43, v21
  v_mfma_f32_16x16x32_bf16 v[204:207], a[20:23], a[92:95], 0
  v_mfma_f32_16x16x32_bf16 v[208:211], a[24:27], a[92:95], 0
  v_mfma_f32_16x16x32_bf16 v[212:215], a[28:31], a[92:95], 0
  s_mov_b32 s35, 13
  s_waitcnt vmcnt(9) lgkmcnt(0)
  s_barrier
  .p2align 6
Lp2r0_loop:
  v_mfma_f32_16x16x32_bf16 v[24:27], a[96:99], a[36:39], v[24:27]
  s_mov_b32 m0, s41
  ds_read_b128 a[0:3], v16 offset:0
  v_mfma_f32_16x16x32_bf16 v[28:31], a[96:99], a[40:43], v[28:31]
  buffer_load_dwordx4 v233, s[12:15], s47 offen offset:0 lds
  ds_read_b64_tr_b16 a[72:73], v20 offset:0
  v_mfma_f32_16x16x32_bf16 v[32:35], a[96:99], a[44:47], v[32:35]
  v_mfma_f32_16x16x32_bf16 v[36:39], a[96:99], a[48:51], v[36:39]
  ds_read_b64_tr_b16 a[74:75], v20 offset:2048
  v_mfma_f32_16x16x32_bf16 v[40:43], a[96:99], a[52:55], v[40:43]
  v_mfma_f32_16x16x32_bf16 v[44:47], a[96:99], a[56:59], v[44:47]
  ds_read_b128 a[4:7], v16 offset:2048
  v_mfma_f32_16x16x32_bf16 v[48:51], a[96:99], a[60:63], v[48:51]
  buffer_load_dwordx4 v234, s[12:15], s47 offen offset:1024 lds
  v_mfma_f32_16x16x32_bf16 v[52:55], a[96:99], a[64:67], v[52:55]
  ds_read_b128 a[8:11], v16 offset:4096
  v_mfma_f32_16x16x32_bf16 v[56:59], a[100:103], a[36:39], v[56:59]
  v_mfma_f32_16x16x32_bf16 v[60:63], a[100:103], a[40:43], v[60:63]
  ds_read_b128 a[12:15], v16 offset:6144
  v_mfma_f32_16x16x32_bf16 v[64:67], a[100:103], a[44:47], v[64:67]
  v_mfma_f32_16x16x32_bf16 v[68:71], a[100:103], a[48:51], v[68:71]
  ds_read_b128 a[16:19], v16 offset:8192
  v_mfma_f32_16x16x32_bf16 v[72:75], a[100:103], a[52:55], v[72:75]
  buffer_load_dwordx4 v235, s[12:15], s47 offen offset:2048 lds
  v_mfma_f32_16x16x32_bf16 v[76:79], a[100:103], a[56:59], v[76:79]
  s_add_u32 m0, s41, 3072
  ds_read_b128 a[20:23], v16 offset:10240
  v_mfma_f32_16x16x32_bf16 v[80:83], a[100:103], a[60:63], v[80:83]
  v_mfma_f32_16x16x32_bf16 v[84:87], a[100:103], a[64:67], v[84:87]
  ds_read_b128 a[24:27], v16 offset:12288
  v_mfma_f32_16x16x32_bf16 v[88:91], a[104:107], a[36:39], v[88:91]
  v_mfma_f32_16x16x32_bf16 v[92:95], a[104:107], a[40:43], v[92:95]
  ds_read_b128 a[28:31], v16 offset:14336
  v_mfma_f32_16x16x32_bf16 v[96:99], a[104:107], a[44:47], v[96:99]
  buffer_load_dwordx4 v236, s[12:15], s47 offen offset:0 lds
  v_mfma_f32_16x16x32_bf16 v[100:103], a[104:107], a[48:51], v[100:103]
  ds_read_b64_tr_b16 a[76:77], v21 offset:0
  v_mfma_f32_16x16x32_bf16 v[104:107], a[104:107], a[52:55], v[104:107]
  ds_read_b64_tr_b16 a[78:79], v21 offset:2048
  v_mfma_f32_16x16x32_bf16 v[108:111], a[104:107], a[56:59], v[108:111]
  v_mfma_f32_16x16x32_bf16 v[112:115], a[104:107], a[60:63], v[112:115]
  ds_read_b64_tr_b16 a[80:81], v20 offset:8192
  v_mfma_f32_16x16x32_bf16 v[116:119], a[104:107], a[64:67], v[116:119]
  v_mfma_f32_16x16x32_bf16 v[216:219], a[104:107], a[68:71], v[216:219]
  buffer_load_dwordx4 v237, s[12:15], s47 offen offset:1024 lds
  ds_read_b64_tr_b16 a[82:83], v20 offset:10240
  v_mfma_f32_16x16x32_bf16 v[120:123], a[108:111], a[36:39], v[120:123]
  v_mfma_f32_16x16x32_bf16 v[124:127], a[108:111], a[40:43], v[124:127]
  ds_read_b128 a[32:35], v18 offset:0
  v_mfma_f32_16x16x32_bf16 v[128:131], a[108:111], a[44:47], v[128:131]
  v_mfma_f32_16x16x32_bf16 v[132:135], a[108:111], a[48:51], v[132:135]
  ds_read_b64_tr_b16 a[84:85], v21 offset:8192
  v_mfma_f32_16x16x32_bf16 v[136:139], a[108:111], a[52:55], v[136:139]
  v_mfma_f32_16x16x32_bf16 v[140:143], a[108:111], a[56:59], v[140:143]
  buffer_load_dwordx4 v238, s[12:15], s47 offen offset:2048 lds
  ds_read_b64_tr_b16 a[86:87], v21 offset:10240
  v_mfma_f32_16x16x32_bf16 v[144:147], a[108:111], a[60:63], v[144:147]
  s_add_u32 m0, s36, s50
  v_mfma_f32_16x16x32_bf16 v[148:151], a[108:111], a[64:67], v[148:151]
  ds_read_b64_tr_b16 a[88:89], v20 offset:16384
  v_mfma_f32_16x16x32_bf16 v[220:223], a[108:111], a[68:71], v[220:223]
  v_mfma_f32_16x16x32_bf16 v[152:155], a[36:39], a[112:115], v[152:155]
  ds_read_b64_tr_b16 a[90:91], v20 offset:18432
  v_mfma_f32_16x16x32_bf16 v[156:159], a[40:43], a[112:115], v[156:159]
  v_mfma_f32_16x16x32_bf16 v[160:163], a[44:47], a[112:115], v[160:163]
  buffer_load_dwordx4 v232, s[8:11], s46 offen offset:0 lds
  ds_read_b64_tr_b16 a[92:93], v21 offset:16384
  v_mfma_f32_16x16x32_bf16 v[164:167], a[48:51], a[112:115], v[164:167]
  s_mov_b32 m0, s36
  v_mfma_f32_16x16x32_bf16 v[168:171], a[52:55], a[112:115], v[168:171]
  ds_read_b64_tr_b16 a[94:95], v21 offset:18432
  v_mfma_f32_16x16x32_bf16 v[172:175], a[56:59], a[112:115], v[172:175]
  v_mfma_f32_16x16x32_bf16 v[176:179], a[60:63], a[112:115], v[176:179]
  v_mfma_f32_16x16x32_bf16 v[180:183], a[64:67], a[112:115], v[180:183]
  v_mfma_f32_16x16x32_bf16 v[184:187], a[36:39], a[116:119], v[184:187]
  buffer_load_dwordx4 v224, s[8:11], s46 offen offset:0 lds
  v_mfma_f32_16x16x32_bf16 v[188:191], a[40:43], a[116:119], v[188:191]
  v_mfma_f32_16x16x32_bf16 v[192:195], a[44:47], a[116:119], v[192:195]
  v_mfma_f32_16x16x32_bf16 v[196:199], a[48:51], a[116:119], v[196:199]
  v_mfma_f32_16x16x32_bf16 v[200:203], a[52:55], a[116:119], v[200:203]
  v_mfma_f32_16x16x32_bf16 v[204:207], a[56:59], a[116:119], v[204:207]
  v_mfma_f32_16x16x32_bf16 v[208:211], a[60:63], a[116:119], v[208:211]
  v_mfma_f32_16x16x32_bf16 v[212:215], a[64:67], a[116:119], v[212:215]
  s_waitcnt lgkmcnt(0)
  v_mfma_f32_16x16x32_bf16 v[24:27], a[72:75], a[0:3], v[24:27]
  buffer_load_dwordx4 v225, s[8:11], s46 offen offset:1024 lds
  ds_read_b128 a[36:39], v17 offset:0
  v_mfma_f32_16x16x32_bf16 v[28:31], a[72:75], a[4:7], v[28:31]
  ds_read_b64_tr_b16 a[96:97], v20 offset:4096
  v_mfma_f32_16x16x32_bf16 v[32:35], a[72:75], a[8:11], v[32:35]
  v_mfma_f32_16x16x32_bf16 v[36:39], a[72:75], a[12:15], v[36:39]
  ds_read_b64_tr_b16 a[98:99], v20 offset:6144
  v_mfma_f32_16x16x32_bf16 v[40:43], a[72:75], a[16:19], v[40:43]
  v_mfma_f32_16x16x32_bf16 v[44:47], a[72:75], a[20:23], v[44:47]
  ds_read_b128 a[40:43], v17 offset:2048
  v_mfma_f32_16x16x32_bf16 v[48:51], a[72:75], a[24:27], v[48:51]
  buffer_load_dwordx4 v226, s[8:11], s46 offen offset:2048 lds
  v_mfma_f32_16x16x32_bf16 v[52:55], a[72:75], a[28:31], v[52:55]
  ds_read_b128 a[44:47], v17 offset:4096
  v_mfma_f32_16x16x32_bf16 v[56:59], a[76:79], a[0:3], v[56:59]
  v_mfma_f32_16x16x32_bf16 v[60:63], a[76:79], a[4:7], v[60:63]
  ds_read_b128 a[48:51], v17 offset:6144
  v_mfma_f32_16x16x32_bf16 v[64:67], a[76:79], a[8:11], v[64:67]
  v_mfma_f32_16x16x32_bf16 v[68:71], a[76:79], a[12:15], v[68:71]
  ds_read_b128 a[52:55], v17 offset:8192
  v_mfma_f32_16x16x32_bf16 v[72:75], a[76:79], a[16:19], v[72:75]
  buffer_load_dwordx4 v227, s[8:11], s46 offen offset:3072 lds
  v_mfma_f32_16x16x32_bf16 v[76:79], a[76:79], a[20:23], v[76:79]
  s_add_u32 m0, s36, 4096
  ds_read_b128 a[56:59], v17 offset:10240
  v_mfma_f32_16x16x32_bf16 v[80:83], a[76:79], a[24:27], v[80:83]
  v_mfma_f32_16x16x32_bf16 v[84:87], a[76:79], a[28:31], v[84:87]
  ds_read_b128 a[60:63], v17 offset:12288
  v_mfma_f32_16x16x32_bf16 v[88:91], a[80:83], a[0:3], v[88:91]
  v_mfma_f32_16x16x32_bf16 v[92:95], a[80:83], a[4:7], v[92:95]
  ds_read_b128 a[64:67], v17 offset:14336
  v_mfma_f32_16x16x32_bf16 v[96:99], a[80:83], a[8:11], v[96:99]
  buffer_load_dwordx4 v228, s[8:11], s46 offen offset:0 lds
  v_mfma_f32_16x16x32_bf16 v[100:103], a[80:83], a[12:15], v[100:103]
  ds_read_b64_tr_b16 a[100:101], v21 offset:4096
  v_mfma_f32_16x16x32_bf16 v[104:107], a[80:83], a[16:19], v[104:107]
  ds_read_b64_tr_b16 a[102:103], v21 offset:6144
  v_mfma_f32_16x16x32_bf16 v[108:111], a[80:83], a[20:23], v[108:111]
  v_mfma_f32_16x16x32_bf16 v[112:115], a[80:83], a[24:27], v[112:115]
  ds_read_b64_tr_b16 a[104:105], v20 offset:12288
  v_mfma_f32_16x16x32_bf16 v[116:119], a[80:83], a[28:31], v[116:119]
  v_mfma_f32_16x16x32_bf16 v[216:219], a[80:83], a[32:35], v[216:219]
  buffer_load_dwordx4 v229, s[8:11], s46 offen offset:1024 lds
  ds_read_b64_tr_b16 a[106:107], v20 offset:14336
  v_mfma_f32_16x16x32_bf16 v[120:123], a[84:87], a[0:3], v[120:123]
  v_mfma_f32_16x16x32_bf16 v[124:127], a[84:87], a[4:7], v[124:127]
  ds_read_b128 a[68:71], v19 offset:0
  v_mfma_f32_16x16x32_bf16 v[128:131], a[84:87], a[8:11], v[128:131]
  v_mfma_f32_16x16x32_bf16 v[132:135], a[84:87], a[12:15], v[132:135]
  ds_read_b64_tr_b16 a[108:109], v21 offset:12288
  v_mfma_f32_16x16x32_bf16 v[136:139], a[84:87], a[16:19], v[136:139]
  v_mfma_f32_16x16x32_bf16 v[140:143], a[84:87], a[20:23], v[140:143]
  buffer_load_dwordx4 v230, s[8:11], s46 offen offset:2048 lds
  ds_read_b64_tr_b16 a[110:111], v21 offset:14336
  v_mfma_f32_16x16x32_bf16 v[144:147], a[84:87], a[24:27], v[144:147]
  v_mfma_f32_16x16x32_bf16 v[148:151], a[84:87], a[28:31], v[148:151]
  ds_read_b64_tr_b16 a[112:113], v20 offset:20480
  v_mfma_f32_16x16x32_bf16 v[220:223], a[84:87], a[32:35], v[220:223]
  v_mfma_f32_16x16x32_bf16 v[152:155], a[0:3], a[88:91], v[152:155]
  ds_read_b64_tr_b16 a[114:115], v20 offset:22528
  v_mfma_f32_16x16x32_bf16 v[156:159], a[4:7], a[88:91], v[156:159]
  v_mfma_f32_16x16x32_bf16 v[160:163], a[8:11], a[88:91], v[160:163]
  buffer_load_dwordx4 v231, s[8:11], s46 offen offset:3072 lds
  ds_read_b64_tr_b16 a[116:117], v21 offset:20480
  v_mfma_f32_16x16x32_bf16 v[164:167], a[12:15], a[88:91], v[164:167]
  s_mul_i32 s47, s48, 393216
  s_bfe_u32 s34, 0x302010e, s49
  s_add_u32 s48, s48, s34
  v_mfma_f32_16x16x32_bf16 v[168:171], a[16:19], a[88:91], v[168:171]
  s_add_u32 s49, s49, 8
  s_and_b32 s49, s49, 0x8001f
  s_and_b32 s48, s48, 15
  v_mfma_f32_16x16x32_bf16 v[172:175], a[20:23], a[88:91], v[172:175]
  s_lshl_b32 s46, s48, 7
  ds_read_b64_tr_b16 a[118:119], v21 offset:22528
  v_mfma_f32_16x16x32_bf16 v[176:179], a[24:27], a[88:91], v[176:179]
  s_add_u32 s36, s36, s38
  s_add_u32 s37, s37, 1
  s_cmp_eq_u32 s37, 3
  s_cselect_b32 s37, 0, s37
  s_cselect_b32 s38, s39, s40
  v_mfma_f32_16x16x32_bf16 v[180:183], a[28:31], a[88:91], v[180:183]
  s_add_u32 s41, s41, s43
  s_sub_u32 s43, 0, s43
  v_mfma_f32_16x16x32_bf16 v[184:187], a[0:3], a[92:95], v[184:187]
  v_add_u32 v16, s38, v16
  v_add_u32 v17, s38, v17
  v_mfma_f32_16x16x32_bf16 v[188:191], a[4:7], a[92:95], v[188:191]
  v_add_u32 v18, s38, v18
  v_add_u32 v19, s38, v19
  v_mfma_f32_16x16x32_bf16 v[192:195], a[8:11], a[92:95], v[192:195]
  v_add_u32 v20, s43, v20
  v_add_u32 v21, s43, v21
  v_mfma_f32_16x16x32_bf16 v[196:199], a[12:15], a[92:95], v[196:199]
  v_mfma_f32_16x16x32_bf16 v[200:203], a[16:19], a[92:95], v[200:203]
  v_mfma_f32_16x16x32_bf16 v[204:207], a[20:23], a[92:95], v[204:207]
  s_waitcnt vmcnt(9) lgkmcnt(0)
  s_barrier
  v_mfma_f32_16x16x32_bf16 v[208:211], a[24:27], a[92:95], v[208:211]
  s_sub_u32 s35, s35, 1
  v_mfma_f32_16x16x32_bf16 v[212:215], a[28:31], a[92:95], v[212:215]
  s_cmp_lg_u32 s35, 0
  s_cbranch_scc1 Lp2r0_loop
  v_accvgpr_read_b32 v4, a222
  v_accvgpr_read_b32 v5, a223
  v_accvgpr_read_b32 v6, a224
  v_accvgpr_read_b32 v7, a225
  v_accvgpr_read_b32 v8, a226
  v_accvgpr_read_b32 v9, a227
  v_accvgpr_read_b32 v10, a228
  v_accvgpr_read_b32 v11, a229
  s_mov_b32 s8, s64
  s_mov_b32 s9, s65
  s_mov_b32 s10, 4194304
  s_mov_b32 s11, 0x00020000
  s_mov_b32 s20, s68
  s_mov_b32 s21, s69
  s_mov_b32 s22, 8388608
  s_mov_b32 s23, 0x00020000
  s_and_b32 s4, s2, 7
  s_lshl_b32 s4, s4, 1
  s_lshr_b32 s5, s2, 6
  s_add_u32 s5, s5, s25
  s_and_b32 s53, s5, 3
  s_lshl_b32 s53, s53, 3
  s_or_b32 s53, s53, 0x80000
  s_bfe_u32 s52, 0xf0f02, s53
  s_add_u32 s52, s52, s4
  s_and_b32 s52, s52, 15
  s_mov_b32 s54, s52
  s_mov_b32 s55, s53
  s_lshl_b32 s29, s52, 7
  s_lshl_b32 s28, s54, 19
  s_lshl_b32 s30, s25, 18
  s_sub_u32 s31, 3932160, s30
  s_or_b32 s26, s30, s29
  s_or_b32 s27, s31, s29
  s_lshl_b32 s68, s3, 12
  s_lshl_b32 s88, s3, 13
  s_add_u32 s88, s88, 98304
  v_mfma_f32_16x16x32_bf16 v[24:27], a[96:99], a[36:39], v[24:27]
  s_mov_b32 m0, s41
  ds_read_b128 a[0:3], v16 offset:0
  v_mfma_f32_16x16x32_bf16 v[28:31], a[96:99], a[40:43], v[28:31]
  buffer_load_dwordx4 v233, s[12:15], s47 offen offset:0 lds
  ds_read_b64_tr_b16 a[72:73], v20 offset:0
  v_mfma_f32_16x16x32_bf16 v[32:35], a[96:99], a[44:47], v[32:35]
  v_mfma_f32_16x16x32_bf16 v[36:39], a[96:99], a[48:51], v[36:39]
  ds_read_b64_tr_b16 a[74:75], v20 offset:2048
  v_mfma_f32_16x16x32_bf16 v[40:43], a[96:99], a[52:55], v[40:43]
  v_mfma_f32_16x16x32_bf16 v[44:47], a[96:99], a[56:59], v[44:47]
  ds_read_b128 a[4:7], v16 offset:2048
  v_mfma_f32_16x16x32_bf16 v[48:51], a[96:99], a[60:63], v[48:51]
  v_mfma_f32_16x16x32_bf16 v[52:55], a[96:99], a[64:67], v[52:55]
  ds_read_b128 a[8:11], v16 offset:4096
  v_mfma_f32_16x16x32_bf16 v[56:59], a[100:103], a[36:39], v[56:59]
  v_mfma_f32_16x16x32_bf16 v[60:63], a[100:103], a[40:43], v[60:63]
  ds_read_b128 a[12:15], v16 offset:6144
  v_mfma_f32_16x16x32_bf16 v[64:67], a[100:103], a[44:47], v[64:67]
  v_mfma_f32_16x16x32_bf16 v[68:71], a[100:103], a[48:51], v[68:71]
  ds_read_b128 a[16:19], v16 offset:8192
  v_mfma_f32_16x16x32_bf16 v[72:75], a[100:103], a[52:55], v[72:75]
  v_mfma_f32_16x16x32_bf16 v[76:79], a[100:103], a[56:59], v[76:79]
  ds_read_b128 a[20:23], v16 offset:10240
  v_mfma_f32_16x16x32_bf16 v[80:83], a[100:103], a[60:63], v[80:83]
  v_mfma_f32_16x16x32_bf16 v[84:87], a[100:103], a[64:67], v[84:87]
  ds_read_b128 a[24:27], v16 offset:12288
  v_mfma_f32_16x16x32_bf16 v[88:91], a[104:107], a[36:39], v[88:91]
  buffer_load_dwordx4 v234, s[12:15], s47 offen offset:1024 lds
  v_mfma_f32_16x16x32_bf16 v[92:95], a[104:107], a[40:43], v[92:95]
  ds_read_b128 a[28:31], v16 offset:14336
  v_mfma_f32_16x16x32_bf16 v[96:99], a[104:107], a[44:47], v[96:99]
  v_mfma_f32_16x16x32_bf16 v[100:103], a[104:107], a[48:51], v[100:103]
  ds_read_b64_tr_b16 a[76:77], v21 offset:0
  v_mfma_f32_16x16x32_bf16 v[104:107], a[104:107], a[52:55], v[104:107]
  ds_read_b64_tr_b16 a[78:79], v21 offset:2048
  v_mfma_f32_16x16x32_bf16 v[108:111], a[104:107], a[56:59], v[108:111]
  v_mfma_f32_16x16x32_bf16 v[112:115], a[104:107], a[60:63], v[112:115]
  ds_read_b64_tr_b16 a[80:81], v20 offset:8192
  v_mfma_f32_16x16x32_bf16 v[116:119], a[104:107], a[64:67], v[116:119]
  v_mfma_f32_16x16x32_bf16 v[216:219], a[104:107], a[68:71], v[216:219]
  ds_read_b64_tr_b16 a[82:83], v20 offset:10240
  v_mfma_f32_16x16x32_bf16 v[120:123], a[108:111], a[36:39], v[120:123]
  v_mfma_f32_16x16x32_bf16 v[124:127], a[108:111], a[40:43], v[124:127]
  ds_read_b128 a[32:35], v18 offset:0
  v_mfma_f32_16x16x32_bf16 v[128:131], a[108:111], a[44:47], v[128:131]
  v_mfma_f32_16x16x32_bf16 v[132:135], a[108:111], a[48:51], v[132:135]
  ds_read_b64_tr_b16 a[84:85], v21 offset:8192
  v_mfma_f32_16x16x32_bf16 v[136:139], a[108:111], a[52:55], v[136:139]
  v_mfma_f32_16x16x32_bf16 v[140:143], a[108:111], a[56:59], v[140:143]
  ds_read_b64_tr_b16 a[86:87], v21 offset:10240
  v_mfma_f32_16x16x32_bf16 v[144:147], a[108:111], a[60:63], v[144:147]
  v_mfma_f32_16x16x32_bf16 v[148:151], a[108:111], a[64:67], v[148:151]
  buffer_load_dwordx4 v235, s[12:15], s47 offen offset:2048 lds
  ds_read_b64_tr_b16 a[88:89], v20 offset:16384
  v_mfma_f32_16x16x32_bf16 v[220:223], a[108:111], a[68:71], v[220:223]
  v_mfma_f32_16x16x32_bf16 v[152:155], a[36:39], a[112:115], v[152:155]
  ds_read_b64_tr_b16 a[90:91], v20 offset:18432
  v_mfma_f32_16x16x32_bf16 v[156:159], a[40:43], a[112:115], v[156:159]
  v_mfma_f32_16x16x32_bf16 v[160:163], a[44:47], a[112:115], v[160:163]
  ds_read_b64_tr_b16 a[92:93], v21 offset:16384
  v_mfma_f32_16x16x32_bf16 v[164:167], a[48:51], a[112:115], v[164:167]
  v_mfma_f32_16x16x32_bf16 v[168:171], a[52:55], a[112:115], v[168:171]
  ds_read_b64_tr_b16 a[94:95], v21 offset:18432
  v_mfma_f32_16x16x32_bf16 v[172:175], a[56:59], a[112:115], v[172:175]
  v_mfma_f32_16x16x32_bf16 v[176:179], a[60:63], a[112:115], v[176:179]
  v_mfma_f32_16x16x32_bf16 v[180:183], a[64:67], a[112:115], v[180:183]
  v_mfma_f32_16x16x32_bf16 v[184:187], a[36:39], a[116:119], v[184:187]
  v_mfma_f32_16x16x32_bf16 v[188:191], a[40:43], a[116:119], v[188:191]
  v_mfma_f32_16x16x32_bf16 v[192:195], a[44:47], a[116:119], v[192:195]
  v_mfma_f32_16x16x32_bf16 v[196:199], a[48:51], a[116:119], v[196:199]
  v_mfma_f32_16x16x32_bf16 v[200:203], a[52:55], a[116:119], v[200:203]
  v_mfma_f32_16x16x32_bf16 v[204:207], a[56:59], a[116:119], v[204:207]
  v_mfma_f32_16x16x32_bf16 v[208:211], a[60:63], a[116:119], v[208:211]
  v_mfma_f32_16x16x32_bf16 v[212:215], a[64:67], a[116:119], v[212:215]
  s_waitcnt lgkmcnt(0)
  v_mfma_f32_16x16x32_bf16 v[24:27], a[72:75], a[0:3], v[24:27]
  s_add_u32 m0, s41, 3072
  ds_read_b128 a[36:39], v17 offset:0
  v_mfma_f32_16x16x32_bf16 v[28:31], a[72:75], a[4:7], v[28:31]
  buffer_load_dwordx4 v236, s[12:15], s47 offen offset:0 lds
  ds_read_b64_tr_b16 a[96:97], v20 offset:4096
  v_mfma_f32_16x16x32_bf16 v[32:35], a[72:75], a[8:11], v[32:35]
  v_mfma_f32_16x16x32_bf16 v[36:39], a[72:75], a[12:15], v[36:39]
  ds_read_b64_tr_b16 a[98:99], v20 offset:6144
  v_mfma_f32_16x16x32_bf16 v[40:43], a[72:75], a[16:19], v[40:43]
  v_mfma_f32_16x16x32_bf16 v[44:47], a[72:75], a[20:23], v[44:47]
  ds_read_b128 a[40:43], v17 offset:2048
  v_mfma_f32_16x16x32_bf16 v[48:51], a[72:75], a[24:27], v[48:51]
  v_mfma_f32_16x16x32_bf16 v[52:55], a[72:75], a[28:31], v[52:55]
  ds_read_b128 a[44:47], v17 offset:4096
  v_mfma_f32_16x16x32_bf16 v[56:59], a[76:79], a[0:3], v[56:59]
  v_mfma_f32_16x16x32_bf16 v[60:63], a[76:79], a[4:7], v[60:63]
  ds_read_b128 a[48:51], v17 offset:6144
  v_mfma_f32_16x16x32_bf16 v[64:67], a[76:79], a[8:11], v[64:67]
  v_mfma_f32_16x16x32_bf16 v[68:71], a[76:79], a[12:15], v[68:71]
  ds_read_b128 a[52:55], v17 offset:8192
  v_mfma_f32_16x16x32_bf16 v[72:75], a[76:79], a[16:19], v[72:75]
  v_mfma_f32_16x16x32_bf16 v[76:79], a[76:79], a[20:23], v[76:79]
  ds_read_b128 a[56:59], v17 offset:10240
  v_mfma_f32_16x16x32_bf16 v[80:83], a[76:79], a[24:27], v[80:83]
  buffer_load_dwordx4 v237, s[12:15], s47 offen offset:1024 lds
  v_mfma_f32_16x16x32_bf16 v[84:87], a[76:79], a[28:31], v[84:87]
  ds_read_b128 a[60:63], v17 offset:12288
  v_mfma_f32_16x16x32_bf16 v[88:91], a[80:83], a[0:3], v[88:91]
  v_mfma_f32_16x16x32_bf16 v[92:95], a[80:83], a[4:7], v[92:95]
  ds_read_b128 a[64:67], v17 offset:14336
  v_mfma_f32_16x16x32_bf16 v[96:99], a[80:83], a[8:11], v[96:99]
  v_mfma_f32_16x16x32_bf16 v[100:103], a[80:83], a[12:15], v[100:103]
  ds_read_b64_tr_b16 a[100:101], v21 offset:4096
  v_mfma_f32_16x16x32_bf16 v[104:107], a[80:83], a[16:19], v[104:107]
  ds_read_b64_tr_b16 a[102:103], v21 offset:6144
  v_mfma_f32_16x16x32_bf16 v[108:111], a[80:83], a[20:23], v[108:111]
  v_mfma_f32_16x16x32_bf16 v[112:115], a[80:83], a[24:27], v[112:115]
  ds_read_b64_tr_b16 a[104:105], v20 offset:12288
  v_mfma_f32_16x16x32_bf16 v[116:119], a[80:83], a[28:31], v[116:119]
  v_mfma_f32_16x16x32_bf16 v[216:219], a[80:83], a[32:35], v[216:219]
  ds_read_b64_tr_b16 a[106:107], v20 offset:14336
  v_mfma_f32_16x16x32_bf16 v[120:123], a[84:87], a[0:3], v[120:123]
  v_mfma_f32_16x16x32_bf16 v[124:127], a[84:87], a[4:7], v[124:127]
  ds_read_b128 a[68:71], v19 offset:0
  v_mfma_f32_16x16x32_bf16 v[128:131], a[84:87], a[8:11], v[128:131]
  v_mfma_f32_16x16x32_bf16 v[132:135], a[84:87], a[12:15], v[132:135]
  buffer_load_dwordx4 v238, s[12:15], s47 offen offset:2048 lds
  ds_read_b64_tr_b16 a[108:109], v21 offset:12288
  v_mfma_f32_16x16x32_bf16 v[136:139], a[84:87], a[16:19], v[136:139]
  s_add_u32 s36, s36, s38
  s_add_u32 s37, s37, 1
  s_cmp_eq_u32 s37, 3
  s_cselect_b32 s37, 0, s37
  s_cselect_b32 s38, s39, s40
  v_mfma_f32_16x16x32_bf16 v[140:143], a[84:87], a[20:23], v[140:143]
  s_add_u32 s41, s41, s43
  s_sub_u32 s43, 0, s43
  ds_read_b64_tr_b16 a[110:111], v21 offset:14336
  v_mfma_f32_16x16x32_bf16 v[144:147], a[84:87], a[24:27], v[144:147]
  v_mfma_f32_16x16x32_bf16 v[148:151], a[84:87], a[28:31], v[148:151]
  ds_read_b64_tr_b16 a[112:113], v20 offset:20480
  v_mfma_f32_16x16x32_bf16 v[220:223], a[84:87], a[32:35], v[220:223]
  v_mfma_f32_16x16x32_bf16 v[152:155], a[0:3], a[88:91], v[152:155]
  ds_read_b64_tr_b16 a[114:115], v20 offset:22528
  v_mfma_f32_16x16x32_bf16 v[156:159], a[4:7], a[88:91], v[156:159]
  v_mfma_f32_16x16x32_bf16 v[160:163], a[8:11], a[88:91], v[160:163]
  ds_read_b64_tr_b16 a[116:117], v21 offset:20480
  v_mfma_f32_16x16x32_bf16 v[164:167], a[12:15], a[88:91], v[164:167]
  v_mfma_f32_16x16x32_bf16 v[168:171], a[16:19], a[88:91], v[168:171]
  ds_read_b64_tr_b16 a[118:119], v21 offset:22528
  v_mfma_f32_16x16x32_bf16 v[172:175], a[20:23], a[88:91], v[172:175]
  v_add_u32 v16, s38, v16
  v_add_u32 v17, s38, v17
  v_mfma_f32_16x16x32_bf16 v[176:179], a[24:27], a[88:91], v[176:179]
  v_add_u32 v18, s38, v18
  v_add_u32 v19, s38, v19
  v_mfma_f32_16x16x32_bf16 v[180:183], a[28:31], a[88:91], v[180:183]
  v_add_u32 v20, s43, v20
  v_add_u32 v21, s43, v21
  v_mfma_f32_16x16x32_bf16 v[184:187], a[0:3], a[92:95], v[184:187]
  v_mfma_f32_16x16x32_bf16 v[188:191], a[4:7], a[92:95], v[188:191]
  v_mfma_f32_16x16x32_bf16 v[192:195], a[8:11], a[92:95], v[192:195]
  v_mfma_f32_16x16x32_bf16 v[196:199], a[12:15], a[92:95], v[196:199]
  v_mfma_f32_16x16x32_bf16 v[200:203], a[16:19], a[92:95], v[200:203]
  v_mfma_f32_16x16x32_bf16 v[204:207], a[20:23], a[92:95], v[204:207]
  v_mfma_f32_16x16x32_bf16 v[208:211], a[24:27], a[92:95], v[208:211]
  v_mfma_f32_16x16x32_bf16 v[212:215], a[28:31], a[92:95], v[212:215]
  s_waitcnt vmcnt(0) lgkmcnt(0)
  s_barrier
  s_mov_b32 s6, 0x3e8293ee
  s_mov_b32 s7, s6
  v_mfma_f32_16x16x32_bf16 v[24:27], a[96:99], a[36:39], v[24:27]
  ds_read_b128 a[0:3], v16 offset:0
  v_mfma_f32_16x16x32_bf16 v[28:31], a[96:99], a[40:43], v[28:31]
  ds_read_b64_tr_b16 a[72:73], v20 offset:0
  v_mfma_f32_16x16x32_bf16 v[32:35], a[96:99], a[44:47], v[32:35]
  v_mfma_f32_16x16x32_bf16 v[36:39], a[96:99], a[48:51], v[36:39]
  ds_read_b64_tr_b16 a[74:75], v20 offset:2048
  v_mfma_f32_16x16x32_bf16 v[40:43], a[96:99], a[52:55], v[40:43]
  v_mfma_f32_16x16x32_bf16 v[44:47], a[96:99], a[56:59], v[44:47]
  ds_read_b128 a[4:7], v16 offset:2048
  v_mfma_f32_16x16x32_bf16 v[48:51], a[96:99], a[60:63], v[48:51]
  v_mfma_f32_16x16x32_bf16 v[52:55], a[96:99], a[64:67], v[52:55]
  ds_read_b128 a[8:11], v16 offset:4096
  v_mfma_f32_16x16x32_bf16 v[56:59], a[100:103], a[36:39], v[56:59]
  v_mfma_f32_16x16x32_bf16 v[60:63], a[100:103], a[40:43], v[60:63]
  ds_read_b128 a[12:15], v16 offset:6144
  v_mfma_f32_16x16x32_bf16 v[64:67], a[100:103], a[44:47], v[64:67]
  v_mfma_f32_16x16x32_bf16 v[68:71], a[100:103], a[48:51], v[68:71]
  ds_read_b128 a[16:19], v16 offset:8192
  v_mfma_f32_16x16x32_bf16 v[72:75], a[100:103], a[52:55], v[72:75]
  v_mfma_f32_16x16x32_bf16 v[76:79], a[100:103], a[56:59], v[76:79]
  ds_read_b128 a[20:23], v16 offset:10240
  v_mfma_f32_16x16x32_bf16 v[80:83], a[100:103], a[60:63], v[80:83]
  v_mfma_f32_16x16x32_bf16 v[84:87], a[100:103], a[64:67], v[84:87]
  ds_read_b128 a[24:27], v16 offset:12288
  v_mfma_f32_16x16x32_bf16 v[88:91], a[104:107], a[36:39], v[88:91]
  v_mfma_f32_16x16x32_bf16 v[92:95], a[104:107], a[40:43], v[92:95]
  ds_read_b128 a[28:31], v16 offset:14336
  v_mfma_f32_16x16x32_bf16 v[96:99], a[104:107], a[44:47], v[96:99]
  v_mfma_f32_16x16x32_bf16 v[100:103], a[104:107], a[48:51], v[100:103]
  ds_read_b64_tr_b16 a[76:77], v21 offset:0
  v_mfma_f32_16x16x32_bf16 v[104:107], a[104:107], a[52:55], v[104:107]
  ds_read_b64_tr_b16 a[78:79], v21 offset:2048
  v_mfma_f32_16x16x32_bf16 v[108:111], a[104:107], a[56:59], v[108:111]
  v_mfma_f32_16x16x32_bf16 v[112:115], a[104:107], a[60:63], v[112:115]
  ds_read_b64_tr_b16 a[80:81], v20 offset:8192
  v_mfma_f32_16x16x32_bf16 v[116:119], a[104:107], a[64:67], v[116:119]
  v_mfma_f32_16x16x32_bf16 v[216:219], a[104:107], a[68:71], v[216:219]
  ds_read_b64_tr_b16 a[82:83], v20 offset:10240
  v_mfma_f32_16x16x32_bf16 v[120:123], a[108:111], a[36:39], v[120:123]
  v_mfma_f32_16x16x32_bf16 v[124:127], a[108:111], a[40:43], v[124:127]
  ds_read_b128 a[32:35], v18 offset:0
  v_mfma_f32_16x16x32_bf16 v[128:131], a[108:111], a[44:47], v[128:131]
  v_mfma_f32_16x16x32_bf16 v[132:135], a[108:111], a[48:51], v[132:135]
  ds_read_b64_tr_b16 a[84:85], v21 offset:8192
  v_mfma_f32_16x16x32_bf16 v[136:139], a[108:111], a[52:55], v[136:139]
  v_mfma_f32_16x16x32_bf16 v[140:143], a[108:111], a[56:59], v[140:143]
  ds_read_b64_tr_b16 a[86:87], v21 offset:10240
  v_mfma_f32_16x16x32_bf16 v[144:147], a[108:111], a[60:63], v[144:147]
  v_mfma_f32_16x16x32_bf16 v[148:151], a[108:111], a[64:67], v[148:151]
  ds_read_b64_tr_b16 a[88:89], v20 offset:16384
  v_mfma_f32_16x16x32_bf16 v[220:223], a[108:111], a[68:71], v[220:223]
  v_mfma_f32_16x16x32_bf16 v[152:155], a[36:39], a[112:115], v[152:155]
  ds_read_b64_tr_b16 a[90:91], v20 offset:18432
  v_mfma_f32_16x16x32_bf16 v[156:159], a[40:43], a[112:115], v[156:159]
  v_mfma_f32_16x16x32_bf16 v[160:163], a[44:47], a[112:115], v[160:163]
  ds_read_b64_tr_b16 a[92:93], v21 offset:16384
  v_mfma_f32_16x16x32_bf16 v[164:167], a[48:51], a[112:115], v[164:167]
  v_mfma_f32_16x16x32_bf16 v[168:171], a[52:55], a[112:115], v[168:171]
  ds_read_b64_tr_b16 a[94:95], v21 offset:18432
  v_mfma_f32_16x16x32_bf16 v[172:175], a[56:59], a[112:115], v[172:175]
  v_mfma_f32_16x16x32_bf16 v[176:179], a[60:63], a[112:115], v[176:179]
  v_mfma_f32_16x16x32_bf16 v[180:183], a[64:67], a[112:115], v[180:183]
  v_mfma_f32_16x16x32_bf16 v[184:187], a[36:39], a[116:119], v[184:187]
  v_mfma_f32_16x16x32_bf16 v[188:191], a[40:43], a[116:119], v[188:191]
  v_mfma_f32_16x16x32_bf16 v[192:195], a[44:47], a[116:119], v[192:195]
  v_mfma_f32_16x16x32_bf16 v[196:199], a[48:51], a[116:119], v[196:199]
  v_mfma_f32_16x16x32_bf16 v[200:203], a[52:55], a[116:119], v[200:203]
  v_mfma_f32_16x16x32_bf16 v[204:207], a[56:59], a[116:119], v[204:207]
  v_mfma_f32_16x16x32_bf16 v[208:211], a[60:63], a[116:119], v[208:211]
  v_mfma_f32_16x16x32_bf16 v[212:215], a[64:67], a[116:119], v[212:215]
  s_waitcnt lgkmcnt(0)
  v_mfma_f32_16x16x32_bf16 v[24:27], a[72:75], a[0:3], v[24:27]
  ds_read_b128 a[36:39], v17 offset:0
  ds_read_b64_tr_b16 a[96:97], v20 offset:4096
  v_mfma_f32_16x16x32_bf16 v[56:59], a[76:79], a[0:3], v[56:59]
  ds_read_b64_tr_b16 a[98:99], v20 offset:6144
  ds_read_b128 a[40:43], v17 offset:2048
  v_mfma_f32_16x16x32_bf16 v[28:31], a[72:75], a[4:7], v[28:31]
  ds_read_b128 a[44:47], v17 offset:4096
  ds_read_b128 a[48:51], v17 offset:6144
  v_mfma_f32_16x16x32_bf16 v[60:63], a[76:79], a[4:7], v[60:63]
  ds_read_b128 a[52:55], v17 offset:8192
  ds_read_b128 a[56:59], v17 offset:10240
  v_mfma_f32_16x16x32_bf16 v[32:35], a[72:75], a[8:11], v[32:35]
  ds_read_b128 a[60:63], v17 offset:12288
  ds_read_b128 a[64:67], v17 offset:14336
  v_mfma_f32_16x16x32_bf16 v[64:67], a[76:79], a[8:11], v[64:67]
  ds_read_b64_tr_b16 a[100:101], v21 offset:4096
  ds_read_b64_tr_b16 a[102:103], v21 offset:6144
  v_mfma_f32_16x16x32_bf16 v[36:39], a[72:75], a[12:15], v[36:39]
  ds_read_b64_tr_b16 a[104:105], v20 offset:12288
  ds_read_b64_tr_b16 a[106:107], v20 offset:14336
  v_mfma_f32_16x16x32_bf16 v[68:71], a[76:79], a[12:15], v[68:71]
  ds_read_b128 a[68:71], v19 offset:0
  ds_read_b64_tr_b16 a[108:109], v21 offset:12288
  v_mfma_f32_16x16x32_bf16 v[40:43], a[72:75], a[16:19], v[40:43]
  ds_read_b64_tr_b16 a[110:111], v21 offset:14336
  ds_read_b64_tr_b16 a[112:113], v20 offset:20480
  v_mfma_f32_16x16x32_bf16 v[72:75], a[76:79], a[16:19], v[72:75]
  ds_read_b64_tr_b16 a[114:115], v20 offset:22528
  ds_read_b64_tr_b16 a[116:117], v21 offset:20480
  v_mfma_f32_16x16x32_bf16 v[44:47], a[72:75], a[20:23], v[44:47]
  ds_read_b64_tr_b16 a[118:119], v21 offset:22528
  v_mfma_f32_16x16x32_bf16 v[76:79], a[76:79], a[20:23], v[76:79]
  v_mfma_f32_16x16x32_bf16 v[48:51], a[72:75], a[24:27], v[48:51]
  v_mfma_f32_16x16x32_bf16 v[80:83], a[76:79], a[24:27], v[80:83]
  v_mfma_f32_16x16x32_bf16 v[52:55], a[72:75], a[28:31], v[52:55]
  v_mfma_f32_16x16x32_bf16 v[84:87], a[76:79], a[28:31], v[84:87]
  s_waitcnt lgkmcnt(0)
  s_barrier
  s_mov_b32 s12, s84
  s_mov_b32 s13, s85
  s_mov_b32 s14, 256
  s_mov_b32 s15, 0x00020000
  buffer_load_dwordx2 v[22:23], off, s[12:15], 0 sc1
  v_mfma_f32_16x16x32_bf16 v[24:27], a[96:99], a[36:39], v[24:27]
  s_mov_b32 m0, s68
  v_mfma_f32_16x16x32_bf16 v[56:59], a[100:103], a[36:39], v[56:59]
  buffer_load_dwordx4 v8, s[20:23], s28 offen offset:0 lds
  v_mfma_f32_16x16x32_bf16 v[28:31], a[96:99], a[40:43], v[28:31]
  v_mfma_f32_16x16x32_bf16 v[60:63], a[100:103], a[40:43], v[60:63]
  v_mfma_f32_16x16x32_bf16 v[32:35], a[96:99], a[44:47], v[32:35]
  v_mfma_f32_16x16x32_bf16 v[64:67], a[100:103], a[44:47], v[64:67]
  buffer_load_dwordx4 v9, s[20:23], s28 offen offset:1024 lds
  v_pk_mul_f32 v[24:25], v[24:25], s[6:7]
  v_mfma_f32_16x16x32_bf16 v[36:39], a[96:99], a[48:51], v[36:39]
  v_pk_mul_f32 v[26:27], v[26:27], s[6:7]
  v_pk_mul_f32 v[56:57], v[56:57], s[6:7]
  v_mfma_f32_16x16x32_bf16 v[68:71], a[100:103], a[48:51], v[68:71]
  v_pk_mul_f32 v[58:59], v[58:59], s[6:7]
  v_cvt_pk_bf16_f32 v24, v24, v25
  v_mfma_f32_16x16x32_bf16 v[40:43], a[96:99], a[52:55], v[40:43]
  v_cvt_pk_bf16_f32 v25, v26, v27
  v_cvt_pk_bf16_f32 v26, v56, v57
  v_mfma_f32_16x16x32_bf16 v[72:75], a[100:103], a[52:55], v[72:75]
  v_cvt_pk_bf16_f32 v27, v58, v59
  v_pk_mul_f32 v[28:29], v[28:29], s[6:7]
  v_mfma_f32_16x16x32_bf16 v[44:47], a[96:99], a[56:59], v[44:47]
  buffer_load_dwordx4 v10, s[20:23], s28 offen offset:2048 lds
  v_pk_mul_f32 v[30:31], v[30:31], s[6:7]
  v_mfma_f32_16x16x32_bf16 v[76:79], a[100:103], a[56:59], v[76:79]
  v_pk_mul_f32 v[60:61], v[60:61], s[6:7]
  v_pk_mul_f32 v[62:63], v[62:63], s[6:7]
  v_mfma_f32_16x16x32_bf16 v[48:51], a[96:99], a[60:63], v[48:51]
  v_cvt_pk_bf16_f32 v28, v28, v29
  v_cvt_pk_bf16_f32 v29, v30, v31
  v_mfma_f32_16x16x32_bf16 v[80:83], a[100:103], a[60:63], v[80:83]
  v_cvt_pk_bf16_f32 v30, v60, v61
  v_cvt_pk_bf16_f32 v31, v62, v63
  v_mfma_f32_16x16x32_bf16 v[52:55], a[96:99], a[64:67], v[52:55]
  v_pk_mul_f32 v[32:33], v[32:33], s[6:7]
  v_pk_mul_f32 v[34:35], v[34:35], s[6:7]
  v_mfma_f32_16x16x32_bf16 v[84:87], a[100:103], a[64:67], v[84:87]
  buffer_load_dwordx4 v11, s[20:23], s28 offen offset:3072 lds
  v_pk_mul_f32 v[64:65], v[64:65], s[6:7]
  v_mfma_f32_16x16x32_bf16 v[216:219], a[80:83], a[32:35], v[216:219]
  s_bfe_u32 s56, 0x302010e, s55
  s_add_u32 s54, s54, s56
  s_add_u32 s55, s55, 8
  v_mfma_f32_16x16x32_bf16 v[220:223], a[84:87], a[32:35], v[220:223]
  s_and_b32 s55, s55, 0x8001f
  s_and_b32 s54, s54, 15
  s_lshl_b32 s28, s54, 19
  v_mfma_f32_16x16x32_bf16 v[216:219], a[104:107], a[68:71], v[216:219]
  s_add_u32 m0, s68, 16384
  v_pk_mul_f32 v[66:67], v[66:67], s[6:7]
  v_cvt_pk_bf16_f32 v32, v32, v33
  v_mfma_f32_16x16x32_bf16 v[220:223], a[108:111], a[68:71], v[220:223]
  v_cvt_pk_bf16_f32 v33, v34, v35
  v_cvt_pk_bf16_f32 v34, v64, v65
  v_mfma_f32_16x16x32_bf16 v[88:91], a[80:83], a[0:3], v[88:91]
  buffer_load_dwordx4 v8, s[20:23], s28 offen offset:0 lds
  v_cvt_pk_bf16_f32 v35, v66, v67
  v_mfma_f32_16x16x32_bf16 v[120:123], a[84:87], a[0:3], v[120:123]
  v_pk_mul_f32 v[36:37], v[36:37], s[6:7]
  v_pk_mul_f32 v[38:39], v[38:39], s[6:7]
  v_mfma_f32_16x16x32_bf16 v[88:91], a[104:107], a[36:39], v[88:91]
  v_pk_mul_f32 v[68:69], v[68:69], s[6:7]
  v_pk_mul_f32 v[70:71], v[70:71], s[6:7]
  v_mfma_f32_16x16x32_bf16 v[120:123], a[108:111], a[36:39], v[120:123]
  v_cvt_pk_bf16_f32 v36, v36, v37
  v_cvt_pk_bf16_f32 v37, v38, v39
  v_mfma_f32_16x16x32_bf16 v[92:95], a[80:83], a[4:7], v[92:95]
  v_cvt_pk_bf16_f32 v38, v68, v69
  v_cvt_pk_bf16_f32 v39, v70, v71
  v_mfma_f32_16x16x32_bf16 v[124:127], a[84:87], a[4:7], v[124:127]
  buffer_load_dwordx4 v9, s[20:23], s28 offen offset:1024 lds
  v_pk_mul_f32 v[40:41], v[40:41], s[6:7]
  v_mfma_f32_16x16x32_bf16 v[92:95], a[104:107], a[40:43], v[92:95]
  v_pk_mul_f32 v[42:43], v[42:43], s[6:7]
  v_pk_mul_f32 v[72:73], v[72:73], s[6:7]
  v_mfma_f32_16x16x32_bf16 v[124:127], a[108:111], a[40:43], v[124:127]
  v_pk_mul_f32 v[74:75], v[74:75], s[6:7]
  v_cvt_pk_bf16_f32 v40, v40, v41
  v_mfma_f32_16x16x32_bf16 v[96:99], a[80:83], a[8:11], v[96:99]
  v_cvt_pk_bf16_f32 v41, v42, v43
  v_cvt_pk_bf16_f32 v42, v72, v73
  v_mfma_f32_16x16x32_bf16 v[128:131], a[84:87], a[8:11], v[128:131]
  v_cvt_pk_bf16_f32 v43, v74, v75
  v_pk_mul_f32 v[44:45], v[44:45], s[6:7]
  v_mfma_f32_16x16x32_bf16 v[96:99], a[104:107], a[44:47], v[96:99]
  v_pk_mul_f32 v[46:47], v[46:47], s[6:7]
  v_pk_mul_f32 v[76:77], v[76:77], s[6:7]
  v_mfma_f32_16x16x32_bf16 v[128:131], a[108:111], a[44:47], v[128:131]
  buffer_load_dwordx4 v10, s[20:23], s28 offen offset:2048 lds
  v_pk_mul_f32 v[78:79], v[78:79], s[6:7]
  v_mfma_f32_16x16x32_bf16 v[100:103], a[80:83], a[12:15], v[100:103]
  v_cvt_pk_bf16_f32 v44, v44, v45
  v_cvt_pk_bf16_f32 v45, v46, v47
  v_mfma_f32_16x16x32_bf16 v[132:135], a[84:87], a[12:15], v[132:135]
  v_cvt_pk_bf16_f32 v46, v76, v77
  v_cvt_pk_bf16_f32 v47, v78, v79
  v_mfma_f32_16x16x32_bf16 v[100:103], a[104:107], a[48:51], v[100:103]
  v_pk_mul_f32 v[48:49], v[48:49], s[6:7]
  v_pk_mul_f32 v[50:51], v[50:51], s[6:7]
  v_mfma_f32_16x16x32_bf16 v[132:135], a[108:111], a[48:51], v[132:135]
  v_pk_mul_f32 v[80:81], v[80:81], s[6:7]
  v_pk_mul_f32 v[82:83], v[82:83], s[6:7]
  v_mfma_f32_16x16x32_bf16 v[104:107], a[80:83], a[16:19], v[104:107]
  buffer_load_dwordx4 v11, s[20:23], s28 offen offset:3072 lds
  v_cvt_pk_bf16_f32 v48, v48, v49
  v_mfma_f32_16x16x32_bf16 v[136:139], a[84:87], a[16:19], v[136:139]
  s_bfe_u32 s56, 0x302010e, s55
  s_add_u32 s54, s54, s56
  s_add_u32 s55, s55, 8
  v_mfma_f32_16x16x32_bf16 v[104:107], a[104:107], a[52:55], v[104:107]
  s_and_b32 s55, s55, 0x8001f
  s_and_b32 s54, s54, 15
  s_lshl_b32 s28, s54, 19
  v_mfma_f32_16x16x32_bf16 v[136:139], a[108:111], a[52:55], v[136:139]
  s_mov_b32 m0, s88
  v_cvt_pk_bf16_f32 v49, v50, v51
  v_cvt_pk_bf16_f32 v50, v80, v81
  v_mfma_f32_16x16x32_bf16 v[108:111], a[80:83], a[20:23], v[108:111]
  v_cvt_pk_bf16_f32 v51, v82, v83
  v_pk_mul_f32 v[52:53], v[52:53], s[6:7]
  v_mfma_f32_16x16x32_bf16 v[140:143], a[84:87], a[20:23], v[140:143]
  buffer_load_dwordx4 v4, s[8:11], s26 offen offset:0 lds
  v_pk_mul_f32 v[54:55], v[54:55], s[6:7]
  v_mfma_f32_16x16x32_bf16 v[108:111], a[104:107], a[56:59], v[108:111]
  v_pk_mul_f32 v[84:85], v[84:85], s[6:7]
  v_pk_mul_f32 v[86:87], v[86:87], s[6:7]
  v_mfma_f32_16x16x32_bf16 v[140:143], a[108:111], a[56:59], v[140:143]
  v_cvt_pk_bf16_f32 v52, v52, v53
  v_cvt_pk_bf16_f32 v53, v54, v55
  v_mfma_f32_16x16x32_bf16 v[112:115], a[80:83], a[24:27], v[112:115]
  v_cvt_pk_bf16_f32 v54, v84, v85
  v_cvt_pk_bf16_f32 v55, v86, v87
  v_mfma_f32_16x16x32_bf16 v[144:147], a[84:87], a[24:27], v[144:147]
  v_cvt_pk_bf16_f32 v216, v216, v217
  v_cvt_pk_bf16_f32 v217, v218, v219
  v_mfma_f32_16x16x32_bf16 v[112:115], a[104:107], a[60:63], v[112:115]
  buffer_load_dwordx4 v5, s[8:11], s26 offen offset:1024 lds
  v_cvt_pk_bf16_f32 v218, v220, v221
  v_mfma_f32_16x16x32_bf16 v[144:147], a[108:111], a[60:63], v[144:147]
  v_cvt_pk_bf16_f32 v219, v222, v223
  v_mfma_f32_16x16x32_bf16 v[116:119], a[80:83], a[28:31], v[116:119]
  ds_write_b128 v252, v[216:219]
  v_cvt_pk_bf16_f32 v88, v88, v89
  v_mfma_f32_16x16x32_bf16 v[148:151], a[84:87], a[28:31], v[148:151]
  v_cvt_pk_bf16_f32 v89, v90, v91
  v_cvt_pk_bf16_f32 v90, v120, v121
  v_mfma_f32_16x16x32_bf16 v[116:119], a[104:107], a[64:67], v[116:119]
  v_cvt_pk_bf16_f32 v91, v122, v123
  v_cvt_pk_bf16_f32 v92, v92, v93
  v_mfma_f32_16x16x32_bf16 v[148:151], a[108:111], a[64:67], v[148:151]
  buffer_load_dwordx4 v6, s[8:11], s26 offen offset:2048 lds
  v_cvt_pk_bf16_f32 v93, v94, v95
  v_mfma_f32_16x16x32_bf16 v[180:183], a[28:31], a[88:91], v[180:183]
  v_cvt_pk_bf16_f32 v94, v124, v125
  v_cvt_pk_bf16_f32 v95, v126, v127
  v_mfma_f32_16x16x32_bf16 v[212:215], a[28:31], a[92:95], v[212:215]
  v_cvt_pk_bf16_f32 v96, v96, v97
  v_cvt_pk_bf16_f32 v97, v98, v99
  v_mfma_f32_16x16x32_bf16 v[180:183], a[64:67], a[112:115], v[180:183]
  v_cvt_pk_bf16_f32 v98, v128, v129
  v_cvt_pk_bf16_f32 v99, v130, v131
  v_mfma_f32_16x16x32_bf16 v[212:215], a[64:67], a[116:119], v[212:215]
  v_cvt_pk_bf16_f32 v100, v100, v101
  v_cvt_pk_bf16_f32 v101, v102, v103
  v_mfma_f32_16x16x32_bf16 v[176:179], a[24:27], a[88:91], v[176:179]
  v_cvt_pk_bf16_f32 v102, v132, v133
  v_cvt_pk_bf16_f32 v103, v134, v135
  v_mfma_f32_16x16x32_bf16 v[208:211], a[24:27], a[92:95], v[208:211]
  buffer_load_dwordx4 v7, s[8:11], s26 offen offset:3072 lds
  v_cvt_pk_bf16_f32 v104, v104, v105
  v_mfma_f32_16x16x32_bf16 v[176:179], a[60:63], a[112:115], v[176:179]
  s_add_u32 m0, s88, 4096
  v_cvt_pk_bf16_f32 v105, v106, v107
  v_cvt_pk_bf16_f32 v106, v136, v137
  v_mfma_f32_16x16x32_bf16 v[208:211], a[60:63], a[116:119], v[208:211]
  v_cvt_pk_bf16_f32 v107, v138, v139
  v_cvt_pk_bf16_f32 v108, v108, v109
  v_mfma_f32_16x16x32_bf16 v[172:175], a[20:23], a[88:91], v[172:175]
  v_cvt_pk_bf16_f32 v109, v110, v111
  v_cvt_pk_bf16_f32 v110, v140, v141
  v_mfma_f32_16x16x32_bf16 v[204:207], a[20:23], a[92:95], v[204:207]
  v_cvt_pk_bf16_f32 v111, v142, v143
  v_cvt_pk_bf16_f32 v112, v112, v113
  v_mfma_f32_16x16x32_bf16 v[172:175], a[56:59], a[112:115], v[172:175]
  buffer_load_dwordx4 v4, s[8:11], s27 offen offset:0 lds
  v_cvt_pk_bf16_f32 v113, v114, v115
  v_mfma_f32_16x16x32_bf16 v[204:207], a[56:59], a[116:119], v[204:207]
  v_cvt_pk_bf16_f32 v114, v144, v145
  v_cvt_pk_bf16_f32 v115, v146, v147
  v_mfma_f32_16x16x32_bf16 v[168:171], a[16:19], a[88:91], v[168:171]
  v_cvt_pk_bf16_f32 v116, v116, v117
  v_cvt_pk_bf16_f32 v117, v118, v119
  v_mfma_f32_16x16x32_bf16 v[200:203], a[16:19], a[92:95], v[200:203]
  v_cvt_pk_bf16_f32 v118, v148, v149
  v_cvt_pk_bf16_f32 v119, v150, v151
  v_mfma_f32_16x16x32_bf16 v[168:171], a[52:55], a[112:115], v[168:171]
  ds_write_b128 v252, v[116:119] offset:2048
  v_cvt_pk_bf16_f32 v72, v180, v181
  v_mfma_f32_16x16x32_bf16 v[200:203], a[52:55], a[116:119], v[200:203]
  buffer_load_dwordx4 v5, s[8:11], s27 offen offset:1024 lds
  v_cvt_pk_bf16_f32 v73, v182, v183
  v_mfma_f32_16x16x32_bf16 v[164:167], a[12:15], a[88:91], v[164:167]
  v_cvt_pk_bf16_f32 v136, v212, v213
  v_cvt_pk_bf16_f32 v137, v214, v215
  v_mfma_f32_16x16x32_bf16 v[196:199], a[12:15], a[92:95], v[196:199]
  ds_write_b64 v252, v[72:73] offset:3072
  ds_write_b64 v252, v[136:137] offset:3080
  v_mfma_f32_16x16x32_bf16 v[164:167], a[48:51], a[112:115], v[164:167]
  v_cvt_pk_bf16_f32 v70, v176, v177
  v_cvt_pk_bf16_f32 v71, v178, v179
  v_mfma_f32_16x16x32_bf16 v[196:199], a[48:51], a[116:119], v[196:199]
  v_cvt_pk_bf16_f32 v134, v208, v209
  v_cvt_pk_bf16_f32 v135, v210, v211
  v_mfma_f32_16x16x32_bf16 v[160:163], a[8:11], a[88:91], v[160:163]
  buffer_load_dwordx4 v6, s[8:11], s27 offen offset:2048 lds
  v_cvt_pk_bf16_f32 v68, v172, v173
  v_mfma_f32_16x16x32_bf16 v[192:195], a[8:11], a[92:95], v[192:195]
  v_cvt_pk_bf16_f32 v69, v174, v175
  v_cvt_pk_bf16_f32 v132, v204, v205
  v_mfma_f32_16x16x32_bf16 v[160:163], a[44:47], a[112:115], v[160:163]
  v_cvt_pk_bf16_f32 v133, v206, v207
  v_cvt_pk_bf16_f32 v66, v168, v169
  v_mfma_f32_16x16x32_bf16 v[192:195], a[44:47], a[116:119], v[192:195]
  v_cvt_pk_bf16_f32 v67, v170, v171
  v_cvt_pk_bf16_f32 v130, v200, v201
  v_mfma_f32_16x16x32_bf16 v[156:159], a[4:7], a[88:91], v[156:159]
  v_cvt_pk_bf16_f32 v131, v202, v203
  v_cvt_pk_bf16_f32 v64, v164, v165
  v_mfma_f32_16x16x32_bf16 v[188:191], a[4:7], a[92:95], v[188:191]
  buffer_load_dwordx4 v7, s[8:11], s27 offen offset:3072 lds
  v_cvt_pk_bf16_f32 v65, v166, v167
  v_mfma_f32_16x16x32_bf16 v[156:159], a[40:43], a[112:115], v[156:159]
  s_bfe_u32 s29, 0x302010e, s53
  s_add_u32 s52, s52, s29
  s_add_u32 s53, s53, 8
  v_mfma_f32_16x16x32_bf16 v[188:191], a[40:43], a[116:119], v[188:191]
  s_and_b32 s53, s53, 0x8001f
  s_and_b32 s52, s52, 15
  s_lshl_b32 s29, s52, 7
  v_mfma_f32_16x16x32_bf16 v[152:155], a[0:3], a[88:91], v[152:155]
  s_or_b32 s26, s30, s29
  s_or_b32 s27, s31, s29
  v_cvt_pk_bf16_f32 v128, v196, v197
  v_mfma_f32_16x16x32_bf16 v[184:187], a[0:3], a[92:95], v[184:187]
  v_cvt_pk_bf16_f32 v129, v198, v199
  v_cvt_pk_bf16_f32 v62, v160, v161
  v_mfma_f32_16x16x32_bf16 v[152:155], a[36:39], a[112:115], v[152:155]
  v_cvt_pk_bf16_f32 v63, v162, v163
  v_cvt_pk_bf16_f32 v126, v192, v193
  v_mfma_f32_16x16x32_bf16 v[184:187], a[36:39], a[116:119], v[184:187]
  v_cvt_pk_bf16_f32 v127, v194, v195
  v_cvt_pk_bf16_f32 v60, v156, v157
  v_cvt_pk_bf16_f32 v61, v158, v159
  v_cvt_pk_bf16_f32 v124, v188, v189
  v_cvt_pk_bf16_f32 v125, v190, v191
  v_cvt_pk_bf16_f32 v58, v152, v153
  v_cvt_pk_bf16_f32 v59, v154, v155
  s_nop 0
  v_cvt_pk_bf16_f32 v122, v184, v185
  v_cvt_pk_bf16_f32 v123, v186, v187
  s_waitcnt lgkmcnt(0)
  s_barrier
  s_branch Lp2_at
Lp2_r1:
  s_mov_b32 m0, s36
  s_nop 0
  buffer_load_dwordx4 v224, s[8:11], s46 offen offset:0 lds
  buffer_load_dwordx4 v225, s[8:11], s46 offen offset:1024 lds
  buffer_load_dwordx4 v226, s[8:11], s46 offen offset:2048 lds
  buffer_load_dwordx4 v227, s[8:11], s46 offen offset:3072 lds
  s_add_u32 m0, s36, 4096
  s_nop 0
  buffer_load_dwordx4 v228, s[8:11], s46 offen offset:0 lds
  buffer_load_dwordx4 v229, s[8:11], s46 offen offset:1024 lds
  buffer_load_dwordx4 v230, s[8:11], s46 offen offset:2048 lds
  buffer_load_dwordx4 v231, s[8:11], s46 offen offset:3072 lds
  s_mul_i32 s47, s48, 393216
  s_bfe_u32 s34, 0x302010e, s49
  s_add_u32 s48, s48, s34
  s_add_u32 s49, s49, 8
  s_and_b32 s49, s49, 0x8001f
  s_and_b32 s48, s48, 15
  s_lshl_b32 s46, s48, 7
  s_mov_b32 m0, s41
  s_nop 0
  buffer_load_dwordx4 v233, s[12:15], s47 offen offset:0 lds
  buffer_load_dwordx4 v234, s[12:15], s47 offen offset:1024 lds
  buffer_load_dwordx4 v235, s[12:15], s47 offen offset:2048 lds
  s_add_u32 m0, s41, 3072
  s_nop 0
  buffer_load_dwordx4 v236, s[12:15], s47 offen offset:0 lds
  buffer_load_dwordx4 v237, s[12:15], s47 offen offset:1024 lds
  buffer_load_dwordx4 v238, s[12:15], s47 offen offset:2048 lds
  s_lshr_b32 s4, s3, 1
  s_lshl_b32 s4, s4, 14
  v_and_b32 v240, 15, v1
  v_lshlrev_b32 v240, 7, v240
  v_lshrrev_b32 v241, 4, v1
  v_and_b32 v242, 6, v1
  v_xor_b32 v241, v241, v242
  v_lshl_add_u32 v240, v241, 4, v240
  v_add_u32 v16, s4, v240
  v_xor_b32 v17, 64, v16
  v_and_b32 v240, 15, v1
  v_lshlrev_b32 v240, 7, v240
  v_lshrrev_b32 v241, 4, v1
  v_and_b32 v242, 6, v1
  v_xor_b32 v241, v241, v242
  v_lshl_add_u32 v240, v241, 4, v240
  v_add_u32 v18, 32768, v240
  v_xor_b32 v19, 64, v18
  v_lshrrev_b32 v240, 2, v1
  v_and_b32 v241, 6, v240
  v_lshlrev_b32 v240, 7, v240
  v_and_b32 v242, 1, v1
  v_lshl_add_u32 v240, v242, 3, v240
  v_add_u32 v240, 104448, v240
  v_bfe_u32 v242, v1, 1, 1
  v_xor_b32 v241, v241, v242
  v_xor_b32 v242, 0, v241
  v_lshl_add_u32 v20, v242, 4, v240
  v_xor_b32 v242, 2, v241
  s_add_u32 m0, s36, 34816
  s_nop 0
  buffer_load_dwordx4 v224, s[8:11], s46 offen offset:0 lds
  v_lshl_add_u32 v21, v242, 4, v240
  s_and_b32 s4, s3, 1
  s_lshl_b32 s4, s4, 6
  v_xor_b32 v20, s4, v20
  v_xor_b32 v21, s4, v21
  s_and_b32 s24, s2, 7
  s_lshr_b32 s4, s2, 6
  s_lshl_b32 s4, s4, 3
  s_add_u32 s24, s24, s4
  s_lshr_b32 s25, s2, 3
  s_and_b32 s25, s25, 7
  v_lshrrev_b32 v24, 3, v1
  v_and_b32 v25, 6, v24
  v_and_b32 v26, 7, v1
  v_xor_b32 v25, v25, v26
  v_lshlrev_b32 v25, 4, v25
  s_and_b32 s4, s3, 1
  s_lshl_b32 s4, s4, 16
  s_lshr_b32 s5, s3, 1
  s_lshl_b32 s5, s5, 7
  s_add_u32 s4, s4, s5
  v_lshl_add_u32 v24, v24, 11, v25
  v_add_u32 v24, s4, v24
  buffer_load_dwordx4 v225, s[8:11], s46 offen offset:1024 lds
  v_add_u32 v25, 0, v24
  v_accvgpr_write_b32 a212, v25
  v_add_u32 v25, 15360, v24
  v_accvgpr_write_b32 a213, v25
  v_add_u32 v25, 30720, v24
  v_accvgpr_write_b32 a214, v25
  v_add_u32 v25, 46080, v24
  v_accvgpr_write_b32 a215, v25
  buffer_load_dwordx4 v226, s[8:11], s46 offen offset:2048 lds
  v_accvgpr_write_b32 a236, 0
  v_mov_b32 v27, 0x3f803f80
  v_accvgpr_write_b32 a208, v27
  v_accvgpr_write_b32 a237, 0
  v_accvgpr_write_b32 a209, v27
  v_accvgpr_write_b32 a238, 0
  v_accvgpr_write_b32 a210, v27
  buffer_load_dwordx4 v227, s[8:11], s46 offen offset:3072 lds
  v_accvgpr_write_b32 a239, 0
  v_accvgpr_write_b32 a211, v27
  v_lshrrev_b32 v24, 3, v1
  v_and_b32 v25, 6, v24
  v_and_b32 v26, 7, v1
  v_xor_b32 v25, v25, v26
  v_lshlrev_b32 v25, 4, v25
  v_lshlrev_b32 v26, 2, v24
  s_add_u32 m0, s36, 38912
  s_nop 0
  buffer_load_dwordx4 v228, s[8:11], s46 offen offset:0 lds
  v_add_u32 v26, s3, v26
  v_lshl_add_u32 v26, v26, 11, v25
  v_add_u32 v27, 0, v26
  v_accvgpr_write_b32 a222, v27
  v_add_u32 v27, 64512, v26
  v_accvgpr_write_b32 a223, v27
  v_add_u32 v27, 129024, v26
  buffer_load_dwordx4 v229, s[8:11], s46 offen offset:1024 lds
  v_accvgpr_write_b32 a224, v27
  v_add_u32 v27, 193536, v26
  v_accvgpr_write_b32 a225, v27
  v_lshrrev_b32 v26, 2, v24
  v_and_b32 v27, 3, v24
  v_lshl_add_u32 v26, v26, 3, v27
  s_and_b32 s4, s3, 1
  s_lshl_b32 s4, s4, 18
  s_lshr_b32 s5, s3, 1
  s_lshl_b32 s5, s5, 7
  s_add_u32 s4, s4, s5
  s_lshl_b32 s5, s24, 8
  s_add_u32 s4, s4, s5
  v_lshl_add_u32 v26, v26, 13, v25
  v_add_u32 v26, s4, v26
  v_add_u32 v27, 0, v26
  buffer_load_dwordx4 v230, s[8:11], s46 offen offset:2048 lds
  v_accvgpr_write_b32 a226, v27
  v_add_u32 v27, 130048, v26
  v_accvgpr_write_b32 a227, v27
  v_add_u32 v27, 30720, v26
  v_accvgpr_write_b32 a228, v27
  v_add_u32 v27, 160768, v26
  v_accvgpr_write_b32 a229, v27
  s_lshl_b32 s4, s3, 13
  s_add_u32 s4, s4, 98304
  v_and_b32 v24, 15, v1
  buffer_load_dwordx4 v231, s[8:11], s46 offen offset:3072 lds
  v_lshlrev_b32 v24, 7, v24
  v_lshrrev_b32 v25, 4, v1
  v_and_b32 v26, 6, v1
  v_xor_b32 v25, v25, v26
  v_lshl_add_u32 v24, v25, 4, v24
  v_add_u32 v28, s4, v24
  v_xor_b32 v29, 64, v28
  v_lshrrev_b32 v24, 2, v1
  s_mul_i32 s47, s48, 393216
  s_bfe_u32 s34, 0x302010e, s49
  s_add_u32 s48, s48, s34
  s_add_u32 s49, s49, 8
  s_and_b32 s49, s49, 0x8001f
  s_and_b32 s48, s48, 15
  s_lshl_b32 s46, s48, 7
  s_add_u32 m0, s41, 24576
  s_nop 0
  buffer_load_dwordx4 v233, s[12:15], s47 offen offset:0 lds
  v_and_b32 v25, 6, v24
  v_lshlrev_b32 v24, 7, v24
  v_and_b32 v26, 1, v1
  v_lshl_add_u32 v24, v26, 3, v24
  v_add_u32 v24, 0, v24
  v_bfe_u32 v26, v1, 1, 1
  v_xor_b32 v25, v25, v26
  buffer_load_dwordx4 v234, s[12:15], s47 offen offset:1024 lds
  v_xor_b32 v26, 0, v25
  v_lshl_add_u32 v30, v26, 4, v24
  v_xor_b32 v26, 2, v25
  v_lshl_add_u32 v31, v26, 4, v24
  v_xor_b32 v26, 4, v25
  v_lshl_add_u32 v32, v26, 4, v24
  v_xor_b32 v26, 6, v25
  v_lshl_add_u32 v33, v26, 4, v24
  buffer_load_dwordx4 v235, s[12:15], s47 offen offset:2048 lds
  v_accvgpr_write_b32 a230, v28
  v_accvgpr_write_b32 a231, v29
  v_accvgpr_write_b32 a232, v30
  v_accvgpr_write_b32 a233, v31
  v_accvgpr_write_b32 a234, v32
  v_accvgpr_write_b32 a235, v33
  v_and_b32 v253, 15, v1
  s_add_u32 m0, s41, 27648
  s_nop 0
  buffer_load_dwordx4 v236, s[12:15], s47 offen offset:0 lds
  v_lshrrev_b32 v254, 4, v1
  v_lshlrev_b32 v254, 2, v254
  v_sub_u32 v253, v253, v254
  v_mov_b32 v254, 0xf149f2ca
  s_lshr_b32 s4, s3, 1
  s_or_b32 s4, s4, s32
  s_cselect_b64 s[6:7], 0, -1
  v_subrev_u32 v255, 0, v253
  v_and_b32 v252, 0x80000001, v255
  v_cmp_ne_u32 vcc, 0, v252
  s_nop 1
  v_cndmask_b32 v244, 0, v254, vcc
  v_add_u32 v255, 1, v255
  v_and_b32 v252, 0x80000001, v255
  v_cmp_ne_u32 vcc, 0x80000001, v252
  s_nop 1
  v_cndmask_b32 v240, 0, v254, vcc
  v_cndmask_b32 v248, v240, v254, s[6:7]
  buffer_load_dwordx4 v237, s[12:15], s47 offen offset:1024 lds
  v_subrev_u32 v255, 1, v253
  v_and_b32 v252, 0x80000001, v255
  v_cmp_ne_u32 vcc, 0, v252
  s_nop 1
  v_cndmask_b32 v245, 0, v254, vcc
  v_add_u32 v255, 1, v255
  v_and_b32 v252, 0x80000001, v255
  v_cmp_ne_u32 vcc, 0x80000001, v252
  s_nop 1
  v_cndmask_b32 v241, 0, v254, vcc
  v_cndmask_b32 v249, v241, v254, s[6:7]
  v_subrev_u32 v255, 2, v253
  v_and_b32 v252, 0x80000001, v255
  v_cmp_ne_u32 vcc, 0, v252
  s_nop 1
  v_cndmask_b32 v246, 0, v254, vcc
  buffer_load_dwordx4 v238, s[12:15], s47 offen offset:2048 lds
  v_add_u32 v255, 1, v255
  v_and_b32 v252, 0x80000001, v255
  v_cmp_ne_u32 vcc, 0x80000001, v252
  s_nop 1
  v_cndmask_b32 v242, 0, v254, vcc
  v_cndmask_b32 v250, v242, v254, s[6:7]
  v_subrev_u32 v255, 3, v253
  v_and_b32 v252, 0x80000001, v255
  v_cmp_ne_u32 vcc, 0, v252
  s_nop 1
  v_cndmask_b32 v247, 0, v254, vcc
  v_add_u32 v255, 1, v255
  v_and_b32 v252, 0x80000001, v255
  v_cmp_ne_u32 vcc, 0x80000001, v252
  s_nop 1
  v_cndmask_b32 v243, 0, v254, vcc
  v_cndmask_b32 v251, v243, v254, s[6:7]
  s_and_b32 s4, s3, 1
  s_lshl_b32 s4, s4, 12
  s_add_u32 s4, s4, 49152
  v_add_u32 v252, s4, v2
  s_lshr_b32 s5, s3, 1
  s_lshl_b32 s5, s5, 11
  v_add_u32 v253, s5, v252
  s_add_u32 s16, s86, 83886080
  s_addc_u32 s17, s87, 0
  s_mov_b32 s18, 4194304
  s_mov_b32 s19, 0x00020000
  s_lshl_b32 s57, s32, 19
  s_lshl_b32 s5, s5, 7
  s_add_u32 s57, s57, s5
  s_lshl_b32 s4, s33, 14
  s_add_u32 s57, s57, s4
  s_and_b32 s4, s3, 1
  s_lshl_b32 s4, s4, 13
  s_add_u32 s57, s57, s4
  s_add_u32 s58, s57, 4096
  s_mov_b32 s37, 0
  s_mov_b32 s39, 4294897664
  s_mov_b32 s40, 34816
  s_mov_b32 s42, 0
  s_mov_b32 s44, 4294942720
  s_mov_b32 s45, 24576
  s_mov_b32 s43, s44
  s_waitcnt vmcnt(14)
  s_barrier
  ds_read_b128 a[0:3], v16 offset:0
  ds_read_b64_tr_b16 a[72:73], v20 offset:0
  ds_read_b64_tr_b16 a[74:75], v20 offset:2048
  ds_read_b128 a[4:7], v16 offset:2048
  ds_read_b128 a[8:11], v16 offset:4096
  ds_read_b128 a[12:15], v16 offset:6144
  ds_read_b128 a[16:19], v16 offset:8192
  ds_read_b128 a[20:23], v16 offset:10240
  ds_read_b128 a[24:27], v16 offset:12288
  ds_read_b128 a[28:31], v16 offset:14336
  ds_read_b64_tr_b16 a[76:77], v21 offset:0
  ds_read_b64_tr_b16 a[78:79], v21 offset:2048
  ds_read_b64_tr_b16 a[80:81], v20 offset:8192
  ds_read_b64_tr_b16 a[82:83], v20 offset:10240
  ds_read_b64_tr_b16 a[84:85], v21 offset:8192
  ds_read_b64_tr_b16 a[86:87], v21 offset:10240
  ds_read_b64_tr_b16 a[88:89], v20 offset:16384
  ds_read_b64_tr_b16 a[90:91], v20 offset:18432
  ds_read_b128 a[32:35], v18 offset:0
  ds_read_b64_tr_b16 a[92:93], v21 offset:16384
  ds_read_b64_tr_b16 a[94:95], v21 offset:18432
  s_waitcnt lgkmcnt(0)
  v_mfma_f32_16x16x32_bf16 v[24:27], a[72:75], a[0:3], 0
  s_add_u32 m0, s36, 69632
  ds_read_b128 a[36:39], v17 offset:0
  v_mfma_f32_16x16x32_bf16 v[28:31], a[72:75], a[4:7], 0
  buffer_load_dwordx4 v224, s[8:11], s46 offen offset:0 lds
  ds_read_b64_tr_b16 a[96:97], v20 offset:4096
  v_mfma_f32_16x16x32_bf16 v[32:35], a[72:75], a[8:11], 0
  v_mfma_f32_16x16x32_bf16 v[36:39], a[72:75], a[12:15], 0
  ds_read_b64_tr_b16 a[98:99], v20 offset:6144
  v_mfma_f32_16x16x32_bf16 v[40:43], a[72:75], a[16:19], 0
  v_mfma_f32_16x16x32_bf16 v[44:47], a[72:75], a[20:23], 0
  buffer_load_dwordx4 v225, s[8:11], s46 offen offset:1024 lds
  ds_read_b128 a[40:43], v17 offset:2048
  v_mfma_f32_16x16x32_bf16 v[48:51], a[72:75], a[24:27], 0
  v_mfma_f32_16x16x32_bf16 v[52:55], a[72:75], a[28:31], 0
  ds_read_b128 a[44:47], v17 offset:4096
  v_mfma_f32_16x16x32_bf16 v[56:59], a[76:79], a[0:3], 0
  v_mfma_f32_16x16x32_bf16 v[60:63], a[76:79], a[4:7], 0
  ds_read_b128 a[48:51], v17 offset:6144
  v_mfma_f32_16x16x32_bf16 v[64:67], a[76:79], a[8:11], 0
  buffer_load_dwordx4 v226, s[8:11], s46 offen offset:2048 lds
  v_mfma_f32_16x16x32_bf16 v[68:71], a[76:79], a[12:15], 0
  ds_read_b128 a[52:55], v17 offset:8192
  v_mfma_f32_16x16x32_bf16 v[72:75], a[76:79], a[16:19], 0
  v_mfma_f32_16x16x32_bf16 v[76:79], a[76:79], a[20:23], 0
  ds_read_b128 a[56:59], v17 offset:10240
  v_mfma_f32_16x16x32_bf16 v[80:83], a[76:79], a[24:27], 0
  v_mfma_f32_16x16x32_bf16 v[84:87], a[76:79], a[28:31], 0
  ds_read_b128 a[60:63], v17 offset:12288
  v_mfma_f32_16x16x32_bf16 v[88:91], a[80:83], a[0:3], 0
  buffer_load_dwordx4 v227, s[8:11], s46 offen offset:3072 lds
  v_mfma_f32_16x16x32_bf16 v[92:95], a[80:83], a[4:7], 0
  s_add_u32 m0, s36, 73728
  ds_read_b128 a[64:67], v17 offset:14336
  v_mfma_f32_16x16x32_bf16 v[96:99], a[80:83], a[8:11], 0
  v_mfma_f32_16x16x32_bf16 v[100:103], a[80:83], a[12:15], 0
  ds_read_b64_tr_b16 a[100:101], v21 offset:4096
  v_mfma_f32_16x16x32_bf16 v[104:107], a[80:83], a[16:19], 0
  ds_read_b64_tr_b16 a[102:103], v21 offset:6144
  v_mfma_f32_16x16x32_bf16 v[108:111], a[80:83], a[20:23], 0
  buffer_load_dwordx4 v228, s[8:11], s46 offen offset:0 lds
  v_mfma_f32_16x16x32_bf16 v[112:115], a[80:83], a[24:27], 0
  ds_read_b64_tr_b16 a[104:105], v20 offset:12288
  v_mfma_f32_16x16x32_bf16 v[116:119], a[80:83], a[28:31], 0
  v_mfma_f32_16x16x32_bf16 v[120:123], a[84:87], a[0:3], 0
  ds_read_b64_tr_b16 a[106:107], v20 offset:14336
  v_mfma_f32_16x16x32_bf16 v[124:127], a[84:87], a[4:7], 0
  v_mfma_f32_16x16x32_bf16 v[128:131], a[84:87], a[8:11], 0
  buffer_load_dwordx4 v229, s[8:11], s46 offen offset:1024 lds
  ds_read_b64_tr_b16 a[108:109], v21 offset:12288
  v_mfma_f32_16x16x32_bf16 v[132:135], a[84:87], a[12:15], 0
  v_mfma_f32_16x16x32_bf16 v[136:139], a[84:87], a[16:19], 0
  ds_read_b64_tr_b16 a[110:111], v21 offset:14336
  v_mfma_f32_16x16x32_bf16 v[140:143], a[84:87], a[20:23], 0
  v_mfma_f32_16x16x32_bf16 v[144:147], a[84:87], a[24:27], 0
  ds_read_b64_tr_b16 a[112:113], v20 offset:20480
  v_mfma_f32_16x16x32_bf16 v[148:151], a[84:87], a[28:31], 0
  v_mfma_f32_16x16x32_bf16 v[152:155], a[0:3], a[88:91], 0
  buffer_load_dwordx4 v230, s[8:11], s46 offen offset:2048 lds
  ds_read_b64_tr_b16 a[114:115], v20 offset:22528
  v_mfma_f32_16x16x32_bf16 v[156:159], a[4:7], a[88:91], 0
  v_mfma_f32_16x16x32_bf16 v[160:163], a[8:11], a[88:91], 0
  ds_read_b128 a[68:71], v19 offset:0
  v_mfma_f32_16x16x32_bf16 v[164:167], a[12:15], a[88:91], 0
  v_mfma_f32_16x16x32_bf16 v[168:171], a[16:19], a[88:91], 0
  ds_read_b64_tr_b16 a[116:117], v21 offset:20480
  v_mfma_f32_16x16x32_bf16 v[172:175], a[20:23], a[88:91], 0
  buffer_load_dwordx4 v231, s[8:11], s46 offen offset:3072 lds
  v_mfma_f32_16x16x32_bf16 v[176:179], a[24:27], a[88:91], 0
  s_mul_i32 s47, s48, 393216
  s_bfe_u32 s34, 0x302010e, s49
  s_add_u32 s48, s48, s34
  v_mfma_f32_16x16x32_bf16 v[180:183], a[28:31], a[88:91], 0
  s_add_u32 s49, s49, 8
  s_and_b32 s49, s49, 0x8001f
  s_and_b32 s48, s48, 15
  v_mfma_f32_16x16x32_bf16 v[216:219], a[32:35], a[88:91], 0
  s_lshl_b32 s46, s48, 7
  ds_read_b64_tr_b16 a[118:119], v21 offset:22528
  v_mfma_f32_16x16x32_bf16 v[184:187], a[0:3], a[92:95], 0
  s_add_u32 s37, s37, 1
  s_cmp_eq_u32 s37, 3
  s_cselect_b32 s37, 0, s37
  s_cselect_b32 s38, s39, s40
  v_mfma_f32_16x16x32_bf16 v[188:191], a[4:7], a[92:95], 0
  s_sub_u32 s43, 0, s43
  v_mfma_f32_16x16x32_bf16 v[192:195], a[8:11], a[92:95], 0
  v_add_u32 v16, s38, v16
  v_add_u32 v17, s38, v17
  v_mfma_f32_16x16x32_bf16 v[196:199], a[12:15], a[92:95], 0
  v_add_u32 v18, s38, v18
  v_add_u32 v19, s38, v19
  v_mfma_f32_16x16x32_bf16 v[200:203], a[16:19], a[92:95], 0
  v_add_u32 v20, s43, v20
  v_add_u32 v21, s43, v21
  v_mfma_f32_16x16x32_bf16 v[204:207], a[20:23], a[92:95], 0
  v_mfma_f32_16x16x32_bf16 v[208:211], a[24:27], a[92:95], 0
  v_mfma_f32_16x16x32_bf16 v[212:215], a[28:31], a[92:95], 0
  v_mfma_f32_16x16x32_bf16 v[220:223], a[32:35], a[92:95], 0
  s_mov_b32 s35, 13
  s_waitcnt vmcnt(8) lgkmcnt(0)
  s_barrier
  .p2align 6
Lp2r1_loop:
  v_mfma_f32_16x16x32_bf16 v[24:27], a[96:99], a[36:39], v[24:27]
  s_mov_b32 m0, s41
  ds_read_b128 a[0:3], v16 offset:0
  v_mfma_f32_16x16x32_bf16 v[28:31], a[96:99], a[40:43], v[28:31]
  buffer_load_dwordx4 v233, s[12:15], s47 offen offset:0 lds
  ds_read_b64_tr_b16 a[72:73], v20 offset:0
  v_mfma_f32_16x16x32_bf16 v[32:35], a[96:99], a[44:47], v[32:35]
  v_mfma_f32_16x16x32_bf16 v[36:39], a[96:99], a[48:51], v[36:39]
  ds_read_b64_tr_b16 a[74:75], v20 offset:2048
  v_mfma_f32_16x16x32_bf16 v[40:43], a[96:99], a[52:55], v[40:43]
  v_mfma_f32_16x16x32_bf16 v[44:47], a[96:99], a[56:59], v[44:47]
  ds_read_b128 a[4:7], v16 offset:2048
  v_mfma_f32_16x16x32_bf16 v[48:51], a[96:99], a[60:63], v[48:51]
  v_mfma_f32_16x16x32_bf16 v[52:55], a[96:99], a[64:67], v[52:55]
  buffer_load_dwordx4 v234, s[12:15], s47 offen offset:1024 lds
  ds_read_b128 a[8:11], v16 offset:4096
  v_mfma_f32_16x16x32_bf16 v[56:59], a[100:103], a[36:39], v[56:59]
  v_mfma_f32_16x16x32_bf16 v[60:63], a[100:103], a[40:43], v[60:63]
  ds_read_b128 a[12:15], v16 offset:6144
  v_mfma_f32_16x16x32_bf16 v[64:67], a[100:103], a[44:47], v[64:67]
  v_mfma_f32_16x16x32_bf16 v[68:71], a[100:103], a[48:51], v[68:71]
  ds_read_b128 a[16:19], v16 offset:8192
  v_mfma_f32_16x16x32_bf16 v[72:75], a[100:103], a[52:55], v[72:75]
  v_mfma_f32_16x16x32_bf16 v[76:79], a[100:103], a[56:59], v[76:79]
  ds_read_b128 a[20:23], v16 offset:10240
  v_mfma_f32_16x16x32_bf16 v[80:83], a[100:103], a[60:63], v[80:83]
  buffer_load_dwordx4 v235, s[12:15], s47 offen offset:2048 lds
  v_mfma_f32_16x16x32_bf16 v[84:87], a[100:103], a[64:67], v[84:87]
  s_add_u32 m0, s41, 3072
  ds_read_b128 a[24:27], v16 offset:12288
  v_mfma_f32_16x16x32_bf16 v[88:91], a[104:107], a[36:39], v[88:91]
  v_mfma_f32_16x16x32_bf16 v[92:95], a[104:107], a[40:43], v[92:95]
  ds_read_b128 a[28:31], v16 offset:14336
  v_mfma_f32_16x16x32_bf16 v[96:99], a[104:107], a[44:47], v[96:99]
  v_mfma_f32_16x16x32_bf16 v[100:103], a[104:107], a[48:51], v[100:103]
  ds_read_b64_tr_b16 a[76:77], v21 offset:0
  v_mfma_f32_16x16x32_bf16 v[104:107], a[104:107], a[52:55], v[104:107]
  ds_read_b64_tr_b16 a[78:79], v21 offset:2048
  v_mfma_f32_16x16x32_bf16 v[108:111], a[104:107], a[56:59], v[108:111]
  buffer_load_dwordx4 v236, s[12:15], s47 offen offset:0 lds
  v_mfma_f32_16x16x32_bf16 v[112:115], a[104:107], a[60:63], v[112:115]
  ds_read_b64_tr_b16 a[80:81], v20 offset:8192
  v_mfma_f32_16x16x32_bf16 v[116:119], a[104:107], a[64:67], v[116:119]
  v_mfma_f32_16x16x32_bf16 v[120:123], a[108:111], a[36:39], v[120:123]
  ds_read_b64_tr_b16 a[82:83], v20 offset:10240
  v_mfma_f32_16x16x32_bf16 v[124:127], a[108:111], a[40:43], v[124:127]
  v_mfma_f32_16x16x32_bf16 v[128:131], a[108:111], a[44:47], v[128:131]
  ds_read_b64_tr_b16 a[84:85], v21 offset:8192
  v_mfma_f32_16x16x32_bf16 v[132:135], a[108:111], a[48:51], v[132:135]
  v_mfma_f32_16x16x32_bf16 v[136:139], a[108:111], a[52:55], v[136:139]
  buffer_load_dwordx4 v237, s[12:15], s47 offen offset:1024 lds
  ds_read_b64_tr_b16 a[86:87], v21 offset:10240
  v_mfma_f32_16x16x32_bf16 v[140:143], a[108:111], a[56:59], v[140:143]
  v_mfma_f32_16x16x32_bf16 v[144:147], a[108:111], a[60:63], v[144:147]
  ds_read_b64_tr_b16 a[88:89], v20 offset:16384
  v_mfma_f32_16x16x32_bf16 v[148:151], a[108:111], a[64:67], v[148:151]
  v_mfma_f32_16x16x32_bf16 v[152:155], a[36:39], a[112:115], v[152:155]
  ds_read_b64_tr_b16 a[90:91], v20 offset:18432
  v_mfma_f32_16x16x32_bf16 v[156:159], a[40:43], a[112:115], v[156:159]
  v_mfma_f32_16x16x32_bf16 v[160:163], a[44:47], a[112:115], v[160:163]
  ds_read_b128 a[32:35], v18 offset:0
  v_mfma_f32_16x16x32_bf16 v[164:167], a[48:51], a[112:115], v[164:167]
  buffer_load_dwordx4 v238, s[12:15], s47 offen offset:2048 lds
  v_mfma_f32_16x16x32_bf16 v[168:171], a[52:55], a[112:115], v[168:171]
  s_mov_b32 m0, s36
  ds_read_b64_tr_b16 a[92:93], v21 offset:16384
  v_mfma_f32_16x16x32_bf16 v[172:175], a[56:59], a[112:115], v[172:175]
  v_mfma_f32_16x16x32_bf16 v[176:179], a[60:63], a[112:115], v[176:179]
  ds_read_b64_tr_b16 a[94:95], v21 offset:18432
  v_mfma_f32_16x16x32_bf16 v[180:183], a[64:67], a[112:115], v[180:183]
  v_mfma_f32_16x16x32_bf16 v[216:219], a[68:71], a[112:115], v[216:219]
  v_mfma_f32_16x16x32_bf16 v[184:187], a[36:39], a[116:119], v[184:187]
  v_mfma_f32_16x16x32_bf16 v[188:191], a[40:43], a[116:119], v[188:191]
  buffer_load_dwordx4 v224, s[8:11], s46 offen offset:0 lds
  v_mfma_f32_16x16x32_bf16 v[192:195], a[44:47], a[116:119], v[192:195]
  v_mfma_f32_16x16x32_bf16 v[196:199], a[48:51], a[116:119], v[196:199]
  v_mfma_f32_16x16x32_bf16 v[200:203], a[52:55], a[116:119], v[200:203]
  v_mfma_f32_16x16x32_bf16 v[204:207], a[56:59], a[116:119], v[204:207]
  v_mfma_f32_16x16x32_bf16 v[208:211], a[60:63], a[116:119], v[208:211]
  v_mfma_f32_16x16x32_bf16 v[212:215], a[64:67], a[116:119], v[212:215]
  v_mfma_f32_16x16x32_bf16 v[220:223], a[68:71], a[116:119], v[220:223]
  s_waitcnt lgkmcnt(0)
  v_mfma_f32_16x16x32_bf16 v[24:27], a[72:75], a[0:3], v[24:27]
  buffer_load_dwordx4 v225, s[8:11], s46 offen offset:1024 lds
  ds_read_b128 a[36:39], v17 offset:0
  v_mfma_f32_16x16x32_bf16 v[28:31], a[72:75], a[4:7], v[28:31]
  ds_read_b64_tr_b16 a[96:97], v20 offset:4096
  v_mfma_f32_16x16x32_bf16 v[32:35], a[72:75], a[8:11], v[32:35]
  v_mfma_f32_16x16x32_bf16 v[36:39], a[72:75], a[12:15], v[36:39]
  ds_read_b64_tr_b16 a[98:99], v20 offset:6144
  v_mfma_f32_16x16x32_bf16 v[40:43], a[72:75], a[16:19], v[40:43]
  v_mfma_f32_16x16x32_bf16 v[44:47], a[72:75], a[20:23], v[44:47]
  ds_read_b128 a[40:43], v17 offset:2048
  v_mfma_f32_16x16x32_bf16 v[48:51], a[72:75], a[24:27], v[48:51]
  buffer_load_dwordx4 v226, s[8:11], s46 offen offset:2048 lds
  v_mfma_f32_16x16x32_bf16 v[52:55], a[72:75], a[28:31], v[52:55]
  ds_read_b128 a[44:47], v17 offset:4096
  v_mfma_f32_16x16x32_bf16 v[56:59], a[76:79], a[0:3], v[56:59]
  v_mfma_f32_16x16x32_bf16 v[60:63], a[76:79], a[4:7], v[60:63]
  ds_read_b128 a[48:51], v17 offset:6144
  v_mfma_f32_16x16x32_bf16 v[64:67], a[76:79], a[8:11], v[64:67]
  v_mfma_f32_16x16x32_bf16 v[68:71], a[76:79], a[12:15], v[68:71]
  ds_read_b128 a[52:55], v17 offset:8192
  v_mfma_f32_16x16x32_bf16 v[72:75], a[76:79], a[16:19], v[72:75]
  buffer_load_dwordx4 v227, s[8:11], s46 offen offset:3072 lds
  v_mfma_f32_16x16x32_bf16 v[76:79], a[76:79], a[20:23], v[76:79]
  s_add_u32 m0, s36, 4096
  ds_read_b128 a[56:59], v17 offset:10240
  v_mfma_f32_16x16x32_bf16 v[80:83], a[76:79], a[24:27], v[80:83]
  v_mfma_f32_16x16x32_bf16 v[84:87], a[76:79], a[28:31], v[84:87]
  ds_read_b128 a[60:63], v17 offset:12288
  v_mfma_f32_16x16x32_bf16 v[88:91], a[80:83], a[0:3], v[88:91]
  v_mfma_f32_16x16x32_bf16 v[92:95], a[80:83], a[4:7], v[92:95]
  ds_read_b128 a[64:67], v17 offset:14336
  v_mfma_f32_16x16x32_bf16 v[96:99], a[80:83], a[8:11], v[96:99]
  buffer_load_dwordx4 v228, s[8:11], s46 offen offset:0 lds
  v_mfma_f32_16x16x32_bf16 v[100:103], a[80:83], a[12:15], v[100:103]
  ds_read_b64_tr_b16 a[100:101], v21 offset:4096
  v_mfma_f32_16x16x32_bf16 v[104:107], a[80:83], a[16:19], v[104:107]
  ds_read_b64_tr_b16 a[102:103], v21 offset:6144
  v_mfma_f32_16x16x32_bf16 v[108:111], a[80:83], a[20:23], v[108:111]
  v_mfma_f32_16x16x32_bf16 v[112:115], a[80:83], a[24:27], v[112:115]
  ds_read_b64_tr_b16 a[104:105], v20 offset:12288
  v_mfma_f32_16x16x32_bf16 v[116:119], a[80:83], a[28:31], v[116:119]
  v_mfma_f32_16x16x32_bf16 v[120:123], a[84:87], a[0:3], v[120:123]
  buffer_load_dwordx4 v229, s[8:11], s46 offen offset:1024 lds
  ds_read_b64_tr_b16 a[106:107], v20 offset:14336
  v_mfma_f32_16x16x32_bf16 v[124:127], a[84:87], a[4:7], v[124:127]
  v_mfma_f32_16x16x32_bf16 v[128:131], a[84:87], a[8:11], v[128:131]
  ds_read_b64_tr_b16 a[108:109], v21 offset:12288
  v_mfma_f32_16x16x32_bf16 v[132:135], a[84:87], a[12:15], v[132:135]
  v_mfma_f32_16x16x32_bf16 v[136:139], a[84:87], a[16:19], v[136:139]
  ds_read_b64_tr_b16 a[110:111], v21 offset:14336
  v_mfma_f32_16x16x32_bf16 v[140:143], a[84:87], a[20:23], v[140:143]
  v_mfma_f32_16x16x32_bf16 v[144:147], a[84:87], a[24:27], v[144:147]
  buffer_load_dwordx4 v230, s[8:11], s46 offen offset:2048 lds
  ds_read_b64_tr_b16 a[112:113], v20 offset:20480
  v_mfma_f32_16x16x32_bf16 v[148:151], a[84:87], a[28:31], v[148:151]
  v_mfma_f32_16x16x32_bf16 v[152:155], a[0:3], a[88:91], v[152:155]
  ds_read_b64_tr_b16 a[114:115], v20 offset:22528
  v_mfma_f32_16x16x32_bf16 v[156:159], a[4:7], a[88:91], v[156:159]
  v_mfma_f32_16x16x32_bf16 v[160:163], a[8:11], a[88:91], v[160:163]
  ds_read_b128 a[68:71], v19 offset:0
  v_mfma_f32_16x16x32_bf16 v[164:167], a[12:15], a[88:91], v[164:167]
  v_mfma_f32_16x16x32_bf16 v[168:171], a[16:19], a[88:91], v[168:171]
  buffer_load_dwordx4 v231, s[8:11], s46 offen offset:3072 lds
  ds_read_b64_tr_b16 a[116:117], v21 offset:20480
  v_mfma_f32_16x16x32_bf16 v[172:175], a[20:23], a[88:91], v[172:175]
  s_mul_i32 s47, s48, 393216
  s_bfe_u32 s34, 0x302010e, s49
  s_add_u32 s48, s48, s34
  v_mfma_f32_16x16x32_bf16 v[176:179], a[24:27], a[88:91], v[176:179]
  s_add_u32 s49, s49, 8
  s_and_b32 s49, s49, 0x8001f
  s_and_b32 s48, s48, 15
  v_mfma_f32_16x16x32_bf16 v[180:183], a[28:31], a[88:91], v[180:183]
  s_lshl_b32 s46, s48, 7
  ds_read_b64_tr_b16 a[118:119], v21 offset:22528
  v_mfma_f32_16x16x32_bf16 v[216:219], a[32:35], a[88:91], v[216:219]
  s_add_u32 s36, s36, s38
  s_add_u32 s37, s37, 1
  s_cmp_eq_u32 s37, 3
  s_cselect_b32 s37, 0, s37
  s_cselect_b32 s38, s39, s40
  v_mfma_f32_16x16x32_bf16 v[184:187], a[0:3], a[92:95], v[184:187]
  s_add_u32 s41, s41, s43
  s_sub_u32 s43, 0, s43
  v_mfma_f32_16x16x32_bf16 v[188:191], a[4:7], a[92:95], v[188:191]
  v_add_u32 v16, s38, v16
  v_add_u32 v17, s38, v17
  v_mfma_f32_16x16x32_bf16 v[192:195], a[8:11], a[92:95], v[192:195]
  v_add_u32 v18, s38, v18
  v_add_u32 v19, s38, v19
  v_mfma_f32_16x16x32_bf16 v[196:199], a[12:15], a[92:95], v[196:199]
  v_add_u32 v20, s43, v20
  v_add_u32 v21, s43, v21
  v_mfma_f32_16x16x32_bf16 v[200:203], a[16:19], a[92:95], v[200:203]
  v_mfma_f32_16x16x32_bf16 v[204:207], a[20:23], a[92:95], v[204:207]
  v_mfma_f32_16x16x32_bf16 v[208:211], a[24:27], a[92:95], v[208:211]
  s_waitcnt vmcnt(8) lgkmcnt(0)
  s_barrier
  v_mfma_f32_16x16x32_bf16 v[212:215], a[28:31], a[92:95], v[212:215]
  s_sub_u32 s35, s35, 1
  v_mfma_f32_16x16x32_bf16 v[220:223], a[32:35], a[92:95], v[220:223]
  s_cmp_lg_u32 s35, 0
  s_cbranch_scc1 Lp2r1_loop
  v_accvgpr_read_b32 v4, a222
  v_accvgpr_read_b32 v5, a223
  v_accvgpr_read_b32 v6, a224
  v_accvgpr_read_b32 v7, a225
  v_accvgpr_read_b32 v8, a226
  v_accvgpr_read_b32 v9, a227
  v_accvgpr_read_b32 v10, a228
  v_accvgpr_read_b32 v11, a229
  s_mov_b32 s8, s64
  s_mov_b32 s9, s65
  s_mov_b32 s10, 4194304
  s_mov_b32 s11, 0x00020000
  s_mov_b32 s20, s68
  s_mov_b32 s21, s69
  s_mov_b32 s22, 8388608
  s_mov_b32 s23, 0x00020000
  s_and_b32 s4, s2, 7
  s_lshl_b32 s4, s4, 1
  s_lshr_b32 s5, s2, 6
  s_add_u32 s5, s5, s25
  s_and_b32 s53, s5, 3
  s_lshl_b32 s53, s53, 3
  s_or_b32 s53, s53, 0x80000
  s_bfe_u32 s52, 0xf0f02, s53
  s_add_u32 s52, s52, s4
  s_and_b32 s52, s52, 15
  s_mov_b32 s54, s52
  s_mov_b32 s55, s53
  s_lshl_b32 s29, s52, 7
  s_lshl_b32 s28, s54, 19
  s_lshl_b32 s30, s25, 18
  s_sub_u32 s31, 3932160, s30
  s_or_b32 s26, s30, s29
  s_or_b32 s27, s31, s29
  s_lshl_b32 s68, s3, 12
  s_lshl_b32 s88, s3, 13
  s_add_u32 s88, s88, 98304
  v_mfma_f32_16x16x32_bf16 v[24:27], a[96:99], a[36:39], v[24:27]
  s_mov_b32 m0, s41
  ds_read_b128 a[0:3], v16 offset:0
  v_mfma_f32_16x16x32_bf16 v[28:31], a[96:99], a[40:43], v[28:31]
  buffer_load_dwordx4 v233, s[12:15], s47 offen offset:0 lds
  ds_read_b64_tr_b16 a[72:73], v20 offset:0
  v_mfma_f32_16x16x32_bf16 v[32:35], a[96:99], a[44:47], v[32:35]
  v_mfma_f32_16x16x32_bf16 v[36:39], a[96:99], a[48:51], v[36:39]
  ds_read_b64_tr_b16 a[74:75], v20 offset:2048
  v_mfma_f32_16x16x32_bf16 v[40:43], a[96:99], a[52:55], v[40:43]
  v_mfma_f32_16x16x32_bf16 v[44:47], a[96:99], a[56:59], v[44:47]
  ds_read_b128 a[4:7], v16 offset:2048
  v_mfma_f32_16x16x32_bf16 v[48:51], a[96:99], a[60:63], v[48:51]
  v_mfma_f32_16x16x32_bf16 v[52:55], a[96:99], a[64:67], v[52:55]
  ds_read_b128 a[8:11], v16 offset:4096
  v_mfma_f32_16x16x32_bf16 v[56:59], a[100:103], a[36:39], v[56:59]
  v_mfma_f32_16x16x32_bf16 v[60:63], a[100:103], a[40:43], v[60:63]
  ds_read_b128 a[12:15], v16 offset:6144
  v_mfma_f32_16x16x32_bf16 v[64:67], a[100:103], a[44:47], v[64:67]
  v_mfma_f32_16x16x32_bf16 v[68:71], a[100:103], a[48:51], v[68:71]
  ds_read_b128 a[16:19], v16 offset:8192
  v_mfma_f32_16x16x32_bf16 v[72:75], a[100:103], a[52:55], v[72:75]
  v_mfma_f32_16x16x32_bf16 v[76:79], a[100:103], a[56:59], v[76:79]
  ds_read_b128 a[20:23], v16 offset:10240
  v_mfma_f32_16x16x32_bf16 v[80:83], a[100:103], a[60:63], v[80:83]
  v_mfma_f32_16x16x32_bf16 v[84:87], a[100:103], a[64:67], v[84:87]
  ds_read_b128 a[24:27], v16 offset:12288
  v_mfma_f32_16x16x32_bf16 v[88:91], a[104:107], a[36:39], v[88:91]
  buffer_load_dwordx4 v234, s[12:15], s47 offen offset:1024 lds
  v_mfma_f32_16x16x32_bf16 v[92:95], a[104:107], a[40:43], v[92:95]
  ds_read_b128 a[28:31], v16 offset:14336
  v_mfma_f32_16x16x32_bf16 v[96:99], a[104:107], a[44:47], v[96:99]
  v_mfma_f32_16x16x32_bf16 v[100:103], a[104:107], a[48:51], v[100:103]
  ds_read_b64_tr_b16 a[76:77], v21 offset:0
  v_mfma_f32_16x16x32_bf16 v[104:107], a[104:107], a[52:55], v[104:107]
  ds_read_b64_tr_b16 a[78:79], v21 offset:2048
  v_mfma_f32_16x16x32_bf16 v[108:111], a[104:107], a[56:59], v[108:111]
  v_mfma_f32_16x16x32_bf16 v[112:115], a[104:107], a[60:63], v[112:115]
  ds_read_b64_tr_b16 a[80:81], v20 offset:8192
  v_mfma_f32_16x16x32_bf16 v[116:119], a[104:107], a[64:67], v[116:119]
  v_mfma_f32_16x16x32_bf16 v[120:123], a[108:111], a[36:39], v[120:123]
  ds_read_b64_tr_b16 a[82:83], v20 offset:10240
  v_mfma_f32_16x16x32_bf16 v[124:127], a[108:111], a[40:43], v[124:127]
  v_mfma_f32_16x16x32_bf16 v[128:131], a[108:111], a[44:47], v[128:131]
  ds_read_b64_tr_b16 a[84:85], v21 offset:8192
  v_mfma_f32_16x16x32_bf16 v[132:135], a[108:111], a[48:51], v[132:135]
  v_mfma_f32_16x16x32_bf16 v[136:139], a[108:111], a[52:55], v[136:139]
  ds_read_b64_tr_b16 a[86:87], v21 offset:10240
  v_mfma_f32_16x16x32_bf16 v[140:143], a[108:111], a[56:59], v[140:143]
  v_mfma_f32_16x16x32_bf16 v[144:147], a[108:111], a[60:63], v[144:147]
  ds_read_b64_tr_b16 a[88:89], v20 offset:16384
  v_mfma_f32_16x16x32_bf16 v[148:151], a[108:111], a[64:67], v[148:151]
  v_mfma_f32_16x16x32_bf16 v[152:155], a[36:39], a[112:115], v[152:155]
  buffer_load_dwordx4 v235, s[12:15], s47 offen offset:2048 lds
  ds_read_b64_tr_b16 a[90:91], v20 offset:18432
  v_mfma_f32_16x16x32_bf16 v[156:159], a[40:43], a[112:115], v[156:159]
  v_mfma_f32_16x16x32_bf16 v[160:163], a[44:47], a[112:115], v[160:163]
  ds_read_b128 a[32:35], v18 offset:0
  v_mfma_f32_16x16x32_bf16 v[164:167], a[48:51], a[112:115], v[164:167]
  v_mfma_f32_16x16x32_bf16 v[168:171], a[52:55], a[112:115], v[168:171]
  ds_read_b64_tr_b16 a[92:93], v21 offset:16384
  v_mfma_f32_16x16x32_bf16 v[172:175], a[56:59], a[112:115], v[172:175]
  v_mfma_f32_16x16x32_bf16 v[176:179], a[60:63], a[112:115], v[176:179]
  ds_read_b64_tr_b16 a[94:95], v21 offset:18432
  v_mfma_f32_16x16x32_bf16 v[180:183], a[64:67], a[112:115], v[180:183]
  v_mfma_f32_16x16x32_bf16 v[216:219], a[68:71], a[112:115], v[216:219]
  v_mfma_f32_16x16x32_bf16 v[184:187], a[36:39], a[116:119], v[184:187]
  v_mfma_f32_16x16x32_bf16 v[188:191], a[40:43], a[116:119], v[188:191]
  v_mfma_f32_16x16x32_bf16 v[192:195], a[44:47], a[116:119], v[192:195]
  v_mfma_f32_16x16x32_bf16 v[196:199], a[48:51], a[116:119], v[196:199]
  v_mfma_f32_16x16x32_bf16 v[200:203], a[52:55], a[116:119], v[200:203]
  v_mfma_f32_16x16x32_bf16 v[204:207], a[56:59], a[116:119], v[204:207]
  v_mfma_f32_16x16x32_bf16 v[208:211], a[60:63], a[116:119], v[208:211]
  v_mfma_f32_16x16x32_bf16 v[212:215], a[64:67], a[116:119], v[212:215]
  v_mfma_f32_16x16x32_bf16 v[220:223], a[68:71], a[116:119], v[220:223]
  s_waitcnt lgkmcnt(0)
  v_mfma_f32_16x16x32_bf16 v[24:27], a[72:75], a[0:3], v[24:27]
  s_add_u32 m0, s41, 3072
  ds_read_b128 a[36:39], v17 offset:0
  v_mfma_f32_16x16x32_bf16 v[28:31], a[72:75], a[4:7], v[28:31]
  buffer_load_dwordx4 v236, s[12:15], s47 offen offset:0 lds
  ds_read_b64_tr_b16 a[96:97], v20 offset:4096
  v_mfma_f32_16x16x32_bf16 v[32:35], a[72:75], a[8:11], v[32:35]
  v_mfma_f32_16x16x32_bf16 v[36:39], a[72:75], a[12:15], v[36:39]
  ds_read_b64_tr_b16 a[98:99], v20 offset:6144
  v_mfma_f32_16x16x32_bf16 v[40:43], a[72:75], a[16:19], v[40:43]
  v_mfma_f32_16x16x32_bf16 v[44:47], a[72:75], a[20:23], v[44:47]
  ds_read_b128 a[40:43], v17 offset:2048
  v_mfma_f32_16x16x32_bf16 v[48:51], a[72:75], a[24:27], v[48:51]
  v_mfma_f32_16x16x32_bf16 v[52:55], a[72:75], a[28:31], v[52:55]
  ds_read_b128 a[44:47], v17 offset:4096
  v_mfma_f32_16x16x32_bf16 v[56:59], a[76:79], a[0:3], v[56:59]
  v_mfma_f32_16x16x32_bf16 v[60:63], a[76:79], a[4:7], v[60:63]
  ds_read_b128 a[48:51], v17 offset:6144
  v_mfma_f32_16x16x32_bf16 v[64:67], a[76:79], a[8:11], v[64:67]
  v_mfma_f32_16x16x32_bf16 v[68:71], a[76:79], a[12:15], v[68:71]
  ds_read_b128 a[52:55], v17 offset:8192
  v_mfma_f32_16x16x32_bf16 v[72:75], a[76:79], a[16:19], v[72:75]
  v_mfma_f32_16x16x32_bf16 v[76:79], a[76:79], a[20:23], v[76:79]
  ds_read_b128 a[56:59], v17 offset:10240
  v_mfma_f32_16x16x32_bf16 v[80:83], a[76:79], a[24:27], v[80:83]
  buffer_load_dwordx4 v237, s[12:15], s47 offen offset:1024 lds
  v_mfma_f32_16x16x32_bf16 v[84:87], a[76:79], a[28:31], v[84:87]
  ds_read_b128 a[60:63], v17 offset:12288
  v_mfma_f32_16x16x32_bf16 v[88:91], a[80:83], a[0:3], v[88:91]
  v_mfma_f32_16x16x32_bf16 v[92:95], a[80:83], a[4:7], v[92:95]
  ds_read_b128 a[64:67], v17 offset:14336
  v_mfma_f32_16x16x32_bf16 v[96:99], a[80:83], a[8:11], v[96:99]
  v_mfma_f32_16x16x32_bf16 v[100:103], a[80:83], a[12:15], v[100:103]
  ds_read_b64_tr_b16 a[100:101], v21 offset:4096
  v_mfma_f32_16x16x32_bf16 v[104:107], a[80:83], a[16:19], v[104:107]
  ds_read_b64_tr_b16 a[102:103], v21 offset:6144
  v_mfma_f32_16x16x32_bf16 v[108:111], a[80:83], a[20:23], v[108:111]
  v_mfma_f32_16x16x32_bf16 v[112:115], a[80:83], a[24:27], v[112:115]
  ds_read_b64_tr_b16 a[104:105], v20 offset:12288
  v_mfma_f32_16x16x32_bf16 v[116:119], a[80:83], a[28:31], v[116:119]
  v_mfma_f32_16x16x32_bf16 v[120:123], a[84:87], a[0:3], v[120:123]
  ds_read_b64_tr_b16 a[106:107], v20 offset:14336
  v_mfma_f32_16x16x32_bf16 v[124:127], a[84:87], a[4:7], v[124:127]
  v_mfma_f32_16x16x32_bf16 v[128:131], a[84:87], a[8:11], v[128:131]
  ds_read_b64_tr_b16 a[108:109], v21 offset:12288
  v_mfma_f32_16x16x32_bf16 v[132:135], a[84:87], a[12:15], v[132:135]
  v_mfma_f32_16x16x32_bf16 v[136:139], a[84:87], a[16:19], v[136:139]
  buffer_load_dwordx4 v238, s[12:15], s47 offen offset:2048 lds
  ds_read_b64_tr_b16 a[110:111], v21 offset:14336
  v_mfma_f32_16x16x32_bf16 v[140:143], a[84:87], a[20:23], v[140:143]
  s_add_u32 s36, s36, s38
  s_add_u32 s37, s37, 1
  s_cmp_eq_u32 s37, 3
  s_cselect_b32 s37, 0, s37
  s_cselect_b32 s38, s39, s40
  v_mfma_f32_16x16x32_bf16 v[144:147], a[84:87], a[24:27], v[144:147]
  s_add_u32 s41, s41, s43
  s_sub_u32 s43, 0, s43
  ds_read_b64_tr_b16 a[112:113], v20 offset:20480
  v_mfma_f32_16x16x32_bf16 v[148:151], a[84:87], a[28:31], v[148:151]
  v_mfma_f32_16x16x32_bf16 v[152:155], a[0:3], a[88:91], v[152:155]
  ds_read_b64_tr_b16 a[114:115], v20 offset:22528
  v_mfma_f32_16x16x32_bf16 v[156:159], a[4:7], a[88:91], v[156:159]
  v_mfma_f32_16x16x32_bf16 v[160:163], a[8:11], a[88:91], v[160:163]
  ds_read_b128 a[68:71], v19 offset:0
  v_mfma_f32_16x16x32_bf16 v[164:167], a[12:15], a[88:91], v[164:167]
  v_mfma_f32_16x16x32_bf16 v[168:171], a[16:19], a[88:91], v[168:171]
  ds_read_b64_tr_b16 a[116:117], v21 offset:20480
  v_mfma_f32_16x16x32_bf16 v[172:175], a[20:23], a[88:91], v[172:175]
  v_mfma_f32_16x16x32_bf16 v[176:179], a[24:27], a[88:91], v[176:179]
  ds_read_b64_tr_b16 a[118:119], v21 offset:22528
  v_mfma_f32_16x16x32_bf16 v[180:183], a[28:31], a[88:91], v[180:183]
  v_add_u32 v16, s38, v16
  v_add_u32 v17, s38, v17
  v_mfma_f32_16x16x32_bf16 v[216:219], a[32:35], a[88:91], v[216:219]
  v_add_u32 v18, s38, v18
  v_add_u32 v19, s38, v19
  v_mfma_f32_16x16x32_bf16 v[184:187], a[0:3], a[92:95], v[184:187]
  v_add_u32 v20, s43, v20
  v_add_u32 v21, s43, v21
  v_mfma_f32_16x16x32_bf16 v[188:191], a[4:7], a[92:95], v[188:191]
  v_mfma_f32_16x16x32_bf16 v[192:195], a[8:11], a[92:95], v[192:195]
  v_mfma_f32_16x16x32_bf16 v[196:199], a[12:15], a[92:95], v[196:199]
  v_mfma_f32_16x16x32_bf16 v[200:203], a[16:19], a[92:95], v[200:203]
  v_mfma_f32_16x16x32_bf16 v[204:207], a[20:23], a[92:95], v[204:207]
  v_mfma_f32_16x16x32_bf16 v[208:211], a[24:27], a[92:95], v[208:211]
  v_mfma_f32_16x16x32_bf16 v[212:215], a[28:31], a[92:95], v[212:215]
  v_mfma_f32_16x16x32_bf16 v[220:223], a[32:35], a[92:95], v[220:223]
  s_waitcnt vmcnt(0) lgkmcnt(0)
  s_barrier
  s_mov_b32 s6, 0x3e8293ee
  s_mov_b32 s7, s6
  v_mfma_f32_16x16x32_bf16 v[24:27], a[96:99], a[36:39], v[24:27]
  ds_read_b128 a[0:3], v16 offset:0
  v_mfma_f32_16x16x32_bf16 v[28:31], a[96:99], a[40:43], v[28:31]
  ds_read_b64_tr_b16 a[72:73], v20 offset:0
  v_mfma_f32_16x16x32_bf16 v[32:35], a[96:99], a[44:47], v[32:35]
  v_mfma_f32_16x16x32_bf16 v[36:39], a[96:99], a[48:51], v[36:39]
  ds_read_b64_tr_b16 a[74:75], v20 offset:2048
  v_mfma_f32_16x16x32_bf16 v[40:43], a[96:99], a[52:55], v[40:43]
  v_mfma_f32_16x16x32_bf16 v[44:47], a[96:99], a[56:59], v[44:47]
  ds_read_b128 a[4:7], v16 offset:2048
  v_mfma_f32_16x16x32_bf16 v[48:51], a[96:99], a[60:63], v[48:51]
  v_mfma_f32_16x16x32_bf16 v[52:55], a[96:99], a[64:67], v[52:55]
  ds_read_b128 a[8:11], v16 offset:4096
  v_mfma_f32_16x16x32_bf16 v[56:59], a[100:103], a[36:39], v[56:59]
  v_mfma_f32_16x16x32_bf16 v[60:63], a[100:103], a[40:43], v[60:63]
  ds_read_b128 a[12:15], v16 offset:6144
  v_mfma_f32_16x16x32_bf16 v[64:67], a[100:103], a[44:47], v[64:67]
  v_mfma_f32_16x16x32_bf16 v[68:71], a[100:103], a[48:51], v[68:71]
  ds_read_b128 a[16:19], v16 offset:8192
  v_mfma_f32_16x16x32_bf16 v[72:75], a[100:103], a[52:55], v[72:75]
  v_mfma_f32_16x16x32_bf16 v[76:79], a[100:103], a[56:59], v[76:79]
  ds_read_b128 a[20:23], v16 offset:10240
  v_mfma_f32_16x16x32_bf16 v[80:83], a[100:103], a[60:63], v[80:83]
  v_mfma_f32_16x16x32_bf16 v[84:87], a[100:103], a[64:67], v[84:87]
  ds_read_b128 a[24:27], v16 offset:12288
  v_mfma_f32_16x16x32_bf16 v[88:91], a[104:107], a[36:39], v[88:91]
  v_mfma_f32_16x16x32_bf16 v[92:95], a[104:107], a[40:43], v[92:95]
  ds_read_b128 a[28:31], v16 offset:14336
  v_mfma_f32_16x16x32_bf16 v[96:99], a[104:107], a[44:47], v[96:99]
  v_mfma_f32_16x16x32_bf16 v[100:103], a[104:107], a[48:51], v[100:103]
  ds_read_b64_tr_b16 a[76:77], v21 offset:0
  v_mfma_f32_16x16x32_bf16 v[104:107], a[104:107], a[52:55], v[104:107]
  ds_read_b64_tr_b16 a[78:79], v21 offset:2048
  v_mfma_f32_16x16x32_bf16 v[108:111], a[104:107], a[56:59], v[108:111]
  v_mfma_f32_16x16x32_bf16 v[112:115], a[104:107], a[60:63], v[112:115]
  ds_read_b64_tr_b16 a[80:81], v20 offset:8192
  v_mfma_f32_16x16x32_bf16 v[116:119], a[104:107], a[64:67], v[116:119]
  v_mfma_f32_16x16x32_bf16 v[120:123], a[108:111], a[36:39], v[120:123]
  ds_read_b64_tr_b16 a[82:83], v20 offset:10240
  v_mfma_f32_16x16x32_bf16 v[124:127], a[108:111], a[40:43], v[124:127]
  v_mfma_f32_16x16x32_bf16 v[128:131], a[108:111], a[44:47], v[128:131]
  ds_read_b64_tr_b16 a[84:85], v21 offset:8192
  v_mfma_f32_16x16x32_bf16 v[132:135], a[108:111], a[48:51], v[132:135]
  v_mfma_f32_16x16x32_bf16 v[136:139], a[108:111], a[52:55], v[136:139]
  ds_read_b64_tr_b16 a[86:87], v21 offset:10240
  v_mfma_f32_16x16x32_bf16 v[140:143], a[108:111], a[56:59], v[140:143]
  v_mfma_f32_16x16x32_bf16 v[144:147], a[108:111], a[60:63], v[144:147]
  ds_read_b64_tr_b16 a[88:89], v20 offset:16384
  v_mfma_f32_16x16x32_bf16 v[148:151], a[108:111], a[64:67], v[148:151]
  v_mfma_f32_16x16x32_bf16 v[152:155], a[36:39], a[112:115], v[152:155]
  ds_read_b64_tr_b16 a[90:91], v20 offset:18432
  v_mfma_f32_16x16x32_bf16 v[156:159], a[40:43], a[112:115], v[156:159]
  v_mfma_f32_16x16x32_bf16 v[160:163], a[44:47], a[112:115], v[160:163]
  ds_read_b128 a[32:35], v18 offset:0
  v_mfma_f32_16x16x32_bf16 v[164:167], a[48:51], a[112:115], v[164:167]
  v_mfma_f32_16x16x32_bf16 v[168:171], a[52:55], a[112:115], v[168:171]
  ds_read_b64_tr_b16 a[92:93], v21 offset:16384
  v_mfma_f32_16x16x32_bf16 v[172:175], a[56:59], a[112:115], v[172:175]
  v_mfma_f32_16x16x32_bf16 v[176:179], a[60:63], a[112:115], v[176:179]
  ds_read_b64_tr_b16 a[94:95], v21 offset:18432
  v_mfma_f32_16x16x32_bf16 v[180:183], a[64:67], a[112:115], v[180:183]
  v_mfma_f32_16x16x32_bf16 v[216:219], a[68:71], a[112:115], v[216:219]
  v_mfma_f32_16x16x32_bf16 v[184:187], a[36:39], a[116:119], v[184:187]
  v_mfma_f32_16x16x32_bf16 v[188:191], a[40:43], a[116:119], v[188:191]
  v_mfma_f32_16x16x32_bf16 v[192:195], a[44:47], a[116:119], v[192:195]
  v_mfma_f32_16x16x32_bf16 v[196:199], a[48:51], a[116:119], v[196:199]
  v_mfma_f32_16x16x32_bf16 v[200:203], a[52:55], a[116:119], v[200:203]
  v_mfma_f32_16x16x32_bf16 v[204:207], a[56:59], a[116:119], v[204:207]
  v_mfma_f32_16x16x32_bf16 v[208:211], a[60:63], a[116:119], v[208:211]
  v_mfma_f32_16x16x32_bf16 v[212:215], a[64:67], a[116:119], v[212:215]
  v_mfma_f32_16x16x32_bf16 v[220:223], a[68:71], a[116:119], v[220:223]
  s_waitcnt lgkmcnt(0)
  v_mfma_f32_16x16x32_bf16 v[24:27], a[72:75], a[0:3], v[24:27]
  ds_read_b128 a[36:39], v17 offset:0
  ds_read_b64_tr_b16 a[96:97], v20 offset:4096
  v_mfma_f32_16x16x32_bf16 v[56:59], a[76:79], a[0:3], v[56:59]
  ds_read_b64_tr_b16 a[98:99], v20 offset:6144
  ds_read_b128 a[40:43], v17 offset:2048
  v_mfma_f32_16x16x32_bf16 v[28:31], a[72:75], a[4:7], v[28:31]
  ds_read_b128 a[44:47], v17 offset:4096
  ds_read_b128 a[48:51], v17 offset:6144
  v_mfma_f32_16x16x32_bf16 v[60:63], a[76:79], a[4:7], v[60:63]
  ds_read_b128 a[52:55], v17 offset:8192
  ds_read_b128 a[56:59], v17 offset:10240
  v_mfma_f32_16x16x32_bf16 v[32:35], a[72:75], a[8:11], v[32:35]
  ds_read_b128 a[60:63], v17 offset:12288
  ds_read_b128 a[64:67], v17 offset:14336
  v_mfma_f32_16x16x32_bf16 v[64:67], a[76:79], a[8:11], v[64:67]
  ds_read_b64_tr_b16 a[100:101], v21 offset:4096
  ds_read_b64_tr_b16 a[102:103], v21 offset:6144
  v_mfma_f32_16x16x32_bf16 v[36:39], a[72:75], a[12:15], v[36:39]
  ds_read_b64_tr_b16 a[104:105], v20 offset:12288
  ds_read_b64_tr_b16 a[106:107], v20 offset:14336
  v_mfma_f32_16x16x32_bf16 v[68:71], a[76:79], a[12:15], v[68:71]
  ds_read_b64_tr_b16 a[108:109], v21 offset:12288
  ds_read_b64_tr_b16 a[110:111], v21 offset:14336
  v_mfma_f32_16x16x32_bf16 v[40:43], a[72:75], a[16:19], v[40:43]
  ds_read_b64_tr_b16 a[112:113], v20 offset:20480
  ds_read_b64_tr_b16 a[114:115], v20 offset:22528
  v_mfma_f32_16x16x32_bf16 v[72:75], a[76:79], a[16:19], v[72:75]
  ds_read_b128 a[68:71], v19 offset:0
  ds_read_b64_tr_b16 a[116:117], v21 offset:20480
  v_mfma_f32_16x16x32_bf16 v[44:47], a[72:75], a[20:23], v[44:47]
  ds_read_b64_tr_b16 a[118:119], v21 offset:22528
  v_mfma_f32_16x16x32_bf16 v[76:79], a[76:79], a[20:23], v[76:79]
  v_mfma_f32_16x16x32_bf16 v[48:51], a[72:75], a[24:27], v[48:51]
  v_mfma_f32_16x16x32_bf16 v[80:83], a[76:79], a[24:27], v[80:83]
  v_mfma_f32_16x16x32_bf16 v[52:55], a[72:75], a[28:31], v[52:55]
  v_mfma_f32_16x16x32_bf16 v[84:87], a[76:79], a[28:31], v[84:87]
  s_waitcnt lgkmcnt(0)
  s_barrier
  s_mov_b32 s12, s84
  s_mov_b32 s13, s85
  s_mov_b32 s14, 256
  s_mov_b32 s15, 0x00020000
  buffer_load_dwordx2 v[22:23], off, s[12:15], 0 sc1
  v_mfma_f32_16x16x32_bf16 v[24:27], a[96:99], a[36:39], v[24:27]
  s_mov_b32 m0, s68
  v_mfma_f32_16x16x32_bf16 v[56:59], a[100:103], a[36:39], v[56:59]
  buffer_load_dwordx4 v8, s[20:23], s28 offen offset:0 lds
  v_mfma_f32_16x16x32_bf16 v[28:31], a[96:99], a[40:43], v[28:31]
  v_mfma_f32_16x16x32_bf16 v[60:63], a[100:103], a[40:43], v[60:63]
  v_mfma_f32_16x16x32_bf16 v[32:35], a[96:99], a[44:47], v[32:35]
  v_mfma_f32_16x16x32_bf16 v[64:67], a[100:103], a[44:47], v[64:67]
  buffer_load_dwordx4 v9, s[20:23], s28 offen offset:1024 lds
  v_pk_mul_f32 v[24:25], v[24:25], s[6:7]
  v_mfma_f32_16x16x32_bf16 v[36:39], a[96:99], a[48:51], v[36:39]
  v_pk_mul_f32 v[26:27], v[26:27], s[6:7]
  v_pk_mul_f32 v[56:57], v[56:57], s[6:7]
  v_mfma_f32_16x16x32_bf16 v[68:71], a[100:103], a[48:51], v[68:71]
  v_pk_mul_f32 v[58:59], v[58:59], s[6:7]
  v_cvt_pk_bf16_f32 v24, v24, v25
  v_mfma_f32_16x16x32_bf16 v[40:43], a[96:99], a[52:55], v[40:43]
  v_cvt_pk_bf16_f32 v25, v26, v27
  v_cvt_pk_bf16_f32 v26, v56, v57
  v_mfma_f32_16x16x32_bf16 v[72:75], a[100:103], a[52:55], v[72:75]
  v_cvt_pk_bf16_f32 v27, v58, v59
  v_pk_mul_f32 v[28:29], v[28:29], s[6:7]
  v_mfma_f32_16x16x32_bf16 v[44:47], a[96:99], a[56:59], v[44:47]
  buffer_load_dwordx4 v10, s[20:23], s28 offen offset:2048 lds
  v_pk_mul_f32 v[30:31], v[30:31], s[6:7]
  v_mfma_f32_16x16x32_bf16 v[76:79], a[100:103], a[56:59], v[76:79]
  v_pk_mul_f32 v[60:61], v[60:61], s[6:7]
  v_pk_mul_f32 v[62:63], v[62:63], s[6:7]
  v_mfma_f32_16x16x32_bf16 v[48:51], a[96:99], a[60:63], v[48:51]
  v_cvt_pk_bf16_f32 v28, v28, v29
  v_cvt_pk_bf16_f32 v29, v30, v31
  v_mfma_f32_16x16x32_bf16 v[80:83], a[100:103], a[60:63], v[80:83]
  v_cvt_pk_bf16_f32 v30, v60, v61
  v_cvt_pk_bf16_f32 v31, v62, v63
  v_mfma_f32_16x16x32_bf16 v[52:55], a[96:99], a[64:67], v[52:55]
  v_pk_mul_f32 v[32:33], v[32:33], s[6:7]
  v_pk_mul_f32 v[34:35], v[34:35], s[6:7]
  v_mfma_f32_16x16x32_bf16 v[84:87], a[100:103], a[64:67], v[84:87]
  buffer_load_dwordx4 v11, s[20:23], s28 offen offset:3072 lds
  v_pk_mul_f32 v[64:65], v[64:65], s[6:7]
  v_mfma_f32_16x16x32_bf16 v[88:91], a[80:83], a[0:3], v[88:91]
  s_bfe_u32 s56, 0x302010e, s55
  s_add_u32 s54, s54, s56
  s_add_u32 s55, s55, 8
  v_mfma_f32_16x16x32_bf16 v[120:123], a[84:87], a[0:3], v[120:123]
  s_and_b32 s55, s55, 0x8001f
  s_and_b32 s54, s54, 15
  s_lshl_b32 s28, s54, 19
  v_mfma_f32_16x16x32_bf16 v[88:91], a[104:107], a[36:39], v[88:91]
  s_add_u32 m0, s68, 16384
  v_pk_mul_f32 v[66:67], v[66:67], s[6:7]
  v_cvt_pk_bf16_f32 v32, v32, v33
  v_mfma_f32_16x16x32_bf16 v[120:123], a[108:111], a[36:39], v[120:123]
  v_cvt_pk_bf16_f32 v33, v34, v35
  v_cvt_pk_bf16_f32 v34, v64, v65
  v_mfma_f32_16x16x32_bf16 v[92:95], a[80:83], a[4:7], v[92:95]
  buffer_load_dwordx4 v8, s[20:23], s28 offen offset:0 lds
  v_cvt_pk_bf16_f32 v35, v66, v67
  v_mfma_f32_16x16x32_bf16 v[124:127], a[84:87], a[4:7], v[124:127]
  v_pk_mul_f32 v[36:37], v[36:37], s[6:7]
  v_pk_mul_f32 v[38:39], v[38:39], s[6:7]
  v_mfma_f32_16x16x32_bf16 v[92:95], a[104:107], a[40:43], v[92:95]
  v_pk_mul_f32 v[68:69], v[68:69], s[6:7]
  v_pk_mul_f32 v[70:71], v[70:71], s[6:7]
  v_mfma_f32_16x16x32_bf16 v[124:127], a[108:111], a[40:43], v[124:127]
  v_cvt_pk_bf16_f32 v36, v36, v37
  v_cvt_pk_bf16_f32 v37, v38, v39
  v_mfma_f32_16x16x32_bf16 v[96:99], a[80:83], a[8:11], v[96:99]
  v_cvt_pk_bf16_f32 v38, v68, v69
  v_cvt_pk_bf16_f32 v39, v70, v71
  v_mfma_f32_16x16x32_bf16 v[128:131], a[84:87], a[8:11], v[128:131]
  buffer_load_dwordx4 v9, s[20:23], s28 offen offset:1024 lds
  v_pk_mul_f32 v[40:41], v[40:41], s[6:7]
  v_mfma_f32_16x16x32_bf16 v[96:99], a[104:107], a[44:47], v[96:99]
  v_pk_mul_f32 v[42:43], v[42:43], s[6:7]
  v_pk_mul_f32 v[72:73], v[72:73], s[6:7]
  v_mfma_f32_16x16x32_bf16 v[128:131], a[108:111], a[44:47], v[128:131]
  v_pk_mul_f32 v[74:75], v[74:75], s[6:7]
  v_cvt_pk_bf16_f32 v40, v40, v41
  v_mfma_f32_16x16x32_bf16 v[100:103], a[80:83], a[12:15], v[100:103]
  v_cvt_pk_bf16_f32 v41, v42, v43
  v_cvt_pk_bf16_f32 v42, v72, v73
  v_mfma_f32_16x16x32_bf16 v[132:135], a[84:87], a[12:15], v[132:135]
  v_cvt_pk_bf16_f32 v43, v74, v75
  v_pk_mul_f32 v[44:45], v[44:45], s[6:7]
  v_mfma_f32_16x16x32_bf16 v[100:103], a[104:107], a[48:51], v[100:103]
  v_pk_mul_f32 v[46:47], v[46:47], s[6:7]
  v_pk_mul_f32 v[76:77], v[76:77], s[6:7]
  v_mfma_f32_16x16x32_bf16 v[132:135], a[108:111], a[48:51], v[132:135]
  buffer_load_dwordx4 v10, s[20:23], s28 offen offset:2048 lds
  v_pk_mul_f32 v[78:79], v[78:79], s[6:7]
  v_mfma_f32_16x16x32_bf16 v[104:107], a[80:83], a[16:19], v[104:107]
  v_cvt_pk_bf16_f32 v44, v44, v45
  v_cvt_pk_bf16_f32 v45, v46, v47
  v_mfma_f32_16x16x32_bf16 v[136:139], a[84:87], a[16:19], v[136:139]
  v_cvt_pk_bf16_f32 v46, v76, v77
  v_cvt_pk_bf16_f32 v47, v78, v79
  v_mfma_f32_16x16x32_bf16 v[104:107], a[104:107], a[52:55], v[104:107]
  v_pk_mul_f32 v[48:49], v[48:49], s[6:7]
  v_pk_mul_f32 v[50:51], v[50:51], s[6:7]
  v_mfma_f32_16x16x32_bf16 v[136:139], a[108:111], a[52:55], v[136:139]
  v_pk_mul_f32 v[80:81], v[80:81], s[6:7]
  v_pk_mul_f32 v[82:83], v[82:83], s[6:7]
  v_mfma_f32_16x16x32_bf16 v[108:111], a[80:83], a[20:23], v[108:111]
  buffer_load_dwordx4 v11, s[20:23], s28 offen offset:3072 lds
  v_cvt_pk_bf16_f32 v48, v48, v49
  v_mfma_f32_16x16x32_bf16 v[140:143], a[84:87], a[20:23], v[140:143]
  s_bfe_u32 s56, 0x302010e, s55
  s_add_u32 s54, s54, s56
  s_add_u32 s55, s55, 8
  v_mfma_f32_16x16x32_bf16 v[108:111], a[104:107], a[56:59], v[108:111]
  s_and_b32 s55, s55, 0x8001f
  s_and_b32 s54, s54, 15
  s_lshl_b32 s28, s54, 19
  v_mfma_f32_16x16x32_bf16 v[140:143], a[108:111], a[56:59], v[140:143]
  s_mov_b32 m0, s88
  v_cvt_pk_bf16_f32 v49, v50, v51
  v_cvt_pk_bf16_f32 v50, v80, v81
  v_mfma_f32_16x16x32_bf16 v[112:115], a[80:83], a[24:27], v[112:115]
  v_cvt_pk_bf16_f32 v51, v82, v83
  v_pk_mul_f32 v[52:53], v[52:53], s[6:7]
  v_mfma_f32_16x16x32_bf16 v[144:147], a[84:87], a[24:27], v[144:147]
  buffer_load_dwordx4 v4, s[8:11], s26 offen offset:0 lds
  v_pk_mul_f32 v[54:55], v[54:55], s[6:7]
  v_mfma_f32_16x16x32_bf16 v[112:115], a[104:107], a[60:63], v[112:115]
  v_pk_mul_f32 v[84:85], v[84:85], s[6:7]
  v_pk_mul_f32 v[86:87], v[86:87], s[6:7]
  v_mfma_f32_16x16x32_bf16 v[144:147], a[108:111], a[60:63], v[144:147]
  v_cvt_pk_bf16_f32 v52, v52, v53
  v_cvt_pk_bf16_f32 v53, v54, v55
  v_mfma_f32_16x16x32_bf16 v[116:119], a[80:83], a[28:31], v[116:119]
  v_cvt_pk_bf16_f32 v54, v84, v85
  v_cvt_pk_bf16_f32 v55, v86, v87
  v_mfma_f32_16x16x32_bf16 v[148:151], a[84:87], a[28:31], v[148:151]
  v_cvt_pk_bf16_f32 v88, v88, v89
  v_cvt_pk_bf16_f32 v89, v90, v91
  v_mfma_f32_16x16x32_bf16 v[116:119], a[104:107], a[64:67], v[116:119]
  buffer_load_dwordx4 v5, s[8:11], s26 offen offset:1024 lds
  v_cvt_pk_bf16_f32 v90, v120, v121
  v_mfma_f32_16x16x32_bf16 v[148:151], a[108:111], a[64:67], v[148:151]
  v_cvt_pk_bf16_f32 v91, v122, v123
  v_cvt_pk_bf16_f32 v92, v92, v93
  v_mfma_f32_16x16x32_bf16 v[216:219], a[32:35], a[88:91], v[216:219]
  v_cvt_pk_bf16_f32 v93, v94, v95
  v_cvt_pk_bf16_f32 v94, v124, v125
  v_mfma_f32_16x16x32_bf16 v[220:223], a[32:35], a[92:95], v[220:223]
  v_cvt_pk_bf16_f32 v95, v126, v127
  v_cvt_pk_bf16_f32 v96, v96, v97
  v_mfma_f32_16x16x32_bf16 v[216:219], a[68:71], a[112:115], v[216:219]
  v_cvt_pk_bf16_f32 v97, v98, v99
  v_cvt_pk_bf16_f32 v98, v128, v129
  v_mfma_f32_16x16x32_bf16 v[220:223], a[68:71], a[116:119], v[220:223]
  buffer_load_dwordx4 v6, s[8:11], s26 offen offset:2048 lds
  v_cvt_pk_bf16_f32 v99, v130, v131
  v_mfma_f32_16x16x32_bf16 v[180:183], a[28:31], a[88:91], v[180:183]
  v_cvt_pk_bf16_f32 v100, v100, v101
  v_cvt_pk_bf16_f32 v101, v102, v103
  v_mfma_f32_16x16x32_bf16 v[212:215], a[28:31], a[92:95], v[212:215]
  v_cvt_pk_bf16_f32 v102, v132, v133
  v_cvt_pk_bf16_f32 v103, v134, v135
  v_mfma_f32_16x16x32_bf16 v[180:183], a[64:67], a[112:115], v[180:183]
  v_cvt_pk_bf16_f32 v104, v104, v105
  v_cvt_pk_bf16_f32 v105, v106, v107
  v_mfma_f32_16x16x32_bf16 v[212:215], a[64:67], a[116:119], v[212:215]
  v_cvt_pk_bf16_f32 v106, v136, v137
  v_cvt_pk_bf16_f32 v107, v138, v139
  v_mfma_f32_16x16x32_bf16 v[176:179], a[24:27], a[88:91], v[176:179]
  v_cvt_pk_bf16_f32 v108, v108, v109
  v_cvt_pk_bf16_f32 v109, v110, v111
  v_mfma_f32_16x16x32_bf16 v[208:211], a[24:27], a[92:95], v[208:211]
  buffer_load_dwordx4 v7, s[8:11], s26 offen offset:3072 lds
  v_cvt_pk_bf16_f32 v110, v140, v141
  v_mfma_f32_16x16x32_bf16 v[176:179], a[60:63], a[112:115], v[176:179]
  s_add_u32 m0, s88, 4096
  v_cvt_pk_bf16_f32 v111, v142, v143
  v_cvt_pk_bf16_f32 v112, v112, v113
  v_mfma_f32_16x16x32_bf16 v[208:211], a[60:63], a[116:119], v[208:211]
  v_cvt_pk_bf16_f32 v113, v114, v115
  v_cvt_pk_bf16_f32 v114, v144, v145
  v_mfma_f32_16x16x32_bf16 v[172:175], a[20:23], a[88:91], v[172:175]
  v_cvt_pk_bf16_f32 v115, v146, v147
  v_cvt_pk_bf16_f32 v116, v116, v117
  v_mfma_f32_16x16x32_bf16 v[204:207], a[20:23], a[92:95], v[204:207]
  v_cvt_pk_bf16_f32 v117, v118, v119
  v_cvt_pk_bf16_f32 v118, v148, v149
  v_mfma_f32_16x16x32_bf16 v[172:175], a[56:59], a[112:115], v[172:175]
  buffer_load_dwordx4 v4, s[8:11], s27 offen offset:0 lds
  v_cvt_pk_bf16_f32 v119, v150, v151
  v_mfma_f32_16x16x32_bf16 v[204:207], a[56:59], a[116:119], v[204:207]
  v_cvt_pk_bf16_f32 v216, v216, v217
  v_cvt_pk_bf16_f32 v217, v218, v219
  v_mfma_f32_16x16x32_bf16 v[168:171], a[16:19], a[88:91], v[168:171]
  v_cvt_pk_bf16_f32 v218, v220, v221
  v_cvt_pk_bf16_f32 v219, v222, v223
  v_mfma_f32_16x16x32_bf16 v[200:203], a[16:19], a[92:95], v[200:203]
  ds_write_b128 v252, v[216:219] offset:1024
  v_cvt_pk_bf16_f32 v72, v180, v181
  v_mfma_f32_16x16x32_bf16 v[168:171], a[52:55], a[112:115], v[168:171]
  v_cvt_pk_bf16_f32 v73, v182, v183
  v_cvt_pk_bf16_f32 v136, v212, v213
  v_mfma_f32_16x16x32_bf16 v[200:203], a[52:55], a[116:119], v[200:203]
  buffer_load_dwordx4 v5, s[8:11], s27 offen offset:1024 lds
  v_cvt_pk_bf16_f32 v137, v214, v215
  v_mfma_f32_16x16x32_bf16 v[164:167], a[12:15], a[88:91], v[164:167]
  v_cvt_pk_bf16_f32 v70, v176, v177
  v_cvt_pk_bf16_f32 v71, v178, v179
  v_mfma_f32_16x16x32_bf16 v[196:199], a[12:15], a[92:95], v[196:199]
  v_cvt_pk_bf16_f32 v134, v208, v209
  v_cvt_pk_bf16_f32 v135, v210, v211
  v_mfma_f32_16x16x32_bf16 v[164:167], a[48:51], a[112:115], v[164:167]
  v_cvt_pk_bf16_f32 v68, v172, v173
  v_cvt_pk_bf16_f32 v69, v174, v175
  v_mfma_f32_16x16x32_bf16 v[196:199], a[48:51], a[116:119], v[196:199]
  v_cvt_pk_bf16_f32 v132, v204, v205
  v_cvt_pk_bf16_f32 v133, v206, v207
  v_mfma_f32_16x16x32_bf16 v[160:163], a[8:11], a[88:91], v[160:163]
  buffer_load_dwordx4 v6, s[8:11], s27 offen offset:2048 lds
  v_cvt_pk_bf16_f32 v66, v168, v169
  v_mfma_f32_16x16x32_bf16 v[192:195], a[8:11], a[92:95], v[192:195]
  v_cvt_pk_bf16_f32 v67, v170, v171
  v_cvt_pk_bf16_f32 v130, v200, v201
  v_mfma_f32_16x16x32_bf16 v[160:163], a[44:47], a[112:115], v[160:163]
  v_cvt_pk_bf16_f32 v131, v202, v203
  v_mfma_f32_16x16x32_bf16 v[192:195], a[44:47], a[116:119], v[192:195]
  v_cvt_pk_bf16_f32 v64, v164, v165
  v_cvt_pk_bf16_f32 v65, v166, v167
  v_mfma_f32_16x16x32_bf16 v[156:159], a[4:7], a[88:91], v[156:159]
  v_cvt_pk_bf16_f32 v128, v196, v197
  v_cvt_pk_bf16_f32 v129, v198, v199
  v_mfma_f32_16x16x32_bf16 v[188:191], a[4:7], a[92:95], v[188:191]
  buffer_load_dwordx4 v7, s[8:11], s27 offen offset:3072 lds
  v_mfma_f32_16x16x32_bf16 v[156:159], a[40:43], a[112:115], v[156:159]
  s_bfe_u32 s29, 0x302010e, s53
  s_add_u32 s52, s52, s29
  s_add_u32 s53, s53, 8
  v_mfma_f32_16x16x32_bf16 v[188:191], a[40:43], a[116:119], v[188:191]
  s_and_b32 s53, s53, 0x8001f
  s_and_b32 s52, s52, 15
  s_lshl_b32 s29, s52, 7
  v_mfma_f32_16x16x32_bf16 v[152:155], a[0:3], a[88:91], v[152:155]
  s_or_b32 s26, s30, s29
  s_or_b32 s27, s31, s29
  v_cvt_pk_bf16_f32 v62, v160, v161
  v_mfma_f32_16x16x32_bf16 v[184:187], a[0:3], a[92:95], v[184:187]
  v_cvt_pk_bf16_f32 v63, v162, v163
  v_cvt_pk_bf16_f32 v126, v192, v193
  v_mfma_f32_16x16x32_bf16 v[152:155], a[36:39], a[112:115], v[152:155]
  v_cvt_pk_bf16_f32 v127, v194, v195
  v_mfma_f32_16x16x32_bf16 v[184:187], a[36:39], a[116:119], v[184:187]
  v_cvt_pk_bf16_f32 v60, v156, v157
  v_cvt_pk_bf16_f32 v61, v158, v159
  v_cvt_pk_bf16_f32 v124, v188, v189
  v_cvt_pk_bf16_f32 v125, v190, v191
  s_nop 1
  v_cvt_pk_bf16_f32 v58, v152, v153
  v_cvt_pk_bf16_f32 v59, v154, v155
  v_cvt_pk_bf16_f32 v122, v184, v185
  v_cvt_pk_bf16_f32 v123, v186, v187
  s_waitcnt lgkmcnt(0)
  s_barrier
Lp2_at:
  ds_read_b128 v[76:79], v253
  ds_read_b64 v[56:57], v253 offset:1024
  ds_read_b64 v[120:121], v253 offset:1032
  v_mfma_f32_16x16x32_bf16 v[208:211], v[112:115], v[52:55], v[240:243]
  s_add_u32 m0, s88, 32768
  s_nop 0
  buffer_load_dwordx4 v4, s[8:11], s26 offen offset:0 lds
  v_mfma_f32_16x16x32_bf16 v[212:215], v[116:119], v[52:55], v[244:247]
  v_mfma_f32_16x16x32_bf16 v[200:203], v[108:111], v[48:51], v[240:243]
  v_mfma_f32_16x16x32_bf16 v[204:207], v[112:115], v[48:51], v[244:247]
  v_mfma_f32_16x16x32_bf16 v[192:195], v[104:107], v[44:47], v[240:243]
  v_mfma_f32_16x16x32_bf16 v[196:199], v[108:111], v[44:47], v[244:247]
  v_mfma_f32_16x16x32_bf16 v[184:187], v[100:103], v[40:43], v[240:243]
  v_mfma_f32_16x16x32_bf16 v[188:191], v[104:107], v[40:43], v[244:247]
  v_mfma_f32_16x16x32_bf16 v[176:179], v[96:99], v[36:39], v[240:243]
  v_mfma_f32_16x16x32_bf16 v[180:183], v[100:103], v[36:39], v[244:247]
  v_mfma_f32_16x16x32_bf16 v[168:171], v[92:95], v[32:35], v[240:243]
  v_mfma_f32_16x16x32_bf16 v[172:175], v[96:99], v[32:35], v[244:247]
  v_mfma_f32_16x16x32_bf16 v[160:163], v[88:91], v[28:31], v[240:243]
  buffer_load_dwordx4 v5, s[8:11], s26 offen offset:1024 lds
  v_mfma_f32_16x16x32_bf16 v[164:167], v[92:95], v[28:31], v[244:247]
  s_waitcnt lgkmcnt(0)
  v_mfma_f32_16x16x32_bf16 v[152:155], v[76:79], v[24:27], v[248:251]
  v_mfma_f32_16x16x32_bf16 v[156:159], v[88:91], v[24:27], v[244:247]
  v_max3_f32 v238, v208, v209, v210
  v_max3_f32 v239, v211, v212, v213
  v_max3_f32 v238, v238, v214, v215
  v_max_f32 v238, v238, v239
  v_max3_f32 v236, v200, v201, v202
  v_max3_f32 v237, v203, v204, v205
  v_max3_f32 v236, v236, v206, v207
  v_max_f32 v236, v236, v237
  v_max3_f32 v234, v192, v193, v194
  v_max3_f32 v235, v195, v196, v197
  buffer_load_dwordx4 v6, s[8:11], s26 offen offset:2048 lds
  v_max3_f32 v234, v234, v198, v199
  v_max_f32 v234, v234, v235
  v_max3_f32 v232, v184, v185, v186
  v_max3_f32 v233, v187, v188, v189
  v_max3_f32 v232, v232, v190, v191
  v_max_f32 v232, v232, v233
  v_max3_f32 v230, v176, v177, v178
  v_max3_f32 v231, v179, v180, v181
  v_max3_f32 v230, v230, v182, v183
  v_max_f32 v230, v230, v231
  v_max3_f32 v228, v168, v169, v170
  v_max3_f32 v229, v171, v172, v173
  buffer_load_dwordx4 v7, s[8:11], s26 offen offset:3072 lds
  v_max3_f32 v228, v228, v174, v175
  v_max_f32 v228, v228, v229
  v_max3_f32 v226, v160, v161, v162
  v_max3_f32 v227, v163, v164, v165
  v_max3_f32 v226, v226, v166, v167
  v_max_f32 v226, v226, v227
  v_max3_f32 v224, v152, v153, v154
  v_max3_f32 v225, v155, v156, v157
  v_max3_f32 v224, v224, v158, v159
  v_max_f32 v224, v224, v225
  v_mov_b32 v239, v238
  v_mov_b32 v237, v236
  v_mov_b32 v235, v234
  s_add_u32 m0, s88, 36864
  s_nop 0
  buffer_load_dwordx4 v4, s[8:11], s27 offen offset:0 lds
  v_mov_b32 v233, v232
  v_mov_b32 v231, v230
  v_mov_b32 v229, v228
  v_mov_b32 v227, v226
  v_mov_b32 v225, v224
  v_permlane32_swap_b32 v238, v239
  v_permlane32_swap_b32 v236, v237
  v_permlane32_swap_b32 v234, v235
  v_permlane32_swap_b32 v232, v233
  v_permlane32_swap_b32 v230, v231
  v_permlane32_swap_b32 v228, v229
  v_permlane32_swap_b32 v226, v227
  buffer_load_dwordx4 v5, s[8:11], s27 offen offset:1024 lds
  v_permlane32_swap_b32 v224, v225
  v_max_f32 v238, v238, v239
  v_max_f32 v236, v236, v237
  v_max_f32 v234, v234, v235
  v_max_f32 v232, v232, v233
  v_max_f32 v230, v230, v231
  v_max_f32 v228, v228, v229
  v_max_f32 v226, v226, v227
  v_max_f32 v224, v224, v225
  v_mov_b32 v239, v238
  v_mov_b32 v237, v236
  v_mov_b32 v235, v234
  buffer_load_dwordx4 v6, s[8:11], s27 offen offset:2048 lds
  v_mov_b32 v233, v232
  v_mov_b32 v231, v230
  v_mov_b32 v229, v228
  v_mov_b32 v227, v226
  v_mov_b32 v225, v224
  v_permlane16_swap_b32 v238, v239
  v_permlane16_swap_b32 v236, v237
  v_permlane16_swap_b32 v234, v235
  v_permlane16_swap_b32 v232, v233
  v_permlane16_swap_b32 v230, v231
  v_permlane16_swap_b32 v228, v229
  v_permlane16_swap_b32 v226, v227
  buffer_load_dwordx4 v7, s[8:11], s27 offen offset:3072 lds
  v_permlane16_swap_b32 v224, v225
  v_max_f32 v238, v238, v239
  v_max_f32 v236, v236, v237
  v_max_f32 v234, v234, v235
  v_max_f32 v232, v232, v233
  v_max_f32 v230, v230, v231
  v_max_f32 v228, v228, v229
  v_max_f32 v226, v226, v227
  v_max_f32 v224, v224, v225
  v_sub_f32 v208, v208, v238
  v_sub_f32 v209, v209, v238
  v_sub_f32 v210, v210, v238
  v_sub_f32 v211, v211, v238
  s_bfe_u32 s29, 0x302010e, s53
  s_add_u32 s52, s52, s29
  s_add_u32 s53, s53, 8
  s_and_b32 s53, s53, 0x8001f
  s_and_b32 s52, s52, 15
  s_lshl_b32 s29, s52, 7
  s_or_b32 s26, s30, s29
  s_or_b32 s27, s31, s29
  s_add_u32 m0, s68, 32768
  s_nop 0
  buffer_load_dwordx4 v8, s[20:23], s28 offen offset:0 lds
  v_sub_f32 v212, v212, v238
  v_sub_f32 v213, v213, v238
  v_sub_f32 v214, v214, v238
  v_sub_f32 v215, v215, v238
  v_exp_f32 v208, v208
  v_exp_f32 v209, v209
  v_exp_f32 v210, v210
  v_exp_f32 v211, v211
  v_exp_f32 v212, v212
  v_exp_f32 v213, v213
  v_exp_f32 v214, v214
  v_exp_f32 v215, v215
  buffer_load_dwordx4 v9, s[20:23], s28 offen offset:1024 lds
  v_sub_f32 v200, v200, v236
  v_sub_f32 v201, v201, v236
  v_sub_f32 v202, v202, v236
  v_sub_f32 v203, v203, v236
  v_sub_f32 v204, v204, v236
  v_sub_f32 v205, v205, v236
  v_sub_f32 v206, v206, v236
  v_sub_f32 v207, v207, v236
  v_exp_f32 v200, v200
  v_exp_f32 v201, v201
  v_exp_f32 v202, v202
  v_exp_f32 v203, v203
  buffer_load_dwordx4 v10, s[20:23], s28 offen offset:2048 lds
  v_exp_f32 v204, v204
  v_exp_f32 v205, v205
  v_exp_f32 v206, v206
  v_exp_f32 v207, v207
  v_cvt_pk_bf16_f32 v116, v208, v209
  v_cvt_pk_bf16_f32 v117, v210, v211
  v_cvt_pk_bf16_f32 v118, v212, v213
  v_cvt_pk_bf16_f32 v119, v214, v215
  s_nop 1
  v_mfma_f32_16x16x32_bf16 v[52:55], a[208:211], v[116:119], 0
  v_mfma_f32_16x16x32_bf16 v[208:211], v[70:73], v[116:119], 0
  v_mfma_f32_16x16x32_bf16 v[212:215], v[134:137], v[116:119], 0
  v_sub_f32 v192, v192, v234
  buffer_load_dwordx4 v11, s[20:23], s28 offen offset:3072 lds
  v_sub_f32 v193, v193, v234
  v_sub_f32 v194, v194, v234
  v_sub_f32 v195, v195, v234
  v_sub_f32 v196, v196, v234
  v_sub_f32 v197, v197, v234
  v_sub_f32 v198, v198, v234
  v_sub_f32 v199, v199, v234
  v_exp_f32 v192, v192
  v_exp_f32 v193, v193
  v_exp_f32 v194, v194
  v_exp_f32 v195, v195
  v_exp_f32 v196, v196
  v_exp_f32 v197, v197
  s_bfe_u32 s56, 0x302010e, s55
  s_add_u32 s54, s54, s56
  s_add_u32 s55, s55, 8
  s_and_b32 s55, s55, 0x8001f
  s_and_b32 s54, s54, 15
  s_lshl_b32 s28, s54, 19
  s_add_u32 m0, s88, -32768
  s_nop 0
  buffer_load_dwordx4 v4, s[8:11], s26 offen offset:0 lds
  v_exp_f32 v198, v198
  v_exp_f32 v199, v199
  v_cvt_pk_bf16_f32 v112, v200, v201
  v_cvt_pk_bf16_f32 v113, v202, v203
  v_cvt_pk_bf16_f32 v114, v204, v205
  v_cvt_pk_bf16_f32 v115, v206, v207
  s_nop 1
  v_mfma_f32_16x16x32_bf16 v[48:51], a[208:211], v[112:115], 0
  v_mfma_f32_16x16x32_bf16 v[200:203], v[68:71], v[112:115], 0
  v_mfma_f32_16x16x32_bf16 v[204:207], v[132:135], v[112:115], 0
  v_sub_f32 v184, v184, v232
  v_sub_f32 v185, v185, v232
  v_sub_f32 v186, v186, v232
  buffer_load_dwordx4 v5, s[8:11], s26 offen offset:1024 lds
  v_sub_f32 v187, v187, v232
  v_sub_f32 v188, v188, v232
  v_sub_f32 v189, v189, v232
  v_sub_f32 v190, v190, v232
  v_sub_f32 v191, v191, v232
  v_exp_f32 v184, v184
  v_exp_f32 v185, v185
  v_exp_f32 v186, v186
  v_exp_f32 v187, v187
  v_exp_f32 v188, v188
  v_exp_f32 v189, v189
  v_exp_f32 v190, v190
  buffer_load_dwordx4 v6, s[8:11], s26 offen offset:2048 lds
  v_exp_f32 v191, v191
  v_cvt_pk_bf16_f32 v108, v192, v193
  v_cvt_pk_bf16_f32 v109, v194, v195
  v_cvt_pk_bf16_f32 v110, v196, v197
  v_cvt_pk_bf16_f32 v111, v198, v199
  s_nop 1
  v_mfma_f32_16x16x32_bf16 v[44:47], a[208:211], v[108:111], 0
  v_mfma_f32_16x16x32_bf16 v[192:195], v[66:69], v[108:111], 0
  v_mfma_f32_16x16x32_bf16 v[196:199], v[130:133], v[108:111], 0
  v_sub_f32 v176, v176, v230
  v_sub_f32 v177, v177, v230
  v_sub_f32 v178, v178, v230
  v_sub_f32 v179, v179, v230
  buffer_load_dwordx4 v7, s[8:11], s26 offen offset:3072 lds
  v_sub_f32 v180, v180, v230
  v_sub_f32 v181, v181, v230
  v_sub_f32 v182, v182, v230
  v_sub_f32 v183, v183, v230
  v_exp_f32 v176, v176
  v_exp_f32 v177, v177
  v_exp_f32 v178, v178
  v_exp_f32 v179, v179
  v_exp_f32 v180, v180
  v_exp_f32 v181, v181
  v_exp_f32 v182, v182
  v_exp_f32 v183, v183
  v_cvt_pk_bf16_f32 v104, v184, v185
  s_add_u32 m0, s88, -28672
  s_nop 0
  buffer_load_dwordx4 v4, s[8:11], s27 offen offset:0 lds
  v_cvt_pk_bf16_f32 v105, v186, v187
  v_cvt_pk_bf16_f32 v106, v188, v189
  v_cvt_pk_bf16_f32 v107, v190, v191
  s_nop 1
  v_mfma_f32_16x16x32_bf16 v[40:43], a[208:211], v[104:107], 0
  v_mfma_f32_16x16x32_bf16 v[184:187], v[64:67], v[104:107], 0
  v_mfma_f32_16x16x32_bf16 v[188:191], v[128:131], v[104:107], 0
  v_sub_f32 v168, v168, v228
  v_sub_f32 v169, v169, v228
  v_sub_f32 v170, v170, v228
  v_sub_f32 v171, v171, v228
  v_sub_f32 v172, v172, v228
  v_sub_f32 v173, v173, v228
  buffer_load_dwordx4 v5, s[8:11], s27 offen offset:1024 lds
  v_sub_f32 v174, v174, v228
  v_sub_f32 v175, v175, v228
  v_exp_f32 v168, v168
  v_exp_f32 v169, v169
  v_exp_f32 v170, v170
  v_exp_f32 v171, v171
  v_exp_f32 v172, v172
  v_exp_f32 v173, v173
  v_exp_f32 v174, v174
  v_exp_f32 v175, v175
  v_cvt_pk_bf16_f32 v100, v176, v177
  v_cvt_pk_bf16_f32 v101, v178, v179
  buffer_load_dwordx4 v6, s[8:11], s27 offen offset:2048 lds
  v_cvt_pk_bf16_f32 v102, v180, v181
  v_cvt_pk_bf16_f32 v103, v182, v183
  s_nop 1
  v_mfma_f32_16x16x32_bf16 v[36:39], a[208:211], v[100:103], 0
  v_mfma_f32_16x16x32_bf16 v[176:179], v[62:65], v[100:103], 0
  v_mfma_f32_16x16x32_bf16 v[180:183], v[126:129], v[100:103], 0
  v_sub_f32 v160, v160, v226
  v_sub_f32 v161, v161, v226
  v_sub_f32 v162, v162, v226
  v_sub_f32 v163, v163, v226
  v_sub_f32 v164, v164, v226
  v_sub_f32 v165, v165, v226
  v_sub_f32 v166, v166, v226
  buffer_load_dwordx4 v7, s[8:11], s27 offen offset:3072 lds
  s_bfe_u32 s29, 0x302010e, s53
  s_add_u32 s52, s52, s29
  s_add_u32 s53, s53, 8
  s_and_b32 s53, s53, 0x8001f
  s_and_b32 s52, s52, 15
  s_lshl_b32 s29, s52, 7
  s_or_b32 s26, s30, s29
  s_or_b32 s27, s31, s29
  v_sub_f32 v167, v167, v226
  v_exp_f32 v160, v160
  v_exp_f32 v161, v161
  v_exp_f32 v162, v162
  v_exp_f32 v163, v163
  v_exp_f32 v164, v164
  v_exp_f32 v165, v165
  v_exp_f32 v166, v166
  v_exp_f32 v167, v167
  v_cvt_pk_bf16_f32 v96, v168, v169
  v_cvt_pk_bf16_f32 v97, v170, v171
  v_cvt_pk_bf16_f32 v98, v172, v173
  v_cvt_pk_bf16_f32 v99, v174, v175
  s_nop 1
  v_mfma_f32_16x16x32_bf16 v[32:35], a[208:211], v[96:99], 0
  v_mfma_f32_16x16x32_bf16 v[168:171], v[60:63], v[96:99], 0
  v_mfma_f32_16x16x32_bf16 v[172:175], v[124:127], v[96:99], 0
  v_sub_f32 v152, v152, v224
  v_sub_f32 v153, v153, v224
  v_sub_f32 v154, v154, v224
  v_sub_f32 v155, v155, v224
  v_sub_f32 v156, v156, v224
  v_sub_f32 v157, v157, v224
  v_sub_f32 v158, v158, v224
  v_sub_f32 v159, v159, v224
  v_exp_f32 v152, v152
  v_exp_f32 v153, v153
  v_exp_f32 v154, v154
  v_exp_f32 v155, v155
  v_exp_f32 v156, v156
  v_exp_f32 v157, v157
  v_exp_f32 v158, v158
  v_exp_f32 v159, v159
  v_cvt_pk_bf16_f32 v92, v160, v161
  v_cvt_pk_bf16_f32 v93, v162, v163
  v_cvt_pk_bf16_f32 v94, v164, v165
  v_cvt_pk_bf16_f32 v95, v166, v167
  s_nop 1
  v_mfma_f32_16x16x32_bf16 v[28:31], a[208:211], v[92:95], 0
  v_mfma_f32_16x16x32_bf16 v[160:163], v[58:61], v[92:95], 0
  v_mfma_f32_16x16x32_bf16 v[164:167], v[122:125], v[92:95], 0
  v_cvt_pk_bf16_f32 v88, v152, v153
  v_cvt_pk_bf16_f32 v89, v154, v155
  v_cvt_pk_bf16_f32 v90, v156, v157
  v_cvt_pk_bf16_f32 v91, v158, v159
  s_nop 1
  v_mfma_f32_16x16x32_bf16 v[24:27], a[208:211], v[88:91], 0
  v_mfma_f32_16x16x32_bf16 v[152:155], v[56:59], v[88:91], 0
  v_mfma_f32_16x16x32_bf16 v[156:159], v[120:123], v[88:91], 0
  v_rcp_f32 v52, v52
  v_rcp_f32 v48, v48
  v_rcp_f32 v44, v44
  v_rcp_f32 v40, v40
  v_rcp_f32 v36, v36
  v_rcp_f32 v32, v32
  v_rcp_f32 v28, v28
  v_rcp_f32 v24, v24
  v_mov_b32 v53, v52
  v_mov_b32 v49, v48
  v_mov_b32 v45, v44
  v_mov_b32 v41, v40
  v_mov_b32 v37, v36
  v_mov_b32 v33, v32
  v_mov_b32 v29, v28
  v_mov_b32 v25, v24
  v_pk_mul_f32 v[208:209], v[208:209], v[52:53]
  v_pk_mul_f32 v[210:211], v[210:211], v[52:53]
  v_pk_mul_f32 v[212:213], v[212:213], v[52:53]
  v_pk_mul_f32 v[214:215], v[214:215], v[52:53]
  v_cvt_pk_bf16_f32 v208, v208, v209
  v_cvt_pk_bf16_f32 v209, v210, v211
  v_cvt_pk_bf16_f32 v210, v212, v213
  v_cvt_pk_bf16_f32 v211, v214, v215
  buffer_store_dwordx4 v[208:211], v2, s[16:19], s58 offen offset:3072 sc1
  v_pk_mul_f32 v[200:201], v[200:201], v[48:49]
  v_pk_mul_f32 v[202:203], v[202:203], v[48:49]
  v_pk_mul_f32 v[204:205], v[204:205], v[48:49]
  v_pk_mul_f32 v[206:207], v[206:207], v[48:49]
  v_cvt_pk_bf16_f32 v200, v200, v201
  v_cvt_pk_bf16_f32 v201, v202, v203
  v_cvt_pk_bf16_f32 v202, v204, v205
  v_cvt_pk_bf16_f32 v203, v206, v207
  buffer_store_dwordx4 v[200:203], v2, s[16:19], s58 offen offset:2048 sc1
  v_pk_mul_f32 v[192:193], v[192:193], v[44:45]
  v_pk_mul_f32 v[194:195], v[194:195], v[44:45]
  v_pk_mul_f32 v[196:197], v[196:197], v[44:45]
  v_pk_mul_f32 v[198:199], v[198:199], v[44:45]
  v_cvt_pk_bf16_f32 v192, v192, v193
  v_cvt_pk_bf16_f32 v193, v194, v195
  v_cvt_pk_bf16_f32 v194, v196, v197
  v_cvt_pk_bf16_f32 v195, v198, v199
  buffer_store_dwordx4 v[192:195], v2, s[16:19], s58 offen offset:1024 sc1
  v_pk_mul_f32 v[184:185], v[184:185], v[40:41]
  v_pk_mul_f32 v[186:187], v[186:187], v[40:41]
  v_pk_mul_f32 v[188:189], v[188:189], v[40:41]
  v_pk_mul_f32 v[190:191], v[190:191], v[40:41]
  v_cvt_pk_bf16_f32 v184, v184, v185
  v_cvt_pk_bf16_f32 v185, v186, v187
  v_cvt_pk_bf16_f32 v186, v188, v189
  v_cvt_pk_bf16_f32 v187, v190, v191
  buffer_store_dwordx4 v[184:187], v2, s[16:19], s58 offen offset:0 sc1
  v_pk_mul_f32 v[176:177], v[176:177], v[36:37]
  v_pk_mul_f32 v[178:179], v[178:179], v[36:37]
  v_pk_mul_f32 v[180:181], v[180:181], v[36:37]
  v_pk_mul_f32 v[182:183], v[182:183], v[36:37]
  v_cvt_pk_bf16_f32 v176, v176, v177
  v_cvt_pk_bf16_f32 v177, v178, v179
  v_cvt_pk_bf16_f32 v178, v180, v181
  v_cvt_pk_bf16_f32 v179, v182, v183
  buffer_store_dwordx4 v[176:179], v2, s[16:19], s57 offen offset:3072 sc1
  v_pk_mul_f32 v[168:169], v[168:169], v[32:33]
  v_pk_mul_f32 v[170:171], v[170:171], v[32:33]
  v_pk_mul_f32 v[172:173], v[172:173], v[32:33]
  v_pk_mul_f32 v[174:175], v[174:175], v[32:33]
  v_cvt_pk_bf16_f32 v168, v168, v169
  v_cvt_pk_bf16_f32 v169, v170, v171
  v_cvt_pk_bf16_f32 v170, v172, v173
  v_cvt_pk_bf16_f32 v171, v174, v175
  buffer_store_dwordx4 v[168:171], v2, s[16:19], s57 offen offset:2048 sc1
  v_pk_mul_f32 v[160:161], v[160:161], v[28:29]
  v_pk_mul_f32 v[162:163], v[162:163], v[28:29]
  v_pk_mul_f32 v[164:165], v[164:165], v[28:29]
  v_pk_mul_f32 v[166:167], v[166:167], v[28:29]
  v_cvt_pk_bf16_f32 v160, v160, v161
  v_cvt_pk_bf16_f32 v161, v162, v163
  v_cvt_pk_bf16_f32 v162, v164, v165
  v_cvt_pk_bf16_f32 v163, v166, v167
  buffer_store_dwordx4 v[160:163], v2, s[16:19], s57 offen offset:1024 sc1
  v_pk_mul_f32 v[152:153], v[152:153], v[24:25]
  v_pk_mul_f32 v[154:155], v[154:155], v[24:25]
  v_pk_mul_f32 v[156:157], v[156:157], v[24:25]
  v_pk_mul_f32 v[158:159], v[158:159], v[24:25]
  v_cvt_pk_bf16_f32 v152, v152, v153
  v_cvt_pk_bf16_f32 v153, v154, v155
  v_cvt_pk_bf16_f32 v154, v156, v157
  v_cvt_pk_bf16_f32 v155, v158, v159
  buffer_store_dwordx4 v[152:155], v2, s[16:19], s57 offen offset:0 sc1
  s_lshl_b32 s34, s32, 4
  s_add_u32 s34, s34, s33
  s_lshl_b32 s34, s34, 7
  s_add_u32 s34, s34, 32768
  s_mov_b32 s63, 0x70000000
Lp3:
  v_accvgpr_read_b32 v16, a230
  v_accvgpr_read_b32 v17, a231
  v_accvgpr_read_b32 v18, a232
  v_accvgpr_read_b32 v19, a233
  v_accvgpr_read_b32 v20, a234
  v_accvgpr_read_b32 v21, a235
  s_mov_b32 s89, 0
  s_mov_b32 s91, 4294901760
  s_mov_b32 s92, 32768
  s_mov_b32 s89, 1
  s_mov_b32 s69, 0
  s_mov_b32 s71, 4294934528
  s_mov_b32 s72, 16384
  s_waitcnt vmcnt(28)
  s_barrier
  ds_read_b128 a[0:3], v16 offset:0
  ds_read_b64_tr_b16 a[32:33], v18 offset:0
  ds_read_b64_tr_b16 a[34:35], v18 offset:2048
  ds_read_b128 a[4:7], v16 offset:2048
  ds_read_b128 a[8:11], v16 offset:4096
  ds_read_b128 a[12:15], v16 offset:6144
  ds_read_b64_tr_b16 a[36:37], v19 offset:0
  ds_read_b64_tr_b16 a[38:39], v19 offset:2048
  ds_read_b64_tr_b16 a[40:41], v20 offset:0
  ds_read_b64_tr_b16 a[42:43], v20 offset:2048
  ds_read_b64_tr_b16 a[44:45], v21 offset:0
  ds_read_b64_tr_b16 a[46:47], v21 offset:2048
  ds_read_b64_tr_b16 a[48:49], v18 offset:8192
  ds_read_b64_tr_b16 a[50:51], v18 offset:10240
  ds_read_b64_tr_b16 a[52:53], v19 offset:8192
  ds_read_b64_tr_b16 a[54:55], v19 offset:10240
  ds_read_b64_tr_b16 a[56:57], v20 offset:8192
  ds_read_b64_tr_b16 a[58:59], v20 offset:10240
  ds_read_b64_tr_b16 a[60:61], v21 offset:8192
  ds_read_b64_tr_b16 a[62:63], v21 offset:10240
  s_waitcnt lgkmcnt(0)
  v_mfma_f32_16x16x32_bf16 v[32:35], a[32:35], a[0:3], 0
  s_add_u32 s60, s63, 32768
  buffer_store_dwordx4 v[192:195], v2, s[16:19], s60 offen offset:0 sc1
  ds_read_b128 a[16:19], v17 offset:0
  v_mfma_f32_16x16x32_bf16 v[64:67], a[32:35], a[4:7], 0
  s_add_u32 s60, s63, 40960
  ds_read_b64_tr_b16 a[64:65], v18 offset:4096
  v_mfma_f32_16x16x32_bf16 v[96:99], a[32:35], a[8:11], 0
  ds_read_b64_tr_b16 a[66:67], v18 offset:6144
  v_mfma_f32_16x16x32_bf16 v[128:131], a[32:35], a[12:15], 0
  ds_read_b128 a[20:23], v17 offset:2048
  v_mfma_f32_16x16x32_bf16 v[36:39], a[36:39], a[0:3], 0
  ds_read_b128 a[24:27], v17 offset:4096
  v_mfma_f32_16x16x32_bf16 v[68:71], a[36:39], a[4:7], 0
  ds_read_b128 a[28:31], v17 offset:6144
  v_mfma_f32_16x16x32_bf16 v[100:103], a[36:39], a[8:11], 0
  ds_read_b64_tr_b16 a[68:69], v19 offset:4096
  v_mfma_f32_16x16x32_bf16 v[132:135], a[36:39], a[12:15], 0
  ds_read_b64_tr_b16 a[70:71], v19 offset:6144
  v_mfma_f32_16x16x32_bf16 v[40:43], a[40:43], a[0:3], 0
  ds_read_b64_tr_b16 a[72:73], v20 offset:4096
  v_mfma_f32_16x16x32_bf16 v[72:75], a[40:43], a[4:7], 0
  ds_read_b64_tr_b16 a[74:75], v20 offset:6144
  v_mfma_f32_16x16x32_bf16 v[104:107], a[40:43], a[8:11], 0
  v_mfma_f32_16x16x32_bf16 v[136:139], a[40:43], a[12:15], 0
  ds_read_b64_tr_b16 a[76:77], v21 offset:4096
  v_mfma_f32_16x16x32_bf16 v[44:47], a[44:47], a[0:3], 0
  buffer_store_dwordx4 v[224:227], v2, s[16:19], s60 offen offset:0 sc1
  ds_read_b64_tr_b16 a[78:79], v21 offset:6144
  v_mfma_f32_16x16x32_bf16 v[76:79], a[44:47], a[4:7], 0
  s_add_u32 s89, s89, 1
  s_cmp_eq_u32 s89, 3
  s_cselect_b32 s89, 0, s89
  s_cselect_b32 s90, s91, s92
  ds_read_b64_tr_b16 a[80:81], v18 offset:12288
  v_mfma_f32_16x16x32_bf16 v[108:111], a[44:47], a[8:11], 0
  s_add_u32 s69, s69, 1
  s_cmp_eq_u32 s69, 3
  s_cselect_b32 s69, 0, s69
  s_cselect_b32 s70, s71, s72
  ds_read_b64_tr_b16 a[82:83], v18 offset:14336
  v_mfma_f32_16x16x32_bf16 v[140:143], a[44:47], a[12:15], 0
  ds_read_b64_tr_b16 a[84:85], v19 offset:12288
  v_mfma_f32_16x16x32_bf16 v[48:51], a[48:51], a[0:3], 0
  ds_read_b64_tr_b16 a[86:87], v19 offset:14336
  v_mfma_f32_16x16x32_bf16 v[80:83], a[48:51], a[4:7], 0
  ds_read_b64_tr_b16 a[88:89], v20 offset:12288
  v_mfma_f32_16x16x32_bf16 v[112:115], a[48:51], a[8:11], 0
  ds_read_b64_tr_b16 a[90:91], v20 offset:14336
  v_mfma_f32_16x16x32_bf16 v[144:147], a[48:51], a[12:15], 0
  ds_read_b64_tr_b16 a[92:93], v21 offset:12288
  v_mfma_f32_16x16x32_bf16 v[52:55], a[52:55], a[0:3], 0
  ds_read_b64_tr_b16 a[94:95], v21 offset:14336
  v_mfma_f32_16x16x32_bf16 v[84:87], a[52:55], a[4:7], 0
  v_add_u32 v16, s90, v16
  v_add_u32 v17, s90, v17
  v_mfma_f32_16x16x32_bf16 v[116:119], a[52:55], a[8:11], 0
  v_add_u32 v18, s70, v18
  v_add_u32 v19, s70, v19
  v_mfma_f32_16x16x32_bf16 v[148:151], a[52:55], a[12:15], 0
  v_add_u32 v20, s70, v20
  v_add_u32 v21, s70, v21
  v_mfma_f32_16x16x32_bf16 v[56:59], a[56:59], a[0:3], 0
  v_mfma_f32_16x16x32_bf16 v[88:91], a[56:59], a[4:7], 0
  v_mfma_f32_16x16x32_bf16 v[120:123], a[56:59], a[8:11], 0
  v_mfma_f32_16x16x32_bf16 v[152:155], a[56:59], a[12:15], 0
  v_mfma_f32_16x16x32_bf16 v[60:63], a[60:63], a[0:3], 0
  v_mfma_f32_16x16x32_bf16 v[92:95], a[60:63], a[4:7], 0
  v_mfma_f32_16x16x32_bf16 v[124:127], a[60:63], a[8:11], 0
  v_mfma_f32_16x16x32_bf16 v[156:159], a[60:63], a[12:15], 0
  s_waitcnt vmcnt(14) lgkmcnt(0)
  s_barrier
  v_mfma_f32_16x16x32_bf16 v[32:35], a[64:67], a[16:19], v[32:35]
  s_mov_b32 m0, s68
  ds_read_b128 a[0:3], v16 offset:0
  v_mfma_f32_16x16x32_bf16 v[64:67], a[64:67], a[20:23], v[64:67]
  buffer_load_dwordx4 v8, s[20:23], s28 offen offset:0 lds
  ds_read_b64_tr_b16 a[32:33], v18 offset:0
  v_mfma_f32_16x16x32_bf16 v[96:99], a[64:67], a[24:27], v[96:99]
  ds_read_b64_tr_b16 a[34:35], v18 offset:2048
  v_mfma_f32_16x16x32_bf16 v[128:131], a[64:67], a[28:31], v[128:131]
  ds_read_b128 a[4:7], v16 offset:2048
  v_mfma_f32_16x16x32_bf16 v[36:39], a[68:71], a[16:19], v[36:39]
  buffer_load_dwordx4 v9, s[20:23], s28 offen offset:1024 lds
  ds_read_b128 a[8:11], v16 offset:4096
  v_mfma_f32_16x16x32_bf16 v[68:71], a[68:71], a[20:23], v[68:71]
  ds_read_b128 a[12:15], v16 offset:6144
  v_mfma_f32_16x16x32_bf16 v[100:103], a[68:71], a[24:27], v[100:103]
  ds_read_b64_tr_b16 a[36:37], v19 offset:0
  v_mfma_f32_16x16x32_bf16 v[132:135], a[68:71], a[28:31], v[132:135]
  ds_read_b64_tr_b16 a[38:39], v19 offset:2048
  v_mfma_f32_16x16x32_bf16 v[40:43], a[72:75], a[16:19], v[40:43]
  buffer_load_dwordx4 v10, s[20:23], s28 offen offset:2048 lds
  ds_read_b64_tr_b16 a[40:41], v20 offset:0
  v_mfma_f32_16x16x32_bf16 v[72:75], a[72:75], a[20:23], v[72:75]
  ds_read_b64_tr_b16 a[42:43], v20 offset:2048
  v_mfma_f32_16x16x32_bf16 v[104:107], a[72:75], a[24:27], v[104:107]
  v_mfma_f32_16x16x32_bf16 v[136:139], a[72:75], a[28:31], v[136:139]
  ds_read_b64_tr_b16 a[44:45], v21 offset:0
  v_mfma_f32_16x16x32_bf16 v[44:47], a[76:79], a[16:19], v[44:47]
  ds_read_b64_tr_b16 a[46:47], v21 offset:2048
  v_mfma_f32_16x16x32_bf16 v[76:79], a[76:79], a[20:23], v[76:79]
  buffer_load_dwordx4 v11, s[20:23], s28 offen offset:3072 lds
  ds_read_b64_tr_b16 a[48:49], v18 offset:8192
  v_mfma_f32_16x16x32_bf16 v[108:111], a[76:79], a[24:27], v[108:111]
  s_bfe_u32 s56, 0x302010e, s55
  s_add_u32 s54, s54, s56
  s_add_u32 s55, s55, 8
  v_mfma_f32_16x16x32_bf16 v[140:143], a[76:79], a[28:31], v[140:143]
  s_and_b32 s55, s55, 0x8001f
  s_and_b32 s54, s54, 15
  s_lshl_b32 s28, s54, 19
  v_mfma_f32_16x16x32_bf16 v[48:51], a[80:83], a[16:19], v[48:51]
  s_mov_b32 m0, s88
  ds_read_b64_tr_b16 a[50:51], v18 offset:10240
  ds_read_b64_tr_b16 a[52:53], v19 offset:8192
  v_mfma_f32_16x16x32_bf16 v[80:83], a[80:83], a[20:23], v[80:83]
  buffer_load_dwordx4 v4, s[8:11], s26 offen offset:0 lds
  ds_read_b64_tr_b16 a[54:55], v19 offset:10240
  v_mfma_f32_16x16x32_bf16 v[112:115], a[80:83], a[24:27], v[112:115]
  ds_read_b64_tr_b16 a[56:57], v20 offset:8192
  ds_read_b64_tr_b16 a[58:59], v20 offset:10240
  v_mfma_f32_16x16x32_bf16 v[144:147], a[80:83], a[28:31], v[144:147]
  ds_read_b64_tr_b16 a[60:61], v21 offset:8192
  v_mfma_f32_16x16x32_bf16 v[52:55], a[84:87], a[16:19], v[52:55]
  ds_read_b64_tr_b16 a[62:63], v21 offset:10240
  v_mfma_f32_16x16x32_bf16 v[84:87], a[84:87], a[20:23], v[84:87]
  v_mfma_f32_16x16x32_bf16 v[116:119], a[84:87], a[24:27], v[116:119]
  buffer_load_dwordx4 v5, s[8:11], s26 offen offset:1024 lds
  v_mfma_f32_16x16x32_bf16 v[148:151], a[84:87], a[28:31], v[148:151]
  v_mfma_f32_16x16x32_bf16 v[56:59], a[88:91], a[16:19], v[56:59]
  v_mfma_f32_16x16x32_bf16 v[88:91], a[88:91], a[20:23], v[88:91]
  v_mfma_f32_16x16x32_bf16 v[120:123], a[88:91], a[24:27], v[120:123]
  buffer_load_dwordx4 v6, s[8:11], s26 offen offset:2048 lds
  v_mfma_f32_16x16x32_bf16 v[152:155], a[88:91], a[28:31], v[152:155]
  v_mfma_f32_16x16x32_bf16 v[60:63], a[92:95], a[16:19], v[60:63]
  v_mfma_f32_16x16x32_bf16 v[92:95], a[92:95], a[20:23], v[92:95]
  v_mfma_f32_16x16x32_bf16 v[124:127], a[92:95], a[24:27], v[124:127]
  v_mfma_f32_16x16x32_bf16 v[156:159], a[92:95], a[28:31], v[156:159]
  s_waitcnt lgkmcnt(0)
  v_mfma_f32_16x16x32_bf16 v[32:35], a[32:35], a[0:3], v[32:35]
  buffer_load_dwordx4 v7, s[8:11], s26 offen offset:3072 lds
  ds_read_b128 a[16:19], v17 offset:0
  v_mfma_f32_16x16x32_bf16 v[64:67], a[32:35], a[4:7], v[64:67]
  s_add_u32 m0, s88, 4096
  ds_read_b64_tr_b16 a[64:65], v18 offset:4096
  v_mfma_f32_16x16x32_bf16 v[96:99], a[32:35], a[8:11], v[96:99]
  ds_read_b64_tr_b16 a[66:67], v18 offset:6144
  v_mfma_f32_16x16x32_bf16 v[128:131], a[32:35], a[12:15], v[128:131]
  buffer_load_dwordx4 v4, s[8:11], s27 offen offset:0 lds
  ds_read_b128 a[20:23], v17 offset:2048
  v_mfma_f32_16x16x32_bf16 v[36:39], a[36:39], a[0:3], v[36:39]
  ds_read_b128 a[24:27], v17 offset:4096
  v_mfma_f32_16x16x32_bf16 v[68:71], a[36:39], a[4:7], v[68:71]
  ds_read_b128 a[28:31], v17 offset:6144
  v_mfma_f32_16x16x32_bf16 v[100:103], a[36:39], a[8:11], v[100:103]
  ds_read_b64_tr_b16 a[68:69], v19 offset:4096
  v_mfma_f32_16x16x32_bf16 v[132:135], a[36:39], a[12:15], v[132:135]
  buffer_load_dwordx4 v5, s[8:11], s27 offen offset:1024 lds
  ds_read_b64_tr_b16 a[70:71], v19 offset:6144
  v_mfma_f32_16x16x32_bf16 v[40:43], a[40:43], a[0:3], v[40:43]
  ds_read_b64_tr_b16 a[72:73], v20 offset:4096
  v_mfma_f32_16x16x32_bf16 v[72:75], a[40:43], a[4:7], v[72:75]
  ds_read_b64_tr_b16 a[74:75], v20 offset:6144
  v_mfma_f32_16x16x32_bf16 v[104:107], a[40:43], a[8:11], v[104:107]
  buffer_load_dwordx4 v6, s[8:11], s27 offen offset:2048 lds
  v_mfma_f32_16x16x32_bf16 v[136:139], a[40:43], a[12:15], v[136:139]
  ds_read_b64_tr_b16 a[76:77], v21 offset:4096
  v_mfma_f32_16x16x32_bf16 v[44:47], a[44:47], a[0:3], v[44:47]
  ds_read_b64_tr_b16 a[78:79], v21 offset:6144
  v_mfma_f32_16x16x32_bf16 v[76:79], a[44:47], a[4:7], v[76:79]
  ds_read_b64_tr_b16 a[80:81], v18 offset:12288
  v_mfma_f32_16x16x32_bf16 v[108:111], a[44:47], a[8:11], v[108:111]
  buffer_load_dwordx4 v7, s[8:11], s27 offen offset:3072 lds
  ds_read_b64_tr_b16 a[82:83], v18 offset:14336
  v_mfma_f32_16x16x32_bf16 v[140:143], a[44:47], a[12:15], v[140:143]
  s_bfe_u32 s29, 0x302010e, s53
  s_add_u32 s52, s52, s29
  s_add_u32 s53, s53, 8
  v_mfma_f32_16x16x32_bf16 v[48:51], a[48:51], a[0:3], v[48:51]
  s_and_b32 s53, s53, 0x8001f
  s_and_b32 s52, s52, 15
  s_lshl_b32 s29, s52, 7
  v_mfma_f32_16x16x32_bf16 v[80:83], a[48:51], a[4:7], v[80:83]
  s_or_b32 s26, s30, s29
  s_or_b32 s27, s31, s29
  s_add_u32 s60, s63, 32768
  v_mfma_f32_16x16x32_bf16 v[112:115], a[48:51], a[8:11], v[112:115]
  buffer_store_dwordx4 v[196:199], v2, s[16:19], s60 offen offset:1024 sc1
  ds_read_b64_tr_b16 a[84:85], v19 offset:12288
  v_mfma_f32_16x16x32_bf16 v[144:147], a[48:51], a[12:15], v[144:147]
  s_add_u32 s60, s63, 40960
  ds_read_b64_tr_b16 a[86:87], v19 offset:14336
  ds_read_b64_tr_b16 a[88:89], v20 offset:12288
  v_mfma_f32_16x16x32_bf16 v[52:55], a[52:55], a[0:3], v[52:55]
  ds_read_b64_tr_b16 a[90:91], v20 offset:14336
  ds_read_b64_tr_b16 a[92:93], v21 offset:12288
  v_mfma_f32_16x16x32_bf16 v[84:87], a[52:55], a[4:7], v[84:87]
  buffer_store_dwordx4 v[228:231], v2, s[16:19], s60 offen offset:1024 sc1
  ds_read_b64_tr_b16 a[94:95], v21 offset:14336
  v_mfma_f32_16x16x32_bf16 v[116:119], a[52:55], a[8:11], v[116:119]
  s_add_u32 s88, s88, s90
  s_add_u32 s89, s89, 1
  s_cmp_eq_u32 s89, 3
  s_cselect_b32 s89, 0, s89
  s_cselect_b32 s90, s91, s92
  v_mfma_f32_16x16x32_bf16 v[148:151], a[52:55], a[12:15], v[148:151]
  s_add_u32 s68, s68, s70
  s_add_u32 s69, s69, 1
  s_cmp_eq_u32 s69, 3
  s_cselect_b32 s69, 0, s69
  s_cselect_b32 s70, s71, s72
  v_mfma_f32_16x16x32_bf16 v[56:59], a[56:59], a[0:3], v[56:59]
  v_add_u32 v16, s90, v16
  v_add_u32 v17, s90, v17
  v_mfma_f32_16x16x32_bf16 v[88:91], a[56:59], a[4:7], v[88:91]
  v_add_u32 v18, s70, v18
  v_add_u32 v19, s70, v19
  v_mfma_f32_16x16x32_bf16 v[120:123], a[56:59], a[8:11], v[120:123]
  v_add_u32 v20, s70, v20
  v_add_u32 v21, s70, v21
  v_mfma_f32_16x16x32_bf16 v[152:155], a[56:59], a[12:15], v[152:155]
  v_mfma_f32_16x16x32_bf16 v[60:63], a[60:63], a[0:3], v[60:63]
  v_mfma_f32_16x16x32_bf16 v[92:95], a[60:63], a[4:7], v[92:95]
  v_mfma_f32_16x16x32_bf16 v[124:127], a[60:63], a[8:11], v[124:127]
  v_mfma_f32_16x16x32_bf16 v[156:159], a[60:63], a[12:15], v[156:159]
  s_waitcnt vmcnt(16) lgkmcnt(0)
  s_barrier
  v_mfma_f32_16x16x32_bf16 v[32:35], a[64:67], a[16:19], v[32:35]
  s_mov_b32 m0, s68
  ds_read_b128 a[0:3], v16 offset:0
  v_mfma_f32_16x16x32_bf16 v[64:67], a[64:67], a[20:23], v[64:67]
  buffer_load_dwordx4 v8, s[20:23], s28 offen offset:0 lds
  ds_read_b64_tr_b16 a[32:33], v18 offset:0
  v_mfma_f32_16x16x32_bf16 v[96:99], a[64:67], a[24:27], v[96:99]
  ds_read_b64_tr_b16 a[34:35], v18 offset:2048
  v_mfma_f32_16x16x32_bf16 v[128:131], a[64:67], a[28:31], v[128:131]
  ds_read_b128 a[4:7], v16 offset:2048
  v_mfma_f32_16x16x32_bf16 v[36:39], a[68:71], a[16:19], v[36:39]
  buffer_load_dwordx4 v9, s[20:23], s28 offen offset:1024 lds
  ds_read_b128 a[8:11], v16 offset:4096
  v_mfma_f32_16x16x32_bf16 v[68:71], a[68:71], a[20:23], v[68:71]
  ds_read_b128 a[12:15], v16 offset:6144
  v_mfma_f32_16x16x32_bf16 v[100:103], a[68:71], a[24:27], v[100:103]
  ds_read_b64_tr_b16 a[36:37], v19 offset:0
  v_mfma_f32_16x16x32_bf16 v[132:135], a[68:71], a[28:31], v[132:135]
  ds_read_b64_tr_b16 a[38:39], v19 offset:2048
  v_mfma_f32_16x16x32_bf16 v[40:43], a[72:75], a[16:19], v[40:43]
  buffer_load_dwordx4 v10, s[20:23], s28 offen offset:2048 lds
  ds_read_b64_tr_b16 a[40:41], v20 offset:0
  v_mfma_f32_16x16x32_bf16 v[72:75], a[72:75], a[20:23], v[72:75]
  ds_read_b64_tr_b16 a[42:43], v20 offset:2048
  v_mfma_f32_16x16x32_bf16 v[104:107], a[72:75], a[24:27], v[104:107]
  v_mfma_f32_16x16x32_bf16 v[136:139], a[72:75], a[28:31], v[136:139]
  ds_read_b64_tr_b16 a[44:45], v21 offset:0
  v_mfma_f32_16x16x32_bf16 v[44:47], a[76:79], a[16:19], v[44:47]
  ds_read_b64_tr_b16 a[46:47], v21 offset:2048
  v_mfma_f32_16x16x32_bf16 v[76:79], a[76:79], a[20:23], v[76:79]
  buffer_load_dwordx4 v11, s[20:23], s28 offen offset:3072 lds
  ds_read_b64_tr_b16 a[48:49], v18 offset:8192
  v_mfma_f32_16x16x32_bf16 v[108:111], a[76:79], a[24:27], v[108:111]
  s_bfe_u32 s56, 0x302010e, s55
  s_add_u32 s54, s54, s56
  s_add_u32 s55, s55, 8
  v_mfma_f32_16x16x32_bf16 v[140:143], a[76:79], a[28:31], v[140:143]
  s_and_b32 s55, s55, 0x8001f
  s_and_b32 s54, s54, 15
  s_lshl_b32 s28, s54, 19
  v_mfma_f32_16x16x32_bf16 v[48:51], a[80:83], a[16:19], v[48:51]
  s_mov_b32 m0, s88
  ds_read_b64_tr_b16 a[50:51], v18 offset:10240
  ds_read_b64_tr_b16 a[52:53], v19 offset:8192
  v_mfma_f32_16x16x32_bf16 v[80:83], a[80:83], a[20:23], v[80:83]
  buffer_load_dwordx4 v4, s[8:11], s26 offen offset:0 lds
  ds_read_b64_tr_b16 a[54:55], v19 offset:10240
  v_mfma_f32_16x16x32_bf16 v[112:115], a[80:83], a[24:27], v[112:115]
  ds_read_b64_tr_b16 a[56:57], v20 offset:8192
  ds_read_b64_tr_b16 a[58:59], v20 offset:10240
  v_mfma_f32_16x16x32_bf16 v[144:147], a[80:83], a[28:31], v[144:147]
  ds_read_b64_tr_b16 a[60:61], v21 offset:8192
  v_mfma_f32_16x16x32_bf16 v[52:55], a[84:87], a[16:19], v[52:55]
  ds_read_b64_tr_b16 a[62:63], v21 offset:10240
  v_mfma_f32_16x16x32_bf16 v[84:87], a[84:87], a[20:23], v[84:87]
  v_mfma_f32_16x16x32_bf16 v[116:119], a[84:87], a[24:27], v[116:119]
  buffer_load_dwordx4 v5, s[8:11], s26 offen offset:1024 lds
  v_mfma_f32_16x16x32_bf16 v[148:151], a[84:87], a[28:31], v[148:151]
  v_mfma_f32_16x16x32_bf16 v[56:59], a[88:91], a[16:19], v[56:59]
  v_mfma_f32_16x16x32_bf16 v[88:91], a[88:91], a[20:23], v[88:91]
  v_mfma_f32_16x16x32_bf16 v[120:123], a[88:91], a[24:27], v[120:123]
  buffer_load_dwordx4 v6, s[8:11], s26 offen offset:2048 lds
  v_mfma_f32_16x16x32_bf16 v[152:155], a[88:91], a[28:31], v[152:155]
  v_mfma_f32_16x16x32_bf16 v[60:63], a[92:95], a[16:19], v[60:63]
  v_mfma_f32_16x16x32_bf16 v[92:95], a[92:95], a[20:23], v[92:95]
  v_mfma_f32_16x16x32_bf16 v[124:127], a[92:95], a[24:27], v[124:127]
  v_mfma_f32_16x16x32_bf16 v[156:159], a[92:95], a[28:31], v[156:159]
  s_waitcnt lgkmcnt(0)
  v_mfma_f32_16x16x32_bf16 v[32:35], a[32:35], a[0:3], v[32:35]
  buffer_load_dwordx4 v7, s[8:11], s26 offen offset:3072 lds
  ds_read_b128 a[16:19], v17 offset:0
  v_mfma_f32_16x16x32_bf16 v[64:67], a[32:35], a[4:7], v[64:67]
  s_add_u32 m0, s88, 4096
  ds_read_b64_tr_b16 a[64:65], v18 offset:4096
  v_mfma_f32_16x16x32_bf16 v[96:99], a[32:35], a[8:11], v[96:99]
  ds_read_b64_tr_b16 a[66:67], v18 offset:6144
  v_mfma_f32_16x16x32_bf16 v[128:131], a[32:35], a[12:15], v[128:131]
  buffer_load_dwordx4 v4, s[8:11], s27 offen offset:0 lds
  ds_read_b128 a[20:23], v17 offset:2048
  v_mfma_f32_16x16x32_bf16 v[36:39], a[36:39], a[0:3], v[36:39]
  ds_read_b128 a[24:27], v17 offset:4096
  v_mfma_f32_16x16x32_bf16 v[68:71], a[36:39], a[4:7], v[68:71]
  ds_read_b128 a[28:31], v17 offset:6144
  v_mfma_f32_16x16x32_bf16 v[100:103], a[36:39], a[8:11], v[100:103]
  ds_read_b64_tr_b16 a[68:69], v19 offset:4096
  v_mfma_f32_16x16x32_bf16 v[132:135], a[36:39], a[12:15], v[132:135]
  buffer_load_dwordx4 v5, s[8:11], s27 offen offset:1024 lds
  ds_read_b64_tr_b16 a[70:71], v19 offset:6144
  v_mfma_f32_16x16x32_bf16 v[40:43], a[40:43], a[0:3], v[40:43]
  ds_read_b64_tr_b16 a[72:73], v20 offset:4096
  v_mfma_f32_16x16x32_bf16 v[72:75], a[40:43], a[4:7], v[72:75]
  ds_read_b64_tr_b16 a[74:75], v20 offset:6144
  v_mfma_f32_16x16x32_bf16 v[104:107], a[40:43], a[8:11], v[104:107]
  buffer_load_dwordx4 v6, s[8:11], s27 offen offset:2048 lds
  v_mfma_f32_16x16x32_bf16 v[136:139], a[40:43], a[12:15], v[136:139]
  ds_read_b64_tr_b16 a[76:77], v21 offset:4096
  v_mfma_f32_16x16x32_bf16 v[44:47], a[44:47], a[0:3], v[44:47]
  ds_read_b64_tr_b16 a[78:79], v21 offset:6144
  v_mfma_f32_16x16x32_bf16 v[76:79], a[44:47], a[4:7], v[76:79]
  ds_read_b64_tr_b16 a[80:81], v18 offset:12288
  v_mfma_f32_16x16x32_bf16 v[108:111], a[44:47], a[8:11], v[108:111]
  buffer_load_dwordx4 v7, s[8:11], s27 offen offset:3072 lds
  ds_read_b64_tr_b16 a[82:83], v18 offset:14336
  v_mfma_f32_16x16x32_bf16 v[140:143], a[44:47], a[12:15], v[140:143]
  s_bfe_u32 s29, 0x302010e, s53
  s_add_u32 s52, s52, s29
  s_add_u32 s53, s53, 8
  v_mfma_f32_16x16x32_bf16 v[48:51], a[48:51], a[0:3], v[48:51]
  s_and_b32 s53, s53, 0x8001f
  s_and_b32 s52, s52, 15
  s_lshl_b32 s29, s52, 7
  v_mfma_f32_16x16x32_bf16 v[80:83], a[48:51], a[4:7], v[80:83]
  s_or_b32 s26, s30, s29
  s_or_b32 s27, s31, s29
  s_add_u32 s60, s63, 32768
  v_mfma_f32_16x16x32_bf16 v[112:115], a[48:51], a[8:11], v[112:115]
  buffer_store_dwordx4 v[200:203], v2, s[16:19], s60 offen offset:2048 sc1
  ds_read_b64_tr_b16 a[84:85], v19 offset:12288
  v_mfma_f32_16x16x32_bf16 v[144:147], a[48:51], a[12:15], v[144:147]
  s_add_u32 s60, s63, 40960
  ds_read_b64_tr_b16 a[86:87], v19 offset:14336
  ds_read_b64_tr_b16 a[88:89], v20 offset:12288
  v_mfma_f32_16x16x32_bf16 v[52:55], a[52:55], a[0:3], v[52:55]
  ds_read_b64_tr_b16 a[90:91], v20 offset:14336
  ds_read_b64_tr_b16 a[92:93], v21 offset:12288
  v_mfma_f32_16x16x32_bf16 v[84:87], a[52:55], a[4:7], v[84:87]
  buffer_store_dwordx4 v[232:235], v2, s[16:19], s60 offen offset:2048 sc1
  ds_read_b64_tr_b16 a[94:95], v21 offset:14336
  v_mfma_f32_16x16x32_bf16 v[116:119], a[52:55], a[8:11], v[116:119]
  s_add_u32 s88, s88, s90
  s_add_u32 s89, s89, 1
  s_cmp_eq_u32 s89, 3
  s_cselect_b32 s89, 0, s89
  s_cselect_b32 s90, s91, s92
  v_mfma_f32_16x16x32_bf16 v[148:151], a[52:55], a[12:15], v[148:151]
  s_add_u32 s68, s68, s70
  s_add_u32 s69, s69, 1
  s_cmp_eq_u32 s69, 3
  s_cselect_b32 s69, 0, s69
  s_cselect_b32 s70, s71, s72
  v_mfma_f32_16x16x32_bf16 v[56:59], a[56:59], a[0:3], v[56:59]
  v_add_u32 v16, s90, v16
  v_add_u32 v17, s90, v17
  v_mfma_f32_16x16x32_bf16 v[88:91], a[56:59], a[4:7], v[88:91]
  v_add_u32 v18, s70, v18
  v_add_u32 v19, s70, v19
  v_mfma_f32_16x16x32_bf16 v[120:123], a[56:59], a[8:11], v[120:123]
  v_add_u32 v20, s70, v20
  v_add_u32 v21, s70, v21
  v_mfma_f32_16x16x32_bf16 v[152:155], a[56:59], a[12:15], v[152:155]
  v_mfma_f32_16x16x32_bf16 v[60:63], a[60:63], a[0:3], v[60:63]
  v_mfma_f32_16x16x32_bf16 v[92:95], a[60:63], a[4:7], v[92:95]
  v_mfma_f32_16x16x32_bf16 v[124:127], a[60:63], a[8:11], v[124:127]
  v_mfma_f32_16x16x32_bf16 v[156:159], a[60:63], a[12:15], v[156:159]
  s_waitcnt vmcnt(16) lgkmcnt(0)
  s_barrier
  v_mfma_f32_16x16x32_bf16 v[32:35], a[64:67], a[16:19], v[32:35]
  s_mov_b32 m0, s68
  ds_read_b128 a[0:3], v16 offset:0
  v_mfma_f32_16x16x32_bf16 v[64:67], a[64:67], a[20:23], v[64:67]
  buffer_load_dwordx4 v8, s[20:23], s28 offen offset:0 lds
  ds_read_b64_tr_b16 a[32:33], v18 offset:0
  v_mfma_f32_16x16x32_bf16 v[96:99], a[64:67], a[24:27], v[96:99]
  ds_read_b64_tr_b16 a[34:35], v18 offset:2048
  v_mfma_f32_16x16x32_bf16 v[128:131], a[64:67], a[28:31], v[128:131]
  ds_read_b128 a[4:7], v16 offset:2048
  v_mfma_f32_16x16x32_bf16 v[36:39], a[68:71], a[16:19], v[36:39]
  buffer_load_dwordx4 v9, s[20:23], s28 offen offset:1024 lds
  ds_read_b128 a[8:11], v16 offset:4096
  v_mfma_f32_16x16x32_bf16 v[68:71], a[68:71], a[20:23], v[68:71]
  ds_read_b128 a[12:15], v16 offset:6144
  v_mfma_f32_16x16x32_bf16 v[100:103], a[68:71], a[24:27], v[100:103]
  ds_read_b64_tr_b16 a[36:37], v19 offset:0
  v_mfma_f32_16x16x32_bf16 v[132:135], a[68:71], a[28:31], v[132:135]
  ds_read_b64_tr_b16 a[38:39], v19 offset:2048
  v_mfma_f32_16x16x32_bf16 v[40:43], a[72:75], a[16:19], v[40:43]
  buffer_load_dwordx4 v10, s[20:23], s28 offen offset:2048 lds
  ds_read_b64_tr_b16 a[40:41], v20 offset:0
  v_mfma_f32_16x16x32_bf16 v[72:75], a[72:75], a[20:23], v[72:75]
  ds_read_b64_tr_b16 a[42:43], v20 offset:2048
  v_mfma_f32_16x16x32_bf16 v[104:107], a[72:75], a[24:27], v[104:107]
  v_mfma_f32_16x16x32_bf16 v[136:139], a[72:75], a[28:31], v[136:139]
  ds_read_b64_tr_b16 a[44:45], v21 offset:0
  v_mfma_f32_16x16x32_bf16 v[44:47], a[76:79], a[16:19], v[44:47]
  ds_read_b64_tr_b16 a[46:47], v21 offset:2048
  v_mfma_f32_16x16x32_bf16 v[76:79], a[76:79], a[20:23], v[76:79]
  buffer_load_dwordx4 v11, s[20:23], s28 offen offset:3072 lds
  ds_read_b64_tr_b16 a[48:49], v18 offset:8192
  v_mfma_f32_16x16x32_bf16 v[108:111], a[76:79], a[24:27], v[108:111]
  s_bfe_u32 s56, 0x302010e, s55
  s_add_u32 s54, s54, s56
  s_add_u32 s55, s55, 8
  v_mfma_f32_16x16x32_bf16 v[140:143], a[76:79], a[28:31], v[140:143]
  s_and_b32 s55, s55, 0x8001f
  s_and_b32 s54, s54, 15
  s_lshl_b32 s28, s54, 19
  v_mfma_f32_16x16x32_bf16 v[48:51], a[80:83], a[16:19], v[48:51]
  s_mov_b32 m0, s88
  ds_read_b64_tr_b16 a[50:51], v18 offset:10240
  ds_read_b64_tr_b16 a[52:53], v19 offset:8192
  v_mfma_f32_16x16x32_bf16 v[80:83], a[80:83], a[20:23], v[80:83]
  buffer_load_dwordx4 v4, s[8:11], s26 offen offset:0 lds
  ds_read_b64_tr_b16 a[54:55], v19 offset:10240
  v_mfma_f32_16x16x32_bf16 v[112:115], a[80:83], a[24:27], v[112:115]
  ds_read_b64_tr_b16 a[56:57], v20 offset:8192
  ds_read_b64_tr_b16 a[58:59], v20 offset:10240
  v_mfma_f32_16x16x32_bf16 v[144:147], a[80:83], a[28:31], v[144:147]
  ds_read_b64_tr_b16 a[60:61], v21 offset:8192
  v_mfma_f32_16x16x32_bf16 v[52:55], a[84:87], a[16:19], v[52:55]
  ds_read_b64_tr_b16 a[62:63], v21 offset:10240
  v_mfma_f32_16x16x32_bf16 v[84:87], a[84:87], a[20:23], v[84:87]
  v_mfma_f32_16x16x32_bf16 v[116:119], a[84:87], a[24:27], v[116:119]
  buffer_load_dwordx4 v5, s[8:11], s26 offen offset:1024 lds
  v_mfma_f32_16x16x32_bf16 v[148:151], a[84:87], a[28:31], v[148:151]
  v_mfma_f32_16x16x32_bf16 v[56:59], a[88:91], a[16:19], v[56:59]
  v_mfma_f32_16x16x32_bf16 v[88:91], a[88:91], a[20:23], v[88:91]
  v_mfma_f32_16x16x32_bf16 v[120:123], a[88:91], a[24:27], v[120:123]
  buffer_load_dwordx4 v6, s[8:11], s26 offen offset:2048 lds
  v_mfma_f32_16x16x32_bf16 v[152:155], a[88:91], a[28:31], v[152:155]
  v_mfma_f32_16x16x32_bf16 v[60:63], a[92:95], a[16:19], v[60:63]
  v_mfma_f32_16x16x32_bf16 v[92:95], a[92:95], a[20:23], v[92:95]
  v_mfma_f32_16x16x32_bf16 v[124:127], a[92:95], a[24:27], v[124:127]
  v_mfma_f32_16x16x32_bf16 v[156:159], a[92:95], a[28:31], v[156:159]
  s_waitcnt lgkmcnt(0)
  v_mfma_f32_16x16x32_bf16 v[32:35], a[32:35], a[0:3], v[32:35]
  buffer_load_dwordx4 v7, s[8:11], s26 offen offset:3072 lds
  ds_read_b128 a[16:19], v17 offset:0
  v_mfma_f32_16x16x32_bf16 v[64:67], a[32:35], a[4:7], v[64:67]
  s_add_u32 m0, s88, 4096
  ds_read_b64_tr_b16 a[64:65], v18 offset:4096
  v_mfma_f32_16x16x32_bf16 v[96:99], a[32:35], a[8:11], v[96:99]
  ds_read_b64_tr_b16 a[66:67], v18 offset:6144
  v_mfma_f32_16x16x32_bf16 v[128:131], a[32:35], a[12:15], v[128:131]
  buffer_load_dwordx4 v4, s[8:11], s27 offen offset:0 lds
  ds_read_b128 a[20:23], v17 offset:2048
  v_mfma_f32_16x16x32_bf16 v[36:39], a[36:39], a[0:3], v[36:39]
  ds_read_b128 a[24:27], v17 offset:4096
  v_mfma_f32_16x16x32_bf16 v[68:71], a[36:39], a[4:7], v[68:71]
  ds_read_b128 a[28:31], v17 offset:6144
  v_mfma_f32_16x16x32_bf16 v[100:103], a[36:39], a[8:11], v[100:103]
  ds_read_b64_tr_b16 a[68:69], v19 offset:4096
  v_mfma_f32_16x16x32_bf16 v[132:135], a[36:39], a[12:15], v[132:135]
  buffer_load_dwordx4 v5, s[8:11], s27 offen offset:1024 lds
  ds_read_b64_tr_b16 a[70:71], v19 offset:6144
  v_mfma_f32_16x16x32_bf16 v[40:43], a[40:43], a[0:3], v[40:43]
  ds_read_b64_tr_b16 a[72:73], v20 offset:4096
  v_mfma_f32_16x16x32_bf16 v[72:75], a[40:43], a[4:7], v[72:75]
  ds_read_b64_tr_b16 a[74:75], v20 offset:6144
  v_mfma_f32_16x16x32_bf16 v[104:107], a[40:43], a[8:11], v[104:107]
  buffer_load_dwordx4 v6, s[8:11], s27 offen offset:2048 lds
  v_mfma_f32_16x16x32_bf16 v[136:139], a[40:43], a[12:15], v[136:139]
  ds_read_b64_tr_b16 a[76:77], v21 offset:4096
  v_mfma_f32_16x16x32_bf16 v[44:47], a[44:47], a[0:3], v[44:47]
  ds_read_b64_tr_b16 a[78:79], v21 offset:6144
  v_mfma_f32_16x16x32_bf16 v[76:79], a[44:47], a[4:7], v[76:79]
  ds_read_b64_tr_b16 a[80:81], v18 offset:12288
  v_mfma_f32_16x16x32_bf16 v[108:111], a[44:47], a[8:11], v[108:111]
  buffer_load_dwordx4 v7, s[8:11], s27 offen offset:3072 lds
  ds_read_b64_tr_b16 a[82:83], v18 offset:14336
  v_mfma_f32_16x16x32_bf16 v[140:143], a[44:47], a[12:15], v[140:143]
  s_bfe_u32 s29, 0x302010e, s53
  s_add_u32 s52, s52, s29
  s_add_u32 s53, s53, 8
  v_mfma_f32_16x16x32_bf16 v[48:51], a[48:51], a[0:3], v[48:51]
  s_and_b32 s53, s53, 0x8001f
  s_and_b32 s52, s52, 15
  s_lshl_b32 s29, s52, 7
  v_mfma_f32_16x16x32_bf16 v[80:83], a[48:51], a[4:7], v[80:83]
  s_or_b32 s26, s30, s29
  s_or_b32 s27, s31, s29
  s_add_u32 s60, s63, 32768
  v_mfma_f32_16x16x32_bf16 v[112:115], a[48:51], a[8:11], v[112:115]
  buffer_store_dwordx4 v[204:207], v2, s[16:19], s60 offen offset:3072 sc1
  ds_read_b64_tr_b16 a[84:85], v19 offset:12288
  v_mfma_f32_16x16x32_bf16 v[144:147], a[48:51], a[12:15], v[144:147]
  s_add_u32 s60, s63, 40960
  ds_read_b64_tr_b16 a[86:87], v19 offset:14336
  ds_read_b64_tr_b16 a[88:89], v20 offset:12288
  v_mfma_f32_16x16x32_bf16 v[52:55], a[52:55], a[0:3], v[52:55]
  ds_read_b64_tr_b16 a[90:91], v20 offset:14336
  ds_read_b64_tr_b16 a[92:93], v21 offset:12288
  v_mfma_f32_16x16x32_bf16 v[84:87], a[52:55], a[4:7], v[84:87]
  buffer_store_dwordx4 v[236:239], v2, s[16:19], s60 offen offset:3072 sc1
  ds_read_b64_tr_b16 a[94:95], v21 offset:14336
  v_mfma_f32_16x16x32_bf16 v[116:119], a[52:55], a[8:11], v[116:119]
  s_add_u32 s88, s88, s90
  s_add_u32 s89, s89, 1
  s_cmp_eq_u32 s89, 3
  s_cselect_b32 s89, 0, s89
  s_cselect_b32 s90, s91, s92
  v_mfma_f32_16x16x32_bf16 v[148:151], a[52:55], a[12:15], v[148:151]
  s_add_u32 s68, s68, s70
  s_add_u32 s69, s69, 1
  s_cmp_eq_u32 s69, 3
  s_cselect_b32 s69, 0, s69
  s_cselect_b32 s70, s71, s72
  v_mfma_f32_16x16x32_bf16 v[56:59], a[56:59], a[0:3], v[56:59]
  v_add_u32 v16, s90, v16
  v_add_u32 v17, s90, v17
  v_mfma_f32_16x16x32_bf16 v[88:91], a[56:59], a[4:7], v[88:91]
  v_add_u32 v18, s70, v18
  v_add_u32 v19, s70, v19
  v_mfma_f32_16x16x32_bf16 v[120:123], a[56:59], a[8:11], v[120:123]
  v_add_u32 v20, s70, v20
  v_add_u32 v21, s70, v21
  v_mfma_f32_16x16x32_bf16 v[152:155], a[56:59], a[12:15], v[152:155]
  v_mfma_f32_16x16x32_bf16 v[60:63], a[60:63], a[0:3], v[60:63]
  v_mfma_f32_16x16x32_bf16 v[92:95], a[60:63], a[4:7], v[92:95]
  v_mfma_f32_16x16x32_bf16 v[124:127], a[60:63], a[8:11], v[124:127]
  v_mfma_f32_16x16x32_bf16 v[156:159], a[60:63], a[12:15], v[156:159]
  s_waitcnt vmcnt(16) lgkmcnt(0)
  s_barrier
  v_mfma_f32_16x16x32_bf16 v[32:35], a[64:67], a[16:19], v[32:35]
  s_mov_b32 m0, s68
  ds_read_b128 a[0:3], v16 offset:0
  v_mfma_f32_16x16x32_bf16 v[64:67], a[64:67], a[20:23], v[64:67]
  buffer_load_dwordx4 v8, s[20:23], s28 offen offset:0 lds
  ds_read_b64_tr_b16 a[32:33], v18 offset:0
  v_mfma_f32_16x16x32_bf16 v[96:99], a[64:67], a[24:27], v[96:99]
  ds_read_b64_tr_b16 a[34:35], v18 offset:2048
  v_mfma_f32_16x16x32_bf16 v[128:131], a[64:67], a[28:31], v[128:131]
  buffer_load_dwordx4 v9, s[20:23], s28 offen offset:1024 lds
  ds_read_b128 a[4:7], v16 offset:2048
  v_mfma_f32_16x16x32_bf16 v[36:39], a[68:71], a[16:19], v[36:39]
  ds_read_b128 a[8:11], v16 offset:4096
  v_mfma_f32_16x16x32_bf16 v[68:71], a[68:71], a[20:23], v[68:71]
  ds_read_b128 a[12:15], v16 offset:6144
  v_mfma_f32_16x16x32_bf16 v[100:103], a[68:71], a[24:27], v[100:103]
  ds_read_b64_tr_b16 a[36:37], v19 offset:0
  v_mfma_f32_16x16x32_bf16 v[132:135], a[68:71], a[28:31], v[132:135]
  buffer_load_dwordx4 v10, s[20:23], s28 offen offset:2048 lds
  ds_read_b64_tr_b16 a[38:39], v19 offset:2048
  v_mfma_f32_16x16x32_bf16 v[40:43], a[72:75], a[16:19], v[40:43]
  ds_read_b64_tr_b16 a[40:41], v20 offset:0
  v_mfma_f32_16x16x32_bf16 v[72:75], a[72:75], a[20:23], v[72:75]
  ds_read_b64_tr_b16 a[42:43], v20 offset:2048
  v_mfma_f32_16x16x32_bf16 v[104:107], a[72:75], a[24:27], v[104:107]
  v_mfma_f32_16x16x32_bf16 v[136:139], a[72:75], a[28:31], v[136:139]
  buffer_load_dwordx4 v11, s[20:23], s28 offen offset:3072 lds
  ds_read_b64_tr_b16 a[44:45], v21 offset:0
  v_mfma_f32_16x16x32_bf16 v[44:47], a[76:79], a[16:19], v[44:47]
  s_bfe_u32 s56, 0x302010e, s55
  s_add_u32 s54, s54, s56
  s_add_u32 s55, s55, 8
  v_mfma_f32_16x16x32_bf16 v[76:79], a[76:79], a[20:23], v[76:79]
  s_and_b32 s55, s55, 0x8001f
  s_and_b32 s54, s54, 15
  s_lshl_b32 s28, s54, 19
  v_mfma_f32_16x16x32_bf16 v[108:111], a[76:79], a[24:27], v[108:111]
  s_mov_b32 m0, s88
  ds_read_b64_tr_b16 a[46:47], v21 offset:2048
  ds_read_b64_tr_b16 a[48:49], v18 offset:8192
  v_mfma_f32_16x16x32_bf16 v[140:143], a[76:79], a[28:31], v[140:143]
  buffer_load_dwordx4 v4, s[8:11], s26 offen offset:0 lds
  ds_read_b64_tr_b16 a[50:51], v18 offset:10240
  v_mfma_f32_16x16x32_bf16 v[48:51], a[80:83], a[16:19], v[48:51]
  ds_read_b64_tr_b16 a[52:53], v19 offset:8192
  ds_read_b64_tr_b16 a[54:55], v19 offset:10240
  v_mfma_f32_16x16x32_bf16 v[80:83], a[80:83], a[20:23], v[80:83]
  ds_read_b64_tr_b16 a[56:57], v20 offset:8192
  v_mfma_f32_16x16x32_bf16 v[112:115], a[80:83], a[24:27], v[112:115]
  ds_read_b64_tr_b16 a[58:59], v20 offset:10240
  v_mfma_f32_16x16x32_bf16 v[144:147], a[80:83], a[28:31], v[144:147]
  buffer_load_dwordx4 v5, s[8:11], s26 offen offset:1024 lds
  ds_read_b64_tr_b16 a[60:61], v21 offset:8192
  v_mfma_f32_16x16x32_bf16 v[52:55], a[84:87], a[16:19], v[52:55]
  ds_read_b64_tr_b16 a[62:63], v21 offset:10240
  v_mfma_f32_16x16x32_bf16 v[84:87], a[84:87], a[20:23], v[84:87]
  v_mfma_f32_16x16x32_bf16 v[116:119], a[84:87], a[24:27], v[116:119]
  v_mfma_f32_16x16x32_bf16 v[148:151], a[84:87], a[28:31], v[148:151]
  buffer_load_dwordx4 v6, s[8:11], s26 offen offset:2048 lds
  v_mfma_f32_16x16x32_bf16 v[56:59], a[88:91], a[16:19], v[56:59]
  v_mfma_f32_16x16x32_bf16 v[88:91], a[88:91], a[20:23], v[88:91]
  v_mfma_f32_16x16x32_bf16 v[120:123], a[88:91], a[24:27], v[120:123]
  v_mfma_f32_16x16x32_bf16 v[152:155], a[88:91], a[28:31], v[152:155]
  buffer_load_dwordx4 v7, s[8:11], s26 offen offset:3072 lds
  v_mfma_f32_16x16x32_bf16 v[60:63], a[92:95], a[16:19], v[60:63]
  v_mfma_f32_16x16x32_bf16 v[92:95], a[92:95], a[20:23], v[92:95]
  v_mfma_f32_16x16x32_bf16 v[124:127], a[92:95], a[24:27], v[124:127]
  v_mfma_f32_16x16x32_bf16 v[156:159], a[92:95], a[28:31], v[156:159]
  s_waitcnt lgkmcnt(0)
  v_mfma_f32_16x16x32_bf16 v[32:35], a[32:35], a[0:3], v[32:35]
  s_add_u32 m0, s88, 4096
  ds_read_b128 a[16:19], v17 offset:0
  v_mfma_f32_16x16x32_bf16 v[64:67], a[32:35], a[4:7], v[64:67]
  buffer_load_dwordx4 v4, s[8:11], s27 offen offset:0 lds
  ds_read_b64_tr_b16 a[64:65], v18 offset:4096
  v_mfma_f32_16x16x32_bf16 v[96:99], a[32:35], a[8:11], v[96:99]
  ds_read_b64_tr_b16 a[66:67], v18 offset:6144
  v_mfma_f32_16x16x32_bf16 v[128:131], a[32:35], a[12:15], v[128:131]
  buffer_load_dwordx4 v5, s[8:11], s27 offen offset:1024 lds
  ds_read_b128 a[20:23], v17 offset:2048
  v_mfma_f32_16x16x32_bf16 v[36:39], a[36:39], a[0:3], v[36:39]
  ds_read_b128 a[24:27], v17 offset:4096
  v_mfma_f32_16x16x32_bf16 v[68:71], a[36:39], a[4:7], v[68:71]
  ds_read_b128 a[28:31], v17 offset:6144
  v_mfma_f32_16x16x32_bf16 v[100:103], a[36:39], a[8:11], v[100:103]
  ds_read_b64_tr_b16 a[68:69], v19 offset:4096
  v_mfma_f32_16x16x32_bf16 v[132:135], a[36:39], a[12:15], v[132:135]
  buffer_load_dwordx4 v6, s[8:11], s27 offen offset:2048 lds
  ds_read_b64_tr_b16 a[70:71], v19 offset:6144
  v_mfma_f32_16x16x32_bf16 v[40:43], a[40:43], a[0:3], v[40:43]
  ds_read_b64_tr_b16 a[72:73], v20 offset:4096
  v_mfma_f32_16x16x32_bf16 v[72:75], a[40:43], a[4:7], v[72:75]
  ds_read_b64_tr_b16 a[74:75], v20 offset:6144
  v_mfma_f32_16x16x32_bf16 v[104:107], a[40:43], a[8:11], v[104:107]
  buffer_load_dwordx4 v7, s[8:11], s27 offen offset:3072 lds
  v_mfma_f32_16x16x32_bf16 v[136:139], a[40:43], a[12:15], v[136:139]
  s_bfe_u32 s29, 0x302010e, s53
  s_add_u32 s52, s52, s29
  s_add_u32 s53, s53, 8
  v_mfma_f32_16x16x32_bf16 v[44:47], a[44:47], a[0:3], v[44:47]
  s_and_b32 s53, s53, 0x8001f
  s_and_b32 s52, s52, 15
  s_lshl_b32 s29, s52, 7
  v_mfma_f32_16x16x32_bf16 v[76:79], a[44:47], a[4:7], v[76:79]
  s_or_b32 s26, s30, s29
  s_or_b32 s27, s31, s29
  s_add_u32 s60, s63, 36864
  v_mfma_f32_16x16x32_bf16 v[108:111], a[44:47], a[8:11], v[108:111]
  buffer_store_dwordx4 v[208:211], v2, s[16:19], s60 offen offset:0 sc1
  ds_read_b64_tr_b16 a[76:77], v21 offset:4096
  v_mfma_f32_16x16x32_bf16 v[140:143], a[44:47], a[12:15], v[140:143]
  s_add_u32 s60, s63, 45056
  ds_read_b64_tr_b16 a[78:79], v21 offset:6144
  ds_read_b64_tr_b16 a[80:81], v18 offset:12288
  v_mfma_f32_16x16x32_bf16 v[48:51], a[48:51], a[0:3], v[48:51]
  ds_read_b64_tr_b16 a[82:83], v18 offset:14336
  ds_read_b64_tr_b16 a[84:85], v19 offset:12288
  v_mfma_f32_16x16x32_bf16 v[80:83], a[48:51], a[4:7], v[80:83]
  buffer_store_dwordx4 v[240:243], v2, s[16:19], s60 offen offset:0 sc1
  ds_read_b64_tr_b16 a[86:87], v19 offset:14336
  v_mfma_f32_16x16x32_bf16 v[112:115], a[48:51], a[8:11], v[112:115]
  s_add_u32 s60, s63, 36864
  ds_read_b64_tr_b16 a[88:89], v20 offset:12288
  ds_read_b64_tr_b16 a[90:91], v20 offset:14336
  v_mfma_f32_16x16x32_bf16 v[144:147], a[48:51], a[12:15], v[144:147]
  ds_read_b64_tr_b16 a[92:93], v21 offset:12288
  v_mfma_f32_16x16x32_bf16 v[52:55], a[52:55], a[0:3], v[52:55]
  ds_read_b64_tr_b16 a[94:95], v21 offset:14336
  v_mfma_f32_16x16x32_bf16 v[84:87], a[52:55], a[4:7], v[84:87]
  buffer_store_dwordx4 v[212:215], v2, s[16:19], s60 offen offset:1024 sc1
  v_mfma_f32_16x16x32_bf16 v[116:119], a[52:55], a[8:11], v[116:119]
  s_add_u32 s88, s88, s90
  s_add_u32 s89, s89, 1
  s_cmp_eq_u32 s89, 3
  s_cselect_b32 s89, 0, s89
  s_cselect_b32 s90, s91, s92
  v_mfma_f32_16x16x32_bf16 v[148:151], a[52:55], a[12:15], v[148:151]
  s_add_u32 s68, s68, s70
  s_add_u32 s69, s69, 1
  s_cmp_eq_u32 s69, 3
  s_cselect_b32 s69, 0, s69
  s_cselect_b32 s70, s71, s72
  v_mfma_f32_16x16x32_bf16 v[56:59], a[56:59], a[0:3], v[56:59]
  v_add_u32 v16, s90, v16
  v_add_u32 v17, s90, v17
  v_mfma_f32_16x16x32_bf16 v[88:91], a[56:59], a[4:7], v[88:91]
  v_add_u32 v18, s70, v18
  v_add_u32 v19, s70, v19
  v_mfma_f32_16x16x32_bf16 v[120:123], a[56:59], a[8:11], v[120:123]
  v_add_u32 v20, s70, v20
  v_add_u32 v21, s70, v21
  v_mfma_f32_16x16x32_bf16 v[152:155], a[56:59], a[12:15], v[152:155]
  v_mfma_f32_16x16x32_bf16 v[60:63], a[60:63], a[0:3], v[60:63]
  v_mfma_f32_16x16x32_bf16 v[92:95], a[60:63], a[4:7], v[92:95]
  v_mfma_f32_16x16x32_bf16 v[124:127], a[60:63], a[8:11], v[124:127]
  v_mfma_f32_16x16x32_bf16 v[156:159], a[60:63], a[12:15], v[156:159]
  s_waitcnt vmcnt(17) lgkmcnt(0)
  s_barrier
  v_mfma_f32_16x16x32_bf16 v[32:35], a[64:67], a[16:19], v[32:35]
  s_mov_b32 m0, s68
  ds_read_b128 a[0:3], v16 offset:0
  v_mfma_f32_16x16x32_bf16 v[64:67], a[64:67], a[20:23], v[64:67]
  buffer_load_dwordx4 v8, s[20:23], s28 offen offset:0 lds
  ds_read_b64_tr_b16 a[32:33], v18 offset:0
  v_mfma_f32_16x16x32_bf16 v[96:99], a[64:67], a[24:27], v[96:99]
  ds_read_b64_tr_b16 a[34:35], v18 offset:2048
  v_mfma_f32_16x16x32_bf16 v[128:131], a[64:67], a[28:31], v[128:131]
  buffer_load_dwordx4 v9, s[20:23], s28 offen offset:1024 lds
  ds_read_b128 a[4:7], v16 offset:2048
  v_mfma_f32_16x16x32_bf16 v[36:39], a[68:71], a[16:19], v[36:39]
  ds_read_b128 a[8:11], v16 offset:4096
  v_mfma_f32_16x16x32_bf16 v[68:71], a[68:71], a[20:23], v[68:71]
  ds_read_b128 a[12:15], v16 offset:6144
  v_mfma_f32_16x16x32_bf16 v[100:103], a[68:71], a[24:27], v[100:103]
  ds_read_b64_tr_b16 a[36:37], v19 offset:0
  v_mfma_f32_16x16x32_bf16 v[132:135], a[68:71], a[28:31], v[132:135]
  buffer_load_dwordx4 v10, s[20:23], s28 offen offset:2048 lds
  ds_read_b64_tr_b16 a[38:39], v19 offset:2048
  v_mfma_f32_16x16x32_bf16 v[40:43], a[72:75], a[16:19], v[40:43]
  ds_read_b64_tr_b16 a[40:41], v20 offset:0
  v_mfma_f32_16x16x32_bf16 v[72:75], a[72:75], a[20:23], v[72:75]
  ds_read_b64_tr_b16 a[42:43], v20 offset:2048
  v_mfma_f32_16x16x32_bf16 v[104:107], a[72:75], a[24:27], v[104:107]
  v_mfma_f32_16x16x32_bf16 v[136:139], a[72:75], a[28:31], v[136:139]
  buffer_load_dwordx4 v11, s[20:23], s28 offen offset:3072 lds
  ds_read_b64_tr_b16 a[44:45], v21 offset:0
  v_mfma_f32_16x16x32_bf16 v[44:47], a[76:79], a[16:19], v[44:47]
  s_bfe_u32 s56, 0x302010e, s55
  s_add_u32 s54, s54, s56
  s_add_u32 s55, s55, 8
  v_mfma_f32_16x16x32_bf16 v[76:79], a[76:79], a[20:23], v[76:79]
  s_and_b32 s55, s55, 0x8001f
  s_and_b32 s54, s54, 15
  s_lshl_b32 s28, s54, 19
  v_mfma_f32_16x16x32_bf16 v[108:111], a[76:79], a[24:27], v[108:111]
  s_mov_b32 m0, s88
  ds_read_b64_tr_b16 a[46:47], v21 offset:2048
  ds_read_b64_tr_b16 a[48:49], v18 offset:8192
  v_mfma_f32_16x16x32_bf16 v[140:143], a[76:79], a[28:31], v[140:143]
  buffer_load_dwordx4 v4, s[8:11], s26 offen offset:0 lds
  ds_read_b64_tr_b16 a[50:51], v18 offset:10240
  v_mfma_f32_16x16x32_bf16 v[48:51], a[80:83], a[16:19], v[48:51]
  ds_read_b64_tr_b16 a[52:53], v19 offset:8192
  ds_read_b64_tr_b16 a[54:55], v19 offset:10240
  v_mfma_f32_16x16x32_bf16 v[80:83], a[80:83], a[20:23], v[80:83]
  ds_read_b64_tr_b16 a[56:57], v20 offset:8192
  v_mfma_f32_16x16x32_bf16 v[112:115], a[80:83], a[24:27], v[112:115]
  ds_read_b64_tr_b16 a[58:59], v20 offset:10240
  v_mfma_f32_16x16x32_bf16 v[144:147], a[80:83], a[28:31], v[144:147]
  buffer_load_dwordx4 v5, s[8:11], s26 offen offset:1024 lds
  ds_read_b64_tr_b16 a[60:61], v21 offset:8192
  v_mfma_f32_16x16x32_bf16 v[52:55], a[84:87], a[16:19], v[52:55]
  ds_read_b64_tr_b16 a[62:63], v21 offset:10240
  v_mfma_f32_16x16x32_bf16 v[84:87], a[84:87], a[20:23], v[84:87]
  v_mfma_f32_16x16x32_bf16 v[116:119], a[84:87], a[24:27], v[116:119]
  v_mfma_f32_16x16x32_bf16 v[148:151], a[84:87], a[28:31], v[148:151]
  buffer_load_dwordx4 v6, s[8:11], s26 offen offset:2048 lds
  v_mfma_f32_16x16x32_bf16 v[56:59], a[88:91], a[16:19], v[56:59]
  v_mfma_f32_16x16x32_bf16 v[88:91], a[88:91], a[20:23], v[88:91]
  v_mfma_f32_16x16x32_bf16 v[120:123], a[88:91], a[24:27], v[120:123]
  v_mfma_f32_16x16x32_bf16 v[152:155], a[88:91], a[28:31], v[152:155]
  buffer_load_dwordx4 v7, s[8:11], s26 offen offset:3072 lds
  v_mfma_f32_16x16x32_bf16 v[60:63], a[92:95], a[16:19], v[60:63]
  v_mfma_f32_16x16x32_bf16 v[92:95], a[92:95], a[20:23], v[92:95]
  v_mfma_f32_16x16x32_bf16 v[124:127], a[92:95], a[24:27], v[124:127]
  v_mfma_f32_16x16x32_bf16 v[156:159], a[92:95], a[28:31], v[156:159]
  s_waitcnt lgkmcnt(0)
  v_mfma_f32_16x16x32_bf16 v[32:35], a[32:35], a[0:3], v[32:35]
  s_add_u32 m0, s88, 4096
  ds_read_b128 a[16:19], v17 offset:0
  v_mfma_f32_16x16x32_bf16 v[64:67], a[32:35], a[4:7], v[64:67]
  buffer_load_dwordx4 v4, s[8:11], s27 offen offset:0 lds
  ds_read_b64_tr_b16 a[64:65], v18 offset:4096
  v_mfma_f32_16x16x32_bf16 v[96:99], a[32:35], a[8:11], v[96:99]
  ds_read_b64_tr_b16 a[66:67], v18 offset:6144
  v_mfma_f32_16x16x32_bf16 v[128:131], a[32:35], a[12:15], v[128:131]
  buffer_load_dwordx4 v5, s[8:11], s27 offen offset:1024 lds
  ds_read_b128 a[20:23], v17 offset:2048
  v_mfma_f32_16x16x32_bf16 v[36:39], a[36:39], a[0:3], v[36:39]
  ds_read_b128 a[24:27], v17 offset:4096
  v_mfma_f32_16x16x32_bf16 v[68:71], a[36:39], a[4:7], v[68:71]
  ds_read_b128 a[28:31], v17 offset:6144
  v_mfma_f32_16x16x32_bf16 v[100:103], a[36:39], a[8:11], v[100:103]
  ds_read_b64_tr_b16 a[68:69], v19 offset:4096
  v_mfma_f32_16x16x32_bf16 v[132:135], a[36:39], a[12:15], v[132:135]
  buffer_load_dwordx4 v6, s[8:11], s27 offen offset:2048 lds
  ds_read_b64_tr_b16 a[70:71], v19 offset:6144
  v_mfma_f32_16x16x32_bf16 v[40:43], a[40:43], a[0:3], v[40:43]
  ds_read_b64_tr_b16 a[72:73], v20 offset:4096
  v_mfma_f32_16x16x32_bf16 v[72:75], a[40:43], a[4:7], v[72:75]
  ds_read_b64_tr_b16 a[74:75], v20 offset:6144
  v_mfma_f32_16x16x32_bf16 v[104:107], a[40:43], a[8:11], v[104:107]
  buffer_load_dwordx4 v7, s[8:11], s27 offen offset:3072 lds
  v_mfma_f32_16x16x32_bf16 v[136:139], a[40:43], a[12:15], v[136:139]
  s_bfe_u32 s29, 0x302010e, s53
  s_add_u32 s52, s52, s29
  s_add_u32 s53, s53, 8
  v_mfma_f32_16x16x32_bf16 v[44:47], a[44:47], a[0:3], v[44:47]
  s_and_b32 s53, s53, 0x8001f
  s_and_b32 s52, s52, 15
  s_lshl_b32 s29, s52, 7
  v_mfma_f32_16x16x32_bf16 v[76:79], a[44:47], a[4:7], v[76:79]
  s_or_b32 s26, s30, s29
  s_or_b32 s27, s31, s29
  s_add_u32 s60, s63, 45056
  v_mfma_f32_16x16x32_bf16 v[108:111], a[44:47], a[8:11], v[108:111]
  buffer_store_dwordx4 v[244:247], v2, s[16:19], s60 offen offset:1024 sc1
  ds_read_b64_tr_b16 a[76:77], v21 offset:4096
  v_mfma_f32_16x16x32_bf16 v[140:143], a[44:47], a[12:15], v[140:143]
  s_add_u32 s60, s63, 36864
  ds_read_b64_tr_b16 a[78:79], v21 offset:6144
  ds_read_b64_tr_b16 a[80:81], v18 offset:12288
  v_mfma_f32_16x16x32_bf16 v[48:51], a[48:51], a[0:3], v[48:51]
  ds_read_b64_tr_b16 a[82:83], v18 offset:14336
  ds_read_b64_tr_b16 a[84:85], v19 offset:12288
  v_mfma_f32_16x16x32_bf16 v[80:83], a[48:51], a[4:7], v[80:83]
  buffer_store_dwordx4 v[216:219], v2, s[16:19], s60 offen offset:2048 sc1
  ds_read_b64_tr_b16 a[86:87], v19 offset:14336
  v_mfma_f32_16x16x32_bf16 v[112:115], a[48:51], a[8:11], v[112:115]
  s_add_u32 s60, s63, 45056
  ds_read_b64_tr_b16 a[88:89], v20 offset:12288
  ds_read_b64_tr_b16 a[90:91], v20 offset:14336
  v_mfma_f32_16x16x32_bf16 v[144:147], a[48:51], a[12:15], v[144:147]
  ds_read_b64_tr_b16 a[92:93], v21 offset:12288
  v_mfma_f32_16x16x32_bf16 v[52:55], a[52:55], a[0:3], v[52:55]
  ds_read_b64_tr_b16 a[94:95], v21 offset:14336
  v_mfma_f32_16x16x32_bf16 v[84:87], a[52:55], a[4:7], v[84:87]
  buffer_store_dwordx4 v[248:251], v2, s[16:19], s60 offen offset:2048 sc1
  v_mfma_f32_16x16x32_bf16 v[116:119], a[52:55], a[8:11], v[116:119]
  s_add_u32 s88, s88, s90
  s_add_u32 s89, s89, 1
  s_cmp_eq_u32 s89, 3
  s_cselect_b32 s89, 0, s89
  s_cselect_b32 s90, s91, s92
  v_mfma_f32_16x16x32_bf16 v[148:151], a[52:55], a[12:15], v[148:151]
  s_add_u32 s68, s68, s70
  s_add_u32 s69, s69, 1
  s_cmp_eq_u32 s69, 3
  s_cselect_b32 s69, 0, s69
  s_cselect_b32 s70, s71, s72
  v_mfma_f32_16x16x32_bf16 v[56:59], a[56:59], a[0:3], v[56:59]
  v_add_u32 v16, s90, v16
  v_add_u32 v17, s90, v17
  v_mfma_f32_16x16x32_bf16 v[88:91], a[56:59], a[4:7], v[88:91]
  v_add_u32 v18, s70, v18
  v_add_u32 v19, s70, v19
  v_mfma_f32_16x16x32_bf16 v[120:123], a[56:59], a[8:11], v[120:123]
  v_add_u32 v20, s70, v20
  v_add_u32 v21, s70, v21
  v_mfma_f32_16x16x32_bf16 v[152:155], a[56:59], a[12:15], v[152:155]
  v_mfma_f32_16x16x32_bf16 v[60:63], a[60:63], a[0:3], v[60:63]
  v_mfma_f32_16x16x32_bf16 v[92:95], a[60:63], a[4:7], v[92:95]
  v_mfma_f32_16x16x32_bf16 v[124:127], a[60:63], a[8:11], v[124:127]
  v_mfma_f32_16x16x32_bf16 v[156:159], a[60:63], a[12:15], v[156:159]
  s_waitcnt vmcnt(18) lgkmcnt(0)
  s_barrier
  v_mfma_f32_16x16x32_bf16 v[32:35], a[64:67], a[16:19], v[32:35]
  s_mov_b32 m0, s68
  ds_read_b128 a[0:3], v16 offset:0
  v_mfma_f32_16x16x32_bf16 v[64:67], a[64:67], a[20:23], v[64:67]
  buffer_load_dwordx4 v8, s[20:23], s28 offen offset:0 lds
  ds_read_b64_tr_b16 a[32:33], v18 offset:0
  v_mfma_f32_16x16x32_bf16 v[96:99], a[64:67], a[24:27], v[96:99]
  ds_read_b64_tr_b16 a[34:35], v18 offset:2048
  v_mfma_f32_16x16x32_bf16 v[128:131], a[64:67], a[28:31], v[128:131]
  buffer_load_dwordx4 v9, s[20:23], s28 offen offset:1024 lds
  ds_read_b128 a[4:7], v16 offset:2048
  v_mfma_f32_16x16x32_bf16 v[36:39], a[68:71], a[16:19], v[36:39]
  ds_read_b128 a[8:11], v16 offset:4096
  v_mfma_f32_16x16x32_bf16 v[68:71], a[68:71], a[20:23], v[68:71]
  ds_read_b128 a[12:15], v16 offset:6144
  v_mfma_f32_16x16x32_bf16 v[100:103], a[68:71], a[24:27], v[100:103]
  ds_read_b64_tr_b16 a[36:37], v19 offset:0
  v_mfma_f32_16x16x32_bf16 v[132:135], a[68:71], a[28:31], v[132:135]
  buffer_load_dwordx4 v10, s[20:23], s28 offen offset:2048 lds
  ds_read_b64_tr_b16 a[38:39], v19 offset:2048
  v_mfma_f32_16x16x32_bf16 v[40:43], a[72:75], a[16:19], v[40:43]
  ds_read_b64_tr_b16 a[40:41], v20 offset:0
  v_mfma_f32_16x16x32_bf16 v[72:75], a[72:75], a[20:23], v[72:75]
  ds_read_b64_tr_b16 a[42:43], v20 offset:2048
  v_mfma_f32_16x16x32_bf16 v[104:107], a[72:75], a[24:27], v[104:107]
  v_mfma_f32_16x16x32_bf16 v[136:139], a[72:75], a[28:31], v[136:139]
  buffer_load_dwordx4 v11, s[20:23], s28 offen offset:3072 lds
  ds_read_b64_tr_b16 a[44:45], v21 offset:0
  v_mfma_f32_16x16x32_bf16 v[44:47], a[76:79], a[16:19], v[44:47]
  s_bfe_u32 s56, 0x302010e, s55
  s_add_u32 s54, s54, s56
  s_add_u32 s55, s55, 8
  v_mfma_f32_16x16x32_bf16 v[76:79], a[76:79], a[20:23], v[76:79]
  s_and_b32 s55, s55, 0x8001f
  s_and_b32 s54, s54, 15
  s_lshl_b32 s28, s54, 19
  v_mfma_f32_16x16x32_bf16 v[108:111], a[76:79], a[24:27], v[108:111]
  s_mov_b32 m0, s88
  ds_read_b64_tr_b16 a[46:47], v21 offset:2048
  ds_read_b64_tr_b16 a[48:49], v18 offset:8192
  v_mfma_f32_16x16x32_bf16 v[140:143], a[76:79], a[28:31], v[140:143]
  buffer_load_dwordx4 v4, s[8:11], s26 offen offset:0 lds
  ds_read_b64_tr_b16 a[50:51], v18 offset:10240
  v_mfma_f32_16x16x32_bf16 v[48:51], a[80:83], a[16:19], v[48:51]
  ds_read_b64_tr_b16 a[52:53], v19 offset:8192
  ds_read_b64_tr_b16 a[54:55], v19 offset:10240
  v_mfma_f32_16x16x32_bf16 v[80:83], a[80:83], a[20:23], v[80:83]
  ds_read_b64_tr_b16 a[56:57], v20 offset:8192
  v_mfma_f32_16x16x32_bf16 v[112:115], a[80:83], a[24:27], v[112:115]
  ds_read_b64_tr_b16 a[58:59], v20 offset:10240
  v_mfma_f32_16x16x32_bf16 v[144:147], a[80:83], a[28:31], v[144:147]
  buffer_load_dwordx4 v5, s[8:11], s26 offen offset:1024 lds
  ds_read_b64_tr_b16 a[60:61], v21 offset:8192
  v_mfma_f32_16x16x32_bf16 v[52:55], a[84:87], a[16:19], v[52:55]
  ds_read_b64_tr_b16 a[62:63], v21 offset:10240
  v_mfma_f32_16x16x32_bf16 v[84:87], a[84:87], a[20:23], v[84:87]
  v_mfma_f32_16x16x32_bf16 v[116:119], a[84:87], a[24:27], v[116:119]
  v_mfma_f32_16x16x32_bf16 v[148:151], a[84:87], a[28:31], v[148:151]
  buffer_load_dwordx4 v6, s[8:11], s26 offen offset:2048 lds
  v_mfma_f32_16x16x32_bf16 v[56:59], a[88:91], a[16:19], v[56:59]
  v_mfma_f32_16x16x32_bf16 v[88:91], a[88:91], a[20:23], v[88:91]
  v_mfma_f32_16x16x32_bf16 v[120:123], a[88:91], a[24:27], v[120:123]
  v_mfma_f32_16x16x32_bf16 v[152:155], a[88:91], a[28:31], v[152:155]
  buffer_load_dwordx4 v7, s[8:11], s26 offen offset:3072 lds
  v_mfma_f32_16x16x32_bf16 v[60:63], a[92:95], a[16:19], v[60:63]
  v_mfma_f32_16x16x32_bf16 v[92:95], a[92:95], a[20:23], v[92:95]
  v_mfma_f32_16x16x32_bf16 v[124:127], a[92:95], a[24:27], v[124:127]
  v_mfma_f32_16x16x32_bf16 v[156:159], a[92:95], a[28:31], v[156:159]
  s_waitcnt lgkmcnt(0)
  v_mfma_f32_16x16x32_bf16 v[32:35], a[32:35], a[0:3], v[32:35]
  s_add_u32 m0, s88, 4096
  ds_read_b128 a[16:19], v17 offset:0
  v_mfma_f32_16x16x32_bf16 v[64:67], a[32:35], a[4:7], v[64:67]
  buffer_load_dwordx4 v4, s[8:11], s27 offen offset:0 lds
  ds_read_b64_tr_b16 a[64:65], v18 offset:4096
  v_mfma_f32_16x16x32_bf16 v[96:99], a[32:35], a[8:11], v[96:99]
  ds_read_b64_tr_b16 a[66:67], v18 offset:6144
  v_mfma_f32_16x16x32_bf16 v[128:131], a[32:35], a[12:15], v[128:131]
  buffer_load_dwordx4 v5, s[8:11], s27 offen offset:1024 lds
  ds_read_b128 a[20:23], v17 offset:2048
  v_mfma_f32_16x16x32_bf16 v[36:39], a[36:39], a[0:3], v[36:39]
  ds_read_b128 a[24:27], v17 offset:4096
  v_mfma_f32_16x16x32_bf16 v[68:71], a[36:39], a[4:7], v[68:71]
  ds_read_b128 a[28:31], v17 offset:6144
  v_mfma_f32_16x16x32_bf16 v[100:103], a[36:39], a[8:11], v[100:103]
  ds_read_b64_tr_b16 a[68:69], v19 offset:4096
  v_mfma_f32_16x16x32_bf16 v[132:135], a[36:39], a[12:15], v[132:135]
  buffer_load_dwordx4 v6, s[8:11], s27 offen offset:2048 lds
  ds_read_b64_tr_b16 a[70:71], v19 offset:6144
  v_mfma_f32_16x16x32_bf16 v[40:43], a[40:43], a[0:3], v[40:43]
  ds_read_b64_tr_b16 a[72:73], v20 offset:4096
  v_mfma_f32_16x16x32_bf16 v[72:75], a[40:43], a[4:7], v[72:75]
  ds_read_b64_tr_b16 a[74:75], v20 offset:6144
  v_mfma_f32_16x16x32_bf16 v[104:107], a[40:43], a[8:11], v[104:107]
  buffer_load_dwordx4 v7, s[8:11], s27 offen offset:3072 lds
  v_mfma_f32_16x16x32_bf16 v[136:139], a[40:43], a[12:15], v[136:139]
  s_bfe_u32 s29, 0x302010e, s53
  s_add_u32 s52, s52, s29
  s_add_u32 s53, s53, 8
  v_mfma_f32_16x16x32_bf16 v[44:47], a[44:47], a[0:3], v[44:47]
  s_and_b32 s53, s53, 0x8001f
  s_and_b32 s52, s52, 15
  s_lshl_b32 s29, s52, 7
  v_mfma_f32_16x16x32_bf16 v[76:79], a[44:47], a[4:7], v[76:79]
  s_or_b32 s26, s30, s29
  s_or_b32 s27, s31, s29
  s_add_u32 s60, s63, 36864
  v_mfma_f32_16x16x32_bf16 v[108:111], a[44:47], a[8:11], v[108:111]
  buffer_store_dwordx4 v[220:223], v2, s[16:19], s60 offen offset:3072 sc1
  ds_read_b64_tr_b16 a[76:77], v21 offset:4096
  v_mfma_f32_16x16x32_bf16 v[140:143], a[44:47], a[12:15], v[140:143]
  s_add_u32 s60, s63, 45056
  ds_read_b64_tr_b16 a[78:79], v21 offset:6144
  ds_read_b64_tr_b16 a[80:81], v18 offset:12288
  v_mfma_f32_16x16x32_bf16 v[48:51], a[48:51], a[0:3], v[48:51]
  ds_read_b64_tr_b16 a[82:83], v18 offset:14336
  ds_read_b64_tr_b16 a[84:85], v19 offset:12288
  v_mfma_f32_16x16x32_bf16 v[80:83], a[48:51], a[4:7], v[80:83]
  buffer_store_dwordx4 v[252:255], v2, s[16:19], s60 offen offset:3072 sc1
  ds_read_b64_tr_b16 a[86:87], v19 offset:14336
  v_mfma_f32_16x16x32_bf16 v[112:115], a[48:51], a[8:11], v[112:115]
  s_add_u32 s60, s63, 0
  ds_read_b64_tr_b16 a[88:89], v20 offset:12288
  ds_read_b64_tr_b16 a[90:91], v20 offset:14336
  v_mfma_f32_16x16x32_bf16 v[144:147], a[48:51], a[12:15], v[144:147]
  ds_read_b64_tr_b16 a[92:93], v21 offset:12288
  v_mfma_f32_16x16x32_bf16 v[52:55], a[52:55], a[0:3], v[52:55]
  ds_read_b64_tr_b16 a[94:95], v21 offset:14336
  v_mfma_f32_16x16x32_bf16 v[84:87], a[52:55], a[4:7], v[84:87]
  buffer_store_dwordx4 v[160:163], v2, s[16:19], s60 offen offset:0 sc1
  v_mfma_f32_16x16x32_bf16 v[116:119], a[52:55], a[8:11], v[116:119]
  s_add_u32 s88, s88, s90
  s_add_u32 s89, s89, 1
  s_cmp_eq_u32 s89, 3
  s_cselect_b32 s89, 0, s89
  s_cselect_b32 s90, s91, s92
  v_mfma_f32_16x16x32_bf16 v[148:151], a[52:55], a[12:15], v[148:151]
  s_add_u32 s68, s68, s70
  s_add_u32 s69, s69, 1
  s_cmp_eq_u32 s69, 3
  s_cselect_b32 s69, 0, s69
  s_cselect_b32 s70, s71, s72
  v_mfma_f32_16x16x32_bf16 v[56:59], a[56:59], a[0:3], v[56:59]
  v_add_u32 v16, s90, v16
  v_add_u32 v17, s90, v17
  v_mfma_f32_16x16x32_bf16 v[88:91], a[56:59], a[4:7], v[88:91]
  v_add_u32 v18, s70, v18
  v_add_u32 v19, s70, v19
  v_mfma_f32_16x16x32_bf16 v[120:123], a[56:59], a[8:11], v[120:123]
  v_add_u32 v20, s70, v20
  v_add_u32 v21, s70, v21
  v_mfma_f32_16x16x32_bf16 v[152:155], a[56:59], a[12:15], v[152:155]
  v_mfma_f32_16x16x32_bf16 v[60:63], a[60:63], a[0:3], v[60:63]
  v_mfma_f32_16x16x32_bf16 v[92:95], a[60:63], a[4:7], v[92:95]
  v_mfma_f32_16x16x32_bf16 v[124:127], a[60:63], a[8:11], v[124:127]
  v_mfma_f32_16x16x32_bf16 v[156:159], a[60:63], a[12:15], v[156:159]
  s_waitcnt vmcnt(18) lgkmcnt(0)
  s_barrier
  v_mfma_f32_16x16x32_bf16 v[32:35], a[64:67], a[16:19], v[32:35]
  s_mov_b32 m0, s68
  ds_read_b128 a[0:3], v16 offset:0
  v_mfma_f32_16x16x32_bf16 v[64:67], a[64:67], a[20:23], v[64:67]
  buffer_load_dwordx4 v8, s[20:23], s28 offen offset:0 lds
  ds_read_b64_tr_b16 a[32:33], v18 offset:0
  v_mfma_f32_16x16x32_bf16 v[96:99], a[64:67], a[24:27], v[96:99]
  ds_read_b64_tr_b16 a[34:35], v18 offset:2048
  v_mfma_f32_16x16x32_bf16 v[128:131], a[64:67], a[28:31], v[128:131]
  buffer_load_dwordx4 v9, s[20:23], s28 offen offset:1024 lds
  ds_read_b128 a[4:7], v16 offset:2048
  v_mfma_f32_16x16x32_bf16 v[36:39], a[68:71], a[16:19], v[36:39]
  ds_read_b128 a[8:11], v16 offset:4096
  v_mfma_f32_16x16x32_bf16 v[68:71], a[68:71], a[20:23], v[68:71]
  ds_read_b128 a[12:15], v16 offset:6144
  v_mfma_f32_16x16x32_bf16 v[100:103], a[68:71], a[24:27], v[100:103]
  ds_read_b64_tr_b16 a[36:37], v19 offset:0
  v_mfma_f32_16x16x32_bf16 v[132:135], a[68:71], a[28:31], v[132:135]
  buffer_load_dwordx4 v10, s[20:23], s28 offen offset:2048 lds
  ds_read_b64_tr_b16 a[38:39], v19 offset:2048
  v_mfma_f32_16x16x32_bf16 v[40:43], a[72:75], a[16:19], v[40:43]
  ds_read_b64_tr_b16 a[40:41], v20 offset:0
  v_mfma_f32_16x16x32_bf16 v[72:75], a[72:75], a[20:23], v[72:75]
  ds_read_b64_tr_b16 a[42:43], v20 offset:2048
  v_mfma_f32_16x16x32_bf16 v[104:107], a[72:75], a[24:27], v[104:107]
  v_mfma_f32_16x16x32_bf16 v[136:139], a[72:75], a[28:31], v[136:139]
  buffer_load_dwordx4 v11, s[20:23], s28 offen offset:3072 lds
  ds_read_b64_tr_b16 a[44:45], v21 offset:0
  v_mfma_f32_16x16x32_bf16 v[44:47], a[76:79], a[16:19], v[44:47]
  s_bfe_u32 s56, 0x302010e, s55
  s_add_u32 s54, s54, s56
  s_add_u32 s55, s55, 8
  v_mfma_f32_16x16x32_bf16 v[76:79], a[76:79], a[20:23], v[76:79]
  s_and_b32 s55, s55, 0x8001f
  s_and_b32 s54, s54, 15
  s_lshl_b32 s28, s54, 19
  v_mfma_f32_16x16x32_bf16 v[108:111], a[76:79], a[24:27], v[108:111]
  s_mov_b32 m0, s88
  ds_read_b64_tr_b16 a[46:47], v21 offset:2048
  ds_read_b64_tr_b16 a[48:49], v18 offset:8192
  v_mfma_f32_16x16x32_bf16 v[140:143], a[76:79], a[28:31], v[140:143]
  buffer_load_dwordx4 v4, s[8:11], s26 offen offset:0 lds
  ds_read_b64_tr_b16 a[50:51], v18 offset:10240
  v_mfma_f32_16x16x32_bf16 v[48:51], a[80:83], a[16:19], v[48:51]
  ds_read_b64_tr_b16 a[52:53], v19 offset:8192
  ds_read_b64_tr_b16 a[54:55], v19 offset:10240
  v_mfma_f32_16x16x32_bf16 v[80:83], a[80:83], a[20:23], v[80:83]
  ds_read_b64_tr_b16 a[56:57], v20 offset:8192
  v_mfma_f32_16x16x32_bf16 v[112:115], a[80:83], a[24:27], v[112:115]
  ds_read_b64_tr_b16 a[58:59], v20 offset:10240
  v_mfma_f32_16x16x32_bf16 v[144:147], a[80:83], a[28:31], v[144:147]
  buffer_load_dwordx4 v5, s[8:11], s26 offen offset:1024 lds
  ds_read_b64_tr_b16 a[60:61], v21 offset:8192
  v_mfma_f32_16x16x32_bf16 v[52:55], a[84:87], a[16:19], v[52:55]
  ds_read_b64_tr_b16 a[62:63], v21 offset:10240
  v_mfma_f32_16x16x32_bf16 v[84:87], a[84:87], a[20:23], v[84:87]
  v_mfma_f32_16x16x32_bf16 v[116:119], a[84:87], a[24:27], v[116:119]
  v_mfma_f32_16x16x32_bf16 v[148:151], a[84:87], a[28:31], v[148:151]
  buffer_load_dwordx4 v6, s[8:11], s26 offen offset:2048 lds
  v_mfma_f32_16x16x32_bf16 v[56:59], a[88:91], a[16:19], v[56:59]
  v_mfma_f32_16x16x32_bf16 v[88:91], a[88:91], a[20:23], v[88:91]
  v_mfma_f32_16x16x32_bf16 v[120:123], a[88:91], a[24:27], v[120:123]
  v_mfma_f32_16x16x32_bf16 v[152:155], a[88:91], a[28:31], v[152:155]
  buffer_load_dwordx4 v7, s[8:11], s26 offen offset:3072 lds
  v_mfma_f32_16x16x32_bf16 v[60:63], a[92:95], a[16:19], v[60:63]
  v_mfma_f32_16x16x32_bf16 v[92:95], a[92:95], a[20:23], v[92:95]
  v_mfma_f32_16x16x32_bf16 v[124:127], a[92:95], a[24:27], v[124:127]
  v_mfma_f32_16x16x32_bf16 v[156:159], a[92:95], a[28:31], v[156:159]
  s_waitcnt lgkmcnt(0)
  v_mfma_f32_16x16x32_bf16 v[32:35], a[32:35], a[0:3], v[32:35]
  s_add_u32 m0, s88, 4096
  ds_read_b128 a[16:19], v17 offset:0
  v_mfma_f32_16x16x32_bf16 v[64:67], a[32:35], a[4:7], v[64:67]
  buffer_load_dwordx4 v4, s[8:11], s27 offen offset:0 lds
  ds_read_b64_tr_b16 a[64:65], v18 offset:4096
  v_mfma_f32_16x16x32_bf16 v[96:99], a[32:35], a[8:11], v[96:99]
  ds_read_b64_tr_b16 a[66:67], v18 offset:6144
  v_mfma_f32_16x16x32_bf16 v[128:131], a[32:35], a[12:15], v[128:131]
  buffer_load_dwordx4 v5, s[8:11], s27 offen offset:1024 lds
  ds_read_b128 a[20:23], v17 offset:2048
  v_mfma_f32_16x16x32_bf16 v[36:39], a[36:39], a[0:3], v[36:39]
  ds_read_b128 a[24:27], v17 offset:4096
  v_mfma_f32_16x16x32_bf16 v[68:71], a[36:39], a[4:7], v[68:71]
  ds_read_b128 a[28:31], v17 offset:6144
  v_mfma_f32_16x16x32_bf16 v[100:103], a[36:39], a[8:11], v[100:103]
  ds_read_b64_tr_b16 a[68:69], v19 offset:4096
  v_mfma_f32_16x16x32_bf16 v[132:135], a[36:39], a[12:15], v[132:135]
  buffer_load_dwordx4 v6, s[8:11], s27 offen offset:2048 lds
  ds_read_b64_tr_b16 a[70:71], v19 offset:6144
  v_mfma_f32_16x16x32_bf16 v[40:43], a[40:43], a[0:3], v[40:43]
  ds_read_b64_tr_b16 a[72:73], v20 offset:4096
  v_mfma_f32_16x16x32_bf16 v[72:75], a[40:43], a[4:7], v[72:75]
  ds_read_b64_tr_b16 a[74:75], v20 offset:6144
  v_mfma_f32_16x16x32_bf16 v[104:107], a[40:43], a[8:11], v[104:107]
  buffer_load_dwordx4 v7, s[8:11], s27 offen offset:3072 lds
  v_mfma_f32_16x16x32_bf16 v[136:139], a[40:43], a[12:15], v[136:139]
  s_bfe_u32 s29, 0x302010e, s53
  s_add_u32 s52, s52, s29
  s_add_u32 s53, s53, 8
  v_mfma_f32_16x16x32_bf16 v[44:47], a[44:47], a[0:3], v[44:47]
  s_and_b32 s53, s53, 0x8001f
  s_and_b32 s52, s52, 15
  s_lshl_b32 s29, s52, 7
  v_mfma_f32_16x16x32_bf16 v[76:79], a[44:47], a[4:7], v[76:79]
  s_or_b32 s26, s30, s29
  s_or_b32 s27, s31, s29
  s_add_u32 s60, s63, 0
  v_mfma_f32_16x16x32_bf16 v[108:111], a[44:47], a[8:11], v[108:111]
  buffer_store_dwordx4 v[164:167], v2, s[16:19], s60 offen offset:1024 sc1
  ds_read_b64_tr_b16 a[76:77], v21 offset:4096
  v_mfma_f32_16x16x32_bf16 v[140:143], a[44:47], a[12:15], v[140:143]
  ds_read_b64_tr_b16 a[78:79], v21 offset:6144
  ds_read_b64_tr_b16 a[80:81], v18 offset:12288
  v_mfma_f32_16x16x32_bf16 v[48:51], a[48:51], a[0:3], v[48:51]
  ds_read_b64_tr_b16 a[82:83], v18 offset:14336
  ds_read_b64_tr_b16 a[84:85], v19 offset:12288
  v_mfma_f32_16x16x32_bf16 v[80:83], a[48:51], a[4:7], v[80:83]
  buffer_store_dwordx4 v[168:171], v2, s[16:19], s60 offen offset:2048 sc1
  ds_read_b64_tr_b16 a[86:87], v19 offset:14336
  v_mfma_f32_16x16x32_bf16 v[112:115], a[48:51], a[8:11], v[112:115]
  ds_read_b64_tr_b16 a[88:89], v20 offset:12288
  ds_read_b64_tr_b16 a[90:91], v20 offset:14336
  v_mfma_f32_16x16x32_bf16 v[144:147], a[48:51], a[12:15], v[144:147]
  ds_read_b64_tr_b16 a[92:93], v21 offset:12288
  v_mfma_f32_16x16x32_bf16 v[52:55], a[52:55], a[0:3], v[52:55]
  ds_read_b64_tr_b16 a[94:95], v21 offset:14336
  v_mfma_f32_16x16x32_bf16 v[84:87], a[52:55], a[4:7], v[84:87]
  buffer_store_dwordx4 v[172:175], v2, s[16:19], s60 offen offset:3072 sc1
  v_mfma_f32_16x16x32_bf16 v[116:119], a[52:55], a[8:11], v[116:119]
  s_add_u32 s88, s88, s90
  s_add_u32 s89, s89, 1
  s_cmp_eq_u32 s89, 3
  s_cselect_b32 s89, 0, s89
  s_cselect_b32 s90, s91, s92
  v_mfma_f32_16x16x32_bf16 v[148:151], a[52:55], a[12:15], v[148:151]
  s_add_u32 s68, s68, s70
  s_add_u32 s69, s69, 1
  s_cmp_eq_u32 s69, 3
  s_cselect_b32 s69, 0, s69
  s_cselect_b32 s70, s71, s72
  v_mfma_f32_16x16x32_bf16 v[56:59], a[56:59], a[0:3], v[56:59]
  v_add_u32 v16, s90, v16
  v_add_u32 v17, s90, v17
  v_mfma_f32_16x16x32_bf16 v[88:91], a[56:59], a[4:7], v[88:91]
  v_add_u32 v18, s70, v18
  v_add_u32 v19, s70, v19
  v_mfma_f32_16x16x32_bf16 v[120:123], a[56:59], a[8:11], v[120:123]
  v_add_u32 v20, s70, v20
  v_add_u32 v21, s70, v21
  v_mfma_f32_16x16x32_bf16 v[152:155], a[56:59], a[12:15], v[152:155]
  v_mfma_f32_16x16x32_bf16 v[60:63], a[60:63], a[0:3], v[60:63]
  v_mfma_f32_16x16x32_bf16 v[92:95], a[60:63], a[4:7], v[92:95]
  v_mfma_f32_16x16x32_bf16 v[124:127], a[60:63], a[8:11], v[124:127]
  v_mfma_f32_16x16x32_bf16 v[156:159], a[60:63], a[12:15], v[156:159]
  s_waitcnt vmcnt(18) lgkmcnt(0)
  s_barrier
  v_mfma_f32_16x16x32_bf16 v[32:35], a[64:67], a[16:19], v[32:35]
  s_mov_b32 m0, s68
  ds_read_b128 a[0:3], v16 offset:0
  v_mfma_f32_16x16x32_bf16 v[64:67], a[64:67], a[20:23], v[64:67]
  buffer_load_dwordx4 v8, s[20:23], s28 offen offset:0 lds
  ds_read_b64_tr_b16 a[32:33], v18 offset:0
  v_mfma_f32_16x16x32_bf16 v[96:99], a[64:67], a[24:27], v[96:99]
  ds_read_b64_tr_b16 a[34:35], v18 offset:2048
  v_mfma_f32_16x16x32_bf16 v[128:131], a[64:67], a[28:31], v[128:131]
  ds_read_b128 a[4:7], v16 offset:2048
  v_mfma_f32_16x16x32_bf16 v[36:39], a[68:71], a[16:19], v[36:39]
  buffer_load_dwordx4 v9, s[20:23], s28 offen offset:1024 lds
  ds_read_b128 a[8:11], v16 offset:4096
  v_mfma_f32_16x16x32_bf16 v[68:71], a[68:71], a[20:23], v[68:71]
  ds_read_b128 a[12:15], v16 offset:6144
  v_mfma_f32_16x16x32_bf16 v[100:103], a[68:71], a[24:27], v[100:103]
  ds_read_b64_tr_b16 a[36:37], v19 offset:0
  v_mfma_f32_16x16x32_bf16 v[132:135], a[68:71], a[28:31], v[132:135]
  ds_read_b64_tr_b16 a[38:39], v19 offset:2048
  v_mfma_f32_16x16x32_bf16 v[40:43], a[72:75], a[16:19], v[40:43]
  buffer_load_dwordx4 v10, s[20:23], s28 offen offset:2048 lds
  ds_read_b64_tr_b16 a[40:41], v20 offset:0
  v_mfma_f32_16x16x32_bf16 v[72:75], a[72:75], a[20:23], v[72:75]
  ds_read_b64_tr_b16 a[42:43], v20 offset:2048
  v_mfma_f32_16x16x32_bf16 v[104:107], a[72:75], a[24:27], v[104:107]
  v_mfma_f32_16x16x32_bf16 v[136:139], a[72:75], a[28:31], v[136:139]
  ds_read_b64_tr_b16 a[44:45], v21 offset:0
  v_mfma_f32_16x16x32_bf16 v[44:47], a[76:79], a[16:19], v[44:47]
  ds_read_b64_tr_b16 a[46:47], v21 offset:2048
  v_mfma_f32_16x16x32_bf16 v[76:79], a[76:79], a[20:23], v[76:79]
  buffer_load_dwordx4 v11, s[20:23], s28 offen offset:3072 lds
  ds_read_b64_tr_b16 a[48:49], v18 offset:8192
  v_mfma_f32_16x16x32_bf16 v[108:111], a[76:79], a[24:27], v[108:111]
  s_bfe_u32 s56, 0x302010e, s55
  s_add_u32 s54, s54, s56
  s_add_u32 s55, s55, 8
  v_mfma_f32_16x16x32_bf16 v[140:143], a[76:79], a[28:31], v[140:143]
  s_and_b32 s55, s55, 0x8001f
  s_and_b32 s54, s54, 15
  s_lshl_b32 s28, s54, 19
  v_mfma_f32_16x16x32_bf16 v[48:51], a[80:83], a[16:19], v[48:51]
  s_mov_b32 m0, s88
  ds_read_b64_tr_b16 a[50:51], v18 offset:10240
  ds_read_b64_tr_b16 a[52:53], v19 offset:8192
  v_mfma_f32_16x16x32_bf16 v[80:83], a[80:83], a[20:23], v[80:83]
  buffer_load_dwordx4 v4, s[8:11], s26 offen offset:0 lds
  ds_read_b64_tr_b16 a[54:55], v19 offset:10240
  v_mfma_f32_16x16x32_bf16 v[112:115], a[80:83], a[24:27], v[112:115]
  ds_read_b64_tr_b16 a[56:57], v20 offset:8192
  ds_read_b64_tr_b16 a[58:59], v20 offset:10240
  v_mfma_f32_16x16x32_bf16 v[144:147], a[80:83], a[28:31], v[144:147]
  ds_read_b64_tr_b16 a[60:61], v21 offset:8192
  v_mfma_f32_16x16x32_bf16 v[52:55], a[84:87], a[16:19], v[52:55]
  ds_read_b64_tr_b16 a[62:63], v21 offset:10240
  v_mfma_f32_16x16x32_bf16 v[84:87], a[84:87], a[20:23], v[84:87]
  v_mfma_f32_16x16x32_bf16 v[116:119], a[84:87], a[24:27], v[116:119]
  buffer_load_dwordx4 v5, s[8:11], s26 offen offset:1024 lds
  v_mfma_f32_16x16x32_bf16 v[148:151], a[84:87], a[28:31], v[148:151]
  v_mfma_f32_16x16x32_bf16 v[56:59], a[88:91], a[16:19], v[56:59]
  v_mfma_f32_16x16x32_bf16 v[88:91], a[88:91], a[20:23], v[88:91]
  v_mfma_f32_16x16x32_bf16 v[120:123], a[88:91], a[24:27], v[120:123]
  buffer_load_dwordx4 v6, s[8:11], s26 offen offset:2048 lds
  v_mfma_f32_16x16x32_bf16 v[152:155], a[88:91], a[28:31], v[152:155]
  v_mfma_f32_16x16x32_bf16 v[60:63], a[92:95], a[16:19], v[60:63]
  v_mfma_f32_16x16x32_bf16 v[92:95], a[92:95], a[20:23], v[92:95]
  v_mfma_f32_16x16x32_bf16 v[124:127], a[92:95], a[24:27], v[124:127]
  v_mfma_f32_16x16x32_bf16 v[156:159], a[92:95], a[28:31], v[156:159]
  s_waitcnt lgkmcnt(0)
  v_mfma_f32_16x16x32_bf16 v[32:35], a[32:35], a[0:3], v[32:35]
  buffer_load_dwordx4 v7, s[8:11], s26 offen offset:3072 lds
  ds_read_b128 a[16:19], v17 offset:0
  v_mfma_f32_16x16x32_bf16 v[64:67], a[32:35], a[4:7], v[64:67]
  s_add_u32 m0, s88, 4096
  ds_read_b64_tr_b16 a[64:65], v18 offset:4096
  v_mfma_f32_16x16x32_bf16 v[96:99], a[32:35], a[8:11], v[96:99]
  ds_read_b64_tr_b16 a[66:67], v18 offset:6144
  v_mfma_f32_16x16x32_bf16 v[128:131], a[32:35], a[12:15], v[128:131]
  buffer_load_dwordx4 v4, s[8:11], s27 offen offset:0 lds
  ds_read_b128 a[20:23], v17 offset:2048
  v_mfma_f32_16x16x32_bf16 v[36:39], a[36:39], a[0:3], v[36:39]
  ds_read_b128 a[24:27], v17 offset:4096
  v_mfma_f32_16x16x32_bf16 v[68:71], a[36:39], a[4:7], v[68:71]
  ds_read_b128 a[28:31], v17 offset:6144
  v_mfma_f32_16x16x32_bf16 v[100:103], a[36:39], a[8:11], v[100:103]
  ds_read_b64_tr_b16 a[68:69], v19 offset:4096
  v_mfma_f32_16x16x32_bf16 v[132:135], a[36:39], a[12:15], v[132:135]
  buffer_load_dwordx4 v5, s[8:11], s27 offen offset:1024 lds
  ds_read_b64_tr_b16 a[70:71], v19 offset:6144
  v_mfma_f32_16x16x32_bf16 v[40:43], a[40:43], a[0:3], v[40:43]
  ds_read_b64_tr_b16 a[72:73], v20 offset:4096
  v_mfma_f32_16x16x32_bf16 v[72:75], a[40:43], a[4:7], v[72:75]
  ds_read_b64_tr_b16 a[74:75], v20 offset:6144
  v_mfma_f32_16x16x32_bf16 v[104:107], a[40:43], a[8:11], v[104:107]
  buffer_load_dwordx4 v6, s[8:11], s27 offen offset:2048 lds
  v_mfma_f32_16x16x32_bf16 v[136:139], a[40:43], a[12:15], v[136:139]
  ds_read_b64_tr_b16 a[76:77], v21 offset:4096
  v_mfma_f32_16x16x32_bf16 v[44:47], a[44:47], a[0:3], v[44:47]
  ds_read_b64_tr_b16 a[78:79], v21 offset:6144
  v_mfma_f32_16x16x32_bf16 v[76:79], a[44:47], a[4:7], v[76:79]
  ds_read_b64_tr_b16 a[80:81], v18 offset:12288
  v_mfma_f32_16x16x32_bf16 v[108:111], a[44:47], a[8:11], v[108:111]
  buffer_load_dwordx4 v7, s[8:11], s27 offen offset:3072 lds
  ds_read_b64_tr_b16 a[82:83], v18 offset:14336
  v_mfma_f32_16x16x32_bf16 v[140:143], a[44:47], a[12:15], v[140:143]
  s_bfe_u32 s29, 0x302010e, s53
  s_add_u32 s52, s52, s29
  s_add_u32 s53, s53, 8
  v_mfma_f32_16x16x32_bf16 v[48:51], a[48:51], a[0:3], v[48:51]
  s_and_b32 s53, s53, 0x8001f
  s_and_b32 s52, s52, 15
  s_lshl_b32 s29, s52, 7
  v_mfma_f32_16x16x32_bf16 v[80:83], a[48:51], a[4:7], v[80:83]
  s_or_b32 s26, s30, s29
  s_or_b32 s27, s31, s29
  s_add_u32 s60, s63, 4096
  v_mfma_f32_16x16x32_bf16 v[112:115], a[48:51], a[8:11], v[112:115]
  buffer_store_dwordx4 v[176:179], v2, s[16:19], s60 offen offset:0 sc1
  ds_read_b64_tr_b16 a[84:85], v19 offset:12288
  v_mfma_f32_16x16x32_bf16 v[144:147], a[48:51], a[12:15], v[144:147]
  ds_read_b64_tr_b16 a[86:87], v19 offset:14336
  ds_read_b64_tr_b16 a[88:89], v20 offset:12288
  v_mfma_f32_16x16x32_bf16 v[52:55], a[52:55], a[0:3], v[52:55]
  ds_read_b64_tr_b16 a[90:91], v20 offset:14336
  ds_read_b64_tr_b16 a[92:93], v21 offset:12288
  v_mfma_f32_16x16x32_bf16 v[84:87], a[52:55], a[4:7], v[84:87]
  buffer_store_dwordx4 v[180:183], v2, s[16:19], s60 offen offset:1024 sc1
  ds_read_b64_tr_b16 a[94:95], v21 offset:14336
  v_mfma_f32_16x16x32_bf16 v[116:119], a[52:55], a[8:11], v[116:119]
  s_add_u32 s88, s88, s90
  s_add_u32 s89, s89, 1
  s_cmp_eq_u32 s89, 3
  s_cselect_b32 s89, 0, s89
  s_cselect_b32 s90, s91, s92
  v_mfma_f32_16x16x32_bf16 v[148:151], a[52:55], a[12:15], v[148:151]
  s_add_u32 s68, s68, s70
  s_add_u32 s69, s69, 1
  s_cmp_eq_u32 s69, 3
  s_cselect_b32 s69, 0, s69
  s_cselect_b32 s70, s71, s72
  v_mfma_f32_16x16x32_bf16 v[56:59], a[56:59], a[0:3], v[56:59]
  v_add_u32 v16, s90, v16
  v_add_u32 v17, s90, v17
  v_mfma_f32_16x16x32_bf16 v[88:91], a[56:59], a[4:7], v[88:91]
  v_add_u32 v18, s70, v18
  v_add_u32 v19, s70, v19
  v_mfma_f32_16x16x32_bf16 v[120:123], a[56:59], a[8:11], v[120:123]
  v_add_u32 v20, s70, v20
  v_add_u32 v21, s70, v21
  v_mfma_f32_16x16x32_bf16 v[152:155], a[56:59], a[12:15], v[152:155]
  v_mfma_f32_16x16x32_bf16 v[60:63], a[60:63], a[0:3], v[60:63]
  v_mfma_f32_16x16x32_bf16 v[92:95], a[60:63], a[4:7], v[92:95]
  v_mfma_f32_16x16x32_bf16 v[124:127], a[60:63], a[8:11], v[124:127]
  v_mfma_f32_16x16x32_bf16 v[156:159], a[60:63], a[12:15], v[156:159]
  s_waitcnt vmcnt(17) lgkmcnt(0)
  s_barrier
  v_mfma_f32_16x16x32_bf16 v[32:35], a[64:67], a[16:19], v[32:35]
  s_mov_b32 m0, s68
  ds_read_b128 a[0:3], v16 offset:0
  v_mfma_f32_16x16x32_bf16 v[64:67], a[64:67], a[20:23], v[64:67]
  buffer_load_dwordx4 v8, s[20:23], s28 offen offset:0 lds
  ds_read_b64_tr_b16 a[32:33], v18 offset:0
  v_mfma_f32_16x16x32_bf16 v[96:99], a[64:67], a[24:27], v[96:99]
  ds_read_b64_tr_b16 a[34:35], v18 offset:2048
  v_mfma_f32_16x16x32_bf16 v[128:131], a[64:67], a[28:31], v[128:131]
  ds_read_b128 a[4:7], v16 offset:2048
  v_mfma_f32_16x16x32_bf16 v[36:39], a[68:71], a[16:19], v[36:39]
  buffer_load_dwordx4 v9, s[20:23], s28 offen offset:1024 lds
  ds_read_b128 a[8:11], v16 offset:4096
  v_mfma_f32_16x16x32_bf16 v[68:71], a[68:71], a[20:23], v[68:71]
  ds_read_b128 a[12:15], v16 offset:6144
  v_mfma_f32_16x16x32_bf16 v[100:103], a[68:71], a[24:27], v[100:103]
  ds_read_b64_tr_b16 a[36:37], v19 offset:0
  v_mfma_f32_16x16x32_bf16 v[132:135], a[68:71], a[28:31], v[132:135]
  ds_read_b64_tr_b16 a[38:39], v19 offset:2048
  v_mfma_f32_16x16x32_bf16 v[40:43], a[72:75], a[16:19], v[40:43]
  buffer_load_dwordx4 v10, s[20:23], s28 offen offset:2048 lds
  ds_read_b64_tr_b16 a[40:41], v20 offset:0
  v_mfma_f32_16x16x32_bf16 v[72:75], a[72:75], a[20:23], v[72:75]
  ds_read_b64_tr_b16 a[42:43], v20 offset:2048
  v_mfma_f32_16x16x32_bf16 v[104:107], a[72:75], a[24:27], v[104:107]
  v_mfma_f32_16x16x32_bf16 v[136:139], a[72:75], a[28:31], v[136:139]
  ds_read_b64_tr_b16 a[44:45], v21 offset:0
  v_mfma_f32_16x16x32_bf16 v[44:47], a[76:79], a[16:19], v[44:47]
  ds_read_b64_tr_b16 a[46:47], v21 offset:2048
  v_mfma_f32_16x16x32_bf16 v[76:79], a[76:79], a[20:23], v[76:79]
  buffer_load_dwordx4 v11, s[20:23], s28 offen offset:3072 lds
  ds_read_b64_tr_b16 a[48:49], v18 offset:8192
  v_mfma_f32_16x16x32_bf16 v[108:111], a[76:79], a[24:27], v[108:111]
  s_bfe_u32 s56, 0x302010e, s55
  s_add_u32 s54, s54, s56
  s_add_u32 s55, s55, 8
  v_mfma_f32_16x16x32_bf16 v[140:143], a[76:79], a[28:31], v[140:143]
  s_and_b32 s55, s55, 0x8001f
  s_and_b32 s54, s54, 15
  s_lshl_b32 s28, s54, 19
  v_mfma_f32_16x16x32_bf16 v[48:51], a[80:83], a[16:19], v[48:51]
  s_mov_b32 m0, s88
  ds_read_b64_tr_b16 a[50:51], v18 offset:10240
  ds_read_b64_tr_b16 a[52:53], v19 offset:8192
  v_mfma_f32_16x16x32_bf16 v[80:83], a[80:83], a[20:23], v[80:83]
  buffer_load_dwordx4 v4, s[8:11], s26 offen offset:0 lds
  ds_read_b64_tr_b16 a[54:55], v19 offset:10240
  v_mfma_f32_16x16x32_bf16 v[112:115], a[80:83], a[24:27], v[112:115]
  ds_read_b64_tr_b16 a[56:57], v20 offset:8192
  ds_read_b64_tr_b16 a[58:59], v20 offset:10240
  v_mfma_f32_16x16x32_bf16 v[144:147], a[80:83], a[28:31], v[144:147]
  ds_read_b64_tr_b16 a[60:61], v21 offset:8192
  v_mfma_f32_16x16x32_bf16 v[52:55], a[84:87], a[16:19], v[52:55]
  ds_read_b64_tr_b16 a[62:63], v21 offset:10240
  v_mfma_f32_16x16x32_bf16 v[84:87], a[84:87], a[20:23], v[84:87]
  v_mfma_f32_16x16x32_bf16 v[116:119], a[84:87], a[24:27], v[116:119]
  buffer_load_dwordx4 v5, s[8:11], s26 offen offset:1024 lds
  v_mfma_f32_16x16x32_bf16 v[148:151], a[84:87], a[28:31], v[148:151]
  v_mfma_f32_16x16x32_bf16 v[56:59], a[88:91], a[16:19], v[56:59]
  v_mfma_f32_16x16x32_bf16 v[88:91], a[88:91], a[20:23], v[88:91]
  v_mfma_f32_16x16x32_bf16 v[120:123], a[88:91], a[24:27], v[120:123]
  buffer_load_dwordx4 v6, s[8:11], s26 offen offset:2048 lds
  v_mfma_f32_16x16x32_bf16 v[152:155], a[88:91], a[28:31], v[152:155]
  v_mfma_f32_16x16x32_bf16 v[60:63], a[92:95], a[16:19], v[60:63]
  v_mfma_f32_16x16x32_bf16 v[92:95], a[92:95], a[20:23], v[92:95]
  v_mfma_f32_16x16x32_bf16 v[124:127], a[92:95], a[24:27], v[124:127]
  v_mfma_f32_16x16x32_bf16 v[156:159], a[92:95], a[28:31], v[156:159]
  s_waitcnt lgkmcnt(0)
  v_mfma_f32_16x16x32_bf16 v[32:35], a[32:35], a[0:3], v[32:35]
  buffer_load_dwordx4 v7, s[8:11], s26 offen offset:3072 lds
  ds_read_b128 a[16:19], v17 offset:0
  v_mfma_f32_16x16x32_bf16 v[64:67], a[32:35], a[4:7], v[64:67]
  s_add_u32 m0, s88, 4096
  ds_read_b64_tr_b16 a[64:65], v18 offset:4096
  v_mfma_f32_16x16x32_bf16 v[96:99], a[32:35], a[8:11], v[96:99]
  ds_read_b64_tr_b16 a[66:67], v18 offset:6144
  v_mfma_f32_16x16x32_bf16 v[128:131], a[32:35], a[12:15], v[128:131]
  buffer_load_dwordx4 v4, s[8:11], s27 offen offset:0 lds
  ds_read_b128 a[20:23], v17 offset:2048
  v_mfma_f32_16x16x32_bf16 v[36:39], a[36:39], a[0:3], v[36:39]
  ds_read_b128 a[24:27], v17 offset:4096
  v_mfma_f32_16x16x32_bf16 v[68:71], a[36:39], a[4:7], v[68:71]
  ds_read_b128 a[28:31], v17 offset:6144
  v_mfma_f32_16x16x32_bf16 v[100:103], a[36:39], a[8:11], v[100:103]
  ds_read_b64_tr_b16 a[68:69], v19 offset:4096
  v_mfma_f32_16x16x32_bf16 v[132:135], a[36:39], a[12:15], v[132:135]
  buffer_load_dwordx4 v5, s[8:11], s27 offen offset:1024 lds
  ds_read_b64_tr_b16 a[70:71], v19 offset:6144
  v_mfma_f32_16x16x32_bf16 v[40:43], a[40:43], a[0:3], v[40:43]
  ds_read_b64_tr_b16 a[72:73], v20 offset:4096
  v_mfma_f32_16x16x32_bf16 v[72:75], a[40:43], a[4:7], v[72:75]
  ds_read_b64_tr_b16 a[74:75], v20 offset:6144
  v_mfma_f32_16x16x32_bf16 v[104:107], a[40:43], a[8:11], v[104:107]
  buffer_load_dwordx4 v6, s[8:11], s27 offen offset:2048 lds
  v_mfma_f32_16x16x32_bf16 v[136:139], a[40:43], a[12:15], v[136:139]
  ds_read_b64_tr_b16 a[76:77], v21 offset:4096
  v_mfma_f32_16x16x32_bf16 v[44:47], a[44:47], a[0:3], v[44:47]
  ds_read_b64_tr_b16 a[78:79], v21 offset:6144
  v_mfma_f32_16x16x32_bf16 v[76:79], a[44:47], a[4:7], v[76:79]
  ds_read_b64_tr_b16 a[80:81], v18 offset:12288
  v_mfma_f32_16x16x32_bf16 v[108:111], a[44:47], a[8:11], v[108:111]
  buffer_load_dwordx4 v7, s[8:11], s27 offen offset:3072 lds
  ds_read_b64_tr_b16 a[82:83], v18 offset:14336
  v_mfma_f32_16x16x32_bf16 v[140:143], a[44:47], a[12:15], v[140:143]
  s_bfe_u32 s29, 0x302010e, s53
  s_add_u32 s52, s52, s29
  s_add_u32 s53, s53, 8
  v_mfma_f32_16x16x32_bf16 v[48:51], a[48:51], a[0:3], v[48:51]
  s_and_b32 s53, s53, 0x8001f
  s_and_b32 s52, s52, 15
  s_lshl_b32 s29, s52, 7
  v_mfma_f32_16x16x32_bf16 v[80:83], a[48:51], a[4:7], v[80:83]
  s_or_b32 s26, s30, s29
  s_or_b32 s27, s31, s29
  s_add_u32 s60, s63, 4096
  v_mfma_f32_16x16x32_bf16 v[112:115], a[48:51], a[8:11], v[112:115]
  buffer_store_dwordx4 v[184:187], v2, s[16:19], s60 offen offset:2048 sc1
  ds_read_b64_tr_b16 a[84:85], v19 offset:12288
  v_mfma_f32_16x16x32_bf16 v[144:147], a[48:51], a[12:15], v[144:147]
  ds_read_b64_tr_b16 a[86:87], v19 offset:14336
  ds_read_b64_tr_b16 a[88:89], v20 offset:12288
  v_mfma_f32_16x16x32_bf16 v[52:55], a[52:55], a[0:3], v[52:55]
  ds_read_b64_tr_b16 a[90:91], v20 offset:14336
  ds_read_b64_tr_b16 a[92:93], v21 offset:12288
  v_mfma_f32_16x16x32_bf16 v[84:87], a[52:55], a[4:7], v[84:87]
  buffer_store_dwordx4 v[188:191], v2, s[16:19], s60 offen offset:3072 sc1
  ds_read_b64_tr_b16 a[94:95], v21 offset:14336
  v_mfma_f32_16x16x32_bf16 v[116:119], a[52:55], a[8:11], v[116:119]
  s_add_u32 s88, s88, s90
  s_add_u32 s89, s89, 1
  s_cmp_eq_u32 s89, 3
  s_cselect_b32 s89, 0, s89
  s_cselect_b32 s90, s91, s92
  v_mfma_f32_16x16x32_bf16 v[148:151], a[52:55], a[12:15], v[148:151]
  s_add_u32 s68, s68, s70
  s_add_u32 s69, s69, 1
  s_cmp_eq_u32 s69, 3
  s_cselect_b32 s69, 0, s69
  s_cselect_b32 s70, s71, s72
  v_mfma_f32_16x16x32_bf16 v[56:59], a[56:59], a[0:3], v[56:59]
  v_add_u32 v16, s90, v16
  v_add_u32 v17, s90, v17
  v_mfma_f32_16x16x32_bf16 v[88:91], a[56:59], a[4:7], v[88:91]
  v_add_u32 v18, s70, v18
  v_add_u32 v19, s70, v19
  v_mfma_f32_16x16x32_bf16 v[120:123], a[56:59], a[8:11], v[120:123]
  v_add_u32 v20, s70, v20
  v_add_u32 v21, s70, v21
  v_mfma_f32_16x16x32_bf16 v[152:155], a[56:59], a[12:15], v[152:155]
  v_mfma_f32_16x16x32_bf16 v[60:63], a[60:63], a[0:3], v[60:63]
  v_mfma_f32_16x16x32_bf16 v[92:95], a[60:63], a[4:7], v[92:95]
  v_mfma_f32_16x16x32_bf16 v[124:127], a[60:63], a[8:11], v[124:127]
  v_mfma_f32_16x16x32_bf16 v[156:159], a[60:63], a[12:15], v[156:159]
  s_waitcnt vmcnt(16) lgkmcnt(0)
  s_barrier
  v_mfma_f32_16x16x32_bf16 v[32:35], a[64:67], a[16:19], v[32:35]
  s_mov_b32 m0, s68
  ds_read_b128 a[0:3], v16 offset:0
  v_mfma_f32_16x16x32_bf16 v[64:67], a[64:67], a[20:23], v[64:67]
  buffer_load_dwordx4 v8, s[20:23], s28 offen offset:0 lds
  ds_read_b64_tr_b16 a[32:33], v18 offset:0
  v_mfma_f32_16x16x32_bf16 v[96:99], a[64:67], a[24:27], v[96:99]
  ds_read_b64_tr_b16 a[34:35], v18 offset:2048
  v_mfma_f32_16x16x32_bf16 v[128:131], a[64:67], a[28:31], v[128:131]
  ds_read_b128 a[4:7], v16 offset:2048
  v_mfma_f32_16x16x32_bf16 v[36:39], a[68:71], a[16:19], v[36:39]
  ds_read_b128 a[8:11], v16 offset:4096
  v_mfma_f32_16x16x32_bf16 v[68:71], a[68:71], a[20:23], v[68:71]
  buffer_load_dwordx4 v9, s[20:23], s28 offen offset:1024 lds
  ds_read_b128 a[12:15], v16 offset:6144
  v_mfma_f32_16x16x32_bf16 v[100:103], a[68:71], a[24:27], v[100:103]
  ds_read_b64_tr_b16 a[36:37], v19 offset:0
  v_mfma_f32_16x16x32_bf16 v[132:135], a[68:71], a[28:31], v[132:135]
  ds_read_b64_tr_b16 a[38:39], v19 offset:2048
  v_mfma_f32_16x16x32_bf16 v[40:43], a[72:75], a[16:19], v[40:43]
  ds_read_b64_tr_b16 a[40:41], v20 offset:0
  v_mfma_f32_16x16x32_bf16 v[72:75], a[72:75], a[20:23], v[72:75]
  ds_read_b64_tr_b16 a[42:43], v20 offset:2048
  v_mfma_f32_16x16x32_bf16 v[104:107], a[72:75], a[24:27], v[104:107]
  buffer_load_dwordx4 v10, s[20:23], s28 offen offset:2048 lds
  v_mfma_f32_16x16x32_bf16 v[136:139], a[72:75], a[28:31], v[136:139]
  ds_read_b64_tr_b16 a[44:45], v21 offset:0
  v_mfma_f32_16x16x32_bf16 v[44:47], a[76:79], a[16:19], v[44:47]
  ds_read_b64_tr_b16 a[46:47], v21 offset:2048
  v_mfma_f32_16x16x32_bf16 v[76:79], a[76:79], a[20:23], v[76:79]
  ds_read_b64_tr_b16 a[48:49], v18 offset:8192
  v_mfma_f32_16x16x32_bf16 v[108:111], a[76:79], a[24:27], v[108:111]
  ds_read_b64_tr_b16 a[50:51], v18 offset:10240
  v_mfma_f32_16x16x32_bf16 v[140:143], a[76:79], a[28:31], v[140:143]
  buffer_load_dwordx4 v11, s[20:23], s28 offen offset:3072 lds
  ds_read_b64_tr_b16 a[52:53], v19 offset:8192
  v_mfma_f32_16x16x32_bf16 v[48:51], a[80:83], a[16:19], v[48:51]
  s_bfe_u32 s56, 0x302010e, s55
  s_add_u32 s54, s54, s56
  s_add_u32 s55, s55, 8
  v_mfma_f32_16x16x32_bf16 v[80:83], a[80:83], a[20:23], v[80:83]
  s_and_b32 s55, s55, 0x8001f
  s_and_b32 s54, s54, 15
  s_lshl_b32 s28, s54, 19
  v_mfma_f32_16x16x32_bf16 v[112:115], a[80:83], a[24:27], v[112:115]
  s_mov_b32 m0, s88
  ds_read_b64_tr_b16 a[54:55], v19 offset:10240
  ds_read_b64_tr_b16 a[56:57], v20 offset:8192
  v_mfma_f32_16x16x32_bf16 v[144:147], a[80:83], a[28:31], v[144:147]
  ds_read_b64_tr_b16 a[58:59], v20 offset:10240
  ds_read_b64_tr_b16 a[60:61], v21 offset:8192
  v_mfma_f32_16x16x32_bf16 v[52:55], a[84:87], a[16:19], v[52:55]
  buffer_load_dwordx4 v4, s[8:11], s26 offen offset:0 lds
  ds_read_b64_tr_b16 a[62:63], v21 offset:10240
  v_mfma_f32_16x16x32_bf16 v[84:87], a[84:87], a[20:23], v[84:87]
  v_mfma_f32_16x16x32_bf16 v[116:119], a[84:87], a[24:27], v[116:119]
  v_mfma_f32_16x16x32_bf16 v[148:151], a[84:87], a[28:31], v[148:151]
  v_mfma_f32_16x16x32_bf16 v[56:59], a[88:91], a[16:19], v[56:59]
  v_mfma_f32_16x16x32_bf16 v[88:91], a[88:91], a[20:23], v[88:91]
  buffer_load_dwordx4 v5, s[8:11], s26 offen offset:1024 lds
  v_mfma_f32_16x16x32_bf16 v[120:123], a[88:91], a[24:27], v[120:123]
  v_mfma_f32_16x16x32_bf16 v[152:155], a[88:91], a[28:31], v[152:155]
  v_mfma_f32_16x16x32_bf16 v[60:63], a[92:95], a[16:19], v[60:63]
  v_mfma_f32_16x16x32_bf16 v[92:95], a[92:95], a[20:23], v[92:95]
  v_mfma_f32_16x16x32_bf16 v[124:127], a[92:95], a[24:27], v[124:127]
  v_mfma_f32_16x16x32_bf16 v[156:159], a[92:95], a[28:31], v[156:159]
  s_waitcnt lgkmcnt(0)
  v_mfma_f32_16x16x32_bf16 v[32:35], a[32:35], a[0:3], v[32:35]
  buffer_load_dwordx4 v6, s[8:11], s26 offen offset:2048 lds
  ds_read_b128 a[16:19], v17 offset:0
  v_mfma_f32_16x16x32_bf16 v[64:67], a[32:35], a[4:7], v[64:67]
  ds_read_b64_tr_b16 a[64:65], v18 offset:4096
  v_mfma_f32_16x16x32_bf16 v[96:99], a[32:35], a[8:11], v[96:99]
  ds_read_b64_tr_b16 a[66:67], v18 offset:6144
  v_mfma_f32_16x16x32_bf16 v[128:131], a[32:35], a[12:15], v[128:131]
  ds_read_b128 a[20:23], v17 offset:2048
  v_mfma_f32_16x16x32_bf16 v[36:39], a[36:39], a[0:3], v[36:39]
  buffer_load_dwordx4 v7, s[8:11], s26 offen offset:3072 lds
  ds_read_b128 a[24:27], v17 offset:4096
  v_mfma_f32_16x16x32_bf16 v[68:71], a[36:39], a[4:7], v[68:71]
  s_add_u32 m0, s88, 4096
  ds_read_b128 a[28:31], v17 offset:6144
  v_mfma_f32_16x16x32_bf16 v[100:103], a[36:39], a[8:11], v[100:103]
  ds_read_b64_tr_b16 a[68:69], v19 offset:4096
  v_mfma_f32_16x16x32_bf16 v[132:135], a[36:39], a[12:15], v[132:135]
  ds_read_b64_tr_b16 a[70:71], v19 offset:6144
  v_mfma_f32_16x16x32_bf16 v[40:43], a[40:43], a[0:3], v[40:43]
  buffer_load_dwordx4 v4, s[8:11], s27 offen offset:0 lds
  ds_read_b64_tr_b16 a[72:73], v20 offset:4096
  v_mfma_f32_16x16x32_bf16 v[72:75], a[40:43], a[4:7], v[72:75]
  ds_read_b64_tr_b16 a[74:75], v20 offset:6144
  v_mfma_f32_16x16x32_bf16 v[104:107], a[40:43], a[8:11], v[104:107]
  v_mfma_f32_16x16x32_bf16 v[136:139], a[40:43], a[12:15], v[136:139]
  ds_read_b64_tr_b16 a[76:77], v21 offset:4096
  v_mfma_f32_16x16x32_bf16 v[44:47], a[44:47], a[0:3], v[44:47]
  buffer_load_dwordx4 v5, s[8:11], s27 offen offset:1024 lds
  ds_read_b64_tr_b16 a[78:79], v21 offset:6144
  v_mfma_f32_16x16x32_bf16 v[76:79], a[44:47], a[4:7], v[76:79]
  ds_read_b64_tr_b16 a[80:81], v18 offset:12288
  v_mfma_f32_16x16x32_bf16 v[108:111], a[44:47], a[8:11], v[108:111]
  ds_read_b64_tr_b16 a[82:83], v18 offset:14336
  v_mfma_f32_16x16x32_bf16 v[140:143], a[44:47], a[12:15], v[140:143]
  ds_read_b64_tr_b16 a[84:85], v19 offset:12288
  v_mfma_f32_16x16x32_bf16 v[48:51], a[48:51], a[0:3], v[48:51]
  buffer_load_dwordx4 v6, s[8:11], s27 offen offset:2048 lds
  ds_read_b64_tr_b16 a[86:87], v19 offset:14336
  v_mfma_f32_16x16x32_bf16 v[80:83], a[48:51], a[4:7], v[80:83]
  ds_read_b64_tr_b16 a[88:89], v20 offset:12288
  v_mfma_f32_16x16x32_bf16 v[112:115], a[48:51], a[8:11], v[112:115]
  ds_read_b64_tr_b16 a[90:91], v20 offset:14336
  v_mfma_f32_16x16x32_bf16 v[144:147], a[48:51], a[12:15], v[144:147]
  ds_read_b64_tr_b16 a[92:93], v21 offset:12288
  v_mfma_f32_16x16x32_bf16 v[52:55], a[52:55], a[0:3], v[52:55]
  buffer_load_dwordx4 v7, s[8:11], s27 offen offset:3072 lds
  ds_read_b64_tr_b16 a[94:95], v21 offset:14336
  v_mfma_f32_16x16x32_bf16 v[84:87], a[52:55], a[4:7], v[84:87]
  s_bfe_u32 s29, 0x302010e, s53
  s_add_u32 s52, s52, s29
  s_add_u32 s53, s53, 8
  v_mfma_f32_16x16x32_bf16 v[116:119], a[52:55], a[8:11], v[116:119]
  s_and_b32 s53, s53, 0x8001f
  s_and_b32 s52, s52, 15
  s_lshl_b32 s29, s52, 7
  v_mfma_f32_16x16x32_bf16 v[148:151], a[52:55], a[12:15], v[148:151]
  s_or_b32 s26, s30, s29
  s_or_b32 s27, s31, s29
  v_mfma_f32_16x16x32_bf16 v[56:59], a[56:59], a[0:3], v[56:59]
  s_add_u32 s88, s88, s90
  s_add_u32 s89, s89, 1
  s_cmp_eq_u32 s89, 3
  s_cselect_b32 s89, 0, s89
  s_cselect_b32 s90, s91, s92
  v_mfma_f32_16x16x32_bf16 v[88:91], a[56:59], a[4:7], v[88:91]
  s_add_u32 s68, s68, s70
  s_add_u32 s69, s69, 1
  s_cmp_eq_u32 s69, 3
  s_cselect_b32 s69, 0, s69
  s_cselect_b32 s70, s71, s72
  v_mfma_f32_16x16x32_bf16 v[120:123], a[56:59], a[8:11], v[120:123]
  v_add_u32 v16, s90, v16
  v_add_u32 v17, s90, v17
  v_mfma_f32_16x16x32_bf16 v[152:155], a[56:59], a[12:15], v[152:155]
  v_add_u32 v18, s70, v18
  v_add_u32 v19, s70, v19
  v_mfma_f32_16x16x32_bf16 v[60:63], a[60:63], a[0:3], v[60:63]
  v_add_u32 v20, s70, v20
  v_add_u32 v21, s70, v21
  v_mfma_f32_16x16x32_bf16 v[92:95], a[60:63], a[4:7], v[92:95]
  v_mfma_f32_16x16x32_bf16 v[124:127], a[60:63], a[8:11], v[124:127]
  v_mfma_f32_16x16x32_bf16 v[156:159], a[60:63], a[12:15], v[156:159]
  s_waitcnt vmcnt(12) lgkmcnt(0)
  s_barrier
  s_mov_b32 s5, 0x40000
Ltg_3:
  v_readfirstlane_b32 s94, v22
  v_readfirstlane_b32 s95, v23
  s_nop 0
  s_cmp_lg_u32 s95, 0
  s_cbranch_scc1 Lpolld_4
  s_sleep 4
  s_mov_b32 s12, s84
  s_mov_b32 s13, s85
  s_mov_b32 s14, 256
  s_mov_b32 s15, 0x00020000
  buffer_load_dwordx2 v[22:23], off, s[12:15], 0 sc1
  s_sub_u32 s5, s5, 1
  s_waitcnt vmcnt(0)
  s_cbranch_scc0 Ltg_3
Lpolld_4:
  v_mov_b32 v3, 0x40000000
  v_mov_b32 v22, s94
  v_cmp_eq_u32 vcc, 0, v0
  v_mov_b32 v23, s95
  s_nop 0
  v_cndmask_b32_e64 v3, v3, 0, vcc
  buffer_store_dwordx2 v[22:23], v3, s[96:99], s34 offen sc1
  v_mfma_f32_16x16x32_bf16 v[32:35], a[64:67], a[16:19], v[32:35]
  s_mov_b32 m0, s68
  ds_read_b128 a[0:3], v16 offset:0
  v_mfma_f32_16x16x32_bf16 v[64:67], a[64:67], a[20:23], v[64:67]
  buffer_load_dwordx4 v8, s[20:23], s28 offen offset:0 lds
  ds_read_b64_tr_b16 a[32:33], v18 offset:0
  v_mfma_f32_16x16x32_bf16 v[96:99], a[64:67], a[24:27], v[96:99]
  ds_read_b64_tr_b16 a[34:35], v18 offset:2048
  v_mfma_f32_16x16x32_bf16 v[128:131], a[64:67], a[28:31], v[128:131]
  ds_read_b128 a[4:7], v16 offset:2048
  v_mfma_f32_16x16x32_bf16 v[36:39], a[68:71], a[16:19], v[36:39]
  ds_read_b128 a[8:11], v16 offset:4096
  v_mfma_f32_16x16x32_bf16 v[68:71], a[68:71], a[20:23], v[68:71]
  buffer_load_dwordx4 v9, s[20:23], s28 offen offset:1024 lds
  ds_read_b128 a[12:15], v16 offset:6144
  v_mfma_f32_16x16x32_bf16 v[100:103], a[68:71], a[24:27], v[100:103]
  ds_read_b64_tr_b16 a[36:37], v19 offset:0
  v_mfma_f32_16x16x32_bf16 v[132:135], a[68:71], a[28:31], v[132:135]
  ds_read_b64_tr_b16 a[38:39], v19 offset:2048
  v_mfma_f32_16x16x32_bf16 v[40:43], a[72:75], a[16:19], v[40:43]
  ds_read_b64_tr_b16 a[40:41], v20 offset:0
  v_mfma_f32_16x16x32_bf16 v[72:75], a[72:75], a[20:23], v[72:75]
  ds_read_b64_tr_b16 a[42:43], v20 offset:2048
  v_mfma_f32_16x16x32_bf16 v[104:107], a[72:75], a[24:27], v[104:107]
  buffer_load_dwordx4 v10, s[20:23], s28 offen offset:2048 lds
  v_mfma_f32_16x16x32_bf16 v[136:139], a[72:75], a[28:31], v[136:139]
  ds_read_b64_tr_b16 a[44:45], v21 offset:0
  v_mfma_f32_16x16x32_bf16 v[44:47], a[76:79], a[16:19], v[44:47]
  ds_read_b64_tr_b16 a[46:47], v21 offset:2048
  v_mfma_f32_16x16x32_bf16 v[76:79], a[76:79], a[20:23], v[76:79]
  ds_read_b64_tr_b16 a[48:49], v18 offset:8192
  v_mfma_f32_16x16x32_bf16 v[108:111], a[76:79], a[24:27], v[108:111]
  ds_read_b64_tr_b16 a[50:51], v18 offset:10240
  v_mfma_f32_16x16x32_bf16 v[140:143], a[76:79], a[28:31], v[140:143]
  buffer_load_dwordx4 v11, s[20:23], s28 offen offset:3072 lds
  ds_read_b64_tr_b16 a[52:53], v19 offset:8192
  v_mfma_f32_16x16x32_bf16 v[48:51], a[80:83], a[16:19], v[48:51]
  s_bfe_u32 s56, 0x302010e, s55
  s_add_u32 s54, s54, s56
  s_add_u32 s55, s55, 8
  v_mfma_f32_16x16x32_bf16 v[80:83], a[80:83], a[20:23], v[80:83]
  s_and_b32 s55, s55, 0x8001f
  s_and_b32 s54, s54, 15
  s_lshl_b32 s28, s54, 19
  v_mfma_f32_16x16x32_bf16 v[112:115], a[80:83], a[24:27], v[112:115]
  s_mov_b32 m0, s88
  ds_read_b64_tr_b16 a[54:55], v19 offset:10240
  ds_read_b64_tr_b16 a[56:57], v20 offset:8192
  v_mfma_f32_16x16x32_bf16 v[144:147], a[80:83], a[28:31], v[144:147]
  ds_read_b64_tr_b16 a[58:59], v20 offset:10240
  ds_read_b64_tr_b16 a[60:61], v21 offset:8192
  v_mfma_f32_16x16x32_bf16 v[52:55], a[84:87], a[16:19], v[52:55]
  buffer_load_dwordx4 v4, s[8:11], s26 offen offset:0 lds
  ds_read_b64_tr_b16 a[62:63], v21 offset:10240
  v_mfma_f32_16x16x32_bf16 v[84:87], a[84:87], a[20:23], v[84:87]
  v_mfma_f32_16x16x32_bf16 v[116:119], a[84:87], a[24:27], v[116:119]
  v_mfma_f32_16x16x32_bf16 v[148:151], a[84:87], a[28:31], v[148:151]
  v_mfma_f32_16x16x32_bf16 v[56:59], a[88:91], a[16:19], v[56:59]
  v_mfma_f32_16x16x32_bf16 v[88:91], a[88:91], a[20:23], v[88:91]
  buffer_load_dwordx4 v5, s[8:11], s26 offen offset:1024 lds
  v_mfma_f32_16x16x32_bf16 v[120:123], a[88:91], a[24:27], v[120:123]
  v_mfma_f32_16x16x32_bf16 v[152:155], a[88:91], a[28:31], v[152:155]
  v_mfma_f32_16x16x32_bf16 v[60:63], a[92:95], a[16:19], v[60:63]
  v_mfma_f32_16x16x32_bf16 v[92:95], a[92:95], a[20:23], v[92:95]
  v_mfma_f32_16x16x32_bf16 v[124:127], a[92:95], a[24:27], v[124:127]
  v_mfma_f32_16x16x32_bf16 v[156:159], a[92:95], a[28:31], v[156:159]
  s_waitcnt lgkmcnt(0)
  v_mfma_f32_16x16x32_bf16 v[32:35], a[32:35], a[0:3], v[32:35]
  buffer_load_dwordx4 v6, s[8:11], s26 offen offset:2048 lds
  ds_read_b128 a[16:19], v17 offset:0
  v_mfma_f32_16x16x32_bf16 v[64:67], a[32:35], a[4:7], v[64:67]
  ds_read_b64_tr_b16 a[64:65], v18 offset:4096
  v_mfma_f32_16x16x32_bf16 v[96:99], a[32:35], a[8:11], v[96:99]
  ds_read_b64_tr_b16 a[66:67], v18 offset:6144
  v_mfma_f32_16x16x32_bf16 v[128:131], a[32:35], a[12:15], v[128:131]
  ds_read_b128 a[20:23], v17 offset:2048
  v_mfma_f32_16x16x32_bf16 v[36:39], a[36:39], a[0:3], v[36:39]
  buffer_load_dwordx4 v7, s[8:11], s26 offen offset:3072 lds
  ds_read_b128 a[24:27], v17 offset:4096
  v_mfma_f32_16x16x32_bf16 v[68:71], a[36:39], a[4:7], v[68:71]
  s_add_u32 m0, s88, 4096
  ds_read_b128 a[28:31], v17 offset:6144
  v_mfma_f32_16x16x32_bf16 v[100:103], a[36:39], a[8:11], v[100:103]
  ds_read_b64_tr_b16 a[68:69], v19 offset:4096
  v_mfma_f32_16x16x32_bf16 v[132:135], a[36:39], a[12:15], v[132:135]
  ds_read_b64_tr_b16 a[70:71], v19 offset:6144
  v_mfma_f32_16x16x32_bf16 v[40:43], a[40:43], a[0:3], v[40:43]
  buffer_load_dwordx4 v4, s[8:11], s27 offen offset:0 lds
  ds_read_b64_tr_b16 a[72:73], v20 offset:4096
  v_mfma_f32_16x16x32_bf16 v[72:75], a[40:43], a[4:7], v[72:75]
  ds_read_b64_tr_b16 a[74:75], v20 offset:6144
  v_mfma_f32_16x16x32_bf16 v[104:107], a[40:43], a[8:11], v[104:107]
  v_mfma_f32_16x16x32_bf16 v[136:139], a[40:43], a[12:15], v[136:139]
  ds_read_b64_tr_b16 a[76:77], v21 offset:4096
  v_mfma_f32_16x16x32_bf16 v[44:47], a[44:47], a[0:3], v[44:47]
  buffer_load_dwordx4 v5, s[8:11], s27 offen offset:1024 lds
  ds_read_b64_tr_b16 a[78:79], v21 offset:6144
  v_mfma_f32_16x16x32_bf16 v[76:79], a[44:47], a[4:7], v[76:79]
  ds_read_b64_tr_b16 a[80:81], v18 offset:12288
  v_mfma_f32_16x16x32_bf16 v[108:111], a[44:47], a[8:11], v[108:111]
  ds_read_b64_tr_b16 a[82:83], v18 offset:14336
  v_mfma_f32_16x16x32_bf16 v[140:143], a[44:47], a[12:15], v[140:143]
  ds_read_b64_tr_b16 a[84:85], v19 offset:12288
  v_mfma_f32_16x16x32_bf16 v[48:51], a[48:51], a[0:3], v[48:51]
  buffer_load_dwordx4 v6, s[8:11], s27 offen offset:2048 lds
  ds_read_b64_tr_b16 a[86:87], v19 offset:14336
  v_mfma_f32_16x16x32_bf16 v[80:83], a[48:51], a[4:7], v[80:83]
  ds_read_b64_tr_b16 a[88:89], v20 offset:12288
  v_mfma_f32_16x16x32_bf16 v[112:115], a[48:51], a[8:11], v[112:115]
  ds_read_b64_tr_b16 a[90:91], v20 offset:14336
  v_mfma_f32_16x16x32_bf16 v[144:147], a[48:51], a[12:15], v[144:147]
  ds_read_b64_tr_b16 a[92:93], v21 offset:12288
  v_mfma_f32_16x16x32_bf16 v[52:55], a[52:55], a[0:3], v[52:55]
  buffer_load_dwordx4 v7, s[8:11], s27 offen offset:3072 lds
  ds_read_b64_tr_b16 a[94:95], v21 offset:14336
  v_mfma_f32_16x16x32_bf16 v[84:87], a[52:55], a[4:7], v[84:87]
  s_bfe_u32 s29, 0x302010e, s53
  s_add_u32 s52, s52, s29
  s_add_u32 s53, s53, 8
  v_mfma_f32_16x16x32_bf16 v[116:119], a[52:55], a[8:11], v[116:119]
  s_and_b32 s53, s53, 0x8001f
  s_and_b32 s52, s52, 15
  s_lshl_b32 s29, s52, 7
  v_mfma_f32_16x16x32_bf16 v[148:151], a[52:55], a[12:15], v[148:151]
  s_or_b32 s26, s30, s29
  s_or_b32 s27, s31, s29
  v_mfma_f32_16x16x32_bf16 v[56:59], a[56:59], a[0:3], v[56:59]
  s_add_u32 s88, s88, s90
  s_add_u32 s89, s89, 1
  s_cmp_eq_u32 s89, 3
  s_cselect_b32 s89, 0, s89
  s_cselect_b32 s90, s91, s92
  v_mfma_f32_16x16x32_bf16 v[88:91], a[56:59], a[4:7], v[88:91]
  s_add_u32 s68, s68, s70
  s_add_u32 s69, s69, 1
  s_cmp_eq_u32 s69, 3
  s_cselect_b32 s69, 0, s69
  s_cselect_b32 s70, s71, s72
  v_mfma_f32_16x16x32_bf16 v[120:123], a[56:59], a[8:11], v[120:123]
  v_add_u32 v16, s90, v16
  v_add_u32 v17, s90, v17
  v_mfma_f32_16x16x32_bf16 v[152:155], a[56:59], a[12:15], v[152:155]
  v_add_u32 v18, s70, v18
  v_add_u32 v19, s70, v19
  v_mfma_f32_16x16x32_bf16 v[60:63], a[60:63], a[0:3], v[60:63]
  v_add_u32 v20, s70, v20
  v_add_u32 v21, s70, v21
  v_mfma_f32_16x16x32_bf16 v[92:95], a[60:63], a[4:7], v[92:95]
  v_mfma_f32_16x16x32_bf16 v[124:127], a[60:63], a[8:11], v[124:127]
  v_mfma_f32_16x16x32_bf16 v[156:159], a[60:63], a[12:15], v[156:159]
  s_mov_b32 s35, 1
  s_waitcnt vmcnt(12) lgkmcnt(0)
  s_barrier
  .p2align 6
Lp3_loop:
  v_mfma_f32_16x16x32_bf16 v[32:35], a[64:67], a[16:19], v[32:35]
  s_mov_b32 m0, s68
  ds_read_b128 a[0:3], v16 offset:0
  v_mfma_f32_16x16x32_bf16 v[64:67], a[64:67], a[20:23], v[64:67]
  buffer_load_dwordx4 v8, s[20:23], s28 offen offset:0 lds
  ds_read_b64_tr_b16 a[32:33], v18 offset:0
  v_mfma_f32_16x16x32_bf16 v[96:99], a[64:67], a[24:27], v[96:99]
  ds_read_b64_tr_b16 a[34:35], v18 offset:2048
  v_mfma_f32_16x16x32_bf16 v[128:131], a[64:67], a[28:31], v[128:131]
  ds_read_b128 a[4:7], v16 offset:2048
  v_mfma_f32_16x16x32_bf16 v[36:39], a[68:71], a[16:19], v[36:39]
  ds_read_b128 a[8:11], v16 offset:4096
  v_mfma_f32_16x16x32_bf16 v[68:71], a[68:71], a[20:23], v[68:71]
  buffer_load_dwordx4 v9, s[20:23], s28 offen offset:1024 lds
  ds_read_b128 a[12:15], v16 offset:6144
  v_mfma_f32_16x16x32_bf16 v[100:103], a[68:71], a[24:27], v[100:103]
  ds_read_b64_tr_b16 a[36:37], v19 offset:0
  v_mfma_f32_16x16x32_bf16 v[132:135], a[68:71], a[28:31], v[132:135]
  ds_read_b64_tr_b16 a[38:39], v19 offset:2048
  v_mfma_f32_16x16x32_bf16 v[40:43], a[72:75], a[16:19], v[40:43]
  ds_read_b64_tr_b16 a[40:41], v20 offset:0
  v_mfma_f32_16x16x32_bf16 v[72:75], a[72:75], a[20:23], v[72:75]
  ds_read_b64_tr_b16 a[42:43], v20 offset:2048
  v_mfma_f32_16x16x32_bf16 v[104:107], a[72:75], a[24:27], v[104:107]
  buffer_load_dwordx4 v10, s[20:23], s28 offen offset:2048 lds
  v_mfma_f32_16x16x32_bf16 v[136:139], a[72:75], a[28:31], v[136:139]
  ds_read_b64_tr_b16 a[44:45], v21 offset:0
  v_mfma_f32_16x16x32_bf16 v[44:47], a[76:79], a[16:19], v[44:47]
  ds_read_b64_tr_b16 a[46:47], v21 offset:2048
  v_mfma_f32_16x16x32_bf16 v[76:79], a[76:79], a[20:23], v[76:79]
  ds_read_b64_tr_b16 a[48:49], v18 offset:8192
  v_mfma_f32_16x16x32_bf16 v[108:111], a[76:79], a[24:27], v[108:111]
  ds_read_b64_tr_b16 a[50:51], v18 offset:10240
  v_mfma_f32_16x16x32_bf16 v[140:143], a[76:79], a[28:31], v[140:143]
  buffer_load_dwordx4 v11, s[20:23], s28 offen offset:3072 lds
  ds_read_b64_tr_b16 a[52:53], v19 offset:8192
  v_mfma_f32_16x16x32_bf16 v[48:51], a[80:83], a[16:19], v[48:51]
  s_bfe_u32 s56, 0x302010e, s55
  s_add_u32 s54, s54, s56
  s_add_u32 s55, s55, 8
  v_mfma_f32_16x16x32_bf16 v[80:83], a[80:83], a[20:23], v[80:83]
  s_and_b32 s55, s55, 0x8001f
  s_and_b32 s54, s54, 15
  s_lshl_b32 s28, s54, 19
  v_mfma_f32_16x16x32_bf16 v[112:115], a[80:83], a[24:27], v[112:115]
  s_mov_b32 m0, s88
  ds_read_b64_tr_b16 a[54:55], v19 offset:10240
  ds_read_b64_tr_b16 a[56:57], v20 offset:8192
  v_mfma_f32_16x16x32_bf16 v[144:147], a[80:83], a[28:31], v[144:147]
  ds_read_b64_tr_b16 a[58:59], v20 offset:10240
  ds_read_b64_tr_b16 a[60:61], v21 offset:8192
  v_mfma_f32_16x16x32_bf16 v[52:55], a[84:87], a[16:19], v[52:55]
  buffer_load_dwordx4 v4, s[8:11], s26 offen offset:0 lds
  ds_read_b64_tr_b16 a[62:63], v21 offset:10240
  v_mfma_f32_16x16x32_bf16 v[84:87], a[84:87], a[20:23], v[84:87]
  v_mfma_f32_16x16x32_bf16 v[116:119], a[84:87], a[24:27], v[116:119]
  v_mfma_f32_16x16x32_bf16 v[148:151], a[84:87], a[28:31], v[148:151]
  v_mfma_f32_16x16x32_bf16 v[56:59], a[88:91], a[16:19], v[56:59]
  v_mfma_f32_16x16x32_bf16 v[88:91], a[88:91], a[20:23], v[88:91]
  buffer_load_dwordx4 v5, s[8:11], s26 offen offset:1024 lds
  v_mfma_f32_16x16x32_bf16 v[120:123], a[88:91], a[24:27], v[120:123]
  v_mfma_f32_16x16x32_bf16 v[152:155], a[88:91], a[28:31], v[152:155]
  v_mfma_f32_16x16x32_bf16 v[60:63], a[92:95], a[16:19], v[60:63]
  v_mfma_f32_16x16x32_bf16 v[92:95], a[92:95], a[20:23], v[92:95]
  v_mfma_f32_16x16x32_bf16 v[124:127], a[92:95], a[24:27], v[124:127]
  v_mfma_f32_16x16x32_bf16 v[156:159], a[92:95], a[28:31], v[156:159]
  s_waitcnt lgkmcnt(0)
  v_mfma_f32_16x16x32_bf16 v[32:35], a[32:35], a[0:3], v[32:35]
  buffer_load_dwordx4 v6, s[8:11], s26 offen offset:2048 lds
  ds_read_b128 a[16:19], v17 offset:0
  v_mfma_f32_16x16x32_bf16 v[64:67], a[32:35], a[4:7], v[64:67]
  ds_read_b64_tr_b16 a[64:65], v18 offset:4096
  v_mfma_f32_16x16x32_bf16 v[96:99], a[32:35], a[8:11], v[96:99]
  ds_read_b64_tr_b16 a[66:67], v18 offset:6144
  v_mfma_f32_16x16x32_bf16 v[128:131], a[32:35], a[12:15], v[128:131]
  ds_read_b128 a[20:23], v17 offset:2048
  v_mfma_f32_16x16x32_bf16 v[36:39], a[36:39], a[0:3], v[36:39]
  buffer_load_dwordx4 v7, s[8:11], s26 offen offset:3072 lds
  ds_read_b128 a[24:27], v17 offset:4096
  v_mfma_f32_16x16x32_bf16 v[68:71], a[36:39], a[4:7], v[68:71]
  s_add_u32 m0, s88, 4096
  ds_read_b128 a[28:31], v17 offset:6144
  v_mfma_f32_16x16x32_bf16 v[100:103], a[36:39], a[8:11], v[100:103]
  ds_read_b64_tr_b16 a[68:69], v19 offset:4096
  v_mfma_f32_16x16x32_bf16 v[132:135], a[36:39], a[12:15], v[132:135]
  ds_read_b64_tr_b16 a[70:71], v19 offset:6144
  v_mfma_f32_16x16x32_bf16 v[40:43], a[40:43], a[0:3], v[40:43]
  buffer_load_dwordx4 v4, s[8:11], s27 offen offset:0 lds
  ds_read_b64_tr_b16 a[72:73], v20 offset:4096
  v_mfma_f32_16x16x32_bf16 v[72:75], a[40:43], a[4:7], v[72:75]
  ds_read_b64_tr_b16 a[74:75], v20 offset:6144
  v_mfma_f32_16x16x32_bf16 v[104:107], a[40:43], a[8:11], v[104:107]
  v_mfma_f32_16x16x32_bf16 v[136:139], a[40:43], a[12:15], v[136:139]
  ds_read_b64_tr_b16 a[76:77], v21 offset:4096
  v_mfma_f32_16x16x32_bf16 v[44:47], a[44:47], a[0:3], v[44:47]
  buffer_load_dwordx4 v5, s[8:11], s27 offen offset:1024 lds
  ds_read_b64_tr_b16 a[78:79], v21 offset:6144
  v_mfma_f32_16x16x32_bf16 v[76:79], a[44:47], a[4:7], v[76:79]
  ds_read_b64_tr_b16 a[80:81], v18 offset:12288
  v_mfma_f32_16x16x32_bf16 v[108:111], a[44:47], a[8:11], v[108:111]
  ds_read_b64_tr_b16 a[82:83], v18 offset:14336
  v_mfma_f32_16x16x32_bf16 v[140:143], a[44:47], a[12:15], v[140:143]
  ds_read_b64_tr_b16 a[84:85], v19 offset:12288
  v_mfma_f32_16x16x32_bf16 v[48:51], a[48:51], a[0:3], v[48:51]
  buffer_load_dwordx4 v6, s[8:11], s27 offen offset:2048 lds
  ds_read_b64_tr_b16 a[86:87], v19 offset:14336
  v_mfma_f32_16x16x32_bf16 v[80:83], a[48:51], a[4:7], v[80:83]
  ds_read_b64_tr_b16 a[88:89], v20 offset:12288
  v_mfma_f32_16x16x32_bf16 v[112:115], a[48:51], a[8:11], v[112:115]
  ds_read_b64_tr_b16 a[90:91], v20 offset:14336
  v_mfma_f32_16x16x32_bf16 v[144:147], a[48:51], a[12:15], v[144:147]
  ds_read_b64_tr_b16 a[92:93], v21 offset:12288
  v_mfma_f32_16x16x32_bf16 v[52:55], a[52:55], a[0:3], v[52:55]
  buffer_load_dwordx4 v7, s[8:11], s27 offen offset:3072 lds
  ds_read_b64_tr_b16 a[94:95], v21 offset:14336
  v_mfma_f32_16x16x32_bf16 v[84:87], a[52:55], a[4:7], v[84:87]
  s_bfe_u32 s29, 0x302010e, s53
  s_add_u32 s52, s52, s29
  s_add_u32 s53, s53, 8
  v_mfma_f32_16x16x32_bf16 v[116:119], a[52:55], a[8:11], v[116:119]
  s_and_b32 s53, s53, 0x8001f
  s_and_b32 s52, s52, 15
  s_lshl_b32 s29, s52, 7
  v_mfma_f32_16x16x32_bf16 v[148:151], a[52:55], a[12:15], v[148:151]
  s_or_b32 s26, s30, s29
  s_or_b32 s27, s31, s29
  v_mfma_f32_16x16x32_bf16 v[56:59], a[56:59], a[0:3], v[56:59]
  s_add_u32 s88, s88, s90
  s_add_u32 s89, s89, 1
  s_cmp_eq_u32 s89, 3
  s_cselect_b32 s89, 0, s89
  s_cselect_b32 s90, s91, s92
  v_mfma_f32_16x16x32_bf16 v[88:91], a[56:59], a[4:7], v[88:91]
  s_add_u32 s68, s68, s70
  s_add_u32 s69, s69, 1
  s_cmp_eq_u32 s69, 3
  s_cselect_b32 s69, 0, s69
  s_cselect_b32 s70, s71, s72
  v_mfma_f32_16x16x32_bf16 v[120:123], a[56:59], a[8:11], v[120:123]
  v_add_u32 v16, s90, v16
  v_add_u32 v17, s90, v17
  v_mfma_f32_16x16x32_bf16 v[152:155], a[56:59], a[12:15], v[152:155]
  v_add_u32 v18, s70, v18
  v_add_u32 v19, s70, v19
  v_mfma_f32_16x16x32_bf16 v[60:63], a[60:63], a[0:3], v[60:63]
  v_add_u32 v20, s70, v20
  v_add_u32 v21, s70, v21
  v_mfma_f32_16x16x32_bf16 v[92:95], a[60:63], a[4:7], v[92:95]
  s_waitcnt vmcnt(12) lgkmcnt(0)
  s_barrier
  v_mfma_f32_16x16x32_bf16 v[124:127], a[60:63], a[8:11], v[124:127]
  s_sub_u32 s35, s35, 1
  v_mfma_f32_16x16x32_bf16 v[156:159], a[60:63], a[12:15], v[156:159]
  s_cmp_lg_u32 s35, 0
  s_cbranch_scc1 Lp3_loop
  s_lshr_b32 s34, s24, 1
  s_lshl_b32 s34, s34, 11
  v_and_b32 v3, 7, v1
  v_lshlrev_b32 v3, 7, v3
  v_mfma_f32_16x16x32_bf16 v[32:35], a[64:67], a[16:19], v[32:35]
  buffer_load_dwordx2 v[22:23], v3, s[96:99], s34 offen sc1
  ds_read_b128 a[0:3], v16 offset:0
  v_mfma_f32_16x16x32_bf16 v[64:67], a[64:67], a[20:23], v[64:67]
  s_mov_b32 m0, s68
  ds_read_b64_tr_b16 a[32:33], v18 offset:0
  v_mfma_f32_16x16x32_bf16 v[96:99], a[64:67], a[24:27], v[96:99]
  ds_read_b64_tr_b16 a[34:35], v18 offset:2048
  v_mfma_f32_16x16x32_bf16 v[128:131], a[64:67], a[28:31], v[128:131]
  ds_read_b128 a[4:7], v16 offset:2048
  v_mfma_f32_16x16x32_bf16 v[36:39], a[68:71], a[16:19], v[36:39]
  buffer_load_dwordx4 v8, s[20:23], s28 offen offset:0 lds
  ds_read_b128 a[8:11], v16 offset:4096
  v_mfma_f32_16x16x32_bf16 v[68:71], a[68:71], a[20:23], v[68:71]
  ds_read_b128 a[12:15], v16 offset:6144
  v_mfma_f32_16x16x32_bf16 v[100:103], a[68:71], a[24:27], v[100:103]
  ds_read_b64_tr_b16 a[36:37], v19 offset:0
  v_mfma_f32_16x16x32_bf16 v[132:135], a[68:71], a[28:31], v[132:135]
  ds_read_b64_tr_b16 a[38:39], v19 offset:2048
  v_mfma_f32_16x16x32_bf16 v[40:43], a[72:75], a[16:19], v[40:43]
  buffer_load_dwordx4 v9, s[20:23], s28 offen offset:1024 lds
  ds_read_b64_tr_b16 a[40:41], v20 offset:0
  v_mfma_f32_16x16x32_bf16 v[72:75], a[72:75], a[20:23], v[72:75]
  ds_read_b64_tr_b16 a[42:43], v20 offset:2048
  v_mfma_f32_16x16x32_bf16 v[104:107], a[72:75], a[24:27], v[104:107]
  v_mfma_f32_16x16x32_bf16 v[136:139], a[72:75], a[28:31], v[136:139]
  ds_read_b64_tr_b16 a[44:45], v21 offset:0
  v_mfma_f32_16x16x32_bf16 v[44:47], a[76:79], a[16:19], v[44:47]
  ds_read_b64_tr_b16 a[46:47], v21 offset:2048
  v_mfma_f32_16x16x32_bf16 v[76:79], a[76:79], a[20:23], v[76:79]
  buffer_load_dwordx4 v10, s[20:23], s28 offen offset:2048 lds
  ds_read_b64_tr_b16 a[48:49], v18 offset:8192
  v_mfma_f32_16x16x32_bf16 v[108:111], a[76:79], a[24:27], v[108:111]
  ds_read_b64_tr_b16 a[50:51], v18 offset:10240
  v_mfma_f32_16x16x32_bf16 v[140:143], a[76:79], a[28:31], v[140:143]
  ds_read_b64_tr_b16 a[52:53], v19 offset:8192
  v_mfma_f32_16x16x32_bf16 v[48:51], a[80:83], a[16:19], v[48:51]
  ds_read_b64_tr_b16 a[54:55], v19 offset:10240
  v_mfma_f32_16x16x32_bf16 v[80:83], a[80:83], a[20:23], v[80:83]
  buffer_load_dwordx4 v11, s[20:23], s28 offen offset:3072 lds
  ds_read_b64_tr_b16 a[56:57], v20 offset:8192
  v_mfma_f32_16x16x32_bf16 v[112:115], a[80:83], a[24:27], v[112:115]
  s_bfe_u32 s56, 0x302010e, s55
  s_add_u32 s54, s54, s56
  s_add_u32 s55, s55, 8
  v_mfma_f32_16x16x32_bf16 v[144:147], a[80:83], a[28:31], v[144:147]
  s_and_b32 s55, s55, 0x8001f
  s_and_b32 s54, s54, 15
  s_lshl_b32 s28, s54, 19
  v_mfma_f32_16x16x32_bf16 v[52:55], a[84:87], a[16:19], v[52:55]
  s_mov_b32 m0, s88
  ds_read_b64_tr_b16 a[58:59], v20 offset:10240
  ds_read_b64_tr_b16 a[60:61], v21 offset:8192
  v_mfma_f32_16x16x32_bf16 v[84:87], a[84:87], a[20:23], v[84:87]
  ds_read_b64_tr_b16 a[62:63], v21 offset:10240
  v_mfma_f32_16x16x32_bf16 v[116:119], a[84:87], a[24:27], v[116:119]
  buffer_load_dwordx4 v4, s[8:11], s26 offen offset:0 lds
  v_mfma_f32_16x16x32_bf16 v[148:151], a[84:87], a[28:31], v[148:151]
  v_mfma_f32_16x16x32_bf16 v[56:59], a[88:91], a[16:19], v[56:59]
  v_mfma_f32_16x16x32_bf16 v[88:91], a[88:91], a[20:23], v[88:91]
  v_mfma_f32_16x16x32_bf16 v[120:123], a[88:91], a[24:27], v[120:123]
  buffer_load_dwordx4 v5, s[8:11], s26 offen offset:1024 lds
  v_mfma_f32_16x16x32_bf16 v[152:155], a[88:91], a[28:31], v[152:155]
  v_mfma_f32_16x16x32_bf16 v[60:63], a[92:95], a[16:19], v[60:63]
  v_mfma_f32_16x16x32_bf16 v[92:95], a[92:95], a[20:23], v[92:95]
  v_mfma_f32_16x16x32_bf16 v[124:127], a[92:95], a[24:27], v[124:127]
  v_mfma_f32_16x16x32_bf16 v[156:159], a[92:95], a[28:31], v[156:159]
  s_waitcnt lgkmcnt(0)
  v_mfma_f32_16x16x32_bf16 v[32:35], a[32:35], a[0:3], v[32:35]
  buffer_load_dwordx4 v6, s[8:11], s26 offen offset:2048 lds
  ds_read_b128 a[16:19], v17 offset:0
  v_mfma_f32_16x16x32_bf16 v[64:67], a[32:35], a[4:7], v[64:67]
  ds_read_b64_tr_b16 a[64:65], v18 offset:4096
  v_mfma_f32_16x16x32_bf16 v[96:99], a[32:35], a[8:11], v[96:99]
  ds_read_b64_tr_b16 a[66:67], v18 offset:6144
  v_mfma_f32_16x16x32_bf16 v[128:131], a[32:35], a[12:15], v[128:131]
  ds_read_b128 a[20:23], v17 offset:2048
  v_mfma_f32_16x16x32_bf16 v[36:39], a[36:39], a[0:3], v[36:39]
  buffer_load_dwordx4 v7, s[8:11], s26 offen offset:3072 lds
  ds_read_b128 a[24:27], v17 offset:4096
  v_mfma_f32_16x16x32_bf16 v[68:71], a[36:39], a[4:7], v[68:71]
  s_add_u32 m0, s88, 4096
  ds_read_b128 a[28:31], v17 offset:6144
  v_mfma_f32_16x16x32_bf16 v[100:103], a[36:39], a[8:11], v[100:103]
  ds_read_b64_tr_b16 a[68:69], v19 offset:4096
  v_mfma_f32_16x16x32_bf16 v[132:135], a[36:39], a[12:15], v[132:135]
  ds_read_b64_tr_b16 a[70:71], v19 offset:6144
  v_mfma_f32_16x16x32_bf16 v[40:43], a[40:43], a[0:3], v[40:43]
  buffer_load_dwordx4 v4, s[8:11], s27 offen offset:0 lds
  ds_read_b64_tr_b16 a[72:73], v20 offset:4096
  v_mfma_f32_16x16x32_bf16 v[72:75], a[40:43], a[4:7], v[72:75]
  ds_read_b64_tr_b16 a[74:75], v20 offset:6144
  v_mfma_f32_16x16x32_bf16 v[104:107], a[40:43], a[8:11], v[104:107]
  v_mfma_f32_16x16x32_bf16 v[136:139], a[40:43], a[12:15], v[136:139]
  ds_read_b64_tr_b16 a[76:77], v21 offset:4096
  v_mfma_f32_16x16x32_bf16 v[44:47], a[44:47], a[0:3], v[44:47]
  buffer_load_dwordx4 v5, s[8:11], s27 offen offset:1024 lds
  ds_read_b64_tr_b16 a[78:79], v21 offset:6144
  v_mfma_f32_16x16x32_bf16 v[76:79], a[44:47], a[4:7], v[76:79]
  ds_read_b64_tr_b16 a[80:81], v18 offset:12288
  v_mfma_f32_16x16x32_bf16 v[108:111], a[44:47], a[8:11], v[108:111]
  ds_read_b64_tr_b16 a[82:83], v18 offset:14336
  v_mfma_f32_16x16x32_bf16 v[140:143], a[44:47], a[12:15], v[140:143]
  ds_read_b64_tr_b16 a[84:85], v19 offset:12288
  v_mfma_f32_16x16x32_bf16 v[48:51], a[48:51], a[0:3], v[48:51]
  buffer_load_dwordx4 v6, s[8:11], s27 offen offset:2048 lds
  ds_read_b64_tr_b16 a[86:87], v19 offset:14336
  v_mfma_f32_16x16x32_bf16 v[80:83], a[48:51], a[4:7], v[80:83]
  ds_read_b64_tr_b16 a[88:89], v20 offset:12288
  v_mfma_f32_16x16x32_bf16 v[112:115], a[48:51], a[8:11], v[112:115]
  ds_read_b64_tr_b16 a[90:91], v20 offset:14336
  v_mfma_f32_16x16x32_bf16 v[144:147], a[48:51], a[12:15], v[144:147]
  ds_read_b64_tr_b16 a[92:93], v21 offset:12288
  v_mfma_f32_16x16x32_bf16 v[52:55], a[52:55], a[0:3], v[52:55]
  buffer_load_dwordx4 v7, s[8:11], s27 offen offset:3072 lds
  ds_read_b64_tr_b16 a[94:95], v21 offset:14336
  v_mfma_f32_16x16x32_bf16 v[84:87], a[52:55], a[4:7], v[84:87]
  s_bfe_u32 s29, 0x302010e, s53
  s_add_u32 s52, s52, s29
  s_add_u32 s53, s53, 8
  v_mfma_f32_16x16x32_bf16 v[116:119], a[52:55], a[8:11], v[116:119]
  s_and_b32 s53, s53, 0x8001f
  s_and_b32 s52, s52, 15
  s_lshl_b32 s29, s52, 7
  v_mfma_f32_16x16x32_bf16 v[148:151], a[52:55], a[12:15], v[148:151]
  s_or_b32 s26, s30, s29
  s_or_b32 s27, s31, s29
  v_mfma_f32_16x16x32_bf16 v[56:59], a[56:59], a[0:3], v[56:59]
  s_add_u32 s88, s88, s90
  s_add_u32 s89, s89, 1
  s_cmp_eq_u32 s89, 3
  s_cselect_b32 s89, 0, s89
  s_cselect_b32 s90, s91, s92
  v_mfma_f32_16x16x32_bf16 v[88:91], a[56:59], a[4:7], v[88:91]
  s_add_u32 s68, s68, s70
  s_add_u32 s69, s69, 1
  s_cmp_eq_u32 s69, 3
  s_cselect_b32 s69, 0, s69
  s_cselect_b32 s70, s71, s72
  v_mfma_f32_16x16x32_bf16 v[120:123], a[56:59], a[8:11], v[120:123]
  v_add_u32 v16, s90, v16
  v_add_u32 v17, s90, v17
  v_mfma_f32_16x16x32_bf16 v[152:155], a[56:59], a[12:15], v[152:155]
  v_add_u32 v18, s70, v18
  v_add_u32 v19, s70, v19
  v_mfma_f32_16x16x32_bf16 v[60:63], a[60:63], a[0:3], v[60:63]
  v_add_u32 v20, s70, v20
  v_add_u32 v21, s70, v21
  v_mfma_f32_16x16x32_bf16 v[92:95], a[60:63], a[4:7], v[92:95]
  v_mfma_f32_16x16x32_bf16 v[124:127], a[60:63], a[8:11], v[124:127]
  v_mfma_f32_16x16x32_bf16 v[156:159], a[60:63], a[12:15], v[156:159]
  s_waitcnt vmcnt(12) lgkmcnt(0)
  s_barrier
  s_mov_b32 s5, 0x40000
Lpoll_5:
  v_cmp_ne_u64 vcc, s[94:95], v[22:23]
  s_nop 0
  s_cbranch_vccz Lpolld_6
  s_sleep 4
  buffer_load_dwordx2 v[22:23], v3, s[96:99], s34 offen sc1
  s_sub_u32 s5, s5, 1
  s_waitcnt vmcnt(0)
  s_cbranch_scc0 Lpoll_5
Lpolld_6:
  s_lshl_b32 s4, s24, 20
  s_lshl_b32 s5, s25, 16
  s_sub_u32 s5, 1048576, s5
  s_add_u32 s20, s86, 16777216
  s_addc_u32 s21, s87, 0
  s_add_u32 s20, s20, s4
  s_addc_u32 s21, s21, 0
  s_mov_b32 s22, s5
  s_mov_b32 s23, 0x00020000
  s_lshl_b32 s28, s3, 12
  s_add_u32 s26, s28, 0xc000
  s_add_u32 s27, s28, 0x10000
  s_add_u32 s29, s28, 0x4000
  s_and_b32 s4, s2, 1
  s_lshl_b32 s4, s4, 3
  s_bfe_u32 s5, s2, 0x30003
  s_add_u32 s73, s4, s5
  s_bfe_u32 s4, s2, 0x10001
  s_lshl_b32 s4, s4, 2
  s_lshr_b32 s5, s2, 6
  s_add_u32 s76, s4, s5
  s_bfe_u32 s77, s2, 0x10002
  s_lshl_b32 s78, s73, 3
  s_add_u32 s78, s78, s76
  s_lshl_b32 s79, s3, 12
  s_add_u32 s64, s79, 131072
  v_mfma_f32_16x16x32_bf16 v[32:35], a[64:67], a[16:19], v[32:35]
  s_mov_b32 m0, s26
  ds_read_b128 a[0:3], v16 offset:0
  v_mfma_f32_16x16x32_bf16 v[64:67], a[64:67], a[20:23], v[64:67]
  buffer_load_dwordx4 v2, s[20:23], s28 offen offset:0 sc1 lds
  ds_read_b64_tr_b16 a[32:33], v18 offset:0
  v_mfma_f32_16x16x32_bf16 v[96:99], a[64:67], a[24:27], v[96:99]
  ds_read_b64_tr_b16 a[34:35], v18 offset:2048
  v_mfma_f32_16x16x32_bf16 v[128:131], a[64:67], a[28:31], v[128:131]
  ds_read_b128 a[4:7], v16 offset:2048
  v_mfma_f32_16x16x32_bf16 v[36:39], a[68:71], a[16:19], v[36:39]
  ds_read_b128 a[8:11], v16 offset:4096
  v_mfma_f32_16x16x32_bf16 v[68:71], a[68:71], a[20:23], v[68:71]
  ds_read_b128 a[12:15], v16 offset:6144
  v_mfma_f32_16x16x32_bf16 v[100:103], a[68:71], a[24:27], v[100:103]
  ds_read_b64_tr_b16 a[36:37], v19 offset:0
  v_mfma_f32_16x16x32_bf16 v[132:135], a[68:71], a[28:31], v[132:135]
  ds_read_b64_tr_b16 a[38:39], v19 offset:2048
  v_mfma_f32_16x16x32_bf16 v[40:43], a[72:75], a[16:19], v[40:43]
  ds_read_b64_tr_b16 a[40:41], v20 offset:0
  v_mfma_f32_16x16x32_bf16 v[72:75], a[72:75], a[20:23], v[72:75]
  ds_read_b64_tr_b16 a[42:43], v20 offset:2048
  v_mfma_f32_16x16x32_bf16 v[104:107], a[72:75], a[24:27], v[104:107]
  v_mfma_f32_16x16x32_bf16 v[136:139], a[72:75], a[28:31], v[136:139]
  ds_read_b64_tr_b16 a[44:45], v21 offset:0
  v_mfma_f32_16x16x32_bf16 v[44:47], a[76:79], a[16:19], v[44:47]
  ds_read_b64_tr_b16 a[46:47], v21 offset:2048
  v_mfma_f32_16x16x32_bf16 v[76:79], a[76:79], a[20:23], v[76:79]
  ds_read_b64_tr_b16 a[48:49], v18 offset:8192
  v_mfma_f32_16x16x32_bf16 v[108:111], a[76:79], a[24:27], v[108:111]
  ds_read_b64_tr_b16 a[50:51], v18 offset:10240
  v_mfma_f32_16x16x32_bf16 v[140:143], a[76:79], a[28:31], v[140:143]
  buffer_load_dwordx4 v2, s[20:23], s28 offen offset:1024 sc1 lds
  ds_read_b64_tr_b16 a[52:53], v19 offset:8192
  v_mfma_f32_16x16x32_bf16 v[48:51], a[80:83], a[16:19], v[48:51]
  ds_read_b64_tr_b16 a[54:55], v19 offset:10240
  v_mfma_f32_16x16x32_bf16 v[80:83], a[80:83], a[20:23], v[80:83]
  ds_read_b64_tr_b16 a[56:57], v20 offset:8192
  v_mfma_f32_16x16x32_bf16 v[112:115], a[80:83], a[24:27], v[112:115]
  ds_read_b64_tr_b16 a[58:59], v20 offset:10240
  v_mfma_f32_16x16x32_bf16 v[144:147], a[80:83], a[28:31], v[144:147]
  ds_read_b64_tr_b16 a[60:61], v21 offset:8192
  v_mfma_f32_16x16x32_bf16 v[52:55], a[84:87], a[16:19], v[52:55]
  ds_read_b64_tr_b16 a[62:63], v21 offset:10240
  v_mfma_f32_16x16x32_bf16 v[84:87], a[84:87], a[20:23], v[84:87]
  v_mfma_f32_16x16x32_bf16 v[116:119], a[84:87], a[24:27], v[116:119]
  v_mfma_f32_16x16x32_bf16 v[148:151], a[84:87], a[28:31], v[148:151]
  v_mfma_f32_16x16x32_bf16 v[56:59], a[88:91], a[16:19], v[56:59]
  v_mfma_f32_16x16x32_bf16 v[88:91], a[88:91], a[20:23], v[88:91]
  v_mfma_f32_16x16x32_bf16 v[120:123], a[88:91], a[24:27], v[120:123]
  v_mfma_f32_16x16x32_bf16 v[152:155], a[88:91], a[28:31], v[152:155]
  v_mfma_f32_16x16x32_bf16 v[60:63], a[92:95], a[16:19], v[60:63]
  v_mfma_f32_16x16x32_bf16 v[92:95], a[92:95], a[20:23], v[92:95]
  v_mfma_f32_16x16x32_bf16 v[124:127], a[92:95], a[24:27], v[124:127]
  v_mfma_f32_16x16x32_bf16 v[156:159], a[92:95], a[28:31], v[156:159]
  s_waitcnt lgkmcnt(0)
  v_mfma_f32_16x16x32_bf16 v[32:35], a[32:35], a[0:3], v[32:35]
  buffer_load_dwordx4 v2, s[20:23], s28 offen offset:2048 sc1 lds
  ds_read_b128 a[16:19], v17 offset:0
  v_mfma_f32_16x16x32_bf16 v[64:67], a[32:35], a[4:7], v[64:67]
  ds_read_b64_tr_b16 a[64:65], v18 offset:4096
  v_mfma_f32_16x16x32_bf16 v[96:99], a[32:35], a[8:11], v[96:99]
  ds_read_b64_tr_b16 a[66:67], v18 offset:6144
  v_mfma_f32_16x16x32_bf16 v[128:131], a[32:35], a[12:15], v[128:131]
  ds_read_b128 a[20:23], v17 offset:2048
  v_mfma_f32_16x16x32_bf16 v[36:39], a[36:39], a[0:3], v[36:39]
  ds_read_b128 a[24:27], v17 offset:4096
  v_mfma_f32_16x16x32_bf16 v[68:71], a[36:39], a[4:7], v[68:71]
  ds_read_b128 a[28:31], v17 offset:6144
  v_mfma_f32_16x16x32_bf16 v[100:103], a[36:39], a[8:11], v[100:103]
  ds_read_b64_tr_b16 a[68:69], v19 offset:4096
  v_mfma_f32_16x16x32_bf16 v[132:135], a[36:39], a[12:15], v[132:135]
  ds_read_b64_tr_b16 a[70:71], v19 offset:6144
  v_mfma_f32_16x16x32_bf16 v[40:43], a[40:43], a[0:3], v[40:43]
  ds_read_b64_tr_b16 a[72:73], v20 offset:4096
  v_mfma_f32_16x16x32_bf16 v[72:75], a[40:43], a[4:7], v[72:75]
  ds_read_b64_tr_b16 a[74:75], v20 offset:6144
  v_mfma_f32_16x16x32_bf16 v[104:107], a[40:43], a[8:11], v[104:107]
  v_mfma_f32_16x16x32_bf16 v[136:139], a[40:43], a[12:15], v[136:139]
  ds_read_b64_tr_b16 a[76:77], v21 offset:4096
  v_mfma_f32_16x16x32_bf16 v[44:47], a[44:47], a[0:3], v[44:47]
  buffer_load_dwordx4 v2, s[20:23], s28 offen offset:3072 sc1 lds
  ds_read_b64_tr_b16 a[78:79], v21 offset:6144
  v_mfma_f32_16x16x32_bf16 v[76:79], a[44:47], a[4:7], v[76:79]
  s_xor_b32 s26, s26, 0x4000
  s_add_u32 s28, s28, 0x8000
  ds_read_b64_tr_b16 a[80:81], v18 offset:12288
  v_mfma_f32_16x16x32_bf16 v[108:111], a[44:47], a[8:11], v[108:111]
  s_add_u32 s88, s88, s90
  s_add_u32 s89, s89, 1
  ds_read_b64_tr_b16 a[82:83], v18 offset:14336
  v_mfma_f32_16x16x32_bf16 v[140:143], a[44:47], a[12:15], v[140:143]
  s_cmp_eq_u32 s89, 3
  s_cselect_b32 s89, 0, s89
  s_cselect_b32 s90, s91, s92
  ds_read_b64_tr_b16 a[84:85], v19 offset:12288
  v_mfma_f32_16x16x32_bf16 v[48:51], a[48:51], a[0:3], v[48:51]
  s_add_u32 s68, s68, s70
  s_add_u32 s69, s69, 1
  ds_read_b64_tr_b16 a[86:87], v19 offset:14336
  v_mfma_f32_16x16x32_bf16 v[80:83], a[48:51], a[4:7], v[80:83]
  s_cmp_eq_u32 s69, 3
  s_cselect_b32 s69, 0, s69
  s_cselect_b32 s70, s71, s72
  ds_read_b64_tr_b16 a[88:89], v20 offset:12288
  v_mfma_f32_16x16x32_bf16 v[112:115], a[48:51], a[8:11], v[112:115]
  ds_read_b64_tr_b16 a[90:91], v20 offset:14336
  v_mfma_f32_16x16x32_bf16 v[144:147], a[48:51], a[12:15], v[144:147]
  ds_read_b64_tr_b16 a[92:93], v21 offset:12288
  v_mfma_f32_16x16x32_bf16 v[52:55], a[52:55], a[0:3], v[52:55]
  ds_read_b64_tr_b16 a[94:95], v21 offset:14336
  v_mfma_f32_16x16x32_bf16 v[84:87], a[52:55], a[4:7], v[84:87]
  v_add_u32 v16, s90, v16
  v_add_u32 v17, s90, v17
  v_mfma_f32_16x16x32_bf16 v[116:119], a[52:55], a[8:11], v[116:119]
  v_add_u32 v18, s70, v18
  v_add_u32 v19, s70, v19
  v_mfma_f32_16x16x32_bf16 v[148:151], a[52:55], a[12:15], v[148:151]
  v_add_u32 v20, s70, v20
  v_add_u32 v21, s70, v21
  v_mfma_f32_16x16x32_bf16 v[56:59], a[56:59], a[0:3], v[56:59]
  v_mfma_f32_16x16x32_bf16 v[88:91], a[56:59], a[4:7], v[88:91]
  v_mfma_f32_16x16x32_bf16 v[120:123], a[56:59], a[8:11], v[120:123]
  v_mfma_f32_16x16x32_bf16 v[152:155], a[56:59], a[12:15], v[152:155]
  v_mfma_f32_16x16x32_bf16 v[60:63], a[60:63], a[0:3], v[60:63]
  v_mfma_f32_16x16x32_bf16 v[92:95], a[60:63], a[4:7], v[92:95]
  v_mfma_f32_16x16x32_bf16 v[124:127], a[60:63], a[8:11], v[124:127]
  v_mfma_f32_16x16x32_bf16 v[156:159], a[60:63], a[12:15], v[156:159]
  s_waitcnt vmcnt(4) lgkmcnt(0)
  s_barrier
  s_mov_b32 s6, 0x3e0293ee
  s_mov_b32 s7, s6
  v_mfma_f32_16x16x32_bf16 v[32:35], a[64:67], a[16:19], v[32:35]
  s_mov_b32 m0, s26
  ds_read_b128 a[0:3], v16 offset:0
  v_mfma_f32_16x16x32_bf16 v[64:67], a[64:67], a[20:23], v[64:67]
  buffer_load_dwordx4 v2, s[20:23], s28 offen offset:0 sc1 lds
  ds_read_b64_tr_b16 a[32:33], v18 offset:0
  v_mfma_f32_16x16x32_bf16 v[96:99], a[64:67], a[24:27], v[96:99]
  ds_read_b64_tr_b16 a[34:35], v18 offset:2048
  v_mfma_f32_16x16x32_bf16 v[128:131], a[64:67], a[28:31], v[128:131]
  buffer_load_dwordx4 v2, s[20:23], s28 offen offset:1024 sc1 lds
  ds_read_b128 a[4:7], v16 offset:2048
  v_mfma_f32_16x16x32_bf16 v[36:39], a[68:71], a[16:19], v[36:39]
  ds_read_b128 a[8:11], v16 offset:4096
  v_mfma_f32_16x16x32_bf16 v[68:71], a[68:71], a[20:23], v[68:71]
  ds_read_b128 a[12:15], v16 offset:6144
  v_mfma_f32_16x16x32_bf16 v[100:103], a[68:71], a[24:27], v[100:103]
  ds_read_b64_tr_b16 a[36:37], v19 offset:0
  v_mfma_f32_16x16x32_bf16 v[132:135], a[68:71], a[28:31], v[132:135]
  buffer_load_dwordx4 v2, s[20:23], s28 offen offset:2048 sc1 lds
  ds_read_b64_tr_b16 a[38:39], v19 offset:2048
  v_mfma_f32_16x16x32_bf16 v[40:43], a[72:75], a[16:19], v[40:43]
  ds_read_b64_tr_b16 a[40:41], v20 offset:0
  v_mfma_f32_16x16x32_bf16 v[72:75], a[72:75], a[20:23], v[72:75]
  ds_read_b64_tr_b16 a[42:43], v20 offset:2048
  v_mfma_f32_16x16x32_bf16 v[104:107], a[72:75], a[24:27], v[104:107]
  v_mfma_f32_16x16x32_bf16 v[136:139], a[72:75], a[28:31], v[136:139]
  buffer_load_dwordx4 v2, s[20:23], s28 offen offset:3072 sc1 lds
  ds_read_b64_tr_b16 a[44:45], v21 offset:0
  v_mfma_f32_16x16x32_bf16 v[44:47], a[76:79], a[16:19], v[44:47]
  s_xor_b32 s26, s26, 0x8000
  s_add_u32 s28, s28, 0x8000
  s_mov_b32 m0, s27
  v_mfma_f32_16x16x32_bf16 v[76:79], a[76:79], a[20:23], v[76:79]
  ds_read_b64_tr_b16 a[46:47], v21 offset:2048
  ds_read_b64_tr_b16 a[48:49], v18 offset:8192
  v_mfma_f32_16x16x32_bf16 v[108:111], a[76:79], a[24:27], v[108:111]
  ds_read_b64_tr_b16 a[50:51], v18 offset:10240
  v_mfma_f32_16x16x32_bf16 v[140:143], a[76:79], a[28:31], v[140:143]
  buffer_load_dwordx4 v2, s[20:23], s29 offen offset:0 sc1 lds
  ds_read_b64_tr_b16 a[52:53], v19 offset:8192
  v_mfma_f32_16x16x32_bf16 v[48:51], a[80:83], a[16:19], v[48:51]
  ds_read_b64_tr_b16 a[54:55], v19 offset:10240
  v_mfma_f32_16x16x32_bf16 v[80:83], a[80:83], a[20:23], v[80:83]
  ds_read_b64_tr_b16 a[56:57], v20 offset:8192
  v_mfma_f32_16x16x32_bf16 v[112:115], a[80:83], a[24:27], v[112:115]
  ds_read_b64_tr_b16 a[58:59], v20 offset:10240
  v_mfma_f32_16x16x32_bf16 v[144:147], a[80:83], a[28:31], v[144:147]
  buffer_load_dwordx4 v2, s[20:23], s29 offen offset:1024 sc1 lds
  ds_read_b64_tr_b16 a[60:61], v21 offset:8192
  v_mfma_f32_16x16x32_bf16 v[52:55], a[84:87], a[16:19], v[52:55]
  ds_read_b64_tr_b16 a[62:63], v21 offset:10240
  v_mfma_f32_16x16x32_bf16 v[84:87], a[84:87], a[20:23], v[84:87]
  v_mfma_f32_16x16x32_bf16 v[116:119], a[84:87], a[24:27], v[116:119]
  v_mfma_f32_16x16x32_bf16 v[148:151], a[84:87], a[28:31], v[148:151]
  buffer_load_dwordx4 v2, s[20:23], s29 offen offset:2048 sc1 lds
  v_mfma_f32_16x16x32_bf16 v[56:59], a[88:91], a[16:19], v[56:59]
  v_mfma_f32_16x16x32_bf16 v[88:91], a[88:91], a[20:23], v[88:91]
  v_mfma_f32_16x16x32_bf16 v[120:123], a[88:91], a[24:27], v[120:123]
  v_mfma_f32_16x16x32_bf16 v[152:155], a[88:91], a[28:31], v[152:155]
  buffer_load_dwordx4 v2, s[20:23], s29 offen offset:3072 sc1 lds
  v_mfma_f32_16x16x32_bf16 v[60:63], a[92:95], a[16:19], v[60:63]
  s_xor_b32 s27, s27, 0x4000
  s_add_u32 s29, s29, 0x8000
  v_mfma_f32_16x16x32_bf16 v[92:95], a[92:95], a[20:23], v[92:95]
  v_mfma_f32_16x16x32_bf16 v[124:127], a[92:95], a[24:27], v[124:127]
  v_mfma_f32_16x16x32_bf16 v[156:159], a[92:95], a[28:31], v[156:159]
  s_waitcnt lgkmcnt(0)
  v_mfma_f32_16x16x32_bf16 v[32:35], a[32:35], a[0:3], v[32:35]
  ds_read_b128 a[16:19], v17 offset:0
  ds_read_b64_tr_b16 a[64:65], v18 offset:4096
  v_mfma_f32_16x16x32_bf16 v[36:39], a[36:39], a[0:3], v[36:39]
  ds_read_b64_tr_b16 a[66:67], v18 offset:6144
  ds_read_b128 a[20:23], v17 offset:2048
  v_mfma_f32_16x16x32_bf16 v[40:43], a[40:43], a[0:3], v[40:43]
  ds_read_b128 a[24:27], v17 offset:4096
  ds_read_b128 a[28:31], v17 offset:6144
  v_mfma_f32_16x16x32_bf16 v[44:47], a[44:47], a[0:3], v[44:47]
  ds_read_b64_tr_b16 a[68:69], v19 offset:4096
  ds_read_b64_tr_b16 a[70:71], v19 offset:6144
  v_mfma_f32_16x16x32_bf16 v[48:51], a[48:51], a[0:3], v[48:51]
  ds_read_b64_tr_b16 a[72:73], v20 offset:4096
  ds_read_b64_tr_b16 a[74:75], v20 offset:6144
  v_mfma_f32_16x16x32_bf16 v[52:55], a[52:55], a[0:3], v[52:55]
  ds_read_b64_tr_b16 a[76:77], v21 offset:4096
  v_mfma_f32_16x16x32_bf16 v[56:59], a[56:59], a[0:3], v[56:59]
  ds_read_b64_tr_b16 a[78:79], v21 offset:6144
  ds_read_b64_tr_b16 a[80:81], v18 offset:12288
  v_mfma_f32_16x16x32_bf16 v[60:63], a[60:63], a[0:3], v[60:63]
  ds_read_b64_tr_b16 a[82:83], v18 offset:14336
  ds_read_b64_tr_b16 a[84:85], v19 offset:12288
  v_mfma_f32_16x16x32_bf16 v[64:67], a[32:35], a[4:7], v[64:67]
  ds_read_b64_tr_b16 a[86:87], v19 offset:14336
  ds_read_b64_tr_b16 a[88:89], v20 offset:12288
  v_mfma_f32_16x16x32_bf16 v[68:71], a[36:39], a[4:7], v[68:71]
  ds_read_b64_tr_b16 a[90:91], v20 offset:14336
  ds_read_b64_tr_b16 a[92:93], v21 offset:12288
  v_mfma_f32_16x16x32_bf16 v[72:75], a[40:43], a[4:7], v[72:75]
  ds_read_b64_tr_b16 a[94:95], v21 offset:14336
  v_mfma_f32_16x16x32_bf16 v[76:79], a[44:47], a[4:7], v[76:79]
  v_mfma_f32_16x16x32_bf16 v[80:83], a[48:51], a[4:7], v[80:83]
  v_mfma_f32_16x16x32_bf16 v[84:87], a[52:55], a[4:7], v[84:87]
  v_mfma_f32_16x16x32_bf16 v[88:91], a[56:59], a[4:7], v[88:91]
  v_mfma_f32_16x16x32_bf16 v[92:95], a[60:63], a[4:7], v[92:95]
  s_waitcnt lgkmcnt(0)
  v_mfma_f32_16x16x32_bf16 v[32:35], a[64:67], a[16:19], v[32:35]
  v_mfma_f32_16x16x32_bf16 v[36:39], a[68:71], a[16:19], v[36:39]
  v_mfma_f32_16x16x32_bf16 v[40:43], a[72:75], a[16:19], v[40:43]
  v_mfma_f32_16x16x32_bf16 v[44:47], a[76:79], a[16:19], v[44:47]
  v_mfma_f32_16x16x32_bf16 v[48:51], a[80:83], a[16:19], v[48:51]
  v_mfma_f32_16x16x32_bf16 v[52:55], a[84:87], a[16:19], v[52:55]
  s_nop 2
  v_pk_mul_f32 v[32:33], v[32:33], s[6:7]
  v_pk_mul_f32 v[34:35], v[34:35], s[6:7]
  v_mfma_f32_16x16x32_bf16 v[56:59], a[88:91], a[16:19], v[56:59]
  v_pk_mul_f32 v[36:37], v[36:37], s[6:7]
  v_pk_mul_f32 v[38:39], v[38:39], s[6:7]
  v_mfma_f32_16x16x32_bf16 v[60:63], a[92:95], a[16:19], v[60:63]
  v_cvt_pk_bf16_f32 v32, v32, v33
  v_cvt_pk_bf16_f32 v33, v34, v35
  v_mfma_f32_16x16x32_bf16 v[64:67], a[64:67], a[20:23], v[64:67]
  v_cvt_pk_bf16_f32 v34, v36, v37
  v_cvt_pk_bf16_f32 v35, v38, v39
  v_mfma_f32_16x16x32_bf16 v[68:71], a[68:71], a[20:23], v[68:71]
  v_accvgpr_write_b32 a128, v32
  v_accvgpr_write_b32 a129, v33
  v_mfma_f32_16x16x32_bf16 v[72:75], a[72:75], a[20:23], v[72:75]
  v_accvgpr_write_b32 a130, v34
  v_accvgpr_write_b32 a131, v35
  v_mfma_f32_16x16x32_bf16 v[76:79], a[76:79], a[20:23], v[76:79]
  v_pk_mul_f32 v[40:41], v[40:41], s[6:7]
  v_pk_mul_f32 v[42:43], v[42:43], s[6:7]
  v_mfma_f32_16x16x32_bf16 v[80:83], a[80:83], a[20:23], v[80:83]
  v_pk_mul_f32 v[44:45], v[44:45], s[6:7]
  v_pk_mul_f32 v[46:47], v[46:47], s[6:7]
  v_mfma_f32_16x16x32_bf16 v[84:87], a[84:87], a[20:23], v[84:87]
  v_cvt_pk_bf16_f32 v40, v40, v41
  v_cvt_pk_bf16_f32 v41, v42, v43
  v_mfma_f32_16x16x32_bf16 v[88:91], a[88:91], a[20:23], v[88:91]
  v_cvt_pk_bf16_f32 v42, v44, v45
  v_cvt_pk_bf16_f32 v43, v46, v47
  v_mfma_f32_16x16x32_bf16 v[92:95], a[92:95], a[20:23], v[92:95]
  v_accvgpr_write_b32 a132, v40
  v_accvgpr_write_b32 a133, v41
  v_mfma_f32_16x16x32_bf16 v[96:99], a[32:35], a[8:11], v[96:99]
  v_accvgpr_write_b32 a134, v42
  v_accvgpr_write_b32 a135, v43
  v_mfma_f32_16x16x32_bf16 v[100:103], a[36:39], a[8:11], v[100:103]
  v_mfma_f32_32x32x16_bf16 v[160:175], a[236:239], a[236:239], 0
  v_pk_mul_f32 v[48:49], v[48:49], s[6:7]
  v_mfma_f32_16x16x32_bf16 v[96:99], a[64:67], a[24:27], v[96:99]
  v_pk_mul_f32 v[50:51], v[50:51], s[6:7]
  v_pk_mul_f32 v[52:53], v[52:53], s[6:7]
  v_mfma_f32_16x16x32_bf16 v[100:103], a[68:71], a[24:27], v[100:103]
  v_pk_mul_f32 v[54:55], v[54:55], s[6:7]
  v_cvt_pk_bf16_f32 v48, v48, v49
  v_mfma_f32_16x16x32_bf16 v[104:107], a[40:43], a[8:11], v[104:107]
  v_cvt_pk_bf16_f32 v49, v50, v51
  v_cvt_pk_bf16_f32 v50, v52, v53
  v_mfma_f32_16x16x32_bf16 v[108:111], a[44:47], a[8:11], v[108:111]
  v_cvt_pk_bf16_f32 v51, v54, v55
  v_accvgpr_write_b32 a136, v48
  v_mfma_f32_16x16x32_bf16 v[104:107], a[72:75], a[24:27], v[104:107]
  v_accvgpr_write_b32 a137, v49
  v_accvgpr_write_b32 a138, v50
  v_mfma_f32_16x16x32_bf16 v[108:111], a[76:79], a[24:27], v[108:111]
  v_accvgpr_write_b32 a139, v51
  v_pk_mul_f32 v[56:57], v[56:57], s[6:7]
  v_mfma_f32_16x16x32_bf16 v[112:115], a[48:51], a[8:11], v[112:115]
  v_pk_mul_f32 v[58:59], v[58:59], s[6:7]
  v_pk_mul_f32 v[60:61], v[60:61], s[6:7]
  v_mfma_f32_16x16x32_bf16 v[116:119], a[52:55], a[8:11], v[116:119]
  v_pk_mul_f32 v[62:63], v[62:63], s[6:7]
  v_cvt_pk_bf16_f32 v56, v56, v57
  v_mfma_f32_16x16x32_bf16 v[112:115], a[80:83], a[24:27], v[112:115]
  v_cvt_pk_bf16_f32 v57, v58, v59
  v_cvt_pk_bf16_f32 v58, v60, v61
  v_mfma_f32_16x16x32_bf16 v[116:119], a[84:87], a[24:27], v[116:119]
  v_cvt_pk_bf16_f32 v59, v62, v63
  v_accvgpr_write_b32 a140, v56
  v_mfma_f32_16x16x32_bf16 v[120:123], a[56:59], a[8:11], v[120:123]
  v_accvgpr_write_b32 a141, v57
  v_accvgpr_write_b32 a142, v58
  v_mfma_f32_16x16x32_bf16 v[124:127], a[60:63], a[8:11], v[124:127]
  v_accvgpr_write_b32 a143, v59
  v_mfma_f32_32x32x16_bf16 v[176:191], a[236:239], a[236:239], 0
  v_mfma_f32_16x16x32_bf16 v[120:123], a[88:91], a[24:27], v[120:123]
  v_pk_mul_f32 v[64:65], v[64:65], s[6:7]
  v_pk_mul_f32 v[66:67], v[66:67], s[6:7]
  v_mfma_f32_16x16x32_bf16 v[124:127], a[92:95], a[24:27], v[124:127]
  v_pk_mul_f32 v[68:69], v[68:69], s[6:7]
  v_pk_mul_f32 v[70:71], v[70:71], s[6:7]
  v_mfma_f32_16x16x32_bf16 v[128:131], a[32:35], a[12:15], v[128:131]
  v_cvt_pk_bf16_f32 v64, v64, v65
  v_cvt_pk_bf16_f32 v65, v66, v67
  v_mfma_f32_16x16x32_bf16 v[132:135], a[36:39], a[12:15], v[132:135]
  v_cvt_pk_bf16_f32 v66, v68, v69
  v_cvt_pk_bf16_f32 v67, v70, v71
  v_mfma_f32_16x16x32_bf16 v[128:131], a[64:67], a[28:31], v[128:131]
  v_accvgpr_write_b32 a144, v64
  v_accvgpr_write_b32 a145, v65
  v_mfma_f32_16x16x32_bf16 v[132:135], a[68:71], a[28:31], v[132:135]
  v_accvgpr_write_b32 a146, v66
  v_accvgpr_write_b32 a147, v67
  v_mfma_f32_16x16x32_bf16 v[136:139], a[40:43], a[12:15], v[136:139]
  v_pk_mul_f32 v[72:73], v[72:73], s[6:7]
  v_pk_mul_f32 v[74:75], v[74:75], s[6:7]
  v_mfma_f32_16x16x32_bf16 v[140:143], a[44:47], a[12:15], v[140:143]
  v_pk_mul_f32 v[76:77], v[76:77], s[6:7]
  v_pk_mul_f32 v[78:79], v[78:79], s[6:7]
  v_mfma_f32_16x16x32_bf16 v[136:139], a[72:75], a[28:31], v[136:139]
  v_cvt_pk_bf16_f32 v72, v72, v73
  v_cvt_pk_bf16_f32 v73, v74, v75
  v_mfma_f32_16x16x32_bf16 v[140:143], a[76:79], a[28:31], v[140:143]
  v_cvt_pk_bf16_f32 v74, v76, v77
  v_cvt_pk_bf16_f32 v75, v78, v79
  v_mfma_f32_16x16x32_bf16 v[144:147], a[48:51], a[12:15], v[144:147]
  v_accvgpr_write_b32 a148, v72
  v_accvgpr_write_b32 a149, v73
  v_mfma_f32_16x16x32_bf16 v[148:151], a[52:55], a[12:15], v[148:151]
  v_accvgpr_write_b32 a150, v74
  v_accvgpr_write_b32 a151, v75
  v_mfma_f32_16x16x32_bf16 v[144:147], a[80:83], a[28:31], v[144:147]
  v_mfma_f32_32x32x16_bf16 v[192:207], a[236:239], a[236:239], 0
  v_pk_mul_f32 v[80:81], v[80:81], s[6:7]
  v_mfma_f32_16x16x32_bf16 v[148:151], a[84:87], a[28:31], v[148:151]
  v_pk_mul_f32 v[82:83], v[82:83], s[6:7]
  v_pk_mul_f32 v[84:85], v[84:85], s[6:7]
  v_mfma_f32_16x16x32_bf16 v[152:155], a[56:59], a[12:15], v[152:155]
  v_pk_mul_f32 v[86:87], v[86:87], s[6:7]
  v_cvt_pk_bf16_f32 v80, v80, v81
  v_mfma_f32_16x16x32_bf16 v[156:159], a[60:63], a[12:15], v[156:159]
  v_cvt_pk_bf16_f32 v81, v82, v83
  v_cvt_pk_bf16_f32 v82, v84, v85
  v_mfma_f32_16x16x32_bf16 v[152:155], a[88:91], a[28:31], v[152:155]
  v_cvt_pk_bf16_f32 v83, v86, v87
  v_accvgpr_write_b32 a152, v80
  v_mfma_f32_16x16x32_bf16 v[156:159], a[92:95], a[28:31], v[156:159]
  v_accvgpr_write_b32 a153, v81
  v_accvgpr_write_b32 a154, v82
  v_accvgpr_write_b32 a155, v83
  v_pk_mul_f32 v[88:89], v[88:89], s[6:7]
  v_pk_mul_f32 v[90:91], v[90:91], s[6:7]
  v_pk_mul_f32 v[92:93], v[92:93], s[6:7]
  v_pk_mul_f32 v[94:95], v[94:95], s[6:7]
  v_cvt_pk_bf16_f32 v88, v88, v89
  v_cvt_pk_bf16_f32 v89, v90, v91
  v_cvt_pk_bf16_f32 v90, v92, v93
  v_cvt_pk_bf16_f32 v91, v94, v95
  v_accvgpr_write_b32 a156, v88
  v_accvgpr_write_b32 a157, v89
  v_accvgpr_write_b32 a158, v90
  v_accvgpr_write_b32 a159, v91
  v_mfma_f32_32x32x16_bf16 v[208:223], a[236:239], a[236:239], 0
  v_pk_mul_f32 v[96:97], v[96:97], s[6:7]
  v_pk_mul_f32 v[98:99], v[98:99], s[6:7]
  v_pk_mul_f32 v[100:101], v[100:101], s[6:7]
  v_pk_mul_f32 v[102:103], v[102:103], s[6:7]
  v_cvt_pk_bf16_f32 v96, v96, v97
  v_cvt_pk_bf16_f32 v97, v98, v99
  v_cvt_pk_bf16_f32 v98, v100, v101
  v_cvt_pk_bf16_f32 v99, v102, v103
  v_accvgpr_write_b32 a160, v96
  v_accvgpr_write_b32 a161, v97
  v_accvgpr_write_b32 a162, v98
  v_accvgpr_write_b32 a163, v99
  v_pk_mul_f32 v[104:105], v[104:105], s[6:7]
  v_pk_mul_f32 v[106:107], v[106:107], s[6:7]
  v_pk_mul_f32 v[108:109], v[108:109], s[6:7]
  v_pk_mul_f32 v[110:111], v[110:111], s[6:7]
  v_cvt_pk_bf16_f32 v104, v104, v105
  v_cvt_pk_bf16_f32 v105, v106, v107
  v_cvt_pk_bf16_f32 v106, v108, v109
  v_cvt_pk_bf16_f32 v107, v110, v111
  v_accvgpr_write_b32 a164, v104
  v_accvgpr_write_b32 a165, v105
  v_accvgpr_write_b32 a166, v106
  v_accvgpr_write_b32 a167, v107
  v_mfma_f32_32x32x16_bf16 v[224:239], a[236:239], a[236:239], 0
  v_pk_mul_f32 v[112:113], v[112:113], s[6:7]
  v_pk_mul_f32 v[114:115], v[114:115], s[6:7]
  v_pk_mul_f32 v[116:117], v[116:117], s[6:7]
  v_pk_mul_f32 v[118:119], v[118:119], s[6:7]
  v_cvt_pk_bf16_f32 v112, v112, v113
  v_cvt_pk_bf16_f32 v113, v114, v115
  v_cvt_pk_bf16_f32 v114, v116, v117
  v_cvt_pk_bf16_f32 v115, v118, v119
  v_accvgpr_write_b32 a168, v112
  v_accvgpr_write_b32 a169, v113
  v_accvgpr_write_b32 a170, v114
  v_accvgpr_write_b32 a171, v115
  v_pk_mul_f32 v[120:121], v[120:121], s[6:7]
  v_pk_mul_f32 v[122:123], v[122:123], s[6:7]
  v_pk_mul_f32 v[124:125], v[124:125], s[6:7]
  v_pk_mul_f32 v[126:127], v[126:127], s[6:7]
  v_cvt_pk_bf16_f32 v120, v120, v121
  v_cvt_pk_bf16_f32 v121, v122, v123
  v_cvt_pk_bf16_f32 v122, v124, v125
  v_cvt_pk_bf16_f32 v123, v126, v127
  v_accvgpr_write_b32 a172, v120
  v_accvgpr_write_b32 a173, v121
  v_accvgpr_write_b32 a174, v122
  v_accvgpr_write_b32 a175, v123
  v_mfma_f32_32x32x16_bf16 v[240:255], a[236:239], a[236:239], 0
  v_pk_mul_f32 v[128:129], v[128:129], s[6:7]
  v_pk_mul_f32 v[130:131], v[130:131], s[6:7]
  v_pk_mul_f32 v[132:133], v[132:133], s[6:7]
  v_pk_mul_f32 v[134:135], v[134:135], s[6:7]
  v_cvt_pk_bf16_f32 v128, v128, v129
  v_cvt_pk_bf16_f32 v129, v130, v131
  v_cvt_pk_bf16_f32 v130, v132, v133
  v_cvt_pk_bf16_f32 v131, v134, v135
  v_accvgpr_write_b32 a176, v128
  v_accvgpr_write_b32 a177, v129
  v_accvgpr_write_b32 a178, v130
  v_accvgpr_write_b32 a179, v131
  v_pk_mul_f32 v[136:137], v[136:137], s[6:7]
  v_pk_mul_f32 v[138:139], v[138:139], s[6:7]
  v_pk_mul_f32 v[140:141], v[140:141], s[6:7]
  v_pk_mul_f32 v[142:143], v[142:143], s[6:7]
  v_cvt_pk_bf16_f32 v136, v136, v137
  v_cvt_pk_bf16_f32 v137, v138, v139
  v_cvt_pk_bf16_f32 v138, v140, v141
  v_cvt_pk_bf16_f32 v139, v142, v143
  v_accvgpr_write_b32 a180, v136
  v_accvgpr_write_b32 a181, v137
  v_accvgpr_write_b32 a182, v138
  v_accvgpr_write_b32 a183, v139
  v_mfma_f32_32x32x16_bf16 v[128:143], a[236:239], a[236:239], 0
  v_pk_mul_f32 v[144:145], v[144:145], s[6:7]
  v_pk_mul_f32 v[146:147], v[146:147], s[6:7]
  v_pk_mul_f32 v[148:149], v[148:149], s[6:7]
  v_pk_mul_f32 v[150:151], v[150:151], s[6:7]
  v_cvt_pk_bf16_f32 v144, v144, v145
  v_cvt_pk_bf16_f32 v145, v146, v147
  v_cvt_pk_bf16_f32 v146, v148, v149
  v_cvt_pk_bf16_f32 v147, v150, v151
  v_accvgpr_write_b32 a184, v144
  v_accvgpr_write_b32 a185, v145
  v_accvgpr_write_b32 a186, v146
  v_accvgpr_write_b32 a187, v147
  v_pk_mul_f32 v[152:153], v[152:153], s[6:7]
  v_pk_mul_f32 v[154:155], v[154:155], s[6:7]
  v_pk_mul_f32 v[156:157], v[156:157], s[6:7]
  v_pk_mul_f32 v[158:159], v[158:159], s[6:7]
  v_cvt_pk_bf16_f32 v152, v152, v153
  v_cvt_pk_bf16_f32 v153, v154, v155
  v_cvt_pk_bf16_f32 v154, v156, v157
  v_cvt_pk_bf16_f32 v155, v158, v159
  v_accvgpr_write_b32 a188, v152
  v_accvgpr_write_b32 a189, v153
  v_accvgpr_write_b32 a190, v154
  v_accvgpr_write_b32 a191, v155
  v_mfma_f32_32x32x16_bf16 v[144:159], a[236:239], a[236:239], 0
  v_add_u32 v3, 0xc000, v2
  v_add_u32 v4, 0x10000, v2
  v_mov_b32 v5, 0xf149f2ca
  s_mov_b32 s89, 0
  v_mfma_f32_32x32x16_bf16 a[192:207], a[236:239], a[236:239], 0
  s_waitcnt vmcnt(8)
  s_barrier
  ds_read_b128 a[32:35], v3 offset:0
  ds_read_b128 a[36:39], v3 offset:1024
  ds_read_b128 a[40:43], v3 offset:2048
  ds_read_b128 a[44:47], v3 offset:3072
  ds_read_b128 a[48:51], v3 offset:4096
  ds_read_b128 a[52:55], v3 offset:5120
  ds_read_b128 a[56:59], v3 offset:6144
  ds_read_b128 a[60:63], v3 offset:7168
  s_waitcnt lgkmcnt(6)
  v_mfma_f32_16x16x32_bf16 v[64:67], a[32:35], a[128:131], 0
  s_lshl_b32 s4, s2, 2
  s_add_u32 s4, s4, s3
  s_lshl_b32 s6, s4, 13
  v_mfma_f32_16x16x32_bf16 v[72:75], a[32:35], a[144:147], 0
  s_lshl_b32 s7, s4, 11
  s_mov_b32 s8, s74
  s_mov_b32 s9, s75
  v_mfma_f32_16x16x32_bf16 v[80:83], a[32:35], a[160:163], 0
  s_mov_b32 s10, 8388608
  s_mov_b32 s11, 0x00020000
  s_mov_b32 s12, s80
  v_mfma_f32_16x16x32_bf16 v[88:91], a[32:35], a[176:179], 0
  s_mov_b32 s13, s81
  s_mov_b32 s14, 2097152
  ds_read_b128 a[0:3], v3 offset:8192
  v_mfma_f32_16x16x32_bf16 v[64:67], a[36:39], a[132:135], v[64:67]
  s_mov_b32 s15, 0x00020000
  s_add_u32 s16, s86, 67108864
  s_addc_u32 s17, s87, 0
  v_mfma_f32_16x16x32_bf16 v[72:75], a[36:39], a[148:151], v[72:75]
  s_mov_b32 s18, 16777216
  s_mov_b32 s19, 0x00020000
  v_mfma_f32_16x16x32_bf16 v[80:83], a[36:39], a[164:167], v[80:83]
  v_and_b32 v6, 15, v1
  v_lshrrev_b32 v7, 4, v1
  v_mfma_f32_16x16x32_bf16 v[88:91], a[36:39], a[180:183], v[88:91]
  s_waitcnt lgkmcnt(5)
  ds_read_b128 a[4:7], v3 offset:9216
  v_sub_u32 v6, v6, v7
  v_mfma_f32_16x16x32_bf16 v[64:67], a[40:43], a[136:139], v[64:67]
  v_lshlrev_b32 v6, 2, v6
  v_add_u32 v6, s3, v6
  v_mfma_f32_16x16x32_bf16 v[72:75], a[40:43], a[152:155], v[72:75]
  v_cmp_gt_i32 s[32:33], 0, v6
  v_cmp_gt_i32 s[34:35], 1, v6
  v_mfma_f32_16x16x32_bf16 v[80:83], a[40:43], a[168:171], v[80:83]
  v_cmp_gt_i32 s[36:37], 2, v6
  v_cmp_gt_i32 s[38:39], 3, v6
  v_mfma_f32_16x16x32_bf16 v[88:91], a[40:43], a[184:187], v[88:91]
  ds_read_b128 a[8:11], v3 offset:10240
  v_cmp_gt_i32 s[40:41], 16, v6
  v_mfma_f32_16x16x32_bf16 v[64:67], a[44:47], a[140:143], v[64:67]
  v_cmp_gt_i32 s[42:43], 17, v6
  v_cmp_gt_i32 s[44:45], 18, v6
  v_mfma_f32_16x16x32_bf16 v[72:75], a[44:47], a[156:159], v[72:75]
  v_cmp_gt_i32 s[46:47], 19, v6
  v_cmp_gt_i32 s[48:49], 32, v6
  v_mfma_f32_16x16x32_bf16 v[80:83], a[44:47], a[172:175], v[80:83]
  v_cmp_gt_i32 s[50:51], 33, v6
  v_cmp_gt_i32 s[52:53], 34, v6
  v_mfma_f32_16x16x32_bf16 v[88:91], a[44:47], a[188:191], v[88:91]
  s_waitcnt lgkmcnt(5)
  ds_read_b128 a[12:15], v3 offset:11264
  v_cmp_gt_i32 s[54:55], 35, v6
  v_mfma_f32_16x16x32_bf16 v[68:71], a[48:51], a[128:131], 0
  v_cmp_gt_i32 s[56:57], 48, v6
  v_cmp_gt_i32 s[58:59], 49, v6
  v_mfma_f32_16x16x32_bf16 v[76:79], a[48:51], a[144:147], 0
  s_mov_b32 s30, 0x8000
  v_cmp_gt_i32 s[60:61], 50, v6
  v_cmp_gt_i32 s[62:63], 51, v6
  v_mfma_f32_16x16x32_bf16 v[84:87], a[48:51], a[160:163], 0
  s_mov_b32 s31, 0x4000
  v_mfma_f32_16x16x32_bf16 v[92:95], a[48:51], a[176:179], 0
  ds_read_b128 a[16:19], v3 offset:12288
  v_mfma_f32_16x16x32_bf16 v[68:71], a[52:55], a[132:135], v[68:71]
  v_mfma_f32_16x16x32_bf16 v[76:79], a[52:55], a[148:151], v[76:79]
  v_mfma_f32_16x16x32_bf16 v[84:87], a[52:55], a[164:167], v[84:87]
  v_mfma_f32_16x16x32_bf16 v[92:95], a[52:55], a[180:183], v[92:95]
  s_waitcnt lgkmcnt(5)
  ds_read_b128 a[20:23], v3 offset:13312
  v_mfma_f32_16x16x32_bf16 v[68:71], a[56:59], a[136:139], v[68:71]
  v_mfma_f32_16x16x32_bf16 v[76:79], a[56:59], a[152:155], v[76:79]
  v_mfma_f32_16x16x32_bf16 v[84:87], a[56:59], a[168:171], v[84:87]
  v_mfma_f32_16x16x32_bf16 v[92:95], a[56:59], a[184:187], v[92:95]
  ds_read_b128 a[24:27], v3 offset:14336
  v_mfma_f32_16x16x32_bf16 v[68:71], a[60:63], a[140:143], v[68:71]
  v_mfma_f32_16x16x32_bf16 v[76:79], a[60:63], a[156:159], v[76:79]
  v_mfma_f32_16x16x32_bf16 v[84:87], a[60:63], a[172:175], v[84:87]
  v_mfma_f32_16x16x32_bf16 v[92:95], a[60:63], a[188:191], v[92:95]
  ds_read_b128 a[28:31], v3 offset:15360
  s_cmp_lg_u32 s25, 0
  s_nop 0
  s_cbranch_scc1 La_nomask0
  v_cndmask_b32 v64, v64, v5, s[32:33]
  v_cndmask_b32 v65, v65, v5, s[34:35]
  v_cndmask_b32 v66, v66, v5, s[36:37]
  v_cndmask_b32 v67, v67, v5, s[38:39]
  v_cndmask_b32 v68, v68, v5, s[40:41]
  v_cndmask_b32 v69, v69, v5, s[42:43]
  v_cndmask_b32 v70, v70, v5, s[44:45]
  v_cndmask_b32 v71, v71, v5, s[46:47]
La_nomask0:
  v_max3_f32 v6, v64, v65, v66
  v_max3_f32 v7, v67, v68, v69
  v_max3_f32 v6, v6, v70, v71
  v_max_f32 v6, v6, v7
  v_max3_f32 v8, v72, v73, v74
  v_max3_f32 v9, v75, v76, v77
  v_max3_f32 v8, v8, v78, v79
  v_max_f32 v8, v8, v9
  v_max3_f32 v10, v80, v81, v82
  v_max3_f32 v11, v83, v84, v85
  v_max3_f32 v10, v10, v86, v87
  v_max_f32 v10, v10, v11
  v_max3_f32 v12, v88, v89, v90
  v_max3_f32 v13, v91, v92, v93
  v_max3_f32 v12, v12, v94, v95
  v_max_f32 v12, v12, v13
  v_mov_b32 v7, v6
  v_mov_b32 v9, v8
  v_mov_b32 v11, v10
  v_mov_b32 v13, v12
  v_permlane32_swap_b32 v6, v7
  v_permlane32_swap_b32 v8, v9
  v_permlane32_swap_b32 v10, v11
  v_permlane32_swap_b32 v12, v13
  v_max_f32 v6, v6, v7
  v_max_f32 v8, v8, v9
  v_max_f32 v10, v10, v11
  v_max_f32 v12, v12, v13
  v_mov_b32 v7, v6
  v_mov_b32 v9, v8
  v_mov_b32 v11, v10
  v_mov_b32 v13, v12
  v_permlane16_swap_b32 v6, v7
  v_permlane16_swap_b32 v8, v9
  v_permlane16_swap_b32 v10, v11
  v_permlane16_swap_b32 v12, v13
  v_max_f32 v6, v6, v7
  v_max_f32 v8, v8, v9
  v_max_f32 v10, v10, v11
  v_max_f32 v12, v12, v13
  v_sub_f32 v16, 0, v6
  v_sub_f32 v17, 0, v6
  v_sub_f32 v18, 0, v6
  v_sub_f32 v19, 0, v6
  v_sub_f32 v20, 0, v8
  v_sub_f32 v21, 0, v8
  v_sub_f32 v22, 0, v8
  v_sub_f32 v23, 0, v8
  v_sub_f32 v24, 0, v10
  v_sub_f32 v25, 0, v10
  v_sub_f32 v26, 0, v10
  v_sub_f32 v27, 0, v10
  v_sub_f32 v28, 0, v12
  v_sub_f32 v29, 0, v12
  v_sub_f32 v30, 0, v12
  v_sub_f32 v31, 0, v12
  v_pk_add_f32 v[64:65], v[64:65], v[16:17]
  v_pk_add_f32 v[66:67], v[66:67], v[16:17]
  v_pk_add_f32 v[68:69], v[68:69], v[16:17]
  v_pk_add_f32 v[70:71], v[70:71], v[16:17]
  v_pk_add_f32 v[72:73], v[72:73], v[20:21]
  v_pk_add_f32 v[74:75], v[74:75], v[20:21]
  v_pk_add_f32 v[76:77], v[76:77], v[20:21]
  v_pk_add_f32 v[78:79], v[78:79], v[20:21]
  v_pk_add_f32 v[80:81], v[80:81], v[24:25]
  v_pk_add_f32 v[82:83], v[82:83], v[24:25]
  v_pk_add_f32 v[84:85], v[84:85], v[24:25]
  v_pk_add_f32 v[86:87], v[86:87], v[24:25]
  v_pk_add_f32 v[88:89], v[88:89], v[28:29]
  v_pk_add_f32 v[90:91], v[90:91], v[28:29]
  v_pk_add_f32 v[92:93], v[92:93], v[28:29]
  v_pk_add_f32 v[94:95], v[94:95], v[28:29]
  s_lshl_b32 s88, s25, 1
  s_waitcnt vmcnt(0)
  s_barrier
  s_waitcnt lgkmcnt(4)
  v_mfma_f32_16x16x32_bf16 v[96:99], a[0:3], a[128:131], v[16:19]
  s_mov_b32 m0, s26
  v_exp_f32 v64, v64
  v_mfma_f32_16x16x32_bf16 v[96:99], a[4:7], a[132:135], v[96:99]
  buffer_load_dwordx4 v2, s[20:23], s28 offen offset:0 sc1 lds
  v_exp_f32 v65, v65
  v_mfma_f32_16x16x32_bf16 v[96:99], a[8:11], a[136:139], v[96:99]
  buffer_load_dwordx4 v2, s[20:23], s28 offen offset:1024 sc1 lds
  v_exp_f32 v66, v66
  v_mfma_f32_16x16x32_bf16 v[96:99], a[12:15], a[140:143], v[96:99]
  buffer_load_dwordx4 v2, s[20:23], s28 offen offset:2048 sc1 lds
  v_exp_f32 v67, v67
  v_mfma_f32_16x16x32_bf16 v[104:107], a[0:3], a[144:147], v[20:23]
  v_exp_f32 v68, v68
  v_cvt_pk_bf16_f32 v32, v64, v65
  v_mfma_f32_16x16x32_bf16 v[104:107], a[4:7], a[148:151], v[104:107]
  buffer_load_dwordx4 v2, s[20:23], s28 offen offset:3072 sc1 lds
  v_exp_f32 v69, v69
  v_mfma_f32_16x16x32_bf16 v[104:107], a[8:11], a[152:155], v[104:107]
  s_xor_b32 s26, s26, 0x4000
  v_exp_f32 v70, v70
  v_cvt_pk_bf16_f32 v33, v66, v67
  v_mfma_f32_16x16x32_bf16 v[104:107], a[12:15], a[156:159], v[104:107]
  s_add_u32 s28, s28, 0x8000
  v_exp_f32 v71, v71
  v_cvt_pk_bf16_f32 v34, v68, v69
  v_mfma_f32_16x16x32_bf16 v[112:115], a[0:3], a[160:163], v[24:27]
  s_mov_b32 m0, s27
  v_exp_f32 v72, v72
  v_cvt_pk_bf16_f32 v35, v70, v71
  v_mfma_f32_16x16x32_bf16 v[112:115], a[4:7], a[164:167], v[112:115]
  buffer_load_dwordx4 v2, s[20:23], s29 offen offset:0 sc1 lds
  v_exp_f32 v73, v73
  v_mfma_f32_16x16x32_bf16 v[112:115], a[8:11], a[168:171], v[112:115]
  buffer_load_dwordx4 v2, s[20:23], s29 offen offset:1024 sc1 lds
  v_exp_f32 v74, v74
  v_mfma_f32_16x16x32_bf16 v[112:115], a[12:15], a[172:175], v[112:115]
  buffer_load_dwordx4 v2, s[20:23], s29 offen offset:2048 sc1 lds
  v_exp_f32 v75, v75
  v_mfma_f32_16x16x32_bf16 v[120:123], a[0:3], a[176:179], v[28:31]
  buffer_load_dwordx4 v2, s[20:23], s29 offen offset:3072 sc1 lds
  v_exp_f32 v76, v76
  v_mfma_f32_16x16x32_bf16 v[120:123], a[4:7], a[180:183], v[120:123]
  s_xor_b32 s27, s27, 0x8000
  v_exp_f32 v77, v77
  v_cvt_pk_bf16_f32 v36, v72, v73
  v_mfma_f32_16x16x32_bf16 v[120:123], a[8:11], a[184:187], v[120:123]
  s_add_u32 s29, s29, 0x8000
  v_exp_f32 v78, v78
  v_cvt_pk_bf16_f32 v37, v74, v75
  v_mfma_f32_16x16x32_bf16 v[120:123], a[12:15], a[188:191], v[120:123]
  s_waitcnt lgkmcnt(0)
  v_exp_f32 v79, v79
  v_cvt_pk_bf16_f32 v38, v76, v77
  v_mfma_f32_16x16x32_bf16 v[100:103], a[16:19], a[128:131], v[16:19]
  s_mov_b32 m0, s26
  v_exp_f32 v80, v80
  v_cvt_pk_bf16_f32 v39, v78, v79
  v_mfma_f32_16x16x32_bf16 v[100:103], a[20:23], a[132:135], v[100:103]
  buffer_load_dwordx4 v2, s[20:23], s28 offen offset:0 sc1 lds
  v_exp_f32 v81, v81
  v_mfma_f32_16x16x32_bf16 v[100:103], a[24:27], a[136:139], v[100:103]
  buffer_load_dwordx4 v2, s[20:23], s28 offen offset:1024 sc1 lds
  v_exp_f32 v82, v82
  v_cvt_pk_bf16_f32 v40, v80, v81
  v_mfma_f32_16x16x32_bf16 v[100:103], a[28:31], a[140:143], v[100:103]
  buffer_load_dwordx4 v2, s[20:23], s28 offen offset:2048 sc1 lds
  v_exp_f32 v83, v83
  v_mfma_f32_16x16x32_bf16 v[108:111], a[16:19], a[144:147], v[20:23]
  buffer_load_dwordx4 v2, s[20:23], s28 offen offset:3072 sc1 lds
  v_exp_f32 v84, v84
  v_cvt_pk_bf16_f32 v41, v82, v83
  v_mfma_f32_16x16x32_bf16 v[108:111], a[20:23], a[148:151], v[108:111]
  s_xor_b32 s26, s26, 0x8000
  v_exp_f32 v85, v85
  v_xor_b32 v3, 0x4000, v3
  v_mfma_f32_16x16x32_bf16 v[108:111], a[24:27], a[152:155], v[108:111]
  s_add_u32 s28, s28, 0x8000
  ds_read_b128 a[32:35], v3 offset:0
  v_exp_f32 v86, v86
  v_cvt_pk_bf16_f32 v42, v84, v85
  v_mfma_f32_16x16x32_bf16 v[108:111], a[28:31], a[156:159], v[108:111]
  s_mov_b32 m0, s27
  ds_read_b128 a[36:39], v3 offset:1024
  v_exp_f32 v87, v87
  v_mfma_f32_16x16x32_bf16 v[116:119], a[16:19], a[160:163], v[24:27]
  buffer_load_dwordx4 v2, s[20:23], s29 offen offset:0 sc1 lds
  v_exp_f32 v88, v88
  v_cvt_pk_bf16_f32 v43, v86, v87
  v_mfma_f32_16x16x32_bf16 v[116:119], a[20:23], a[164:167], v[116:119]
  buffer_load_dwordx4 v2, s[20:23], s29 offen offset:1024 sc1 lds
  v_exp_f32 v89, v89
  v_mfma_f32_16x16x32_bf16 v[116:119], a[24:27], a[168:171], v[116:119]
  buffer_load_dwordx4 v2, s[20:23], s29 offen offset:2048 sc1 lds
  v_exp_f32 v90, v90
  v_cvt_pk_bf16_f32 v44, v88, v89
  v_mfma_f32_16x16x32_bf16 v[116:119], a[28:31], a[172:175], v[116:119]
  buffer_load_dwordx4 v2, s[20:23], s29 offen offset:3072 sc1 lds
  v_exp_f32 v91, v91
  v_mfma_f32_16x16x32_bf16 v[124:127], a[16:19], a[176:179], v[28:31]
  s_xor_b32 s27, s27, 0x4000
  ds_read_b128 a[40:43], v3 offset:2048
  v_exp_f32 v92, v92
  v_cvt_pk_bf16_f32 v45, v90, v91
  v_mfma_f32_16x16x32_bf16 v[124:127], a[20:23], a[180:183], v[124:127]
  s_add_u32 s29, s29, 0x8000
  ds_read_b128 a[44:47], v3 offset:3072
  v_exp_f32 v93, v93
  v_mfma_f32_16x16x32_bf16 v[124:127], a[24:27], a[184:187], v[124:127]
  ds_read_b128 a[48:51], v3 offset:4096
  v_exp_f32 v94, v94
  v_cvt_pk_bf16_f32 v46, v92, v93
  v_mfma_f32_16x16x32_bf16 v[124:127], a[28:31], a[188:191], v[124:127]
  ds_read_b128 a[52:55], v3 offset:5120
  ds_read_b128 a[56:59], v3 offset:6144
  ds_read_b128 a[60:63], v3 offset:7168
  ds_read_b128 a[0:3], v4 offset:0
  ds_read_b128 a[4:7], v4 offset:1024
  ds_read_b128 a[8:11], v4 offset:2048
  v_exp_f32 v95, v95
  s_nop 0
  v_cvt_pk_bf16_f32 v47, v94, v95
  s_cmp_eq_u32 s25, 0
  s_cbranch_scc1 La_d1
  .p2align 6
La_lo:
  s_waitcnt lgkmcnt(7)
  v_mfma_f32_16x16x32_bf16 v[64:67], a[32:35], a[128:131], v[16:19]
  v_exp_f32 v96, v96
  v_mfma_f32_16x16x32_bf16 v[64:67], a[36:39], a[132:135], v[64:67]
  ds_read_b128 a[12:15], v4 offset:3072
  v_mfma_f32_16x16x32_bf16 v[64:67], a[40:43], a[136:139], v[64:67]
  v_exp_f32 v97, v97
  v_mfma_f32_16x16x32_bf16 v[64:67], a[44:47], a[140:143], v[64:67]
  v_cvt_pk_bf16_f32 v48, v96, v97
  v_mfma_f32_16x16x32_bf16 v[72:75], a[32:35], a[144:147], v[20:23]
  v_exp_f32 v98, v98
  v_mfma_f32_16x16x32_bf16 v[72:75], a[36:39], a[148:151], v[72:75]
  ds_read_b128 a[16:19], v4 offset:4096
  v_mfma_f32_16x16x32_bf16 v[72:75], a[40:43], a[152:155], v[72:75]
  v_exp_f32 v99, v99
  v_mfma_f32_16x16x32_bf16 v[72:75], a[44:47], a[156:159], v[72:75]
  v_cvt_pk_bf16_f32 v49, v98, v99
  v_mfma_f32_16x16x32_bf16 v[80:83], a[32:35], a[160:163], v[24:27]
  v_exp_f32 v100, v100
  v_mfma_f32_16x16x32_bf16 v[80:83], a[36:39], a[164:167], v[80:83]
  ds_read_b128 a[20:23], v4 offset:5120
  v_mfma_f32_16x16x32_bf16 v[80:83], a[40:43], a[168:171], v[80:83]
  v_exp_f32 v101, v101
  v_mfma_f32_16x16x32_bf16 v[80:83], a[44:47], a[172:175], v[80:83]
  v_cvt_pk_bf16_f32 v50, v100, v101
  v_mfma_f32_16x16x32_bf16 v[88:91], a[32:35], a[176:179], v[28:31]
  v_exp_f32 v102, v102
  v_mfma_f32_16x16x32_bf16 v[88:91], a[36:39], a[180:183], v[88:91]
  ds_read_b128 a[24:27], v4 offset:6144
  v_mfma_f32_16x16x32_bf16 v[88:91], a[40:43], a[184:187], v[88:91]
  v_exp_f32 v103, v103
  v_mfma_f32_16x16x32_bf16 v[88:91], a[44:47], a[188:191], v[88:91]
  s_waitcnt lgkmcnt(7)
  v_cvt_pk_bf16_f32 v51, v102, v103
  v_mfma_f32_16x16x32_bf16 v[68:71], a[48:51], a[128:131], v[16:19]
  v_exp_f32 v104, v104
  v_mfma_f32_16x16x32_bf16 v[68:71], a[52:55], a[132:135], v[68:71]
  ds_read_b128 a[28:31], v4 offset:7168
  v_mfma_f32_16x16x32_bf16 v[68:71], a[56:59], a[136:139], v[68:71]
  v_exp_f32 v105, v105
  v_mfma_f32_16x16x32_bf16 v[68:71], a[60:63], a[140:143], v[68:71]
  v_cvt_pk_bf16_f32 v52, v104, v105
  v_mfma_f32_16x16x32_bf16 v[76:79], a[48:51], a[144:147], v[20:23]
  v_exp_f32 v106, v106
  v_mfma_f32_16x16x32_bf16 v[76:79], a[52:55], a[148:151], v[76:79]
  ds_read_b128 a[32:35], v3 offset:8192
  v_mfma_f32_16x16x32_bf16 v[76:79], a[56:59], a[152:155], v[76:79]
  v_exp_f32 v107, v107
  v_mfma_f32_16x16x32_bf16 v[76:79], a[60:63], a[156:159], v[76:79]
  v_cvt_pk_bf16_f32 v53, v106, v107
  v_mfma_f32_16x16x32_bf16 v[84:87], a[48:51], a[160:163], v[24:27]
  v_exp_f32 v108, v108
  v_mfma_f32_16x16x32_bf16 v[84:87], a[52:55], a[164:167], v[84:87]
  ds_read_b128 a[36:39], v3 offset:9216
  v_mfma_f32_16x16x32_bf16 v[84:87], a[56:59], a[168:171], v[84:87]
  v_exp_f32 v109, v109
  v_mfma_f32_16x16x32_bf16 v[84:87], a[60:63], a[172:175], v[84:87]
  v_cvt_pk_bf16_f32 v54, v108, v109
  v_mfma_f32_16x16x32_bf16 v[92:95], a[48:51], a[176:179], v[28:31]
  v_exp_f32 v110, v110
  v_mfma_f32_16x16x32_bf16 v[92:95], a[52:55], a[180:183], v[92:95]
  ds_read_b128 a[40:43], v3 offset:10240
  v_mfma_f32_16x16x32_bf16 v[92:95], a[56:59], a[184:187], v[92:95]
  v_exp_f32 v111, v111
  v_mfma_f32_16x16x32_bf16 v[92:95], a[60:63], a[188:191], v[92:95]
  s_waitcnt lgkmcnt(7)
  v_cvt_pk_bf16_f32 v55, v110, v111
  v_mfma_f32_16x16x32_bf16 v[128:131], a[0:3], v[32:35], v[128:131]
  ds_read_b128 a[44:47], v3 offset:11264
  v_mfma_f32_16x16x32_bf16 v[160:163], a[0:3], v[36:39], v[160:163]
  v_exp_f32 v112, v112
  v_mfma_f32_16x16x32_bf16 v[192:195], a[0:3], v[40:43], v[192:195]
  s_sub_u32 s88, s88, 1
  v_mfma_f32_16x16x32_bf16 v[224:227], a[0:3], v[44:47], v[224:227]
  v_exp_f32 v113, v113
  v_mfma_f32_16x16x32_bf16 a[192:195], a[208:211], v[32:35], a[192:195]
  v_cvt_pk_bf16_f32 v56, v112, v113
  v_mfma_f32_16x16x32_bf16 v[132:135], a[4:7], v[32:35], v[132:135]
  v_exp_f32 v114, v114
  v_mfma_f32_16x16x32_bf16 v[164:167], a[4:7], v[36:39], v[164:167]
  ds_read_b128 a[48:51], v3 offset:12288
  v_mfma_f32_16x16x32_bf16 v[196:199], a[4:7], v[40:43], v[196:199]
  v_exp_f32 v115, v115
  v_mfma_f32_16x16x32_bf16 v[228:231], a[4:7], v[44:47], v[228:231]
  v_cvt_pk_bf16_f32 v57, v114, v115
  v_mfma_f32_16x16x32_bf16 a[196:199], a[208:211], v[36:39], a[196:199]
  v_exp_f32 v116, v116
  v_mfma_f32_16x16x32_bf16 v[136:139], a[8:11], v[32:35], v[136:139]
  ds_read_b128 a[52:55], v3 offset:13312
  v_mfma_f32_16x16x32_bf16 v[168:171], a[8:11], v[36:39], v[168:171]
  v_exp_f32 v117, v117
  v_mfma_f32_16x16x32_bf16 v[200:203], a[8:11], v[40:43], v[200:203]
  v_cvt_pk_bf16_f32 v58, v116, v117
  v_mfma_f32_16x16x32_bf16 v[232:235], a[8:11], v[44:47], v[232:235]
  v_exp_f32 v118, v118
  v_mfma_f32_16x16x32_bf16 a[200:203], a[208:211], v[40:43], a[200:203]
  v_mfma_f32_16x16x32_bf16 v[140:143], a[12:15], v[32:35], v[140:143]
  v_exp_f32 v119, v119
  v_mfma_f32_16x16x32_bf16 v[172:175], a[12:15], v[36:39], v[172:175]
  ds_read_b128 a[56:59], v3 offset:14336
  v_cvt_pk_bf16_f32 v59, v118, v119
  v_mfma_f32_16x16x32_bf16 v[204:207], a[12:15], v[40:43], v[204:207]
  v_exp_f32 v120, v120
  v_mfma_f32_16x16x32_bf16 v[236:239], a[12:15], v[44:47], v[236:239]
  v_mfma_f32_16x16x32_bf16 a[204:207], a[208:211], v[44:47], a[204:207]
  s_waitcnt lgkmcnt(7)
  v_exp_f32 v121, v121
  v_mfma_f32_16x16x32_bf16 v[144:147], a[16:19], v[32:35], v[144:147]
  ds_read_b128 a[60:63], v3 offset:15360
  v_cvt_pk_bf16_f32 v60, v120, v121
  v_mfma_f32_16x16x32_bf16 v[176:179], a[16:19], v[36:39], v[176:179]
  v_exp_f32 v122, v122
  v_mfma_f32_16x16x32_bf16 v[208:211], a[16:19], v[40:43], v[208:211]
  v_mfma_f32_16x16x32_bf16 v[240:243], a[16:19], v[44:47], v[240:243]
  v_exp_f32 v123, v123
  v_mfma_f32_16x16x32_bf16 v[148:151], a[20:23], v[32:35], v[148:151]
  ds_read_b128 a[0:3], v4 offset:8192
  v_cvt_pk_bf16_f32 v61, v122, v123
  v_mfma_f32_16x16x32_bf16 v[180:183], a[20:23], v[36:39], v[180:183]
  v_exp_f32 v124, v124
  v_mfma_f32_16x16x32_bf16 v[212:215], a[20:23], v[40:43], v[212:215]
  v_mfma_f32_16x16x32_bf16 v[244:247], a[20:23], v[44:47], v[244:247]
  v_exp_f32 v125, v125
  v_mfma_f32_16x16x32_bf16 v[152:155], a[24:27], v[32:35], v[152:155]
  ds_read_b128 a[4:7], v4 offset:9216
  v_cvt_pk_bf16_f32 v62, v124, v125
  v_mfma_f32_16x16x32_bf16 v[184:187], a[24:27], v[36:39], v[184:187]
  v_exp_f32 v126, v126
  v_mfma_f32_16x16x32_bf16 v[216:219], a[24:27], v[40:43], v[216:219]
  v_mfma_f32_16x16x32_bf16 v[248:251], a[24:27], v[44:47], v[248:251]
  v_exp_f32 v127, v127
  v_mfma_f32_16x16x32_bf16 v[156:159], a[28:31], v[32:35], v[156:159]
  ds_read_b128 a[8:11], v4 offset:10240
  v_cvt_pk_bf16_f32 v63, v126, v127
  v_mfma_f32_16x16x32_bf16 v[188:191], a[28:31], v[36:39], v[188:191]
  v_mfma_f32_16x16x32_bf16 v[220:223], a[28:31], v[40:43], v[220:223]
  s_waitcnt vmcnt(8)
  s_barrier
  v_mfma_f32_16x16x32_bf16 v[252:255], a[28:31], v[44:47], v[252:255]
  s_cmp_eq_u32 s88, 0
  s_cbranch_scc1 La_d0
  s_waitcnt lgkmcnt(7)
  v_mfma_f32_16x16x32_bf16 v[96:99], a[32:35], a[128:131], v[16:19]
  s_mov_b32 m0, s26
  v_exp_f32 v64, v64
  v_mfma_f32_16x16x32_bf16 v[96:99], a[36:39], a[132:135], v[96:99]
  buffer_load_dwordx4 v2, s[20:23], s28 offen offset:0 sc1 lds
  ds_read_b128 a[12:15], v4 offset:11264
  v_mfma_f32_16x16x32_bf16 v[96:99], a[40:43], a[136:139], v[96:99]
  v_exp_f32 v65, v65
  v_mfma_f32_16x16x32_bf16 v[96:99], a[44:47], a[140:143], v[96:99]
  v_cvt_pk_bf16_f32 v32, v64, v65
  v_mfma_f32_16x16x32_bf16 v[104:107], a[32:35], a[144:147], v[20:23]
  v_exp_f32 v66, v66
  v_mfma_f32_16x16x32_bf16 v[104:107], a[36:39], a[148:151], v[104:107]
  ds_read_b128 a[16:19], v4 offset:12288
  v_mfma_f32_16x16x32_bf16 v[104:107], a[40:43], a[152:155], v[104:107]
  v_exp_f32 v67, v67
  v_mfma_f32_16x16x32_bf16 v[104:107], a[44:47], a[156:159], v[104:107]
  v_cvt_pk_bf16_f32 v33, v66, v67
  v_mfma_f32_16x16x32_bf16 v[112:115], a[32:35], a[160:163], v[24:27]
  v_exp_f32 v68, v68
  v_mfma_f32_16x16x32_bf16 v[112:115], a[36:39], a[164:167], v[112:115]
  buffer_load_dwordx4 v2, s[20:23], s28 offen offset:1024 sc1 lds
  ds_read_b128 a[20:23], v4 offset:13312
  v_mfma_f32_16x16x32_bf16 v[112:115], a[40:43], a[168:171], v[112:115]
  v_exp_f32 v69, v69
  v_mfma_f32_16x16x32_bf16 v[112:115], a[44:47], a[172:175], v[112:115]
  v_cvt_pk_bf16_f32 v34, v68, v69
  v_mfma_f32_16x16x32_bf16 v[120:123], a[32:35], a[176:179], v[28:31]
  v_exp_f32 v70, v70
  v_mfma_f32_16x16x32_bf16 v[120:123], a[36:39], a[180:183], v[120:123]
  ds_read_b128 a[24:27], v4 offset:14336
  v_mfma_f32_16x16x32_bf16 v[120:123], a[40:43], a[184:187], v[120:123]
  v_exp_f32 v71, v71
  v_mfma_f32_16x16x32_bf16 v[120:123], a[44:47], a[188:191], v[120:123]
  s_waitcnt lgkmcnt(7)
  v_cvt_pk_bf16_f32 v35, v70, v71
  v_mfma_f32_16x16x32_bf16 v[100:103], a[48:51], a[128:131], v[16:19]
  v_exp_f32 v72, v72
  v_mfma_f32_16x16x32_bf16 v[100:103], a[52:55], a[132:135], v[100:103]
  buffer_load_dwordx4 v2, s[20:23], s28 offen offset:2048 sc1 lds
  ds_read_b128 a[28:31], v4 offset:15360
  v_mfma_f32_16x16x32_bf16 v[100:103], a[56:59], a[136:139], v[100:103]
  v_exp_f32 v73, v73
  v_mfma_f32_16x16x32_bf16 v[100:103], a[60:63], a[140:143], v[100:103]
  v_xor_b32 v3, s30, v3
  v_cvt_pk_bf16_f32 v36, v72, v73
  v_mfma_f32_16x16x32_bf16 v[108:111], a[48:51], a[144:147], v[20:23]
  v_exp_f32 v74, v74
  v_mfma_f32_16x16x32_bf16 v[108:111], a[52:55], a[148:151], v[108:111]
  ds_read_b128 a[32:35], v3 offset:0
  v_mfma_f32_16x16x32_bf16 v[108:111], a[56:59], a[152:155], v[108:111]
  v_exp_f32 v75, v75
  v_mfma_f32_16x16x32_bf16 v[108:111], a[60:63], a[156:159], v[108:111]
  v_cvt_pk_bf16_f32 v37, v74, v75
  v_mfma_f32_16x16x32_bf16 v[116:119], a[48:51], a[160:163], v[24:27]
  v_exp_f32 v76, v76
  v_mfma_f32_16x16x32_bf16 v[116:119], a[52:55], a[164:167], v[116:119]
  buffer_load_dwordx4 v2, s[20:23], s28 offen offset:3072 sc1 lds
  ds_read_b128 a[36:39], v3 offset:1024
  v_mfma_f32_16x16x32_bf16 v[116:119], a[56:59], a[168:171], v[116:119]
  s_xor_b32 s26, s26, s31
  v_exp_f32 v77, v77
  v_mfma_f32_16x16x32_bf16 v[116:119], a[60:63], a[172:175], v[116:119]
  s_add_u32 s28, s28, 0x8000
  s_mov_b32 m0, s27
  v_cvt_pk_bf16_f32 v38, v76, v77
  v_mfma_f32_16x16x32_bf16 v[124:127], a[48:51], a[176:179], v[28:31]
  v_exp_f32 v78, v78
  v_mfma_f32_16x16x32_bf16 v[124:127], a[52:55], a[180:183], v[124:127]
  ds_read_b128 a[40:43], v3 offset:2048
  v_mfma_f32_16x16x32_bf16 v[124:127], a[56:59], a[184:187], v[124:127]
  v_exp_f32 v79, v79
  v_mfma_f32_16x16x32_bf16 v[124:127], a[60:63], a[188:191], v[124:127]
  s_waitcnt lgkmcnt(7)
  v_cvt_pk_bf16_f32 v39, v78, v79
  v_mfma_f32_16x16x32_bf16 v[128:131], a[0:3], v[48:51], v[128:131]
  buffer_load_dwordx4 v2, s[20:23], s29 offen offset:0 sc1 lds
  ds_read_b128 a[44:47], v3 offset:3072
  v_mfma_f32_16x16x32_bf16 v[160:163], a[0:3], v[52:55], v[160:163]
  v_exp_f32 v80, v80
  v_mfma_f32_16x16x32_bf16 v[192:195], a[0:3], v[56:59], v[192:195]
  v_mfma_f32_16x16x32_bf16 v[224:227], a[0:3], v[60:63], v[224:227]
  v_exp_f32 v81, v81
  v_mfma_f32_16x16x32_bf16 a[192:195], a[208:211], v[48:51], a[192:195]
  v_cvt_pk_bf16_f32 v40, v80, v81
  v_mfma_f32_16x16x32_bf16 v[132:135], a[4:7], v[48:51], v[132:135]
  v_exp_f32 v82, v82
  v_mfma_f32_16x16x32_bf16 v[164:167], a[4:7], v[52:55], v[164:167]
  ds_read_b128 a[48:51], v3 offset:4096
  v_mfma_f32_16x16x32_bf16 v[196:199], a[4:7], v[56:59], v[196:199]
  v_exp_f32 v83, v83
  v_mfma_f32_16x16x32_bf16 v[228:231], a[4:7], v[60:63], v[228:231]
  buffer_load_dwordx4 v2, s[20:23], s29 offen offset:1024 sc1 lds
  v_cvt_pk_bf16_f32 v41, v82, v83
  v_mfma_f32_16x16x32_bf16 a[196:199], a[208:211], v[52:55], a[196:199]
  v_exp_f32 v84, v84
  v_mfma_f32_16x16x32_bf16 v[136:139], a[8:11], v[48:51], v[136:139]
  ds_read_b128 a[52:55], v3 offset:5120
  v_mfma_f32_16x16x32_bf16 v[168:171], a[8:11], v[52:55], v[168:171]
  v_exp_f32 v85, v85
  v_mfma_f32_16x16x32_bf16 v[200:203], a[8:11], v[56:59], v[200:203]
  v_cvt_pk_bf16_f32 v42, v84, v85
  v_mfma_f32_16x16x32_bf16 v[232:235], a[8:11], v[60:63], v[232:235]
  v_exp_f32 v86, v86
  v_mfma_f32_16x16x32_bf16 a[200:203], a[208:211], v[56:59], a[200:203]
  v_mfma_f32_16x16x32_bf16 v[140:143], a[12:15], v[48:51], v[140:143]
  v_exp_f32 v87, v87
  v_mfma_f32_16x16x32_bf16 v[172:175], a[12:15], v[52:55], v[172:175]
  buffer_load_dwordx4 v2, s[20:23], s29 offen offset:2048 sc1 lds
  ds_read_b128 a[56:59], v3 offset:6144
  v_mfma_f32_16x16x32_bf16 v[204:207], a[12:15], v[56:59], v[204:207]
  v_exp_f32 v88, v88
  v_mfma_f32_16x16x32_bf16 v[236:239], a[12:15], v[60:63], v[236:239]
  v_cvt_pk_bf16_f32 v43, v86, v87
  v_mfma_f32_16x16x32_bf16 a[204:207], a[208:211], v[60:63], a[204:207]
  s_waitcnt lgkmcnt(7)
  v_exp_f32 v89, v89
  v_mfma_f32_16x16x32_bf16 v[144:147], a[16:19], v[48:51], v[144:147]
  ds_read_b128 a[60:63], v3 offset:7168
  v_cvt_pk_bf16_f32 v44, v88, v89
  v_mfma_f32_16x16x32_bf16 v[176:179], a[16:19], v[52:55], v[176:179]
  v_exp_f32 v90, v90
  v_mfma_f32_16x16x32_bf16 v[208:211], a[16:19], v[56:59], v[208:211]
  v_mfma_f32_16x16x32_bf16 v[240:243], a[16:19], v[60:63], v[240:243]
  v_exp_f32 v91, v91
  v_mfma_f32_16x16x32_bf16 v[148:151], a[20:23], v[48:51], v[148:151]
  buffer_load_dwordx4 v2, s[20:23], s29 offen offset:3072 sc1 lds
  v_xor_b32 v4, s31, v4
  v_mfma_f32_16x16x32_bf16 v[180:183], a[20:23], v[52:55], v[180:183]
  s_xor_b32 s27, s27, s30
  v_exp_f32 v92, v92
  v_mfma_f32_16x16x32_bf16 v[212:215], a[20:23], v[56:59], v[212:215]
  s_add_u32 s29, s29, 0x8000
  ds_read_b128 a[0:3], v4 offset:0
  v_cvt_pk_bf16_f32 v45, v90, v91
  v_mfma_f32_16x16x32_bf16 v[244:247], a[20:23], v[60:63], v[244:247]
  v_exp_f32 v93, v93
  v_mfma_f32_16x16x32_bf16 v[152:155], a[24:27], v[48:51], v[152:155]
  ds_read_b128 a[4:7], v4 offset:1024
  v_cvt_pk_bf16_f32 v46, v92, v93
  v_mfma_f32_16x16x32_bf16 v[184:187], a[24:27], v[52:55], v[184:187]
  v_exp_f32 v94, v94
  v_mfma_f32_16x16x32_bf16 v[216:219], a[24:27], v[56:59], v[216:219]
  v_mfma_f32_16x16x32_bf16 v[248:251], a[24:27], v[60:63], v[248:251]
  v_exp_f32 v95, v95
  v_mfma_f32_16x16x32_bf16 v[156:159], a[28:31], v[48:51], v[156:159]
  ds_read_b128 a[8:11], v4 offset:2048
  v_cvt_pk_bf16_f32 v47, v94, v95
  v_mfma_f32_16x16x32_bf16 v[188:191], a[28:31], v[52:55], v[188:191]
  v_mfma_f32_16x16x32_bf16 v[220:223], a[28:31], v[56:59], v[220:223]
  v_mfma_f32_16x16x32_bf16 v[252:255], a[28:31], v[60:63], v[252:255]
  s_xor_b32 s30, s30, 0xc000
  s_xor_b32 s31, s31, 0xc000
  s_branch La_lo
La_d0:
  s_waitcnt lgkmcnt(7)
  v_mfma_f32_16x16x32_bf16 v[96:99], a[32:35], a[128:131], v[16:19]
  s_mov_b32 m0, s26
  ds_read_b128 a[12:15], v4 offset:11264
  v_cndmask_b32 v64, v64, v5, s[32:33]
  v_mfma_f32_16x16x32_bf16 v[96:99], a[36:39], a[132:135], v[96:99]
  v_exp_f32 v64, v64
  v_mfma_f32_16x16x32_bf16 v[96:99], a[40:43], a[136:139], v[96:99]
  v_cndmask_b32 v65, v65, v5, s[34:35]
  v_exp_f32 v65, v65
  v_mfma_f32_16x16x32_bf16 v[96:99], a[44:47], a[140:143], v[96:99]
  buffer_load_dwordx4 v2, s[20:23], s28 offen offset:0 sc1 lds
  v_cndmask_b32 v66, v66, v5, s[36:37]
  v_mfma_f32_16x16x32_bf16 v[104:107], a[32:35], a[144:147], v[20:23]
  v_exp_f32 v66, v66
  v_mfma_f32_16x16x32_bf16 v[104:107], a[36:39], a[148:151], v[104:107]
  ds_read_b128 a[16:19], v4 offset:12288
  v_cndmask_b32 v67, v67, v5, s[38:39]
  v_mfma_f32_16x16x32_bf16 v[104:107], a[40:43], a[152:155], v[104:107]
  v_exp_f32 v67, v67
  v_mfma_f32_16x16x32_bf16 v[104:107], a[44:47], a[156:159], v[104:107]
  v_cndmask_b32 v68, v68, v5, s[40:41]
  v_cndmask_b32 v69, v69, v5, s[42:43]
  v_mfma_f32_16x16x32_bf16 v[112:115], a[32:35], a[160:163], v[24:27]
  v_exp_f32 v68, v68
  v_mfma_f32_16x16x32_bf16 v[112:115], a[36:39], a[164:167], v[112:115]
  buffer_load_dwordx4 v2, s[20:23], s28 offen offset:1024 sc1 lds
  ds_read_b128 a[20:23], v4 offset:13312
  v_mfma_f32_16x16x32_bf16 v[112:115], a[40:43], a[168:171], v[112:115]
  v_exp_f32 v69, v69
  v_mfma_f32_16x16x32_bf16 v[112:115], a[44:47], a[172:175], v[112:115]
  v_cndmask_b32 v70, v70, v5, s[44:45]
  v_cvt_pk_bf16_f32 v32, v64, v65
  v_mfma_f32_16x16x32_bf16 v[120:123], a[32:35], a[176:179], v[28:31]
  v_exp_f32 v70, v70
  v_mfma_f32_16x16x32_bf16 v[120:123], a[36:39], a[180:183], v[120:123]
  ds_read_b128 a[24:27], v4 offset:14336
  v_cndmask_b32 v71, v71, v5, s[46:47]
  v_mfma_f32_16x16x32_bf16 v[120:123], a[40:43], a[184:187], v[120:123]
  v_exp_f32 v71, v71
  v_mfma_f32_16x16x32_bf16 v[120:123], a[44:47], a[188:191], v[120:123]
  s_waitcnt lgkmcnt(7)
  v_cvt_pk_bf16_f32 v33, v66, v67
  v_cvt_pk_bf16_f32 v34, v68, v69
  v_mfma_f32_16x16x32_bf16 v[100:103], a[48:51], a[128:131], v[16:19]
  v_exp_f32 v72, v72
  v_mfma_f32_16x16x32_bf16 v[100:103], a[52:55], a[132:135], v[100:103]
  buffer_load_dwordx4 v2, s[20:23], s28 offen offset:2048 sc1 lds
  ds_read_b128 a[28:31], v4 offset:15360
  v_mfma_f32_16x16x32_bf16 v[100:103], a[56:59], a[136:139], v[100:103]
  v_exp_f32 v73, v73
  v_mfma_f32_16x16x32_bf16 v[100:103], a[60:63], a[140:143], v[100:103]
  v_xor_b32 v3, 0x4000, v3
  v_cvt_pk_bf16_f32 v35, v70, v71
  v_mfma_f32_16x16x32_bf16 v[108:111], a[48:51], a[144:147], v[20:23]
  v_exp_f32 v74, v74
  v_mfma_f32_16x16x32_bf16 v[108:111], a[52:55], a[148:151], v[108:111]
  ds_read_b128 a[32:35], v3 offset:0
  v_cvt_pk_bf16_f32 v36, v72, v73
  v_mfma_f32_16x16x32_bf16 v[108:111], a[56:59], a[152:155], v[108:111]
  v_exp_f32 v75, v75
  v_mfma_f32_16x16x32_bf16 v[108:111], a[60:63], a[156:159], v[108:111]
  v_cvt_pk_bf16_f32 v37, v74, v75
  v_mfma_f32_16x16x32_bf16 v[116:119], a[48:51], a[160:163], v[24:27]
  v_exp_f32 v76, v76
  v_mfma_f32_16x16x32_bf16 v[116:119], a[52:55], a[164:167], v[116:119]
  buffer_load_dwordx4 v2, s[20:23], s28 offen offset:3072 sc1 lds
  ds_read_b128 a[36:39], v3 offset:1024
  v_mfma_f32_16x16x32_bf16 v[116:119], a[56:59], a[168:171], v[116:119]
  s_xor_b32 s26, s26, 0x8000
  v_exp_f32 v77, v77
  v_mfma_f32_16x16x32_bf16 v[116:119], a[60:63], a[172:175], v[116:119]
  s_add_u32 s28, s28, 0x8000
  s_mov_b32 m0, s27
  v_cvt_pk_bf16_f32 v38, v76, v77
  v_mfma_f32_16x16x32_bf16 v[124:127], a[48:51], a[176:179], v[28:31]
  v_exp_f32 v78, v78
  v_mfma_f32_16x16x32_bf16 v[124:127], a[52:55], a[180:183], v[124:127]
  ds_read_b128 a[40:43], v3 offset:2048
  v_mfma_f32_16x16x32_bf16 v[124:127], a[56:59], a[184:187], v[124:127]
  v_exp_f32 v79, v79
  v_mfma_f32_16x16x32_bf16 v[124:127], a[60:63], a[188:191], v[124:127]
  s_waitcnt lgkmcnt(7)
  v_cvt_pk_bf16_f32 v39, v78, v79
  v_mfma_f32_16x16x32_bf16 v[128:131], a[0:3], v[48:51], v[128:131]
  buffer_load_dwordx4 v2, s[20:23], s29 offen offset:0 sc1 lds
  ds_read_b128 a[44:47], v3 offset:3072
  v_mfma_f32_16x16x32_bf16 v[160:163], a[0:3], v[52:55], v[160:163]
  v_exp_f32 v80, v80
  v_mfma_f32_16x16x32_bf16 v[192:195], a[0:3], v[56:59], v[192:195]
  v_mfma_f32_16x16x32_bf16 v[224:227], a[0:3], v[60:63], v[224:227]
  v_exp_f32 v81, v81
  v_mfma_f32_16x16x32_bf16 a[192:195], a[208:211], v[48:51], a[192:195]
  v_cvt_pk_bf16_f32 v40, v80, v81
  v_mfma_f32_16x16x32_bf16 v[132:135], a[4:7], v[48:51], v[132:135]
  v_exp_f32 v82, v82
  v_mfma_f32_16x16x32_bf16 v[164:167], a[4:7], v[52:55], v[164:167]
  ds_read_b128 a[48:51], v3 offset:4096
  v_mfma_f32_16x16x32_bf16 v[196:199], a[4:7], v[56:59], v[196:199]
  v_exp_f32 v83, v83
  v_mfma_f32_16x16x32_bf16 v[228:231], a[4:7], v[60:63], v[228:231]
  buffer_load_dwordx4 v2, s[20:23], s29 offen offset:1024 sc1 lds
  v_cvt_pk_bf16_f32 v41, v82, v83
  v_mfma_f32_16x16x32_bf16 a[196:199], a[208:211], v[52:55], a[196:199]
  v_exp_f32 v84, v84
  v_mfma_f32_16x16x32_bf16 v[136:139], a[8:11], v[48:51], v[136:139]
  ds_read_b128 a[52:55], v3 offset:5120
  v_mfma_f32_16x16x32_bf16 v[168:171], a[8:11], v[52:55], v[168:171]
  v_exp_f32 v85, v85
  v_mfma_f32_16x16x32_bf16 v[200:203], a[8:11], v[56:59], v[200:203]
  v_cvt_pk_bf16_f32 v42, v84, v85
  v_mfma_f32_16x16x32_bf16 v[232:235], a[8:11], v[60:63], v[232:235]
  v_exp_f32 v86, v86
  v_mfma_f32_16x16x32_bf16 a[200:203], a[208:211], v[56:59], a[200:203]
  v_mfma_f32_16x16x32_bf16 v[140:143], a[12:15], v[48:51], v[140:143]
  v_exp_f32 v87, v87
  v_mfma_f32_16x16x32_bf16 v[172:175], a[12:15], v[52:55], v[172:175]
  buffer_load_dwordx4 v2, s[20:23], s29 offen offset:2048 sc1 lds
  ds_read_b128 a[56:59], v3 offset:6144
  v_mfma_f32_16x16x32_bf16 v[204:207], a[12:15], v[56:59], v[204:207]
  v_exp_f32 v88, v88
  v_mfma_f32_16x16x32_bf16 v[236:239], a[12:15], v[60:63], v[236:239]
  v_cvt_pk_bf16_f32 v43, v86, v87
  v_mfma_f32_16x16x32_bf16 a[204:207], a[208:211], v[60:63], a[204:207]
  s_waitcnt lgkmcnt(7)
  v_exp_f32 v89, v89
  v_mfma_f32_16x16x32_bf16 v[144:147], a[16:19], v[48:51], v[144:147]
  ds_read_b128 a[60:63], v3 offset:7168
  v_cvt_pk_bf16_f32 v44, v88, v89
  v_mfma_f32_16x16x32_bf16 v[176:179], a[16:19], v[52:55], v[176:179]
  v_exp_f32 v90, v90
  v_mfma_f32_16x16x32_bf16 v[208:211], a[16:19], v[56:59], v[208:211]
  v_mfma_f32_16x16x32_bf16 v[240:243], a[16:19], v[60:63], v[240:243]
  v_exp_f32 v91, v91
  v_mfma_f32_16x16x32_bf16 v[148:151], a[20:23], v[48:51], v[148:151]
  buffer_load_dwordx4 v2, s[20:23], s29 offen offset:3072 sc1 lds
  v_xor_b32 v4, 0x8000, v4
  v_mfma_f32_16x16x32_bf16 v[180:183], a[20:23], v[52:55], v[180:183]
  s_xor_b32 s27, s27, 0x4000
  v_exp_f32 v92, v92
  v_mfma_f32_16x16x32_bf16 v[212:215], a[20:23], v[56:59], v[212:215]
  s_add_u32 s29, s29, 0x8000
  ds_read_b128 a[0:3], v4 offset:0
  v_cvt_pk_bf16_f32 v45, v90, v91
  v_mfma_f32_16x16x32_bf16 v[244:247], a[20:23], v[60:63], v[244:247]
  v_exp_f32 v93, v93
  v_mfma_f32_16x16x32_bf16 v[152:155], a[24:27], v[48:51], v[152:155]
  ds_read_b128 a[4:7], v4 offset:1024
  v_cvt_pk_bf16_f32 v46, v92, v93
  v_mfma_f32_16x16x32_bf16 v[184:187], a[24:27], v[52:55], v[184:187]
  v_exp_f32 v94, v94
  v_mfma_f32_16x16x32_bf16 v[216:219], a[24:27], v[56:59], v[216:219]
  v_mfma_f32_16x16x32_bf16 v[248:251], a[24:27], v[60:63], v[248:251]
  v_exp_f32 v95, v95
  v_mfma_f32_16x16x32_bf16 v[156:159], a[28:31], v[48:51], v[156:159]
  ds_read_b128 a[8:11], v4 offset:2048
  v_cvt_pk_bf16_f32 v47, v94, v95
  v_mfma_f32_16x16x32_bf16 v[188:191], a[28:31], v[52:55], v[188:191]
  v_mfma_f32_16x16x32_bf16 v[220:223], a[28:31], v[56:59], v[220:223]
  v_mfma_f32_16x16x32_bf16 v[252:255], a[28:31], v[60:63], v[252:255]
La_d1:
  s_waitcnt lgkmcnt(7)
  v_mfma_f32_16x16x32_bf16 v[72:75], a[32:35], a[144:147], v[20:23]
  buffer_load_dwordx4 a[64:67], v2, s[8:11], s6 offen offset:0
  ds_read_b128 a[12:15], v4 offset:3072
  v_mfma_f32_16x16x32_bf16 v[72:75], a[36:39], a[148:151], v[72:75]
  v_cndmask_b32 v96, v96, v5, s[48:49]
  v_exp_f32 v96, v96
  v_mfma_f32_16x16x32_bf16 v[72:75], a[40:43], a[152:155], v[72:75]
  v_cndmask_b32 v97, v97, v5, s[50:51]
  v_exp_f32 v97, v97
  v_mfma_f32_16x16x32_bf16 v[72:75], a[44:47], a[156:159], v[72:75]
  v_cndmask_b32 v98, v98, v5, s[52:53]
  v_exp_f32 v98, v98
  v_mfma_f32_16x16x32_bf16 v[80:83], a[32:35], a[160:163], v[24:27]
  ds_read_b128 a[16:19], v4 offset:4096
  v_cndmask_b32 v99, v99, v5, s[54:55]
  v_mfma_f32_16x16x32_bf16 v[80:83], a[36:39], a[164:167], v[80:83]
  v_exp_f32 v99, v99
  v_mfma_f32_16x16x32_bf16 v[80:83], a[40:43], a[168:171], v[80:83]
  buffer_load_dwordx4 a[64:67], v2, s[8:11], s6 offen offset:1024
  ds_read_b128 a[20:23], v4 offset:5120
  v_mfma_f32_16x16x32_bf16 v[80:83], a[44:47], a[172:175], v[80:83]
  v_cndmask_b32 v100, v100, v5, s[56:57]
  v_exp_f32 v100, v100
  v_mfma_f32_16x16x32_bf16 v[88:91], a[32:35], a[176:179], v[28:31]
  v_cndmask_b32 v101, v101, v5, s[58:59]
  v_cndmask_b32 v102, v102, v5, s[60:61]
  v_mfma_f32_16x16x32_bf16 v[88:91], a[36:39], a[180:183], v[88:91]
  v_exp_f32 v101, v101
  v_mfma_f32_16x16x32_bf16 v[88:91], a[40:43], a[184:187], v[88:91]
  v_exp_f32 v102, v102
  v_mfma_f32_16x16x32_bf16 v[88:91], a[44:47], a[188:191], v[88:91]
  s_waitcnt lgkmcnt(6)
  buffer_load_dwordx4 a[64:67], v2, s[8:11], s6 offen offset:2048
  ds_read_b128 a[24:27], v4 offset:6144
  v_mfma_f32_16x16x32_bf16 v[76:79], a[48:51], a[144:147], v[20:23]
  v_cndmask_b32 v103, v103, v5, s[62:63]
  v_exp_f32 v103, v103
  v_mfma_f32_16x16x32_bf16 v[76:79], a[52:55], a[148:151], v[76:79]
  ds_read_b128 a[28:31], v4 offset:7168
  v_cvt_pk_bf16_f32 v48, v96, v97
  v_mfma_f32_16x16x32_bf16 v[76:79], a[56:59], a[152:155], v[76:79]
  v_exp_f32 v104, v104
  v_mfma_f32_16x16x32_bf16 v[76:79], a[60:63], a[156:159], v[76:79]
  ds_read_b128 a[32:35], v3 offset:8192
  v_cvt_pk_bf16_f32 v49, v98, v99
  v_mfma_f32_16x16x32_bf16 v[84:87], a[48:51], a[160:163], v[24:27]
  v_exp_f32 v105, v105
  v_mfma_f32_16x16x32_bf16 v[84:87], a[52:55], a[164:167], v[84:87]
  buffer_load_dwordx4 a[64:67], v2, s[8:11], s6 offen offset:3072
  v_cvt_pk_bf16_f32 v50, v100, v101
  v_mfma_f32_16x16x32_bf16 v[84:87], a[56:59], a[168:171], v[84:87]
  s_add_u32 s6, s6, 4096
  v_exp_f32 v106, v106
  v_mfma_f32_16x16x32_bf16 v[84:87], a[60:63], a[172:175], v[84:87]
  v_exp_f32 v107, v107
  v_mfma_f32_16x16x32_bf16 v[92:95], a[48:51], a[176:179], v[28:31]
  ds_read_b128 a[36:39], v3 offset:9216
  v_cvt_pk_bf16_f32 v51, v102, v103
  v_mfma_f32_16x16x32_bf16 v[92:95], a[52:55], a[180:183], v[92:95]
  v_exp_f32 v108, v108
  v_mfma_f32_16x16x32_bf16 v[92:95], a[56:59], a[184:187], v[92:95]
  buffer_load_dwordx4 a[64:67], v2, s[8:11], s6 offen offset:0
  ds_read_b128 a[40:43], v3 offset:10240
  v_mfma_f32_16x16x32_bf16 v[92:95], a[60:63], a[188:191], v[92:95]
  s_waitcnt lgkmcnt(7)
  v_exp_f32 v109, v109
  v_mfma_f32_16x16x32_bf16 v[128:131], a[0:3], v[32:35], v[128:131]
  ds_read_b128 a[44:47], v3 offset:11264
  v_cvt_pk_bf16_f32 v52, v104, v105
  v_mfma_f32_16x16x32_bf16 v[160:163], a[0:3], v[36:39], v[160:163]
  v_exp_f32 v110, v110
  v_mfma_f32_16x16x32_bf16 v[192:195], a[0:3], v[40:43], v[192:195]
  v_cvt_pk_bf16_f32 v53, v106, v107
  v_cvt_pk_bf16_f32 v54, v108, v109
  v_mfma_f32_16x16x32_bf16 v[224:227], a[0:3], v[44:47], v[224:227]
  v_exp_f32 v111, v111
  v_mfma_f32_16x16x32_bf16 a[192:195], a[208:211], v[32:35], a[192:195]
  buffer_load_dwordx4 a[64:67], v2, s[8:11], s6 offen offset:1024
  v_cvt_pk_bf16_f32 v55, v110, v111
  v_mfma_f32_16x16x32_bf16 v[132:135], a[4:7], v[32:35], v[132:135]
  v_exp_f32 v112, v112
  v_mfma_f32_16x16x32_bf16 v[164:167], a[4:7], v[36:39], v[164:167]
  v_exp_f32 v113, v113
  v_mfma_f32_16x16x32_bf16 v[196:199], a[4:7], v[40:43], v[196:199]
  ds_read_b128 a[48:51], v3 offset:12288
  v_cvt_pk_bf16_f32 v56, v112, v113
  v_mfma_f32_16x16x32_bf16 v[228:231], a[4:7], v[44:47], v[228:231]
  v_exp_f32 v114, v114
  v_mfma_f32_16x16x32_bf16 a[196:199], a[208:211], v[36:39], a[196:199]
  buffer_load_dwordx4 a[64:67], v2, s[8:11], s6 offen offset:2048
  v_mfma_f32_16x16x32_bf16 v[136:139], a[8:11], v[32:35], v[136:139]
  v_exp_f32 v115, v115
  v_mfma_f32_16x16x32_bf16 v[168:171], a[8:11], v[36:39], v[168:171]
  ds_read_b128 a[52:55], v3 offset:13312
  v_cvt_pk_bf16_f32 v57, v114, v115
  v_mfma_f32_16x16x32_bf16 v[200:203], a[8:11], v[40:43], v[200:203]
  v_exp_f32 v116, v116
  v_mfma_f32_16x16x32_bf16 v[232:235], a[8:11], v[44:47], v[232:235]
  v_mfma_f32_16x16x32_bf16 a[200:203], a[208:211], v[40:43], a[200:203]
  v_exp_f32 v117, v117
  v_mfma_f32_16x16x32_bf16 v[140:143], a[12:15], v[32:35], v[140:143]
  v_exp_f32 v118, v118
  v_mfma_f32_16x16x32_bf16 v[172:175], a[12:15], v[36:39], v[172:175]
  buffer_load_dwordx4 a[64:67], v2, s[8:11], s6 offen offset:3072
  ds_read_b128 a[56:59], v3 offset:14336
  v_mfma_f32_16x16x32_bf16 v[204:207], a[12:15], v[40:43], v[204:207]
  v_exp_f32 v119, v119
  v_mfma_f32_16x16x32_bf16 v[236:239], a[12:15], v[44:47], v[236:239]
  v_cvt_pk_bf16_f32 v58, v116, v117
  v_cvt_pk_bf16_f32 v59, v118, v119
  v_mfma_f32_16x16x32_bf16 a[204:207], a[208:211], v[44:47], a[204:207]
  s_waitcnt lgkmcnt(7)
  v_exp_f32 v120, v120
  v_mfma_f32_16x16x32_bf16 v[144:147], a[16:19], v[32:35], v[144:147]
  buffer_load_dwordx4 a[64:67], v2, s[12:15], s7 offen offset:0
  ds_read_b128 a[60:63], v3 offset:15360
  v_mfma_f32_16x16x32_bf16 v[176:179], a[16:19], v[36:39], v[176:179]
  v_exp_f32 v121, v121
  v_mfma_f32_16x16x32_bf16 v[208:211], a[16:19], v[40:43], v[208:211]
  v_cvt_pk_bf16_f32 v60, v120, v121
  v_mfma_f32_16x16x32_bf16 v[240:243], a[16:19], v[44:47], v[240:243]
  v_exp_f32 v122, v122
  v_mfma_f32_16x16x32_bf16 v[148:151], a[20:23], v[32:35], v[148:151]
  v_exp_f32 v123, v123
  v_mfma_f32_16x16x32_bf16 v[180:183], a[20:23], v[36:39], v[180:183]
  ds_read_b128 a[0:3], v4 offset:8192
  v_cvt_pk_bf16_f32 v61, v122, v123
  v_mfma_f32_16x16x32_bf16 v[212:215], a[20:23], v[40:43], v[212:215]
  v_exp_f32 v124, v124
  v_mfma_f32_16x16x32_bf16 v[244:247], a[20:23], v[44:47], v[244:247]
  buffer_load_dwordx4 a[64:67], v2, s[12:15], s7 offen offset:1024
  v_mfma_f32_16x16x32_bf16 v[152:155], a[24:27], v[32:35], v[152:155]
  v_exp_f32 v125, v125
  v_mfma_f32_16x16x32_bf16 v[184:187], a[24:27], v[36:39], v[184:187]
  ds_read_b128 a[4:7], v4 offset:9216
  v_cvt_pk_bf16_f32 v62, v124, v125
  v_mfma_f32_16x16x32_bf16 v[216:219], a[24:27], v[40:43], v[216:219]
  v_exp_f32 v126, v126
  v_mfma_f32_16x16x32_bf16 v[248:251], a[24:27], v[44:47], v[248:251]
  v_mfma_f32_16x16x32_bf16 v[156:159], a[28:31], v[32:35], v[156:159]
  v_exp_f32 v127, v127
  v_mfma_f32_16x16x32_bf16 v[188:191], a[28:31], v[36:39], v[188:191]
  ds_read_b128 a[8:11], v4 offset:10240
  v_cvt_pk_bf16_f32 v63, v126, v127
  v_mfma_f32_16x16x32_bf16 v[220:223], a[28:31], v[40:43], v[220:223]
  s_waitcnt vmcnt(22)
  s_barrier
  v_mfma_f32_16x16x32_bf16 v[252:255], a[28:31], v[44:47], v[252:255]
  s_waitcnt lgkmcnt(7)
  v_mfma_f32_16x16x32_bf16 v[104:107], a[32:35], a[144:147], v[20:23]
  s_mov_b32 m0, s26
  ds_read_b128 a[12:15], v4 offset:11264
  v_cndmask_b32 v72, v72, v5, s[32:33]
  v_mfma_f32_16x16x32_bf16 v[104:107], a[36:39], a[148:151], v[104:107]
  v_exp_f32 v72, v72
  v_mfma_f32_16x16x32_bf16 v[104:107], a[40:43], a[152:155], v[104:107]
  v_cndmask_b32 v73, v73, v5, s[34:35]
  v_exp_f32 v73, v73
  v_mfma_f32_16x16x32_bf16 v[104:107], a[44:47], a[156:159], v[104:107]
  buffer_load_dwordx4 v2, s[20:23], s28 offen offset:0 sc1 lds
  ds_read_b128 a[16:19], v4 offset:12288
  v_mfma_f32_16x16x32_bf16 v[112:115], a[32:35], a[160:163], v[24:27]
  v_cndmask_b32 v74, v74, v5, s[36:37]
  v_exp_f32 v74, v74
  v_mfma_f32_16x16x32_bf16 v[112:115], a[36:39], a[164:167], v[112:115]
  v_cvt_pk_bf16_f32 v36, v72, v73
  v_mfma_f32_16x16x32_bf16 v[112:115], a[40:43], a[168:171], v[112:115]
  ds_read_b128 a[20:23], v4 offset:13312
  v_cndmask_b32 v75, v75, v5, s[38:39]
  v_mfma_f32_16x16x32_bf16 v[112:115], a[44:47], a[172:175], v[112:115]
  v_exp_f32 v75, v75
  v_mfma_f32_16x16x32_bf16 v[120:123], a[32:35], a[176:179], v[28:31]
  buffer_load_dwordx4 v2, s[20:23], s28 offen offset:1024 sc1 lds
  v_cndmask_b32 v76, v76, v5, s[40:41]
  v_mfma_f32_16x16x32_bf16 v[120:123], a[36:39], a[180:183], v[120:123]
  v_exp_f32 v76, v76
  v_mfma_f32_16x16x32_bf16 v[120:123], a[40:43], a[184:187], v[120:123]
  ds_read_b128 a[24:27], v4 offset:14336
  v_cndmask_b32 v79, v79, v5, s[46:47]
  v_mfma_f32_16x16x32_bf16 v[120:123], a[44:47], a[188:191], v[120:123]
  s_waitcnt lgkmcnt(7)
  v_cndmask_b32 v77, v77, v5, s[42:43]
  v_cndmask_b32 v78, v78, v5, s[44:45]
  v_mfma_f32_16x16x32_bf16 v[108:111], a[48:51], a[144:147], v[20:23]
  v_exp_f32 v77, v77
  v_mfma_f32_16x16x32_bf16 v[108:111], a[52:55], a[148:151], v[108:111]
  ds_read_b128 a[28:31], v4 offset:15360
  v_xor_b32 v4, 0x4000, v4
  v_mfma_f32_16x16x32_bf16 v[108:111], a[56:59], a[152:155], v[108:111]
  v_exp_f32 v78, v78
  v_mfma_f32_16x16x32_bf16 v[108:111], a[60:63], a[156:159], v[108:111]
  buffer_load_dwordx4 v2, s[20:23], s28 offen offset:2048 sc1 lds
  v_xor_b32 v3, 0x8000, v3
  v_mfma_f32_16x16x32_bf16 v[116:119], a[48:51], a[160:163], v[24:27]
  v_exp_f32 v79, v79
  v_mfma_f32_16x16x32_bf16 v[116:119], a[52:55], a[164:167], v[116:119]
  ds_read_b128 a[32:35], v3 offset:0
  v_cvt_pk_bf16_f32 v37, v74, v75
  v_mfma_f32_16x16x32_bf16 v[116:119], a[56:59], a[168:171], v[116:119]
  ds_read_b128 a[36:39], v3 offset:1024
  v_cvt_pk_bf16_f32 v38, v76, v77
  v_mfma_f32_16x16x32_bf16 v[116:119], a[60:63], a[172:175], v[116:119]
  v_exp_f32 v80, v80
  v_mfma_f32_16x16x32_bf16 v[124:127], a[48:51], a[176:179], v[28:31]
  v_cvt_pk_bf16_f32 v39, v78, v79
  v_mfma_f32_16x16x32_bf16 v[124:127], a[52:55], a[180:183], v[124:127]
  v_exp_f32 v81, v81
  v_mfma_f32_16x16x32_bf16 v[124:127], a[56:59], a[184:187], v[124:127]
  buffer_load_dwordx4 v2, s[20:23], s28 offen offset:3072 sc1 lds
  ds_read_b128 a[40:43], v3 offset:2048
  v_mfma_f32_16x16x32_bf16 v[124:127], a[60:63], a[188:191], v[124:127]
  s_waitcnt lgkmcnt(7)
  s_xor_b32 s26, s26, 0x4000
  s_add_u32 s28, s28, 0x8000
  v_mfma_f32_16x16x32_bf16 v[128:131], a[0:3], v[48:51], v[128:131]
  s_mov_b32 m0, s27
  v_exp_f32 v82, v82
  v_mfma_f32_16x16x32_bf16 v[160:163], a[0:3], v[52:55], v[160:163]
  ds_read_b128 a[44:47], v3 offset:3072
  v_cvt_pk_bf16_f32 v40, v80, v81
  v_mfma_f32_16x16x32_bf16 v[192:195], a[0:3], v[56:59], v[192:195]
  v_exp_f32 v83, v83
  v_mfma_f32_16x16x32_bf16 v[224:227], a[0:3], v[60:63], v[224:227]
  v_cvt_pk_bf16_f32 v41, v82, v83
  v_mfma_f32_16x16x32_bf16 a[192:195], a[208:211], v[48:51], a[192:195]
  buffer_load_dwordx4 v2, s[20:23], s29 offen offset:0 sc1 lds
  v_mfma_f32_16x16x32_bf16 v[132:135], a[4:7], v[48:51], v[132:135]
  v_exp_f32 v84, v84
  v_mfma_f32_16x16x32_bf16 v[164:167], a[4:7], v[52:55], v[164:167]
  ds_read_b128 a[48:51], v3 offset:4096
  v_mfma_f32_16x16x32_bf16 v[196:199], a[4:7], v[56:59], v[196:199]
  v_exp_f32 v85, v85
  v_mfma_f32_16x16x32_bf16 v[228:231], a[4:7], v[60:63], v[228:231]
  v_cvt_pk_bf16_f32 v42, v84, v85
  v_mfma_f32_16x16x32_bf16 a[196:199], a[208:211], v[52:55], a[196:199]
  v_exp_f32 v86, v86
  v_mfma_f32_16x16x32_bf16 v[136:139], a[8:11], v[48:51], v[136:139]
  ds_read_b128 a[52:55], v3 offset:5120
  v_mfma_f32_16x16x32_bf16 v[168:171], a[8:11], v[52:55], v[168:171]
  buffer_load_dwordx4 v2, s[20:23], s29 offen offset:1024 sc1 lds
  v_mfma_f32_16x16x32_bf16 v[200:203], a[8:11], v[56:59], v[200:203]
  v_exp_f32 v87, v87
  v_mfma_f32_16x16x32_bf16 v[232:235], a[8:11], v[60:63], v[232:235]
  v_cvt_pk_bf16_f32 v43, v86, v87
  v_mfma_f32_16x16x32_bf16 a[200:203], a[208:211], v[56:59], a[200:203]
  v_exp_f32 v88, v88
  v_mfma_f32_16x16x32_bf16 v[140:143], a[12:15], v[48:51], v[140:143]
  ds_read_b128 a[56:59], v3 offset:6144
  v_mfma_f32_16x16x32_bf16 v[172:175], a[12:15], v[52:55], v[172:175]
  v_mfma_f32_16x16x32_bf16 v[204:207], a[12:15], v[56:59], v[204:207]
  v_exp_f32 v89, v89
  v_mfma_f32_16x16x32_bf16 v[236:239], a[12:15], v[60:63], v[236:239]
  buffer_load_dwordx4 v2, s[20:23], s29 offen offset:2048 sc1 lds
  v_cvt_pk_bf16_f32 v44, v88, v89
  v_mfma_f32_16x16x32_bf16 a[204:207], a[208:211], v[60:63], a[204:207]
  s_waitcnt lgkmcnt(7)
  v_exp_f32 v90, v90
  v_mfma_f32_16x16x32_bf16 v[144:147], a[16:19], v[48:51], v[144:147]
  ds_read_b128 a[60:63], v3 offset:7168
  v_mfma_f32_16x16x32_bf16 v[176:179], a[16:19], v[52:55], v[176:179]
  v_exp_f32 v91, v91
  v_mfma_f32_16x16x32_bf16 v[208:211], a[16:19], v[56:59], v[208:211]
  v_cvt_pk_bf16_f32 v45, v90, v91
  v_mfma_f32_16x16x32_bf16 v[240:243], a[16:19], v[60:63], v[240:243]
  v_mfma_f32_16x16x32_bf16 v[148:151], a[20:23], v[48:51], v[148:151]
  v_exp_f32 v92, v92
  v_mfma_f32_16x16x32_bf16 v[180:183], a[20:23], v[52:55], v[180:183]
  buffer_load_dwordx4 v2, s[20:23], s29 offen offset:3072 sc1 lds
  ds_read_b128 a[0:3], v3 offset:8192
  v_mfma_f32_16x16x32_bf16 v[212:215], a[20:23], v[56:59], v[212:215]
  s_xor_b32 s27, s27, 0x8000
  v_exp_f32 v93, v93
  v_mfma_f32_16x16x32_bf16 v[244:247], a[20:23], v[60:63], v[244:247]
  s_add_u32 s29, s29, 0x8000
  v_cvt_pk_bf16_f32 v46, v92, v93
  v_mfma_f32_16x16x32_bf16 v[152:155], a[24:27], v[48:51], v[152:155]
  ds_read_b128 a[4:7], v3 offset:9216
  v_mfma_f32_16x16x32_bf16 v[184:187], a[24:27], v[52:55], v[184:187]
  v_exp_f32 v94, v94
  v_mfma_f32_16x16x32_bf16 v[216:219], a[24:27], v[56:59], v[216:219]
  v_mfma_f32_16x16x32_bf16 v[248:251], a[24:27], v[60:63], v[248:251]
  v_exp_f32 v95, v95
  v_mfma_f32_16x16x32_bf16 v[156:159], a[28:31], v[48:51], v[156:159]
  ds_read_b128 a[8:11], v3 offset:10240
  v_cvt_pk_bf16_f32 v47, v94, v95
  v_mfma_f32_16x16x32_bf16 v[188:191], a[28:31], v[52:55], v[188:191]
  v_mfma_f32_16x16x32_bf16 v[220:223], a[28:31], v[56:59], v[220:223]
  s_waitcnt vmcnt(22)
  s_barrier
  v_mfma_f32_16x16x32_bf16 v[252:255], a[28:31], v[60:63], v[252:255]
  s_lshr_b32 s91, s73, 1
  s_lshl_b32 s91, s91, 11
  s_add_u32 s91, s91, 32768
  v_and_b32 v14, 15, v1
  v_lshlrev_b32 v14, 7, v14
  s_waitcnt lgkmcnt(3)
  v_mfma_f32_16x16x32_bf16 v[64:67], a[32:35], a[160:163], v[24:27]
  s_mov_b32 m0, s26
  ds_read_b128 a[12:15], v3 offset:11264
  v_cndmask_b32 v104, v104, v5, s[48:49]
  v_mfma_f32_16x16x32_bf16 v[64:67], a[36:39], a[164:167], v[64:67]
  v_exp_f32 v104, v104
  v_mfma_f32_16x16x32_bf16 v[64:67], a[40:43], a[168:171], v[64:67]
  v_cndmask_b32 v105, v105, v5, s[50:51]
  v_exp_f32 v105, v105
  v_mfma_f32_16x16x32_bf16 v[64:67], a[44:47], a[172:175], v[64:67]
  buffer_load_dwordx4 v2, s[20:23], s28 offen offset:0 sc1 lds
  ds_read_b128 a[16:19], v3 offset:12288
  v_mfma_f32_16x16x32_bf16 v[72:75], a[32:35], a[176:179], v[28:31]
  v_cndmask_b32 v106, v106, v5, s[52:53]
  v_exp_f32 v106, v106
  v_mfma_f32_16x16x32_bf16 v[72:75], a[36:39], a[180:183], v[72:75]
  ds_read_b128 a[20:23], v3 offset:13312
  v_cndmask_b32 v107, v107, v5, s[54:55]
  v_mfma_f32_16x16x32_bf16 v[72:75], a[40:43], a[184:187], v[72:75]
  buffer_load_dwordx4 v2, s[20:23], s28 offen offset:1024 sc1 lds
  ds_read_b128 a[24:27], v3 offset:14336
  v_mfma_f32_16x16x32_bf16 v[72:75], a[44:47], a[188:191], v[72:75]
  v_exp_f32 v107, v107
  v_mfma_f32_16x16x32_bf16 v[68:71], a[48:51], a[160:163], v[24:27]
  ds_read_b128 a[28:31], v3 offset:15360
  v_cndmask_b32 v108, v108, v5, s[56:57]
  v_mfma_f32_16x16x32_bf16 v[68:71], a[52:55], a[164:167], v[68:71]
  v_exp_f32 v108, v108
  v_mfma_f32_16x16x32_bf16 v[68:71], a[56:59], a[168:171], v[68:71]
  ds_read_b128 a[32:35], v4 offset:0
  v_cndmask_b32 v109, v109, v5, s[58:59]
  v_mfma_f32_16x16x32_bf16 v[68:71], a[60:63], a[172:175], v[68:71]
  v_exp_f32 v109, v109
  v_mfma_f32_16x16x32_bf16 v[76:79], a[48:51], a[176:179], v[28:31]
  ds_read_b128 a[36:39], v4 offset:1024
  v_cvt_pk_bf16_f32 v52, v104, v105
  v_mfma_f32_16x16x32_bf16 v[76:79], a[52:55], a[180:183], v[76:79]
  buffer_load_dwordx4 v2, s[20:23], s28 offen offset:2048 sc1 lds
  v_cndmask_b32 v110, v110, v5, s[60:61]
  v_mfma_f32_16x16x32_bf16 v[76:79], a[56:59], a[184:187], v[76:79]
  v_exp_f32 v110, v110
  v_mfma_f32_16x16x32_bf16 v[76:79], a[60:63], a[188:191], v[76:79]
  s_waitcnt lgkmcnt(2)
  ds_read_b128 a[40:43], v4 offset:2048
  v_cndmask_b32 v111, v111, v5, s[62:63]
  v_mfma_f32_16x16x32_bf16 v[80:83], a[0:3], a[160:163], v[24:27]
  v_exp_f32 v111, v111
  v_mfma_f32_16x16x32_bf16 v[80:83], a[4:7], a[164:167], v[80:83]
  ds_read_b128 a[44:47], v4 offset:3072
  v_cvt_pk_bf16_f32 v53, v106, v107
  v_mfma_f32_16x16x32_bf16 v[80:83], a[8:11], a[168:171], v[80:83]
  ds_read_b128 a[48:51], v4 offset:4096
  v_cvt_pk_bf16_f32 v54, v108, v109
  v_mfma_f32_16x16x32_bf16 v[80:83], a[12:15], a[172:175], v[80:83]
  v_exp_f32 v112, v112
  v_mfma_f32_16x16x32_bf16 v[88:91], a[0:3], a[176:179], v[28:31]
  buffer_load_dwordx4 v2, s[20:23], s28 offen offset:3072 sc1 lds
  ds_read_b128 a[52:55], v4 offset:5120
  v_mfma_f32_16x16x32_bf16 v[88:91], a[4:7], a[180:183], v[88:91]
  s_xor_b32 s26, s26, 0x8000
  v_exp_f32 v113, v113
  v_mfma_f32_16x16x32_bf16 v[88:91], a[8:11], a[184:187], v[88:91]
  s_add_u32 s28, s28, 0x8000
  s_mov_b32 m0, s27
  ds_read_b128 a[56:59], v4 offset:6144
  v_mfma_f32_16x16x32_bf16 v[88:91], a[12:15], a[188:191], v[88:91]
  v_exp_f32 v114, v114
  v_mfma_f32_16x16x32_bf16 v[84:87], a[16:19], a[160:163], v[24:27]
  ds_read_b128 a[60:63], v4 offset:7168
  v_cvt_pk_bf16_f32 v55, v110, v111
  v_mfma_f32_16x16x32_bf16 v[84:87], a[20:23], a[164:167], v[84:87]
  v_xor_b32 v3, 0x4000, v3
  v_cvt_pk_bf16_f32 v56, v112, v113
  v_mfma_f32_16x16x32_bf16 v[84:87], a[24:27], a[168:171], v[84:87]
  v_exp_f32 v115, v115
  v_mfma_f32_16x16x32_bf16 v[84:87], a[28:31], a[172:175], v[84:87]
  buffer_load_dwordx4 v2, s[20:23], s29 offen offset:0 sc1 lds
  ds_read_b128 a[0:3], v3 offset:0
  v_mfma_f32_16x16x32_bf16 v[92:95], a[16:19], a[176:179], v[28:31]
  v_exp_f32 v116, v116
  v_mfma_f32_16x16x32_bf16 v[92:95], a[20:23], a[180:183], v[92:95]
  ds_read_b128 a[4:7], v3 offset:1024
  v_cvt_pk_bf16_f32 v57, v114, v115
  v_mfma_f32_16x16x32_bf16 v[92:95], a[24:27], a[184:187], v[92:95]
  v_exp_f32 v117, v117
  v_mfma_f32_16x16x32_bf16 v[92:95], a[28:31], a[188:191], v[92:95]
  s_waitcnt lgkmcnt(6)
  ds_read_b128 a[8:11], v3 offset:2048
  v_cvt_pk_bf16_f32 v58, v116, v117
  v_mfma_f32_16x16x32_bf16 v[160:163], a[32:35], v[36:39], v[160:163]
  ds_read_b128 a[12:15], v3 offset:3072
  v_mfma_f32_16x16x32_bf16 v[192:195], a[32:35], v[40:43], v[192:195]
  v_exp_f32 v118, v118
  v_mfma_f32_16x16x32_bf16 v[224:227], a[32:35], v[44:47], v[224:227]
  buffer_load_dwordx4 v2, s[20:23], s29 offen offset:1024 sc1 lds
  v_mfma_f32_16x16x32_bf16 a[196:199], a[208:211], v[36:39], a[196:199]
  v_exp_f32 v119, v119
  v_mfma_f32_16x16x32_bf16 v[164:167], a[36:39], v[36:39], v[164:167]
  ds_read_b128 a[16:19], v3 offset:4096
  v_cvt_pk_bf16_f32 v59, v118, v119
  v_mfma_f32_16x16x32_bf16 v[196:199], a[36:39], v[40:43], v[196:199]
  v_mfma_f32_16x16x32_bf16 v[228:231], a[36:39], v[44:47], v[228:231]
  v_exp_f32 v120, v120
  v_mfma_f32_16x16x32_bf16 a[200:203], a[208:211], v[40:43], a[200:203]
  v_mfma_f32_16x16x32_bf16 v[168:171], a[40:43], v[36:39], v[168:171]
  v_exp_f32 v121, v121
  v_mfma_f32_16x16x32_bf16 v[200:203], a[40:43], v[40:43], v[200:203]
  buffer_load_dwordx4 v2, s[20:23], s29 offen offset:2048 sc1 lds
  ds_read_b128 a[20:23], v3 offset:5120
  v_mfma_f32_16x16x32_bf16 v[232:235], a[40:43], v[44:47], v[232:235]
  v_exp_f32 v122, v122
  v_mfma_f32_16x16x32_bf16 a[204:207], a[208:211], v[44:47], a[204:207]
  v_cvt_pk_bf16_f32 v60, v120, v121
  v_mfma_f32_16x16x32_bf16 v[172:175], a[44:47], v[36:39], v[172:175]
  ds_read_b128 a[24:27], v3 offset:6144
  v_mfma_f32_16x16x32_bf16 v[204:207], a[44:47], v[40:43], v[204:207]
  v_exp_f32 v123, v123
  v_mfma_f32_16x16x32_bf16 v[236:239], a[44:47], v[44:47], v[236:239]
  s_waitcnt lgkmcnt(7)
  v_cvt_pk_bf16_f32 v61, v122, v123
  v_mfma_f32_16x16x32_bf16 v[176:179], a[48:51], v[36:39], v[176:179]
  v_exp_f32 v124, v124
  v_mfma_f32_16x16x32_bf16 v[208:211], a[48:51], v[40:43], v[208:211]
  buffer_load_dwordx4 v2, s[20:23], s29 offen offset:3072 sc1 lds
  ds_read_b128 a[28:31], v3 offset:7168
  v_mfma_f32_16x16x32_bf16 v[240:243], a[48:51], v[44:47], v[240:243]
  s_xor_b32 s27, s27, 0x4000
  v_exp_f32 v125, v125
  v_mfma_f32_16x16x32_bf16 v[180:183], a[52:55], v[36:39], v[180:183]
  s_add_u32 s29, s29, 0x8000
  ds_read_b128 a[32:35], v3 offset:8192
  v_cvt_pk_bf16_f32 v62, v124, v125
  v_mfma_f32_16x16x32_bf16 v[212:215], a[52:55], v[40:43], v[212:215]
  v_mfma_f32_16x16x32_bf16 v[244:247], a[52:55], v[44:47], v[244:247]
  v_exp_f32 v126, v126
  v_mfma_f32_16x16x32_bf16 v[184:187], a[56:59], v[36:39], v[184:187]
  ds_read_b128 a[36:39], v3 offset:9216
  v_mfma_f32_16x16x32_bf16 v[216:219], a[56:59], v[40:43], v[216:219]
  v_exp_f32 v127, v127
  v_mfma_f32_16x16x32_bf16 v[248:251], a[56:59], v[44:47], v[248:251]
  v_cvt_pk_bf16_f32 v63, v126, v127
  v_mfma_f32_16x16x32_bf16 v[188:191], a[60:63], v[36:39], v[188:191]
  ds_read_b128 a[40:43], v3 offset:10240
  v_mfma_f32_16x16x32_bf16 v[220:223], a[60:63], v[40:43], v[220:223]
  s_waitcnt vmcnt(12)
  s_barrier
  v_mfma_f32_16x16x32_bf16 v[252:255], a[60:63], v[44:47], v[252:255]
  s_cmp_eq_u32 s25, 7
  s_cbranch_scc1 La_t7
  s_waitcnt lgkmcnt(3)
  v_mfma_f32_16x16x32_bf16 v[96:99], a[0:3], a[160:163], v[24:27]
  s_mov_b32 m0, s26
  v_exp_f32 v64, v64
  v_mfma_f32_16x16x32_bf16 v[96:99], a[4:7], a[164:167], v[96:99]
  v_exp_f32 v65, v65
  v_mfma_f32_16x16x32_bf16 v[96:99], a[8:11], a[168:171], v[96:99]
  buffer_load_dwordx4 v2, s[20:23], s28 offen offset:0 sc1 lds
  ds_read_b128 a[44:47], v3 offset:11264
  v_mfma_f32_16x16x32_bf16 v[96:99], a[12:15], a[172:175], v[96:99]
  v_exp_f32 v66, v66
  v_mfma_f32_16x16x32_bf16 v[104:107], a[0:3], a[176:179], v[28:31]
  ds_read_b128 a[48:51], v3 offset:12288
  ds_read_b128 a[52:55], v3 offset:13312
  v_mfma_f32_16x16x32_bf16 v[104:107], a[4:7], a[180:183], v[104:107]
  v_exp_f32 v67, v67
  v_mfma_f32_16x16x32_bf16 v[104:107], a[8:11], a[184:187], v[104:107]
  ds_read_b128 a[56:59], v3 offset:14336
  v_cvt_pk_bf16_f32 v32, v64, v65
  v_mfma_f32_16x16x32_bf16 v[104:107], a[12:15], a[188:191], v[104:107]
  v_exp_f32 v68, v68
  v_mfma_f32_16x16x32_bf16 v[100:103], a[16:19], a[160:163], v[24:27]
  v_exp_f32 v69, v69
  v_mfma_f32_16x16x32_bf16 v[100:103], a[20:23], a[164:167], v[100:103]
  ds_read_b128 a[60:63], v3 offset:15360
  v_cvt_pk_bf16_f32 v33, v66, v67
  v_mfma_f32_16x16x32_bf16 v[100:103], a[24:27], a[168:171], v[100:103]
  v_exp_f32 v70, v70
  v_mfma_f32_16x16x32_bf16 v[100:103], a[28:31], a[172:175], v[100:103]
  ds_read_b128 a[0:3], v4 offset:8192
  v_cvt_pk_bf16_f32 v34, v68, v69
  v_mfma_f32_16x16x32_bf16 v[108:111], a[16:19], a[176:179], v[28:31]
  v_exp_f32 v71, v71
  v_mfma_f32_16x16x32_bf16 v[108:111], a[20:23], a[180:183], v[108:111]
  buffer_load_dwordx4 v2, s[20:23], s28 offen offset:1024 sc1 lds
  ds_read_b128 a[4:7], v4 offset:9216
  v_mfma_f32_16x16x32_bf16 v[108:111], a[24:27], a[184:187], v[108:111]
  v_exp_f32 v72, v72
  v_mfma_f32_16x16x32_bf16 v[108:111], a[28:31], a[188:191], v[108:111]
  s_waitcnt lgkmcnt(2)
  ds_read_b128 a[8:11], v4 offset:10240
  v_cvt_pk_bf16_f32 v35, v70, v71
  v_mfma_f32_16x16x32_bf16 v[112:115], a[32:35], a[160:163], v[24:27]
  v_exp_f32 v73, v73
  v_mfma_f32_16x16x32_bf16 v[112:115], a[36:39], a[164:167], v[112:115]
  v_exp_f32 v74, v74
  v_mfma_f32_16x16x32_bf16 v[112:115], a[40:43], a[168:171], v[112:115]
  ds_read_b128 a[12:15], v4 offset:11264
  ds_read_b128 a[16:19], v4 offset:12288
  v_mfma_f32_16x16x32_bf16 v[112:115], a[44:47], a[172:175], v[112:115]
  v_exp_f32 v75, v75
  v_mfma_f32_16x16x32_bf16 v[120:123], a[32:35], a[176:179], v[28:31]
  ds_read_b128 a[20:23], v4 offset:13312
  v_cvt_pk_bf16_f32 v36, v72, v73
  v_mfma_f32_16x16x32_bf16 v[120:123], a[36:39], a[180:183], v[120:123]
  v_exp_f32 v76, v76
  v_mfma_f32_16x16x32_bf16 v[120:123], a[40:43], a[184:187], v[120:123]
  ds_read_b128 a[24:27], v4 offset:14336
  v_cvt_pk_bf16_f32 v37, v74, v75
  v_mfma_f32_16x16x32_bf16 v[120:123], a[44:47], a[188:191], v[120:123]
  v_exp_f32 v77, v77
  v_mfma_f32_16x16x32_bf16 v[116:119], a[48:51], a[160:163], v[24:27]
  v_exp_f32 v78, v78
  v_mfma_f32_16x16x32_bf16 v[116:119], a[52:55], a[164:167], v[116:119]
  ds_read_b128 a[28:31], v4 offset:15360
  v_xor_b32 v4, 0x8000, v4
  v_mfma_f32_16x16x32_bf16 v[116:119], a[56:59], a[168:171], v[116:119]
  v_exp_f32 v79, v79
  v_mfma_f32_16x16x32_bf16 v[116:119], a[60:63], a[172:175], v[116:119]
  buffer_load_dwordx4 v2, s[20:23], s28 offen offset:2048 sc1 lds
  v_xor_b32 v3, 0x8000, v3
  v_mfma_f32_16x16x32_bf16 v[124:127], a[48:51], a[176:179], v[28:31]
  v_exp_f32 v80, v80
  v_mfma_f32_16x16x32_bf16 v[124:127], a[52:55], a[180:183], v[124:127]
  ds_read_b128 a[32:35], v3 offset:0
  ds_read_b128 a[36:39], v3 offset:1024
  v_mfma_f32_16x16x32_bf16 v[124:127], a[56:59], a[184:187], v[124:127]
  v_exp_f32 v81, v81
  v_mfma_f32_16x16x32_bf16 v[124:127], a[60:63], a[188:191], v[124:127]
  s_waitcnt lgkmcnt(6)
  ds_read_b128 a[40:43], v3 offset:2048
  v_cvt_pk_bf16_f32 v38, v76, v77
  v_mfma_f32_16x16x32_bf16 v[160:163], a[0:3], v[52:55], v[160:163]
  v_exp_f32 v82, v82
  v_mfma_f32_16x16x32_bf16 v[192:195], a[0:3], v[56:59], v[192:195]
  v_exp_f32 v83, v83
  v_mfma_f32_16x16x32_bf16 v[224:227], a[0:3], v[60:63], v[224:227]
  ds_read_b128 a[44:47], v3 offset:3072
  v_cvt_pk_bf16_f32 v39, v78, v79
  v_mfma_f32_16x16x32_bf16 a[196:199], a[208:211], v[52:55], a[196:199]
  v_exp_f32 v84, v84
  v_mfma_f32_16x16x32_bf16 v[164:167], a[4:7], v[52:55], v[164:167]
  ds_read_b128 a[48:51], v3 offset:4096
  v_cvt_pk_bf16_f32 v40, v80, v81
  v_mfma_f32_16x16x32_bf16 v[196:199], a[4:7], v[56:59], v[196:199]
  v_exp_f32 v85, v85
  v_mfma_f32_16x16x32_bf16 v[228:231], a[4:7], v[60:63], v[228:231]
  v_cvt_pk_bf16_f32 v41, v82, v83
  v_cvt_pk_bf16_f32 v42, v84, v85
  v_mfma_f32_16x16x32_bf16 a[200:203], a[208:211], v[56:59], a[200:203]
  v_exp_f32 v86, v86
  v_mfma_f32_16x16x32_bf16 v[168:171], a[8:11], v[52:55], v[168:171]
  v_exp_f32 v87, v87
  v_mfma_f32_16x16x32_bf16 v[200:203], a[8:11], v[56:59], v[200:203]
  buffer_load_dwordx4 v2, s[20:23], s28 offen offset:3072 sc1 lds
  ds_read_b128 a[52:55], v3 offset:5120
  v_mfma_f32_16x16x32_bf16 v[232:235], a[8:11], v[60:63], v[232:235]
  s_xor_b32 s26, s26, 0x4000
  v_exp_f32 v88, v88
  v_mfma_f32_16x16x32_bf16 a[204:207], a[208:211], v[60:63], a[204:207]
  s_add_u32 s28, s28, 0x8000
  v_cvt_pk_bf16_f32 v43, v86, v87
  v_mfma_f32_16x16x32_bf16 v[172:175], a[12:15], v[52:55], v[172:175]
  v_exp_f32 v89, v89
  v_mfma_f32_16x16x32_bf16 v[204:207], a[12:15], v[56:59], v[204:207]
  ds_read_b128 a[56:59], v3 offset:6144
  v_cvt_pk_bf16_f32 v44, v88, v89
  v_mfma_f32_16x16x32_bf16 v[236:239], a[12:15], v[60:63], v[236:239]
  s_waitcnt lgkmcnt(7)
  v_exp_f32 v90, v90
  v_mfma_f32_16x16x32_bf16 v[176:179], a[16:19], v[52:55], v[176:179]
  ds_read_b128 a[60:63], v3 offset:7168
  v_mfma_f32_16x16x32_bf16 v[208:211], a[16:19], v[56:59], v[208:211]
  v_exp_f32 v91, v91
  v_mfma_f32_16x16x32_bf16 v[240:243], a[16:19], v[60:63], v[240:243]
  v_exp_f32 v92, v92
  v_mfma_f32_16x16x32_bf16 v[180:183], a[20:23], v[52:55], v[180:183]
  ds_read_b128 a[0:3], v3 offset:8192
  v_cvt_pk_bf16_f32 v45, v90, v91
  v_mfma_f32_16x16x32_bf16 v[212:215], a[20:23], v[56:59], v[212:215]
  v_exp_f32 v93, v93
  v_mfma_f32_16x16x32_bf16 v[244:247], a[20:23], v[60:63], v[244:247]
  v_cvt_pk_bf16_f32 v46, v92, v93
  v_mfma_f32_16x16x32_bf16 v[184:187], a[24:27], v[52:55], v[184:187]
  v_exp_f32 v94, v94
  v_mfma_f32_16x16x32_bf16 v[216:219], a[24:27], v[56:59], v[216:219]
  ds_read_b128 a[4:7], v3 offset:9216
  v_mfma_f32_16x16x32_bf16 v[248:251], a[24:27], v[60:63], v[248:251]
  v_exp_f32 v95, v95
  v_mfma_f32_16x16x32_bf16 v[188:191], a[28:31], v[52:55], v[188:191]
  ds_read_b128 a[8:11], v3 offset:10240
  v_cvt_pk_bf16_f32 v47, v94, v95
  v_mfma_f32_16x16x32_bf16 v[220:223], a[28:31], v[56:59], v[220:223]
  s_waitcnt vmcnt(8)
  s_barrier
  v_mfma_f32_16x16x32_bf16 v[252:255], a[28:31], v[60:63], v[252:255]
  s_lshl_b32 s4, s25, 20
  s_lshl_b32 s5, s24, 15
  s_add_u32 s4, s4, s5
  s_lshl_b32 s5, s3, 11
  s_add_u32 s4, s4, s5
  v_accvgpr_read_b32 v6, a192
  v_accvgpr_read_b32 v8, a196
  s_mov_b32 s5, 0x5f800000
  v_cmp_ngt_f32 vcc, s5, v6
  v_rcp_f32 v6, v6
  s_or_b32 s89, s89, vcc_lo
  s_or_b32 s89, s89, vcc_hi
  v_mov_b32 v7, v6
  v_cmp_ngt_f32 vcc, s5, v8
  v_rcp_f32 v8, v8
  s_or_b32 s89, s89, vcc_lo
  s_or_b32 s89, s89, vcc_hi
  v_mov_b32 v9, v8
  v_pk_mul_f32 v[128:129], v[128:129], v[6:7]
  v_pk_mul_f32 v[130:131], v[130:131], v[6:7]
  v_pk_mul_f32 v[132:133], v[132:133], v[6:7]
  v_pk_mul_f32 v[134:135], v[134:135], v[6:7]
  v_cvt_pk_bf16_f32 v128, v128, v129
  v_cvt_pk_bf16_f32 v129, v130, v131
  v_cvt_pk_bf16_f32 v130, v132, v133
  v_cvt_pk_bf16_f32 v131, v134, v135
  buffer_store_dwordx4 v[128:131], v2, s[16:19], s4 offen offset:0 sc1
  v_pk_mul_f32 v[160:161], v[160:161], v[8:9]
  v_pk_mul_f32 v[162:163], v[162:163], v[8:9]
  v_pk_mul_f32 v[164:165], v[164:165], v[8:9]
  v_pk_mul_f32 v[166:167], v[166:167], v[8:9]
  v_cvt_pk_bf16_f32 v160, v160, v161
  v_cvt_pk_bf16_f32 v161, v162, v163
  v_cvt_pk_bf16_f32 v162, v164, v165
  v_cvt_pk_bf16_f32 v163, v166, v167
  buffer_store_dwordx4 v[160:163], v2, s[16:19], s4 offen offset:1024 sc1
  s_add_u32 s4, s4, 8192
  v_pk_mul_f32 v[136:137], v[136:137], v[6:7]
  v_pk_mul_f32 v[138:139], v[138:139], v[6:7]
  v_pk_mul_f32 v[140:141], v[140:141], v[6:7]
  v_pk_mul_f32 v[142:143], v[142:143], v[6:7]
  v_cvt_pk_bf16_f32 v136, v136, v137
  v_cvt_pk_bf16_f32 v137, v138, v139
  v_cvt_pk_bf16_f32 v138, v140, v141
  v_cvt_pk_bf16_f32 v139, v142, v143
  buffer_store_dwordx4 v[136:139], v2, s[16:19], s4 offen offset:0 sc1
  v_pk_mul_f32 v[168:169], v[168:169], v[8:9]
  v_pk_mul_f32 v[170:171], v[170:171], v[8:9]
  v_pk_mul_f32 v[172:173], v[172:173], v[8:9]
  v_pk_mul_f32 v[174:175], v[174:175], v[8:9]
  v_cvt_pk_bf16_f32 v168, v168, v169
  v_cvt_pk_bf16_f32 v169, v170, v171
  v_cvt_pk_bf16_f32 v170, v172, v173
  v_cvt_pk_bf16_f32 v171, v174, v175
  buffer_store_dwordx4 v[168:171], v2, s[16:19], s4 offen offset:1024 sc1
  s_add_u32 s4, s4, 8192
  v_pk_mul_f32 v[144:145], v[144:145], v[6:7]
  v_pk_mul_f32 v[146:147], v[146:147], v[6:7]
  v_pk_mul_f32 v[148:149], v[148:149], v[6:7]
  v_pk_mul_f32 v[150:151], v[150:151], v[6:7]
  v_cvt_pk_bf16_f32 v144, v144, v145
  v_cvt_pk_bf16_f32 v145, v146, v147
  v_cvt_pk_bf16_f32 v146, v148, v149
  v_cvt_pk_bf16_f32 v147, v150, v151
  buffer_store_dwordx4 v[144:147], v2, s[16:19], s4 offen offset:0 sc1
  v_pk_mul_f32 v[176:177], v[176:177], v[8:9]
  v_pk_mul_f32 v[178:179], v[178:179], v[8:9]
  v_pk_mul_f32 v[180:181], v[180:181], v[8:9]
  v_pk_mul_f32 v[182:183], v[182:183], v[8:9]
  v_cvt_pk_bf16_f32 v176, v176, v177
  v_cvt_pk_bf16_f32 v177, v178, v179
  v_cvt_pk_bf16_f32 v178, v180, v181
  v_cvt_pk_bf16_f32 v179, v182, v183
  buffer_store_dwordx4 v[176:179], v2, s[16:19], s4 offen offset:1024 sc1
  s_add_u32 s4, s4, 8192
  v_pk_mul_f32 v[152:153], v[152:153], v[6:7]
  v_pk_mul_f32 v[154:155], v[154:155], v[6:7]
  v_pk_mul_f32 v[156:157], v[156:157], v[6:7]
  v_pk_mul_f32 v[158:159], v[158:159], v[6:7]
  v_cvt_pk_bf16_f32 v152, v152, v153
  v_cvt_pk_bf16_f32 v153, v154, v155
  v_cvt_pk_bf16_f32 v154, v156, v157
  v_cvt_pk_bf16_f32 v155, v158, v159
  buffer_store_dwordx4 v[152:155], v2, s[16:19], s4 offen offset:0 sc1
  v_pk_mul_f32 v[184:185], v[184:185], v[8:9]
  v_pk_mul_f32 v[186:187], v[186:187], v[8:9]
  v_pk_mul_f32 v[188:189], v[188:189], v[8:9]
  v_pk_mul_f32 v[190:191], v[190:191], v[8:9]
  v_cvt_pk_bf16_f32 v184, v184, v185
  v_cvt_pk_bf16_f32 v185, v186, v187
  v_cvt_pk_bf16_f32 v186, v188, v189
  v_cvt_pk_bf16_f32 v187, v190, v191
  buffer_store_dwordx4 v[184:187], v2, s[16:19], s4 offen offset:1024 sc1
  s_lshl_b32 s88, s25, 1
  s_sub_u32 s88, 14, s88
  .p2align 6
La_so:
  s_waitcnt lgkmcnt(3)
  v_mfma_f32_16x16x32_bf16 v[64:67], a[32:35], a[160:163], v[24:27]
  s_mov_b32 m0, s26
  v_exp_f32 v96, v96
  v_mfma_f32_16x16x32_bf16 v[64:67], a[36:39], a[164:167], v[64:67]
  buffer_load_dwordx4 v2, s[20:23], s28 offen offset:0 sc1 lds
  ds_read_b128 a[12:15], v3 offset:11264
  v_mfma_f32_16x16x32_bf16 v[64:67], a[40:43], a[168:171], v[64:67]
  v_exp_f32 v97, v97
  v_mfma_f32_16x16x32_bf16 v[64:67], a[44:47], a[172:175], v[64:67]
  ds_read_b128 a[16:19], v3 offset:12288
  v_cvt_pk_bf16_f32 v48, v96, v97
  v_mfma_f32_16x16x32_bf16 v[72:75], a[32:35], a[176:179], v[28:31]
  v_exp_f32 v98, v98
  v_mfma_f32_16x16x32_bf16 v[72:75], a[36:39], a[180:183], v[72:75]
  ds_read_b128 a[20:23], v3 offset:13312
  v_mfma_f32_16x16x32_bf16 v[72:75], a[40:43], a[184:187], v[72:75]
  v_exp_f32 v99, v99
  v_mfma_f32_16x16x32_bf16 v[72:75], a[44:47], a[188:191], v[72:75]
  ds_read_b128 a[24:27], v3 offset:14336
  v_cvt_pk_bf16_f32 v49, v98, v99
  v_mfma_f32_16x16x32_bf16 v[68:71], a[48:51], a[160:163], v[24:27]
  v_exp_f32 v100, v100
  v_mfma_f32_16x16x32_bf16 v[68:71], a[52:55], a[164:167], v[68:71]
  buffer_load_dwordx4 v2, s[20:23], s28 offen offset:1024 sc1 lds
  ds_read_b128 a[28:31], v3 offset:15360
  v_mfma_f32_16x16x32_bf16 v[68:71], a[56:59], a[168:171], v[68:71]
  v_exp_f32 v101, v101
  v_mfma_f32_16x16x32_bf16 v[68:71], a[60:63], a[172:175], v[68:71]
  ds_read_b128 a[32:35], v4 offset:0
  v_cvt_pk_bf16_f32 v50, v100, v101
  v_mfma_f32_16x16x32_bf16 v[76:79], a[48:51], a[176:179], v[28:31]
  v_exp_f32 v102, v102
  v_mfma_f32_16x16x32_bf16 v[76:79], a[52:55], a[180:183], v[76:79]
  ds_read_b128 a[36:39], v4 offset:1024
  v_mfma_f32_16x16x32_bf16 v[76:79], a[56:59], a[184:187], v[76:79]
  v_exp_f32 v103, v103
  v_mfma_f32_16x16x32_bf16 v[76:79], a[60:63], a[188:191], v[76:79]
  s_waitcnt lgkmcnt(2)
  ds_read_b128 a[40:43], v4 offset:2048
  v_cvt_pk_bf16_f32 v51, v102, v103
  v_mfma_f32_16x16x32_bf16 v[80:83], a[0:3], a[160:163], v[24:27]
  v_exp_f32 v104, v104
  v_mfma_f32_16x16x32_bf16 v[80:83], a[4:7], a[164:167], v[80:83]
  buffer_load_dwordx4 v2, s[20:23], s28 offen offset:2048 sc1 lds
  ds_read_b128 a[44:47], v4 offset:3072
  v_mfma_f32_16x16x32_bf16 v[80:83], a[8:11], a[168:171], v[80:83]
  v_exp_f32 v105, v105
  v_mfma_f32_16x16x32_bf16 v[80:83], a[12:15], a[172:175], v[80:83]
  ds_read_b128 a[48:51], v4 offset:4096
  v_cvt_pk_bf16_f32 v52, v104, v105
  v_mfma_f32_16x16x32_bf16 v[88:91], a[0:3], a[176:179], v[28:31]
  v_exp_f32 v106, v106
  v_mfma_f32_16x16x32_bf16 v[88:91], a[4:7], a[180:183], v[88:91]
  ds_read_b128 a[52:55], v4 offset:5120
  v_mfma_f32_16x16x32_bf16 v[88:91], a[8:11], a[184:187], v[88:91]
  v_exp_f32 v107, v107
  v_mfma_f32_16x16x32_bf16 v[88:91], a[12:15], a[188:191], v[88:91]
  ds_read_b128 a[56:59], v4 offset:6144
  v_cvt_pk_bf16_f32 v53, v106, v107
  v_mfma_f32_16x16x32_bf16 v[84:87], a[16:19], a[160:163], v[24:27]
  v_exp_f32 v108, v108
  v_mfma_f32_16x16x32_bf16 v[84:87], a[20:23], a[164:167], v[84:87]
  buffer_load_dwordx4 v2, s[20:23], s28 offen offset:3072 sc1 lds
  ds_read_b128 a[60:63], v4 offset:7168
  v_mfma_f32_16x16x32_bf16 v[84:87], a[24:27], a[168:171], v[84:87]
  s_xor_b32 s26, s26, 0x8000
  v_exp_f32 v109, v109
  v_mfma_f32_16x16x32_bf16 v[84:87], a[28:31], a[172:175], v[84:87]
  s_add_u32 s28, s28, 0x8000
  s_mov_b32 m0, s27
  ds_read_b128 a[0:3], v4 offset:8192
  v_mfma_f32_16x16x32_bf16 v[92:95], a[16:19], a[176:179], v[28:31]
  v_exp_f32 v110, v110
  v_mfma_f32_16x16x32_bf16 v[92:95], a[20:23], a[180:183], v[92:95]
  ds_read_b128 a[4:7], v4 offset:9216
  v_cvt_pk_bf16_f32 v54, v108, v109
  v_mfma_f32_16x16x32_bf16 v[92:95], a[24:27], a[184:187], v[92:95]
  v_exp_f32 v111, v111
  v_mfma_f32_16x16x32_bf16 v[92:95], a[28:31], a[188:191], v[92:95]
  s_waitcnt lgkmcnt(2)
  ds_read_b128 a[8:11], v4 offset:10240
  v_cvt_pk_bf16_f32 v55, v110, v111
  v_mfma_f32_16x16x32_bf16 v[192:195], a[32:35], v[32:35], v[192:195]
  buffer_load_dwordx4 v2, s[20:23], s29 offen offset:0 sc1 lds
  ds_read_b128 a[12:15], v4 offset:11264
  v_mfma_f32_16x16x32_bf16 v[224:227], a[32:35], v[36:39], v[224:227]
  v_exp_f32 v112, v112
  v_mfma_f32_16x16x32_bf16 a[200:203], a[208:211], v[32:35], a[200:203]
  s_sub_u32 s88, s88, 1
  v_mfma_f32_16x16x32_bf16 v[196:199], a[36:39], v[32:35], v[196:199]
  v_exp_f32 v113, v113
  v_mfma_f32_16x16x32_bf16 v[228:231], a[36:39], v[36:39], v[228:231]
  ds_read_b128 a[16:19], v4 offset:12288
  v_cvt_pk_bf16_f32 v56, v112, v113
  v_mfma_f32_16x16x32_bf16 a[204:207], a[208:211], v[36:39], a[204:207]
  v_exp_f32 v114, v114
  v_mfma_f32_16x16x32_bf16 v[200:203], a[40:43], v[32:35], v[200:203]
  ds_read_b128 a[20:23], v4 offset:13312
  v_mfma_f32_16x16x32_bf16 v[232:235], a[40:43], v[36:39], v[232:235]
  v_exp_f32 v115, v115
  v_mfma_f32_16x16x32_bf16 v[204:207], a[44:47], v[32:35], v[204:207]
  buffer_load_dwordx4 v2, s[20:23], s29 offen offset:1024 sc1 lds
  ds_read_b128 a[24:27], v4 offset:14336
  v_mfma_f32_16x16x32_bf16 v[236:239], a[44:47], v[36:39], v[236:239]
  v_exp_f32 v116, v116
  v_mfma_f32_16x16x32_bf16 v[208:211], a[48:51], v[32:35], v[208:211]
  ds_read_b128 a[28:31], v4 offset:15360
  v_xor_b32 v4, 0x4000, v4
  v_mfma_f32_16x16x32_bf16 v[240:243], a[48:51], v[36:39], v[240:243]
  v_exp_f32 v117, v117
  v_mfma_f32_16x16x32_bf16 v[212:215], a[52:55], v[32:35], v[212:215]
  v_xor_b32 v3, 0x4000, v3
  v_cvt_pk_bf16_f32 v57, v114, v115
  v_mfma_f32_16x16x32_bf16 v[244:247], a[52:55], v[36:39], v[244:247]
  v_exp_f32 v118, v118
  v_mfma_f32_16x16x32_bf16 v[216:219], a[56:59], v[32:35], v[216:219]
  ds_read_b128 a[32:35], v3 offset:0
  ds_read_b128 a[36:39], v3 offset:1024
  v_mfma_f32_16x16x32_bf16 v[248:251], a[56:59], v[36:39], v[248:251]
  v_exp_f32 v119, v119
  v_mfma_f32_16x16x32_bf16 v[220:223], a[60:63], v[32:35], v[220:223]
  buffer_load_dwordx4 v2, s[20:23], s29 offen offset:2048 sc1 lds
  ds_read_b128 a[40:43], v3 offset:2048
  v_mfma_f32_16x16x32_bf16 v[252:255], a[60:63], v[36:39], v[252:255]
  s_waitcnt lgkmcnt(3)
  v_exp_f32 v120, v120
  v_mfma_f32_16x16x32_bf16 v[192:195], a[0:3], v[40:43], v[192:195]
  ds_read_b128 a[44:47], v3 offset:3072
  v_cvt_pk_bf16_f32 v58, v116, v117
  v_mfma_f32_16x16x32_bf16 v[224:227], a[0:3], v[44:47], v[224:227]
  v_exp_f32 v121, v121
  v_mfma_f32_16x16x32_bf16 a[200:203], a[208:211], v[40:43], a[200:203]
  v_cvt_pk_bf16_f32 v59, v118, v119
  v_cvt_pk_bf16_f32 v60, v120, v121
  v_mfma_f32_16x16x32_bf16 v[196:199], a[4:7], v[40:43], v[196:199]
  v_exp_f32 v122, v122
  v_mfma_f32_16x16x32_bf16 v[228:231], a[4:7], v[44:47], v[228:231]
  ds_read_b128 a[48:51], v3 offset:4096
  v_mfma_f32_16x16x32_bf16 a[204:207], a[208:211], v[44:47], a[204:207]
  v_exp_f32 v123, v123
  v_mfma_f32_16x16x32_bf16 v[200:203], a[8:11], v[40:43], v[200:203]
  buffer_load_dwordx4 v2, s[20:23], s29 offen offset:3072 sc1 lds
  ds_read_b128 a[52:55], v3 offset:5120
  v_mfma_f32_16x16x32_bf16 v[232:235], a[8:11], v[44:47], v[232:235]
  s_xor_b32 s27, s27, 0x8000
  v_exp_f32 v124, v124
  v_mfma_f32_16x16x32_bf16 v[204:207], a[12:15], v[40:43], v[204:207]
  s_add_u32 s29, s29, 0x8000
  ds_read_b128 a[56:59], v3 offset:6144
  v_cvt_pk_bf16_f32 v61, v122, v123
  v_mfma_f32_16x16x32_bf16 v[236:239], a[12:15], v[44:47], v[236:239]
  v_exp_f32 v125, v125
  v_mfma_f32_16x16x32_bf16 v[208:211], a[16:19], v[40:43], v[208:211]
  ds_read_b128 a[60:63], v3 offset:7168
  v_cvt_pk_bf16_f32 v62, v124, v125
  v_mfma_f32_16x16x32_bf16 v[240:243], a[16:19], v[44:47], v[240:243]
  v_exp_f32 v126, v126
  v_mfma_f32_16x16x32_bf16 v[212:215], a[20:23], v[40:43], v[212:215]
  ds_read_b128 a[0:3], v3 offset:8192
  v_mfma_f32_16x16x32_bf16 v[244:247], a[20:23], v[44:47], v[244:247]
  v_exp_f32 v127, v127
  v_mfma_f32_16x16x32_bf16 v[216:219], a[24:27], v[40:43], v[216:219]
  ds_read_b128 a[4:7], v3 offset:9216
  v_cvt_pk_bf16_f32 v63, v126, v127
  v_mfma_f32_16x16x32_bf16 v[248:251], a[24:27], v[44:47], v[248:251]
  v_mfma_f32_16x16x32_bf16 v[220:223], a[28:31], v[40:43], v[220:223]
  s_waitcnt vmcnt(8)
  s_barrier
  v_mfma_f32_16x16x32_bf16 v[252:255], a[28:31], v[44:47], v[252:255]
  ds_read_b128 a[8:11], v3 offset:10240
  s_cmp_eq_u32 s88, 0
  s_cbranch_scc1 La_e0
  s_waitcnt lgkmcnt(3)
  v_mfma_f32_16x16x32_bf16 v[96:99], a[32:35], a[160:163], v[24:27]
  s_mov_b32 m0, s26
  v_exp_f32 v64, v64
  v_mfma_f32_16x16x32_bf16 v[96:99], a[36:39], a[164:167], v[96:99]
  buffer_load_dwordx4 v2, s[20:23], s28 offen offset:0 sc1 lds
  ds_read_b128 a[12:15], v3 offset:11264
  v_mfma_f32_16x16x32_bf16 v[96:99], a[40:43], a[168:171], v[96:99]
  v_exp_f32 v65, v65
  v_mfma_f32_16x16x32_bf16 v[96:99], a[44:47], a[172:175], v[96:99]
  ds_read_b128 a[16:19], v3 offset:12288
  v_cvt_pk_bf16_f32 v32, v64, v65
  v_mfma_f32_16x16x32_bf16 v[104:107], a[32:35], a[176:179], v[28:31]
  v_exp_f32 v66, v66
  v_mfma_f32_16x16x32_bf16 v[104:107], a[36:39], a[180:183], v[104:107]
  ds_read_b128 a[20:23], v3 offset:13312
  v_mfma_f32_16x16x32_bf16 v[104:107], a[40:43], a[184:187], v[104:107]
  v_exp_f32 v67, v67
  v_mfma_f32_16x16x32_bf16 v[104:107], a[44:47], a[188:191], v[104:107]
  ds_read_b128 a[24:27], v3 offset:14336
  v_cvt_pk_bf16_f32 v33, v66, v67
  v_mfma_f32_16x16x32_bf16 v[100:103], a[48:51], a[160:163], v[24:27]
  v_exp_f32 v68, v68
  v_mfma_f32_16x16x32_bf16 v[100:103], a[52:55], a[164:167], v[100:103]
  buffer_load_dwordx4 v2, s[20:23], s28 offen offset:1024 sc1 lds
  ds_read_b128 a[28:31], v3 offset:15360
  v_mfma_f32_16x16x32_bf16 v[100:103], a[56:59], a[168:171], v[100:103]
  v_exp_f32 v69, v69
  v_mfma_f32_16x16x32_bf16 v[100:103], a[60:63], a[172:175], v[100:103]
  ds_read_b128 a[32:35], v4 offset:0
  v_cvt_pk_bf16_f32 v34, v68, v69
  v_mfma_f32_16x16x32_bf16 v[108:111], a[48:51], a[176:179], v[28:31]
  v_exp_f32 v70, v70
  v_mfma_f32_16x16x32_bf16 v[108:111], a[52:55], a[180:183], v[108:111]
  ds_read_b128 a[36:39], v4 offset:1024
  v_mfma_f32_16x16x32_bf16 v[108:111], a[56:59], a[184:187], v[108:111]
  v_exp_f32 v71, v71
  v_mfma_f32_16x16x32_bf16 v[108:111], a[60:63], a[188:191], v[108:111]
  s_waitcnt lgkmcnt(2)
  ds_read_b128 a[40:43], v4 offset:2048
  v_cvt_pk_bf16_f32 v35, v70, v71
  v_mfma_f32_16x16x32_bf16 v[112:115], a[0:3], a[160:163], v[24:27]
  v_exp_f32 v72, v72
  v_mfma_f32_16x16x32_bf16 v[112:115], a[4:7], a[164:167], v[112:115]
  buffer_load_dwordx4 v2, s[20:23], s28 offen offset:2048 sc1 lds
  ds_read_b128 a[44:47], v4 offset:3072
  v_mfma_f32_16x16x32_bf16 v[112:115], a[8:11], a[168:171], v[112:115]
  v_exp_f32 v73, v73
  v_mfma_f32_16x16x32_bf16 v[112:115], a[12:15], a[172:175], v[112:115]
  ds_read_b128 a[48:51], v4 offset:4096
  v_cvt_pk_bf16_f32 v36, v72, v73
  v_mfma_f32_16x16x32_bf16 v[120:123], a[0:3], a[176:179], v[28:31]
  v_exp_f32 v74, v74
  v_mfma_f32_16x16x32_bf16 v[120:123], a[4:7], a[180:183], v[120:123]
  ds_read_b128 a[52:55], v4 offset:5120
  v_mfma_f32_16x16x32_bf16 v[120:123], a[8:11], a[184:187], v[120:123]
  v_exp_f32 v75, v75
  v_mfma_f32_16x16x32_bf16 v[120:123], a[12:15], a[188:191], v[120:123]
  ds_read_b128 a[56:59], v4 offset:6144
  v_cvt_pk_bf16_f32 v37, v74, v75
  v_mfma_f32_16x16x32_bf16 v[116:119], a[16:19], a[160:163], v[24:27]
  v_exp_f32 v76, v76
  v_mfma_f32_16x16x32_bf16 v[116:119], a[20:23], a[164:167], v[116:119]
  buffer_load_dwordx4 v2, s[20:23], s28 offen offset:3072 sc1 lds
  ds_read_b128 a[60:63], v4 offset:7168
  v_mfma_f32_16x16x32_bf16 v[116:119], a[24:27], a[168:171], v[116:119]
  s_xor_b32 s26, s26, 0x4000
  v_exp_f32 v77, v77
  v_mfma_f32_16x16x32_bf16 v[116:119], a[28:31], a[172:175], v[116:119]
  s_add_u32 s28, s28, 0x8000
  s_mov_b32 m0, s27
  ds_read_b128 a[0:3], v4 offset:8192
  v_mfma_f32_16x16x32_bf16 v[124:127], a[16:19], a[176:179], v[28:31]
  v_exp_f32 v78, v78
  v_mfma_f32_16x16x32_bf16 v[124:127], a[20:23], a[180:183], v[124:127]
  ds_read_b128 a[4:7], v4 offset:9216
  v_cvt_pk_bf16_f32 v38, v76, v77
  v_mfma_f32_16x16x32_bf16 v[124:127], a[24:27], a[184:187], v[124:127]
  v_exp_f32 v79, v79
  v_mfma_f32_16x16x32_bf16 v[124:127], a[28:31], a[188:191], v[124:127]
  s_waitcnt lgkmcnt(2)
  ds_read_b128 a[8:11], v4 offset:10240
  v_cvt_pk_bf16_f32 v39, v78, v79
  v_mfma_f32_16x16x32_bf16 v[192:195], a[32:35], v[48:51], v[192:195]
  buffer_load_dwordx4 v2, s[20:23], s29 offen offset:0 sc1 lds
  ds_read_b128 a[12:15], v4 offset:11264
  v_mfma_f32_16x16x32_bf16 v[224:227], a[32:35], v[52:55], v[224:227]
  v_exp_f32 v80, v80
  v_mfma_f32_16x16x32_bf16 a[200:203], a[208:211], v[48:51], a[200:203]
  v_mfma_f32_16x16x32_bf16 v[196:199], a[36:39], v[48:51], v[196:199]
  v_exp_f32 v81, v81
  v_mfma_f32_16x16x32_bf16 v[228:231], a[36:39], v[52:55], v[228:231]
  ds_read_b128 a[16:19], v4 offset:12288
  v_cvt_pk_bf16_f32 v40, v80, v81
  v_mfma_f32_16x16x32_bf16 a[204:207], a[208:211], v[52:55], a[204:207]
  v_exp_f32 v82, v82
  v_mfma_f32_16x16x32_bf16 v[200:203], a[40:43], v[48:51], v[200:203]
  ds_read_b128 a[20:23], v4 offset:13312
  v_mfma_f32_16x16x32_bf16 v[232:235], a[40:43], v[52:55], v[232:235]
  v_exp_f32 v83, v83
  v_mfma_f32_16x16x32_bf16 v[204:207], a[44:47], v[48:51], v[204:207]
  buffer_load_dwordx4 v2, s[20:23], s29 offen offset:1024 sc1 lds
  ds_read_b128 a[24:27], v4 offset:14336
  v_mfma_f32_16x16x32_bf16 v[236:239], a[44:47], v[52:55], v[236:239]
  v_exp_f32 v84, v84
  v_mfma_f32_16x16x32_bf16 v[208:211], a[48:51], v[48:51], v[208:211]
  ds_read_b128 a[28:31], v4 offset:15360
  v_xor_b32 v4, 0x8000, v4
  v_mfma_f32_16x16x32_bf16 v[240:243], a[48:51], v[52:55], v[240:243]
  v_exp_f32 v85, v85
  v_mfma_f32_16x16x32_bf16 v[212:215], a[52:55], v[48:51], v[212:215]
  v_xor_b32 v3, 0x8000, v3
  v_cvt_pk_bf16_f32 v41, v82, v83
  v_mfma_f32_16x16x32_bf16 v[244:247], a[52:55], v[52:55], v[244:247]
  v_exp_f32 v86, v86
  v_mfma_f32_16x16x32_bf16 v[216:219], a[56:59], v[48:51], v[216:219]
  ds_read_b128 a[32:35], v3 offset:0
  ds_read_b128 a[36:39], v3 offset:1024
  v_mfma_f32_16x16x32_bf16 v[248:251], a[56:59], v[52:55], v[248:251]
  v_exp_f32 v87, v87
  v_mfma_f32_16x16x32_bf16 v[220:223], a[60:63], v[48:51], v[220:223]
  buffer_load_dwordx4 v2, s[20:23], s29 offen offset:2048 sc1 lds
  ds_read_b128 a[40:43], v3 offset:2048
  v_mfma_f32_16x16x32_bf16 v[252:255], a[60:63], v[52:55], v[252:255]
  s_waitcnt lgkmcnt(3)
  v_exp_f32 v88, v88
  v_mfma_f32_16x16x32_bf16 v[192:195], a[0:3], v[56:59], v[192:195]
  ds_read_b128 a[44:47], v3 offset:3072
  v_cvt_pk_bf16_f32 v42, v84, v85
  v_mfma_f32_16x16x32_bf16 v[224:227], a[0:3], v[60:63], v[224:227]
  v_exp_f32 v89, v89
  v_mfma_f32_16x16x32_bf16 a[200:203], a[208:211], v[56:59], a[200:203]
  v_cvt_pk_bf16_f32 v43, v86, v87
  v_cvt_pk_bf16_f32 v44, v88, v89
  v_mfma_f32_16x16x32_bf16 v[196:199], a[4:7], v[56:59], v[196:199]
  v_exp_f32 v90, v90
  v_mfma_f32_16x16x32_bf16 v[228:231], a[4:7], v[60:63], v[228:231]
  ds_read_b128 a[48:51], v3 offset:4096
  v_mfma_f32_16x16x32_bf16 a[204:207], a[208:211], v[60:63], a[204:207]
  v_exp_f32 v91, v91
  v_mfma_f32_16x16x32_bf16 v[200:203], a[8:11], v[56:59], v[200:203]
  buffer_load_dwordx4 v2, s[20:23], s29 offen offset:3072 sc1 lds
  ds_read_b128 a[52:55], v3 offset:5120
  v_mfma_f32_16x16x32_bf16 v[232:235], a[8:11], v[60:63], v[232:235]
  s_xor_b32 s27, s27, 0x4000
  v_exp_f32 v92, v92
  v_mfma_f32_16x16x32_bf16 v[204:207], a[12:15], v[56:59], v[204:207]
  s_add_u32 s29, s29, 0x8000
  ds_read_b128 a[56:59], v3 offset:6144
  v_cvt_pk_bf16_f32 v45, v90, v91
  v_mfma_f32_16x16x32_bf16 v[236:239], a[12:15], v[60:63], v[236:239]
  v_exp_f32 v93, v93
  v_mfma_f32_16x16x32_bf16 v[208:211], a[16:19], v[56:59], v[208:211]
  ds_read_b128 a[60:63], v3 offset:7168
  v_cvt_pk_bf16_f32 v46, v92, v93
  v_mfma_f32_16x16x32_bf16 v[240:243], a[16:19], v[60:63], v[240:243]
  v_exp_f32 v94, v94
  v_mfma_f32_16x16x32_bf16 v[212:215], a[20:23], v[56:59], v[212:215]
  ds_read_b128 a[0:3], v3 offset:8192
  v_mfma_f32_16x16x32_bf16 v[244:247], a[20:23], v[60:63], v[244:247]
  v_exp_f32 v95, v95
  v_mfma_f32_16x16x32_bf16 v[216:219], a[24:27], v[56:59], v[216:219]
  ds_read_b128 a[4:7], v3 offset:9216
  v_cvt_pk_bf16_f32 v47, v94, v95
  v_mfma_f32_16x16x32_bf16 v[248:251], a[24:27], v[60:63], v[248:251]
  v_mfma_f32_16x16x32_bf16 v[220:223], a[28:31], v[56:59], v[220:223]
  s_waitcnt vmcnt(12)
  s_barrier
  v_mfma_f32_16x16x32_bf16 v[252:255], a[28:31], v[60:63], v[252:255]
  ds_read_b128 a[8:11], v3 offset:10240
  s_branch La_so
La_t7:
  s_waitcnt lgkmcnt(7)
  v_mfma_f32_16x16x32_bf16 v[104:107], a[0:3], a[176:179], v[28:31]
  buffer_load_dwordx2 v[12:13], v14, s[96:99], s91 offen sc1
  ds_read_b128 a[44:47], v3 offset:11264
  v_mfma_f32_16x16x32_bf16 v[104:107], a[4:7], a[180:183], v[104:107]
  v_cndmask_b32 v64, v64, v5, s[32:33]
  v_exp_f32 v64, v64
  v_mfma_f32_16x16x32_bf16 v[104:107], a[8:11], a[184:187], v[104:107]
  v_cndmask_b32 v65, v65, v5, s[34:35]
  v_exp_f32 v65, v65
  v_mfma_f32_16x16x32_bf16 v[104:107], a[12:15], a[188:191], v[104:107]
  s_waitcnt lgkmcnt(4)
  v_cndmask_b32 v66, v66, v5, s[36:37]
  v_exp_f32 v66, v66
  v_mfma_f32_16x16x32_bf16 v[108:111], a[16:19], a[176:179], v[28:31]
  v_cndmask_b32 v67, v67, v5, s[38:39]
  v_exp_f32 v67, v67
  v_mfma_f32_16x16x32_bf16 v[108:111], a[20:23], a[180:183], v[108:111]
  v_cndmask_b32 v68, v68, v5, s[40:41]
  v_exp_f32 v68, v68
  v_mfma_f32_16x16x32_bf16 v[108:111], a[24:27], a[184:187], v[108:111]
  v_cndmask_b32 v69, v69, v5, s[42:43]
  v_exp_f32 v69, v69
  v_mfma_f32_16x16x32_bf16 v[108:111], a[28:31], a[188:191], v[108:111]
  s_waitcnt lgkmcnt(0)
  v_cndmask_b32 v70, v70, v5, s[44:45]
  v_exp_f32 v70, v70
  v_mfma_f32_16x16x32_bf16 v[120:123], a[32:35], a[176:179], v[28:31]
  v_cndmask_b32 v71, v71, v5, s[46:47]
  v_exp_f32 v71, v71
  v_mfma_f32_16x16x32_bf16 v[120:123], a[36:39], a[180:183], v[120:123]
  ds_read_b128 a[48:51], v3 offset:12288
  ds_read_b128 a[52:55], v3 offset:13312
  ds_read_b128 a[56:59], v3 offset:14336
  v_mfma_f32_16x16x32_bf16 v[120:123], a[40:43], a[184:187], v[120:123]
  ds_read_b128 a[60:63], v3 offset:15360
  v_exp_f32 v72, v72
  v_mfma_f32_16x16x32_bf16 v[120:123], a[44:47], a[188:191], v[120:123]
  s_waitcnt lgkmcnt(0)
  v_exp_f32 v73, v73
  v_cvt_pk_bf16_f32 v33, v66, v67
  v_mfma_f32_16x16x32_bf16 v[124:127], a[48:51], a[176:179], v[28:31]
  v_exp_f32 v74, v74
  v_cvt_pk_bf16_f32 v34, v68, v69
  v_mfma_f32_16x16x32_bf16 v[124:127], a[52:55], a[180:183], v[124:127]
  ds_read_b128 a[0:3], v4 offset:8192
  ds_read_b128 a[4:7], v4 offset:9216
  ds_read_b128 a[8:11], v4 offset:10240
  v_mfma_f32_16x16x32_bf16 v[124:127], a[56:59], a[184:187], v[124:127]
  ds_read_b128 a[12:15], v4 offset:11264
  v_exp_f32 v75, v75
  v_mfma_f32_16x16x32_bf16 v[124:127], a[60:63], a[188:191], v[124:127]
  s_waitcnt lgkmcnt(0)
  v_exp_f32 v76, v76
  v_cvt_pk_bf16_f32 v35, v70, v71
  v_mfma_f32_16x16x32_bf16 v[160:163], a[0:3], v[52:55], v[160:163]
  v_exp_f32 v77, v77
  v_cvt_pk_bf16_f32 v36, v72, v73
  v_mfma_f32_16x16x32_bf16 v[192:195], a[0:3], v[56:59], v[192:195]
  v_exp_f32 v78, v78
  v_cvt_pk_bf16_f32 v37, v74, v75
  v_mfma_f32_16x16x32_bf16 v[224:227], a[0:3], v[60:63], v[224:227]
  ds_read_b128 a[16:19], v4 offset:12288
  ds_read_b128 a[20:23], v4 offset:13312
  v_cvt_pk_bf16_f32 v38, v76, v77
  v_mfma_f32_16x16x32_bf16 a[196:199], a[208:211], v[52:55], a[196:199]
  v_exp_f32 v79, v79
  v_mfma_f32_16x16x32_bf16 v[164:167], a[4:7], v[52:55], v[164:167]
  v_cndmask_b32 v80, v80, v5, s[48:49]
  v_exp_f32 v80, v80
  v_cvt_pk_bf16_f32 v39, v78, v79
  v_mfma_f32_16x16x32_bf16 v[196:199], a[4:7], v[56:59], v[196:199]
  v_cndmask_b32 v81, v81, v5, s[50:51]
  v_exp_f32 v81, v81
  v_mfma_f32_16x16x32_bf16 v[228:231], a[4:7], v[60:63], v[228:231]
  ds_read_b128 a[24:27], v4 offset:14336
  ds_read_b128 a[28:31], v4 offset:15360
  v_cvt_pk_bf16_f32 v40, v80, v81
  v_mfma_f32_16x16x32_bf16 a[200:203], a[208:211], v[56:59], a[200:203]
  v_cndmask_b32 v82, v82, v5, s[52:53]
  v_exp_f32 v82, v82
  v_mfma_f32_16x16x32_bf16 v[168:171], a[8:11], v[52:55], v[168:171]
  v_cndmask_b32 v83, v83, v5, s[54:55]
  v_exp_f32 v83, v83
  v_mfma_f32_16x16x32_bf16 v[200:203], a[8:11], v[56:59], v[200:203]
  v_cndmask_b32 v84, v84, v5, s[56:57]
  v_exp_f32 v84, v84
  v_mfma_f32_16x16x32_bf16 v[232:235], a[8:11], v[60:63], v[232:235]
  v_cndmask_b32 v85, v85, v5, s[58:59]
  v_exp_f32 v85, v85
  v_mfma_f32_16x16x32_bf16 a[204:207], a[208:211], v[60:63], a[204:207]
  v_xor_b32 v4, 0x8000, v4
  v_cvt_pk_bf16_f32 v32, v64, v65
  v_cvt_pk_bf16_f32 v41, v82, v83
  v_mfma_f32_16x16x32_bf16 v[172:175], a[12:15], v[52:55], v[172:175]
  v_cndmask_b32 v86, v86, v5, s[60:61]
  v_exp_f32 v86, v86
  v_mfma_f32_16x16x32_bf16 v[204:207], a[12:15], v[56:59], v[204:207]
  v_cndmask_b32 v87, v87, v5, s[62:63]
  v_exp_f32 v87, v87
  v_mfma_f32_16x16x32_bf16 v[236:239], a[12:15], v[60:63], v[236:239]
  s_waitcnt lgkmcnt(0)
  v_exp_f32 v88, v88
  v_cvt_pk_bf16_f32 v42, v84, v85
  v_mfma_f32_16x16x32_bf16 v[176:179], a[16:19], v[52:55], v[176:179]
  ds_read_b128 a[32:35], v4 offset:0
  ds_read_b128 a[36:39], v4 offset:1024
  v_cvt_pk_bf16_f32 v43, v86, v87
  v_mfma_f32_16x16x32_bf16 v[208:211], a[16:19], v[56:59], v[208:211]
  v_exp_f32 v89, v89
  v_mfma_f32_16x16x32_bf16 v[240:243], a[16:19], v[60:63], v[240:243]
  v_exp_f32 v90, v90
  v_cvt_pk_bf16_f32 v44, v88, v89
  v_mfma_f32_16x16x32_bf16 v[180:183], a[20:23], v[52:55], v[180:183]
  v_exp_f32 v91, v91
  v_mfma_f32_16x16x32_bf16 v[212:215], a[20:23], v[56:59], v[212:215]
  v_exp_f32 v92, v92
  v_cvt_pk_bf16_f32 v45, v90, v91
  v_mfma_f32_16x16x32_bf16 v[244:247], a[20:23], v[60:63], v[244:247]
  ds_read_b128 a[40:43], v4 offset:2048
  ds_read_b128 a[44:47], v4 offset:3072
  v_mfma_f32_16x16x32_bf16 v[184:187], a[24:27], v[52:55], v[184:187]
  v_exp_f32 v93, v93
  v_mfma_f32_16x16x32_bf16 v[216:219], a[24:27], v[56:59], v[216:219]
  v_exp_f32 v94, v94
  v_cvt_pk_bf16_f32 v46, v92, v93
  v_mfma_f32_16x16x32_bf16 v[248:251], a[24:27], v[60:63], v[248:251]
  v_exp_f32 v95, v95
  v_mfma_f32_16x16x32_bf16 v[188:191], a[28:31], v[52:55], v[188:191]
  ds_read_b128 a[48:51], v4 offset:4096
  ds_read_b128 a[52:55], v4 offset:5120
  v_cvt_pk_bf16_f32 v47, v94, v95
  v_mfma_f32_16x16x32_bf16 v[220:223], a[28:31], v[56:59], v[220:223]
  s_waitcnt vmcnt(0)
  s_barrier
  v_mfma_f32_16x16x32_bf16 v[252:255], a[28:31], v[60:63], v[252:255]
  ds_read_b128 a[56:59], v4 offset:6144
  ds_read_b128 a[60:63], v4 offset:7168
  ds_read_b128 a[0:3], v4 offset:8192
  ds_read_b128 a[4:7], v4 offset:9216
  ds_read_b128 a[8:11], v4 offset:10240
  s_lshl_b32 s4, s25, 20
  s_lshl_b32 s5, s24, 15
  s_add_u32 s4, s4, s5
  s_lshl_b32 s5, s3, 11
  s_add_u32 s4, s4, s5
  v_accvgpr_read_b32 v6, a192
  v_accvgpr_read_b32 v8, a196
  s_mov_b32 s5, 0x5f800000
  v_cmp_ngt_f32 vcc, s5, v6
  v_rcp_f32 v6, v6
  s_or_b32 s89, s89, vcc_lo
  s_or_b32 s89, s89, vcc_hi
  v_mov_b32 v7, v6
  v_cmp_ngt_f32 vcc, s5, v8
  v_rcp_f32 v8, v8
  s_or_b32 s89, s89, vcc_lo
  s_or_b32 s89, s89, vcc_hi
  v_mov_b32 v9, v8
  v_pk_mul_f32 v[128:129], v[128:129], v[6:7]
  v_pk_mul_f32 v[130:131], v[130:131], v[6:7]
  v_pk_mul_f32 v[132:133], v[132:133], v[6:7]
  v_pk_mul_f32 v[134:135], v[134:135], v[6:7]
  v_cvt_pk_bf16_f32 v128, v128, v129
  v_cvt_pk_bf16_f32 v129, v130, v131
  v_cvt_pk_bf16_f32 v130, v132, v133
  v_cvt_pk_bf16_f32 v131, v134, v135
  buffer_store_dwordx4 v[128:131], v2, s[16:19], s4 offen offset:0 sc1
  v_pk_mul_f32 v[160:161], v[160:161], v[8:9]
  v_pk_mul_f32 v[162:163], v[162:163], v[8:9]
  v_pk_mul_f32 v[164:165], v[164:165], v[8:9]
  v_pk_mul_f32 v[166:167], v[166:167], v[8:9]
  v_cvt_pk_bf16_f32 v160, v160, v161
  v_cvt_pk_bf16_f32 v161, v162, v163
  v_cvt_pk_bf16_f32 v162, v164, v165
  v_cvt_pk_bf16_f32 v163, v166, v167
  buffer_store_dwordx4 v[160:163], v2, s[16:19], s4 offen offset:1024 sc1
  s_add_u32 s4, s4, 8192
  v_pk_mul_f32 v[136:137], v[136:137], v[6:7]
  v_pk_mul_f32 v[138:139], v[138:139], v[6:7]
  v_pk_mul_f32 v[140:141], v[140:141], v[6:7]
  v_pk_mul_f32 v[142:143], v[142:143], v[6:7]
  v_cvt_pk_bf16_f32 v136, v136, v137
  v_cvt_pk_bf16_f32 v137, v138, v139
  v_cvt_pk_bf16_f32 v138, v140, v141
  v_cvt_pk_bf16_f32 v139, v142, v143
  buffer_store_dwordx4 v[136:139], v2, s[16:19], s4 offen offset:0 sc1
  v_pk_mul_f32 v[168:169], v[168:169], v[8:9]
  v_pk_mul_f32 v[170:171], v[170:171], v[8:9]
  v_pk_mul_f32 v[172:173], v[172:173], v[8:9]
  v_pk_mul_f32 v[174:175], v[174:175], v[8:9]
  v_cvt_pk_bf16_f32 v168, v168, v169
  v_cvt_pk_bf16_f32 v169, v170, v171
  v_cvt_pk_bf16_f32 v170, v172, v173
  v_cvt_pk_bf16_f32 v171, v174, v175
  buffer_store_dwordx4 v[168:171], v2, s[16:19], s4 offen offset:1024 sc1
  s_add_u32 s4, s4, 8192
  v_pk_mul_f32 v[144:145], v[144:145], v[6:7]
  v_pk_mul_f32 v[146:147], v[146:147], v[6:7]
  v_pk_mul_f32 v[148:149], v[148:149], v[6:7]
  v_pk_mul_f32 v[150:151], v[150:151], v[6:7]
  v_cvt_pk_bf16_f32 v144, v144, v145
  v_cvt_pk_bf16_f32 v145, v146, v147
  v_cvt_pk_bf16_f32 v146, v148, v149
  v_cvt_pk_bf16_f32 v147, v150, v151
  buffer_store_dwordx4 v[144:147], v2, s[16:19], s4 offen offset:0 sc1
  v_pk_mul_f32 v[176:177], v[176:177], v[8:9]
  v_pk_mul_f32 v[178:179], v[178:179], v[8:9]
  v_pk_mul_f32 v[180:181], v[180:181], v[8:9]
  v_pk_mul_f32 v[182:183], v[182:183], v[8:9]
  v_cvt_pk_bf16_f32 v176, v176, v177
  v_cvt_pk_bf16_f32 v177, v178, v179
  v_cvt_pk_bf16_f32 v178, v180, v181
  v_cvt_pk_bf16_f32 v179, v182, v183
  buffer_store_dwordx4 v[176:179], v2, s[16:19], s4 offen offset:1024 sc1
  s_add_u32 s4, s4, 8192
  v_pk_mul_f32 v[152:153], v[152:153], v[6:7]
  v_pk_mul_f32 v[154:155], v[154:155], v[6:7]
  v_pk_mul_f32 v[156:157], v[156:157], v[6:7]
  v_pk_mul_f32 v[158:159], v[158:159], v[6:7]
  v_cvt_pk_bf16_f32 v152, v152, v153
  v_cvt_pk_bf16_f32 v153, v154, v155
  v_cvt_pk_bf16_f32 v154, v156, v157
  v_cvt_pk_bf16_f32 v155, v158, v159
  buffer_store_dwordx4 v[152:155], v2, s[16:19], s4 offen offset:0 sc1
  v_pk_mul_f32 v[184:185], v[184:185], v[8:9]
  v_pk_mul_f32 v[186:187], v[186:187], v[8:9]
  v_pk_mul_f32 v[188:189], v[188:189], v[8:9]
  v_pk_mul_f32 v[190:191], v[190:191], v[8:9]
  v_cvt_pk_bf16_f32 v184, v184, v185
  v_cvt_pk_bf16_f32 v185, v186, v187
  v_cvt_pk_bf16_f32 v186, v188, v189
  v_cvt_pk_bf16_f32 v187, v190, v191
  buffer_store_dwordx4 v[184:187], v2, s[16:19], s4 offen offset:1024 sc1
  s_branch La_e1
La_e0:
  s_waitcnt lgkmcnt(7)
  v_mfma_f32_16x16x32_bf16 v[104:107], a[32:35], a[176:179], v[28:31]
  buffer_load_dwordx2 v[12:13], v14, s[96:99], s91 offen sc1
  ds_read_b128 a[12:15], v3 offset:11264
  v_mfma_f32_16x16x32_bf16 v[104:107], a[36:39], a[180:183], v[104:107]
  v_cndmask_b32 v64, v64, v5, s[32:33]
  v_exp_f32 v64, v64
  v_mfma_f32_16x16x32_bf16 v[104:107], a[40:43], a[184:187], v[104:107]
  v_cndmask_b32 v65, v65, v5, s[34:35]
  v_exp_f32 v65, v65
  v_mfma_f32_16x16x32_bf16 v[104:107], a[44:47], a[188:191], v[104:107]
  s_waitcnt lgkmcnt(4)
  v_cndmask_b32 v66, v66, v5, s[36:37]
  v_exp_f32 v66, v66
  v_mfma_f32_16x16x32_bf16 v[108:111], a[48:51], a[176:179], v[28:31]
  v_cndmask_b32 v67, v67, v5, s[38:39]
  v_exp_f32 v67, v67
  v_mfma_f32_16x16x32_bf16 v[108:111], a[52:55], a[180:183], v[108:111]
  ds_read_b128 a[16:19], v3 offset:12288
  ds_read_b128 a[20:23], v3 offset:13312
  v_mfma_f32_16x16x32_bf16 v[108:111], a[56:59], a[184:187], v[108:111]
  v_cndmask_b32 v68, v68, v5, s[40:41]
  v_exp_f32 v68, v68
  v_mfma_f32_16x16x32_bf16 v[108:111], a[60:63], a[188:191], v[108:111]
  s_waitcnt lgkmcnt(2)
  v_cndmask_b32 v69, v69, v5, s[42:43]
  v_exp_f32 v69, v69
  v_mfma_f32_16x16x32_bf16 v[120:123], a[0:3], a[176:179], v[28:31]
  ds_read_b128 a[24:27], v3 offset:14336
  ds_read_b128 a[28:31], v3 offset:15360
  v_mfma_f32_16x16x32_bf16 v[120:123], a[4:7], a[180:183], v[120:123]
  v_cndmask_b32 v70, v70, v5, s[44:45]
  v_exp_f32 v70, v70
  v_mfma_f32_16x16x32_bf16 v[120:123], a[8:11], a[184:187], v[120:123]
  v_cndmask_b32 v71, v71, v5, s[46:47]
  v_exp_f32 v71, v71
  v_mfma_f32_16x16x32_bf16 v[120:123], a[12:15], a[188:191], v[120:123]
  s_waitcnt lgkmcnt(0)
  ds_read_b128 a[32:35], v4 offset:0
  ds_read_b128 a[36:39], v4 offset:1024
  v_mfma_f32_16x16x32_bf16 v[124:127], a[16:19], a[176:179], v[28:31]
  v_exp_f32 v72, v72
  v_mfma_f32_16x16x32_bf16 v[124:127], a[20:23], a[180:183], v[124:127]
  ds_read_b128 a[40:43], v4 offset:2048
  ds_read_b128 a[44:47], v4 offset:3072
  ds_read_b128 a[48:51], v4 offset:4096
  v_mfma_f32_16x16x32_bf16 v[124:127], a[24:27], a[184:187], v[124:127]
  ds_read_b128 a[52:55], v4 offset:5120
  ds_read_b128 a[56:59], v4 offset:6144
  ds_read_b128 a[60:63], v4 offset:7168
  v_exp_f32 v73, v73
  v_mfma_f32_16x16x32_bf16 v[124:127], a[28:31], a[188:191], v[124:127]
  s_waitcnt lgkmcnt(0)
  v_exp_f32 v74, v74
  v_mfma_f32_16x16x32_bf16 v[192:195], a[32:35], v[48:51], v[192:195]
  ds_read_b128 a[0:3], v4 offset:8192
  ds_read_b128 a[4:7], v4 offset:9216
  v_mfma_f32_16x16x32_bf16 v[224:227], a[32:35], v[52:55], v[224:227]
  v_exp_f32 v75, v75
  v_mfma_f32_16x16x32_bf16 a[200:203], a[208:211], v[48:51], a[200:203]
  v_exp_f32 v76, v76
  v_mfma_f32_16x16x32_bf16 v[196:199], a[36:39], v[48:51], v[196:199]
  ds_read_b128 a[8:11], v4 offset:10240
  ds_read_b128 a[12:15], v4 offset:11264
  v_mfma_f32_16x16x32_bf16 v[228:231], a[36:39], v[52:55], v[228:231]
  v_exp_f32 v77, v77
  v_mfma_f32_16x16x32_bf16 a[204:207], a[208:211], v[52:55], a[204:207]
  v_exp_f32 v78, v78
  v_mfma_f32_16x16x32_bf16 v[200:203], a[40:43], v[48:51], v[200:203]
  ds_read_b128 a[16:19], v4 offset:12288
  ds_read_b128 a[20:23], v4 offset:13312
  v_mfma_f32_16x16x32_bf16 v[232:235], a[40:43], v[52:55], v[232:235]
  v_exp_f32 v79, v79
  v_mfma_f32_16x16x32_bf16 v[204:207], a[44:47], v[48:51], v[204:207]
  ds_read_b128 a[24:27], v4 offset:14336
  v_cvt_pk_bf16_f32 v32, v64, v65
  v_mfma_f32_16x16x32_bf16 v[236:239], a[44:47], v[52:55], v[236:239]
  v_cndmask_b32 v80, v80, v5, s[48:49]
  v_exp_f32 v80, v80
  v_mfma_f32_16x16x32_bf16 v[208:211], a[48:51], v[48:51], v[208:211]
  v_cndmask_b32 v81, v81, v5, s[50:51]
  v_exp_f32 v81, v81
  v_mfma_f32_16x16x32_bf16 v[240:243], a[48:51], v[52:55], v[240:243]
  ds_read_b128 a[28:31], v4 offset:15360
  v_xor_b32 v4, 0x8000, v4
  v_cvt_pk_bf16_f32 v40, v80, v81
  v_mfma_f32_16x16x32_bf16 v[212:215], a[52:55], v[48:51], v[212:215]
  v_cndmask_b32 v82, v82, v5, s[52:53]
  v_exp_f32 v82, v82
  v_mfma_f32_16x16x32_bf16 v[244:247], a[52:55], v[52:55], v[244:247]
  v_cndmask_b32 v83, v83, v5, s[54:55]
  v_exp_f32 v83, v83
  v_mfma_f32_16x16x32_bf16 v[216:219], a[56:59], v[48:51], v[216:219]
  ds_read_b128 a[32:35], v4 offset:0
  ds_read_b128 a[36:39], v4 offset:1024
  v_cvt_pk_bf16_f32 v41, v82, v83
  v_mfma_f32_16x16x32_bf16 v[248:251], a[56:59], v[52:55], v[248:251]
  v_cndmask_b32 v84, v84, v5, s[56:57]
  v_exp_f32 v84, v84
  v_mfma_f32_16x16x32_bf16 v[220:223], a[60:63], v[48:51], v[220:223]
  v_cndmask_b32 v85, v85, v5, s[58:59]
  v_exp_f32 v85, v85
  v_mfma_f32_16x16x32_bf16 v[252:255], a[60:63], v[52:55], v[252:255]
  s_waitcnt lgkmcnt(2)
  ds_read_b128 a[40:43], v4 offset:2048
  v_cvt_pk_bf16_f32 v33, v66, v67
  v_cvt_pk_bf16_f32 v42, v84, v85
  v_mfma_f32_16x16x32_bf16 v[192:195], a[0:3], v[56:59], v[192:195]
  v_cndmask_b32 v86, v86, v5, s[60:61]
  v_exp_f32 v86, v86
  v_mfma_f32_16x16x32_bf16 v[224:227], a[0:3], v[60:63], v[224:227]
  v_cndmask_b32 v87, v87, v5, s[62:63]
  v_exp_f32 v87, v87
  v_mfma_f32_16x16x32_bf16 a[200:203], a[208:211], v[56:59], a[200:203]
  ds_read_b128 a[44:47], v4 offset:3072
  v_cvt_pk_bf16_f32 v34, v68, v69
  v_cvt_pk_bf16_f32 v43, v86, v87
  v_mfma_f32_16x16x32_bf16 v[196:199], a[4:7], v[56:59], v[196:199]
  v_exp_f32 v88, v88
  v_mfma_f32_16x16x32_bf16 v[228:231], a[4:7], v[60:63], v[228:231]
  ds_read_b128 a[48:51], v4 offset:4096
  v_cvt_pk_bf16_f32 v35, v70, v71
  v_mfma_f32_16x16x32_bf16 a[204:207], a[208:211], v[60:63], a[204:207]
  v_exp_f32 v89, v89
  v_mfma_f32_16x16x32_bf16 v[200:203], a[8:11], v[56:59], v[200:203]
  v_exp_f32 v90, v90
  v_cvt_pk_bf16_f32 v44, v88, v89
  v_mfma_f32_16x16x32_bf16 v[232:235], a[8:11], v[60:63], v[232:235]
  ds_read_b128 a[52:55], v4 offset:5120
  v_cvt_pk_bf16_f32 v36, v72, v73
  v_mfma_f32_16x16x32_bf16 v[204:207], a[12:15], v[56:59], v[204:207]
  v_exp_f32 v91, v91
  v_mfma_f32_16x16x32_bf16 v[236:239], a[12:15], v[60:63], v[236:239]
  v_exp_f32 v92, v92
  v_cvt_pk_bf16_f32 v45, v90, v91
  v_mfma_f32_16x16x32_bf16 v[208:211], a[16:19], v[56:59], v[208:211]
  ds_read_b128 a[56:59], v4 offset:6144
  ds_read_b128 a[60:63], v4 offset:7168
  v_mfma_f32_16x16x32_bf16 v[240:243], a[16:19], v[60:63], v[240:243]
  v_exp_f32 v93, v93
  v_mfma_f32_16x16x32_bf16 v[212:215], a[20:23], v[56:59], v[212:215]
  v_exp_f32 v94, v94
  v_cvt_pk_bf16_f32 v46, v92, v93
  v_mfma_f32_16x16x32_bf16 v[244:247], a[20:23], v[60:63], v[244:247]
  ds_read_b128 a[0:3], v4 offset:8192
  v_cvt_pk_bf16_f32 v37, v74, v75
  v_mfma_f32_16x16x32_bf16 v[216:219], a[24:27], v[56:59], v[216:219]
  v_exp_f32 v95, v95
  v_mfma_f32_16x16x32_bf16 v[248:251], a[24:27], v[60:63], v[248:251]
  ds_read_b128 a[4:7], v4 offset:9216
  v_cvt_pk_bf16_f32 v38, v76, v77
  v_cvt_pk_bf16_f32 v47, v94, v95
  v_mfma_f32_16x16x32_bf16 v[220:223], a[28:31], v[56:59], v[220:223]
  s_waitcnt vmcnt(0)
  s_barrier
  v_mfma_f32_16x16x32_bf16 v[252:255], a[28:31], v[60:63], v[252:255]
  ds_read_b128 a[8:11], v4 offset:10240
  v_cvt_pk_bf16_f32 v39, v78, v79
La_e1:
  s_mov_b32 s5, 0x40000
Lpoll_7:
  v_cmp_ne_u64 vcc, s[94:95], v[12:13]
  s_nop 0
  s_cbranch_vccz Lpolld_8
  s_sleep 4
  buffer_load_dwordx2 v[12:13], v14, s[96:99], s91 offen sc1
  s_sub_u32 s5, s5, 1
  s_waitcnt vmcnt(0)
  s_cbranch_scc0 Lpoll_7
Lpolld_8:
  v_accvgpr_read_b32 v10, a212
  v_accvgpr_read_b32 v11, a213
  v_accvgpr_read_b32 v12, a214
  v_accvgpr_read_b32 v13, a215
  s_mov_b32 s12, s80
  s_mov_b32 s13, s81
  s_mov_b32 s14, 2097152
  s_mov_b32 s15, 0x00020000
  s_lshl_b32 s93, s77, 20
  s_lshl_b32 s72, s76, 8
  s_add_u32 s93, s93, s72
  s_add_u32 s72, s73, s76
  s_and_b32 s31, s72, 3
  s_lshl_b32 s31, s31, 3
  s_or_b32 s31, s31, 0x80000
  s_bfe_u32 s30, 0x70702, s31
  s_add_u32 s30, s30, 0
  s_and_b32 s30, s30, 7
  s_lshl_b32 s72, s30, 17
  s_add_u32 s71, s93, s72
  s_add_u32 s8, s86, 83886080
  s_addc_u32 s9, s87, 0
  s_mov_b32 s10, 4194304
  s_mov_b32 s11, 0x00020000
  s_lshl_b32 s92, s73, 1
  s_add_u32 s92, s92, s77
  s_lshl_b32 s92, s92, 17
  s_add_u32 s92, s92, s79
  s_add_u32 s72, s73, s76
  s_and_b32 s1, s72, 3
  s_lshl_b32 s1, s1, 3
  s_or_b32 s1, s1, 0x80000
  s_bfe_u32 s0, 0x70702, s1
  s_add_u32 s0, s0, 0
  s_and_b32 s0, s0, 7
  s_lshl_b32 s72, s0, 14
  s_add_u32 s70, s92, s72
  s_waitcnt lgkmcnt(3)
  v_mfma_f32_16x16x32_bf16 v[192:195], a[32:35], v[32:35], v[192:195]
  s_add_u32 m0, s79, 147456
  ds_read_b128 a[12:15], v4 offset:11264
  v_cndmask_b32 v104, v104, v5, s[32:33]
  v_mfma_f32_16x16x32_bf16 v[224:227], a[32:35], v[36:39], v[224:227]
  v_exp_f32 v104, v104
  v_mfma_f32_16x16x32_bf16 a[200:203], a[208:211], v[32:35], a[200:203]
  v_cndmask_b32 v105, v105, v5, s[34:35]
  v_exp_f32 v105, v105
  v_mfma_f32_16x16x32_bf16 v[196:199], a[36:39], v[32:35], v[196:199]
  buffer_load_dwordx4 v10, s[12:15], s71 offen offset:0 lds
  ds_read_b128 a[16:19], v4 offset:12288
  v_mfma_f32_16x16x32_bf16 v[228:231], a[36:39], v[36:39], v[228:231]
  v_cndmask_b32 v106, v106, v5, s[36:37]
  v_exp_f32 v106, v106
  v_mfma_f32_16x16x32_bf16 a[204:207], a[208:211], v[36:39], a[204:207]
  buffer_load_dwordx4 v11, s[12:15], s71 offen offset:1024 lds
  v_cndmask_b32 v107, v107, v5, s[38:39]
  v_mfma_f32_16x16x32_bf16 v[200:203], a[40:43], v[32:35], v[200:203]
  v_exp_f32 v107, v107
  v_mfma_f32_16x16x32_bf16 v[232:235], a[40:43], v[36:39], v[232:235]
  ds_read_b128 a[20:23], v4 offset:13312
  v_cndmask_b32 v108, v108, v5, s[40:41]
  v_mfma_f32_16x16x32_bf16 v[204:207], a[44:47], v[32:35], v[204:207]
  v_exp_f32 v108, v108
  v_mfma_f32_16x16x32_bf16 v[236:239], a[44:47], v[36:39], v[236:239]
  buffer_load_dwordx4 v12, s[12:15], s71 offen offset:2048 lds
  ds_read_b128 a[24:27], v4 offset:14336
  v_mfma_f32_16x16x32_bf16 v[208:211], a[48:51], v[32:35], v[208:211]
  v_cndmask_b32 v109, v109, v5, s[42:43]
  v_exp_f32 v109, v109
  v_mfma_f32_16x16x32_bf16 v[240:243], a[48:51], v[36:39], v[240:243]
  ds_read_b128 a[28:31], v4 offset:15360
  v_xor_b32 v4, 0x4000, v4
  v_mfma_f32_16x16x32_bf16 v[212:215], a[52:55], v[32:35], v[212:215]
  v_cndmask_b32 v110, v110, v5, s[44:45]
  v_exp_f32 v110, v110
  v_mfma_f32_16x16x32_bf16 v[244:247], a[52:55], v[36:39], v[244:247]
  buffer_load_dwordx4 v13, s[12:15], s71 offen offset:3072 lds
  ds_read_b128 a[32:35], v4 offset:0
  v_mfma_f32_16x16x32_bf16 v[216:219], a[56:59], v[32:35], v[216:219]
  s_bfe_u32 s72, 0x3020106, s31
  v_cndmask_b32 v111, v111, v5, s[46:47]
  v_exp_f32 v111, v111
  v_mfma_f32_16x16x32_bf16 v[248:251], a[56:59], v[36:39], v[248:251]
  s_add_u32 s30, s30, s72
  s_add_u32 s31, s31, 8
  s_and_b32 s31, s31, 0x8001f
  v_mfma_f32_16x16x32_bf16 v[220:223], a[60:63], v[32:35], v[220:223]
  s_and_b32 s30, s30, 7
  s_lshl_b32 s72, s30, 17
  s_add_u32 s71, s93, s72
  v_mfma_f32_16x16x32_bf16 v[252:255], a[60:63], v[36:39], v[252:255]
  s_waitcnt lgkmcnt(1)
  v_cndmask_b32 v120, v120, v5, s[48:49]
  v_exp_f32 v120, v120
  v_mfma_f32_16x16x32_bf16 v[192:195], a[0:3], v[40:43], v[192:195]
  s_add_u32 m0, s79, 131072
  ds_read_b128 a[36:39], v4 offset:1024
  ds_read_b128 a[40:43], v4 offset:2048
  v_mfma_f32_16x16x32_bf16 v[224:227], a[0:3], v[44:47], v[224:227]
  v_cndmask_b32 v121, v121, v5, s[50:51]
  v_exp_f32 v121, v121
  v_mfma_f32_16x16x32_bf16 a[200:203], a[208:211], v[40:43], a[200:203]
  buffer_load_dwordx4 v2, s[8:11], s70 offen offset:0 sc1 lds
  ds_read_b128 a[44:47], v4 offset:3072
  v_mfma_f32_16x16x32_bf16 v[196:199], a[4:7], v[40:43], v[196:199]
  v_cndmask_b32 v122, v122, v5, s[52:53]
  v_exp_f32 v122, v122
  v_mfma_f32_16x16x32_bf16 v[228:231], a[4:7], v[44:47], v[228:231]
  buffer_load_dwordx4 v2, s[8:11], s70 offen offset:1024 sc1 lds
  ds_read_b128 a[48:51], v4 offset:4096
  v_mfma_f32_16x16x32_bf16 a[204:207], a[208:211], v[44:47], a[204:207]
  v_cndmask_b32 v123, v123, v5, s[54:55]
  v_exp_f32 v123, v123
  v_mfma_f32_16x16x32_bf16 v[200:203], a[8:11], v[40:43], v[200:203]
  buffer_load_dwordx4 v2, s[8:11], s70 offen offset:2048 sc1 lds
  ds_read_b128 a[52:55], v4 offset:5120
  v_cvt_pk_bf16_f32 v61, v122, v123
  v_mfma_f32_16x16x32_bf16 v[232:235], a[8:11], v[44:47], v[232:235]
  v_cndmask_b32 v124, v124, v5, s[56:57]
  v_exp_f32 v124, v124
  v_mfma_f32_16x16x32_bf16 v[204:207], a[12:15], v[40:43], v[204:207]
  ds_read_b128 a[56:59], v4 offset:6144
  v_cvt_pk_bf16_f32 v52, v104, v105
  v_mfma_f32_16x16x32_bf16 v[236:239], a[12:15], v[44:47], v[236:239]
  v_cndmask_b32 v125, v125, v5, s[58:59]
  v_exp_f32 v125, v125
  v_mfma_f32_16x16x32_bf16 v[208:211], a[16:19], v[40:43], v[208:211]
  buffer_load_dwordx4 v2, s[8:11], s70 offen offset:3072 sc1 lds
  ds_read_b128 a[60:63], v4 offset:7168
  v_cvt_pk_bf16_f32 v62, v124, v125
  v_mfma_f32_16x16x32_bf16 v[240:243], a[16:19], v[44:47], v[240:243]
  s_bfe_u32 s72, 0x3020106, s1
  v_cndmask_b32 v126, v126, v5, s[60:61]
  v_exp_f32 v126, v126
  v_mfma_f32_16x16x32_bf16 v[212:215], a[20:23], v[40:43], v[212:215]
  s_add_u32 s0, s0, s72
  s_add_u32 s1, s1, 8
  s_and_b32 s1, s1, 0x8001f
  v_mfma_f32_16x16x32_bf16 v[244:247], a[20:23], v[44:47], v[244:247]
  s_and_b32 s0, s0, 7
  v_cndmask_b32 v127, v127, v5, s[62:63]
  v_exp_f32 v127, v127
  v_mfma_f32_16x16x32_bf16 v[216:219], a[24:27], v[40:43], v[216:219]
  s_lshl_b32 s72, s0, 14
  s_add_u32 s70, s92, s72
  ds_read_b128 a[0:3], v4 offset:8192
  v_cvt_pk_bf16_f32 v63, v126, v127
  v_mfma_f32_16x16x32_bf16 v[248:251], a[24:27], v[44:47], v[248:251]
  ds_read_b128 a[4:7], v4 offset:9216
  v_cvt_pk_bf16_f32 v53, v106, v107
  v_mfma_f32_16x16x32_bf16 v[220:223], a[28:31], v[40:43], v[220:223]
  ds_read_b128 a[8:11], v4 offset:10240
  v_cvt_pk_bf16_f32 v54, v108, v109
  v_mfma_f32_16x16x32_bf16 v[252:255], a[28:31], v[44:47], v[252:255]
  v_cvt_pk_bf16_f32 v55, v110, v111
  v_cvt_pk_bf16_f32 v60, v120, v121
  s_waitcnt lgkmcnt(7)
  v_mfma_f32_16x16x32_bf16 v[224:227], a[32:35], v[52:55], v[224:227]
  s_add_u32 m0, s79, 49152
  ds_read_b128 a[12:15], v4 offset:11264
  v_mfma_f32_16x16x32_bf16 a[204:207], a[208:211], v[52:55], a[204:207]
  buffer_load_dwordx4 v10, s[12:15], s71 offen offset:0 lds
  v_mfma_f32_16x16x32_bf16 v[228:231], a[36:39], v[52:55], v[228:231]
  buffer_load_dwordx4 v11, s[12:15], s71 offen offset:1024 lds
  ds_read_b128 a[16:19], v4 offset:12288
  v_mfma_f32_16x16x32_bf16 v[232:235], a[40:43], v[52:55], v[232:235]
  buffer_load_dwordx4 v12, s[12:15], s71 offen offset:2048 lds
  ds_read_b128 a[20:23], v4 offset:13312
  v_mfma_f32_16x16x32_bf16 v[236:239], a[44:47], v[52:55], v[236:239]
  s_waitcnt lgkmcnt(6)
  ds_read_b128 a[24:27], v4 offset:14336
  v_mfma_f32_16x16x32_bf16 v[240:243], a[48:51], v[52:55], v[240:243]
  buffer_load_dwordx4 v13, s[12:15], s71 offen offset:3072 lds
  ds_read_b128 a[28:31], v4 offset:15360
  v_mfma_f32_16x16x32_bf16 v[244:247], a[52:55], v[52:55], v[244:247]
  s_bfe_u32 s72, 0x3020106, s31
  s_add_u32 s30, s30, s72
  s_add_u32 s31, s31, 8
  v_mfma_f32_16x16x32_bf16 v[248:251], a[56:59], v[52:55], v[248:251]
  s_and_b32 s31, s31, 0x8001f
  s_and_b32 s30, s30, 7
  s_lshl_b32 s72, s30, 17
  v_mfma_f32_16x16x32_bf16 v[252:255], a[60:63], v[52:55], v[252:255]
  s_waitcnt lgkmcnt(4)
  s_add_u32 s71, s93, s72
  s_add_u32 m0, s79, 32768
  v_mfma_f32_16x16x32_bf16 v[224:227], a[0:3], v[60:63], v[224:227]
  buffer_load_dwordx4 v2, s[8:11], s70 offen offset:0 sc1 lds
  v_mfma_f32_16x16x32_bf16 a[204:207], a[208:211], v[60:63], a[204:207]
  buffer_load_dwordx4 v2, s[8:11], s70 offen offset:1024 sc1 lds
  v_mfma_f32_16x16x32_bf16 v[228:231], a[4:7], v[60:63], v[228:231]
  buffer_load_dwordx4 v2, s[8:11], s70 offen offset:2048 sc1 lds
  v_mfma_f32_16x16x32_bf16 v[232:235], a[8:11], v[60:63], v[232:235]
  buffer_load_dwordx4 v2, s[8:11], s70 offen offset:3072 sc1 lds
  v_mfma_f32_16x16x32_bf16 v[236:239], a[12:15], v[60:63], v[236:239]
  s_waitcnt lgkmcnt(0)
  s_bfe_u32 s72, 0x3020106, s1
  s_add_u32 s0, s0, s72
  v_mfma_f32_16x16x32_bf16 v[240:243], a[16:19], v[60:63], v[240:243]
  s_add_u32 s1, s1, 8
  s_and_b32 s1, s1, 0x8001f
  s_and_b32 s0, s0, 7
  v_mfma_f32_16x16x32_bf16 v[244:247], a[20:23], v[60:63], v[244:247]
  s_lshl_b32 s72, s0, 14
  s_add_u32 s70, s92, s72
  v_mfma_f32_16x16x32_bf16 v[248:251], a[24:27], v[60:63], v[248:251]
  v_mfma_f32_16x16x32_bf16 v[252:255], a[28:31], v[60:63], v[252:255]
  s_sub_u32 s88, 15, s25
  s_lshl_b32 s4, s88, 20
  s_lshl_b32 s5, s24, 15
  s_add_u32 s4, s4, s5
  s_lshl_b32 s5, s3, 11
  s_add_u32 s4, s4, s5
  v_accvgpr_read_b32 v6, a200
  v_accvgpr_read_b32 v8, a204
  s_mov_b32 s5, 0x5f800000
  v_cmp_ngt_f32 vcc, s5, v6
  v_rcp_f32 v6, v6
  s_or_b32 s89, s89, vcc_lo
  s_or_b32 s89, s89, vcc_hi
  v_mov_b32 v7, v6
  v_cmp_ngt_f32 vcc, s5, v8
  v_rcp_f32 v8, v8
  s_or_b32 s89, s89, vcc_lo
  s_or_b32 s89, s89, vcc_hi
  v_mov_b32 v9, v8
  v_pk_mul_f32 v[192:193], v[192:193], v[6:7]
  v_pk_mul_f32 v[194:195], v[194:195], v[6:7]
  v_pk_mul_f32 v[196:197], v[196:197], v[6:7]
  v_pk_mul_f32 v[198:199], v[198:199], v[6:7]
  v_cvt_pk_bf16_f32 v192, v192, v193
  v_cvt_pk_bf16_f32 v193, v194, v195
  v_cvt_pk_bf16_f32 v194, v196, v197
  v_cvt_pk_bf16_f32 v195, v198, v199
  buffer_store_dwordx4 v[192:195], v2, s[16:19], s4 offen offset:0 sc1
  v_pk_mul_f32 v[224:225], v[224:225], v[8:9]
  v_pk_mul_f32 v[226:227], v[226:227], v[8:9]
  v_pk_mul_f32 v[228:229], v[228:229], v[8:9]
  v_pk_mul_f32 v[230:231], v[230:231], v[8:9]
  v_cvt_pk_bf16_f32 v224, v224, v225
  v_cvt_pk_bf16_f32 v225, v226, v227
  v_cvt_pk_bf16_f32 v226, v228, v229
  v_cvt_pk_bf16_f32 v227, v230, v231
  buffer_store_dwordx4 v[224:227], v2, s[16:19], s4 offen offset:1024 sc1
  s_add_u32 s4, s4, 8192
  v_pk_mul_f32 v[200:201], v[200:201], v[6:7]
  v_pk_mul_f32 v[202:203], v[202:203], v[6:7]
  v_pk_mul_f32 v[204:205], v[204:205], v[6:7]
  v_pk_mul_f32 v[206:207], v[206:207], v[6:7]
  v_cvt_pk_bf16_f32 v200, v200, v201
  v_cvt_pk_bf16_f32 v201, v202, v203
  v_cvt_pk_bf16_f32 v202, v204, v205
  v_cvt_pk_bf16_f32 v203, v206, v207
  buffer_store_dwordx4 v[200:203], v2, s[16:19], s4 offen offset:0 sc1
  v_pk_mul_f32 v[232:233], v[232:233], v[8:9]
  v_pk_mul_f32 v[234:235], v[234:235], v[8:9]
  v_pk_mul_f32 v[236:237], v[236:237], v[8:9]
  v_pk_mul_f32 v[238:239], v[238:239], v[8:9]
  v_cvt_pk_bf16_f32 v232, v232, v233
  v_cvt_pk_bf16_f32 v233, v234, v235
  v_cvt_pk_bf16_f32 v234, v236, v237
  v_cvt_pk_bf16_f32 v235, v238, v239
  buffer_store_dwordx4 v[232:235], v2, s[16:19], s4 offen offset:1024 sc1
  s_add_u32 s4, s4, 8192
  v_pk_mul_f32 v[208:209], v[208:209], v[6:7]
  v_pk_mul_f32 v[210:211], v[210:211], v[6:7]
  v_pk_mul_f32 v[212:213], v[212:213], v[6:7]
  v_pk_mul_f32 v[214:215], v[214:215], v[6:7]
  v_cvt_pk_bf16_f32 v208, v208, v209
  v_cvt_pk_bf16_f32 v209, v210, v211
  v_cvt_pk_bf16_f32 v210, v212, v213
  v_cvt_pk_bf16_f32 v211, v214, v215
  buffer_store_dwordx4 v[208:211], v2, s[16:19], s4 offen offset:0 sc1
  v_pk_mul_f32 v[240:241], v[240:241], v[8:9]
  v_pk_mul_f32 v[242:243], v[242:243], v[8:9]
  v_pk_mul_f32 v[244:245], v[244:245], v[8:9]
  v_pk_mul_f32 v[246:247], v[246:247], v[8:9]
  v_cvt_pk_bf16_f32 v240, v240, v241
  v_cvt_pk_bf16_f32 v241, v242, v243
  v_cvt_pk_bf16_f32 v242, v244, v245
  v_cvt_pk_bf16_f32 v243, v246, v247
  buffer_store_dwordx4 v[240:243], v2, s[16:19], s4 offen offset:1024 sc1
  s_add_u32 s4, s4, 8192
  v_pk_mul_f32 v[216:217], v[216:217], v[6:7]
  v_pk_mul_f32 v[218:219], v[218:219], v[6:7]
  v_pk_mul_f32 v[220:221], v[220:221], v[6:7]
  v_pk_mul_f32 v[222:223], v[222:223], v[6:7]
  v_cvt_pk_bf16_f32 v216, v216, v217
  v_cvt_pk_bf16_f32 v217, v218, v219
  v_cvt_pk_bf16_f32 v218, v220, v221
  v_cvt_pk_bf16_f32 v219, v222, v223
  buffer_store_dwordx4 v[216:219], v2, s[16:19], s4 offen offset:0 sc1
  v_pk_mul_f32 v[248:249], v[248:249], v[8:9]
  v_pk_mul_f32 v[250:251], v[250:251], v[8:9]
  v_pk_mul_f32 v[252:253], v[252:253], v[8:9]
  v_pk_mul_f32 v[254:255], v[254:255], v[8:9]
  v_cvt_pk_bf16_f32 v248, v248, v249
  v_cvt_pk_bf16_f32 v249, v250, v251
  v_cvt_pk_bf16_f32 v250, v252, v253
  v_cvt_pk_bf16_f32 v251, v254, v255
  buffer_store_dwordx4 v[248:251], v2, s[16:19], s4 offen offset:1024 sc1
  s_cmp_eq_u32 s89, 0
  s_cbranch_scc1 La_done
  s_waitcnt vmcnt(0)
  s_sub_u32 s6, 15, s25
La_sl_blk:
  v_mov_b32 v192, 0
  v_mov_b32 v193, 0
  v_mov_b32 v194, 0
  v_mov_b32 v195, 0
  v_mov_b32 v196, 0
  v_mov_b32 v197, 0
  v_mov_b32 v198, 0
  v_mov_b32 v199, 0
  v_mov_b32 v200, 0
  v_mov_b32 v201, 0
  v_mov_b32 v202, 0
  v_mov_b32 v203, 0
  v_mov_b32 v204, 0
  v_mov_b32 v205, 0
  v_mov_b32 v206, 0
  v_mov_b32 v207, 0
  v_mov_b32 v208, 0
  v_mov_b32 v209, 0
  v_mov_b32 v210, 0
  v_mov_b32 v211, 0
  v_mov_b32 v212, 0
  v_mov_b32 v213, 0
  v_mov_b32 v214, 0
  v_mov_b32 v215, 0
  v_mov_b32 v216, 0
  v_mov_b32 v217, 0
  v_mov_b32 v218, 0
  v_mov_b32 v219, 0
  v_mov_b32 v220, 0
  v_mov_b32 v221, 0
  v_mov_b32 v222, 0
  v_mov_b32 v223, 0
  v_mov_b32 v224, 0
  v_mov_b32 v225, 0
  v_mov_b32 v226, 0
  v_mov_b32 v227, 0
  v_mov_b32 v228, 0
  v_mov_b32 v229, 0
  v_mov_b32 v230, 0
  v_mov_b32 v231, 0
  v_mov_b32 v232, 0
  v_mov_b32 v233, 0
  v_mov_b32 v234, 0
  v_mov_b32 v235, 0
  v_mov_b32 v236, 0
  v_mov_b32 v237, 0
  v_mov_b32 v238, 0
  v_mov_b32 v239, 0
  v_mov_b32 v240, 0
  v_mov_b32 v241, 0
  v_mov_b32 v242, 0
  v_mov_b32 v243, 0
  v_mov_b32 v244, 0
  v_mov_b32 v245, 0
  v_mov_b32 v246, 0
  v_mov_b32 v247, 0
  v_mov_b32 v248, 0
  v_mov_b32 v249, 0
  v_mov_b32 v250, 0
  v_mov_b32 v251, 0
  v_mov_b32 v252, 0
  v_mov_b32 v253, 0
  v_mov_b32 v254, 0
  v_mov_b32 v255, 0
  v_mov_b32 v24, 0
  v_mov_b32 v25, 0
  v_mov_b32 v26, 0
  v_mov_b32 v27, 0
  v_mov_b32 v28, 0
  v_mov_b32 v29, 0
  v_mov_b32 v30, 0
  v_mov_b32 v31, 0
  v_mov_b32 v16, v5
  v_mov_b32 v17, v5
  v_and_b32 v20, 15, v1
  v_lshrrev_b32 v21, 4, v1
  v_sub_u32 v20, v20, v21
  v_lshlrev_b32 v20, 2, v20
  s_lshl_b32 s4, s6, 7
  s_add_u32 s4, s4, s3
  v_add_u32 v20, s4, v20
  v_add_u32 v21, 64, v20
  s_add_u32 s7, s6, 1
  s_lshl_b32 s7, s7, 2
  s_mov_b32 s90, 0
La_sl_loop:
  s_add_u32 s4, s90, 0
  buffer_load_dwordx4 a[0:3], v2, s[20:23], s4 offen offset:0 sc1
  buffer_load_dwordx4 a[4:7], v2, s[20:23], s4 offen offset:1024 sc1
  buffer_load_dwordx4 a[8:11], v2, s[20:23], s4 offen offset:2048 sc1
  buffer_load_dwordx4 a[12:15], v2, s[20:23], s4 offen offset:3072 sc1
  s_add_u32 s4, s90, 4096
  buffer_load_dwordx4 a[16:19], v2, s[20:23], s4 offen offset:0 sc1
  buffer_load_dwordx4 a[20:23], v2, s[20:23], s4 offen offset:1024 sc1
  buffer_load_dwordx4 a[24:27], v2, s[20:23], s4 offen offset:2048 sc1
  buffer_load_dwordx4 a[28:31], v2, s[20:23], s4 offen offset:3072 sc1
  s_add_u32 s4, s90, 16384
  buffer_load_dwordx4 a[32:35], v2, s[20:23], s4 offen offset:0 sc1
  buffer_load_dwordx4 a[36:39], v2, s[20:23], s4 offen offset:1024 sc1
  buffer_load_dwordx4 a[40:43], v2, s[20:23], s4 offen offset:2048 sc1
  buffer_load_dwordx4 a[44:47], v2, s[20:23], s4 offen offset:3072 sc1
  s_add_u32 s4, s90, 20480
  buffer_load_dwordx4 a[48:51], v2, s[20:23], s4 offen offset:0 sc1
  buffer_load_dwordx4 a[52:55], v2, s[20:23], s4 offen offset:1024 sc1
  buffer_load_dwordx4 a[56:59], v2, s[20:23], s4 offen offset:2048 sc1
  buffer_load_dwordx4 a[60:63], v2, s[20:23], s4 offen offset:3072 sc1
  s_waitcnt vmcnt(0)
  v_mfma_f32_16x16x32_bf16 v[64:67], a[0:3], a[160:163], 0
  v_mfma_f32_16x16x32_bf16 v[72:75], a[0:3], a[176:179], 0
  v_mfma_f32_16x16x32_bf16 v[64:67], a[4:7], a[164:167], v[64:67]
  v_mfma_f32_16x16x32_bf16 v[72:75], a[4:7], a[180:183], v[72:75]
  v_mfma_f32_16x16x32_bf16 v[64:67], a[8:11], a[168:171], v[64:67]
  v_mfma_f32_16x16x32_bf16 v[72:75], a[8:11], a[184:187], v[72:75]
  v_mfma_f32_16x16x32_bf16 v[64:67], a[12:15], a[172:175], v[64:67]
  v_mfma_f32_16x16x32_bf16 v[72:75], a[12:15], a[188:191], v[72:75]
  v_mfma_f32_16x16x32_bf16 v[68:71], a[16:19], a[160:163], 0
  v_mfma_f32_16x16x32_bf16 v[76:79], a[16:19], a[176:179], 0
  v_mfma_f32_16x16x32_bf16 v[68:71], a[20:23], a[164:167], v[68:71]
  v_mfma_f32_16x16x32_bf16 v[76:79], a[20:23], a[180:183], v[76:79]
  v_mfma_f32_16x16x32_bf16 v[68:71], a[24:27], a[168:171], v[68:71]
  v_mfma_f32_16x16x32_bf16 v[76:79], a[24:27], a[184:187], v[76:79]
  v_mfma_f32_16x16x32_bf16 v[68:71], a[28:31], a[172:175], v[68:71]
  v_mfma_f32_16x16x32_bf16 v[76:79], a[28:31], a[188:191], v[76:79]
  v_cmp_gt_i32 vcc, 0, v20
  s_nop 1
  v_cndmask_b32 v64, v64, v5, vcc
  v_cmp_gt_i32 vcc, 1, v20
  s_nop 1
  v_cndmask_b32 v65, v65, v5, vcc
  v_cmp_gt_i32 vcc, 2, v20
  s_nop 1
  v_cndmask_b32 v66, v66, v5, vcc
  v_cmp_gt_i32 vcc, 3, v20
  s_nop 1
  v_cndmask_b32 v67, v67, v5, vcc
  v_cmp_gt_i32 vcc, 16, v20
  s_nop 1
  v_cndmask_b32 v68, v68, v5, vcc
  v_cmp_gt_i32 vcc, 17, v20
  s_nop 1
  v_cndmask_b32 v69, v69, v5, vcc
  v_cmp_gt_i32 vcc, 18, v20
  s_nop 1
  v_cndmask_b32 v70, v70, v5, vcc
  v_cmp_gt_i32 vcc, 19, v20
  s_nop 1
  v_cndmask_b32 v71, v71, v5, vcc
  v_subrev_u32 v20, 32, v20
  v_max3_f32 v6, v64, v65, v66
  v_max3_f32 v7, v67, v68, v69
  v_max3_f32 v6, v6, v70, v71
  v_max_f32 v6, v6, v7
  v_cmp_gt_i32 vcc, 0, v21
  s_nop 1
  v_cndmask_b32 v72, v72, v5, vcc
  v_cmp_gt_i32 vcc, 1, v21
  s_nop 1
  v_cndmask_b32 v73, v73, v5, vcc
  v_cmp_gt_i32 vcc, 2, v21
  s_nop 1
  v_cndmask_b32 v74, v74, v5, vcc
  v_cmp_gt_i32 vcc, 3, v21
  s_nop 1
  v_cndmask_b32 v75, v75, v5, vcc
  v_cmp_gt_i32 vcc, 16, v21
  s_nop 1
  v_cndmask_b32 v76, v76, v5, vcc
  v_cmp_gt_i32 vcc, 17, v21
  s_nop 1
  v_cndmask_b32 v77, v77, v5, vcc
  v_cmp_gt_i32 vcc, 18, v21
  s_nop 1
  v_cndmask_b32 v78, v78, v5, vcc
  v_cmp_gt_i32 vcc, 19, v21
  s_nop 1
  v_cndmask_b32 v79, v79, v5, vcc
  v_subrev_u32 v21, 32, v21
  v_max3_f32 v8, v72, v73, v74
  v_max3_f32 v9, v75, v76, v77
  v_max3_f32 v8, v8, v78, v79
  v_max_f32 v8, v8, v9
  v_mov_b32 v7, v6
  v_mov_b32 v9, v8
  s_nop 0
  v_permlane32_swap_b32 v6, v7
  v_permlane32_swap_b32 v8, v9
  v_max_f32 v6, v6, v7
  v_max_f32 v8, v8, v9
  v_mov_b32 v7, v6
  v_mov_b32 v9, v8
  s_nop 0
  v_permlane16_swap_b32 v6, v7
  v_permlane16_swap_b32 v8, v9
  v_max_f32 v6, v6, v7
  v_max_f32 v8, v8, v9
  v_max_f32 v6, v6, v16
  v_sub_f32 v7, v16, v6
  v_exp_f32 v7, v7
  v_mov_b32 v16, v6
  v_sub_f32 v64, v64, v16
  v_sub_f32 v65, v65, v16
  v_sub_f32 v66, v66, v16
  v_sub_f32 v67, v67, v16
  v_sub_f32 v68, v68, v16
  v_sub_f32 v69, v69, v16
  v_sub_f32 v70, v70, v16
  v_sub_f32 v71, v71, v16
  v_exp_f32 v64, v64
  v_exp_f32 v65, v65
  v_exp_f32 v66, v66
  v_exp_f32 v67, v67
  v_exp_f32 v68, v68
  v_exp_f32 v69, v69
  v_exp_f32 v70, v70
  v_exp_f32 v71, v71
  v_mul_f32 v24, v24, v7
  v_mul_f32 v25, v25, v7
  v_mul_f32 v26, v26, v7
  v_mul_f32 v27, v27, v7
  v_mul_f32 v192, v192, v7
  v_mul_f32 v193, v193, v7
  v_mul_f32 v194, v194, v7
  v_mul_f32 v195, v195, v7
  v_mul_f32 v196, v196, v7
  v_mul_f32 v197, v197, v7
  v_mul_f32 v198, v198, v7
  v_mul_f32 v199, v199, v7
  v_mul_f32 v200, v200, v7
  v_mul_f32 v201, v201, v7
  v_mul_f32 v202, v202, v7
  v_mul_f32 v203, v203, v7
  v_mul_f32 v204, v204, v7
  v_mul_f32 v205, v205, v7
  v_mul_f32 v206, v206, v7
  v_mul_f32 v207, v207, v7
  v_mul_f32 v208, v208, v7
  v_mul_f32 v209, v209, v7
  v_mul_f32 v210, v210, v7
  v_mul_f32 v211, v211, v7
  v_mul_f32 v212, v212, v7
  v_mul_f32 v213, v213, v7
  v_mul_f32 v214, v214, v7
  v_mul_f32 v215, v215, v7
  v_mul_f32 v216, v216, v7
  v_mul_f32 v217, v217, v7
  v_mul_f32 v218, v218, v7
  v_mul_f32 v219, v219, v7
  v_mul_f32 v220, v220, v7
  v_mul_f32 v221, v221, v7
  v_mul_f32 v222, v222, v7
  v_mul_f32 v223, v223, v7
  v_cvt_pk_bf16_f32 v32, v64, v65
  v_cvt_pk_bf16_f32 v33, v66, v67
  v_cvt_pk_bf16_f32 v34, v68, v69
  v_cvt_pk_bf16_f32 v35, v70, v71
  v_max_f32 v8, v8, v17
  v_sub_f32 v9, v17, v8
  v_exp_f32 v9, v9
  v_mov_b32 v17, v8
  v_sub_f32 v72, v72, v17
  v_sub_f32 v73, v73, v17
  v_sub_f32 v74, v74, v17
  v_sub_f32 v75, v75, v17
  v_sub_f32 v76, v76, v17
  v_sub_f32 v77, v77, v17
  v_sub_f32 v78, v78, v17
  v_sub_f32 v79, v79, v17
  v_exp_f32 v72, v72
  v_exp_f32 v73, v73
  v_exp_f32 v74, v74
  v_exp_f32 v75, v75
  v_exp_f32 v76, v76
  v_exp_f32 v77, v77
  v_exp_f32 v78, v78
  v_exp_f32 v79, v79
  v_mul_f32 v28, v28, v9
  v_mul_f32 v29, v29, v9
  v_mul_f32 v30, v30, v9
  v_mul_f32 v31, v31, v9
  v_mul_f32 v224, v224, v9
  v_mul_f32 v225, v225, v9
  v_mul_f32 v226, v226, v9
  v_mul_f32 v227, v227, v9
  v_mul_f32 v228, v228, v9
  v_mul_f32 v229, v229, v9
  v_mul_f32 v230, v230, v9
  v_mul_f32 v231, v231, v9
  v_mul_f32 v232, v232, v9
  v_mul_f32 v233, v233, v9
  v_mul_f32 v234, v234, v9
  v_mul_f32 v235, v235, v9
  v_mul_f32 v236, v236, v9
  v_mul_f32 v237, v237, v9
  v_mul_f32 v238, v238, v9
  v_mul_f32 v239, v239, v9
  v_mul_f32 v240, v240, v9
  v_mul_f32 v241, v241, v9
  v_mul_f32 v242, v242, v9
  v_mul_f32 v243, v243, v9
  v_mul_f32 v244, v244, v9
  v_mul_f32 v245, v245, v9
  v_mul_f32 v246, v246, v9
  v_mul_f32 v247, v247, v9
  v_mul_f32 v248, v248, v9
  v_mul_f32 v249, v249, v9
  v_mul_f32 v250, v250, v9
  v_mul_f32 v251, v251, v9
  v_mul_f32 v252, v252, v9
  v_mul_f32 v253, v253, v9
  v_mul_f32 v254, v254, v9
  v_mul_f32 v255, v255, v9
  v_cvt_pk_bf16_f32 v36, v72, v73
  v_cvt_pk_bf16_f32 v37, v74, v75
  v_cvt_pk_bf16_f32 v38, v76, v77
  v_cvt_pk_bf16_f32 v39, v78, v79
  v_mfma_f32_16x16x32_bf16 v[24:27], a[208:211], v[32:35], v[24:27]
  v_mfma_f32_16x16x32_bf16 v[192:195], a[32:35], v[32:35], v[192:195]
  v_mfma_f32_16x16x32_bf16 v[196:199], a[36:39], v[32:35], v[196:199]
  v_mfma_f32_16x16x32_bf16 v[200:203], a[40:43], v[32:35], v[200:203]
  v_mfma_f32_16x16x32_bf16 v[204:207], a[44:47], v[32:35], v[204:207]
  v_mfma_f32_16x16x32_bf16 v[208:211], a[48:51], v[32:35], v[208:211]
  v_mfma_f32_16x16x32_bf16 v[212:215], a[52:55], v[32:35], v[212:215]
  v_mfma_f32_16x16x32_bf16 v[216:219], a[56:59], v[32:35], v[216:219]
  v_mfma_f32_16x16x32_bf16 v[220:223], a[60:63], v[32:35], v[220:223]
  v_mfma_f32_16x16x32_bf16 v[28:31], a[208:211], v[36:39], v[28:31]
  v_mfma_f32_16x16x32_bf16 v[224:227], a[32:35], v[36:39], v[224:227]
  v_mfma_f32_16x16x32_bf16 v[228:231], a[36:39], v[36:39], v[228:231]
  v_mfma_f32_16x16x32_bf16 v[232:235], a[40:43], v[36:39], v[232:235]
  v_mfma_f32_16x16x32_bf16 v[236:239], a[44:47], v[36:39], v[236:239]
  v_mfma_f32_16x16x32_bf16 v[240:243], a[48:51], v[36:39], v[240:243]
  v_mfma_f32_16x16x32_bf16 v[244:247], a[52:55], v[36:39], v[244:247]
  v_mfma_f32_16x16x32_bf16 v[248:251], a[56:59], v[36:39], v[248:251]
  v_mfma_f32_16x16x32_bf16 v[252:255], a[60:63], v[36:39], v[252:255]
  s_add_u32 s90, s90, 8192
  s_and_b32 s4, s90, 0x4000
  s_add_u32 s90, s90, s4
  s_sub_u32 s7, s7, 1
  s_cmp_lg_u32 s7, 0
  s_cbranch_scc1 La_sl_loop
  s_lshl_b32 s4, s6, 20
  s_lshl_b32 s5, s24, 15
  s_add_u32 s4, s4, s5
  s_lshl_b32 s5, s3, 11
  s_add_u32 s4, s4, s5
  v_rcp_f32 v6, v24
  s_nop 0
  v_mov_b32 v7, v6
  v_rcp_f32 v8, v28
  s_nop 0
  v_mov_b32 v9, v8
  v_pk_mul_f32 v[192:193], v[192:193], v[6:7]
  v_pk_mul_f32 v[194:195], v[194:195], v[6:7]
  v_pk_mul_f32 v[196:197], v[196:197], v[6:7]
  v_pk_mul_f32 v[198:199], v[198:199], v[6:7]
  v_cvt_pk_bf16_f32 v192, v192, v193
  v_cvt_pk_bf16_f32 v193, v194, v195
  v_cvt_pk_bf16_f32 v194, v196, v197
  v_cvt_pk_bf16_f32 v195, v198, v199
  buffer_store_dwordx4 v[192:195], v2, s[16:19], s4 offen offset:0 sc1
  v_pk_mul_f32 v[224:225], v[224:225], v[8:9]
  v_pk_mul_f32 v[226:227], v[226:227], v[8:9]
  v_pk_mul_f32 v[228:229], v[228:229], v[8:9]
  v_pk_mul_f32 v[230:231], v[230:231], v[8:9]
  v_cvt_pk_bf16_f32 v224, v224, v225
  v_cvt_pk_bf16_f32 v225, v226, v227
  v_cvt_pk_bf16_f32 v226, v228, v229
  v_cvt_pk_bf16_f32 v227, v230, v231
  buffer_store_dwordx4 v[224:227], v2, s[16:19], s4 offen offset:1024 sc1
  s_add_u32 s4, s4, 8192
  v_pk_mul_f32 v[200:201], v[200:201], v[6:7]
  v_pk_mul_f32 v[202:203], v[202:203], v[6:7]
  v_pk_mul_f32 v[204:205], v[204:205], v[6:7]
  v_pk_mul_f32 v[206:207], v[206:207], v[6:7]
  v_cvt_pk_bf16_f32 v200, v200, v201
  v_cvt_pk_bf16_f32 v201, v202, v203
  v_cvt_pk_bf16_f32 v202, v204, v205
  v_cvt_pk_bf16_f32 v203, v206, v207
  buffer_store_dwordx4 v[200:203], v2, s[16:19], s4 offen offset:0 sc1
  v_pk_mul_f32 v[232:233], v[232:233], v[8:9]
  v_pk_mul_f32 v[234:235], v[234:235], v[8:9]
  v_pk_mul_f32 v[236:237], v[236:237], v[8:9]
  v_pk_mul_f32 v[238:239], v[238:239], v[8:9]
  v_cvt_pk_bf16_f32 v232, v232, v233
  v_cvt_pk_bf16_f32 v233, v234, v235
  v_cvt_pk_bf16_f32 v234, v236, v237
  v_cvt_pk_bf16_f32 v235, v238, v239
  buffer_store_dwordx4 v[232:235], v2, s[16:19], s4 offen offset:1024 sc1
  s_add_u32 s4, s4, 8192
  v_pk_mul_f32 v[208:209], v[208:209], v[6:7]
  v_pk_mul_f32 v[210:211], v[210:211], v[6:7]
  v_pk_mul_f32 v[212:213], v[212:213], v[6:7]
  v_pk_mul_f32 v[214:215], v[214:215], v[6:7]
  v_cvt_pk_bf16_f32 v208, v208, v209
  v_cvt_pk_bf16_f32 v209, v210, v211
  v_cvt_pk_bf16_f32 v210, v212, v213
  v_cvt_pk_bf16_f32 v211, v214, v215
  buffer_store_dwordx4 v[208:211], v2, s[16:19], s4 offen offset:0 sc1
  v_pk_mul_f32 v[240:241], v[240:241], v[8:9]
  v_pk_mul_f32 v[242:243], v[242:243], v[8:9]
  v_pk_mul_f32 v[244:245], v[244:245], v[8:9]
  v_pk_mul_f32 v[246:247], v[246:247], v[8:9]
  v_cvt_pk_bf16_f32 v240, v240, v241
  v_cvt_pk_bf16_f32 v241, v242, v243
  v_cvt_pk_bf16_f32 v242, v244, v245
  v_cvt_pk_bf16_f32 v243, v246, v247
  buffer_store_dwordx4 v[240:243], v2, s[16:19], s4 offen offset:1024 sc1
  s_add_u32 s4, s4, 8192
  v_pk_mul_f32 v[216:217], v[216:217], v[6:7]
  v_pk_mul_f32 v[218:219], v[218:219], v[6:7]
  v_pk_mul_f32 v[220:221], v[220:221], v[6:7]
  v_pk_mul_f32 v[222:223], v[222:223], v[6:7]
  v_cvt_pk_bf16_f32 v216, v216, v217
  v_cvt_pk_bf16_f32 v217, v218, v219
  v_cvt_pk_bf16_f32 v218, v220, v221
  v_cvt_pk_bf16_f32 v219, v222, v223
  buffer_store_dwordx4 v[216:219], v2, s[16:19], s4 offen offset:0 sc1
  v_pk_mul_f32 v[248:249], v[248:249], v[8:9]
  v_pk_mul_f32 v[250:251], v[250:251], v[8:9]
  v_pk_mul_f32 v[252:253], v[252:253], v[8:9]
  v_pk_mul_f32 v[254:255], v[254:255], v[8:9]
  v_cvt_pk_bf16_f32 v248, v248, v249
  v_cvt_pk_bf16_f32 v249, v250, v251
  v_cvt_pk_bf16_f32 v250, v252, v253
  v_cvt_pk_bf16_f32 v251, v254, v255
  buffer_store_dwordx4 v[248:251], v2, s[16:19], s4 offen offset:1024 sc1
  s_cmp_eq_u32 s6, s25
  s_cbranch_scc1 La_done
  v_accvgpr_read_b32 v64, a128
  v_accvgpr_read_b32 v65, a129
  v_accvgpr_read_b32 v66, a130
  v_accvgpr_read_b32 v67, a131
  v_accvgpr_read_b32 v68, a132
  v_accvgpr_read_b32 v69, a133
  v_accvgpr_read_b32 v70, a134
  v_accvgpr_read_b32 v71, a135
  v_accvgpr_read_b32 v72, a136
  v_accvgpr_read_b32 v73, a137
  v_accvgpr_read_b32 v74, a138
  v_accvgpr_read_b32 v75, a139
  v_accvgpr_read_b32 v76, a140
  v_accvgpr_read_b32 v77, a141
  v_accvgpr_read_b32 v78, a142
  v_accvgpr_read_b32 v79, a143
  v_accvgpr_read_b32 v80, a144
  v_accvgpr_read_b32 v81, a145
  v_accvgpr_read_b32 v82, a146
  v_accvgpr_read_b32 v83, a147
  v_accvgpr_read_b32 v84, a148
  v_accvgpr_read_b32 v85, a149
  v_accvgpr_read_b32 v86, a150
  v_accvgpr_read_b32 v87, a151
  v_accvgpr_read_b32 v88, a152
  v_accvgpr_read_b32 v89, a153
  v_accvgpr_read_b32 v90, a154
  v_accvgpr_read_b32 v91, a155
  v_accvgpr_read_b32 v92, a156
  v_accvgpr_read_b32 v93, a157
  v_accvgpr_read_b32 v94, a158
  v_accvgpr_read_b32 v95, a159
  v_accvgpr_write_b32 a160, v64
  v_accvgpr_write_b32 a161, v65
  v_accvgpr_write_b32 a162, v66
  v_accvgpr_write_b32 a163, v67
  v_accvgpr_write_b32 a164, v68
  v_accvgpr_write_b32 a165, v69
  v_accvgpr_write_b32 a166, v70
  v_accvgpr_write_b32 a167, v71
  v_accvgpr_write_b32 a168, v72
  v_accvgpr_write_b32 a169, v73
  v_accvgpr_write_b32 a170, v74
  v_accvgpr_write_b32 a171, v75
  v_accvgpr_write_b32 a172, v76
  v_accvgpr_write_b32 a173, v77
  v_accvgpr_write_b32 a174, v78
  v_accvgpr_write_b32 a175, v79
  v_accvgpr_write_b32 a176, v80
  v_accvgpr_write_b32 a177, v81
  v_accvgpr_write_b32 a178, v82
  v_accvgpr_write_b32 a179, v83
  v_accvgpr_write_b32 a180, v84
  v_accvgpr_write_b32 a181, v85
  v_accvgpr_write_b32 a182, v86
  v_accvgpr_write_b32 a183, v87
  v_accvgpr_write_b32 a184, v88
  v_accvgpr_write_b32 a185, v89
  v_accvgpr_write_b32 a186, v90
  v_accvgpr_write_b32 a187, v91
  v_accvgpr_write_b32 a188, v92
  v_accvgpr_write_b32 a189, v93
  v_accvgpr_write_b32 a190, v94
  v_accvgpr_write_b32 a191, v95
  s_mov_b32 s6, s25
  s_branch La_sl_blk
La_done:
  s_lshr_b32 s4, s3, 1
  s_lshl_b32 s4, s4, 12
  s_add_u32 s4, s4, 131072
  s_lshl_b32 s5, s77, 11
  s_add_u32 s4, s4, s5
  v_add_u32 v16, s4, v2
  v_xor_b32 v17, 0x800, v16
  s_and_b32 s4, s3, 1
  s_lshl_b32 s4, s4, 13
  s_add_u32 s4, s4, 131072
  v_lshrrev_b32 v24, 2, v1
  v_and_b32 v25, 6, v24
  v_lshlrev_b32 v24, 7, v24
  v_and_b32 v26, 1, v1
  v_lshl_add_u32 v24, v26, 3, v24
  v_add_u32 v24, s4, v24
  v_bfe_u32 v26, v1, 1, 1
  v_xor_b32 v25, v25, v26
  v_xor_b32 v26, 0, v25
  v_lshl_add_u32 v18, v26, 4, v24
  v_xor_b32 v26, 2, v25
  v_lshl_add_u32 v19, v26, 4, v24
  v_xor_b32 v26, 4, v25
  v_lshl_add_u32 v20, v26, 4, v24
  v_xor_b32 v26, 6, v25
  v_lshl_add_u32 v21, v26, 4, v24
  s_mov_b32 s65, 0
  s_mov_b32 s67, 4294868992
  s_mov_b32 s68, 32768
  s_mov_b32 s65, 3
  s_waitcnt vmcnt(16)
  s_barrier
  ds_read_b128 a[64:67], v16 offset:0
  ds_read_b64_tr_b16 a[96:97], v18 offset:16384
  ds_read_b64_tr_b16 a[98:99], v18 offset:18432
  ds_read_b128 a[68:71], v16 offset:1024
  ds_read_b128 a[72:75], v17 offset:0
  ds_read_b128 a[76:79], v17 offset:1024
  ds_read_b64_tr_b16 a[100:101], v19 offset:16384
  ds_read_b64_tr_b16 a[102:103], v19 offset:18432
  ds_read_b64_tr_b16 a[104:105], v20 offset:16384
  ds_read_b64_tr_b16 a[106:107], v20 offset:18432
  ds_read_b64_tr_b16 a[108:109], v21 offset:16384
  ds_read_b64_tr_b16 a[110:111], v21 offset:18432
  s_waitcnt lgkmcnt(0)
  v_mfma_f32_16x16x32_bf16 v[32:35], a[96:99], a[64:67], 0
  s_add_u32 m0, s79, 81920
  ds_read_b128 a[80:83], v16 offset:8192
  ds_read_b64_tr_b16 a[112:113], v18 offset:20480
  v_mfma_f32_16x16x32_bf16 v[48:51], a[96:99], a[68:71], 0
  buffer_load_dwordx4 v10, s[12:15], s71 offen offset:0 lds
  ds_read_b64_tr_b16 a[114:115], v18 offset:22528
  v_mfma_f32_16x16x32_bf16 v[64:67], a[96:99], a[72:75], 0
  buffer_load_dwordx4 v11, s[12:15], s71 offen offset:1024 lds
  ds_read_b128 a[84:87], v16 offset:9216
  v_mfma_f32_16x16x32_bf16 v[80:83], a[96:99], a[76:79], 0
  buffer_load_dwordx4 v12, s[12:15], s71 offen offset:2048 lds
  ds_read_b128 a[88:91], v17 offset:8192
  v_mfma_f32_16x16x32_bf16 v[36:39], a[100:103], a[64:67], 0
  buffer_load_dwordx4 v13, s[12:15], s71 offen offset:3072 lds
  ds_read_b128 a[92:95], v17 offset:9216
  v_mfma_f32_16x16x32_bf16 v[52:55], a[100:103], a[68:71], 0
  s_bfe_u32 s72, 0x3020106, s31
  s_add_u32 s30, s30, s72
  s_add_u32 s31, s31, 8
  v_mfma_f32_16x16x32_bf16 v[68:71], a[100:103], a[72:75], 0
  s_and_b32 s31, s31, 0x8001f
  s_and_b32 s30, s30, 7
  s_lshl_b32 s72, s30, 17
  v_mfma_f32_16x16x32_bf16 v[84:87], a[100:103], a[76:79], 0
  s_add_u32 s71, s93, s72
  s_add_u32 m0, s79, 65536
  ds_read_b64_tr_b16 a[116:117], v19 offset:20480
  v_mfma_f32_16x16x32_bf16 v[40:43], a[104:107], a[64:67], 0
  buffer_load_dwordx4 v2, s[8:11], s70 offen offset:0 sc1 lds
  ds_read_b64_tr_b16 a[118:119], v19 offset:22528
  v_mfma_f32_16x16x32_bf16 v[56:59], a[104:107], a[68:71], 0
  buffer_load_dwordx4 v2, s[8:11], s70 offen offset:1024 sc1 lds
  ds_read_b64_tr_b16 a[120:121], v20 offset:20480
  v_mfma_f32_16x16x32_bf16 v[72:75], a[104:107], a[72:75], 0
  buffer_load_dwordx4 v2, s[8:11], s70 offen offset:2048 sc1 lds
  ds_read_b64_tr_b16 a[122:123], v20 offset:22528
  v_mfma_f32_16x16x32_bf16 v[88:91], a[104:107], a[76:79], 0
  buffer_load_dwordx4 v2, s[8:11], s70 offen offset:3072 sc1 lds
  ds_read_b64_tr_b16 a[124:125], v21 offset:20480
  v_mfma_f32_16x16x32_bf16 v[44:47], a[108:111], a[64:67], 0
  s_bfe_u32 s72, 0x3020106, s1
  s_add_u32 s0, s0, s72
  s_add_u32 s1, s1, 8
  v_mfma_f32_16x16x32_bf16 v[60:63], a[108:111], a[68:71], 0
  s_and_b32 s1, s1, 0x8001f
  s_and_b32 s0, s0, 7
  s_lshl_b32 s72, s0, 14
  v_mfma_f32_16x16x32_bf16 v[76:79], a[108:111], a[72:75], 0
  s_add_u32 s70, s92, s72
  s_add_u32 m0, s79, 114688
  ds_read_b64_tr_b16 a[126:127], v21 offset:22528
  v_mfma_f32_16x16x32_bf16 v[92:95], a[108:111], a[76:79], 0
  buffer_load_dwordx4 v10, s[12:15], s71 offen offset:0 lds
  buffer_load_dwordx4 v11, s[12:15], s71 offen offset:1024 lds
  buffer_load_dwordx4 v12, s[12:15], s71 offen offset:2048 lds
  buffer_load_dwordx4 v13, s[12:15], s71 offen offset:3072 lds
  s_bfe_u32 s72, 0x3020106, s31
  s_add_u32 s30, s30, s72
  s_add_u32 s31, s31, 8
  s_and_b32 s31, s31, 0x8001f
  s_and_b32 s30, s30, 7
  s_lshl_b32 s72, s30, 17
  s_add_u32 s71, s93, s72
  s_add_u32 m0, s79, 98304
  s_nop 0
  buffer_load_dwordx4 v2, s[8:11], s70 offen offset:0 sc1 lds
  buffer_load_dwordx4 v2, s[8:11], s70 offen offset:1024 sc1 lds
  buffer_load_dwordx4 v2, s[8:11], s70 offen offset:2048 sc1 lds
  buffer_load_dwordx4 v2, s[8:11], s70 offen offset:3072 sc1 lds
  s_bfe_u32 s72, 0x3020106, s1
  s_add_u32 s0, s0, s72
  s_add_u32 s1, s1, 8
  s_and_b32 s1, s1, 0x8001f
  s_and_b32 s0, s0, 7
  s_lshl_b32 s72, s0, 14
  s_add_u32 s70, s92, s72
  s_add_u32 s65, s65, 1
  s_cmp_eq_u32 s65, 4
  s_cselect_b32 s65, 0, s65
  s_cselect_b32 s66, s67, s68
  v_add_u32 v16, s66, v16
  v_add_u32 v17, s66, v17
  v_add_u32 v18, s66, v18
  v_add_u32 v19, s66, v19
  v_add_u32 v20, s66, v20
  v_add_u32 v21, s66, v21
  s_waitcnt vmcnt(16) lgkmcnt(0)
  s_barrier
  s_lshl_b32 s4, s24, 7
  s_lshl_b32 s5, s25, 12
  s_add_u32 s6, s4, 65536
  s_add_u32 s7, s6, 61440
  s_add_u32 s6, s6, s5
  s_sub_u32 s7, s7, s5
  v_mov_b32 v8, 0x40000000
  v_mov_b32 v6, s94
  v_cmp_eq_u32 vcc, 0, v0
  v_mov_b32 v7, s95
  s_nop 0
  v_cndmask_b32_e64 v8, v8, 0, vcc
  buffer_store_dwordx2 v[6:7], v8, s[96:99], s6 offen sc1
  buffer_store_dwordx2 v[6:7], v8, s[96:99], s7 offen sc1
  s_lshl_b32 s91, s73, 12
  s_add_u32 s91, s91, 65536
  v_and_b32 v14, 31, v1
  v_lshlrev_b32 v14, 7, v14
  s_add_u32 s16, s86, 100663296
  s_addc_u32 s17, s87, 0
  s_mov_b32 s18, 16777216
  s_mov_b32 s19, 0x00020000
  v_mfma_f32_16x16x32_bf16 v[32:35], a[112:115], a[80:83], v[32:35]
  s_add_u32 m0, s64, 16384
  ds_read_b128 a[64:67], v16 offset:0
  ds_read_b64_tr_b16 a[96:97], v18 offset:16384
  v_mfma_f32_16x16x32_bf16 v[48:51], a[112:115], a[84:87], v[48:51]
  buffer_load_dwordx4 v10, s[12:15], s71 offen offset:0 lds
  ds_read_b64_tr_b16 a[98:99], v18 offset:18432
  v_mfma_f32_16x16x32_bf16 v[64:67], a[112:115], a[88:91], v[64:67]
  ds_read_b128 a[68:71], v16 offset:1024
  ds_read_b128 a[72:75], v17 offset:0
  v_mfma_f32_16x16x32_bf16 v[80:83], a[112:115], a[92:95], v[80:83]
  buffer_load_dwordx4 v11, s[12:15], s71 offen offset:1024 lds
  ds_read_b128 a[76:79], v17 offset:1024
  v_mfma_f32_16x16x32_bf16 v[36:39], a[116:119], a[80:83], v[36:39]
  ds_read_b64_tr_b16 a[100:101], v19 offset:16384
  ds_read_b64_tr_b16 a[102:103], v19 offset:18432
  v_mfma_f32_16x16x32_bf16 v[52:55], a[116:119], a[84:87], v[52:55]
  ds_read_b64_tr_b16 a[104:105], v20 offset:16384
  ds_read_b64_tr_b16 a[106:107], v20 offset:18432
  v_mfma_f32_16x16x32_bf16 v[68:71], a[116:119], a[88:91], v[68:71]
  ds_read_b64_tr_b16 a[108:109], v21 offset:16384
  ds_read_b64_tr_b16 a[110:111], v21 offset:18432
  v_mfma_f32_16x16x32_bf16 v[84:87], a[116:119], a[92:95], v[84:87]
  buffer_load_dwordx4 v12, s[12:15], s71 offen offset:2048 lds
  v_mfma_f32_16x16x32_bf16 v[40:43], a[120:123], a[80:83], v[40:43]
  v_mfma_f32_16x16x32_bf16 v[56:59], a[120:123], a[84:87], v[56:59]
  v_mfma_f32_16x16x32_bf16 v[72:75], a[120:123], a[88:91], v[72:75]
  v_mfma_f32_16x16x32_bf16 v[88:91], a[120:123], a[92:95], v[88:91]
  buffer_load_dwordx4 v13, s[12:15], s71 offen offset:3072 lds
  v_mfma_f32_16x16x32_bf16 v[44:47], a[124:127], a[80:83], v[44:47]
  s_bfe_u32 s72, 0x3020106, s31
  s_add_u32 s30, s30, s72
  s_add_u32 s31, s31, 8
  v_mfma_f32_16x16x32_bf16 v[60:63], a[124:127], a[84:87], v[60:63]
  s_and_b32 s31, s31, 0x8001f
  s_and_b32 s30, s30, 7
  s_lshl_b32 s72, s30, 17
  v_mfma_f32_16x16x32_bf16 v[76:79], a[124:127], a[88:91], v[76:79]
  s_add_u32 s71, s93, s72
  v_mfma_f32_16x16x32_bf16 v[92:95], a[124:127], a[92:95], v[92:95]
  s_waitcnt lgkmcnt(0)
  v_mfma_f32_16x16x32_bf16 v[32:35], a[96:99], a[64:67], v[32:35]
  s_mov_b32 m0, s64
  ds_read_b128 a[80:83], v16 offset:8192
  ds_read_b64_tr_b16 a[112:113], v18 offset:20480
  v_mfma_f32_16x16x32_bf16 v[48:51], a[96:99], a[68:71], v[48:51]
  buffer_load_dwordx4 v2, s[8:11], s70 offen offset:0 sc1 lds
  ds_read_b64_tr_b16 a[114:115], v18 offset:22528
  v_mfma_f32_16x16x32_bf16 v[64:67], a[96:99], a[72:75], v[64:67]
  buffer_load_dwordx4 v2, s[8:11], s70 offen offset:1024 sc1 lds
  ds_read_b128 a[84:87], v16 offset:9216
  v_mfma_f32_16x16x32_bf16 v[80:83], a[96:99], a[76:79], v[80:83]
  ds_read_b128 a[88:91], v17 offset:8192
  ds_read_b128 a[92:95], v17 offset:9216
  v_mfma_f32_16x16x32_bf16 v[36:39], a[100:103], a[64:67], v[36:39]
  buffer_load_dwordx4 v2, s[8:11], s70 offen offset:2048 sc1 lds
  ds_read_b64_tr_b16 a[116:117], v19 offset:20480
  v_mfma_f32_16x16x32_bf16 v[52:55], a[100:103], a[68:71], v[52:55]
  ds_read_b64_tr_b16 a[118:119], v19 offset:22528
  ds_read_b64_tr_b16 a[120:121], v20 offset:20480
  v_mfma_f32_16x16x32_bf16 v[68:71], a[100:103], a[72:75], v[68:71]
  buffer_load_dwordx4 v2, s[8:11], s70 offen offset:3072 sc1 lds
  ds_read_b64_tr_b16 a[122:123], v20 offset:22528
  v_mfma_f32_16x16x32_bf16 v[84:87], a[100:103], a[76:79], v[84:87]
  s_bfe_u32 s72, 0x3020106, s1
  s_add_u32 s0, s0, s72
  s_add_u32 s1, s1, 8
  v_mfma_f32_16x16x32_bf16 v[40:43], a[104:107], a[64:67], v[40:43]
  s_and_b32 s1, s1, 0x8001f
  s_and_b32 s0, s0, 7
  s_lshl_b32 s72, s0, 14
  v_mfma_f32_16x16x32_bf16 v[56:59], a[104:107], a[68:71], v[56:59]
  s_add_u32 s70, s92, s72
  ds_read_b64_tr_b16 a[124:125], v21 offset:20480
  ds_read_b64_tr_b16 a[126:127], v21 offset:22528
  v_mfma_f32_16x16x32_bf16 v[72:75], a[104:107], a[72:75], v[72:75]
  s_add_u32 s64, s64, s66
  s_add_u32 s65, s65, 1
  s_cmp_eq_u32 s65, 4
  s_cselect_b32 s65, 0, s65
  s_cselect_b32 s66, s67, s68
  v_mfma_f32_16x16x32_bf16 v[88:91], a[104:107], a[76:79], v[88:91]
  v_add_u32 v16, s66, v16
  v_add_u32 v17, s66, v17
  v_mfma_f32_16x16x32_bf16 v[44:47], a[108:111], a[64:67], v[44:47]
  v_add_u32 v18, s66, v18
  v_add_u32 v19, s66, v19
  v_mfma_f32_16x16x32_bf16 v[60:63], a[108:111], a[68:71], v[60:63]
  v_add_u32 v20, s66, v20
  v_add_u32 v21, s66, v21
  v_mfma_f32_16x16x32_bf16 v[76:79], a[108:111], a[72:75], v[76:79]
  v_mfma_f32_16x16x32_bf16 v[92:95], a[108:111], a[76:79], v[92:95]
  s_waitcnt vmcnt(18) lgkmcnt(0)
  s_barrier
  v_mfma_f32_16x16x32_bf16 v[32:35], a[112:115], a[80:83], v[32:35]
  s_add_u32 m0, s64, 16384
  ds_read_b128 a[64:67], v16 offset:0
  ds_read_b64_tr_b16 a[96:97], v18 offset:16384
  v_mfma_f32_16x16x32_bf16 v[48:51], a[112:115], a[84:87], v[48:51]
  buffer_load_dwordx4 v10, s[12:15], s71 offen offset:0 lds
  ds_read_b64_tr_b16 a[98:99], v18 offset:18432
  v_mfma_f32_16x16x32_bf16 v[64:67], a[112:115], a[88:91], v[64:67]
  ds_read_b128 a[68:71], v16 offset:1024
  ds_read_b128 a[72:75], v17 offset:0
  v_mfma_f32_16x16x32_bf16 v[80:83], a[112:115], a[92:95], v[80:83]
  buffer_load_dwordx4 v11, s[12:15], s71 offen offset:1024 lds
  ds_read_b128 a[76:79], v17 offset:1024
  v_mfma_f32_16x16x32_bf16 v[36:39], a[116:119], a[80:83], v[36:39]
  ds_read_b64_tr_b16 a[100:101], v19 offset:16384
  ds_read_b64_tr_b16 a[102:103], v19 offset:18432
  v_mfma_f32_16x16x32_bf16 v[52:55], a[116:119], a[84:87], v[52:55]
  ds_read_b64_tr_b16 a[104:105], v20 offset:16384
  ds_read_b64_tr_b16 a[106:107], v20 offset:18432
  v_mfma_f32_16x16x32_bf16 v[68:71], a[116:119], a[88:91], v[68:71]
  ds_read_b64_tr_b16 a[108:109], v21 offset:16384
  ds_read_b64_tr_b16 a[110:111], v21 offset:18432
  v_mfma_f32_16x16x32_bf16 v[84:87], a[116:119], a[92:95], v[84:87]
  buffer_load_dwordx4 v12, s[12:15], s71 offen offset:2048 lds
  v_mfma_f32_16x16x32_bf16 v[40:43], a[120:123], a[80:83], v[40:43]
  v_mfma_f32_16x16x32_bf16 v[56:59], a[120:123], a[84:87], v[56:59]
  v_mfma_f32_16x16x32_bf16 v[72:75], a[120:123], a[88:91], v[72:75]
  v_mfma_f32_16x16x32_bf16 v[88:91], a[120:123], a[92:95], v[88:91]
  buffer_load_dwordx4 v13, s[12:15], s71 offen offset:3072 lds
  v_mfma_f32_16x16x32_bf16 v[44:47], a[124:127], a[80:83], v[44:47]
  s_bfe_u32 s72, 0x3020106, s31
  s_add_u32 s30, s30, s72
  s_add_u32 s31, s31, 8
  v_mfma_f32_16x16x32_bf16 v[60:63], a[124:127], a[84:87], v[60:63]
  s_and_b32 s31, s31, 0x8001f
  s_and_b32 s30, s30, 7
  s_lshl_b32 s72, s30, 17
  v_mfma_f32_16x16x32_bf16 v[76:79], a[124:127], a[88:91], v[76:79]
  s_add_u32 s71, s93, s72
  v_mfma_f32_16x16x32_bf16 v[92:95], a[124:127], a[92:95], v[92:95]
  s_waitcnt lgkmcnt(0)
  v_mfma_f32_16x16x32_bf16 v[32:35], a[96:99], a[64:67], v[32:35]
  s_mov_b32 m0, s64
  ds_read_b128 a[80:83], v16 offset:8192
  ds_read_b64_tr_b16 a[112:113], v18 offset:20480
  v_mfma_f32_16x16x32_bf16 v[48:51], a[96:99], a[68:71], v[48:51]
  buffer_load_dwordx4 v2, s[8:11], s70 offen offset:0 sc1 lds
  ds_read_b64_tr_b16 a[114:115], v18 offset:22528
  v_mfma_f32_16x16x32_bf16 v[64:67], a[96:99], a[72:75], v[64:67]
  buffer_load_dwordx4 v2, s[8:11], s70 offen offset:1024 sc1 lds
  ds_read_b128 a[84:87], v16 offset:9216
  v_mfma_f32_16x16x32_bf16 v[80:83], a[96:99], a[76:79], v[80:83]
  ds_read_b128 a[88:91], v17 offset:8192
  ds_read_b128 a[92:95], v17 offset:9216
  v_mfma_f32_16x16x32_bf16 v[36:39], a[100:103], a[64:67], v[36:39]
  buffer_load_dwordx4 v2, s[8:11], s70 offen offset:2048 sc1 lds
  ds_read_b64_tr_b16 a[116:117], v19 offset:20480
  v_mfma_f32_16x16x32_bf16 v[52:55], a[100:103], a[68:71], v[52:55]
  ds_read_b64_tr_b16 a[118:119], v19 offset:22528
  ds_read_b64_tr_b16 a[120:121], v20 offset:20480
  v_mfma_f32_16x16x32_bf16 v[68:71], a[100:103], a[72:75], v[68:71]
  buffer_load_dwordx4 v2, s[8:11], s70 offen offset:3072 sc1 lds
  ds_read_b64_tr_b16 a[122:123], v20 offset:22528
  v_mfma_f32_16x16x32_bf16 v[84:87], a[100:103], a[76:79], v[84:87]
  s_bfe_u32 s72, 0x3020106, s1
  s_add_u32 s0, s0, s72
  s_add_u32 s1, s1, 8
  v_mfma_f32_16x16x32_bf16 v[40:43], a[104:107], a[64:67], v[40:43]
  s_and_b32 s1, s1, 0x8001f
  s_and_b32 s0, s0, 7
  s_lshl_b32 s72, s0, 14
  v_mfma_f32_16x16x32_bf16 v[56:59], a[104:107], a[68:71], v[56:59]
  s_add_u32 s70, s92, s72
  ds_read_b64_tr_b16 a[124:125], v21 offset:20480
  ds_read_b64_tr_b16 a[126:127], v21 offset:22528
  v_mfma_f32_16x16x32_bf16 v[72:75], a[104:107], a[72:75], v[72:75]
  s_add_u32 s64, s64, s66
  s_add_u32 s65, s65, 1
  s_cmp_eq_u32 s65, 4
  s_cselect_b32 s65, 0, s65
  s_cselect_b32 s66, s67, s68
  v_mfma_f32_16x16x32_bf16 v[88:91], a[104:107], a[76:79], v[88:91]
  v_add_u32 v16, s66, v16
  v_add_u32 v17, s66, v17
  v_mfma_f32_16x16x32_bf16 v[44:47], a[108:111], a[64:67], v[44:47]
  v_add_u32 v18, s66, v18
  v_add_u32 v19, s66, v19
  v_mfma_f32_16x16x32_bf16 v[60:63], a[108:111], a[68:71], v[60:63]
  v_add_u32 v20, s66, v20
  v_add_u32 v21, s66, v21
  v_mfma_f32_16x16x32_bf16 v[76:79], a[108:111], a[72:75], v[76:79]
  v_mfma_f32_16x16x32_bf16 v[92:95], a[108:111], a[76:79], v[92:95]
  s_waitcnt vmcnt(18) lgkmcnt(0)
  s_barrier
  v_mfma_f32_16x16x32_bf16 v[32:35], a[112:115], a[80:83], v[32:35]
  s_add_u32 m0, s64, 16384
  ds_read_b128 a[64:67], v16 offset:0
  ds_read_b64_tr_b16 a[96:97], v18 offset:16384
  v_mfma_f32_16x16x32_bf16 v[48:51], a[112:115], a[84:87], v[48:51]
  buffer_load_dwordx4 v10, s[12:15], s71 offen offset:0 lds
  ds_read_b64_tr_b16 a[98:99], v18 offset:18432
  v_mfma_f32_16x16x32_bf16 v[64:67], a[112:115], a[88:91], v[64:67]
  ds_read_b128 a[68:71], v16 offset:1024
  ds_read_b128 a[72:75], v17 offset:0
  v_mfma_f32_16x16x32_bf16 v[80:83], a[112:115], a[92:95], v[80:83]
  buffer_load_dwordx4 v11, s[12:15], s71 offen offset:1024 lds
  ds_read_b128 a[76:79], v17 offset:1024
  v_mfma_f32_16x16x32_bf16 v[36:39], a[116:119], a[80:83], v[36:39]
  ds_read_b64_tr_b16 a[100:101], v19 offset:16384
  ds_read_b64_tr_b16 a[102:103], v19 offset:18432
  v_mfma_f32_16x16x32_bf16 v[52:55], a[116:119], a[84:87], v[52:55]
  ds_read_b64_tr_b16 a[104:105], v20 offset:16384
  ds_read_b64_tr_b16 a[106:107], v20 offset:18432
  v_mfma_f32_16x16x32_bf16 v[68:71], a[116:119], a[88:91], v[68:71]
  ds_read_b64_tr_b16 a[108:109], v21 offset:16384
  ds_read_b64_tr_b16 a[110:111], v21 offset:18432
  v_mfma_f32_16x16x32_bf16 v[84:87], a[116:119], a[92:95], v[84:87]
  buffer_load_dwordx4 v12, s[12:15], s71 offen offset:2048 lds
  v_mfma_f32_16x16x32_bf16 v[40:43], a[120:123], a[80:83], v[40:43]
  v_mfma_f32_16x16x32_bf16 v[56:59], a[120:123], a[84:87], v[56:59]
  v_mfma_f32_16x16x32_bf16 v[72:75], a[120:123], a[88:91], v[72:75]
  v_mfma_f32_16x16x32_bf16 v[88:91], a[120:123], a[92:95], v[88:91]
  buffer_load_dwordx4 v13, s[12:15], s71 offen offset:3072 lds
  v_mfma_f32_16x16x32_bf16 v[44:47], a[124:127], a[80:83], v[44:47]
  s_bfe_u32 s72, 0x3020106, s31
  s_add_u32 s30, s30, s72
  s_add_u32 s31, s31, 8
  v_mfma_f32_16x16x32_bf16 v[60:63], a[124:127], a[84:87], v[60:63]
  s_and_b32 s31, s31, 0x8001f
  s_and_b32 s30, s30, 7
  s_lshl_b32 s72, s30, 17
  v_mfma_f32_16x16x32_bf16 v[76:79], a[124:127], a[88:91], v[76:79]
  s_add_u32 s71, s93, s72
  v_mfma_f32_16x16x32_bf16 v[92:95], a[124:127], a[92:95], v[92:95]
  s_waitcnt lgkmcnt(0)
  v_mfma_f32_16x16x32_bf16 v[32:35], a[96:99], a[64:67], v[32:35]
  s_mov_b32 m0, s64
  ds_read_b128 a[80:83], v16 offset:8192
  ds_read_b64_tr_b16 a[112:113], v18 offset:20480
  v_mfma_f32_16x16x32_bf16 v[48:51], a[96:99], a[68:71], v[48:51]
  buffer_load_dwordx4 v2, s[8:11], s70 offen offset:0 sc1 lds
  ds_read_b64_tr_b16 a[114:115], v18 offset:22528
  v_mfma_f32_16x16x32_bf16 v[64:67], a[96:99], a[72:75], v[64:67]
  buffer_load_dwordx4 v2, s[8:11], s70 offen offset:1024 sc1 lds
  ds_read_b128 a[84:87], v16 offset:9216
  v_mfma_f32_16x16x32_bf16 v[80:83], a[96:99], a[76:79], v[80:83]
  ds_read_b128 a[88:91], v17 offset:8192
  ds_read_b128 a[92:95], v17 offset:9216
  v_mfma_f32_16x16x32_bf16 v[36:39], a[100:103], a[64:67], v[36:39]
  buffer_load_dwordx4 v2, s[8:11], s70 offen offset:2048 sc1 lds
  ds_read_b64_tr_b16 a[116:117], v19 offset:20480
  v_mfma_f32_16x16x32_bf16 v[52:55], a[100:103], a[68:71], v[52:55]
  ds_read_b64_tr_b16 a[118:119], v19 offset:22528
  ds_read_b64_tr_b16 a[120:121], v20 offset:20480
  v_mfma_f32_16x16x32_bf16 v[68:71], a[100:103], a[72:75], v[68:71]
  buffer_load_dwordx4 v2, s[8:11], s70 offen offset:3072 sc1 lds
  ds_read_b64_tr_b16 a[122:123], v20 offset:22528
  v_mfma_f32_16x16x32_bf16 v[84:87], a[100:103], a[76:79], v[84:87]
  s_bfe_u32 s72, 0x3020106, s1
  s_add_u32 s0, s0, s72
  s_add_u32 s1, s1, 8
  v_mfma_f32_16x16x32_bf16 v[40:43], a[104:107], a[64:67], v[40:43]
  s_and_b32 s1, s1, 0x8001f
  s_and_b32 s0, s0, 7
  s_lshl_b32 s72, s0, 14
  v_mfma_f32_16x16x32_bf16 v[56:59], a[104:107], a[68:71], v[56:59]
  s_add_u32 s70, s92, s72
  ds_read_b64_tr_b16 a[124:125], v21 offset:20480
  ds_read_b64_tr_b16 a[126:127], v21 offset:22528
  v_mfma_f32_16x16x32_bf16 v[72:75], a[104:107], a[72:75], v[72:75]
  s_add_u32 s64, s64, s66
  s_add_u32 s65, s65, 1
  s_cmp_eq_u32 s65, 4
  s_cselect_b32 s65, 0, s65
  s_cselect_b32 s66, s67, s68
  v_mfma_f32_16x16x32_bf16 v[88:91], a[104:107], a[76:79], v[88:91]
  v_add_u32 v16, s66, v16
  v_add_u32 v17, s66, v17
  v_mfma_f32_16x16x32_bf16 v[44:47], a[108:111], a[64:67], v[44:47]
  v_add_u32 v18, s66, v18
  v_add_u32 v19, s66, v19
  v_mfma_f32_16x16x32_bf16 v[60:63], a[108:111], a[68:71], v[60:63]
  v_add_u32 v20, s66, v20
  v_add_u32 v21, s66, v21
  v_mfma_f32_16x16x32_bf16 v[76:79], a[108:111], a[72:75], v[76:79]
  v_mfma_f32_16x16x32_bf16 v[92:95], a[108:111], a[76:79], v[92:95]
  s_waitcnt vmcnt(16) lgkmcnt(0)
  s_barrier
  v_mfma_f32_16x16x32_bf16 v[32:35], a[112:115], a[80:83], v[32:35]
  s_add_u32 m0, s64, 16384
  ds_read_b128 a[64:67], v16 offset:0
  ds_read_b64_tr_b16 a[96:97], v18 offset:16384
  v_mfma_f32_16x16x32_bf16 v[48:51], a[112:115], a[84:87], v[48:51]
  buffer_load_dwordx4 v10, s[12:15], s71 offen offset:0 lds
  ds_read_b64_tr_b16 a[98:99], v18 offset:18432
  v_mfma_f32_16x16x32_bf16 v[64:67], a[112:115], a[88:91], v[64:67]
  ds_read_b128 a[68:71], v16 offset:1024
  ds_read_b128 a[72:75], v17 offset:0
  v_mfma_f32_16x16x32_bf16 v[80:83], a[112:115], a[92:95], v[80:83]
  buffer_load_dwordx4 v11, s[12:15], s71 offen offset:1024 lds
  ds_read_b128 a[76:79], v17 offset:1024
  v_mfma_f32_16x16x32_bf16 v[36:39], a[116:119], a[80:83], v[36:39]
  ds_read_b64_tr_b16 a[100:101], v19 offset:16384
  ds_read_b64_tr_b16 a[102:103], v19 offset:18432
  v_mfma_f32_16x16x32_bf16 v[52:55], a[116:119], a[84:87], v[52:55]
  ds_read_b64_tr_b16 a[104:105], v20 offset:16384
  ds_read_b64_tr_b16 a[106:107], v20 offset:18432
  v_mfma_f32_16x16x32_bf16 v[68:71], a[116:119], a[88:91], v[68:71]
  ds_read_b64_tr_b16 a[108:109], v21 offset:16384
  ds_read_b64_tr_b16 a[110:111], v21 offset:18432
  v_mfma_f32_16x16x32_bf16 v[84:87], a[116:119], a[92:95], v[84:87]
  buffer_load_dwordx4 v12, s[12:15], s71 offen offset:2048 lds
  v_mfma_f32_16x16x32_bf16 v[40:43], a[120:123], a[80:83], v[40:43]
  v_mfma_f32_16x16x32_bf16 v[56:59], a[120:123], a[84:87], v[56:59]
  v_mfma_f32_16x16x32_bf16 v[72:75], a[120:123], a[88:91], v[72:75]
  v_mfma_f32_16x16x32_bf16 v[88:91], a[120:123], a[92:95], v[88:91]
  buffer_load_dwordx4 v13, s[12:15], s71 offen offset:3072 lds
  v_mfma_f32_16x16x32_bf16 v[44:47], a[124:127], a[80:83], v[44:47]
  s_bfe_u32 s72, 0x3020106, s31
  s_add_u32 s30, s30, s72
  s_add_u32 s31, s31, 8
  v_mfma_f32_16x16x32_bf16 v[60:63], a[124:127], a[84:87], v[60:63]
  s_and_b32 s31, s31, 0x8001f
  s_and_b32 s30, s30, 7
  s_lshl_b32 s72, s30, 17
  v_mfma_f32_16x16x32_bf16 v[76:79], a[124:127], a[88:91], v[76:79]
  s_add_u32 s71, s93, s72
  v_mfma_f32_16x16x32_bf16 v[92:95], a[124:127], a[92:95], v[92:95]
  s_waitcnt lgkmcnt(0)
  v_mfma_f32_16x16x32_bf16 v[32:35], a[96:99], a[64:67], v[32:35]
  s_mov_b32 m0, s64
  ds_read_b128 a[80:83], v16 offset:8192
  ds_read_b64_tr_b16 a[112:113], v18 offset:20480
  v_mfma_f32_16x16x32_bf16 v[48:51], a[96:99], a[68:71], v[48:51]
  buffer_load_dwordx4 v2, s[8:11], s70 offen offset:0 sc1 lds
  ds_read_b64_tr_b16 a[114:115], v18 offset:22528
  v_mfma_f32_16x16x32_bf16 v[64:67], a[96:99], a[72:75], v[64:67]
  buffer_load_dwordx4 v2, s[8:11], s70 offen offset:1024 sc1 lds
  ds_read_b128 a[84:87], v16 offset:9216
  v_mfma_f32_16x16x32_bf16 v[80:83], a[96:99], a[76:79], v[80:83]
  ds_read_b128 a[88:91], v17 offset:8192
  ds_read_b128 a[92:95], v17 offset:9216
  v_mfma_f32_16x16x32_bf16 v[36:39], a[100:103], a[64:67], v[36:39]
  buffer_load_dwordx4 v2, s[8:11], s70 offen offset:2048 sc1 lds
  ds_read_b64_tr_b16 a[116:117], v19 offset:20480
  v_mfma_f32_16x16x32_bf16 v[52:55], a[100:103], a[68:71], v[52:55]
  ds_read_b64_tr_b16 a[118:119], v19 offset:22528
  ds_read_b64_tr_b16 a[120:121], v20 offset:20480
  v_mfma_f32_16x16x32_bf16 v[68:71], a[100:103], a[72:75], v[68:71]
  buffer_load_dwordx4 v2, s[8:11], s70 offen offset:3072 sc1 lds
  ds_read_b64_tr_b16 a[122:123], v20 offset:22528
  v_mfma_f32_16x16x32_bf16 v[84:87], a[100:103], a[76:79], v[84:87]
  s_bfe_u32 s72, 0x3020106, s1
  s_add_u32 s0, s0, s72
  s_add_u32 s1, s1, 8
  v_mfma_f32_16x16x32_bf16 v[40:43], a[104:107], a[64:67], v[40:43]
  s_and_b32 s1, s1, 0x8001f
  s_and_b32 s0, s0, 7
  s_lshl_b32 s72, s0, 14
  v_mfma_f32_16x16x32_bf16 v[56:59], a[104:107], a[68:71], v[56:59]
  s_add_u32 s70, s92, s72
  ds_read_b64_tr_b16 a[124:125], v21 offset:20480
  ds_read_b64_tr_b16 a[126:127], v21 offset:22528
  v_mfma_f32_16x16x32_bf16 v[72:75], a[104:107], a[72:75], v[72:75]
  s_add_u32 s64, s64, s66
  s_add_u32 s65, s65, 1
  s_cmp_eq_u32 s65, 4
  s_cselect_b32 s65, 0, s65
  s_cselect_b32 s66, s67, s68
  v_mfma_f32_16x16x32_bf16 v[88:91], a[104:107], a[76:79], v[88:91]
  v_add_u32 v16, s66, v16
  v_add_u32 v17, s66, v17
  v_mfma_f32_16x16x32_bf16 v[44:47], a[108:111], a[64:67], v[44:47]
  v_add_u32 v18, s66, v18
  v_add_u32 v19, s66, v19
  v_mfma_f32_16x16x32_bf16 v[60:63], a[108:111], a[68:71], v[60:63]
  v_add_u32 v20, s66, v20
  v_add_u32 v21, s66, v21
  v_mfma_f32_16x16x32_bf16 v[76:79], a[108:111], a[72:75], v[76:79]
  v_mfma_f32_16x16x32_bf16 v[92:95], a[108:111], a[76:79], v[92:95]
  s_waitcnt vmcnt(16) lgkmcnt(0)
  s_barrier
  v_mfma_f32_16x16x32_bf16 v[32:35], a[112:115], a[80:83], v[32:35]
  s_mov_b32 s12, s74
  s_mov_b32 s13, s75
  s_mov_b32 s14, 8388608
  v_mfma_f32_16x16x32_bf16 v[48:51], a[112:115], a[84:87], v[48:51]
  s_mov_b32 s15, 0x00020000
  s_lshl_b32 s93, s77, 22
  s_lshl_b32 s72, s76, 8
  v_mfma_f32_16x16x32_bf16 v[64:67], a[112:115], a[88:91], v[64:67]
  s_add_u32 s93, s93, s72
  s_add_u32 s72, s73, s76
  s_and_b32 s31, s72, 3
  v_mfma_f32_16x16x32_bf16 v[80:83], a[112:115], a[92:95], v[80:83]
  s_lshl_b32 s31, s31, 3
  s_or_b32 s31, s31, 0x80000
  s_bfe_u32 s30, 0x1b1b02, s31
  v_mfma_f32_16x16x32_bf16 v[36:39], a[116:119], a[80:83], v[36:39]
  s_add_u32 s30, s30, 0
  s_cmp_ge_u32 s30, 28
  s_cselect_b32 s72, 28, 0
  v_mfma_f32_16x16x32_bf16 v[52:55], a[116:119], a[84:87], v[52:55]
  s_sub_u32 s30, s30, s72
  s_lshl_b32 s72, s30, 17
  s_add_u32 s71, s93, s72
  v_mfma_f32_16x16x32_bf16 v[68:71], a[116:119], a[88:91], v[68:71]
  s_add_u32 m0, s64, 16384
  ds_read_b128 a[64:67], v16 offset:0
  ds_read_b64_tr_b16 a[96:97], v18 offset:16384
  v_mfma_f32_16x16x32_bf16 v[84:87], a[116:119], a[92:95], v[84:87]
  buffer_load_dwordx4 v10, s[12:15], s71 offen offset:0 lds
  ds_read_b64_tr_b16 a[98:99], v18 offset:18432
  v_mfma_f32_16x16x32_bf16 v[40:43], a[120:123], a[80:83], v[40:43]
  buffer_load_dwordx4 v11, s[12:15], s71 offen offset:1024 lds
  ds_read_b128 a[68:71], v16 offset:1024
  v_mfma_f32_16x16x32_bf16 v[56:59], a[120:123], a[84:87], v[56:59]
  ds_read_b128 a[72:75], v17 offset:0
  ds_read_b128 a[76:79], v17 offset:1024
  v_mfma_f32_16x16x32_bf16 v[72:75], a[120:123], a[88:91], v[72:75]
  buffer_load_dwordx4 v12, s[12:15], s71 offen offset:2048 lds
  ds_read_b64_tr_b16 a[100:101], v19 offset:16384
  v_mfma_f32_16x16x32_bf16 v[88:91], a[120:123], a[92:95], v[88:91]
  ds_read_b64_tr_b16 a[102:103], v19 offset:18432
  ds_read_b64_tr_b16 a[104:105], v20 offset:16384
  v_mfma_f32_16x16x32_bf16 v[44:47], a[124:127], a[80:83], v[44:47]
  ds_read_b64_tr_b16 a[106:107], v20 offset:18432
  ds_read_b64_tr_b16 a[108:109], v21 offset:16384
  v_mfma_f32_16x16x32_bf16 v[60:63], a[124:127], a[84:87], v[60:63]
  ds_read_b64_tr_b16 a[110:111], v21 offset:18432
  v_mfma_f32_16x16x32_bf16 v[76:79], a[124:127], a[88:91], v[76:79]
  v_mfma_f32_16x16x32_bf16 v[92:95], a[124:127], a[92:95], v[92:95]
  s_waitcnt lgkmcnt(0)
  v_mfma_f32_16x16x32_bf16 v[32:35], a[96:99], a[64:67], v[32:35]
  buffer_load_dwordx4 v13, s[12:15], s71 offen offset:3072 lds
  ds_read_b128 a[80:83], v16 offset:8192
  v_mfma_f32_16x16x32_bf16 v[48:51], a[96:99], a[68:71], v[48:51]
  s_bfe_u32 s72, 0x302011a, s31
  s_add_u32 s30, s30, s72
  s_add_u32 s31, s31, 8
  v_mfma_f32_16x16x32_bf16 v[64:67], a[96:99], a[72:75], v[64:67]
  s_and_b32 s31, s31, 0x8001f
  s_cmp_ge_u32 s30, 28
  s_cselect_b32 s72, 28, 0
  v_mfma_f32_16x16x32_bf16 v[80:83], a[96:99], a[76:79], v[80:83]
  s_sub_u32 s30, s30, s72
  s_lshl_b32 s72, s30, 17
  s_add_u32 s71, s93, s72
  v_mfma_f32_16x16x32_bf16 v[36:39], a[100:103], a[64:67], v[36:39]
  buffer_load_dwordx2 v[6:7], v14, s[96:99], s91 offen sc1
  ds_read_b64_tr_b16 a[112:113], v18 offset:20480
  v_mfma_f32_16x16x32_bf16 v[52:55], a[100:103], a[68:71], v[52:55]
  s_add_u32 s64, s64, s66
  ds_read_b64_tr_b16 a[114:115], v18 offset:22528
  ds_read_b128 a[84:87], v16 offset:9216
  v_mfma_f32_16x16x32_bf16 v[68:71], a[100:103], a[72:75], v[68:71]
  s_add_u32 s65, s65, 1
  ds_read_b128 a[88:91], v17 offset:8192
  ds_read_b128 a[92:95], v17 offset:9216
  v_mfma_f32_16x16x32_bf16 v[84:87], a[100:103], a[76:79], v[84:87]
  s_cmp_eq_u32 s65, 4
  s_cselect_b32 s65, 0, s65
  s_cselect_b32 s66, s67, s68
  ds_read_b64_tr_b16 a[116:117], v19 offset:20480
  ds_read_b64_tr_b16 a[118:119], v19 offset:22528
  v_mfma_f32_16x16x32_bf16 v[40:43], a[104:107], a[64:67], v[40:43]
  ds_read_b64_tr_b16 a[120:121], v20 offset:20480
  ds_read_b64_tr_b16 a[122:123], v20 offset:22528
  v_mfma_f32_16x16x32_bf16 v[56:59], a[104:107], a[68:71], v[56:59]
  ds_read_b64_tr_b16 a[124:125], v21 offset:20480
  ds_read_b64_tr_b16 a[126:127], v21 offset:22528
  v_mfma_f32_16x16x32_bf16 v[72:75], a[104:107], a[72:75], v[72:75]
  v_add_u32 v16, s66, v16
  v_add_u32 v17, s66, v17
  v_mfma_f32_16x16x32_bf16 v[88:91], a[104:107], a[76:79], v[88:91]
  v_add_u32 v18, s66, v18
  v_add_u32 v19, s66, v19
  v_mfma_f32_16x16x32_bf16 v[44:47], a[108:111], a[64:67], v[44:47]
  v_add_u32 v20, s66, v20
  v_add_u32 v21, s66, v21
  v_mfma_f32_16x16x32_bf16 v[60:63], a[108:111], a[68:71], v[60:63]
  v_mfma_f32_16x16x32_bf16 v[76:79], a[108:111], a[72:75], v[76:79]
  v_mfma_f32_16x16x32_bf16 v[92:95], a[108:111], a[76:79], v[92:95]
  s_waitcnt vmcnt(0)
  v_cmp_ne_u64 vcc, s[94:95], v[6:7]
  s_nop 1
  v_cndmask_b32_e64 v8, 0, 1, vcc
  v_lshlrev_b32 v9, 2, v0
  ds_write_b32 v9, v8
  v_lshlrev_b32 v9, 4, v1
  s_waitcnt lgkmcnt(0)
  s_barrier
  ds_read_b128 v[160:163], v9
  s_waitcnt lgkmcnt(0)
  v_or3_b32 v160, v160, v161, v162
  v_or_b32 v160, v160, v163
  v_cmp_ne_u32 vcc, 0, v160
  s_nop 0
  s_cbranch_vccnz Lp6_late
  s_add_u32 s8, s86, 67108864
  s_addc_u32 s9, s87, 0
  s_mov_b32 s10, 16777216
  s_mov_b32 s11, 0x00020000
  s_lshl_b32 s92, s73, 1
  s_add_u32 s92, s92, s77
  s_lshl_b32 s92, s92, 19
  s_add_u32 s92, s92, s79
  s_add_u32 s72, s73, s76
  s_and_b32 s1, s72, 3
  s_lshl_b32 s1, s1, 3
  s_or_b32 s1, s1, 0x80000
  s_bfe_u32 s0, 0x1b1b02, s1
  s_add_u32 s0, s0, 0
  s_cmp_ge_u32 s0, 28
  s_cselect_b32 s72, 28, 0
  s_sub_u32 s0, s0, s72
  s_lshl_b32 s72, s0, 14
  s_add_u32 s70, s92, s72
  v_mfma_f32_16x16x32_bf16 v[32:35], a[112:115], a[80:83], v[32:35]
  s_add_u32 m0, s79, 131072
  ds_read_b128 a[64:67], v16 offset:0
  ds_read_b64_tr_b16 a[96:97], v18 offset:16384
  v_mfma_f32_16x16x32_bf16 v[48:51], a[112:115], a[84:87], v[48:51]
  buffer_load_dwordx4 v2, s[8:11], s70 offen offset:0 sc1 lds
  ds_read_b64_tr_b16 a[98:99], v18 offset:18432
  v_mfma_f32_16x16x32_bf16 v[64:67], a[112:115], a[88:91], v[64:67]
  buffer_load_dwordx4 v2, s[8:11], s70 offen offset:1024 sc1 lds
  ds_read_b128 a[68:71], v16 offset:1024
  v_mfma_f32_16x16x32_bf16 v[80:83], a[112:115], a[92:95], v[80:83]
  ds_read_b128 a[72:75], v17 offset:0
  ds_read_b128 a[76:79], v17 offset:1024
  v_mfma_f32_16x16x32_bf16 v[36:39], a[116:119], a[80:83], v[36:39]
  ds_read_b64_tr_b16 a[100:101], v19 offset:16384
  ds_read_b64_tr_b16 a[102:103], v19 offset:18432
  v_mfma_f32_16x16x32_bf16 v[52:55], a[116:119], a[84:87], v[52:55]
  buffer_load_dwordx4 v2, s[8:11], s70 offen offset:2048 sc1 lds
  ds_read_b64_tr_b16 a[104:105], v20 offset:16384
  v_mfma_f32_16x16x32_bf16 v[68:71], a[116:119], a[88:91], v[68:71]
  ds_read_b64_tr_b16 a[106:107], v20 offset:18432
  ds_read_b64_tr_b16 a[108:109], v21 offset:16384
  v_mfma_f32_16x16x32_bf16 v[84:87], a[116:119], a[92:95], v[84:87]
  buffer_load_dwordx4 v2, s[8:11], s70 offen offset:3072 sc1 lds
  ds_read_b64_tr_b16 a[110:111], v21 offset:18432
  v_mfma_f32_16x16x32_bf16 v[40:43], a[120:123], a[80:83], v[40:43]
  s_bfe_u32 s72, 0x302011a, s1
  s_add_u32 s0, s0, s72
  s_add_u32 s1, s1, 8
  v_mfma_f32_16x16x32_bf16 v[56:59], a[120:123], a[84:87], v[56:59]
  s_and_b32 s1, s1, 0x8001f
  s_cmp_ge_u32 s0, 28
  s_cselect_b32 s72, 28, 0
  v_mfma_f32_16x16x32_bf16 v[72:75], a[120:123], a[88:91], v[72:75]
  s_sub_u32 s0, s0, s72
  s_lshl_b32 s72, s0, 14
  s_add_u32 s70, s92, s72
  v_mfma_f32_16x16x32_bf16 v[88:91], a[120:123], a[92:95], v[88:91]
  s_add_u32 m0, s64, 16384
  v_mfma_f32_16x16x32_bf16 v[44:47], a[124:127], a[80:83], v[44:47]
  buffer_load_dwordx4 v10, s[12:15], s71 offen offset:0 lds
  v_mfma_f32_16x16x32_bf16 v[60:63], a[124:127], a[84:87], v[60:63]
  buffer_load_dwordx4 v11, s[12:15], s71 offen offset:1024 lds
  v_mfma_f32_16x16x32_bf16 v[76:79], a[124:127], a[88:91], v[76:79]
  v_mfma_f32_16x16x32_bf16 v[92:95], a[124:127], a[92:95], v[92:95]
  s_waitcnt lgkmcnt(0)
  v_mfma_f32_16x16x32_bf16 v[32:35], a[96:99], a[64:67], v[32:35]
  buffer_load_dwordx4 v12, s[12:15], s71 offen offset:2048 lds
  ds_read_b128 a[80:83], v16 offset:8192
  v_mfma_f32_16x16x32_bf16 v[48:51], a[96:99], a[68:71], v[48:51]
  buffer_load_dwordx4 v13, s[12:15], s71 offen offset:3072 lds
  ds_read_b64_tr_b16 a[112:113], v18 offset:20480
  v_mfma_f32_16x16x32_bf16 v[64:67], a[96:99], a[72:75], v[64:67]
  s_bfe_u32 s72, 0x302011a, s31
  s_add_u32 s30, s30, s72
  s_add_u32 s31, s31, 8
  v_mfma_f32_16x16x32_bf16 v[80:83], a[96:99], a[76:79], v[80:83]
  s_and_b32 s31, s31, 0x8001f
  s_cmp_ge_u32 s30, 28
  s_cselect_b32 s72, 28, 0
  v_mfma_f32_16x16x32_bf16 v[36:39], a[100:103], a[64:67], v[36:39]
  s_sub_u32 s30, s30, s72
  s_lshl_b32 s72, s30, 17
  s_add_u32 s71, s93, s72
  v_mfma_f32_16x16x32_bf16 v[52:55], a[100:103], a[68:71], v[52:55]
  s_mov_b32 m0, s64
  ds_read_b64_tr_b16 a[114:115], v18 offset:22528
  ds_read_b128 a[84:87], v16 offset:9216
  v_mfma_f32_16x16x32_bf16 v[68:71], a[100:103], a[72:75], v[68:71]
  buffer_load_dwordx4 v2, s[8:11], s70 offen offset:0 sc1 lds
  ds_read_b128 a[88:91], v17 offset:8192
  v_mfma_f32_16x16x32_bf16 v[84:87], a[100:103], a[76:79], v[84:87]
  buffer_load_dwordx4 v2, s[8:11], s70 offen offset:1024 sc1 lds
  ds_read_b128 a[92:95], v17 offset:9216
  v_mfma_f32_16x16x32_bf16 v[40:43], a[104:107], a[64:67], v[40:43]
  buffer_load_dwordx4 v2, s[8:11], s70 offen offset:2048 sc1 lds
  ds_read_b64_tr_b16 a[116:117], v19 offset:20480
  v_mfma_f32_16x16x32_bf16 v[56:59], a[104:107], a[68:71], v[56:59]
  buffer_load_dwordx4 v2, s[8:11], s70 offen offset:3072 sc1 lds
  ds_read_b64_tr_b16 a[118:119], v19 offset:22528
  v_mfma_f32_16x16x32_bf16 v[72:75], a[104:107], a[72:75], v[72:75]
  s_bfe_u32 s72, 0x302011a, s1
  s_add_u32 s0, s0, s72
  s_add_u32 s1, s1, 8
  v_mfma_f32_16x16x32_bf16 v[88:91], a[104:107], a[76:79], v[88:91]
  s_and_b32 s1, s1, 0x8001f
  s_cmp_ge_u32 s0, 28
  s_cselect_b32 s72, 28, 0
  v_mfma_f32_16x16x32_bf16 v[44:47], a[108:111], a[64:67], v[44:47]
  s_sub_u32 s0, s0, s72
  s_lshl_b32 s72, s0, 14
  s_add_u32 s70, s92, s72
  v_mfma_f32_16x16x32_bf16 v[60:63], a[108:111], a[68:71], v[60:63]
  s_add_u32 s64, s64, s66
  ds_read_b64_tr_b16 a[120:121], v20 offset:20480
  ds_read_b64_tr_b16 a[122:123], v20 offset:22528
  v_mfma_f32_16x16x32_bf16 v[76:79], a[108:111], a[72:75], v[76:79]
  s_add_u32 s65, s65, 1
  ds_read_b64_tr_b16 a[124:125], v21 offset:20480
  ds_read_b64_tr_b16 a[126:127], v21 offset:22528
  v_mfma_f32_16x16x32_bf16 v[92:95], a[108:111], a[76:79], v[92:95]
  s_cmp_eq_u32 s65, 4
  s_cselect_b32 s65, 0, s65
  s_cselect_b32 s66, s67, s68
  v_add_u32 v16, s66, v16
  v_add_u32 v17, s66, v17
  v_add_u32 v18, s66, v18
  v_add_u32 v19, s66, v19
  v_add_u32 v20, s66, v20
  v_add_u32 v21, s66, v21
  s_waitcnt vmcnt(12) lgkmcnt(0)
  s_barrier
  v_mfma_f32_16x16x32_bf16 v[32:35], a[112:115], a[80:83], v[32:35]
  s_add_u32 m0, s64, 16384
  ds_read_b128 a[64:67], v16 offset:0
  ds_read_b64_tr_b16 a[96:97], v18 offset:16384
  v_mfma_f32_16x16x32_bf16 v[48:51], a[112:115], a[84:87], v[48:51]
  buffer_load_dwordx4 v10, s[12:15], s71 offen offset:0 lds
  ds_read_b64_tr_b16 a[98:99], v18 offset:18432
  v_mfma_f32_16x16x32_bf16 v[64:67], a[112:115], a[88:91], v[64:67]
  ds_read_b128 a[68:71], v16 offset:1024
  ds_read_b128 a[72:75], v17 offset:0
  v_mfma_f32_16x16x32_bf16 v[80:83], a[112:115], a[92:95], v[80:83]
  buffer_load_dwordx4 v11, s[12:15], s71 offen offset:1024 lds
  ds_read_b128 a[76:79], v17 offset:1024
  v_mfma_f32_16x16x32_bf16 v[36:39], a[116:119], a[80:83], v[36:39]
  ds_read_b64_tr_b16 a[100:101], v19 offset:16384
  ds_read_b64_tr_b16 a[102:103], v19 offset:18432
  v_mfma_f32_16x16x32_bf16 v[52:55], a[116:119], a[84:87], v[52:55]
  ds_read_b64_tr_b16 a[104:105], v20 offset:16384
  ds_read_b64_tr_b16 a[106:107], v20 offset:18432
  v_mfma_f32_16x16x32_bf16 v[68:71], a[116:119], a[88:91], v[68:71]
  ds_read_b64_tr_b16 a[108:109], v21 offset:16384
  ds_read_b64_tr_b16 a[110:111], v21 offset:18432
  v_mfma_f32_16x16x32_bf16 v[84:87], a[116:119], a[92:95], v[84:87]
  buffer_load_dwordx4 v12, s[12:15], s71 offen offset:2048 lds
  v_mfma_f32_16x16x32_bf16 v[40:43], a[120:123], a[80:83], v[40:43]
  v_mfma_f32_16x16x32_bf16 v[56:59], a[120:123], a[84:87], v[56:59]
  v_mfma_f32_16x16x32_bf16 v[72:75], a[120:123], a[88:91], v[72:75]
  v_mfma_f32_16x16x32_bf16 v[88:91], a[120:123], a[92:95], v[88:91]
  buffer_load_dwordx4 v13, s[12:15], s71 offen offset:3072 lds
  v_mfma_f32_16x16x32_bf16 v[44:47], a[124:127], a[80:83], v[44:47]
  s_bfe_u32 s72, 0x302011a, s31
  s_add_u32 s30, s30, s72
  s_add_u32 s31, s31, 8
  v_mfma_f32_16x16x32_bf16 v[60:63], a[124:127], a[84:87], v[60:63]
  s_and_b32 s31, s31, 0x8001f
  s_cmp_ge_u32 s30, 28
  s_cselect_b32 s72, 28, 0
  v_mfma_f32_16x16x32_bf16 v[76:79], a[124:127], a[88:91], v[76:79]
  s_sub_u32 s30, s30, s72
  s_lshl_b32 s72, s30, 17
  s_add_u32 s71, s93, s72
  v_mfma_f32_16x16x32_bf16 v[92:95], a[124:127], a[92:95], v[92:95]
  s_waitcnt lgkmcnt(0)
  v_mfma_f32_16x16x32_bf16 v[32:35], a[96:99], a[64:67], v[32:35]
  s_mov_b32 m0, s64
  ds_read_b128 a[80:83], v16 offset:8192
  ds_read_b64_tr_b16 a[112:113], v18 offset:20480
  v_mfma_f32_16x16x32_bf16 v[48:51], a[96:99], a[68:71], v[48:51]
  buffer_load_dwordx4 v2, s[8:11], s70 offen offset:0 sc1 lds
  ds_read_b64_tr_b16 a[114:115], v18 offset:22528
  v_mfma_f32_16x16x32_bf16 v[64:67], a[96:99], a[72:75], v[64:67]
  buffer_load_dwordx4 v2, s[8:11], s70 offen offset:1024 sc1 lds
  ds_read_b128 a[84:87], v16 offset:9216
  v_mfma_f32_16x16x32_bf16 v[80:83], a[96:99], a[76:79], v[80:83]
  ds_read_b128 a[88:91], v17 offset:8192
  ds_read_b128 a[92:95], v17 offset:9216
  v_mfma_f32_16x16x32_bf16 v[36:39], a[100:103], a[64:67], v[36:39]
  buffer_load_dwordx4 v2, s[8:11], s70 offen offset:2048 sc1 lds
  ds_read_b64_tr_b16 a[116:117], v19 offset:20480
  v_mfma_f32_16x16x32_bf16 v[52:55], a[100:103], a[68:71], v[52:55]
  ds_read_b64_tr_b16 a[118:119], v19 offset:22528
  ds_read_b64_tr_b16 a[120:121], v20 offset:20480
  v_mfma_f32_16x16x32_bf16 v[68:71], a[100:103], a[72:75], v[68:71]
  buffer_load_dwordx4 v2, s[8:11], s70 offen offset:3072 sc1 lds
  ds_read_b64_tr_b16 a[122:123], v20 offset:22528
  v_mfma_f32_16x16x32_bf16 v[84:87], a[100:103], a[76:79], v[84:87]
  s_bfe_u32 s72, 0x302011a, s1
  s_add_u32 s0, s0, s72
  s_add_u32 s1, s1, 8
  v_mfma_f32_16x16x32_bf16 v[40:43], a[104:107], a[64:67], v[40:43]
  s_and_b32 s1, s1, 0x8001f
  s_cmp_ge_u32 s0, 28
  s_cselect_b32 s72, 28, 0
  v_mfma_f32_16x16x32_bf16 v[56:59], a[104:107], a[68:71], v[56:59]
  s_sub_u32 s0, s0, s72
  s_lshl_b32 s72, s0, 14
  s_add_u32 s70, s92, s72
  v_mfma_f32_16x16x32_bf16 v[72:75], a[104:107], a[72:75], v[72:75]
  s_add_u32 s64, s64, s66
  ds_read_b64_tr_b16 a[124:125], v21 offset:20480
  ds_read_b64_tr_b16 a[126:127], v21 offset:22528
  v_mfma_f32_16x16x32_bf16 v[88:91], a[104:107], a[76:79], v[88:91]
  s_add_u32 s65, s65, 1
  s_cmp_eq_u32 s65, 4
  s_cselect_b32 s65, 0, s65
  s_cselect_b32 s66, s67, s68
  v_mfma_f32_16x16x32_bf16 v[44:47], a[108:111], a[64:67], v[44:47]
  v_add_u32 v16, s66, v16
  v_add_u32 v17, s66, v17
  v_mfma_f32_16x16x32_bf16 v[60:63], a[108:111], a[68:71], v[60:63]
  v_add_u32 v18, s66, v18
  v_add_u32 v19, s66, v19
  v_mfma_f32_16x16x32_bf16 v[76:79], a[108:111], a[72:75], v[76:79]
  v_add_u32 v20, s66, v20
  v_add_u32 v21, s66, v21
  v_mfma_f32_16x16x32_bf16 v[92:95], a[108:111], a[76:79], v[92:95]
  s_waitcnt vmcnt(16) lgkmcnt(0)
  s_barrier
  v_mfma_f32_16x16x32_bf16 v[32:35], a[112:115], a[80:83], v[32:35]
  s_add_u32 m0, s64, 16384
  ds_read_b128 a[64:67], v16 offset:0
  ds_read_b64_tr_b16 a[96:97], v18 offset:16384
  v_mfma_f32_16x16x32_bf16 v[48:51], a[112:115], a[84:87], v[48:51]
  buffer_load_dwordx4 v10, s[12:15], s71 offen offset:0 lds
  ds_read_b64_tr_b16 a[98:99], v18 offset:18432
  v_mfma_f32_16x16x32_bf16 v[64:67], a[112:115], a[88:91], v[64:67]
  buffer_load_dwordx4 v11, s[12:15], s71 offen offset:1024 lds
  ds_read_b128 a[68:71], v16 offset:1024
  v_mfma_f32_16x16x32_bf16 v[80:83], a[112:115], a[92:95], v[80:83]
  buffer_load_dwordx4 v12, s[12:15], s71 offen offset:2048 lds
  ds_read_b128 a[72:75], v17 offset:0
  v_mfma_f32_16x16x32_bf16 v[36:39], a[116:119], a[80:83], v[36:39]
  ds_read_b128 a[76:79], v17 offset:1024
  ds_read_b64_tr_b16 a[100:101], v19 offset:16384
  v_mfma_f32_16x16x32_bf16 v[52:55], a[116:119], a[84:87], v[52:55]
  buffer_load_dwordx4 v13, s[12:15], s71 offen offset:3072 lds
  ds_read_b64_tr_b16 a[102:103], v19 offset:18432
  v_mfma_f32_16x16x32_bf16 v[68:71], a[116:119], a[88:91], v[68:71]
  s_bfe_u32 s72, 0x302011a, s31
  s_add_u32 s30, s30, s72
  s_add_u32 s31, s31, 8
  v_mfma_f32_16x16x32_bf16 v[84:87], a[116:119], a[92:95], v[84:87]
  s_and_b32 s31, s31, 0x8001f
  s_cmp_ge_u32 s30, 28
  s_cselect_b32 s72, 28, 0
  v_mfma_f32_16x16x32_bf16 v[40:43], a[120:123], a[80:83], v[40:43]
  s_sub_u32 s30, s30, s72
  s_lshl_b32 s72, s30, 17
  s_add_u32 s71, s93, s72
  v_mfma_f32_16x16x32_bf16 v[56:59], a[120:123], a[84:87], v[56:59]
  s_mov_b32 m0, s64
  ds_read_b64_tr_b16 a[104:105], v20 offset:16384
  ds_read_b64_tr_b16 a[106:107], v20 offset:18432
  v_mfma_f32_16x16x32_bf16 v[72:75], a[120:123], a[88:91], v[72:75]
  buffer_load_dwordx4 v2, s[8:11], s70 offen offset:0 sc1 lds
  ds_read_b64_tr_b16 a[108:109], v21 offset:16384
  v_mfma_f32_16x16x32_bf16 v[88:91], a[120:123], a[92:95], v[88:91]
  buffer_load_dwordx4 v2, s[8:11], s70 offen offset:1024 sc1 lds
  ds_read_b64_tr_b16 a[110:111], v21 offset:18432
  v_mfma_f32_16x16x32_bf16 v[44:47], a[124:127], a[80:83], v[44:47]
  buffer_load_dwordx4 v2, s[8:11], s70 offen offset:2048 sc1 lds
  v_mfma_f32_16x16x32_bf16 v[60:63], a[124:127], a[84:87], v[60:63]
  buffer_load_dwordx4 v2, s[8:11], s70 offen offset:3072 sc1 lds
  v_mfma_f32_16x16x32_bf16 v[76:79], a[124:127], a[88:91], v[76:79]
  s_bfe_u32 s72, 0x302011a, s1
  s_add_u32 s0, s0, s72
  s_add_u32 s1, s1, 8
  v_mfma_f32_16x16x32_bf16 v[92:95], a[124:127], a[92:95], v[92:95]
  s_and_b32 s1, s1, 0x8001f
  s_cmp_ge_u32 s0, 28
  s_cselect_b32 s72, 28, 0
  s_sub_u32 s0, s0, s72
  s_lshl_b32 s72, s0, 14
  s_add_u32 s70, s92, s72
  s_waitcnt lgkmcnt(0)
  s_lshl_b32 s6, s78, 1
  s_add_u32 s6, s6, s77
  s_xor_b32 s6, s6, 1
  s_lshl_b32 s6, s6, 2
  s_add_u32 s6, s6, s3
  s_lshl_b32 s6, s6, 13
  s_add_u32 s6, s6, 8388608
  s_add_u32 s7, s6, 4096
  v_mfma_f32_16x16x32_bf16 v[96:99], a[96:99], a[64:67], 0
  s_add_u32 s64, s64, s66
  ds_read_b128 a[80:83], v16 offset:8192
  ds_read_b64_tr_b16 a[112:113], v18 offset:20480
  v_mfma_f32_16x16x32_bf16 v[112:115], a[96:99], a[68:71], 0
  s_add_u32 s65, s65, 1
  ds_read_b64_tr_b16 a[114:115], v18 offset:22528
  ds_read_b128 a[84:87], v16 offset:9216
  v_mfma_f32_16x16x32_bf16 v[128:131], a[96:99], a[72:75], 0
  s_cmp_eq_u32 s65, 4
  s_cselect_b32 s65, 0, s65
  s_cselect_b32 s66, s67, s68
  ds_read_b128 a[88:91], v17 offset:8192
  ds_read_b128 a[92:95], v17 offset:9216
  v_mfma_f32_16x16x32_bf16 v[144:147], a[96:99], a[76:79], 0
  ds_read_b64_tr_b16 a[116:117], v19 offset:20480
  v_mfma_f32_16x16x32_bf16 v[100:103], a[100:103], a[64:67], 0
  ds_read_b64_tr_b16 a[118:119], v19 offset:22528
  ds_read_b64_tr_b16 a[120:121], v20 offset:20480
  v_mfma_f32_16x16x32_bf16 v[116:119], a[100:103], a[68:71], 0
  ds_read_b64_tr_b16 a[122:123], v20 offset:22528
  ds_read_b64_tr_b16 a[124:125], v21 offset:20480
  v_mfma_f32_16x16x32_bf16 v[132:135], a[100:103], a[72:75], 0
  buffer_store_dwordx4 v[64:67], v2, s[16:19], s6 offen offset:0 sc1
  ds_read_b64_tr_b16 a[126:127], v21 offset:22528
  v_mfma_f32_16x16x32_bf16 v[148:151], a[100:103], a[76:79], 0
  v_add_u32 v16, s66, v16
  v_add_u32 v17, s66, v17
  v_mfma_f32_16x16x32_bf16 v[104:107], a[104:107], a[64:67], 0
  v_add_u32 v18, s66, v18
  v_add_u32 v19, s66, v19
  v_mfma_f32_16x16x32_bf16 v[120:123], a[104:107], a[68:71], 0
  v_add_u32 v20, s66, v20
  v_add_u32 v21, s66, v21
  v_mfma_f32_16x16x32_bf16 v[136:139], a[104:107], a[72:75], 0
  buffer_store_dwordx4 v[68:71], v2, s[16:19], s6 offen offset:1024 sc1
  v_mfma_f32_16x16x32_bf16 v[152:155], a[104:107], a[76:79], 0
  buffer_store_dwordx4 v[72:75], v2, s[16:19], s6 offen offset:2048 sc1
  v_mfma_f32_16x16x32_bf16 v[108:111], a[108:111], a[64:67], 0
  buffer_store_dwordx4 v[76:79], v2, s[16:19], s6 offen offset:3072 sc1
  v_mfma_f32_16x16x32_bf16 v[124:127], a[108:111], a[68:71], 0
  buffer_store_dwordx4 v[80:83], v2, s[16:19], s7 offen offset:0 sc1
  v_mfma_f32_16x16x32_bf16 v[140:143], a[108:111], a[72:75], 0
  buffer_store_dwordx4 v[84:87], v2, s[16:19], s7 offen offset:1024 sc1
  v_mfma_f32_16x16x32_bf16 v[156:159], a[108:111], a[76:79], 0
  buffer_store_dwordx4 v[88:91], v2, s[16:19], s7 offen offset:2048 sc1
  buffer_store_dwordx4 v[92:95], v2, s[16:19], s7 offen offset:3072 sc1
  s_branch Lp7
Lp6_late:
  v_mfma_f32_16x16x32_bf16 v[32:35], a[112:115], a[80:83], v[32:35]
  s_add_u32 m0, s64, 16384
  ds_read_b128 a[64:67], v16 offset:0
  ds_read_b64_tr_b16 a[96:97], v18 offset:16384
  v_mfma_f32_16x16x32_bf16 v[48:51], a[112:115], a[84:87], v[48:51]
  buffer_load_dwordx4 v10, s[12:15], s71 offen offset:0 lds
  ds_read_b64_tr_b16 a[98:99], v18 offset:18432
  v_mfma_f32_16x16x32_bf16 v[64:67], a[112:115], a[88:91], v[64:67]
  ds_read_b128 a[68:71], v16 offset:1024
  ds_read_b128 a[72:75], v17 offset:0
  v_mfma_f32_16x16x32_bf16 v[80:83], a[112:115], a[92:95], v[80:83]
  ds_read_b128 a[76:79], v17 offset:1024
  ds_read_b64_tr_b16 a[100:101], v19 offset:16384
  v_mfma_f32_16x16x32_bf16 v[36:39], a[116:119], a[80:83], v[36:39]
  ds_read_b64_tr_b16 a[102:103], v19 offset:18432
  ds_read_b64_tr_b16 a[104:105], v20 offset:16384
  v_mfma_f32_16x16x32_bf16 v[52:55], a[116:119], a[84:87], v[52:55]
  ds_read_b64_tr_b16 a[106:107], v20 offset:18432
  ds_read_b64_tr_b16 a[108:109], v21 offset:16384
  v_mfma_f32_16x16x32_bf16 v[68:71], a[116:119], a[88:91], v[68:71]
  ds_read_b64_tr_b16 a[110:111], v21 offset:18432
  v_mfma_f32_16x16x32_bf16 v[84:87], a[116:119], a[92:95], v[84:87]
  buffer_load_dwordx4 v11, s[12:15], s71 offen offset:1024 lds
  v_mfma_f32_16x16x32_bf16 v[40:43], a[120:123], a[80:83], v[40:43]
  v_mfma_f32_16x16x32_bf16 v[56:59], a[120:123], a[84:87], v[56:59]
  v_mfma_f32_16x16x32_bf16 v[72:75], a[120:123], a[88:91], v[72:75]
  v_mfma_f32_16x16x32_bf16 v[88:91], a[120:123], a[92:95], v[88:91]
  v_mfma_f32_16x16x32_bf16 v[44:47], a[124:127], a[80:83], v[44:47]
  v_mfma_f32_16x16x32_bf16 v[60:63], a[124:127], a[84:87], v[60:63]
  v_mfma_f32_16x16x32_bf16 v[76:79], a[124:127], a[88:91], v[76:79]
  v_mfma_f32_16x16x32_bf16 v[92:95], a[124:127], a[92:95], v[92:95]
  s_waitcnt lgkmcnt(0)
  v_mfma_f32_16x16x32_bf16 v[32:35], a[96:99], a[64:67], v[32:35]
  buffer_load_dwordx4 v12, s[12:15], s71 offen offset:2048 lds
  ds_read_b128 a[80:83], v16 offset:8192
  v_mfma_f32_16x16x32_bf16 v[48:51], a[96:99], a[68:71], v[48:51]
  ds_read_b64_tr_b16 a[112:113], v18 offset:20480
  ds_read_b64_tr_b16 a[114:115], v18 offset:22528
  v_mfma_f32_16x16x32_bf16 v[64:67], a[96:99], a[72:75], v[64:67]
  ds_read_b128 a[84:87], v16 offset:9216
  ds_read_b128 a[88:91], v17 offset:8192
  v_mfma_f32_16x16x32_bf16 v[80:83], a[96:99], a[76:79], v[80:83]
  ds_read_b128 a[92:95], v17 offset:9216
  ds_read_b64_tr_b16 a[116:117], v19 offset:20480
  v_mfma_f32_16x16x32_bf16 v[36:39], a[100:103], a[64:67], v[36:39]
  buffer_load_dwordx4 v13, s[12:15], s71 offen offset:3072 lds
  ds_read_b64_tr_b16 a[118:119], v19 offset:22528
  v_mfma_f32_16x16x32_bf16 v[52:55], a[100:103], a[68:71], v[52:55]
  s_bfe_u32 s72, 0x302011a, s31
  s_add_u32 s30, s30, s72
  s_add_u32 s31, s31, 8
  v_mfma_f32_16x16x32_bf16 v[68:71], a[100:103], a[72:75], v[68:71]
  s_and_b32 s31, s31, 0x8001f
  s_cmp_ge_u32 s30, 28
  s_cselect_b32 s72, 28, 0
  v_mfma_f32_16x16x32_bf16 v[84:87], a[100:103], a[76:79], v[84:87]
  s_sub_u32 s30, s30, s72
  s_lshl_b32 s72, s30, 17
  s_add_u32 s71, s93, s72
  v_mfma_f32_16x16x32_bf16 v[40:43], a[104:107], a[64:67], v[40:43]
  s_add_u32 s64, s64, s66
  ds_read_b64_tr_b16 a[120:121], v20 offset:20480
  ds_read_b64_tr_b16 a[122:123], v20 offset:22528
  v_mfma_f32_16x16x32_bf16 v[56:59], a[104:107], a[68:71], v[56:59]
  s_add_u32 s65, s65, 1
  ds_read_b64_tr_b16 a[124:125], v21 offset:20480
  ds_read_b64_tr_b16 a[126:127], v21 offset:22528
  v_mfma_f32_16x16x32_bf16 v[72:75], a[104:107], a[72:75], v[72:75]
  s_cmp_eq_u32 s65, 4
  s_cselect_b32 s65, 0, s65
  s_cselect_b32 s66, s67, s68
  v_mfma_f32_16x16x32_bf16 v[88:91], a[104:107], a[76:79], v[88:91]
  v_add_u32 v16, s66, v16
  v_add_u32 v17, s66, v17
  v_mfma_f32_16x16x32_bf16 v[44:47], a[108:111], a[64:67], v[44:47]
  v_add_u32 v18, s66, v18
  v_add_u32 v19, s66, v19
  v_mfma_f32_16x16x32_bf16 v[60:63], a[108:111], a[68:71], v[60:63]
  v_add_u32 v20, s66, v20
  v_add_u32 v21, s66, v21
  v_mfma_f32_16x16x32_bf16 v[76:79], a[108:111], a[72:75], v[76:79]
  v_mfma_f32_16x16x32_bf16 v[92:95], a[108:111], a[76:79], v[92:95]
  s_waitcnt vmcnt(4) lgkmcnt(0)
  s_barrier
  v_mfma_f32_16x16x32_bf16 v[32:35], a[112:115], a[80:83], v[32:35]
  s_add_u32 m0, s64, 16384
  ds_read_b128 a[64:67], v16 offset:0
  ds_read_b64_tr_b16 a[96:97], v18 offset:16384
  v_mfma_f32_16x16x32_bf16 v[48:51], a[112:115], a[84:87], v[48:51]
  buffer_load_dwordx4 v10, s[12:15], s71 offen offset:0 lds
  ds_read_b64_tr_b16 a[98:99], v18 offset:18432
  v_mfma_f32_16x16x32_bf16 v[64:67], a[112:115], a[88:91], v[64:67]
  ds_read_b128 a[68:71], v16 offset:1024
  ds_read_b128 a[72:75], v17 offset:0
  v_mfma_f32_16x16x32_bf16 v[80:83], a[112:115], a[92:95], v[80:83]
  ds_read_b128 a[76:79], v17 offset:1024
  ds_read_b64_tr_b16 a[100:101], v19 offset:16384
  v_mfma_f32_16x16x32_bf16 v[36:39], a[116:119], a[80:83], v[36:39]
  ds_read_b64_tr_b16 a[102:103], v19 offset:18432
  ds_read_b64_tr_b16 a[104:105], v20 offset:16384
  v_mfma_f32_16x16x32_bf16 v[52:55], a[116:119], a[84:87], v[52:55]
  buffer_load_dwordx4 v11, s[12:15], s71 offen offset:1024 lds
  ds_read_b64_tr_b16 a[106:107], v20 offset:18432
  v_mfma_f32_16x16x32_bf16 v[68:71], a[116:119], a[88:91], v[68:71]
  ds_read_b64_tr_b16 a[108:109], v21 offset:16384
  ds_read_b64_tr_b16 a[110:111], v21 offset:18432
  v_mfma_f32_16x16x32_bf16 v[84:87], a[116:119], a[92:95], v[84:87]
  v_mfma_f32_16x16x32_bf16 v[40:43], a[120:123], a[80:83], v[40:43]
  v_mfma_f32_16x16x32_bf16 v[56:59], a[120:123], a[84:87], v[56:59]
  v_mfma_f32_16x16x32_bf16 v[72:75], a[120:123], a[88:91], v[72:75]
  buffer_load_dwordx4 v12, s[12:15], s71 offen offset:2048 lds
  v_mfma_f32_16x16x32_bf16 v[88:91], a[120:123], a[92:95], v[88:91]
  v_mfma_f32_16x16x32_bf16 v[44:47], a[124:127], a[80:83], v[44:47]
  v_mfma_f32_16x16x32_bf16 v[60:63], a[124:127], a[84:87], v[60:63]
  v_mfma_f32_16x16x32_bf16 v[76:79], a[124:127], a[88:91], v[76:79]
  v_mfma_f32_16x16x32_bf16 v[92:95], a[124:127], a[92:95], v[92:95]
  s_waitcnt lgkmcnt(0)
  v_mfma_f32_16x16x32_bf16 v[32:35], a[96:99], a[64:67], v[32:35]
  buffer_load_dwordx4 v13, s[12:15], s71 offen offset:3072 lds
  ds_read_b128 a[80:83], v16 offset:8192
  v_mfma_f32_16x16x32_bf16 v[48:51], a[96:99], a[68:71], v[48:51]
  s_bfe_u32 s72, 0x302011a, s31
  s_add_u32 s30, s30, s72
  s_add_u32 s31, s31, 8
  v_mfma_f32_16x16x32_bf16 v[64:67], a[96:99], a[72:75], v[64:67]
  s_and_b32 s31, s31, 0x8001f
  s_cmp_ge_u32 s30, 28
  s_cselect_b32 s72, 28, 0
  v_mfma_f32_16x16x32_bf16 v[80:83], a[96:99], a[76:79], v[80:83]
  s_sub_u32 s30, s30, s72
  s_lshl_b32 s72, s30, 17
  s_add_u32 s71, s93, s72
  v_mfma_f32_16x16x32_bf16 v[36:39], a[100:103], a[64:67], v[36:39]
  buffer_load_dwordx2 v[6:7], v14, s[96:99], s91 offen sc1
  ds_read_b64_tr_b16 a[112:113], v18 offset:20480
  v_mfma_f32_16x16x32_bf16 v[52:55], a[100:103], a[68:71], v[52:55]
  s_add_u32 s64, s64, s66
  ds_read_b64_tr_b16 a[114:115], v18 offset:22528
  ds_read_b128 a[84:87], v16 offset:9216
  v_mfma_f32_16x16x32_bf16 v[68:71], a[100:103], a[72:75], v[68:71]
  s_add_u32 s65, s65, 1
  ds_read_b128 a[88:91], v17 offset:8192
  ds_read_b128 a[92:95], v17 offset:9216
  v_mfma_f32_16x16x32_bf16 v[84:87], a[100:103], a[76:79], v[84:87]
  s_cmp_eq_u32 s65, 4
  s_cselect_b32 s65, 0, s65
  s_cselect_b32 s66, s67, s68
  ds_read_b64_tr_b16 a[116:117], v19 offset:20480
  ds_read_b64_tr_b16 a[118:119], v19 offset:22528
  v_mfma_f32_16x16x32_bf16 v[40:43], a[104:107], a[64:67], v[40:43]
  ds_read_b64_tr_b16 a[120:121], v20 offset:20480
  ds_read_b64_tr_b16 a[122:123], v20 offset:22528
  v_mfma_f32_16x16x32_bf16 v[56:59], a[104:107], a[68:71], v[56:59]
  ds_read_b64_tr_b16 a[124:125], v21 offset:20480
  ds_read_b64_tr_b16 a[126:127], v21 offset:22528
  v_mfma_f32_16x16x32_bf16 v[72:75], a[104:107], a[72:75], v[72:75]
  v_add_u32 v16, s66, v16
  v_add_u32 v17, s66, v17
  v_mfma_f32_16x16x32_bf16 v[88:91], a[104:107], a[76:79], v[88:91]
  v_add_u32 v18, s66, v18
  v_add_u32 v19, s66, v19
  v_mfma_f32_16x16x32_bf16 v[44:47], a[108:111], a[64:67], v[44:47]
  v_add_u32 v20, s66, v20
  v_add_u32 v21, s66, v21
  v_mfma_f32_16x16x32_bf16 v[60:63], a[108:111], a[68:71], v[60:63]
  v_mfma_f32_16x16x32_bf16 v[76:79], a[108:111], a[72:75], v[76:79]
  v_mfma_f32_16x16x32_bf16 v[92:95], a[108:111], a[76:79], v[92:95]
  s_waitcnt vmcnt(0) lgkmcnt(0)
  s_barrier
  s_mov_b32 s5, 0x40000
Lpoll_9:
  v_cmp_ne_u64 vcc, s[94:95], v[6:7]
  s_nop 0
  s_cbranch_vccz Lpolld_10
  s_sleep 4
  buffer_load_dwordx2 v[6:7], v14, s[96:99], s91 offen sc1
  s_sub_u32 s5, s5, 1
  s_waitcnt vmcnt(0)
  s_cbranch_scc0 Lpoll_9
Lpolld_10:
  s_add_u32 s8, s86, 67108864
  s_addc_u32 s9, s87, 0
  s_mov_b32 s10, 16777216
  s_mov_b32 s11, 0x00020000
  s_lshl_b32 s92, s73, 1
  s_add_u32 s92, s92, s77
  s_lshl_b32 s92, s92, 19
  s_add_u32 s92, s92, s79
  s_add_u32 s72, s73, s76
  s_and_b32 s1, s72, 3
  s_lshl_b32 s1, s1, 3
  s_or_b32 s1, s1, 0x80000
  s_bfe_u32 s0, 0x1b1b02, s1
  s_add_u32 s0, s0, 0
  s_cmp_ge_u32 s0, 28
  s_cselect_b32 s72, 28, 0
  s_sub_u32 s0, s0, s72
  s_lshl_b32 s72, s0, 14
  s_add_u32 s70, s92, s72
  v_mfma_f32_16x16x32_bf16 v[32:35], a[112:115], a[80:83], v[32:35]
  s_add_u32 m0, s79, 131072
  v_mfma_f32_16x16x32_bf16 v[48:51], a[112:115], a[84:87], v[48:51]
  buffer_load_dwordx4 v2, s[8:11], s70 offen offset:0 sc1 lds
  v_mfma_f32_16x16x32_bf16 v[64:67], a[112:115], a[88:91], v[64:67]
  buffer_load_dwordx4 v2, s[8:11], s70 offen offset:1024 sc1 lds
  v_mfma_f32_16x16x32_bf16 v[80:83], a[112:115], a[92:95], v[80:83]
  buffer_load_dwordx4 v2, s[8:11], s70 offen offset:2048 sc1 lds
  v_mfma_f32_16x16x32_bf16 v[36:39], a[116:119], a[80:83], v[36:39]
  buffer_load_dwordx4 v2, s[8:11], s70 offen offset:3072 sc1 lds
  v_mfma_f32_16x16x32_bf16 v[52:55], a[116:119], a[84:87], v[52:55]
  s_bfe_u32 s72, 0x302011a, s1
  s_add_u32 s0, s0, s72
  s_add_u32 s1, s1, 8
  v_mfma_f32_16x16x32_bf16 v[68:71], a[116:119], a[88:91], v[68:71]
  s_and_b32 s1, s1, 0x8001f
  s_cmp_ge_u32 s0, 28
  s_cselect_b32 s72, 28, 0
  v_mfma_f32_16x16x32_bf16 v[84:87], a[116:119], a[92:95], v[84:87]
  s_sub_u32 s0, s0, s72
  s_lshl_b32 s72, s0, 14
  s_add_u32 s70, s92, s72
  v_mfma_f32_16x16x32_bf16 v[40:43], a[120:123], a[80:83], v[40:43]
  s_add_u32 m0, s79, 32768
  v_mfma_f32_16x16x32_bf16 v[56:59], a[120:123], a[84:87], v[56:59]
  buffer_load_dwordx4 v2, s[8:11], s70 offen offset:0 sc1 lds
  v_mfma_f32_16x16x32_bf16 v[72:75], a[120:123], a[88:91], v[72:75]
  buffer_load_dwordx4 v2, s[8:11], s70 offen offset:1024 sc1 lds
  v_mfma_f32_16x16x32_bf16 v[88:91], a[120:123], a[92:95], v[88:91]
  buffer_load_dwordx4 v2, s[8:11], s70 offen offset:2048 sc1 lds
  v_mfma_f32_16x16x32_bf16 v[44:47], a[124:127], a[80:83], v[44:47]
  buffer_load_dwordx4 v2, s[8:11], s70 offen offset:3072 sc1 lds
  v_mfma_f32_16x16x32_bf16 v[60:63], a[124:127], a[84:87], v[60:63]
  s_bfe_u32 s72, 0x302011a, s1
  s_add_u32 s0, s0, s72
  s_add_u32 s1, s1, 8
  v_mfma_f32_16x16x32_bf16 v[76:79], a[124:127], a[88:91], v[76:79]
  s_and_b32 s1, s1, 0x8001f
  s_cmp_ge_u32 s0, 28
  s_cselect_b32 s72, 28, 0
  v_mfma_f32_16x16x32_bf16 v[92:95], a[124:127], a[92:95], v[92:95]
  s_sub_u32 s0, s0, s72
  s_lshl_b32 s72, s0, 14
  s_add_u32 s70, s92, s72
  s_add_u32 m0, s79, 65536
  s_nop 0
  buffer_load_dwordx4 v2, s[8:11], s70 offen offset:0 sc1 lds
  buffer_load_dwordx4 v2, s[8:11], s70 offen offset:1024 sc1 lds
  buffer_load_dwordx4 v2, s[8:11], s70 offen offset:2048 sc1 lds
  buffer_load_dwordx4 v2, s[8:11], s70 offen offset:3072 sc1 lds
  s_bfe_u32 s72, 0x302011a, s1
  s_add_u32 s0, s0, s72
  s_add_u32 s1, s1, 8
  s_and_b32 s1, s1, 0x8001f
  s_cmp_ge_u32 s0, 28
  s_cselect_b32 s72, 28, 0
  s_sub_u32 s0, s0, s72
  s_lshl_b32 s72, s0, 14
  s_add_u32 s70, s92, s72
  s_add_u32 m0, s79, 114688
  s_nop 0
  buffer_load_dwordx4 v10, s[12:15], s71 offen offset:0 lds
  buffer_load_dwordx4 v11, s[12:15], s71 offen offset:1024 lds
  buffer_load_dwordx4 v12, s[12:15], s71 offen offset:2048 lds
  buffer_load_dwordx4 v13, s[12:15], s71 offen offset:3072 lds
  s_bfe_u32 s72, 0x302011a, s31
  s_add_u32 s30, s30, s72
  s_add_u32 s31, s31, 8
  s_and_b32 s31, s31, 0x8001f
  s_cmp_ge_u32 s30, 28
  s_cselect_b32 s72, 28, 0
  s_sub_u32 s30, s30, s72
  s_lshl_b32 s72, s30, 17
  s_add_u32 s71, s93, s72
  s_add_u32 m0, s79, 98304
  s_nop 0
  buffer_load_dwordx4 v2, s[8:11], s70 offen offset:0 sc1 lds
  buffer_load_dwordx4 v2, s[8:11], s70 offen offset:1024 sc1 lds
  buffer_load_dwordx4 v2, s[8:11], s70 offen offset:2048 sc1 lds
  buffer_load_dwordx4 v2, s[8:11], s70 offen offset:3072 sc1 lds
  s_bfe_u32 s72, 0x302011a, s1
  s_add_u32 s0, s0, s72
  s_add_u32 s1, s1, 8
  s_and_b32 s1, s1, 0x8001f
  s_cmp_ge_u32 s0, 28
  s_cselect_b32 s72, 28, 0
  s_sub_u32 s0, s0, s72
  s_lshl_b32 s72, s0, 14
  s_add_u32 s70, s92, s72
  s_lshl_b32 s6, s78, 1
  s_add_u32 s6, s6, s77
  s_xor_b32 s6, s6, 1
  s_lshl_b32 s6, s6, 2
  s_add_u32 s6, s6, s3
  s_lshl_b32 s6, s6, 13
  s_add_u32 s6, s6, 8388608
  s_add_u32 s7, s6, 4096
  buffer_store_dwordx4 v[64:67], v2, s[16:19], s6 offen offset:0 sc1
  buffer_store_dwordx4 v[68:71], v2, s[16:19], s6 offen offset:1024 sc1
  buffer_store_dwordx4 v[72:75], v2, s[16:19], s6 offen offset:2048 sc1
  buffer_store_dwordx4 v[76:79], v2, s[16:19], s6 offen offset:3072 sc1
  buffer_store_dwordx4 v[80:83], v2, s[16:19], s7 offen offset:0 sc1
  buffer_store_dwordx4 v[84:87], v2, s[16:19], s7 offen offset:1024 sc1
  buffer_store_dwordx4 v[88:91], v2, s[16:19], s7 offen offset:2048 sc1
  buffer_store_dwordx4 v[92:95], v2, s[16:19], s7 offen offset:3072 sc1
  s_waitcnt vmcnt(24)
  s_barrier
  ds_read_b128 a[64:67], v16 offset:0
  ds_read_b64_tr_b16 a[96:97], v18 offset:16384
  ds_read_b64_tr_b16 a[98:99], v18 offset:18432
  ds_read_b128 a[68:71], v16 offset:1024
  ds_read_b128 a[72:75], v17 offset:0
  ds_read_b128 a[76:79], v17 offset:1024
  ds_read_b64_tr_b16 a[100:101], v19 offset:16384
  ds_read_b64_tr_b16 a[102:103], v19 offset:18432
  ds_read_b64_tr_b16 a[104:105], v20 offset:16384
  ds_read_b64_tr_b16 a[106:107], v20 offset:18432
  ds_read_b64_tr_b16 a[108:109], v21 offset:16384
  ds_read_b64_tr_b16 a[110:111], v21 offset:18432
  s_waitcnt lgkmcnt(0)
  v_mfma_f32_16x16x32_bf16 v[96:99], a[96:99], a[64:67], 0
  s_add_u32 s64, s64, s66
  ds_read_b128 a[80:83], v16 offset:8192
  ds_read_b64_tr_b16 a[112:113], v18 offset:20480
  v_mfma_f32_16x16x32_bf16 v[112:115], a[96:99], a[68:71], 0
  s_add_u32 s65, s65, 1
  ds_read_b64_tr_b16 a[114:115], v18 offset:22528
  ds_read_b128 a[84:87], v16 offset:9216
  v_mfma_f32_16x16x32_bf16 v[128:131], a[96:99], a[72:75], 0
  s_cmp_eq_u32 s65, 4
  s_cselect_b32 s65, 0, s65
  s_cselect_b32 s66, s67, s68
  ds_read_b128 a[88:91], v17 offset:8192
  ds_read_b128 a[92:95], v17 offset:9216
  v_mfma_f32_16x16x32_bf16 v[144:147], a[96:99], a[76:79], 0
  ds_read_b64_tr_b16 a[116:117], v19 offset:20480
  v_mfma_f32_16x16x32_bf16 v[100:103], a[100:103], a[64:67], 0
  ds_read_b64_tr_b16 a[118:119], v19 offset:22528
  ds_read_b64_tr_b16 a[120:121], v20 offset:20480
  v_mfma_f32_16x16x32_bf16 v[116:119], a[100:103], a[68:71], 0
  ds_read_b64_tr_b16 a[122:123], v20 offset:22528
  ds_read_b64_tr_b16 a[124:125], v21 offset:20480
  v_mfma_f32_16x16x32_bf16 v[132:135], a[100:103], a[72:75], 0
  ds_read_b64_tr_b16 a[126:127], v21 offset:22528
  v_mfma_f32_16x16x32_bf16 v[148:151], a[100:103], a[76:79], 0
  v_add_u32 v16, s66, v16
  v_add_u32 v17, s66, v17
  v_mfma_f32_16x16x32_bf16 v[104:107], a[104:107], a[64:67], 0
  v_add_u32 v18, s66, v18
  v_add_u32 v19, s66, v19
  v_mfma_f32_16x16x32_bf16 v[120:123], a[104:107], a[68:71], 0
  v_add_u32 v20, s66, v20
  v_add_u32 v21, s66, v21
  v_mfma_f32_16x16x32_bf16 v[136:139], a[104:107], a[72:75], 0
  v_mfma_f32_16x16x32_bf16 v[152:155], a[104:107], a[76:79], 0
  v_mfma_f32_16x16x32_bf16 v[108:111], a[108:111], a[64:67], 0
  v_mfma_f32_16x16x32_bf16 v[124:127], a[108:111], a[68:71], 0
  v_mfma_f32_16x16x32_bf16 v[140:143], a[108:111], a[72:75], 0
  v_mfma_f32_16x16x32_bf16 v[156:159], a[108:111], a[76:79], 0
Lp7:
  s_mov_b32 s69, 23
  s_waitcnt vmcnt(16) lgkmcnt(0)
  s_barrier
  .p2align 6
Lp7_loop:
  v_mfma_f32_16x16x32_bf16 v[96:99], a[112:115], a[80:83], v[96:99]
  s_add_u32 m0, s64, 16384
  ds_read_b128 a[64:67], v16 offset:0
  ds_read_b64_tr_b16 a[96:97], v18 offset:16384
  v_mfma_f32_16x16x32_bf16 v[112:115], a[112:115], a[84:87], v[112:115]
  buffer_load_dwordx4 v10, s[12:15], s71 offen offset:0 lds
  ds_read_b64_tr_b16 a[98:99], v18 offset:18432
  v_mfma_f32_16x16x32_bf16 v[128:131], a[112:115], a[88:91], v[128:131]
  ds_read_b128 a[68:71], v16 offset:1024
  ds_read_b128 a[72:75], v17 offset:0
  v_mfma_f32_16x16x32_bf16 v[144:147], a[112:115], a[92:95], v[144:147]
  buffer_load_dwordx4 v11, s[12:15], s71 offen offset:1024 lds
  ds_read_b128 a[76:79], v17 offset:1024
  v_mfma_f32_16x16x32_bf16 v[100:103], a[116:119], a[80:83], v[100:103]
  ds_read_b64_tr_b16 a[100:101], v19 offset:16384
  ds_read_b64_tr_b16 a[102:103], v19 offset:18432
  v_mfma_f32_16x16x32_bf16 v[116:119], a[116:119], a[84:87], v[116:119]
  ds_read_b64_tr_b16 a[104:105], v20 offset:16384
  ds_read_b64_tr_b16 a[106:107], v20 offset:18432
  v_mfma_f32_16x16x32_bf16 v[132:135], a[116:119], a[88:91], v[132:135]
  ds_read_b64_tr_b16 a[108:109], v21 offset:16384
  ds_read_b64_tr_b16 a[110:111], v21 offset:18432
  v_mfma_f32_16x16x32_bf16 v[148:151], a[116:119], a[92:95], v[148:151]
  buffer_load_dwordx4 v12, s[12:15], s71 offen offset:2048 lds
  v_mfma_f32_16x16x32_bf16 v[104:107], a[120:123], a[80:83], v[104:107]
  v_mfma_f32_16x16x32_bf16 v[120:123], a[120:123], a[84:87], v[120:123]
  v_mfma_f32_16x16x32_bf16 v[136:139], a[120:123], a[88:91], v[136:139]
  v_mfma_f32_16x16x32_bf16 v[152:155], a[120:123], a[92:95], v[152:155]
  buffer_load_dwordx4 v13, s[12:15], s71 offen offset:3072 lds
  v_mfma_f32_16x16x32_bf16 v[108:111], a[124:127], a[80:83], v[108:111]
  s_bfe_u32 s72, 0x302011a, s31
  s_add_u32 s30, s30, s72
  s_add_u32 s31, s31, 8
  v_mfma_f32_16x16x32_bf16 v[124:127], a[124:127], a[84:87], v[124:127]
  s_and_b32 s31, s31, 0x8001f
  s_cmp_ge_u32 s30, 28
  s_cselect_b32 s72, 28, 0
  v_mfma_f32_16x16x32_bf16 v[140:143], a[124:127], a[88:91], v[140:143]
  s_sub_u32 s30, s30, s72
  s_lshl_b32 s72, s30, 17
  s_add_u32 s71, s93, s72
  v_mfma_f32_16x16x32_bf16 v[156:159], a[124:127], a[92:95], v[156:159]
  s_waitcnt lgkmcnt(0)
  v_mfma_f32_16x16x32_bf16 v[96:99], a[96:99], a[64:67], v[96:99]
  s_mov_b32 m0, s64
  ds_read_b128 a[80:83], v16 offset:8192
  ds_read_b64_tr_b16 a[112:113], v18 offset:20480
  v_mfma_f32_16x16x32_bf16 v[112:115], a[96:99], a[68:71], v[112:115]
  buffer_load_dwordx4 v2, s[8:11], s70 offen offset:0 sc1 lds
  ds_read_b64_tr_b16 a[114:115], v18 offset:22528
  v_mfma_f32_16x16x32_bf16 v[128:131], a[96:99], a[72:75], v[128:131]
  buffer_load_dwordx4 v2, s[8:11], s70 offen offset:1024 sc1 lds
  ds_read_b128 a[84:87], v16 offset:9216
  v_mfma_f32_16x16x32_bf16 v[144:147], a[96:99], a[76:79], v[144:147]
  ds_read_b128 a[88:91], v17 offset:8192
  ds_read_b128 a[92:95], v17 offset:9216
  v_mfma_f32_16x16x32_bf16 v[100:103], a[100:103], a[64:67], v[100:103]
  buffer_load_dwordx4 v2, s[8:11], s70 offen offset:2048 sc1 lds
  ds_read_b64_tr_b16 a[116:117], v19 offset:20480
  v_mfma_f32_16x16x32_bf16 v[116:119], a[100:103], a[68:71], v[116:119]
  ds_read_b64_tr_b16 a[118:119], v19 offset:22528
  ds_read_b64_tr_b16 a[120:121], v20 offset:20480
  v_mfma_f32_16x16x32_bf16 v[132:135], a[100:103], a[72:75], v[132:135]
  buffer_load_dwordx4 v2, s[8:11], s70 offen offset:3072 sc1 lds
  ds_read_b64_tr_b16 a[122:123], v20 offset:22528
  v_mfma_f32_16x16x32_bf16 v[148:151], a[100:103], a[76:79], v[148:151]
  s_bfe_u32 s72, 0x302011a, s1
  s_add_u32 s0, s0, s72
  s_add_u32 s1, s1, 8
  v_mfma_f32_16x16x32_bf16 v[104:107], a[104:107], a[64:67], v[104:107]
  s_and_b32 s1, s1, 0x8001f
  s_cmp_ge_u32 s0, 28
  s_cselect_b32 s72, 28, 0
  v_mfma_f32_16x16x32_bf16 v[120:123], a[104:107], a[68:71], v[120:123]
  s_sub_u32 s0, s0, s72
  s_lshl_b32 s72, s0, 14
  s_add_u32 s70, s92, s72
  v_mfma_f32_16x16x32_bf16 v[136:139], a[104:107], a[72:75], v[136:139]
  s_add_u32 s64, s64, s66
  ds_read_b64_tr_b16 a[124:125], v21 offset:20480
  ds_read_b64_tr_b16 a[126:127], v21 offset:22528
  v_mfma_f32_16x16x32_bf16 v[152:155], a[104:107], a[76:79], v[152:155]
  s_add_u32 s65, s65, 1
  s_cmp_eq_u32 s65, 4
  s_cselect_b32 s65, 0, s65
  s_cselect_b32 s66, s67, s68
  v_mfma_f32_16x16x32_bf16 v[108:111], a[108:111], a[64:67], v[108:111]
  v_add_u32 v16, s66, v16
  v_add_u32 v17, s66, v17
  v_mfma_f32_16x16x32_bf16 v[124:127], a[108:111], a[68:71], v[124:127]
  s_waitcnt vmcnt(16) lgkmcnt(0)
  s_barrier
  v_add_u32 v18, s66, v18
  v_add_u32 v19, s66, v19
  v_mfma_f32_16x16x32_bf16 v[140:143], a[108:111], a[72:75], v[140:143]
  s_sub_u32 s69, s69, 1
  v_add_u32 v20, s66, v20
  v_add_u32 v21, s66, v21
  v_mfma_f32_16x16x32_bf16 v[156:159], a[108:111], a[76:79], v[156:159]
  s_cmp_lg_u32 s69, 0
  s_cbranch_scc1 Lp7_loop
  s_lshl_b32 s6, s78, 1
  s_add_u32 s6, s6, s77
  s_lshl_b32 s6, s6, 7
  s_add_u32 s6, s6, 163840
  v_mov_b32 v8, 0x40000000
  v_mov_b32 v6, s94
  v_cmp_eq_u32 vcc, 0, v0
  v_mov_b32 v7, s95
  s_nop 0
  v_cndmask_b32_e64 v8, v8, 0, vcc
  buffer_store_dwordx2 v[6:7], v8, s[96:99], s6 offen sc1
  s_lshl_b32 s90, s78, 1
  s_add_u32 s90, s90, s77
  s_xor_b32 s90, s90, 1
  s_lshl_b32 s90, s90, 7
  s_add_u32 s90, s90, 163840
  s_mov_b32 s20, s82
  s_mov_b32 s21, s83
  s_mov_b32 s22, 8388608
  s_mov_b32 s23, 0x00020000
  v_bfe_u32 v25, v1, 4, 1
  v_lshrrev_b32 v26, 5, v1
  v_lshl_or_b32 v25, v25, 1, v26
  v_lshlrev_b32 v25, 4, v25
  v_and_b32 v24, 15, v1
  v_lshl_add_u32 v26, v24, 14, v25
  v_lshl_add_u32 v27, v24, 12, v25
  v_mfma_f32_16x16x32_bf16 v[96:99], a[112:115], a[80:83], v[96:99]
  s_add_u32 m0, s64, 16384
  ds_read_b128 a[64:67], v16 offset:0
  ds_read_b64_tr_b16 a[96:97], v18 offset:16384
  v_mfma_f32_16x16x32_bf16 v[112:115], a[112:115], a[84:87], v[112:115]
  buffer_load_dwordx4 v10, s[12:15], s71 offen offset:0 lds
  ds_read_b64_tr_b16 a[98:99], v18 offset:18432
  v_mfma_f32_16x16x32_bf16 v[128:131], a[112:115], a[88:91], v[128:131]
  ds_read_b128 a[68:71], v16 offset:1024
  ds_read_b128 a[72:75], v17 offset:0
  v_mfma_f32_16x16x32_bf16 v[144:147], a[112:115], a[92:95], v[144:147]
  buffer_load_dwordx4 v11, s[12:15], s71 offen offset:1024 lds
  ds_read_b128 a[76:79], v17 offset:1024
  v_mfma_f32_16x16x32_bf16 v[100:103], a[116:119], a[80:83], v[100:103]
  ds_read_b64_tr_b16 a[100:101], v19 offset:16384
  ds_read_b64_tr_b16 a[102:103], v19 offset:18432
  v_mfma_f32_16x16x32_bf16 v[116:119], a[116:119], a[84:87], v[116:119]
  ds_read_b64_tr_b16 a[104:105], v20 offset:16384
  ds_read_b64_tr_b16 a[106:107], v20 offset:18432
  v_mfma_f32_16x16x32_bf16 v[132:135], a[116:119], a[88:91], v[132:135]
  ds_read_b64_tr_b16 a[108:109], v21 offset:16384
  ds_read_b64_tr_b16 a[110:111], v21 offset:18432
  v_mfma_f32_16x16x32_bf16 v[148:151], a[116:119], a[92:95], v[148:151]
  buffer_load_dwordx4 v12, s[12:15], s71 offen offset:2048 lds
  v_mfma_f32_16x16x32_bf16 v[104:107], a[120:123], a[80:83], v[104:107]
  v_mfma_f32_16x16x32_bf16 v[120:123], a[120:123], a[84:87], v[120:123]
  v_mfma_f32_16x16x32_bf16 v[136:139], a[120:123], a[88:91], v[136:139]
  v_mfma_f32_16x16x32_bf16 v[152:155], a[120:123], a[92:95], v[152:155]
  buffer_load_dwordx4 v13, s[12:15], s71 offen offset:3072 lds
  v_mfma_f32_16x16x32_bf16 v[108:111], a[124:127], a[80:83], v[108:111]
  s_bfe_u32 s72, 0x302011a, s31
  s_add_u32 s30, s30, s72
  s_add_u32 s31, s31, 8
  v_mfma_f32_16x16x32_bf16 v[124:127], a[124:127], a[84:87], v[124:127]
  s_and_b32 s31, s31, 0x8001f
  s_cmp_ge_u32 s30, 28
  s_cselect_b32 s72, 28, 0
  v_mfma_f32_16x16x32_bf16 v[140:143], a[124:127], a[88:91], v[140:143]
  s_sub_u32 s30, s30, s72
  s_lshl_b32 s72, s30, 17
  s_add_u32 s71, s93, s72
  v_mfma_f32_16x16x32_bf16 v[156:159], a[124:127], a[92:95], v[156:159]
  s_waitcnt lgkmcnt(0)
  v_mfma_f32_16x16x32_bf16 v[96:99], a[96:99], a[64:67], v[96:99]
  s_mov_b32 m0, s64
  ds_read_b128 a[80:83], v16 offset:8192
  ds_read_b64_tr_b16 a[112:113], v18 offset:20480
  v_mfma_f32_16x16x32_bf16 v[112:115], a[96:99], a[68:71], v[112:115]
  buffer_load_dwordx4 v2, s[8:11], s70 offen offset:0 sc1 lds
  ds_read_b64_tr_b16 a[114:115], v18 offset:22528
  v_mfma_f32_16x16x32_bf16 v[128:131], a[96:99], a[72:75], v[128:131]
  buffer_load_dwordx4 v2, s[8:11], s70 offen offset:1024 sc1 lds
  ds_read_b128 a[84:87], v16 offset:9216
  v_mfma_f32_16x16x32_bf16 v[144:147], a[96:99], a[76:79], v[144:147]
  ds_read_b128 a[88:91], v17 offset:8192
  ds_read_b128 a[92:95], v17 offset:9216
  v_mfma_f32_16x16x32_bf16 v[100:103], a[100:103], a[64:67], v[100:103]
  buffer_load_dwordx4 v2, s[8:11], s70 offen offset:2048 sc1 lds
  ds_read_b64_tr_b16 a[116:117], v19 offset:20480
  v_mfma_f32_16x16x32_bf16 v[116:119], a[100:103], a[68:71], v[116:119]
  ds_read_b64_tr_b16 a[118:119], v19 offset:22528
  ds_read_b64_tr_b16 a[120:121], v20 offset:20480
  v_mfma_f32_16x16x32_bf16 v[132:135], a[100:103], a[72:75], v[132:135]
  buffer_load_dwordx4 v2, s[8:11], s70 offen offset:3072 sc1 lds
  ds_read_b64_tr_b16 a[122:123], v20 offset:22528
  v_mfma_f32_16x16x32_bf16 v[148:151], a[100:103], a[76:79], v[148:151]
  s_bfe_u32 s72, 0x302011a, s1
  s_add_u32 s0, s0, s72
  s_add_u32 s1, s1, 8
  v_mfma_f32_16x16x32_bf16 v[104:107], a[104:107], a[64:67], v[104:107]
  s_and_b32 s1, s1, 0x8001f
  s_cmp_ge_u32 s0, 28
  s_cselect_b32 s72, 28, 0
  v_mfma_f32_16x16x32_bf16 v[120:123], a[104:107], a[68:71], v[120:123]
  s_sub_u32 s0, s0, s72
  s_lshl_b32 s72, s0, 14
  s_add_u32 s70, s92, s72
  v_mfma_f32_16x16x32_bf16 v[136:139], a[104:107], a[72:75], v[136:139]
  s_add_u32 s64, s64, s66
  ds_read_b64_tr_b16 a[124:125], v21 offset:20480
  ds_read_b64_tr_b16 a[126:127], v21 offset:22528
  v_mfma_f32_16x16x32_bf16 v[152:155], a[104:107], a[76:79], v[152:155]
  s_add_u32 s65, s65, 1
  s_cmp_eq_u32 s65, 4
  s_cselect_b32 s65, 0, s65
  s_cselect_b32 s66, s67, s68
  v_mfma_f32_16x16x32_bf16 v[108:111], a[108:111], a[64:67], v[108:111]
  v_add_u32 v16, s66, v16
  v_add_u32 v17, s66, v17
  v_mfma_f32_16x16x32_bf16 v[124:127], a[108:111], a[68:71], v[124:127]
  v_add_u32 v18, s66, v18
  v_add_u32 v19, s66, v19
  v_mfma_f32_16x16x32_bf16 v[140:143], a[108:111], a[72:75], v[140:143]
  v_add_u32 v20, s66, v20
  v_add_u32 v21, s66, v21
  v_mfma_f32_16x16x32_bf16 v[156:159], a[108:111], a[76:79], v[156:159]
  s_waitcnt vmcnt(17) lgkmcnt(0)
  s_barrier
  v_mfma_f32_16x16x32_bf16 v[96:99], a[112:115], a[80:83], v[96:99]
  buffer_load_dwordx2 v[6:7], off, s[96:99], s90 sc1
  ds_read_b128 a[64:67], v16 offset:0
  v_mfma_f32_16x16x32_bf16 v[112:115], a[112:115], a[84:87], v[112:115]
  s_and_b32 s88, s3, 1
  s_lshl_b32 s88, s88, 12
  s_lshr_b32 s72, s3, 1
  v_mfma_f32_16x16x32_bf16 v[128:131], a[112:115], a[88:91], v[128:131]
  s_lshl_b32 s72, s72, 13
  s_add_u32 s88, s88, s72
  s_lshl_b32 s72, s77, 11
  v_mfma_f32_16x16x32_bf16 v[144:147], a[112:115], a[92:95], v[144:147]
  s_add_u32 s88, s88, s72
  s_sub_u32 s88, s88, s79
  s_add_u32 s70, s92, s88
  v_mfma_f32_16x16x32_bf16 v[100:103], a[116:119], a[80:83], v[100:103]
  s_add_u32 s70, s70, 458752
  s_add_u32 s71, s93, 3670016
  s_add_u32 m0, s64, 16384
  v_mfma_f32_16x16x32_bf16 v[116:119], a[116:119], a[84:87], v[116:119]
  buffer_load_dwordx4 v10, s[12:15], s71 offen offset:0 lds
  ds_read_b64_tr_b16 a[96:97], v18 offset:16384
  v_mfma_f32_16x16x32_bf16 v[132:135], a[116:119], a[88:91], v[132:135]
  ds_read_b64_tr_b16 a[98:99], v18 offset:18432
  ds_read_b128 a[68:71], v16 offset:1024
  v_mfma_f32_16x16x32_bf16 v[148:151], a[116:119], a[92:95], v[148:151]
  buffer_load_dwordx4 v11, s[12:15], s71 offen offset:1024 lds
  ds_read_b128 a[72:75], v17 offset:0
  v_mfma_f32_16x16x32_bf16 v[104:107], a[120:123], a[80:83], v[104:107]
  ds_read_b128 a[76:79], v17 offset:1024
  ds_read_b64_tr_b16 a[100:101], v19 offset:16384
  v_mfma_f32_16x16x32_bf16 v[120:123], a[120:123], a[84:87], v[120:123]
  ds_read_b64_tr_b16 a[102:103], v19 offset:18432
  ds_read_b64_tr_b16 a[104:105], v20 offset:16384
  v_mfma_f32_16x16x32_bf16 v[136:139], a[120:123], a[88:91], v[136:139]
  ds_read_b64_tr_b16 a[106:107], v20 offset:18432
  ds_read_b64_tr_b16 a[108:109], v21 offset:16384
  v_mfma_f32_16x16x32_bf16 v[152:155], a[120:123], a[92:95], v[152:155]
  buffer_load_dwordx4 v12, s[12:15], s71 offen offset:2048 lds
  ds_read_b64_tr_b16 a[110:111], v21 offset:18432
  v_mfma_f32_16x16x32_bf16 v[108:111], a[124:127], a[80:83], v[108:111]
  v_mfma_f32_16x16x32_bf16 v[124:127], a[124:127], a[84:87], v[124:127]
  v_mfma_f32_16x16x32_bf16 v[140:143], a[124:127], a[88:91], v[140:143]
  v_mfma_f32_16x16x32_bf16 v[156:159], a[124:127], a[92:95], v[156:159]
  s_waitcnt lgkmcnt(0)
  v_mfma_f32_16x16x32_bf16 v[96:99], a[96:99], a[64:67], v[96:99]
  buffer_load_dwordx4 v13, s[12:15], s71 offen offset:3072 lds
  ds_read_b128 a[80:83], v16 offset:8192
  v_mfma_f32_16x16x32_bf16 v[112:115], a[96:99], a[68:71], v[112:115]
  s_add_u32 s71, s71, 131072
  s_add_u32 m0, s64, s88
  ds_read_b64_tr_b16 a[112:113], v18 offset:20480
  v_mfma_f32_16x16x32_bf16 v[128:131], a[96:99], a[72:75], v[128:131]
  ds_read_b64_tr_b16 a[114:115], v18 offset:22528
  ds_read_b128 a[84:87], v16 offset:9216
  v_mfma_f32_16x16x32_bf16 v[144:147], a[96:99], a[76:79], v[144:147]
  buffer_load_dwordx4 v2, s[8:11], s70 offen offset:0 sc1 lds
  ds_read_b128 a[88:91], v17 offset:8192
  v_mfma_f32_16x16x32_bf16 v[100:103], a[100:103], a[64:67], v[100:103]
  ds_read_b128 a[92:95], v17 offset:9216
  ds_read_b64_tr_b16 a[116:117], v19 offset:20480
  v_mfma_f32_16x16x32_bf16 v[116:119], a[100:103], a[68:71], v[116:119]
  ds_read_b64_tr_b16 a[118:119], v19 offset:22528
  ds_read_b64_tr_b16 a[120:121], v20 offset:20480
  v_mfma_f32_16x16x32_bf16 v[132:135], a[100:103], a[72:75], v[132:135]
  buffer_load_dwordx4 v2, s[8:11], s70 offen offset:1024 sc1 lds
  ds_read_b64_tr_b16 a[122:123], v20 offset:22528
  v_mfma_f32_16x16x32_bf16 v[148:151], a[100:103], a[76:79], v[148:151]
  s_add_u32 s70, s70, 16384
  ds_read_b64_tr_b16 a[124:125], v21 offset:20480
  ds_read_b64_tr_b16 a[126:127], v21 offset:22528
  v_mfma_f32_16x16x32_bf16 v[104:107], a[104:107], a[64:67], v[104:107]
  s_add_u32 s64, s64, s66
  s_add_u32 s65, s65, 1
  s_cmp_eq_u32 s65, 4
  s_cselect_b32 s65, 0, s65
  s_cselect_b32 s66, s67, s68
  v_mfma_f32_16x16x32_bf16 v[120:123], a[104:107], a[68:71], v[120:123]
  v_add_u32 v16, s66, v16
  v_add_u32 v17, s66, v17
  v_mfma_f32_16x16x32_bf16 v[136:139], a[104:107], a[72:75], v[136:139]
  v_add_u32 v18, s66, v18
  v_add_u32 v19, s66, v19
  v_mfma_f32_16x16x32_bf16 v[152:155], a[104:107], a[76:79], v[152:155]
  v_add_u32 v20, s66, v20
  v_add_u32 v21, s66, v21
  v_mfma_f32_16x16x32_bf16 v[108:111], a[108:111], a[64:67], v[108:111]
  v_mfma_f32_16x16x32_bf16 v[124:127], a[108:111], a[68:71], v[124:127]
  v_mfma_f32_16x16x32_bf16 v[140:143], a[108:111], a[72:75], v[140:143]
  v_mfma_f32_16x16x32_bf16 v[156:159], a[108:111], a[76:79], v[156:159]
  s_waitcnt vmcnt(6) lgkmcnt(0)
  s_barrier
  s_mov_b32 s5, 0x40000
Lpoll_11:
  v_cmp_ne_u64 vcc, s[94:95], v[6:7]
  s_nop 0
  s_cbranch_vccz Lpolld_12
  s_sleep 4
  buffer_load_dwordx2 v[6:7], off, s[96:99], s90 sc1
  s_sub_u32 s5, s5, 1
  s_waitcnt vmcnt(0)
  s_cbranch_scc0 Lpoll_11
Lpolld_12:
  v_mfma_f32_16x16x32_bf16 v[96:99], a[112:115], a[80:83], v[96:99]
  s_lshl_b32 s6, s78, 1
  s_add_u32 s6, s6, s77
  s_lshl_b32 s6, s6, 2
  v_mfma_f32_16x16x32_bf16 v[112:115], a[112:115], a[84:87], v[112:115]
  s_add_u32 s6, s6, s3
  s_lshl_b32 s6, s6, 13
  s_add_u32 s6, s6, 8388608
  v_mfma_f32_16x16x32_bf16 v[128:131], a[112:115], a[88:91], v[128:131]
  s_add_u32 s7, s6, 4096
  buffer_load_dwordx4 v[160:163], v2, s[16:19], s6 offen offset:0 sc1
  ds_read_b128 a[64:67], v16 offset:0
  v_mfma_f32_16x16x32_bf16 v[144:147], a[112:115], a[92:95], v[144:147]
  buffer_load_dwordx4 v[164:167], v2, s[16:19], s6 offen offset:1024 sc1
  ds_read_b64_tr_b16 a[96:97], v18 offset:16384
  v_mfma_f32_16x16x32_bf16 v[100:103], a[116:119], a[80:83], v[100:103]
  buffer_load_dwordx4 v[168:171], v2, s[16:19], s6 offen offset:2048 sc1
  ds_read_b64_tr_b16 a[98:99], v18 offset:18432
  v_mfma_f32_16x16x32_bf16 v[116:119], a[116:119], a[84:87], v[116:119]
  ds_read_b128 a[68:71], v16 offset:1024
  ds_read_b128 a[72:75], v17 offset:0
  v_mfma_f32_16x16x32_bf16 v[132:135], a[116:119], a[88:91], v[132:135]
  buffer_load_dwordx4 v[172:175], v2, s[16:19], s6 offen offset:3072 sc1
  ds_read_b128 a[76:79], v17 offset:1024
  v_mfma_f32_16x16x32_bf16 v[148:151], a[116:119], a[92:95], v[148:151]
  ds_read_b64_tr_b16 a[100:101], v19 offset:16384
  ds_read_b64_tr_b16 a[102:103], v19 offset:18432
  v_mfma_f32_16x16x32_bf16 v[104:107], a[120:123], a[80:83], v[104:107]
  buffer_load_dwordx4 v[176:179], v2, s[16:19], s7 offen offset:0 sc1
  ds_read_b64_tr_b16 a[104:105], v20 offset:16384
  v_mfma_f32_16x16x32_bf16 v[120:123], a[120:123], a[84:87], v[120:123]
  ds_read_b64_tr_b16 a[106:107], v20 offset:18432
  ds_read_b64_tr_b16 a[108:109], v21 offset:16384
  v_mfma_f32_16x16x32_bf16 v[136:139], a[120:123], a[88:91], v[136:139]
  buffer_load_dwordx4 v[180:183], v2, s[16:19], s7 offen offset:1024 sc1
  ds_read_b64_tr_b16 a[110:111], v21 offset:18432
  v_mfma_f32_16x16x32_bf16 v[152:155], a[120:123], a[92:95], v[152:155]
  v_mfma_f32_16x16x32_bf16 v[108:111], a[124:127], a[80:83], v[108:111]
  buffer_load_dwordx4 v[184:187], v2, s[16:19], s7 offen offset:2048 sc1
  v_mfma_f32_16x16x32_bf16 v[124:127], a[124:127], a[84:87], v[124:127]
  v_mfma_f32_16x16x32_bf16 v[140:143], a[124:127], a[88:91], v[140:143]
  v_mfma_f32_16x16x32_bf16 v[156:159], a[124:127], a[92:95], v[156:159]
  s_waitcnt lgkmcnt(0)
  v_mfma_f32_16x16x32_bf16 v[96:99], a[96:99], a[64:67], v[96:99]
  buffer_load_dwordx4 v[188:191], v2, s[16:19], s7 offen offset:3072 sc1
  ds_read_b128 a[80:83], v16 offset:8192
  v_mfma_f32_16x16x32_bf16 v[112:115], a[96:99], a[68:71], v[112:115]
  s_add_u32 m0, s64, 16384
  ds_read_b64_tr_b16 a[112:113], v18 offset:20480
  ds_read_b64_tr_b16 a[114:115], v18 offset:22528
  v_mfma_f32_16x16x32_bf16 v[128:131], a[96:99], a[72:75], v[128:131]
  buffer_load_dwordx4 v10, s[12:15], s71 offen offset:0 lds
  ds_read_b128 a[84:87], v16 offset:9216
  v_mfma_f32_16x16x32_bf16 v[144:147], a[96:99], a[76:79], v[144:147]
  buffer_load_dwordx4 v11, s[12:15], s71 offen offset:1024 lds
  ds_read_b128 a[88:91], v17 offset:8192
  v_mfma_f32_16x16x32_bf16 v[100:103], a[100:103], a[64:67], v[100:103]
  buffer_load_dwordx4 v12, s[12:15], s71 offen offset:2048 lds
  ds_read_b128 a[92:95], v17 offset:9216
  v_mfma_f32_16x16x32_bf16 v[116:119], a[100:103], a[68:71], v[116:119]
  buffer_load_dwordx4 v13, s[12:15], s71 offen offset:3072 lds
  ds_read_b64_tr_b16 a[116:117], v19 offset:20480
  v_mfma_f32_16x16x32_bf16 v[132:135], a[100:103], a[72:75], v[132:135]
  s_add_u32 s71, s71, 131072
  s_add_u32 m0, s64, s88
  ds_read_b64_tr_b16 a[118:119], v19 offset:22528
  v_mfma_f32_16x16x32_bf16 v[148:151], a[100:103], a[76:79], v[148:151]
  buffer_load_dwordx4 v2, s[8:11], s70 offen offset:0 sc1 lds
  ds_read_b64_tr_b16 a[120:121], v20 offset:20480
  v_mfma_f32_16x16x32_bf16 v[104:107], a[104:107], a[64:67], v[104:107]
  buffer_load_dwordx4 v2, s[8:11], s70 offen offset:1024 sc1 lds
  ds_read_b64_tr_b16 a[122:123], v20 offset:22528
  v_mfma_f32_16x16x32_bf16 v[120:123], a[104:107], a[68:71], v[120:123]
  s_add_u32 s70, s70, 16384
  ds_read_b64_tr_b16 a[124:125], v21 offset:20480
  ds_read_b64_tr_b16 a[126:127], v21 offset:22528
  v_mfma_f32_16x16x32_bf16 v[136:139], a[104:107], a[72:75], v[136:139]
  s_add_u32 s64, s64, s66
  s_add_u32 s65, s65, 1
  s_cmp_eq_u32 s65, 4
  s_cselect_b32 s65, 0, s65
  s_cselect_b32 s66, s67, s68
  v_mfma_f32_16x16x32_bf16 v[152:155], a[104:107], a[76:79], v[152:155]
  v_add_u32 v16, s66, v16
  v_add_u32 v17, s66, v17
  v_mfma_f32_16x16x32_bf16 v[108:111], a[108:111], a[64:67], v[108:111]
  v_add_u32 v18, s66, v18
  v_add_u32 v19, s66, v19
  v_mfma_f32_16x16x32_bf16 v[124:127], a[108:111], a[68:71], v[124:127]
  v_add_u32 v20, s66, v20
  v_add_u32 v21, s66, v21
  v_mfma_f32_16x16x32_bf16 v[140:143], a[108:111], a[72:75], v[140:143]
  v_mfma_f32_16x16x32_bf16 v[156:159], a[108:111], a[76:79], v[156:159]
  s_waitcnt vmcnt(20) lgkmcnt(0)
  s_barrier
  v_mfma_f32_16x16x32_bf16 v[96:99], a[112:115], a[80:83], v[96:99]
  s_add_u32 m0, s64, 16384
  ds_read_b128 a[64:67], v16 offset:0
  ds_read_b64_tr_b16 a[96:97], v18 offset:16384
  v_mfma_f32_16x16x32_bf16 v[112:115], a[112:115], a[84:87], v[112:115]
  buffer_load_dwordx4 v10, s[12:15], s71 offen offset:0 lds
  ds_read_b64_tr_b16 a[98:99], v18 offset:18432
  v_mfma_f32_16x16x32_bf16 v[128:131], a[112:115], a[88:91], v[128:131]
  ds_read_b128 a[68:71], v16 offset:1024
  ds_read_b128 a[72:75], v17 offset:0
  v_mfma_f32_16x16x32_bf16 v[144:147], a[112:115], a[92:95], v[144:147]
  ds_read_b128 a[76:79], v17 offset:1024
  ds_read_b64_tr_b16 a[100:101], v19 offset:16384
  v_mfma_f32_16x16x32_bf16 v[100:103], a[116:119], a[80:83], v[100:103]
  ds_read_b64_tr_b16 a[102:103], v19 offset:18432
  ds_read_b64_tr_b16 a[104:105], v20 offset:16384
  v_mfma_f32_16x16x32_bf16 v[116:119], a[116:119], a[84:87], v[116:119]
  buffer_load_dwordx4 v11, s[12:15], s71 offen offset:1024 lds
  ds_read_b64_tr_b16 a[106:107], v20 offset:18432
  v_mfma_f32_16x16x32_bf16 v[132:135], a[116:119], a[88:91], v[132:135]
  ds_read_b64_tr_b16 a[108:109], v21 offset:16384
  ds_read_b64_tr_b16 a[110:111], v21 offset:18432
  v_mfma_f32_16x16x32_bf16 v[148:151], a[116:119], a[92:95], v[148:151]
  v_mfma_f32_16x16x32_bf16 v[104:107], a[120:123], a[80:83], v[104:107]
  v_mfma_f32_16x16x32_bf16 v[120:123], a[120:123], a[84:87], v[120:123]
  v_mfma_f32_16x16x32_bf16 v[136:139], a[120:123], a[88:91], v[136:139]
  buffer_load_dwordx4 v12, s[12:15], s71 offen offset:2048 lds
  v_mfma_f32_16x16x32_bf16 v[152:155], a[120:123], a[92:95], v[152:155]
  v_mfma_f32_16x16x32_bf16 v[108:111], a[124:127], a[80:83], v[108:111]
  v_mfma_f32_16x16x32_bf16 v[124:127], a[124:127], a[84:87], v[124:127]
  v_mfma_f32_16x16x32_bf16 v[140:143], a[124:127], a[88:91], v[140:143]
  v_mfma_f32_16x16x32_bf16 v[156:159], a[124:127], a[92:95], v[156:159]
  s_waitcnt lgkmcnt(0)
  v_mfma_f32_16x16x32_bf16 v[96:99], a[96:99], a[64:67], v[96:99]
  buffer_load_dwordx4 v13, s[12:15], s71 offen offset:3072 lds
  ds_read_b128 a[80:83], v16 offset:8192
  v_mfma_f32_16x16x32_bf16 v[112:115], a[96:99], a[68:71], v[112:115]
  s_add_u32 s71, s71, 131072
  s_add_u32 m0, s64, s88
  ds_read_b64_tr_b16 a[112:113], v18 offset:20480
  v_mfma_f32_16x16x32_bf16 v[128:131], a[96:99], a[72:75], v[128:131]
  ds_read_b64_tr_b16 a[114:115], v18 offset:22528
  ds_read_b128 a[84:87], v16 offset:9216
  v_mfma_f32_16x16x32_bf16 v[144:147], a[96:99], a[76:79], v[144:147]
  buffer_load_dwordx4 v2, s[8:11], s70 offen offset:0 sc1 lds
  ds_read_b128 a[88:91], v17 offset:8192
  v_mfma_f32_16x16x32_bf16 v[100:103], a[100:103], a[64:67], v[100:103]
  ds_read_b128 a[92:95], v17 offset:9216
  ds_read_b64_tr_b16 a[116:117], v19 offset:20480
  v_mfma_f32_16x16x32_bf16 v[116:119], a[100:103], a[68:71], v[116:119]
  ds_read_b64_tr_b16 a[118:119], v19 offset:22528
  ds_read_b64_tr_b16 a[120:121], v20 offset:20480
  v_mfma_f32_16x16x32_bf16 v[132:135], a[100:103], a[72:75], v[132:135]
  buffer_load_dwordx4 v2, s[8:11], s70 offen offset:1024 sc1 lds
  ds_read_b64_tr_b16 a[122:123], v20 offset:22528
  v_mfma_f32_16x16x32_bf16 v[148:151], a[100:103], a[76:79], v[148:151]
  s_add_u32 s70, s70, 16384
  ds_read_b64_tr_b16 a[124:125], v21 offset:20480
  ds_read_b64_tr_b16 a[126:127], v21 offset:22528
  v_mfma_f32_16x16x32_bf16 v[104:107], a[104:107], a[64:67], v[104:107]
  s_add_u32 s64, s64, s66
  s_add_u32 s65, s65, 1
  s_cmp_eq_u32 s65, 4
  s_cselect_b32 s65, 0, s65
  s_cselect_b32 s66, s67, s68
  v_mfma_f32_16x16x32_bf16 v[120:123], a[104:107], a[68:71], v[120:123]
  v_add_u32 v16, s66, v16
  v_add_u32 v17, s66, v17
  v_mfma_f32_16x16x32_bf16 v[136:139], a[104:107], a[72:75], v[136:139]
  v_add_u32 v18, s66, v18
  v_add_u32 v19, s66, v19
  v_mfma_f32_16x16x32_bf16 v[152:155], a[104:107], a[76:79], v[152:155]
  v_add_u32 v20, s66, v20
  v_add_u32 v21, s66, v21
  v_mfma_f32_16x16x32_bf16 v[108:111], a[108:111], a[64:67], v[108:111]
  v_mfma_f32_16x16x32_bf16 v[124:127], a[108:111], a[68:71], v[124:127]
  v_mfma_f32_16x16x32_bf16 v[140:143], a[108:111], a[72:75], v[140:143]
  v_mfma_f32_16x16x32_bf16 v[156:159], a[108:111], a[76:79], v[156:159]
  s_waitcnt vmcnt(12) lgkmcnt(0)
  s_barrier
  s_lshl_b32 s4, s73, 19
  s_lshl_b32 s72, s76, 8
  s_add_u32 s4, s4, s72
  s_and_b32 s72, s3, 1
  s_lshl_b32 s72, s72, 7
  s_add_u32 s4, s4, s72
  s_lshr_b32 s72, s3, 1
  s_lshl_b32 s72, s72, 1
  s_add_u32 s72, s72, s77
  s_lshl_b32 s72, s72, 17
  s_add_u32 s4, s4, s72
  s_add_u32 s4, s4, 2048
  s_add_u32 s5, s4, 65536
  s_lshl_b32 s89, s78, 1
  s_add_u32 s89, s89, s77
  s_lshl_b32 s89, s89, 7
  s_add_u32 s89, s89, 131072
  s_lshl_b32 s90, s78, 1
  s_add_u32 s90, s90, s77
  s_xor_b32 s90, s90, 1
  s_lshl_b32 s90, s90, 7
  s_add_u32 s90, s90, 131072
  v_mfma_f32_16x16x32_bf16 v[96:99], a[112:115], a[80:83], v[96:99]
  s_add_u32 m0, s64, 16384
  ds_read_b128 a[64:67], v16 offset:0
  ds_read_b64_tr_b16 a[96:97], v18 offset:16384
  v_mfma_f32_16x16x32_bf16 v[112:115], a[112:115], a[84:87], v[112:115]
  buffer_load_dwordx4 v10, s[12:15], s71 offen offset:0 lds
  ds_read_b64_tr_b16 a[98:99], v18 offset:18432
  v_mfma_f32_16x16x32_bf16 v[128:131], a[112:115], a[88:91], v[128:131]
  buffer_load_dwordx4 v11, s[12:15], s71 offen offset:1024 lds
  ds_read_b128 a[68:71], v16 offset:1024
  v_mfma_f32_16x16x32_bf16 v[144:147], a[112:115], a[92:95], v[144:147]
  ds_read_b64_tr_b16 a[100:101], v19 offset:16384
  ds_read_b64_tr_b16 a[102:103], v19 offset:18432
  v_mfma_f32_16x16x32_bf16 v[100:103], a[116:119], a[80:83], v[100:103]
  ds_read_b64_tr_b16 a[104:105], v20 offset:16384
  ds_read_b64_tr_b16 a[106:107], v20 offset:18432
  v_mfma_f32_16x16x32_bf16 v[116:119], a[116:119], a[84:87], v[116:119]
  buffer_load_dwordx4 v12, s[12:15], s71 offen offset:2048 lds
  ds_read_b64_tr_b16 a[108:109], v21 offset:16384
  v_mfma_f32_16x16x32_bf16 v[132:135], a[116:119], a[88:91], v[132:135]
  ds_read_b64_tr_b16 a[110:111], v21 offset:18432
  v_mfma_f32_16x16x32_bf16 v[148:151], a[116:119], a[92:95], v[148:151]
  buffer_load_dwordx4 v13, s[12:15], s71 offen offset:3072 lds
  v_mfma_f32_16x16x32_bf16 v[104:107], a[120:123], a[80:83], v[104:107]
  s_add_u32 s71, s71, 131072
  s_add_u32 m0, s64, s88
  v_mfma_f32_16x16x32_bf16 v[120:123], a[120:123], a[84:87], v[120:123]
  v_mfma_f32_16x16x32_bf16 v[136:139], a[120:123], a[88:91], v[136:139]
  buffer_load_dwordx4 v2, s[8:11], s70 offen offset:0 sc1 lds
  v_mfma_f32_16x16x32_bf16 v[152:155], a[120:123], a[92:95], v[152:155]
  v_mfma_f32_16x16x32_bf16 v[108:111], a[124:127], a[80:83], v[108:111]
  buffer_load_dwordx4 v2, s[8:11], s70 offen offset:1024 sc1 lds
  v_mfma_f32_16x16x32_bf16 v[124:127], a[124:127], a[84:87], v[124:127]
  s_add_u32 s70, s70, 16384
  s_lshl_b32 s6, s78, 1
  s_add_u32 s6, s6, s77
  v_mfma_f32_16x16x32_bf16 v[140:143], a[124:127], a[88:91], v[140:143]
  s_xor_b32 s6, s6, 1
  s_lshl_b32 s6, s6, 2
  s_add_u32 s6, s6, s3
  v_mfma_f32_16x16x32_bf16 v[156:159], a[124:127], a[92:95], v[156:159]
  s_lshl_b32 s6, s6, 13
  s_add_u32 s7, s6, 4096
  s_waitcnt lgkmcnt(0)
  v_mfma_f32_16x16x32_bf16 v[96:99], a[96:99], a[64:67], v[96:99]
  buffer_store_dwordx4 v[128:131], v2, s[16:19], s6 offen offset:0 sc1
  ds_read_b128 a[80:83], v16 offset:8192
  v_mfma_f32_16x16x32_bf16 v[112:115], a[96:99], a[68:71], v[112:115]
  buffer_store_dwordx4 v[132:135], v2, s[16:19], s6 offen offset:1024 sc1
  ds_read_b64_tr_b16 a[112:113], v18 offset:20480
  v_mfma_f32_16x16x32_bf16 v[100:103], a[100:103], a[64:67], v[100:103]
  ds_read_b64_tr_b16 a[114:115], v18 offset:22528
  ds_read_b128 a[84:87], v16 offset:9216
  v_mfma_f32_16x16x32_bf16 v[116:119], a[100:103], a[68:71], v[116:119]
  buffer_store_dwordx4 v[136:139], v2, s[16:19], s6 offen offset:2048 sc1
  ds_read_b64_tr_b16 a[116:117], v19 offset:20480
  v_mfma_f32_16x16x32_bf16 v[104:107], a[104:107], a[64:67], v[104:107]
  ds_read_b64_tr_b16 a[118:119], v19 offset:22528
  ds_read_b64_tr_b16 a[120:121], v20 offset:20480
  v_mfma_f32_16x16x32_bf16 v[120:123], a[104:107], a[68:71], v[120:123]
  buffer_store_dwordx4 v[140:143], v2, s[16:19], s6 offen offset:3072 sc1
  ds_read_b64_tr_b16 a[122:123], v20 offset:22528
  v_mfma_f32_16x16x32_bf16 v[108:111], a[108:111], a[64:67], v[108:111]
  s_add_u32 s64, s64, s66
  ds_read_b64_tr_b16 a[124:125], v21 offset:20480
  ds_read_b64_tr_b16 a[126:127], v21 offset:22528
  v_mfma_f32_16x16x32_bf16 v[124:127], a[108:111], a[68:71], v[124:127]
  s_add_u32 s65, s65, 1
  s_cmp_eq_u32 s65, 4
  s_cselect_b32 s65, 0, s65
  s_cselect_b32 s66, s67, s68
  v_add_u32 v16, s66, v16
  v_add_u32 v17, s66, v17
  v_add_u32 v18, s66, v18
  v_add_u32 v19, s66, v19
  v_add_u32 v20, s66, v20
  v_add_u32 v21, s66, v21
  s_waitcnt vmcnt(16) lgkmcnt(0)
  s_barrier
  v_mfma_f32_16x16x32_bf16 v[96:99], a[112:115], a[80:83], v[96:99]
  buffer_store_dwordx4 v[144:147], v2, s[16:19], s7 offen offset:0 sc1
  ds_read_b128 a[64:67], v16 offset:0
  v_mfma_f32_16x16x32_bf16 v[112:115], a[112:115], a[84:87], v[112:115]
  buffer_store_dwordx4 v[148:151], v2, s[16:19], s7 offen offset:1024 sc1
  ds_read_b64_tr_b16 a[96:97], v18 offset:16384
  v_mfma_f32_16x16x32_bf16 v[100:103], a[116:119], a[80:83], v[100:103]
  ds_read_b64_tr_b16 a[98:99], v18 offset:18432
  ds_read_b128 a[68:71], v16 offset:1024
  v_mfma_f32_16x16x32_bf16 v[116:119], a[116:119], a[84:87], v[116:119]
  buffer_store_dwordx4 v[152:155], v2, s[16:19], s7 offen offset:2048 sc1
  ds_read_b64_tr_b16 a[100:101], v19 offset:16384
  v_mfma_f32_16x16x32_bf16 v[104:107], a[120:123], a[80:83], v[104:107]
  ds_read_b64_tr_b16 a[102:103], v19 offset:18432
  ds_read_b64_tr_b16 a[104:105], v20 offset:16384
  v_mfma_f32_16x16x32_bf16 v[120:123], a[120:123], a[84:87], v[120:123]
  buffer_store_dwordx4 v[156:159], v2, s[16:19], s7 offen offset:3072 sc1
  ds_read_b64_tr_b16 a[106:107], v20 offset:18432
  v_mfma_f32_16x16x32_bf16 v[108:111], a[124:127], a[80:83], v[108:111]
  ds_read_b64_tr_b16 a[108:109], v21 offset:16384
  ds_read_b64_tr_b16 a[110:111], v21 offset:18432
  v_mfma_f32_16x16x32_bf16 v[124:127], a[124:127], a[84:87], v[124:127]
  v_pk_add_f32 v[160:161], v[160:161], v[32:33]
  v_pk_add_f32 v[162:163], v[162:163], v[34:35]
  v_pk_add_f32 v[164:165], v[164:165], v[36:37]
  v_pk_add_f32 v[166:167], v[166:167], v[38:39]
  v_cvt_pk_bf16_f32 v160, v160, v161
  v_cvt_pk_bf16_f32 v161, v162, v163
  v_cvt_pk_bf16_f32 v162, v164, v165
  v_cvt_pk_bf16_f32 v163, v166, v167
  s_nop 0
  v_permlane16_swap_b32 v160, v162
  v_permlane16_swap_b32 v161, v163
  s_waitcnt lgkmcnt(0)
  v_mfma_f32_16x16x32_bf16 v[96:99], a[96:99], a[64:67], v[96:99]
  s_sub_u32 s70, s70, 65536
  s_xor_b32 s70, s70, 524288
  s_sub_u32 s71, s71, 524288
  v_mfma_f32_16x16x32_bf16 v[112:115], a[96:99], a[68:71], v[112:115]
  s_xor_b32 s71, s71, 4194304
  s_add_u32 m0, s64, 16384
  ds_read_b128 a[80:83], v16 offset:8192
  v_mfma_f32_16x16x32_bf16 v[100:103], a[100:103], a[64:67], v[100:103]
  buffer_load_dwordx4 v10, s[12:15], s71 offen offset:0 lds
  ds_read_b64_tr_b16 a[112:113], v18 offset:20480
  v_mfma_f32_16x16x32_bf16 v[116:119], a[100:103], a[68:71], v[116:119]
  buffer_load_dwordx4 v11, s[12:15], s71 offen offset:1024 lds
  ds_read_b64_tr_b16 a[114:115], v18 offset:22528
  v_mfma_f32_16x16x32_bf16 v[104:107], a[104:107], a[64:67], v[104:107]
  buffer_load_dwordx4 v12, s[12:15], s71 offen offset:2048 lds
  ds_read_b128 a[84:87], v16 offset:9216
  v_mfma_f32_16x16x32_bf16 v[120:123], a[104:107], a[68:71], v[120:123]
  buffer_load_dwordx4 v13, s[12:15], s71 offen offset:3072 lds
  ds_read_b64_tr_b16 a[116:117], v19 offset:20480
  v_mfma_f32_16x16x32_bf16 v[108:111], a[108:111], a[64:67], v[108:111]
  s_add_u32 s71, s71, 131072
  s_add_u32 m0, s64, s88
  ds_read_b64_tr_b16 a[118:119], v19 offset:22528
  ds_read_b64_tr_b16 a[120:121], v20 offset:20480
  v_mfma_f32_16x16x32_bf16 v[124:127], a[108:111], a[68:71], v[124:127]
  buffer_load_dwordx4 v2, s[8:11], s70 offen offset:0 sc1 lds
  buffer_load_dwordx4 v2, s[8:11], s70 offen offset:1024 sc1 lds
  ds_read_b64_tr_b16 a[122:123], v20 offset:22528
  ds_read_b64_tr_b16 a[124:125], v21 offset:20480
  ds_read_b64_tr_b16 a[126:127], v21 offset:22528
  s_add_u32 s70, s70, 16384
  s_add_u32 s64, s64, s66
  s_add_u32 s65, s65, 1
  s_cmp_eq_u32 s65, 4
  s_cselect_b32 s65, 0, s65
  s_cselect_b32 s66, s67, s68
  v_add_u32 v16, s66, v16
  v_add_u32 v17, s66, v17
  v_add_u32 v18, s66, v18
  v_add_u32 v19, s66, v19
  v_add_u32 v20, s66, v20
  v_add_u32 v21, s66, v21
  buffer_store_dwordx4 v[160:163], v27, s[20:23], s4 offen offset:0
  s_waitcnt vmcnt(21) lgkmcnt(0)
  s_barrier
  v_mfma_f32_16x16x32_bf16 v[96:99], a[112:115], a[80:83], v[96:99]
  s_add_u32 m0, s64, 16384
  ds_read_b128 a[64:67], v16 offset:0
  ds_read_b64_tr_b16 a[96:97], v18 offset:16384
  v_mfma_f32_16x16x32_bf16 v[112:115], a[112:115], a[84:87], v[112:115]
  buffer_load_dwordx4 v10, s[12:15], s71 offen offset:0 lds
  ds_read_b64_tr_b16 a[98:99], v18 offset:18432
  v_mfma_f32_16x16x32_bf16 v[100:103], a[116:119], a[80:83], v[100:103]
  buffer_load_dwordx4 v11, s[12:15], s71 offen offset:1024 lds
  ds_read_b128 a[68:71], v16 offset:1024
  v_mfma_f32_16x16x32_bf16 v[116:119], a[116:119], a[84:87], v[116:119]
  ds_read_b64_tr_b16 a[100:101], v19 offset:16384
  ds_read_b64_tr_b16 a[102:103], v19 offset:18432
  v_mfma_f32_16x16x32_bf16 v[104:107], a[120:123], a[80:83], v[104:107]
  buffer_load_dwordx4 v12, s[12:15], s71 offen offset:2048 lds
  ds_read_b64_tr_b16 a[104:105], v20 offset:16384
  v_mfma_f32_16x16x32_bf16 v[120:123], a[120:123], a[84:87], v[120:123]
  ds_read_b64_tr_b16 a[106:107], v20 offset:18432
  ds_read_b64_tr_b16 a[108:109], v21 offset:16384
  v_mfma_f32_16x16x32_bf16 v[108:111], a[124:127], a[80:83], v[108:111]
  ds_read_b64_tr_b16 a[110:111], v21 offset:18432
  v_pk_add_f32 v[168:169], v[168:169], v[40:41]
  v_mfma_f32_16x16x32_bf16 v[124:127], a[124:127], a[84:87], v[124:127]
  v_pk_add_f32 v[170:171], v[170:171], v[42:43]
  v_pk_add_f32 v[172:173], v[172:173], v[44:45]
  v_pk_add_f32 v[174:175], v[174:175], v[46:47]
  v_cvt_pk_bf16_f32 v168, v168, v169
  v_cvt_pk_bf16_f32 v169, v170, v171
  v_cvt_pk_bf16_f32 v170, v172, v173
  v_cvt_pk_bf16_f32 v171, v174, v175
  s_nop 0
  v_permlane16_swap_b32 v168, v170
  v_permlane16_swap_b32 v169, v171
  s_waitcnt lgkmcnt(0)
  v_mfma_f32_16x16x32_bf16 v[96:99], a[96:99], a[64:67], v[96:99]
  buffer_load_dwordx4 v13, s[12:15], s71 offen offset:3072 lds
  ds_read_b128 a[80:83], v16 offset:8192
  v_mfma_f32_16x16x32_bf16 v[112:115], a[96:99], a[68:71], v[112:115]
  s_add_u32 s71, s71, 131072
  s_add_u32 m0, s64, s88
  ds_read_b64_tr_b16 a[112:113], v18 offset:20480
  v_mfma_f32_16x16x32_bf16 v[100:103], a[100:103], a[64:67], v[100:103]
  buffer_load_dwordx4 v2, s[8:11], s70 offen offset:0 sc1 lds
  ds_read_b64_tr_b16 a[114:115], v18 offset:22528
  v_mfma_f32_16x16x32_bf16 v[116:119], a[100:103], a[68:71], v[116:119]
  ds_read_b128 a[84:87], v16 offset:9216
  ds_read_b64_tr_b16 a[116:117], v19 offset:20480
  v_mfma_f32_16x16x32_bf16 v[104:107], a[104:107], a[64:67], v[104:107]
  buffer_load_dwordx4 v2, s[8:11], s70 offen offset:1024 sc1 lds
  ds_read_b64_tr_b16 a[118:119], v19 offset:22528
  v_mfma_f32_16x16x32_bf16 v[120:123], a[104:107], a[68:71], v[120:123]
  s_add_u32 s70, s70, 16384
  ds_read_b64_tr_b16 a[120:121], v20 offset:20480
  ds_read_b64_tr_b16 a[122:123], v20 offset:22528
  v_mfma_f32_16x16x32_bf16 v[108:111], a[108:111], a[64:67], v[108:111]
  s_add_u32 s64, s64, s66
  ds_read_b64_tr_b16 a[124:125], v21 offset:20480
  ds_read_b64_tr_b16 a[126:127], v21 offset:22528
  v_mfma_f32_16x16x32_bf16 v[124:127], a[108:111], a[68:71], v[124:127]
  s_add_u32 s65, s65, 1
  s_cmp_eq_u32 s65, 4
  s_cselect_b32 s65, 0, s65
  s_cselect_b32 s66, s67, s68
  v_add_u32 v16, s66, v16
  v_add_u32 v17, s66, v17
  v_add_u32 v18, s66, v18
  v_add_u32 v19, s66, v19
  v_add_u32 v20, s66, v20
  v_add_u32 v21, s66, v21
  buffer_store_dwordx4 v[168:171], v27, s[20:23], s4 offen offset:64
  s_waitcnt vmcnt(14) lgkmcnt(0)
  s_barrier
  v_mov_b32 v8, 0x40000000
  v_mov_b32 v6, s94
  v_cmp_eq_u32 vcc, 0, v0
  v_mov_b32 v7, s95
  s_nop 0
  v_cndmask_b32_e64 v8, v8, 0, vcc
  buffer_store_dwordx2 v[6:7], v8, s[96:99], s89 offen sc1
  v_mfma_f32_16x16x32_bf16 v[96:99], a[112:115], a[80:83], v[96:99]
  s_add_u32 m0, s64, 16384
  ds_read_b128 a[64:67], v16 offset:0
  ds_read_b64_tr_b16 a[96:97], v18 offset:16384
  v_mfma_f32_16x16x32_bf16 v[112:115], a[112:115], a[84:87], v[112:115]
  buffer_load_dwordx4 v10, s[12:15], s71 offen offset:0 lds
  ds_read_b64_tr_b16 a[98:99], v18 offset:18432
  v_mfma_f32_16x16x32_bf16 v[100:103], a[116:119], a[80:83], v[100:103]
  buffer_load_dwordx4 v11, s[12:15], s71 offen offset:1024 lds
  ds_read_b128 a[68:71], v16 offset:1024
  v_mfma_f32_16x16x32_bf16 v[116:119], a[116:119], a[84:87], v[116:119]
  ds_read_b64_tr_b16 a[100:101], v19 offset:16384
  ds_read_b64_tr_b16 a[102:103], v19 offset:18432
  v_mfma_f32_16x16x32_bf16 v[104:107], a[120:123], a[80:83], v[104:107]
  buffer_load_dwordx4 v12, s[12:15], s71 offen offset:2048 lds
  ds_read_b64_tr_b16 a[104:105], v20 offset:16384
  v_mfma_f32_16x16x32_bf16 v[120:123], a[120:123], a[84:87], v[120:123]
  ds_read_b64_tr_b16 a[106:107], v20 offset:18432
  ds_read_b64_tr_b16 a[108:109], v21 offset:16384
  v_mfma_f32_16x16x32_bf16 v[108:111], a[124:127], a[80:83], v[108:111]
  ds_read_b64_tr_b16 a[110:111], v21 offset:18432
  v_pk_add_f32 v[176:177], v[176:177], v[48:49]
  v_mfma_f32_16x16x32_bf16 v[124:127], a[124:127], a[84:87], v[124:127]
  v_pk_add_f32 v[178:179], v[178:179], v[50:51]
  v_pk_add_f32 v[180:181], v[180:181], v[52:53]
  v_pk_add_f32 v[182:183], v[182:183], v[54:55]
  v_cvt_pk_bf16_f32 v176, v176, v177
  v_cvt_pk_bf16_f32 v177, v178, v179
  v_cvt_pk_bf16_f32 v178, v180, v181
  v_cvt_pk_bf16_f32 v179, v182, v183
  s_nop 0
  v_permlane16_swap_b32 v176, v178
  v_permlane16_swap_b32 v177, v179
  s_waitcnt lgkmcnt(0)
  v_mfma_f32_16x16x32_bf16 v[96:99], a[96:99], a[64:67], v[96:99]
  buffer_load_dwordx4 v13, s[12:15], s71 offen offset:3072 lds
  ds_read_b128 a[80:83], v16 offset:8192
  v_mfma_f32_16x16x32_bf16 v[112:115], a[96:99], a[68:71], v[112:115]
  s_add_u32 s71, s71, 131072
  s_add_u32 m0, s64, s88
  ds_read_b64_tr_b16 a[112:113], v18 offset:20480
  v_mfma_f32_16x16x32_bf16 v[100:103], a[100:103], a[64:67], v[100:103]
  buffer_load_dwordx4 v2, s[8:11], s70 offen offset:0 sc1 lds
  ds_read_b64_tr_b16 a[114:115], v18 offset:22528
  v_mfma_f32_16x16x32_bf16 v[116:119], a[100:103], a[68:71], v[116:119]
  ds_read_b128 a[84:87], v16 offset:9216
  ds_read_b64_tr_b16 a[116:117], v19 offset:20480
  v_mfma_f32_16x16x32_bf16 v[104:107], a[104:107], a[64:67], v[104:107]
  buffer_load_dwordx4 v2, s[8:11], s70 offen offset:1024 sc1 lds
  ds_read_b64_tr_b16 a[118:119], v19 offset:22528
  v_mfma_f32_16x16x32_bf16 v[120:123], a[104:107], a[68:71], v[120:123]
  s_add_u32 s70, s70, 16384
  ds_read_b64_tr_b16 a[120:121], v20 offset:20480
  ds_read_b64_tr_b16 a[122:123], v20 offset:22528
  v_mfma_f32_16x16x32_bf16 v[108:111], a[108:111], a[64:67], v[108:111]
  s_add_u32 s64, s64, s66
  ds_read_b64_tr_b16 a[124:125], v21 offset:20480
  ds_read_b64_tr_b16 a[126:127], v21 offset:22528
  v_mfma_f32_16x16x32_bf16 v[124:127], a[108:111], a[68:71], v[124:127]
  s_add_u32 s65, s65, 1
  s_cmp_eq_u32 s65, 4
  s_cselect_b32 s65, 0, s65
  s_cselect_b32 s66, s67, s68
  v_add_u32 v16, s66, v16
  v_add_u32 v17, s66, v17
  v_add_u32 v18, s66, v18
  v_add_u32 v19, s66, v19
  v_add_u32 v20, s66, v20
  v_add_u32 v21, s66, v21
  buffer_store_dwordx4 v[176:179], v27, s[20:23], s5 offen offset:0
  s_waitcnt vmcnt(16) lgkmcnt(0)
  s_barrier
  v_mfma_f32_16x16x32_bf16 v[96:99], a[112:115], a[80:83], v[96:99]
  s_add_u32 m0, s64, 16384
  ds_read_b128 a[64:67], v16 offset:0
  ds_read_b64_tr_b16 a[96:97], v18 offset:16384
  v_mfma_f32_16x16x32_bf16 v[112:115], a[112:115], a[84:87], v[112:115]
  buffer_load_dwordx4 v10, s[12:15], s71 offen offset:0 lds
  ds_read_b64_tr_b16 a[98:99], v18 offset:18432
  v_mfma_f32_16x16x32_bf16 v[100:103], a[116:119], a[80:83], v[100:103]
  buffer_load_dwordx4 v11, s[12:15], s71 offen offset:1024 lds
  ds_read_b128 a[68:71], v16 offset:1024
  v_mfma_f32_16x16x32_bf16 v[116:119], a[116:119], a[84:87], v[116:119]
  ds_read_b64_tr_b16 a[100:101], v19 offset:16384
  ds_read_b64_tr_b16 a[102:103], v19 offset:18432
  v_mfma_f32_16x16x32_bf16 v[104:107], a[120:123], a[80:83], v[104:107]
  buffer_load_dwordx4 v12, s[12:15], s71 offen offset:2048 lds
  ds_read_b64_tr_b16 a[104:105], v20 offset:16384
  v_mfma_f32_16x16x32_bf16 v[120:123], a[120:123], a[84:87], v[120:123]
  ds_read_b64_tr_b16 a[106:107], v20 offset:18432
  ds_read_b64_tr_b16 a[108:109], v21 offset:16384
  v_mfma_f32_16x16x32_bf16 v[108:111], a[124:127], a[80:83], v[108:111]
  ds_read_b64_tr_b16 a[110:111], v21 offset:18432
  v_pk_add_f32 v[184:185], v[184:185], v[56:57]
  v_mfma_f32_16x16x32_bf16 v[124:127], a[124:127], a[84:87], v[124:127]
  v_pk_add_f32 v[186:187], v[186:187], v[58:59]
  v_pk_add_f32 v[188:189], v[188:189], v[60:61]
  v_pk_add_f32 v[190:191], v[190:191], v[62:63]
  v_cvt_pk_bf16_f32 v184, v184, v185
  v_cvt_pk_bf16_f32 v185, v186, v187
  v_cvt_pk_bf16_f32 v186, v188, v189
  v_cvt_pk_bf16_f32 v187, v190, v191
  s_nop 0
  v_permlane16_swap_b32 v184, v186
  v_permlane16_swap_b32 v185, v187
  s_waitcnt lgkmcnt(0)
  v_mfma_f32_16x16x32_bf16 v[96:99], a[96:99], a[64:67], v[96:99]
  buffer_load_dwordx4 v13, s[12:15], s71 offen offset:3072 lds
  ds_read_b128 a[80:83], v16 offset:8192
  v_mfma_f32_16x16x32_bf16 v[112:115], a[96:99], a[68:71], v[112:115]
  s_add_u32 s71, s71, 131072
  s_add_u32 m0, s64, s88
  ds_read_b64_tr_b16 a[112:113], v18 offset:20480
  v_mfma_f32_16x16x32_bf16 v[100:103], a[100:103], a[64:67], v[100:103]
  buffer_load_dwordx4 v2, s[8:11], s70 offen offset:0 sc1 lds
  ds_read_b64_tr_b16 a[114:115], v18 offset:22528
  v_mfma_f32_16x16x32_bf16 v[116:119], a[100:103], a[68:71], v[116:119]
  ds_read_b128 a[84:87], v16 offset:9216
  ds_read_b64_tr_b16 a[116:117], v19 offset:20480
  v_mfma_f32_16x16x32_bf16 v[104:107], a[104:107], a[64:67], v[104:107]
  buffer_load_dwordx4 v2, s[8:11], s70 offen offset:1024 sc1 lds
  ds_read_b64_tr_b16 a[118:119], v19 offset:22528
  v_mfma_f32_16x16x32_bf16 v[120:123], a[104:107], a[68:71], v[120:123]
  s_add_u32 s70, s70, 16384
  ds_read_b64_tr_b16 a[120:121], v20 offset:20480
  ds_read_b64_tr_b16 a[122:123], v20 offset:22528
  v_mfma_f32_16x16x32_bf16 v[108:111], a[108:111], a[64:67], v[108:111]
  s_add_u32 s64, s64, s66
  ds_read_b64_tr_b16 a[124:125], v21 offset:20480
  ds_read_b64_tr_b16 a[126:127], v21 offset:22528
  v_mfma_f32_16x16x32_bf16 v[124:127], a[108:111], a[68:71], v[124:127]
  s_add_u32 s65, s65, 1
  s_cmp_eq_u32 s65, 4
  s_cselect_b32 s65, 0, s65
  s_cselect_b32 s66, s67, s68
  v_add_u32 v16, s66, v16
  v_add_u32 v17, s66, v17
  v_add_u32 v18, s66, v18
  v_add_u32 v19, s66, v19
  v_add_u32 v20, s66, v20
  v_add_u32 v21, s66, v21
  buffer_store_dwordx4 v[184:187], v27, s[20:23], s5 offen offset:64
  s_waitcnt vmcnt(16) lgkmcnt(0)
  s_barrier
  v_mfma_f32_16x16x32_bf16 v[96:99], a[112:115], a[80:83], v[96:99]
  buffer_load_dwordx2 v[6:7], off, s[96:99], s90 sc1
  ds_read_b128 a[64:67], v16 offset:0
  v_mfma_f32_16x16x32_bf16 v[112:115], a[112:115], a[84:87], v[112:115]
  ds_read_b64_tr_b16 a[96:97], v18 offset:16384
  ds_read_b64_tr_b16 a[98:99], v18 offset:18432
  v_mfma_f32_16x16x32_bf16 v[100:103], a[116:119], a[80:83], v[100:103]
  ds_read_b128 a[68:71], v16 offset:1024
  ds_read_b64_tr_b16 a[100:101], v19 offset:16384
  v_mfma_f32_16x16x32_bf16 v[116:119], a[116:119], a[84:87], v[116:119]
  ds_read_b64_tr_b16 a[102:103], v19 offset:18432
  ds_read_b64_tr_b16 a[104:105], v20 offset:16384
  v_mfma_f32_16x16x32_bf16 v[104:107], a[120:123], a[80:83], v[104:107]
  ds_read_b64_tr_b16 a[106:107], v20 offset:18432
  ds_read_b64_tr_b16 a[108:109], v21 offset:16384
  v_mfma_f32_16x16x32_bf16 v[120:123], a[120:123], a[84:87], v[120:123]
  ds_read_b64_tr_b16 a[110:111], v21 offset:18432
  v_mfma_f32_16x16x32_bf16 v[108:111], a[124:127], a[80:83], v[108:111]
  v_mfma_f32_16x16x32_bf16 v[124:127], a[124:127], a[84:87], v[124:127]
  s_waitcnt lgkmcnt(0)
  v_mfma_f32_16x16x32_bf16 v[96:99], a[96:99], a[64:67], v[96:99]
  s_add_u32 s64, s64, s66
  ds_read_b128 a[80:83], v16 offset:8192
  ds_read_b64_tr_b16 a[112:113], v18 offset:20480
  v_mfma_f32_16x16x32_bf16 v[112:115], a[96:99], a[68:71], v[112:115]
  s_add_u32 s65, s65, 1
  ds_read_b64_tr_b16 a[114:115], v18 offset:22528
  ds_read_b128 a[84:87], v16 offset:9216
  v_mfma_f32_16x16x32_bf16 v[100:103], a[100:103], a[64:67], v[100:103]
  s_cmp_eq_u32 s65, 4
  s_cselect_b32 s65, 0, s65
  s_cselect_b32 s66, s67, s68
  ds_read_b64_tr_b16 a[116:117], v19 offset:20480
  v_mfma_f32_16x16x32_bf16 v[116:119], a[100:103], a[68:71], v[116:119]
  ds_read_b64_tr_b16 a[118:119], v19 offset:22528
  ds_read_b64_tr_b16 a[120:121], v20 offset:20480
  v_mfma_f32_16x16x32_bf16 v[104:107], a[104:107], a[64:67], v[104:107]
  ds_read_b64_tr_b16 a[122:123], v20 offset:22528
  ds_read_b64_tr_b16 a[124:125], v21 offset:20480
  v_mfma_f32_16x16x32_bf16 v[120:123], a[104:107], a[68:71], v[120:123]
  ds_read_b64_tr_b16 a[126:127], v21 offset:22528
  v_mfma_f32_16x16x32_bf16 v[108:111], a[108:111], a[64:67], v[108:111]
  v_add_u32 v16, s66, v16
  v_add_u32 v17, s66, v17
  v_add_u32 v20, s66, v20
  v_mfma_f32_16x16x32_bf16 v[124:127], a[108:111], a[68:71], v[124:127]
  v_add_u32 v18, s66, v18
  v_add_u32 v19, s66, v19
  v_add_u32 v21, s66, v21
  s_waitcnt vmcnt(0) lgkmcnt(0)
  s_barrier
  s_mov_b32 s5, 0x40000
Lpoll_13:
  v_cmp_ne_u64 vcc, s[94:95], v[6:7]
  s_nop 0
  s_cbranch_vccz Lpolld_14
  s_sleep 4
  buffer_load_dwordx2 v[6:7], off, s[96:99], s90 sc1
  s_sub_u32 s5, s5, 1
  s_waitcnt vmcnt(0)
  s_cbranch_scc0 Lpoll_13
Lpolld_14:
  v_mfma_f32_16x16x32_bf16 v[96:99], a[112:115], a[80:83], v[96:99]
  s_lshl_b32 s6, s78, 1
  s_add_u32 s6, s6, s77
  s_lshl_b32 s6, s6, 2
  v_mfma_f32_16x16x32_bf16 v[112:115], a[112:115], a[84:87], v[112:115]
  s_add_u32 s6, s6, s3
  s_lshl_b32 s6, s6, 13
  s_add_u32 s7, s6, 4096
  v_mfma_f32_16x16x32_bf16 v[100:103], a[116:119], a[80:83], v[100:103]
  buffer_load_dwordx4 v[192:195], v2, s[16:19], s6 offen offset:0 sc1
  ds_read_b128 a[64:67], v16 offset:0
  v_mfma_f32_16x16x32_bf16 v[116:119], a[116:119], a[84:87], v[116:119]
  buffer_load_dwordx4 v[196:199], v2, s[16:19], s6 offen offset:1024 sc1
  ds_read_b64_tr_b16 a[96:97], v18 offset:16384
  v_mfma_f32_16x16x32_bf16 v[104:107], a[120:123], a[80:83], v[104:107]
  buffer_load_dwordx4 v[200:203], v2, s[16:19], s6 offen offset:2048 sc1
  ds_read_b64_tr_b16 a[98:99], v18 offset:18432
  v_mfma_f32_16x16x32_bf16 v[120:123], a[120:123], a[84:87], v[120:123]
  buffer_load_dwordx4 v[204:207], v2, s[16:19], s6 offen offset:3072 sc1
  ds_read_b128 a[68:71], v16 offset:1024
  v_mfma_f32_16x16x32_bf16 v[108:111], a[124:127], a[80:83], v[108:111]
  ds_read_b64_tr_b16 a[100:101], v19 offset:16384
  ds_read_b64_tr_b16 a[102:103], v19 offset:18432
  v_mfma_f32_16x16x32_bf16 v[124:127], a[124:127], a[84:87], v[124:127]
  ds_read_b64_tr_b16 a[104:105], v20 offset:16384
  ds_read_b64_tr_b16 a[106:107], v20 offset:18432
  ds_read_b64_tr_b16 a[108:109], v21 offset:16384
  ds_read_b64_tr_b16 a[110:111], v21 offset:18432
  s_waitcnt lgkmcnt(0)
  v_mfma_f32_16x16x32_bf16 v[96:99], a[96:99], a[64:67], v[96:99]
  buffer_load_dwordx4 v[208:211], v2, s[16:19], s7 offen offset:0 sc1
  ds_read_b128 a[80:83], v16 offset:8192
  v_mfma_f32_16x16x32_bf16 v[112:115], a[96:99], a[68:71], v[112:115]
  buffer_load_dwordx4 v[212:215], v2, s[16:19], s7 offen offset:1024 sc1
  ds_read_b64_tr_b16 a[112:113], v18 offset:20480
  v_mfma_f32_16x16x32_bf16 v[100:103], a[100:103], a[64:67], v[100:103]
  ds_read_b64_tr_b16 a[114:115], v18 offset:22528
  ds_read_b128 a[84:87], v16 offset:9216
  v_mfma_f32_16x16x32_bf16 v[116:119], a[100:103], a[68:71], v[116:119]
  buffer_load_dwordx4 v[216:219], v2, s[16:19], s7 offen offset:2048 sc1
  ds_read_b64_tr_b16 a[116:117], v19 offset:20480
  v_mfma_f32_16x16x32_bf16 v[104:107], a[104:107], a[64:67], v[104:107]
  ds_read_b64_tr_b16 a[118:119], v19 offset:22528
  ds_read_b64_tr_b16 a[120:121], v20 offset:20480
  v_mfma_f32_16x16x32_bf16 v[120:123], a[104:107], a[68:71], v[120:123]
  buffer_load_dwordx4 v[220:223], v2, s[16:19], s7 offen offset:3072 sc1
  ds_read_b64_tr_b16 a[122:123], v20 offset:22528
  v_mfma_f32_16x16x32_bf16 v[108:111], a[108:111], a[64:67], v[108:111]
  s_add_u32 s64, s64, s66
  ds_read_b64_tr_b16 a[124:125], v21 offset:20480
  ds_read_b64_tr_b16 a[126:127], v21 offset:22528
  v_mfma_f32_16x16x32_bf16 v[124:127], a[108:111], a[68:71], v[124:127]
  s_add_u32 s65, s65, 1
  s_cmp_eq_u32 s65, 4
  s_cselect_b32 s65, 0, s65
  s_cselect_b32 s66, s67, s68
  v_add_u32 v16, s66, v16
  v_add_u32 v17, s66, v17
  v_add_u32 v18, s66, v18
  v_add_u32 v19, s66, v19
  v_add_u32 v20, s66, v20
  v_add_u32 v21, s66, v21
  s_waitcnt vmcnt(8) lgkmcnt(0)
  s_barrier
  v_mfma_f32_16x16x32_bf16 v[96:99], a[112:115], a[80:83], v[96:99]
  ds_read_b128 a[64:67], v16 offset:0
  ds_read_b64_tr_b16 a[96:97], v18 offset:16384
  v_mfma_f32_16x16x32_bf16 v[112:115], a[112:115], a[84:87], v[112:115]
  ds_read_b64_tr_b16 a[98:99], v18 offset:18432
  ds_read_b128 a[68:71], v16 offset:1024
  v_mfma_f32_16x16x32_bf16 v[100:103], a[116:119], a[80:83], v[100:103]
  ds_read_b64_tr_b16 a[100:101], v19 offset:16384
  v_mfma_f32_16x16x32_bf16 v[116:119], a[116:119], a[84:87], v[116:119]
  ds_read_b64_tr_b16 a[102:103], v19 offset:18432
  ds_read_b64_tr_b16 a[104:105], v20 offset:16384
  v_mfma_f32_16x16x32_bf16 v[104:107], a[120:123], a[80:83], v[104:107]
  ds_read_b64_tr_b16 a[106:107], v20 offset:18432
  ds_read_b64_tr_b16 a[108:109], v21 offset:16384
  v_mfma_f32_16x16x32_bf16 v[120:123], a[120:123], a[84:87], v[120:123]
  ds_read_b64_tr_b16 a[110:111], v21 offset:18432
  v_mfma_f32_16x16x32_bf16 v[108:111], a[124:127], a[80:83], v[108:111]
  v_mfma_f32_16x16x32_bf16 v[124:127], a[124:127], a[84:87], v[124:127]
  s_waitcnt lgkmcnt(0)
  v_mfma_f32_16x16x32_bf16 v[96:99], a[96:99], a[64:67], v[96:99]
  ds_read_b128 a[80:83], v16 offset:8192
  ds_read_b64_tr_b16 a[112:113], v18 offset:20480
  v_mfma_f32_16x16x32_bf16 v[112:115], a[96:99], a[68:71], v[112:115]
  ds_read_b64_tr_b16 a[114:115], v18 offset:22528
  ds_read_b128 a[84:87], v16 offset:9216
  v_mfma_f32_16x16x32_bf16 v[100:103], a[100:103], a[64:67], v[100:103]
  ds_read_b64_tr_b16 a[116:117], v19 offset:20480
  v_mfma_f32_16x16x32_bf16 v[116:119], a[100:103], a[68:71], v[116:119]
  ds_read_b64_tr_b16 a[118:119], v19 offset:22528
  ds_read_b64_tr_b16 a[120:121], v20 offset:20480
  v_mfma_f32_16x16x32_bf16 v[104:107], a[104:107], a[64:67], v[104:107]
  ds_read_b64_tr_b16 a[122:123], v20 offset:22528
  ds_read_b64_tr_b16 a[124:125], v21 offset:20480
  v_mfma_f32_16x16x32_bf16 v[120:123], a[104:107], a[68:71], v[120:123]
  ds_read_b64_tr_b16 a[126:127], v21 offset:22528
  v_mfma_f32_16x16x32_bf16 v[108:111], a[108:111], a[64:67], v[108:111]
  v_mfma_f32_16x16x32_bf16 v[124:127], a[108:111], a[68:71], v[124:127]
  s_lshl_b32 s4, s73, 19
  s_lshl_b32 s72, s76, 8
  s_add_u32 s4, s4, s72
  s_and_b32 s72, s3, 1
  s_lshl_b32 s72, s72, 7
  s_add_u32 s4, s4, s72
  s_lshr_b32 s72, s3, 1
  s_lshl_b32 s72, s72, 1
  s_add_u32 s72, s72, s77
  s_lshl_b32 s72, s72, 12
  s_add_u32 s4, s4, s72
  s_add_u32 s5, s4, 262144
  s_waitcnt lgkmcnt(0)
  v_mfma_f32_16x16x32_bf16 v[96:99], a[112:115], a[80:83], v[96:99]
  v_mfma_f32_16x16x32_bf16 v[112:115], a[112:115], a[84:87], v[112:115]
  v_mfma_f32_16x16x32_bf16 v[100:103], a[116:119], a[80:83], v[100:103]
  v_mfma_f32_16x16x32_bf16 v[116:119], a[116:119], a[84:87], v[116:119]
  v_mfma_f32_16x16x32_bf16 v[104:107], a[120:123], a[80:83], v[104:107]
  v_mfma_f32_16x16x32_bf16 v[120:123], a[120:123], a[84:87], v[120:123]
  v_mfma_f32_16x16x32_bf16 v[108:111], a[124:127], a[80:83], v[108:111]
  v_mfma_f32_16x16x32_bf16 v[124:127], a[124:127], a[84:87], v[124:127]
  s_waitcnt vmcnt(0)
  v_pk_add_f32 v[192:193], v[192:193], v[96:97]
  s_nop 2
  v_pk_add_f32 v[200:201], v[200:201], v[104:105]
  v_pk_add_f32 v[208:209], v[208:209], v[112:113]
  v_pk_add_f32 v[216:217], v[216:217], v[120:121]
  v_pk_add_f32 v[194:195], v[194:195], v[98:99]
  v_pk_add_f32 v[202:203], v[202:203], v[106:107]
  v_pk_add_f32 v[210:211], v[210:211], v[114:115]
  v_pk_add_f32 v[218:219], v[218:219], v[122:123]
  v_pk_add_f32 v[196:197], v[196:197], v[100:101]
  v_pk_add_f32 v[204:205], v[204:205], v[108:109]
  v_pk_add_f32 v[212:213], v[212:213], v[116:117]
  v_pk_add_f32 v[220:221], v[220:221], v[124:125]
  v_pk_add_f32 v[198:199], v[198:199], v[102:103]
  v_pk_add_f32 v[206:207], v[206:207], v[110:111]
  v_pk_add_f32 v[214:215], v[214:215], v[118:119]
  v_pk_add_f32 v[222:223], v[222:223], v[126:127]
  v_cvt_pk_bf16_f32 v192, v192, v193
  v_cvt_pk_bf16_f32 v200, v200, v201
  v_cvt_pk_bf16_f32 v208, v208, v209
  v_cvt_pk_bf16_f32 v216, v216, v217
  v_cvt_pk_bf16_f32 v193, v194, v195
  v_cvt_pk_bf16_f32 v201, v202, v203
  v_cvt_pk_bf16_f32 v209, v210, v211
  v_cvt_pk_bf16_f32 v217, v218, v219
  v_cvt_pk_bf16_f32 v194, v196, v197
  v_cvt_pk_bf16_f32 v202, v204, v205
  v_cvt_pk_bf16_f32 v210, v212, v213
  v_cvt_pk_bf16_f32 v218, v220, v221
  v_cvt_pk_bf16_f32 v195, v198, v199
  v_cvt_pk_bf16_f32 v203, v206, v207
  v_cvt_pk_bf16_f32 v211, v214, v215
  v_cvt_pk_bf16_f32 v219, v222, v223
  v_permlane16_swap_b32 v192, v194
  v_permlane16_swap_b32 v200, v202
  v_permlane16_swap_b32 v208, v210
  v_permlane16_swap_b32 v216, v218
  v_permlane16_swap_b32 v193, v195
  v_permlane16_swap_b32 v201, v203
  v_permlane16_swap_b32 v209, v211
  v_permlane16_swap_b32 v217, v219
  buffer_store_dwordx4 v[192:195], v26, s[20:23], s4 offen offset:0
  buffer_store_dwordx4 v[200:203], v26, s[20:23], s4 offen offset:64
  buffer_store_dwordx4 v[208:211], v26, s[20:23], s5 offen offset:0
  buffer_store_dwordx4 v[216:219], v26, s[20:23], s5 offen offset:64
Lend:
  s_endpgm
.section .rodata,"a"
.p2align 6
.amdhsa_kernel concat_heads__compressed_kv_cla__sliding_local_dilated__prompt_kernel
  .amdhsa_next_free_vgpr 512
  .amdhsa_next_free_sgpr 102
  .amdhsa_accum_offset 256
  .amdhsa_group_segment_fixed_size 0
  .amdhsa_kernarg_size 96
  .amdhsa_user_sgpr_count 2
  .amdhsa_user_sgpr_kernarg_segment_ptr 1
  .amdhsa_system_sgpr_workgroup_id_x 1
.end_amdhsa_kernel
```

```asm
; @launch grid=(256,1,1) block=(256,1,1) lds=163840
.amdgcn_target "amdgcn-amd-amdhsa--gfx950"
.text
.globl concat_heads__compressed_kv_cla__sliding_local_dilated__prompt_kernel
.p2align 8
.type concat_heads__compressed_kv_cla__sliding_local_dilated__prompt_kernel,@function
concat_heads__compressed_kv_cla__sliding_local_dilated__prompt_kernel:
  s_cmp_ge_u32 s2, 256
  s_cbranch_scc1 Lend
  s_load_dwordx16 s[64:79], s[0:1], 0
  s_load_dwordx8 s[80:87], s[0:1], 64
  v_lshrrev_b32 v2, 6, v0
  v_and_b32 v1, 63, v0
  v_readfirstlane_b32 s3, v2
  v_lshlrev_b32 v2, 4, v1
  s_bfe_u32 s59, s2, 0x30003
  s_lshr_b32 s4, s2, 7
  s_lshl_b32 s4, s4, 3
  s_add_u32 s59, s59, s4
  s_lshr_b32 s4, s2, 3
  s_xor_b32 s4, s4, s2
  s_bitcmp1_b32 s4, 3
  s_cbranch_scc1 Lp2
  s_and_b32 s4, s2, 1
  s_lshl_b32 s4, s4, 2
  s_and_b32 s5, s59, 3
  s_add_u32 s61, s4, s5
  s_bfe_u32 s4, s2, 0x20001
  s_lshl_b32 s4, s4, 2
  s_lshr_b32 s5, s59, 2
  s_add_u32 s62, s4, s5
  s_lshl_b32 s4, s3, 13
  s_add_u32 s36, s4, 65536
  s_add_u32 s41, s4, 98304
  v_lshrrev_b32 v32, 3, v1
  v_and_b32 v33, 6, v32
  v_and_b32 v34, 7, v1
  v_xor_b32 v33, v33, v34
  v_lshlrev_b32 v33, 4, v33
  s_lshl_b32 s4, s61, 2
  s_add_u32 s4, s4, s3
  s_lshl_b32 s4, s4, 6
  v_add_u32 v34, s4, v32
  v_lshl_add_u32 v34, v34, 10, v33
  v_add_u32 v48, 0, v34
  v_add_u32 v49, 7168, v34
  v_add_u32 v50, 14336, v34
  v_add_u32 v51, 21504, v34
  v_add_u32 v52, 32768, v34
  v_add_u32 v53, 39936, v34
  v_add_u32 v54, 47104, v34
  v_add_u32 v55, 54272, v34
  v_lshrrev_b32 v34, 2, v32
  v_and_b32 v35, 3, v32
  v_lshl_add_u32 v34, v34, 3, v35
  s_lshl_b32 s4, s62, 2
  s_add_u32 s4, s4, s3
  s_lshl_b32 s4, s4, 7
  v_lshl_add_u32 v34, v34, 13, v33
  v_add_u32 v34, s4, v34
  v_add_u32 v56, 0, v34
  v_add_u32 v57, 130048, v34
  v_add_u32 v58, 30720, v34
  v_add_u32 v59, 160768, v34
  v_add_u32 v60, 262144, v34
  v_add_u32 v61, 392192, v34
  v_add_u32 v62, 292864, v34
  v_add_u32 v63, 422912, v34
  s_and_b32 s6, s2, 7
  s_add_u32 s4, s61, s62
  s_and_b32 s49, s4, 3
  s_lshl_b32 s49, s49, 3
  s_or_b32 s49, s49, 0x80000
  s_bfe_u32 s48, 0x70702, s49
  s_add_u32 s48, s48, s6
  s_and_b32 s48, s48, 7
  s_lshl_b32 s46, s48, 7
  s_waitcnt lgkmcnt(0)
  s_mov_b32 s8, s66
  s_mov_b32 s9, s67
  s_mov_b32 s10, 2097152
  s_mov_b32 s11, 0x00020000
  s_mov_b32 s12, s70
  s_mov_b32 s13, s71
  s_mov_b32 s14, 4194304
  s_mov_b32 s15, 0x00020000
  s_mov_b32 s50, 9
  s_add_u32 s96, s86, 125829120
  s_addc_u32 s97, s87, 0
  s_mov_b32 s98, 262144
  s_mov_b32 s99, 0x00020000
  s_or_b32 s4, s2, s3
  s_cbranch_scc1 Ltag_1
  s_mov_b32 s4, 196608
  buffer_load_dwordx2 v[22:23], off, s[96:99], s4 sc1
Ltag_1:
  s_mov_b32 m0, s36
  s_nop 0
  buffer_load_dwordx4 v48, s[8:11], s46 offen offset:0 lds
  buffer_load_dwordx4 v49, s[8:11], s46 offen offset:1024 lds
  buffer_load_dwordx4 v50, s[8:11], s46 offen offset:2048 lds
  buffer_load_dwordx4 v51, s[8:11], s46 offen offset:3072 lds
  s_add_u32 m0, s36, 4096
  s_nop 0
  buffer_load_dwordx4 v52, s[8:11], s46 offen offset:0 lds
  buffer_load_dwordx4 v53, s[8:11], s46 offen offset:1024 lds
  buffer_load_dwordx4 v54, s[8:11], s46 offen offset:2048 lds
  buffer_load_dwordx4 v55, s[8:11], s46 offen offset:3072 lds
  s_sub_u32 s50, s50, 1
  s_cmp_eq_u32 s50, 0
  s_cselect_b32 s12, s72, s12
  s_cselect_b32 s13, s73, s13
  s_lshl_b32 s47, s48, 19
  s_bfe_u32 s34, 0x3020106, s49
  s_add_u32 s48, s48, s34
  s_add_u32 s49, s49, 8
  s_and_b32 s49, s49, 0x8001f
  s_and_b32 s48, s48, 7
  s_lshl_b32 s46, s48, 7
  s_mov_b32 m0, s41
  s_nop 0
  buffer_load_dwordx4 v56, s[12:15], s47 offen offset:0 lds
  buffer_load_dwordx4 v57, s[12:15], s47 offen offset:1024 lds
  buffer_load_dwordx4 v58, s[12:15], s47 offen offset:2048 lds
  buffer_load_dwordx4 v59, s[12:15], s47 offen offset:3072 lds
  s_add_u32 m0, s41, 4096
  s_nop 0
  buffer_load_dwordx4 v60, s[12:15], s47 offen offset:0 lds
  buffer_load_dwordx4 v61, s[12:15], s47 offen offset:1024 lds
  buffer_load_dwordx4 v62, s[12:15], s47 offen offset:2048 lds
  buffer_load_dwordx4 v63, s[12:15], s47 offen offset:3072 lds
  s_lshr_b32 s4, s3, 1
  s_lshl_b32 s4, s4, 14
  s_add_u32 s4, s4, 65536
  v_and_b32 v32, 15, v1
  v_lshlrev_b32 v32, 7, v32
  v_lshrrev_b32 v33, 4, v1
  v_and_b32 v34, 6, v1
  v_xor_b32 v33, v33, v34
  v_lshl_add_u32 v32, v33, 4, v32
  v_add_u32 v16, s4, v32
  v_xor_b32 v17, 64, v16
  s_and_b32 s4, s3, 1
  s_lshl_b32 s4, s4, 14
  s_add_u32 s4, s4, 98304
  v_lshrrev_b32 v32, 2, v1
  v_and_b32 v33, 6, v32
  v_lshlrev_b32 v32, 7, v32
  v_and_b32 v34, 1, v1
  v_lshl_add_u32 v32, v34, 3, v32
  v_add_u32 v32, s4, v32
  v_bfe_u32 v34, v1, 1, 1
  v_xor_b32 v33, v33, v34
  v_xor_b32 v34, 0, v33
  v_lshl_add_u32 v18, v34, 4, v32
  v_xor_b32 v34, 2, v33
  v_lshl_add_u32 v19, v34, 4, v32
  v_xor_b32 v34, 4, v33
  v_lshl_add_u32 v20, v34, 4, v32
  s_add_u32 m0, s36, -65536
  s_nop 0
  buffer_load_dwordx4 v48, s[8:11], s46 offen offset:0 lds
  v_xor_b32 v34, 6, v33
  v_lshl_add_u32 v21, v34, 4, v32
  s_and_b32 s24, s2, 7
  s_lshr_b32 s4, s2, 6
  s_lshl_b32 s4, s4, 3
  s_add_u32 s24, s24, s4
  s_lshr_b32 s25, s2, 3
  s_and_b32 s25, s25, 7
  v_lshrrev_b32 v24, 3, v1
  v_and_b32 v25, 6, v24
  v_and_b32 v26, 7, v1
  v_xor_b32 v25, v25, v26
  buffer_load_dwordx4 v49, s[8:11], s46 offen offset:1024 lds
  v_lshlrev_b32 v25, 4, v25
  s_and_b32 s4, s3, 1
  s_lshl_b32 s4, s4, 16
  s_lshr_b32 s5, s3, 1
  s_lshl_b32 s5, s5, 7
  s_add_u32 s4, s4, s5
  v_lshl_add_u32 v24, v24, 11, v25
  v_add_u32 v24, s4, v24
  v_add_u32 v25, 0, v24
  v_accvgpr_write_b32 a212, v25
  v_add_u32 v25, 15360, v24
  buffer_load_dwordx4 v50, s[8:11], s46 offen offset:2048 lds
  v_accvgpr_write_b32 a213, v25
  v_add_u32 v25, 30720, v24
  v_accvgpr_write_b32 a214, v25
  v_add_u32 v25, 46080, v24
  v_accvgpr_write_b32 a215, v25
  buffer_load_dwordx4 v51, s[8:11], s46 offen offset:3072 lds
  v_accvgpr_write_b32 a236, 0
  v_mov_b32 v27, 0x3f803f80
  v_accvgpr_write_b32 a208, v27
  v_accvgpr_write_b32 a237, 0
  v_accvgpr_write_b32 a209, v27
  s_add_u32 m0, s36, -61440
  s_nop 0
  buffer_load_dwordx4 v52, s[8:11], s46 offen offset:0 lds
  v_accvgpr_write_b32 a238, 0
  v_accvgpr_write_b32 a210, v27
  v_accvgpr_write_b32 a239, 0
  v_accvgpr_write_b32 a211, v27
  v_lshrrev_b32 v24, 3, v1
  buffer_load_dwordx4 v53, s[8:11], s46 offen offset:1024 lds
  v_and_b32 v25, 6, v24
  v_and_b32 v26, 7, v1
  v_xor_b32 v25, v25, v26
  v_lshlrev_b32 v25, 4, v25
  v_lshlrev_b32 v26, 2, v24
  buffer_load_dwordx4 v54, s[8:11], s46 offen offset:2048 lds
  v_add_u32 v26, s3, v26
  v_lshl_add_u32 v26, v26, 11, v25
  v_add_u32 v27, 0, v26
  v_accvgpr_write_b32 a222, v27
  v_add_u32 v27, 64512, v26
  buffer_load_dwordx4 v55, s[8:11], s46 offen offset:3072 lds
  v_accvgpr_write_b32 a223, v27
  v_add_u32 v27, 129024, v26
  v_accvgpr_write_b32 a224, v27
  v_add_u32 v27, 193536, v26
  v_accvgpr_write_b32 a225, v27
  s_sub_u32 s50, s50, 1
  s_cmp_eq_u32 s50, 0
  s_cselect_b32 s12, s72, s12
  s_cselect_b32 s13, s73, s13
  s_lshl_b32 s47, s48, 19
  s_bfe_u32 s34, 0x3020106, s49
  s_add_u32 s48, s48, s34
  s_add_u32 s49, s49, 8
  s_and_b32 s49, s49, 0x8001f
  s_and_b32 s48, s48, 7
  s_lshl_b32 s46, s48, 7
  s_add_u32 m0, s41, 32768
  s_nop 0
  buffer_load_dwordx4 v56, s[12:15], s47 offen offset:0 lds
  v_lshrrev_b32 v26, 2, v24
  v_and_b32 v27, 3, v24
  v_lshl_add_u32 v26, v26, 3, v27
  s_and_b32 s4, s3, 1
  s_lshl_b32 s4, s4, 18
  s_lshr_b32 s5, s3, 1
  s_lshl_b32 s5, s5, 7
  s_add_u32 s4, s4, s5
  s_lshl_b32 s5, s24, 8
  s_add_u32 s4, s4, s5
  v_lshl_add_u32 v26, v26, 13, v25
  v_add_u32 v26, s4, v26
  v_add_u32 v27, 0, v26
  buffer_load_dwordx4 v57, s[12:15], s47 offen offset:1024 lds
  v_accvgpr_write_b32 a226, v27
  v_add_u32 v27, 130048, v26
  v_accvgpr_write_b32 a227, v27
  v_add_u32 v27, 30720, v26
  v_accvgpr_write_b32 a228, v27
  buffer_load_dwordx4 v58, s[12:15], s47 offen offset:2048 lds
  v_add_u32 v27, 160768, v26
  v_accvgpr_write_b32 a229, v27
  s_lshl_b32 s4, s3, 13
  s_add_u32 s4, s4, 98304
  v_and_b32 v24, 15, v1
  v_lshlrev_b32 v24, 7, v24
  v_lshrrev_b32 v25, 4, v1
  v_and_b32 v26, 6, v1
  buffer_load_dwordx4 v59, s[12:15], s47 offen offset:3072 lds
  v_xor_b32 v25, v25, v26
  v_lshl_add_u32 v24, v25, 4, v24
  v_add_u32 v28, s4, v24
  v_xor_b32 v29, 64, v28
  v_lshrrev_b32 v24, 2, v1
  s_add_u32 m0, s41, 36864
  s_nop 0
  buffer_load_dwordx4 v60, s[12:15], s47 offen offset:0 lds
  v_and_b32 v25, 6, v24
  v_lshlrev_b32 v24, 7, v24
  v_and_b32 v26, 1, v1
  v_lshl_add_u32 v24, v26, 3, v24
  v_add_u32 v24, 0, v24
  buffer_load_dwordx4 v61, s[12:15], s47 offen offset:1024 lds
  v_bfe_u32 v26, v1, 1, 1
  v_xor_b32 v25, v25, v26
  v_xor_b32 v26, 0, v25
  v_lshl_add_u32 v30, v26, 4, v24
  v_xor_b32 v26, 2, v25
  buffer_load_dwordx4 v62, s[12:15], s47 offen offset:2048 lds
  v_lshl_add_u32 v31, v26, 4, v24
  v_xor_b32 v26, 4, v25
  v_lshl_add_u32 v32, v26, 4, v24
  v_xor_b32 v26, 6, v25
  v_lshl_add_u32 v33, v26, 4, v24
  buffer_load_dwordx4 v63, s[12:15], s47 offen offset:3072 lds
  v_accvgpr_write_b32 a230, v28
  v_accvgpr_write_b32 a231, v29
  v_accvgpr_write_b32 a232, v30
  v_accvgpr_write_b32 a233, v31
  v_accvgpr_write_b32 a234, v32
  v_accvgpr_write_b32 a235, v33
  s_and_b32 s4, s3, 1
  s_lshl_b32 s5, s62, 1
  s_add_u32 s4, s4, s5
  s_lshr_b32 s5, s3, 1
  s_lshl_b32 s6, s61, 1
  s_add_u32 s5, s5, s6
  s_add_u32 s16, s86, 16777216
  s_addc_u32 s17, s87, 0
  s_mov_b32 s18, 33554432
  s_mov_b32 s19, 0x00020000
  s_lshl_b32 s4, s4, 20
  s_lshl_b32 s5, s5, 16
  s_add_u32 s63, s4, s5
  s_mov_b32 s37, 0
  s_mov_b32 s39, 4294901760
  s_mov_b32 s40, 32768
  s_mov_b32 s37, 2
  s_mov_b32 s42, 0
  s_mov_b32 s44, 4294934528
  s_mov_b32 s45, 32768
  s_mov_b32 s43, s44
  s_or_b32 s4, s2, s3
  s_cbranch_scc1 Ltag_2
  s_mov_b32 s4, 196608
  s_mov_b32 s92, s84
  s_mov_b32 s93, s85
  s_mov_b32 s94, 256
  s_mov_b32 s95, 0x00020000
  s_waitcnt vmcnt(32)
  v_add_u32 v22, 1, v22
  v_or_b32 v23, 0x80000000, v23
  buffer_store_dwordx2 v[22:23], off, s[96:99], s4 sc1
  buffer_store_dwordx2 v[22:23], off, s[92:95], 0 sc1
Ltag_2:
  s_waitcnt vmcnt(16)
  s_barrier
  ds_read_b128 a[0:3], v16 offset:0
  ds_read_b64_tr_b16 a[64:65], v18 offset:0
  ds_read_b64_tr_b16 a[66:67], v18 offset:2048
  ds_read_b128 a[4:7], v16 offset:2048
  ds_read_b128 a[8:11], v16 offset:4096
  ds_read_b128 a[12:15], v16 offset:6144
  ds_read_b128 a[16:19], v16 offset:8192
  ds_read_b128 a[20:23], v16 offset:10240
  ds_read_b128 a[24:27], v16 offset:12288
  ds_read_b128 a[28:31], v16 offset:14336
  ds_read_b64_tr_b16 a[68:69], v19 offset:0
  ds_read_b64_tr_b16 a[70:71], v19 offset:2048
  ds_read_b64_tr_b16 a[72:73], v20 offset:0
  ds_read_b64_tr_b16 a[74:75], v20 offset:2048
  ds_read_b64_tr_b16 a[76:77], v21 offset:0
  ds_read_b64_tr_b16 a[78:79], v21 offset:2048
  ds_read_b64_tr_b16 a[80:81], v18 offset:8192
  ds_read_b64_tr_b16 a[82:83], v18 offset:10240
  ds_read_b64_tr_b16 a[84:85], v19 offset:8192
  ds_read_b64_tr_b16 a[86:87], v19 offset:10240
  ds_read_b64_tr_b16 a[88:89], v20 offset:8192
  ds_read_b64_tr_b16 a[90:91], v20 offset:10240
  ds_read_b64_tr_b16 a[92:93], v21 offset:8192
  ds_read_b64_tr_b16 a[94:95], v21 offset:10240
  s_waitcnt lgkmcnt(0)
  v_mfma_f32_16x16x32_bf16 v[64:67], a[64:67], a[0:3], 0
  s_add_u32 m0, s36, -32768
  ds_read_b128 a[32:35], v17 offset:0
  v_mfma_f32_16x16x32_bf16 v[96:99], a[64:67], a[4:7], 0
  buffer_load_dwordx4 v48, s[8:11], s46 offen offset:0 lds
  v_mfma_f32_16x16x32_bf16 v[128:131], a[64:67], a[8:11], 0
  ds_read_b64_tr_b16 a[96:97], v18 offset:4096
  v_mfma_f32_16x16x32_bf16 v[160:163], a[64:67], a[12:15], 0
  v_mfma_f32_16x16x32_bf16 v[192:195], a[64:67], a[16:19], 0
  ds_read_b64_tr_b16 a[98:99], v18 offset:6144
  v_mfma_f32_16x16x32_bf16 v[224:227], a[64:67], a[20:23], 0
  v_mfma_f32_16x16x32_bf16 a[128:131], a[64:67], a[24:27], 0
  ds_read_b128 a[36:39], v17 offset:2048
  v_mfma_f32_16x16x32_bf16 a[160:163], a[64:67], a[28:31], 0
  buffer_load_dwordx4 v49, s[8:11], s46 offen offset:1024 lds
  v_mfma_f32_16x16x32_bf16 v[68:71], a[68:71], a[0:3], 0
  v_mfma_f32_16x16x32_bf16 v[100:103], a[68:71], a[4:7], 0
  ds_read_b128 a[40:43], v17 offset:4096
  v_mfma_f32_16x16x32_bf16 v[132:135], a[68:71], a[8:11], 0
  v_mfma_f32_16x16x32_bf16 v[164:167], a[68:71], a[12:15], 0
  ds_read_b128 a[44:47], v17 offset:6144
  v_mfma_f32_16x16x32_bf16 v[196:199], a[68:71], a[16:19], 0
  v_mfma_f32_16x16x32_bf16 v[228:231], a[68:71], a[20:23], 0
  ds_read_b128 a[48:51], v17 offset:8192
  v_mfma_f32_16x16x32_bf16 a[132:135], a[68:71], a[24:27], 0
  buffer_load_dwordx4 v50, s[8:11], s46 offen offset:2048 lds
  v_mfma_f32_16x16x32_bf16 a[164:167], a[68:71], a[28:31], 0
  ds_read_b128 a[52:55], v17 offset:10240
  v_mfma_f32_16x16x32_bf16 v[72:75], a[72:75], a[0:3], 0
  v_mfma_f32_16x16x32_bf16 v[104:107], a[72:75], a[4:7], 0
  v_mfma_f32_16x16x32_bf16 v[136:139], a[72:75], a[8:11], 0
  ds_read_b128 a[56:59], v17 offset:12288
  v_mfma_f32_16x16x32_bf16 v[168:171], a[72:75], a[12:15], 0
  v_mfma_f32_16x16x32_bf16 v[200:203], a[72:75], a[16:19], 0
  ds_read_b128 a[60:63], v17 offset:14336
  v_mfma_f32_16x16x32_bf16 v[232:235], a[72:75], a[20:23], 0
  buffer_load_dwordx4 v51, s[8:11], s46 offen offset:3072 lds
  v_mfma_f32_16x16x32_bf16 a[136:139], a[72:75], a[24:27], 0
  s_add_u32 m0, s36, -28672
  ds_read_b64_tr_b16 a[100:101], v19 offset:4096
  v_mfma_f32_16x16x32_bf16 a[168:171], a[72:75], a[28:31], 0
  v_mfma_f32_16x16x32_bf16 v[76:79], a[76:79], a[0:3], 0
  ds_read_b64_tr_b16 a[102:103], v19 offset:6144
  v_mfma_f32_16x16x32_bf16 v[108:111], a[76:79], a[4:7], 0
  v_mfma_f32_16x16x32_bf16 v[140:143], a[76:79], a[8:11], 0
  v_mfma_f32_16x16x32_bf16 v[172:175], a[76:79], a[12:15], 0
  ds_read_b64_tr_b16 a[104:105], v20 offset:4096
  v_mfma_f32_16x16x32_bf16 v[204:207], a[76:79], a[16:19], 0
  buffer_load_dwordx4 v52, s[8:11], s46 offen offset:0 lds
  v_mfma_f32_16x16x32_bf16 v[236:239], a[76:79], a[20:23], 0
  ds_read_b64_tr_b16 a[106:107], v20 offset:6144
  v_mfma_f32_16x16x32_bf16 a[140:143], a[76:79], a[24:27], 0
  v_mfma_f32_16x16x32_bf16 a[172:175], a[76:79], a[28:31], 0
  ds_read_b64_tr_b16 a[108:109], v21 offset:4096
  v_mfma_f32_16x16x32_bf16 v[80:83], a[80:83], a[0:3], 0
  v_mfma_f32_16x16x32_bf16 v[112:115], a[80:83], a[4:7], 0
  ds_read_b64_tr_b16 a[110:111], v21 offset:6144
  v_mfma_f32_16x16x32_bf16 v[144:147], a[80:83], a[8:11], 0
  v_mfma_f32_16x16x32_bf16 v[176:179], a[80:83], a[12:15], 0
  buffer_load_dwordx4 v53, s[8:11], s46 offen offset:1024 lds
  v_mfma_f32_16x16x32_bf16 v[208:211], a[80:83], a[16:19], 0
  ds_read_b64_tr_b16 a[112:113], v18 offset:12288
  v_mfma_f32_16x16x32_bf16 v[240:243], a[80:83], a[20:23], 0
  v_mfma_f32_16x16x32_bf16 a[144:147], a[80:83], a[24:27], 0
  ds_read_b64_tr_b16 a[114:115], v18 offset:14336
  v_mfma_f32_16x16x32_bf16 a[176:179], a[80:83], a[28:31], 0
  v_mfma_f32_16x16x32_bf16 v[84:87], a[84:87], a[0:3], 0
  ds_read_b64_tr_b16 a[116:117], v19 offset:12288
  v_mfma_f32_16x16x32_bf16 v[116:119], a[84:87], a[4:7], 0
  v_mfma_f32_16x16x32_bf16 v[148:151], a[84:87], a[8:11], 0
  buffer_load_dwordx4 v54, s[8:11], s46 offen offset:2048 lds
  ds_read_b64_tr_b16 a[118:119], v19 offset:14336
  v_mfma_f32_16x16x32_bf16 v[180:183], a[84:87], a[12:15], 0
  v_mfma_f32_16x16x32_bf16 v[212:215], a[84:87], a[16:19], 0
  v_mfma_f32_16x16x32_bf16 v[244:247], a[84:87], a[20:23], 0
  ds_read_b64_tr_b16 a[120:121], v20 offset:12288
  v_mfma_f32_16x16x32_bf16 a[148:151], a[84:87], a[24:27], 0
  v_mfma_f32_16x16x32_bf16 a[180:183], a[84:87], a[28:31], 0
  ds_read_b64_tr_b16 a[122:123], v20 offset:14336
  v_mfma_f32_16x16x32_bf16 v[88:91], a[88:91], a[0:3], 0
  v_mfma_f32_16x16x32_bf16 v[120:123], a[88:91], a[4:7], 0
  buffer_load_dwordx4 v55, s[8:11], s46 offen offset:3072 lds
  ds_read_b64_tr_b16 a[124:125], v21 offset:12288
  v_mfma_f32_16x16x32_bf16 v[152:155], a[88:91], a[8:11], 0
  s_sub_u32 s50, s50, 1
  s_cmp_eq_u32 s50, 0
  s_cselect_b32 s12, s72, s12
  s_cselect_b32 s13, s73, s13
  v_mfma_f32_16x16x32_bf16 v[184:187], a[88:91], a[12:15], 0
  s_lshl_b32 s47, s48, 19
  s_bfe_u32 s34, 0x3020106, s49
  s_add_u32 s48, s48, s34
  v_mfma_f32_16x16x32_bf16 v[216:219], a[88:91], a[16:19], 0
  s_add_u32 s49, s49, 8
  s_and_b32 s49, s49, 0x8001f
  s_and_b32 s48, s48, 7
  v_mfma_f32_16x16x32_bf16 v[248:251], a[88:91], a[20:23], 0
  s_lshl_b32 s46, s48, 7
  ds_read_b64_tr_b16 a[126:127], v21 offset:14336
  v_mfma_f32_16x16x32_bf16 a[152:155], a[88:91], a[24:27], 0
  s_add_u32 s37, s37, 1
  s_cmp_eq_u32 s37, 3
  s_cselect_b32 s37, 0, s37
  s_cselect_b32 s38, s39, s40
  v_mfma_f32_16x16x32_bf16 a[184:187], a[88:91], a[28:31], 0
  s_sub_u32 s43, 0, s43
  v_mfma_f32_16x16x32_bf16 v[92:95], a[92:95], a[0:3], 0
  v_add_u32 v16, s38, v16
  v_add_u32 v17, s38, v17
  v_mfma_f32_16x16x32_bf16 v[124:127], a[92:95], a[4:7], 0
  v_add_u32 v18, s43, v18
  v_add_u32 v19, s43, v19
  v_mfma_f32_16x16x32_bf16 v[156:159], a[92:95], a[8:11], 0
  v_add_u32 v20, s43, v20
  v_add_u32 v21, s43, v21
  v_mfma_f32_16x16x32_bf16 v[188:191], a[92:95], a[12:15], 0
  v_mfma_f32_16x16x32_bf16 v[220:223], a[92:95], a[16:19], 0
  v_mfma_f32_16x16x32_bf16 v[252:255], a[92:95], a[20:23], 0
  v_mfma_f32_16x16x32_bf16 a[156:159], a[92:95], a[24:27], 0
  v_mfma_f32_16x16x32_bf16 a[188:191], a[92:95], a[28:31], 0
  s_mov_b32 s35, 6
  s_waitcnt vmcnt(8) lgkmcnt(0)
  s_barrier
  .p2align 6
Lp1wx_loop:
  v_mfma_f32_16x16x32_bf16 v[64:67], a[96:99], a[32:35], v[64:67]
  s_mov_b32 m0, s41
  ds_read_b128 a[0:3], v16 offset:0
  v_mfma_f32_16x16x32_bf16 v[96:99], a[96:99], a[36:39], v[96:99]
  buffer_load_dwordx4 v56, s[12:15], s47 offen offset:0 lds
  v_mfma_f32_16x16x32_bf16 v[128:131], a[96:99], a[40:43], v[128:131]
  ds_read_b64_tr_b16 a[64:65], v18 offset:0
  v_mfma_f32_16x16x32_bf16 v[160:163], a[96:99], a[44:47], v[160:163]
  v_mfma_f32_16x16x32_bf16 v[192:195], a[96:99], a[48:51], v[192:195]
  ds_read_b64_tr_b16 a[66:67], v18 offset:2048
  v_mfma_f32_16x16x32_bf16 v[224:227], a[96:99], a[52:55], v[224:227]
  v_mfma_f32_16x16x32_bf16 a[128:131], a[96:99], a[56:59], a[128:131]
  ds_read_b128 a[4:7], v16 offset:2048
  v_mfma_f32_16x16x32_bf16 a[160:163], a[96:99], a[60:63], a[160:163]
  buffer_load_dwordx4 v57, s[12:15], s47 offen offset:1024 lds
  v_mfma_f32_16x16x32_bf16 v[68:71], a[100:103], a[32:35], v[68:71]
  v_mfma_f32_16x16x32_bf16 v[100:103], a[100:103], a[36:39], v[100:103]
  ds_read_b128 a[8:11], v16 offset:4096
  v_mfma_f32_16x16x32_bf16 v[132:135], a[100:103], a[40:43], v[132:135]
  v_mfma_f32_16x16x32_bf16 v[164:167], a[100:103], a[44:47], v[164:167]
  ds_read_b128 a[12:15], v16 offset:6144
  v_mfma_f32_16x16x32_bf16 v[196:199], a[100:103], a[48:51], v[196:199]
  v_mfma_f32_16x16x32_bf16 v[228:231], a[100:103], a[52:55], v[228:231]
  ds_read_b128 a[16:19], v16 offset:8192
  v_mfma_f32_16x16x32_bf16 a[132:135], a[100:103], a[56:59], a[132:135]
  v_mfma_f32_16x16x32_bf16 a[164:167], a[100:103], a[60:63], a[164:167]
  buffer_load_dwordx4 v58, s[12:15], s47 offen offset:2048 lds
  ds_read_b128 a[20:23], v16 offset:10240
  v_mfma_f32_16x16x32_bf16 v[72:75], a[104:107], a[32:35], v[72:75]
  v_mfma_f32_16x16x32_bf16 v[104:107], a[104:107], a[36:39], v[104:107]
  v_mfma_f32_16x16x32_bf16 v[136:139], a[104:107], a[40:43], v[136:139]
  ds_read_b128 a[24:27], v16 offset:12288
  v_mfma_f32_16x16x32_bf16 v[168:171], a[104:107], a[44:47], v[168:171]
  v_mfma_f32_16x16x32_bf16 v[200:203], a[104:107], a[48:51], v[200:203]
  ds_read_b128 a[28:31], v16 offset:14336
  v_mfma_f32_16x16x32_bf16 v[232:235], a[104:107], a[52:55], v[232:235]
  v_mfma_f32_16x16x32_bf16 a[136:139], a[104:107], a[56:59], a[136:139]
  ds_read_b64_tr_b16 a[68:69], v19 offset:0
  v_mfma_f32_16x16x32_bf16 a[168:171], a[104:107], a[60:63], a[168:171]
  buffer_load_dwordx4 v59, s[12:15], s47 offen offset:3072 lds
  v_mfma_f32_16x16x32_bf16 v[76:79], a[108:111], a[32:35], v[76:79]
  s_add_u32 m0, s41, 4096
  ds_read_b64_tr_b16 a[70:71], v19 offset:2048
  v_mfma_f32_16x16x32_bf16 v[108:111], a[108:111], a[36:39], v[108:111]
  v_mfma_f32_16x16x32_bf16 v[140:143], a[108:111], a[40:43], v[140:143]
  v_mfma_f32_16x16x32_bf16 v[172:175], a[108:111], a[44:47], v[172:175]
  ds_read_b64_tr_b16 a[72:73], v20 offset:0
  v_mfma_f32_16x16x32_bf16 v[204:207], a[108:111], a[48:51], v[204:207]
  v_mfma_f32_16x16x32_bf16 v[236:239], a[108:111], a[52:55], v[236:239]
  ds_read_b64_tr_b16 a[74:75], v20 offset:2048
  v_mfma_f32_16x16x32_bf16 a[140:143], a[108:111], a[56:59], a[140:143]
  v_mfma_f32_16x16x32_bf16 a[172:175], a[108:111], a[60:63], a[172:175]
  buffer_load_dwordx4 v60, s[12:15], s47 offen offset:0 lds
  ds_read_b64_tr_b16 a[76:77], v21 offset:0
  v_mfma_f32_16x16x32_bf16 v[80:83], a[112:115], a[32:35], v[80:83]
  v_mfma_f32_16x16x32_bf16 v[112:115], a[112:115], a[36:39], v[112:115]
  ds_read_b64_tr_b16 a[78:79], v21 offset:2048
  v_mfma_f32_16x16x32_bf16 v[144:147], a[112:115], a[40:43], v[144:147]
  v_mfma_f32_16x16x32_bf16 v[176:179], a[112:115], a[44:47], v[176:179]
  v_mfma_f32_16x16x32_bf16 v[208:211], a[112:115], a[48:51], v[208:211]
  ds_read_b64_tr_b16 a[80:81], v18 offset:8192
  v_mfma_f32_16x16x32_bf16 v[240:243], a[112:115], a[52:55], v[240:243]
  v_mfma_f32_16x16x32_bf16 a[144:147], a[112:115], a[56:59], a[144:147]
  ds_read_b64_tr_b16 a[82:83], v18 offset:10240
  v_mfma_f32_16x16x32_bf16 a[176:179], a[112:115], a[60:63], a[176:179]
  buffer_load_dwordx4 v61, s[12:15], s47 offen offset:1024 lds
  v_mfma_f32_16x16x32_bf16 v[84:87], a[116:119], a[32:35], v[84:87]
  ds_read_b64_tr_b16 a[84:85], v19 offset:8192
  v_mfma_f32_16x16x32_bf16 v[116:119], a[116:119], a[36:39], v[116:119]
  v_mfma_f32_16x16x32_bf16 v[148:151], a[116:119], a[40:43], v[148:151]
  ds_read_b64_tr_b16 a[86:87], v19 offset:10240
  v_mfma_f32_16x16x32_bf16 v[180:183], a[116:119], a[44:47], v[180:183]
  v_mfma_f32_16x16x32_bf16 v[212:215], a[116:119], a[48:51], v[212:215]
  v_mfma_f32_16x16x32_bf16 v[244:247], a[116:119], a[52:55], v[244:247]
  ds_read_b64_tr_b16 a[88:89], v20 offset:8192
  v_mfma_f32_16x16x32_bf16 a[148:151], a[116:119], a[56:59], a[148:151]
  v_mfma_f32_16x16x32_bf16 a[180:183], a[116:119], a[60:63], a[180:183]
  buffer_load_dwordx4 v62, s[12:15], s47 offen offset:2048 lds
  ds_read_b64_tr_b16 a[90:91], v20 offset:10240
  v_mfma_f32_16x16x32_bf16 v[88:91], a[120:123], a[32:35], v[88:91]
  v_mfma_f32_16x16x32_bf16 v[120:123], a[120:123], a[36:39], v[120:123]
  ds_read_b64_tr_b16 a[92:93], v21 offset:8192
  v_mfma_f32_16x16x32_bf16 v[152:155], a[120:123], a[40:43], v[152:155]
  v_mfma_f32_16x16x32_bf16 v[184:187], a[120:123], a[44:47], v[184:187]
  ds_read_b64_tr_b16 a[94:95], v21 offset:10240
  v_mfma_f32_16x16x32_bf16 v[216:219], a[120:123], a[48:51], v[216:219]
  v_mfma_f32_16x16x32_bf16 v[248:251], a[120:123], a[52:55], v[248:251]
  v_mfma_f32_16x16x32_bf16 a[152:155], a[120:123], a[56:59], a[152:155]
  v_mfma_f32_16x16x32_bf16 a[184:187], a[120:123], a[60:63], a[184:187]
  buffer_load_dwordx4 v63, s[12:15], s47 offen offset:3072 lds
  v_mfma_f32_16x16x32_bf16 v[92:95], a[124:127], a[32:35], v[92:95]
  v_mfma_f32_16x16x32_bf16 v[124:127], a[124:127], a[36:39], v[124:127]
  v_mfma_f32_16x16x32_bf16 v[156:159], a[124:127], a[40:43], v[156:159]
  v_mfma_f32_16x16x32_bf16 v[188:191], a[124:127], a[44:47], v[188:191]
  v_mfma_f32_16x16x32_bf16 v[220:223], a[124:127], a[48:51], v[220:223]
  v_mfma_f32_16x16x32_bf16 v[252:255], a[124:127], a[52:55], v[252:255]
  v_mfma_f32_16x16x32_bf16 a[156:159], a[124:127], a[56:59], a[156:159]
  v_mfma_f32_16x16x32_bf16 a[188:191], a[124:127], a[60:63], a[188:191]
  s_waitcnt lgkmcnt(0)
  v_mfma_f32_16x16x32_bf16 v[64:67], a[64:67], a[0:3], v[64:67]
  s_mov_b32 m0, s36
  ds_read_b128 a[32:35], v17 offset:0
  v_mfma_f32_16x16x32_bf16 v[96:99], a[64:67], a[4:7], v[96:99]
  buffer_load_dwordx4 v48, s[8:11], s46 offen offset:0 lds
  v_mfma_f32_16x16x32_bf16 v[128:131], a[64:67], a[8:11], v[128:131]
  ds_read_b64_tr_b16 a[96:97], v18 offset:4096
  v_mfma_f32_16x16x32_bf16 v[160:163], a[64:67], a[12:15], v[160:163]
  v_mfma_f32_16x16x32_bf16 v[192:195], a[64:67], a[16:19], v[192:195]
  ds_read_b64_tr_b16 a[98:99], v18 offset:6144
  v_mfma_f32_16x16x32_bf16 v[224:227], a[64:67], a[20:23], v[224:227]
  v_mfma_f32_16x16x32_bf16 a[128:131], a[64:67], a[24:27], a[128:131]
  ds_read_b128 a[36:39], v17 offset:2048
  v_mfma_f32_16x16x32_bf16 a[160:163], a[64:67], a[28:31], a[160:163]
  buffer_load_dwordx4 v49, s[8:11], s46 offen offset:1024 lds
  v_mfma_f32_16x16x32_bf16 v[68:71], a[68:71], a[0:3], v[68:71]
  v_mfma_f32_16x16x32_bf16 v[100:103], a[68:71], a[4:7], v[100:103]
  ds_read_b128 a[40:43], v17 offset:4096
  v_mfma_f32_16x16x32_bf16 v[132:135], a[68:71], a[8:11], v[132:135]
  v_mfma_f32_16x16x32_bf16 v[164:167], a[68:71], a[12:15], v[164:167]
  ds_read_b128 a[44:47], v17 offset:6144
  v_mfma_f32_16x16x32_bf16 v[196:199], a[68:71], a[16:19], v[196:199]
  v_mfma_f32_16x16x32_bf16 v[228:231], a[68:71], a[20:23], v[228:231]
  ds_read_b128 a[48:51], v17 offset:8192
  v_mfma_f32_16x16x32_bf16 a[132:135], a[68:71], a[24:27], a[132:135]
  buffer_load_dwordx4 v50, s[8:11], s46 offen offset:2048 lds
  v_mfma_f32_16x16x32_bf16 a[164:167], a[68:71], a[28:31], a[164:167]
  ds_read_b128 a[52:55], v17 offset:10240
  v_mfma_f32_16x16x32_bf16 v[72:75], a[72:75], a[0:3], v[72:75]
  v_mfma_f32_16x16x32_bf16 v[104:107], a[72:75], a[4:7], v[104:107]
  v_mfma_f32_16x16x32_bf16 v[136:139], a[72:75], a[8:11], v[136:139]
  ds_read_b128 a[56:59], v17 offset:12288
  v_mfma_f32_16x16x32_bf16 v[168:171], a[72:75], a[12:15], v[168:171]
  v_mfma_f32_16x16x32_bf16 v[200:203], a[72:75], a[16:19], v[200:203]
  ds_read_b128 a[60:63], v17 offset:14336
  v_mfma_f32_16x16x32_bf16 v[232:235], a[72:75], a[20:23], v[232:235]
  buffer_load_dwordx4 v51, s[8:11], s46 offen offset:3072 lds
  v_mfma_f32_16x16x32_bf16 a[136:139], a[72:75], a[24:27], a[136:139]
  s_add_u32 m0, s36, 4096
  ds_read_b64_tr_b16 a[100:101], v19 offset:4096
  v_mfma_f32_16x16x32_bf16 a[168:171], a[72:75], a[28:31], a[168:171]
  v_mfma_f32_16x16x32_bf16 v[76:79], a[76:79], a[0:3], v[76:79]
  ds_read_b64_tr_b16 a[102:103], v19 offset:6144
  v_mfma_f32_16x16x32_bf16 v[108:111], a[76:79], a[4:7], v[108:111]
  v_mfma_f32_16x16x32_bf16 v[140:143], a[76:79], a[8:11], v[140:143]
  v_mfma_f32_16x16x32_bf16 v[172:175], a[76:79], a[12:15], v[172:175]
  ds_read_b64_tr_b16 a[104:105], v20 offset:4096
  v_mfma_f32_16x16x32_bf16 v[204:207], a[76:79], a[16:19], v[204:207]
  buffer_load_dwordx4 v52, s[8:11], s46 offen offset:0 lds
  v_mfma_f32_16x16x32_bf16 v[236:239], a[76:79], a[20:23], v[236:239]
  ds_read_b64_tr_b16 a[106:107], v20 offset:6144
  v_mfma_f32_16x16x32_bf16 a[140:143], a[76:79], a[24:27], a[140:143]
  v_mfma_f32_16x16x32_bf16 a[172:175], a[76:79], a[28:31], a[172:175]
  ds_read_b64_tr_b16 a[108:109], v21 offset:4096
  v_mfma_f32_16x16x32_bf16 v[80:83], a[80:83], a[0:3], v[80:83]
  v_mfma_f32_16x16x32_bf16 v[112:115], a[80:83], a[4:7], v[112:115]
  ds_read_b64_tr_b16 a[110:111], v21 offset:6144
  v_mfma_f32_16x16x32_bf16 v[144:147], a[80:83], a[8:11], v[144:147]
  v_mfma_f32_16x16x32_bf16 v[176:179], a[80:83], a[12:15], v[176:179]
  buffer_load_dwordx4 v53, s[8:11], s46 offen offset:1024 lds
  v_mfma_f32_16x16x32_bf16 v[208:211], a[80:83], a[16:19], v[208:211]
  ds_read_b64_tr_b16 a[112:113], v18 offset:12288
  v_mfma_f32_16x16x32_bf16 v[240:243], a[80:83], a[20:23], v[240:243]
  v_mfma_f32_16x16x32_bf16 a[144:147], a[80:83], a[24:27], a[144:147]
  ds_read_b64_tr_b16 a[114:115], v18 offset:14336
  v_mfma_f32_16x16x32_bf16 a[176:179], a[80:83], a[28:31], a[176:179]
  v_mfma_f32_16x16x32_bf16 v[84:87], a[84:87], a[0:3], v[84:87]
  ds_read_b64_tr_b16 a[116:117], v19 offset:12288
  v_mfma_f32_16x16x32_bf16 v[116:119], a[84:87], a[4:7], v[116:119]
  v_mfma_f32_16x16x32_bf16 v[148:151], a[84:87], a[8:11], v[148:151]
  buffer_load_dwordx4 v54, s[8:11], s46 offen offset:2048 lds
  ds_read_b64_tr_b16 a[118:119], v19 offset:14336
  v_mfma_f32_16x16x32_bf16 v[180:183], a[84:87], a[12:15], v[180:183]
  v_mfma_f32_16x16x32_bf16 v[212:215], a[84:87], a[16:19], v[212:215]
  v_mfma_f32_16x16x32_bf16 v[244:247], a[84:87], a[20:23], v[244:247]
  ds_read_b64_tr_b16 a[120:121], v20 offset:12288
  v_mfma_f32_16x16x32_bf16 a[148:151], a[84:87], a[24:27], a[148:151]
  v_mfma_f32_16x16x32_bf16 a[180:183], a[84:87], a[28:31], a[180:183]
  ds_read_b64_tr_b16 a[122:123], v20 offset:14336
  v_mfma_f32_16x16x32_bf16 v[88:91], a[88:91], a[0:3], v[88:91]
  v_mfma_f32_16x16x32_bf16 v[120:123], a[88:91], a[4:7], v[120:123]
  buffer_load_dwordx4 v55, s[8:11], s46 offen offset:3072 lds
  ds_read_b64_tr_b16 a[124:125], v21 offset:12288
  v_mfma_f32_16x16x32_bf16 v[152:155], a[88:91], a[8:11], v[152:155]
  s_sub_u32 s50, s50, 1
  s_cmp_eq_u32 s50, 0
  s_cselect_b32 s12, s72, s12
  s_cselect_b32 s13, s73, s13
  v_mfma_f32_16x16x32_bf16 v[184:187], a[88:91], a[12:15], v[184:187]
  s_lshl_b32 s47, s48, 19
  s_bfe_u32 s34, 0x3020106, s49
  s_add_u32 s48, s48, s34
  v_mfma_f32_16x16x32_bf16 v[216:219], a[88:91], a[16:19], v[216:219]
  s_add_u32 s49, s49, 8
  s_and_b32 s49, s49, 0x8001f
  s_and_b32 s48, s48, 7
  v_mfma_f32_16x16x32_bf16 v[248:251], a[88:91], a[20:23], v[248:251]
  s_lshl_b32 s46, s48, 7
  ds_read_b64_tr_b16 a[126:127], v21 offset:14336
  v_mfma_f32_16x16x32_bf16 a[152:155], a[88:91], a[24:27], a[152:155]
  s_add_u32 s36, s36, s38
  s_add_u32 s37, s37, 1
  s_cmp_eq_u32 s37, 3
  s_cselect_b32 s37, 0, s37
  s_cselect_b32 s38, s39, s40
  v_mfma_f32_16x16x32_bf16 a[184:187], a[88:91], a[28:31], a[184:187]
  s_add_u32 s41, s41, s43
  s_sub_u32 s43, 0, s43
  v_mfma_f32_16x16x32_bf16 v[92:95], a[92:95], a[0:3], v[92:95]
  v_add_u32 v16, s38, v16
  v_add_u32 v17, s38, v17
  v_mfma_f32_16x16x32_bf16 v[124:127], a[92:95], a[4:7], v[124:127]
  v_add_u32 v18, s43, v18
  v_add_u32 v19, s43, v19
  v_mfma_f32_16x16x32_bf16 v[156:159], a[92:95], a[8:11], v[156:159]
  v_add_u32 v20, s43, v20
  v_add_u32 v21, s43, v21
  v_mfma_f32_16x16x32_bf16 v[188:191], a[92:95], a[12:15], v[188:191]
  v_mfma_f32_16x16x32_bf16 v[220:223], a[92:95], a[16:19], v[220:223]
  v_mfma_f32_16x16x32_bf16 v[252:255], a[92:95], a[20:23], v[252:255]
  s_waitcnt vmcnt(8) lgkmcnt(0)
  s_barrier
  v_mfma_f32_16x16x32_bf16 a[156:159], a[92:95], a[24:27], a[156:159]
  s_sub_u32 s35, s35, 1
  v_mfma_f32_16x16x32_bf16 a[188:191], a[92:95], a[28:31], a[188:191]
  s_cmp_lg_u32 s35, 0
  s_cbranch_scc1 Lp1wx_loop
  v_mfma_f32_16x16x32_bf16 v[64:67], a[96:99], a[32:35], v[64:67]
  s_mov_b32 m0, s41
  ds_read_b128 a[0:3], v16 offset:0
  v_mfma_f32_16x16x32_bf16 v[96:99], a[96:99], a[36:39], v[96:99]
  buffer_load_dwordx4 v56, s[12:15], s47 offen offset:0 lds
  v_mfma_f32_16x16x32_bf16 v[128:131], a[96:99], a[40:43], v[128:131]
  ds_read_b64_tr_b16 a[64:65], v18 offset:0
  v_mfma_f32_16x16x32_bf16 v[160:163], a[96:99], a[44:47], v[160:163]
  buffer_load_dwordx4 v57, s[12:15], s47 offen offset:1024 lds
  v_mfma_f32_16x16x32_bf16 v[192:195], a[96:99], a[48:51], v[192:195]
  ds_read_b64_tr_b16 a[66:67], v18 offset:2048
  v_mfma_f32_16x16x32_bf16 v[224:227], a[96:99], a[52:55], v[224:227]
  v_mfma_f32_16x16x32_bf16 a[128:131], a[96:99], a[56:59], a[128:131]
  ds_read_b128 a[4:7], v16 offset:2048
  v_mfma_f32_16x16x32_bf16 a[160:163], a[96:99], a[60:63], a[160:163]
  buffer_load_dwordx4 v58, s[12:15], s47 offen offset:2048 lds
  v_mfma_f32_16x16x32_bf16 v[68:71], a[100:103], a[32:35], v[68:71]
  v_mfma_f32_16x16x32_bf16 v[100:103], a[100:103], a[36:39], v[100:103]
  ds_read_b128 a[8:11], v16 offset:4096
  v_mfma_f32_16x16x32_bf16 v[132:135], a[100:103], a[40:43], v[132:135]
  v_mfma_f32_16x16x32_bf16 v[164:167], a[100:103], a[44:47], v[164:167]
  buffer_load_dwordx4 v59, s[12:15], s47 offen offset:3072 lds
  ds_read_b128 a[12:15], v16 offset:6144
  v_mfma_f32_16x16x32_bf16 v[196:199], a[100:103], a[48:51], v[196:199]
  s_add_u32 m0, s41, 4096
  v_mfma_f32_16x16x32_bf16 v[228:231], a[100:103], a[52:55], v[228:231]
  ds_read_b128 a[16:19], v16 offset:8192
  v_mfma_f32_16x16x32_bf16 a[132:135], a[100:103], a[56:59], a[132:135]
  v_mfma_f32_16x16x32_bf16 a[164:167], a[100:103], a[60:63], a[164:167]
  buffer_load_dwordx4 v60, s[12:15], s47 offen offset:0 lds
  ds_read_b128 a[20:23], v16 offset:10240
  v_mfma_f32_16x16x32_bf16 v[72:75], a[104:107], a[32:35], v[72:75]
  v_mfma_f32_16x16x32_bf16 v[104:107], a[104:107], a[36:39], v[104:107]
  v_mfma_f32_16x16x32_bf16 v[136:139], a[104:107], a[40:43], v[136:139]
  ds_read_b128 a[24:27], v16 offset:12288
  v_mfma_f32_16x16x32_bf16 v[168:171], a[104:107], a[44:47], v[168:171]
  buffer_load_dwordx4 v61, s[12:15], s47 offen offset:1024 lds
  v_mfma_f32_16x16x32_bf16 v[200:203], a[104:107], a[48:51], v[200:203]
  ds_read_b128 a[28:31], v16 offset:14336
  v_mfma_f32_16x16x32_bf16 v[232:235], a[104:107], a[52:55], v[232:235]
  v_mfma_f32_16x16x32_bf16 a[136:139], a[104:107], a[56:59], a[136:139]
  ds_read_b64_tr_b16 a[68:69], v19 offset:0
  v_mfma_f32_16x16x32_bf16 a[168:171], a[104:107], a[60:63], a[168:171]
  buffer_load_dwordx4 v62, s[12:15], s47 offen offset:2048 lds
  v_mfma_f32_16x16x32_bf16 v[76:79], a[108:111], a[32:35], v[76:79]
  ds_read_b64_tr_b16 a[70:71], v19 offset:2048
  v_mfma_f32_16x16x32_bf16 v[108:111], a[108:111], a[36:39], v[108:111]
  v_mfma_f32_16x16x32_bf16 v[140:143], a[108:111], a[40:43], v[140:143]
  v_mfma_f32_16x16x32_bf16 v[172:175], a[108:111], a[44:47], v[172:175]
  buffer_load_dwordx4 v63, s[12:15], s47 offen offset:3072 lds
  ds_read_b64_tr_b16 a[72:73], v20 offset:0
  v_mfma_f32_16x16x32_bf16 v[204:207], a[108:111], a[48:51], v[204:207]
  s_mov_b32 m0, s36
  v_mfma_f32_16x16x32_bf16 v[236:239], a[108:111], a[52:55], v[236:239]
  ds_read_b64_tr_b16 a[74:75], v20 offset:2048
  v_mfma_f32_16x16x32_bf16 a[140:143], a[108:111], a[56:59], a[140:143]
  v_mfma_f32_16x16x32_bf16 a[172:175], a[108:111], a[60:63], a[172:175]
  buffer_load_dwordx4 v48, s[8:11], s46 offen offset:0 lds
  ds_read_b64_tr_b16 a[76:77], v21 offset:0
  v_mfma_f32_16x16x32_bf16 v[80:83], a[112:115], a[32:35], v[80:83]
  v_mfma_f32_16x16x32_bf16 v[112:115], a[112:115], a[36:39], v[112:115]
  ds_read_b64_tr_b16 a[78:79], v21 offset:2048
  v_mfma_f32_16x16x32_bf16 v[144:147], a[112:115], a[40:43], v[144:147]
  v_mfma_f32_16x16x32_bf16 v[176:179], a[112:115], a[44:47], v[176:179]
  buffer_load_dwordx4 v49, s[8:11], s46 offen offset:1024 lds
  v_mfma_f32_16x16x32_bf16 v[208:211], a[112:115], a[48:51], v[208:211]
  ds_read_b64_tr_b16 a[80:81], v18 offset:8192
  v_mfma_f32_16x16x32_bf16 v[240:243], a[112:115], a[52:55], v[240:243]
  v_mfma_f32_16x16x32_bf16 a[144:147], a[112:115], a[56:59], a[144:147]
  ds_read_b64_tr_b16 a[82:83], v18 offset:10240
  v_mfma_f32_16x16x32_bf16 a[176:179], a[112:115], a[60:63], a[176:179]
  buffer_load_dwordx4 v50, s[8:11], s46 offen offset:2048 lds
  v_mfma_f32_16x16x32_bf16 v[84:87], a[116:119], a[32:35], v[84:87]
  ds_read_b64_tr_b16 a[84:85], v19 offset:8192
  v_mfma_f32_16x16x32_bf16 v[116:119], a[116:119], a[36:39], v[116:119]
  v_mfma_f32_16x16x32_bf16 v[148:151], a[116:119], a[40:43], v[148:151]
  ds_read_b64_tr_b16 a[86:87], v19 offset:10240
  v_mfma_f32_16x16x32_bf16 v[180:183], a[116:119], a[44:47], v[180:183]
  buffer_load_dwordx4 v51, s[8:11], s46 offen offset:3072 lds
  v_mfma_f32_16x16x32_bf16 v[212:215], a[116:119], a[48:51], v[212:215]
  s_add_u32 m0, s36, 4096
  v_mfma_f32_16x16x32_bf16 v[244:247], a[116:119], a[52:55], v[244:247]
  ds_read_b64_tr_b16 a[88:89], v20 offset:8192
  v_mfma_f32_16x16x32_bf16 a[148:151], a[116:119], a[56:59], a[148:151]
  v_mfma_f32_16x16x32_bf16 a[180:183], a[116:119], a[60:63], a[180:183]
  buffer_load_dwordx4 v52, s[8:11], s46 offen offset:0 lds
  ds_read_b64_tr_b16 a[90:91], v20 offset:10240
  v_mfma_f32_16x16x32_bf16 v[88:91], a[120:123], a[32:35], v[88:91]
  v_mfma_f32_16x16x32_bf16 v[120:123], a[120:123], a[36:39], v[120:123]
  ds_read_b64_tr_b16 a[92:93], v21 offset:8192
  v_mfma_f32_16x16x32_bf16 v[152:155], a[120:123], a[40:43], v[152:155]
  v_mfma_f32_16x16x32_bf16 v[184:187], a[120:123], a[44:47], v[184:187]
  buffer_load_dwordx4 v53, s[8:11], s46 offen offset:1024 lds
  ds_read_b64_tr_b16 a[94:95], v21 offset:10240
  v_mfma_f32_16x16x32_bf16 v[216:219], a[120:123], a[48:51], v[216:219]
  v_mfma_f32_16x16x32_bf16 v[248:251], a[120:123], a[52:55], v[248:251]
  v_mfma_f32_16x16x32_bf16 a[152:155], a[120:123], a[56:59], a[152:155]
  v_mfma_f32_16x16x32_bf16 a[184:187], a[120:123], a[60:63], a[184:187]
  buffer_load_dwordx4 v54, s[8:11], s46 offen offset:2048 lds
  v_mfma_f32_16x16x32_bf16 v[92:95], a[124:127], a[32:35], v[92:95]
  v_mfma_f32_16x16x32_bf16 v[124:127], a[124:127], a[36:39], v[124:127]
  v_mfma_f32_16x16x32_bf16 v[156:159], a[124:127], a[40:43], v[156:159]
  v_mfma_f32_16x16x32_bf16 v[188:191], a[124:127], a[44:47], v[188:191]
  buffer_load_dwordx4 v55, s[8:11], s46 offen offset:3072 lds
  v_mfma_f32_16x16x32_bf16 v[220:223], a[124:127], a[48:51], v[220:223]
  s_sub_u32 s50, s50, 1
  s_cmp_eq_u32 s50, 0
  s_cselect_b32 s12, s72, s12
  s_cselect_b32 s13, s73, s13
  v_mfma_f32_16x16x32_bf16 v[252:255], a[124:127], a[52:55], v[252:255]
  s_lshl_b32 s47, s48, 19
  s_bfe_u32 s34, 0x3020106, s49
  s_add_u32 s48, s48, s34
  v_mfma_f32_16x16x32_bf16 a[156:159], a[124:127], a[56:59], a[156:159]
  s_add_u32 s49, s49, 8
  s_and_b32 s49, s49, 0x8001f
  s_and_b32 s48, s48, 7
  v_mfma_f32_16x16x32_bf16 a[188:191], a[124:127], a[60:63], a[188:191]
  s_lshl_b32 s46, s48, 7
  s_waitcnt lgkmcnt(0)
  v_mfma_f32_16x16x32_bf16 v[128:131], a[64:67], a[8:11], v[128:131]
  ds_read_b128 a[32:35], v17 offset:0
  ds_read_b64_tr_b16 a[96:97], v18 offset:4096
  v_mfma_f32_16x16x32_bf16 v[132:135], a[68:71], a[8:11], v[132:135]
  ds_read_b64_tr_b16 a[98:99], v18 offset:6144
  ds_read_b128 a[36:39], v17 offset:2048
  v_mfma_f32_16x16x32_bf16 a[128:131], a[64:67], a[24:27], a[128:131]
  ds_read_b128 a[40:43], v17 offset:4096
  ds_read_b128 a[44:47], v17 offset:6144
  v_mfma_f32_16x16x32_bf16 a[132:135], a[68:71], a[24:27], a[132:135]
  ds_read_b128 a[48:51], v17 offset:8192
  ds_read_b128 a[52:55], v17 offset:10240
  v_mfma_f32_16x16x32_bf16 v[136:139], a[72:75], a[8:11], v[136:139]
  ds_read_b128 a[56:59], v17 offset:12288
  ds_read_b128 a[60:63], v17 offset:14336
  v_mfma_f32_16x16x32_bf16 v[140:143], a[76:79], a[8:11], v[140:143]
  ds_read_b64_tr_b16 a[100:101], v19 offset:4096
  ds_read_b64_tr_b16 a[102:103], v19 offset:6144
  v_mfma_f32_16x16x32_bf16 a[136:139], a[72:75], a[24:27], a[136:139]
  ds_read_b64_tr_b16 a[104:105], v20 offset:4096
  v_mfma_f32_16x16x32_bf16 a[140:143], a[76:79], a[24:27], a[140:143]
  ds_read_b64_tr_b16 a[106:107], v20 offset:6144
  ds_read_b64_tr_b16 a[108:109], v21 offset:4096
  v_mfma_f32_16x16x32_bf16 v[144:147], a[80:83], a[8:11], v[144:147]
  ds_read_b64_tr_b16 a[110:111], v21 offset:6144
  ds_read_b64_tr_b16 a[112:113], v18 offset:12288
  v_mfma_f32_16x16x32_bf16 v[148:151], a[84:87], a[8:11], v[148:151]
  ds_read_b64_tr_b16 a[114:115], v18 offset:14336
  ds_read_b64_tr_b16 a[116:117], v19 offset:12288
  v_mfma_f32_16x16x32_bf16 a[144:147], a[80:83], a[24:27], a[144:147]
  ds_read_b64_tr_b16 a[118:119], v19 offset:14336
  ds_read_b64_tr_b16 a[120:121], v20 offset:12288
  v_mfma_f32_16x16x32_bf16 a[148:151], a[84:87], a[24:27], a[148:151]
  ds_read_b64_tr_b16 a[122:123], v20 offset:14336
  ds_read_b64_tr_b16 a[124:125], v21 offset:12288
  v_mfma_f32_16x16x32_bf16 v[152:155], a[88:91], a[8:11], v[152:155]
  ds_read_b64_tr_b16 a[126:127], v21 offset:14336
  v_mfma_f32_16x16x32_bf16 v[156:159], a[92:95], a[8:11], v[156:159]
  v_mfma_f32_16x16x32_bf16 a[152:155], a[88:91], a[24:27], a[152:155]
  v_mfma_f32_16x16x32_bf16 a[156:159], a[92:95], a[24:27], a[156:159]
  v_mfma_f32_16x16x32_bf16 v[160:163], a[64:67], a[12:15], v[160:163]
  v_mfma_f32_16x16x32_bf16 v[164:167], a[68:71], a[12:15], v[164:167]
  s_add_u32 s36, s36, s38
  s_add_u32 s37, s37, 1
  s_cmp_eq_u32 s37, 3
  s_cselect_b32 s37, 0, s37
  s_cselect_b32 s38, s39, s40
  v_add_u32 v16, s38, v16
  v_add_u32 v17, s38, v17
  s_add_u32 s41, s41, s43
  s_sub_u32 s43, 0, s43
  v_add_u32 v18, s43, v18
  v_add_u32 v19, s43, v19
  v_add_u32 v20, s43, v20
  v_add_u32 v21, s43, v21
  s_waitcnt vmcnt(8) lgkmcnt(0)
  s_barrier
  v_mfma_f32_16x16x32_bf16 v[128:131], a[96:99], a[40:43], v[128:131]
  s_mov_b32 m0, s41
  v_mfma_f32_16x16x32_bf16 v[132:135], a[100:103], a[40:43], v[132:135]
  buffer_load_dwordx4 v56, s[12:15], s47 offen offset:0 lds
  v_mfma_f32_16x16x32_bf16 a[128:131], a[96:99], a[56:59], a[128:131]
  v_mfma_f32_16x16x32_bf16 a[132:135], a[100:103], a[56:59], a[132:135]
  v_mfma_f32_16x16x32_bf16 v[136:139], a[104:107], a[40:43], v[136:139]
  v_mfma_f32_16x16x32_bf16 v[140:143], a[108:111], a[40:43], v[140:143]
  buffer_load_dwordx4 v57, s[12:15], s47 offen offset:1024 lds
  v_cvt_pk_bf16_f32 v128, v128, v129
  v_mfma_f32_16x16x32_bf16 a[136:139], a[104:107], a[56:59], a[136:139]
  v_cvt_pk_bf16_f32 v129, v130, v131
  v_cvt_pk_bf16_f32 v130, v132, v133
  v_mfma_f32_16x16x32_bf16 a[140:143], a[108:111], a[56:59], a[140:143]
  v_cvt_pk_bf16_f32 v131, v134, v135
  v_accvgpr_read_b32 v24, a128
  v_mfma_f32_16x16x32_bf16 v[144:147], a[112:115], a[40:43], v[144:147]
  v_accvgpr_read_b32 v25, a129
  v_accvgpr_read_b32 v26, a130
  v_mfma_f32_16x16x32_bf16 v[148:151], a[116:119], a[40:43], v[148:151]
  v_accvgpr_read_b32 v27, a131
  v_accvgpr_read_b32 v28, a132
  v_mfma_f32_16x16x32_bf16 a[144:147], a[112:115], a[56:59], a[144:147]
  v_accvgpr_read_b32 v29, a133
  v_accvgpr_read_b32 v30, a134
  v_mfma_f32_16x16x32_bf16 a[148:151], a[116:119], a[56:59], a[148:151]
  buffer_load_dwordx4 v58, s[12:15], s47 offen offset:2048 lds
  v_accvgpr_read_b32 v31, a135
  v_mfma_f32_16x16x32_bf16 v[152:155], a[120:123], a[40:43], v[152:155]
  v_cvt_pk_bf16_f32 v132, v24, v25
  v_cvt_pk_bf16_f32 v133, v26, v27
  v_mfma_f32_16x16x32_bf16 v[156:159], a[124:127], a[40:43], v[156:159]
  v_cvt_pk_bf16_f32 v134, v28, v29
  v_cvt_pk_bf16_f32 v135, v30, v31
  v_mfma_f32_16x16x32_bf16 a[152:155], a[120:123], a[56:59], a[152:155]
  s_add_u32 s60, s63, 8192
  buffer_store_dwordx4 v[128:131], v2, s[16:19], s60 offen offset:0 sc1
  v_cvt_pk_bf16_f32 v136, v136, v137
  v_mfma_f32_16x16x32_bf16 a[156:159], a[124:127], a[56:59], a[156:159]
  v_cvt_pk_bf16_f32 v137, v138, v139
  v_cvt_pk_bf16_f32 v138, v140, v141
  v_mfma_f32_16x16x32_bf16 v[160:163], a[96:99], a[44:47], v[160:163]
  v_cvt_pk_bf16_f32 v139, v142, v143
  v_mfma_f32_16x16x32_bf16 v[164:167], a[100:103], a[44:47], v[164:167]
  buffer_load_dwordx4 v59, s[12:15], s47 offen offset:3072 lds
  v_mfma_f32_16x16x32_bf16 a[160:163], a[64:67], a[28:31], a[160:163]
  s_add_u32 m0, s41, 4096
  v_mfma_f32_16x16x32_bf16 a[164:167], a[68:71], a[28:31], a[164:167]
  s_add_u32 s60, s63, 40960
  buffer_store_dwordx4 v[132:135], v2, s[16:19], s60 offen offset:0 sc1
  v_accvgpr_read_b32 v32, a136
  v_mfma_f32_16x16x32_bf16 a[160:163], a[96:99], a[60:63], a[160:163]
  v_accvgpr_read_b32 v33, a137
  v_accvgpr_read_b32 v34, a138
  v_mfma_f32_16x16x32_bf16 a[164:167], a[100:103], a[60:63], a[164:167]
  v_accvgpr_read_b32 v35, a139
  v_accvgpr_read_b32 v36, a140
  v_mfma_f32_16x16x32_bf16 v[168:171], a[72:75], a[12:15], v[168:171]
  buffer_load_dwordx4 v60, s[12:15], s47 offen offset:0 lds
  v_accvgpr_read_b32 v37, a141
  v_mfma_f32_16x16x32_bf16 v[172:175], a[76:79], a[12:15], v[172:175]
  v_accvgpr_read_b32 v38, a142
  v_accvgpr_read_b32 v39, a143
  v_mfma_f32_16x16x32_bf16 v[168:171], a[104:107], a[44:47], v[168:171]
  v_cvt_pk_bf16_f32 v140, v32, v33
  v_cvt_pk_bf16_f32 v141, v34, v35
  v_mfma_f32_16x16x32_bf16 v[172:175], a[108:111], a[44:47], v[172:175]
  v_cvt_pk_bf16_f32 v142, v36, v37
  v_cvt_pk_bf16_f32 v143, v38, v39
  v_mfma_f32_16x16x32_bf16 a[168:171], a[72:75], a[28:31], a[168:171]
  s_add_u32 s60, s63, 8192
  buffer_store_dwordx4 v[136:139], v2, s[16:19], s60 offen offset:1024 sc1
  v_cvt_pk_bf16_f32 v144, v144, v145
  v_mfma_f32_16x16x32_bf16 a[172:175], a[76:79], a[28:31], a[172:175]
  v_cvt_pk_bf16_f32 v145, v146, v147
  v_cvt_pk_bf16_f32 v146, v148, v149
  v_mfma_f32_16x16x32_bf16 a[168:171], a[104:107], a[60:63], a[168:171]
  buffer_load_dwordx4 v61, s[12:15], s47 offen offset:1024 lds
  v_cvt_pk_bf16_f32 v147, v150, v151
  v_mfma_f32_16x16x32_bf16 a[172:175], a[108:111], a[60:63], a[172:175]
  s_add_u32 s60, s63, 40960
  buffer_store_dwordx4 v[140:143], v2, s[16:19], s60 offen offset:1024 sc1
  v_accvgpr_read_b32 v40, a144
  v_mfma_f32_16x16x32_bf16 v[176:179], a[80:83], a[12:15], v[176:179]
  v_accvgpr_read_b32 v41, a145
  v_accvgpr_read_b32 v42, a146
  v_mfma_f32_16x16x32_bf16 v[180:183], a[84:87], a[12:15], v[180:183]
  v_accvgpr_read_b32 v43, a147
  v_accvgpr_read_b32 v44, a148
  v_mfma_f32_16x16x32_bf16 v[176:179], a[112:115], a[44:47], v[176:179]
  v_accvgpr_read_b32 v45, a149
  v_accvgpr_read_b32 v46, a150
  v_mfma_f32_16x16x32_bf16 v[180:183], a[116:119], a[44:47], v[180:183]
  v_accvgpr_read_b32 v47, a151
  v_cvt_pk_bf16_f32 v148, v40, v41
  v_mfma_f32_16x16x32_bf16 a[176:179], a[80:83], a[28:31], a[176:179]
  buffer_load_dwordx4 v62, s[12:15], s47 offen offset:2048 lds
  v_cvt_pk_bf16_f32 v149, v42, v43
  v_mfma_f32_16x16x32_bf16 a[180:183], a[84:87], a[28:31], a[180:183]
  v_cvt_pk_bf16_f32 v150, v44, v45
  v_cvt_pk_bf16_f32 v151, v46, v47
  v_mfma_f32_16x16x32_bf16 a[176:179], a[112:115], a[60:63], a[176:179]
  s_add_u32 s60, s63, 8192
  buffer_store_dwordx4 v[144:147], v2, s[16:19], s60 offen offset:2048 sc1
  v_cvt_pk_bf16_f32 v152, v152, v153
  v_mfma_f32_16x16x32_bf16 a[180:183], a[116:119], a[60:63], a[180:183]
  v_cvt_pk_bf16_f32 v153, v154, v155
  v_cvt_pk_bf16_f32 v154, v156, v157
  v_mfma_f32_16x16x32_bf16 v[184:187], a[88:91], a[12:15], v[184:187]
  v_cvt_pk_bf16_f32 v155, v158, v159
  v_mfma_f32_16x16x32_bf16 v[188:191], a[92:95], a[12:15], v[188:191]
  buffer_load_dwordx4 v63, s[12:15], s47 offen offset:3072 lds
  v_mfma_f32_16x16x32_bf16 v[184:187], a[120:123], a[44:47], v[184:187]
  s_mov_b32 m0, s36
  v_mfma_f32_16x16x32_bf16 v[188:191], a[124:127], a[44:47], v[188:191]
  s_add_u32 s60, s63, 40960
  buffer_store_dwordx4 v[148:151], v2, s[16:19], s60 offen offset:2048 sc1
  v_accvgpr_read_b32 v24, a152
  v_mfma_f32_16x16x32_bf16 a[184:187], a[88:91], a[28:31], a[184:187]
  v_accvgpr_read_b32 v25, a153
  v_accvgpr_read_b32 v26, a154
  v_mfma_f32_16x16x32_bf16 a[188:191], a[92:95], a[28:31], a[188:191]
  v_accvgpr_read_b32 v27, a155
  v_accvgpr_read_b32 v28, a156
  v_mfma_f32_16x16x32_bf16 a[184:187], a[120:123], a[60:63], a[184:187]
  v_accvgpr_read_b32 v29, a157
  v_accvgpr_read_b32 v30, a158
  v_mfma_f32_16x16x32_bf16 a[188:191], a[124:127], a[60:63], a[188:191]
  buffer_load_dwordx4 v48, s[8:11], s46 offen offset:0 lds
  v_accvgpr_read_b32 v31, a159
  v_mfma_f32_16x16x32_bf16 v[192:195], a[64:67], a[16:19], v[192:195]
  v_cvt_pk_bf16_f32 v156, v24, v25
  v_cvt_pk_bf16_f32 v157, v26, v27
  v_mfma_f32_16x16x32_bf16 v[196:199], a[68:71], a[16:19], v[196:199]
  v_cvt_pk_bf16_f32 v158, v28, v29
  v_cvt_pk_bf16_f32 v159, v30, v31
  v_mfma_f32_16x16x32_bf16 v[192:195], a[96:99], a[48:51], v[192:195]
  v_cvt_pk_bf16_f32 v160, v160, v161
  v_cvt_pk_bf16_f32 v161, v162, v163
  v_mfma_f32_16x16x32_bf16 v[196:199], a[100:103], a[48:51], v[196:199]
  v_cvt_pk_bf16_f32 v162, v164, v165
  v_cvt_pk_bf16_f32 v163, v166, v167
  v_mfma_f32_16x16x32_bf16 v[64:67], a[64:67], a[0:3], v[64:67]
  s_add_u32 s60, s63, 8192
  buffer_store_dwordx4 v[152:155], v2, s[16:19], s60 offen offset:3072 sc1
  v_accvgpr_read_b32 v32, a160
  v_mfma_f32_16x16x32_bf16 v[68:71], a[68:71], a[0:3], v[68:71]
  buffer_load_dwordx4 v49, s[8:11], s46 offen offset:1024 lds
  v_accvgpr_read_b32 v33, a161
  v_mfma_f32_16x16x32_bf16 v[64:67], a[96:99], a[32:35], v[64:67]
  v_accvgpr_read_b32 v34, a162
  v_accvgpr_read_b32 v35, a163
  v_mfma_f32_16x16x32_bf16 v[68:71], a[100:103], a[32:35], v[68:71]
  v_accvgpr_read_b32 v36, a164
  v_accvgpr_read_b32 v37, a165
  v_mfma_f32_16x16x32_bf16 v[200:203], a[72:75], a[16:19], v[200:203]
  v_accvgpr_read_b32 v38, a166
  v_accvgpr_read_b32 v39, a167
  v_mfma_f32_16x16x32_bf16 v[204:207], a[76:79], a[16:19], v[204:207]
  v_cvt_pk_bf16_f32 v164, v32, v33
  v_cvt_pk_bf16_f32 v165, v34, v35
  v_mfma_f32_16x16x32_bf16 v[200:203], a[104:107], a[48:51], v[200:203]
  buffer_load_dwordx4 v50, s[8:11], s46 offen offset:2048 lds
  v_cvt_pk_bf16_f32 v166, v36, v37
  v_mfma_f32_16x16x32_bf16 v[204:207], a[108:111], a[48:51], v[204:207]
  v_cvt_pk_bf16_f32 v167, v38, v39
  v_mfma_f32_16x16x32_bf16 v[72:75], a[72:75], a[0:3], v[72:75]
  s_add_u32 s60, s63, 40960
  buffer_store_dwordx4 v[156:159], v2, s[16:19], s60 offen offset:3072 sc1
  v_cvt_pk_bf16_f32 v168, v168, v169
  v_mfma_f32_16x16x32_bf16 v[76:79], a[76:79], a[0:3], v[76:79]
  v_cvt_pk_bf16_f32 v169, v170, v171
  v_cvt_pk_bf16_f32 v170, v172, v173
  v_mfma_f32_16x16x32_bf16 v[72:75], a[104:107], a[32:35], v[72:75]
  v_cvt_pk_bf16_f32 v171, v174, v175
  v_mfma_f32_16x16x32_bf16 v[76:79], a[108:111], a[32:35], v[76:79]
  s_add_u32 s60, s63, 12288
  buffer_store_dwordx4 v[160:163], v2, s[16:19], s60 offen offset:0 sc1
  v_accvgpr_read_b32 v40, a168
  v_mfma_f32_16x16x32_bf16 v[208:211], a[80:83], a[16:19], v[208:211]
  buffer_load_dwordx4 v51, s[8:11], s46 offen offset:3072 lds
  v_accvgpr_read_b32 v41, a169
  v_mfma_f32_16x16x32_bf16 v[212:215], a[84:87], a[16:19], v[212:215]
  s_add_u32 m0, s36, 4096
  v_accvgpr_read_b32 v42, a170
  v_accvgpr_read_b32 v43, a171
  v_mfma_f32_16x16x32_bf16 v[208:211], a[112:115], a[48:51], v[208:211]
  v_accvgpr_read_b32 v44, a172
  v_accvgpr_read_b32 v45, a173
  v_mfma_f32_16x16x32_bf16 v[212:215], a[116:119], a[48:51], v[212:215]
  v_accvgpr_read_b32 v46, a174
  v_accvgpr_read_b32 v47, a175
  v_mfma_f32_16x16x32_bf16 v[80:83], a[80:83], a[0:3], v[80:83]
  v_cvt_pk_bf16_f32 v172, v40, v41
  v_cvt_pk_bf16_f32 v173, v42, v43
  v_mfma_f32_16x16x32_bf16 v[84:87], a[84:87], a[0:3], v[84:87]
  v_cvt_pk_bf16_f32 v174, v44, v45
  v_cvt_pk_bf16_f32 v175, v46, v47
  v_mfma_f32_16x16x32_bf16 v[80:83], a[112:115], a[32:35], v[80:83]
  buffer_load_dwordx4 v52, s[8:11], s46 offen offset:0 lds
  v_mfma_f32_16x16x32_bf16 v[84:87], a[116:119], a[32:35], v[84:87]
  s_add_u32 s60, s63, 45056
  buffer_store_dwordx4 v[164:167], v2, s[16:19], s60 offen offset:0 sc1
  v_cvt_pk_bf16_f32 v176, v176, v177
  v_mfma_f32_16x16x32_bf16 v[216:219], a[88:91], a[16:19], v[216:219]
  v_cvt_pk_bf16_f32 v177, v178, v179
  v_cvt_pk_bf16_f32 v178, v180, v181
  v_mfma_f32_16x16x32_bf16 v[220:223], a[92:95], a[16:19], v[220:223]
  v_cvt_pk_bf16_f32 v179, v182, v183
  v_mfma_f32_16x16x32_bf16 v[216:219], a[120:123], a[48:51], v[216:219]
  s_add_u32 s60, s63, 12288
  buffer_store_dwordx4 v[168:171], v2, s[16:19], s60 offen offset:1024 sc1
  v_accvgpr_read_b32 v24, a176
  v_mfma_f32_16x16x32_bf16 v[220:223], a[124:127], a[48:51], v[220:223]
  buffer_load_dwordx4 v53, s[8:11], s46 offen offset:1024 lds
  v_accvgpr_read_b32 v25, a177
  v_mfma_f32_16x16x32_bf16 v[88:91], a[88:91], a[0:3], v[88:91]
  v_accvgpr_read_b32 v26, a178
  v_accvgpr_read_b32 v27, a179
  v_mfma_f32_16x16x32_bf16 v[92:95], a[92:95], a[0:3], v[92:95]
  v_accvgpr_read_b32 v28, a180
  v_accvgpr_read_b32 v29, a181
  v_mfma_f32_16x16x32_bf16 v[224:227], a[64:67], a[20:23], v[224:227]
  v_accvgpr_read_b32 v30, a182
  v_accvgpr_read_b32 v31, a183
  v_mfma_f32_16x16x32_bf16 v[228:231], a[68:71], a[20:23], v[228:231]
  v_cvt_pk_bf16_f32 v180, v24, v25
  v_cvt_pk_bf16_f32 v181, v26, v27
  v_mfma_f32_16x16x32_bf16 v[96:99], a[64:67], a[4:7], v[96:99]
  v_cvt_pk_bf16_f32 v182, v28, v29
  v_cvt_pk_bf16_f32 v183, v30, v31
  v_mfma_f32_16x16x32_bf16 v[100:103], a[68:71], a[4:7], v[100:103]
  buffer_load_dwordx4 v54, s[8:11], s46 offen offset:2048 lds
  v_mfma_f32_16x16x32_bf16 v[232:235], a[72:75], a[20:23], v[232:235]
  s_add_u32 s60, s63, 45056
  buffer_store_dwordx4 v[172:175], v2, s[16:19], s60 offen offset:1024 sc1
  v_cvt_pk_bf16_f32 v184, v184, v185
  v_mfma_f32_16x16x32_bf16 v[236:239], a[76:79], a[20:23], v[236:239]
  v_cvt_pk_bf16_f32 v185, v186, v187
  v_cvt_pk_bf16_f32 v186, v188, v189
  v_mfma_f32_16x16x32_bf16 v[104:107], a[72:75], a[4:7], v[104:107]
  v_cvt_pk_bf16_f32 v187, v190, v191
  v_accvgpr_read_b32 v32, a184
  v_mfma_f32_16x16x32_bf16 v[108:111], a[76:79], a[4:7], v[108:111]
  v_accvgpr_read_b32 v33, a185
  v_accvgpr_read_b32 v34, a186
  v_mfma_f32_16x16x32_bf16 v[240:243], a[80:83], a[20:23], v[240:243]
  v_accvgpr_read_b32 v35, a187
  v_accvgpr_read_b32 v36, a188
  v_mfma_f32_16x16x32_bf16 v[244:247], a[84:87], a[20:23], v[244:247]
  buffer_load_dwordx4 v55, s[8:11], s46 offen offset:3072 lds
  v_accvgpr_read_b32 v37, a189
  v_mfma_f32_16x16x32_bf16 v[112:115], a[80:83], a[4:7], v[112:115]
  s_sub_u32 s50, s50, 1
  s_cmp_eq_u32 s50, 0
  s_cselect_b32 s12, s72, s12
  s_cselect_b32 s13, s73, s13
  v_mfma_f32_16x16x32_bf16 v[116:119], a[84:87], a[4:7], v[116:119]
  s_lshl_b32 s47, s48, 19
  s_bfe_u32 s34, 0x3020106, s49
  s_add_u32 s48, s48, s34
  v_mfma_f32_16x16x32_bf16 v[248:251], a[88:91], a[20:23], v[248:251]
  s_add_u32 s49, s49, 8
  s_and_b32 s49, s49, 0x8001f
  s_and_b32 s48, s48, 7
  v_mfma_f32_16x16x32_bf16 v[252:255], a[92:95], a[20:23], v[252:255]
  s_lshl_b32 s46, s48, 7
  v_accvgpr_read_b32 v38, a190
  v_accvgpr_read_b32 v39, a191
  v_mfma_f32_16x16x32_bf16 v[120:123], a[88:91], a[4:7], v[120:123]
  v_cvt_pk_bf16_f32 v188, v32, v33
  v_cvt_pk_bf16_f32 v189, v34, v35
  v_mfma_f32_16x16x32_bf16 v[124:127], a[92:95], a[4:7], v[124:127]
  v_cvt_pk_bf16_f32 v190, v36, v37
  v_cvt_pk_bf16_f32 v191, v38, v39
  v_mfma_f32_16x16x32_bf16 v[88:91], a[120:123], a[32:35], v[88:91]
  ds_read_b128 a[0:3], v16 offset:0
  ds_read_b64_tr_b16 a[64:65], v18 offset:0
  v_mfma_f32_16x16x32_bf16 v[92:95], a[124:127], a[32:35], v[92:95]
  ds_read_b64_tr_b16 a[66:67], v18 offset:2048
  ds_read_b128 a[4:7], v16 offset:2048
  v_mfma_f32_16x16x32_bf16 v[224:227], a[96:99], a[52:55], v[224:227]
  ds_read_b128 a[8:11], v16 offset:4096
  ds_read_b128 a[12:15], v16 offset:6144
  v_mfma_f32_16x16x32_bf16 v[228:231], a[100:103], a[52:55], v[228:231]
  ds_read_b128 a[16:19], v16 offset:8192
  ds_read_b128 a[20:23], v16 offset:10240
  v_mfma_f32_16x16x32_bf16 v[96:99], a[96:99], a[36:39], v[96:99]
  ds_read_b128 a[24:27], v16 offset:12288
  ds_read_b128 a[28:31], v16 offset:14336
  v_mfma_f32_16x16x32_bf16 v[100:103], a[100:103], a[36:39], v[100:103]
  ds_read_b64_tr_b16 a[68:69], v19 offset:0
  ds_read_b64_tr_b16 a[70:71], v19 offset:2048
  v_mfma_f32_16x16x32_bf16 v[232:235], a[104:107], a[52:55], v[232:235]
  ds_read_b64_tr_b16 a[72:73], v20 offset:0
  ds_read_b64_tr_b16 a[74:75], v20 offset:2048
  v_mfma_f32_16x16x32_bf16 v[236:239], a[108:111], a[52:55], v[236:239]
  ds_read_b64_tr_b16 a[76:77], v21 offset:0
  ds_read_b64_tr_b16 a[78:79], v21 offset:2048
  v_mfma_f32_16x16x32_bf16 v[104:107], a[104:107], a[36:39], v[104:107]
  ds_read_b64_tr_b16 a[80:81], v18 offset:8192
  ds_read_b64_tr_b16 a[82:83], v18 offset:10240
  v_mfma_f32_16x16x32_bf16 v[108:111], a[108:111], a[36:39], v[108:111]
  ds_read_b64_tr_b16 a[84:85], v19 offset:8192
  ds_read_b64_tr_b16 a[86:87], v19 offset:10240
  v_mfma_f32_16x16x32_bf16 v[240:243], a[112:115], a[52:55], v[240:243]
  ds_read_b64_tr_b16 a[88:89], v20 offset:8192
  ds_read_b64_tr_b16 a[90:91], v20 offset:10240
  v_mfma_f32_16x16x32_bf16 v[244:247], a[116:119], a[52:55], v[244:247]
  ds_read_b64_tr_b16 a[92:93], v21 offset:8192
  ds_read_b64_tr_b16 a[94:95], v21 offset:10240
  v_mfma_f32_16x16x32_bf16 v[112:115], a[112:115], a[36:39], v[112:115]
  v_cvt_pk_bf16_f32 v192, v192, v193
  v_cvt_pk_bf16_f32 v193, v194, v195
  v_mfma_f32_16x16x32_bf16 v[116:119], a[116:119], a[36:39], v[116:119]
  v_cvt_pk_bf16_f32 v194, v196, v197
  v_cvt_pk_bf16_f32 v195, v198, v199
  v_mfma_f32_16x16x32_bf16 v[248:251], a[120:123], a[52:55], v[248:251]
  v_cvt_pk_bf16_f32 v196, v64, v65
  v_cvt_pk_bf16_f32 v197, v66, v67
  v_mfma_f32_16x16x32_bf16 v[252:255], a[124:127], a[52:55], v[252:255]
  v_cvt_pk_bf16_f32 v198, v68, v69
  v_cvt_pk_bf16_f32 v199, v70, v71
  v_mfma_f32_16x16x32_bf16 v[120:123], a[120:123], a[36:39], v[120:123]
  v_cvt_pk_bf16_f32 v200, v200, v201
  v_cvt_pk_bf16_f32 v201, v202, v203
  v_mfma_f32_16x16x32_bf16 v[124:127], a[124:127], a[36:39], v[124:127]
  v_cvt_pk_bf16_f32 v202, v204, v205
  v_cvt_pk_bf16_f32 v203, v206, v207
  s_waitcnt lgkmcnt(0)
  v_mfma_f32_16x16x32_bf16 a[128:131], a[24:27], a[64:67], 0
  ds_read_b128 a[32:35], v17 offset:0
  ds_read_b64_tr_b16 a[96:97], v18 offset:4096
  v_mfma_f32_16x16x32_bf16 a[132:135], a[24:27], a[68:71], 0
  ds_read_b64_tr_b16 a[98:99], v18 offset:6144
  ds_read_b128 a[36:39], v17 offset:2048
  v_mfma_f32_16x16x32_bf16 a[136:139], a[24:27], a[72:75], 0
  ds_read_b128 a[40:43], v17 offset:4096
  ds_read_b128 a[44:47], v17 offset:6144
  v_mfma_f32_16x16x32_bf16 a[140:143], a[24:27], a[76:79], 0
  ds_read_b128 a[48:51], v17 offset:8192
  ds_read_b128 a[52:55], v17 offset:10240
  v_mfma_f32_16x16x32_bf16 a[144:147], a[24:27], a[80:83], 0
  ds_read_b128 a[56:59], v17 offset:12288
  ds_read_b128 a[60:63], v17 offset:14336
  v_mfma_f32_16x16x32_bf16 a[148:151], a[24:27], a[84:87], 0
  ds_read_b64_tr_b16 a[100:101], v19 offset:4096
  ds_read_b64_tr_b16 a[102:103], v19 offset:6144
  v_mfma_f32_16x16x32_bf16 a[152:155], a[24:27], a[88:91], 0
  ds_read_b64_tr_b16 a[104:105], v20 offset:4096
  v_cvt_pk_bf16_f32 v204, v72, v73
  v_mfma_f32_16x16x32_bf16 a[156:159], a[24:27], a[92:95], 0
  ds_read_b64_tr_b16 a[106:107], v20 offset:6144
  ds_read_b64_tr_b16 a[108:109], v21 offset:4096
  v_mfma_f32_16x16x32_bf16 a[160:163], a[28:31], a[64:67], 0
  ds_read_b64_tr_b16 a[110:111], v21 offset:6144
  ds_read_b64_tr_b16 a[112:113], v18 offset:12288
  v_mfma_f32_16x16x32_bf16 a[164:167], a[28:31], a[68:71], 0
  ds_read_b64_tr_b16 a[114:115], v18 offset:14336
  ds_read_b64_tr_b16 a[116:117], v19 offset:12288
  v_mfma_f32_16x16x32_bf16 a[168:171], a[28:31], a[72:75], 0
  ds_read_b64_tr_b16 a[118:119], v19 offset:14336
  ds_read_b64_tr_b16 a[120:121], v20 offset:12288
  v_mfma_f32_16x16x32_bf16 a[172:175], a[28:31], a[76:79], 0
  ds_read_b64_tr_b16 a[122:123], v20 offset:14336
  ds_read_b64_tr_b16 a[124:125], v21 offset:12288
  v_mfma_f32_16x16x32_bf16 a[176:179], a[28:31], a[80:83], 0
  ds_read_b64_tr_b16 a[126:127], v21 offset:14336
  v_cvt_pk_bf16_f32 v205, v74, v75
  v_mfma_f32_16x16x32_bf16 a[180:183], a[28:31], a[84:87], 0
  v_cvt_pk_bf16_f32 v206, v76, v77
  v_cvt_pk_bf16_f32 v207, v78, v79
  v_mfma_f32_16x16x32_bf16 a[184:187], a[28:31], a[88:91], 0
  v_cvt_pk_bf16_f32 v208, v208, v209
  v_cvt_pk_bf16_f32 v209, v210, v211
  v_mfma_f32_16x16x32_bf16 a[188:191], a[28:31], a[92:95], 0
  v_cvt_pk_bf16_f32 v210, v212, v213
  v_cvt_pk_bf16_f32 v211, v214, v215
  v_mfma_f32_16x16x32_bf16 v[128:131], a[8:11], a[64:67], 0
  v_cvt_pk_bf16_f32 v212, v80, v81
  v_cvt_pk_bf16_f32 v213, v82, v83
  v_mfma_f32_16x16x32_bf16 v[132:135], a[8:11], a[68:71], 0
  v_cvt_pk_bf16_f32 v214, v84, v85
  v_cvt_pk_bf16_f32 v215, v86, v87
  v_mfma_f32_16x16x32_bf16 v[136:139], a[8:11], a[72:75], 0
  v_cvt_pk_bf16_f32 v216, v216, v217
  v_cvt_pk_bf16_f32 v217, v218, v219
  v_mfma_f32_16x16x32_bf16 v[140:143], a[8:11], a[76:79], 0
  s_add_u32 s36, s36, s38
  s_add_u32 s37, s37, 1
  s_cmp_eq_u32 s37, 3
  s_cselect_b32 s37, 0, s37
  s_cselect_b32 s38, s39, s40
  v_add_u32 v16, s38, v16
  v_add_u32 v17, s38, v17
  s_add_u32 s41, s41, s43
  s_sub_u32 s43, 0, s43
  v_add_u32 v18, s43, v18
  v_add_u32 v19, s43, v19
  v_add_u32 v20, s43, v20
  v_add_u32 v21, s43, v21
  s_waitcnt vmcnt(8) lgkmcnt(0)
  s_barrier
  v_mfma_f32_16x16x32_bf16 a[128:131], a[56:59], a[96:99], a[128:131]
  s_mov_b32 m0, s41
  v_cvt_pk_bf16_f32 v218, v220, v221
  v_cvt_pk_bf16_f32 v219, v222, v223
  v_mfma_f32_16x16x32_bf16 a[132:135], a[56:59], a[100:103], a[132:135]
  v_cvt_pk_bf16_f32 v220, v88, v89
  v_cvt_pk_bf16_f32 v221, v90, v91
  v_mfma_f32_16x16x32_bf16 a[136:139], a[56:59], a[104:107], a[136:139]
  v_cvt_pk_bf16_f32 v222, v92, v93
  v_cvt_pk_bf16_f32 v223, v94, v95
  v_mfma_f32_16x16x32_bf16 a[140:143], a[56:59], a[108:111], a[140:143]
  v_cvt_pk_bf16_f32 v224, v224, v225
  v_cvt_pk_bf16_f32 v225, v226, v227
  v_mfma_f32_16x16x32_bf16 a[144:147], a[56:59], a[112:115], a[144:147]
  v_cvt_pk_bf16_f32 v226, v228, v229
  v_cvt_pk_bf16_f32 v227, v230, v231
  v_mfma_f32_16x16x32_bf16 a[148:151], a[56:59], a[116:119], a[148:151]
  v_cvt_pk_bf16_f32 v228, v96, v97
  v_cvt_pk_bf16_f32 v229, v98, v99
  v_mfma_f32_16x16x32_bf16 a[152:155], a[56:59], a[120:123], a[152:155]
  v_cvt_pk_bf16_f32 v230, v100, v101
  v_cvt_pk_bf16_f32 v231, v102, v103
  v_mfma_f32_16x16x32_bf16 a[156:159], a[56:59], a[124:127], a[156:159]
  v_cvt_pk_bf16_f32 v232, v232, v233
  v_cvt_pk_bf16_f32 v233, v234, v235
  v_mfma_f32_16x16x32_bf16 a[160:163], a[60:63], a[96:99], a[160:163]
  v_cvt_pk_bf16_f32 v234, v236, v237
  v_cvt_pk_bf16_f32 v235, v238, v239
  v_mfma_f32_16x16x32_bf16 a[164:167], a[60:63], a[100:103], a[164:167]
  v_cvt_pk_bf16_f32 v236, v104, v105
  v_cvt_pk_bf16_f32 v237, v106, v107
  v_mfma_f32_16x16x32_bf16 a[168:171], a[60:63], a[104:107], a[168:171]
  v_cvt_pk_bf16_f32 v238, v108, v109
  v_cvt_pk_bf16_f32 v239, v110, v111
  v_mfma_f32_16x16x32_bf16 a[172:175], a[60:63], a[108:111], a[172:175]
  v_cvt_pk_bf16_f32 v240, v240, v241
  v_cvt_pk_bf16_f32 v241, v242, v243
  v_mfma_f32_16x16x32_bf16 a[176:179], a[60:63], a[112:115], a[176:179]
  v_cvt_pk_bf16_f32 v242, v244, v245
  v_cvt_pk_bf16_f32 v243, v246, v247
  v_mfma_f32_16x16x32_bf16 a[180:183], a[60:63], a[116:119], a[180:183]
  v_cvt_pk_bf16_f32 v244, v112, v113
  v_cvt_pk_bf16_f32 v245, v114, v115
  v_mfma_f32_16x16x32_bf16 a[184:187], a[60:63], a[120:123], a[184:187]
  v_cvt_pk_bf16_f32 v246, v116, v117
  v_cvt_pk_bf16_f32 v247, v118, v119
  v_mfma_f32_16x16x32_bf16 a[188:191], a[60:63], a[124:127], a[188:191]
  v_cvt_pk_bf16_f32 v248, v248, v249
  v_cvt_pk_bf16_f32 v249, v250, v251
  v_mfma_f32_16x16x32_bf16 v[128:131], a[40:43], a[96:99], v[128:131]
  v_cvt_pk_bf16_f32 v250, v252, v253
  v_cvt_pk_bf16_f32 v251, v254, v255
  v_mfma_f32_16x16x32_bf16 v[132:135], a[40:43], a[100:103], v[132:135]
  v_cvt_pk_bf16_f32 v252, v120, v121
  v_cvt_pk_bf16_f32 v253, v122, v123
  v_mfma_f32_16x16x32_bf16 v[136:139], a[40:43], a[104:107], v[136:139]
  v_cvt_pk_bf16_f32 v254, v124, v125
  v_cvt_pk_bf16_f32 v255, v126, v127
  v_mfma_f32_16x16x32_bf16 v[140:143], a[40:43], a[108:111], v[140:143]
  s_add_u32 s60, s63, 12288
  buffer_store_dwordx4 v[176:179], v2, s[16:19], s60 offen offset:2048 sc1
  v_mfma_f32_16x16x32_bf16 v[144:147], a[8:11], a[80:83], 0
  s_add_u32 s60, s63, 45056
  buffer_store_dwordx4 v[180:183], v2, s[16:19], s60 offen offset:2048 sc1
  v_mfma_f32_16x16x32_bf16 v[148:151], a[8:11], a[84:87], 0
  s_add_u32 s60, s63, 12288
  buffer_store_dwordx4 v[184:187], v2, s[16:19], s60 offen offset:3072 sc1
  v_mfma_f32_16x16x32_bf16 v[144:147], a[40:43], a[112:115], v[144:147]
  s_add_u32 s60, s63, 45056
  buffer_store_dwordx4 v[188:191], v2, s[16:19], s60 offen offset:3072 sc1
  v_mfma_f32_16x16x32_bf16 v[148:151], a[40:43], a[116:119], v[148:151]
  s_add_u32 s60, s63, 32768
  buffer_store_dwordx4 v[192:195], v2, s[16:19], s60 offen offset:0 sc1
  v_mfma_f32_16x16x32_bf16 v[152:155], a[8:11], a[88:91], 0
  s_add_u32 s60, s63, 0
  buffer_store_dwordx4 v[196:199], v2, s[16:19], s60 offen offset:0 sc1
  v_mfma_f32_16x16x32_bf16 v[156:159], a[8:11], a[92:95], 0
  buffer_load_dwordx4 v56, s[12:15], s47 offen offset:0 lds
  v_mfma_f32_16x16x32_bf16 v[152:155], a[40:43], a[120:123], v[152:155]
  s_add_u32 s60, s63, 32768
  buffer_store_dwordx4 v[200:203], v2, s[16:19], s60 offen offset:1024 sc1
  v_mfma_f32_16x16x32_bf16 v[156:159], a[40:43], a[124:127], v[156:159]
  buffer_load_dwordx4 v57, s[12:15], s47 offen offset:1024 lds
  v_mfma_f32_16x16x32_bf16 v[160:163], a[12:15], a[64:67], 0
  buffer_load_dwordx4 v58, s[12:15], s47 offen offset:2048 lds
  v_mfma_f32_16x16x32_bf16 v[164:167], a[12:15], a[68:71], 0
  buffer_load_dwordx4 v59, s[12:15], s47 offen offset:3072 lds
  v_mfma_f32_16x16x32_bf16 v[160:163], a[44:47], a[96:99], v[160:163]
  s_add_u32 m0, s41, 4096
  v_mfma_f32_16x16x32_bf16 v[164:167], a[44:47], a[100:103], v[164:167]
  s_add_u32 s60, s63, 0
  buffer_store_dwordx4 v[204:207], v2, s[16:19], s60 offen offset:1024 sc1
  v_mfma_f32_16x16x32_bf16 v[168:171], a[12:15], a[72:75], 0
  buffer_load_dwordx4 v60, s[12:15], s47 offen offset:0 lds
  v_mfma_f32_16x16x32_bf16 v[172:175], a[12:15], a[76:79], 0
  buffer_load_dwordx4 v61, s[12:15], s47 offen offset:1024 lds
  v_mfma_f32_16x16x32_bf16 v[168:171], a[44:47], a[104:107], v[168:171]
  buffer_load_dwordx4 v62, s[12:15], s47 offen offset:2048 lds
  v_mfma_f32_16x16x32_bf16 v[172:175], a[44:47], a[108:111], v[172:175]
  s_add_u32 s60, s63, 32768
  buffer_store_dwordx4 v[208:211], v2, s[16:19], s60 offen offset:2048 sc1
  v_mfma_f32_16x16x32_bf16 v[64:67], a[0:3], a[64:67], 0
  v_mfma_f32_16x16x32_bf16 v[68:71], a[0:3], a[68:71], 0
  v_mfma_f32_16x16x32_bf16 v[64:67], a[32:35], a[96:99], v[64:67]
  buffer_load_dwordx4 v63, s[12:15], s47 offen offset:3072 lds
  v_mfma_f32_16x16x32_bf16 v[68:71], a[32:35], a[100:103], v[68:71]
  s_add_u32 s60, s63, 0
  buffer_store_dwordx4 v[212:215], v2, s[16:19], s60 offen offset:2048 sc1
  s_mov_b32 m0, s36
  s_nop 0
  buffer_load_dwordx4 v48, s[8:11], s46 offen offset:0 lds
  buffer_load_dwordx4 v49, s[8:11], s46 offen offset:1024 lds
  buffer_load_dwordx4 v50, s[8:11], s46 offen offset:2048 lds
  buffer_load_dwordx4 v51, s[8:11], s46 offen offset:3072 lds
  v_mfma_f32_16x16x32_bf16 v[72:75], a[0:3], a[72:75], 0
  s_add_u32 m0, s36, 4096
  v_mfma_f32_16x16x32_bf16 v[76:79], a[0:3], a[76:79], 0
  v_mfma_f32_16x16x32_bf16 v[72:75], a[32:35], a[104:107], v[72:75]
  v_mfma_f32_16x16x32_bf16 v[76:79], a[32:35], a[108:111], v[76:79]
  v_mfma_f32_16x16x32_bf16 v[80:83], a[0:3], a[80:83], 0
  s_add_u32 s60, s63, 32768
  buffer_store_dwordx4 v[216:219], v2, s[16:19], s60 offen offset:3072 sc1
  v_mfma_f32_16x16x32_bf16 v[84:87], a[0:3], a[84:87], 0
  v_mfma_f32_16x16x32_bf16 v[80:83], a[32:35], a[112:115], v[80:83]
  v_mfma_f32_16x16x32_bf16 v[84:87], a[32:35], a[116:119], v[84:87]
  v_mfma_f32_16x16x32_bf16 v[88:91], a[0:3], a[88:91], 0
  s_add_u32 s60, s63, 0
  buffer_store_dwordx4 v[220:223], v2, s[16:19], s60 offen offset:3072 sc1
  v_mfma_f32_16x16x32_bf16 v[92:95], a[0:3], a[92:95], 0
  v_mfma_f32_16x16x32_bf16 v[88:91], a[32:35], a[120:123], v[88:91]
  v_mfma_f32_16x16x32_bf16 v[92:95], a[32:35], a[124:127], v[92:95]
  v_mfma_f32_16x16x32_bf16 v[96:99], a[4:7], a[64:67], 0
  s_add_u32 s60, s63, 36864
  buffer_store_dwordx4 v[224:227], v2, s[16:19], s60 offen offset:0 sc1
  v_mfma_f32_16x16x32_bf16 v[100:103], a[4:7], a[68:71], 0
  v_mfma_f32_16x16x32_bf16 v[96:99], a[36:39], a[96:99], v[96:99]
  v_mfma_f32_16x16x32_bf16 v[100:103], a[36:39], a[100:103], v[100:103]
  v_mfma_f32_16x16x32_bf16 v[104:107], a[4:7], a[72:75], 0
  s_add_u32 s60, s63, 4096
  buffer_store_dwordx4 v[228:231], v2, s[16:19], s60 offen offset:0 sc1
  v_mfma_f32_16x16x32_bf16 v[108:111], a[4:7], a[76:79], 0
  v_mfma_f32_16x16x32_bf16 v[104:107], a[36:39], a[104:107], v[104:107]
  v_mfma_f32_16x16x32_bf16 v[108:111], a[36:39], a[108:111], v[108:111]
  v_mfma_f32_16x16x32_bf16 v[112:115], a[4:7], a[80:83], 0
  v_mfma_f32_16x16x32_bf16 v[116:119], a[4:7], a[84:87], 0
  s_add_u32 s60, s63, 36864
  buffer_store_dwordx4 v[232:235], v2, s[16:19], s60 offen offset:1024 sc1
  v_mfma_f32_16x16x32_bf16 v[112:115], a[36:39], a[112:115], v[112:115]
  v_mfma_f32_16x16x32_bf16 v[116:119], a[36:39], a[116:119], v[116:119]
  v_mfma_f32_16x16x32_bf16 v[120:123], a[4:7], a[88:91], 0
  v_mfma_f32_16x16x32_bf16 v[124:127], a[4:7], a[92:95], 0
  s_add_u32 s60, s63, 4096
  buffer_store_dwordx4 v[236:239], v2, s[16:19], s60 offen offset:1024 sc1
  v_mfma_f32_16x16x32_bf16 v[120:123], a[36:39], a[120:123], v[120:123]
  buffer_load_dwordx4 v52, s[8:11], s46 offen offset:0 lds
  v_mfma_f32_16x16x32_bf16 v[124:127], a[36:39], a[124:127], v[124:127]
  v_mfma_f32_16x16x32_bf16 v[176:179], a[12:15], a[80:83], 0
  v_mfma_f32_16x16x32_bf16 v[180:183], a[12:15], a[84:87], 0
  s_add_u32 s60, s63, 36864
  buffer_store_dwordx4 v[240:243], v2, s[16:19], s60 offen offset:2048 sc1
  v_mfma_f32_16x16x32_bf16 v[176:179], a[44:47], a[112:115], v[176:179]
  v_mfma_f32_16x16x32_bf16 v[180:183], a[44:47], a[116:119], v[180:183]
  v_mfma_f32_16x16x32_bf16 v[184:187], a[12:15], a[88:91], 0
  buffer_load_dwordx4 v53, s[8:11], s46 offen offset:1024 lds
  v_mfma_f32_16x16x32_bf16 v[188:191], a[12:15], a[92:95], 0
  v_mfma_f32_16x16x32_bf16 v[192:195], a[16:19], a[64:67], 0
  s_add_u32 s60, s63, 4096
  buffer_store_dwordx4 v[244:247], v2, s[16:19], s60 offen offset:2048 sc1
  v_mfma_f32_16x16x32_bf16 v[196:199], a[16:19], a[68:71], 0
  v_mfma_f32_16x16x32_bf16 v[200:203], a[16:19], a[72:75], 0
  v_mfma_f32_16x16x32_bf16 v[204:207], a[16:19], a[76:79], 0
  buffer_load_dwordx4 v54, s[8:11], s46 offen offset:2048 lds
  v_mfma_f32_16x16x32_bf16 v[208:211], a[16:19], a[80:83], 0
  s_add_u32 s60, s63, 36864
  buffer_store_dwordx4 v[248:251], v2, s[16:19], s60 offen offset:3072 sc1
  v_mfma_f32_16x16x32_bf16 v[212:215], a[16:19], a[84:87], 0
  v_mfma_f32_16x16x32_bf16 v[216:219], a[16:19], a[88:91], 0
  v_mfma_f32_16x16x32_bf16 v[220:223], a[16:19], a[92:95], 0
  v_mfma_f32_16x16x32_bf16 v[224:227], a[20:23], a[64:67], 0
  s_add_u32 s60, s63, 4096
  buffer_store_dwordx4 v[252:255], v2, s[16:19], s60 offen offset:3072 sc1
  v_mfma_f32_16x16x32_bf16 v[228:231], a[20:23], a[68:71], 0
  buffer_load_dwordx4 v55, s[8:11], s46 offen offset:3072 lds
  v_mfma_f32_16x16x32_bf16 v[232:235], a[20:23], a[72:75], 0
  s_sub_u32 s50, s50, 1
  s_cmp_eq_u32 s50, 0
  s_cselect_b32 s12, s72, s12
  s_cselect_b32 s13, s73, s13
  v_mfma_f32_16x16x32_bf16 v[236:239], a[20:23], a[76:79], 0
  s_lshl_b32 s47, s48, 19
  s_bfe_u32 s34, 0x3020106, s49
  s_add_u32 s48, s48, s34
  v_mfma_f32_16x16x32_bf16 v[240:243], a[20:23], a[80:83], 0
  s_add_u32 s49, s49, 8
  s_and_b32 s49, s49, 0x8001f
  s_and_b32 s48, s48, 7
  v_mfma_f32_16x16x32_bf16 v[244:247], a[20:23], a[84:87], 0
  s_lshl_b32 s46, s48, 7
  v_mfma_f32_16x16x32_bf16 v[248:251], a[20:23], a[88:91], 0
  v_mfma_f32_16x16x32_bf16 v[252:255], a[20:23], a[92:95], 0
  v_mfma_f32_16x16x32_bf16 v[184:187], a[44:47], a[120:123], v[184:187]
  ds_read_b128 a[0:3], v16 offset:0
  ds_read_b64_tr_b16 a[64:65], v18 offset:0
  v_mfma_f32_16x16x32_bf16 v[188:191], a[44:47], a[124:127], v[188:191]
  ds_read_b64_tr_b16 a[66:67], v18 offset:2048
  ds_read_b128 a[4:7], v16 offset:2048
  v_mfma_f32_16x16x32_bf16 v[192:195], a[48:51], a[96:99], v[192:195]
  ds_read_b128 a[8:11], v16 offset:4096
  ds_read_b128 a[12:15], v16 offset:6144
  v_mfma_f32_16x16x32_bf16 v[196:199], a[48:51], a[100:103], v[196:199]
  ds_read_b128 a[16:19], v16 offset:8192
  ds_read_b128 a[20:23], v16 offset:10240
  v_mfma_f32_16x16x32_bf16 v[200:203], a[48:51], a[104:107], v[200:203]
  ds_read_b128 a[24:27], v16 offset:12288
  ds_read_b128 a[28:31], v16 offset:14336
  v_mfma_f32_16x16x32_bf16 v[204:207], a[48:51], a[108:111], v[204:207]
  ds_read_b64_tr_b16 a[68:69], v19 offset:0
  ds_read_b64_tr_b16 a[70:71], v19 offset:2048
  v_mfma_f32_16x16x32_bf16 v[208:211], a[48:51], a[112:115], v[208:211]
  ds_read_b64_tr_b16 a[72:73], v20 offset:0
  ds_read_b64_tr_b16 a[74:75], v20 offset:2048
  v_mfma_f32_16x16x32_bf16 v[212:215], a[48:51], a[116:119], v[212:215]
  ds_read_b64_tr_b16 a[76:77], v21 offset:0
  ds_read_b64_tr_b16 a[78:79], v21 offset:2048
  v_mfma_f32_16x16x32_bf16 v[216:219], a[48:51], a[120:123], v[216:219]
  ds_read_b64_tr_b16 a[80:81], v18 offset:8192
  ds_read_b64_tr_b16 a[82:83], v18 offset:10240
  v_mfma_f32_16x16x32_bf16 v[220:223], a[48:51], a[124:127], v[220:223]
  ds_read_b64_tr_b16 a[84:85], v19 offset:8192
  ds_read_b64_tr_b16 a[86:87], v19 offset:10240
  v_mfma_f32_16x16x32_bf16 v[224:227], a[52:55], a[96:99], v[224:227]
  ds_read_b64_tr_b16 a[88:89], v20 offset:8192
  ds_read_b64_tr_b16 a[90:91], v20 offset:10240
  v_mfma_f32_16x16x32_bf16 v[228:231], a[52:55], a[100:103], v[228:231]
  ds_read_b64_tr_b16 a[92:93], v21 offset:8192
  ds_read_b64_tr_b16 a[94:95], v21 offset:10240
  v_mfma_f32_16x16x32_bf16 v[232:235], a[52:55], a[104:107], v[232:235]
  v_mfma_f32_16x16x32_bf16 v[236:239], a[52:55], a[108:111], v[236:239]
  v_mfma_f32_16x16x32_bf16 v[240:243], a[52:55], a[112:115], v[240:243]
  v_mfma_f32_16x16x32_bf16 v[244:247], a[52:55], a[116:119], v[244:247]
  v_mfma_f32_16x16x32_bf16 v[248:251], a[52:55], a[120:123], v[248:251]
  v_mfma_f32_16x16x32_bf16 v[252:255], a[52:55], a[124:127], v[252:255]
  s_add_u32 s63, s63, 0x4000
  s_waitcnt lgkmcnt(0)
  v_mfma_f32_16x16x32_bf16 v[64:67], a[0:3], a[64:67], v[64:67]
  s_add_u32 s36, s36, s38
  s_add_u32 s37, s37, 1
  ds_read_b128 a[32:35], v17 offset:0
  v_mfma_f32_16x16x32_bf16 v[96:99], a[4:7], a[64:67], v[96:99]
  s_cmp_eq_u32 s37, 3
  s_cselect_b32 s37, 0, s37
  s_cselect_b32 s38, s39, s40
  v_mfma_f32_16x16x32_bf16 v[128:131], a[8:11], a[64:67], v[128:131]
  s_add_u32 s41, s41, s43
  s_sub_u32 s43, 0, s43
  ds_read_b64_tr_b16 a[96:97], v18 offset:4096
  v_mfma_f32_16x16x32_bf16 v[160:163], a[12:15], a[64:67], v[160:163]
  v_mfma_f32_16x16x32_bf16 v[192:195], a[16:19], a[64:67], v[192:195]
  ds_read_b64_tr_b16 a[98:99], v18 offset:6144
  v_mfma_f32_16x16x32_bf16 v[224:227], a[20:23], a[64:67], v[224:227]
  v_mfma_f32_16x16x32_bf16 a[128:131], a[24:27], a[64:67], a[128:131]
  ds_read_b128 a[36:39], v17 offset:2048
  v_mfma_f32_16x16x32_bf16 a[160:163], a[28:31], a[64:67], a[160:163]
  v_mfma_f32_16x16x32_bf16 v[68:71], a[0:3], a[68:71], v[68:71]
  v_mfma_f32_16x16x32_bf16 v[100:103], a[4:7], a[68:71], v[100:103]
  ds_read_b128 a[40:43], v17 offset:4096
  v_mfma_f32_16x16x32_bf16 v[132:135], a[8:11], a[68:71], v[132:135]
  v_mfma_f32_16x16x32_bf16 v[164:167], a[12:15], a[68:71], v[164:167]
  ds_read_b128 a[44:47], v17 offset:6144
  v_mfma_f32_16x16x32_bf16 v[196:199], a[16:19], a[68:71], v[196:199]
  v_mfma_f32_16x16x32_bf16 v[228:231], a[20:23], a[68:71], v[228:231]
  ds_read_b128 a[48:51], v17 offset:8192
  v_mfma_f32_16x16x32_bf16 a[132:135], a[24:27], a[68:71], a[132:135]
  v_mfma_f32_16x16x32_bf16 a[164:167], a[28:31], a[68:71], a[164:167]
  ds_read_b128 a[52:55], v17 offset:10240
  v_mfma_f32_16x16x32_bf16 v[72:75], a[0:3], a[72:75], v[72:75]
  v_mfma_f32_16x16x32_bf16 v[104:107], a[4:7], a[72:75], v[104:107]
  v_mfma_f32_16x16x32_bf16 v[136:139], a[8:11], a[72:75], v[136:139]
  ds_read_b128 a[56:59], v17 offset:12288
  v_mfma_f32_16x16x32_bf16 v[168:171], a[12:15], a[72:75], v[168:171]
  v_mfma_f32_16x16x32_bf16 v[200:203], a[16:19], a[72:75], v[200:203]
  ds_read_b128 a[60:63], v17 offset:14336
  v_mfma_f32_16x16x32_bf16 v[232:235], a[20:23], a[72:75], v[232:235]
  v_mfma_f32_16x16x32_bf16 a[136:139], a[24:27], a[72:75], a[136:139]
  ds_read_b64_tr_b16 a[100:101], v19 offset:4096
  v_mfma_f32_16x16x32_bf16 a[168:171], a[28:31], a[72:75], a[168:171]
  v_mfma_f32_16x16x32_bf16 v[76:79], a[0:3], a[76:79], v[76:79]
  ds_read_b64_tr_b16 a[102:103], v19 offset:6144
  v_mfma_f32_16x16x32_bf16 v[108:111], a[4:7], a[76:79], v[108:111]
  v_mfma_f32_16x16x32_bf16 v[140:143], a[8:11], a[76:79], v[140:143]
  v_mfma_f32_16x16x32_bf16 v[172:175], a[12:15], a[76:79], v[172:175]
  ds_read_b64_tr_b16 a[104:105], v20 offset:4096
  v_mfma_f32_16x16x32_bf16 v[204:207], a[16:19], a[76:79], v[204:207]
  v_mfma_f32_16x16x32_bf16 v[236:239], a[20:23], a[76:79], v[236:239]
  ds_read_b64_tr_b16 a[106:107], v20 offset:6144
  v_mfma_f32_16x16x32_bf16 a[140:143], a[24:27], a[76:79], a[140:143]
  v_mfma_f32_16x16x32_bf16 a[172:175], a[28:31], a[76:79], a[172:175]
  ds_read_b64_tr_b16 a[108:109], v21 offset:4096
  v_mfma_f32_16x16x32_bf16 v[80:83], a[0:3], a[80:83], v[80:83]
  v_mfma_f32_16x16x32_bf16 v[112:115], a[4:7], a[80:83], v[112:115]
  ds_read_b64_tr_b16 a[110:111], v21 offset:6144
  v_mfma_f32_16x16x32_bf16 v[144:147], a[8:11], a[80:83], v[144:147]
  v_mfma_f32_16x16x32_bf16 v[176:179], a[12:15], a[80:83], v[176:179]
  v_mfma_f32_16x16x32_bf16 v[208:211], a[16:19], a[80:83], v[208:211]
  ds_read_b64_tr_b16 a[112:113], v18 offset:12288
  v_mfma_f32_16x16x32_bf16 v[240:243], a[20:23], a[80:83], v[240:243]
  v_mfma_f32_16x16x32_bf16 a[144:147], a[24:27], a[80:83], a[144:147]
  ds_read_b64_tr_b16 a[114:115], v18 offset:14336
  v_mfma_f32_16x16x32_bf16 a[176:179], a[28:31], a[80:83], a[176:179]
  v_mfma_f32_16x16x32_bf16 v[84:87], a[0:3], a[84:87], v[84:87]
  ds_read_b64_tr_b16 a[116:117], v19 offset:12288
  v_mfma_f32_16x16x32_bf16 v[116:119], a[4:7], a[84:87], v[116:119]
  v_mfma_f32_16x16x32_bf16 v[148:151], a[8:11], a[84:87], v[148:151]
  ds_read_b64_tr_b16 a[118:119], v19 offset:14336
  v_mfma_f32_16x16x32_bf16 v[180:183], a[12:15], a[84:87], v[180:183]
  v_mfma_f32_16x16x32_bf16 v[212:215], a[16:19], a[84:87], v[212:215]
  v_mfma_f32_16x16x32_bf16 v[244:247], a[20:23], a[84:87], v[244:247]
  ds_read_b64_tr_b16 a[120:121], v20 offset:12288
  v_mfma_f32_16x16x32_bf16 a[148:151], a[24:27], a[84:87], a[148:151]
  v_mfma_f32_16x16x32_bf16 a[180:183], a[28:31], a[84:87], a[180:183]
  ds_read_b64_tr_b16 a[122:123], v20 offset:14336
  v_mfma_f32_16x16x32_bf16 v[88:91], a[0:3], a[88:91], v[88:91]
  v_mfma_f32_16x16x32_bf16 v[120:123], a[4:7], a[88:91], v[120:123]
  ds_read_b64_tr_b16 a[124:125], v21 offset:12288
  v_mfma_f32_16x16x32_bf16 v[152:155], a[8:11], a[88:91], v[152:155]
  v_mfma_f32_16x16x32_bf16 v[184:187], a[12:15], a[88:91], v[184:187]
  ds_read_b64_tr_b16 a[126:127], v21 offset:14336
  v_mfma_f32_16x16x32_bf16 v[216:219], a[16:19], a[88:91], v[216:219]
  v_add_u32 v16, s38, v16
  v_add_u32 v17, s38, v17
  v_mfma_f32_16x16x32_bf16 v[248:251], a[20:23], a[88:91], v[248:251]
  v_add_u32 v18, s43, v18
  v_add_u32 v19, s43, v19
  v_mfma_f32_16x16x32_bf16 a[152:155], a[24:27], a[88:91], a[152:155]
  v_add_u32 v20, s43, v20
  v_add_u32 v21, s43, v21
  v_mfma_f32_16x16x32_bf16 a[184:187], a[28:31], a[88:91], a[184:187]
  v_mfma_f32_16x16x32_bf16 v[92:95], a[0:3], a[92:95], v[92:95]
  v_mfma_f32_16x16x32_bf16 v[124:127], a[4:7], a[92:95], v[124:127]
  v_mfma_f32_16x16x32_bf16 v[156:159], a[8:11], a[92:95], v[156:159]
  v_mfma_f32_16x16x32_bf16 v[188:191], a[12:15], a[92:95], v[188:191]
  v_mfma_f32_16x16x32_bf16 v[220:223], a[16:19], a[92:95], v[220:223]
  v_mfma_f32_16x16x32_bf16 v[252:255], a[20:23], a[92:95], v[252:255]
  v_mfma_f32_16x16x32_bf16 a[156:159], a[24:27], a[92:95], a[156:159]
  v_mfma_f32_16x16x32_bf16 a[188:191], a[28:31], a[92:95], a[188:191]
  s_mov_b32 s35, 4
  s_waitcnt vmcnt(8) lgkmcnt(0)
  s_barrier
  .p2align 6
Lp1xw_loop:
  v_mfma_f32_16x16x32_bf16 v[64:67], a[32:35], a[96:99], v[64:67]
  s_mov_b32 m0, s41
  ds_read_b128 a[0:3], v16 offset:0
  v_mfma_f32_16x16x32_bf16 v[96:99], a[36:39], a[96:99], v[96:99]
  buffer_load_dwordx4 v56, s[12:15], s47 offen offset:0 lds
  v_mfma_f32_16x16x32_bf16 v[128:131], a[40:43], a[96:99], v[128:131]
  ds_read_b64_tr_b16 a[64:65], v18 offset:0
  v_mfma_f32_16x16x32_bf16 v[160:163], a[44:47], a[96:99], v[160:163]
  v_mfma_f32_16x16x32_bf16 v[192:195], a[48:51], a[96:99], v[192:195]
  ds_read_b64_tr_b16 a[66:67], v18 offset:2048
  v_mfma_f32_16x16x32_bf16 v[224:227], a[52:55], a[96:99], v[224:227]
  v_mfma_f32_16x16x32_bf16 a[128:131], a[56:59], a[96:99], a[128:131]
  ds_read_b128 a[4:7], v16 offset:2048
  v_mfma_f32_16x16x32_bf16 a[160:163], a[60:63], a[96:99], a[160:163]
  buffer_load_dwordx4 v57, s[12:15], s47 offen offset:1024 lds
  v_mfma_f32_16x16x32_bf16 v[68:71], a[32:35], a[100:103], v[68:71]
  v_mfma_f32_16x16x32_bf16 v[100:103], a[36:39], a[100:103], v[100:103]
  ds_read_b128 a[8:11], v16 offset:4096
  v_mfma_f32_16x16x32_bf16 v[132:135], a[40:43], a[100:103], v[132:135]
  v_mfma_f32_16x16x32_bf16 v[164:167], a[44:47], a[100:103], v[164:167]
  ds_read_b128 a[12:15], v16 offset:6144
  v_mfma_f32_16x16x32_bf16 v[196:199], a[48:51], a[100:103], v[196:199]
  v_mfma_f32_16x16x32_bf16 v[228:231], a[52:55], a[100:103], v[228:231]
  ds_read_b128 a[16:19], v16 offset:8192
  v_mfma_f32_16x16x32_bf16 a[132:135], a[56:59], a[100:103], a[132:135]
  v_mfma_f32_16x16x32_bf16 a[164:167], a[60:63], a[100:103], a[164:167]
  buffer_load_dwordx4 v58, s[12:15], s47 offen offset:2048 lds
  ds_read_b128 a[20:23], v16 offset:10240
  v_mfma_f32_16x16x32_bf16 v[72:75], a[32:35], a[104:107], v[72:75]
  v_mfma_f32_16x16x32_bf16 v[104:107], a[36:39], a[104:107], v[104:107]
  v_mfma_f32_16x16x32_bf16 v[136:139], a[40:43], a[104:107], v[136:139]
  ds_read_b128 a[24:27], v16 offset:12288
  v_mfma_f32_16x16x32_bf16 v[168:171], a[44:47], a[104:107], v[168:171]
  v_mfma_f32_16x16x32_bf16 v[200:203], a[48:51], a[104:107], v[200:203]
  ds_read_b128 a[28:31], v16 offset:14336
  v_mfma_f32_16x16x32_bf16 v[232:235], a[52:55], a[104:107], v[232:235]
  v_mfma_f32_16x16x32_bf16 a[136:139], a[56:59], a[104:107], a[136:139]
  ds_read_b64_tr_b16 a[68:69], v19 offset:0
  v_mfma_f32_16x16x32_bf16 a[168:171], a[60:63], a[104:107], a[168:171]
  buffer_load_dwordx4 v59, s[12:15], s47 offen offset:3072 lds
  v_mfma_f32_16x16x32_bf16 v[76:79], a[32:35], a[108:111], v[76:79]
  s_add_u32 m0, s41, 4096
  ds_read_b64_tr_b16 a[70:71], v19 offset:2048
  v_mfma_f32_16x16x32_bf16 v[108:111], a[36:39], a[108:111], v[108:111]
  v_mfma_f32_16x16x32_bf16 v[140:143], a[40:43], a[108:111], v[140:143]
  v_mfma_f32_16x16x32_bf16 v[172:175], a[44:47], a[108:111], v[172:175]
  ds_read_b64_tr_b16 a[72:73], v20 offset:0
  v_mfma_f32_16x16x32_bf16 v[204:207], a[48:51], a[108:111], v[204:207]
  v_mfma_f32_16x16x32_bf16 v[236:239], a[52:55], a[108:111], v[236:239]
  ds_read_b64_tr_b16 a[74:75], v20 offset:2048
  v_mfma_f32_16x16x32_bf16 a[140:143], a[56:59], a[108:111], a[140:143]
  v_mfma_f32_16x16x32_bf16 a[172:175], a[60:63], a[108:111], a[172:175]
  buffer_load_dwordx4 v60, s[12:15], s47 offen offset:0 lds
  ds_read_b64_tr_b16 a[76:77], v21 offset:0
  v_mfma_f32_16x16x32_bf16 v[80:83], a[32:35], a[112:115], v[80:83]
  v_mfma_f32_16x16x32_bf16 v[112:115], a[36:39], a[112:115], v[112:115]
  ds_read_b64_tr_b16 a[78:79], v21 offset:2048
  v_mfma_f32_16x16x32_bf16 v[144:147], a[40:43], a[112:115], v[144:147]
  v_mfma_f32_16x16x32_bf16 v[176:179], a[44:47], a[112:115], v[176:179]
  v_mfma_f32_16x16x32_bf16 v[208:211], a[48:51], a[112:115], v[208:211]
  ds_read_b64_tr_b16 a[80:81], v18 offset:8192
  v_mfma_f32_16x16x32_bf16 v[240:243], a[52:55], a[112:115], v[240:243]
  v_mfma_f32_16x16x32_bf16 a[144:147], a[56:59], a[112:115], a[144:147]
  ds_read_b64_tr_b16 a[82:83], v18 offset:10240
  v_mfma_f32_16x16x32_bf16 a[176:179], a[60:63], a[112:115], a[176:179]
  buffer_load_dwordx4 v61, s[12:15], s47 offen offset:1024 lds
  v_mfma_f32_16x16x32_bf16 v[84:87], a[32:35], a[116:119], v[84:87]
  ds_read_b64_tr_b16 a[84:85], v19 offset:8192
  v_mfma_f32_16x16x32_bf16 v[116:119], a[36:39], a[116:119], v[116:119]
  v_mfma_f32_16x16x32_bf16 v[148:151], a[40:43], a[116:119], v[148:151]
  ds_read_b64_tr_b16 a[86:87], v19 offset:10240
  v_mfma_f32_16x16x32_bf16 v[180:183], a[44:47], a[116:119], v[180:183]
  v_mfma_f32_16x16x32_bf16 v[212:215], a[48:51], a[116:119], v[212:215]
  v_mfma_f32_16x16x32_bf16 v[244:247], a[52:55], a[116:119], v[244:247]
  ds_read_b64_tr_b16 a[88:89], v20 offset:8192
  v_mfma_f32_16x16x32_bf16 a[148:151], a[56:59], a[116:119], a[148:151]
  v_mfma_f32_16x16x32_bf16 a[180:183], a[60:63], a[116:119], a[180:183]
  buffer_load_dwordx4 v62, s[12:15], s47 offen offset:2048 lds
  ds_read_b64_tr_b16 a[90:91], v20 offset:10240
  v_mfma_f32_16x16x32_bf16 v[88:91], a[32:35], a[120:123], v[88:91]
  v_mfma_f32_16x16x32_bf16 v[120:123], a[36:39], a[120:123], v[120:123]
  ds_read_b64_tr_b16 a[92:93], v21 offset:8192
  v_mfma_f32_16x16x32_bf16 v[152:155], a[40:43], a[120:123], v[152:155]
  v_mfma_f32_16x16x32_bf16 v[184:187], a[44:47], a[120:123], v[184:187]
  ds_read_b64_tr_b16 a[94:95], v21 offset:10240
  v_mfma_f32_16x16x32_bf16 v[216:219], a[48:51], a[120:123], v[216:219]
  v_mfma_f32_16x16x32_bf16 v[248:251], a[52:55], a[120:123], v[248:251]
  v_mfma_f32_16x16x32_bf16 a[152:155], a[56:59], a[120:123], a[152:155]
  v_mfma_f32_16x16x32_bf16 a[184:187], a[60:63], a[120:123], a[184:187]
  buffer_load_dwordx4 v63, s[12:15], s47 offen offset:3072 lds
  v_mfma_f32_16x16x32_bf16 v[92:95], a[32:35], a[124:127], v[92:95]
  v_mfma_f32_16x16x32_bf16 v[124:127], a[36:39], a[124:127], v[124:127]
  v_mfma_f32_16x16x32_bf16 v[156:159], a[40:43], a[124:127], v[156:159]
  v_mfma_f32_16x16x32_bf16 v[188:191], a[44:47], a[124:127], v[188:191]
  v_mfma_f32_16x16x32_bf16 v[220:223], a[48:51], a[124:127], v[220:223]
  v_mfma_f32_16x16x32_bf16 v[252:255], a[52:55], a[124:127], v[252:255]
  v_mfma_f32_16x16x32_bf16 a[156:159], a[56:59], a[124:127], a[156:159]
  v_mfma_f32_16x16x32_bf16 a[188:191], a[60:63], a[124:127], a[188:191]
  s_waitcnt lgkmcnt(0)
  v_mfma_f32_16x16x32_bf16 v[64:67], a[0:3], a[64:67], v[64:67]
  s_mov_b32 m0, s36
  ds_read_b128 a[32:35], v17 offset:0
  v_mfma_f32_16x16x32_bf16 v[96:99], a[4:7], a[64:67], v[96:99]
  buffer_load_dwordx4 v48, s[8:11], s46 offen offset:0 lds
  v_mfma_f32_16x16x32_bf16 v[128:131], a[8:11], a[64:67], v[128:131]
  ds_read_b64_tr_b16 a[96:97], v18 offset:4096
  v_mfma_f32_16x16x32_bf16 v[160:163], a[12:15], a[64:67], v[160:163]
  v_mfma_f32_16x16x32_bf16 v[192:195], a[16:19], a[64:67], v[192:195]
  ds_read_b64_tr_b16 a[98:99], v18 offset:6144
  v_mfma_f32_16x16x32_bf16 v[224:227], a[20:23], a[64:67], v[224:227]
  v_mfma_f32_16x16x32_bf16 a[128:131], a[24:27], a[64:67], a[128:131]
  ds_read_b128 a[36:39], v17 offset:2048
  v_mfma_f32_16x16x32_bf16 a[160:163], a[28:31], a[64:67], a[160:163]
  buffer_load_dwordx4 v49, s[8:11], s46 offen offset:1024 lds
  v_mfma_f32_16x16x32_bf16 v[68:71], a[0:3], a[68:71], v[68:71]
  v_mfma_f32_16x16x32_bf16 v[100:103], a[4:7], a[68:71], v[100:103]
  ds_read_b128 a[40:43], v17 offset:4096
  v_mfma_f32_16x16x32_bf16 v[132:135], a[8:11], a[68:71], v[132:135]
  v_mfma_f32_16x16x32_bf16 v[164:167], a[12:15], a[68:71], v[164:167]
  ds_read_b128 a[44:47], v17 offset:6144
  v_mfma_f32_16x16x32_bf16 v[196:199], a[16:19], a[68:71], v[196:199]
  v_mfma_f32_16x16x32_bf16 v[228:231], a[20:23], a[68:71], v[228:231]
  ds_read_b128 a[48:51], v17 offset:8192
  v_mfma_f32_16x16x32_bf16 a[132:135], a[24:27], a[68:71], a[132:135]
  buffer_load_dwordx4 v50, s[8:11], s46 offen offset:2048 lds
  v_mfma_f32_16x16x32_bf16 a[164:167], a[28:31], a[68:71], a[164:167]
  ds_read_b128 a[52:55], v17 offset:10240
  v_mfma_f32_16x16x32_bf16 v[72:75], a[0:3], a[72:75], v[72:75]
  v_mfma_f32_16x16x32_bf16 v[104:107], a[4:7], a[72:75], v[104:107]
  v_mfma_f32_16x16x32_bf16 v[136:139], a[8:11], a[72:75], v[136:139]
  ds_read_b128 a[56:59], v17 offset:12288
  v_mfma_f32_16x16x32_bf16 v[168:171], a[12:15], a[72:75], v[168:171]
  v_mfma_f32_16x16x32_bf16 v[200:203], a[16:19], a[72:75], v[200:203]
  ds_read_b128 a[60:63], v17 offset:14336
  v_mfma_f32_16x16x32_bf16 v[232:235], a[20:23], a[72:75], v[232:235]
  buffer_load_dwordx4 v51, s[8:11], s46 offen offset:3072 lds
  v_mfma_f32_16x16x32_bf16 a[136:139], a[24:27], a[72:75], a[136:139]
  s_add_u32 m0, s36, 4096
  ds_read_b64_tr_b16 a[100:101], v19 offset:4096
  v_mfma_f32_16x16x32_bf16 a[168:171], a[28:31], a[72:75], a[168:171]
  v_mfma_f32_16x16x32_bf16 v[76:79], a[0:3], a[76:79], v[76:79]
  ds_read_b64_tr_b16 a[102:103], v19 offset:6144
  v_mfma_f32_16x16x32_bf16 v[108:111], a[4:7], a[76:79], v[108:111]
  v_mfma_f32_16x16x32_bf16 v[140:143], a[8:11], a[76:79], v[140:143]
  v_mfma_f32_16x16x32_bf16 v[172:175], a[12:15], a[76:79], v[172:175]
  ds_read_b64_tr_b16 a[104:105], v20 offset:4096
  v_mfma_f32_16x16x32_bf16 v[204:207], a[16:19], a[76:79], v[204:207]
  buffer_load_dwordx4 v52, s[8:11], s46 offen offset:0 lds
  v_mfma_f32_16x16x32_bf16 v[236:239], a[20:23], a[76:79], v[236:239]
  ds_read_b64_tr_b16 a[106:107], v20 offset:6144
  v_mfma_f32_16x16x32_bf16 a[140:143], a[24:27], a[76:79], a[140:143]
  v_mfma_f32_16x16x32_bf16 a[172:175], a[28:31], a[76:79], a[172:175]
  ds_read_b64_tr_b16 a[108:109], v21 offset:4096
  v_mfma_f32_16x16x32_bf16 v[80:83], a[0:3], a[80:83], v[80:83]
  v_mfma_f32_16x16x32_bf16 v[112:115], a[4:7], a[80:83], v[112:115]
  ds_read_b64_tr_b16 a[110:111], v21 offset:6144
  v_mfma_f32_16x16x32_bf16 v[144:147], a[8:11], a[80:83], v[144:147]
  v_mfma_f32_16x16x32_bf16 v[176:179], a[12:15], a[80:83], v[176:179]
  buffer_load_dwordx4 v53, s[8:11], s46 offen offset:1024 lds
  v_mfma_f32_16x16x32_bf16 v[208:211], a[16:19], a[80:83], v[208:211]
  ds_read_b64_tr_b16 a[112:113], v18 offset:12288
  v_mfma_f32_16x16x32_bf16 v[240:243], a[20:23], a[80:83], v[240:243]
  v_mfma_f32_16x16x32_bf16 a[144:147], a[24:27], a[80:83], a[144:147]
  ds_read_b64_tr_b16 a[114:115], v18 offset:14336
  v_mfma_f32_16x16x32_bf16 a[176:179], a[28:31], a[80:83], a[176:179]
  v_mfma_f32_16x16x32_bf16 v[84:87], a[0:3], a[84:87], v[84:87]
  ds_read_b64_tr_b16 a[116:117], v19 offset:12288
  v_mfma_f32_16x16x32_bf16 v[116:119], a[4:7], a[84:87], v[116:119]
  v_mfma_f32_16x16x32_bf16 v[148:151], a[8:11], a[84:87], v[148:151]
  buffer_load_dwordx4 v54, s[8:11], s46 offen offset:2048 lds
  ds_read_b64_tr_b16 a[118:119], v19 offset:14336
  v_mfma_f32_16x16x32_bf16 v[180:183], a[12:15], a[84:87], v[180:183]
  v_mfma_f32_16x16x32_bf16 v[212:215], a[16:19], a[84:87], v[212:215]
  v_mfma_f32_16x16x32_bf16 v[244:247], a[20:23], a[84:87], v[244:247]
  ds_read_b64_tr_b16 a[120:121], v20 offset:12288
  v_mfma_f32_16x16x32_bf16 a[148:151], a[24:27], a[84:87], a[148:151]
  v_mfma_f32_16x16x32_bf16 a[180:183], a[28:31], a[84:87], a[180:183]
  ds_read_b64_tr_b16 a[122:123], v20 offset:14336
  v_mfma_f32_16x16x32_bf16 v[88:91], a[0:3], a[88:91], v[88:91]
  v_mfma_f32_16x16x32_bf16 v[120:123], a[4:7], a[88:91], v[120:123]
  buffer_load_dwordx4 v55, s[8:11], s46 offen offset:3072 lds
  ds_read_b64_tr_b16 a[124:125], v21 offset:12288
  v_mfma_f32_16x16x32_bf16 v[152:155], a[8:11], a[88:91], v[152:155]
  s_sub_u32 s50, s50, 1
  s_cmp_eq_u32 s50, 0
  s_cselect_b32 s12, s72, s12
  s_cselect_b32 s13, s73, s13
  v_mfma_f32_16x16x32_bf16 v[184:187], a[12:15], a[88:91], v[184:187]
  s_lshl_b32 s47, s48, 19
  s_bfe_u32 s34, 0x3020106, s49
  s_add_u32 s48, s48, s34
  v_mfma_f32_16x16x32_bf16 v[216:219], a[16:19], a[88:91], v[216:219]
  s_add_u32 s49, s49, 8
  s_and_b32 s49, s49, 0x8001f
  s_and_b32 s48, s48, 7
  v_mfma_f32_16x16x32_bf16 v[248:251], a[20:23], a[88:91], v[248:251]
  s_lshl_b32 s46, s48, 7
  ds_read_b64_tr_b16 a[126:127], v21 offset:14336
  v_mfma_f32_16x16x32_bf16 a[152:155], a[24:27], a[88:91], a[152:155]
  s_add_u32 s36, s36, s38
  s_add_u32 s37, s37, 1
  s_cmp_eq_u32 s37, 3
  s_cselect_b32 s37, 0, s37
  s_cselect_b32 s38, s39, s40
  v_mfma_f32_16x16x32_bf16 a[184:187], a[28:31], a[88:91], a[184:187]
  s_add_u32 s41, s41, s43
  s_sub_u32 s43, 0, s43
  v_mfma_f32_16x16x32_bf16 v[92:95], a[0:3], a[92:95], v[92:95]
  v_add_u32 v16, s38, v16
  v_add_u32 v17, s38, v17
  v_mfma_f32_16x16x32_bf16 v[124:127], a[4:7], a[92:95], v[124:127]
  v_add_u32 v18, s43, v18
  v_add_u32 v19, s43, v19
  v_mfma_f32_16x16x32_bf16 v[156:159], a[8:11], a[92:95], v[156:159]
  v_add_u32 v20, s43, v20
  v_add_u32 v21, s43, v21
  v_mfma_f32_16x16x32_bf16 v[188:191], a[12:15], a[92:95], v[188:191]
  v_mfma_f32_16x16x32_bf16 v[220:223], a[16:19], a[92:95], v[220:223]
  v_mfma_f32_16x16x32_bf16 v[252:255], a[20:23], a[92:95], v[252:255]
  s_waitcnt vmcnt(8) lgkmcnt(0)
  s_barrier
  v_mfma_f32_16x16x32_bf16 a[156:159], a[24:27], a[92:95], a[156:159]
  s_sub_u32 s35, s35, 1
  v_mfma_f32_16x16x32_bf16 a[188:191], a[28:31], a[92:95], a[188:191]
  s_cmp_lg_u32 s35, 0
  s_cbranch_scc1 Lp1xw_loop
  v_accvgpr_read_b32 v4, a222
  v_accvgpr_read_b32 v5, a223
  v_accvgpr_read_b32 v6, a224
  v_accvgpr_read_b32 v7, a225
  v_accvgpr_read_b32 v8, a226
  v_accvgpr_read_b32 v9, a227
  v_accvgpr_read_b32 v10, a228
  v_accvgpr_read_b32 v11, a229
  s_mov_b32 s8, s64
  s_mov_b32 s9, s65
  s_mov_b32 s10, 4194304
  s_mov_b32 s11, 0x00020000
  s_mov_b32 s20, s68
  s_mov_b32 s21, s69
  s_mov_b32 s22, 8388608
  s_mov_b32 s23, 0x00020000
  s_and_b32 s4, s2, 7
  s_lshl_b32 s4, s4, 1
  s_lshr_b32 s5, s2, 6
  s_add_u32 s5, s5, s25
  s_and_b32 s53, s5, 3
  s_lshl_b32 s53, s53, 3
  s_or_b32 s53, s53, 0x80000
  s_bfe_u32 s52, 0xf0f02, s53
  s_add_u32 s52, s52, s4
  s_and_b32 s52, s52, 15
  s_mov_b32 s54, s52
  s_mov_b32 s55, s53
  s_lshl_b32 s29, s52, 7
  s_lshl_b32 s28, s54, 19
  s_lshl_b32 s30, s25, 18
  s_sub_u32 s31, 3932160, s30
  s_or_b32 s26, s30, s29
  s_or_b32 s27, s31, s29
  s_lshl_b32 s68, s3, 12
  s_lshl_b32 s88, s3, 13
  s_add_u32 s88, s88, 98304
  v_mfma_f32_16x16x32_bf16 v[64:67], a[32:35], a[96:99], v[64:67]
  s_mov_b32 m0, s41
  ds_read_b128 a[0:3], v16 offset:0
  v_mfma_f32_16x16x32_bf16 v[96:99], a[36:39], a[96:99], v[96:99]
  buffer_load_dwordx4 v56, s[12:15], s47 offen offset:0 lds
  v_mfma_f32_16x16x32_bf16 v[128:131], a[40:43], a[96:99], v[128:131]
  ds_read_b64_tr_b16 a[64:65], v18 offset:0
  v_mfma_f32_16x16x32_bf16 v[160:163], a[44:47], a[96:99], v[160:163]
  v_mfma_f32_16x16x32_bf16 v[192:195], a[48:51], a[96:99], v[192:195]
  ds_read_b64_tr_b16 a[66:67], v18 offset:2048
  v_mfma_f32_16x16x32_bf16 v[224:227], a[52:55], a[96:99], v[224:227]
  v_mfma_f32_16x16x32_bf16 a[128:131], a[56:59], a[96:99], a[128:131]
  ds_read_b128 a[4:7], v16 offset:2048
  v_mfma_f32_16x16x32_bf16 a[160:163], a[60:63], a[96:99], a[160:163]
  buffer_load_dwordx4 v57, s[12:15], s47 offen offset:1024 lds
  v_mfma_f32_16x16x32_bf16 v[68:71], a[32:35], a[100:103], v[68:71]
  v_mfma_f32_16x16x32_bf16 v[100:103], a[36:39], a[100:103], v[100:103]
  ds_read_b128 a[8:11], v16 offset:4096
  v_mfma_f32_16x16x32_bf16 v[132:135], a[40:43], a[100:103], v[132:135]
  v_mfma_f32_16x16x32_bf16 v[164:167], a[44:47], a[100:103], v[164:167]
  ds_read_b128 a[12:15], v16 offset:6144
  v_mfma_f32_16x16x32_bf16 v[196:199], a[48:51], a[100:103], v[196:199]
  v_mfma_f32_16x16x32_bf16 v[228:231], a[52:55], a[100:103], v[228:231]
  ds_read_b128 a[16:19], v16 offset:8192
  v_mfma_f32_16x16x32_bf16 a[132:135], a[56:59], a[100:103], a[132:135]
  v_mfma_f32_16x16x32_bf16 a[164:167], a[60:63], a[100:103], a[164:167]
  buffer_load_dwordx4 v58, s[12:15], s47 offen offset:2048 lds
  ds_read_b128 a[20:23], v16 offset:10240
  v_mfma_f32_16x16x32_bf16 v[72:75], a[32:35], a[104:107], v[72:75]
  v_mfma_f32_16x16x32_bf16 v[104:107], a[36:39], a[104:107], v[104:107]
  v_mfma_f32_16x16x32_bf16 v[136:139], a[40:43], a[104:107], v[136:139]
  ds_read_b128 a[24:27], v16 offset:12288
  v_mfma_f32_16x16x32_bf16 v[168:171], a[44:47], a[104:107], v[168:171]
  v_mfma_f32_16x16x32_bf16 v[200:203], a[48:51], a[104:107], v[200:203]
  ds_read_b128 a[28:31], v16 offset:14336
  v_mfma_f32_16x16x32_bf16 v[232:235], a[52:55], a[104:107], v[232:235]
  v_mfma_f32_16x16x32_bf16 a[136:139], a[56:59], a[104:107], a[136:139]
  ds_read_b64_tr_b16 a[68:69], v19 offset:0
  v_mfma_f32_16x16x32_bf16 a[168:171], a[60:63], a[104:107], a[168:171]
  buffer_load_dwordx4 v59, s[12:15], s47 offen offset:3072 lds
  v_mfma_f32_16x16x32_bf16 v[76:79], a[32:35], a[108:111], v[76:79]
  s_add_u32 m0, s41, 4096
  ds_read_b64_tr_b16 a[70:71], v19 offset:2048
  v_mfma_f32_16x16x32_bf16 v[108:111], a[36:39], a[108:111], v[108:111]
  v_mfma_f32_16x16x32_bf16 v[140:143], a[40:43], a[108:111], v[140:143]
  v_mfma_f32_16x16x32_bf16 v[172:175], a[44:47], a[108:111], v[172:175]
  ds_read_b64_tr_b16 a[72:73], v20 offset:0
  v_mfma_f32_16x16x32_bf16 v[204:207], a[48:51], a[108:111], v[204:207]
  v_mfma_f32_16x16x32_bf16 v[236:239], a[52:55], a[108:111], v[236:239]
  ds_read_b64_tr_b16 a[74:75], v20 offset:2048
  v_mfma_f32_16x16x32_bf16 a[140:143], a[56:59], a[108:111], a[140:143]
  v_mfma_f32_16x16x32_bf16 a[172:175], a[60:63], a[108:111], a[172:175]
  buffer_load_dwordx4 v60, s[12:15], s47 offen offset:0 lds
  ds_read_b64_tr_b16 a[76:77], v21 offset:0
  v_mfma_f32_16x16x32_bf16 v[80:83], a[32:35], a[112:115], v[80:83]
  v_mfma_f32_16x16x32_bf16 v[112:115], a[36:39], a[112:115], v[112:115]
  ds_read_b64_tr_b16 a[78:79], v21 offset:2048
  v_mfma_f32_16x16x32_bf16 v[144:147], a[40:43], a[112:115], v[144:147]
  v_mfma_f32_16x16x32_bf16 v[176:179], a[44:47], a[112:115], v[176:179]
  v_mfma_f32_16x16x32_bf16 v[208:211], a[48:51], a[112:115], v[208:211]
  ds_read_b64_tr_b16 a[80:81], v18 offset:8192
  v_mfma_f32_16x16x32_bf16 v[240:243], a[52:55], a[112:115], v[240:243]
  v_mfma_f32_16x16x32_bf16 a[144:147], a[56:59], a[112:115], a[144:147]
  ds_read_b64_tr_b16 a[82:83], v18 offset:10240
  v_mfma_f32_16x16x32_bf16 a[176:179], a[60:63], a[112:115], a[176:179]
  buffer_load_dwordx4 v61, s[12:15], s47 offen offset:1024 lds
  v_mfma_f32_16x16x32_bf16 v[84:87], a[32:35], a[116:119], v[84:87]
  ds_read_b64_tr_b16 a[84:85], v19 offset:8192
  v_mfma_f32_16x16x32_bf16 v[116:119], a[36:39], a[116:119], v[116:119]
  v_mfma_f32_16x16x32_bf16 v[148:151], a[40:43], a[116:119], v[148:151]
  ds_read_b64_tr_b16 a[86:87], v19 offset:10240
  v_mfma_f32_16x16x32_bf16 v[180:183], a[44:47], a[116:119], v[180:183]
  v_mfma_f32_16x16x32_bf16 v[212:215], a[48:51], a[116:119], v[212:215]
  v_mfma_f32_16x16x32_bf16 v[244:247], a[52:55], a[116:119], v[244:247]
  ds_read_b64_tr_b16 a[88:89], v20 offset:8192
  v_mfma_f32_16x16x32_bf16 a[148:151], a[56:59], a[116:119], a[148:151]
  v_mfma_f32_16x16x32_bf16 a[180:183], a[60:63], a[116:119], a[180:183]
  buffer_load_dwordx4 v62, s[12:15], s47 offen offset:2048 lds
  ds_read_b64_tr_b16 a[90:91], v20 offset:10240
  v_mfma_f32_16x16x32_bf16 v[88:91], a[32:35], a[120:123], v[88:91]
  v_mfma_f32_16x16x32_bf16 v[120:123], a[36:39], a[120:123], v[120:123]
  ds_read_b64_tr_b16 a[92:93], v21 offset:8192
  v_mfma_f32_16x16x32_bf16 v[152:155], a[40:43], a[120:123], v[152:155]
  v_mfma_f32_16x16x32_bf16 v[184:187], a[44:47], a[120:123], v[184:187]
  ds_read_b64_tr_b16 a[94:95], v21 offset:10240
  v_mfma_f32_16x16x32_bf16 v[216:219], a[48:51], a[120:123], v[216:219]
  v_mfma_f32_16x16x32_bf16 v[248:251], a[52:55], a[120:123], v[248:251]
  v_mfma_f32_16x16x32_bf16 a[152:155], a[56:59], a[120:123], a[152:155]
  v_mfma_f32_16x16x32_bf16 a[184:187], a[60:63], a[120:123], a[184:187]
  buffer_load_dwordx4 v63, s[12:15], s47 offen offset:3072 lds
  v_mfma_f32_16x16x32_bf16 v[92:95], a[32:35], a[124:127], v[92:95]
  v_mfma_f32_16x16x32_bf16 v[124:127], a[36:39], a[124:127], v[124:127]
  v_mfma_f32_16x16x32_bf16 v[156:159], a[40:43], a[124:127], v[156:159]
  v_mfma_f32_16x16x32_bf16 v[188:191], a[44:47], a[124:127], v[188:191]
  v_mfma_f32_16x16x32_bf16 v[220:223], a[48:51], a[124:127], v[220:223]
  v_mfma_f32_16x16x32_bf16 v[252:255], a[52:55], a[124:127], v[252:255]
  v_mfma_f32_16x16x32_bf16 a[156:159], a[56:59], a[124:127], a[156:159]
  v_mfma_f32_16x16x32_bf16 a[188:191], a[60:63], a[124:127], a[188:191]
  s_waitcnt lgkmcnt(0)
  v_mfma_f32_16x16x32_bf16 v[64:67], a[0:3], a[64:67], v[64:67]
  s_mov_b32 m0, s68
  ds_read_b128 a[32:35], v17 offset:0
  v_mfma_f32_16x16x32_bf16 v[96:99], a[4:7], a[64:67], v[96:99]
  buffer_load_dwordx4 v8, s[20:23], s28 offen offset:0 lds
  v_mfma_f32_16x16x32_bf16 v[128:131], a[8:11], a[64:67], v[128:131]
  ds_read_b64_tr_b16 a[96:97], v18 offset:4096
  v_mfma_f32_16x16x32_bf16 v[160:163], a[12:15], a[64:67], v[160:163]
  v_mfma_f32_16x16x32_bf16 v[192:195], a[16:19], a[64:67], v[192:195]
  ds_read_b64_tr_b16 a[98:99], v18 offset:6144
  v_mfma_f32_16x16x32_bf16 v[224:227], a[20:23], a[64:67], v[224:227]
  v_mfma_f32_16x16x32_bf16 a[128:131], a[24:27], a[64:67], a[128:131]
  ds_read_b128 a[36:39], v17 offset:2048
  v_mfma_f32_16x16x32_bf16 a[160:163], a[28:31], a[64:67], a[160:163]
  buffer_load_dwordx4 v9, s[20:23], s28 offen offset:1024 lds
  v_mfma_f32_16x16x32_bf16 v[68:71], a[0:3], a[68:71], v[68:71]
  v_mfma_f32_16x16x32_bf16 v[100:103], a[4:7], a[68:71], v[100:103]
  ds_read_b128 a[40:43], v17 offset:4096
  v_mfma_f32_16x16x32_bf16 v[132:135], a[8:11], a[68:71], v[132:135]
  v_mfma_f32_16x16x32_bf16 v[164:167], a[12:15], a[68:71], v[164:167]
  ds_read_b128 a[44:47], v17 offset:6144
  v_mfma_f32_16x16x32_bf16 v[196:199], a[16:19], a[68:71], v[196:199]
  v_mfma_f32_16x16x32_bf16 v[228:231], a[20:23], a[68:71], v[228:231]
  ds_read_b128 a[48:51], v17 offset:8192
  v_mfma_f32_16x16x32_bf16 a[132:135], a[24:27], a[68:71], a[132:135]
  buffer_load_dwordx4 v10, s[20:23], s28 offen offset:2048 lds
  v_mfma_f32_16x16x32_bf16 a[164:167], a[28:31], a[68:71], a[164:167]
  ds_read_b128 a[52:55], v17 offset:10240
  v_mfma_f32_16x16x32_bf16 v[72:75], a[0:3], a[72:75], v[72:75]
  v_mfma_f32_16x16x32_bf16 v[104:107], a[4:7], a[72:75], v[104:107]
  v_mfma_f32_16x16x32_bf16 v[136:139], a[8:11], a[72:75], v[136:139]
  ds_read_b128 a[56:59], v17 offset:12288
  v_mfma_f32_16x16x32_bf16 v[168:171], a[12:15], a[72:75], v[168:171]
  v_mfma_f32_16x16x32_bf16 v[200:203], a[16:19], a[72:75], v[200:203]
  ds_read_b128 a[60:63], v17 offset:14336
  v_mfma_f32_16x16x32_bf16 v[232:235], a[20:23], a[72:75], v[232:235]
  buffer_load_dwordx4 v11, s[20:23], s28 offen offset:3072 lds
  v_mfma_f32_16x16x32_bf16 a[136:139], a[24:27], a[72:75], a[136:139]
  s_bfe_u32 s56, 0x302010e, s55
  s_add_u32 s54, s54, s56
  s_add_u32 s55, s55, 8
  v_mfma_f32_16x16x32_bf16 a[168:171], a[28:31], a[72:75], a[168:171]
  s_and_b32 s55, s55, 0x8001f
  s_and_b32 s54, s54, 15
  s_lshl_b32 s28, s54, 19
  v_mfma_f32_16x16x32_bf16 v[76:79], a[0:3], a[76:79], v[76:79]
  s_add_u32 m0, s68, 16384
  ds_read_b64_tr_b16 a[100:101], v19 offset:4096
  ds_read_b64_tr_b16 a[102:103], v19 offset:6144
  v_mfma_f32_16x16x32_bf16 v[108:111], a[4:7], a[76:79], v[108:111]
  v_mfma_f32_16x16x32_bf16 v[140:143], a[8:11], a[76:79], v[140:143]
  v_mfma_f32_16x16x32_bf16 v[172:175], a[12:15], a[76:79], v[172:175]
  ds_read_b64_tr_b16 a[104:105], v20 offset:4096
  v_mfma_f32_16x16x32_bf16 v[204:207], a[16:19], a[76:79], v[204:207]
  buffer_load_dwordx4 v8, s[20:23], s28 offen offset:0 lds
  v_mfma_f32_16x16x32_bf16 v[236:239], a[20:23], a[76:79], v[236:239]
  ds_read_b64_tr_b16 a[106:107], v20 offset:6144
  v_mfma_f32_16x16x32_bf16 a[140:143], a[24:27], a[76:79], a[140:143]
  v_mfma_f32_16x16x32_bf16 a[172:175], a[28:31], a[76:79], a[172:175]
  ds_read_b64_tr_b16 a[108:109], v21 offset:4096
  v_mfma_f32_16x16x32_bf16 v[80:83], a[0:3], a[80:83], v[80:83]
  v_mfma_f32_16x16x32_bf16 v[112:115], a[4:7], a[80:83], v[112:115]
  ds_read_b64_tr_b16 a[110:111], v21 offset:6144
  v_mfma_f32_16x16x32_bf16 v[144:147], a[8:11], a[80:83], v[144:147]
  v_mfma_f32_16x16x32_bf16 v[176:179], a[12:15], a[80:83], v[176:179]
  buffer_load_dwordx4 v9, s[20:23], s28 offen offset:1024 lds
  v_mfma_f32_16x16x32_bf16 v[208:211], a[16:19], a[80:83], v[208:211]
  ds_read_b64_tr_b16 a[112:113], v18 offset:12288
  v_mfma_f32_16x16x32_bf16 v[240:243], a[20:23], a[80:83], v[240:243]
  v_mfma_f32_16x16x32_bf16 a[144:147], a[24:27], a[80:83], a[144:147]
  ds_read_b64_tr_b16 a[114:115], v18 offset:14336
  v_mfma_f32_16x16x32_bf16 a[176:179], a[28:31], a[80:83], a[176:179]
  v_mfma_f32_16x16x32_bf16 v[84:87], a[0:3], a[84:87], v[84:87]
  ds_read_b64_tr_b16 a[116:117], v19 offset:12288
  v_mfma_f32_16x16x32_bf16 v[116:119], a[4:7], a[84:87], v[116:119]
  v_mfma_f32_16x16x32_bf16 v[148:151], a[8:11], a[84:87], v[148:151]
  buffer_load_dwordx4 v10, s[20:23], s28 offen offset:2048 lds
  ds_read_b64_tr_b16 a[118:119], v19 offset:14336
  v_mfma_f32_16x16x32_bf16 v[180:183], a[12:15], a[84:87], v[180:183]
  v_mfma_f32_16x16x32_bf16 v[212:215], a[16:19], a[84:87], v[212:215]
  v_mfma_f32_16x16x32_bf16 v[244:247], a[20:23], a[84:87], v[244:247]
  ds_read_b64_tr_b16 a[120:121], v20 offset:12288
  v_mfma_f32_16x16x32_bf16 a[148:151], a[24:27], a[84:87], a[148:151]
  v_mfma_f32_16x16x32_bf16 a[180:183], a[28:31], a[84:87], a[180:183]
  ds_read_b64_tr_b16 a[122:123], v20 offset:14336
  v_mfma_f32_16x16x32_bf16 v[88:91], a[0:3], a[88:91], v[88:91]
  v_mfma_f32_16x16x32_bf16 v[120:123], a[4:7], a[88:91], v[120:123]
  buffer_load_dwordx4 v11, s[20:23], s28 offen offset:3072 lds
  ds_read_b64_tr_b16 a[124:125], v21 offset:12288
  v_mfma_f32_16x16x32_bf16 v[152:155], a[8:11], a[88:91], v[152:155]
  s_bfe_u32 s56, 0x302010e, s55
  s_add_u32 s54, s54, s56
  s_add_u32 s55, s55, 8
  v_mfma_f32_16x16x32_bf16 v[184:187], a[12:15], a[88:91], v[184:187]
  s_and_b32 s55, s55, 0x8001f
  s_and_b32 s54, s54, 15
  s_lshl_b32 s28, s54, 19
  v_mfma_f32_16x16x32_bf16 v[216:219], a[16:19], a[88:91], v[216:219]
  s_add_u32 s36, s36, s38
  s_add_u32 s37, s37, 1
  ds_read_b64_tr_b16 a[126:127], v21 offset:14336
  v_mfma_f32_16x16x32_bf16 v[248:251], a[20:23], a[88:91], v[248:251]
  s_cmp_eq_u32 s37, 3
  s_cselect_b32 s37, 0, s37
  s_cselect_b32 s38, s39, s40
  v_mfma_f32_16x16x32_bf16 a[152:155], a[24:27], a[88:91], a[152:155]
  s_add_u32 s41, s41, s43
  s_sub_u32 s43, 0, s43
  v_mfma_f32_16x16x32_bf16 a[184:187], a[28:31], a[88:91], a[184:187]
  v_add_u32 v16, s38, v16
  v_add_u32 v17, s38, v17
  v_mfma_f32_16x16x32_bf16 v[92:95], a[0:3], a[92:95], v[92:95]
  v_add_u32 v18, s43, v18
  v_add_u32 v19, s43, v19
  v_mfma_f32_16x16x32_bf16 v[124:127], a[4:7], a[92:95], v[124:127]
  v_add_u32 v20, s43, v20
  v_add_u32 v21, s43, v21
  v_mfma_f32_16x16x32_bf16 v[156:159], a[8:11], a[92:95], v[156:159]
  v_mfma_f32_16x16x32_bf16 v[188:191], a[12:15], a[92:95], v[188:191]
  v_mfma_f32_16x16x32_bf16 v[220:223], a[16:19], a[92:95], v[220:223]
  v_mfma_f32_16x16x32_bf16 v[252:255], a[20:23], a[92:95], v[252:255]
  v_mfma_f32_16x16x32_bf16 a[156:159], a[24:27], a[92:95], a[156:159]
  v_mfma_f32_16x16x32_bf16 a[188:191], a[28:31], a[92:95], a[188:191]
  s_waitcnt vmcnt(8) lgkmcnt(0)
  s_barrier
  v_mfma_f32_16x16x32_bf16 v[64:67], a[32:35], a[96:99], v[64:67]
  s_mov_b32 m0, s88
  ds_read_b128 a[0:3], v16 offset:0
  v_mfma_f32_16x16x32_bf16 v[96:99], a[36:39], a[96:99], v[96:99]
  buffer_load_dwordx4 v4, s[8:11], s26 offen offset:0 lds
  v_mfma_f32_16x16x32_bf16 v[128:131], a[40:43], a[96:99], v[128:131]
  ds_read_b64_tr_b16 a[64:65], v18 offset:0
  v_mfma_f32_16x16x32_bf16 v[160:163], a[44:47], a[96:99], v[160:163]
  v_mfma_f32_16x16x32_bf16 v[192:195], a[48:51], a[96:99], v[192:195]
  ds_read_b64_tr_b16 a[66:67], v18 offset:2048
  v_mfma_f32_16x16x32_bf16 v[224:227], a[52:55], a[96:99], v[224:227]
  v_mfma_f32_16x16x32_bf16 a[128:131], a[56:59], a[96:99], a[128:131]
  ds_read_b128 a[4:7], v16 offset:2048
  v_mfma_f32_16x16x32_bf16 a[160:163], a[60:63], a[96:99], a[160:163]
  buffer_load_dwordx4 v5, s[8:11], s26 offen offset:1024 lds
  v_mfma_f32_16x16x32_bf16 v[68:71], a[32:35], a[100:103], v[68:71]
  v_mfma_f32_16x16x32_bf16 v[100:103], a[36:39], a[100:103], v[100:103]
  ds_read_b128 a[8:11], v16 offset:4096
  v_mfma_f32_16x16x32_bf16 v[132:135], a[40:43], a[100:103], v[132:135]
  v_mfma_f32_16x16x32_bf16 v[164:167], a[44:47], a[100:103], v[164:167]
  ds_read_b128 a[12:15], v16 offset:6144
  v_mfma_f32_16x16x32_bf16 v[196:199], a[48:51], a[100:103], v[196:199]
  v_mfma_f32_16x16x32_bf16 v[228:231], a[52:55], a[100:103], v[228:231]
  ds_read_b128 a[16:19], v16 offset:8192
  v_mfma_f32_16x16x32_bf16 a[132:135], a[56:59], a[100:103], a[132:135]
  v_mfma_f32_16x16x32_bf16 a[164:167], a[60:63], a[100:103], a[164:167]
  buffer_load_dwordx4 v6, s[8:11], s26 offen offset:2048 lds
  ds_read_b128 a[20:23], v16 offset:10240
  v_mfma_f32_16x16x32_bf16 v[72:75], a[32:35], a[104:107], v[72:75]
  v_mfma_f32_16x16x32_bf16 v[104:107], a[36:39], a[104:107], v[104:107]
  v_mfma_f32_16x16x32_bf16 v[136:139], a[40:43], a[104:107], v[136:139]
  ds_read_b128 a[24:27], v16 offset:12288
  v_mfma_f32_16x16x32_bf16 v[168:171], a[44:47], a[104:107], v[168:171]
  v_mfma_f32_16x16x32_bf16 v[200:203], a[48:51], a[104:107], v[200:203]
  ds_read_b128 a[28:31], v16 offset:14336
  v_mfma_f32_16x16x32_bf16 v[232:235], a[52:55], a[104:107], v[232:235]
  v_mfma_f32_16x16x32_bf16 a[136:139], a[56:59], a[104:107], a[136:139]
  ds_read_b64_tr_b16 a[68:69], v19 offset:0
  v_mfma_f32_16x16x32_bf16 a[168:171], a[60:63], a[104:107], a[168:171]
  buffer_load_dwordx4 v7, s[8:11], s26 offen offset:3072 lds
  v_mfma_f32_16x16x32_bf16 v[76:79], a[32:35], a[108:111], v[76:79]
  s_add_u32 m0, s88, 4096
  ds_read_b64_tr_b16 a[70:71], v19 offset:2048
  v_mfma_f32_16x16x32_bf16 v[108:111], a[36:39], a[108:111], v[108:111]
  v_mfma_f32_16x16x32_bf16 v[140:143], a[40:43], a[108:111], v[140:143]
  v_mfma_f32_16x16x32_bf16 v[172:175], a[44:47], a[108:111], v[172:175]
  ds_read_b64_tr_b16 a[72:73], v20 offset:0
  v_mfma_f32_16x16x32_bf16 v[204:207], a[48:51], a[108:111], v[204:207]
  v_mfma_f32_16x16x32_bf16 v[236:239], a[52:55], a[108:111], v[236:239]
  ds_read_b64_tr_b16 a[74:75], v20 offset:2048
  v_mfma_f32_16x16x32_bf16 a[140:143], a[56:59], a[108:111], a[140:143]
  v_mfma_f32_16x16x32_bf16 a[172:175], a[60:63], a[108:111], a[172:175]
  buffer_load_dwordx4 v4, s[8:11], s27 offen offset:0 lds
  ds_read_b64_tr_b16 a[76:77], v21 offset:0
  v_mfma_f32_16x16x32_bf16 v[80:83], a[32:35], a[112:115], v[80:83]
  v_mfma_f32_16x16x32_bf16 v[112:115], a[36:39], a[112:115], v[112:115]
  ds_read_b64_tr_b16 a[78:79], v21 offset:2048
  v_mfma_f32_16x16x32_bf16 v[144:147], a[40:43], a[112:115], v[144:147]
  v_mfma_f32_16x16x32_bf16 v[176:179], a[44:47], a[112:115], v[176:179]
  v_mfma_f32_16x16x32_bf16 v[208:211], a[48:51], a[112:115], v[208:211]
  ds_read_b64_tr_b16 a[80:81], v18 offset:8192
  v_mfma_f32_16x16x32_bf16 v[240:243], a[52:55], a[112:115], v[240:243]
  v_mfma_f32_16x16x32_bf16 a[144:147], a[56:59], a[112:115], a[144:147]
  ds_read_b64_tr_b16 a[82:83], v18 offset:10240
  v_mfma_f32_16x16x32_bf16 a[176:179], a[60:63], a[112:115], a[176:179]
  buffer_load_dwordx4 v5, s[8:11], s27 offen offset:1024 lds
  v_mfma_f32_16x16x32_bf16 v[84:87], a[32:35], a[116:119], v[84:87]
  ds_read_b64_tr_b16 a[84:85], v19 offset:8192
  v_mfma_f32_16x16x32_bf16 v[116:119], a[36:39], a[116:119], v[116:119]
  v_mfma_f32_16x16x32_bf16 v[148:151], a[40:43], a[116:119], v[148:151]
  ds_read_b64_tr_b16 a[86:87], v19 offset:10240
  v_mfma_f32_16x16x32_bf16 v[180:183], a[44:47], a[116:119], v[180:183]
  v_mfma_f32_16x16x32_bf16 v[212:215], a[48:51], a[116:119], v[212:215]
  v_mfma_f32_16x16x32_bf16 v[244:247], a[52:55], a[116:119], v[244:247]
  ds_read_b64_tr_b16 a[88:89], v20 offset:8192
  v_mfma_f32_16x16x32_bf16 a[148:151], a[56:59], a[116:119], a[148:151]
  v_mfma_f32_16x16x32_bf16 a[180:183], a[60:63], a[116:119], a[180:183]
  buffer_load_dwordx4 v6, s[8:11], s27 offen offset:2048 lds
  ds_read_b64_tr_b16 a[90:91], v20 offset:10240
  v_mfma_f32_16x16x32_bf16 v[88:91], a[32:35], a[120:123], v[88:91]
  v_mfma_f32_16x16x32_bf16 v[120:123], a[36:39], a[120:123], v[120:123]
  ds_read_b64_tr_b16 a[92:93], v21 offset:8192
  v_mfma_f32_16x16x32_bf16 v[152:155], a[40:43], a[120:123], v[152:155]
  v_mfma_f32_16x16x32_bf16 v[184:187], a[44:47], a[120:123], v[184:187]
  ds_read_b64_tr_b16 a[94:95], v21 offset:10240
  v_mfma_f32_16x16x32_bf16 v[216:219], a[48:51], a[120:123], v[216:219]
  v_mfma_f32_16x16x32_bf16 v[248:251], a[52:55], a[120:123], v[248:251]
  v_mfma_f32_16x16x32_bf16 a[152:155], a[56:59], a[120:123], a[152:155]
  v_mfma_f32_16x16x32_bf16 a[184:187], a[60:63], a[120:123], a[184:187]
  buffer_load_dwordx4 v7, s[8:11], s27 offen offset:3072 lds
  v_mfma_f32_16x16x32_bf16 v[92:95], a[32:35], a[124:127], v[92:95]
  s_bfe_u32 s29, 0x302010e, s53
  s_add_u32 s52, s52, s29
  s_add_u32 s53, s53, 8
  v_mfma_f32_16x16x32_bf16 v[124:127], a[36:39], a[124:127], v[124:127]
  s_and_b32 s53, s53, 0x8001f
  s_and_b32 s52, s52, 15
  s_lshl_b32 s29, s52, 7
  v_mfma_f32_16x16x32_bf16 v[156:159], a[40:43], a[124:127], v[156:159]
  s_or_b32 s26, s30, s29
  s_or_b32 s27, s31, s29
  v_mfma_f32_16x16x32_bf16 v[188:191], a[44:47], a[124:127], v[188:191]
  v_mfma_f32_16x16x32_bf16 v[220:223], a[48:51], a[124:127], v[220:223]
  v_mfma_f32_16x16x32_bf16 v[252:255], a[52:55], a[124:127], v[252:255]
  v_mfma_f32_16x16x32_bf16 a[156:159], a[56:59], a[124:127], a[156:159]
  v_mfma_f32_16x16x32_bf16 a[188:191], a[60:63], a[124:127], a[188:191]
  s_waitcnt lgkmcnt(0)
  v_mfma_f32_16x16x32_bf16 v[128:131], a[8:11], a[64:67], v[128:131]
  ds_read_b128 a[32:35], v17 offset:0
  ds_read_b64_tr_b16 a[96:97], v18 offset:4096
  v_mfma_f32_16x16x32_bf16 v[160:163], a[12:15], a[64:67], v[160:163]
  ds_read_b64_tr_b16 a[98:99], v18 offset:6144
  ds_read_b128 a[36:39], v17 offset:2048
  v_mfma_f32_16x16x32_bf16 v[132:135], a[8:11], a[68:71], v[132:135]
  ds_read_b128 a[40:43], v17 offset:4096
  ds_read_b128 a[44:47], v17 offset:6144
  v_mfma_f32_16x16x32_bf16 v[164:167], a[12:15], a[68:71], v[164:167]
  ds_read_b128 a[48:51], v17 offset:8192
  ds_read_b128 a[52:55], v17 offset:10240
  v_mfma_f32_16x16x32_bf16 v[136:139], a[8:11], a[72:75], v[136:139]
  ds_read_b128 a[56:59], v17 offset:12288
  ds_read_b128 a[60:63], v17 offset:14336
  v_mfma_f32_16x16x32_bf16 v[168:171], a[12:15], a[72:75], v[168:171]
  ds_read_b64_tr_b16 a[100:101], v19 offset:4096
  ds_read_b64_tr_b16 a[102:103], v19 offset:6144
  v_mfma_f32_16x16x32_bf16 v[140:143], a[8:11], a[76:79], v[140:143]
  ds_read_b64_tr_b16 a[104:105], v20 offset:4096
  v_mfma_f32_16x16x32_bf16 v[172:175], a[12:15], a[76:79], v[172:175]
  ds_read_b64_tr_b16 a[106:107], v20 offset:6144
  ds_read_b64_tr_b16 a[108:109], v21 offset:4096
  v_mfma_f32_16x16x32_bf16 v[144:147], a[8:11], a[80:83], v[144:147]
  ds_read_b64_tr_b16 a[110:111], v21 offset:6144
  ds_read_b64_tr_b16 a[112:113], v18 offset:12288
  v_mfma_f32_16x16x32_bf16 v[176:179], a[12:15], a[80:83], v[176:179]
  ds_read_b64_tr_b16 a[114:115], v18 offset:14336
  ds_read_b64_tr_b16 a[116:117], v19 offset:12288
  v_mfma_f32_16x16x32_bf16 v[148:151], a[8:11], a[84:87], v[148:151]
  ds_read_b64_tr_b16 a[118:119], v19 offset:14336
  ds_read_b64_tr_b16 a[120:121], v20 offset:12288
  v_mfma_f32_16x16x32_bf16 v[180:183], a[12:15], a[84:87], v[180:183]
  ds_read_b64_tr_b16 a[122:123], v20 offset:14336
  ds_read_b64_tr_b16 a[124:125], v21 offset:12288
  v_mfma_f32_16x16x32_bf16 v[152:155], a[8:11], a[88:91], v[152:155]
  ds_read_b64_tr_b16 a[126:127], v21 offset:14336
  v_mfma_f32_16x16x32_bf16 v[184:187], a[12:15], a[88:91], v[184:187]
  v_mfma_f32_16x16x32_bf16 v[156:159], a[8:11], a[92:95], v[156:159]
  v_mfma_f32_16x16x32_bf16 v[188:191], a[12:15], a[92:95], v[188:191]
  v_mfma_f32_16x16x32_bf16 v[192:195], a[16:19], a[64:67], v[192:195]
  v_mfma_f32_16x16x32_bf16 v[224:227], a[20:23], a[64:67], v[224:227]
  s_waitcnt lgkmcnt(0)
  s_barrier
  s_mov_b32 s12, s84
  s_mov_b32 s13, s85
  s_mov_b32 s14, 256
  s_mov_b32 s15, 0x00020000
  buffer_load_dwordx2 v[22:23], off, s[12:15], 0 sc1
  v_mfma_f32_16x16x32_bf16 v[128:131], a[40:43], a[96:99], v[128:131]
  s_add_u32 m0, s88, 32768
  v_mfma_f32_16x16x32_bf16 v[160:163], a[44:47], a[96:99], v[160:163]
  buffer_load_dwordx4 v4, s[8:11], s26 offen offset:0 lds
  v_mfma_f32_16x16x32_bf16 v[132:135], a[40:43], a[100:103], v[132:135]
  v_mfma_f32_16x16x32_bf16 v[164:167], a[44:47], a[100:103], v[164:167]
  v_mfma_f32_16x16x32_bf16 v[136:139], a[40:43], a[104:107], v[136:139]
  v_mfma_f32_16x16x32_bf16 v[168:171], a[44:47], a[104:107], v[168:171]
  buffer_load_dwordx4 v5, s[8:11], s26 offen offset:1024 lds
  v_cvt_pk_bf16_f32 v128, v128, v129
  v_mfma_f32_16x16x32_bf16 v[140:143], a[40:43], a[108:111], v[140:143]
  v_cvt_pk_bf16_f32 v129, v130, v131
  v_cvt_pk_bf16_f32 v130, v160, v161
  v_mfma_f32_16x16x32_bf16 v[172:175], a[44:47], a[108:111], v[172:175]
  v_cvt_pk_bf16_f32 v131, v162, v163
  v_cvt_pk_bf16_f32 v132, v132, v133
  v_mfma_f32_16x16x32_bf16 v[144:147], a[40:43], a[112:115], v[144:147]
  v_cvt_pk_bf16_f32 v133, v134, v135
  v_cvt_pk_bf16_f32 v134, v164, v165
  v_mfma_f32_16x16x32_bf16 v[176:179], a[44:47], a[112:115], v[176:179]
  v_cvt_pk_bf16_f32 v135, v166, v167
  v_mfma_f32_16x16x32_bf16 v[148:151], a[40:43], a[116:119], v[148:151]
  buffer_load_dwordx4 v6, s[8:11], s26 offen offset:2048 lds
  v_mfma_f32_16x16x32_bf16 v[180:183], a[44:47], a[116:119], v[180:183]
  s_add_u32 s60, s63, 8192
  buffer_store_dwordx4 v[128:131], v2, s[16:19], s60 offen offset:0 sc1
  v_cvt_pk_bf16_f32 v136, v136, v137
  v_mfma_f32_16x16x32_bf16 v[152:155], a[40:43], a[120:123], v[152:155]
  v_cvt_pk_bf16_f32 v137, v138, v139
  v_cvt_pk_bf16_f32 v138, v168, v169
  v_mfma_f32_16x16x32_bf16 v[184:187], a[44:47], a[120:123], v[184:187]
  v_cvt_pk_bf16_f32 v139, v170, v171
  v_cvt_pk_bf16_f32 v140, v140, v141
  v_mfma_f32_16x16x32_bf16 v[156:159], a[40:43], a[124:127], v[156:159]
  v_cvt_pk_bf16_f32 v141, v142, v143
  v_cvt_pk_bf16_f32 v142, v172, v173
  v_mfma_f32_16x16x32_bf16 v[188:191], a[44:47], a[124:127], v[188:191]
  v_cvt_pk_bf16_f32 v143, v174, v175
  v_cvt_pk_bf16_f32 v144, v144, v145
  v_mfma_f32_16x16x32_bf16 v[192:195], a[48:51], a[96:99], v[192:195]
  buffer_load_dwordx4 v7, s[8:11], s26 offen offset:3072 lds
  v_cvt_pk_bf16_f32 v145, v146, v147
  v_mfma_f32_16x16x32_bf16 v[224:227], a[52:55], a[96:99], v[224:227]
  s_add_u32 m0, s88, 36864
  v_cvt_pk_bf16_f32 v146, v176, v177
  v_cvt_pk_bf16_f32 v147, v178, v179
  v_mfma_f32_16x16x32_bf16 a[128:131], a[24:27], a[64:67], a[128:131]
  s_add_u32 s60, s63, 8192
  buffer_store_dwordx4 v[132:135], v2, s[16:19], s60 offen offset:1024 sc1
  v_cvt_pk_bf16_f32 v148, v148, v149
  v_mfma_f32_16x16x32_bf16 a[160:163], a[28:31], a[64:67], a[160:163]
  v_cvt_pk_bf16_f32 v149, v150, v151
  v_cvt_pk_bf16_f32 v150, v180, v181
  v_mfma_f32_16x16x32_bf16 a[128:131], a[56:59], a[96:99], a[128:131]
  v_cvt_pk_bf16_f32 v151, v182, v183
  v_cvt_pk_bf16_f32 v152, v152, v153
  v_mfma_f32_16x16x32_bf16 a[160:163], a[60:63], a[96:99], a[160:163]
  buffer_load_dwordx4 v4, s[8:11], s27 offen offset:0 lds
  v_cvt_pk_bf16_f32 v153, v154, v155
  v_mfma_f32_16x16x32_bf16 v[196:199], a[16:19], a[68:71], v[196:199]
  v_cvt_pk_bf16_f32 v154, v184, v185
  v_cvt_pk_bf16_f32 v155, v186, v187
  v_mfma_f32_16x16x32_bf16 v[228:231], a[20:23], a[68:71], v[228:231]
  v_cvt_pk_bf16_f32 v156, v156, v157
  v_cvt_pk_bf16_f32 v157, v158, v159
  v_mfma_f32_16x16x32_bf16 v[196:199], a[48:51], a[100:103], v[196:199]
  v_cvt_pk_bf16_f32 v158, v188, v189
  v_cvt_pk_bf16_f32 v159, v190, v191
  v_mfma_f32_16x16x32_bf16 v[228:231], a[52:55], a[100:103], v[228:231]
  v_cvt_pk_bf16_f32 v192, v192, v193
  v_cvt_pk_bf16_f32 v193, v194, v195
  v_mfma_f32_16x16x32_bf16 a[132:135], a[24:27], a[68:71], a[132:135]
  v_cvt_pk_bf16_f32 v194, v224, v225
  v_cvt_pk_bf16_f32 v195, v226, v227
  v_mfma_f32_16x16x32_bf16 a[164:167], a[28:31], a[68:71], a[164:167]
  buffer_load_dwordx4 v5, s[8:11], s27 offen offset:1024 lds
  v_mfma_f32_16x16x32_bf16 a[132:135], a[56:59], a[100:103], a[132:135]
  s_add_u32 s60, s63, 8192
  buffer_store_dwordx4 v[136:139], v2, s[16:19], s60 offen offset:2048 sc1
  v_accvgpr_read_b32 v24, a128
  v_mfma_f32_16x16x32_bf16 a[164:167], a[60:63], a[100:103], a[164:167]
  v_accvgpr_read_b32 v25, a129
  v_accvgpr_read_b32 v26, a130
  v_mfma_f32_16x16x32_bf16 v[200:203], a[16:19], a[72:75], v[200:203]
  v_accvgpr_read_b32 v27, a131
  v_accvgpr_read_b32 v28, a160
  v_mfma_f32_16x16x32_bf16 v[232:235], a[20:23], a[72:75], v[232:235]
  v_accvgpr_read_b32 v29, a161
  v_accvgpr_read_b32 v30, a162
  v_mfma_f32_16x16x32_bf16 v[200:203], a[48:51], a[104:107], v[200:203]
  buffer_load_dwordx4 v6, s[8:11], s27 offen offset:2048 lds
  v_accvgpr_read_b32 v31, a163
  v_mfma_f32_16x16x32_bf16 v[232:235], a[52:55], a[104:107], v[232:235]
  v_cvt_pk_bf16_f32 v224, v24, v25
  v_cvt_pk_bf16_f32 v225, v26, v27
  v_mfma_f32_16x16x32_bf16 a[136:139], a[24:27], a[72:75], a[136:139]
  v_cvt_pk_bf16_f32 v226, v28, v29
  v_cvt_pk_bf16_f32 v227, v30, v31
  v_mfma_f32_16x16x32_bf16 a[168:171], a[28:31], a[72:75], a[168:171]
  v_cvt_pk_bf16_f32 v196, v196, v197
  v_cvt_pk_bf16_f32 v197, v198, v199
  v_mfma_f32_16x16x32_bf16 a[136:139], a[56:59], a[104:107], a[136:139]
  v_cvt_pk_bf16_f32 v198, v228, v229
  v_cvt_pk_bf16_f32 v199, v230, v231
  v_mfma_f32_16x16x32_bf16 a[168:171], a[60:63], a[104:107], a[168:171]
  v_accvgpr_read_b32 v32, a132
  v_accvgpr_read_b32 v33, a133
  v_mfma_f32_16x16x32_bf16 v[204:207], a[16:19], a[76:79], v[204:207]
  buffer_load_dwordx4 v7, s[8:11], s27 offen offset:3072 lds
  v_accvgpr_read_b32 v34, a134
  v_mfma_f32_16x16x32_bf16 v[236:239], a[20:23], a[76:79], v[236:239]
  s_bfe_u32 s29, 0x302010e, s53
  s_add_u32 s52, s52, s29
  s_add_u32 s53, s53, 8
  v_mfma_f32_16x16x32_bf16 v[204:207], a[48:51], a[108:111], v[204:207]
  s_and_b32 s53, s53, 0x8001f
  s_and_b32 s52, s52, 15
  s_lshl_b32 s29, s52, 7
  v_mfma_f32_16x16x32_bf16 v[236:239], a[52:55], a[108:111], v[236:239]
  s_or_b32 s26, s30, s29
  s_or_b32 s27, s31, s29
  s_add_u32 m0, s68, 32768
  v_mfma_f32_16x16x32_bf16 a[140:143], a[24:27], a[76:79], a[140:143]
  v_accvgpr_read_b32 v35, a135
  v_accvgpr_read_b32 v36, a164
  v_mfma_f32_16x16x32_bf16 a[172:175], a[28:31], a[76:79], a[172:175]
  buffer_load_dwordx4 v8, s[20:23], s28 offen offset:0 lds
  v_accvgpr_read_b32 v37, a165
  v_mfma_f32_16x16x32_bf16 a[140:143], a[56:59], a[108:111], a[140:143]
  v_accvgpr_read_b32 v38, a166
  v_accvgpr_read_b32 v39, a167
  v_mfma_f32_16x16x32_bf16 a[172:175], a[60:63], a[108:111], a[172:175]
  v_cvt_pk_bf16_f32 v228, v32, v33
  v_cvt_pk_bf16_f32 v229, v34, v35
  v_mfma_f32_16x16x32_bf16 v[208:211], a[16:19], a[80:83], v[208:211]
  v_cvt_pk_bf16_f32 v230, v36, v37
  v_cvt_pk_bf16_f32 v231, v38, v39
  v_mfma_f32_16x16x32_bf16 v[240:243], a[20:23], a[80:83], v[240:243]
  s_add_u32 s60, s63, 8192
  buffer_store_dwordx4 v[140:143], v2, s[16:19], s60 offen offset:3072 sc1
  v_cvt_pk_bf16_f32 v200, v200, v201
  v_mfma_f32_16x16x32_bf16 v[208:211], a[48:51], a[112:115], v[208:211]
  v_cvt_pk_bf16_f32 v201, v202, v203
  v_cvt_pk_bf16_f32 v202, v232, v233
  v_mfma_f32_16x16x32_bf16 v[240:243], a[52:55], a[112:115], v[240:243]
  buffer_load_dwordx4 v9, s[20:23], s28 offen offset:1024 lds
  v_cvt_pk_bf16_f32 v203, v234, v235
  v_mfma_f32_16x16x32_bf16 a[144:147], a[24:27], a[80:83], a[144:147]
  v_accvgpr_read_b32 v40, a136
  v_accvgpr_read_b32 v41, a137
  v_mfma_f32_16x16x32_bf16 a[176:179], a[28:31], a[80:83], a[176:179]
  v_accvgpr_read_b32 v42, a138
  v_accvgpr_read_b32 v43, a139
  v_mfma_f32_16x16x32_bf16 a[144:147], a[56:59], a[112:115], a[144:147]
  v_accvgpr_read_b32 v44, a168
  v_accvgpr_read_b32 v45, a169
  v_mfma_f32_16x16x32_bf16 a[176:179], a[60:63], a[112:115], a[176:179]
  v_accvgpr_read_b32 v46, a170
  v_accvgpr_read_b32 v47, a171
  v_mfma_f32_16x16x32_bf16 v[212:215], a[16:19], a[84:87], v[212:215]
  buffer_load_dwordx4 v10, s[20:23], s28 offen offset:2048 lds
  v_cvt_pk_bf16_f32 v232, v40, v41
  v_mfma_f32_16x16x32_bf16 v[244:247], a[20:23], a[84:87], v[244:247]
  v_cvt_pk_bf16_f32 v233, v42, v43
  v_cvt_pk_bf16_f32 v234, v44, v45
  v_mfma_f32_16x16x32_bf16 v[212:215], a[48:51], a[116:119], v[212:215]
  v_cvt_pk_bf16_f32 v235, v46, v47
  v_cvt_pk_bf16_f32 v204, v204, v205
  v_mfma_f32_16x16x32_bf16 v[244:247], a[52:55], a[116:119], v[244:247]
  v_cvt_pk_bf16_f32 v205, v206, v207
  v_cvt_pk_bf16_f32 v206, v236, v237
  v_mfma_f32_16x16x32_bf16 a[148:151], a[24:27], a[84:87], a[148:151]
  v_cvt_pk_bf16_f32 v207, v238, v239
  v_accvgpr_read_b32 v24, a140
  v_mfma_f32_16x16x32_bf16 a[180:183], a[28:31], a[84:87], a[180:183]
  buffer_load_dwordx4 v11, s[20:23], s28 offen offset:3072 lds
  v_accvgpr_read_b32 v25, a141
  v_mfma_f32_16x16x32_bf16 a[148:151], a[56:59], a[116:119], a[148:151]
  s_bfe_u32 s56, 0x302010e, s55
  s_add_u32 s54, s54, s56
  s_add_u32 s55, s55, 8
  v_mfma_f32_16x16x32_bf16 a[180:183], a[60:63], a[116:119], a[180:183]
  s_and_b32 s55, s55, 0x8001f
  s_and_b32 s54, s54, 15
  s_lshl_b32 s28, s54, 19
  v_mfma_f32_16x16x32_bf16 v[216:219], a[16:19], a[88:91], v[216:219]
  s_add_u32 m0, s88, -32768
  v_accvgpr_read_b32 v26, a142
  v_accvgpr_read_b32 v27, a143
  v_mfma_f32_16x16x32_bf16 v[248:251], a[20:23], a[88:91], v[248:251]
  v_accvgpr_read_b32 v28, a172
  v_accvgpr_read_b32 v29, a173
  v_mfma_f32_16x16x32_bf16 v[216:219], a[48:51], a[120:123], v[216:219]
  v_accvgpr_read_b32 v30, a174
  v_accvgpr_read_b32 v31, a175
  v_mfma_f32_16x16x32_bf16 v[248:251], a[52:55], a[120:123], v[248:251]
  buffer_load_dwordx4 v4, s[8:11], s26 offen offset:0 lds
  v_cvt_pk_bf16_f32 v236, v24, v25
  v_mfma_f32_16x16x32_bf16 a[152:155], a[24:27], a[88:91], a[152:155]
  v_cvt_pk_bf16_f32 v237, v26, v27
  v_cvt_pk_bf16_f32 v238, v28, v29
  v_mfma_f32_16x16x32_bf16 a[184:187], a[28:31], a[88:91], a[184:187]
  v_cvt_pk_bf16_f32 v239, v30, v31
  v_mfma_f32_16x16x32_bf16 a[152:155], a[56:59], a[120:123], a[152:155]
  s_add_u32 s60, s63, 12288
  buffer_store_dwordx4 v[144:147], v2, s[16:19], s60 offen offset:0 sc1
  v_cvt_pk_bf16_f32 v208, v208, v209
  v_mfma_f32_16x16x32_bf16 a[184:187], a[60:63], a[120:123], a[184:187]
  v_cvt_pk_bf16_f32 v209, v210, v211
  v_cvt_pk_bf16_f32 v210, v240, v241
  v_mfma_f32_16x16x32_bf16 v[220:223], a[16:19], a[92:95], v[220:223]
  buffer_load_dwordx4 v5, s[8:11], s26 offen offset:1024 lds
  v_cvt_pk_bf16_f32 v211, v242, v243
  v_mfma_f32_16x16x32_bf16 v[252:255], a[20:23], a[92:95], v[252:255]
  v_accvgpr_read_b32 v32, a144
  v_accvgpr_read_b32 v33, a145
  v_mfma_f32_16x16x32_bf16 v[220:223], a[48:51], a[124:127], v[220:223]
  v_accvgpr_read_b32 v34, a146
  v_accvgpr_read_b32 v35, a147
  v_mfma_f32_16x16x32_bf16 v[252:255], a[52:55], a[124:127], v[252:255]
  v_accvgpr_read_b32 v36, a176
  v_accvgpr_read_b32 v37, a177
  v_mfma_f32_16x16x32_bf16 a[156:159], a[24:27], a[92:95], a[156:159]
  v_accvgpr_read_b32 v38, a178
  v_accvgpr_read_b32 v39, a179
  v_mfma_f32_16x16x32_bf16 a[188:191], a[28:31], a[92:95], a[188:191]
  v_cvt_pk_bf16_f32 v240, v32, v33
  v_cvt_pk_bf16_f32 v241, v34, v35
  v_mfma_f32_16x16x32_bf16 a[156:159], a[56:59], a[124:127], a[156:159]
  buffer_load_dwordx4 v6, s[8:11], s26 offen offset:2048 lds
  v_cvt_pk_bf16_f32 v242, v36, v37
  v_mfma_f32_16x16x32_bf16 a[188:191], a[60:63], a[124:127], a[188:191]
  v_cvt_pk_bf16_f32 v243, v38, v39
  v_cvt_pk_bf16_f32 v212, v212, v213
  v_mfma_f32_16x16x32_bf16 v[64:67], a[0:3], a[64:67], v[64:67]
  v_cvt_pk_bf16_f32 v213, v214, v215
  v_cvt_pk_bf16_f32 v214, v244, v245
  v_mfma_f32_16x16x32_bf16 v[96:99], a[4:7], a[64:67], v[96:99]
  v_cvt_pk_bf16_f32 v215, v246, v247
  v_mfma_f32_16x16x32_bf16 v[64:67], a[32:35], a[96:99], v[64:67]
  s_add_u32 s60, s63, 12288
  buffer_store_dwordx4 v[148:151], v2, s[16:19], s60 offen offset:1024 sc1
  v_accvgpr_read_b32 v40, a148
  v_mfma_f32_16x16x32_bf16 v[96:99], a[36:39], a[96:99], v[96:99]
  buffer_load_dwordx4 v7, s[8:11], s26 offen offset:3072 lds
  v_accvgpr_read_b32 v41, a149
  v_mfma_f32_16x16x32_bf16 v[68:71], a[0:3], a[68:71], v[68:71]
  s_add_u32 m0, s88, -28672
  v_accvgpr_read_b32 v42, a150
  v_accvgpr_read_b32 v43, a151
  v_mfma_f32_16x16x32_bf16 v[100:103], a[4:7], a[68:71], v[100:103]
  v_accvgpr_read_b32 v44, a180
  v_accvgpr_read_b32 v45, a181
  v_mfma_f32_16x16x32_bf16 v[68:71], a[32:35], a[100:103], v[68:71]
  v_accvgpr_read_b32 v46, a182
  v_accvgpr_read_b32 v47, a183
  v_mfma_f32_16x16x32_bf16 v[100:103], a[36:39], a[100:103], v[100:103]
  v_cvt_pk_bf16_f32 v244, v40, v41
  v_cvt_pk_bf16_f32 v245, v42, v43
  v_mfma_f32_16x16x32_bf16 v[72:75], a[0:3], a[72:75], v[72:75]
  v_cvt_pk_bf16_f32 v246, v44, v45
  v_cvt_pk_bf16_f32 v247, v46, v47
  v_mfma_f32_16x16x32_bf16 v[104:107], a[4:7], a[72:75], v[104:107]
  buffer_load_dwordx4 v4, s[8:11], s27 offen offset:0 lds
  v_cvt_pk_bf16_f32 v216, v216, v217
  v_mfma_f32_16x16x32_bf16 v[72:75], a[32:35], a[104:107], v[72:75]
  v_cvt_pk_bf16_f32 v217, v218, v219
  v_cvt_pk_bf16_f32 v218, v248, v249
  v_mfma_f32_16x16x32_bf16 v[104:107], a[36:39], a[104:107], v[104:107]
  v_cvt_pk_bf16_f32 v219, v250, v251
  v_accvgpr_read_b32 v24, a152
  v_mfma_f32_16x16x32_bf16 v[76:79], a[0:3], a[76:79], v[76:79]
  v_accvgpr_read_b32 v25, a153
  v_accvgpr_read_b32 v26, a154
  v_mfma_f32_16x16x32_bf16 v[108:111], a[4:7], a[76:79], v[108:111]
  v_accvgpr_read_b32 v27, a155
  v_accvgpr_read_b32 v28, a184
  v_mfma_f32_16x16x32_bf16 v[76:79], a[32:35], a[108:111], v[76:79]
  buffer_load_dwordx4 v5, s[8:11], s27 offen offset:1024 lds
  v_accvgpr_read_b32 v29, a185
  v_mfma_f32_16x16x32_bf16 v[108:111], a[36:39], a[108:111], v[108:111]
  v_accvgpr_read_b32 v30, a186
  v_accvgpr_read_b32 v31, a187
  v_mfma_f32_16x16x32_bf16 v[80:83], a[0:3], a[80:83], v[80:83]
  v_cvt_pk_bf16_f32 v248, v24, v25
  v_cvt_pk_bf16_f32 v249, v26, v27
  v_mfma_f32_16x16x32_bf16 v[112:115], a[4:7], a[80:83], v[112:115]
  v_cvt_pk_bf16_f32 v250, v28, v29
  v_cvt_pk_bf16_f32 v251, v30, v31
  v_mfma_f32_16x16x32_bf16 v[80:83], a[32:35], a[112:115], v[80:83]
  v_cvt_pk_bf16_f32 v220, v220, v221
  v_cvt_pk_bf16_f32 v221, v222, v223
  v_mfma_f32_16x16x32_bf16 v[112:115], a[36:39], a[112:115], v[112:115]
  v_cvt_pk_bf16_f32 v222, v252, v253
  v_cvt_pk_bf16_f32 v223, v254, v255
  v_mfma_f32_16x16x32_bf16 v[84:87], a[0:3], a[84:87], v[84:87]
  buffer_load_dwordx4 v6, s[8:11], s27 offen offset:2048 lds
  v_mfma_f32_16x16x32_bf16 v[116:119], a[4:7], a[84:87], v[116:119]
  s_add_u32 s60, s63, 12288
  buffer_store_dwordx4 v[152:155], v2, s[16:19], s60 offen offset:2048 sc1
  v_accvgpr_read_b32 v32, a156
  v_mfma_f32_16x16x32_bf16 v[84:87], a[32:35], a[116:119], v[84:87]
  v_accvgpr_read_b32 v33, a157
  v_accvgpr_read_b32 v34, a158
  v_mfma_f32_16x16x32_bf16 v[116:119], a[36:39], a[116:119], v[116:119]
  v_accvgpr_read_b32 v35, a159
  v_accvgpr_read_b32 v36, a188
  v_mfma_f32_16x16x32_bf16 v[88:91], a[0:3], a[88:91], v[88:91]
  v_accvgpr_read_b32 v37, a189
  v_accvgpr_read_b32 v38, a190
  v_mfma_f32_16x16x32_bf16 v[120:123], a[4:7], a[88:91], v[120:123]
  buffer_load_dwordx4 v7, s[8:11], s27 offen offset:3072 lds
  v_accvgpr_read_b32 v39, a191
  v_mfma_f32_16x16x32_bf16 v[88:91], a[32:35], a[120:123], v[88:91]
  s_bfe_u32 s29, 0x302010e, s53
  s_add_u32 s52, s52, s29
  s_add_u32 s53, s53, 8
  v_mfma_f32_16x16x32_bf16 v[120:123], a[36:39], a[120:123], v[120:123]
  s_and_b32 s53, s53, 0x8001f
  s_and_b32 s52, s52, 15
  s_lshl_b32 s29, s52, 7
  v_mfma_f32_16x16x32_bf16 v[92:95], a[0:3], a[92:95], v[92:95]
  s_or_b32 s26, s30, s29
  s_or_b32 s27, s31, s29
  v_cvt_pk_bf16_f32 v252, v32, v33
  v_mfma_f32_16x16x32_bf16 v[124:127], a[4:7], a[92:95], v[124:127]
  v_cvt_pk_bf16_f32 v253, v34, v35
  v_cvt_pk_bf16_f32 v254, v36, v37
  v_mfma_f32_16x16x32_bf16 v[92:95], a[32:35], a[124:127], v[92:95]
  v_cvt_pk_bf16_f32 v255, v38, v39
  v_cvt_pk_bf16_f32 v160, v64, v65
  v_mfma_f32_16x16x32_bf16 v[124:127], a[36:39], a[124:127], v[124:127]
  v_cvt_pk_bf16_f32 v161, v66, v67
  v_cvt_pk_bf16_f32 v162, v96, v97
  v_cvt_pk_bf16_f32 v163, v98, v99
  v_cvt_pk_bf16_f32 v164, v68, v69
  v_cvt_pk_bf16_f32 v165, v70, v71
  v_cvt_pk_bf16_f32 v166, v100, v101
  v_cvt_pk_bf16_f32 v167, v102, v103
  s_add_u32 s60, s63, 12288
  buffer_store_dwordx4 v[156:159], v2, s[16:19], s60 offen offset:3072 sc1
  v_cvt_pk_bf16_f32 v168, v72, v73
  v_cvt_pk_bf16_f32 v169, v74, v75
  v_cvt_pk_bf16_f32 v170, v104, v105
  v_cvt_pk_bf16_f32 v171, v106, v107
  v_cvt_pk_bf16_f32 v172, v76, v77
  v_cvt_pk_bf16_f32 v173, v78, v79
  v_cvt_pk_bf16_f32 v174, v108, v109
  v_cvt_pk_bf16_f32 v175, v110, v111
  v_cvt_pk_bf16_f32 v176, v80, v81
  v_cvt_pk_bf16_f32 v177, v82, v83
  v_cvt_pk_bf16_f32 v178, v112, v113
  v_cvt_pk_bf16_f32 v179, v114, v115
  v_cvt_pk_bf16_f32 v180, v84, v85
  v_cvt_pk_bf16_f32 v181, v86, v87
  v_cvt_pk_bf16_f32 v182, v116, v117
  v_cvt_pk_bf16_f32 v183, v118, v119
  v_cvt_pk_bf16_f32 v184, v88, v89
  v_cvt_pk_bf16_f32 v185, v90, v91
  v_cvt_pk_bf16_f32 v186, v120, v121
  v_cvt_pk_bf16_f32 v187, v122, v123
  v_cvt_pk_bf16_f32 v188, v92, v93
  v_cvt_pk_bf16_f32 v189, v94, v95
  v_cvt_pk_bf16_f32 v190, v124, v125
  v_cvt_pk_bf16_f32 v191, v126, v127
  s_lshl_b32 s34, s62, 4
  s_add_u32 s34, s34, s61
  s_lshl_b32 s34, s34, 7
  s_branch Lp3
Lp2:
  s_and_b32 s4, s2, 1
  s_lshl_b32 s4, s4, 2
  s_and_b32 s5, s59, 3
  s_add_u32 s32, s4, s5
  s_bfe_u32 s4, s2, 0x20001
  s_lshl_b32 s4, s4, 2
  s_lshr_b32 s5, s59, 2
  s_add_u32 s33, s4, s5
  s_and_b32 s4, s2, 7
  s_lshl_b32 s4, s4, 1
  s_add_u32 s5, s32, s33
  s_and_b32 s49, s5, 3
  s_lshl_b32 s49, s49, 3
  s_or_b32 s49, s49, 0x80000
  s_bfe_u32 s48, 0xf0f02, s49
  s_add_u32 s48, s48, s4
  s_and_b32 s48, s48, 15
  s_lshl_b32 s46, s48, 7
  s_lshl_b32 s36, s3, 13
  s_mul_i32 s41, s3, 6144
  s_add_u32 s41, s41, 104448
  s_mul_i32 s4, s3, 7168
  s_sub_u32 s50, 32768, s4
  v_lshrrev_b32 v240, 3, v1
  v_and_b32 v241, 6, v240
  v_and_b32 v242, 7, v1
  v_xor_b32 v241, v241, v242
  v_lshlrev_b32 v241, 4, v241
  s_lshl_b32 s4, s3, 6
  s_add_u32 s4, s4, 16
  v_add_u32 v242, s4, v240
  v_lshl_add_u32 v242, v242, 11, v241
  v_add_u32 v224, 0, v242
  v_add_u32 v225, 15360, v242
  v_add_u32 v226, 30720, v242
  v_add_u32 v227, 46080, v242
  v_add_u32 v228, 65536, v242
  v_add_u32 v229, 80896, v242
  v_add_u32 v230, 96256, v242
  v_add_u32 v231, 111616, v242
  s_lshl_b32 s4, s3, 14
  s_cmp_eq_u32 s32, 0
  s_cselect_b32 s4, 0x40000000, s4
  v_lshl_add_u32 v242, v240, 11, v241
  v_add_u32 v232, s4, v242
  v_lshrrev_b32 v242, 2, v240
  v_and_b32 v243, 3, v240
  v_lshl_add_u32 v242, v242, 3, v243
  v_mul_u32_u24 v242, 6144, v242
  v_add_u32 v242, v242, v241
  s_lshl_b32 s4, s33, 7
  v_add_u32 v242, s4, v242
  s_mul_i32 s6, s3, 6
  s_add_u32 s7, s6, 0
  s_bfe_u32 s4, s7, 0x10002
  s_lshl_b32 s4, s4, 5
  s_and_b32 s5, s7, 1
  s_lshl_b32 s5, s5, 4
  s_add_u32 s4, s4, s5
  s_bfe_u32 s5, s7, 0x10001
  s_lshl_b32 s5, s5, 2
  s_add_u32 s4, s4, s5
  s_mul_i32 s4, s4, 6144
  s_lshr_b32 s5, s7, 3
  s_lshl_b32 s5, s5, 11
  s_add_u32 s4, s4, s5
  s_add_u32 s4, s4, 2048
  v_add_u32 v233, s4, v242
  s_add_u32 s7, s6, 1
  s_bfe_u32 s4, s7, 0x10002
  s_lshl_b32 s4, s4, 5
  s_and_b32 s5, s7, 1
  s_lshl_b32 s5, s5, 4
  s_add_u32 s4, s4, s5
  s_bfe_u32 s5, s7, 0x10001
  s_lshl_b32 s5, s5, 2
  s_add_u32 s4, s4, s5
  s_mul_i32 s4, s4, 6144
  s_lshr_b32 s5, s7, 3
  s_lshl_b32 s5, s5, 11
  s_add_u32 s4, s4, s5
  s_add_u32 s4, s4, 1024
  v_add_u32 v234, s4, v242
  s_add_u32 s7, s6, 2
  s_bfe_u32 s4, s7, 0x10002
  s_lshl_b32 s4, s4, 5
  s_and_b32 s5, s7, 1
  s_lshl_b32 s5, s5, 4
  s_add_u32 s4, s4, s5
  s_bfe_u32 s5, s7, 0x10001
  s_lshl_b32 s5, s5, 2
  s_add_u32 s4, s4, s5
  s_mul_i32 s4, s4, 6144
  s_lshr_b32 s5, s7, 3
  s_lshl_b32 s5, s5, 11
  s_add_u32 s4, s4, s5
  s_add_u32 s4, s4, 0
  v_add_u32 v235, s4, v242
  s_add_u32 s7, s6, 3
  s_bfe_u32 s4, s7, 0x10002
  s_lshl_b32 s4, s4, 5
  s_and_b32 s5, s7, 1
  s_lshl_b32 s5, s5, 4
  s_add_u32 s4, s4, s5
  s_bfe_u32 s5, s7, 0x10001
  s_lshl_b32 s5, s5, 2
  s_add_u32 s4, s4, s5
  s_mul_i32 s4, s4, 6144
  s_lshr_b32 s5, s7, 3
  s_lshl_b32 s5, s5, 11
  s_add_u32 s4, s4, s5
  s_add_u32 s4, s4, 2048
  v_add_u32 v236, s4, v242
  s_add_u32 s7, s6, 4
  s_bfe_u32 s4, s7, 0x10002
  s_lshl_b32 s4, s4, 5
  s_and_b32 s5, s7, 1
  s_lshl_b32 s5, s5, 4
  s_add_u32 s4, s4, s5
  s_bfe_u32 s5, s7, 0x10001
  s_lshl_b32 s5, s5, 2
  s_add_u32 s4, s4, s5
  s_mul_i32 s4, s4, 6144
  s_lshr_b32 s5, s7, 3
  s_lshl_b32 s5, s5, 11
  s_add_u32 s4, s4, s5
  s_add_u32 s4, s4, 1024
  v_add_u32 v237, s4, v242
  s_add_u32 s7, s6, 5
  s_bfe_u32 s4, s7, 0x10002
  s_lshl_b32 s4, s4, 5
  s_and_b32 s5, s7, 1
  s_lshl_b32 s5, s5, 4
  s_add_u32 s4, s4, s5
  s_bfe_u32 s5, s7, 0x10001
  s_lshl_b32 s5, s5, 2
  s_add_u32 s4, s4, s5
  s_mul_i32 s4, s4, 6144
  s_lshr_b32 s5, s7, 3
  s_lshl_b32 s5, s5, 11
  s_add_u32 s4, s4, s5
  s_add_u32 s4, s4, 0
  v_add_u32 v238, s4, v242
  s_waitcnt lgkmcnt(0)
  s_lshl_b32 s10, s32, 19
  s_add_u32 s8, s76, s10
  s_addc_u32 s9, s77, 0
  s_sub_u32 s8, s8, 32768
  s_subb_u32 s9, s9, 0
  s_mov_b32 s10, 557056
  s_mov_b32 s11, 0x00020000
  s_sub_u32 s12, s78, 2048
  s_subb_u32 s13, s79, 0
  s_mov_b32 s14, 6293504
  s_mov_b32 s15, 0x00020000
  s_add_u32 s96, s86, 125829120
  s_addc_u32 s97, s87, 0
  s_mov_b32 s98, 262144
  s_mov_b32 s99, 0x00020000
  s_cmp_ge_u32 s3, 2
  s_cbranch_scc1 Lp2_r1
  s_and_b32 s4, s2, 7
  s_lshl_b32 s4, s4, 4
  s_add_u32 s4, s4, s59
  s_lshl_b32 s4, s4, 2
  s_add_u32 s4, s4, s3
  s_lshl_b32 s51, s4, 13
  s_add_u32 m0, s36, s50
  s_nop 0
  buffer_load_dwordx4 v232, s[8:11], s46 offen offset:0 lds
  s_mov_b32 m0, s36
  s_nop 0
  buffer_load_dwordx4 v224, s[8:11], s46 offen offset:0 lds
  buffer_load_dwordx4 v225, s[8:11], s46 offen offset:1024 lds
  buffer_load_dwordx4 v226, s[8:11], s46 offen offset:2048 lds
  buffer_load_dwordx4 v227, s[8:11], s46 offen offset:3072 lds
  s_add_u32 m0, s36, 4096
  s_nop 0
  buffer_load_dwordx4 v228, s[8:11], s46 offen offset:0 lds
  buffer_load_dwordx4 v229, s[8:11], s46 offen offset:1024 lds
  buffer_load_dwordx4 v230, s[8:11], s46 offen offset:2048 lds
  buffer_load_dwordx4 v231, s[8:11], s46 offen offset:3072 lds
  s_mul_i32 s47, s48, 393216
  s_bfe_u32 s34, 0x302010e, s49
  s_add_u32 s48, s48, s34
  s_add_u32 s49, s49, 8
  s_and_b32 s49, s49, 0x8001f
  s_and_b32 s48, s48, 15
  s_lshl_b32 s46, s48, 7
  s_mov_b32 m0, s41
  s_nop 0
  buffer_load_dwordx4 v233, s[12:15], s47 offen offset:0 lds
  buffer_load_dwordx4 v234, s[12:15], s47 offen offset:1024 lds
  buffer_load_dwordx4 v235, s[12:15], s47 offen offset:2048 lds
  s_add_u32 m0, s41, 3072
  s_nop 0
  buffer_load_dwordx4 v236, s[12:15], s47 offen offset:0 lds
  buffer_load_dwordx4 v237, s[12:15], s47 offen offset:1024 lds
  buffer_load_dwordx4 v238, s[12:15], s47 offen offset:2048 lds
  s_lshr_b32 s4, s3, 1
  s_lshl_b32 s4, s4, 14
  v_and_b32 v240, 15, v1
  v_lshlrev_b32 v240, 7, v240
  v_lshrrev_b32 v241, 4, v1
  v_and_b32 v242, 6, v1
  v_xor_b32 v241, v241, v242
  v_lshl_add_u32 v240, v241, 4, v240
  v_add_u32 v16, s4, v240
  v_xor_b32 v17, 64, v16
  v_and_b32 v240, 15, v1
  v_lshlrev_b32 v240, 7, v240
  v_lshrrev_b32 v241, 4, v1
  v_and_b32 v242, 6, v1
  v_xor_b32 v241, v241, v242
  v_lshl_add_u32 v240, v241, 4, v240
  v_add_u32 v18, 32768, v240
  v_xor_b32 v19, 64, v18
  v_lshrrev_b32 v240, 2, v1
  v_and_b32 v241, 6, v240
  v_lshlrev_b32 v240, 7, v240
  v_and_b32 v242, 1, v1
  v_lshl_add_u32 v240, v242, 3, v240
  v_add_u32 v240, 104448, v240
  v_bfe_u32 v242, v1, 1, 1
  v_xor_b32 v241, v241, v242
  v_xor_b32 v242, 0, v241
  v_lshl_add_u32 v20, v242, 4, v240
  v_xor_b32 v242, 2, v241
  s_add_u32 m0, s36, s50
  s_add_u32 m0, m0, 34816
  s_nop 0
  buffer_load_dwordx4 v232, s[8:11], s46 offen offset:0 lds
  v_lshl_add_u32 v21, v242, 4, v240
  s_and_b32 s4, s3, 1
  s_lshl_b32 s4, s4, 6
  v_xor_b32 v20, s4, v20
  v_xor_b32 v21, s4, v21
  s_and_b32 s24, s2, 7
  s_lshr_b32 s4, s2, 6
  s_lshl_b32 s4, s4, 3
  s_add_u32 s24, s24, s4
  s_lshr_b32 s25, s2, 3
  s_and_b32 s25, s25, 7
  v_lshrrev_b32 v24, 3, v1
  v_and_b32 v25, 6, v24
  v_and_b32 v26, 7, v1
  v_xor_b32 v25, v25, v26
  v_lshlrev_b32 v25, 4, v25
  s_and_b32 s4, s3, 1
  s_lshl_b32 s4, s4, 16
  s_lshr_b32 s5, s3, 1
  s_lshl_b32 s5, s5, 7
  s_add_u32 s4, s4, s5
  v_lshl_add_u32 v24, v24, 11, v25
  v_add_u32 v24, s4, v24
  s_add_u32 m0, s36, 34816
  s_nop 0
  buffer_load_dwordx4 v224, s[8:11], s46 offen offset:0 lds
  v_add_u32 v25, 0, v24
  v_accvgpr_write_b32 a212, v25
  v_add_u32 v25, 15360, v24
  v_accvgpr_write_b32 a213, v25
  v_add_u32 v25, 30720, v24
  v_accvgpr_write_b32 a214, v25
  v_add_u32 v25, 46080, v24
  buffer_load_dwordx4 v225, s[8:11], s46 offen offset:1024 lds
  v_accvgpr_write_b32 a215, v25
  v_accvgpr_write_b32 a236, 0
  v_mov_b32 v27, 0x3f803f80
  v_accvgpr_write_b32 a208, v27
  v_accvgpr_write_b32 a237, 0
  v_accvgpr_write_b32 a209, v27
  v_accvgpr_write_b32 a238, 0
  buffer_load_dwordx4 v226, s[8:11], s46 offen offset:2048 lds
  v_accvgpr_write_b32 a210, v27
  v_accvgpr_write_b32 a239, 0
  v_accvgpr_write_b32 a211, v27
  v_lshrrev_b32 v24, 3, v1
  v_and_b32 v25, 6, v24
  v_and_b32 v26, 7, v1
  v_xor_b32 v25, v25, v26
  buffer_load_dwordx4 v227, s[8:11], s46 offen offset:3072 lds
  v_lshlrev_b32 v25, 4, v25
  v_lshlrev_b32 v26, 2, v24
  v_add_u32 v26, s3, v26
  v_lshl_add_u32 v26, v26, 11, v25
  v_add_u32 v27, 0, v26
  v_accvgpr_write_b32 a222, v27
  v_add_u32 v27, 64512, v26
  s_add_u32 m0, s36, 38912
  s_nop 0
  buffer_load_dwordx4 v228, s[8:11], s46 offen offset:0 lds
  v_accvgpr_write_b32 a223, v27
  v_add_u32 v27, 129024, v26
  v_accvgpr_write_b32 a224, v27
  v_add_u32 v27, 193536, v26
  v_accvgpr_write_b32 a225, v27
  v_lshrrev_b32 v26, 2, v24
  v_and_b32 v27, 3, v24
  buffer_load_dwordx4 v229, s[8:11], s46 offen offset:1024 lds
  v_lshl_add_u32 v26, v26, 3, v27
  s_and_b32 s4, s3, 1
  s_lshl_b32 s4, s4, 18
  s_lshr_b32 s5, s3, 1
  s_lshl_b32 s5, s5, 7
  s_add_u32 s4, s4, s5
  s_lshl_b32 s5, s24, 8
  s_add_u32 s4, s4, s5
  v_lshl_add_u32 v26, v26, 13, v25
  v_add_u32 v26, s4, v26
  v_add_u32 v27, 0, v26
  v_accvgpr_write_b32 a226, v27
  v_add_u32 v27, 130048, v26
  v_accvgpr_write_b32 a227, v27
  v_add_u32 v27, 30720, v26
  buffer_load_dwordx4 v230, s[8:11], s46 offen offset:2048 lds
  v_accvgpr_write_b32 a228, v27
  v_add_u32 v27, 160768, v26
  v_accvgpr_write_b32 a229, v27
  s_lshl_b32 s4, s3, 13
  s_add_u32 s4, s4, 98304
  v_and_b32 v24, 15, v1
  v_lshlrev_b32 v24, 7, v24
  v_lshrrev_b32 v25, 4, v1
  v_and_b32 v26, 6, v1
  v_xor_b32 v25, v25, v26
  buffer_load_dwordx4 v231, s[8:11], s46 offen offset:3072 lds
  v_lshl_add_u32 v24, v25, 4, v24
  v_add_u32 v28, s4, v24
  v_xor_b32 v29, 64, v28
  v_lshrrev_b32 v24, 2, v1
  v_and_b32 v25, 6, v24
  v_lshlrev_b32 v24, 7, v24
  v_and_b32 v26, 1, v1
  s_mul_i32 s47, s48, 393216
  s_bfe_u32 s34, 0x302010e, s49
  s_add_u32 s48, s48, s34
  s_add_u32 s49, s49, 8
  s_and_b32 s49, s49, 0x8001f
  s_and_b32 s48, s48, 15
  s_lshl_b32 s46, s48, 7
  s_add_u32 m0, s41, 24576
  s_nop 0
  buffer_load_dwordx4 v233, s[12:15], s47 offen offset:0 lds
  v_lshl_add_u32 v24, v26, 3, v24
  v_add_u32 v24, 0, v24
  v_bfe_u32 v26, v1, 1, 1
  v_xor_b32 v25, v25, v26
  v_xor_b32 v26, 0, v25
  v_lshl_add_u32 v30, v26, 4, v24
  v_xor_b32 v26, 2, v25
  buffer_load_dwordx4 v234, s[12:15], s47 offen offset:1024 lds
  v_lshl_add_u32 v31, v26, 4, v24
  v_xor_b32 v26, 4, v25
  v_lshl_add_u32 v32, v26, 4, v24
  v_xor_b32 v26, 6, v25
  v_lshl_add_u32 v33, v26, 4, v24
  v_accvgpr_write_b32 a230, v28
  v_accvgpr_write_b32 a231, v29
  buffer_load_dwordx4 v235, s[12:15], s47 offen offset:2048 lds
  v_accvgpr_write_b32 a232, v30
  v_accvgpr_write_b32 a233, v31
  v_accvgpr_write_b32 a234, v32
  v_accvgpr_write_b32 a235, v33
  v_and_b32 v253, 15, v1
  v_lshrrev_b32 v254, 4, v1
  v_lshlrev_b32 v254, 2, v254
  s_add_u32 m0, s41, 27648
  s_nop 0
  buffer_load_dwordx4 v236, s[12:15], s47 offen offset:0 lds
  v_sub_u32 v253, v253, v254
  v_mov_b32 v254, 0xf149f2ca
  s_lshr_b32 s4, s3, 1
  s_or_b32 s4, s4, s32
  s_cselect_b64 s[6:7], 0, -1
  v_subrev_u32 v255, 0, v253
  v_and_b32 v252, 0x80000001, v255
  v_cmp_ne_u32 vcc, 0, v252
  s_nop 1
  v_cndmask_b32 v244, 0, v254, vcc
  v_add_u32 v255, 1, v255
  v_and_b32 v252, 0x80000001, v255
  v_cmp_ne_u32 vcc, 0x80000001, v252
  s_nop 1
  v_cndmask_b32 v240, 0, v254, vcc
  v_cndmask_b32 v248, v240, v254, s[6:7]
  v_subrev_u32 v255, 1, v253
  buffer_load_dwordx4 v237, s[12:15], s47 offen offset:1024 lds
  v_and_b32 v252, 0x80000001, v255
  v_cmp_ne_u32 vcc, 0, v252
  s_nop 1
  v_cndmask_b32 v245, 0, v254, vcc
  v_add_u32 v255, 1, v255
  v_and_b32 v252, 0x80000001, v255
  v_cmp_ne_u32 vcc, 0x80000001, v252
  s_nop 1
  v_cndmask_b32 v241, 0, v254, vcc
  v_cndmask_b32 v249, v241, v254, s[6:7]
  v_subrev_u32 v255, 2, v253
  v_and_b32 v252, 0x80000001, v255
  v_cmp_ne_u32 vcc, 0, v252
  s_nop 1
  v_cndmask_b32 v246, 0, v254, vcc
  v_add_u32 v255, 1, v255
  buffer_load_dwordx4 v238, s[12:15], s47 offen offset:2048 lds
  v_and_b32 v252, 0x80000001, v255
  v_cmp_ne_u32 vcc, 0x80000001, v252
  s_nop 1
  v_cndmask_b32 v242, 0, v254, vcc
  v_cndmask_b32 v250, v242, v254, s[6:7]
  v_subrev_u32 v255, 3, v253
  v_and_b32 v252, 0x80000001, v255
  v_cmp_ne_u32 vcc, 0, v252
  s_nop 1
  v_cndmask_b32 v247, 0, v254, vcc
  v_add_u32 v255, 1, v255
  v_and_b32 v252, 0x80000001, v255
  v_cmp_ne_u32 vcc, 0x80000001, v252
  s_nop 1
  v_cndmask_b32 v243, 0, v254, vcc
  v_cndmask_b32 v251, v243, v254, s[6:7]
  s_and_b32 s4, s3, 1
  s_lshl_b32 s4, s4, 12
  s_add_u32 s4, s4, 49152
  v_add_u32 v252, s4, v2
  s_lshr_b32 s5, s3, 1
  s_lshl_b32 s5, s5, 11
  v_add_u32 v253, s5, v252
  s_add_u32 s16, s86, 83886080
  s_addc_u32 s17, s87, 0
  s_mov_b32 s18, 4194304
  s_mov_b32 s19, 0x00020000
  s_lshl_b32 s57, s32, 19
  s_lshl_b32 s5, s5, 7
  s_add_u32 s57, s57, s5
  s_lshl_b32 s4, s33, 14
  s_add_u32 s57, s57, s4
  s_and_b32 s4, s3, 1
  s_lshl_b32 s4, s4, 13
  s_add_u32 s57, s57, s4
  s_add_u32 s58, s57, 4096
  s_mov_b32 s37, 0
  s_mov_b32 s39, 4294897664
  s_mov_b32 s40, 34816
  s_mov_b32 s42, 0
  s_mov_b32 s44, 4294942720
  s_mov_b32 s45, 24576
  s_mov_b32 s43, s44
  s_mov_b32 s52, s72
  s_mov_b32 s53, s73
  s_mov_b32 s54, 4194304
  s_mov_b32 s55, 0x00020000
  s_add_u32 s56, s51, 8192
  s_waitcnt vmcnt(15)
  s_barrier
  ds_read_b128 a[0:3], v16 offset:0
  ds_read_b64_tr_b16 a[72:73], v20 offset:0
  ds_read_b64_tr_b16 a[74:75], v20 offset:2048
  ds_read_b128 a[4:7], v16 offset:2048
  ds_read_b128 a[8:11], v16 offset:4096
  ds_read_b128 a[12:15], v16 offset:6144
  ds_read_b128 a[16:19], v16 offset:8192
  ds_read_b128 a[20:23], v16 offset:10240
  ds_read_b128 a[24:27], v16 offset:12288
  ds_read_b128 a[28:31], v16 offset:14336
  ds_read_b64_tr_b16 a[76:77], v21 offset:0
  ds_read_b64_tr_b16 a[78:79], v21 offset:2048
  ds_read_b64_tr_b16 a[80:81], v20 offset:8192
  ds_read_b64_tr_b16 a[82:83], v20 offset:10240
  ds_read_b128 a[32:35], v18 offset:0
  ds_read_b64_tr_b16 a[84:85], v21 offset:8192
  ds_read_b64_tr_b16 a[86:87], v21 offset:10240
  ds_read_b64_tr_b16 a[88:89], v20 offset:16384
  ds_read_b64_tr_b16 a[90:91], v20 offset:18432
  ds_read_b64_tr_b16 a[92:93], v21 offset:16384
  ds_read_b64_tr_b16 a[94:95], v21 offset:18432
  s_waitcnt lgkmcnt(0)
  v_mfma_f32_16x16x32_bf16 v[24:27], a[72:75], a[0:3], 0
  s_add_u32 m0, s36, s50
  s_add_u32 m0, m0, 69632
  ds_read_b128 a[36:39], v17 offset:0
  v_mfma_f32_16x16x32_bf16 v[28:31], a[72:75], a[4:7], 0
  buffer_load_dwordx4 v232, s[8:11], s46 offen offset:0 lds
  ds_read_b64_tr_b16 a[96:97], v20 offset:4096
  v_mfma_f32_16x16x32_bf16 v[32:35], a[72:75], a[8:11], 0
  s_add_u32 m0, s36, 69632
  v_mfma_f32_16x16x32_bf16 v[36:39], a[72:75], a[12:15], 0
  ds_read_b64_tr_b16 a[98:99], v20 offset:6144
  v_mfma_f32_16x16x32_bf16 v[40:43], a[72:75], a[16:19], 0
  buffer_load_dwordx4 v224, s[8:11], s46 offen offset:0 lds
  v_mfma_f32_16x16x32_bf16 v[44:47], a[72:75], a[20:23], 0
  ds_read_b128 a[40:43], v17 offset:2048
  v_mfma_f32_16x16x32_bf16 v[48:51], a[72:75], a[24:27], 0
  v_mfma_f32_16x16x32_bf16 v[52:55], a[72:75], a[28:31], 0
  ds_read_b128 a[44:47], v17 offset:4096
  v_mfma_f32_16x16x32_bf16 v[56:59], a[76:79], a[0:3], 0
  v_mfma_f32_16x16x32_bf16 v[60:63], a[76:79], a[4:7], 0
  buffer_load_dwordx4 v225, s[8:11], s46 offen offset:1024 lds
  ds_read_b128 a[48:51], v17 offset:6144
  v_mfma_f32_16x16x32_bf16 v[64:67], a[76:79], a[8:11], 0
  v_mfma_f32_16x16x32_bf16 v[68:71], a[76:79], a[12:15], 0
  ds_read_b128 a[52:55], v17 offset:8192
  v_mfma_f32_16x16x32_bf16 v[72:75], a[76:79], a[16:19], 0
  v_mfma_f32_16x16x32_bf16 v[76:79], a[76:79], a[20:23], 0
  ds_read_b128 a[56:59], v17 offset:10240
  v_mfma_f32_16x16x32_bf16 v[80:83], a[76:79], a[24:27], 0
  buffer_load_dwordx4 v226, s[8:11], s46 offen offset:2048 lds
  v_mfma_f32_16x16x32_bf16 v[84:87], a[76:79], a[28:31], 0
  ds_read_b128 a[60:63], v17 offset:12288
  v_mfma_f32_16x16x32_bf16 v[88:91], a[80:83], a[0:3], 0
  v_mfma_f32_16x16x32_bf16 v[92:95], a[80:83], a[4:7], 0
  ds_read_b128 a[64:67], v17 offset:14336
  v_mfma_f32_16x16x32_bf16 v[96:99], a[80:83], a[8:11], 0
  v_mfma_f32_16x16x32_bf16 v[100:103], a[80:83], a[12:15], 0
  buffer_load_dwordx4 v227, s[8:11], s46 offen offset:3072 lds
  ds_read_b64_tr_b16 a[100:101], v21 offset:4096
  v_mfma_f32_16x16x32_bf16 v[104:107], a[80:83], a[16:19], 0
  s_add_u32 m0, s36, 73728
  ds_read_b64_tr_b16 a[102:103], v21 offset:6144
  v_mfma_f32_16x16x32_bf16 v[108:111], a[80:83], a[20:23], 0
  v_mfma_f32_16x16x32_bf16 v[112:115], a[80:83], a[24:27], 0
  ds_read_b64_tr_b16 a[104:105], v20 offset:12288
  v_mfma_f32_16x16x32_bf16 v[116:119], a[80:83], a[28:31], 0
  buffer_load_dwordx4 v228, s[8:11], s46 offen offset:0 lds
  v_mfma_f32_16x16x32_bf16 v[216:219], a[80:83], a[32:35], 0
  ds_read_b64_tr_b16 a[106:107], v20 offset:14336
  v_mfma_f32_16x16x32_bf16 v[120:123], a[84:87], a[0:3], 0
  v_mfma_f32_16x16x32_bf16 v[124:127], a[84:87], a[4:7], 0
  ds_read_b128 a[68:71], v19 offset:0
  v_mfma_f32_16x16x32_bf16 v[128:131], a[84:87], a[8:11], 0
  v_mfma_f32_16x16x32_bf16 v[132:135], a[84:87], a[12:15], 0
  buffer_load_dwordx4 v229, s[8:11], s46 offen offset:1024 lds
  ds_read_b64_tr_b16 a[108:109], v21 offset:12288
  v_mfma_f32_16x16x32_bf16 v[136:139], a[84:87], a[16:19], 0
  v_mfma_f32_16x16x32_bf16 v[140:143], a[84:87], a[20:23], 0
  ds_read_b64_tr_b16 a[110:111], v21 offset:14336
  v_mfma_f32_16x16x32_bf16 v[144:147], a[84:87], a[24:27], 0
  v_mfma_f32_16x16x32_bf16 v[148:151], a[84:87], a[28:31], 0
  ds_read_b64_tr_b16 a[112:113], v20 offset:20480
  v_mfma_f32_16x16x32_bf16 v[220:223], a[84:87], a[32:35], 0
  buffer_load_dwordx4 v230, s[8:11], s46 offen offset:2048 lds
  v_mfma_f32_16x16x32_bf16 v[152:155], a[0:3], a[88:91], 0
  ds_read_b64_tr_b16 a[114:115], v20 offset:22528
  v_mfma_f32_16x16x32_bf16 v[156:159], a[4:7], a[88:91], 0
  v_mfma_f32_16x16x32_bf16 v[160:163], a[8:11], a[88:91], 0
  ds_read_b64_tr_b16 a[116:117], v21 offset:20480
  v_mfma_f32_16x16x32_bf16 v[164:167], a[12:15], a[88:91], 0
  v_mfma_f32_16x16x32_bf16 v[168:171], a[16:19], a[88:91], 0
  buffer_load_dwordx4 v231, s[8:11], s46 offen offset:3072 lds
  ds_read_b64_tr_b16 a[118:119], v21 offset:22528
  v_mfma_f32_16x16x32_bf16 v[172:175], a[20:23], a[88:91], 0
  s_mul_i32 s47, s48, 393216
  s_bfe_u32 s34, 0x302010e, s49
  s_add_u32 s48, s48, s34
  v_mfma_f32_16x16x32_bf16 v[176:179], a[24:27], a[88:91], 0
  s_add_u32 s49, s49, 8
  s_and_b32 s49, s49, 0x8001f
  s_and_b32 s48, s48, 15
  v_mfma_f32_16x16x32_bf16 v[180:183], a[28:31], a[88:91], 0
  s_lshl_b32 s46, s48, 7
  v_mfma_f32_16x16x32_bf16 v[184:187], a[0:3], a[92:95], 0
  s_add_u32 s37, s37, 1
  s_cmp_eq_u32 s37, 3
  s_cselect_b32 s37, 0, s37
  s_cselect_b32 s38, s39, s40
  v_mfma_f32_16x16x32_bf16 v[188:191], a[4:7], a[92:95], 0
  s_sub_u32 s43, 0, s43
  v_mfma_f32_16x16x32_bf16 v[192:195], a[8:11], a[92:95], 0
  v_add_u32 v16, s38, v16
  v_add_u32 v17, s38, v17
  v_mfma_f32_16x16x32_bf16 v[196:199], a[12:15], a[92:95], 0
  v_add_u32 v18, s38, v18
  v_add_u32 v19, s38, v19
  v_mfma_f32_16x16x32_bf16 v[200:203], a[16:19], a[92:95], 0
  v_add_u32 v20, s43, v20
  v_add_u32 v21, s43, v21
  v_mfma_f32_16x16x32_bf16 v[204:207], a[20:23], a[92:95], 0
  v_mfma_f32_16x16x32_bf16 v[208:211], a[24:27], a[92:95], 0
  v_mfma_f32_16x16x32_bf16 v[212:215], a[28:31], a[92:95], 0
  s_mov_b32 s35, 13
  s_waitcnt vmcnt(9) lgkmcnt(0)
  s_barrier
  .p2align 6
Lp2r0_loop:
  v_mfma_f32_16x16x32_bf16 v[24:27], a[96:99], a[36:39], v[24:27]
  buffer_load_dwordx4 a[192:195], v2, s[52:55], s51 offen
  ds_read_b128 a[0:3], v16 offset:0
  v_mfma_f32_16x16x32_bf16 v[28:31], a[96:99], a[40:43], v[28:31]
  s_add_u32 s51, s51, 1024
  s_cmp_eq_u32 s51, s56
  s_cselect_b32 s54, 0, s54
  v_mfma_f32_16x16x32_bf16 v[32:35], a[96:99], a[44:47], v[32:35]
  ds_read_b64_tr_b16 a[72:73], v20 offset:0
  v_mfma_f32_16x16x32_bf16 v[36:39], a[96:99], a[48:51], v[36:39]
  ds_read_b64_tr_b16 a[74:75], v20 offset:2048
  v_mfma_f32_16x16x32_bf16 v[40:43], a[96:99], a[52:55], v[40:43]
  buffer_load_dwordx4 a[192:195], v2, s[52:55], s51 offen
  v_mfma_f32_16x16x32_bf16 v[44:47], a[96:99], a[56:59], v[44:47]
  s_add_u32 s51, s51, 1024
  s_cmp_eq_u32 s51, s56
  s_cselect_b32 s54, 0, s54
  v_mfma_f32_16x16x32_bf16 v[48:51], a[96:99], a[60:63], v[48:51]
  ds_read_b128 a[4:7], v16 offset:2048
  v_mfma_f32_16x16x32_bf16 v[52:55], a[96:99], a[64:67], v[52:55]
  ds_read_b128 a[8:11], v16 offset:4096
  v_mfma_f32_16x16x32_bf16 v[56:59], a[100:103], a[36:39], v[56:59]
  v_mfma_f32_16x16x32_bf16 v[60:63], a[100:103], a[40:43], v[60:63]
  buffer_load_dwordx4 a[192:195], v2, s[52:55], s51 offen
  ds_read_b128 a[12:15], v16 offset:6144
  v_mfma_f32_16x16x32_bf16 v[64:67], a[100:103], a[44:47], v[64:67]
  s_add_u32 s51, s51, 1024
  s_cmp_eq_u32 s51, s56
  s_cselect_b32 s54, 0, s54
  v_mfma_f32_16x16x32_bf16 v[68:71], a[100:103], a[48:51], v[68:71]
  ds_read_b128 a[16:19], v16 offset:8192
  v_mfma_f32_16x16x32_bf16 v[72:75], a[100:103], a[52:55], v[72:75]
  v_mfma_f32_16x16x32_bf16 v[76:79], a[100:103], a[56:59], v[76:79]
  ds_read_b128 a[20:23], v16 offset:10240
  v_mfma_f32_16x16x32_bf16 v[80:83], a[100:103], a[60:63], v[80:83]
  buffer_load_dwordx4 a[192:195], v2, s[52:55], s51 offen
  v_mfma_f32_16x16x32_bf16 v[84:87], a[100:103], a[64:67], v[84:87]
  s_add_u32 s51, s51, 1024
  s_cmp_eq_u32 s51, s56
  s_cselect_b32 s54, 0, s54
  v_mfma_f32_16x16x32_bf16 v[88:91], a[104:107], a[36:39], v[88:91]
  s_mov_b32 m0, s41
  ds_read_b128 a[24:27], v16 offset:12288
  v_mfma_f32_16x16x32_bf16 v[92:95], a[104:107], a[40:43], v[92:95]
  ds_read_b128 a[28:31], v16 offset:14336
  v_mfma_f32_16x16x32_bf16 v[96:99], a[104:107], a[44:47], v[96:99]
  v_mfma_f32_16x16x32_bf16 v[100:103], a[104:107], a[48:51], v[100:103]
  buffer_load_dwordx4 v233, s[12:15], s47 offen offset:0 lds
  ds_read_b64_tr_b16 a[76:77], v21 offset:0
  v_mfma_f32_16x16x32_bf16 v[104:107], a[104:107], a[52:55], v[104:107]
  ds_read_b64_tr_b16 a[78:79], v21 offset:2048
  v_mfma_f32_16x16x32_bf16 v[108:111], a[104:107], a[56:59], v[108:111]
  v_mfma_f32_16x16x32_bf16 v[112:115], a[104:107], a[60:63], v[112:115]
  ds_read_b64_tr_b16 a[80:81], v20 offset:8192
  v_mfma_f32_16x16x32_bf16 v[116:119], a[104:107], a[64:67], v[116:119]
  v_mfma_f32_16x16x32_bf16 v[216:219], a[104:107], a[68:71], v[216:219]
  buffer_load_dwordx4 v234, s[12:15], s47 offen offset:1024 lds
  ds_read_b64_tr_b16 a[82:83], v20 offset:10240
  v_mfma_f32_16x16x32_bf16 v[120:123], a[108:111], a[36:39], v[120:123]
  v_mfma_f32_16x16x32_bf16 v[124:127], a[108:111], a[40:43], v[124:127]
  ds_read_b128 a[32:35], v18 offset:0
  v_mfma_f32_16x16x32_bf16 v[128:131], a[108:111], a[44:47], v[128:131]
  v_mfma_f32_16x16x32_bf16 v[132:135], a[108:111], a[48:51], v[132:135]
  ds_read_b64_tr_b16 a[84:85], v21 offset:8192
  v_mfma_f32_16x16x32_bf16 v[136:139], a[108:111], a[52:55], v[136:139]
  buffer_load_dwordx4 v235, s[12:15], s47 offen offset:2048 lds
  v_mfma_f32_16x16x32_bf16 v[140:143], a[108:111], a[56:59], v[140:143]
  s_add_u32 m0, s41, 3072
  ds_read_b64_tr_b16 a[86:87], v21 offset:10240
  v_mfma_f32_16x16x32_bf16 v[144:147], a[108:111], a[60:63], v[144:147]
  v_mfma_f32_16x16x32_bf16 v[148:151], a[108:111], a[64:67], v[148:151]
  ds_read_b64_tr_b16 a[88:89], v20 offset:16384
  v_mfma_f32_16x16x32_bf16 v[220:223], a[108:111], a[68:71], v[220:223]
  v_mfma_f32_16x16x32_bf16 v[152:155], a[36:39], a[112:115], v[152:155]
  buffer_load_dwordx4 v236, s[12:15], s47 offen offset:0 lds
  ds_read_b64_tr_b16 a[90:91], v20 offset:18432
  v_mfma_f32_16x16x32_bf16 v[156:159], a[40:43], a[112:115], v[156:159]
  v_mfma_f32_16x16x32_bf16 v[160:163], a[44:47], a[112:115], v[160:163]
  ds_read_b64_tr_b16 a[92:93], v21 offset:16384
  v_mfma_f32_16x16x32_bf16 v[164:167], a[48:51], a[112:115], v[164:167]
  v_mfma_f32_16x16x32_bf16 v[168:171], a[52:55], a[112:115], v[168:171]
  ds_read_b64_tr_b16 a[94:95], v21 offset:18432
  v_mfma_f32_16x16x32_bf16 v[172:175], a[56:59], a[112:115], v[172:175]
  buffer_load_dwordx4 v237, s[12:15], s47 offen offset:1024 lds
  v_mfma_f32_16x16x32_bf16 v[176:179], a[60:63], a[112:115], v[176:179]
  v_mfma_f32_16x16x32_bf16 v[180:183], a[64:67], a[112:115], v[180:183]
  v_mfma_f32_16x16x32_bf16 v[184:187], a[36:39], a[116:119], v[184:187]
  v_mfma_f32_16x16x32_bf16 v[188:191], a[40:43], a[116:119], v[188:191]
  v_mfma_f32_16x16x32_bf16 v[192:195], a[44:47], a[116:119], v[192:195]
  buffer_load_dwordx4 v238, s[12:15], s47 offen offset:2048 lds
  v_mfma_f32_16x16x32_bf16 v[196:199], a[48:51], a[116:119], v[196:199]
  v_mfma_f32_16x16x32_bf16 v[200:203], a[52:55], a[116:119], v[200:203]
  v_mfma_f32_16x16x32_bf16 v[204:207], a[56:59], a[116:119], v[204:207]
  v_mfma_f32_16x16x32_bf16 v[208:211], a[60:63], a[116:119], v[208:211]
  v_mfma_f32_16x16x32_bf16 v[212:215], a[64:67], a[116:119], v[212:215]
  s_waitcnt lgkmcnt(0)
  v_mfma_f32_16x16x32_bf16 v[24:27], a[72:75], a[0:3], v[24:27]
  s_add_u32 m0, s36, s50
  ds_read_b128 a[36:39], v17 offset:0
  v_mfma_f32_16x16x32_bf16 v[28:31], a[72:75], a[4:7], v[28:31]
  buffer_load_dwordx4 v232, s[8:11], s46 offen offset:0 lds
  ds_read_b64_tr_b16 a[96:97], v20 offset:4096
  v_mfma_f32_16x16x32_bf16 v[32:35], a[72:75], a[8:11], v[32:35]
  s_mov_b32 m0, s36
  v_mfma_f32_16x16x32_bf16 v[36:39], a[72:75], a[12:15], v[36:39]
  ds_read_b64_tr_b16 a[98:99], v20 offset:6144
  v_mfma_f32_16x16x32_bf16 v[40:43], a[72:75], a[16:19], v[40:43]
  buffer_load_dwordx4 v224, s[8:11], s46 offen offset:0 lds
  v_mfma_f32_16x16x32_bf16 v[44:47], a[72:75], a[20:23], v[44:47]
  ds_read_b128 a[40:43], v17 offset:2048
  v_mfma_f32_16x16x32_bf16 v[48:51], a[72:75], a[24:27], v[48:51]
  v_mfma_f32_16x16x32_bf16 v[52:55], a[72:75], a[28:31], v[52:55]
  ds_read_b128 a[44:47], v17 offset:4096
  v_mfma_f32_16x16x32_bf16 v[56:59], a[76:79], a[0:3], v[56:59]
  v_mfma_f32_16x16x32_bf16 v[60:63], a[76:79], a[4:7], v[60:63]
  buffer_load_dwordx4 v225, s[8:11], s46 offen offset:1024 lds
  ds_read_b128 a[48:51], v17 offset:6144
  v_mfma_f32_16x16x32_bf16 v[64:67], a[76:79], a[8:11], v[64:67]
  v_mfma_f32_16x16x32_bf16 v[68:71], a[76:79], a[12:15], v[68:71]
  ds_read_b128 a[52:55], v17 offset:8192
  v_mfma_f32_16x16x32_bf16 v[72:75], a[76:79], a[16:19], v[72:75]
  v_mfma_f32_16x16x32_bf16 v[76:79], a[76:79], a[20:23], v[76:79]
  ds_read_b128 a[56:59], v17 offset:10240
  v_mfma_f32_16x16x32_bf16 v[80:83], a[76:79], a[24:27], v[80:83]
  buffer_load_dwordx4 v226, s[8:11], s46 offen offset:2048 lds
  v_mfma_f32_16x16x32_bf16 v[84:87], a[76:79], a[28:31], v[84:87]
  ds_read_b128 a[60:63], v17 offset:12288
  v_mfma_f32_16x16x32_bf16 v[88:91], a[80:83], a[0:3], v[88:91]
  v_mfma_f32_16x16x32_bf16 v[92:95], a[80:83], a[4:7], v[92:95]
  ds_read_b128 a[64:67], v17 offset:14336
  v_mfma_f32_16x16x32_bf16 v[96:99], a[80:83], a[8:11], v[96:99]
  v_mfma_f32_16x16x32_bf16 v[100:103], a[80:83], a[12:15], v[100:103]
  buffer_load_dwordx4 v227, s[8:11], s46 offen offset:3072 lds
  ds_read_b64_tr_b16 a[100:101], v21 offset:4096
  v_mfma_f32_16x16x32_bf16 v[104:107], a[80:83], a[16:19], v[104:107]
  s_add_u32 m0, s36, 4096
  ds_read_b64_tr_b16 a[102:103], v21 offset:6144
  v_mfma_f32_16x16x32_bf16 v[108:111], a[80:83], a[20:23], v[108:111]
  v_mfma_f32_16x16x32_bf16 v[112:115], a[80:83], a[24:27], v[112:115]
  ds_read_b64_tr_b16 a[104:105], v20 offset:12288
  v_mfma_f32_16x16x32_bf16 v[116:119], a[80:83], a[28:31], v[116:119]
  buffer_load_dwordx4 v228, s[8:11], s46 offen offset:0 lds
  v_mfma_f32_16x16x32_bf16 v[216:219], a[80:83], a[32:35], v[216:219]
  ds_read_b64_tr_b16 a[106:107], v20 offset:14336
  v_mfma_f32_16x16x32_bf16 v[120:123], a[84:87], a[0:3], v[120:123]
  v_mfma_f32_16x16x32_bf16 v[124:127], a[84:87], a[4:7], v[124:127]
  ds_read_b128 a[68:71], v19 offset:0
  v_mfma_f32_16x16x32_bf16 v[128:131], a[84:87], a[8:11], v[128:131]
  v_mfma_f32_16x16x32_bf16 v[132:135], a[84:87], a[12:15], v[132:135]
  buffer_load_dwordx4 v229, s[8:11], s46 offen offset:1024 lds
  ds_read_b64_tr_b16 a[108:109], v21 offset:12288
  v_mfma_f32_16x16x32_bf16 v[136:139], a[84:87], a[16:19], v[136:139]
  v_mfma_f32_16x16x32_bf16 v[140:143], a[84:87], a[20:23], v[140:143]
  ds_read_b64_tr_b16 a[110:111], v21 offset:14336
  v_mfma_f32_16x16x32_bf16 v[144:147], a[84:87], a[24:27], v[144:147]
  v_mfma_f32_16x16x32_bf16 v[148:151], a[84:87], a[28:31], v[148:151]
  ds_read_b64_tr_b16 a[112:113], v20 offset:20480
  v_mfma_f32_16x16x32_bf16 v[220:223], a[84:87], a[32:35], v[220:223]
  buffer_load_dwordx4 v230, s[8:11], s46 offen offset:2048 lds
  v_mfma_f32_16x16x32_bf16 v[152:155], a[0:3], a[88:91], v[152:155]
  ds_read_b64_tr_b16 a[114:115], v20 offset:22528
  v_mfma_f32_16x16x32_bf16 v[156:159], a[4:7], a[88:91], v[156:159]
  v_mfma_f32_16x16x32_bf16 v[160:163], a[8:11], a[88:91], v[160:163]
  ds_read_b64_tr_b16 a[116:117], v21 offset:20480
  v_mfma_f32_16x16x32_bf16 v[164:167], a[12:15], a[88:91], v[164:167]
  v_mfma_f32_16x16x32_bf16 v[168:171], a[16:19], a[88:91], v[168:171]
  buffer_load_dwordx4 v231, s[8:11], s46 offen offset:3072 lds
  ds_read_b64_tr_b16 a[118:119], v21 offset:22528
  v_mfma_f32_16x16x32_bf16 v[172:175], a[20:23], a[88:91], v[172:175]
  s_mul_i32 s47, s48, 393216
  s_bfe_u32 s34, 0x302010e, s49
  s_add_u32 s48, s48, s34
  v_mfma_f32_16x16x32_bf16 v[176:179], a[24:27], a[88:91], v[176:179]
  s_add_u32 s49, s49, 8
  s_and_b32 s49, s49, 0x8001f
  s_and_b32 s48, s48, 15
  v_mfma_f32_16x16x32_bf16 v[180:183], a[28:31], a[88:91], v[180:183]
  s_lshl_b32 s46, s48, 7
  v_mfma_f32_16x16x32_bf16 v[184:187], a[0:3], a[92:95], v[184:187]
  s_add_u32 s36, s36, s38
  s_add_u32 s37, s37, 1
  s_cmp_eq_u32 s37, 3
  s_cselect_b32 s37, 0, s37
  s_cselect_b32 s38, s39, s40
  v_mfma_f32_16x16x32_bf16 v[188:191], a[4:7], a[92:95], v[188:191]
  s_add_u32 s41, s41, s43
  s_sub_u32 s43, 0, s43
  v_mfma_f32_16x16x32_bf16 v[192:195], a[8:11], a[92:95], v[192:195]
  v_add_u32 v16, s38, v16
  v_add_u32 v17, s38, v17
  v_mfma_f32_16x16x32_bf16 v[196:199], a[12:15], a[92:95], v[196:199]
  v_add_u32 v18, s38, v18
  v_add_u32 v19, s38, v19
  v_mfma_f32_16x16x32_bf16 v[200:203], a[16:19], a[92:95], v[200:203]
  v_add_u32 v20, s43, v20
  v_add_u32 v21, s43, v21
  v_mfma_f32_16x16x32_bf16 v[204:207], a[20:23], a[92:95], v[204:207]
  s_waitcnt vmcnt(9) lgkmcnt(0)
  s_barrier
  v_mfma_f32_16x16x32_bf16 v[208:211], a[24:27], a[92:95], v[208:211]
  s_sub_u32 s35, s35, 1
  v_mfma_f32_16x16x32_bf16 v[212:215], a[28:31], a[92:95], v[212:215]
  s_cmp_lg_u32 s35, 0
  s_cbranch_scc1 Lp2r0_loop
  v_accvgpr_read_b32 v4, a222
  v_accvgpr_read_b32 v5, a223
  v_accvgpr_read_b32 v6, a224
  v_accvgpr_read_b32 v7, a225
  v_accvgpr_read_b32 v8, a226
  v_accvgpr_read_b32 v9, a227
  v_accvgpr_read_b32 v10, a228
  v_accvgpr_read_b32 v11, a229
  s_mov_b32 s8, s64
  s_mov_b32 s9, s65
  s_mov_b32 s10, 4194304
  s_mov_b32 s11, 0x00020000
  s_mov_b32 s20, s68
  s_mov_b32 s21, s69
  s_mov_b32 s22, 8388608
  s_mov_b32 s23, 0x00020000
  s_and_b32 s4, s2, 7
  s_lshl_b32 s4, s4, 1
  s_lshr_b32 s5, s2, 6
  s_add_u32 s5, s5, s25
  s_and_b32 s53, s5, 3
  s_lshl_b32 s53, s53, 3
  s_or_b32 s53, s53, 0x80000
  s_bfe_u32 s52, 0xf0f02, s53
  s_add_u32 s52, s52, s4
  s_and_b32 s52, s52, 15
  s_mov_b32 s54, s52
  s_mov_b32 s55, s53
  s_lshl_b32 s29, s52, 7
  s_lshl_b32 s28, s54, 19
  s_lshl_b32 s30, s25, 18
  s_sub_u32 s31, 3932160, s30
  s_or_b32 s26, s30, s29
  s_or_b32 s27, s31, s29
  s_lshl_b32 s68, s3, 12
  s_lshl_b32 s88, s3, 13
  s_add_u32 s88, s88, 98304
  v_mfma_f32_16x16x32_bf16 v[24:27], a[96:99], a[36:39], v[24:27]
  s_mov_b32 m0, s41
  ds_read_b128 a[0:3], v16 offset:0
  v_mfma_f32_16x16x32_bf16 v[28:31], a[96:99], a[40:43], v[28:31]
  buffer_load_dwordx4 v233, s[12:15], s47 offen offset:0 lds
  ds_read_b64_tr_b16 a[72:73], v20 offset:0
  v_mfma_f32_16x16x32_bf16 v[32:35], a[96:99], a[44:47], v[32:35]
  v_mfma_f32_16x16x32_bf16 v[36:39], a[96:99], a[48:51], v[36:39]
  ds_read_b64_tr_b16 a[74:75], v20 offset:2048
  v_mfma_f32_16x16x32_bf16 v[40:43], a[96:99], a[52:55], v[40:43]
  v_mfma_f32_16x16x32_bf16 v[44:47], a[96:99], a[56:59], v[44:47]
  ds_read_b128 a[4:7], v16 offset:2048
  v_mfma_f32_16x16x32_bf16 v[48:51], a[96:99], a[60:63], v[48:51]
  v_mfma_f32_16x16x32_bf16 v[52:55], a[96:99], a[64:67], v[52:55]
  ds_read_b128 a[8:11], v16 offset:4096
  v_mfma_f32_16x16x32_bf16 v[56:59], a[100:103], a[36:39], v[56:59]
  v_mfma_f32_16x16x32_bf16 v[60:63], a[100:103], a[40:43], v[60:63]
  ds_read_b128 a[12:15], v16 offset:6144
  v_mfma_f32_16x16x32_bf16 v[64:67], a[100:103], a[44:47], v[64:67]
  v_mfma_f32_16x16x32_bf16 v[68:71], a[100:103], a[48:51], v[68:71]
  ds_read_b128 a[16:19], v16 offset:8192
  v_mfma_f32_16x16x32_bf16 v[72:75], a[100:103], a[52:55], v[72:75]
  v_mfma_f32_16x16x32_bf16 v[76:79], a[100:103], a[56:59], v[76:79]
  ds_read_b128 a[20:23], v16 offset:10240
  v_mfma_f32_16x16x32_bf16 v[80:83], a[100:103], a[60:63], v[80:83]
  v_mfma_f32_16x16x32_bf16 v[84:87], a[100:103], a[64:67], v[84:87]
  ds_read_b128 a[24:27], v16 offset:12288
  v_mfma_f32_16x16x32_bf16 v[88:91], a[104:107], a[36:39], v[88:91]
  buffer_load_dwordx4 v234, s[12:15], s47 offen offset:1024 lds
  v_mfma_f32_16x16x32_bf16 v[92:95], a[104:107], a[40:43], v[92:95]
  ds_read_b128 a[28:31], v16 offset:14336
  v_mfma_f32_16x16x32_bf16 v[96:99], a[104:107], a[44:47], v[96:99]
  v_mfma_f32_16x16x32_bf16 v[100:103], a[104:107], a[48:51], v[100:103]
  ds_read_b64_tr_b16 a[76:77], v21 offset:0
  v_mfma_f32_16x16x32_bf16 v[104:107], a[104:107], a[52:55], v[104:107]
  ds_read_b64_tr_b16 a[78:79], v21 offset:2048
  v_mfma_f32_16x16x32_bf16 v[108:111], a[104:107], a[56:59], v[108:111]
  v_mfma_f32_16x16x32_bf16 v[112:115], a[104:107], a[60:63], v[112:115]
  ds_read_b64_tr_b16 a[80:81], v20 offset:8192
  v_mfma_f32_16x16x32_bf16 v[116:119], a[104:107], a[64:67], v[116:119]
  v_mfma_f32_16x16x32_bf16 v[216:219], a[104:107], a[68:71], v[216:219]
  ds_read_b64_tr_b16 a[82:83], v20 offset:10240
  v_mfma_f32_16x16x32_bf16 v[120:123], a[108:111], a[36:39], v[120:123]
  v_mfma_f32_16x16x32_bf16 v[124:127], a[108:111], a[40:43], v[124:127]
  ds_read_b128 a[32:35], v18 offset:0
  v_mfma_f32_16x16x32_bf16 v[128:131], a[108:111], a[44:47], v[128:131]
  v_mfma_f32_16x16x32_bf16 v[132:135], a[108:111], a[48:51], v[132:135]
  ds_read_b64_tr_b16 a[84:85], v21 offset:8192
  v_mfma_f32_16x16x32_bf16 v[136:139], a[108:111], a[52:55], v[136:139]
  v_mfma_f32_16x16x32_bf16 v[140:143], a[108:111], a[56:59], v[140:143]
  ds_read_b64_tr_b16 a[86:87], v21 offset:10240
  v_mfma_f32_16x16x32_bf16 v[144:147], a[108:111], a[60:63], v[144:147]
  v_mfma_f32_16x16x32_bf16 v[148:151], a[108:111], a[64:67], v[148:151]
  buffer_load_dwordx4 v235, s[12:15], s47 offen offset:2048 lds
  ds_read_b64_tr_b16 a[88:89], v20 offset:16384
  v_mfma_f32_16x16x32_bf16 v[220:223], a[108:111], a[68:71], v[220:223]
  v_mfma_f32_16x16x32_bf16 v[152:155], a[36:39], a[112:115], v[152:155]
  ds_read_b64_tr_b16 a[90:91], v20 offset:18432
  v_mfma_f32_16x16x32_bf16 v[156:159], a[40:43], a[112:115], v[156:159]
  v_mfma_f32_16x16x32_bf16 v[160:163], a[44:47], a[112:115], v[160:163]
  ds_read_b64_tr_b16 a[92:93], v21 offset:16384
  v_mfma_f32_16x16x32_bf16 v[164:167], a[48:51], a[112:115], v[164:167]
  v_mfma_f32_16x16x32_bf16 v[168:171], a[52:55], a[112:115], v[168:171]
  ds_read_b64_tr_b16 a[94:95], v21 offset:18432
  v_mfma_f32_16x16x32_bf16 v[172:175], a[56:59], a[112:115], v[172:175]
  v_mfma_f32_16x16x32_bf16 v[176:179], a[60:63], a[112:115], v[176:179]
  v_mfma_f32_16x16x32_bf16 v[180:183], a[64:67], a[112:115], v[180:183]
  v_mfma_f32_16x16x32_bf16 v[184:187], a[36:39], a[116:119], v[184:187]
  v_mfma_f32_16x16x32_bf16 v[188:191], a[40:43], a[116:119], v[188:191]
  v_mfma_f32_16x16x32_bf16 v[192:195], a[44:47], a[116:119], v[192:195]
  v_mfma_f32_16x16x32_bf16 v[196:199], a[48:51], a[116:119], v[196:199]
  v_mfma_f32_16x16x32_bf16 v[200:203], a[52:55], a[116:119], v[200:203]
  v_mfma_f32_16x16x32_bf16 v[204:207], a[56:59], a[116:119], v[204:207]
  v_mfma_f32_16x16x32_bf16 v[208:211], a[60:63], a[116:119], v[208:211]
  v_mfma_f32_16x16x32_bf16 v[212:215], a[64:67], a[116:119], v[212:215]
  s_waitcnt lgkmcnt(0)
  v_mfma_f32_16x16x32_bf16 v[24:27], a[72:75], a[0:3], v[24:27]
  s_add_u32 m0, s41, 3072
  ds_read_b128 a[36:39], v17 offset:0
  v_mfma_f32_16x16x32_bf16 v[28:31], a[72:75], a[4:7], v[28:31]
  buffer_load_dwordx4 v236, s[12:15], s47 offen offset:0 lds
  ds_read_b64_tr_b16 a[96:97], v20 offset:4096
  v_mfma_f32_16x16x32_bf16 v[32:35], a[72:75], a[8:11], v[32:35]
  v_mfma_f32_16x16x32_bf16 v[36:39], a[72:75], a[12:15], v[36:39]
  ds_read_b64_tr_b16 a[98:99], v20 offset:6144
  v_mfma_f32_16x16x32_bf16 v[40:43], a[72:75], a[16:19], v[40:43]
  v_mfma_f32_16x16x32_bf16 v[44:47], a[72:75], a[20:23], v[44:47]
  ds_read_b128 a[40:43], v17 offset:2048
  v_mfma_f32_16x16x32_bf16 v[48:51], a[72:75], a[24:27], v[48:51]
  v_mfma_f32_16x16x32_bf16 v[52:55], a[72:75], a[28:31], v[52:55]
  ds_read_b128 a[44:47], v17 offset:4096
  v_mfma_f32_16x16x32_bf16 v[56:59], a[76:79], a[0:3], v[56:59]
  v_mfma_f32_16x16x32_bf16 v[60:63], a[76:79], a[4:7], v[60:63]
  ds_read_b128 a[48:51], v17 offset:6144
  v_mfma_f32_16x16x32_bf16 v[64:67], a[76:79], a[8:11], v[64:67]
  v_mfma_f32_16x16x32_bf16 v[68:71], a[76:79], a[12:15], v[68:71]
  ds_read_b128 a[52:55], v17 offset:8192
  v_mfma_f32_16x16x32_bf16 v[72:75], a[76:79], a[16:19], v[72:75]
  v_mfma_f32_16x16x32_bf16 v[76:79], a[76:79], a[20:23], v[76:79]
  ds_read_b128 a[56:59], v17 offset:10240
  v_mfma_f32_16x16x32_bf16 v[80:83], a[76:79], a[24:27], v[80:83]
  buffer_load_dwordx4 v237, s[12:15], s47 offen offset:1024 lds
  v_mfma_f32_16x16x32_bf16 v[84:87], a[76:79], a[28:31], v[84:87]
  ds_read_b128 a[60:63], v17 offset:12288
  v_mfma_f32_16x16x32_bf16 v[88:91], a[80:83], a[0:3], v[88:91]
  v_mfma_f32_16x16x32_bf16 v[92:95], a[80:83], a[4:7], v[92:95]
  ds_read_b128 a[64:67], v17 offset:14336
  v_mfma_f32_16x16x32_bf16 v[96:99], a[80:83], a[8:11], v[96:99]
  v_mfma_f32_16x16x32_bf16 v[100:103], a[80:83], a[12:15], v[100:103]
  ds_read_b64_tr_b16 a[100:101], v21 offset:4096
  v_mfma_f32_16x16x32_bf16 v[104:107], a[80:83], a[16:19], v[104:107]
  ds_read_b64_tr_b16 a[102:103], v21 offset:6144
  v_mfma_f32_16x16x32_bf16 v[108:111], a[80:83], a[20:23], v[108:111]
  v_mfma_f32_16x16x32_bf16 v[112:115], a[80:83], a[24:27], v[112:115]
  ds_read_b64_tr_b16 a[104:105], v20 offset:12288
  v_mfma_f32_16x16x32_bf16 v[116:119], a[80:83], a[28:31], v[116:119]
  v_mfma_f32_16x16x32_bf16 v[216:219], a[80:83], a[32:35], v[216:219]
  ds_read_b64_tr_b16 a[106:107], v20 offset:14336
  v_mfma_f32_16x16x32_bf16 v[120:123], a[84:87], a[0:3], v[120:123]
  v_mfma_f32_16x16x32_bf16 v[124:127], a[84:87], a[4:7], v[124:127]
  ds_read_b128 a[68:71], v19 offset:0
  v_mfma_f32_16x16x32_bf16 v[128:131], a[84:87], a[8:11], v[128:131]
  v_mfma_f32_16x16x32_bf16 v[132:135], a[84:87], a[12:15], v[132:135]
  buffer_load_dwordx4 v238, s[12:15], s47 offen offset:2048 lds
  ds_read_b64_tr_b16 a[108:109], v21 offset:12288
  v_mfma_f32_16x16x32_bf16 v[136:139], a[84:87], a[16:19], v[136:139]
  s_add_u32 s36, s36, s38
  s_add_u32 s37, s37, 1
  s_cmp_eq_u32 s37, 3
  s_cselect_b32 s37, 0, s37
  s_cselect_b32 s38, s39, s40
  v_mfma_f32_16x16x32_bf16 v[140:143], a[84:87], a[20:23], v[140:143]
  s_add_u32 s41, s41, s43
  s_sub_u32 s43, 0, s43
  ds_read_b64_tr_b16 a[110:111], v21 offset:14336
  v_mfma_f32_16x16x32_bf16 v[144:147], a[84:87], a[24:27], v[144:147]
  v_mfma_f32_16x16x32_bf16 v[148:151], a[84:87], a[28:31], v[148:151]
  ds_read_b64_tr_b16 a[112:113], v20 offset:20480
  v_mfma_f32_16x16x32_bf16 v[220:223], a[84:87], a[32:35], v[220:223]
  v_mfma_f32_16x16x32_bf16 v[152:155], a[0:3], a[88:91], v[152:155]
  ds_read_b64_tr_b16 a[114:115], v20 offset:22528
  v_mfma_f32_16x16x32_bf16 v[156:159], a[4:7], a[88:91], v[156:159]
  v_mfma_f32_16x16x32_bf16 v[160:163], a[8:11], a[88:91], v[160:163]
  ds_read_b64_tr_b16 a[116:117], v21 offset:20480
  v_mfma_f32_16x16x32_bf16 v[164:167], a[12:15], a[88:91], v[164:167]
  v_mfma_f32_16x16x32_bf16 v[168:171], a[16:19], a[88:91], v[168:171]
  ds_read_b64_tr_b16 a[118:119], v21 offset:22528
  v_mfma_f32_16x16x32_bf16 v[172:175], a[20:23], a[88:91], v[172:175]
  v_add_u32 v16, s38, v16
  v_add_u32 v17, s38, v17
  v_mfma_f32_16x16x32_bf16 v[176:179], a[24:27], a[88:91], v[176:179]
  v_add_u32 v18, s38, v18
  v_add_u32 v19, s38, v19
  v_mfma_f32_16x16x32_bf16 v[180:183], a[28:31], a[88:91], v[180:183]
  v_add_u32 v20, s43, v20
  v_add_u32 v21, s43, v21
  v_mfma_f32_16x16x32_bf16 v[184:187], a[0:3], a[92:95], v[184:187]
  v_mfma_f32_16x16x32_bf16 v[188:191], a[4:7], a[92:95], v[188:191]
  v_mfma_f32_16x16x32_bf16 v[192:195], a[8:11], a[92:95], v[192:195]
  v_mfma_f32_16x16x32_bf16 v[196:199], a[12:15], a[92:95], v[196:199]
  v_mfma_f32_16x16x32_bf16 v[200:203], a[16:19], a[92:95], v[200:203]
  v_mfma_f32_16x16x32_bf16 v[204:207], a[20:23], a[92:95], v[204:207]
  v_mfma_f32_16x16x32_bf16 v[208:211], a[24:27], a[92:95], v[208:211]
  v_mfma_f32_16x16x32_bf16 v[212:215], a[28:31], a[92:95], v[212:215]
  s_waitcnt vmcnt(0) lgkmcnt(0)
  s_barrier
  s_mov_b32 s6, 0x3e8293ee
  s_mov_b32 s7, s6
  v_mfma_f32_16x16x32_bf16 v[24:27], a[96:99], a[36:39], v[24:27]
  ds_read_b128 a[0:3], v16 offset:0
  v_mfma_f32_16x16x32_bf16 v[28:31], a[96:99], a[40:43], v[28:31]
  ds_read_b64_tr_b16 a[72:73], v20 offset:0
  v_mfma_f32_16x16x32_bf16 v[32:35], a[96:99], a[44:47], v[32:35]
  v_mfma_f32_16x16x32_bf16 v[36:39], a[96:99], a[48:51], v[36:39]
  ds_read_b64_tr_b16 a[74:75], v20 offset:2048
  v_mfma_f32_16x16x32_bf16 v[40:43], a[96:99], a[52:55], v[40:43]
  v_mfma_f32_16x16x32_bf16 v[44:47], a[96:99], a[56:59], v[44:47]
  ds_read_b128 a[4:7], v16 offset:2048
  v_mfma_f32_16x16x32_bf16 v[48:51], a[96:99], a[60:63], v[48:51]
  v_mfma_f32_16x16x32_bf16 v[52:55], a[96:99], a[64:67], v[52:55]
  ds_read_b128 a[8:11], v16 offset:4096
  v_mfma_f32_16x16x32_bf16 v[56:59], a[100:103], a[36:39], v[56:59]
  v_mfma_f32_16x16x32_bf16 v[60:63], a[100:103], a[40:43], v[60:63]
  ds_read_b128 a[12:15], v16 offset:6144
  v_mfma_f32_16x16x32_bf16 v[64:67], a[100:103], a[44:47], v[64:67]
  v_mfma_f32_16x16x32_bf16 v[68:71], a[100:103], a[48:51], v[68:71]
  ds_read_b128 a[16:19], v16 offset:8192
  v_mfma_f32_16x16x32_bf16 v[72:75], a[100:103], a[52:55], v[72:75]
  v_mfma_f32_16x16x32_bf16 v[76:79], a[100:103], a[56:59], v[76:79]
  ds_read_b128 a[20:23], v16 offset:10240
  v_mfma_f32_16x16x32_bf16 v[80:83], a[100:103], a[60:63], v[80:83]
  v_mfma_f32_16x16x32_bf16 v[84:87], a[100:103], a[64:67], v[84:87]
  ds_read_b128 a[24:27], v16 offset:12288
  v_mfma_f32_16x16x32_bf16 v[88:91], a[104:107], a[36:39], v[88:91]
  v_mfma_f32_16x16x32_bf16 v[92:95], a[104:107], a[40:43], v[92:95]
  ds_read_b128 a[28:31], v16 offset:14336
  v_mfma_f32_16x16x32_bf16 v[96:99], a[104:107], a[44:47], v[96:99]
  v_mfma_f32_16x16x32_bf16 v[100:103], a[104:107], a[48:51], v[100:103]
  ds_read_b64_tr_b16 a[76:77], v21 offset:0
  v_mfma_f32_16x16x32_bf16 v[104:107], a[104:107], a[52:55], v[104:107]
  ds_read_b64_tr_b16 a[78:79], v21 offset:2048
  v_mfma_f32_16x16x32_bf16 v[108:111], a[104:107], a[56:59], v[108:111]
  v_mfma_f32_16x16x32_bf16 v[112:115], a[104:107], a[60:63], v[112:115]
  ds_read_b64_tr_b16 a[80:81], v20 offset:8192
  v_mfma_f32_16x16x32_bf16 v[116:119], a[104:107], a[64:67], v[116:119]
  v_mfma_f32_16x16x32_bf16 v[216:219], a[104:107], a[68:71], v[216:219]
  ds_read_b64_tr_b16 a[82:83], v20 offset:10240
  v_mfma_f32_16x16x32_bf16 v[120:123], a[108:111], a[36:39], v[120:123]
  v_mfma_f32_16x16x32_bf16 v[124:127], a[108:111], a[40:43], v[124:127]
  ds_read_b128 a[32:35], v18 offset:0
  v_mfma_f32_16x16x32_bf16 v[128:131], a[108:111], a[44:47], v[128:131]
  v_mfma_f32_16x16x32_bf16 v[132:135], a[108:111], a[48:51], v[132:135]
  ds_read_b64_tr_b16 a[84:85], v21 offset:8192
  v_mfma_f32_16x16x32_bf16 v[136:139], a[108:111], a[52:55], v[136:139]
  v_mfma_f32_16x16x32_bf16 v[140:143], a[108:111], a[56:59], v[140:143]
  ds_read_b64_tr_b16 a[86:87], v21 offset:10240
  v_mfma_f32_16x16x32_bf16 v[144:147], a[108:111], a[60:63], v[144:147]
  v_mfma_f32_16x16x32_bf16 v[148:151], a[108:111], a[64:67], v[148:151]
  ds_read_b64_tr_b16 a[88:89], v20 offset:16384
  v_mfma_f32_16x16x32_bf16 v[220:223], a[108:111], a[68:71], v[220:223]
  v_mfma_f32_16x16x32_bf16 v[152:155], a[36:39], a[112:115], v[152:155]
  ds_read_b64_tr_b16 a[90:91], v20 offset:18432
  v_mfma_f32_16x16x32_bf16 v[156:159], a[40:43], a[112:115], v[156:159]
  v_mfma_f32_16x16x32_bf16 v[160:163], a[44:47], a[112:115], v[160:163]
  ds_read_b64_tr_b16 a[92:93], v21 offset:16384
  v_mfma_f32_16x16x32_bf16 v[164:167], a[48:51], a[112:115], v[164:167]
  v_mfma_f32_16x16x32_bf16 v[168:171], a[52:55], a[112:115], v[168:171]
  ds_read_b64_tr_b16 a[94:95], v21 offset:18432
  v_mfma_f32_16x16x32_bf16 v[172:175], a[56:59], a[112:115], v[172:175]
  v_mfma_f32_16x16x32_bf16 v[176:179], a[60:63], a[112:115], v[176:179]
  v_mfma_f32_16x16x32_bf16 v[180:183], a[64:67], a[112:115], v[180:183]
  v_mfma_f32_16x16x32_bf16 v[184:187], a[36:39], a[116:119], v[184:187]
  v_mfma_f32_16x16x32_bf16 v[188:191], a[40:43], a[116:119], v[188:191]
  v_mfma_f32_16x16x32_bf16 v[192:195], a[44:47], a[116:119], v[192:195]
  v_mfma_f32_16x16x32_bf16 v[196:199], a[48:51], a[116:119], v[196:199]
  v_mfma_f32_16x16x32_bf16 v[200:203], a[52:55], a[116:119], v[200:203]
  v_mfma_f32_16x16x32_bf16 v[204:207], a[56:59], a[116:119], v[204:207]
  v_mfma_f32_16x16x32_bf16 v[208:211], a[60:63], a[116:119], v[208:211]
  v_mfma_f32_16x16x32_bf16 v[212:215], a[64:67], a[116:119], v[212:215]
  s_waitcnt lgkmcnt(0)
  v_mfma_f32_16x16x32_bf16 v[24:27], a[72:75], a[0:3], v[24:27]
  ds_read_b128 a[36:39], v17 offset:0
  ds_read_b64_tr_b16 a[96:97], v20 offset:4096
  v_mfma_f32_16x16x32_bf16 v[56:59], a[76:79], a[0:3], v[56:59]
  ds_read_b64_tr_b16 a[98:99], v20 offset:6144
  ds_read_b128 a[40:43], v17 offset:2048
  v_mfma_f32_16x16x32_bf16 v[28:31], a[72:75], a[4:7], v[28:31]
  ds_read_b128 a[44:47], v17 offset:4096
  ds_read_b128 a[48:51], v17 offset:6144
  v_mfma_f32_16x16x32_bf16 v[60:63], a[76:79], a[4:7], v[60:63]
  ds_read_b128 a[52:55], v17 offset:8192
  ds_read_b128 a[56:59], v17 offset:10240
  v_mfma_f32_16x16x32_bf16 v[32:35], a[72:75], a[8:11], v[32:35]
  ds_read_b128 a[60:63], v17 offset:12288
  ds_read_b128 a[64:67], v17 offset:14336
  v_mfma_f32_16x16x32_bf16 v[64:67], a[76:79], a[8:11], v[64:67]
  ds_read_b64_tr_b16 a[100:101], v21 offset:4096
  ds_read_b64_tr_b16 a[102:103], v21 offset:6144
  v_mfma_f32_16x16x32_bf16 v[36:39], a[72:75], a[12:15], v[36:39]
  ds_read_b64_tr_b16 a[104:105], v20 offset:12288
  ds_read_b64_tr_b16 a[106:107], v20 offset:14336
  v_mfma_f32_16x16x32_bf16 v[68:71], a[76:79], a[12:15], v[68:71]
  ds_read_b128 a[68:71], v19 offset:0
  ds_read_b64_tr_b16 a[108:109], v21 offset:12288
  v_mfma_f32_16x16x32_bf16 v[40:43], a[72:75], a[16:19], v[40:43]
  ds_read_b64_tr_b16 a[110:111], v21 offset:14336
  ds_read_b64_tr_b16 a[112:113], v20 offset:20480
  v_mfma_f32_16x16x32_bf16 v[72:75], a[76:79], a[16:19], v[72:75]
  ds_read_b64_tr_b16 a[114:115], v20 offset:22528
  ds_read_b64_tr_b16 a[116:117], v21 offset:20480
  v_mfma_f32_16x16x32_bf16 v[44:47], a[72:75], a[20:23], v[44:47]
  ds_read_b64_tr_b16 a[118:119], v21 offset:22528
  v_mfma_f32_16x16x32_bf16 v[76:79], a[76:79], a[20:23], v[76:79]
  v_mfma_f32_16x16x32_bf16 v[48:51], a[72:75], a[24:27], v[48:51]
  v_mfma_f32_16x16x32_bf16 v[80:83], a[76:79], a[24:27], v[80:83]
  v_mfma_f32_16x16x32_bf16 v[52:55], a[72:75], a[28:31], v[52:55]
  v_mfma_f32_16x16x32_bf16 v[84:87], a[76:79], a[28:31], v[84:87]
  s_waitcnt lgkmcnt(0)
  s_barrier
  s_mov_b32 s12, s84
  s_mov_b32 s13, s85
  s_mov_b32 s14, 256
  s_mov_b32 s15, 0x00020000
  buffer_load_dwordx2 v[22:23], off, s[12:15], 0 sc1
  v_mfma_f32_16x16x32_bf16 v[24:27], a[96:99], a[36:39], v[24:27]
  s_mov_b32 m0, s68
  v_mfma_f32_16x16x32_bf16 v[56:59], a[100:103], a[36:39], v[56:59]
  buffer_load_dwordx4 v8, s[20:23], s28 offen offset:0 lds
  v_mfma_f32_16x16x32_bf16 v[28:31], a[96:99], a[40:43], v[28:31]
  v_mfma_f32_16x16x32_bf16 v[60:63], a[100:103], a[40:43], v[60:63]
  v_mfma_f32_16x16x32_bf16 v[32:35], a[96:99], a[44:47], v[32:35]
  v_mfma_f32_16x16x32_bf16 v[64:67], a[100:103], a[44:47], v[64:67]
  buffer_load_dwordx4 v9, s[20:23], s28 offen offset:1024 lds
  v_pk_mul_f32 v[24:25], v[24:25], s[6:7]
  v_mfma_f32_16x16x32_bf16 v[36:39], a[96:99], a[48:51], v[36:39]
  v_pk_mul_f32 v[26:27], v[26:27], s[6:7]
  v_pk_mul_f32 v[56:57], v[56:57], s[6:7]
  v_mfma_f32_16x16x32_bf16 v[68:71], a[100:103], a[48:51], v[68:71]
  v_pk_mul_f32 v[58:59], v[58:59], s[6:7]
  v_cvt_pk_bf16_f32 v24, v24, v25
  v_mfma_f32_16x16x32_bf16 v[40:43], a[96:99], a[52:55], v[40:43]
  v_cvt_pk_bf16_f32 v25, v26, v27
  v_cvt_pk_bf16_f32 v26, v56, v57
  v_mfma_f32_16x16x32_bf16 v[72:75], a[100:103], a[52:55], v[72:75]
  v_cvt_pk_bf16_f32 v27, v58, v59
  v_pk_mul_f32 v[28:29], v[28:29], s[6:7]
  v_mfma_f32_16x16x32_bf16 v[44:47], a[96:99], a[56:59], v[44:47]
  buffer_load_dwordx4 v10, s[20:23], s28 offen offset:2048 lds
  v_pk_mul_f32 v[30:31], v[30:31], s[6:7]
  v_mfma_f32_16x16x32_bf16 v[76:79], a[100:103], a[56:59], v[76:79]
  v_pk_mul_f32 v[60:61], v[60:61], s[6:7]
  v_pk_mul_f32 v[62:63], v[62:63], s[6:7]
  v_mfma_f32_16x16x32_bf16 v[48:51], a[96:99], a[60:63], v[48:51]
  v_cvt_pk_bf16_f32 v28, v28, v29
  v_cvt_pk_bf16_f32 v29, v30, v31
  v_mfma_f32_16x16x32_bf16 v[80:83], a[100:103], a[60:63], v[80:83]
  v_cvt_pk_bf16_f32 v30, v60, v61
  v_cvt_pk_bf16_f32 v31, v62, v63
  v_mfma_f32_16x16x32_bf16 v[52:55], a[96:99], a[64:67], v[52:55]
  v_pk_mul_f32 v[32:33], v[32:33], s[6:7]
  v_pk_mul_f32 v[34:35], v[34:35], s[6:7]
  v_mfma_f32_16x16x32_bf16 v[84:87], a[100:103], a[64:67], v[84:87]
  buffer_load_dwordx4 v11, s[20:23], s28 offen offset:3072 lds
  v_pk_mul_f32 v[64:65], v[64:65], s[6:7]
  v_mfma_f32_16x16x32_bf16 v[216:219], a[80:83], a[32:35], v[216:219]
  s_bfe_u32 s56, 0x302010e, s55
  s_add_u32 s54, s54, s56
  s_add_u32 s55, s55, 8
  v_mfma_f32_16x16x32_bf16 v[220:223], a[84:87], a[32:35], v[220:223]
  s_and_b32 s55, s55, 0x8001f
  s_and_b32 s54, s54, 15
  s_lshl_b32 s28, s54, 19
  v_mfma_f32_16x16x32_bf16 v[216:219], a[104:107], a[68:71], v[216:219]
  s_add_u32 m0, s68, 16384
  v_pk_mul_f32 v[66:67], v[66:67], s[6:7]
  v_cvt_pk_bf16_f32 v32, v32, v33
  v_mfma_f32_16x16x32_bf16 v[220:223], a[108:111], a[68:71], v[220:223]
  v_cvt_pk_bf16_f32 v33, v34, v35
  v_cvt_pk_bf16_f32 v34, v64, v65
  v_mfma_f32_16x16x32_bf16 v[88:91], a[80:83], a[0:3], v[88:91]
  buffer_load_dwordx4 v8, s[20:23], s28 offen offset:0 lds
  v_cvt_pk_bf16_f32 v35, v66, v67
  v_mfma_f32_16x16x32_bf16 v[120:123], a[84:87], a[0:3], v[120:123]
  v_pk_mul_f32 v[36:37], v[36:37], s[6:7]
  v_pk_mul_f32 v[38:39], v[38:39], s[6:7]
  v_mfma_f32_16x16x32_bf16 v[88:91], a[104:107], a[36:39], v[88:91]
  v_pk_mul_f32 v[68:69], v[68:69], s[6:7]
  v_pk_mul_f32 v[70:71], v[70:71], s[6:7]
  v_mfma_f32_16x16x32_bf16 v[120:123], a[108:111], a[36:39], v[120:123]
  v_cvt_pk_bf16_f32 v36, v36, v37
  v_cvt_pk_bf16_f32 v37, v38, v39
  v_mfma_f32_16x16x32_bf16 v[92:95], a[80:83], a[4:7], v[92:95]
  v_cvt_pk_bf16_f32 v38, v68, v69
  v_cvt_pk_bf16_f32 v39, v70, v71
  v_mfma_f32_16x16x32_bf16 v[124:127], a[84:87], a[4:7], v[124:127]
  buffer_load_dwordx4 v9, s[20:23], s28 offen offset:1024 lds
  v_pk_mul_f32 v[40:41], v[40:41], s[6:7]
  v_mfma_f32_16x16x32_bf16 v[92:95], a[104:107], a[40:43], v[92:95]
  v_pk_mul_f32 v[42:43], v[42:43], s[6:7]
  v_pk_mul_f32 v[72:73], v[72:73], s[6:7]
  v_mfma_f32_16x16x32_bf16 v[124:127], a[108:111], a[40:43], v[124:127]
  v_pk_mul_f32 v[74:75], v[74:75], s[6:7]
  v_cvt_pk_bf16_f32 v40, v40, v41
  v_mfma_f32_16x16x32_bf16 v[96:99], a[80:83], a[8:11], v[96:99]
  v_cvt_pk_bf16_f32 v41, v42, v43
  v_cvt_pk_bf16_f32 v42, v72, v73
  v_mfma_f32_16x16x32_bf16 v[128:131], a[84:87], a[8:11], v[128:131]
  v_cvt_pk_bf16_f32 v43, v74, v75
  v_pk_mul_f32 v[44:45], v[44:45], s[6:7]
  v_mfma_f32_16x16x32_bf16 v[96:99], a[104:107], a[44:47], v[96:99]
  v_pk_mul_f32 v[46:47], v[46:47], s[6:7]
  v_pk_mul_f32 v[76:77], v[76:77], s[6:7]
  v_mfma_f32_16x16x32_bf16 v[128:131], a[108:111], a[44:47], v[128:131]
  buffer_load_dwordx4 v10, s[20:23], s28 offen offset:2048 lds
  v_pk_mul_f32 v[78:79], v[78:79], s[6:7]
  v_mfma_f32_16x16x32_bf16 v[100:103], a[80:83], a[12:15], v[100:103]
  v_cvt_pk_bf16_f32 v44, v44, v45
  v_cvt_pk_bf16_f32 v45, v46, v47
  v_mfma_f32_16x16x32_bf16 v[132:135], a[84:87], a[12:15], v[132:135]
  v_cvt_pk_bf16_f32 v46, v76, v77
  v_cvt_pk_bf16_f32 v47, v78, v79
  v_mfma_f32_16x16x32_bf16 v[100:103], a[104:107], a[48:51], v[100:103]
  v_pk_mul_f32 v[48:49], v[48:49], s[6:7]
  v_pk_mul_f32 v[50:51], v[50:51], s[6:7]
  v_mfma_f32_16x16x32_bf16 v[132:135], a[108:111], a[48:51], v[132:135]
  v_pk_mul_f32 v[80:81], v[80:81], s[6:7]
  v_pk_mul_f32 v[82:83], v[82:83], s[6:7]
  v_mfma_f32_16x16x32_bf16 v[104:107], a[80:83], a[16:19], v[104:107]
  buffer_load_dwordx4 v11, s[20:23], s28 offen offset:3072 lds
  v_cvt_pk_bf16_f32 v48, v48, v49
  v_mfma_f32_16x16x32_bf16 v[136:139], a[84:87], a[16:19], v[136:139]
  s_bfe_u32 s56, 0x302010e, s55
  s_add_u32 s54, s54, s56
  s_add_u32 s55, s55, 8
  v_mfma_f32_16x16x32_bf16 v[104:107], a[104:107], a[52:55], v[104:107]
  s_and_b32 s55, s55, 0x8001f
  s_and_b32 s54, s54, 15
  s_lshl_b32 s28, s54, 19
  v_mfma_f32_16x16x32_bf16 v[136:139], a[108:111], a[52:55], v[136:139]
  s_mov_b32 m0, s88
  v_cvt_pk_bf16_f32 v49, v50, v51
  v_cvt_pk_bf16_f32 v50, v80, v81
  v_mfma_f32_16x16x32_bf16 v[108:111], a[80:83], a[20:23], v[108:111]
  v_cvt_pk_bf16_f32 v51, v82, v83
  v_pk_mul_f32 v[52:53], v[52:53], s[6:7]
  v_mfma_f32_16x16x32_bf16 v[140:143], a[84:87], a[20:23], v[140:143]
  buffer_load_dwordx4 v4, s[8:11], s26 offen offset:0 lds
  v_pk_mul_f32 v[54:55], v[54:55], s[6:7]
  v_mfma_f32_16x16x32_bf16 v[108:111], a[104:107], a[56:59], v[108:111]
  v_pk_mul_f32 v[84:85], v[84:85], s[6:7]
  v_pk_mul_f32 v[86:87], v[86:87], s[6:7]
  v_mfma_f32_16x16x32_bf16 v[140:143], a[108:111], a[56:59], v[140:143]
  v_cvt_pk_bf16_f32 v52, v52, v53
  v_cvt_pk_bf16_f32 v53, v54, v55
  v_mfma_f32_16x16x32_bf16 v[112:115], a[80:83], a[24:27], v[112:115]
  v_cvt_pk_bf16_f32 v54, v84, v85
  v_cvt_pk_bf16_f32 v55, v86, v87
  v_mfma_f32_16x16x32_bf16 v[144:147], a[84:87], a[24:27], v[144:147]
  v_cvt_pk_bf16_f32 v216, v216, v217
  v_cvt_pk_bf16_f32 v217, v218, v219
  v_mfma_f32_16x16x32_bf16 v[112:115], a[104:107], a[60:63], v[112:115]
  buffer_load_dwordx4 v5, s[8:11], s26 offen offset:1024 lds
  v_cvt_pk_bf16_f32 v218, v220, v221
  v_mfma_f32_16x16x32_bf16 v[144:147], a[108:111], a[60:63], v[144:147]
  v_cvt_pk_bf16_f32 v219, v222, v223
  v_mfma_f32_16x16x32_bf16 v[116:119], a[80:83], a[28:31], v[116:119]
  ds_write_b128 v252, v[216:219]
  v_cvt_pk_bf16_f32 v88, v88, v89
  v_mfma_f32_16x16x32_bf16 v[148:151], a[84:87], a[28:31], v[148:151]
  v_cvt_pk_bf16_f32 v89, v90, v91
  v_cvt_pk_bf16_f32 v90, v120, v121
  v_mfma_f32_16x16x32_bf16 v[116:119], a[104:107], a[64:67], v[116:119]
  v_cvt_pk_bf16_f32 v91, v122, v123
  v_cvt_pk_bf16_f32 v92, v92, v93
  v_mfma_f32_16x16x32_bf16 v[148:151], a[108:111], a[64:67], v[148:151]
  buffer_load_dwordx4 v6, s[8:11], s26 offen offset:2048 lds
  v_cvt_pk_bf16_f32 v93, v94, v95
  v_mfma_f32_16x16x32_bf16 v[180:183], a[28:31], a[88:91], v[180:183]
  v_cvt_pk_bf16_f32 v94, v124, v125
  v_cvt_pk_bf16_f32 v95, v126, v127
  v_mfma_f32_16x16x32_bf16 v[212:215], a[28:31], a[92:95], v[212:215]
  v_cvt_pk_bf16_f32 v96, v96, v97
  v_cvt_pk_bf16_f32 v97, v98, v99
  v_mfma_f32_16x16x32_bf16 v[180:183], a[64:67], a[112:115], v[180:183]
  v_cvt_pk_bf16_f32 v98, v128, v129
  v_cvt_pk_bf16_f32 v99, v130, v131
  v_mfma_f32_16x16x32_bf16 v[212:215], a[64:67], a[116:119], v[212:215]
  v_cvt_pk_bf16_f32 v100, v100, v101
  v_cvt_pk_bf16_f32 v101, v102, v103
  v_mfma_f32_16x16x32_bf16 v[176:179], a[24:27], a[88:91], v[176:179]
  v_cvt_pk_bf16_f32 v102, v132, v133
  v_cvt_pk_bf16_f32 v103, v134, v135
  v_mfma_f32_16x16x32_bf16 v[208:211], a[24:27], a[92:95], v[208:211]
  buffer_load_dwordx4 v7, s[8:11], s26 offen offset:3072 lds
  v_cvt_pk_bf16_f32 v104, v104, v105
  v_mfma_f32_16x16x32_bf16 v[176:179], a[60:63], a[112:115], v[176:179]
  s_add_u32 m0, s88, 4096
  v_cvt_pk_bf16_f32 v105, v106, v107
  v_cvt_pk_bf16_f32 v106, v136, v137
  v_mfma_f32_16x16x32_bf16 v[208:211], a[60:63], a[116:119], v[208:211]
  v_cvt_pk_bf16_f32 v107, v138, v139
  v_cvt_pk_bf16_f32 v108, v108, v109
  v_mfma_f32_16x16x32_bf16 v[172:175], a[20:23], a[88:91], v[172:175]
  v_cvt_pk_bf16_f32 v109, v110, v111
  v_cvt_pk_bf16_f32 v110, v140, v141
  v_mfma_f32_16x16x32_bf16 v[204:207], a[20:23], a[92:95], v[204:207]
  v_cvt_pk_bf16_f32 v111, v142, v143
  v_cvt_pk_bf16_f32 v112, v112, v113
  v_mfma_f32_16x16x32_bf16 v[172:175], a[56:59], a[112:115], v[172:175]
  buffer_load_dwordx4 v4, s[8:11], s27 offen offset:0 lds
  v_cvt_pk_bf16_f32 v113, v114, v115
  v_mfma_f32_16x16x32_bf16 v[204:207], a[56:59], a[116:119], v[204:207]
  v_cvt_pk_bf16_f32 v114, v144, v145
  v_cvt_pk_bf16_f32 v115, v146, v147
  v_mfma_f32_16x16x32_bf16 v[168:171], a[16:19], a[88:91], v[168:171]
  v_cvt_pk_bf16_f32 v116, v116, v117
  v_cvt_pk_bf16_f32 v117, v118, v119
  v_mfma_f32_16x16x32_bf16 v[200:203], a[16:19], a[92:95], v[200:203]
  v_cvt_pk_bf16_f32 v118, v148, v149
  v_cvt_pk_bf16_f32 v119, v150, v151
  v_mfma_f32_16x16x32_bf16 v[168:171], a[52:55], a[112:115], v[168:171]
  ds_write_b128 v252, v[116:119] offset:2048
  v_cvt_pk_bf16_f32 v72, v180, v181
  v_mfma_f32_16x16x32_bf16 v[200:203], a[52:55], a[116:119], v[200:203]
  buffer_load_dwordx4 v5, s[8:11], s27 offen offset:1024 lds
  v_cvt_pk_bf16_f32 v73, v182, v183
  v_mfma_f32_16x16x32_bf16 v[164:167], a[12:15], a[88:91], v[164:167]
  v_cvt_pk_bf16_f32 v136, v212, v213
  v_cvt_pk_bf16_f32 v137, v214, v215
  v_mfma_f32_16x16x32_bf16 v[196:199], a[12:15], a[92:95], v[196:199]
  ds_write_b64 v252, v[72:73] offset:3072
  ds_write_b64 v252, v[136:137] offset:3080
  v_mfma_f32_16x16x32_bf16 v[164:167], a[48:51], a[112:115], v[164:167]
  v_cvt_pk_bf16_f32 v70, v176, v177
  v_cvt_pk_bf16_f32 v71, v178, v179
  v_mfma_f32_16x16x32_bf16 v[196:199], a[48:51], a[116:119], v[196:199]
  v_cvt_pk_bf16_f32 v134, v208, v209
  v_cvt_pk_bf16_f32 v135, v210, v211
  v_mfma_f32_16x16x32_bf16 v[160:163], a[8:11], a[88:91], v[160:163]
  buffer_load_dwordx4 v6, s[8:11], s27 offen offset:2048 lds
  v_cvt_pk_bf16_f32 v68, v172, v173
  v_mfma_f32_16x16x32_bf16 v[192:195], a[8:11], a[92:95], v[192:195]
  v_cvt_pk_bf16_f32 v69, v174, v175
  v_cvt_pk_bf16_f32 v132, v204, v205
  v_mfma_f32_16x16x32_bf16 v[160:163], a[44:47], a[112:115], v[160:163]
  v_cvt_pk_bf16_f32 v133, v206, v207
  v_cvt_pk_bf16_f32 v66, v168, v169
  v_mfma_f32_16x16x32_bf16 v[192:195], a[44:47], a[116:119], v[192:195]
  v_cvt_pk_bf16_f32 v67, v170, v171
  v_cvt_pk_bf16_f32 v130, v200, v201
  v_mfma_f32_16x16x32_bf16 v[156:159], a[4:7], a[88:91], v[156:159]
  v_cvt_pk_bf16_f32 v131, v202, v203
  v_cvt_pk_bf16_f32 v64, v164, v165
  v_mfma_f32_16x16x32_bf16 v[188:191], a[4:7], a[92:95], v[188:191]
  buffer_load_dwordx4 v7, s[8:11], s27 offen offset:3072 lds
  v_cvt_pk_bf16_f32 v65, v166, v167
  v_mfma_f32_16x16x32_bf16 v[156:159], a[40:43], a[112:115], v[156:159]
  s_bfe_u32 s29, 0x302010e, s53
  s_add_u32 s52, s52, s29
  s_add_u32 s53, s53, 8
  v_mfma_f32_16x16x32_bf16 v[188:191], a[40:43], a[116:119], v[188:191]
  s_and_b32 s53, s53, 0x8001f
  s_and_b32 s52, s52, 15
  s_lshl_b32 s29, s52, 7
  v_mfma_f32_16x16x32_bf16 v[152:155], a[0:3], a[88:91], v[152:155]
  s_or_b32 s26, s30, s29
  s_or_b32 s27, s31, s29
  v_cvt_pk_bf16_f32 v128, v196, v197
  v_mfma_f32_16x16x32_bf16 v[184:187], a[0:3], a[92:95], v[184:187]
  v_cvt_pk_bf16_f32 v129, v198, v199
  v_cvt_pk_bf16_f32 v62, v160, v161
  v_mfma_f32_16x16x32_bf16 v[152:155], a[36:39], a[112:115], v[152:155]
  v_cvt_pk_bf16_f32 v63, v162, v163
  v_cvt_pk_bf16_f32 v126, v192, v193
  v_mfma_f32_16x16x32_bf16 v[184:187], a[36:39], a[116:119], v[184:187]
  v_cvt_pk_bf16_f32 v127, v194, v195
  v_cvt_pk_bf16_f32 v60, v156, v157
  v_cvt_pk_bf16_f32 v61, v158, v159
  v_cvt_pk_bf16_f32 v124, v188, v189
  v_cvt_pk_bf16_f32 v125, v190, v191
  v_cvt_pk_bf16_f32 v58, v152, v153
  v_cvt_pk_bf16_f32 v59, v154, v155
  s_nop 0
  v_cvt_pk_bf16_f32 v122, v184, v185
  v_cvt_pk_bf16_f32 v123, v186, v187
  s_waitcnt lgkmcnt(0)
  s_barrier
  s_branch Lp2_at
Lp2_r1:
  s_and_b32 s4, s2, 7
  s_lshl_b32 s4, s4, 4
  s_add_u32 s4, s4, s59
  s_lshl_b32 s4, s4, 2
  s_add_u32 s4, s4, s3
  s_lshl_b32 s51, s4, 13
  s_mov_b32 m0, s36
  s_nop 0
  buffer_load_dwordx4 v224, s[8:11], s46 offen offset:0 lds
  buffer_load_dwordx4 v225, s[8:11], s46 offen offset:1024 lds
  buffer_load_dwordx4 v226, s[8:11], s46 offen offset:2048 lds
  buffer_load_dwordx4 v227, s[8:11], s46 offen offset:3072 lds
  s_add_u32 m0, s36, 4096
  s_nop 0
  buffer_load_dwordx4 v228, s[8:11], s46 offen offset:0 lds
  buffer_load_dwordx4 v229, s[8:11], s46 offen offset:1024 lds
  buffer_load_dwordx4 v230, s[8:11], s46 offen offset:2048 lds
  buffer_load_dwordx4 v231, s[8:11], s46 offen offset:3072 lds
  s_mul_i32 s47, s48, 393216
  s_bfe_u32 s34, 0x302010e, s49
  s_add_u32 s48, s48, s34
  s_add_u32 s49, s49, 8
  s_and_b32 s49, s49, 0x8001f
  s_and_b32 s48, s48, 15
  s_lshl_b32 s46, s48, 7
  s_mov_b32 m0, s41
  s_nop 0
  buffer_load_dwordx4 v233, s[12:15], s47 offen offset:0 lds
  buffer_load_dwordx4 v234, s[12:15], s47 offen offset:1024 lds
  buffer_load_dwordx4 v235, s[12:15], s47 offen offset:2048 lds
  s_add_u32 m0, s41, 3072
  s_nop 0
  buffer_load_dwordx4 v236, s[12:15], s47 offen offset:0 lds
  buffer_load_dwordx4 v237, s[12:15], s47 offen offset:1024 lds
  buffer_load_dwordx4 v238, s[12:15], s47 offen offset:2048 lds
  s_lshr_b32 s4, s3, 1
  s_lshl_b32 s4, s4, 14
  v_and_b32 v240, 15, v1
  v_lshlrev_b32 v240, 7, v240
  v_lshrrev_b32 v241, 4, v1
  v_and_b32 v242, 6, v1
  v_xor_b32 v241, v241, v242
  v_lshl_add_u32 v240, v241, 4, v240
  v_add_u32 v16, s4, v240
  v_xor_b32 v17, 64, v16
  v_and_b32 v240, 15, v1
  v_lshlrev_b32 v240, 7, v240
  v_lshrrev_b32 v241, 4, v1
  v_and_b32 v242, 6, v1
  v_xor_b32 v241, v241, v242
  v_lshl_add_u32 v240, v241, 4, v240
  v_add_u32 v18, 32768, v240
  v_xor_b32 v19, 64, v18
  v_lshrrev_b32 v240, 2, v1
  v_and_b32 v241, 6, v240
  v_lshlrev_b32 v240, 7, v240
  v_and_b32 v242, 1, v1
  v_lshl_add_u32 v240, v242, 3, v240
  v_add_u32 v240, 104448, v240
  v_bfe_u32 v242, v1, 1, 1
  v_xor_b32 v241, v241, v242
  v_xor_b32 v242, 0, v241
  v_lshl_add_u32 v20, v242, 4, v240
  v_xor_b32 v242, 2, v241
  s_add_u32 m0, s36, 34816
  s_nop 0
  buffer_load_dwordx4 v224, s[8:11], s46 offen offset:0 lds
  v_lshl_add_u32 v21, v242, 4, v240
  s_and_b32 s4, s3, 1
  s_lshl_b32 s4, s4, 6
  v_xor_b32 v20, s4, v20
  v_xor_b32 v21, s4, v21
  s_and_b32 s24, s2, 7
  s_lshr_b32 s4, s2, 6
  s_lshl_b32 s4, s4, 3
  s_add_u32 s24, s24, s4
  s_lshr_b32 s25, s2, 3
  s_and_b32 s25, s25, 7
  v_lshrrev_b32 v24, 3, v1
  v_and_b32 v25, 6, v24
  v_and_b32 v26, 7, v1
  v_xor_b32 v25, v25, v26
  v_lshlrev_b32 v25, 4, v25
  s_and_b32 s4, s3, 1
  s_lshl_b32 s4, s4, 16
  s_lshr_b32 s5, s3, 1
  s_lshl_b32 s5, s5, 7
  s_add_u32 s4, s4, s5
  v_lshl_add_u32 v24, v24, 11, v25
  v_add_u32 v24, s4, v24
  buffer_load_dwordx4 v225, s[8:11], s46 offen offset:1024 lds
  v_add_u32 v25, 0, v24
  v_accvgpr_write_b32 a212, v25
  v_add_u32 v25, 15360, v24
  v_accvgpr_write_b32 a213, v25
  v_add_u32 v25, 30720, v24
  v_accvgpr_write_b32 a214, v25
  v_add_u32 v25, 46080, v24
  v_accvgpr_write_b32 a215, v25
  buffer_load_dwordx4 v226, s[8:11], s46 offen offset:2048 lds
  v_accvgpr_write_b32 a236, 0
  v_mov_b32 v27, 0x3f803f80
  v_accvgpr_write_b32 a208, v27
  v_accvgpr_write_b32 a237, 0
  v_accvgpr_write_b32 a209, v27
  v_accvgpr_write_b32 a238, 0
  v_accvgpr_write_b32 a210, v27
  buffer_load_dwordx4 v227, s[8:11], s46 offen offset:3072 lds
  v_accvgpr_write_b32 a239, 0
  v_accvgpr_write_b32 a211, v27
  v_lshrrev_b32 v24, 3, v1
  v_and_b32 v25, 6, v24
  v_and_b32 v26, 7, v1
  v_xor_b32 v25, v25, v26
  v_lshlrev_b32 v25, 4, v25
  v_lshlrev_b32 v26, 2, v24
  s_add_u32 m0, s36, 38912
  s_nop 0
  buffer_load_dwordx4 v228, s[8:11], s46 offen offset:0 lds
  v_add_u32 v26, s3, v26
  v_lshl_add_u32 v26, v26, 11, v25
  v_add_u32 v27, 0, v26
  v_accvgpr_write_b32 a222, v27
  v_add_u32 v27, 64512, v26
  v_accvgpr_write_b32 a223, v27
  v_add_u32 v27, 129024, v26
  buffer_load_dwordx4 v229, s[8:11], s46 offen offset:1024 lds
  v_accvgpr_write_b32 a224, v27
  v_add_u32 v27, 193536, v26
  v_accvgpr_write_b32 a225, v27
  v_lshrrev_b32 v26, 2, v24
  v_and_b32 v27, 3, v24
  v_lshl_add_u32 v26, v26, 3, v27
  s_and_b32 s4, s3, 1
  s_lshl_b32 s4, s4, 18
  s_lshr_b32 s5, s3, 1
  s_lshl_b32 s5, s5, 7
  s_add_u32 s4, s4, s5
  s_lshl_b32 s5, s24, 8
  s_add_u32 s4, s4, s5
  v_lshl_add_u32 v26, v26, 13, v25
  v_add_u32 v26, s4, v26
  v_add_u32 v27, 0, v26
  buffer_load_dwordx4 v230, s[8:11], s46 offen offset:2048 lds
  v_accvgpr_write_b32 a226, v27
  v_add_u32 v27, 130048, v26
  v_accvgpr_write_b32 a227, v27
  v_add_u32 v27, 30720, v26
  v_accvgpr_write_b32 a228, v27
  v_add_u32 v27, 160768, v26
  v_accvgpr_write_b32 a229, v27
  s_lshl_b32 s4, s3, 13
  s_add_u32 s4, s4, 98304
  v_and_b32 v24, 15, v1
  buffer_load_dwordx4 v231, s[8:11], s46 offen offset:3072 lds
  v_lshlrev_b32 v24, 7, v24
  v_lshrrev_b32 v25, 4, v1
  v_and_b32 v26, 6, v1
  v_xor_b32 v25, v25, v26
  v_lshl_add_u32 v24, v25, 4, v24
  v_add_u32 v28, s4, v24
  v_xor_b32 v29, 64, v28
  v_lshrrev_b32 v24, 2, v1
  s_mul_i32 s47, s48, 393216
  s_bfe_u32 s34, 0x302010e, s49
  s_add_u32 s48, s48, s34
  s_add_u32 s49, s49, 8
  s_and_b32 s49, s49, 0x8001f
  s_and_b32 s48, s48, 15
  s_lshl_b32 s46, s48, 7
  s_add_u32 m0, s41, 24576
  s_nop 0
  buffer_load_dwordx4 v233, s[12:15], s47 offen offset:0 lds
  v_and_b32 v25, 6, v24
  v_lshlrev_b32 v24, 7, v24
  v_and_b32 v26, 1, v1
  v_lshl_add_u32 v24, v26, 3, v24
  v_add_u32 v24, 0, v24
  v_bfe_u32 v26, v1, 1, 1
  v_xor_b32 v25, v25, v26
  buffer_load_dwordx4 v234, s[12:15], s47 offen offset:1024 lds
  v_xor_b32 v26, 0, v25
  v_lshl_add_u32 v30, v26, 4, v24
  v_xor_b32 v26, 2, v25
  v_lshl_add_u32 v31, v26, 4, v24
  v_xor_b32 v26, 4, v25
  v_lshl_add_u32 v32, v26, 4, v24
  v_xor_b32 v26, 6, v25
  v_lshl_add_u32 v33, v26, 4, v24
  buffer_load_dwordx4 v235, s[12:15], s47 offen offset:2048 lds
  v_accvgpr_write_b32 a230, v28
  v_accvgpr_write_b32 a231, v29
  v_accvgpr_write_b32 a232, v30
  v_accvgpr_write_b32 a233, v31
  v_accvgpr_write_b32 a234, v32
  v_accvgpr_write_b32 a235, v33
  v_and_b32 v253, 15, v1
  s_add_u32 m0, s41, 27648
  s_nop 0
  buffer_load_dwordx4 v236, s[12:15], s47 offen offset:0 lds
  v_lshrrev_b32 v254, 4, v1
  v_lshlrev_b32 v254, 2, v254
  v_sub_u32 v253, v253, v254
  v_mov_b32 v254, 0xf149f2ca
  s_lshr_b32 s4, s3, 1
  s_or_b32 s4, s4, s32
  s_cselect_b64 s[6:7], 0, -1
  v_subrev_u32 v255, 0, v253
  v_and_b32 v252, 0x80000001, v255
  v_cmp_ne_u32 vcc, 0, v252
  s_nop 1
  v_cndmask_b32 v244, 0, v254, vcc
  v_add_u32 v255, 1, v255
  v_and_b32 v252, 0x80000001, v255
  v_cmp_ne_u32 vcc, 0x80000001, v252
  s_nop 1
  v_cndmask_b32 v240, 0, v254, vcc
  v_cndmask_b32 v248, v240, v254, s[6:7]
  buffer_load_dwordx4 v237, s[12:15], s47 offen offset:1024 lds
  v_subrev_u32 v255, 1, v253
  v_and_b32 v252, 0x80000001, v255
  v_cmp_ne_u32 vcc, 0, v252
  s_nop 1
  v_cndmask_b32 v245, 0, v254, vcc
  v_add_u32 v255, 1, v255
  v_and_b32 v252, 0x80000001, v255
  v_cmp_ne_u32 vcc, 0x80000001, v252
  s_nop 1
  v_cndmask_b32 v241, 0, v254, vcc
  v_cndmask_b32 v249, v241, v254, s[6:7]
  v_subrev_u32 v255, 2, v253
  v_and_b32 v252, 0x80000001, v255
  v_cmp_ne_u32 vcc, 0, v252
  s_nop 1
  v_cndmask_b32 v246, 0, v254, vcc
  buffer_load_dwordx4 v238, s[12:15], s47 offen offset:2048 lds
  v_add_u32 v255, 1, v255
  v_and_b32 v252, 0x80000001, v255
  v_cmp_ne_u32 vcc, 0x80000001, v252
  s_nop 1
  v_cndmask_b32 v242, 0, v254, vcc
  v_cndmask_b32 v250, v242, v254, s[6:7]
  v_subrev_u32 v255, 3, v253
  v_and_b32 v252, 0x80000001, v255
  v_cmp_ne_u32 vcc, 0, v252
  s_nop 1
  v_cndmask_b32 v247, 0, v254, vcc
  v_add_u32 v255, 1, v255
  v_and_b32 v252, 0x80000001, v255
  v_cmp_ne_u32 vcc, 0x80000001, v252
  s_nop 1
  v_cndmask_b32 v243, 0, v254, vcc
  v_cndmask_b32 v251, v243, v254, s[6:7]
  s_and_b32 s4, s3, 1
  s_lshl_b32 s4, s4, 12
  s_add_u32 s4, s4, 49152
  v_add_u32 v252, s4, v2
  s_lshr_b32 s5, s3, 1
  s_lshl_b32 s5, s5, 11
  v_add_u32 v253, s5, v252
  s_add_u32 s16, s86, 83886080
  s_addc_u32 s17, s87, 0
  s_mov_b32 s18, 4194304
  s_mov_b32 s19, 0x00020000
  s_lshl_b32 s57, s32, 19
  s_lshl_b32 s5, s5, 7
  s_add_u32 s57, s57, s5
  s_lshl_b32 s4, s33, 14
  s_add_u32 s57, s57, s4
  s_and_b32 s4, s3, 1
  s_lshl_b32 s4, s4, 13
  s_add_u32 s57, s57, s4
  s_add_u32 s58, s57, 4096
  s_mov_b32 s37, 0
  s_mov_b32 s39, 4294897664
  s_mov_b32 s40, 34816
  s_mov_b32 s42, 0
  s_mov_b32 s44, 4294942720
  s_mov_b32 s45, 24576
  s_mov_b32 s43, s44
  s_mov_b32 s52, s72
  s_mov_b32 s53, s73
  s_mov_b32 s54, 4194304
  s_mov_b32 s55, 0x00020000
  s_add_u32 s56, s51, 8192
  s_waitcnt vmcnt(14)
  s_barrier
  ds_read_b128 a[0:3], v16 offset:0
  ds_read_b64_tr_b16 a[72:73], v20 offset:0
  ds_read_b64_tr_b16 a[74:75], v20 offset:2048
  ds_read_b128 a[4:7], v16 offset:2048
  ds_read_b128 a[8:11], v16 offset:4096
  ds_read_b128 a[12:15], v16 offset:6144
  ds_read_b128 a[16:19], v16 offset:8192
  ds_read_b128 a[20:23], v16 offset:10240
  ds_read_b128 a[24:27], v16 offset:12288
  ds_read_b128 a[28:31], v16 offset:14336
  ds_read_b64_tr_b16 a[76:77], v21 offset:0
  ds_read_b64_tr_b16 a[78:79], v21 offset:2048
  ds_read_b64_tr_b16 a[80:81], v20 offset:8192
  ds_read_b64_tr_b16 a[82:83], v20 offset:10240
  ds_read_b64_tr_b16 a[84:85], v21 offset:8192
  ds_read_b64_tr_b16 a[86:87], v21 offset:10240
  ds_read_b64_tr_b16 a[88:89], v20 offset:16384
  ds_read_b64_tr_b16 a[90:91], v20 offset:18432
  ds_read_b128 a[32:35], v18 offset:0
  ds_read_b64_tr_b16 a[92:93], v21 offset:16384
  ds_read_b64_tr_b16 a[94:95], v21 offset:18432
  s_waitcnt lgkmcnt(0)
  v_mfma_f32_16x16x32_bf16 v[24:27], a[72:75], a[0:3], 0
  s_add_u32 m0, s36, 69632
  ds_read_b128 a[36:39], v17 offset:0
  v_mfma_f32_16x16x32_bf16 v[28:31], a[72:75], a[4:7], 0
  buffer_load_dwordx4 v224, s[8:11], s46 offen offset:0 lds
  ds_read_b64_tr_b16 a[96:97], v20 offset:4096
  v_mfma_f32_16x16x32_bf16 v[32:35], a[72:75], a[8:11], 0
  v_mfma_f32_16x16x32_bf16 v[36:39], a[72:75], a[12:15], 0
  ds_read_b64_tr_b16 a[98:99], v20 offset:6144
  v_mfma_f32_16x16x32_bf16 v[40:43], a[72:75], a[16:19], 0
  v_mfma_f32_16x16x32_bf16 v[44:47], a[72:75], a[20:23], 0
  buffer_load_dwordx4 v225, s[8:11], s46 offen offset:1024 lds
  ds_read_b128 a[40:43], v17 offset:2048
  v_mfma_f32_16x16x32_bf16 v[48:51], a[72:75], a[24:27], 0
  v_mfma_f32_16x16x32_bf16 v[52:55], a[72:75], a[28:31], 0
  ds_read_b128 a[44:47], v17 offset:4096
  v_mfma_f32_16x16x32_bf16 v[56:59], a[76:79], a[0:3], 0
  v_mfma_f32_16x16x32_bf16 v[60:63], a[76:79], a[4:7], 0
  ds_read_b128 a[48:51], v17 offset:6144
  v_mfma_f32_16x16x32_bf16 v[64:67], a[76:79], a[8:11], 0
  buffer_load_dwordx4 v226, s[8:11], s46 offen offset:2048 lds
  v_mfma_f32_16x16x32_bf16 v[68:71], a[76:79], a[12:15], 0
  ds_read_b128 a[52:55], v17 offset:8192
  v_mfma_f32_16x16x32_bf16 v[72:75], a[76:79], a[16:19], 0
  v_mfma_f32_16x16x32_bf16 v[76:79], a[76:79], a[20:23], 0
  ds_read_b128 a[56:59], v17 offset:10240
  v_mfma_f32_16x16x32_bf16 v[80:83], a[76:79], a[24:27], 0
  v_mfma_f32_16x16x32_bf16 v[84:87], a[76:79], a[28:31], 0
  ds_read_b128 a[60:63], v17 offset:12288
  v_mfma_f32_16x16x32_bf16 v[88:91], a[80:83], a[0:3], 0
  buffer_load_dwordx4 v227, s[8:11], s46 offen offset:3072 lds
  v_mfma_f32_16x16x32_bf16 v[92:95], a[80:83], a[4:7], 0
  s_add_u32 m0, s36, 73728
  ds_read_b128 a[64:67], v17 offset:14336
  v_mfma_f32_16x16x32_bf16 v[96:99], a[80:83], a[8:11], 0
  v_mfma_f32_16x16x32_bf16 v[100:103], a[80:83], a[12:15], 0
  ds_read_b64_tr_b16 a[100:101], v21 offset:4096
  v_mfma_f32_16x16x32_bf16 v[104:107], a[80:83], a[16:19], 0
  ds_read_b64_tr_b16 a[102:103], v21 offset:6144
  v_mfma_f32_16x16x32_bf16 v[108:111], a[80:83], a[20:23], 0
  buffer_load_dwordx4 v228, s[8:11], s46 offen offset:0 lds
  v_mfma_f32_16x16x32_bf16 v[112:115], a[80:83], a[24:27], 0
  ds_read_b64_tr_b16 a[104:105], v20 offset:12288
  v_mfma_f32_16x16x32_bf16 v[116:119], a[80:83], a[28:31], 0
  v_mfma_f32_16x16x32_bf16 v[120:123], a[84:87], a[0:3], 0
  ds_read_b64_tr_b16 a[106:107], v20 offset:14336
  v_mfma_f32_16x16x32_bf16 v[124:127], a[84:87], a[4:7], 0
  v_mfma_f32_16x16x32_bf16 v[128:131], a[84:87], a[8:11], 0
  buffer_load_dwordx4 v229, s[8:11], s46 offen offset:1024 lds
  ds_read_b64_tr_b16 a[108:109], v21 offset:12288
  v_mfma_f32_16x16x32_bf16 v[132:135], a[84:87], a[12:15], 0
  v_mfma_f32_16x16x32_bf16 v[136:139], a[84:87], a[16:19], 0
  ds_read_b64_tr_b16 a[110:111], v21 offset:14336
  v_mfma_f32_16x16x32_bf16 v[140:143], a[84:87], a[20:23], 0
  v_mfma_f32_16x16x32_bf16 v[144:147], a[84:87], a[24:27], 0
  ds_read_b64_tr_b16 a[112:113], v20 offset:20480
  v_mfma_f32_16x16x32_bf16 v[148:151], a[84:87], a[28:31], 0
  v_mfma_f32_16x16x32_bf16 v[152:155], a[0:3], a[88:91], 0
  buffer_load_dwordx4 v230, s[8:11], s46 offen offset:2048 lds
  ds_read_b64_tr_b16 a[114:115], v20 offset:22528
  v_mfma_f32_16x16x32_bf16 v[156:159], a[4:7], a[88:91], 0
  v_mfma_f32_16x16x32_bf16 v[160:163], a[8:11], a[88:91], 0
  ds_read_b128 a[68:71], v19 offset:0
  v_mfma_f32_16x16x32_bf16 v[164:167], a[12:15], a[88:91], 0
  v_mfma_f32_16x16x32_bf16 v[168:171], a[16:19], a[88:91], 0
  ds_read_b64_tr_b16 a[116:117], v21 offset:20480
  v_mfma_f32_16x16x32_bf16 v[172:175], a[20:23], a[88:91], 0
  buffer_load_dwordx4 v231, s[8:11], s46 offen offset:3072 lds
  v_mfma_f32_16x16x32_bf16 v[176:179], a[24:27], a[88:91], 0
  s_mul_i32 s47, s48, 393216
  s_bfe_u32 s34, 0x302010e, s49
  s_add_u32 s48, s48, s34
  v_mfma_f32_16x16x32_bf16 v[180:183], a[28:31], a[88:91], 0
  s_add_u32 s49, s49, 8
  s_and_b32 s49, s49, 0x8001f
  s_and_b32 s48, s48, 15
  v_mfma_f32_16x16x32_bf16 v[216:219], a[32:35], a[88:91], 0
  s_lshl_b32 s46, s48, 7
  ds_read_b64_tr_b16 a[118:119], v21 offset:22528
  v_mfma_f32_16x16x32_bf16 v[184:187], a[0:3], a[92:95], 0
  s_add_u32 s37, s37, 1
  s_cmp_eq_u32 s37, 3
  s_cselect_b32 s37, 0, s37
  s_cselect_b32 s38, s39, s40
  v_mfma_f32_16x16x32_bf16 v[188:191], a[4:7], a[92:95], 0
  s_sub_u32 s43, 0, s43
  v_mfma_f32_16x16x32_bf16 v[192:195], a[8:11], a[92:95], 0
  v_add_u32 v16, s38, v16
  v_add_u32 v17, s38, v17
  v_mfma_f32_16x16x32_bf16 v[196:199], a[12:15], a[92:95], 0
  v_add_u32 v18, s38, v18
  v_add_u32 v19, s38, v19
  v_mfma_f32_16x16x32_bf16 v[200:203], a[16:19], a[92:95], 0
  v_add_u32 v20, s43, v20
  v_add_u32 v21, s43, v21
  v_mfma_f32_16x16x32_bf16 v[204:207], a[20:23], a[92:95], 0
  v_mfma_f32_16x16x32_bf16 v[208:211], a[24:27], a[92:95], 0
  v_mfma_f32_16x16x32_bf16 v[212:215], a[28:31], a[92:95], 0
  v_mfma_f32_16x16x32_bf16 v[220:223], a[32:35], a[92:95], 0
  s_mov_b32 s35, 13
  s_waitcnt vmcnt(8) lgkmcnt(0)
  s_barrier
  .p2align 6
Lp2r1_loop:
  v_mfma_f32_16x16x32_bf16 v[24:27], a[96:99], a[36:39], v[24:27]
  buffer_load_dwordx4 a[192:195], v2, s[52:55], s51 offen
  ds_read_b128 a[0:3], v16 offset:0
  v_mfma_f32_16x16x32_bf16 v[28:31], a[96:99], a[40:43], v[28:31]
  s_add_u32 s51, s51, 1024
  s_cmp_eq_u32 s51, s56
  s_cselect_b32 s54, 0, s54
  v_mfma_f32_16x16x32_bf16 v[32:35], a[96:99], a[44:47], v[32:35]
  ds_read_b64_tr_b16 a[72:73], v20 offset:0
  v_mfma_f32_16x16x32_bf16 v[36:39], a[96:99], a[48:51], v[36:39]
  ds_read_b64_tr_b16 a[74:75], v20 offset:2048
  v_mfma_f32_16x16x32_bf16 v[40:43], a[96:99], a[52:55], v[40:43]
  v_mfma_f32_16x16x32_bf16 v[44:47], a[96:99], a[56:59], v[44:47]
  buffer_load_dwordx4 a[192:195], v2, s[52:55], s51 offen
  ds_read_b128 a[4:7], v16 offset:2048
  v_mfma_f32_16x16x32_bf16 v[48:51], a[96:99], a[60:63], v[48:51]
  s_add_u32 s51, s51, 1024
  s_cmp_eq_u32 s51, s56
  s_cselect_b32 s54, 0, s54
  v_mfma_f32_16x16x32_bf16 v[52:55], a[96:99], a[64:67], v[52:55]
  ds_read_b128 a[8:11], v16 offset:4096
  v_mfma_f32_16x16x32_bf16 v[56:59], a[100:103], a[36:39], v[56:59]
  v_mfma_f32_16x16x32_bf16 v[60:63], a[100:103], a[40:43], v[60:63]
  ds_read_b128 a[12:15], v16 offset:6144
  v_mfma_f32_16x16x32_bf16 v[64:67], a[100:103], a[44:47], v[64:67]
  buffer_load_dwordx4 a[192:195], v2, s[52:55], s51 offen
  v_mfma_f32_16x16x32_bf16 v[68:71], a[100:103], a[48:51], v[68:71]
  s_add_u32 s51, s51, 1024
  s_cmp_eq_u32 s51, s56
  s_cselect_b32 s54, 0, s54
  v_mfma_f32_16x16x32_bf16 v[72:75], a[100:103], a[52:55], v[72:75]
  ds_read_b128 a[16:19], v16 offset:8192
  v_mfma_f32_16x16x32_bf16 v[76:79], a[100:103], a[56:59], v[76:79]
  ds_read_b128 a[20:23], v16 offset:10240
  v_mfma_f32_16x16x32_bf16 v[80:83], a[100:103], a[60:63], v[80:83]
  v_mfma_f32_16x16x32_bf16 v[84:87], a[100:103], a[64:67], v[84:87]
  ds_read_b128 a[24:27], v16 offset:12288
  v_mfma_f32_16x16x32_bf16 v[88:91], a[104:107], a[36:39], v[88:91]
  buffer_load_dwordx4 a[192:195], v2, s[52:55], s51 offen
  v_mfma_f32_16x16x32_bf16 v[92:95], a[104:107], a[40:43], v[92:95]
  s_add_u32 s51, s51, 1024
  s_cmp_eq_u32 s51, s56
  s_cselect_b32 s54, 0, s54
  v_mfma_f32_16x16x32_bf16 v[96:99], a[104:107], a[44:47], v[96:99]
  s_mov_b32 m0, s41
  ds_read_b128 a[28:31], v16 offset:14336
  v_mfma_f32_16x16x32_bf16 v[100:103], a[104:107], a[48:51], v[100:103]
  ds_read_b64_tr_b16 a[76:77], v21 offset:0
  v_mfma_f32_16x16x32_bf16 v[104:107], a[104:107], a[52:55], v[104:107]
  ds_read_b64_tr_b16 a[78:79], v21 offset:2048
  v_mfma_f32_16x16x32_bf16 v[108:111], a[104:107], a[56:59], v[108:111]
  buffer_load_dwordx4 v233, s[12:15], s47 offen offset:0 lds
  v_mfma_f32_16x16x32_bf16 v[112:115], a[104:107], a[60:63], v[112:115]
  ds_read_b64_tr_b16 a[80:81], v20 offset:8192
  v_mfma_f32_16x16x32_bf16 v[116:119], a[104:107], a[64:67], v[116:119]
  v_mfma_f32_16x16x32_bf16 v[120:123], a[108:111], a[36:39], v[120:123]
  ds_read_b64_tr_b16 a[82:83], v20 offset:10240
  v_mfma_f32_16x16x32_bf16 v[124:127], a[108:111], a[40:43], v[124:127]
  v_mfma_f32_16x16x32_bf16 v[128:131], a[108:111], a[44:47], v[128:131]
  ds_read_b64_tr_b16 a[84:85], v21 offset:8192
  v_mfma_f32_16x16x32_bf16 v[132:135], a[108:111], a[48:51], v[132:135]
  buffer_load_dwordx4 v234, s[12:15], s47 offen offset:1024 lds
  v_mfma_f32_16x16x32_bf16 v[136:139], a[108:111], a[52:55], v[136:139]
  ds_read_b64_tr_b16 a[86:87], v21 offset:10240
  v_mfma_f32_16x16x32_bf16 v[140:143], a[108:111], a[56:59], v[140:143]
  v_mfma_f32_16x16x32_bf16 v[144:147], a[108:111], a[60:63], v[144:147]
  ds_read_b64_tr_b16 a[88:89], v20 offset:16384
  v_mfma_f32_16x16x32_bf16 v[148:151], a[108:111], a[64:67], v[148:151]
  v_mfma_f32_16x16x32_bf16 v[152:155], a[36:39], a[112:115], v[152:155]
  buffer_load_dwordx4 v235, s[12:15], s47 offen offset:2048 lds
  ds_read_b64_tr_b16 a[90:91], v20 offset:18432
  v_mfma_f32_16x16x32_bf16 v[156:159], a[40:43], a[112:115], v[156:159]
  s_add_u32 m0, s41, 3072
  v_mfma_f32_16x16x32_bf16 v[160:163], a[44:47], a[112:115], v[160:163]
  ds_read_b128 a[32:35], v18 offset:0
  v_mfma_f32_16x16x32_bf16 v[164:167], a[48:51], a[112:115], v[164:167]
  v_mfma_f32_16x16x32_bf16 v[168:171], a[52:55], a[112:115], v[168:171]
  ds_read_b64_tr_b16 a[92:93], v21 offset:16384
  v_mfma_f32_16x16x32_bf16 v[172:175], a[56:59], a[112:115], v[172:175]
  v_mfma_f32_16x16x32_bf16 v[176:179], a[60:63], a[112:115], v[176:179]
  buffer_load_dwordx4 v236, s[12:15], s47 offen offset:0 lds
  ds_read_b64_tr_b16 a[94:95], v21 offset:18432
  v_mfma_f32_16x16x32_bf16 v[180:183], a[64:67], a[112:115], v[180:183]
  v_mfma_f32_16x16x32_bf16 v[216:219], a[68:71], a[112:115], v[216:219]
  v_mfma_f32_16x16x32_bf16 v[184:187], a[36:39], a[116:119], v[184:187]
  v_mfma_f32_16x16x32_bf16 v[188:191], a[40:43], a[116:119], v[188:191]
  v_mfma_f32_16x16x32_bf16 v[192:195], a[44:47], a[116:119], v[192:195]
  buffer_load_dwordx4 v237, s[12:15], s47 offen offset:1024 lds
  v_mfma_f32_16x16x32_bf16 v[196:199], a[48:51], a[116:119], v[196:199]
  v_mfma_f32_16x16x32_bf16 v[200:203], a[52:55], a[116:119], v[200:203]
  v_mfma_f32_16x16x32_bf16 v[204:207], a[56:59], a[116:119], v[204:207]
  v_mfma_f32_16x16x32_bf16 v[208:211], a[60:63], a[116:119], v[208:211]
  v_mfma_f32_16x16x32_bf16 v[212:215], a[64:67], a[116:119], v[212:215]
  v_mfma_f32_16x16x32_bf16 v[220:223], a[68:71], a[116:119], v[220:223]
  s_waitcnt lgkmcnt(0)
  v_mfma_f32_16x16x32_bf16 v[24:27], a[72:75], a[0:3], v[24:27]
  buffer_load_dwordx4 v238, s[12:15], s47 offen offset:2048 lds
  ds_read_b128 a[36:39], v17 offset:0
  v_mfma_f32_16x16x32_bf16 v[28:31], a[72:75], a[4:7], v[28:31]
  s_mov_b32 m0, s36
  ds_read_b64_tr_b16 a[96:97], v20 offset:4096
  v_mfma_f32_16x16x32_bf16 v[32:35], a[72:75], a[8:11], v[32:35]
  v_mfma_f32_16x16x32_bf16 v[36:39], a[72:75], a[12:15], v[36:39]
  ds_read_b64_tr_b16 a[98:99], v20 offset:6144
  v_mfma_f32_16x16x32_bf16 v[40:43], a[72:75], a[16:19], v[40:43]
  buffer_load_dwordx4 v224, s[8:11], s46 offen offset:0 lds
  v_mfma_f32_16x16x32_bf16 v[44:47], a[72:75], a[20:23], v[44:47]
  ds_read_b128 a[40:43], v17 offset:2048
  v_mfma_f32_16x16x32_bf16 v[48:51], a[72:75], a[24:27], v[48:51]
  v_mfma_f32_16x16x32_bf16 v[52:55], a[72:75], a[28:31], v[52:55]
  ds_read_b128 a[44:47], v17 offset:4096
  v_mfma_f32_16x16x32_bf16 v[56:59], a[76:79], a[0:3], v[56:59]
  v_mfma_f32_16x16x32_bf16 v[60:63], a[76:79], a[4:7], v[60:63]
  buffer_load_dwordx4 v225, s[8:11], s46 offen offset:1024 lds
  ds_read_b128 a[48:51], v17 offset:6144
  v_mfma_f32_16x16x32_bf16 v[64:67], a[76:79], a[8:11], v[64:67]
  v_mfma_f32_16x16x32_bf16 v[68:71], a[76:79], a[12:15], v[68:71]
  ds_read_b128 a[52:55], v17 offset:8192
  v_mfma_f32_16x16x32_bf16 v[72:75], a[76:79], a[16:19], v[72:75]
  v_mfma_f32_16x16x32_bf16 v[76:79], a[76:79], a[20:23], v[76:79]
  ds_read_b128 a[56:59], v17 offset:10240
  v_mfma_f32_16x16x32_bf16 v[80:83], a[76:79], a[24:27], v[80:83]
  buffer_load_dwordx4 v226, s[8:11], s46 offen offset:2048 lds
  v_mfma_f32_16x16x32_bf16 v[84:87], a[76:79], a[28:31], v[84:87]
  ds_read_b128 a[60:63], v17 offset:12288
  v_mfma_f32_16x16x32_bf16 v[88:91], a[80:83], a[0:3], v[88:91]
  v_mfma_f32_16x16x32_bf16 v[92:95], a[80:83], a[4:7], v[92:95]
  ds_read_b128 a[64:67], v17 offset:14336
  v_mfma_f32_16x16x32_bf16 v[96:99], a[80:83], a[8:11], v[96:99]
  v_mfma_f32_16x16x32_bf16 v[100:103], a[80:83], a[12:15], v[100:103]
  buffer_load_dwordx4 v227, s[8:11], s46 offen offset:3072 lds
  ds_read_b64_tr_b16 a[100:101], v21 offset:4096
  v_mfma_f32_16x16x32_bf16 v[104:107], a[80:83], a[16:19], v[104:107]
  s_add_u32 m0, s36, 4096
  ds_read_b64_tr_b16 a[102:103], v21 offset:6144
  v_mfma_f32_16x16x32_bf16 v[108:111], a[80:83], a[20:23], v[108:111]
  v_mfma_f32_16x16x32_bf16 v[112:115], a[80:83], a[24:27], v[112:115]
  ds_read_b64_tr_b16 a[104:105], v20 offset:12288
  v_mfma_f32_16x16x32_bf16 v[116:119], a[80:83], a[28:31], v[116:119]
  buffer_load_dwordx4 v228, s[8:11], s46 offen offset:0 lds
  v_mfma_f32_16x16x32_bf16 v[120:123], a[84:87], a[0:3], v[120:123]
  ds_read_b64_tr_b16 a[106:107], v20 offset:14336
  v_mfma_f32_16x16x32_bf16 v[124:127], a[84:87], a[4:7], v[124:127]
  v_mfma_f32_16x16x32_bf16 v[128:131], a[84:87], a[8:11], v[128:131]
  ds_read_b64_tr_b16 a[108:109], v21 offset:12288
  v_mfma_f32_16x16x32_bf16 v[132:135], a[84:87], a[12:15], v[132:135]
  v_mfma_f32_16x16x32_bf16 v[136:139], a[84:87], a[16:19], v[136:139]
  buffer_load_dwordx4 v229, s[8:11], s46 offen offset:1024 lds
  ds_read_b64_tr_b16 a[110:111], v21 offset:14336
  v_mfma_f32_16x16x32_bf16 v[140:143], a[84:87], a[20:23], v[140:143]
  v_mfma_f32_16x16x32_bf16 v[144:147], a[84:87], a[24:27], v[144:147]
  ds_read_b64_tr_b16 a[112:113], v20 offset:20480
  v_mfma_f32_16x16x32_bf16 v[148:151], a[84:87], a[28:31], v[148:151]
  v_mfma_f32_16x16x32_bf16 v[152:155], a[0:3], a[88:91], v[152:155]
  ds_read_b64_tr_b16 a[114:115], v20 offset:22528
  v_mfma_f32_16x16x32_bf16 v[156:159], a[4:7], a[88:91], v[156:159]
  buffer_load_dwordx4 v230, s[8:11], s46 offen offset:2048 lds
  v_mfma_f32_16x16x32_bf16 v[160:163], a[8:11], a[88:91], v[160:163]
  ds_read_b128 a[68:71], v19 offset:0
  v_mfma_f32_16x16x32_bf16 v[164:167], a[12:15], a[88:91], v[164:167]
  v_mfma_f32_16x16x32_bf16 v[168:171], a[16:19], a[88:91], v[168:171]
  ds_read_b64_tr_b16 a[116:117], v21 offset:20480
  v_mfma_f32_16x16x32_bf16 v[172:175], a[20:23], a[88:91], v[172:175]
  v_mfma_f32_16x16x32_bf16 v[176:179], a[24:27], a[88:91], v[176:179]
  buffer_load_dwordx4 v231, s[8:11], s46 offen offset:3072 lds
  ds_read_b64_tr_b16 a[118:119], v21 offset:22528
  v_mfma_f32_16x16x32_bf16 v[180:183], a[28:31], a[88:91], v[180:183]
  s_mul_i32 s47, s48, 393216
  s_bfe_u32 s34, 0x302010e, s49
  s_add_u32 s48, s48, s34
  v_mfma_f32_16x16x32_bf16 v[216:219], a[32:35], a[88:91], v[216:219]
  s_add_u32 s49, s49, 8
  s_and_b32 s49, s49, 0x8001f
  s_and_b32 s48, s48, 15
  v_mfma_f32_16x16x32_bf16 v[184:187], a[0:3], a[92:95], v[184:187]
  s_lshl_b32 s46, s48, 7
  v_mfma_f32_16x16x32_bf16 v[188:191], a[4:7], a[92:95], v[188:191]
  s_add_u32 s36, s36, s38
  s_add_u32 s37, s37, 1
  s_cmp_eq_u32 s37, 3
  s_cselect_b32 s37, 0, s37
  s_cselect_b32 s38, s39, s40
  v_mfma_f32_16x16x32_bf16 v[192:195], a[8:11], a[92:95], v[192:195]
  s_add_u32 s41, s41, s43
  s_sub_u32 s43, 0, s43
  v_mfma_f32_16x16x32_bf16 v[196:199], a[12:15], a[92:95], v[196:199]
  v_add_u32 v16, s38, v16
  v_add_u32 v17, s38, v17
  v_mfma_f32_16x16x32_bf16 v[200:203], a[16:19], a[92:95], v[200:203]
  v_add_u32 v18, s38, v18
  v_add_u32 v19, s38, v19
  v_mfma_f32_16x16x32_bf16 v[204:207], a[20:23], a[92:95], v[204:207]
  v_add_u32 v20, s43, v20
  v_add_u32 v21, s43, v21
  v_mfma_f32_16x16x32_bf16 v[208:211], a[24:27], a[92:95], v[208:211]
  s_waitcnt vmcnt(8) lgkmcnt(0)
  s_barrier
  v_mfma_f32_16x16x32_bf16 v[212:215], a[28:31], a[92:95], v[212:215]
  s_sub_u32 s35, s35, 1
  v_mfma_f32_16x16x32_bf16 v[220:223], a[32:35], a[92:95], v[220:223]
  s_cmp_lg_u32 s35, 0
  s_cbranch_scc1 Lp2r1_loop
  v_accvgpr_read_b32 v4, a222
  v_accvgpr_read_b32 v5, a223
  v_accvgpr_read_b32 v6, a224
  v_accvgpr_read_b32 v7, a225
  v_accvgpr_read_b32 v8, a226
  v_accvgpr_read_b32 v9, a227
  v_accvgpr_read_b32 v10, a228
  v_accvgpr_read_b32 v11, a229
  s_mov_b32 s8, s64
  s_mov_b32 s9, s65
  s_mov_b32 s10, 4194304
  s_mov_b32 s11, 0x00020000
  s_mov_b32 s20, s68
  s_mov_b32 s21, s69
  s_mov_b32 s22, 8388608
  s_mov_b32 s23, 0x00020000
  s_and_b32 s4, s2, 7
  s_lshl_b32 s4, s4, 1
  s_lshr_b32 s5, s2, 6
  s_add_u32 s5, s5, s25
  s_and_b32 s53, s5, 3
  s_lshl_b32 s53, s53, 3
  s_or_b32 s53, s53, 0x80000
  s_bfe_u32 s52, 0xf0f02, s53
  s_add_u32 s52, s52, s4
  s_and_b32 s52, s52, 15
  s_mov_b32 s54, s52
  s_mov_b32 s55, s53
  s_lshl_b32 s29, s52, 7
  s_lshl_b32 s28, s54, 19
  s_lshl_b32 s30, s25, 18
  s_sub_u32 s31, 3932160, s30
  s_or_b32 s26, s30, s29
  s_or_b32 s27, s31, s29
  s_lshl_b32 s68, s3, 12
  s_lshl_b32 s88, s3, 13
  s_add_u32 s88, s88, 98304
  v_mfma_f32_16x16x32_bf16 v[24:27], a[96:99], a[36:39], v[24:27]
  s_mov_b32 m0, s41
  ds_read_b128 a[0:3], v16 offset:0
  v_mfma_f32_16x16x32_bf16 v[28:31], a[96:99], a[40:43], v[28:31]
  buffer_load_dwordx4 v233, s[12:15], s47 offen offset:0 lds
  ds_read_b64_tr_b16 a[72:73], v20 offset:0
  v_mfma_f32_16x16x32_bf16 v[32:35], a[96:99], a[44:47], v[32:35]
  v_mfma_f32_16x16x32_bf16 v[36:39], a[96:99], a[48:51], v[36:39]
  ds_read_b64_tr_b16 a[74:75], v20 offset:2048
  v_mfma_f32_16x16x32_bf16 v[40:43], a[96:99], a[52:55], v[40:43]
  v_mfma_f32_16x16x32_bf16 v[44:47], a[96:99], a[56:59], v[44:47]
  ds_read_b128 a[4:7], v16 offset:2048
  v_mfma_f32_16x16x32_bf16 v[48:51], a[96:99], a[60:63], v[48:51]
  v_mfma_f32_16x16x32_bf16 v[52:55], a[96:99], a[64:67], v[52:55]
  ds_read_b128 a[8:11], v16 offset:4096
  v_mfma_f32_16x16x32_bf16 v[56:59], a[100:103], a[36:39], v[56:59]
  v_mfma_f32_16x16x32_bf16 v[60:63], a[100:103], a[40:43], v[60:63]
  ds_read_b128 a[12:15], v16 offset:6144
  v_mfma_f32_16x16x32_bf16 v[64:67], a[100:103], a[44:47], v[64:67]
  v_mfma_f32_16x16x32_bf16 v[68:71], a[100:103], a[48:51], v[68:71]
  ds_read_b128 a[16:19], v16 offset:8192
  v_mfma_f32_16x16x32_bf16 v[72:75], a[100:103], a[52:55], v[72:75]
  v_mfma_f32_16x16x32_bf16 v[76:79], a[100:103], a[56:59], v[76:79]
  ds_read_b128 a[20:23], v16 offset:10240
  v_mfma_f32_16x16x32_bf16 v[80:83], a[100:103], a[60:63], v[80:83]
  v_mfma_f32_16x16x32_bf16 v[84:87], a[100:103], a[64:67], v[84:87]
  ds_read_b128 a[24:27], v16 offset:12288
  v_mfma_f32_16x16x32_bf16 v[88:91], a[104:107], a[36:39], v[88:91]
  buffer_load_dwordx4 v234, s[12:15], s47 offen offset:1024 lds
  v_mfma_f32_16x16x32_bf16 v[92:95], a[104:107], a[40:43], v[92:95]
  ds_read_b128 a[28:31], v16 offset:14336
  v_mfma_f32_16x16x32_bf16 v[96:99], a[104:107], a[44:47], v[96:99]
  v_mfma_f32_16x16x32_bf16 v[100:103], a[104:107], a[48:51], v[100:103]
  ds_read_b64_tr_b16 a[76:77], v21 offset:0
  v_mfma_f32_16x16x32_bf16 v[104:107], a[104:107], a[52:55], v[104:107]
  ds_read_b64_tr_b16 a[78:79], v21 offset:2048
  v_mfma_f32_16x16x32_bf16 v[108:111], a[104:107], a[56:59], v[108:111]
  v_mfma_f32_16x16x32_bf16 v[112:115], a[104:107], a[60:63], v[112:115]
  ds_read_b64_tr_b16 a[80:81], v20 offset:8192
  v_mfma_f32_16x16x32_bf16 v[116:119], a[104:107], a[64:67], v[116:119]
  v_mfma_f32_16x16x32_bf16 v[120:123], a[108:111], a[36:39], v[120:123]
  ds_read_b64_tr_b16 a[82:83], v20 offset:10240
  v_mfma_f32_16x16x32_bf16 v[124:127], a[108:111], a[40:43], v[124:127]
  v_mfma_f32_16x16x32_bf16 v[128:131], a[108:111], a[44:47], v[128:131]
  ds_read_b64_tr_b16 a[84:85], v21 offset:8192
  v_mfma_f32_16x16x32_bf16 v[132:135], a[108:111], a[48:51], v[132:135]
  v_mfma_f32_16x16x32_bf16 v[136:139], a[108:111], a[52:55], v[136:139]
  ds_read_b64_tr_b16 a[86:87], v21 offset:10240
  v_mfma_f32_16x16x32_bf16 v[140:143], a[108:111], a[56:59], v[140:143]
  v_mfma_f32_16x16x32_bf16 v[144:147], a[108:111], a[60:63], v[144:147]
  ds_read_b64_tr_b16 a[88:89], v20 offset:16384
  v_mfma_f32_16x16x32_bf16 v[148:151], a[108:111], a[64:67], v[148:151]
  v_mfma_f32_16x16x32_bf16 v[152:155], a[36:39], a[112:115], v[152:155]
  buffer_load_dwordx4 v235, s[12:15], s47 offen offset:2048 lds
  ds_read_b64_tr_b16 a[90:91], v20 offset:18432
  v_mfma_f32_16x16x32_bf16 v[156:159], a[40:43], a[112:115], v[156:159]
  v_mfma_f32_16x16x32_bf16 v[160:163], a[44:47], a[112:115], v[160:163]
  ds_read_b128 a[32:35], v18 offset:0
  v_mfma_f32_16x16x32_bf16 v[164:167], a[48:51], a[112:115], v[164:167]
  v_mfma_f32_16x16x32_bf16 v[168:171], a[52:55], a[112:115], v[168:171]
  ds_read_b64_tr_b16 a[92:93], v21 offset:16384
  v_mfma_f32_16x16x32_bf16 v[172:175], a[56:59], a[112:115], v[172:175]
  v_mfma_f32_16x16x32_bf16 v[176:179], a[60:63], a[112:115], v[176:179]
  ds_read_b64_tr_b16 a[94:95], v21 offset:18432
  v_mfma_f32_16x16x32_bf16 v[180:183], a[64:67], a[112:115], v[180:183]
  v_mfma_f32_16x16x32_bf16 v[216:219], a[68:71], a[112:115], v[216:219]
  v_mfma_f32_16x16x32_bf16 v[184:187], a[36:39], a[116:119], v[184:187]
  v_mfma_f32_16x16x32_bf16 v[188:191], a[40:43], a[116:119], v[188:191]
  v_mfma_f32_16x16x32_bf16 v[192:195], a[44:47], a[116:119], v[192:195]
  v_mfma_f32_16x16x32_bf16 v[196:199], a[48:51], a[116:119], v[196:199]
  v_mfma_f32_16x16x32_bf16 v[200:203], a[52:55], a[116:119], v[200:203]
  v_mfma_f32_16x16x32_bf16 v[204:207], a[56:59], a[116:119], v[204:207]
  v_mfma_f32_16x16x32_bf16 v[208:211], a[60:63], a[116:119], v[208:211]
  v_mfma_f32_16x16x32_bf16 v[212:215], a[64:67], a[116:119], v[212:215]
  v_mfma_f32_16x16x32_bf16 v[220:223], a[68:71], a[116:119], v[220:223]
  s_waitcnt lgkmcnt(0)
  v_mfma_f32_16x16x32_bf16 v[24:27], a[72:75], a[0:3], v[24:27]
  s_add_u32 m0, s41, 3072
  ds_read_b128 a[36:39], v17 offset:0
  v_mfma_f32_16x16x32_bf16 v[28:31], a[72:75], a[4:7], v[28:31]
  buffer_load_dwordx4 v236, s[12:15], s47 offen offset:0 lds
  ds_read_b64_tr_b16 a[96:97], v20 offset:4096
  v_mfma_f32_16x16x32_bf16 v[32:35], a[72:75], a[8:11], v[32:35]
  v_mfma_f32_16x16x32_bf16 v[36:39], a[72:75], a[12:15], v[36:39]
  ds_read_b64_tr_b16 a[98:99], v20 offset:6144
  v_mfma_f32_16x16x32_bf16 v[40:43], a[72:75], a[16:19], v[40:43]
  v_mfma_f32_16x16x32_bf16 v[44:47], a[72:75], a[20:23], v[44:47]
  ds_read_b128 a[40:43], v17 offset:2048
  v_mfma_f32_16x16x32_bf16 v[48:51], a[72:75], a[24:27], v[48:51]
  v_mfma_f32_16x16x32_bf16 v[52:55], a[72:75], a[28:31], v[52:55]
  ds_read_b128 a[44:47], v17 offset:4096
  v_mfma_f32_16x16x32_bf16 v[56:59], a[76:79], a[0:3], v[56:59]
  v_mfma_f32_16x16x32_bf16 v[60:63], a[76:79], a[4:7], v[60:63]
  ds_read_b128 a[48:51], v17 offset:6144
  v_mfma_f32_16x16x32_bf16 v[64:67], a[76:79], a[8:11], v[64:67]
  v_mfma_f32_16x16x32_bf16 v[68:71], a[76:79], a[12:15], v[68:71]
  ds_read_b128 a[52:55], v17 offset:8192
  v_mfma_f32_16x16x32_bf16 v[72:75], a[76:79], a[16:19], v[72:75]
  v_mfma_f32_16x16x32_bf16 v[76:79], a[76:79], a[20:23], v[76:79]
  ds_read_b128 a[56:59], v17 offset:10240
  v_mfma_f32_16x16x32_bf16 v[80:83], a[76:79], a[24:27], v[80:83]
  buffer_load_dwordx4 v237, s[12:15], s47 offen offset:1024 lds
  v_mfma_f32_16x16x32_bf16 v[84:87], a[76:79], a[28:31], v[84:87]
  ds_read_b128 a[60:63], v17 offset:12288
  v_mfma_f32_16x16x32_bf16 v[88:91], a[80:83], a[0:3], v[88:91]
  v_mfma_f32_16x16x32_bf16 v[92:95], a[80:83], a[4:7], v[92:95]
  ds_read_b128 a[64:67], v17 offset:14336
  v_mfma_f32_16x16x32_bf16 v[96:99], a[80:83], a[8:11], v[96:99]
  v_mfma_f32_16x16x32_bf16 v[100:103], a[80:83], a[12:15], v[100:103]
  ds_read_b64_tr_b16 a[100:101], v21 offset:4096
  v_mfma_f32_16x16x32_bf16 v[104:107], a[80:83], a[16:19], v[104:107]
  ds_read_b64_tr_b16 a[102:103], v21 offset:6144
  v_mfma_f32_16x16x32_bf16 v[108:111], a[80:83], a[20:23], v[108:111]
  v_mfma_f32_16x16x32_bf16 v[112:115], a[80:83], a[24:27], v[112:115]
  ds_read_b64_tr_b16 a[104:105], v20 offset:12288
  v_mfma_f32_16x16x32_bf16 v[116:119], a[80:83], a[28:31], v[116:119]
  v_mfma_f32_16x16x32_bf16 v[120:123], a[84:87], a[0:3], v[120:123]
  ds_read_b64_tr_b16 a[106:107], v20 offset:14336
  v_mfma_f32_16x16x32_bf16 v[124:127], a[84:87], a[4:7], v[124:127]
  v_mfma_f32_16x16x32_bf16 v[128:131], a[84:87], a[8:11], v[128:131]
  ds_read_b64_tr_b16 a[108:109], v21 offset:12288
  v_mfma_f32_16x16x32_bf16 v[132:135], a[84:87], a[12:15], v[132:135]
  v_mfma_f32_16x16x32_bf16 v[136:139], a[84:87], a[16:19], v[136:139]
  buffer_load_dwordx4 v238, s[12:15], s47 offen offset:2048 lds
  ds_read_b64_tr_b16 a[110:111], v21 offset:14336
  v_mfma_f32_16x16x32_bf16 v[140:143], a[84:87], a[20:23], v[140:143]
  s_add_u32 s36, s36, s38
  s_add_u32 s37, s37, 1
  s_cmp_eq_u32 s37, 3
  s_cselect_b32 s37, 0, s37
  s_cselect_b32 s38, s39, s40
  v_mfma_f32_16x16x32_bf16 v[144:147], a[84:87], a[24:27], v[144:147]
  s_add_u32 s41, s41, s43
  s_sub_u32 s43, 0, s43
  ds_read_b64_tr_b16 a[112:113], v20 offset:20480
  v_mfma_f32_16x16x32_bf16 v[148:151], a[84:87], a[28:31], v[148:151]
  v_mfma_f32_16x16x32_bf16 v[152:155], a[0:3], a[88:91], v[152:155]
  ds_read_b64_tr_b16 a[114:115], v20 offset:22528
  v_mfma_f32_16x16x32_bf16 v[156:159], a[4:7], a[88:91], v[156:159]
  v_mfma_f32_16x16x32_bf16 v[160:163], a[8:11], a[88:91], v[160:163]
  ds_read_b128 a[68:71], v19 offset:0
  v_mfma_f32_16x16x32_bf16 v[164:167], a[12:15], a[88:91], v[164:167]
  v_mfma_f32_16x16x32_bf16 v[168:171], a[16:19], a[88:91], v[168:171]
  ds_read_b64_tr_b16 a[116:117], v21 offset:20480
  v_mfma_f32_16x16x32_bf16 v[172:175], a[20:23], a[88:91], v[172:175]
  v_mfma_f32_16x16x32_bf16 v[176:179], a[24:27], a[88:91], v[176:179]
  ds_read_b64_tr_b16 a[118:119], v21 offset:22528
  v_mfma_f32_16x16x32_bf16 v[180:183], a[28:31], a[88:91], v[180:183]
  v_add_u32 v16, s38, v16
  v_add_u32 v17, s38, v17
  v_mfma_f32_16x16x32_bf16 v[216:219], a[32:35], a[88:91], v[216:219]
  v_add_u32 v18, s38, v18
  v_add_u32 v19, s38, v19
  v_mfma_f32_16x16x32_bf16 v[184:187], a[0:3], a[92:95], v[184:187]
  v_add_u32 v20, s43, v20
  v_add_u32 v21, s43, v21
  v_mfma_f32_16x16x32_bf16 v[188:191], a[4:7], a[92:95], v[188:191]
  v_mfma_f32_16x16x32_bf16 v[192:195], a[8:11], a[92:95], v[192:195]
  v_mfma_f32_16x16x32_bf16 v[196:199], a[12:15], a[92:95], v[196:199]
  v_mfma_f32_16x16x32_bf16 v[200:203], a[16:19], a[92:95], v[200:203]
  v_mfma_f32_16x16x32_bf16 v[204:207], a[20:23], a[92:95], v[204:207]
  v_mfma_f32_16x16x32_bf16 v[208:211], a[24:27], a[92:95], v[208:211]
  v_mfma_f32_16x16x32_bf16 v[212:215], a[28:31], a[92:95], v[212:215]
  v_mfma_f32_16x16x32_bf16 v[220:223], a[32:35], a[92:95], v[220:223]
  s_waitcnt vmcnt(0) lgkmcnt(0)
  s_barrier
  s_mov_b32 s6, 0x3e8293ee
  s_mov_b32 s7, s6
  v_mfma_f32_16x16x32_bf16 v[24:27], a[96:99], a[36:39], v[24:27]
  ds_read_b128 a[0:3], v16 offset:0
  v_mfma_f32_16x16x32_bf16 v[28:31], a[96:99], a[40:43], v[28:31]
  ds_read_b64_tr_b16 a[72:73], v20 offset:0
  v_mfma_f32_16x16x32_bf16 v[32:35], a[96:99], a[44:47], v[32:35]
  v_mfma_f32_16x16x32_bf16 v[36:39], a[96:99], a[48:51], v[36:39]
  ds_read_b64_tr_b16 a[74:75], v20 offset:2048
  v_mfma_f32_16x16x32_bf16 v[40:43], a[96:99], a[52:55], v[40:43]
  v_mfma_f32_16x16x32_bf16 v[44:47], a[96:99], a[56:59], v[44:47]
  ds_read_b128 a[4:7], v16 offset:2048
  v_mfma_f32_16x16x32_bf16 v[48:51], a[96:99], a[60:63], v[48:51]
  v_mfma_f32_16x16x32_bf16 v[52:55], a[96:99], a[64:67], v[52:55]
  ds_read_b128 a[8:11], v16 offset:4096
  v_mfma_f32_16x16x32_bf16 v[56:59], a[100:103], a[36:39], v[56:59]
  v_mfma_f32_16x16x32_bf16 v[60:63], a[100:103], a[40:43], v[60:63]
  ds_read_b128 a[12:15], v16 offset:6144
  v_mfma_f32_16x16x32_bf16 v[64:67], a[100:103], a[44:47], v[64:67]
  v_mfma_f32_16x16x32_bf16 v[68:71], a[100:103], a[48:51], v[68:71]
  ds_read_b128 a[16:19], v16 offset:8192
  v_mfma_f32_16x16x32_bf16 v[72:75], a[100:103], a[52:55], v[72:75]
  v_mfma_f32_16x16x32_bf16 v[76:79], a[100:103], a[56:59], v[76:79]
  ds_read_b128 a[20:23], v16 offset:10240
  v_mfma_f32_16x16x32_bf16 v[80:83], a[100:103], a[60:63], v[80:83]
  v_mfma_f32_16x16x32_bf16 v[84:87], a[100:103], a[64:67], v[84:87]
  ds_read_b128 a[24:27], v16 offset:12288
  v_mfma_f32_16x16x32_bf16 v[88:91], a[104:107], a[36:39], v[88:91]
  v_mfma_f32_16x16x32_bf16 v[92:95], a[104:107], a[40:43], v[92:95]
  ds_read_b128 a[28:31], v16 offset:14336
  v_mfma_f32_16x16x32_bf16 v[96:99], a[104:107], a[44:47], v[96:99]
  v_mfma_f32_16x16x32_bf16 v[100:103], a[104:107], a[48:51], v[100:103]
  ds_read_b64_tr_b16 a[76:77], v21 offset:0
  v_mfma_f32_16x16x32_bf16 v[104:107], a[104:107], a[52:55], v[104:107]
  ds_read_b64_tr_b16 a[78:79], v21 offset:2048
  v_mfma_f32_16x16x32_bf16 v[108:111], a[104:107], a[56:59], v[108:111]
  v_mfma_f32_16x16x32_bf16 v[112:115], a[104:107], a[60:63], v[112:115]
  ds_read_b64_tr_b16 a[80:81], v20 offset:8192
  v_mfma_f32_16x16x32_bf16 v[116:119], a[104:107], a[64:67], v[116:119]
  v_mfma_f32_16x16x32_bf16 v[120:123], a[108:111], a[36:39], v[120:123]
  ds_read_b64_tr_b16 a[82:83], v20 offset:10240
  v_mfma_f32_16x16x32_bf16 v[124:127], a[108:111], a[40:43], v[124:127]
  v_mfma_f32_16x16x32_bf16 v[128:131], a[108:111], a[44:47], v[128:131]
  ds_read_b64_tr_b16 a[84:85], v21 offset:8192
  v_mfma_f32_16x16x32_bf16 v[132:135], a[108:111], a[48:51], v[132:135]
  v_mfma_f32_16x16x32_bf16 v[136:139], a[108:111], a[52:55], v[136:139]
  ds_read_b64_tr_b16 a[86:87], v21 offset:10240
  v_mfma_f32_16x16x32_bf16 v[140:143], a[108:111], a[56:59], v[140:143]
  v_mfma_f32_16x16x32_bf16 v[144:147], a[108:111], a[60:63], v[144:147]
  ds_read_b64_tr_b16 a[88:89], v20 offset:16384
  v_mfma_f32_16x16x32_bf16 v[148:151], a[108:111], a[64:67], v[148:151]
  v_mfma_f32_16x16x32_bf16 v[152:155], a[36:39], a[112:115], v[152:155]
  ds_read_b64_tr_b16 a[90:91], v20 offset:18432
  v_mfma_f32_16x16x32_bf16 v[156:159], a[40:43], a[112:115], v[156:159]
  v_mfma_f32_16x16x32_bf16 v[160:163], a[44:47], a[112:115], v[160:163]
  ds_read_b128 a[32:35], v18 offset:0
  v_mfma_f32_16x16x32_bf16 v[164:167], a[48:51], a[112:115], v[164:167]
  v_mfma_f32_16x16x32_bf16 v[168:171], a[52:55], a[112:115], v[168:171]
  ds_read_b64_tr_b16 a[92:93], v21 offset:16384
  v_mfma_f32_16x16x32_bf16 v[172:175], a[56:59], a[112:115], v[172:175]
  v_mfma_f32_16x16x32_bf16 v[176:179], a[60:63], a[112:115], v[176:179]
  ds_read_b64_tr_b16 a[94:95], v21 offset:18432
  v_mfma_f32_16x16x32_bf16 v[180:183], a[64:67], a[112:115], v[180:183]
  v_mfma_f32_16x16x32_bf16 v[216:219], a[68:71], a[112:115], v[216:219]
  v_mfma_f32_16x16x32_bf16 v[184:187], a[36:39], a[116:119], v[184:187]
  v_mfma_f32_16x16x32_bf16 v[188:191], a[40:43], a[116:119], v[188:191]
  v_mfma_f32_16x16x32_bf16 v[192:195], a[44:47], a[116:119], v[192:195]
  v_mfma_f32_16x16x32_bf16 v[196:199], a[48:51], a[116:119], v[196:199]
  v_mfma_f32_16x16x32_bf16 v[200:203], a[52:55], a[116:119], v[200:203]
  v_mfma_f32_16x16x32_bf16 v[204:207], a[56:59], a[116:119], v[204:207]
  v_mfma_f32_16x16x32_bf16 v[208:211], a[60:63], a[116:119], v[208:211]
  v_mfma_f32_16x16x32_bf16 v[212:215], a[64:67], a[116:119], v[212:215]
  v_mfma_f32_16x16x32_bf16 v[220:223], a[68:71], a[116:119], v[220:223]
  s_waitcnt lgkmcnt(0)
  v_mfma_f32_16x16x32_bf16 v[24:27], a[72:75], a[0:3], v[24:27]
  ds_read_b128 a[36:39], v17 offset:0
  ds_read_b64_tr_b16 a[96:97], v20 offset:4096
  v_mfma_f32_16x16x32_bf16 v[56:59], a[76:79], a[0:3], v[56:59]
  ds_read_b64_tr_b16 a[98:99], v20 offset:6144
  ds_read_b128 a[40:43], v17 offset:2048
  v_mfma_f32_16x16x32_bf16 v[28:31], a[72:75], a[4:7], v[28:31]
  ds_read_b128 a[44:47], v17 offset:4096
  ds_read_b128 a[48:51], v17 offset:6144
  v_mfma_f32_16x16x32_bf16 v[60:63], a[76:79], a[4:7], v[60:63]
  ds_read_b128 a[52:55], v17 offset:8192
  ds_read_b128 a[56:59], v17 offset:10240
  v_mfma_f32_16x16x32_bf16 v[32:35], a[72:75], a[8:11], v[32:35]
  ds_read_b128 a[60:63], v17 offset:12288
  ds_read_b128 a[64:67], v17 offset:14336
  v_mfma_f32_16x16x32_bf16 v[64:67], a[76:79], a[8:11], v[64:67]
  ds_read_b64_tr_b16 a[100:101], v21 offset:4096
  ds_read_b64_tr_b16 a[102:103], v21 offset:6144
  v_mfma_f32_16x16x32_bf16 v[36:39], a[72:75], a[12:15], v[36:39]
  ds_read_b64_tr_b16 a[104:105], v20 offset:12288
  ds_read_b64_tr_b16 a[106:107], v20 offset:14336
  v_mfma_f32_16x16x32_bf16 v[68:71], a[76:79], a[12:15], v[68:71]
  ds_read_b64_tr_b16 a[108:109], v21 offset:12288
  ds_read_b64_tr_b16 a[110:111], v21 offset:14336
  v_mfma_f32_16x16x32_bf16 v[40:43], a[72:75], a[16:19], v[40:43]
  ds_read_b64_tr_b16 a[112:113], v20 offset:20480
  ds_read_b64_tr_b16 a[114:115], v20 offset:22528
  v_mfma_f32_16x16x32_bf16 v[72:75], a[76:79], a[16:19], v[72:75]
  ds_read_b128 a[68:71], v19 offset:0
  ds_read_b64_tr_b16 a[116:117], v21 offset:20480
  v_mfma_f32_16x16x32_bf16 v[44:47], a[72:75], a[20:23], v[44:47]
  ds_read_b64_tr_b16 a[118:119], v21 offset:22528
  v_mfma_f32_16x16x32_bf16 v[76:79], a[76:79], a[20:23], v[76:79]
  v_mfma_f32_16x16x32_bf16 v[48:51], a[72:75], a[24:27], v[48:51]
  v_mfma_f32_16x16x32_bf16 v[80:83], a[76:79], a[24:27], v[80:83]
  v_mfma_f32_16x16x32_bf16 v[52:55], a[72:75], a[28:31], v[52:55]
  v_mfma_f32_16x16x32_bf16 v[84:87], a[76:79], a[28:31], v[84:87]
  s_waitcnt lgkmcnt(0)
  s_barrier
  s_mov_b32 s12, s84
  s_mov_b32 s13, s85
  s_mov_b32 s14, 256
  s_mov_b32 s15, 0x00020000
  buffer_load_dwordx2 v[22:23], off, s[12:15], 0 sc1
  v_mfma_f32_16x16x32_bf16 v[24:27], a[96:99], a[36:39], v[24:27]
  s_mov_b32 m0, s68
  v_mfma_f32_16x16x32_bf16 v[56:59], a[100:103], a[36:39], v[56:59]
  buffer_load_dwordx4 v8, s[20:23], s28 offen offset:0 lds
  v_mfma_f32_16x16x32_bf16 v[28:31], a[96:99], a[40:43], v[28:31]
  v_mfma_f32_16x16x32_bf16 v[60:63], a[100:103], a[40:43], v[60:63]
  v_mfma_f32_16x16x32_bf16 v[32:35], a[96:99], a[44:47], v[32:35]
  v_mfma_f32_16x16x32_bf16 v[64:67], a[100:103], a[44:47], v[64:67]
  buffer_load_dwordx4 v9, s[20:23], s28 offen offset:1024 lds
  v_pk_mul_f32 v[24:25], v[24:25], s[6:7]
  v_mfma_f32_16x16x32_bf16 v[36:39], a[96:99], a[48:51], v[36:39]
  v_pk_mul_f32 v[26:27], v[26:27], s[6:7]
  v_pk_mul_f32 v[56:57], v[56:57], s[6:7]
  v_mfma_f32_16x16x32_bf16 v[68:71], a[100:103], a[48:51], v[68:71]
  v_pk_mul_f32 v[58:59], v[58:59], s[6:7]
  v_cvt_pk_bf16_f32 v24, v24, v25
  v_mfma_f32_16x16x32_bf16 v[40:43], a[96:99], a[52:55], v[40:43]
  v_cvt_pk_bf16_f32 v25, v26, v27
  v_cvt_pk_bf16_f32 v26, v56, v57
  v_mfma_f32_16x16x32_bf16 v[72:75], a[100:103], a[52:55], v[72:75]
  v_cvt_pk_bf16_f32 v27, v58, v59
  v_pk_mul_f32 v[28:29], v[28:29], s[6:7]
  v_mfma_f32_16x16x32_bf16 v[44:47], a[96:99], a[56:59], v[44:47]
  buffer_load_dwordx4 v10, s[20:23], s28 offen offset:2048 lds
  v_pk_mul_f32 v[30:31], v[30:31], s[6:7]
  v_mfma_f32_16x16x32_bf16 v[76:79], a[100:103], a[56:59], v[76:79]
  v_pk_mul_f32 v[60:61], v[60:61], s[6:7]
  v_pk_mul_f32 v[62:63], v[62:63], s[6:7]
  v_mfma_f32_16x16x32_bf16 v[48:51], a[96:99], a[60:63], v[48:51]
  v_cvt_pk_bf16_f32 v28, v28, v29
  v_cvt_pk_bf16_f32 v29, v30, v31
  v_mfma_f32_16x16x32_bf16 v[80:83], a[100:103], a[60:63], v[80:83]
  v_cvt_pk_bf16_f32 v30, v60, v61
  v_cvt_pk_bf16_f32 v31, v62, v63
  v_mfma_f32_16x16x32_bf16 v[52:55], a[96:99], a[64:67], v[52:55]
  v_pk_mul_f32 v[32:33], v[32:33], s[6:7]
  v_pk_mul_f32 v[34:35], v[34:35], s[6:7]
  v_mfma_f32_16x16x32_bf16 v[84:87], a[100:103], a[64:67], v[84:87]
  buffer_load_dwordx4 v11, s[20:23], s28 offen offset:3072 lds
  v_pk_mul_f32 v[64:65], v[64:65], s[6:7]
  v_mfma_f32_16x16x32_bf16 v[88:91], a[80:83], a[0:3], v[88:91]
  s_bfe_u32 s56, 0x302010e, s55
  s_add_u32 s54, s54, s56
  s_add_u32 s55, s55, 8
  v_mfma_f32_16x16x32_bf16 v[120:123], a[84:87], a[0:3], v[120:123]
  s_and_b32 s55, s55, 0x8001f
  s_and_b32 s54, s54, 15
  s_lshl_b32 s28, s54, 19
  v_mfma_f32_16x16x32_bf16 v[88:91], a[104:107], a[36:39], v[88:91]
  s_add_u32 m0, s68, 16384
  v_pk_mul_f32 v[66:67], v[66:67], s[6:7]
  v_cvt_pk_bf16_f32 v32, v32, v33
  v_mfma_f32_16x16x32_bf16 v[120:123], a[108:111], a[36:39], v[120:123]
  v_cvt_pk_bf16_f32 v33, v34, v35
  v_cvt_pk_bf16_f32 v34, v64, v65
  v_mfma_f32_16x16x32_bf16 v[92:95], a[80:83], a[4:7], v[92:95]
  buffer_load_dwordx4 v8, s[20:23], s28 offen offset:0 lds
  v_cvt_pk_bf16_f32 v35, v66, v67
  v_mfma_f32_16x16x32_bf16 v[124:127], a[84:87], a[4:7], v[124:127]
  v_pk_mul_f32 v[36:37], v[36:37], s[6:7]
  v_pk_mul_f32 v[38:39], v[38:39], s[6:7]
  v_mfma_f32_16x16x32_bf16 v[92:95], a[104:107], a[40:43], v[92:95]
  v_pk_mul_f32 v[68:69], v[68:69], s[6:7]
  v_pk_mul_f32 v[70:71], v[70:71], s[6:7]
  v_mfma_f32_16x16x32_bf16 v[124:127], a[108:111], a[40:43], v[124:127]
  v_cvt_pk_bf16_f32 v36, v36, v37
  v_cvt_pk_bf16_f32 v37, v38, v39
  v_mfma_f32_16x16x32_bf16 v[96:99], a[80:83], a[8:11], v[96:99]
  v_cvt_pk_bf16_f32 v38, v68, v69
  v_cvt_pk_bf16_f32 v39, v70, v71
  v_mfma_f32_16x16x32_bf16 v[128:131], a[84:87], a[8:11], v[128:131]
  buffer_load_dwordx4 v9, s[20:23], s28 offen offset:1024 lds
  v_pk_mul_f32 v[40:41], v[40:41], s[6:7]
  v_mfma_f32_16x16x32_bf16 v[96:99], a[104:107], a[44:47], v[96:99]
  v_pk_mul_f32 v[42:43], v[42:43], s[6:7]
  v_pk_mul_f32 v[72:73], v[72:73], s[6:7]
  v_mfma_f32_16x16x32_bf16 v[128:131], a[108:111], a[44:47], v[128:131]
  v_pk_mul_f32 v[74:75], v[74:75], s[6:7]
  v_cvt_pk_bf16_f32 v40, v40, v41
  v_mfma_f32_16x16x32_bf16 v[100:103], a[80:83], a[12:15], v[100:103]
  v_cvt_pk_bf16_f32 v41, v42, v43
  v_cvt_pk_bf16_f32 v42, v72, v73
  v_mfma_f32_16x16x32_bf16 v[132:135], a[84:87], a[12:15], v[132:135]
  v_cvt_pk_bf16_f32 v43, v74, v75
  v_pk_mul_f32 v[44:45], v[44:45], s[6:7]
  v_mfma_f32_16x16x32_bf16 v[100:103], a[104:107], a[48:51], v[100:103]
  v_pk_mul_f32 v[46:47], v[46:47], s[6:7]
  v_pk_mul_f32 v[76:77], v[76:77], s[6:7]
  v_mfma_f32_16x16x32_bf16 v[132:135], a[108:111], a[48:51], v[132:135]
  buffer_load_dwordx4 v10, s[20:23], s28 offen offset:2048 lds
  v_pk_mul_f32 v[78:79], v[78:79], s[6:7]
  v_mfma_f32_16x16x32_bf16 v[104:107], a[80:83], a[16:19], v[104:107]
  v_cvt_pk_bf16_f32 v44, v44, v45
  v_cvt_pk_bf16_f32 v45, v46, v47
  v_mfma_f32_16x16x32_bf16 v[136:139], a[84:87], a[16:19], v[136:139]
  v_cvt_pk_bf16_f32 v46, v76, v77
  v_cvt_pk_bf16_f32 v47, v78, v79
  v_mfma_f32_16x16x32_bf16 v[104:107], a[104:107], a[52:55], v[104:107]
  v_pk_mul_f32 v[48:49], v[48:49], s[6:7]
  v_pk_mul_f32 v[50:51], v[50:51], s[6:7]
  v_mfma_f32_16x16x32_bf16 v[136:139], a[108:111], a[52:55], v[136:139]
  v_pk_mul_f32 v[80:81], v[80:81], s[6:7]
  v_pk_mul_f32 v[82:83], v[82:83], s[6:7]
  v_mfma_f32_16x16x32_bf16 v[108:111], a[80:83], a[20:23], v[108:111]
  buffer_load_dwordx4 v11, s[20:23], s28 offen offset:3072 lds
  v_cvt_pk_bf16_f32 v48, v48, v49
  v_mfma_f32_16x16x32_bf16 v[140:143], a[84:87], a[20:23], v[140:143]
  s_bfe_u32 s56, 0x302010e, s55
  s_add_u32 s54, s54, s56
  s_add_u32 s55, s55, 8
  v_mfma_f32_16x16x32_bf16 v[108:111], a[104:107], a[56:59], v[108:111]
  s_and_b32 s55, s55, 0x8001f
  s_and_b32 s54, s54, 15
  s_lshl_b32 s28, s54, 19
  v_mfma_f32_16x16x32_bf16 v[140:143], a[108:111], a[56:59], v[140:143]
  s_mov_b32 m0, s88
  v_cvt_pk_bf16_f32 v49, v50, v51
  v_cvt_pk_bf16_f32 v50, v80, v81
  v_mfma_f32_16x16x32_bf16 v[112:115], a[80:83], a[24:27], v[112:115]
  v_cvt_pk_bf16_f32 v51, v82, v83
  v_pk_mul_f32 v[52:53], v[52:53], s[6:7]
  v_mfma_f32_16x16x32_bf16 v[144:147], a[84:87], a[24:27], v[144:147]
  buffer_load_dwordx4 v4, s[8:11], s26 offen offset:0 lds
  v_pk_mul_f32 v[54:55], v[54:55], s[6:7]
  v_mfma_f32_16x16x32_bf16 v[112:115], a[104:107], a[60:63], v[112:115]
  v_pk_mul_f32 v[84:85], v[84:85], s[6:7]
  v_pk_mul_f32 v[86:87], v[86:87], s[6:7]
  v_mfma_f32_16x16x32_bf16 v[144:147], a[108:111], a[60:63], v[144:147]
  v_cvt_pk_bf16_f32 v52, v52, v53
  v_cvt_pk_bf16_f32 v53, v54, v55
  v_mfma_f32_16x16x32_bf16 v[116:119], a[80:83], a[28:31], v[116:119]
  v_cvt_pk_bf16_f32 v54, v84, v85
  v_cvt_pk_bf16_f32 v55, v86, v87
  v_mfma_f32_16x16x32_bf16 v[148:151], a[84:87], a[28:31], v[148:151]
  v_cvt_pk_bf16_f32 v88, v88, v89
  v_cvt_pk_bf16_f32 v89, v90, v91
  v_mfma_f32_16x16x32_bf16 v[116:119], a[104:107], a[64:67], v[116:119]
  buffer_load_dwordx4 v5, s[8:11], s26 offen offset:1024 lds
  v_cvt_pk_bf16_f32 v90, v120, v121
  v_mfma_f32_16x16x32_bf16 v[148:151], a[108:111], a[64:67], v[148:151]
  v_cvt_pk_bf16_f32 v91, v122, v123
  v_cvt_pk_bf16_f32 v92, v92, v93
  v_mfma_f32_16x16x32_bf16 v[216:219], a[32:35], a[88:91], v[216:219]
  v_cvt_pk_bf16_f32 v93, v94, v95
  v_cvt_pk_bf16_f32 v94, v124, v125
  v_mfma_f32_16x16x32_bf16 v[220:223], a[32:35], a[92:95], v[220:223]
  v_cvt_pk_bf16_f32 v95, v126, v127
  v_cvt_pk_bf16_f32 v96, v96, v97
  v_mfma_f32_16x16x32_bf16 v[216:219], a[68:71], a[112:115], v[216:219]
  v_cvt_pk_bf16_f32 v97, v98, v99
  v_cvt_pk_bf16_f32 v98, v128, v129
  v_mfma_f32_16x16x32_bf16 v[220:223], a[68:71], a[116:119], v[220:223]
  buffer_load_dwordx4 v6, s[8:11], s26 offen offset:2048 lds
  v_cvt_pk_bf16_f32 v99, v130, v131
  v_mfma_f32_16x16x32_bf16 v[180:183], a[28:31], a[88:91], v[180:183]
  v_cvt_pk_bf16_f32 v100, v100, v101
  v_cvt_pk_bf16_f32 v101, v102, v103
  v_mfma_f32_16x16x32_bf16 v[212:215], a[28:31], a[92:95], v[212:215]
  v_cvt_pk_bf16_f32 v102, v132, v133
  v_cvt_pk_bf16_f32 v103, v134, v135
  v_mfma_f32_16x16x32_bf16 v[180:183], a[64:67], a[112:115], v[180:183]
  v_cvt_pk_bf16_f32 v104, v104, v105
  v_cvt_pk_bf16_f32 v105, v106, v107
  v_mfma_f32_16x16x32_bf16 v[212:215], a[64:67], a[116:119], v[212:215]
  v_cvt_pk_bf16_f32 v106, v136, v137
  v_cvt_pk_bf16_f32 v107, v138, v139
  v_mfma_f32_16x16x32_bf16 v[176:179], a[24:27], a[88:91], v[176:179]
  v_cvt_pk_bf16_f32 v108, v108, v109
  v_cvt_pk_bf16_f32 v109, v110, v111
  v_mfma_f32_16x16x32_bf16 v[208:211], a[24:27], a[92:95], v[208:211]
  buffer_load_dwordx4 v7, s[8:11], s26 offen offset:3072 lds
  v_cvt_pk_bf16_f32 v110, v140, v141
  v_mfma_f32_16x16x32_bf16 v[176:179], a[60:63], a[112:115], v[176:179]
  s_add_u32 m0, s88, 4096
  v_cvt_pk_bf16_f32 v111, v142, v143
  v_cvt_pk_bf16_f32 v112, v112, v113
  v_mfma_f32_16x16x32_bf16 v[208:211], a[60:63], a[116:119], v[208:211]
  v_cvt_pk_bf16_f32 v113, v114, v115
  v_cvt_pk_bf16_f32 v114, v144, v145
  v_mfma_f32_16x16x32_bf16 v[172:175], a[20:23], a[88:91], v[172:175]
  v_cvt_pk_bf16_f32 v115, v146, v147
  v_cvt_pk_bf16_f32 v116, v116, v117
  v_mfma_f32_16x16x32_bf16 v[204:207], a[20:23], a[92:95], v[204:207]
  v_cvt_pk_bf16_f32 v117, v118, v119
  v_cvt_pk_bf16_f32 v118, v148, v149
  v_mfma_f32_16x16x32_bf16 v[172:175], a[56:59], a[112:115], v[172:175]
  buffer_load_dwordx4 v4, s[8:11], s27 offen offset:0 lds
  v_cvt_pk_bf16_f32 v119, v150, v151
  v_mfma_f32_16x16x32_bf16 v[204:207], a[56:59], a[116:119], v[204:207]
  v_cvt_pk_bf16_f32 v216, v216, v217
  v_cvt_pk_bf16_f32 v217, v218, v219
  v_mfma_f32_16x16x32_bf16 v[168:171], a[16:19], a[88:91], v[168:171]
  v_cvt_pk_bf16_f32 v218, v220, v221
  v_cvt_pk_bf16_f32 v219, v222, v223
  v_mfma_f32_16x16x32_bf16 v[200:203], a[16:19], a[92:95], v[200:203]
  ds_write_b128 v252, v[216:219] offset:1024
  v_cvt_pk_bf16_f32 v72, v180, v181
  v_mfma_f32_16x16x32_bf16 v[168:171], a[52:55], a[112:115], v[168:171]
  v_cvt_pk_bf16_f32 v73, v182, v183
  v_cvt_pk_bf16_f32 v136, v212, v213
  v_mfma_f32_16x16x32_bf16 v[200:203], a[52:55], a[116:119], v[200:203]
  buffer_load_dwordx4 v5, s[8:11], s27 offen offset:1024 lds
  v_cvt_pk_bf16_f32 v137, v214, v215
  v_mfma_f32_16x16x32_bf16 v[164:167], a[12:15], a[88:91], v[164:167]
  v_cvt_pk_bf16_f32 v70, v176, v177
  v_cvt_pk_bf16_f32 v71, v178, v179
  v_mfma_f32_16x16x32_bf16 v[196:199], a[12:15], a[92:95], v[196:199]
  v_cvt_pk_bf16_f32 v134, v208, v209
  v_cvt_pk_bf16_f32 v135, v210, v211
  v_mfma_f32_16x16x32_bf16 v[164:167], a[48:51], a[112:115], v[164:167]
  v_cvt_pk_bf16_f32 v68, v172, v173
  v_cvt_pk_bf16_f32 v69, v174, v175
  v_mfma_f32_16x16x32_bf16 v[196:199], a[48:51], a[116:119], v[196:199]
  v_cvt_pk_bf16_f32 v132, v204, v205
  v_cvt_pk_bf16_f32 v133, v206, v207
  v_mfma_f32_16x16x32_bf16 v[160:163], a[8:11], a[88:91], v[160:163]
  buffer_load_dwordx4 v6, s[8:11], s27 offen offset:2048 lds
  v_cvt_pk_bf16_f32 v66, v168, v169
  v_mfma_f32_16x16x32_bf16 v[192:195], a[8:11], a[92:95], v[192:195]
  v_cvt_pk_bf16_f32 v67, v170, v171
  v_cvt_pk_bf16_f32 v130, v200, v201
  v_mfma_f32_16x16x32_bf16 v[160:163], a[44:47], a[112:115], v[160:163]
  v_cvt_pk_bf16_f32 v131, v202, v203
  v_mfma_f32_16x16x32_bf16 v[192:195], a[44:47], a[116:119], v[192:195]
  v_cvt_pk_bf16_f32 v64, v164, v165
  v_cvt_pk_bf16_f32 v65, v166, v167
  v_mfma_f32_16x16x32_bf16 v[156:159], a[4:7], a[88:91], v[156:159]
  v_cvt_pk_bf16_f32 v128, v196, v197
  v_cvt_pk_bf16_f32 v129, v198, v199
  v_mfma_f32_16x16x32_bf16 v[188:191], a[4:7], a[92:95], v[188:191]
  buffer_load_dwordx4 v7, s[8:11], s27 offen offset:3072 lds
  v_mfma_f32_16x16x32_bf16 v[156:159], a[40:43], a[112:115], v[156:159]
  s_bfe_u32 s29, 0x302010e, s53
  s_add_u32 s52, s52, s29
  s_add_u32 s53, s53, 8
  v_mfma_f32_16x16x32_bf16 v[188:191], a[40:43], a[116:119], v[188:191]
  s_and_b32 s53, s53, 0x8001f
  s_and_b32 s52, s52, 15
  s_lshl_b32 s29, s52, 7
  v_mfma_f32_16x16x32_bf16 v[152:155], a[0:3], a[88:91], v[152:155]
  s_or_b32 s26, s30, s29
  s_or_b32 s27, s31, s29
  v_cvt_pk_bf16_f32 v62, v160, v161
  v_mfma_f32_16x16x32_bf16 v[184:187], a[0:3], a[92:95], v[184:187]
  v_cvt_pk_bf16_f32 v63, v162, v163
  v_cvt_pk_bf16_f32 v126, v192, v193
  v_mfma_f32_16x16x32_bf16 v[152:155], a[36:39], a[112:115], v[152:155]
  v_cvt_pk_bf16_f32 v127, v194, v195
  v_mfma_f32_16x16x32_bf16 v[184:187], a[36:39], a[116:119], v[184:187]
  v_cvt_pk_bf16_f32 v60, v156, v157
  v_cvt_pk_bf16_f32 v61, v158, v159
  v_cvt_pk_bf16_f32 v124, v188, v189
  v_cvt_pk_bf16_f32 v125, v190, v191
  s_nop 1
  v_cvt_pk_bf16_f32 v58, v152, v153
  v_cvt_pk_bf16_f32 v59, v154, v155
  v_cvt_pk_bf16_f32 v122, v184, v185
  v_cvt_pk_bf16_f32 v123, v186, v187
  s_waitcnt lgkmcnt(0)
  s_barrier
Lp2_at:
  ds_read_b128 v[76:79], v253
  ds_read_b64 v[56:57], v253 offset:1024
  ds_read_b64 v[120:121], v253 offset:1032
  v_mfma_f32_16x16x32_bf16 v[208:211], v[112:115], v[52:55], v[240:243]
  s_add_u32 m0, s88, 32768
  s_nop 0
  buffer_load_dwordx4 v4, s[8:11], s26 offen offset:0 lds
  v_mfma_f32_16x16x32_bf16 v[212:215], v[116:119], v[52:55], v[244:247]
  v_mfma_f32_16x16x32_bf16 v[200:203], v[108:111], v[48:51], v[240:243]
  v_mfma_f32_16x16x32_bf16 v[204:207], v[112:115], v[48:51], v[244:247]
  v_mfma_f32_16x16x32_bf16 v[192:195], v[104:107], v[44:47], v[240:243]
  v_mfma_f32_16x16x32_bf16 v[196:199], v[108:111], v[44:47], v[244:247]
  v_mfma_f32_16x16x32_bf16 v[184:187], v[100:103], v[40:43], v[240:243]
  v_mfma_f32_16x16x32_bf16 v[188:191], v[104:107], v[40:43], v[244:247]
  v_mfma_f32_16x16x32_bf16 v[176:179], v[96:99], v[36:39], v[240:243]
  v_mfma_f32_16x16x32_bf16 v[180:183], v[100:103], v[36:39], v[244:247]
  v_mfma_f32_16x16x32_bf16 v[168:171], v[92:95], v[32:35], v[240:243]
  v_mfma_f32_16x16x32_bf16 v[172:175], v[96:99], v[32:35], v[244:247]
  v_mfma_f32_16x16x32_bf16 v[160:163], v[88:91], v[28:31], v[240:243]
  buffer_load_dwordx4 v5, s[8:11], s26 offen offset:1024 lds
  v_mfma_f32_16x16x32_bf16 v[164:167], v[92:95], v[28:31], v[244:247]
  s_waitcnt lgkmcnt(0)
  v_mfma_f32_16x16x32_bf16 v[152:155], v[76:79], v[24:27], v[248:251]
  v_mfma_f32_16x16x32_bf16 v[156:159], v[88:91], v[24:27], v[244:247]
  v_max3_f32 v238, v208, v209, v210
  v_max3_f32 v239, v211, v212, v213
  v_max3_f32 v238, v238, v214, v215
  v_max_f32 v238, v238, v239
  v_max3_f32 v236, v200, v201, v202
  v_max3_f32 v237, v203, v204, v205
  v_max3_f32 v236, v236, v206, v207
  v_max_f32 v236, v236, v237
  v_max3_f32 v234, v192, v193, v194
  v_max3_f32 v235, v195, v196, v197
  buffer_load_dwordx4 v6, s[8:11], s26 offen offset:2048 lds
  v_max3_f32 v234, v234, v198, v199
  v_max_f32 v234, v234, v235
  v_max3_f32 v232, v184, v185, v186
  v_max3_f32 v233, v187, v188, v189
  v_max3_f32 v232, v232, v190, v191
  v_max_f32 v232, v232, v233
  v_max3_f32 v230, v176, v177, v178
  v_max3_f32 v231, v179, v180, v181
  v_max3_f32 v230, v230, v182, v183
  v_max_f32 v230, v230, v231
  v_max3_f32 v228, v168, v169, v170
  v_max3_f32 v229, v171, v172, v173
  buffer_load_dwordx4 v7, s[8:11], s26 offen offset:3072 lds
  v_max3_f32 v228, v228, v174, v175
  v_max_f32 v228, v228, v229
  v_max3_f32 v226, v160, v161, v162
  v_max3_f32 v227, v163, v164, v165
  v_max3_f32 v226, v226, v166, v167
  v_max_f32 v226, v226, v227
  v_max3_f32 v224, v152, v153, v154
  v_max3_f32 v225, v155, v156, v157
  v_max3_f32 v224, v224, v158, v159
  v_max_f32 v224, v224, v225
  v_mov_b32 v239, v238
  v_mov_b32 v237, v236
  v_mov_b32 v235, v234
  s_add_u32 m0, s88, 36864
  s_nop 0
  buffer_load_dwordx4 v4, s[8:11], s27 offen offset:0 lds
  v_mov_b32 v233, v232
  v_mov_b32 v231, v230
  v_mov_b32 v229, v228
  v_mov_b32 v227, v226
  v_mov_b32 v225, v224
  v_permlane32_swap_b32 v238, v239
  v_permlane32_swap_b32 v236, v237
  v_permlane32_swap_b32 v234, v235
  v_permlane32_swap_b32 v232, v233
  v_permlane32_swap_b32 v230, v231
  v_permlane32_swap_b32 v228, v229
  v_permlane32_swap_b32 v226, v227
  buffer_load_dwordx4 v5, s[8:11], s27 offen offset:1024 lds
  v_permlane32_swap_b32 v224, v225
  v_max_f32 v238, v238, v239
  v_max_f32 v236, v236, v237
  v_max_f32 v234, v234, v235
  v_max_f32 v232, v232, v233
  v_max_f32 v230, v230, v231
  v_max_f32 v228, v228, v229
  v_max_f32 v226, v226, v227
  v_max_f32 v224, v224, v225
  v_mov_b32 v239, v238
  v_mov_b32 v237, v236
  v_mov_b32 v235, v234
  buffer_load_dwordx4 v6, s[8:11], s27 offen offset:2048 lds
  v_mov_b32 v233, v232
  v_mov_b32 v231, v230
  v_mov_b32 v229, v228
  v_mov_b32 v227, v226
  v_mov_b32 v225, v224
  v_permlane16_swap_b32 v238, v239
  v_permlane16_swap_b32 v236, v237
  v_permlane16_swap_b32 v234, v235
  v_permlane16_swap_b32 v232, v233
  v_permlane16_swap_b32 v230, v231
  v_permlane16_swap_b32 v228, v229
  v_permlane16_swap_b32 v226, v227
  buffer_load_dwordx4 v7, s[8:11], s27 offen offset:3072 lds
  v_permlane16_swap_b32 v224, v225
  v_max_f32 v238, v238, v239
  v_max_f32 v236, v236, v237
  v_max_f32 v234, v234, v235
  v_max_f32 v232, v232, v233
  v_max_f32 v230, v230, v231
  v_max_f32 v228, v228, v229
  v_max_f32 v226, v226, v227
  v_max_f32 v224, v224, v225
  v_sub_f32 v208, v208, v238
  v_sub_f32 v209, v209, v238
  v_sub_f32 v210, v210, v238
  v_sub_f32 v211, v211, v238
  s_bfe_u32 s29, 0x302010e, s53
  s_add_u32 s52, s52, s29
  s_add_u32 s53, s53, 8
  s_and_b32 s53, s53, 0x8001f
  s_and_b32 s52, s52, 15
  s_lshl_b32 s29, s52, 7
  s_or_b32 s26, s30, s29
  s_or_b32 s27, s31, s29
  s_add_u32 m0, s68, 32768
  s_nop 0
  buffer_load_dwordx4 v8, s[20:23], s28 offen offset:0 lds
  v_sub_f32 v212, v212, v238
  v_sub_f32 v213, v213, v238
  v_sub_f32 v214, v214, v238
  v_sub_f32 v215, v215, v238
  v_exp_f32 v208, v208
  v_exp_f32 v209, v209
  v_exp_f32 v210, v210
  v_exp_f32 v211, v211
  v_exp_f32 v212, v212
  v_exp_f32 v213, v213
  v_exp_f32 v214, v214
  v_exp_f32 v215, v215
  buffer_load_dwordx4 v9, s[20:23], s28 offen offset:1024 lds
  v_sub_f32 v200, v200, v236
  v_sub_f32 v201, v201, v236
  v_sub_f32 v202, v202, v236
  v_sub_f32 v203, v203, v236
  v_sub_f32 v204, v204, v236
  v_sub_f32 v205, v205, v236
  v_sub_f32 v206, v206, v236
  v_sub_f32 v207, v207, v236
  v_exp_f32 v200, v200
  v_exp_f32 v201, v201
  v_exp_f32 v202, v202
  v_exp_f32 v203, v203
  buffer_load_dwordx4 v10, s[20:23], s28 offen offset:2048 lds
  v_exp_f32 v204, v204
  v_exp_f32 v205, v205
  v_exp_f32 v206, v206
  v_exp_f32 v207, v207
  v_cvt_pk_bf16_f32 v116, v208, v209
  v_cvt_pk_bf16_f32 v117, v210, v211
  v_cvt_pk_bf16_f32 v118, v212, v213
  v_cvt_pk_bf16_f32 v119, v214, v215
  s_nop 1
  v_mfma_f32_16x16x32_bf16 v[52:55], a[208:211], v[116:119], 0
  v_mfma_f32_16x16x32_bf16 v[208:211], v[70:73], v[116:119], 0
  v_mfma_f32_16x16x32_bf16 v[212:215], v[134:137], v[116:119], 0
  v_sub_f32 v192, v192, v234
  buffer_load_dwordx4 v11, s[20:23], s28 offen offset:3072 lds
  v_sub_f32 v193, v193, v234
  v_sub_f32 v194, v194, v234
  v_sub_f32 v195, v195, v234
  v_sub_f32 v196, v196, v234
  v_sub_f32 v197, v197, v234
  v_sub_f32 v198, v198, v234
  v_sub_f32 v199, v199, v234
  v_exp_f32 v192, v192
  v_exp_f32 v193, v193
  v_exp_f32 v194, v194
  v_exp_f32 v195, v195
  v_exp_f32 v196, v196
  v_exp_f32 v197, v197
  s_bfe_u32 s56, 0x302010e, s55
  s_add_u32 s54, s54, s56
  s_add_u32 s55, s55, 8
  s_and_b32 s55, s55, 0x8001f
  s_and_b32 s54, s54, 15
  s_lshl_b32 s28, s54, 19
  s_add_u32 m0, s88, -32768
  s_nop 0
  buffer_load_dwordx4 v4, s[8:11], s26 offen offset:0 lds
  v_exp_f32 v198, v198
  v_exp_f32 v199, v199
  v_cvt_pk_bf16_f32 v112, v200, v201
  v_cvt_pk_bf16_f32 v113, v202, v203
  v_cvt_pk_bf16_f32 v114, v204, v205
  v_cvt_pk_bf16_f32 v115, v206, v207
  s_nop 1
  v_mfma_f32_16x16x32_bf16 v[48:51], a[208:211], v[112:115], 0
  v_mfma_f32_16x16x32_bf16 v[200:203], v[68:71], v[112:115], 0
  v_mfma_f32_16x16x32_bf16 v[204:207], v[132:135], v[112:115], 0
  v_sub_f32 v184, v184, v232
  v_sub_f32 v185, v185, v232
  v_sub_f32 v186, v186, v232
  buffer_load_dwordx4 v5, s[8:11], s26 offen offset:1024 lds
  v_sub_f32 v187, v187, v232
  v_sub_f32 v188, v188, v232
  v_sub_f32 v189, v189, v232
  v_sub_f32 v190, v190, v232
  v_sub_f32 v191, v191, v232
  v_exp_f32 v184, v184
  v_exp_f32 v185, v185
  v_exp_f32 v186, v186
  v_exp_f32 v187, v187
  v_exp_f32 v188, v188
  v_exp_f32 v189, v189
  v_exp_f32 v190, v190
  buffer_load_dwordx4 v6, s[8:11], s26 offen offset:2048 lds
  v_exp_f32 v191, v191
  v_cvt_pk_bf16_f32 v108, v192, v193
  v_cvt_pk_bf16_f32 v109, v194, v195
  v_cvt_pk_bf16_f32 v110, v196, v197
  v_cvt_pk_bf16_f32 v111, v198, v199
  s_nop 1
  v_mfma_f32_16x16x32_bf16 v[44:47], a[208:211], v[108:111], 0
  v_mfma_f32_16x16x32_bf16 v[192:195], v[66:69], v[108:111], 0
  v_mfma_f32_16x16x32_bf16 v[196:199], v[130:133], v[108:111], 0
  v_sub_f32 v176, v176, v230
  v_sub_f32 v177, v177, v230
  v_sub_f32 v178, v178, v230
  v_sub_f32 v179, v179, v230
  buffer_load_dwordx4 v7, s[8:11], s26 offen offset:3072 lds
  v_sub_f32 v180, v180, v230
  v_sub_f32 v181, v181, v230
  v_sub_f32 v182, v182, v230
  v_sub_f32 v183, v183, v230
  v_exp_f32 v176, v176
  v_exp_f32 v177, v177
  v_exp_f32 v178, v178
  v_exp_f32 v179, v179
  v_exp_f32 v180, v180
  v_exp_f32 v181, v181
  v_exp_f32 v182, v182
  v_exp_f32 v183, v183
  v_cvt_pk_bf16_f32 v104, v184, v185
  s_add_u32 m0, s88, -28672
  s_nop 0
  buffer_load_dwordx4 v4, s[8:11], s27 offen offset:0 lds
  v_cvt_pk_bf16_f32 v105, v186, v187
  v_cvt_pk_bf16_f32 v106, v188, v189
  v_cvt_pk_bf16_f32 v107, v190, v191
  s_nop 1
  v_mfma_f32_16x16x32_bf16 v[40:43], a[208:211], v[104:107], 0
  v_mfma_f32_16x16x32_bf16 v[184:187], v[64:67], v[104:107], 0
  v_mfma_f32_16x16x32_bf16 v[188:191], v[128:131], v[104:107], 0
  v_sub_f32 v168, v168, v228
  v_sub_f32 v169, v169, v228
  v_sub_f32 v170, v170, v228
  v_sub_f32 v171, v171, v228
  v_sub_f32 v172, v172, v228
  v_sub_f32 v173, v173, v228
  buffer_load_dwordx4 v5, s[8:11], s27 offen offset:1024 lds
  v_sub_f32 v174, v174, v228
  v_sub_f32 v175, v175, v228
  v_exp_f32 v168, v168
  v_exp_f32 v169, v169
  v_exp_f32 v170, v170
  v_exp_f32 v171, v171
  v_exp_f32 v172, v172
  v_exp_f32 v173, v173
  v_exp_f32 v174, v174
  v_exp_f32 v175, v175
  v_cvt_pk_bf16_f32 v100, v176, v177
  v_cvt_pk_bf16_f32 v101, v178, v179
  buffer_load_dwordx4 v6, s[8:11], s27 offen offset:2048 lds
  v_cvt_pk_bf16_f32 v102, v180, v181
  v_cvt_pk_bf16_f32 v103, v182, v183
  s_nop 1
  v_mfma_f32_16x16x32_bf16 v[36:39], a[208:211], v[100:103], 0
  v_mfma_f32_16x16x32_bf16 v[176:179], v[62:65], v[100:103], 0
  v_mfma_f32_16x16x32_bf16 v[180:183], v[126:129], v[100:103], 0
  v_sub_f32 v160, v160, v226
  v_sub_f32 v161, v161, v226
  v_sub_f32 v162, v162, v226
  v_sub_f32 v163, v163, v226
  v_sub_f32 v164, v164, v226
  v_sub_f32 v165, v165, v226
  v_sub_f32 v166, v166, v226
  buffer_load_dwordx4 v7, s[8:11], s27 offen offset:3072 lds
  s_bfe_u32 s29, 0x302010e, s53
  s_add_u32 s52, s52, s29
  s_add_u32 s53, s53, 8
  s_and_b32 s53, s53, 0x8001f
  s_and_b32 s52, s52, 15
  s_lshl_b32 s29, s52, 7
  s_or_b32 s26, s30, s29
  s_or_b32 s27, s31, s29
  v_sub_f32 v167, v167, v226
  v_exp_f32 v160, v160
  v_exp_f32 v161, v161
  v_exp_f32 v162, v162
  v_exp_f32 v163, v163
  v_exp_f32 v164, v164
  v_exp_f32 v165, v165
  v_exp_f32 v166, v166
  v_exp_f32 v167, v167
  v_cvt_pk_bf16_f32 v96, v168, v169
  v_cvt_pk_bf16_f32 v97, v170, v171
  v_cvt_pk_bf16_f32 v98, v172, v173
  v_cvt_pk_bf16_f32 v99, v174, v175
  s_nop 1
  v_mfma_f32_16x16x32_bf16 v[32:35], a[208:211], v[96:99], 0
  v_mfma_f32_16x16x32_bf16 v[168:171], v[60:63], v[96:99], 0
  v_mfma_f32_16x16x32_bf16 v[172:175], v[124:127], v[96:99], 0
  v_sub_f32 v152, v152, v224
  v_sub_f32 v153, v153, v224
  v_sub_f32 v154, v154, v224
  v_sub_f32 v155, v155, v224
  v_sub_f32 v156, v156, v224
  v_sub_f32 v157, v157, v224
  v_sub_f32 v158, v158, v224
  v_sub_f32 v159, v159, v224
  v_exp_f32 v152, v152
  v_exp_f32 v153, v153
  v_exp_f32 v154, v154
  v_exp_f32 v155, v155
  v_exp_f32 v156, v156
  v_exp_f32 v157, v157
  v_exp_f32 v158, v158
  v_exp_f32 v159, v159
  v_cvt_pk_bf16_f32 v92, v160, v161
  v_cvt_pk_bf16_f32 v93, v162, v163
  v_cvt_pk_bf16_f32 v94, v164, v165
  v_cvt_pk_bf16_f32 v95, v166, v167
  s_nop 1
  v_mfma_f32_16x16x32_bf16 v[28:31], a[208:211], v[92:95], 0
  v_mfma_f32_16x16x32_bf16 v[160:163], v[58:61], v[92:95], 0
  v_mfma_f32_16x16x32_bf16 v[164:167], v[122:125], v[92:95], 0
  v_cvt_pk_bf16_f32 v88, v152, v153
  v_cvt_pk_bf16_f32 v89, v154, v155
  v_cvt_pk_bf16_f32 v90, v156, v157
  v_cvt_pk_bf16_f32 v91, v158, v159
  s_nop 1
  v_mfma_f32_16x16x32_bf16 v[24:27], a[208:211], v[88:91], 0
  v_mfma_f32_16x16x32_bf16 v[152:155], v[56:59], v[88:91], 0
  v_mfma_f32_16x16x32_bf16 v[156:159], v[120:123], v[88:91], 0
  v_rcp_f32 v52, v52
  v_rcp_f32 v48, v48
  v_rcp_f32 v44, v44
  v_rcp_f32 v40, v40
  v_rcp_f32 v36, v36
  v_rcp_f32 v32, v32
  v_rcp_f32 v28, v28
  v_rcp_f32 v24, v24
  v_mov_b32 v53, v52
  v_mov_b32 v49, v48
  v_mov_b32 v45, v44
  v_mov_b32 v41, v40
  v_mov_b32 v37, v36
  v_mov_b32 v33, v32
  v_mov_b32 v29, v28
  v_mov_b32 v25, v24
  v_pk_mul_f32 v[208:209], v[208:209], v[52:53]
  v_pk_mul_f32 v[210:211], v[210:211], v[52:53]
  v_pk_mul_f32 v[212:213], v[212:213], v[52:53]
  v_pk_mul_f32 v[214:215], v[214:215], v[52:53]
  v_cvt_pk_bf16_f32 v208, v208, v209
  v_cvt_pk_bf16_f32 v209, v210, v211
  v_cvt_pk_bf16_f32 v210, v212, v213
  v_cvt_pk_bf16_f32 v211, v214, v215
  buffer_store_dwordx4 v[208:211], v2, s[16:19], s58 offen offset:3072 sc1
  v_pk_mul_f32 v[200:201], v[200:201], v[48:49]
  v_pk_mul_f32 v[202:203], v[202:203], v[48:49]
  v_pk_mul_f32 v[204:205], v[204:205], v[48:49]
  v_pk_mul_f32 v[206:207], v[206:207], v[48:49]
  v_cvt_pk_bf16_f32 v200, v200, v201
  v_cvt_pk_bf16_f32 v201, v202, v203
  v_cvt_pk_bf16_f32 v202, v204, v205
  v_cvt_pk_bf16_f32 v203, v206, v207
  buffer_store_dwordx4 v[200:203], v2, s[16:19], s58 offen offset:2048 sc1
  v_pk_mul_f32 v[192:193], v[192:193], v[44:45]
  v_pk_mul_f32 v[194:195], v[194:195], v[44:45]
  v_pk_mul_f32 v[196:197], v[196:197], v[44:45]
  v_pk_mul_f32 v[198:199], v[198:199], v[44:45]
  v_cvt_pk_bf16_f32 v192, v192, v193
  v_cvt_pk_bf16_f32 v193, v194, v195
  v_cvt_pk_bf16_f32 v194, v196, v197
  v_cvt_pk_bf16_f32 v195, v198, v199
  buffer_store_dwordx4 v[192:195], v2, s[16:19], s58 offen offset:1024 sc1
  v_pk_mul_f32 v[184:185], v[184:185], v[40:41]
  v_pk_mul_f32 v[186:187], v[186:187], v[40:41]
  v_pk_mul_f32 v[188:189], v[188:189], v[40:41]
  v_pk_mul_f32 v[190:191], v[190:191], v[40:41]
  v_cvt_pk_bf16_f32 v184, v184, v185
  v_cvt_pk_bf16_f32 v185, v186, v187
  v_cvt_pk_bf16_f32 v186, v188, v189
  v_cvt_pk_bf16_f32 v187, v190, v191
  buffer_store_dwordx4 v[184:187], v2, s[16:19], s58 offen offset:0 sc1
  v_pk_mul_f32 v[176:177], v[176:177], v[36:37]
  v_pk_mul_f32 v[178:179], v[178:179], v[36:37]
  v_pk_mul_f32 v[180:181], v[180:181], v[36:37]
  v_pk_mul_f32 v[182:183], v[182:183], v[36:37]
  v_cvt_pk_bf16_f32 v176, v176, v177
  v_cvt_pk_bf16_f32 v177, v178, v179
  v_cvt_pk_bf16_f32 v178, v180, v181
  v_cvt_pk_bf16_f32 v179, v182, v183
  buffer_store_dwordx4 v[176:179], v2, s[16:19], s57 offen offset:3072 sc1
  v_pk_mul_f32 v[168:169], v[168:169], v[32:33]
  v_pk_mul_f32 v[170:171], v[170:171], v[32:33]
  v_pk_mul_f32 v[172:173], v[172:173], v[32:33]
  v_pk_mul_f32 v[174:175], v[174:175], v[32:33]
  v_cvt_pk_bf16_f32 v168, v168, v169
  v_cvt_pk_bf16_f32 v169, v170, v171
  v_cvt_pk_bf16_f32 v170, v172, v173
  v_cvt_pk_bf16_f32 v171, v174, v175
  buffer_store_dwordx4 v[168:171], v2, s[16:19], s57 offen offset:2048 sc1
  v_pk_mul_f32 v[160:161], v[160:161], v[28:29]
  v_pk_mul_f32 v[162:163], v[162:163], v[28:29]
  v_pk_mul_f32 v[164:165], v[164:165], v[28:29]
  v_pk_mul_f32 v[166:167], v[166:167], v[28:29]
  v_cvt_pk_bf16_f32 v160, v160, v161
  v_cvt_pk_bf16_f32 v161, v162, v163
  v_cvt_pk_bf16_f32 v162, v164, v165
  v_cvt_pk_bf16_f32 v163, v166, v167
  buffer_store_dwordx4 v[160:163], v2, s[16:19], s57 offen offset:1024 sc1
  v_pk_mul_f32 v[152:153], v[152:153], v[24:25]
  v_pk_mul_f32 v[154:155], v[154:155], v[24:25]
  v_pk_mul_f32 v[156:157], v[156:157], v[24:25]
  v_pk_mul_f32 v[158:159], v[158:159], v[24:25]
  v_cvt_pk_bf16_f32 v152, v152, v153
  v_cvt_pk_bf16_f32 v153, v154, v155
  v_cvt_pk_bf16_f32 v154, v156, v157
  v_cvt_pk_bf16_f32 v155, v158, v159
  buffer_store_dwordx4 v[152:155], v2, s[16:19], s57 offen offset:0 sc1
  s_lshl_b32 s34, s32, 4
  s_add_u32 s34, s34, s33
  s_lshl_b32 s34, s34, 7
  s_add_u32 s34, s34, 32768
  s_mov_b32 s63, 0x70000000
Lp3:
  v_accvgpr_read_b32 v16, a230
  v_accvgpr_read_b32 v17, a231
  v_accvgpr_read_b32 v18, a232
  v_accvgpr_read_b32 v19, a233
  v_accvgpr_read_b32 v20, a234
  v_accvgpr_read_b32 v21, a235
  s_mov_b32 s89, 0
  s_mov_b32 s91, 4294901760
  s_mov_b32 s92, 32768
  s_mov_b32 s89, 1
  s_mov_b32 s69, 0
  s_mov_b32 s71, 4294934528
  s_mov_b32 s72, 16384
  s_waitcnt vmcnt(28)
  s_barrier
  ds_read_b128 a[0:3], v16 offset:0
  ds_read_b64_tr_b16 a[32:33], v18 offset:0
  ds_read_b64_tr_b16 a[34:35], v18 offset:2048
  ds_read_b128 a[4:7], v16 offset:2048
  ds_read_b128 a[8:11], v16 offset:4096
  ds_read_b128 a[12:15], v16 offset:6144
  ds_read_b64_tr_b16 a[36:37], v19 offset:0
  ds_read_b64_tr_b16 a[38:39], v19 offset:2048
  ds_read_b64_tr_b16 a[40:41], v20 offset:0
  ds_read_b64_tr_b16 a[42:43], v20 offset:2048
  ds_read_b64_tr_b16 a[44:45], v21 offset:0
  ds_read_b64_tr_b16 a[46:47], v21 offset:2048
  ds_read_b64_tr_b16 a[48:49], v18 offset:8192
  ds_read_b64_tr_b16 a[50:51], v18 offset:10240
  ds_read_b64_tr_b16 a[52:53], v19 offset:8192
  ds_read_b64_tr_b16 a[54:55], v19 offset:10240
  ds_read_b64_tr_b16 a[56:57], v20 offset:8192
  ds_read_b64_tr_b16 a[58:59], v20 offset:10240
  ds_read_b64_tr_b16 a[60:61], v21 offset:8192
  ds_read_b64_tr_b16 a[62:63], v21 offset:10240
  s_waitcnt lgkmcnt(0)
  v_mfma_f32_16x16x32_bf16 v[32:35], a[32:35], a[0:3], 0
  s_add_u32 s60, s63, 32768
  buffer_store_dwordx4 v[192:195], v2, s[16:19], s60 offen offset:0 sc1
  ds_read_b128 a[16:19], v17 offset:0
  v_mfma_f32_16x16x32_bf16 v[64:67], a[32:35], a[4:7], 0
  s_add_u32 s60, s63, 40960
  ds_read_b64_tr_b16 a[64:65], v18 offset:4096
  v_mfma_f32_16x16x32_bf16 v[96:99], a[32:35], a[8:11], 0
  ds_read_b64_tr_b16 a[66:67], v18 offset:6144
  v_mfma_f32_16x16x32_bf16 v[128:131], a[32:35], a[12:15], 0
  ds_read_b128 a[20:23], v17 offset:2048
  v_mfma_f32_16x16x32_bf16 v[36:39], a[36:39], a[0:3], 0
  ds_read_b128 a[24:27], v17 offset:4096
  v_mfma_f32_16x16x32_bf16 v[68:71], a[36:39], a[4:7], 0
  ds_read_b128 a[28:31], v17 offset:6144
  v_mfma_f32_16x16x32_bf16 v[100:103], a[36:39], a[8:11], 0
  ds_read_b64_tr_b16 a[68:69], v19 offset:4096
  v_mfma_f32_16x16x32_bf16 v[132:135], a[36:39], a[12:15], 0
  ds_read_b64_tr_b16 a[70:71], v19 offset:6144
  v_mfma_f32_16x16x32_bf16 v[40:43], a[40:43], a[0:3], 0
  ds_read_b64_tr_b16 a[72:73], v20 offset:4096
  v_mfma_f32_16x16x32_bf16 v[72:75], a[40:43], a[4:7], 0
  ds_read_b64_tr_b16 a[74:75], v20 offset:6144
  v_mfma_f32_16x16x32_bf16 v[104:107], a[40:43], a[8:11], 0
  v_mfma_f32_16x16x32_bf16 v[136:139], a[40:43], a[12:15], 0
  ds_read_b64_tr_b16 a[76:77], v21 offset:4096
  v_mfma_f32_16x16x32_bf16 v[44:47], a[44:47], a[0:3], 0
  buffer_store_dwordx4 v[224:227], v2, s[16:19], s60 offen offset:0 sc1
  ds_read_b64_tr_b16 a[78:79], v21 offset:6144
  v_mfma_f32_16x16x32_bf16 v[76:79], a[44:47], a[4:7], 0
  s_add_u32 s89, s89, 1
  s_cmp_eq_u32 s89, 3
  s_cselect_b32 s89, 0, s89
  s_cselect_b32 s90, s91, s92
  ds_read_b64_tr_b16 a[80:81], v18 offset:12288
  v_mfma_f32_16x16x32_bf16 v[108:111], a[44:47], a[8:11], 0
  s_add_u32 s69, s69, 1
  s_cmp_eq_u32 s69, 3
  s_cselect_b32 s69, 0, s69
  s_cselect_b32 s70, s71, s72
  ds_read_b64_tr_b16 a[82:83], v18 offset:14336
  v_mfma_f32_16x16x32_bf16 v[140:143], a[44:47], a[12:15], 0
  ds_read_b64_tr_b16 a[84:85], v19 offset:12288
  v_mfma_f32_16x16x32_bf16 v[48:51], a[48:51], a[0:3], 0
  ds_read_b64_tr_b16 a[86:87], v19 offset:14336
  v_mfma_f32_16x16x32_bf16 v[80:83], a[48:51], a[4:7], 0
  ds_read_b64_tr_b16 a[88:89], v20 offset:12288
  v_mfma_f32_16x16x32_bf16 v[112:115], a[48:51], a[8:11], 0
  ds_read_b64_tr_b16 a[90:91], v20 offset:14336
  v_mfma_f32_16x16x32_bf16 v[144:147], a[48:51], a[12:15], 0
  ds_read_b64_tr_b16 a[92:93], v21 offset:12288
  v_mfma_f32_16x16x32_bf16 v[52:55], a[52:55], a[0:3], 0
  ds_read_b64_tr_b16 a[94:95], v21 offset:14336
  v_mfma_f32_16x16x32_bf16 v[84:87], a[52:55], a[4:7], 0
  v_add_u32 v16, s90, v16
  v_add_u32 v17, s90, v17
  v_mfma_f32_16x16x32_bf16 v[116:119], a[52:55], a[8:11], 0
  v_add_u32 v18, s70, v18
  v_add_u32 v19, s70, v19
  v_mfma_f32_16x16x32_bf16 v[148:151], a[52:55], a[12:15], 0
  v_add_u32 v20, s70, v20
  v_add_u32 v21, s70, v21
  v_mfma_f32_16x16x32_bf16 v[56:59], a[56:59], a[0:3], 0
  v_mfma_f32_16x16x32_bf16 v[88:91], a[56:59], a[4:7], 0
  v_mfma_f32_16x16x32_bf16 v[120:123], a[56:59], a[8:11], 0
  v_mfma_f32_16x16x32_bf16 v[152:155], a[56:59], a[12:15], 0
  v_mfma_f32_16x16x32_bf16 v[60:63], a[60:63], a[0:3], 0
  v_mfma_f32_16x16x32_bf16 v[92:95], a[60:63], a[4:7], 0
  v_mfma_f32_16x16x32_bf16 v[124:127], a[60:63], a[8:11], 0
  v_mfma_f32_16x16x32_bf16 v[156:159], a[60:63], a[12:15], 0
  s_waitcnt vmcnt(14) lgkmcnt(0)
  s_barrier
  v_mfma_f32_16x16x32_bf16 v[32:35], a[64:67], a[16:19], v[32:35]
  s_mov_b32 m0, s68
  ds_read_b128 a[0:3], v16 offset:0
  v_mfma_f32_16x16x32_bf16 v[64:67], a[64:67], a[20:23], v[64:67]
  buffer_load_dwordx4 v8, s[20:23], s28 offen offset:0 lds
  ds_read_b64_tr_b16 a[32:33], v18 offset:0
  v_mfma_f32_16x16x32_bf16 v[96:99], a[64:67], a[24:27], v[96:99]
  ds_read_b64_tr_b16 a[34:35], v18 offset:2048
  v_mfma_f32_16x16x32_bf16 v[128:131], a[64:67], a[28:31], v[128:131]
  ds_read_b128 a[4:7], v16 offset:2048
  v_mfma_f32_16x16x32_bf16 v[36:39], a[68:71], a[16:19], v[36:39]
  buffer_load_dwordx4 v9, s[20:23], s28 offen offset:1024 lds
  ds_read_b128 a[8:11], v16 offset:4096
  v_mfma_f32_16x16x32_bf16 v[68:71], a[68:71], a[20:23], v[68:71]
  ds_read_b128 a[12:15], v16 offset:6144
  v_mfma_f32_16x16x32_bf16 v[100:103], a[68:71], a[24:27], v[100:103]
  ds_read_b64_tr_b16 a[36:37], v19 offset:0
  v_mfma_f32_16x16x32_bf16 v[132:135], a[68:71], a[28:31], v[132:135]
  ds_read_b64_tr_b16 a[38:39], v19 offset:2048
  v_mfma_f32_16x16x32_bf16 v[40:43], a[72:75], a[16:19], v[40:43]
  buffer_load_dwordx4 v10, s[20:23], s28 offen offset:2048 lds
  ds_read_b64_tr_b16 a[40:41], v20 offset:0
  v_mfma_f32_16x16x32_bf16 v[72:75], a[72:75], a[20:23], v[72:75]
  ds_read_b64_tr_b16 a[42:43], v20 offset:2048
  v_mfma_f32_16x16x32_bf16 v[104:107], a[72:75], a[24:27], v[104:107]
  v_mfma_f32_16x16x32_bf16 v[136:139], a[72:75], a[28:31], v[136:139]
  ds_read_b64_tr_b16 a[44:45], v21 offset:0
  v_mfma_f32_16x16x32_bf16 v[44:47], a[76:79], a[16:19], v[44:47]
  ds_read_b64_tr_b16 a[46:47], v21 offset:2048
  v_mfma_f32_16x16x32_bf16 v[76:79], a[76:79], a[20:23], v[76:79]
  buffer_load_dwordx4 v11, s[20:23], s28 offen offset:3072 lds
  ds_read_b64_tr_b16 a[48:49], v18 offset:8192
  v_mfma_f32_16x16x32_bf16 v[108:111], a[76:79], a[24:27], v[108:111]
  s_bfe_u32 s56, 0x302010e, s55
  s_add_u32 s54, s54, s56
  s_add_u32 s55, s55, 8
  v_mfma_f32_16x16x32_bf16 v[140:143], a[76:79], a[28:31], v[140:143]
  s_and_b32 s55, s55, 0x8001f
  s_and_b32 s54, s54, 15
  s_lshl_b32 s28, s54, 19
  v_mfma_f32_16x16x32_bf16 v[48:51], a[80:83], a[16:19], v[48:51]
  s_mov_b32 m0, s88
  ds_read_b64_tr_b16 a[50:51], v18 offset:10240
  ds_read_b64_tr_b16 a[52:53], v19 offset:8192
  v_mfma_f32_16x16x32_bf16 v[80:83], a[80:83], a[20:23], v[80:83]
  buffer_load_dwordx4 v4, s[8:11], s26 offen offset:0 lds
  ds_read_b64_tr_b16 a[54:55], v19 offset:10240
  v_mfma_f32_16x16x32_bf16 v[112:115], a[80:83], a[24:27], v[112:115]
  ds_read_b64_tr_b16 a[56:57], v20 offset:8192
  ds_read_b64_tr_b16 a[58:59], v20 offset:10240
  v_mfma_f32_16x16x32_bf16 v[144:147], a[80:83], a[28:31], v[144:147]
  ds_read_b64_tr_b16 a[60:61], v21 offset:8192
  v_mfma_f32_16x16x32_bf16 v[52:55], a[84:87], a[16:19], v[52:55]
  ds_read_b64_tr_b16 a[62:63], v21 offset:10240
  v_mfma_f32_16x16x32_bf16 v[84:87], a[84:87], a[20:23], v[84:87]
  v_mfma_f32_16x16x32_bf16 v[116:119], a[84:87], a[24:27], v[116:119]
  buffer_load_dwordx4 v5, s[8:11], s26 offen offset:1024 lds
  v_mfma_f32_16x16x32_bf16 v[148:151], a[84:87], a[28:31], v[148:151]
  v_mfma_f32_16x16x32_bf16 v[56:59], a[88:91], a[16:19], v[56:59]
  v_mfma_f32_16x16x32_bf16 v[88:91], a[88:91], a[20:23], v[88:91]
  v_mfma_f32_16x16x32_bf16 v[120:123], a[88:91], a[24:27], v[120:123]
  buffer_load_dwordx4 v6, s[8:11], s26 offen offset:2048 lds
  v_mfma_f32_16x16x32_bf16 v[152:155], a[88:91], a[28:31], v[152:155]
  v_mfma_f32_16x16x32_bf16 v[60:63], a[92:95], a[16:19], v[60:63]
  v_mfma_f32_16x16x32_bf16 v[92:95], a[92:95], a[20:23], v[92:95]
  v_mfma_f32_16x16x32_bf16 v[124:127], a[92:95], a[24:27], v[124:127]
  v_mfma_f32_16x16x32_bf16 v[156:159], a[92:95], a[28:31], v[156:159]
  s_waitcnt lgkmcnt(0)
  v_mfma_f32_16x16x32_bf16 v[32:35], a[32:35], a[0:3], v[32:35]
  buffer_load_dwordx4 v7, s[8:11], s26 offen offset:3072 lds
  ds_read_b128 a[16:19], v17 offset:0
  v_mfma_f32_16x16x32_bf16 v[64:67], a[32:35], a[4:7], v[64:67]
  s_add_u32 m0, s88, 4096
  ds_read_b64_tr_b16 a[64:65], v18 offset:4096
  v_mfma_f32_16x16x32_bf16 v[96:99], a[32:35], a[8:11], v[96:99]
  ds_read_b64_tr_b16 a[66:67], v18 offset:6144
  v_mfma_f32_16x16x32_bf16 v[128:131], a[32:35], a[12:15], v[128:131]
  buffer_load_dwordx4 v4, s[8:11], s27 offen offset:0 lds
  ds_read_b128 a[20:23], v17 offset:2048
  v_mfma_f32_16x16x32_bf16 v[36:39], a[36:39], a[0:3], v[36:39]
  ds_read_b128 a[24:27], v17 offset:4096
  v_mfma_f32_16x16x32_bf16 v[68:71], a[36:39], a[4:7], v[68:71]
  ds_read_b128 a[28:31], v17 offset:6144
  v_mfma_f32_16x16x32_bf16 v[100:103], a[36:39], a[8:11], v[100:103]
  ds_read_b64_tr_b16 a[68:69], v19 offset:4096
  v_mfma_f32_16x16x32_bf16 v[132:135], a[36:39], a[12:15], v[132:135]
  buffer_load_dwordx4 v5, s[8:11], s27 offen offset:1024 lds
  ds_read_b64_tr_b16 a[70:71], v19 offset:6144
  v_mfma_f32_16x16x32_bf16 v[40:43], a[40:43], a[0:3], v[40:43]
  ds_read_b64_tr_b16 a[72:73], v20 offset:4096
  v_mfma_f32_16x16x32_bf16 v[72:75], a[40:43], a[4:7], v[72:75]
  ds_read_b64_tr_b16 a[74:75], v20 offset:6144
  v_mfma_f32_16x16x32_bf16 v[104:107], a[40:43], a[8:11], v[104:107]
  buffer_load_dwordx4 v6, s[8:11], s27 offen offset:2048 lds
  v_mfma_f32_16x16x32_bf16 v[136:139], a[40:43], a[12:15], v[136:139]
  ds_read_b64_tr_b16 a[76:77], v21 offset:4096
  v_mfma_f32_16x16x32_bf16 v[44:47], a[44:47], a[0:3], v[44:47]
  ds_read_b64_tr_b16 a[78:79], v21 offset:6144
  v_mfma_f32_16x16x32_bf16 v[76:79], a[44:47], a[4:7], v[76:79]
  ds_read_b64_tr_b16 a[80:81], v18 offset:12288
  v_mfma_f32_16x16x32_bf16 v[108:111], a[44:47], a[8:11], v[108:111]
  buffer_load_dwordx4 v7, s[8:11], s27 offen offset:3072 lds
  ds_read_b64_tr_b16 a[82:83], v18 offset:14336
  v_mfma_f32_16x16x32_bf16 v[140:143], a[44:47], a[12:15], v[140:143]
  s_bfe_u32 s29, 0x302010e, s53
  s_add_u32 s52, s52, s29
  s_add_u32 s53, s53, 8
  v_mfma_f32_16x16x32_bf16 v[48:51], a[48:51], a[0:3], v[48:51]
  s_and_b32 s53, s53, 0x8001f
  s_and_b32 s52, s52, 15
  s_lshl_b32 s29, s52, 7
  v_mfma_f32_16x16x32_bf16 v[80:83], a[48:51], a[4:7], v[80:83]
  s_or_b32 s26, s30, s29
  s_or_b32 s27, s31, s29
  s_add_u32 s60, s63, 32768
  v_mfma_f32_16x16x32_bf16 v[112:115], a[48:51], a[8:11], v[112:115]
  buffer_store_dwordx4 v[196:199], v2, s[16:19], s60 offen offset:1024 sc1
  ds_read_b64_tr_b16 a[84:85], v19 offset:12288
  v_mfma_f32_16x16x32_bf16 v[144:147], a[48:51], a[12:15], v[144:147]
  s_add_u32 s60, s63, 40960
  ds_read_b64_tr_b16 a[86:87], v19 offset:14336
  ds_read_b64_tr_b16 a[88:89], v20 offset:12288
  v_mfma_f32_16x16x32_bf16 v[52:55], a[52:55], a[0:3], v[52:55]
  ds_read_b64_tr_b16 a[90:91], v20 offset:14336
  ds_read_b64_tr_b16 a[92:93], v21 offset:12288
  v_mfma_f32_16x16x32_bf16 v[84:87], a[52:55], a[4:7], v[84:87]
  buffer_store_dwordx4 v[228:231], v2, s[16:19], s60 offen offset:1024 sc1
  ds_read_b64_tr_b16 a[94:95], v21 offset:14336
  v_mfma_f32_16x16x32_bf16 v[116:119], a[52:55], a[8:11], v[116:119]
  s_add_u32 s88, s88, s90
  s_add_u32 s89, s89, 1
  s_cmp_eq_u32 s89, 3
  s_cselect_b32 s89, 0, s89
  s_cselect_b32 s90, s91, s92
  v_mfma_f32_16x16x32_bf16 v[148:151], a[52:55], a[12:15], v[148:151]
  s_add_u32 s68, s68, s70
  s_add_u32 s69, s69, 1
  s_cmp_eq_u32 s69, 3
  s_cselect_b32 s69, 0, s69
  s_cselect_b32 s70, s71, s72
  v_mfma_f32_16x16x32_bf16 v[56:59], a[56:59], a[0:3], v[56:59]
  v_add_u32 v16, s90, v16
  v_add_u32 v17, s90, v17
  v_mfma_f32_16x16x32_bf16 v[88:91], a[56:59], a[4:7], v[88:91]
  v_add_u32 v18, s70, v18
  v_add_u32 v19, s70, v19
  v_mfma_f32_16x16x32_bf16 v[120:123], a[56:59], a[8:11], v[120:123]
  v_add_u32 v20, s70, v20
  v_add_u32 v21, s70, v21
  v_mfma_f32_16x16x32_bf16 v[152:155], a[56:59], a[12:15], v[152:155]
  v_mfma_f32_16x16x32_bf16 v[60:63], a[60:63], a[0:3], v[60:63]
  v_mfma_f32_16x16x32_bf16 v[92:95], a[60:63], a[4:7], v[92:95]
  v_mfma_f32_16x16x32_bf16 v[124:127], a[60:63], a[8:11], v[124:127]
  v_mfma_f32_16x16x32_bf16 v[156:159], a[60:63], a[12:15], v[156:159]
  s_waitcnt vmcnt(16) lgkmcnt(0)
  s_barrier
  v_mfma_f32_16x16x32_bf16 v[32:35], a[64:67], a[16:19], v[32:35]
  s_mov_b32 m0, s68
  ds_read_b128 a[0:3], v16 offset:0
  v_mfma_f32_16x16x32_bf16 v[64:67], a[64:67], a[20:23], v[64:67]
  buffer_load_dwordx4 v8, s[20:23], s28 offen offset:0 lds
  ds_read_b64_tr_b16 a[32:33], v18 offset:0
  v_mfma_f32_16x16x32_bf16 v[96:99], a[64:67], a[24:27], v[96:99]
  ds_read_b64_tr_b16 a[34:35], v18 offset:2048
  v_mfma_f32_16x16x32_bf16 v[128:131], a[64:67], a[28:31], v[128:131]
  ds_read_b128 a[4:7], v16 offset:2048
  v_mfma_f32_16x16x32_bf16 v[36:39], a[68:71], a[16:19], v[36:39]
  buffer_load_dwordx4 v9, s[20:23], s28 offen offset:1024 lds
  ds_read_b128 a[8:11], v16 offset:4096
  v_mfma_f32_16x16x32_bf16 v[68:71], a[68:71], a[20:23], v[68:71]
  ds_read_b128 a[12:15], v16 offset:6144
  v_mfma_f32_16x16x32_bf16 v[100:103], a[68:71], a[24:27], v[100:103]
  ds_read_b64_tr_b16 a[36:37], v19 offset:0
  v_mfma_f32_16x16x32_bf16 v[132:135], a[68:71], a[28:31], v[132:135]
  ds_read_b64_tr_b16 a[38:39], v19 offset:2048
  v_mfma_f32_16x16x32_bf16 v[40:43], a[72:75], a[16:19], v[40:43]
  buffer_load_dwordx4 v10, s[20:23], s28 offen offset:2048 lds
  ds_read_b64_tr_b16 a[40:41], v20 offset:0
  v_mfma_f32_16x16x32_bf16 v[72:75], a[72:75], a[20:23], v[72:75]
  ds_read_b64_tr_b16 a[42:43], v20 offset:2048
  v_mfma_f32_16x16x32_bf16 v[104:107], a[72:75], a[24:27], v[104:107]
  v_mfma_f32_16x16x32_bf16 v[136:139], a[72:75], a[28:31], v[136:139]
  ds_read_b64_tr_b16 a[44:45], v21 offset:0
  v_mfma_f32_16x16x32_bf16 v[44:47], a[76:79], a[16:19], v[44:47]
  ds_read_b64_tr_b16 a[46:47], v21 offset:2048
  v_mfma_f32_16x16x32_bf16 v[76:79], a[76:79], a[20:23], v[76:79]
  buffer_load_dwordx4 v11, s[20:23], s28 offen offset:3072 lds
  ds_read_b64_tr_b16 a[48:49], v18 offset:8192
  v_mfma_f32_16x16x32_bf16 v[108:111], a[76:79], a[24:27], v[108:111]
  s_bfe_u32 s56, 0x302010e, s55
  s_add_u32 s54, s54, s56
  s_add_u32 s55, s55, 8
  v_mfma_f32_16x16x32_bf16 v[140:143], a[76:79], a[28:31], v[140:143]
  s_and_b32 s55, s55, 0x8001f
  s_and_b32 s54, s54, 15
  s_lshl_b32 s28, s54, 19
  v_mfma_f32_16x16x32_bf16 v[48:51], a[80:83], a[16:19], v[48:51]
  s_mov_b32 m0, s88
  ds_read_b64_tr_b16 a[50:51], v18 offset:10240
  ds_read_b64_tr_b16 a[52:53], v19 offset:8192
  v_mfma_f32_16x16x32_bf16 v[80:83], a[80:83], a[20:23], v[80:83]
  buffer_load_dwordx4 v4, s[8:11], s26 offen offset:0 lds
  ds_read_b64_tr_b16 a[54:55], v19 offset:10240
  v_mfma_f32_16x16x32_bf16 v[112:115], a[80:83], a[24:27], v[112:115]
  ds_read_b64_tr_b16 a[56:57], v20 offset:8192
  ds_read_b64_tr_b16 a[58:59], v20 offset:10240
  v_mfma_f32_16x16x32_bf16 v[144:147], a[80:83], a[28:31], v[144:147]
  ds_read_b64_tr_b16 a[60:61], v21 offset:8192
  v_mfma_f32_16x16x32_bf16 v[52:55], a[84:87], a[16:19], v[52:55]
  ds_read_b64_tr_b16 a[62:63], v21 offset:10240
  v_mfma_f32_16x16x32_bf16 v[84:87], a[84:87], a[20:23], v[84:87]
  v_mfma_f32_16x16x32_bf16 v[116:119], a[84:87], a[24:27], v[116:119]
  buffer_load_dwordx4 v5, s[8:11], s26 offen offset:1024 lds
  v_mfma_f32_16x16x32_bf16 v[148:151], a[84:87], a[28:31], v[148:151]
  v_mfma_f32_16x16x32_bf16 v[56:59], a[88:91], a[16:19], v[56:59]
  v_mfma_f32_16x16x32_bf16 v[88:91], a[88:91], a[20:23], v[88:91]
  v_mfma_f32_16x16x32_bf16 v[120:123], a[88:91], a[24:27], v[120:123]
  buffer_load_dwordx4 v6, s[8:11], s26 offen offset:2048 lds
  v_mfma_f32_16x16x32_bf16 v[152:155], a[88:91], a[28:31], v[152:155]
  v_mfma_f32_16x16x32_bf16 v[60:63], a[92:95], a[16:19], v[60:63]
  v_mfma_f32_16x16x32_bf16 v[92:95], a[92:95], a[20:23], v[92:95]
  v_mfma_f32_16x16x32_bf16 v[124:127], a[92:95], a[24:27], v[124:127]
  v_mfma_f32_16x16x32_bf16 v[156:159], a[92:95], a[28:31], v[156:159]
  s_waitcnt lgkmcnt(0)
  v_mfma_f32_16x16x32_bf16 v[32:35], a[32:35], a[0:3], v[32:35]
  buffer_load_dwordx4 v7, s[8:11], s26 offen offset:3072 lds
  ds_read_b128 a[16:19], v17 offset:0
  v_mfma_f32_16x16x32_bf16 v[64:67], a[32:35], a[4:7], v[64:67]
  s_add_u32 m0, s88, 4096
  ds_read_b64_tr_b16 a[64:65], v18 offset:4096
  v_mfma_f32_16x16x32_bf16 v[96:99], a[32:35], a[8:11], v[96:99]
  ds_read_b64_tr_b16 a[66:67], v18 offset:6144
  v_mfma_f32_16x16x32_bf16 v[128:131], a[32:35], a[12:15], v[128:131]
  buffer_load_dwordx4 v4, s[8:11], s27 offen offset:0 lds
  ds_read_b128 a[20:23], v17 offset:2048
  v_mfma_f32_16x16x32_bf16 v[36:39], a[36:39], a[0:3], v[36:39]
  ds_read_b128 a[24:27], v17 offset:4096
  v_mfma_f32_16x16x32_bf16 v[68:71], a[36:39], a[4:7], v[68:71]
  ds_read_b128 a[28:31], v17 offset:6144
  v_mfma_f32_16x16x32_bf16 v[100:103], a[36:39], a[8:11], v[100:103]
  ds_read_b64_tr_b16 a[68:69], v19 offset:4096
  v_mfma_f32_16x16x32_bf16 v[132:135], a[36:39], a[12:15], v[132:135]
  buffer_load_dwordx4 v5, s[8:11], s27 offen offset:1024 lds
  ds_read_b64_tr_b16 a[70:71], v19 offset:6144
  v_mfma_f32_16x16x32_bf16 v[40:43], a[40:43], a[0:3], v[40:43]
  ds_read_b64_tr_b16 a[72:73], v20 offset:4096
  v_mfma_f32_16x16x32_bf16 v[72:75], a[40:43], a[4:7], v[72:75]
  ds_read_b64_tr_b16 a[74:75], v20 offset:6144
  v_mfma_f32_16x16x32_bf16 v[104:107], a[40:43], a[8:11], v[104:107]
  buffer_load_dwordx4 v6, s[8:11], s27 offen offset:2048 lds
  v_mfma_f32_16x16x32_bf16 v[136:139], a[40:43], a[12:15], v[136:139]
  ds_read_b64_tr_b16 a[76:77], v21 offset:4096
  v_mfma_f32_16x16x32_bf16 v[44:47], a[44:47], a[0:3], v[44:47]
  ds_read_b64_tr_b16 a[78:79], v21 offset:6144
  v_mfma_f32_16x16x32_bf16 v[76:79], a[44:47], a[4:7], v[76:79]
  ds_read_b64_tr_b16 a[80:81], v18 offset:12288
  v_mfma_f32_16x16x32_bf16 v[108:111], a[44:47], a[8:11], v[108:111]
  buffer_load_dwordx4 v7, s[8:11], s27 offen offset:3072 lds
  ds_read_b64_tr_b16 a[82:83], v18 offset:14336
  v_mfma_f32_16x16x32_bf16 v[140:143], a[44:47], a[12:15], v[140:143]
  s_bfe_u32 s29, 0x302010e, s53
  s_add_u32 s52, s52, s29
  s_add_u32 s53, s53, 8
  v_mfma_f32_16x16x32_bf16 v[48:51], a[48:51], a[0:3], v[48:51]
  s_and_b32 s53, s53, 0x8001f
  s_and_b32 s52, s52, 15
  s_lshl_b32 s29, s52, 7
  v_mfma_f32_16x16x32_bf16 v[80:83], a[48:51], a[4:7], v[80:83]
  s_or_b32 s26, s30, s29
  s_or_b32 s27, s31, s29
  s_add_u32 s60, s63, 32768
  v_mfma_f32_16x16x32_bf16 v[112:115], a[48:51], a[8:11], v[112:115]
  buffer_store_dwordx4 v[200:203], v2, s[16:19], s60 offen offset:2048 sc1
  ds_read_b64_tr_b16 a[84:85], v19 offset:12288
  v_mfma_f32_16x16x32_bf16 v[144:147], a[48:51], a[12:15], v[144:147]
  s_add_u32 s60, s63, 40960
  ds_read_b64_tr_b16 a[86:87], v19 offset:14336
  ds_read_b64_tr_b16 a[88:89], v20 offset:12288
  v_mfma_f32_16x16x32_bf16 v[52:55], a[52:55], a[0:3], v[52:55]
  ds_read_b64_tr_b16 a[90:91], v20 offset:14336
  ds_read_b64_tr_b16 a[92:93], v21 offset:12288
  v_mfma_f32_16x16x32_bf16 v[84:87], a[52:55], a[4:7], v[84:87]
  buffer_store_dwordx4 v[232:235], v2, s[16:19], s60 offen offset:2048 sc1
  ds_read_b64_tr_b16 a[94:95], v21 offset:14336
  v_mfma_f32_16x16x32_bf16 v[116:119], a[52:55], a[8:11], v[116:119]
  s_add_u32 s88, s88, s90
  s_add_u32 s89, s89, 1
  s_cmp_eq_u32 s89, 3
  s_cselect_b32 s89, 0, s89
  s_cselect_b32 s90, s91, s92
  v_mfma_f32_16x16x32_bf16 v[148:151], a[52:55], a[12:15], v[148:151]
  s_add_u32 s68, s68, s70
  s_add_u32 s69, s69, 1
  s_cmp_eq_u32 s69, 3
  s_cselect_b32 s69, 0, s69
  s_cselect_b32 s70, s71, s72
  v_mfma_f32_16x16x32_bf16 v[56:59], a[56:59], a[0:3], v[56:59]
  v_add_u32 v16, s90, v16
  v_add_u32 v17, s90, v17
  v_mfma_f32_16x16x32_bf16 v[88:91], a[56:59], a[4:7], v[88:91]
  v_add_u32 v18, s70, v18
  v_add_u32 v19, s70, v19
  v_mfma_f32_16x16x32_bf16 v[120:123], a[56:59], a[8:11], v[120:123]
  v_add_u32 v20, s70, v20
  v_add_u32 v21, s70, v21
  v_mfma_f32_16x16x32_bf16 v[152:155], a[56:59], a[12:15], v[152:155]
  v_mfma_f32_16x16x32_bf16 v[60:63], a[60:63], a[0:3], v[60:63]
  v_mfma_f32_16x16x32_bf16 v[92:95], a[60:63], a[4:7], v[92:95]
  v_mfma_f32_16x16x32_bf16 v[124:127], a[60:63], a[8:11], v[124:127]
  v_mfma_f32_16x16x32_bf16 v[156:159], a[60:63], a[12:15], v[156:159]
  s_waitcnt vmcnt(16) lgkmcnt(0)
  s_barrier
  v_mfma_f32_16x16x32_bf16 v[32:35], a[64:67], a[16:19], v[32:35]
  s_mov_b32 m0, s68
  ds_read_b128 a[0:3], v16 offset:0
  v_mfma_f32_16x16x32_bf16 v[64:67], a[64:67], a[20:23], v[64:67]
  buffer_load_dwordx4 v8, s[20:23], s28 offen offset:0 lds
  ds_read_b64_tr_b16 a[32:33], v18 offset:0
  v_mfma_f32_16x16x32_bf16 v[96:99], a[64:67], a[24:27], v[96:99]
  ds_read_b64_tr_b16 a[34:35], v18 offset:2048
  v_mfma_f32_16x16x32_bf16 v[128:131], a[64:67], a[28:31], v[128:131]
  ds_read_b128 a[4:7], v16 offset:2048
  v_mfma_f32_16x16x32_bf16 v[36:39], a[68:71], a[16:19], v[36:39]
  buffer_load_dwordx4 v9, s[20:23], s28 offen offset:1024 lds
  ds_read_b128 a[8:11], v16 offset:4096
  v_mfma_f32_16x16x32_bf16 v[68:71], a[68:71], a[20:23], v[68:71]
  ds_read_b128 a[12:15], v16 offset:6144
  v_mfma_f32_16x16x32_bf16 v[100:103], a[68:71], a[24:27], v[100:103]
  ds_read_b64_tr_b16 a[36:37], v19 offset:0
  v_mfma_f32_16x16x32_bf16 v[132:135], a[68:71], a[28:31], v[132:135]
  ds_read_b64_tr_b16 a[38:39], v19 offset:2048
  v_mfma_f32_16x16x32_bf16 v[40:43], a[72:75], a[16:19], v[40:43]
  buffer_load_dwordx4 v10, s[20:23], s28 offen offset:2048 lds
  ds_read_b64_tr_b16 a[40:41], v20 offset:0
  v_mfma_f32_16x16x32_bf16 v[72:75], a[72:75], a[20:23], v[72:75]
  ds_read_b64_tr_b16 a[42:43], v20 offset:2048
  v_mfma_f32_16x16x32_bf16 v[104:107], a[72:75], a[24:27], v[104:107]
  v_mfma_f32_16x16x32_bf16 v[136:139], a[72:75], a[28:31], v[136:139]
  ds_read_b64_tr_b16 a[44:45], v21 offset:0
  v_mfma_f32_16x16x32_bf16 v[44:47], a[76:79], a[16:19], v[44:47]
  ds_read_b64_tr_b16 a[46:47], v21 offset:2048
  v_mfma_f32_16x16x32_bf16 v[76:79], a[76:79], a[20:23], v[76:79]
  buffer_load_dwordx4 v11, s[20:23], s28 offen offset:3072 lds
  ds_read_b64_tr_b16 a[48:49], v18 offset:8192
  v_mfma_f32_16x16x32_bf16 v[108:111], a[76:79], a[24:27], v[108:111]
  s_bfe_u32 s56, 0x302010e, s55
  s_add_u32 s54, s54, s56
  s_add_u32 s55, s55, 8
  v_mfma_f32_16x16x32_bf16 v[140:143], a[76:79], a[28:31], v[140:143]
  s_and_b32 s55, s55, 0x8001f
  s_and_b32 s54, s54, 15
  s_lshl_b32 s28, s54, 19
  v_mfma_f32_16x16x32_bf16 v[48:51], a[80:83], a[16:19], v[48:51]
  s_mov_b32 m0, s88
  ds_read_b64_tr_b16 a[50:51], v18 offset:10240
  ds_read_b64_tr_b16 a[52:53], v19 offset:8192
  v_mfma_f32_16x16x32_bf16 v[80:83], a[80:83], a[20:23], v[80:83]
  buffer_load_dwordx4 v4, s[8:11], s26 offen offset:0 lds
  ds_read_b64_tr_b16 a[54:55], v19 offset:10240
  v_mfma_f32_16x16x32_bf16 v[112:115], a[80:83], a[24:27], v[112:115]
  ds_read_b64_tr_b16 a[56:57], v20 offset:8192
  ds_read_b64_tr_b16 a[58:59], v20 offset:10240
  v_mfma_f32_16x16x32_bf16 v[144:147], a[80:83], a[28:31], v[144:147]
  ds_read_b64_tr_b16 a[60:61], v21 offset:8192
  v_mfma_f32_16x16x32_bf16 v[52:55], a[84:87], a[16:19], v[52:55]
  ds_read_b64_tr_b16 a[62:63], v21 offset:10240
  v_mfma_f32_16x16x32_bf16 v[84:87], a[84:87], a[20:23], v[84:87]
  v_mfma_f32_16x16x32_bf16 v[116:119], a[84:87], a[24:27], v[116:119]
  buffer_load_dwordx4 v5, s[8:11], s26 offen offset:1024 lds
  v_mfma_f32_16x16x32_bf16 v[148:151], a[84:87], a[28:31], v[148:151]
  v_mfma_f32_16x16x32_bf16 v[56:59], a[88:91], a[16:19], v[56:59]
  v_mfma_f32_16x16x32_bf16 v[88:91], a[88:91], a[20:23], v[88:91]
  v_mfma_f32_16x16x32_bf16 v[120:123], a[88:91], a[24:27], v[120:123]
  buffer_load_dwordx4 v6, s[8:11], s26 offen offset:2048 lds
  v_mfma_f32_16x16x32_bf16 v[152:155], a[88:91], a[28:31], v[152:155]
  v_mfma_f32_16x16x32_bf16 v[60:63], a[92:95], a[16:19], v[60:63]
  v_mfma_f32_16x16x32_bf16 v[92:95], a[92:95], a[20:23], v[92:95]
  v_mfma_f32_16x16x32_bf16 v[124:127], a[92:95], a[24:27], v[124:127]
  v_mfma_f32_16x16x32_bf16 v[156:159], a[92:95], a[28:31], v[156:159]
  s_waitcnt lgkmcnt(0)
  v_mfma_f32_16x16x32_bf16 v[32:35], a[32:35], a[0:3], v[32:35]
  buffer_load_dwordx4 v7, s[8:11], s26 offen offset:3072 lds
  ds_read_b128 a[16:19], v17 offset:0
  v_mfma_f32_16x16x32_bf16 v[64:67], a[32:35], a[4:7], v[64:67]
  s_add_u32 m0, s88, 4096
  ds_read_b64_tr_b16 a[64:65], v18 offset:4096
  v_mfma_f32_16x16x32_bf16 v[96:99], a[32:35], a[8:11], v[96:99]
  ds_read_b64_tr_b16 a[66:67], v18 offset:6144
  v_mfma_f32_16x16x32_bf16 v[128:131], a[32:35], a[12:15], v[128:131]
  buffer_load_dwordx4 v4, s[8:11], s27 offen offset:0 lds
  ds_read_b128 a[20:23], v17 offset:2048
  v_mfma_f32_16x16x32_bf16 v[36:39], a[36:39], a[0:3], v[36:39]
  ds_read_b128 a[24:27], v17 offset:4096
  v_mfma_f32_16x16x32_bf16 v[68:71], a[36:39], a[4:7], v[68:71]
  ds_read_b128 a[28:31], v17 offset:6144
  v_mfma_f32_16x16x32_bf16 v[100:103], a[36:39], a[8:11], v[100:103]
  ds_read_b64_tr_b16 a[68:69], v19 offset:4096
  v_mfma_f32_16x16x32_bf16 v[132:135], a[36:39], a[12:15], v[132:135]
  buffer_load_dwordx4 v5, s[8:11], s27 offen offset:1024 lds
  ds_read_b64_tr_b16 a[70:71], v19 offset:6144
  v_mfma_f32_16x16x32_bf16 v[40:43], a[40:43], a[0:3], v[40:43]
  ds_read_b64_tr_b16 a[72:73], v20 offset:4096
  v_mfma_f32_16x16x32_bf16 v[72:75], a[40:43], a[4:7], v[72:75]
  ds_read_b64_tr_b16 a[74:75], v20 offset:6144
  v_mfma_f32_16x16x32_bf16 v[104:107], a[40:43], a[8:11], v[104:107]
  buffer_load_dwordx4 v6, s[8:11], s27 offen offset:2048 lds
  v_mfma_f32_16x16x32_bf16 v[136:139], a[40:43], a[12:15], v[136:139]
  ds_read_b64_tr_b16 a[76:77], v21 offset:4096
  v_mfma_f32_16x16x32_bf16 v[44:47], a[44:47], a[0:3], v[44:47]
  ds_read_b64_tr_b16 a[78:79], v21 offset:6144
  v_mfma_f32_16x16x32_bf16 v[76:79], a[44:47], a[4:7], v[76:79]
  ds_read_b64_tr_b16 a[80:81], v18 offset:12288
  v_mfma_f32_16x16x32_bf16 v[108:111], a[44:47], a[8:11], v[108:111]
  buffer_load_dwordx4 v7, s[8:11], s27 offen offset:3072 lds
  ds_read_b64_tr_b16 a[82:83], v18 offset:14336
  v_mfma_f32_16x16x32_bf16 v[140:143], a[44:47], a[12:15], v[140:143]
  s_bfe_u32 s29, 0x302010e, s53
  s_add_u32 s52, s52, s29
  s_add_u32 s53, s53, 8
  v_mfma_f32_16x16x32_bf16 v[48:51], a[48:51], a[0:3], v[48:51]
  s_and_b32 s53, s53, 0x8001f
  s_and_b32 s52, s52, 15
  s_lshl_b32 s29, s52, 7
  v_mfma_f32_16x16x32_bf16 v[80:83], a[48:51], a[4:7], v[80:83]
  s_or_b32 s26, s30, s29
  s_or_b32 s27, s31, s29
  s_add_u32 s60, s63, 32768
  v_mfma_f32_16x16x32_bf16 v[112:115], a[48:51], a[8:11], v[112:115]
  buffer_store_dwordx4 v[204:207], v2, s[16:19], s60 offen offset:3072 sc1
  ds_read_b64_tr_b16 a[84:85], v19 offset:12288
  v_mfma_f32_16x16x32_bf16 v[144:147], a[48:51], a[12:15], v[144:147]
  s_add_u32 s60, s63, 40960
  ds_read_b64_tr_b16 a[86:87], v19 offset:14336
  ds_read_b64_tr_b16 a[88:89], v20 offset:12288
  v_mfma_f32_16x16x32_bf16 v[52:55], a[52:55], a[0:3], v[52:55]
  ds_read_b64_tr_b16 a[90:91], v20 offset:14336
  ds_read_b64_tr_b16 a[92:93], v21 offset:12288
  v_mfma_f32_16x16x32_bf16 v[84:87], a[52:55], a[4:7], v[84:87]
  buffer_store_dwordx4 v[236:239], v2, s[16:19], s60 offen offset:3072 sc1
  ds_read_b64_tr_b16 a[94:95], v21 offset:14336
  v_mfma_f32_16x16x32_bf16 v[116:119], a[52:55], a[8:11], v[116:119]
  s_add_u32 s88, s88, s90
  s_add_u32 s89, s89, 1
  s_cmp_eq_u32 s89, 3
  s_cselect_b32 s89, 0, s89
  s_cselect_b32 s90, s91, s92
  v_mfma_f32_16x16x32_bf16 v[148:151], a[52:55], a[12:15], v[148:151]
  s_add_u32 s68, s68, s70
  s_add_u32 s69, s69, 1
  s_cmp_eq_u32 s69, 3
  s_cselect_b32 s69, 0, s69
  s_cselect_b32 s70, s71, s72
  v_mfma_f32_16x16x32_bf16 v[56:59], a[56:59], a[0:3], v[56:59]
  v_add_u32 v16, s90, v16
  v_add_u32 v17, s90, v17
  v_mfma_f32_16x16x32_bf16 v[88:91], a[56:59], a[4:7], v[88:91]
  v_add_u32 v18, s70, v18
  v_add_u32 v19, s70, v19
  v_mfma_f32_16x16x32_bf16 v[120:123], a[56:59], a[8:11], v[120:123]
  v_add_u32 v20, s70, v20
  v_add_u32 v21, s70, v21
  v_mfma_f32_16x16x32_bf16 v[152:155], a[56:59], a[12:15], v[152:155]
  v_mfma_f32_16x16x32_bf16 v[60:63], a[60:63], a[0:3], v[60:63]
  v_mfma_f32_16x16x32_bf16 v[92:95], a[60:63], a[4:7], v[92:95]
  v_mfma_f32_16x16x32_bf16 v[124:127], a[60:63], a[8:11], v[124:127]
  v_mfma_f32_16x16x32_bf16 v[156:159], a[60:63], a[12:15], v[156:159]
  s_waitcnt vmcnt(16) lgkmcnt(0)
  s_barrier
  v_mfma_f32_16x16x32_bf16 v[32:35], a[64:67], a[16:19], v[32:35]
  s_mov_b32 m0, s68
  ds_read_b128 a[0:3], v16 offset:0
  v_mfma_f32_16x16x32_bf16 v[64:67], a[64:67], a[20:23], v[64:67]
  buffer_load_dwordx4 v8, s[20:23], s28 offen offset:0 lds
  ds_read_b64_tr_b16 a[32:33], v18 offset:0
  v_mfma_f32_16x16x32_bf16 v[96:99], a[64:67], a[24:27], v[96:99]
  ds_read_b64_tr_b16 a[34:35], v18 offset:2048
  v_mfma_f32_16x16x32_bf16 v[128:131], a[64:67], a[28:31], v[128:131]
  buffer_load_dwordx4 v9, s[20:23], s28 offen offset:1024 lds
  ds_read_b128 a[4:7], v16 offset:2048
  v_mfma_f32_16x16x32_bf16 v[36:39], a[68:71], a[16:19], v[36:39]
  ds_read_b128 a[8:11], v16 offset:4096
  v_mfma_f32_16x16x32_bf16 v[68:71], a[68:71], a[20:23], v[68:71]
  ds_read_b128 a[12:15], v16 offset:6144
  v_mfma_f32_16x16x32_bf16 v[100:103], a[68:71], a[24:27], v[100:103]
  ds_read_b64_tr_b16 a[36:37], v19 offset:0
  v_mfma_f32_16x16x32_bf16 v[132:135], a[68:71], a[28:31], v[132:135]
  buffer_load_dwordx4 v10, s[20:23], s28 offen offset:2048 lds
  ds_read_b64_tr_b16 a[38:39], v19 offset:2048
  v_mfma_f32_16x16x32_bf16 v[40:43], a[72:75], a[16:19], v[40:43]
  ds_read_b64_tr_b16 a[40:41], v20 offset:0
  v_mfma_f32_16x16x32_bf16 v[72:75], a[72:75], a[20:23], v[72:75]
  ds_read_b64_tr_b16 a[42:43], v20 offset:2048
  v_mfma_f32_16x16x32_bf16 v[104:107], a[72:75], a[24:27], v[104:107]
  v_mfma_f32_16x16x32_bf16 v[136:139], a[72:75], a[28:31], v[136:139]
  buffer_load_dwordx4 v11, s[20:23], s28 offen offset:3072 lds
  ds_read_b64_tr_b16 a[44:45], v21 offset:0
  v_mfma_f32_16x16x32_bf16 v[44:47], a[76:79], a[16:19], v[44:47]
  s_bfe_u32 s56, 0x302010e, s55
  s_add_u32 s54, s54, s56
  s_add_u32 s55, s55, 8
  v_mfma_f32_16x16x32_bf16 v[76:79], a[76:79], a[20:23], v[76:79]
  s_and_b32 s55, s55, 0x8001f
  s_and_b32 s54, s54, 15
  s_lshl_b32 s28, s54, 19
  v_mfma_f32_16x16x32_bf16 v[108:111], a[76:79], a[24:27], v[108:111]
  s_mov_b32 m0, s88
  ds_read_b64_tr_b16 a[46:47], v21 offset:2048
  ds_read_b64_tr_b16 a[48:49], v18 offset:8192
  v_mfma_f32_16x16x32_bf16 v[140:143], a[76:79], a[28:31], v[140:143]
  buffer_load_dwordx4 v4, s[8:11], s26 offen offset:0 lds
  ds_read_b64_tr_b16 a[50:51], v18 offset:10240
  v_mfma_f32_16x16x32_bf16 v[48:51], a[80:83], a[16:19], v[48:51]
  ds_read_b64_tr_b16 a[52:53], v19 offset:8192
  ds_read_b64_tr_b16 a[54:55], v19 offset:10240
  v_mfma_f32_16x16x32_bf16 v[80:83], a[80:83], a[20:23], v[80:83]
  ds_read_b64_tr_b16 a[56:57], v20 offset:8192
  v_mfma_f32_16x16x32_bf16 v[112:115], a[80:83], a[24:27], v[112:115]
  ds_read_b64_tr_b16 a[58:59], v20 offset:10240
  v_mfma_f32_16x16x32_bf16 v[144:147], a[80:83], a[28:31], v[144:147]
  buffer_load_dwordx4 v5, s[8:11], s26 offen offset:1024 lds
  ds_read_b64_tr_b16 a[60:61], v21 offset:8192
  v_mfma_f32_16x16x32_bf16 v[52:55], a[84:87], a[16:19], v[52:55]
  ds_read_b64_tr_b16 a[62:63], v21 offset:10240
  v_mfma_f32_16x16x32_bf16 v[84:87], a[84:87], a[20:23], v[84:87]
  v_mfma_f32_16x16x32_bf16 v[116:119], a[84:87], a[24:27], v[116:119]
  v_mfma_f32_16x16x32_bf16 v[148:151], a[84:87], a[28:31], v[148:151]
  buffer_load_dwordx4 v6, s[8:11], s26 offen offset:2048 lds
  v_mfma_f32_16x16x32_bf16 v[56:59], a[88:91], a[16:19], v[56:59]
  v_mfma_f32_16x16x32_bf16 v[88:91], a[88:91], a[20:23], v[88:91]
  v_mfma_f32_16x16x32_bf16 v[120:123], a[88:91], a[24:27], v[120:123]
  v_mfma_f32_16x16x32_bf16 v[152:155], a[88:91], a[28:31], v[152:155]
  buffer_load_dwordx4 v7, s[8:11], s26 offen offset:3072 lds
  v_mfma_f32_16x16x32_bf16 v[60:63], a[92:95], a[16:19], v[60:63]
  v_mfma_f32_16x16x32_bf16 v[92:95], a[92:95], a[20:23], v[92:95]
  v_mfma_f32_16x16x32_bf16 v[124:127], a[92:95], a[24:27], v[124:127]
  v_mfma_f32_16x16x32_bf16 v[156:159], a[92:95], a[28:31], v[156:159]
  s_waitcnt lgkmcnt(0)
  v_mfma_f32_16x16x32_bf16 v[32:35], a[32:35], a[0:3], v[32:35]
  s_add_u32 m0, s88, 4096
  ds_read_b128 a[16:19], v17 offset:0
  v_mfma_f32_16x16x32_bf16 v[64:67], a[32:35], a[4:7], v[64:67]
  buffer_load_dwordx4 v4, s[8:11], s27 offen offset:0 lds
  ds_read_b64_tr_b16 a[64:65], v18 offset:4096
  v_mfma_f32_16x16x32_bf16 v[96:99], a[32:35], a[8:11], v[96:99]
  ds_read_b64_tr_b16 a[66:67], v18 offset:6144
  v_mfma_f32_16x16x32_bf16 v[128:131], a[32:35], a[12:15], v[128:131]
  buffer_load_dwordx4 v5, s[8:11], s27 offen offset:1024 lds
  ds_read_b128 a[20:23], v17 offset:2048
  v_mfma_f32_16x16x32_bf16 v[36:39], a[36:39], a[0:3], v[36:39]
  ds_read_b128 a[24:27], v17 offset:4096
  v_mfma_f32_16x16x32_bf16 v[68:71], a[36:39], a[4:7], v[68:71]
  ds_read_b128 a[28:31], v17 offset:6144
  v_mfma_f32_16x16x32_bf16 v[100:103], a[36:39], a[8:11], v[100:103]
  ds_read_b64_tr_b16 a[68:69], v19 offset:4096
  v_mfma_f32_16x16x32_bf16 v[132:135], a[36:39], a[12:15], v[132:135]
  buffer_load_dwordx4 v6, s[8:11], s27 offen offset:2048 lds
  ds_read_b64_tr_b16 a[70:71], v19 offset:6144
  v_mfma_f32_16x16x32_bf16 v[40:43], a[40:43], a[0:3], v[40:43]
  ds_read_b64_tr_b16 a[72:73], v20 offset:4096
  v_mfma_f32_16x16x32_bf16 v[72:75], a[40:43], a[4:7], v[72:75]
  ds_read_b64_tr_b16 a[74:75], v20 offset:6144
  v_mfma_f32_16x16x32_bf16 v[104:107], a[40:43], a[8:11], v[104:107]
  buffer_load_dwordx4 v7, s[8:11], s27 offen offset:3072 lds
  v_mfma_f32_16x16x32_bf16 v[136:139], a[40:43], a[12:15], v[136:139]
  s_bfe_u32 s29, 0x302010e, s53
  s_add_u32 s52, s52, s29
  s_add_u32 s53, s53, 8
  v_mfma_f32_16x16x32_bf16 v[44:47], a[44:47], a[0:3], v[44:47]
  s_and_b32 s53, s53, 0x8001f
  s_and_b32 s52, s52, 15
  s_lshl_b32 s29, s52, 7
  v_mfma_f32_16x16x32_bf16 v[76:79], a[44:47], a[4:7], v[76:79]
  s_or_b32 s26, s30, s29
  s_or_b32 s27, s31, s29
  s_add_u32 s60, s63, 36864
  v_mfma_f32_16x16x32_bf16 v[108:111], a[44:47], a[8:11], v[108:111]
  buffer_store_dwordx4 v[208:211], v2, s[16:19], s60 offen offset:0 sc1
  ds_read_b64_tr_b16 a[76:77], v21 offset:4096
  v_mfma_f32_16x16x32_bf16 v[140:143], a[44:47], a[12:15], v[140:143]
  s_add_u32 s60, s63, 45056
  ds_read_b64_tr_b16 a[78:79], v21 offset:6144
  ds_read_b64_tr_b16 a[80:81], v18 offset:12288
  v_mfma_f32_16x16x32_bf16 v[48:51], a[48:51], a[0:3], v[48:51]
  ds_read_b64_tr_b16 a[82:83], v18 offset:14336
  ds_read_b64_tr_b16 a[84:85], v19 offset:12288
  v_mfma_f32_16x16x32_bf16 v[80:83], a[48:51], a[4:7], v[80:83]
  buffer_store_dwordx4 v[240:243], v2, s[16:19], s60 offen offset:0 sc1
  ds_read_b64_tr_b16 a[86:87], v19 offset:14336
  v_mfma_f32_16x16x32_bf16 v[112:115], a[48:51], a[8:11], v[112:115]
  s_add_u32 s60, s63, 36864
  ds_read_b64_tr_b16 a[88:89], v20 offset:12288
  ds_read_b64_tr_b16 a[90:91], v20 offset:14336
  v_mfma_f32_16x16x32_bf16 v[144:147], a[48:51], a[12:15], v[144:147]
  ds_read_b64_tr_b16 a[92:93], v21 offset:12288
  v_mfma_f32_16x16x32_bf16 v[52:55], a[52:55], a[0:3], v[52:55]
  ds_read_b64_tr_b16 a[94:95], v21 offset:14336
  v_mfma_f32_16x16x32_bf16 v[84:87], a[52:55], a[4:7], v[84:87]
  buffer_store_dwordx4 v[212:215], v2, s[16:19], s60 offen offset:1024 sc1
  v_mfma_f32_16x16x32_bf16 v[116:119], a[52:55], a[8:11], v[116:119]
  s_add_u32 s88, s88, s90
  s_add_u32 s89, s89, 1
  s_cmp_eq_u32 s89, 3
  s_cselect_b32 s89, 0, s89
  s_cselect_b32 s90, s91, s92
  v_mfma_f32_16x16x32_bf16 v[148:151], a[52:55], a[12:15], v[148:151]
  s_add_u32 s68, s68, s70
  s_add_u32 s69, s69, 1
  s_cmp_eq_u32 s69, 3
  s_cselect_b32 s69, 0, s69
  s_cselect_b32 s70, s71, s72
  v_mfma_f32_16x16x32_bf16 v[56:59], a[56:59], a[0:3], v[56:59]
  v_add_u32 v16, s90, v16
  v_add_u32 v17, s90, v17
  v_mfma_f32_16x16x32_bf16 v[88:91], a[56:59], a[4:7], v[88:91]
  v_add_u32 v18, s70, v18
  v_add_u32 v19, s70, v19
  v_mfma_f32_16x16x32_bf16 v[120:123], a[56:59], a[8:11], v[120:123]
  v_add_u32 v20, s70, v20
  v_add_u32 v21, s70, v21
  v_mfma_f32_16x16x32_bf16 v[152:155], a[56:59], a[12:15], v[152:155]
  v_mfma_f32_16x16x32_bf16 v[60:63], a[60:63], a[0:3], v[60:63]
  v_mfma_f32_16x16x32_bf16 v[92:95], a[60:63], a[4:7], v[92:95]
  v_mfma_f32_16x16x32_bf16 v[124:127], a[60:63], a[8:11], v[124:127]
  v_mfma_f32_16x16x32_bf16 v[156:159], a[60:63], a[12:15], v[156:159]
  s_waitcnt vmcnt(17) lgkmcnt(0)
  s_barrier
  v_mfma_f32_16x16x32_bf16 v[32:35], a[64:67], a[16:19], v[32:35]
  s_mov_b32 m0, s68
  ds_read_b128 a[0:3], v16 offset:0
  v_mfma_f32_16x16x32_bf16 v[64:67], a[64:67], a[20:23], v[64:67]
  buffer_load_dwordx4 v8, s[20:23], s28 offen offset:0 lds
  ds_read_b64_tr_b16 a[32:33], v18 offset:0
  v_mfma_f32_16x16x32_bf16 v[96:99], a[64:67], a[24:27], v[96:99]
  ds_read_b64_tr_b16 a[34:35], v18 offset:2048
  v_mfma_f32_16x16x32_bf16 v[128:131], a[64:67], a[28:31], v[128:131]
  buffer_load_dwordx4 v9, s[20:23], s28 offen offset:1024 lds
  ds_read_b128 a[4:7], v16 offset:2048
  v_mfma_f32_16x16x32_bf16 v[36:39], a[68:71], a[16:19], v[36:39]
  ds_read_b128 a[8:11], v16 offset:4096
  v_mfma_f32_16x16x32_bf16 v[68:71], a[68:71], a[20:23], v[68:71]
  ds_read_b128 a[12:15], v16 offset:6144
  v_mfma_f32_16x16x32_bf16 v[100:103], a[68:71], a[24:27], v[100:103]
  ds_read_b64_tr_b16 a[36:37], v19 offset:0
  v_mfma_f32_16x16x32_bf16 v[132:135], a[68:71], a[28:31], v[132:135]
  buffer_load_dwordx4 v10, s[20:23], s28 offen offset:2048 lds
  ds_read_b64_tr_b16 a[38:39], v19 offset:2048
  v_mfma_f32_16x16x32_bf16 v[40:43], a[72:75], a[16:19], v[40:43]
  ds_read_b64_tr_b16 a[40:41], v20 offset:0
  v_mfma_f32_16x16x32_bf16 v[72:75], a[72:75], a[20:23], v[72:75]
  ds_read_b64_tr_b16 a[42:43], v20 offset:2048
  v_mfma_f32_16x16x32_bf16 v[104:107], a[72:75], a[24:27], v[104:107]
  v_mfma_f32_16x16x32_bf16 v[136:139], a[72:75], a[28:31], v[136:139]
  buffer_load_dwordx4 v11, s[20:23], s28 offen offset:3072 lds
  ds_read_b64_tr_b16 a[44:45], v21 offset:0
  v_mfma_f32_16x16x32_bf16 v[44:47], a[76:79], a[16:19], v[44:47]
  s_bfe_u32 s56, 0x302010e, s55
  s_add_u32 s54, s54, s56
  s_add_u32 s55, s55, 8
  v_mfma_f32_16x16x32_bf16 v[76:79], a[76:79], a[20:23], v[76:79]
  s_and_b32 s55, s55, 0x8001f
  s_and_b32 s54, s54, 15
  s_lshl_b32 s28, s54, 19
  v_mfma_f32_16x16x32_bf16 v[108:111], a[76:79], a[24:27], v[108:111]
  s_mov_b32 m0, s88
  ds_read_b64_tr_b16 a[46:47], v21 offset:2048
  ds_read_b64_tr_b16 a[48:49], v18 offset:8192
  v_mfma_f32_16x16x32_bf16 v[140:143], a[76:79], a[28:31], v[140:143]
  buffer_load_dwordx4 v4, s[8:11], s26 offen offset:0 lds
  ds_read_b64_tr_b16 a[50:51], v18 offset:10240
  v_mfma_f32_16x16x32_bf16 v[48:51], a[80:83], a[16:19], v[48:51]
  ds_read_b64_tr_b16 a[52:53], v19 offset:8192
  ds_read_b64_tr_b16 a[54:55], v19 offset:10240
  v_mfma_f32_16x16x32_bf16 v[80:83], a[80:83], a[20:23], v[80:83]
  ds_read_b64_tr_b16 a[56:57], v20 offset:8192
  v_mfma_f32_16x16x32_bf16 v[112:115], a[80:83], a[24:27], v[112:115]
  ds_read_b64_tr_b16 a[58:59], v20 offset:10240
  v_mfma_f32_16x16x32_bf16 v[144:147], a[80:83], a[28:31], v[144:147]
  buffer_load_dwordx4 v5, s[8:11], s26 offen offset:1024 lds
  ds_read_b64_tr_b16 a[60:61], v21 offset:8192
  v_mfma_f32_16x16x32_bf16 v[52:55], a[84:87], a[16:19], v[52:55]
  ds_read_b64_tr_b16 a[62:63], v21 offset:10240
  v_mfma_f32_16x16x32_bf16 v[84:87], a[84:87], a[20:23], v[84:87]
  v_mfma_f32_16x16x32_bf16 v[116:119], a[84:87], a[24:27], v[116:119]
  v_mfma_f32_16x16x32_bf16 v[148:151], a[84:87], a[28:31], v[148:151]
  buffer_load_dwordx4 v6, s[8:11], s26 offen offset:2048 lds
  v_mfma_f32_16x16x32_bf16 v[56:59], a[88:91], a[16:19], v[56:59]
  v_mfma_f32_16x16x32_bf16 v[88:91], a[88:91], a[20:23], v[88:91]
  v_mfma_f32_16x16x32_bf16 v[120:123], a[88:91], a[24:27], v[120:123]
  v_mfma_f32_16x16x32_bf16 v[152:155], a[88:91], a[28:31], v[152:155]
  buffer_load_dwordx4 v7, s[8:11], s26 offen offset:3072 lds
  v_mfma_f32_16x16x32_bf16 v[60:63], a[92:95], a[16:19], v[60:63]
  v_mfma_f32_16x16x32_bf16 v[92:95], a[92:95], a[20:23], v[92:95]
  v_mfma_f32_16x16x32_bf16 v[124:127], a[92:95], a[24:27], v[124:127]
  v_mfma_f32_16x16x32_bf16 v[156:159], a[92:95], a[28:31], v[156:159]
  s_waitcnt lgkmcnt(0)
  v_mfma_f32_16x16x32_bf16 v[32:35], a[32:35], a[0:3], v[32:35]
  s_add_u32 m0, s88, 4096
  ds_read_b128 a[16:19], v17 offset:0
  v_mfma_f32_16x16x32_bf16 v[64:67], a[32:35], a[4:7], v[64:67]
  buffer_load_dwordx4 v4, s[8:11], s27 offen offset:0 lds
  ds_read_b64_tr_b16 a[64:65], v18 offset:4096
  v_mfma_f32_16x16x32_bf16 v[96:99], a[32:35], a[8:11], v[96:99]
  ds_read_b64_tr_b16 a[66:67], v18 offset:6144
  v_mfma_f32_16x16x32_bf16 v[128:131], a[32:35], a[12:15], v[128:131]
  buffer_load_dwordx4 v5, s[8:11], s27 offen offset:1024 lds
  ds_read_b128 a[20:23], v17 offset:2048
  v_mfma_f32_16x16x32_bf16 v[36:39], a[36:39], a[0:3], v[36:39]
  ds_read_b128 a[24:27], v17 offset:4096
  v_mfma_f32_16x16x32_bf16 v[68:71], a[36:39], a[4:7], v[68:71]
  ds_read_b128 a[28:31], v17 offset:6144
  v_mfma_f32_16x16x32_bf16 v[100:103], a[36:39], a[8:11], v[100:103]
  ds_read_b64_tr_b16 a[68:69], v19 offset:4096
  v_mfma_f32_16x16x32_bf16 v[132:135], a[36:39], a[12:15], v[132:135]
  buffer_load_dwordx4 v6, s[8:11], s27 offen offset:2048 lds
  ds_read_b64_tr_b16 a[70:71], v19 offset:6144
  v_mfma_f32_16x16x32_bf16 v[40:43], a[40:43], a[0:3], v[40:43]
  ds_read_b64_tr_b16 a[72:73], v20 offset:4096
  v_mfma_f32_16x16x32_bf16 v[72:75], a[40:43], a[4:7], v[72:75]
  ds_read_b64_tr_b16 a[74:75], v20 offset:6144
  v_mfma_f32_16x16x32_bf16 v[104:107], a[40:43], a[8:11], v[104:107]
  buffer_load_dwordx4 v7, s[8:11], s27 offen offset:3072 lds
  v_mfma_f32_16x16x32_bf16 v[136:139], a[40:43], a[12:15], v[136:139]
  s_bfe_u32 s29, 0x302010e, s53
  s_add_u32 s52, s52, s29
  s_add_u32 s53, s53, 8
  v_mfma_f32_16x16x32_bf16 v[44:47], a[44:47], a[0:3], v[44:47]
  s_and_b32 s53, s53, 0x8001f
  s_and_b32 s52, s52, 15
  s_lshl_b32 s29, s52, 7
  v_mfma_f32_16x16x32_bf16 v[76:79], a[44:47], a[4:7], v[76:79]
  s_or_b32 s26, s30, s29
  s_or_b32 s27, s31, s29
  s_add_u32 s60, s63, 45056
  v_mfma_f32_16x16x32_bf16 v[108:111], a[44:47], a[8:11], v[108:111]
  buffer_store_dwordx4 v[244:247], v2, s[16:19], s60 offen offset:1024 sc1
  ds_read_b64_tr_b16 a[76:77], v21 offset:4096
  v_mfma_f32_16x16x32_bf16 v[140:143], a[44:47], a[12:15], v[140:143]
  s_add_u32 s60, s63, 36864
  ds_read_b64_tr_b16 a[78:79], v21 offset:6144
  ds_read_b64_tr_b16 a[80:81], v18 offset:12288
  v_mfma_f32_16x16x32_bf16 v[48:51], a[48:51], a[0:3], v[48:51]
  ds_read_b64_tr_b16 a[82:83], v18 offset:14336
  ds_read_b64_tr_b16 a[84:85], v19 offset:12288
  v_mfma_f32_16x16x32_bf16 v[80:83], a[48:51], a[4:7], v[80:83]
  buffer_store_dwordx4 v[216:219], v2, s[16:19], s60 offen offset:2048 sc1
  ds_read_b64_tr_b16 a[86:87], v19 offset:14336
  v_mfma_f32_16x16x32_bf16 v[112:115], a[48:51], a[8:11], v[112:115]
  s_add_u32 s60, s63, 45056
  ds_read_b64_tr_b16 a[88:89], v20 offset:12288
  ds_read_b64_tr_b16 a[90:91], v20 offset:14336
  v_mfma_f32_16x16x32_bf16 v[144:147], a[48:51], a[12:15], v[144:147]
  ds_read_b64_tr_b16 a[92:93], v21 offset:12288
  v_mfma_f32_16x16x32_bf16 v[52:55], a[52:55], a[0:3], v[52:55]
  ds_read_b64_tr_b16 a[94:95], v21 offset:14336
  v_mfma_f32_16x16x32_bf16 v[84:87], a[52:55], a[4:7], v[84:87]
  buffer_store_dwordx4 v[248:251], v2, s[16:19], s60 offen offset:2048 sc1
  v_mfma_f32_16x16x32_bf16 v[116:119], a[52:55], a[8:11], v[116:119]
  s_add_u32 s88, s88, s90
  s_add_u32 s89, s89, 1
  s_cmp_eq_u32 s89, 3
  s_cselect_b32 s89, 0, s89
  s_cselect_b32 s90, s91, s92
  v_mfma_f32_16x16x32_bf16 v[148:151], a[52:55], a[12:15], v[148:151]
  s_add_u32 s68, s68, s70
  s_add_u32 s69, s69, 1
  s_cmp_eq_u32 s69, 3
  s_cselect_b32 s69, 0, s69
  s_cselect_b32 s70, s71, s72
  v_mfma_f32_16x16x32_bf16 v[56:59], a[56:59], a[0:3], v[56:59]
  v_add_u32 v16, s90, v16
  v_add_u32 v17, s90, v17
  v_mfma_f32_16x16x32_bf16 v[88:91], a[56:59], a[4:7], v[88:91]
  v_add_u32 v18, s70, v18
  v_add_u32 v19, s70, v19
  v_mfma_f32_16x16x32_bf16 v[120:123], a[56:59], a[8:11], v[120:123]
  v_add_u32 v20, s70, v20
  v_add_u32 v21, s70, v21
  v_mfma_f32_16x16x32_bf16 v[152:155], a[56:59], a[12:15], v[152:155]
  v_mfma_f32_16x16x32_bf16 v[60:63], a[60:63], a[0:3], v[60:63]
  v_mfma_f32_16x16x32_bf16 v[92:95], a[60:63], a[4:7], v[92:95]
  v_mfma_f32_16x16x32_bf16 v[124:127], a[60:63], a[8:11], v[124:127]
  v_mfma_f32_16x16x32_bf16 v[156:159], a[60:63], a[12:15], v[156:159]
  s_waitcnt vmcnt(18) lgkmcnt(0)
  s_barrier
  v_mfma_f32_16x16x32_bf16 v[32:35], a[64:67], a[16:19], v[32:35]
  s_mov_b32 m0, s68
  ds_read_b128 a[0:3], v16 offset:0
  v_mfma_f32_16x16x32_bf16 v[64:67], a[64:67], a[20:23], v[64:67]
  buffer_load_dwordx4 v8, s[20:23], s28 offen offset:0 lds
  ds_read_b64_tr_b16 a[32:33], v18 offset:0
  v_mfma_f32_16x16x32_bf16 v[96:99], a[64:67], a[24:27], v[96:99]
  ds_read_b64_tr_b16 a[34:35], v18 offset:2048
  v_mfma_f32_16x16x32_bf16 v[128:131], a[64:67], a[28:31], v[128:131]
  buffer_load_dwordx4 v9, s[20:23], s28 offen offset:1024 lds
  ds_read_b128 a[4:7], v16 offset:2048
  v_mfma_f32_16x16x32_bf16 v[36:39], a[68:71], a[16:19], v[36:39]
  ds_read_b128 a[8:11], v16 offset:4096
  v_mfma_f32_16x16x32_bf16 v[68:71], a[68:71], a[20:23], v[68:71]
  ds_read_b128 a[12:15], v16 offset:6144
  v_mfma_f32_16x16x32_bf16 v[100:103], a[68:71], a[24:27], v[100:103]
  ds_read_b64_tr_b16 a[36:37], v19 offset:0
  v_mfma_f32_16x16x32_bf16 v[132:135], a[68:71], a[28:31], v[132:135]
  buffer_load_dwordx4 v10, s[20:23], s28 offen offset:2048 lds
  ds_read_b64_tr_b16 a[38:39], v19 offset:2048
  v_mfma_f32_16x16x32_bf16 v[40:43], a[72:75], a[16:19], v[40:43]
  ds_read_b64_tr_b16 a[40:41], v20 offset:0
  v_mfma_f32_16x16x32_bf16 v[72:75], a[72:75], a[20:23], v[72:75]
  ds_read_b64_tr_b16 a[42:43], v20 offset:2048
  v_mfma_f32_16x16x32_bf16 v[104:107], a[72:75], a[24:27], v[104:107]
  v_mfma_f32_16x16x32_bf16 v[136:139], a[72:75], a[28:31], v[136:139]
  buffer_load_dwordx4 v11, s[20:23], s28 offen offset:3072 lds
  ds_read_b64_tr_b16 a[44:45], v21 offset:0
  v_mfma_f32_16x16x32_bf16 v[44:47], a[76:79], a[16:19], v[44:47]
  s_bfe_u32 s56, 0x302010e, s55
  s_add_u32 s54, s54, s56
  s_add_u32 s55, s55, 8
  v_mfma_f32_16x16x32_bf16 v[76:79], a[76:79], a[20:23], v[76:79]
  s_and_b32 s55, s55, 0x8001f
  s_and_b32 s54, s54, 15
  s_lshl_b32 s28, s54, 19
  v_mfma_f32_16x16x32_bf16 v[108:111], a[76:79], a[24:27], v[108:111]
  s_mov_b32 m0, s88
  ds_read_b64_tr_b16 a[46:47], v21 offset:2048
  ds_read_b64_tr_b16 a[48:49], v18 offset:8192
  v_mfma_f32_16x16x32_bf16 v[140:143], a[76:79], a[28:31], v[140:143]
  buffer_load_dwordx4 v4, s[8:11], s26 offen offset:0 lds
  ds_read_b64_tr_b16 a[50:51], v18 offset:10240
  v_mfma_f32_16x16x32_bf16 v[48:51], a[80:83], a[16:19], v[48:51]
  ds_read_b64_tr_b16 a[52:53], v19 offset:8192
  ds_read_b64_tr_b16 a[54:55], v19 offset:10240
  v_mfma_f32_16x16x32_bf16 v[80:83], a[80:83], a[20:23], v[80:83]
  ds_read_b64_tr_b16 a[56:57], v20 offset:8192
  v_mfma_f32_16x16x32_bf16 v[112:115], a[80:83], a[24:27], v[112:115]
  ds_read_b64_tr_b16 a[58:59], v20 offset:10240
  v_mfma_f32_16x16x32_bf16 v[144:147], a[80:83], a[28:31], v[144:147]
  buffer_load_dwordx4 v5, s[8:11], s26 offen offset:1024 lds
  ds_read_b64_tr_b16 a[60:61], v21 offset:8192
  v_mfma_f32_16x16x32_bf16 v[52:55], a[84:87], a[16:19], v[52:55]
  ds_read_b64_tr_b16 a[62:63], v21 offset:10240
  v_mfma_f32_16x16x32_bf16 v[84:87], a[84:87], a[20:23], v[84:87]
  v_mfma_f32_16x16x32_bf16 v[116:119], a[84:87], a[24:27], v[116:119]
  v_mfma_f32_16x16x32_bf16 v[148:151], a[84:87], a[28:31], v[148:151]
  buffer_load_dwordx4 v6, s[8:11], s26 offen offset:2048 lds
  v_mfma_f32_16x16x32_bf16 v[56:59], a[88:91], a[16:19], v[56:59]
  v_mfma_f32_16x16x32_bf16 v[88:91], a[88:91], a[20:23], v[88:91]
  v_mfma_f32_16x16x32_bf16 v[120:123], a[88:91], a[24:27], v[120:123]
  v_mfma_f32_16x16x32_bf16 v[152:155], a[88:91], a[28:31], v[152:155]
  buffer_load_dwordx4 v7, s[8:11], s26 offen offset:3072 lds
  v_mfma_f32_16x16x32_bf16 v[60:63], a[92:95], a[16:19], v[60:63]
  v_mfma_f32_16x16x32_bf16 v[92:95], a[92:95], a[20:23], v[92:95]
  v_mfma_f32_16x16x32_bf16 v[124:127], a[92:95], a[24:27], v[124:127]
  v_mfma_f32_16x16x32_bf16 v[156:159], a[92:95], a[28:31], v[156:159]
  s_waitcnt lgkmcnt(0)
  v_mfma_f32_16x16x32_bf16 v[32:35], a[32:35], a[0:3], v[32:35]
  s_add_u32 m0, s88, 4096
  ds_read_b128 a[16:19], v17 offset:0
  v_mfma_f32_16x16x32_bf16 v[64:67], a[32:35], a[4:7], v[64:67]
  buffer_load_dwordx4 v4, s[8:11], s27 offen offset:0 lds
  ds_read_b64_tr_b16 a[64:65], v18 offset:4096
  v_mfma_f32_16x16x32_bf16 v[96:99], a[32:35], a[8:11], v[96:99]
  ds_read_b64_tr_b16 a[66:67], v18 offset:6144
  v_mfma_f32_16x16x32_bf16 v[128:131], a[32:35], a[12:15], v[128:131]
  buffer_load_dwordx4 v5, s[8:11], s27 offen offset:1024 lds
  ds_read_b128 a[20:23], v17 offset:2048
  v_mfma_f32_16x16x32_bf16 v[36:39], a[36:39], a[0:3], v[36:39]
  ds_read_b128 a[24:27], v17 offset:4096
  v_mfma_f32_16x16x32_bf16 v[68:71], a[36:39], a[4:7], v[68:71]
  ds_read_b128 a[28:31], v17 offset:6144
  v_mfma_f32_16x16x32_bf16 v[100:103], a[36:39], a[8:11], v[100:103]
  ds_read_b64_tr_b16 a[68:69], v19 offset:4096
  v_mfma_f32_16x16x32_bf16 v[132:135], a[36:39], a[12:15], v[132:135]
  buffer_load_dwordx4 v6, s[8:11], s27 offen offset:2048 lds
  ds_read_b64_tr_b16 a[70:71], v19 offset:6144
  v_mfma_f32_16x16x32_bf16 v[40:43], a[40:43], a[0:3], v[40:43]
  ds_read_b64_tr_b16 a[72:73], v20 offset:4096
  v_mfma_f32_16x16x32_bf16 v[72:75], a[40:43], a[4:7], v[72:75]
  ds_read_b64_tr_b16 a[74:75], v20 offset:6144
  v_mfma_f32_16x16x32_bf16 v[104:107], a[40:43], a[8:11], v[104:107]
  buffer_load_dwordx4 v7, s[8:11], s27 offen offset:3072 lds
  v_mfma_f32_16x16x32_bf16 v[136:139], a[40:43], a[12:15], v[136:139]
  s_bfe_u32 s29, 0x302010e, s53
  s_add_u32 s52, s52, s29
  s_add_u32 s53, s53, 8
  v_mfma_f32_16x16x32_bf16 v[44:47], a[44:47], a[0:3], v[44:47]
  s_and_b32 s53, s53, 0x8001f
  s_and_b32 s52, s52, 15
  s_lshl_b32 s29, s52, 7
  v_mfma_f32_16x16x32_bf16 v[76:79], a[44:47], a[4:7], v[76:79]
  s_or_b32 s26, s30, s29
  s_or_b32 s27, s31, s29
  s_add_u32 s60, s63, 36864
  v_mfma_f32_16x16x32_bf16 v[108:111], a[44:47], a[8:11], v[108:111]
  buffer_store_dwordx4 v[220:223], v2, s[16:19], s60 offen offset:3072 sc1
  ds_read_b64_tr_b16 a[76:77], v21 offset:4096
  v_mfma_f32_16x16x32_bf16 v[140:143], a[44:47], a[12:15], v[140:143]
  s_add_u32 s60, s63, 45056
  ds_read_b64_tr_b16 a[78:79], v21 offset:6144
  ds_read_b64_tr_b16 a[80:81], v18 offset:12288
  v_mfma_f32_16x16x32_bf16 v[48:51], a[48:51], a[0:3], v[48:51]
  ds_read_b64_tr_b16 a[82:83], v18 offset:14336
  ds_read_b64_tr_b16 a[84:85], v19 offset:12288
  v_mfma_f32_16x16x32_bf16 v[80:83], a[48:51], a[4:7], v[80:83]
  buffer_store_dwordx4 v[252:255], v2, s[16:19], s60 offen offset:3072 sc1
  ds_read_b64_tr_b16 a[86:87], v19 offset:14336
  v_mfma_f32_16x16x32_bf16 v[112:115], a[48:51], a[8:11], v[112:115]
  s_add_u32 s60, s63, 0
  ds_read_b64_tr_b16 a[88:89], v20 offset:12288
  ds_read_b64_tr_b16 a[90:91], v20 offset:14336
  v_mfma_f32_16x16x32_bf16 v[144:147], a[48:51], a[12:15], v[144:147]
  ds_read_b64_tr_b16 a[92:93], v21 offset:12288
  v_mfma_f32_16x16x32_bf16 v[52:55], a[52:55], a[0:3], v[52:55]
  ds_read_b64_tr_b16 a[94:95], v21 offset:14336
  v_mfma_f32_16x16x32_bf16 v[84:87], a[52:55], a[4:7], v[84:87]
  buffer_store_dwordx4 v[160:163], v2, s[16:19], s60 offen offset:0 sc1
  v_mfma_f32_16x16x32_bf16 v[116:119], a[52:55], a[8:11], v[116:119]
  s_add_u32 s88, s88, s90
  s_add_u32 s89, s89, 1
  s_cmp_eq_u32 s89, 3
  s_cselect_b32 s89, 0, s89
  s_cselect_b32 s90, s91, s92
  v_mfma_f32_16x16x32_bf16 v[148:151], a[52:55], a[12:15], v[148:151]
  s_add_u32 s68, s68, s70
  s_add_u32 s69, s69, 1
  s_cmp_eq_u32 s69, 3
  s_cselect_b32 s69, 0, s69
  s_cselect_b32 s70, s71, s72
  v_mfma_f32_16x16x32_bf16 v[56:59], a[56:59], a[0:3], v[56:59]
  v_add_u32 v16, s90, v16
  v_add_u32 v17, s90, v17
  v_mfma_f32_16x16x32_bf16 v[88:91], a[56:59], a[4:7], v[88:91]
  v_add_u32 v18, s70, v18
  v_add_u32 v19, s70, v19
  v_mfma_f32_16x16x32_bf16 v[120:123], a[56:59], a[8:11], v[120:123]
  v_add_u32 v20, s70, v20
  v_add_u32 v21, s70, v21
  v_mfma_f32_16x16x32_bf16 v[152:155], a[56:59], a[12:15], v[152:155]
  v_mfma_f32_16x16x32_bf16 v[60:63], a[60:63], a[0:3], v[60:63]
  v_mfma_f32_16x16x32_bf16 v[92:95], a[60:63], a[4:7], v[92:95]
  v_mfma_f32_16x16x32_bf16 v[124:127], a[60:63], a[8:11], v[124:127]
  v_mfma_f32_16x16x32_bf16 v[156:159], a[60:63], a[12:15], v[156:159]
  s_waitcnt vmcnt(18) lgkmcnt(0)
  s_barrier
  v_mfma_f32_16x16x32_bf16 v[32:35], a[64:67], a[16:19], v[32:35]
  s_mov_b32 m0, s68
  ds_read_b128 a[0:3], v16 offset:0
  v_mfma_f32_16x16x32_bf16 v[64:67], a[64:67], a[20:23], v[64:67]
  buffer_load_dwordx4 v8, s[20:23], s28 offen offset:0 lds
  ds_read_b64_tr_b16 a[32:33], v18 offset:0
  v_mfma_f32_16x16x32_bf16 v[96:99], a[64:67], a[24:27], v[96:99]
  ds_read_b64_tr_b16 a[34:35], v18 offset:2048
  v_mfma_f32_16x16x32_bf16 v[128:131], a[64:67], a[28:31], v[128:131]
  buffer_load_dwordx4 v9, s[20:23], s28 offen offset:1024 lds
  ds_read_b128 a[4:7], v16 offset:2048
  v_mfma_f32_16x16x32_bf16 v[36:39], a[68:71], a[16:19], v[36:39]
  ds_read_b128 a[8:11], v16 offset:4096
  v_mfma_f32_16x16x32_bf16 v[68:71], a[68:71], a[20:23], v[68:71]
  ds_read_b128 a[12:15], v16 offset:6144
  v_mfma_f32_16x16x32_bf16 v[100:103], a[68:71], a[24:27], v[100:103]
  ds_read_b64_tr_b16 a[36:37], v19 offset:0
  v_mfma_f32_16x16x32_bf16 v[132:135], a[68:71], a[28:31], v[132:135]
  buffer_load_dwordx4 v10, s[20:23], s28 offen offset:2048 lds
  ds_read_b64_tr_b16 a[38:39], v19 offset:2048
  v_mfma_f32_16x16x32_bf16 v[40:43], a[72:75], a[16:19], v[40:43]
  ds_read_b64_tr_b16 a[40:41], v20 offset:0
  v_mfma_f32_16x16x32_bf16 v[72:75], a[72:75], a[20:23], v[72:75]
  ds_read_b64_tr_b16 a[42:43], v20 offset:2048
  v_mfma_f32_16x16x32_bf16 v[104:107], a[72:75], a[24:27], v[104:107]
  v_mfma_f32_16x16x32_bf16 v[136:139], a[72:75], a[28:31], v[136:139]
  buffer_load_dwordx4 v11, s[20:23], s28 offen offset:3072 lds
  ds_read_b64_tr_b16 a[44:45], v21 offset:0
  v_mfma_f32_16x16x32_bf16 v[44:47], a[76:79], a[16:19], v[44:47]
  s_bfe_u32 s56, 0x302010e, s55
  s_add_u32 s54, s54, s56
  s_add_u32 s55, s55, 8
  v_mfma_f32_16x16x32_bf16 v[76:79], a[76:79], a[20:23], v[76:79]
  s_and_b32 s55, s55, 0x8001f
  s_and_b32 s54, s54, 15
  s_lshl_b32 s28, s54, 19
  v_mfma_f32_16x16x32_bf16 v[108:111], a[76:79], a[24:27], v[108:111]
  s_mov_b32 m0, s88
  ds_read_b64_tr_b16 a[46:47], v21 offset:2048
  ds_read_b64_tr_b16 a[48:49], v18 offset:8192
  v_mfma_f32_16x16x32_bf16 v[140:143], a[76:79], a[28:31], v[140:143]
  buffer_load_dwordx4 v4, s[8:11], s26 offen offset:0 lds
  ds_read_b64_tr_b16 a[50:51], v18 offset:10240
  v_mfma_f32_16x16x32_bf16 v[48:51], a[80:83], a[16:19], v[48:51]
  ds_read_b64_tr_b16 a[52:53], v19 offset:8192
  ds_read_b64_tr_b16 a[54:55], v19 offset:10240
  v_mfma_f32_16x16x32_bf16 v[80:83], a[80:83], a[20:23], v[80:83]
  ds_read_b64_tr_b16 a[56:57], v20 offset:8192
  v_mfma_f32_16x16x32_bf16 v[112:115], a[80:83], a[24:27], v[112:115]
  ds_read_b64_tr_b16 a[58:59], v20 offset:10240
  v_mfma_f32_16x16x32_bf16 v[144:147], a[80:83], a[28:31], v[144:147]
  buffer_load_dwordx4 v5, s[8:11], s26 offen offset:1024 lds
  ds_read_b64_tr_b16 a[60:61], v21 offset:8192
  v_mfma_f32_16x16x32_bf16 v[52:55], a[84:87], a[16:19], v[52:55]
  ds_read_b64_tr_b16 a[62:63], v21 offset:10240
  v_mfma_f32_16x16x32_bf16 v[84:87], a[84:87], a[20:23], v[84:87]
  v_mfma_f32_16x16x32_bf16 v[116:119], a[84:87], a[24:27], v[116:119]
  v_mfma_f32_16x16x32_bf16 v[148:151], a[84:87], a[28:31], v[148:151]
  buffer_load_dwordx4 v6, s[8:11], s26 offen offset:2048 lds
  v_mfma_f32_16x16x32_bf16 v[56:59], a[88:91], a[16:19], v[56:59]
  v_mfma_f32_16x16x32_bf16 v[88:91], a[88:91], a[20:23], v[88:91]
  v_mfma_f32_16x16x32_bf16 v[120:123], a[88:91], a[24:27], v[120:123]
  v_mfma_f32_16x16x32_bf16 v[152:155], a[88:91], a[28:31], v[152:155]
  buffer_load_dwordx4 v7, s[8:11], s26 offen offset:3072 lds
  v_mfma_f32_16x16x32_bf16 v[60:63], a[92:95], a[16:19], v[60:63]
  v_mfma_f32_16x16x32_bf16 v[92:95], a[92:95], a[20:23], v[92:95]
  v_mfma_f32_16x16x32_bf16 v[124:127], a[92:95], a[24:27], v[124:127]
  v_mfma_f32_16x16x32_bf16 v[156:159], a[92:95], a[28:31], v[156:159]
  s_waitcnt lgkmcnt(0)
  v_mfma_f32_16x16x32_bf16 v[32:35], a[32:35], a[0:3], v[32:35]
  s_add_u32 m0, s88, 4096
  ds_read_b128 a[16:19], v17 offset:0
  v_mfma_f32_16x16x32_bf16 v[64:67], a[32:35], a[4:7], v[64:67]
  buffer_load_dwordx4 v4, s[8:11], s27 offen offset:0 lds
  ds_read_b64_tr_b16 a[64:65], v18 offset:4096
  v_mfma_f32_16x16x32_bf16 v[96:99], a[32:35], a[8:11], v[96:99]
  ds_read_b64_tr_b16 a[66:67], v18 offset:6144
  v_mfma_f32_16x16x32_bf16 v[128:131], a[32:35], a[12:15], v[128:131]
  buffer_load_dwordx4 v5, s[8:11], s27 offen offset:1024 lds
  ds_read_b128 a[20:23], v17 offset:2048
  v_mfma_f32_16x16x32_bf16 v[36:39], a[36:39], a[0:3], v[36:39]
  ds_read_b128 a[24:27], v17 offset:4096
  v_mfma_f32_16x16x32_bf16 v[68:71], a[36:39], a[4:7], v[68:71]
  ds_read_b128 a[28:31], v17 offset:6144
  v_mfma_f32_16x16x32_bf16 v[100:103], a[36:39], a[8:11], v[100:103]
  ds_read_b64_tr_b16 a[68:69], v19 offset:4096
  v_mfma_f32_16x16x32_bf16 v[132:135], a[36:39], a[12:15], v[132:135]
  buffer_load_dwordx4 v6, s[8:11], s27 offen offset:2048 lds
  ds_read_b64_tr_b16 a[70:71], v19 offset:6144
  v_mfma_f32_16x16x32_bf16 v[40:43], a[40:43], a[0:3], v[40:43]
  ds_read_b64_tr_b16 a[72:73], v20 offset:4096
  v_mfma_f32_16x16x32_bf16 v[72:75], a[40:43], a[4:7], v[72:75]
  ds_read_b64_tr_b16 a[74:75], v20 offset:6144
  v_mfma_f32_16x16x32_bf16 v[104:107], a[40:43], a[8:11], v[104:107]
  buffer_load_dwordx4 v7, s[8:11], s27 offen offset:3072 lds
  v_mfma_f32_16x16x32_bf16 v[136:139], a[40:43], a[12:15], v[136:139]
  s_bfe_u32 s29, 0x302010e, s53
  s_add_u32 s52, s52, s29
  s_add_u32 s53, s53, 8
  v_mfma_f32_16x16x32_bf16 v[44:47], a[44:47], a[0:3], v[44:47]
  s_and_b32 s53, s53, 0x8001f
  s_and_b32 s52, s52, 15
  s_lshl_b32 s29, s52, 7
  v_mfma_f32_16x16x32_bf16 v[76:79], a[44:47], a[4:7], v[76:79]
  s_or_b32 s26, s30, s29
  s_or_b32 s27, s31, s29
  s_add_u32 s60, s63, 0
  v_mfma_f32_16x16x32_bf16 v[108:111], a[44:47], a[8:11], v[108:111]
  buffer_store_dwordx4 v[164:167], v2, s[16:19], s60 offen offset:1024 sc1
  ds_read_b64_tr_b16 a[76:77], v21 offset:4096
  v_mfma_f32_16x16x32_bf16 v[140:143], a[44:47], a[12:15], v[140:143]
  ds_read_b64_tr_b16 a[78:79], v21 offset:6144
  ds_read_b64_tr_b16 a[80:81], v18 offset:12288
  v_mfma_f32_16x16x32_bf16 v[48:51], a[48:51], a[0:3], v[48:51]
  ds_read_b64_tr_b16 a[82:83], v18 offset:14336
  ds_read_b64_tr_b16 a[84:85], v19 offset:12288
  v_mfma_f32_16x16x32_bf16 v[80:83], a[48:51], a[4:7], v[80:83]
  buffer_store_dwordx4 v[168:171], v2, s[16:19], s60 offen offset:2048 sc1
  ds_read_b64_tr_b16 a[86:87], v19 offset:14336
  v_mfma_f32_16x16x32_bf16 v[112:115], a[48:51], a[8:11], v[112:115]
  ds_read_b64_tr_b16 a[88:89], v20 offset:12288
  ds_read_b64_tr_b16 a[90:91], v20 offset:14336
  v_mfma_f32_16x16x32_bf16 v[144:147], a[48:51], a[12:15], v[144:147]
  ds_read_b64_tr_b16 a[92:93], v21 offset:12288
  v_mfma_f32_16x16x32_bf16 v[52:55], a[52:55], a[0:3], v[52:55]
  ds_read_b64_tr_b16 a[94:95], v21 offset:14336
  v_mfma_f32_16x16x32_bf16 v[84:87], a[52:55], a[4:7], v[84:87]
  buffer_store_dwordx4 v[172:175], v2, s[16:19], s60 offen offset:3072 sc1
  v_mfma_f32_16x16x32_bf16 v[116:119], a[52:55], a[8:11], v[116:119]
  s_add_u32 s88, s88, s90
  s_add_u32 s89, s89, 1
  s_cmp_eq_u32 s89, 3
  s_cselect_b32 s89, 0, s89
  s_cselect_b32 s90, s91, s92
  v_mfma_f32_16x16x32_bf16 v[148:151], a[52:55], a[12:15], v[148:151]
  s_add_u32 s68, s68, s70
  s_add_u32 s69, s69, 1
  s_cmp_eq_u32 s69, 3
  s_cselect_b32 s69, 0, s69
  s_cselect_b32 s70, s71, s72
  v_mfma_f32_16x16x32_bf16 v[56:59], a[56:59], a[0:3], v[56:59]
  v_add_u32 v16, s90, v16
  v_add_u32 v17, s90, v17
  v_mfma_f32_16x16x32_bf16 v[88:91], a[56:59], a[4:7], v[88:91]
  v_add_u32 v18, s70, v18
  v_add_u32 v19, s70, v19
  v_mfma_f32_16x16x32_bf16 v[120:123], a[56:59], a[8:11], v[120:123]
  v_add_u32 v20, s70, v20
  v_add_u32 v21, s70, v21
  v_mfma_f32_16x16x32_bf16 v[152:155], a[56:59], a[12:15], v[152:155]
  v_mfma_f32_16x16x32_bf16 v[60:63], a[60:63], a[0:3], v[60:63]
  v_mfma_f32_16x16x32_bf16 v[92:95], a[60:63], a[4:7], v[92:95]
  v_mfma_f32_16x16x32_bf16 v[124:127], a[60:63], a[8:11], v[124:127]
  v_mfma_f32_16x16x32_bf16 v[156:159], a[60:63], a[12:15], v[156:159]
  s_waitcnt vmcnt(18) lgkmcnt(0)
  s_barrier
  v_mfma_f32_16x16x32_bf16 v[32:35], a[64:67], a[16:19], v[32:35]
  s_mov_b32 m0, s68
  ds_read_b128 a[0:3], v16 offset:0
  v_mfma_f32_16x16x32_bf16 v[64:67], a[64:67], a[20:23], v[64:67]
  buffer_load_dwordx4 v8, s[20:23], s28 offen offset:0 lds
  ds_read_b64_tr_b16 a[32:33], v18 offset:0
  v_mfma_f32_16x16x32_bf16 v[96:99], a[64:67], a[24:27], v[96:99]
  ds_read_b64_tr_b16 a[34:35], v18 offset:2048
  v_mfma_f32_16x16x32_bf16 v[128:131], a[64:67], a[28:31], v[128:131]
  ds_read_b128 a[4:7], v16 offset:2048
  v_mfma_f32_16x16x32_bf16 v[36:39], a[68:71], a[16:19], v[36:39]
  buffer_load_dwordx4 v9, s[20:23], s28 offen offset:1024 lds
  ds_read_b128 a[8:11], v16 offset:4096
  v_mfma_f32_16x16x32_bf16 v[68:71], a[68:71], a[20:23], v[68:71]
  ds_read_b128 a[12:15], v16 offset:6144
  v_mfma_f32_16x16x32_bf16 v[100:103], a[68:71], a[24:27], v[100:103]
  ds_read_b64_tr_b16 a[36:37], v19 offset:0
  v_mfma_f32_16x16x32_bf16 v[132:135], a[68:71], a[28:31], v[132:135]
  ds_read_b64_tr_b16 a[38:39], v19 offset:2048
  v_mfma_f32_16x16x32_bf16 v[40:43], a[72:75], a[16:19], v[40:43]
  buffer_load_dwordx4 v10, s[20:23], s28 offen offset:2048 lds
  ds_read_b64_tr_b16 a[40:41], v20 offset:0
  v_mfma_f32_16x16x32_bf16 v[72:75], a[72:75], a[20:23], v[72:75]
  ds_read_b64_tr_b16 a[42:43], v20 offset:2048
  v_mfma_f32_16x16x32_bf16 v[104:107], a[72:75], a[24:27], v[104:107]
  v_mfma_f32_16x16x32_bf16 v[136:139], a[72:75], a[28:31], v[136:139]
  ds_read_b64_tr_b16 a[44:45], v21 offset:0
  v_mfma_f32_16x16x32_bf16 v[44:47], a[76:79], a[16:19], v[44:47]
  ds_read_b64_tr_b16 a[46:47], v21 offset:2048
  v_mfma_f32_16x16x32_bf16 v[76:79], a[76:79], a[20:23], v[76:79]
  buffer_load_dwordx4 v11, s[20:23], s28 offen offset:3072 lds
  ds_read_b64_tr_b16 a[48:49], v18 offset:8192
  v_mfma_f32_16x16x32_bf16 v[108:111], a[76:79], a[24:27], v[108:111]
  s_bfe_u32 s56, 0x302010e, s55
  s_add_u32 s54, s54, s56
  s_add_u32 s55, s55, 8
  v_mfma_f32_16x16x32_bf16 v[140:143], a[76:79], a[28:31], v[140:143]
  s_and_b32 s55, s55, 0x8001f
  s_and_b32 s54, s54, 15
  s_lshl_b32 s28, s54, 19
  v_mfma_f32_16x16x32_bf16 v[48:51], a[80:83], a[16:19], v[48:51]
  s_mov_b32 m0, s88
  ds_read_b64_tr_b16 a[50:51], v18 offset:10240
  ds_read_b64_tr_b16 a[52:53], v19 offset:8192
  v_mfma_f32_16x16x32_bf16 v[80:83], a[80:83], a[20:23], v[80:83]
  buffer_load_dwordx4 v4, s[8:11], s26 offen offset:0 lds
  ds_read_b64_tr_b16 a[54:55], v19 offset:10240
  v_mfma_f32_16x16x32_bf16 v[112:115], a[80:83], a[24:27], v[112:115]
  ds_read_b64_tr_b16 a[56:57], v20 offset:8192
  ds_read_b64_tr_b16 a[58:59], v20 offset:10240
  v_mfma_f32_16x16x32_bf16 v[144:147], a[80:83], a[28:31], v[144:147]
  ds_read_b64_tr_b16 a[60:61], v21 offset:8192
  v_mfma_f32_16x16x32_bf16 v[52:55], a[84:87], a[16:19], v[52:55]
  ds_read_b64_tr_b16 a[62:63], v21 offset:10240
  v_mfma_f32_16x16x32_bf16 v[84:87], a[84:87], a[20:23], v[84:87]
  v_mfma_f32_16x16x32_bf16 v[116:119], a[84:87], a[24:27], v[116:119]
  buffer_load_dwordx4 v5, s[8:11], s26 offen offset:1024 lds
  v_mfma_f32_16x16x32_bf16 v[148:151], a[84:87], a[28:31], v[148:151]
  v_mfma_f32_16x16x32_bf16 v[56:59], a[88:91], a[16:19], v[56:59]
  v_mfma_f32_16x16x32_bf16 v[88:91], a[88:91], a[20:23], v[88:91]
  v_mfma_f32_16x16x32_bf16 v[120:123], a[88:91], a[24:27], v[120:123]
  buffer_load_dwordx4 v6, s[8:11], s26 offen offset:2048 lds
  v_mfma_f32_16x16x32_bf16 v[152:155], a[88:91], a[28:31], v[152:155]
  v_mfma_f32_16x16x32_bf16 v[60:63], a[92:95], a[16:19], v[60:63]
  v_mfma_f32_16x16x32_bf16 v[92:95], a[92:95], a[20:23], v[92:95]
  v_mfma_f32_16x16x32_bf16 v[124:127], a[92:95], a[24:27], v[124:127]
  v_mfma_f32_16x16x32_bf16 v[156:159], a[92:95], a[28:31], v[156:159]
  s_waitcnt lgkmcnt(0)
  v_mfma_f32_16x16x32_bf16 v[32:35], a[32:35], a[0:3], v[32:35]
  buffer_load_dwordx4 v7, s[8:11], s26 offen offset:3072 lds
  ds_read_b128 a[16:19], v17 offset:0
  v_mfma_f32_16x16x32_bf16 v[64:67], a[32:35], a[4:7], v[64:67]
  s_add_u32 m0, s88, 4096
  ds_read_b64_tr_b16 a[64:65], v18 offset:4096
  v_mfma_f32_16x16x32_bf16 v[96:99], a[32:35], a[8:11], v[96:99]
  ds_read_b64_tr_b16 a[66:67], v18 offset:6144
  v_mfma_f32_16x16x32_bf16 v[128:131], a[32:35], a[12:15], v[128:131]
  buffer_load_dwordx4 v4, s[8:11], s27 offen offset:0 lds
  ds_read_b128 a[20:23], v17 offset:2048
  v_mfma_f32_16x16x32_bf16 v[36:39], a[36:39], a[0:3], v[36:39]
  ds_read_b128 a[24:27], v17 offset:4096
  v_mfma_f32_16x16x32_bf16 v[68:71], a[36:39], a[4:7], v[68:71]
  ds_read_b128 a[28:31], v17 offset:6144
  v_mfma_f32_16x16x32_bf16 v[100:103], a[36:39], a[8:11], v[100:103]
  ds_read_b64_tr_b16 a[68:69], v19 offset:4096
  v_mfma_f32_16x16x32_bf16 v[132:135], a[36:39], a[12:15], v[132:135]
  buffer_load_dwordx4 v5, s[8:11], s27 offen offset:1024 lds
  ds_read_b64_tr_b16 a[70:71], v19 offset:6144
  v_mfma_f32_16x16x32_bf16 v[40:43], a[40:43], a[0:3], v[40:43]
  ds_read_b64_tr_b16 a[72:73], v20 offset:4096
  v_mfma_f32_16x16x32_bf16 v[72:75], a[40:43], a[4:7], v[72:75]
  ds_read_b64_tr_b16 a[74:75], v20 offset:6144
  v_mfma_f32_16x16x32_bf16 v[104:107], a[40:43], a[8:11], v[104:107]
  buffer_load_dwordx4 v6, s[8:11], s27 offen offset:2048 lds
  v_mfma_f32_16x16x32_bf16 v[136:139], a[40:43], a[12:15], v[136:139]
  ds_read_b64_tr_b16 a[76:77], v21 offset:4096
  v_mfma_f32_16x16x32_bf16 v[44:47], a[44:47], a[0:3], v[44:47]
  ds_read_b64_tr_b16 a[78:79], v21 offset:6144
  v_mfma_f32_16x16x32_bf16 v[76:79], a[44:47], a[4:7], v[76:79]
  ds_read_b64_tr_b16 a[80:81], v18 offset:12288
  v_mfma_f32_16x16x32_bf16 v[108:111], a[44:47], a[8:11], v[108:111]
  buffer_load_dwordx4 v7, s[8:11], s27 offen offset:3072 lds
  ds_read_b64_tr_b16 a[82:83], v18 offset:14336
  v_mfma_f32_16x16x32_bf16 v[140:143], a[44:47], a[12:15], v[140:143]
  s_bfe_u32 s29, 0x302010e, s53
  s_add_u32 s52, s52, s29
  s_add_u32 s53, s53, 8
  v_mfma_f32_16x16x32_bf16 v[48:51], a[48:51], a[0:3], v[48:51]
  s_and_b32 s53, s53, 0x8001f
  s_and_b32 s52, s52, 15
  s_lshl_b32 s29, s52, 7
  v_mfma_f32_16x16x32_bf16 v[80:83], a[48:51], a[4:7], v[80:83]
  s_or_b32 s26, s30, s29
  s_or_b32 s27, s31, s29
  s_add_u32 s60, s63, 4096
  v_mfma_f32_16x16x32_bf16 v[112:115], a[48:51], a[8:11], v[112:115]
  buffer_store_dwordx4 v[176:179], v2, s[16:19], s60 offen offset:0 sc1
  ds_read_b64_tr_b16 a[84:85], v19 offset:12288
  v_mfma_f32_16x16x32_bf16 v[144:147], a[48:51], a[12:15], v[144:147]
  ds_read_b64_tr_b16 a[86:87], v19 offset:14336
  ds_read_b64_tr_b16 a[88:89], v20 offset:12288
  v_mfma_f32_16x16x32_bf16 v[52:55], a[52:55], a[0:3], v[52:55]
  ds_read_b64_tr_b16 a[90:91], v20 offset:14336
  ds_read_b64_tr_b16 a[92:93], v21 offset:12288
  v_mfma_f32_16x16x32_bf16 v[84:87], a[52:55], a[4:7], v[84:87]
  buffer_store_dwordx4 v[180:183], v2, s[16:19], s60 offen offset:1024 sc1
  ds_read_b64_tr_b16 a[94:95], v21 offset:14336
  v_mfma_f32_16x16x32_bf16 v[116:119], a[52:55], a[8:11], v[116:119]
  s_add_u32 s88, s88, s90
  s_add_u32 s89, s89, 1
  s_cmp_eq_u32 s89, 3
  s_cselect_b32 s89, 0, s89
  s_cselect_b32 s90, s91, s92
  v_mfma_f32_16x16x32_bf16 v[148:151], a[52:55], a[12:15], v[148:151]
  s_add_u32 s68, s68, s70
  s_add_u32 s69, s69, 1
  s_cmp_eq_u32 s69, 3
  s_cselect_b32 s69, 0, s69
  s_cselect_b32 s70, s71, s72
  v_mfma_f32_16x16x32_bf16 v[56:59], a[56:59], a[0:3], v[56:59]
  v_add_u32 v16, s90, v16
  v_add_u32 v17, s90, v17
  v_mfma_f32_16x16x32_bf16 v[88:91], a[56:59], a[4:7], v[88:91]
  v_add_u32 v18, s70, v18
  v_add_u32 v19, s70, v19
  v_mfma_f32_16x16x32_bf16 v[120:123], a[56:59], a[8:11], v[120:123]
  v_add_u32 v20, s70, v20
  v_add_u32 v21, s70, v21
  v_mfma_f32_16x16x32_bf16 v[152:155], a[56:59], a[12:15], v[152:155]
  v_mfma_f32_16x16x32_bf16 v[60:63], a[60:63], a[0:3], v[60:63]
  v_mfma_f32_16x16x32_bf16 v[92:95], a[60:63], a[4:7], v[92:95]
  v_mfma_f32_16x16x32_bf16 v[124:127], a[60:63], a[8:11], v[124:127]
  v_mfma_f32_16x16x32_bf16 v[156:159], a[60:63], a[12:15], v[156:159]
  s_waitcnt vmcnt(17) lgkmcnt(0)
  s_barrier
  v_mfma_f32_16x16x32_bf16 v[32:35], a[64:67], a[16:19], v[32:35]
  s_mov_b32 m0, s68
  ds_read_b128 a[0:3], v16 offset:0
  v_mfma_f32_16x16x32_bf16 v[64:67], a[64:67], a[20:23], v[64:67]
  buffer_load_dwordx4 v8, s[20:23], s28 offen offset:0 lds
  ds_read_b64_tr_b16 a[32:33], v18 offset:0
  v_mfma_f32_16x16x32_bf16 v[96:99], a[64:67], a[24:27], v[96:99]
  ds_read_b64_tr_b16 a[34:35], v18 offset:2048
  v_mfma_f32_16x16x32_bf16 v[128:131], a[64:67], a[28:31], v[128:131]
  ds_read_b128 a[4:7], v16 offset:2048
  v_mfma_f32_16x16x32_bf16 v[36:39], a[68:71], a[16:19], v[36:39]
  buffer_load_dwordx4 v9, s[20:23], s28 offen offset:1024 lds
  ds_read_b128 a[8:11], v16 offset:4096
  v_mfma_f32_16x16x32_bf16 v[68:71], a[68:71], a[20:23], v[68:71]
  ds_read_b128 a[12:15], v16 offset:6144
  v_mfma_f32_16x16x32_bf16 v[100:103], a[68:71], a[24:27], v[100:103]
  ds_read_b64_tr_b16 a[36:37], v19 offset:0
  v_mfma_f32_16x16x32_bf16 v[132:135], a[68:71], a[28:31], v[132:135]
  ds_read_b64_tr_b16 a[38:39], v19 offset:2048
  v_mfma_f32_16x16x32_bf16 v[40:43], a[72:75], a[16:19], v[40:43]
  buffer_load_dwordx4 v10, s[20:23], s28 offen offset:2048 lds
  ds_read_b64_tr_b16 a[40:41], v20 offset:0
  v_mfma_f32_16x16x32_bf16 v[72:75], a[72:75], a[20:23], v[72:75]
  ds_read_b64_tr_b16 a[42:43], v20 offset:2048
  v_mfma_f32_16x16x32_bf16 v[104:107], a[72:75], a[24:27], v[104:107]
  v_mfma_f32_16x16x32_bf16 v[136:139], a[72:75], a[28:31], v[136:139]
  ds_read_b64_tr_b16 a[44:45], v21 offset:0
  v_mfma_f32_16x16x32_bf16 v[44:47], a[76:79], a[16:19], v[44:47]
  ds_read_b64_tr_b16 a[46:47], v21 offset:2048
  v_mfma_f32_16x16x32_bf16 v[76:79], a[76:79], a[20:23], v[76:79]
  buffer_load_dwordx4 v11, s[20:23], s28 offen offset:3072 lds
  ds_read_b64_tr_b16 a[48:49], v18 offset:8192
  v_mfma_f32_16x16x32_bf16 v[108:111], a[76:79], a[24:27], v[108:111]
  s_bfe_u32 s56, 0x302010e, s55
  s_add_u32 s54, s54, s56
  s_add_u32 s55, s55, 8
  v_mfma_f32_16x16x32_bf16 v[140:143], a[76:79], a[28:31], v[140:143]
  s_and_b32 s55, s55, 0x8001f
  s_and_b32 s54, s54, 15
  s_lshl_b32 s28, s54, 19
  v_mfma_f32_16x16x32_bf16 v[48:51], a[80:83], a[16:19], v[48:51]
  s_mov_b32 m0, s88
  ds_read_b64_tr_b16 a[50:51], v18 offset:10240
  ds_read_b64_tr_b16 a[52:53], v19 offset:8192
  v_mfma_f32_16x16x32_bf16 v[80:83], a[80:83], a[20:23], v[80:83]
  buffer_load_dwordx4 v4, s[8:11], s26 offen offset:0 lds
  ds_read_b64_tr_b16 a[54:55], v19 offset:10240
  v_mfma_f32_16x16x32_bf16 v[112:115], a[80:83], a[24:27], v[112:115]
  ds_read_b64_tr_b16 a[56:57], v20 offset:8192
  ds_read_b64_tr_b16 a[58:59], v20 offset:10240
  v_mfma_f32_16x16x32_bf16 v[144:147], a[80:83], a[28:31], v[144:147]
  ds_read_b64_tr_b16 a[60:61], v21 offset:8192
  v_mfma_f32_16x16x32_bf16 v[52:55], a[84:87], a[16:19], v[52:55]
  ds_read_b64_tr_b16 a[62:63], v21 offset:10240
  v_mfma_f32_16x16x32_bf16 v[84:87], a[84:87], a[20:23], v[84:87]
  v_mfma_f32_16x16x32_bf16 v[116:119], a[84:87], a[24:27], v[116:119]
  buffer_load_dwordx4 v5, s[8:11], s26 offen offset:1024 lds
  v_mfma_f32_16x16x32_bf16 v[148:151], a[84:87], a[28:31], v[148:151]
  v_mfma_f32_16x16x32_bf16 v[56:59], a[88:91], a[16:19], v[56:59]
  v_mfma_f32_16x16x32_bf16 v[88:91], a[88:91], a[20:23], v[88:91]
  v_mfma_f32_16x16x32_bf16 v[120:123], a[88:91], a[24:27], v[120:123]
  buffer_load_dwordx4 v6, s[8:11], s26 offen offset:2048 lds
  v_mfma_f32_16x16x32_bf16 v[152:155], a[88:91], a[28:31], v[152:155]
  v_mfma_f32_16x16x32_bf16 v[60:63], a[92:95], a[16:19], v[60:63]
  v_mfma_f32_16x16x32_bf16 v[92:95], a[92:95], a[20:23], v[92:95]
  v_mfma_f32_16x16x32_bf16 v[124:127], a[92:95], a[24:27], v[124:127]
  v_mfma_f32_16x16x32_bf16 v[156:159], a[92:95], a[28:31], v[156:159]
  s_waitcnt lgkmcnt(0)
  v_mfma_f32_16x16x32_bf16 v[32:35], a[32:35], a[0:3], v[32:35]
  buffer_load_dwordx4 v7, s[8:11], s26 offen offset:3072 lds
  ds_read_b128 a[16:19], v17 offset:0
  v_mfma_f32_16x16x32_bf16 v[64:67], a[32:35], a[4:7], v[64:67]
  s_add_u32 m0, s88, 4096
  ds_read_b64_tr_b16 a[64:65], v18 offset:4096
  v_mfma_f32_16x16x32_bf16 v[96:99], a[32:35], a[8:11], v[96:99]
  ds_read_b64_tr_b16 a[66:67], v18 offset:6144
  v_mfma_f32_16x16x32_bf16 v[128:131], a[32:35], a[12:15], v[128:131]
  buffer_load_dwordx4 v4, s[8:11], s27 offen offset:0 lds
  ds_read_b128 a[20:23], v17 offset:2048
  v_mfma_f32_16x16x32_bf16 v[36:39], a[36:39], a[0:3], v[36:39]
  ds_read_b128 a[24:27], v17 offset:4096
  v_mfma_f32_16x16x32_bf16 v[68:71], a[36:39], a[4:7], v[68:71]
  ds_read_b128 a[28:31], v17 offset:6144
  v_mfma_f32_16x16x32_bf16 v[100:103], a[36:39], a[8:11], v[100:103]
  ds_read_b64_tr_b16 a[68:69], v19 offset:4096
  v_mfma_f32_16x16x32_bf16 v[132:135], a[36:39], a[12:15], v[132:135]
  buffer_load_dwordx4 v5, s[8:11], s27 offen offset:1024 lds
  ds_read_b64_tr_b16 a[70:71], v19 offset:6144
  v_mfma_f32_16x16x32_bf16 v[40:43], a[40:43], a[0:3], v[40:43]
  ds_read_b64_tr_b16 a[72:73], v20 offset:4096
  v_mfma_f32_16x16x32_bf16 v[72:75], a[40:43], a[4:7], v[72:75]
  ds_read_b64_tr_b16 a[74:75], v20 offset:6144
  v_mfma_f32_16x16x32_bf16 v[104:107], a[40:43], a[8:11], v[104:107]
  buffer_load_dwordx4 v6, s[8:11], s27 offen offset:2048 lds
  v_mfma_f32_16x16x32_bf16 v[136:139], a[40:43], a[12:15], v[136:139]
  ds_read_b64_tr_b16 a[76:77], v21 offset:4096
  v_mfma_f32_16x16x32_bf16 v[44:47], a[44:47], a[0:3], v[44:47]
  ds_read_b64_tr_b16 a[78:79], v21 offset:6144
  v_mfma_f32_16x16x32_bf16 v[76:79], a[44:47], a[4:7], v[76:79]
  ds_read_b64_tr_b16 a[80:81], v18 offset:12288
  v_mfma_f32_16x16x32_bf16 v[108:111], a[44:47], a[8:11], v[108:111]
  buffer_load_dwordx4 v7, s[8:11], s27 offen offset:3072 lds
  ds_read_b64_tr_b16 a[82:83], v18 offset:14336
  v_mfma_f32_16x16x32_bf16 v[140:143], a[44:47], a[12:15], v[140:143]
  s_bfe_u32 s29, 0x302010e, s53
  s_add_u32 s52, s52, s29
  s_add_u32 s53, s53, 8
  v_mfma_f32_16x16x32_bf16 v[48:51], a[48:51], a[0:3], v[48:51]
  s_and_b32 s53, s53, 0x8001f
  s_and_b32 s52, s52, 15
  s_lshl_b32 s29, s52, 7
  v_mfma_f32_16x16x32_bf16 v[80:83], a[48:51], a[4:7], v[80:83]
  s_or_b32 s26, s30, s29
  s_or_b32 s27, s31, s29
  s_add_u32 s60, s63, 4096
  v_mfma_f32_16x16x32_bf16 v[112:115], a[48:51], a[8:11], v[112:115]
  buffer_store_dwordx4 v[184:187], v2, s[16:19], s60 offen offset:2048 sc1
  ds_read_b64_tr_b16 a[84:85], v19 offset:12288
  v_mfma_f32_16x16x32_bf16 v[144:147], a[48:51], a[12:15], v[144:147]
  ds_read_b64_tr_b16 a[86:87], v19 offset:14336
  ds_read_b64_tr_b16 a[88:89], v20 offset:12288
  v_mfma_f32_16x16x32_bf16 v[52:55], a[52:55], a[0:3], v[52:55]
  ds_read_b64_tr_b16 a[90:91], v20 offset:14336
  ds_read_b64_tr_b16 a[92:93], v21 offset:12288
  v_mfma_f32_16x16x32_bf16 v[84:87], a[52:55], a[4:7], v[84:87]
  buffer_store_dwordx4 v[188:191], v2, s[16:19], s60 offen offset:3072 sc1
  ds_read_b64_tr_b16 a[94:95], v21 offset:14336
  v_mfma_f32_16x16x32_bf16 v[116:119], a[52:55], a[8:11], v[116:119]
  s_add_u32 s88, s88, s90
  s_add_u32 s89, s89, 1
  s_cmp_eq_u32 s89, 3
  s_cselect_b32 s89, 0, s89
  s_cselect_b32 s90, s91, s92
  v_mfma_f32_16x16x32_bf16 v[148:151], a[52:55], a[12:15], v[148:151]
  s_add_u32 s68, s68, s70
  s_add_u32 s69, s69, 1
  s_cmp_eq_u32 s69, 3
  s_cselect_b32 s69, 0, s69
  s_cselect_b32 s70, s71, s72
  v_mfma_f32_16x16x32_bf16 v[56:59], a[56:59], a[0:3], v[56:59]
  v_add_u32 v16, s90, v16
  v_add_u32 v17, s90, v17
  v_mfma_f32_16x16x32_bf16 v[88:91], a[56:59], a[4:7], v[88:91]
  v_add_u32 v18, s70, v18
  v_add_u32 v19, s70, v19
  v_mfma_f32_16x16x32_bf16 v[120:123], a[56:59], a[8:11], v[120:123]
  v_add_u32 v20, s70, v20
  v_add_u32 v21, s70, v21
  v_mfma_f32_16x16x32_bf16 v[152:155], a[56:59], a[12:15], v[152:155]
  v_mfma_f32_16x16x32_bf16 v[60:63], a[60:63], a[0:3], v[60:63]
  v_mfma_f32_16x16x32_bf16 v[92:95], a[60:63], a[4:7], v[92:95]
  v_mfma_f32_16x16x32_bf16 v[124:127], a[60:63], a[8:11], v[124:127]
  v_mfma_f32_16x16x32_bf16 v[156:159], a[60:63], a[12:15], v[156:159]
  s_waitcnt vmcnt(16) lgkmcnt(0)
  s_barrier
  v_mfma_f32_16x16x32_bf16 v[32:35], a[64:67], a[16:19], v[32:35]
  s_mov_b32 m0, s68
  ds_read_b128 a[0:3], v16 offset:0
  v_mfma_f32_16x16x32_bf16 v[64:67], a[64:67], a[20:23], v[64:67]
  buffer_load_dwordx4 v8, s[20:23], s28 offen offset:0 lds
  ds_read_b64_tr_b16 a[32:33], v18 offset:0
  v_mfma_f32_16x16x32_bf16 v[96:99], a[64:67], a[24:27], v[96:99]
  ds_read_b64_tr_b16 a[34:35], v18 offset:2048
  v_mfma_f32_16x16x32_bf16 v[128:131], a[64:67], a[28:31], v[128:131]
  ds_read_b128 a[4:7], v16 offset:2048
  v_mfma_f32_16x16x32_bf16 v[36:39], a[68:71], a[16:19], v[36:39]
  ds_read_b128 a[8:11], v16 offset:4096
  v_mfma_f32_16x16x32_bf16 v[68:71], a[68:71], a[20:23], v[68:71]
  buffer_load_dwordx4 v9, s[20:23], s28 offen offset:1024 lds
  ds_read_b128 a[12:15], v16 offset:6144
  v_mfma_f32_16x16x32_bf16 v[100:103], a[68:71], a[24:27], v[100:103]
  ds_read_b64_tr_b16 a[36:37], v19 offset:0
  v_mfma_f32_16x16x32_bf16 v[132:135], a[68:71], a[28:31], v[132:135]
  ds_read_b64_tr_b16 a[38:39], v19 offset:2048
  v_mfma_f32_16x16x32_bf16 v[40:43], a[72:75], a[16:19], v[40:43]
  ds_read_b64_tr_b16 a[40:41], v20 offset:0
  v_mfma_f32_16x16x32_bf16 v[72:75], a[72:75], a[20:23], v[72:75]
  ds_read_b64_tr_b16 a[42:43], v20 offset:2048
  v_mfma_f32_16x16x32_bf16 v[104:107], a[72:75], a[24:27], v[104:107]
  buffer_load_dwordx4 v10, s[20:23], s28 offen offset:2048 lds
  v_mfma_f32_16x16x32_bf16 v[136:139], a[72:75], a[28:31], v[136:139]
  ds_read_b64_tr_b16 a[44:45], v21 offset:0
  v_mfma_f32_16x16x32_bf16 v[44:47], a[76:79], a[16:19], v[44:47]
  ds_read_b64_tr_b16 a[46:47], v21 offset:2048
  v_mfma_f32_16x16x32_bf16 v[76:79], a[76:79], a[20:23], v[76:79]
  ds_read_b64_tr_b16 a[48:49], v18 offset:8192
  v_mfma_f32_16x16x32_bf16 v[108:111], a[76:79], a[24:27], v[108:111]
  ds_read_b64_tr_b16 a[50:51], v18 offset:10240
  v_mfma_f32_16x16x32_bf16 v[140:143], a[76:79], a[28:31], v[140:143]
  buffer_load_dwordx4 v11, s[20:23], s28 offen offset:3072 lds
  ds_read_b64_tr_b16 a[52:53], v19 offset:8192
  v_mfma_f32_16x16x32_bf16 v[48:51], a[80:83], a[16:19], v[48:51]
  s_bfe_u32 s56, 0x302010e, s55
  s_add_u32 s54, s54, s56
  s_add_u32 s55, s55, 8
  v_mfma_f32_16x16x32_bf16 v[80:83], a[80:83], a[20:23], v[80:83]
  s_and_b32 s55, s55, 0x8001f
  s_and_b32 s54, s54, 15
  s_lshl_b32 s28, s54, 19
  v_mfma_f32_16x16x32_bf16 v[112:115], a[80:83], a[24:27], v[112:115]
  s_mov_b32 m0, s88
  ds_read_b64_tr_b16 a[54:55], v19 offset:10240
  ds_read_b64_tr_b16 a[56:57], v20 offset:8192
  v_mfma_f32_16x16x32_bf16 v[144:147], a[80:83], a[28:31], v[144:147]
  ds_read_b64_tr_b16 a[58:59], v20 offset:10240
  ds_read_b64_tr_b16 a[60:61], v21 offset:8192
  v_mfma_f32_16x16x32_bf16 v[52:55], a[84:87], a[16:19], v[52:55]
  buffer_load_dwordx4 v4, s[8:11], s26 offen offset:0 lds
  ds_read_b64_tr_b16 a[62:63], v21 offset:10240
  v_mfma_f32_16x16x32_bf16 v[84:87], a[84:87], a[20:23], v[84:87]
  v_mfma_f32_16x16x32_bf16 v[116:119], a[84:87], a[24:27], v[116:119]
  v_mfma_f32_16x16x32_bf16 v[148:151], a[84:87], a[28:31], v[148:151]
  v_mfma_f32_16x16x32_bf16 v[56:59], a[88:91], a[16:19], v[56:59]
  v_mfma_f32_16x16x32_bf16 v[88:91], a[88:91], a[20:23], v[88:91]
  buffer_load_dwordx4 v5, s[8:11], s26 offen offset:1024 lds
  v_mfma_f32_16x16x32_bf16 v[120:123], a[88:91], a[24:27], v[120:123]
  v_mfma_f32_16x16x32_bf16 v[152:155], a[88:91], a[28:31], v[152:155]
  v_mfma_f32_16x16x32_bf16 v[60:63], a[92:95], a[16:19], v[60:63]
  v_mfma_f32_16x16x32_bf16 v[92:95], a[92:95], a[20:23], v[92:95]
  v_mfma_f32_16x16x32_bf16 v[124:127], a[92:95], a[24:27], v[124:127]
  v_mfma_f32_16x16x32_bf16 v[156:159], a[92:95], a[28:31], v[156:159]
  s_waitcnt lgkmcnt(0)
  v_mfma_f32_16x16x32_bf16 v[32:35], a[32:35], a[0:3], v[32:35]
  buffer_load_dwordx4 v6, s[8:11], s26 offen offset:2048 lds
  ds_read_b128 a[16:19], v17 offset:0
  v_mfma_f32_16x16x32_bf16 v[64:67], a[32:35], a[4:7], v[64:67]
  ds_read_b64_tr_b16 a[64:65], v18 offset:4096
  v_mfma_f32_16x16x32_bf16 v[96:99], a[32:35], a[8:11], v[96:99]
  ds_read_b64_tr_b16 a[66:67], v18 offset:6144
  v_mfma_f32_16x16x32_bf16 v[128:131], a[32:35], a[12:15], v[128:131]
  ds_read_b128 a[20:23], v17 offset:2048
  v_mfma_f32_16x16x32_bf16 v[36:39], a[36:39], a[0:3], v[36:39]
  buffer_load_dwordx4 v7, s[8:11], s26 offen offset:3072 lds
  ds_read_b128 a[24:27], v17 offset:4096
  v_mfma_f32_16x16x32_bf16 v[68:71], a[36:39], a[4:7], v[68:71]
  s_add_u32 m0, s88, 4096
  ds_read_b128 a[28:31], v17 offset:6144
  v_mfma_f32_16x16x32_bf16 v[100:103], a[36:39], a[8:11], v[100:103]
  ds_read_b64_tr_b16 a[68:69], v19 offset:4096
  v_mfma_f32_16x16x32_bf16 v[132:135], a[36:39], a[12:15], v[132:135]
  ds_read_b64_tr_b16 a[70:71], v19 offset:6144
  v_mfma_f32_16x16x32_bf16 v[40:43], a[40:43], a[0:3], v[40:43]
  buffer_load_dwordx4 v4, s[8:11], s27 offen offset:0 lds
  ds_read_b64_tr_b16 a[72:73], v20 offset:4096
  v_mfma_f32_16x16x32_bf16 v[72:75], a[40:43], a[4:7], v[72:75]
  ds_read_b64_tr_b16 a[74:75], v20 offset:6144
  v_mfma_f32_16x16x32_bf16 v[104:107], a[40:43], a[8:11], v[104:107]
  v_mfma_f32_16x16x32_bf16 v[136:139], a[40:43], a[12:15], v[136:139]
  ds_read_b64_tr_b16 a[76:77], v21 offset:4096
  v_mfma_f32_16x16x32_bf16 v[44:47], a[44:47], a[0:3], v[44:47]
  buffer_load_dwordx4 v5, s[8:11], s27 offen offset:1024 lds
  ds_read_b64_tr_b16 a[78:79], v21 offset:6144
  v_mfma_f32_16x16x32_bf16 v[76:79], a[44:47], a[4:7], v[76:79]
  ds_read_b64_tr_b16 a[80:81], v18 offset:12288
  v_mfma_f32_16x16x32_bf16 v[108:111], a[44:47], a[8:11], v[108:111]
  ds_read_b64_tr_b16 a[82:83], v18 offset:14336
  v_mfma_f32_16x16x32_bf16 v[140:143], a[44:47], a[12:15], v[140:143]
  ds_read_b64_tr_b16 a[84:85], v19 offset:12288
  v_mfma_f32_16x16x32_bf16 v[48:51], a[48:51], a[0:3], v[48:51]
  buffer_load_dwordx4 v6, s[8:11], s27 offen offset:2048 lds
  ds_read_b64_tr_b16 a[86:87], v19 offset:14336
  v_mfma_f32_16x16x32_bf16 v[80:83], a[48:51], a[4:7], v[80:83]
  ds_read_b64_tr_b16 a[88:89], v20 offset:12288
  v_mfma_f32_16x16x32_bf16 v[112:115], a[48:51], a[8:11], v[112:115]
  ds_read_b64_tr_b16 a[90:91], v20 offset:14336
  v_mfma_f32_16x16x32_bf16 v[144:147], a[48:51], a[12:15], v[144:147]
  ds_read_b64_tr_b16 a[92:93], v21 offset:12288
  v_mfma_f32_16x16x32_bf16 v[52:55], a[52:55], a[0:3], v[52:55]
  buffer_load_dwordx4 v7, s[8:11], s27 offen offset:3072 lds
  ds_read_b64_tr_b16 a[94:95], v21 offset:14336
  v_mfma_f32_16x16x32_bf16 v[84:87], a[52:55], a[4:7], v[84:87]
  s_bfe_u32 s29, 0x302010e, s53
  s_add_u32 s52, s52, s29
  s_add_u32 s53, s53, 8
  v_mfma_f32_16x16x32_bf16 v[116:119], a[52:55], a[8:11], v[116:119]
  s_and_b32 s53, s53, 0x8001f
  s_and_b32 s52, s52, 15
  s_lshl_b32 s29, s52, 7
  v_mfma_f32_16x16x32_bf16 v[148:151], a[52:55], a[12:15], v[148:151]
  s_or_b32 s26, s30, s29
  s_or_b32 s27, s31, s29
  v_mfma_f32_16x16x32_bf16 v[56:59], a[56:59], a[0:3], v[56:59]
  s_add_u32 s88, s88, s90
  s_add_u32 s89, s89, 1
  s_cmp_eq_u32 s89, 3
  s_cselect_b32 s89, 0, s89
  s_cselect_b32 s90, s91, s92
  v_mfma_f32_16x16x32_bf16 v[88:91], a[56:59], a[4:7], v[88:91]
  s_add_u32 s68, s68, s70
  s_add_u32 s69, s69, 1
  s_cmp_eq_u32 s69, 3
  s_cselect_b32 s69, 0, s69
  s_cselect_b32 s70, s71, s72
  v_mfma_f32_16x16x32_bf16 v[120:123], a[56:59], a[8:11], v[120:123]
  v_add_u32 v16, s90, v16
  v_add_u32 v17, s90, v17
  v_mfma_f32_16x16x32_bf16 v[152:155], a[56:59], a[12:15], v[152:155]
  v_add_u32 v18, s70, v18
  v_add_u32 v19, s70, v19
  v_mfma_f32_16x16x32_bf16 v[60:63], a[60:63], a[0:3], v[60:63]
  v_add_u32 v20, s70, v20
  v_add_u32 v21, s70, v21
  v_mfma_f32_16x16x32_bf16 v[92:95], a[60:63], a[4:7], v[92:95]
  v_mfma_f32_16x16x32_bf16 v[124:127], a[60:63], a[8:11], v[124:127]
  v_mfma_f32_16x16x32_bf16 v[156:159], a[60:63], a[12:15], v[156:159]
  s_waitcnt vmcnt(12) lgkmcnt(0)
  s_barrier
  s_mov_b32 s5, 0x40000
Ltg_3:
  v_readfirstlane_b32 s94, v22
  v_readfirstlane_b32 s95, v23
  s_nop 0
  s_cmp_lg_u32 s95, 0
  s_cbranch_scc1 Lpolld_4
  s_sleep 4
  s_mov_b32 s12, s84
  s_mov_b32 s13, s85
  s_mov_b32 s14, 256
  s_mov_b32 s15, 0x00020000
  buffer_load_dwordx2 v[22:23], off, s[12:15], 0 sc1
  s_sub_u32 s5, s5, 1
  s_waitcnt vmcnt(0)
  s_cbranch_scc0 Ltg_3
Lpolld_4:
  v_mov_b32 v3, 0x40000000
  v_mov_b32 v22, s94
  v_cmp_eq_u32 vcc, 0, v0
  v_mov_b32 v23, s95
  s_nop 0
  v_cndmask_b32_e64 v3, v3, 0, vcc
  buffer_store_dwordx2 v[22:23], v3, s[96:99], s34 offen sc1
  v_mfma_f32_16x16x32_bf16 v[32:35], a[64:67], a[16:19], v[32:35]
  s_mov_b32 m0, s68
  ds_read_b128 a[0:3], v16 offset:0
  v_mfma_f32_16x16x32_bf16 v[64:67], a[64:67], a[20:23], v[64:67]
  buffer_load_dwordx4 v8, s[20:23], s28 offen offset:0 lds
  ds_read_b64_tr_b16 a[32:33], v18 offset:0
  v_mfma_f32_16x16x32_bf16 v[96:99], a[64:67], a[24:27], v[96:99]
  ds_read_b64_tr_b16 a[34:35], v18 offset:2048
  v_mfma_f32_16x16x32_bf16 v[128:131], a[64:67], a[28:31], v[128:131]
  ds_read_b128 a[4:7], v16 offset:2048
  v_mfma_f32_16x16x32_bf16 v[36:39], a[68:71], a[16:19], v[36:39]
  ds_read_b128 a[8:11], v16 offset:4096
  v_mfma_f32_16x16x32_bf16 v[68:71], a[68:71], a[20:23], v[68:71]
  buffer_load_dwordx4 v9, s[20:23], s28 offen offset:1024 lds
  ds_read_b128 a[12:15], v16 offset:6144
  v_mfma_f32_16x16x32_bf16 v[100:103], a[68:71], a[24:27], v[100:103]
  ds_read_b64_tr_b16 a[36:37], v19 offset:0
  v_mfma_f32_16x16x32_bf16 v[132:135], a[68:71], a[28:31], v[132:135]
  ds_read_b64_tr_b16 a[38:39], v19 offset:2048
  v_mfma_f32_16x16x32_bf16 v[40:43], a[72:75], a[16:19], v[40:43]
  ds_read_b64_tr_b16 a[40:41], v20 offset:0
  v_mfma_f32_16x16x32_bf16 v[72:75], a[72:75], a[20:23], v[72:75]
  ds_read_b64_tr_b16 a[42:43], v20 offset:2048
  v_mfma_f32_16x16x32_bf16 v[104:107], a[72:75], a[24:27], v[104:107]
  buffer_load_dwordx4 v10, s[20:23], s28 offen offset:2048 lds
  v_mfma_f32_16x16x32_bf16 v[136:139], a[72:75], a[28:31], v[136:139]
  ds_read_b64_tr_b16 a[44:45], v21 offset:0
  v_mfma_f32_16x16x32_bf16 v[44:47], a[76:79], a[16:19], v[44:47]
  ds_read_b64_tr_b16 a[46:47], v21 offset:2048
  v_mfma_f32_16x16x32_bf16 v[76:79], a[76:79], a[20:23], v[76:79]
  ds_read_b64_tr_b16 a[48:49], v18 offset:8192
  v_mfma_f32_16x16x32_bf16 v[108:111], a[76:79], a[24:27], v[108:111]
  ds_read_b64_tr_b16 a[50:51], v18 offset:10240
  v_mfma_f32_16x16x32_bf16 v[140:143], a[76:79], a[28:31], v[140:143]
  buffer_load_dwordx4 v11, s[20:23], s28 offen offset:3072 lds
  ds_read_b64_tr_b16 a[52:53], v19 offset:8192
  v_mfma_f32_16x16x32_bf16 v[48:51], a[80:83], a[16:19], v[48:51]
  s_bfe_u32 s56, 0x302010e, s55
  s_add_u32 s54, s54, s56
  s_add_u32 s55, s55, 8
  v_mfma_f32_16x16x32_bf16 v[80:83], a[80:83], a[20:23], v[80:83]
  s_and_b32 s55, s55, 0x8001f
  s_and_b32 s54, s54, 15
  s_lshl_b32 s28, s54, 19
  v_mfma_f32_16x16x32_bf16 v[112:115], a[80:83], a[24:27], v[112:115]
  s_mov_b32 m0, s88
  ds_read_b64_tr_b16 a[54:55], v19 offset:10240
  ds_read_b64_tr_b16 a[56:57], v20 offset:8192
  v_mfma_f32_16x16x32_bf16 v[144:147], a[80:83], a[28:31], v[144:147]
  ds_read_b64_tr_b16 a[58:59], v20 offset:10240
  ds_read_b64_tr_b16 a[60:61], v21 offset:8192
  v_mfma_f32_16x16x32_bf16 v[52:55], a[84:87], a[16:19], v[52:55]
  buffer_load_dwordx4 v4, s[8:11], s26 offen offset:0 lds
  ds_read_b64_tr_b16 a[62:63], v21 offset:10240
  v_mfma_f32_16x16x32_bf16 v[84:87], a[84:87], a[20:23], v[84:87]
  v_mfma_f32_16x16x32_bf16 v[116:119], a[84:87], a[24:27], v[116:119]
  v_mfma_f32_16x16x32_bf16 v[148:151], a[84:87], a[28:31], v[148:151]
  v_mfma_f32_16x16x32_bf16 v[56:59], a[88:91], a[16:19], v[56:59]
  v_mfma_f32_16x16x32_bf16 v[88:91], a[88:91], a[20:23], v[88:91]
  buffer_load_dwordx4 v5, s[8:11], s26 offen offset:1024 lds
  v_mfma_f32_16x16x32_bf16 v[120:123], a[88:91], a[24:27], v[120:123]
  v_mfma_f32_16x16x32_bf16 v[152:155], a[88:91], a[28:31], v[152:155]
  v_mfma_f32_16x16x32_bf16 v[60:63], a[92:95], a[16:19], v[60:63]
  v_mfma_f32_16x16x32_bf16 v[92:95], a[92:95], a[20:23], v[92:95]
  v_mfma_f32_16x16x32_bf16 v[124:127], a[92:95], a[24:27], v[124:127]
  v_mfma_f32_16x16x32_bf16 v[156:159], a[92:95], a[28:31], v[156:159]
  s_waitcnt lgkmcnt(0)
  v_mfma_f32_16x16x32_bf16 v[32:35], a[32:35], a[0:3], v[32:35]
  buffer_load_dwordx4 v6, s[8:11], s26 offen offset:2048 lds
  ds_read_b128 a[16:19], v17 offset:0
  v_mfma_f32_16x16x32_bf16 v[64:67], a[32:35], a[4:7], v[64:67]
  ds_read_b64_tr_b16 a[64:65], v18 offset:4096
  v_mfma_f32_16x16x32_bf16 v[96:99], a[32:35], a[8:11], v[96:99]
  ds_read_b64_tr_b16 a[66:67], v18 offset:6144
  v_mfma_f32_16x16x32_bf16 v[128:131], a[32:35], a[12:15], v[128:131]
  ds_read_b128 a[20:23], v17 offset:2048
  v_mfma_f32_16x16x32_bf16 v[36:39], a[36:39], a[0:3], v[36:39]
  buffer_load_dwordx4 v7, s[8:11], s26 offen offset:3072 lds
  ds_read_b128 a[24:27], v17 offset:4096
  v_mfma_f32_16x16x32_bf16 v[68:71], a[36:39], a[4:7], v[68:71]
  s_add_u32 m0, s88, 4096
  ds_read_b128 a[28:31], v17 offset:6144
  v_mfma_f32_16x16x32_bf16 v[100:103], a[36:39], a[8:11], v[100:103]
  ds_read_b64_tr_b16 a[68:69], v19 offset:4096
  v_mfma_f32_16x16x32_bf16 v[132:135], a[36:39], a[12:15], v[132:135]
  ds_read_b64_tr_b16 a[70:71], v19 offset:6144
  v_mfma_f32_16x16x32_bf16 v[40:43], a[40:43], a[0:3], v[40:43]
  buffer_load_dwordx4 v4, s[8:11], s27 offen offset:0 lds
  ds_read_b64_tr_b16 a[72:73], v20 offset:4096
  v_mfma_f32_16x16x32_bf16 v[72:75], a[40:43], a[4:7], v[72:75]
  ds_read_b64_tr_b16 a[74:75], v20 offset:6144
  v_mfma_f32_16x16x32_bf16 v[104:107], a[40:43], a[8:11], v[104:107]
  v_mfma_f32_16x16x32_bf16 v[136:139], a[40:43], a[12:15], v[136:139]
  ds_read_b64_tr_b16 a[76:77], v21 offset:4096
  v_mfma_f32_16x16x32_bf16 v[44:47], a[44:47], a[0:3], v[44:47]
  buffer_load_dwordx4 v5, s[8:11], s27 offen offset:1024 lds
  ds_read_b64_tr_b16 a[78:79], v21 offset:6144
  v_mfma_f32_16x16x32_bf16 v[76:79], a[44:47], a[4:7], v[76:79]
  ds_read_b64_tr_b16 a[80:81], v18 offset:12288
  v_mfma_f32_16x16x32_bf16 v[108:111], a[44:47], a[8:11], v[108:111]
  ds_read_b64_tr_b16 a[82:83], v18 offset:14336
  v_mfma_f32_16x16x32_bf16 v[140:143], a[44:47], a[12:15], v[140:143]
  ds_read_b64_tr_b16 a[84:85], v19 offset:12288
  v_mfma_f32_16x16x32_bf16 v[48:51], a[48:51], a[0:3], v[48:51]
  buffer_load_dwordx4 v6, s[8:11], s27 offen offset:2048 lds
  ds_read_b64_tr_b16 a[86:87], v19 offset:14336
  v_mfma_f32_16x16x32_bf16 v[80:83], a[48:51], a[4:7], v[80:83]
  ds_read_b64_tr_b16 a[88:89], v20 offset:12288
  v_mfma_f32_16x16x32_bf16 v[112:115], a[48:51], a[8:11], v[112:115]
  ds_read_b64_tr_b16 a[90:91], v20 offset:14336
  v_mfma_f32_16x16x32_bf16 v[144:147], a[48:51], a[12:15], v[144:147]
  ds_read_b64_tr_b16 a[92:93], v21 offset:12288
  v_mfma_f32_16x16x32_bf16 v[52:55], a[52:55], a[0:3], v[52:55]
  buffer_load_dwordx4 v7, s[8:11], s27 offen offset:3072 lds
  ds_read_b64_tr_b16 a[94:95], v21 offset:14336
  v_mfma_f32_16x16x32_bf16 v[84:87], a[52:55], a[4:7], v[84:87]
  s_bfe_u32 s29, 0x302010e, s53
  s_add_u32 s52, s52, s29
  s_add_u32 s53, s53, 8
  v_mfma_f32_16x16x32_bf16 v[116:119], a[52:55], a[8:11], v[116:119]
  s_and_b32 s53, s53, 0x8001f
  s_and_b32 s52, s52, 15
  s_lshl_b32 s29, s52, 7
  v_mfma_f32_16x16x32_bf16 v[148:151], a[52:55], a[12:15], v[148:151]
  s_or_b32 s26, s30, s29
  s_or_b32 s27, s31, s29
  v_mfma_f32_16x16x32_bf16 v[56:59], a[56:59], a[0:3], v[56:59]
  s_add_u32 s88, s88, s90
  s_add_u32 s89, s89, 1
  s_cmp_eq_u32 s89, 3
  s_cselect_b32 s89, 0, s89
  s_cselect_b32 s90, s91, s92
  v_mfma_f32_16x16x32_bf16 v[88:91], a[56:59], a[4:7], v[88:91]
  s_add_u32 s68, s68, s70
  s_add_u32 s69, s69, 1
  s_cmp_eq_u32 s69, 3
  s_cselect_b32 s69, 0, s69
  s_cselect_b32 s70, s71, s72
  v_mfma_f32_16x16x32_bf16 v[120:123], a[56:59], a[8:11], v[120:123]
  v_add_u32 v16, s90, v16
  v_add_u32 v17, s90, v17
  v_mfma_f32_16x16x32_bf16 v[152:155], a[56:59], a[12:15], v[152:155]
  v_add_u32 v18, s70, v18
  v_add_u32 v19, s70, v19
  v_mfma_f32_16x16x32_bf16 v[60:63], a[60:63], a[0:3], v[60:63]
  v_add_u32 v20, s70, v20
  v_add_u32 v21, s70, v21
  v_mfma_f32_16x16x32_bf16 v[92:95], a[60:63], a[4:7], v[92:95]
  v_mfma_f32_16x16x32_bf16 v[124:127], a[60:63], a[8:11], v[124:127]
  v_mfma_f32_16x16x32_bf16 v[156:159], a[60:63], a[12:15], v[156:159]
  s_mov_b32 s35, 1
  s_waitcnt vmcnt(12) lgkmcnt(0)
  s_barrier
  .p2align 6
Lp3_loop:
  v_mfma_f32_16x16x32_bf16 v[32:35], a[64:67], a[16:19], v[32:35]
  s_mov_b32 m0, s68
  ds_read_b128 a[0:3], v16 offset:0
  v_mfma_f32_16x16x32_bf16 v[64:67], a[64:67], a[20:23], v[64:67]
  buffer_load_dwordx4 v8, s[20:23], s28 offen offset:0 lds
  ds_read_b64_tr_b16 a[32:33], v18 offset:0
  v_mfma_f32_16x16x32_bf16 v[96:99], a[64:67], a[24:27], v[96:99]
  ds_read_b64_tr_b16 a[34:35], v18 offset:2048
  v_mfma_f32_16x16x32_bf16 v[128:131], a[64:67], a[28:31], v[128:131]
  ds_read_b128 a[4:7], v16 offset:2048
  v_mfma_f32_16x16x32_bf16 v[36:39], a[68:71], a[16:19], v[36:39]
  ds_read_b128 a[8:11], v16 offset:4096
  v_mfma_f32_16x16x32_bf16 v[68:71], a[68:71], a[20:23], v[68:71]
  buffer_load_dwordx4 v9, s[20:23], s28 offen offset:1024 lds
  ds_read_b128 a[12:15], v16 offset:6144
  v_mfma_f32_16x16x32_bf16 v[100:103], a[68:71], a[24:27], v[100:103]
  ds_read_b64_tr_b16 a[36:37], v19 offset:0
  v_mfma_f32_16x16x32_bf16 v[132:135], a[68:71], a[28:31], v[132:135]
  ds_read_b64_tr_b16 a[38:39], v19 offset:2048
  v_mfma_f32_16x16x32_bf16 v[40:43], a[72:75], a[16:19], v[40:43]
  ds_read_b64_tr_b16 a[40:41], v20 offset:0
  v_mfma_f32_16x16x32_bf16 v[72:75], a[72:75], a[20:23], v[72:75]
  ds_read_b64_tr_b16 a[42:43], v20 offset:2048
  v_mfma_f32_16x16x32_bf16 v[104:107], a[72:75], a[24:27], v[104:107]
  buffer_load_dwordx4 v10, s[20:23], s28 offen offset:2048 lds
  v_mfma_f32_16x16x32_bf16 v[136:139], a[72:75], a[28:31], v[136:139]
  ds_read_b64_tr_b16 a[44:45], v21 offset:0
  v_mfma_f32_16x16x32_bf16 v[44:47], a[76:79], a[16:19], v[44:47]
  ds_read_b64_tr_b16 a[46:47], v21 offset:2048
  v_mfma_f32_16x16x32_bf16 v[76:79], a[76:79], a[20:23], v[76:79]
  ds_read_b64_tr_b16 a[48:49], v18 offset:8192
  v_mfma_f32_16x16x32_bf16 v[108:111], a[76:79], a[24:27], v[108:111]
  ds_read_b64_tr_b16 a[50:51], v18 offset:10240
  v_mfma_f32_16x16x32_bf16 v[140:143], a[76:79], a[28:31], v[140:143]
  buffer_load_dwordx4 v11, s[20:23], s28 offen offset:3072 lds
  ds_read_b64_tr_b16 a[52:53], v19 offset:8192
  v_mfma_f32_16x16x32_bf16 v[48:51], a[80:83], a[16:19], v[48:51]
  s_bfe_u32 s56, 0x302010e, s55
  s_add_u32 s54, s54, s56
  s_add_u32 s55, s55, 8
  v_mfma_f32_16x16x32_bf16 v[80:83], a[80:83], a[20:23], v[80:83]
  s_and_b32 s55, s55, 0x8001f
  s_and_b32 s54, s54, 15
  s_lshl_b32 s28, s54, 19
  v_mfma_f32_16x16x32_bf16 v[112:115], a[80:83], a[24:27], v[112:115]
  s_mov_b32 m0, s88
  ds_read_b64_tr_b16 a[54:55], v19 offset:10240
  ds_read_b64_tr_b16 a[56:57], v20 offset:8192
  v_mfma_f32_16x16x32_bf16 v[144:147], a[80:83], a[28:31], v[144:147]
  ds_read_b64_tr_b16 a[58:59], v20 offset:10240
  ds_read_b64_tr_b16 a[60:61], v21 offset:8192
  v_mfma_f32_16x16x32_bf16 v[52:55], a[84:87], a[16:19], v[52:55]
  buffer_load_dwordx4 v4, s[8:11], s26 offen offset:0 lds
  ds_read_b64_tr_b16 a[62:63], v21 offset:10240
  v_mfma_f32_16x16x32_bf16 v[84:87], a[84:87], a[20:23], v[84:87]
  v_mfma_f32_16x16x32_bf16 v[116:119], a[84:87], a[24:27], v[116:119]
  v_mfma_f32_16x16x32_bf16 v[148:151], a[84:87], a[28:31], v[148:151]
  v_mfma_f32_16x16x32_bf16 v[56:59], a[88:91], a[16:19], v[56:59]
  v_mfma_f32_16x16x32_bf16 v[88:91], a[88:91], a[20:23], v[88:91]
  buffer_load_dwordx4 v5, s[8:11], s26 offen offset:1024 lds
  v_mfma_f32_16x16x32_bf16 v[120:123], a[88:91], a[24:27], v[120:123]
  v_mfma_f32_16x16x32_bf16 v[152:155], a[88:91], a[28:31], v[152:155]
  v_mfma_f32_16x16x32_bf16 v[60:63], a[92:95], a[16:19], v[60:63]
  v_mfma_f32_16x16x32_bf16 v[92:95], a[92:95], a[20:23], v[92:95]
  v_mfma_f32_16x16x32_bf16 v[124:127], a[92:95], a[24:27], v[124:127]
  v_mfma_f32_16x16x32_bf16 v[156:159], a[92:95], a[28:31], v[156:159]
  s_waitcnt lgkmcnt(0)
  v_mfma_f32_16x16x32_bf16 v[32:35], a[32:35], a[0:3], v[32:35]
  buffer_load_dwordx4 v6, s[8:11], s26 offen offset:2048 lds
  ds_read_b128 a[16:19], v17 offset:0
  v_mfma_f32_16x16x32_bf16 v[64:67], a[32:35], a[4:7], v[64:67]
  ds_read_b64_tr_b16 a[64:65], v18 offset:4096
  v_mfma_f32_16x16x32_bf16 v[96:99], a[32:35], a[8:11], v[96:99]
  ds_read_b64_tr_b16 a[66:67], v18 offset:6144
  v_mfma_f32_16x16x32_bf16 v[128:131], a[32:35], a[12:15], v[128:131]
  ds_read_b128 a[20:23], v17 offset:2048
  v_mfma_f32_16x16x32_bf16 v[36:39], a[36:39], a[0:3], v[36:39]
  buffer_load_dwordx4 v7, s[8:11], s26 offen offset:3072 lds
  ds_read_b128 a[24:27], v17 offset:4096
  v_mfma_f32_16x16x32_bf16 v[68:71], a[36:39], a[4:7], v[68:71]
  s_add_u32 m0, s88, 4096
  ds_read_b128 a[28:31], v17 offset:6144
  v_mfma_f32_16x16x32_bf16 v[100:103], a[36:39], a[8:11], v[100:103]
  ds_read_b64_tr_b16 a[68:69], v19 offset:4096
  v_mfma_f32_16x16x32_bf16 v[132:135], a[36:39], a[12:15], v[132:135]
  ds_read_b64_tr_b16 a[70:71], v19 offset:6144
  v_mfma_f32_16x16x32_bf16 v[40:43], a[40:43], a[0:3], v[40:43]
  buffer_load_dwordx4 v4, s[8:11], s27 offen offset:0 lds
  ds_read_b64_tr_b16 a[72:73], v20 offset:4096
  v_mfma_f32_16x16x32_bf16 v[72:75], a[40:43], a[4:7], v[72:75]
  ds_read_b64_tr_b16 a[74:75], v20 offset:6144
  v_mfma_f32_16x16x32_bf16 v[104:107], a[40:43], a[8:11], v[104:107]
  v_mfma_f32_16x16x32_bf16 v[136:139], a[40:43], a[12:15], v[136:139]
  ds_read_b64_tr_b16 a[76:77], v21 offset:4096
  v_mfma_f32_16x16x32_bf16 v[44:47], a[44:47], a[0:3], v[44:47]
  buffer_load_dwordx4 v5, s[8:11], s27 offen offset:1024 lds
  ds_read_b64_tr_b16 a[78:79], v21 offset:6144
  v_mfma_f32_16x16x32_bf16 v[76:79], a[44:47], a[4:7], v[76:79]
  ds_read_b64_tr_b16 a[80:81], v18 offset:12288
  v_mfma_f32_16x16x32_bf16 v[108:111], a[44:47], a[8:11], v[108:111]
  ds_read_b64_tr_b16 a[82:83], v18 offset:14336
  v_mfma_f32_16x16x32_bf16 v[140:143], a[44:47], a[12:15], v[140:143]
  ds_read_b64_tr_b16 a[84:85], v19 offset:12288
  v_mfma_f32_16x16x32_bf16 v[48:51], a[48:51], a[0:3], v[48:51]
  buffer_load_dwordx4 v6, s[8:11], s27 offen offset:2048 lds
  ds_read_b64_tr_b16 a[86:87], v19 offset:14336
  v_mfma_f32_16x16x32_bf16 v[80:83], a[48:51], a[4:7], v[80:83]
  ds_read_b64_tr_b16 a[88:89], v20 offset:12288
  v_mfma_f32_16x16x32_bf16 v[112:115], a[48:51], a[8:11], v[112:115]
  ds_read_b64_tr_b16 a[90:91], v20 offset:14336
  v_mfma_f32_16x16x32_bf16 v[144:147], a[48:51], a[12:15], v[144:147]
  ds_read_b64_tr_b16 a[92:93], v21 offset:12288
  v_mfma_f32_16x16x32_bf16 v[52:55], a[52:55], a[0:3], v[52:55]
  buffer_load_dwordx4 v7, s[8:11], s27 offen offset:3072 lds
  ds_read_b64_tr_b16 a[94:95], v21 offset:14336
  v_mfma_f32_16x16x32_bf16 v[84:87], a[52:55], a[4:7], v[84:87]
  s_bfe_u32 s29, 0x302010e, s53
  s_add_u32 s52, s52, s29
  s_add_u32 s53, s53, 8
  v_mfma_f32_16x16x32_bf16 v[116:119], a[52:55], a[8:11], v[116:119]
  s_and_b32 s53, s53, 0x8001f
  s_and_b32 s52, s52, 15
  s_lshl_b32 s29, s52, 7
  v_mfma_f32_16x16x32_bf16 v[148:151], a[52:55], a[12:15], v[148:151]
  s_or_b32 s26, s30, s29
  s_or_b32 s27, s31, s29
  v_mfma_f32_16x16x32_bf16 v[56:59], a[56:59], a[0:3], v[56:59]
  s_add_u32 s88, s88, s90
  s_add_u32 s89, s89, 1
  s_cmp_eq_u32 s89, 3
  s_cselect_b32 s89, 0, s89
  s_cselect_b32 s90, s91, s92
  v_mfma_f32_16x16x32_bf16 v[88:91], a[56:59], a[4:7], v[88:91]
  s_add_u32 s68, s68, s70
  s_add_u32 s69, s69, 1
  s_cmp_eq_u32 s69, 3
  s_cselect_b32 s69, 0, s69
  s_cselect_b32 s70, s71, s72
  v_mfma_f32_16x16x32_bf16 v[120:123], a[56:59], a[8:11], v[120:123]
  v_add_u32 v16, s90, v16
  v_add_u32 v17, s90, v17
  v_mfma_f32_16x16x32_bf16 v[152:155], a[56:59], a[12:15], v[152:155]
  v_add_u32 v18, s70, v18
  v_add_u32 v19, s70, v19
  v_mfma_f32_16x16x32_bf16 v[60:63], a[60:63], a[0:3], v[60:63]
  v_add_u32 v20, s70, v20
  v_add_u32 v21, s70, v21
  v_mfma_f32_16x16x32_bf16 v[92:95], a[60:63], a[4:7], v[92:95]
  s_waitcnt vmcnt(12) lgkmcnt(0)
  s_barrier
  v_mfma_f32_16x16x32_bf16 v[124:127], a[60:63], a[8:11], v[124:127]
  s_sub_u32 s35, s35, 1
  v_mfma_f32_16x16x32_bf16 v[156:159], a[60:63], a[12:15], v[156:159]
  s_cmp_lg_u32 s35, 0
  s_cbranch_scc1 Lp3_loop
  s_lshr_b32 s34, s24, 1
  s_lshl_b32 s34, s34, 11
  v_and_b32 v3, 7, v1
  v_lshlrev_b32 v3, 7, v3
  v_mfma_f32_16x16x32_bf16 v[32:35], a[64:67], a[16:19], v[32:35]
  buffer_load_dwordx2 v[22:23], v3, s[96:99], s34 offen sc1
  ds_read_b128 a[0:3], v16 offset:0
  v_mfma_f32_16x16x32_bf16 v[64:67], a[64:67], a[20:23], v[64:67]
  s_mov_b32 m0, s68
  ds_read_b64_tr_b16 a[32:33], v18 offset:0
  v_mfma_f32_16x16x32_bf16 v[96:99], a[64:67], a[24:27], v[96:99]
  ds_read_b64_tr_b16 a[34:35], v18 offset:2048
  v_mfma_f32_16x16x32_bf16 v[128:131], a[64:67], a[28:31], v[128:131]
  ds_read_b128 a[4:7], v16 offset:2048
  v_mfma_f32_16x16x32_bf16 v[36:39], a[68:71], a[16:19], v[36:39]
  buffer_load_dwordx4 v8, s[20:23], s28 offen offset:0 lds
  ds_read_b128 a[8:11], v16 offset:4096
  v_mfma_f32_16x16x32_bf16 v[68:71], a[68:71], a[20:23], v[68:71]
  ds_read_b128 a[12:15], v16 offset:6144
  v_mfma_f32_16x16x32_bf16 v[100:103], a[68:71], a[24:27], v[100:103]
  ds_read_b64_tr_b16 a[36:37], v19 offset:0
  v_mfma_f32_16x16x32_bf16 v[132:135], a[68:71], a[28:31], v[132:135]
  ds_read_b64_tr_b16 a[38:39], v19 offset:2048
  v_mfma_f32_16x16x32_bf16 v[40:43], a[72:75], a[16:19], v[40:43]
  buffer_load_dwordx4 v9, s[20:23], s28 offen offset:1024 lds
  ds_read_b64_tr_b16 a[40:41], v20 offset:0
  v_mfma_f32_16x16x32_bf16 v[72:75], a[72:75], a[20:23], v[72:75]
  ds_read_b64_tr_b16 a[42:43], v20 offset:2048
  v_mfma_f32_16x16x32_bf16 v[104:107], a[72:75], a[24:27], v[104:107]
  v_mfma_f32_16x16x32_bf16 v[136:139], a[72:75], a[28:31], v[136:139]
  ds_read_b64_tr_b16 a[44:45], v21 offset:0
  v_mfma_f32_16x16x32_bf16 v[44:47], a[76:79], a[16:19], v[44:47]
  ds_read_b64_tr_b16 a[46:47], v21 offset:2048
  v_mfma_f32_16x16x32_bf16 v[76:79], a[76:79], a[20:23], v[76:79]
  buffer_load_dwordx4 v10, s[20:23], s28 offen offset:2048 lds
  ds_read_b64_tr_b16 a[48:49], v18 offset:8192
  v_mfma_f32_16x16x32_bf16 v[108:111], a[76:79], a[24:27], v[108:111]
  ds_read_b64_tr_b16 a[50:51], v18 offset:10240
  v_mfma_f32_16x16x32_bf16 v[140:143], a[76:79], a[28:31], v[140:143]
  ds_read_b64_tr_b16 a[52:53], v19 offset:8192
  v_mfma_f32_16x16x32_bf16 v[48:51], a[80:83], a[16:19], v[48:51]
  ds_read_b64_tr_b16 a[54:55], v19 offset:10240
  v_mfma_f32_16x16x32_bf16 v[80:83], a[80:83], a[20:23], v[80:83]
  buffer_load_dwordx4 v11, s[20:23], s28 offen offset:3072 lds
  ds_read_b64_tr_b16 a[56:57], v20 offset:8192
  v_mfma_f32_16x16x32_bf16 v[112:115], a[80:83], a[24:27], v[112:115]
  s_bfe_u32 s56, 0x302010e, s55
  s_add_u32 s54, s54, s56
  s_add_u32 s55, s55, 8
  v_mfma_f32_16x16x32_bf16 v[144:147], a[80:83], a[28:31], v[144:147]
  s_and_b32 s55, s55, 0x8001f
  s_and_b32 s54, s54, 15
  s_lshl_b32 s28, s54, 19
  v_mfma_f32_16x16x32_bf16 v[52:55], a[84:87], a[16:19], v[52:55]
  s_mov_b32 m0, s88
  ds_read_b64_tr_b16 a[58:59], v20 offset:10240
  ds_read_b64_tr_b16 a[60:61], v21 offset:8192
  v_mfma_f32_16x16x32_bf16 v[84:87], a[84:87], a[20:23], v[84:87]
  ds_read_b64_tr_b16 a[62:63], v21 offset:10240
  v_mfma_f32_16x16x32_bf16 v[116:119], a[84:87], a[24:27], v[116:119]
  buffer_load_dwordx4 v4, s[8:11], s26 offen offset:0 lds
  v_mfma_f32_16x16x32_bf16 v[148:151], a[84:87], a[28:31], v[148:151]
  v_mfma_f32_16x16x32_bf16 v[56:59], a[88:91], a[16:19], v[56:59]
  v_mfma_f32_16x16x32_bf16 v[88:91], a[88:91], a[20:23], v[88:91]
  v_mfma_f32_16x16x32_bf16 v[120:123], a[88:91], a[24:27], v[120:123]
  buffer_load_dwordx4 v5, s[8:11], s26 offen offset:1024 lds
  v_mfma_f32_16x16x32_bf16 v[152:155], a[88:91], a[28:31], v[152:155]
  v_mfma_f32_16x16x32_bf16 v[60:63], a[92:95], a[16:19], v[60:63]
  v_mfma_f32_16x16x32_bf16 v[92:95], a[92:95], a[20:23], v[92:95]
  v_mfma_f32_16x16x32_bf16 v[124:127], a[92:95], a[24:27], v[124:127]
  v_mfma_f32_16x16x32_bf16 v[156:159], a[92:95], a[28:31], v[156:159]
  s_waitcnt lgkmcnt(0)
  v_mfma_f32_16x16x32_bf16 v[32:35], a[32:35], a[0:3], v[32:35]
  buffer_load_dwordx4 v6, s[8:11], s26 offen offset:2048 lds
  ds_read_b128 a[16:19], v17 offset:0
  v_mfma_f32_16x16x32_bf16 v[64:67], a[32:35], a[4:7], v[64:67]
  ds_read_b64_tr_b16 a[64:65], v18 offset:4096
  v_mfma_f32_16x16x32_bf16 v[96:99], a[32:35], a[8:11], v[96:99]
  ds_read_b64_tr_b16 a[66:67], v18 offset:6144
  v_mfma_f32_16x16x32_bf16 v[128:131], a[32:35], a[12:15], v[128:131]
  ds_read_b128 a[20:23], v17 offset:2048
  v_mfma_f32_16x16x32_bf16 v[36:39], a[36:39], a[0:3], v[36:39]
  buffer_load_dwordx4 v7, s[8:11], s26 offen offset:3072 lds
  ds_read_b128 a[24:27], v17 offset:4096
  v_mfma_f32_16x16x32_bf16 v[68:71], a[36:39], a[4:7], v[68:71]
  s_add_u32 m0, s88, 4096
  ds_read_b128 a[28:31], v17 offset:6144
  v_mfma_f32_16x16x32_bf16 v[100:103], a[36:39], a[8:11], v[100:103]
  ds_read_b64_tr_b16 a[68:69], v19 offset:4096
  v_mfma_f32_16x16x32_bf16 v[132:135], a[36:39], a[12:15], v[132:135]
  ds_read_b64_tr_b16 a[70:71], v19 offset:6144
  v_mfma_f32_16x16x32_bf16 v[40:43], a[40:43], a[0:3], v[40:43]
  buffer_load_dwordx4 v4, s[8:11], s27 offen offset:0 lds
  ds_read_b64_tr_b16 a[72:73], v20 offset:4096
  v_mfma_f32_16x16x32_bf16 v[72:75], a[40:43], a[4:7], v[72:75]
  ds_read_b64_tr_b16 a[74:75], v20 offset:6144
  v_mfma_f32_16x16x32_bf16 v[104:107], a[40:43], a[8:11], v[104:107]
  v_mfma_f32_16x16x32_bf16 v[136:139], a[40:43], a[12:15], v[136:139]
  ds_read_b64_tr_b16 a[76:77], v21 offset:4096
  v_mfma_f32_16x16x32_bf16 v[44:47], a[44:47], a[0:3], v[44:47]
  buffer_load_dwordx4 v5, s[8:11], s27 offen offset:1024 lds
  ds_read_b64_tr_b16 a[78:79], v21 offset:6144
  v_mfma_f32_16x16x32_bf16 v[76:79], a[44:47], a[4:7], v[76:79]
  ds_read_b64_tr_b16 a[80:81], v18 offset:12288
  v_mfma_f32_16x16x32_bf16 v[108:111], a[44:47], a[8:11], v[108:111]
  ds_read_b64_tr_b16 a[82:83], v18 offset:14336
  v_mfma_f32_16x16x32_bf16 v[140:143], a[44:47], a[12:15], v[140:143]
  ds_read_b64_tr_b16 a[84:85], v19 offset:12288
  v_mfma_f32_16x16x32_bf16 v[48:51], a[48:51], a[0:3], v[48:51]
  buffer_load_dwordx4 v6, s[8:11], s27 offen offset:2048 lds
  ds_read_b64_tr_b16 a[86:87], v19 offset:14336
  v_mfma_f32_16x16x32_bf16 v[80:83], a[48:51], a[4:7], v[80:83]
  ds_read_b64_tr_b16 a[88:89], v20 offset:12288
  v_mfma_f32_16x16x32_bf16 v[112:115], a[48:51], a[8:11], v[112:115]
  ds_read_b64_tr_b16 a[90:91], v20 offset:14336
  v_mfma_f32_16x16x32_bf16 v[144:147], a[48:51], a[12:15], v[144:147]
  ds_read_b64_tr_b16 a[92:93], v21 offset:12288
  v_mfma_f32_16x16x32_bf16 v[52:55], a[52:55], a[0:3], v[52:55]
  buffer_load_dwordx4 v7, s[8:11], s27 offen offset:3072 lds
  ds_read_b64_tr_b16 a[94:95], v21 offset:14336
  v_mfma_f32_16x16x32_bf16 v[84:87], a[52:55], a[4:7], v[84:87]
  s_bfe_u32 s29, 0x302010e, s53
  s_add_u32 s52, s52, s29
  s_add_u32 s53, s53, 8
  v_mfma_f32_16x16x32_bf16 v[116:119], a[52:55], a[8:11], v[116:119]
  s_and_b32 s53, s53, 0x8001f
  s_and_b32 s52, s52, 15
  s_lshl_b32 s29, s52, 7
  v_mfma_f32_16x16x32_bf16 v[148:151], a[52:55], a[12:15], v[148:151]
  s_or_b32 s26, s30, s29
  s_or_b32 s27, s31, s29
  v_mfma_f32_16x16x32_bf16 v[56:59], a[56:59], a[0:3], v[56:59]
  s_add_u32 s88, s88, s90
  s_add_u32 s89, s89, 1
  s_cmp_eq_u32 s89, 3
  s_cselect_b32 s89, 0, s89
  s_cselect_b32 s90, s91, s92
  v_mfma_f32_16x16x32_bf16 v[88:91], a[56:59], a[4:7], v[88:91]
  s_add_u32 s68, s68, s70
  s_add_u32 s69, s69, 1
  s_cmp_eq_u32 s69, 3
  s_cselect_b32 s69, 0, s69
  s_cselect_b32 s70, s71, s72
  v_mfma_f32_16x16x32_bf16 v[120:123], a[56:59], a[8:11], v[120:123]
  v_add_u32 v16, s90, v16
  v_add_u32 v17, s90, v17
  v_mfma_f32_16x16x32_bf16 v[152:155], a[56:59], a[12:15], v[152:155]
  v_add_u32 v18, s70, v18
  v_add_u32 v19, s70, v19
  v_mfma_f32_16x16x32_bf16 v[60:63], a[60:63], a[0:3], v[60:63]
  v_add_u32 v20, s70, v20
  v_add_u32 v21, s70, v21
  v_mfma_f32_16x16x32_bf16 v[92:95], a[60:63], a[4:7], v[92:95]
  v_mfma_f32_16x16x32_bf16 v[124:127], a[60:63], a[8:11], v[124:127]
  v_mfma_f32_16x16x32_bf16 v[156:159], a[60:63], a[12:15], v[156:159]
  s_waitcnt vmcnt(12) lgkmcnt(0)
  s_barrier
  s_mov_b32 s5, 0x40000
Lpoll_5:
  v_cmp_ne_u64 vcc, s[94:95], v[22:23]
  s_nop 0
  s_cbranch_vccz Lpolld_6
  s_sleep 4
  buffer_load_dwordx2 v[22:23], v3, s[96:99], s34 offen sc1
  s_sub_u32 s5, s5, 1
  s_waitcnt vmcnt(0)
  s_cbranch_scc0 Lpoll_5
Lpolld_6:
  s_lshl_b32 s4, s24, 20
  s_lshl_b32 s5, s25, 16
  s_sub_u32 s5, 1048576, s5
  s_add_u32 s20, s86, 16777216
  s_addc_u32 s21, s87, 0
  s_add_u32 s20, s20, s4
  s_addc_u32 s21, s21, 0
  s_mov_b32 s22, s5
  s_mov_b32 s23, 0x00020000
  s_lshl_b32 s28, s3, 12
  s_add_u32 s26, s28, 0xc000
  s_add_u32 s27, s28, 0x10000
  s_add_u32 s29, s28, 0x4000
  s_and_b32 s4, s2, 1
  s_lshl_b32 s4, s4, 3
  s_bfe_u32 s5, s2, 0x30003
  s_add_u32 s73, s4, s5
  s_bfe_u32 s4, s2, 0x10001
  s_lshl_b32 s4, s4, 2
  s_lshr_b32 s5, s2, 6
  s_add_u32 s76, s4, s5
  s_bfe_u32 s77, s2, 0x10002
  s_lshl_b32 s78, s73, 3
  s_add_u32 s78, s78, s76
  s_lshl_b32 s79, s3, 12
  s_add_u32 s64, s79, 131072
  v_mfma_f32_16x16x32_bf16 v[32:35], a[64:67], a[16:19], v[32:35]
  s_mov_b32 m0, s26
  ds_read_b128 a[0:3], v16 offset:0
  v_mfma_f32_16x16x32_bf16 v[64:67], a[64:67], a[20:23], v[64:67]
  buffer_load_dwordx4 v2, s[20:23], s28 offen offset:0 sc1 lds
  ds_read_b64_tr_b16 a[32:33], v18 offset:0
  v_mfma_f32_16x16x32_bf16 v[96:99], a[64:67], a[24:27], v[96:99]
  ds_read_b64_tr_b16 a[34:35], v18 offset:2048
  v_mfma_f32_16x16x32_bf16 v[128:131], a[64:67], a[28:31], v[128:131]
  ds_read_b128 a[4:7], v16 offset:2048
  v_mfma_f32_16x16x32_bf16 v[36:39], a[68:71], a[16:19], v[36:39]
  ds_read_b128 a[8:11], v16 offset:4096
  v_mfma_f32_16x16x32_bf16 v[68:71], a[68:71], a[20:23], v[68:71]
  ds_read_b128 a[12:15], v16 offset:6144
  v_mfma_f32_16x16x32_bf16 v[100:103], a[68:71], a[24:27], v[100:103]
  ds_read_b64_tr_b16 a[36:37], v19 offset:0
  v_mfma_f32_16x16x32_bf16 v[132:135], a[68:71], a[28:31], v[132:135]
  ds_read_b64_tr_b16 a[38:39], v19 offset:2048
  v_mfma_f32_16x16x32_bf16 v[40:43], a[72:75], a[16:19], v[40:43]
  ds_read_b64_tr_b16 a[40:41], v20 offset:0
  v_mfma_f32_16x16x32_bf16 v[72:75], a[72:75], a[20:23], v[72:75]
  ds_read_b64_tr_b16 a[42:43], v20 offset:2048
  v_mfma_f32_16x16x32_bf16 v[104:107], a[72:75], a[24:27], v[104:107]
  v_mfma_f32_16x16x32_bf16 v[136:139], a[72:75], a[28:31], v[136:139]
  ds_read_b64_tr_b16 a[44:45], v21 offset:0
  v_mfma_f32_16x16x32_bf16 v[44:47], a[76:79], a[16:19], v[44:47]
  ds_read_b64_tr_b16 a[46:47], v21 offset:2048
  v_mfma_f32_16x16x32_bf16 v[76:79], a[76:79], a[20:23], v[76:79]
  ds_read_b64_tr_b16 a[48:49], v18 offset:8192
  v_mfma_f32_16x16x32_bf16 v[108:111], a[76:79], a[24:27], v[108:111]
  ds_read_b64_tr_b16 a[50:51], v18 offset:10240
  v_mfma_f32_16x16x32_bf16 v[140:143], a[76:79], a[28:31], v[140:143]
  buffer_load_dwordx4 v2, s[20:23], s28 offen offset:1024 sc1 lds
  ds_read_b64_tr_b16 a[52:53], v19 offset:8192
  v_mfma_f32_16x16x32_bf16 v[48:51], a[80:83], a[16:19], v[48:51]
  ds_read_b64_tr_b16 a[54:55], v19 offset:10240
  v_mfma_f32_16x16x32_bf16 v[80:83], a[80:83], a[20:23], v[80:83]
  ds_read_b64_tr_b16 a[56:57], v20 offset:8192
  v_mfma_f32_16x16x32_bf16 v[112:115], a[80:83], a[24:27], v[112:115]
  ds_read_b64_tr_b16 a[58:59], v20 offset:10240
  v_mfma_f32_16x16x32_bf16 v[144:147], a[80:83], a[28:31], v[144:147]
  ds_read_b64_tr_b16 a[60:61], v21 offset:8192
  v_mfma_f32_16x16x32_bf16 v[52:55], a[84:87], a[16:19], v[52:55]
  ds_read_b64_tr_b16 a[62:63], v21 offset:10240
  v_mfma_f32_16x16x32_bf16 v[84:87], a[84:87], a[20:23], v[84:87]
  v_mfma_f32_16x16x32_bf16 v[116:119], a[84:87], a[24:27], v[116:119]
  v_mfma_f32_16x16x32_bf16 v[148:151], a[84:87], a[28:31], v[148:151]
  v_mfma_f32_16x16x32_bf16 v[56:59], a[88:91], a[16:19], v[56:59]
  v_mfma_f32_16x16x32_bf16 v[88:91], a[88:91], a[20:23], v[88:91]
  v_mfma_f32_16x16x32_bf16 v[120:123], a[88:91], a[24:27], v[120:123]
  v_mfma_f32_16x16x32_bf16 v[152:155], a[88:91], a[28:31], v[152:155]
  v_mfma_f32_16x16x32_bf16 v[60:63], a[92:95], a[16:19], v[60:63]
  v_mfma_f32_16x16x32_bf16 v[92:95], a[92:95], a[20:23], v[92:95]
  v_mfma_f32_16x16x32_bf16 v[124:127], a[92:95], a[24:27], v[124:127]
  v_mfma_f32_16x16x32_bf16 v[156:159], a[92:95], a[28:31], v[156:159]
  s_waitcnt lgkmcnt(0)
  v_mfma_f32_16x16x32_bf16 v[32:35], a[32:35], a[0:3], v[32:35]
  buffer_load_dwordx4 v2, s[20:23], s28 offen offset:2048 sc1 lds
  ds_read_b128 a[16:19], v17 offset:0
  v_mfma_f32_16x16x32_bf16 v[64:67], a[32:35], a[4:7], v[64:67]
  ds_read_b64_tr_b16 a[64:65], v18 offset:4096
  v_mfma_f32_16x16x32_bf16 v[96:99], a[32:35], a[8:11], v[96:99]
  ds_read_b64_tr_b16 a[66:67], v18 offset:6144
  v_mfma_f32_16x16x32_bf16 v[128:131], a[32:35], a[12:15], v[128:131]
  ds_read_b128 a[20:23], v17 offset:2048
  v_mfma_f32_16x16x32_bf16 v[36:39], a[36:39], a[0:3], v[36:39]
  ds_read_b128 a[24:27], v17 offset:4096
  v_mfma_f32_16x16x32_bf16 v[68:71], a[36:39], a[4:7], v[68:71]
  ds_read_b128 a[28:31], v17 offset:6144
  v_mfma_f32_16x16x32_bf16 v[100:103], a[36:39], a[8:11], v[100:103]
  ds_read_b64_tr_b16 a[68:69], v19 offset:4096
  v_mfma_f32_16x16x32_bf16 v[132:135], a[36:39], a[12:15], v[132:135]
  ds_read_b64_tr_b16 a[70:71], v19 offset:6144
  v_mfma_f32_16x16x32_bf16 v[40:43], a[40:43], a[0:3], v[40:43]
  ds_read_b64_tr_b16 a[72:73], v20 offset:4096
  v_mfma_f32_16x16x32_bf16 v[72:75], a[40:43], a[4:7], v[72:75]
  ds_read_b64_tr_b16 a[74:75], v20 offset:6144
  v_mfma_f32_16x16x32_bf16 v[104:107], a[40:43], a[8:11], v[104:107]
  v_mfma_f32_16x16x32_bf16 v[136:139], a[40:43], a[12:15], v[136:139]
  ds_read_b64_tr_b16 a[76:77], v21 offset:4096
  v_mfma_f32_16x16x32_bf16 v[44:47], a[44:47], a[0:3], v[44:47]
  buffer_load_dwordx4 v2, s[20:23], s28 offen offset:3072 sc1 lds
  ds_read_b64_tr_b16 a[78:79], v21 offset:6144
  v_mfma_f32_16x16x32_bf16 v[76:79], a[44:47], a[4:7], v[76:79]
  s_xor_b32 s26, s26, 0x4000
  s_add_u32 s28, s28, 0x8000
  ds_read_b64_tr_b16 a[80:81], v18 offset:12288
  v_mfma_f32_16x16x32_bf16 v[108:111], a[44:47], a[8:11], v[108:111]
  s_add_u32 s88, s88, s90
  s_add_u32 s89, s89, 1
  ds_read_b64_tr_b16 a[82:83], v18 offset:14336
  v_mfma_f32_16x16x32_bf16 v[140:143], a[44:47], a[12:15], v[140:143]
  s_cmp_eq_u32 s89, 3
  s_cselect_b32 s89, 0, s89
  s_cselect_b32 s90, s91, s92
  ds_read_b64_tr_b16 a[84:85], v19 offset:12288
  v_mfma_f32_16x16x32_bf16 v[48:51], a[48:51], a[0:3], v[48:51]
  s_add_u32 s68, s68, s70
  s_add_u32 s69, s69, 1
  ds_read_b64_tr_b16 a[86:87], v19 offset:14336
  v_mfma_f32_16x16x32_bf16 v[80:83], a[48:51], a[4:7], v[80:83]
  s_cmp_eq_u32 s69, 3
  s_cselect_b32 s69, 0, s69
  s_cselect_b32 s70, s71, s72
  ds_read_b64_tr_b16 a[88:89], v20 offset:12288
  v_mfma_f32_16x16x32_bf16 v[112:115], a[48:51], a[8:11], v[112:115]
  ds_read_b64_tr_b16 a[90:91], v20 offset:14336
  v_mfma_f32_16x16x32_bf16 v[144:147], a[48:51], a[12:15], v[144:147]
  ds_read_b64_tr_b16 a[92:93], v21 offset:12288
  v_mfma_f32_16x16x32_bf16 v[52:55], a[52:55], a[0:3], v[52:55]
  ds_read_b64_tr_b16 a[94:95], v21 offset:14336
  v_mfma_f32_16x16x32_bf16 v[84:87], a[52:55], a[4:7], v[84:87]
  v_add_u32 v16, s90, v16
  v_add_u32 v17, s90, v17
  v_mfma_f32_16x16x32_bf16 v[116:119], a[52:55], a[8:11], v[116:119]
  v_add_u32 v18, s70, v18
  v_add_u32 v19, s70, v19
  v_mfma_f32_16x16x32_bf16 v[148:151], a[52:55], a[12:15], v[148:151]
  v_add_u32 v20, s70, v20
  v_add_u32 v21, s70, v21
  v_mfma_f32_16x16x32_bf16 v[56:59], a[56:59], a[0:3], v[56:59]
  v_mfma_f32_16x16x32_bf16 v[88:91], a[56:59], a[4:7], v[88:91]
  v_mfma_f32_16x16x32_bf16 v[120:123], a[56:59], a[8:11], v[120:123]
  v_mfma_f32_16x16x32_bf16 v[152:155], a[56:59], a[12:15], v[152:155]
  v_mfma_f32_16x16x32_bf16 v[60:63], a[60:63], a[0:3], v[60:63]
  v_mfma_f32_16x16x32_bf16 v[92:95], a[60:63], a[4:7], v[92:95]
  v_mfma_f32_16x16x32_bf16 v[124:127], a[60:63], a[8:11], v[124:127]
  v_mfma_f32_16x16x32_bf16 v[156:159], a[60:63], a[12:15], v[156:159]
  s_waitcnt vmcnt(4) lgkmcnt(0)
  s_barrier
  s_mov_b32 s6, 0x3e0293ee
  s_mov_b32 s7, s6
  v_mfma_f32_16x16x32_bf16 v[32:35], a[64:67], a[16:19], v[32:35]
  s_mov_b32 m0, s26
  ds_read_b128 a[0:3], v16 offset:0
  v_mfma_f32_16x16x32_bf16 v[64:67], a[64:67], a[20:23], v[64:67]
  buffer_load_dwordx4 v2, s[20:23], s28 offen offset:0 sc1 lds
  ds_read_b64_tr_b16 a[32:33], v18 offset:0
  v_mfma_f32_16x16x32_bf16 v[96:99], a[64:67], a[24:27], v[96:99]
  ds_read_b64_tr_b16 a[34:35], v18 offset:2048
  v_mfma_f32_16x16x32_bf16 v[128:131], a[64:67], a[28:31], v[128:131]
  buffer_load_dwordx4 v2, s[20:23], s28 offen offset:1024 sc1 lds
  ds_read_b128 a[4:7], v16 offset:2048
  v_mfma_f32_16x16x32_bf16 v[36:39], a[68:71], a[16:19], v[36:39]
  ds_read_b128 a[8:11], v16 offset:4096
  v_mfma_f32_16x16x32_bf16 v[68:71], a[68:71], a[20:23], v[68:71]
  ds_read_b128 a[12:15], v16 offset:6144
  v_mfma_f32_16x16x32_bf16 v[100:103], a[68:71], a[24:27], v[100:103]
  ds_read_b64_tr_b16 a[36:37], v19 offset:0
  v_mfma_f32_16x16x32_bf16 v[132:135], a[68:71], a[28:31], v[132:135]
  buffer_load_dwordx4 v2, s[20:23], s28 offen offset:2048 sc1 lds
  ds_read_b64_tr_b16 a[38:39], v19 offset:2048
  v_mfma_f32_16x16x32_bf16 v[40:43], a[72:75], a[16:19], v[40:43]
  ds_read_b64_tr_b16 a[40:41], v20 offset:0
  v_mfma_f32_16x16x32_bf16 v[72:75], a[72:75], a[20:23], v[72:75]
  ds_read_b64_tr_b16 a[42:43], v20 offset:2048
  v_mfma_f32_16x16x32_bf16 v[104:107], a[72:75], a[24:27], v[104:107]
  v_mfma_f32_16x16x32_bf16 v[136:139], a[72:75], a[28:31], v[136:139]
  buffer_load_dwordx4 v2, s[20:23], s28 offen offset:3072 sc1 lds
  ds_read_b64_tr_b16 a[44:45], v21 offset:0
  v_mfma_f32_16x16x32_bf16 v[44:47], a[76:79], a[16:19], v[44:47]
  s_xor_b32 s26, s26, 0x8000
  s_add_u32 s28, s28, 0x8000
  s_mov_b32 m0, s27
  v_mfma_f32_16x16x32_bf16 v[76:79], a[76:79], a[20:23], v[76:79]
  ds_read_b64_tr_b16 a[46:47], v21 offset:2048
  ds_read_b64_tr_b16 a[48:49], v18 offset:8192
  v_mfma_f32_16x16x32_bf16 v[108:111], a[76:79], a[24:27], v[108:111]
  ds_read_b64_tr_b16 a[50:51], v18 offset:10240
  v_mfma_f32_16x16x32_bf16 v[140:143], a[76:79], a[28:31], v[140:143]
  buffer_load_dwordx4 v2, s[20:23], s29 offen offset:0 sc1 lds
  ds_read_b64_tr_b16 a[52:53], v19 offset:8192
  v_mfma_f32_16x16x32_bf16 v[48:51], a[80:83], a[16:19], v[48:51]
  ds_read_b64_tr_b16 a[54:55], v19 offset:10240
  v_mfma_f32_16x16x32_bf16 v[80:83], a[80:83], a[20:23], v[80:83]
  ds_read_b64_tr_b16 a[56:57], v20 offset:8192
  v_mfma_f32_16x16x32_bf16 v[112:115], a[80:83], a[24:27], v[112:115]
  ds_read_b64_tr_b16 a[58:59], v20 offset:10240
  v_mfma_f32_16x16x32_bf16 v[144:147], a[80:83], a[28:31], v[144:147]
  buffer_load_dwordx4 v2, s[20:23], s29 offen offset:1024 sc1 lds
  ds_read_b64_tr_b16 a[60:61], v21 offset:8192
  v_mfma_f32_16x16x32_bf16 v[52:55], a[84:87], a[16:19], v[52:55]
  ds_read_b64_tr_b16 a[62:63], v21 offset:10240
  v_mfma_f32_16x16x32_bf16 v[84:87], a[84:87], a[20:23], v[84:87]
  v_mfma_f32_16x16x32_bf16 v[116:119], a[84:87], a[24:27], v[116:119]
  v_mfma_f32_16x16x32_bf16 v[148:151], a[84:87], a[28:31], v[148:151]
  buffer_load_dwordx4 v2, s[20:23], s29 offen offset:2048 sc1 lds
  v_mfma_f32_16x16x32_bf16 v[56:59], a[88:91], a[16:19], v[56:59]
  v_mfma_f32_16x16x32_bf16 v[88:91], a[88:91], a[20:23], v[88:91]
  v_mfma_f32_16x16x32_bf16 v[120:123], a[88:91], a[24:27], v[120:123]
  v_mfma_f32_16x16x32_bf16 v[152:155], a[88:91], a[28:31], v[152:155]
  buffer_load_dwordx4 v2, s[20:23], s29 offen offset:3072 sc1 lds
  v_mfma_f32_16x16x32_bf16 v[60:63], a[92:95], a[16:19], v[60:63]
  s_xor_b32 s27, s27, 0x4000
  s_add_u32 s29, s29, 0x8000
  v_mfma_f32_16x16x32_bf16 v[92:95], a[92:95], a[20:23], v[92:95]
  v_mfma_f32_16x16x32_bf16 v[124:127], a[92:95], a[24:27], v[124:127]
  v_mfma_f32_16x16x32_bf16 v[156:159], a[92:95], a[28:31], v[156:159]
  s_waitcnt lgkmcnt(0)
  v_mfma_f32_16x16x32_bf16 v[32:35], a[32:35], a[0:3], v[32:35]
  ds_read_b128 a[16:19], v17 offset:0
  ds_read_b64_tr_b16 a[64:65], v18 offset:4096
  v_mfma_f32_16x16x32_bf16 v[36:39], a[36:39], a[0:3], v[36:39]
  ds_read_b64_tr_b16 a[66:67], v18 offset:6144
  ds_read_b128 a[20:23], v17 offset:2048
  v_mfma_f32_16x16x32_bf16 v[40:43], a[40:43], a[0:3], v[40:43]
  ds_read_b128 a[24:27], v17 offset:4096
  ds_read_b128 a[28:31], v17 offset:6144
  v_mfma_f32_16x16x32_bf16 v[44:47], a[44:47], a[0:3], v[44:47]
  ds_read_b64_tr_b16 a[68:69], v19 offset:4096
  ds_read_b64_tr_b16 a[70:71], v19 offset:6144
  v_mfma_f32_16x16x32_bf16 v[48:51], a[48:51], a[0:3], v[48:51]
  ds_read_b64_tr_b16 a[72:73], v20 offset:4096
  ds_read_b64_tr_b16 a[74:75], v20 offset:6144
  v_mfma_f32_16x16x32_bf16 v[52:55], a[52:55], a[0:3], v[52:55]
  ds_read_b64_tr_b16 a[76:77], v21 offset:4096
  v_mfma_f32_16x16x32_bf16 v[56:59], a[56:59], a[0:3], v[56:59]
  ds_read_b64_tr_b16 a[78:79], v21 offset:6144
  ds_read_b64_tr_b16 a[80:81], v18 offset:12288
  v_mfma_f32_16x16x32_bf16 v[60:63], a[60:63], a[0:3], v[60:63]
  ds_read_b64_tr_b16 a[82:83], v18 offset:14336
  ds_read_b64_tr_b16 a[84:85], v19 offset:12288
  v_mfma_f32_16x16x32_bf16 v[64:67], a[32:35], a[4:7], v[64:67]
  ds_read_b64_tr_b16 a[86:87], v19 offset:14336
  ds_read_b64_tr_b16 a[88:89], v20 offset:12288
  v_mfma_f32_16x16x32_bf16 v[68:71], a[36:39], a[4:7], v[68:71]
  ds_read_b64_tr_b16 a[90:91], v20 offset:14336
  ds_read_b64_tr_b16 a[92:93], v21 offset:12288
  v_mfma_f32_16x16x32_bf16 v[72:75], a[40:43], a[4:7], v[72:75]
  ds_read_b64_tr_b16 a[94:95], v21 offset:14336
  v_mfma_f32_16x16x32_bf16 v[76:79], a[44:47], a[4:7], v[76:79]
  v_mfma_f32_16x16x32_bf16 v[80:83], a[48:51], a[4:7], v[80:83]
  v_mfma_f32_16x16x32_bf16 v[84:87], a[52:55], a[4:7], v[84:87]
  v_mfma_f32_16x16x32_bf16 v[88:91], a[56:59], a[4:7], v[88:91]
  v_mfma_f32_16x16x32_bf16 v[92:95], a[60:63], a[4:7], v[92:95]
  s_waitcnt lgkmcnt(0)
  v_mfma_f32_16x16x32_bf16 v[32:35], a[64:67], a[16:19], v[32:35]
  v_mfma_f32_16x16x32_bf16 v[36:39], a[68:71], a[16:19], v[36:39]
  v_mfma_f32_16x16x32_bf16 v[40:43], a[72:75], a[16:19], v[40:43]
  v_mfma_f32_16x16x32_bf16 v[44:47], a[76:79], a[16:19], v[44:47]
  v_mfma_f32_16x16x32_bf16 v[48:51], a[80:83], a[16:19], v[48:51]
  v_mfma_f32_16x16x32_bf16 v[52:55], a[84:87], a[16:19], v[52:55]
  s_nop 2
  v_pk_mul_f32 v[32:33], v[32:33], s[6:7]
  v_pk_mul_f32 v[34:35], v[34:35], s[6:7]
  v_mfma_f32_16x16x32_bf16 v[56:59], a[88:91], a[16:19], v[56:59]
  v_pk_mul_f32 v[36:37], v[36:37], s[6:7]
  v_pk_mul_f32 v[38:39], v[38:39], s[6:7]
  v_mfma_f32_16x16x32_bf16 v[60:63], a[92:95], a[16:19], v[60:63]
  v_cvt_pk_bf16_f32 v32, v32, v33
  v_cvt_pk_bf16_f32 v33, v34, v35
  v_mfma_f32_16x16x32_bf16 v[64:67], a[64:67], a[20:23], v[64:67]
  v_cvt_pk_bf16_f32 v34, v36, v37
  v_cvt_pk_bf16_f32 v35, v38, v39
  v_mfma_f32_16x16x32_bf16 v[68:71], a[68:71], a[20:23], v[68:71]
  v_accvgpr_write_b32 a128, v32
  v_accvgpr_write_b32 a129, v33
  v_mfma_f32_16x16x32_bf16 v[72:75], a[72:75], a[20:23], v[72:75]
  v_accvgpr_write_b32 a130, v34
  v_accvgpr_write_b32 a131, v35
  v_mfma_f32_16x16x32_bf16 v[76:79], a[76:79], a[20:23], v[76:79]
  v_pk_mul_f32 v[40:41], v[40:41], s[6:7]
  v_pk_mul_f32 v[42:43], v[42:43], s[6:7]
  v_mfma_f32_16x16x32_bf16 v[80:83], a[80:83], a[20:23], v[80:83]
  v_pk_mul_f32 v[44:45], v[44:45], s[6:7]
  v_pk_mul_f32 v[46:47], v[46:47], s[6:7]
  v_mfma_f32_16x16x32_bf16 v[84:87], a[84:87], a[20:23], v[84:87]
  v_cvt_pk_bf16_f32 v40, v40, v41
  v_cvt_pk_bf16_f32 v41, v42, v43
  v_mfma_f32_16x16x32_bf16 v[88:91], a[88:91], a[20:23], v[88:91]
  v_cvt_pk_bf16_f32 v42, v44, v45
  v_cvt_pk_bf16_f32 v43, v46, v47
  v_mfma_f32_16x16x32_bf16 v[92:95], a[92:95], a[20:23], v[92:95]
  v_accvgpr_write_b32 a132, v40
  v_accvgpr_write_b32 a133, v41
  v_mfma_f32_16x16x32_bf16 v[96:99], a[32:35], a[8:11], v[96:99]
  v_accvgpr_write_b32 a134, v42
  v_accvgpr_write_b32 a135, v43
  v_mfma_f32_16x16x32_bf16 v[100:103], a[36:39], a[8:11], v[100:103]
  v_mfma_f32_32x32x16_bf16 v[160:175], a[236:239], a[236:239], 0
  v_pk_mul_f32 v[48:49], v[48:49], s[6:7]
  v_mfma_f32_16x16x32_bf16 v[96:99], a[64:67], a[24:27], v[96:99]
  v_pk_mul_f32 v[50:51], v[50:51], s[6:7]
  v_pk_mul_f32 v[52:53], v[52:53], s[6:7]
  v_mfma_f32_16x16x32_bf16 v[100:103], a[68:71], a[24:27], v[100:103]
  v_pk_mul_f32 v[54:55], v[54:55], s[6:7]
  v_cvt_pk_bf16_f32 v48, v48, v49
  v_mfma_f32_16x16x32_bf16 v[104:107], a[40:43], a[8:11], v[104:107]
  v_cvt_pk_bf16_f32 v49, v50, v51
  v_cvt_pk_bf16_f32 v50, v52, v53
  v_mfma_f32_16x16x32_bf16 v[108:111], a[44:47], a[8:11], v[108:111]
  v_cvt_pk_bf16_f32 v51, v54, v55
  v_accvgpr_write_b32 a136, v48
  v_mfma_f32_16x16x32_bf16 v[104:107], a[72:75], a[24:27], v[104:107]
  v_accvgpr_write_b32 a137, v49
  v_accvgpr_write_b32 a138, v50
  v_mfma_f32_16x16x32_bf16 v[108:111], a[76:79], a[24:27], v[108:111]
  v_accvgpr_write_b32 a139, v51
  v_pk_mul_f32 v[56:57], v[56:57], s[6:7]
  v_mfma_f32_16x16x32_bf16 v[112:115], a[48:51], a[8:11], v[112:115]
  v_pk_mul_f32 v[58:59], v[58:59], s[6:7]
  v_pk_mul_f32 v[60:61], v[60:61], s[6:7]
  v_mfma_f32_16x16x32_bf16 v[116:119], a[52:55], a[8:11], v[116:119]
  v_pk_mul_f32 v[62:63], v[62:63], s[6:7]
  v_cvt_pk_bf16_f32 v56, v56, v57
  v_mfma_f32_16x16x32_bf16 v[112:115], a[80:83], a[24:27], v[112:115]
  v_cvt_pk_bf16_f32 v57, v58, v59
  v_cvt_pk_bf16_f32 v58, v60, v61
  v_mfma_f32_16x16x32_bf16 v[116:119], a[84:87], a[24:27], v[116:119]
  v_cvt_pk_bf16_f32 v59, v62, v63
  v_accvgpr_write_b32 a140, v56
  v_mfma_f32_16x16x32_bf16 v[120:123], a[56:59], a[8:11], v[120:123]
  v_accvgpr_write_b32 a141, v57
  v_accvgpr_write_b32 a142, v58
  v_mfma_f32_16x16x32_bf16 v[124:127], a[60:63], a[8:11], v[124:127]
  v_accvgpr_write_b32 a143, v59
  v_mfma_f32_32x32x16_bf16 v[176:191], a[236:239], a[236:239], 0
  v_mfma_f32_16x16x32_bf16 v[120:123], a[88:91], a[24:27], v[120:123]
  v_pk_mul_f32 v[64:65], v[64:65], s[6:7]
  v_pk_mul_f32 v[66:67], v[66:67], s[6:7]
  v_mfma_f32_16x16x32_bf16 v[124:127], a[92:95], a[24:27], v[124:127]
  v_pk_mul_f32 v[68:69], v[68:69], s[6:7]
  v_pk_mul_f32 v[70:71], v[70:71], s[6:7]
  v_mfma_f32_16x16x32_bf16 v[128:131], a[32:35], a[12:15], v[128:131]
  v_cvt_pk_bf16_f32 v64, v64, v65
  v_cvt_pk_bf16_f32 v65, v66, v67
  v_mfma_f32_16x16x32_bf16 v[132:135], a[36:39], a[12:15], v[132:135]
  v_cvt_pk_bf16_f32 v66, v68, v69
  v_cvt_pk_bf16_f32 v67, v70, v71
  v_mfma_f32_16x16x32_bf16 v[128:131], a[64:67], a[28:31], v[128:131]
  v_accvgpr_write_b32 a144, v64
  v_accvgpr_write_b32 a145, v65
  v_mfma_f32_16x16x32_bf16 v[132:135], a[68:71], a[28:31], v[132:135]
  v_accvgpr_write_b32 a146, v66
  v_accvgpr_write_b32 a147, v67
  v_mfma_f32_16x16x32_bf16 v[136:139], a[40:43], a[12:15], v[136:139]
  v_pk_mul_f32 v[72:73], v[72:73], s[6:7]
  v_pk_mul_f32 v[74:75], v[74:75], s[6:7]
  v_mfma_f32_16x16x32_bf16 v[140:143], a[44:47], a[12:15], v[140:143]
  v_pk_mul_f32 v[76:77], v[76:77], s[6:7]
  v_pk_mul_f32 v[78:79], v[78:79], s[6:7]
  v_mfma_f32_16x16x32_bf16 v[136:139], a[72:75], a[28:31], v[136:139]
  v_cvt_pk_bf16_f32 v72, v72, v73
  v_cvt_pk_bf16_f32 v73, v74, v75
  v_mfma_f32_16x16x32_bf16 v[140:143], a[76:79], a[28:31], v[140:143]
  v_cvt_pk_bf16_f32 v74, v76, v77
  v_cvt_pk_bf16_f32 v75, v78, v79
  v_mfma_f32_16x16x32_bf16 v[144:147], a[48:51], a[12:15], v[144:147]
  v_accvgpr_write_b32 a148, v72
  v_accvgpr_write_b32 a149, v73
  v_mfma_f32_16x16x32_bf16 v[148:151], a[52:55], a[12:15], v[148:151]
  v_accvgpr_write_b32 a150, v74
  v_accvgpr_write_b32 a151, v75
  v_mfma_f32_16x16x32_bf16 v[144:147], a[80:83], a[28:31], v[144:147]
  v_mfma_f32_32x32x16_bf16 v[192:207], a[236:239], a[236:239], 0
  v_pk_mul_f32 v[80:81], v[80:81], s[6:7]
  v_mfma_f32_16x16x32_bf16 v[148:151], a[84:87], a[28:31], v[148:151]
  v_pk_mul_f32 v[82:83], v[82:83], s[6:7]
  v_pk_mul_f32 v[84:85], v[84:85], s[6:7]
  v_mfma_f32_16x16x32_bf16 v[152:155], a[56:59], a[12:15], v[152:155]
  v_pk_mul_f32 v[86:87], v[86:87], s[6:7]
  v_cvt_pk_bf16_f32 v80, v80, v81
  v_mfma_f32_16x16x32_bf16 v[156:159], a[60:63], a[12:15], v[156:159]
  v_cvt_pk_bf16_f32 v81, v82, v83
  v_cvt_pk_bf16_f32 v82, v84, v85
  v_mfma_f32_16x16x32_bf16 v[152:155], a[88:91], a[28:31], v[152:155]
  v_cvt_pk_bf16_f32 v83, v86, v87
  v_accvgpr_write_b32 a152, v80
  v_mfma_f32_16x16x32_bf16 v[156:159], a[92:95], a[28:31], v[156:159]
  v_accvgpr_write_b32 a153, v81
  v_accvgpr_write_b32 a154, v82
  v_accvgpr_write_b32 a155, v83
  v_pk_mul_f32 v[88:89], v[88:89], s[6:7]
  v_pk_mul_f32 v[90:91], v[90:91], s[6:7]
  v_pk_mul_f32 v[92:93], v[92:93], s[6:7]
  v_pk_mul_f32 v[94:95], v[94:95], s[6:7]
  v_cvt_pk_bf16_f32 v88, v88, v89
  v_cvt_pk_bf16_f32 v89, v90, v91
  v_cvt_pk_bf16_f32 v90, v92, v93
  v_cvt_pk_bf16_f32 v91, v94, v95
  v_accvgpr_write_b32 a156, v88
  v_accvgpr_write_b32 a157, v89
  v_accvgpr_write_b32 a158, v90
  v_accvgpr_write_b32 a159, v91
  v_mfma_f32_32x32x16_bf16 v[208:223], a[236:239], a[236:239], 0
  v_pk_mul_f32 v[96:97], v[96:97], s[6:7]
  v_pk_mul_f32 v[98:99], v[98:99], s[6:7]
  v_pk_mul_f32 v[100:101], v[100:101], s[6:7]
  v_pk_mul_f32 v[102:103], v[102:103], s[6:7]
  v_cvt_pk_bf16_f32 v96, v96, v97
  v_cvt_pk_bf16_f32 v97, v98, v99
  v_cvt_pk_bf16_f32 v98, v100, v101
  v_cvt_pk_bf16_f32 v99, v102, v103
  v_accvgpr_write_b32 a160, v96
  v_accvgpr_write_b32 a161, v97
  v_accvgpr_write_b32 a162, v98
  v_accvgpr_write_b32 a163, v99
  v_pk_mul_f32 v[104:105], v[104:105], s[6:7]
  v_pk_mul_f32 v[106:107], v[106:107], s[6:7]
  v_pk_mul_f32 v[108:109], v[108:109], s[6:7]
  v_pk_mul_f32 v[110:111], v[110:111], s[6:7]
  v_cvt_pk_bf16_f32 v104, v104, v105
  v_cvt_pk_bf16_f32 v105, v106, v107
  v_cvt_pk_bf16_f32 v106, v108, v109
  v_cvt_pk_bf16_f32 v107, v110, v111
  v_accvgpr_write_b32 a164, v104
  v_accvgpr_write_b32 a165, v105
  v_accvgpr_write_b32 a166, v106
  v_accvgpr_write_b32 a167, v107
  v_mfma_f32_32x32x16_bf16 v[224:239], a[236:239], a[236:239], 0
  v_pk_mul_f32 v[112:113], v[112:113], s[6:7]
  v_pk_mul_f32 v[114:115], v[114:115], s[6:7]
  v_pk_mul_f32 v[116:117], v[116:117], s[6:7]
  v_pk_mul_f32 v[118:119], v[118:119], s[6:7]
  v_cvt_pk_bf16_f32 v112, v112, v113
  v_cvt_pk_bf16_f32 v113, v114, v115
  v_cvt_pk_bf16_f32 v114, v116, v117
  v_cvt_pk_bf16_f32 v115, v118, v119
  v_accvgpr_write_b32 a168, v112
  v_accvgpr_write_b32 a169, v113
  v_accvgpr_write_b32 a170, v114
  v_accvgpr_write_b32 a171, v115
  v_pk_mul_f32 v[120:121], v[120:121], s[6:7]
  v_pk_mul_f32 v[122:123], v[122:123], s[6:7]
  v_pk_mul_f32 v[124:125], v[124:125], s[6:7]
  v_pk_mul_f32 v[126:127], v[126:127], s[6:7]
  v_cvt_pk_bf16_f32 v120, v120, v121
  v_cvt_pk_bf16_f32 v121, v122, v123
  v_cvt_pk_bf16_f32 v122, v124, v125
  v_cvt_pk_bf16_f32 v123, v126, v127
  v_accvgpr_write_b32 a172, v120
  v_accvgpr_write_b32 a173, v121
  v_accvgpr_write_b32 a174, v122
  v_accvgpr_write_b32 a175, v123
  v_mfma_f32_32x32x16_bf16 v[240:255], a[236:239], a[236:239], 0
  v_pk_mul_f32 v[128:129], v[128:129], s[6:7]
  v_pk_mul_f32 v[130:131], v[130:131], s[6:7]
  v_pk_mul_f32 v[132:133], v[132:133], s[6:7]
  v_pk_mul_f32 v[134:135], v[134:135], s[6:7]
  v_cvt_pk_bf16_f32 v128, v128, v129
  v_cvt_pk_bf16_f32 v129, v130, v131
  v_cvt_pk_bf16_f32 v130, v132, v133
  v_cvt_pk_bf16_f32 v131, v134, v135
  v_accvgpr_write_b32 a176, v128
  v_accvgpr_write_b32 a177, v129
  v_accvgpr_write_b32 a178, v130
  v_accvgpr_write_b32 a179, v131
  v_pk_mul_f32 v[136:137], v[136:137], s[6:7]
  v_pk_mul_f32 v[138:139], v[138:139], s[6:7]
  v_pk_mul_f32 v[140:141], v[140:141], s[6:7]
  v_pk_mul_f32 v[142:143], v[142:143], s[6:7]
  v_cvt_pk_bf16_f32 v136, v136, v137
  v_cvt_pk_bf16_f32 v137, v138, v139
  v_cvt_pk_bf16_f32 v138, v140, v141
  v_cvt_pk_bf16_f32 v139, v142, v143
  v_accvgpr_write_b32 a180, v136
  v_accvgpr_write_b32 a181, v137
  v_accvgpr_write_b32 a182, v138
  v_accvgpr_write_b32 a183, v139
  v_mfma_f32_32x32x16_bf16 v[128:143], a[236:239], a[236:239], 0
  v_pk_mul_f32 v[144:145], v[144:145], s[6:7]
  v_pk_mul_f32 v[146:147], v[146:147], s[6:7]
  v_pk_mul_f32 v[148:149], v[148:149], s[6:7]
  v_pk_mul_f32 v[150:151], v[150:151], s[6:7]
  v_cvt_pk_bf16_f32 v144, v144, v145
  v_cvt_pk_bf16_f32 v145, v146, v147
  v_cvt_pk_bf16_f32 v146, v148, v149
  v_cvt_pk_bf16_f32 v147, v150, v151
  v_accvgpr_write_b32 a184, v144
  v_accvgpr_write_b32 a185, v145
  v_accvgpr_write_b32 a186, v146
  v_accvgpr_write_b32 a187, v147
  v_pk_mul_f32 v[152:153], v[152:153], s[6:7]
  v_pk_mul_f32 v[154:155], v[154:155], s[6:7]
  v_pk_mul_f32 v[156:157], v[156:157], s[6:7]
  v_pk_mul_f32 v[158:159], v[158:159], s[6:7]
  v_cvt_pk_bf16_f32 v152, v152, v153
  v_cvt_pk_bf16_f32 v153, v154, v155
  v_cvt_pk_bf16_f32 v154, v156, v157
  v_cvt_pk_bf16_f32 v155, v158, v159
  v_accvgpr_write_b32 a188, v152
  v_accvgpr_write_b32 a189, v153
  v_accvgpr_write_b32 a190, v154
  v_accvgpr_write_b32 a191, v155
  v_mfma_f32_32x32x16_bf16 v[144:159], a[236:239], a[236:239], 0
  v_add_u32 v3, 0xc000, v2
  v_add_u32 v4, 0x10000, v2
  v_mov_b32 v5, 0xf149f2ca
  s_mov_b32 s89, 0
  v_mfma_f32_32x32x16_bf16 a[192:207], a[236:239], a[236:239], 0
  s_waitcnt vmcnt(8)
  s_barrier
  ds_read_b128 a[32:35], v3 offset:0
  ds_read_b128 a[36:39], v3 offset:1024
  ds_read_b128 a[40:43], v3 offset:2048
  ds_read_b128 a[44:47], v3 offset:3072
  ds_read_b128 a[48:51], v3 offset:4096
  ds_read_b128 a[52:55], v3 offset:5120
  ds_read_b128 a[56:59], v3 offset:6144
  ds_read_b128 a[60:63], v3 offset:7168
  s_waitcnt lgkmcnt(6)
  v_mfma_f32_16x16x32_bf16 v[64:67], a[32:35], a[128:131], 0
  s_lshl_b32 s4, s2, 2
  s_add_u32 s4, s4, s3
  s_lshl_b32 s6, s4, 13
  v_mfma_f32_16x16x32_bf16 v[72:75], a[32:35], a[144:147], 0
  s_lshl_b32 s7, s4, 11
  s_mov_b32 s8, s74
  s_mov_b32 s9, s75
  v_mfma_f32_16x16x32_bf16 v[80:83], a[32:35], a[160:163], 0
  s_mov_b32 s10, 8388608
  s_mov_b32 s11, 0x00020000
  s_mov_b32 s12, s80
  v_mfma_f32_16x16x32_bf16 v[88:91], a[32:35], a[176:179], 0
  s_mov_b32 s13, s81
  s_mov_b32 s14, 2097152
  ds_read_b128 a[0:3], v3 offset:8192
  v_mfma_f32_16x16x32_bf16 v[64:67], a[36:39], a[132:135], v[64:67]
  s_mov_b32 s15, 0x00020000
  s_add_u32 s16, s86, 67108864
  s_addc_u32 s17, s87, 0
  v_mfma_f32_16x16x32_bf16 v[72:75], a[36:39], a[148:151], v[72:75]
  s_mov_b32 s18, 16777216
  s_mov_b32 s19, 0x00020000
  v_mfma_f32_16x16x32_bf16 v[80:83], a[36:39], a[164:167], v[80:83]
  v_and_b32 v6, 15, v1
  v_lshrrev_b32 v7, 4, v1
  v_mfma_f32_16x16x32_bf16 v[88:91], a[36:39], a[180:183], v[88:91]
  s_waitcnt lgkmcnt(5)
  ds_read_b128 a[4:7], v3 offset:9216
  v_sub_u32 v6, v6, v7
  v_mfma_f32_16x16x32_bf16 v[64:67], a[40:43], a[136:139], v[64:67]
  v_lshlrev_b32 v6, 2, v6
  v_add_u32 v6, s3, v6
  v_mfma_f32_16x16x32_bf16 v[72:75], a[40:43], a[152:155], v[72:75]
  v_cmp_gt_i32 s[32:33], 0, v6
  v_cmp_gt_i32 s[34:35], 1, v6
  v_mfma_f32_16x16x32_bf16 v[80:83], a[40:43], a[168:171], v[80:83]
  v_cmp_gt_i32 s[36:37], 2, v6
  v_cmp_gt_i32 s[38:39], 3, v6
  v_mfma_f32_16x16x32_bf16 v[88:91], a[40:43], a[184:187], v[88:91]
  ds_read_b128 a[8:11], v3 offset:10240
  v_cmp_gt_i32 s[40:41], 16, v6
  v_mfma_f32_16x16x32_bf16 v[64:67], a[44:47], a[140:143], v[64:67]
  v_cmp_gt_i32 s[42:43], 17, v6
  v_cmp_gt_i32 s[44:45], 18, v6
  v_mfma_f32_16x16x32_bf16 v[72:75], a[44:47], a[156:159], v[72:75]
  v_cmp_gt_i32 s[46:47], 19, v6
  v_cmp_gt_i32 s[48:49], 32, v6
  v_mfma_f32_16x16x32_bf16 v[80:83], a[44:47], a[172:175], v[80:83]
  v_cmp_gt_i32 s[50:51], 33, v6
  v_cmp_gt_i32 s[52:53], 34, v6
  v_mfma_f32_16x16x32_bf16 v[88:91], a[44:47], a[188:191], v[88:91]
  s_waitcnt lgkmcnt(5)
  ds_read_b128 a[12:15], v3 offset:11264
  v_cmp_gt_i32 s[54:55], 35, v6
  v_mfma_f32_16x16x32_bf16 v[68:71], a[48:51], a[128:131], 0
  v_cmp_gt_i32 s[56:57], 48, v6
  v_cmp_gt_i32 s[58:59], 49, v6
  v_mfma_f32_16x16x32_bf16 v[76:79], a[48:51], a[144:147], 0
  s_mov_b32 s30, 0x8000
  v_cmp_gt_i32 s[60:61], 50, v6
  v_cmp_gt_i32 s[62:63], 51, v6
  v_mfma_f32_16x16x32_bf16 v[84:87], a[48:51], a[160:163], 0
  s_mov_b32 s31, 0x4000
  v_mfma_f32_16x16x32_bf16 v[92:95], a[48:51], a[176:179], 0
  ds_read_b128 a[16:19], v3 offset:12288
  v_mfma_f32_16x16x32_bf16 v[68:71], a[52:55], a[132:135], v[68:71]
  v_mfma_f32_16x16x32_bf16 v[76:79], a[52:55], a[148:151], v[76:79]
  v_mfma_f32_16x16x32_bf16 v[84:87], a[52:55], a[164:167], v[84:87]
  v_mfma_f32_16x16x32_bf16 v[92:95], a[52:55], a[180:183], v[92:95]
  s_waitcnt lgkmcnt(5)
  ds_read_b128 a[20:23], v3 offset:13312
  v_mfma_f32_16x16x32_bf16 v[68:71], a[56:59], a[136:139], v[68:71]
  v_mfma_f32_16x16x32_bf16 v[76:79], a[56:59], a[152:155], v[76:79]
  v_mfma_f32_16x16x32_bf16 v[84:87], a[56:59], a[168:171], v[84:87]
  v_mfma_f32_16x16x32_bf16 v[92:95], a[56:59], a[184:187], v[92:95]
  ds_read_b128 a[24:27], v3 offset:14336
  v_mfma_f32_16x16x32_bf16 v[68:71], a[60:63], a[140:143], v[68:71]
  v_mfma_f32_16x16x32_bf16 v[76:79], a[60:63], a[156:159], v[76:79]
  v_mfma_f32_16x16x32_bf16 v[84:87], a[60:63], a[172:175], v[84:87]
  v_mfma_f32_16x16x32_bf16 v[92:95], a[60:63], a[188:191], v[92:95]
  ds_read_b128 a[28:31], v3 offset:15360
  s_cmp_lg_u32 s25, 0
  s_nop 0
  s_cbranch_scc1 La_nomask0
  v_cndmask_b32 v64, v64, v5, s[32:33]
  v_cndmask_b32 v65, v65, v5, s[34:35]
  v_cndmask_b32 v66, v66, v5, s[36:37]
  v_cndmask_b32 v67, v67, v5, s[38:39]
  v_cndmask_b32 v68, v68, v5, s[40:41]
  v_cndmask_b32 v69, v69, v5, s[42:43]
  v_cndmask_b32 v70, v70, v5, s[44:45]
  v_cndmask_b32 v71, v71, v5, s[46:47]
La_nomask0:
  v_max3_f32 v6, v64, v65, v66
  v_max3_f32 v7, v67, v68, v69
  v_max3_f32 v6, v6, v70, v71
  v_max_f32 v6, v6, v7
  v_max3_f32 v8, v72, v73, v74
  v_max3_f32 v9, v75, v76, v77
  v_max3_f32 v8, v8, v78, v79
  v_max_f32 v8, v8, v9
  v_max3_f32 v10, v80, v81, v82
  v_max3_f32 v11, v83, v84, v85
  v_max3_f32 v10, v10, v86, v87
  v_max_f32 v10, v10, v11
  v_max3_f32 v12, v88, v89, v90
  v_max3_f32 v13, v91, v92, v93
  v_max3_f32 v12, v12, v94, v95
  v_max_f32 v12, v12, v13
  v_mov_b32 v7, v6
  v_mov_b32 v9, v8
  v_mov_b32 v11, v10
  v_mov_b32 v13, v12
  v_permlane32_swap_b32 v6, v7
  v_permlane32_swap_b32 v8, v9
  v_permlane32_swap_b32 v10, v11
  v_permlane32_swap_b32 v12, v13
  v_max_f32 v6, v6, v7
  v_max_f32 v8, v8, v9
  v_max_f32 v10, v10, v11
  v_max_f32 v12, v12, v13
  v_mov_b32 v7, v6
  v_mov_b32 v9, v8
  v_mov_b32 v11, v10
  v_mov_b32 v13, v12
  v_permlane16_swap_b32 v6, v7
  v_permlane16_swap_b32 v8, v9
  v_permlane16_swap_b32 v10, v11
  v_permlane16_swap_b32 v12, v13
  v_max_f32 v6, v6, v7
  v_max_f32 v8, v8, v9
  v_max_f32 v10, v10, v11
  v_max_f32 v12, v12, v13
  v_sub_f32 v16, 0, v6
  v_sub_f32 v17, 0, v6
  v_sub_f32 v18, 0, v6
  v_sub_f32 v19, 0, v6
  v_sub_f32 v20, 0, v8
  v_sub_f32 v21, 0, v8
  v_sub_f32 v22, 0, v8
  v_sub_f32 v23, 0, v8
  v_sub_f32 v24, 0, v10
  v_sub_f32 v25, 0, v10
  v_sub_f32 v26, 0, v10
  v_sub_f32 v27, 0, v10
  v_sub_f32 v28, 0, v12
  v_sub_f32 v29, 0, v12
  v_sub_f32 v30, 0, v12
  v_sub_f32 v31, 0, v12
  v_pk_add_f32 v[64:65], v[64:65], v[16:17]
  v_pk_add_f32 v[66:67], v[66:67], v[16:17]
  v_pk_add_f32 v[68:69], v[68:69], v[16:17]
  v_pk_add_f32 v[70:71], v[70:71], v[16:17]
  v_pk_add_f32 v[72:73], v[72:73], v[20:21]
  v_pk_add_f32 v[74:75], v[74:75], v[20:21]
  v_pk_add_f32 v[76:77], v[76:77], v[20:21]
  v_pk_add_f32 v[78:79], v[78:79], v[20:21]
  v_pk_add_f32 v[80:81], v[80:81], v[24:25]
  v_pk_add_f32 v[82:83], v[82:83], v[24:25]
  v_pk_add_f32 v[84:85], v[84:85], v[24:25]
  v_pk_add_f32 v[86:87], v[86:87], v[24:25]
  v_pk_add_f32 v[88:89], v[88:89], v[28:29]
  v_pk_add_f32 v[90:91], v[90:91], v[28:29]
  v_pk_add_f32 v[92:93], v[92:93], v[28:29]
  v_pk_add_f32 v[94:95], v[94:95], v[28:29]
  s_lshl_b32 s88, s25, 1
  s_waitcnt vmcnt(0)
  s_barrier
  s_waitcnt lgkmcnt(4)
  v_mfma_f32_16x16x32_bf16 v[96:99], a[0:3], a[128:131], v[16:19]
  s_mov_b32 m0, s26
  v_exp_f32 v64, v64
  v_mfma_f32_16x16x32_bf16 v[96:99], a[4:7], a[132:135], v[96:99]
  buffer_load_dwordx4 v2, s[20:23], s28 offen offset:0 sc1 lds
  v_exp_f32 v65, v65
  v_mfma_f32_16x16x32_bf16 v[96:99], a[8:11], a[136:139], v[96:99]
  buffer_load_dwordx4 v2, s[20:23], s28 offen offset:1024 sc1 lds
  v_exp_f32 v66, v66
  v_mfma_f32_16x16x32_bf16 v[96:99], a[12:15], a[140:143], v[96:99]
  buffer_load_dwordx4 v2, s[20:23], s28 offen offset:2048 sc1 lds
  v_exp_f32 v67, v67
  v_mfma_f32_16x16x32_bf16 v[104:107], a[0:3], a[144:147], v[20:23]
  v_exp_f32 v68, v68
  v_cvt_pk_bf16_f32 v32, v64, v65
  v_mfma_f32_16x16x32_bf16 v[104:107], a[4:7], a[148:151], v[104:107]
  buffer_load_dwordx4 v2, s[20:23], s28 offen offset:3072 sc1 lds
  v_exp_f32 v69, v69
  v_mfma_f32_16x16x32_bf16 v[104:107], a[8:11], a[152:155], v[104:107]
  s_xor_b32 s26, s26, 0x4000
  v_exp_f32 v70, v70
  v_cvt_pk_bf16_f32 v33, v66, v67
  v_mfma_f32_16x16x32_bf16 v[104:107], a[12:15], a[156:159], v[104:107]
  s_add_u32 s28, s28, 0x8000
  v_exp_f32 v71, v71
  v_cvt_pk_bf16_f32 v34, v68, v69
  v_mfma_f32_16x16x32_bf16 v[112:115], a[0:3], a[160:163], v[24:27]
  s_mov_b32 m0, s27
  v_exp_f32 v72, v72
  v_cvt_pk_bf16_f32 v35, v70, v71
  v_mfma_f32_16x16x32_bf16 v[112:115], a[4:7], a[164:167], v[112:115]
  buffer_load_dwordx4 v2, s[20:23], s29 offen offset:0 sc1 lds
  v_exp_f32 v73, v73
  v_mfma_f32_16x16x32_bf16 v[112:115], a[8:11], a[168:171], v[112:115]
  buffer_load_dwordx4 v2, s[20:23], s29 offen offset:1024 sc1 lds
  v_exp_f32 v74, v74
  v_mfma_f32_16x16x32_bf16 v[112:115], a[12:15], a[172:175], v[112:115]
  buffer_load_dwordx4 v2, s[20:23], s29 offen offset:2048 sc1 lds
  v_exp_f32 v75, v75
  v_mfma_f32_16x16x32_bf16 v[120:123], a[0:3], a[176:179], v[28:31]
  buffer_load_dwordx4 v2, s[20:23], s29 offen offset:3072 sc1 lds
  v_exp_f32 v76, v76
  v_mfma_f32_16x16x32_bf16 v[120:123], a[4:7], a[180:183], v[120:123]
  s_xor_b32 s27, s27, 0x8000
  v_exp_f32 v77, v77
  v_cvt_pk_bf16_f32 v36, v72, v73
  v_mfma_f32_16x16x32_bf16 v[120:123], a[8:11], a[184:187], v[120:123]
  s_add_u32 s29, s29, 0x8000
  v_exp_f32 v78, v78
  v_cvt_pk_bf16_f32 v37, v74, v75
  v_mfma_f32_16x16x32_bf16 v[120:123], a[12:15], a[188:191], v[120:123]
  s_waitcnt lgkmcnt(0)
  v_exp_f32 v79, v79
  v_cvt_pk_bf16_f32 v38, v76, v77
  v_mfma_f32_16x16x32_bf16 v[100:103], a[16:19], a[128:131], v[16:19]
  s_mov_b32 m0, s26
  v_exp_f32 v80, v80
  v_cvt_pk_bf16_f32 v39, v78, v79
  v_mfma_f32_16x16x32_bf16 v[100:103], a[20:23], a[132:135], v[100:103]
  buffer_load_dwordx4 v2, s[20:23], s28 offen offset:0 sc1 lds
  v_exp_f32 v81, v81
  v_mfma_f32_16x16x32_bf16 v[100:103], a[24:27], a[136:139], v[100:103]
  buffer_load_dwordx4 v2, s[20:23], s28 offen offset:1024 sc1 lds
  v_exp_f32 v82, v82
  v_cvt_pk_bf16_f32 v40, v80, v81
  v_mfma_f32_16x16x32_bf16 v[100:103], a[28:31], a[140:143], v[100:103]
  buffer_load_dwordx4 v2, s[20:23], s28 offen offset:2048 sc1 lds
  v_exp_f32 v83, v83
  v_mfma_f32_16x16x32_bf16 v[108:111], a[16:19], a[144:147], v[20:23]
  buffer_load_dwordx4 v2, s[20:23], s28 offen offset:3072 sc1 lds
  v_exp_f32 v84, v84
  v_cvt_pk_bf16_f32 v41, v82, v83
  v_mfma_f32_16x16x32_bf16 v[108:111], a[20:23], a[148:151], v[108:111]
  s_xor_b32 s26, s26, 0x8000
  v_exp_f32 v85, v85
  v_xor_b32 v3, 0x4000, v3
  v_mfma_f32_16x16x32_bf16 v[108:111], a[24:27], a[152:155], v[108:111]
  s_add_u32 s28, s28, 0x8000
  ds_read_b128 a[32:35], v3 offset:0
  v_exp_f32 v86, v86
  v_cvt_pk_bf16_f32 v42, v84, v85
  v_mfma_f32_16x16x32_bf16 v[108:111], a[28:31], a[156:159], v[108:111]
  s_mov_b32 m0, s27
  ds_read_b128 a[36:39], v3 offset:1024
  v_exp_f32 v87, v87
  v_mfma_f32_16x16x32_bf16 v[116:119], a[16:19], a[160:163], v[24:27]
  buffer_load_dwordx4 v2, s[20:23], s29 offen offset:0 sc1 lds
  v_exp_f32 v88, v88
  v_cvt_pk_bf16_f32 v43, v86, v87
  v_mfma_f32_16x16x32_bf16 v[116:119], a[20:23], a[164:167], v[116:119]
  buffer_load_dwordx4 v2, s[20:23], s29 offen offset:1024 sc1 lds
  v_exp_f32 v89, v89
  v_mfma_f32_16x16x32_bf16 v[116:119], a[24:27], a[168:171], v[116:119]
  buffer_load_dwordx4 v2, s[20:23], s29 offen offset:2048 sc1 lds
  v_exp_f32 v90, v90
  v_cvt_pk_bf16_f32 v44, v88, v89
  v_mfma_f32_16x16x32_bf16 v[116:119], a[28:31], a[172:175], v[116:119]
  buffer_load_dwordx4 v2, s[20:23], s29 offen offset:3072 sc1 lds
  v_exp_f32 v91, v91
  v_mfma_f32_16x16x32_bf16 v[124:127], a[16:19], a[176:179], v[28:31]
  s_xor_b32 s27, s27, 0x4000
  ds_read_b128 a[40:43], v3 offset:2048
  v_exp_f32 v92, v92
  v_cvt_pk_bf16_f32 v45, v90, v91
  v_mfma_f32_16x16x32_bf16 v[124:127], a[20:23], a[180:183], v[124:127]
  s_add_u32 s29, s29, 0x8000
  ds_read_b128 a[44:47], v3 offset:3072
  v_exp_f32 v93, v93
  v_mfma_f32_16x16x32_bf16 v[124:127], a[24:27], a[184:187], v[124:127]
  ds_read_b128 a[48:51], v3 offset:4096
  v_exp_f32 v94, v94
  v_cvt_pk_bf16_f32 v46, v92, v93
  v_mfma_f32_16x16x32_bf16 v[124:127], a[28:31], a[188:191], v[124:127]
  ds_read_b128 a[52:55], v3 offset:5120
  ds_read_b128 a[56:59], v3 offset:6144
  ds_read_b128 a[60:63], v3 offset:7168
  ds_read_b128 a[0:3], v4 offset:0
  ds_read_b128 a[4:7], v4 offset:1024
  ds_read_b128 a[8:11], v4 offset:2048
  v_exp_f32 v95, v95
  s_nop 0
  v_cvt_pk_bf16_f32 v47, v94, v95
  s_cmp_eq_u32 s25, 0
  s_cbranch_scc1 La_d1
  .p2align 6
La_lo:
  s_waitcnt lgkmcnt(7)
  v_mfma_f32_16x16x32_bf16 v[64:67], a[32:35], a[128:131], v[16:19]
  v_exp_f32 v96, v96
  v_mfma_f32_16x16x32_bf16 v[64:67], a[36:39], a[132:135], v[64:67]
  ds_read_b128 a[12:15], v4 offset:3072
  v_mfma_f32_16x16x32_bf16 v[64:67], a[40:43], a[136:139], v[64:67]
  v_exp_f32 v97, v97
  v_mfma_f32_16x16x32_bf16 v[64:67], a[44:47], a[140:143], v[64:67]
  v_cvt_pk_bf16_f32 v48, v96, v97
  v_mfma_f32_16x16x32_bf16 v[72:75], a[32:35], a[144:147], v[20:23]
  v_exp_f32 v98, v98
  v_mfma_f32_16x16x32_bf16 v[72:75], a[36:39], a[148:151], v[72:75]
  ds_read_b128 a[16:19], v4 offset:4096
  v_mfma_f32_16x16x32_bf16 v[72:75], a[40:43], a[152:155], v[72:75]
  v_exp_f32 v99, v99
  v_mfma_f32_16x16x32_bf16 v[72:75], a[44:47], a[156:159], v[72:75]
  v_cvt_pk_bf16_f32 v49, v98, v99
  v_mfma_f32_16x16x32_bf16 v[80:83], a[32:35], a[160:163], v[24:27]
  v_exp_f32 v100, v100
  v_mfma_f32_16x16x32_bf16 v[80:83], a[36:39], a[164:167], v[80:83]
  ds_read_b128 a[20:23], v4 offset:5120
  v_mfma_f32_16x16x32_bf16 v[80:83], a[40:43], a[168:171], v[80:83]
  v_exp_f32 v101, v101
  v_mfma_f32_16x16x32_bf16 v[80:83], a[44:47], a[172:175], v[80:83]
  v_cvt_pk_bf16_f32 v50, v100, v101
  v_mfma_f32_16x16x32_bf16 v[88:91], a[32:35], a[176:179], v[28:31]
  v_exp_f32 v102, v102
  v_mfma_f32_16x16x32_bf16 v[88:91], a[36:39], a[180:183], v[88:91]
  ds_read_b128 a[24:27], v4 offset:6144
  v_mfma_f32_16x16x32_bf16 v[88:91], a[40:43], a[184:187], v[88:91]
  v_exp_f32 v103, v103
  v_mfma_f32_16x16x32_bf16 v[88:91], a[44:47], a[188:191], v[88:91]
  s_waitcnt lgkmcnt(7)
  v_cvt_pk_bf16_f32 v51, v102, v103
  v_mfma_f32_16x16x32_bf16 v[68:71], a[48:51], a[128:131], v[16:19]
  v_exp_f32 v104, v104
  v_mfma_f32_16x16x32_bf16 v[68:71], a[52:55], a[132:135], v[68:71]
  ds_read_b128 a[28:31], v4 offset:7168
  v_mfma_f32_16x16x32_bf16 v[68:71], a[56:59], a[136:139], v[68:71]
  v_exp_f32 v105, v105
  v_mfma_f32_16x16x32_bf16 v[68:71], a[60:63], a[140:143], v[68:71]
  v_cvt_pk_bf16_f32 v52, v104, v105
  v_mfma_f32_16x16x32_bf16 v[76:79], a[48:51], a[144:147], v[20:23]
  v_exp_f32 v106, v106
  v_mfma_f32_16x16x32_bf16 v[76:79], a[52:55], a[148:151], v[76:79]
  ds_read_b128 a[32:35], v3 offset:8192
  v_mfma_f32_16x16x32_bf16 v[76:79], a[56:59], a[152:155], v[76:79]
  v_exp_f32 v107, v107
  v_mfma_f32_16x16x32_bf16 v[76:79], a[60:63], a[156:159], v[76:79]
  v_cvt_pk_bf16_f32 v53, v106, v107
  v_mfma_f32_16x16x32_bf16 v[84:87], a[48:51], a[160:163], v[24:27]
  v_exp_f32 v108, v108
  v_mfma_f32_16x16x32_bf16 v[84:87], a[52:55], a[164:167], v[84:87]
  ds_read_b128 a[36:39], v3 offset:9216
  v_mfma_f32_16x16x32_bf16 v[84:87], a[56:59], a[168:171], v[84:87]
  v_exp_f32 v109, v109
  v_mfma_f32_16x16x32_bf16 v[84:87], a[60:63], a[172:175], v[84:87]
  v_cvt_pk_bf16_f32 v54, v108, v109
  v_mfma_f32_16x16x32_bf16 v[92:95], a[48:51], a[176:179], v[28:31]
  v_exp_f32 v110, v110
  v_mfma_f32_16x16x32_bf16 v[92:95], a[52:55], a[180:183], v[92:95]
  ds_read_b128 a[40:43], v3 offset:10240
  v_mfma_f32_16x16x32_bf16 v[92:95], a[56:59], a[184:187], v[92:95]
  v_exp_f32 v111, v111
  v_mfma_f32_16x16x32_bf16 v[92:95], a[60:63], a[188:191], v[92:95]
  s_waitcnt lgkmcnt(7)
  v_cvt_pk_bf16_f32 v55, v110, v111
  v_mfma_f32_16x16x32_bf16 v[128:131], a[0:3], v[32:35], v[128:131]
  ds_read_b128 a[44:47], v3 offset:11264
  v_mfma_f32_16x16x32_bf16 v[160:163], a[0:3], v[36:39], v[160:163]
  v_exp_f32 v112, v112
  v_mfma_f32_16x16x32_bf16 v[192:195], a[0:3], v[40:43], v[192:195]
  s_sub_u32 s88, s88, 1
  v_mfma_f32_16x16x32_bf16 v[224:227], a[0:3], v[44:47], v[224:227]
  v_exp_f32 v113, v113
  v_mfma_f32_16x16x32_bf16 a[192:195], a[208:211], v[32:35], a[192:195]
  v_cvt_pk_bf16_f32 v56, v112, v113
  v_mfma_f32_16x16x32_bf16 v[132:135], a[4:7], v[32:35], v[132:135]
  v_exp_f32 v114, v114
  v_mfma_f32_16x16x32_bf16 v[164:167], a[4:7], v[36:39], v[164:167]
  ds_read_b128 a[48:51], v3 offset:12288
  v_mfma_f32_16x16x32_bf16 v[196:199], a[4:7], v[40:43], v[196:199]
  v_exp_f32 v115, v115
  v_mfma_f32_16x16x32_bf16 v[228:231], a[4:7], v[44:47], v[228:231]
  v_cvt_pk_bf16_f32 v57, v114, v115
  v_mfma_f32_16x16x32_bf16 a[196:199], a[208:211], v[36:39], a[196:199]
  v_exp_f32 v116, v116
  v_mfma_f32_16x16x32_bf16 v[136:139], a[8:11], v[32:35], v[136:139]
  ds_read_b128 a[52:55], v3 offset:13312
  v_mfma_f32_16x16x32_bf16 v[168:171], a[8:11], v[36:39], v[168:171]
  v_exp_f32 v117, v117
  v_mfma_f32_16x16x32_bf16 v[200:203], a[8:11], v[40:43], v[200:203]
  v_cvt_pk_bf16_f32 v58, v116, v117
  v_mfma_f32_16x16x32_bf16 v[232:235], a[8:11], v[44:47], v[232:235]
  v_exp_f32 v118, v118
  v_mfma_f32_16x16x32_bf16 a[200:203], a[208:211], v[40:43], a[200:203]
  v_mfma_f32_16x16x32_bf16 v[140:143], a[12:15], v[32:35], v[140:143]
  v_exp_f32 v119, v119
  v_mfma_f32_16x16x32_bf16 v[172:175], a[12:15], v[36:39], v[172:175]
  ds_read_b128 a[56:59], v3 offset:14336
  v_cvt_pk_bf16_f32 v59, v118, v119
  v_mfma_f32_16x16x32_bf16 v[204:207], a[12:15], v[40:43], v[204:207]
  v_exp_f32 v120, v120
  v_mfma_f32_16x16x32_bf16 v[236:239], a[12:15], v[44:47], v[236:239]
  v_mfma_f32_16x16x32_bf16 a[204:207], a[208:211], v[44:47], a[204:207]
  s_waitcnt lgkmcnt(7)
  v_exp_f32 v121, v121
  v_mfma_f32_16x16x32_bf16 v[144:147], a[16:19], v[32:35], v[144:147]
  ds_read_b128 a[60:63], v3 offset:15360
  v_cvt_pk_bf16_f32 v60, v120, v121
  v_mfma_f32_16x16x32_bf16 v[176:179], a[16:19], v[36:39], v[176:179]
  v_exp_f32 v122, v122
  v_mfma_f32_16x16x32_bf16 v[208:211], a[16:19], v[40:43], v[208:211]
  v_mfma_f32_16x16x32_bf16 v[240:243], a[16:19], v[44:47], v[240:243]
  v_exp_f32 v123, v123
  v_mfma_f32_16x16x32_bf16 v[148:151], a[20:23], v[32:35], v[148:151]
  ds_read_b128 a[0:3], v4 offset:8192
  v_cvt_pk_bf16_f32 v61, v122, v123
  v_mfma_f32_16x16x32_bf16 v[180:183], a[20:23], v[36:39], v[180:183]
  v_exp_f32 v124, v124
  v_mfma_f32_16x16x32_bf16 v[212:215], a[20:23], v[40:43], v[212:215]
  v_mfma_f32_16x16x32_bf16 v[244:247], a[20:23], v[44:47], v[244:247]
  v_exp_f32 v125, v125
  v_mfma_f32_16x16x32_bf16 v[152:155], a[24:27], v[32:35], v[152:155]
  ds_read_b128 a[4:7], v4 offset:9216
  v_cvt_pk_bf16_f32 v62, v124, v125
  v_mfma_f32_16x16x32_bf16 v[184:187], a[24:27], v[36:39], v[184:187]
  v_exp_f32 v126, v126
  v_mfma_f32_16x16x32_bf16 v[216:219], a[24:27], v[40:43], v[216:219]
  v_mfma_f32_16x16x32_bf16 v[248:251], a[24:27], v[44:47], v[248:251]
  v_exp_f32 v127, v127
  v_mfma_f32_16x16x32_bf16 v[156:159], a[28:31], v[32:35], v[156:159]
  ds_read_b128 a[8:11], v4 offset:10240
  v_cvt_pk_bf16_f32 v63, v126, v127
  v_mfma_f32_16x16x32_bf16 v[188:191], a[28:31], v[36:39], v[188:191]
  v_mfma_f32_16x16x32_bf16 v[220:223], a[28:31], v[40:43], v[220:223]
  s_waitcnt vmcnt(8)
  s_barrier
  v_mfma_f32_16x16x32_bf16 v[252:255], a[28:31], v[44:47], v[252:255]
  s_cmp_eq_u32 s88, 0
  s_cbranch_scc1 La_d0
  s_waitcnt lgkmcnt(7)
  v_mfma_f32_16x16x32_bf16 v[96:99], a[32:35], a[128:131], v[16:19]
  s_mov_b32 m0, s26
  v_exp_f32 v64, v64
  v_mfma_f32_16x16x32_bf16 v[96:99], a[36:39], a[132:135], v[96:99]
  buffer_load_dwordx4 v2, s[20:23], s28 offen offset:0 sc1 lds
  ds_read_b128 a[12:15], v4 offset:11264
  v_mfma_f32_16x16x32_bf16 v[96:99], a[40:43], a[136:139], v[96:99]
  v_exp_f32 v65, v65
  v_mfma_f32_16x16x32_bf16 v[96:99], a[44:47], a[140:143], v[96:99]
  v_cvt_pk_bf16_f32 v32, v64, v65
  v_mfma_f32_16x16x32_bf16 v[104:107], a[32:35], a[144:147], v[20:23]
  v_exp_f32 v66, v66
  v_mfma_f32_16x16x32_bf16 v[104:107], a[36:39], a[148:151], v[104:107]
  ds_read_b128 a[16:19], v4 offset:12288
  v_mfma_f32_16x16x32_bf16 v[104:107], a[40:43], a[152:155], v[104:107]
  v_exp_f32 v67, v67
  v_mfma_f32_16x16x32_bf16 v[104:107], a[44:47], a[156:159], v[104:107]
  v_cvt_pk_bf16_f32 v33, v66, v67
  v_mfma_f32_16x16x32_bf16 v[112:115], a[32:35], a[160:163], v[24:27]
  v_exp_f32 v68, v68
  v_mfma_f32_16x16x32_bf16 v[112:115], a[36:39], a[164:167], v[112:115]
  buffer_load_dwordx4 v2, s[20:23], s28 offen offset:1024 sc1 lds
  ds_read_b128 a[20:23], v4 offset:13312
  v_mfma_f32_16x16x32_bf16 v[112:115], a[40:43], a[168:171], v[112:115]
  v_exp_f32 v69, v69
  v_mfma_f32_16x16x32_bf16 v[112:115], a[44:47], a[172:175], v[112:115]
  v_cvt_pk_bf16_f32 v34, v68, v69
  v_mfma_f32_16x16x32_bf16 v[120:123], a[32:35], a[176:179], v[28:31]
  v_exp_f32 v70, v70
  v_mfma_f32_16x16x32_bf16 v[120:123], a[36:39], a[180:183], v[120:123]
  ds_read_b128 a[24:27], v4 offset:14336
  v_mfma_f32_16x16x32_bf16 v[120:123], a[40:43], a[184:187], v[120:123]
  v_exp_f32 v71, v71
  v_mfma_f32_16x16x32_bf16 v[120:123], a[44:47], a[188:191], v[120:123]
  s_waitcnt lgkmcnt(7)
  v_cvt_pk_bf16_f32 v35, v70, v71
  v_mfma_f32_16x16x32_bf16 v[100:103], a[48:51], a[128:131], v[16:19]
  v_exp_f32 v72, v72
  v_mfma_f32_16x16x32_bf16 v[100:103], a[52:55], a[132:135], v[100:103]
  buffer_load_dwordx4 v2, s[20:23], s28 offen offset:2048 sc1 lds
  ds_read_b128 a[28:31], v4 offset:15360
  v_mfma_f32_16x16x32_bf16 v[100:103], a[56:59], a[136:139], v[100:103]
  v_exp_f32 v73, v73
  v_mfma_f32_16x16x32_bf16 v[100:103], a[60:63], a[140:143], v[100:103]
  v_xor_b32 v3, s30, v3
  v_cvt_pk_bf16_f32 v36, v72, v73
  v_mfma_f32_16x16x32_bf16 v[108:111], a[48:51], a[144:147], v[20:23]
  v_exp_f32 v74, v74
  v_mfma_f32_16x16x32_bf16 v[108:111], a[52:55], a[148:151], v[108:111]
  ds_read_b128 a[32:35], v3 offset:0
  v_mfma_f32_16x16x32_bf16 v[108:111], a[56:59], a[152:155], v[108:111]
  v_exp_f32 v75, v75
  v_mfma_f32_16x16x32_bf16 v[108:111], a[60:63], a[156:159], v[108:111]
  v_cvt_pk_bf16_f32 v37, v74, v75
  v_mfma_f32_16x16x32_bf16 v[116:119], a[48:51], a[160:163], v[24:27]
  v_exp_f32 v76, v76
  v_mfma_f32_16x16x32_bf16 v[116:119], a[52:55], a[164:167], v[116:119]
  buffer_load_dwordx4 v2, s[20:23], s28 offen offset:3072 sc1 lds
  ds_read_b128 a[36:39], v3 offset:1024
  v_mfma_f32_16x16x32_bf16 v[116:119], a[56:59], a[168:171], v[116:119]
  s_xor_b32 s26, s26, s31
  v_exp_f32 v77, v77
  v_mfma_f32_16x16x32_bf16 v[116:119], a[60:63], a[172:175], v[116:119]
  s_add_u32 s28, s28, 0x8000
  s_mov_b32 m0, s27
  v_cvt_pk_bf16_f32 v38, v76, v77
  v_mfma_f32_16x16x32_bf16 v[124:127], a[48:51], a[176:179], v[28:31]
  v_exp_f32 v78, v78
  v_mfma_f32_16x16x32_bf16 v[124:127], a[52:55], a[180:183], v[124:127]
  ds_read_b128 a[40:43], v3 offset:2048
  v_mfma_f32_16x16x32_bf16 v[124:127], a[56:59], a[184:187], v[124:127]
  v_exp_f32 v79, v79
  v_mfma_f32_16x16x32_bf16 v[124:127], a[60:63], a[188:191], v[124:127]
  s_waitcnt lgkmcnt(7)
  v_cvt_pk_bf16_f32 v39, v78, v79
  v_mfma_f32_16x16x32_bf16 v[128:131], a[0:3], v[48:51], v[128:131]
  buffer_load_dwordx4 v2, s[20:23], s29 offen offset:0 sc1 lds
  ds_read_b128 a[44:47], v3 offset:3072
  v_mfma_f32_16x16x32_bf16 v[160:163], a[0:3], v[52:55], v[160:163]
  v_exp_f32 v80, v80
  v_mfma_f32_16x16x32_bf16 v[192:195], a[0:3], v[56:59], v[192:195]
  v_mfma_f32_16x16x32_bf16 v[224:227], a[0:3], v[60:63], v[224:227]
  v_exp_f32 v81, v81
  v_mfma_f32_16x16x32_bf16 a[192:195], a[208:211], v[48:51], a[192:195]
  v_cvt_pk_bf16_f32 v40, v80, v81
  v_mfma_f32_16x16x32_bf16 v[132:135], a[4:7], v[48:51], v[132:135]
  v_exp_f32 v82, v82
  v_mfma_f32_16x16x32_bf16 v[164:167], a[4:7], v[52:55], v[164:167]
  ds_read_b128 a[48:51], v3 offset:4096
  v_mfma_f32_16x16x32_bf16 v[196:199], a[4:7], v[56:59], v[196:199]
  v_exp_f32 v83, v83
  v_mfma_f32_16x16x32_bf16 v[228:231], a[4:7], v[60:63], v[228:231]
  buffer_load_dwordx4 v2, s[20:23], s29 offen offset:1024 sc1 lds
  v_cvt_pk_bf16_f32 v41, v82, v83
  v_mfma_f32_16x16x32_bf16 a[196:199], a[208:211], v[52:55], a[196:199]
  v_exp_f32 v84, v84
  v_mfma_f32_16x16x32_bf16 v[136:139], a[8:11], v[48:51], v[136:139]
  ds_read_b128 a[52:55], v3 offset:5120
  v_mfma_f32_16x16x32_bf16 v[168:171], a[8:11], v[52:55], v[168:171]
  v_exp_f32 v85, v85
  v_mfma_f32_16x16x32_bf16 v[200:203], a[8:11], v[56:59], v[200:203]
  v_cvt_pk_bf16_f32 v42, v84, v85
  v_mfma_f32_16x16x32_bf16 v[232:235], a[8:11], v[60:63], v[232:235]
  v_exp_f32 v86, v86
  v_mfma_f32_16x16x32_bf16 a[200:203], a[208:211], v[56:59], a[200:203]
  v_mfma_f32_16x16x32_bf16 v[140:143], a[12:15], v[48:51], v[140:143]
  v_exp_f32 v87, v87
  v_mfma_f32_16x16x32_bf16 v[172:175], a[12:15], v[52:55], v[172:175]
  buffer_load_dwordx4 v2, s[20:23], s29 offen offset:2048 sc1 lds
  ds_read_b128 a[56:59], v3 offset:6144
  v_mfma_f32_16x16x32_bf16 v[204:207], a[12:15], v[56:59], v[204:207]
  v_exp_f32 v88, v88
  v_mfma_f32_16x16x32_bf16 v[236:239], a[12:15], v[60:63], v[236:239]
  v_cvt_pk_bf16_f32 v43, v86, v87
  v_mfma_f32_16x16x32_bf16 a[204:207], a[208:211], v[60:63], a[204:207]
  s_waitcnt lgkmcnt(7)
  v_exp_f32 v89, v89
  v_mfma_f32_16x16x32_bf16 v[144:147], a[16:19], v[48:51], v[144:147]
  ds_read_b128 a[60:63], v3 offset:7168
  v_cvt_pk_bf16_f32 v44, v88, v89
  v_mfma_f32_16x16x32_bf16 v[176:179], a[16:19], v[52:55], v[176:179]
  v_exp_f32 v90, v90
  v_mfma_f32_16x16x32_bf16 v[208:211], a[16:19], v[56:59], v[208:211]
  v_mfma_f32_16x16x32_bf16 v[240:243], a[16:19], v[60:63], v[240:243]
  v_exp_f32 v91, v91
  v_mfma_f32_16x16x32_bf16 v[148:151], a[20:23], v[48:51], v[148:151]
  buffer_load_dwordx4 v2, s[20:23], s29 offen offset:3072 sc1 lds
  v_xor_b32 v4, s31, v4
  v_mfma_f32_16x16x32_bf16 v[180:183], a[20:23], v[52:55], v[180:183]
  s_xor_b32 s27, s27, s30
  v_exp_f32 v92, v92
  v_mfma_f32_16x16x32_bf16 v[212:215], a[20:23], v[56:59], v[212:215]
  s_add_u32 s29, s29, 0x8000
  ds_read_b128 a[0:3], v4 offset:0
  v_cvt_pk_bf16_f32 v45, v90, v91
  v_mfma_f32_16x16x32_bf16 v[244:247], a[20:23], v[60:63], v[244:247]
  v_exp_f32 v93, v93
  v_mfma_f32_16x16x32_bf16 v[152:155], a[24:27], v[48:51], v[152:155]
  ds_read_b128 a[4:7], v4 offset:1024
  v_cvt_pk_bf16_f32 v46, v92, v93
  v_mfma_f32_16x16x32_bf16 v[184:187], a[24:27], v[52:55], v[184:187]
  v_exp_f32 v94, v94
  v_mfma_f32_16x16x32_bf16 v[216:219], a[24:27], v[56:59], v[216:219]
  v_mfma_f32_16x16x32_bf16 v[248:251], a[24:27], v[60:63], v[248:251]
  v_exp_f32 v95, v95
  v_mfma_f32_16x16x32_bf16 v[156:159], a[28:31], v[48:51], v[156:159]
  ds_read_b128 a[8:11], v4 offset:2048
  v_cvt_pk_bf16_f32 v47, v94, v95
  v_mfma_f32_16x16x32_bf16 v[188:191], a[28:31], v[52:55], v[188:191]
  v_mfma_f32_16x16x32_bf16 v[220:223], a[28:31], v[56:59], v[220:223]
  v_mfma_f32_16x16x32_bf16 v[252:255], a[28:31], v[60:63], v[252:255]
  s_xor_b32 s30, s30, 0xc000
  s_xor_b32 s31, s31, 0xc000
  s_branch La_lo
La_d0:
  s_waitcnt lgkmcnt(7)
  v_mfma_f32_16x16x32_bf16 v[96:99], a[32:35], a[128:131], v[16:19]
  s_mov_b32 m0, s26
  ds_read_b128 a[12:15], v4 offset:11264
  v_cndmask_b32 v64, v64, v5, s[32:33]
  v_mfma_f32_16x16x32_bf16 v[96:99], a[36:39], a[132:135], v[96:99]
  v_exp_f32 v64, v64
  v_mfma_f32_16x16x32_bf16 v[96:99], a[40:43], a[136:139], v[96:99]
  v_cndmask_b32 v65, v65, v5, s[34:35]
  v_exp_f32 v65, v65
  v_mfma_f32_16x16x32_bf16 v[96:99], a[44:47], a[140:143], v[96:99]
  buffer_load_dwordx4 v2, s[20:23], s28 offen offset:0 sc1 lds
  v_cndmask_b32 v66, v66, v5, s[36:37]
  v_mfma_f32_16x16x32_bf16 v[104:107], a[32:35], a[144:147], v[20:23]
  v_exp_f32 v66, v66
  v_mfma_f32_16x16x32_bf16 v[104:107], a[36:39], a[148:151], v[104:107]
  ds_read_b128 a[16:19], v4 offset:12288
  v_cndmask_b32 v67, v67, v5, s[38:39]
  v_mfma_f32_16x16x32_bf16 v[104:107], a[40:43], a[152:155], v[104:107]
  v_exp_f32 v67, v67
  v_mfma_f32_16x16x32_bf16 v[104:107], a[44:47], a[156:159], v[104:107]
  v_cndmask_b32 v68, v68, v5, s[40:41]
  v_cndmask_b32 v69, v69, v5, s[42:43]
  v_mfma_f32_16x16x32_bf16 v[112:115], a[32:35], a[160:163], v[24:27]
  v_exp_f32 v68, v68
  v_mfma_f32_16x16x32_bf16 v[112:115], a[36:39], a[164:167], v[112:115]
  buffer_load_dwordx4 v2, s[20:23], s28 offen offset:1024 sc1 lds
  ds_read_b128 a[20:23], v4 offset:13312
  v_mfma_f32_16x16x32_bf16 v[112:115], a[40:43], a[168:171], v[112:115]
  v_exp_f32 v69, v69
  v_mfma_f32_16x16x32_bf16 v[112:115], a[44:47], a[172:175], v[112:115]
  v_cndmask_b32 v70, v70, v5, s[44:45]
  v_cvt_pk_bf16_f32 v32, v64, v65
  v_mfma_f32_16x16x32_bf16 v[120:123], a[32:35], a[176:179], v[28:31]
  v_exp_f32 v70, v70
  v_mfma_f32_16x16x32_bf16 v[120:123], a[36:39], a[180:183], v[120:123]
  ds_read_b128 a[24:27], v4 offset:14336
  v_cndmask_b32 v71, v71, v5, s[46:47]
  v_mfma_f32_16x16x32_bf16 v[120:123], a[40:43], a[184:187], v[120:123]
  v_exp_f32 v71, v71
  v_mfma_f32_16x16x32_bf16 v[120:123], a[44:47], a[188:191], v[120:123]
  s_waitcnt lgkmcnt(7)
  v_cvt_pk_bf16_f32 v33, v66, v67
  v_cvt_pk_bf16_f32 v34, v68, v69
  v_mfma_f32_16x16x32_bf16 v[100:103], a[48:51], a[128:131], v[16:19]
  v_exp_f32 v72, v72
  v_mfma_f32_16x16x32_bf16 v[100:103], a[52:55], a[132:135], v[100:103]
  buffer_load_dwordx4 v2, s[20:23], s28 offen offset:2048 sc1 lds
  ds_read_b128 a[28:31], v4 offset:15360
  v_mfma_f32_16x16x32_bf16 v[100:103], a[56:59], a[136:139], v[100:103]
  v_exp_f32 v73, v73
  v_mfma_f32_16x16x32_bf16 v[100:103], a[60:63], a[140:143], v[100:103]
  v_xor_b32 v3, 0x4000, v3
  v_cvt_pk_bf16_f32 v35, v70, v71
  v_mfma_f32_16x16x32_bf16 v[108:111], a[48:51], a[144:147], v[20:23]
  v_exp_f32 v74, v74
  v_mfma_f32_16x16x32_bf16 v[108:111], a[52:55], a[148:151], v[108:111]
  ds_read_b128 a[32:35], v3 offset:0
  v_cvt_pk_bf16_f32 v36, v72, v73
  v_mfma_f32_16x16x32_bf16 v[108:111], a[56:59], a[152:155], v[108:111]
  v_exp_f32 v75, v75
  v_mfma_f32_16x16x32_bf16 v[108:111], a[60:63], a[156:159], v[108:111]
  v_cvt_pk_bf16_f32 v37, v74, v75
  v_mfma_f32_16x16x32_bf16 v[116:119], a[48:51], a[160:163], v[24:27]
  v_exp_f32 v76, v76
  v_mfma_f32_16x16x32_bf16 v[116:119], a[52:55], a[164:167], v[116:119]
  buffer_load_dwordx4 v2, s[20:23], s28 offen offset:3072 sc1 lds
  ds_read_b128 a[36:39], v3 offset:1024
  v_mfma_f32_16x16x32_bf16 v[116:119], a[56:59], a[168:171], v[116:119]
  s_xor_b32 s26, s26, 0x8000
  v_exp_f32 v77, v77
  v_mfma_f32_16x16x32_bf16 v[116:119], a[60:63], a[172:175], v[116:119]
  s_add_u32 s28, s28, 0x8000
  s_mov_b32 m0, s27
  v_cvt_pk_bf16_f32 v38, v76, v77
  v_mfma_f32_16x16x32_bf16 v[124:127], a[48:51], a[176:179], v[28:31]
  v_exp_f32 v78, v78
  v_mfma_f32_16x16x32_bf16 v[124:127], a[52:55], a[180:183], v[124:127]
  ds_read_b128 a[40:43], v3 offset:2048
  v_mfma_f32_16x16x32_bf16 v[124:127], a[56:59], a[184:187], v[124:127]
  v_exp_f32 v79, v79
  v_mfma_f32_16x16x32_bf16 v[124:127], a[60:63], a[188:191], v[124:127]
  s_waitcnt lgkmcnt(7)
  v_cvt_pk_bf16_f32 v39, v78, v79
  v_mfma_f32_16x16x32_bf16 v[128:131], a[0:3], v[48:51], v[128:131]
  buffer_load_dwordx4 v2, s[20:23], s29 offen offset:0 sc1 lds
  ds_read_b128 a[44:47], v3 offset:3072
  v_mfma_f32_16x16x32_bf16 v[160:163], a[0:3], v[52:55], v[160:163]
  v_exp_f32 v80, v80
  v_mfma_f32_16x16x32_bf16 v[192:195], a[0:3], v[56:59], v[192:195]
  v_mfma_f32_16x16x32_bf16 v[224:227], a[0:3], v[60:63], v[224:227]
  v_exp_f32 v81, v81
  v_mfma_f32_16x16x32_bf16 a[192:195], a[208:211], v[48:51], a[192:195]
  v_cvt_pk_bf16_f32 v40, v80, v81
  v_mfma_f32_16x16x32_bf16 v[132:135], a[4:7], v[48:51], v[132:135]
  v_exp_f32 v82, v82
  v_mfma_f32_16x16x32_bf16 v[164:167], a[4:7], v[52:55], v[164:167]
  ds_read_b128 a[48:51], v3 offset:4096
  v_mfma_f32_16x16x32_bf16 v[196:199], a[4:7], v[56:59], v[196:199]
  v_exp_f32 v83, v83
  v_mfma_f32_16x16x32_bf16 v[228:231], a[4:7], v[60:63], v[228:231]
  buffer_load_dwordx4 v2, s[20:23], s29 offen offset:1024 sc1 lds
  v_cvt_pk_bf16_f32 v41, v82, v83
  v_mfma_f32_16x16x32_bf16 a[196:199], a[208:211], v[52:55], a[196:199]
  v_exp_f32 v84, v84
  v_mfma_f32_16x16x32_bf16 v[136:139], a[8:11], v[48:51], v[136:139]
  ds_read_b128 a[52:55], v3 offset:5120
  v_mfma_f32_16x16x32_bf16 v[168:171], a[8:11], v[52:55], v[168:171]
  v_exp_f32 v85, v85
  v_mfma_f32_16x16x32_bf16 v[200:203], a[8:11], v[56:59], v[200:203]
  v_cvt_pk_bf16_f32 v42, v84, v85
  v_mfma_f32_16x16x32_bf16 v[232:235], a[8:11], v[60:63], v[232:235]
  v_exp_f32 v86, v86
  v_mfma_f32_16x16x32_bf16 a[200:203], a[208:211], v[56:59], a[200:203]
  v_mfma_f32_16x16x32_bf16 v[140:143], a[12:15], v[48:51], v[140:143]
  v_exp_f32 v87, v87
  v_mfma_f32_16x16x32_bf16 v[172:175], a[12:15], v[52:55], v[172:175]
  buffer_load_dwordx4 v2, s[20:23], s29 offen offset:2048 sc1 lds
  ds_read_b128 a[56:59], v3 offset:6144
  v_mfma_f32_16x16x32_bf16 v[204:207], a[12:15], v[56:59], v[204:207]
  v_exp_f32 v88, v88
  v_mfma_f32_16x16x32_bf16 v[236:239], a[12:15], v[60:63], v[236:239]
  v_cvt_pk_bf16_f32 v43, v86, v87
  v_mfma_f32_16x16x32_bf16 a[204:207], a[208:211], v[60:63], a[204:207]
  s_waitcnt lgkmcnt(7)
  v_exp_f32 v89, v89
  v_mfma_f32_16x16x32_bf16 v[144:147], a[16:19], v[48:51], v[144:147]
  ds_read_b128 a[60:63], v3 offset:7168
  v_cvt_pk_bf16_f32 v44, v88, v89
  v_mfma_f32_16x16x32_bf16 v[176:179], a[16:19], v[52:55], v[176:179]
  v_exp_f32 v90, v90
  v_mfma_f32_16x16x32_bf16 v[208:211], a[16:19], v[56:59], v[208:211]
  v_mfma_f32_16x16x32_bf16 v[240:243], a[16:19], v[60:63], v[240:243]
  v_exp_f32 v91, v91
  v_mfma_f32_16x16x32_bf16 v[148:151], a[20:23], v[48:51], v[148:151]
  buffer_load_dwordx4 v2, s[20:23], s29 offen offset:3072 sc1 lds
  v_xor_b32 v4, 0x8000, v4
  v_mfma_f32_16x16x32_bf16 v[180:183], a[20:23], v[52:55], v[180:183]
  s_xor_b32 s27, s27, 0x4000
  v_exp_f32 v92, v92
  v_mfma_f32_16x16x32_bf16 v[212:215], a[20:23], v[56:59], v[212:215]
  s_add_u32 s29, s29, 0x8000
  ds_read_b128 a[0:3], v4 offset:0
  v_cvt_pk_bf16_f32 v45, v90, v91
  v_mfma_f32_16x16x32_bf16 v[244:247], a[20:23], v[60:63], v[244:247]
  v_exp_f32 v93, v93
  v_mfma_f32_16x16x32_bf16 v[152:155], a[24:27], v[48:51], v[152:155]
  ds_read_b128 a[4:7], v4 offset:1024
  v_cvt_pk_bf16_f32 v46, v92, v93
  v_mfma_f32_16x16x32_bf16 v[184:187], a[24:27], v[52:55], v[184:187]
  v_exp_f32 v94, v94
  v_mfma_f32_16x16x32_bf16 v[216:219], a[24:27], v[56:59], v[216:219]
  v_mfma_f32_16x16x32_bf16 v[248:251], a[24:27], v[60:63], v[248:251]
  v_exp_f32 v95, v95
  v_mfma_f32_16x16x32_bf16 v[156:159], a[28:31], v[48:51], v[156:159]
  ds_read_b128 a[8:11], v4 offset:2048
  v_cvt_pk_bf16_f32 v47, v94, v95
  v_mfma_f32_16x16x32_bf16 v[188:191], a[28:31], v[52:55], v[188:191]
  v_mfma_f32_16x16x32_bf16 v[220:223], a[28:31], v[56:59], v[220:223]
  v_mfma_f32_16x16x32_bf16 v[252:255], a[28:31], v[60:63], v[252:255]
La_d1:
  s_waitcnt lgkmcnt(7)
  v_mfma_f32_16x16x32_bf16 v[72:75], a[32:35], a[144:147], v[20:23]
  buffer_load_dwordx4 a[64:67], v2, s[8:11], s6 offen offset:0
  ds_read_b128 a[12:15], v4 offset:3072
  v_mfma_f32_16x16x32_bf16 v[72:75], a[36:39], a[148:151], v[72:75]
  v_cndmask_b32 v96, v96, v5, s[48:49]
  v_exp_f32 v96, v96
  v_mfma_f32_16x16x32_bf16 v[72:75], a[40:43], a[152:155], v[72:75]
  v_cndmask_b32 v97, v97, v5, s[50:51]
  v_exp_f32 v97, v97
  v_mfma_f32_16x16x32_bf16 v[72:75], a[44:47], a[156:159], v[72:75]
  v_cndmask_b32 v98, v98, v5, s[52:53]
  v_exp_f32 v98, v98
  v_mfma_f32_16x16x32_bf16 v[80:83], a[32:35], a[160:163], v[24:27]
  ds_read_b128 a[16:19], v4 offset:4096
  v_cndmask_b32 v99, v99, v5, s[54:55]
  v_mfma_f32_16x16x32_bf16 v[80:83], a[36:39], a[164:167], v[80:83]
  v_exp_f32 v99, v99
  v_mfma_f32_16x16x32_bf16 v[80:83], a[40:43], a[168:171], v[80:83]
  buffer_load_dwordx4 a[64:67], v2, s[8:11], s6 offen offset:1024
  ds_read_b128 a[20:23], v4 offset:5120
  v_mfma_f32_16x16x32_bf16 v[80:83], a[44:47], a[172:175], v[80:83]
  v_cndmask_b32 v100, v100, v5, s[56:57]
  v_exp_f32 v100, v100
  v_mfma_f32_16x16x32_bf16 v[88:91], a[32:35], a[176:179], v[28:31]
  v_cndmask_b32 v101, v101, v5, s[58:59]
  v_cndmask_b32 v102, v102, v5, s[60:61]
  v_mfma_f32_16x16x32_bf16 v[88:91], a[36:39], a[180:183], v[88:91]
  v_exp_f32 v101, v101
  v_mfma_f32_16x16x32_bf16 v[88:91], a[40:43], a[184:187], v[88:91]
  v_exp_f32 v102, v102
  v_mfma_f32_16x16x32_bf16 v[88:91], a[44:47], a[188:191], v[88:91]
  s_waitcnt lgkmcnt(6)
  buffer_load_dwordx4 a[64:67], v2, s[8:11], s6 offen offset:2048
  ds_read_b128 a[24:27], v4 offset:6144
  v_mfma_f32_16x16x32_bf16 v[76:79], a[48:51], a[144:147], v[20:23]
  v_cndmask_b32 v103, v103, v5, s[62:63]
  v_exp_f32 v103, v103
  v_mfma_f32_16x16x32_bf16 v[76:79], a[52:55], a[148:151], v[76:79]
  ds_read_b128 a[28:31], v4 offset:7168
  v_cvt_pk_bf16_f32 v48, v96, v97
  v_mfma_f32_16x16x32_bf16 v[76:79], a[56:59], a[152:155], v[76:79]
  v_exp_f32 v104, v104
  v_mfma_f32_16x16x32_bf16 v[76:79], a[60:63], a[156:159], v[76:79]
  ds_read_b128 a[32:35], v3 offset:8192
  v_cvt_pk_bf16_f32 v49, v98, v99
  v_mfma_f32_16x16x32_bf16 v[84:87], a[48:51], a[160:163], v[24:27]
  v_exp_f32 v105, v105
  v_mfma_f32_16x16x32_bf16 v[84:87], a[52:55], a[164:167], v[84:87]
  buffer_load_dwordx4 a[64:67], v2, s[8:11], s6 offen offset:3072
  v_cvt_pk_bf16_f32 v50, v100, v101
  v_mfma_f32_16x16x32_bf16 v[84:87], a[56:59], a[168:171], v[84:87]
  s_add_u32 s6, s6, 4096
  v_exp_f32 v106, v106
  v_mfma_f32_16x16x32_bf16 v[84:87], a[60:63], a[172:175], v[84:87]
  v_exp_f32 v107, v107
  v_mfma_f32_16x16x32_bf16 v[92:95], a[48:51], a[176:179], v[28:31]
  ds_read_b128 a[36:39], v3 offset:9216
  v_cvt_pk_bf16_f32 v51, v102, v103
  v_mfma_f32_16x16x32_bf16 v[92:95], a[52:55], a[180:183], v[92:95]
  v_exp_f32 v108, v108
  v_mfma_f32_16x16x32_bf16 v[92:95], a[56:59], a[184:187], v[92:95]
  buffer_load_dwordx4 a[64:67], v2, s[8:11], s6 offen offset:0
  ds_read_b128 a[40:43], v3 offset:10240
  v_mfma_f32_16x16x32_bf16 v[92:95], a[60:63], a[188:191], v[92:95]
  s_waitcnt lgkmcnt(7)
  v_exp_f32 v109, v109
  v_mfma_f32_16x16x32_bf16 v[128:131], a[0:3], v[32:35], v[128:131]
  ds_read_b128 a[44:47], v3 offset:11264
  v_cvt_pk_bf16_f32 v52, v104, v105
  v_mfma_f32_16x16x32_bf16 v[160:163], a[0:3], v[36:39], v[160:163]
  v_exp_f32 v110, v110
  v_mfma_f32_16x16x32_bf16 v[192:195], a[0:3], v[40:43], v[192:195]
  v_cvt_pk_bf16_f32 v53, v106, v107
  v_cvt_pk_bf16_f32 v54, v108, v109
  v_mfma_f32_16x16x32_bf16 v[224:227], a[0:3], v[44:47], v[224:227]
  v_exp_f32 v111, v111
  v_mfma_f32_16x16x32_bf16 a[192:195], a[208:211], v[32:35], a[192:195]
  buffer_load_dwordx4 a[64:67], v2, s[8:11], s6 offen offset:1024
  v_cvt_pk_bf16_f32 v55, v110, v111
  v_mfma_f32_16x16x32_bf16 v[132:135], a[4:7], v[32:35], v[132:135]
  v_exp_f32 v112, v112
  v_mfma_f32_16x16x32_bf16 v[164:167], a[4:7], v[36:39], v[164:167]
  v_exp_f32 v113, v113
  v_mfma_f32_16x16x32_bf16 v[196:199], a[4:7], v[40:43], v[196:199]
  ds_read_b128 a[48:51], v3 offset:12288
  v_cvt_pk_bf16_f32 v56, v112, v113
  v_mfma_f32_16x16x32_bf16 v[228:231], a[4:7], v[44:47], v[228:231]
  v_exp_f32 v114, v114
  v_mfma_f32_16x16x32_bf16 a[196:199], a[208:211], v[36:39], a[196:199]
  buffer_load_dwordx4 a[64:67], v2, s[8:11], s6 offen offset:2048
  v_mfma_f32_16x16x32_bf16 v[136:139], a[8:11], v[32:35], v[136:139]
  v_exp_f32 v115, v115
  v_mfma_f32_16x16x32_bf16 v[168:171], a[8:11], v[36:39], v[168:171]
  ds_read_b128 a[52:55], v3 offset:13312
  v_cvt_pk_bf16_f32 v57, v114, v115
  v_mfma_f32_16x16x32_bf16 v[200:203], a[8:11], v[40:43], v[200:203]
  v_exp_f32 v116, v116
  v_mfma_f32_16x16x32_bf16 v[232:235], a[8:11], v[44:47], v[232:235]
  v_mfma_f32_16x16x32_bf16 a[200:203], a[208:211], v[40:43], a[200:203]
  v_exp_f32 v117, v117
  v_mfma_f32_16x16x32_bf16 v[140:143], a[12:15], v[32:35], v[140:143]
  v_exp_f32 v118, v118
  v_mfma_f32_16x16x32_bf16 v[172:175], a[12:15], v[36:39], v[172:175]
  buffer_load_dwordx4 a[64:67], v2, s[8:11], s6 offen offset:3072
  ds_read_b128 a[56:59], v3 offset:14336
  v_mfma_f32_16x16x32_bf16 v[204:207], a[12:15], v[40:43], v[204:207]
  v_exp_f32 v119, v119
  v_mfma_f32_16x16x32_bf16 v[236:239], a[12:15], v[44:47], v[236:239]
  v_cvt_pk_bf16_f32 v58, v116, v117
  v_cvt_pk_bf16_f32 v59, v118, v119
  v_mfma_f32_16x16x32_bf16 a[204:207], a[208:211], v[44:47], a[204:207]
  s_waitcnt lgkmcnt(7)
  v_exp_f32 v120, v120
  v_mfma_f32_16x16x32_bf16 v[144:147], a[16:19], v[32:35], v[144:147]
  buffer_load_dwordx4 a[64:67], v2, s[12:15], s7 offen offset:0
  ds_read_b128 a[60:63], v3 offset:15360
  v_mfma_f32_16x16x32_bf16 v[176:179], a[16:19], v[36:39], v[176:179]
  v_exp_f32 v121, v121
  v_mfma_f32_16x16x32_bf16 v[208:211], a[16:19], v[40:43], v[208:211]
  v_cvt_pk_bf16_f32 v60, v120, v121
  v_mfma_f32_16x16x32_bf16 v[240:243], a[16:19], v[44:47], v[240:243]
  v_exp_f32 v122, v122
  v_mfma_f32_16x16x32_bf16 v[148:151], a[20:23], v[32:35], v[148:151]
  v_exp_f32 v123, v123
  v_mfma_f32_16x16x32_bf16 v[180:183], a[20:23], v[36:39], v[180:183]
  ds_read_b128 a[0:3], v4 offset:8192
  v_cvt_pk_bf16_f32 v61, v122, v123
  v_mfma_f32_16x16x32_bf16 v[212:215], a[20:23], v[40:43], v[212:215]
  v_exp_f32 v124, v124
  v_mfma_f32_16x16x32_bf16 v[244:247], a[20:23], v[44:47], v[244:247]
  buffer_load_dwordx4 a[64:67], v2, s[12:15], s7 offen offset:1024
  v_mfma_f32_16x16x32_bf16 v[152:155], a[24:27], v[32:35], v[152:155]
  v_exp_f32 v125, v125
  v_mfma_f32_16x16x32_bf16 v[184:187], a[24:27], v[36:39], v[184:187]
  ds_read_b128 a[4:7], v4 offset:9216
  v_cvt_pk_bf16_f32 v62, v124, v125
  v_mfma_f32_16x16x32_bf16 v[216:219], a[24:27], v[40:43], v[216:219]
  v_exp_f32 v126, v126
  v_mfma_f32_16x16x32_bf16 v[248:251], a[24:27], v[44:47], v[248:251]
  v_mfma_f32_16x16x32_bf16 v[156:159], a[28:31], v[32:35], v[156:159]
  v_exp_f32 v127, v127
  v_mfma_f32_16x16x32_bf16 v[188:191], a[28:31], v[36:39], v[188:191]
  ds_read_b128 a[8:11], v4 offset:10240
  v_cvt_pk_bf16_f32 v63, v126, v127
  v_mfma_f32_16x16x32_bf16 v[220:223], a[28:31], v[40:43], v[220:223]
  s_waitcnt vmcnt(22)
  s_barrier
  v_mfma_f32_16x16x32_bf16 v[252:255], a[28:31], v[44:47], v[252:255]
  s_waitcnt lgkmcnt(7)
  v_mfma_f32_16x16x32_bf16 v[104:107], a[32:35], a[144:147], v[20:23]
  s_mov_b32 m0, s26
  ds_read_b128 a[12:15], v4 offset:11264
  v_cndmask_b32 v72, v72, v5, s[32:33]
  v_mfma_f32_16x16x32_bf16 v[104:107], a[36:39], a[148:151], v[104:107]
  v_exp_f32 v72, v72
  v_mfma_f32_16x16x32_bf16 v[104:107], a[40:43], a[152:155], v[104:107]
  v_cndmask_b32 v73, v73, v5, s[34:35]
  v_exp_f32 v73, v73
  v_mfma_f32_16x16x32_bf16 v[104:107], a[44:47], a[156:159], v[104:107]
  buffer_load_dwordx4 v2, s[20:23], s28 offen offset:0 sc1 lds
  ds_read_b128 a[16:19], v4 offset:12288
  v_mfma_f32_16x16x32_bf16 v[112:115], a[32:35], a[160:163], v[24:27]
  v_cndmask_b32 v74, v74, v5, s[36:37]
  v_exp_f32 v74, v74
  v_mfma_f32_16x16x32_bf16 v[112:115], a[36:39], a[164:167], v[112:115]
  v_cvt_pk_bf16_f32 v36, v72, v73
  v_mfma_f32_16x16x32_bf16 v[112:115], a[40:43], a[168:171], v[112:115]
  ds_read_b128 a[20:23], v4 offset:13312
  v_cndmask_b32 v75, v75, v5, s[38:39]
  v_mfma_f32_16x16x32_bf16 v[112:115], a[44:47], a[172:175], v[112:115]
  v_exp_f32 v75, v75
  v_mfma_f32_16x16x32_bf16 v[120:123], a[32:35], a[176:179], v[28:31]
  buffer_load_dwordx4 v2, s[20:23], s28 offen offset:1024 sc1 lds
  v_cndmask_b32 v76, v76, v5, s[40:41]
  v_mfma_f32_16x16x32_bf16 v[120:123], a[36:39], a[180:183], v[120:123]
  v_exp_f32 v76, v76
  v_mfma_f32_16x16x32_bf16 v[120:123], a[40:43], a[184:187], v[120:123]
  ds_read_b128 a[24:27], v4 offset:14336
  v_cndmask_b32 v79, v79, v5, s[46:47]
  v_mfma_f32_16x16x32_bf16 v[120:123], a[44:47], a[188:191], v[120:123]
  s_waitcnt lgkmcnt(7)
  v_cndmask_b32 v77, v77, v5, s[42:43]
  v_cndmask_b32 v78, v78, v5, s[44:45]
  v_mfma_f32_16x16x32_bf16 v[108:111], a[48:51], a[144:147], v[20:23]
  v_exp_f32 v77, v77
  v_mfma_f32_16x16x32_bf16 v[108:111], a[52:55], a[148:151], v[108:111]
  ds_read_b128 a[28:31], v4 offset:15360
  v_xor_b32 v4, 0x4000, v4
  v_mfma_f32_16x16x32_bf16 v[108:111], a[56:59], a[152:155], v[108:111]
  v_exp_f32 v78, v78
  v_mfma_f32_16x16x32_bf16 v[108:111], a[60:63], a[156:159], v[108:111]
  buffer_load_dwordx4 v2, s[20:23], s28 offen offset:2048 sc1 lds
  v_xor_b32 v3, 0x8000, v3
  v_mfma_f32_16x16x32_bf16 v[116:119], a[48:51], a[160:163], v[24:27]
  v_exp_f32 v79, v79
  v_mfma_f32_16x16x32_bf16 v[116:119], a[52:55], a[164:167], v[116:119]
  ds_read_b128 a[32:35], v3 offset:0
  v_cvt_pk_bf16_f32 v37, v74, v75
  v_mfma_f32_16x16x32_bf16 v[116:119], a[56:59], a[168:171], v[116:119]
  ds_read_b128 a[36:39], v3 offset:1024
  v_cvt_pk_bf16_f32 v38, v76, v77
  v_mfma_f32_16x16x32_bf16 v[116:119], a[60:63], a[172:175], v[116:119]
  v_exp_f32 v80, v80
  v_mfma_f32_16x16x32_bf16 v[124:127], a[48:51], a[176:179], v[28:31]
  v_cvt_pk_bf16_f32 v39, v78, v79
  v_mfma_f32_16x16x32_bf16 v[124:127], a[52:55], a[180:183], v[124:127]
  v_exp_f32 v81, v81
  v_mfma_f32_16x16x32_bf16 v[124:127], a[56:59], a[184:187], v[124:127]
  buffer_load_dwordx4 v2, s[20:23], s28 offen offset:3072 sc1 lds
  ds_read_b128 a[40:43], v3 offset:2048
  v_mfma_f32_16x16x32_bf16 v[124:127], a[60:63], a[188:191], v[124:127]
  s_waitcnt lgkmcnt(7)
  s_xor_b32 s26, s26, 0x4000
  s_add_u32 s28, s28, 0x8000
  v_mfma_f32_16x16x32_bf16 v[128:131], a[0:3], v[48:51], v[128:131]
  s_mov_b32 m0, s27
  v_exp_f32 v82, v82
  v_mfma_f32_16x16x32_bf16 v[160:163], a[0:3], v[52:55], v[160:163]
  ds_read_b128 a[44:47], v3 offset:3072
  v_cvt_pk_bf16_f32 v40, v80, v81
  v_mfma_f32_16x16x32_bf16 v[192:195], a[0:3], v[56:59], v[192:195]
  v_exp_f32 v83, v83
  v_mfma_f32_16x16x32_bf16 v[224:227], a[0:3], v[60:63], v[224:227]
  v_cvt_pk_bf16_f32 v41, v82, v83
  v_mfma_f32_16x16x32_bf16 a[192:195], a[208:211], v[48:51], a[192:195]
  buffer_load_dwordx4 v2, s[20:23], s29 offen offset:0 sc1 lds
  v_mfma_f32_16x16x32_bf16 v[132:135], a[4:7], v[48:51], v[132:135]
  v_exp_f32 v84, v84
  v_mfma_f32_16x16x32_bf16 v[164:167], a[4:7], v[52:55], v[164:167]
  ds_read_b128 a[48:51], v3 offset:4096
  v_mfma_f32_16x16x32_bf16 v[196:199], a[4:7], v[56:59], v[196:199]
  v_exp_f32 v85, v85
  v_mfma_f32_16x16x32_bf16 v[228:231], a[4:7], v[60:63], v[228:231]
  v_cvt_pk_bf16_f32 v42, v84, v85
  v_mfma_f32_16x16x32_bf16 a[196:199], a[208:211], v[52:55], a[196:199]
  v_exp_f32 v86, v86
  v_mfma_f32_16x16x32_bf16 v[136:139], a[8:11], v[48:51], v[136:139]
  ds_read_b128 a[52:55], v3 offset:5120
  v_mfma_f32_16x16x32_bf16 v[168:171], a[8:11], v[52:55], v[168:171]
  buffer_load_dwordx4 v2, s[20:23], s29 offen offset:1024 sc1 lds
  v_mfma_f32_16x16x32_bf16 v[200:203], a[8:11], v[56:59], v[200:203]
  v_exp_f32 v87, v87
  v_mfma_f32_16x16x32_bf16 v[232:235], a[8:11], v[60:63], v[232:235]
  v_cvt_pk_bf16_f32 v43, v86, v87
  v_mfma_f32_16x16x32_bf16 a[200:203], a[208:211], v[56:59], a[200:203]
  v_exp_f32 v88, v88
  v_mfma_f32_16x16x32_bf16 v[140:143], a[12:15], v[48:51], v[140:143]
  ds_read_b128 a[56:59], v3 offset:6144
  v_mfma_f32_16x16x32_bf16 v[172:175], a[12:15], v[52:55], v[172:175]
  v_mfma_f32_16x16x32_bf16 v[204:207], a[12:15], v[56:59], v[204:207]
  v_exp_f32 v89, v89
  v_mfma_f32_16x16x32_bf16 v[236:239], a[12:15], v[60:63], v[236:239]
  buffer_load_dwordx4 v2, s[20:23], s29 offen offset:2048 sc1 lds
  v_cvt_pk_bf16_f32 v44, v88, v89
  v_mfma_f32_16x16x32_bf16 a[204:207], a[208:211], v[60:63], a[204:207]
  s_waitcnt lgkmcnt(7)
  v_exp_f32 v90, v90
  v_mfma_f32_16x16x32_bf16 v[144:147], a[16:19], v[48:51], v[144:147]
  ds_read_b128 a[60:63], v3 offset:7168
  v_mfma_f32_16x16x32_bf16 v[176:179], a[16:19], v[52:55], v[176:179]
  v_exp_f32 v91, v91
  v_mfma_f32_16x16x32_bf16 v[208:211], a[16:19], v[56:59], v[208:211]
  v_cvt_pk_bf16_f32 v45, v90, v91
  v_mfma_f32_16x16x32_bf16 v[240:243], a[16:19], v[60:63], v[240:243]
  v_mfma_f32_16x16x32_bf16 v[148:151], a[20:23], v[48:51], v[148:151]
  v_exp_f32 v92, v92
  v_mfma_f32_16x16x32_bf16 v[180:183], a[20:23], v[52:55], v[180:183]
  buffer_load_dwordx4 v2, s[20:23], s29 offen offset:3072 sc1 lds
  ds_read_b128 a[0:3], v3 offset:8192
  v_mfma_f32_16x16x32_bf16 v[212:215], a[20:23], v[56:59], v[212:215]
  s_xor_b32 s27, s27, 0x8000
  v_exp_f32 v93, v93
  v_mfma_f32_16x16x32_bf16 v[244:247], a[20:23], v[60:63], v[244:247]
  s_add_u32 s29, s29, 0x8000
  v_cvt_pk_bf16_f32 v46, v92, v93
  v_mfma_f32_16x16x32_bf16 v[152:155], a[24:27], v[48:51], v[152:155]
  ds_read_b128 a[4:7], v3 offset:9216
  v_mfma_f32_16x16x32_bf16 v[184:187], a[24:27], v[52:55], v[184:187]
  v_exp_f32 v94, v94
  v_mfma_f32_16x16x32_bf16 v[216:219], a[24:27], v[56:59], v[216:219]
  v_mfma_f32_16x16x32_bf16 v[248:251], a[24:27], v[60:63], v[248:251]
  v_exp_f32 v95, v95
  v_mfma_f32_16x16x32_bf16 v[156:159], a[28:31], v[48:51], v[156:159]
  ds_read_b128 a[8:11], v3 offset:10240
  v_cvt_pk_bf16_f32 v47, v94, v95
  v_mfma_f32_16x16x32_bf16 v[188:191], a[28:31], v[52:55], v[188:191]
  v_mfma_f32_16x16x32_bf16 v[220:223], a[28:31], v[56:59], v[220:223]
  s_waitcnt vmcnt(22)
  s_barrier
  v_mfma_f32_16x16x32_bf16 v[252:255], a[28:31], v[60:63], v[252:255]
  s_lshr_b32 s91, s73, 1
  s_lshl_b32 s91, s91, 11
  s_add_u32 s91, s91, 32768
  v_and_b32 v14, 15, v1
  v_lshlrev_b32 v14, 7, v14
  s_waitcnt lgkmcnt(3)
  v_mfma_f32_16x16x32_bf16 v[64:67], a[32:35], a[160:163], v[24:27]
  s_mov_b32 m0, s26
  ds_read_b128 a[12:15], v3 offset:11264
  v_cndmask_b32 v104, v104, v5, s[48:49]
  v_mfma_f32_16x16x32_bf16 v[64:67], a[36:39], a[164:167], v[64:67]
  v_exp_f32 v104, v104
  v_mfma_f32_16x16x32_bf16 v[64:67], a[40:43], a[168:171], v[64:67]
  v_cndmask_b32 v105, v105, v5, s[50:51]
  v_exp_f32 v105, v105
  v_mfma_f32_16x16x32_bf16 v[64:67], a[44:47], a[172:175], v[64:67]
  buffer_load_dwordx4 v2, s[20:23], s28 offen offset:0 sc1 lds
  ds_read_b128 a[16:19], v3 offset:12288
  v_mfma_f32_16x16x32_bf16 v[72:75], a[32:35], a[176:179], v[28:31]
  v_cndmask_b32 v106, v106, v5, s[52:53]
  v_exp_f32 v106, v106
  v_mfma_f32_16x16x32_bf16 v[72:75], a[36:39], a[180:183], v[72:75]
  ds_read_b128 a[20:23], v3 offset:13312
  v_cndmask_b32 v107, v107, v5, s[54:55]
  v_mfma_f32_16x16x32_bf16 v[72:75], a[40:43], a[184:187], v[72:75]
  buffer_load_dwordx4 v2, s[20:23], s28 offen offset:1024 sc1 lds
  ds_read_b128 a[24:27], v3 offset:14336
  v_mfma_f32_16x16x32_bf16 v[72:75], a[44:47], a[188:191], v[72:75]
  v_exp_f32 v107, v107
  v_mfma_f32_16x16x32_bf16 v[68:71], a[48:51], a[160:163], v[24:27]
  ds_read_b128 a[28:31], v3 offset:15360
  v_cndmask_b32 v108, v108, v5, s[56:57]
  v_mfma_f32_16x16x32_bf16 v[68:71], a[52:55], a[164:167], v[68:71]
  v_exp_f32 v108, v108
  v_mfma_f32_16x16x32_bf16 v[68:71], a[56:59], a[168:171], v[68:71]
  ds_read_b128 a[32:35], v4 offset:0
  v_cndmask_b32 v109, v109, v5, s[58:59]
  v_mfma_f32_16x16x32_bf16 v[68:71], a[60:63], a[172:175], v[68:71]
  v_exp_f32 v109, v109
  v_mfma_f32_16x16x32_bf16 v[76:79], a[48:51], a[176:179], v[28:31]
  ds_read_b128 a[36:39], v4 offset:1024
  v_cvt_pk_bf16_f32 v52, v104, v105
  v_mfma_f32_16x16x32_bf16 v[76:79], a[52:55], a[180:183], v[76:79]
  buffer_load_dwordx4 v2, s[20:23], s28 offen offset:2048 sc1 lds
  v_cndmask_b32 v110, v110, v5, s[60:61]
  v_mfma_f32_16x16x32_bf16 v[76:79], a[56:59], a[184:187], v[76:79]
  v_exp_f32 v110, v110
  v_mfma_f32_16x16x32_bf16 v[76:79], a[60:63], a[188:191], v[76:79]
  s_waitcnt lgkmcnt(2)
  ds_read_b128 a[40:43], v4 offset:2048
  v_cndmask_b32 v111, v111, v5, s[62:63]
  v_mfma_f32_16x16x32_bf16 v[80:83], a[0:3], a[160:163], v[24:27]
  v_exp_f32 v111, v111
  v_mfma_f32_16x16x32_bf16 v[80:83], a[4:7], a[164:167], v[80:83]
  ds_read_b128 a[44:47], v4 offset:3072
  v_cvt_pk_bf16_f32 v53, v106, v107
  v_mfma_f32_16x16x32_bf16 v[80:83], a[8:11], a[168:171], v[80:83]
  ds_read_b128 a[48:51], v4 offset:4096
  v_cvt_pk_bf16_f32 v54, v108, v109
  v_mfma_f32_16x16x32_bf16 v[80:83], a[12:15], a[172:175], v[80:83]
  v_exp_f32 v112, v112
  v_mfma_f32_16x16x32_bf16 v[88:91], a[0:3], a[176:179], v[28:31]
  buffer_load_dwordx4 v2, s[20:23], s28 offen offset:3072 sc1 lds
  ds_read_b128 a[52:55], v4 offset:5120
  v_mfma_f32_16x16x32_bf16 v[88:91], a[4:7], a[180:183], v[88:91]
  s_xor_b32 s26, s26, 0x8000
  v_exp_f32 v113, v113
  v_mfma_f32_16x16x32_bf16 v[88:91], a[8:11], a[184:187], v[88:91]
  s_add_u32 s28, s28, 0x8000
  s_mov_b32 m0, s27
  ds_read_b128 a[56:59], v4 offset:6144
  v_mfma_f32_16x16x32_bf16 v[88:91], a[12:15], a[188:191], v[88:91]
  v_exp_f32 v114, v114
  v_mfma_f32_16x16x32_bf16 v[84:87], a[16:19], a[160:163], v[24:27]
  ds_read_b128 a[60:63], v4 offset:7168
  v_cvt_pk_bf16_f32 v55, v110, v111
  v_mfma_f32_16x16x32_bf16 v[84:87], a[20:23], a[164:167], v[84:87]
  v_xor_b32 v3, 0x4000, v3
  v_cvt_pk_bf16_f32 v56, v112, v113
  v_mfma_f32_16x16x32_bf16 v[84:87], a[24:27], a[168:171], v[84:87]
  v_exp_f32 v115, v115
  v_mfma_f32_16x16x32_bf16 v[84:87], a[28:31], a[172:175], v[84:87]
  buffer_load_dwordx4 v2, s[20:23], s29 offen offset:0 sc1 lds
  ds_read_b128 a[0:3], v3 offset:0
  v_mfma_f32_16x16x32_bf16 v[92:95], a[16:19], a[176:179], v[28:31]
  v_exp_f32 v116, v116
  v_mfma_f32_16x16x32_bf16 v[92:95], a[20:23], a[180:183], v[92:95]
  ds_read_b128 a[4:7], v3 offset:1024
  v_cvt_pk_bf16_f32 v57, v114, v115
  v_mfma_f32_16x16x32_bf16 v[92:95], a[24:27], a[184:187], v[92:95]
  v_exp_f32 v117, v117
  v_mfma_f32_16x16x32_bf16 v[92:95], a[28:31], a[188:191], v[92:95]
  s_waitcnt lgkmcnt(6)
  ds_read_b128 a[8:11], v3 offset:2048
  v_cvt_pk_bf16_f32 v58, v116, v117
  v_mfma_f32_16x16x32_bf16 v[160:163], a[32:35], v[36:39], v[160:163]
  ds_read_b128 a[12:15], v3 offset:3072
  v_mfma_f32_16x16x32_bf16 v[192:195], a[32:35], v[40:43], v[192:195]
  v_exp_f32 v118, v118
  v_mfma_f32_16x16x32_bf16 v[224:227], a[32:35], v[44:47], v[224:227]
  buffer_load_dwordx4 v2, s[20:23], s29 offen offset:1024 sc1 lds
  v_mfma_f32_16x16x32_bf16 a[196:199], a[208:211], v[36:39], a[196:199]
  v_exp_f32 v119, v119
  v_mfma_f32_16x16x32_bf16 v[164:167], a[36:39], v[36:39], v[164:167]
  ds_read_b128 a[16:19], v3 offset:4096
  v_cvt_pk_bf16_f32 v59, v118, v119
  v_mfma_f32_16x16x32_bf16 v[196:199], a[36:39], v[40:43], v[196:199]
  v_mfma_f32_16x16x32_bf16 v[228:231], a[36:39], v[44:47], v[228:231]
  v_exp_f32 v120, v120
  v_mfma_f32_16x16x32_bf16 a[200:203], a[208:211], v[40:43], a[200:203]
  v_mfma_f32_16x16x32_bf16 v[168:171], a[40:43], v[36:39], v[168:171]
  v_exp_f32 v121, v121
  v_mfma_f32_16x16x32_bf16 v[200:203], a[40:43], v[40:43], v[200:203]
  buffer_load_dwordx4 v2, s[20:23], s29 offen offset:2048 sc1 lds
  ds_read_b128 a[20:23], v3 offset:5120
  v_mfma_f32_16x16x32_bf16 v[232:235], a[40:43], v[44:47], v[232:235]
  v_exp_f32 v122, v122
  v_mfma_f32_16x16x32_bf16 a[204:207], a[208:211], v[44:47], a[204:207]
  v_cvt_pk_bf16_f32 v60, v120, v121
  v_mfma_f32_16x16x32_bf16 v[172:175], a[44:47], v[36:39], v[172:175]
  ds_read_b128 a[24:27], v3 offset:6144
  v_mfma_f32_16x16x32_bf16 v[204:207], a[44:47], v[40:43], v[204:207]
  v_exp_f32 v123, v123
  v_mfma_f32_16x16x32_bf16 v[236:239], a[44:47], v[44:47], v[236:239]
  s_waitcnt lgkmcnt(7)
  v_cvt_pk_bf16_f32 v61, v122, v123
  v_mfma_f32_16x16x32_bf16 v[176:179], a[48:51], v[36:39], v[176:179]
  v_exp_f32 v124, v124
  v_mfma_f32_16x16x32_bf16 v[208:211], a[48:51], v[40:43], v[208:211]
  buffer_load_dwordx4 v2, s[20:23], s29 offen offset:3072 sc1 lds
  ds_read_b128 a[28:31], v3 offset:7168
  v_mfma_f32_16x16x32_bf16 v[240:243], a[48:51], v[44:47], v[240:243]
  s_xor_b32 s27, s27, 0x4000
  v_exp_f32 v125, v125
  v_mfma_f32_16x16x32_bf16 v[180:183], a[52:55], v[36:39], v[180:183]
  s_add_u32 s29, s29, 0x8000
  ds_read_b128 a[32:35], v3 offset:8192
  v_cvt_pk_bf16_f32 v62, v124, v125
  v_mfma_f32_16x16x32_bf16 v[212:215], a[52:55], v[40:43], v[212:215]
  v_mfma_f32_16x16x32_bf16 v[244:247], a[52:55], v[44:47], v[244:247]
  v_exp_f32 v126, v126
  v_mfma_f32_16x16x32_bf16 v[184:187], a[56:59], v[36:39], v[184:187]
  ds_read_b128 a[36:39], v3 offset:9216
  v_mfma_f32_16x16x32_bf16 v[216:219], a[56:59], v[40:43], v[216:219]
  v_exp_f32 v127, v127
  v_mfma_f32_16x16x32_bf16 v[248:251], a[56:59], v[44:47], v[248:251]
  v_cvt_pk_bf16_f32 v63, v126, v127
  v_mfma_f32_16x16x32_bf16 v[188:191], a[60:63], v[36:39], v[188:191]
  ds_read_b128 a[40:43], v3 offset:10240
  v_mfma_f32_16x16x32_bf16 v[220:223], a[60:63], v[40:43], v[220:223]
  s_waitcnt vmcnt(12)
  s_barrier
  v_mfma_f32_16x16x32_bf16 v[252:255], a[60:63], v[44:47], v[252:255]
  s_cmp_eq_u32 s25, 7
  s_cbranch_scc1 La_t7
  s_waitcnt lgkmcnt(3)
  v_mfma_f32_16x16x32_bf16 v[96:99], a[0:3], a[160:163], v[24:27]
  s_mov_b32 m0, s26
  v_exp_f32 v64, v64
  v_mfma_f32_16x16x32_bf16 v[96:99], a[4:7], a[164:167], v[96:99]
  v_exp_f32 v65, v65
  v_mfma_f32_16x16x32_bf16 v[96:99], a[8:11], a[168:171], v[96:99]
  buffer_load_dwordx4 v2, s[20:23], s28 offen offset:0 sc1 lds
  ds_read_b128 a[44:47], v3 offset:11264
  v_mfma_f32_16x16x32_bf16 v[96:99], a[12:15], a[172:175], v[96:99]
  v_exp_f32 v66, v66
  v_mfma_f32_16x16x32_bf16 v[104:107], a[0:3], a[176:179], v[28:31]
  ds_read_b128 a[48:51], v3 offset:12288
  ds_read_b128 a[52:55], v3 offset:13312
  v_mfma_f32_16x16x32_bf16 v[104:107], a[4:7], a[180:183], v[104:107]
  v_exp_f32 v67, v67
  v_mfma_f32_16x16x32_bf16 v[104:107], a[8:11], a[184:187], v[104:107]
  ds_read_b128 a[56:59], v3 offset:14336
  v_cvt_pk_bf16_f32 v32, v64, v65
  v_mfma_f32_16x16x32_bf16 v[104:107], a[12:15], a[188:191], v[104:107]
  v_exp_f32 v68, v68
  v_mfma_f32_16x16x32_bf16 v[100:103], a[16:19], a[160:163], v[24:27]
  v_exp_f32 v69, v69
  v_mfma_f32_16x16x32_bf16 v[100:103], a[20:23], a[164:167], v[100:103]
  ds_read_b128 a[60:63], v3 offset:15360
  v_cvt_pk_bf16_f32 v33, v66, v67
  v_mfma_f32_16x16x32_bf16 v[100:103], a[24:27], a[168:171], v[100:103]
  v_exp_f32 v70, v70
  v_mfma_f32_16x16x32_bf16 v[100:103], a[28:31], a[172:175], v[100:103]
  ds_read_b128 a[0:3], v4 offset:8192
  v_cvt_pk_bf16_f32 v34, v68, v69
  v_mfma_f32_16x16x32_bf16 v[108:111], a[16:19], a[176:179], v[28:31]
  v_exp_f32 v71, v71
  v_mfma_f32_16x16x32_bf16 v[108:111], a[20:23], a[180:183], v[108:111]
  buffer_load_dwordx4 v2, s[20:23], s28 offen offset:1024 sc1 lds
  ds_read_b128 a[4:7], v4 offset:9216
  v_mfma_f32_16x16x32_bf16 v[108:111], a[24:27], a[184:187], v[108:111]
  v_exp_f32 v72, v72
  v_mfma_f32_16x16x32_bf16 v[108:111], a[28:31], a[188:191], v[108:111]
  s_waitcnt lgkmcnt(2)
  ds_read_b128 a[8:11], v4 offset:10240
  v_cvt_pk_bf16_f32 v35, v70, v71
  v_mfma_f32_16x16x32_bf16 v[112:115], a[32:35], a[160:163], v[24:27]
  v_exp_f32 v73, v73
  v_mfma_f32_16x16x32_bf16 v[112:115], a[36:39], a[164:167], v[112:115]
  v_exp_f32 v74, v74
  v_mfma_f32_16x16x32_bf16 v[112:115], a[40:43], a[168:171], v[112:115]
  ds_read_b128 a[12:15], v4 offset:11264
  ds_read_b128 a[16:19], v4 offset:12288
  v_mfma_f32_16x16x32_bf16 v[112:115], a[44:47], a[172:175], v[112:115]
  v_exp_f32 v75, v75
  v_mfma_f32_16x16x32_bf16 v[120:123], a[32:35], a[176:179], v[28:31]
  ds_read_b128 a[20:23], v4 offset:13312
  v_cvt_pk_bf16_f32 v36, v72, v73
  v_mfma_f32_16x16x32_bf16 v[120:123], a[36:39], a[180:183], v[120:123]
  v_exp_f32 v76, v76
  v_mfma_f32_16x16x32_bf16 v[120:123], a[40:43], a[184:187], v[120:123]
  ds_read_b128 a[24:27], v4 offset:14336
  v_cvt_pk_bf16_f32 v37, v74, v75
  v_mfma_f32_16x16x32_bf16 v[120:123], a[44:47], a[188:191], v[120:123]
  v_exp_f32 v77, v77
  v_mfma_f32_16x16x32_bf16 v[116:119], a[48:51], a[160:163], v[24:27]
  v_exp_f32 v78, v78
  v_mfma_f32_16x16x32_bf16 v[116:119], a[52:55], a[164:167], v[116:119]
  ds_read_b128 a[28:31], v4 offset:15360
  v_xor_b32 v4, 0x8000, v4
  v_mfma_f32_16x16x32_bf16 v[116:119], a[56:59], a[168:171], v[116:119]
  v_exp_f32 v79, v79
  v_mfma_f32_16x16x32_bf16 v[116:119], a[60:63], a[172:175], v[116:119]
  buffer_load_dwordx4 v2, s[20:23], s28 offen offset:2048 sc1 lds
  v_xor_b32 v3, 0x8000, v3
  v_mfma_f32_16x16x32_bf16 v[124:127], a[48:51], a[176:179], v[28:31]
  v_exp_f32 v80, v80
  v_mfma_f32_16x16x32_bf16 v[124:127], a[52:55], a[180:183], v[124:127]
  ds_read_b128 a[32:35], v3 offset:0
  ds_read_b128 a[36:39], v3 offset:1024
  v_mfma_f32_16x16x32_bf16 v[124:127], a[56:59], a[184:187], v[124:127]
  v_exp_f32 v81, v81
  v_mfma_f32_16x16x32_bf16 v[124:127], a[60:63], a[188:191], v[124:127]
  s_waitcnt lgkmcnt(6)
  ds_read_b128 a[40:43], v3 offset:2048
  v_cvt_pk_bf16_f32 v38, v76, v77
  v_mfma_f32_16x16x32_bf16 v[160:163], a[0:3], v[52:55], v[160:163]
  v_exp_f32 v82, v82
  v_mfma_f32_16x16x32_bf16 v[192:195], a[0:3], v[56:59], v[192:195]
  v_exp_f32 v83, v83
  v_mfma_f32_16x16x32_bf16 v[224:227], a[0:3], v[60:63], v[224:227]
  ds_read_b128 a[44:47], v3 offset:3072
  v_cvt_pk_bf16_f32 v39, v78, v79
  v_mfma_f32_16x16x32_bf16 a[196:199], a[208:211], v[52:55], a[196:199]
  v_exp_f32 v84, v84
  v_mfma_f32_16x16x32_bf16 v[164:167], a[4:7], v[52:55], v[164:167]
  ds_read_b128 a[48:51], v3 offset:4096
  v_cvt_pk_bf16_f32 v40, v80, v81
  v_mfma_f32_16x16x32_bf16 v[196:199], a[4:7], v[56:59], v[196:199]
  v_exp_f32 v85, v85
  v_mfma_f32_16x16x32_bf16 v[228:231], a[4:7], v[60:63], v[228:231]
  v_cvt_pk_bf16_f32 v41, v82, v83
  v_cvt_pk_bf16_f32 v42, v84, v85
  v_mfma_f32_16x16x32_bf16 a[200:203], a[208:211], v[56:59], a[200:203]
  v_exp_f32 v86, v86
  v_mfma_f32_16x16x32_bf16 v[168:171], a[8:11], v[52:55], v[168:171]
  v_exp_f32 v87, v87
  v_mfma_f32_16x16x32_bf16 v[200:203], a[8:11], v[56:59], v[200:203]
  buffer_load_dwordx4 v2, s[20:23], s28 offen offset:3072 sc1 lds
  ds_read_b128 a[52:55], v3 offset:5120
  v_mfma_f32_16x16x32_bf16 v[232:235], a[8:11], v[60:63], v[232:235]
  s_xor_b32 s26, s26, 0x4000
  v_exp_f32 v88, v88
  v_mfma_f32_16x16x32_bf16 a[204:207], a[208:211], v[60:63], a[204:207]
  s_add_u32 s28, s28, 0x8000
  v_cvt_pk_bf16_f32 v43, v86, v87
  v_mfma_f32_16x16x32_bf16 v[172:175], a[12:15], v[52:55], v[172:175]
  v_exp_f32 v89, v89
  v_mfma_f32_16x16x32_bf16 v[204:207], a[12:15], v[56:59], v[204:207]
  ds_read_b128 a[56:59], v3 offset:6144
  v_cvt_pk_bf16_f32 v44, v88, v89
  v_mfma_f32_16x16x32_bf16 v[236:239], a[12:15], v[60:63], v[236:239]
  s_waitcnt lgkmcnt(7)
  v_exp_f32 v90, v90
  v_mfma_f32_16x16x32_bf16 v[176:179], a[16:19], v[52:55], v[176:179]
  ds_read_b128 a[60:63], v3 offset:7168
  v_mfma_f32_16x16x32_bf16 v[208:211], a[16:19], v[56:59], v[208:211]
  v_exp_f32 v91, v91
  v_mfma_f32_16x16x32_bf16 v[240:243], a[16:19], v[60:63], v[240:243]
  v_exp_f32 v92, v92
  v_mfma_f32_16x16x32_bf16 v[180:183], a[20:23], v[52:55], v[180:183]
  ds_read_b128 a[0:3], v3 offset:8192
  v_cvt_pk_bf16_f32 v45, v90, v91
  v_mfma_f32_16x16x32_bf16 v[212:215], a[20:23], v[56:59], v[212:215]
  v_exp_f32 v93, v93
  v_mfma_f32_16x16x32_bf16 v[244:247], a[20:23], v[60:63], v[244:247]
  v_cvt_pk_bf16_f32 v46, v92, v93
  v_mfma_f32_16x16x32_bf16 v[184:187], a[24:27], v[52:55], v[184:187]
  v_exp_f32 v94, v94
  v_mfma_f32_16x16x32_bf16 v[216:219], a[24:27], v[56:59], v[216:219]
  ds_read_b128 a[4:7], v3 offset:9216
  v_mfma_f32_16x16x32_bf16 v[248:251], a[24:27], v[60:63], v[248:251]
  v_exp_f32 v95, v95
  v_mfma_f32_16x16x32_bf16 v[188:191], a[28:31], v[52:55], v[188:191]
  ds_read_b128 a[8:11], v3 offset:10240
  v_cvt_pk_bf16_f32 v47, v94, v95
  v_mfma_f32_16x16x32_bf16 v[220:223], a[28:31], v[56:59], v[220:223]
  s_waitcnt vmcnt(8)
  s_barrier
  v_mfma_f32_16x16x32_bf16 v[252:255], a[28:31], v[60:63], v[252:255]
  s_lshl_b32 s4, s25, 20
  s_lshl_b32 s5, s24, 15
  s_add_u32 s4, s4, s5
  s_lshl_b32 s5, s3, 11
  s_add_u32 s4, s4, s5
  v_accvgpr_read_b32 v6, a192
  v_accvgpr_read_b32 v8, a196
  s_mov_b32 s5, 0x5f800000
  v_cmp_ngt_f32 vcc, s5, v6
  v_rcp_f32 v6, v6
  s_or_b32 s89, s89, vcc_lo
  s_or_b32 s89, s89, vcc_hi
  v_mov_b32 v7, v6
  v_cmp_ngt_f32 vcc, s5, v8
  v_rcp_f32 v8, v8
  s_or_b32 s89, s89, vcc_lo
  s_or_b32 s89, s89, vcc_hi
  v_mov_b32 v9, v8
  v_pk_mul_f32 v[128:129], v[128:129], v[6:7]
  v_pk_mul_f32 v[130:131], v[130:131], v[6:7]
  v_pk_mul_f32 v[132:133], v[132:133], v[6:7]
  v_pk_mul_f32 v[134:135], v[134:135], v[6:7]
  v_cvt_pk_bf16_f32 v128, v128, v129
  v_cvt_pk_bf16_f32 v129, v130, v131
  v_cvt_pk_bf16_f32 v130, v132, v133
  v_cvt_pk_bf16_f32 v131, v134, v135
  buffer_store_dwordx4 v[128:131], v2, s[16:19], s4 offen offset:0 sc1
  v_pk_mul_f32 v[160:161], v[160:161], v[8:9]
  v_pk_mul_f32 v[162:163], v[162:163], v[8:9]
  v_pk_mul_f32 v[164:165], v[164:165], v[8:9]
  v_pk_mul_f32 v[166:167], v[166:167], v[8:9]
  v_cvt_pk_bf16_f32 v160, v160, v161
  v_cvt_pk_bf16_f32 v161, v162, v163
  v_cvt_pk_bf16_f32 v162, v164, v165
  v_cvt_pk_bf16_f32 v163, v166, v167
  buffer_store_dwordx4 v[160:163], v2, s[16:19], s4 offen offset:1024 sc1
  s_add_u32 s4, s4, 8192
  v_pk_mul_f32 v[136:137], v[136:137], v[6:7]
  v_pk_mul_f32 v[138:139], v[138:139], v[6:7]
  v_pk_mul_f32 v[140:141], v[140:141], v[6:7]
  v_pk_mul_f32 v[142:143], v[142:143], v[6:7]
  v_cvt_pk_bf16_f32 v136, v136, v137
  v_cvt_pk_bf16_f32 v137, v138, v139
  v_cvt_pk_bf16_f32 v138, v140, v141
  v_cvt_pk_bf16_f32 v139, v142, v143
  buffer_store_dwordx4 v[136:139], v2, s[16:19], s4 offen offset:0 sc1
  v_pk_mul_f32 v[168:169], v[168:169], v[8:9]
  v_pk_mul_f32 v[170:171], v[170:171], v[8:9]
  v_pk_mul_f32 v[172:173], v[172:173], v[8:9]
  v_pk_mul_f32 v[174:175], v[174:175], v[8:9]
  v_cvt_pk_bf16_f32 v168, v168, v169
  v_cvt_pk_bf16_f32 v169, v170, v171
  v_cvt_pk_bf16_f32 v170, v172, v173
  v_cvt_pk_bf16_f32 v171, v174, v175
  buffer_store_dwordx4 v[168:171], v2, s[16:19], s4 offen offset:1024 sc1
  s_add_u32 s4, s4, 8192
  v_pk_mul_f32 v[144:145], v[144:145], v[6:7]
  v_pk_mul_f32 v[146:147], v[146:147], v[6:7]
  v_pk_mul_f32 v[148:149], v[148:149], v[6:7]
  v_pk_mul_f32 v[150:151], v[150:151], v[6:7]
  v_cvt_pk_bf16_f32 v144, v144, v145
  v_cvt_pk_bf16_f32 v145, v146, v147
  v_cvt_pk_bf16_f32 v146, v148, v149
  v_cvt_pk_bf16_f32 v147, v150, v151
  buffer_store_dwordx4 v[144:147], v2, s[16:19], s4 offen offset:0 sc1
  v_pk_mul_f32 v[176:177], v[176:177], v[8:9]
  v_pk_mul_f32 v[178:179], v[178:179], v[8:9]
  v_pk_mul_f32 v[180:181], v[180:181], v[8:9]
  v_pk_mul_f32 v[182:183], v[182:183], v[8:9]
  v_cvt_pk_bf16_f32 v176, v176, v177
  v_cvt_pk_bf16_f32 v177, v178, v179
  v_cvt_pk_bf16_f32 v178, v180, v181
  v_cvt_pk_bf16_f32 v179, v182, v183
  buffer_store_dwordx4 v[176:179], v2, s[16:19], s4 offen offset:1024 sc1
  s_add_u32 s4, s4, 8192
  v_pk_mul_f32 v[152:153], v[152:153], v[6:7]
  v_pk_mul_f32 v[154:155], v[154:155], v[6:7]
  v_pk_mul_f32 v[156:157], v[156:157], v[6:7]
  v_pk_mul_f32 v[158:159], v[158:159], v[6:7]
  v_cvt_pk_bf16_f32 v152, v152, v153
  v_cvt_pk_bf16_f32 v153, v154, v155
  v_cvt_pk_bf16_f32 v154, v156, v157
  v_cvt_pk_bf16_f32 v155, v158, v159
  buffer_store_dwordx4 v[152:155], v2, s[16:19], s4 offen offset:0 sc1
  v_pk_mul_f32 v[184:185], v[184:185], v[8:9]
  v_pk_mul_f32 v[186:187], v[186:187], v[8:9]
  v_pk_mul_f32 v[188:189], v[188:189], v[8:9]
  v_pk_mul_f32 v[190:191], v[190:191], v[8:9]
  v_cvt_pk_bf16_f32 v184, v184, v185
  v_cvt_pk_bf16_f32 v185, v186, v187
  v_cvt_pk_bf16_f32 v186, v188, v189
  v_cvt_pk_bf16_f32 v187, v190, v191
  buffer_store_dwordx4 v[184:187], v2, s[16:19], s4 offen offset:1024 sc1
  s_lshl_b32 s88, s25, 1
  s_sub_u32 s88, 14, s88
  .p2align 6
La_so:
  s_waitcnt lgkmcnt(3)
  v_mfma_f32_16x16x32_bf16 v[64:67], a[32:35], a[160:163], v[24:27]
  s_mov_b32 m0, s26
  v_exp_f32 v96, v96
  v_mfma_f32_16x16x32_bf16 v[64:67], a[36:39], a[164:167], v[64:67]
  buffer_load_dwordx4 v2, s[20:23], s28 offen offset:0 sc1 lds
  ds_read_b128 a[12:15], v3 offset:11264
  v_mfma_f32_16x16x32_bf16 v[64:67], a[40:43], a[168:171], v[64:67]
  v_exp_f32 v97, v97
  v_mfma_f32_16x16x32_bf16 v[64:67], a[44:47], a[172:175], v[64:67]
  ds_read_b128 a[16:19], v3 offset:12288
  v_cvt_pk_bf16_f32 v48, v96, v97
  v_mfma_f32_16x16x32_bf16 v[72:75], a[32:35], a[176:179], v[28:31]
  v_exp_f32 v98, v98
  v_mfma_f32_16x16x32_bf16 v[72:75], a[36:39], a[180:183], v[72:75]
  ds_read_b128 a[20:23], v3 offset:13312
  v_mfma_f32_16x16x32_bf16 v[72:75], a[40:43], a[184:187], v[72:75]
  v_exp_f32 v99, v99
  v_mfma_f32_16x16x32_bf16 v[72:75], a[44:47], a[188:191], v[72:75]
  ds_read_b128 a[24:27], v3 offset:14336
  v_cvt_pk_bf16_f32 v49, v98, v99
  v_mfma_f32_16x16x32_bf16 v[68:71], a[48:51], a[160:163], v[24:27]
  v_exp_f32 v100, v100
  v_mfma_f32_16x16x32_bf16 v[68:71], a[52:55], a[164:167], v[68:71]
  buffer_load_dwordx4 v2, s[20:23], s28 offen offset:1024 sc1 lds
  ds_read_b128 a[28:31], v3 offset:15360
  v_mfma_f32_16x16x32_bf16 v[68:71], a[56:59], a[168:171], v[68:71]
  v_exp_f32 v101, v101
  v_mfma_f32_16x16x32_bf16 v[68:71], a[60:63], a[172:175], v[68:71]
  ds_read_b128 a[32:35], v4 offset:0
  v_cvt_pk_bf16_f32 v50, v100, v101
  v_mfma_f32_16x16x32_bf16 v[76:79], a[48:51], a[176:179], v[28:31]
  v_exp_f32 v102, v102
  v_mfma_f32_16x16x32_bf16 v[76:79], a[52:55], a[180:183], v[76:79]
  ds_read_b128 a[36:39], v4 offset:1024
  v_mfma_f32_16x16x32_bf16 v[76:79], a[56:59], a[184:187], v[76:79]
  v_exp_f32 v103, v103
  v_mfma_f32_16x16x32_bf16 v[76:79], a[60:63], a[188:191], v[76:79]
  s_waitcnt lgkmcnt(2)
  ds_read_b128 a[40:43], v4 offset:2048
  v_cvt_pk_bf16_f32 v51, v102, v103
  v_mfma_f32_16x16x32_bf16 v[80:83], a[0:3], a[160:163], v[24:27]
  v_exp_f32 v104, v104
  v_mfma_f32_16x16x32_bf16 v[80:83], a[4:7], a[164:167], v[80:83]
  buffer_load_dwordx4 v2, s[20:23], s28 offen offset:2048 sc1 lds
  ds_read_b128 a[44:47], v4 offset:3072
  v_mfma_f32_16x16x32_bf16 v[80:83], a[8:11], a[168:171], v[80:83]
  v_exp_f32 v105, v105
  v_mfma_f32_16x16x32_bf16 v[80:83], a[12:15], a[172:175], v[80:83]
  ds_read_b128 a[48:51], v4 offset:4096
  v_cvt_pk_bf16_f32 v52, v104, v105
  v_mfma_f32_16x16x32_bf16 v[88:91], a[0:3], a[176:179], v[28:31]
  v_exp_f32 v106, v106
  v_mfma_f32_16x16x32_bf16 v[88:91], a[4:7], a[180:183], v[88:91]
  ds_read_b128 a[52:55], v4 offset:5120
  v_mfma_f32_16x16x32_bf16 v[88:91], a[8:11], a[184:187], v[88:91]
  v_exp_f32 v107, v107
  v_mfma_f32_16x16x32_bf16 v[88:91], a[12:15], a[188:191], v[88:91]
  ds_read_b128 a[56:59], v4 offset:6144
  v_cvt_pk_bf16_f32 v53, v106, v107
  v_mfma_f32_16x16x32_bf16 v[84:87], a[16:19], a[160:163], v[24:27]
  v_exp_f32 v108, v108
  v_mfma_f32_16x16x32_bf16 v[84:87], a[20:23], a[164:167], v[84:87]
  buffer_load_dwordx4 v2, s[20:23], s28 offen offset:3072 sc1 lds
  ds_read_b128 a[60:63], v4 offset:7168
  v_mfma_f32_16x16x32_bf16 v[84:87], a[24:27], a[168:171], v[84:87]
  s_xor_b32 s26, s26, 0x8000
  v_exp_f32 v109, v109
  v_mfma_f32_16x16x32_bf16 v[84:87], a[28:31], a[172:175], v[84:87]
  s_add_u32 s28, s28, 0x8000
  s_mov_b32 m0, s27
  ds_read_b128 a[0:3], v4 offset:8192
  v_mfma_f32_16x16x32_bf16 v[92:95], a[16:19], a[176:179], v[28:31]
  v_exp_f32 v110, v110
  v_mfma_f32_16x16x32_bf16 v[92:95], a[20:23], a[180:183], v[92:95]
  ds_read_b128 a[4:7], v4 offset:9216
  v_cvt_pk_bf16_f32 v54, v108, v109
  v_mfma_f32_16x16x32_bf16 v[92:95], a[24:27], a[184:187], v[92:95]
  v_exp_f32 v111, v111
  v_mfma_f32_16x16x32_bf16 v[92:95], a[28:31], a[188:191], v[92:95]
  s_waitcnt lgkmcnt(2)
  ds_read_b128 a[8:11], v4 offset:10240
  v_cvt_pk_bf16_f32 v55, v110, v111
  v_mfma_f32_16x16x32_bf16 v[192:195], a[32:35], v[32:35], v[192:195]
  buffer_load_dwordx4 v2, s[20:23], s29 offen offset:0 sc1 lds
  ds_read_b128 a[12:15], v4 offset:11264
  v_mfma_f32_16x16x32_bf16 v[224:227], a[32:35], v[36:39], v[224:227]
  v_exp_f32 v112, v112
  v_mfma_f32_16x16x32_bf16 a[200:203], a[208:211], v[32:35], a[200:203]
  s_sub_u32 s88, s88, 1
  v_mfma_f32_16x16x32_bf16 v[196:199], a[36:39], v[32:35], v[196:199]
  v_exp_f32 v113, v113
  v_mfma_f32_16x16x32_bf16 v[228:231], a[36:39], v[36:39], v[228:231]
  ds_read_b128 a[16:19], v4 offset:12288
  v_cvt_pk_bf16_f32 v56, v112, v113
  v_mfma_f32_16x16x32_bf16 a[204:207], a[208:211], v[36:39], a[204:207]
  v_exp_f32 v114, v114
  v_mfma_f32_16x16x32_bf16 v[200:203], a[40:43], v[32:35], v[200:203]
  ds_read_b128 a[20:23], v4 offset:13312
  v_mfma_f32_16x16x32_bf16 v[232:235], a[40:43], v[36:39], v[232:235]
  v_exp_f32 v115, v115
  v_mfma_f32_16x16x32_bf16 v[204:207], a[44:47], v[32:35], v[204:207]
  buffer_load_dwordx4 v2, s[20:23], s29 offen offset:1024 sc1 lds
  ds_read_b128 a[24:27], v4 offset:14336
  v_mfma_f32_16x16x32_bf16 v[236:239], a[44:47], v[36:39], v[236:239]
  v_exp_f32 v116, v116
  v_mfma_f32_16x16x32_bf16 v[208:211], a[48:51], v[32:35], v[208:211]
  ds_read_b128 a[28:31], v4 offset:15360
  v_xor_b32 v4, 0x4000, v4
  v_mfma_f32_16x16x32_bf16 v[240:243], a[48:51], v[36:39], v[240:243]
  v_exp_f32 v117, v117
  v_mfma_f32_16x16x32_bf16 v[212:215], a[52:55], v[32:35], v[212:215]
  v_xor_b32 v3, 0x4000, v3
  v_cvt_pk_bf16_f32 v57, v114, v115
  v_mfma_f32_16x16x32_bf16 v[244:247], a[52:55], v[36:39], v[244:247]
  v_exp_f32 v118, v118
  v_mfma_f32_16x16x32_bf16 v[216:219], a[56:59], v[32:35], v[216:219]
  ds_read_b128 a[32:35], v3 offset:0
  ds_read_b128 a[36:39], v3 offset:1024
  v_mfma_f32_16x16x32_bf16 v[248:251], a[56:59], v[36:39], v[248:251]
  v_exp_f32 v119, v119
  v_mfma_f32_16x16x32_bf16 v[220:223], a[60:63], v[32:35], v[220:223]
  buffer_load_dwordx4 v2, s[20:23], s29 offen offset:2048 sc1 lds
  ds_read_b128 a[40:43], v3 offset:2048
  v_mfma_f32_16x16x32_bf16 v[252:255], a[60:63], v[36:39], v[252:255]
  s_waitcnt lgkmcnt(3)
  v_exp_f32 v120, v120
  v_mfma_f32_16x16x32_bf16 v[192:195], a[0:3], v[40:43], v[192:195]
  ds_read_b128 a[44:47], v3 offset:3072
  v_cvt_pk_bf16_f32 v58, v116, v117
  v_mfma_f32_16x16x32_bf16 v[224:227], a[0:3], v[44:47], v[224:227]
  v_exp_f32 v121, v121
  v_mfma_f32_16x16x32_bf16 a[200:203], a[208:211], v[40:43], a[200:203]
  v_cvt_pk_bf16_f32 v59, v118, v119
  v_cvt_pk_bf16_f32 v60, v120, v121
  v_mfma_f32_16x16x32_bf16 v[196:199], a[4:7], v[40:43], v[196:199]
  v_exp_f32 v122, v122
  v_mfma_f32_16x16x32_bf16 v[228:231], a[4:7], v[44:47], v[228:231]
  ds_read_b128 a[48:51], v3 offset:4096
  v_mfma_f32_16x16x32_bf16 a[204:207], a[208:211], v[44:47], a[204:207]
  v_exp_f32 v123, v123
  v_mfma_f32_16x16x32_bf16 v[200:203], a[8:11], v[40:43], v[200:203]
  buffer_load_dwordx4 v2, s[20:23], s29 offen offset:3072 sc1 lds
  ds_read_b128 a[52:55], v3 offset:5120
  v_mfma_f32_16x16x32_bf16 v[232:235], a[8:11], v[44:47], v[232:235]
  s_xor_b32 s27, s27, 0x8000
  v_exp_f32 v124, v124
  v_mfma_f32_16x16x32_bf16 v[204:207], a[12:15], v[40:43], v[204:207]
  s_add_u32 s29, s29, 0x8000
  ds_read_b128 a[56:59], v3 offset:6144
  v_cvt_pk_bf16_f32 v61, v122, v123
  v_mfma_f32_16x16x32_bf16 v[236:239], a[12:15], v[44:47], v[236:239]
  v_exp_f32 v125, v125
  v_mfma_f32_16x16x32_bf16 v[208:211], a[16:19], v[40:43], v[208:211]
  ds_read_b128 a[60:63], v3 offset:7168
  v_cvt_pk_bf16_f32 v62, v124, v125
  v_mfma_f32_16x16x32_bf16 v[240:243], a[16:19], v[44:47], v[240:243]
  v_exp_f32 v126, v126
  v_mfma_f32_16x16x32_bf16 v[212:215], a[20:23], v[40:43], v[212:215]
  ds_read_b128 a[0:3], v3 offset:8192
  v_mfma_f32_16x16x32_bf16 v[244:247], a[20:23], v[44:47], v[244:247]
  v_exp_f32 v127, v127
  v_mfma_f32_16x16x32_bf16 v[216:219], a[24:27], v[40:43], v[216:219]
  ds_read_b128 a[4:7], v3 offset:9216
  v_cvt_pk_bf16_f32 v63, v126, v127
  v_mfma_f32_16x16x32_bf16 v[248:251], a[24:27], v[44:47], v[248:251]
  v_mfma_f32_16x16x32_bf16 v[220:223], a[28:31], v[40:43], v[220:223]
  s_waitcnt vmcnt(8)
  s_barrier
  v_mfma_f32_16x16x32_bf16 v[252:255], a[28:31], v[44:47], v[252:255]
  ds_read_b128 a[8:11], v3 offset:10240
  s_cmp_eq_u32 s88, 0
  s_cbranch_scc1 La_e0
  s_waitcnt lgkmcnt(3)
  v_mfma_f32_16x16x32_bf16 v[96:99], a[32:35], a[160:163], v[24:27]
  s_mov_b32 m0, s26
  v_exp_f32 v64, v64
  v_mfma_f32_16x16x32_bf16 v[96:99], a[36:39], a[164:167], v[96:99]
  buffer_load_dwordx4 v2, s[20:23], s28 offen offset:0 sc1 lds
  ds_read_b128 a[12:15], v3 offset:11264
  v_mfma_f32_16x16x32_bf16 v[96:99], a[40:43], a[168:171], v[96:99]
  v_exp_f32 v65, v65
  v_mfma_f32_16x16x32_bf16 v[96:99], a[44:47], a[172:175], v[96:99]
  ds_read_b128 a[16:19], v3 offset:12288
  v_cvt_pk_bf16_f32 v32, v64, v65
  v_mfma_f32_16x16x32_bf16 v[104:107], a[32:35], a[176:179], v[28:31]
  v_exp_f32 v66, v66
  v_mfma_f32_16x16x32_bf16 v[104:107], a[36:39], a[180:183], v[104:107]
  ds_read_b128 a[20:23], v3 offset:13312
  v_mfma_f32_16x16x32_bf16 v[104:107], a[40:43], a[184:187], v[104:107]
  v_exp_f32 v67, v67
  v_mfma_f32_16x16x32_bf16 v[104:107], a[44:47], a[188:191], v[104:107]
  ds_read_b128 a[24:27], v3 offset:14336
  v_cvt_pk_bf16_f32 v33, v66, v67
  v_mfma_f32_16x16x32_bf16 v[100:103], a[48:51], a[160:163], v[24:27]
  v_exp_f32 v68, v68
  v_mfma_f32_16x16x32_bf16 v[100:103], a[52:55], a[164:167], v[100:103]
  buffer_load_dwordx4 v2, s[20:23], s28 offen offset:1024 sc1 lds
  ds_read_b128 a[28:31], v3 offset:15360
  v_mfma_f32_16x16x32_bf16 v[100:103], a[56:59], a[168:171], v[100:103]
  v_exp_f32 v69, v69
  v_mfma_f32_16x16x32_bf16 v[100:103], a[60:63], a[172:175], v[100:103]
  ds_read_b128 a[32:35], v4 offset:0
  v_cvt_pk_bf16_f32 v34, v68, v69
  v_mfma_f32_16x16x32_bf16 v[108:111], a[48:51], a[176:179], v[28:31]
  v_exp_f32 v70, v70
  v_mfma_f32_16x16x32_bf16 v[108:111], a[52:55], a[180:183], v[108:111]
  ds_read_b128 a[36:39], v4 offset:1024
  v_mfma_f32_16x16x32_bf16 v[108:111], a[56:59], a[184:187], v[108:111]
  v_exp_f32 v71, v71
  v_mfma_f32_16x16x32_bf16 v[108:111], a[60:63], a[188:191], v[108:111]
  s_waitcnt lgkmcnt(2)
  ds_read_b128 a[40:43], v4 offset:2048
  v_cvt_pk_bf16_f32 v35, v70, v71
  v_mfma_f32_16x16x32_bf16 v[112:115], a[0:3], a[160:163], v[24:27]
  v_exp_f32 v72, v72
  v_mfma_f32_16x16x32_bf16 v[112:115], a[4:7], a[164:167], v[112:115]
  buffer_load_dwordx4 v2, s[20:23], s28 offen offset:2048 sc1 lds
  ds_read_b128 a[44:47], v4 offset:3072
  v_mfma_f32_16x16x32_bf16 v[112:115], a[8:11], a[168:171], v[112:115]
  v_exp_f32 v73, v73
  v_mfma_f32_16x16x32_bf16 v[112:115], a[12:15], a[172:175], v[112:115]
  ds_read_b128 a[48:51], v4 offset:4096
  v_cvt_pk_bf16_f32 v36, v72, v73
  v_mfma_f32_16x16x32_bf16 v[120:123], a[0:3], a[176:179], v[28:31]
  v_exp_f32 v74, v74
  v_mfma_f32_16x16x32_bf16 v[120:123], a[4:7], a[180:183], v[120:123]
  ds_read_b128 a[52:55], v4 offset:5120
  v_mfma_f32_16x16x32_bf16 v[120:123], a[8:11], a[184:187], v[120:123]
  v_exp_f32 v75, v75
  v_mfma_f32_16x16x32_bf16 v[120:123], a[12:15], a[188:191], v[120:123]
  ds_read_b128 a[56:59], v4 offset:6144
  v_cvt_pk_bf16_f32 v37, v74, v75
  v_mfma_f32_16x16x32_bf16 v[116:119], a[16:19], a[160:163], v[24:27]
  v_exp_f32 v76, v76
  v_mfma_f32_16x16x32_bf16 v[116:119], a[20:23], a[164:167], v[116:119]
  buffer_load_dwordx4 v2, s[20:23], s28 offen offset:3072 sc1 lds
  ds_read_b128 a[60:63], v4 offset:7168
  v_mfma_f32_16x16x32_bf16 v[116:119], a[24:27], a[168:171], v[116:119]
  s_xor_b32 s26, s26, 0x4000
  v_exp_f32 v77, v77
  v_mfma_f32_16x16x32_bf16 v[116:119], a[28:31], a[172:175], v[116:119]
  s_add_u32 s28, s28, 0x8000
  s_mov_b32 m0, s27
  ds_read_b128 a[0:3], v4 offset:8192
  v_mfma_f32_16x16x32_bf16 v[124:127], a[16:19], a[176:179], v[28:31]
  v_exp_f32 v78, v78
  v_mfma_f32_16x16x32_bf16 v[124:127], a[20:23], a[180:183], v[124:127]
  ds_read_b128 a[4:7], v4 offset:9216
  v_cvt_pk_bf16_f32 v38, v76, v77
  v_mfma_f32_16x16x32_bf16 v[124:127], a[24:27], a[184:187], v[124:127]
  v_exp_f32 v79, v79
  v_mfma_f32_16x16x32_bf16 v[124:127], a[28:31], a[188:191], v[124:127]
  s_waitcnt lgkmcnt(2)
  ds_read_b128 a[8:11], v4 offset:10240
  v_cvt_pk_bf16_f32 v39, v78, v79
  v_mfma_f32_16x16x32_bf16 v[192:195], a[32:35], v[48:51], v[192:195]
  buffer_load_dwordx4 v2, s[20:23], s29 offen offset:0 sc1 lds
  ds_read_b128 a[12:15], v4 offset:11264
  v_mfma_f32_16x16x32_bf16 v[224:227], a[32:35], v[52:55], v[224:227]
  v_exp_f32 v80, v80
  v_mfma_f32_16x16x32_bf16 a[200:203], a[208:211], v[48:51], a[200:203]
  v_mfma_f32_16x16x32_bf16 v[196:199], a[36:39], v[48:51], v[196:199]
  v_exp_f32 v81, v81
  v_mfma_f32_16x16x32_bf16 v[228:231], a[36:39], v[52:55], v[228:231]
  ds_read_b128 a[16:19], v4 offset:12288
  v_cvt_pk_bf16_f32 v40, v80, v81
  v_mfma_f32_16x16x32_bf16 a[204:207], a[208:211], v[52:55], a[204:207]
  v_exp_f32 v82, v82
  v_mfma_f32_16x16x32_bf16 v[200:203], a[40:43], v[48:51], v[200:203]
  ds_read_b128 a[20:23], v4 offset:13312
  v_mfma_f32_16x16x32_bf16 v[232:235], a[40:43], v[52:55], v[232:235]
  v_exp_f32 v83, v83
  v_mfma_f32_16x16x32_bf16 v[204:207], a[44:47], v[48:51], v[204:207]
  buffer_load_dwordx4 v2, s[20:23], s29 offen offset:1024 sc1 lds
  ds_read_b128 a[24:27], v4 offset:14336
  v_mfma_f32_16x16x32_bf16 v[236:239], a[44:47], v[52:55], v[236:239]
  v_exp_f32 v84, v84
  v_mfma_f32_16x16x32_bf16 v[208:211], a[48:51], v[48:51], v[208:211]
  ds_read_b128 a[28:31], v4 offset:15360
  v_xor_b32 v4, 0x8000, v4
  v_mfma_f32_16x16x32_bf16 v[240:243], a[48:51], v[52:55], v[240:243]
  v_exp_f32 v85, v85
  v_mfma_f32_16x16x32_bf16 v[212:215], a[52:55], v[48:51], v[212:215]
  v_xor_b32 v3, 0x8000, v3
  v_cvt_pk_bf16_f32 v41, v82, v83
  v_mfma_f32_16x16x32_bf16 v[244:247], a[52:55], v[52:55], v[244:247]
  v_exp_f32 v86, v86
  v_mfma_f32_16x16x32_bf16 v[216:219], a[56:59], v[48:51], v[216:219]
  ds_read_b128 a[32:35], v3 offset:0
  ds_read_b128 a[36:39], v3 offset:1024
  v_mfma_f32_16x16x32_bf16 v[248:251], a[56:59], v[52:55], v[248:251]
  v_exp_f32 v87, v87
  v_mfma_f32_16x16x32_bf16 v[220:223], a[60:63], v[48:51], v[220:223]
  buffer_load_dwordx4 v2, s[20:23], s29 offen offset:2048 sc1 lds
  ds_read_b128 a[40:43], v3 offset:2048
  v_mfma_f32_16x16x32_bf16 v[252:255], a[60:63], v[52:55], v[252:255]
  s_waitcnt lgkmcnt(3)
  v_exp_f32 v88, v88
  v_mfma_f32_16x16x32_bf16 v[192:195], a[0:3], v[56:59], v[192:195]
  ds_read_b128 a[44:47], v3 offset:3072
  v_cvt_pk_bf16_f32 v42, v84, v85
  v_mfma_f32_16x16x32_bf16 v[224:227], a[0:3], v[60:63], v[224:227]
  v_exp_f32 v89, v89
  v_mfma_f32_16x16x32_bf16 a[200:203], a[208:211], v[56:59], a[200:203]
  v_cvt_pk_bf16_f32 v43, v86, v87
  v_cvt_pk_bf16_f32 v44, v88, v89
  v_mfma_f32_16x16x32_bf16 v[196:199], a[4:7], v[56:59], v[196:199]
  v_exp_f32 v90, v90
  v_mfma_f32_16x16x32_bf16 v[228:231], a[4:7], v[60:63], v[228:231]
  ds_read_b128 a[48:51], v3 offset:4096
  v_mfma_f32_16x16x32_bf16 a[204:207], a[208:211], v[60:63], a[204:207]
  v_exp_f32 v91, v91
  v_mfma_f32_16x16x32_bf16 v[200:203], a[8:11], v[56:59], v[200:203]
  buffer_load_dwordx4 v2, s[20:23], s29 offen offset:3072 sc1 lds
  ds_read_b128 a[52:55], v3 offset:5120
  v_mfma_f32_16x16x32_bf16 v[232:235], a[8:11], v[60:63], v[232:235]
  s_xor_b32 s27, s27, 0x4000
  v_exp_f32 v92, v92
  v_mfma_f32_16x16x32_bf16 v[204:207], a[12:15], v[56:59], v[204:207]
  s_add_u32 s29, s29, 0x8000
  ds_read_b128 a[56:59], v3 offset:6144
  v_cvt_pk_bf16_f32 v45, v90, v91
  v_mfma_f32_16x16x32_bf16 v[236:239], a[12:15], v[60:63], v[236:239]
  v_exp_f32 v93, v93
  v_mfma_f32_16x16x32_bf16 v[208:211], a[16:19], v[56:59], v[208:211]
  ds_read_b128 a[60:63], v3 offset:7168
  v_cvt_pk_bf16_f32 v46, v92, v93
  v_mfma_f32_16x16x32_bf16 v[240:243], a[16:19], v[60:63], v[240:243]
  v_exp_f32 v94, v94
  v_mfma_f32_16x16x32_bf16 v[212:215], a[20:23], v[56:59], v[212:215]
  ds_read_b128 a[0:3], v3 offset:8192
  v_mfma_f32_16x16x32_bf16 v[244:247], a[20:23], v[60:63], v[244:247]
  v_exp_f32 v95, v95
  v_mfma_f32_16x16x32_bf16 v[216:219], a[24:27], v[56:59], v[216:219]
  ds_read_b128 a[4:7], v3 offset:9216
  v_cvt_pk_bf16_f32 v47, v94, v95
  v_mfma_f32_16x16x32_bf16 v[248:251], a[24:27], v[60:63], v[248:251]
  v_mfma_f32_16x16x32_bf16 v[220:223], a[28:31], v[56:59], v[220:223]
  s_waitcnt vmcnt(12)
  s_barrier
  v_mfma_f32_16x16x32_bf16 v[252:255], a[28:31], v[60:63], v[252:255]
  ds_read_b128 a[8:11], v3 offset:10240
  s_branch La_so
La_t7:
  s_waitcnt lgkmcnt(7)
  v_mfma_f32_16x16x32_bf16 v[104:107], a[0:3], a[176:179], v[28:31]
  buffer_load_dwordx2 v[12:13], v14, s[96:99], s91 offen sc1
  ds_read_b128 a[44:47], v3 offset:11264
  v_mfma_f32_16x16x32_bf16 v[104:107], a[4:7], a[180:183], v[104:107]
  v_cndmask_b32 v64, v64, v5, s[32:33]
  v_exp_f32 v64, v64
  v_mfma_f32_16x16x32_bf16 v[104:107], a[8:11], a[184:187], v[104:107]
  v_cndmask_b32 v65, v65, v5, s[34:35]
  v_exp_f32 v65, v65
  v_mfma_f32_16x16x32_bf16 v[104:107], a[12:15], a[188:191], v[104:107]
  s_waitcnt lgkmcnt(4)
  v_cndmask_b32 v66, v66, v5, s[36:37]
  v_exp_f32 v66, v66
  v_mfma_f32_16x16x32_bf16 v[108:111], a[16:19], a[176:179], v[28:31]
  v_cndmask_b32 v67, v67, v5, s[38:39]
  v_exp_f32 v67, v67
  v_mfma_f32_16x16x32_bf16 v[108:111], a[20:23], a[180:183], v[108:111]
  v_cndmask_b32 v68, v68, v5, s[40:41]
  v_exp_f32 v68, v68
  v_mfma_f32_16x16x32_bf16 v[108:111], a[24:27], a[184:187], v[108:111]
  v_cndmask_b32 v69, v69, v5, s[42:43]
  v_exp_f32 v69, v69
  v_mfma_f32_16x16x32_bf16 v[108:111], a[28:31], a[188:191], v[108:111]
  s_waitcnt lgkmcnt(0)
  v_cndmask_b32 v70, v70, v5, s[44:45]
  v_exp_f32 v70, v70
  v_mfma_f32_16x16x32_bf16 v[120:123], a[32:35], a[176:179], v[28:31]
  v_cndmask_b32 v71, v71, v5, s[46:47]
  v_exp_f32 v71, v71
  v_mfma_f32_16x16x32_bf16 v[120:123], a[36:39], a[180:183], v[120:123]
  ds_read_b128 a[48:51], v3 offset:12288
  ds_read_b128 a[52:55], v3 offset:13312
  ds_read_b128 a[56:59], v3 offset:14336
  v_mfma_f32_16x16x32_bf16 v[120:123], a[40:43], a[184:187], v[120:123]
  ds_read_b128 a[60:63], v3 offset:15360
  v_exp_f32 v72, v72
  v_mfma_f32_16x16x32_bf16 v[120:123], a[44:47], a[188:191], v[120:123]
  s_waitcnt lgkmcnt(0)
  v_exp_f32 v73, v73
  v_cvt_pk_bf16_f32 v33, v66, v67
  v_mfma_f32_16x16x32_bf16 v[124:127], a[48:51], a[176:179], v[28:31]
  v_exp_f32 v74, v74
  v_cvt_pk_bf16_f32 v34, v68, v69
  v_mfma_f32_16x16x32_bf16 v[124:127], a[52:55], a[180:183], v[124:127]
  ds_read_b128 a[0:3], v4 offset:8192
  ds_read_b128 a[4:7], v4 offset:9216
  ds_read_b128 a[8:11], v4 offset:10240
  v_mfma_f32_16x16x32_bf16 v[124:127], a[56:59], a[184:187], v[124:127]
  ds_read_b128 a[12:15], v4 offset:11264
  v_exp_f32 v75, v75
  v_mfma_f32_16x16x32_bf16 v[124:127], a[60:63], a[188:191], v[124:127]
  s_waitcnt lgkmcnt(0)
  v_exp_f32 v76, v76
  v_cvt_pk_bf16_f32 v35, v70, v71
  v_mfma_f32_16x16x32_bf16 v[160:163], a[0:3], v[52:55], v[160:163]
  v_exp_f32 v77, v77
  v_cvt_pk_bf16_f32 v36, v72, v73
  v_mfma_f32_16x16x32_bf16 v[192:195], a[0:3], v[56:59], v[192:195]
  v_exp_f32 v78, v78
  v_cvt_pk_bf16_f32 v37, v74, v75
  v_mfma_f32_16x16x32_bf16 v[224:227], a[0:3], v[60:63], v[224:227]
  ds_read_b128 a[16:19], v4 offset:12288
  ds_read_b128 a[20:23], v4 offset:13312
  v_cvt_pk_bf16_f32 v38, v76, v77
  v_mfma_f32_16x16x32_bf16 a[196:199], a[208:211], v[52:55], a[196:199]
  v_exp_f32 v79, v79
  v_mfma_f32_16x16x32_bf16 v[164:167], a[4:7], v[52:55], v[164:167]
  v_cndmask_b32 v80, v80, v5, s[48:49]
  v_exp_f32 v80, v80
  v_cvt_pk_bf16_f32 v39, v78, v79
  v_mfma_f32_16x16x32_bf16 v[196:199], a[4:7], v[56:59], v[196:199]
  v_cndmask_b32 v81, v81, v5, s[50:51]
  v_exp_f32 v81, v81
  v_mfma_f32_16x16x32_bf16 v[228:231], a[4:7], v[60:63], v[228:231]
  ds_read_b128 a[24:27], v4 offset:14336
  ds_read_b128 a[28:31], v4 offset:15360
  v_cvt_pk_bf16_f32 v40, v80, v81
  v_mfma_f32_16x16x32_bf16 a[200:203], a[208:211], v[56:59], a[200:203]
  v_cndmask_b32 v82, v82, v5, s[52:53]
  v_exp_f32 v82, v82
  v_mfma_f32_16x16x32_bf16 v[168:171], a[8:11], v[52:55], v[168:171]
  v_cndmask_b32 v83, v83, v5, s[54:55]
  v_exp_f32 v83, v83
  v_mfma_f32_16x16x32_bf16 v[200:203], a[8:11], v[56:59], v[200:203]
  v_cndmask_b32 v84, v84, v5, s[56:57]
  v_exp_f32 v84, v84
  v_mfma_f32_16x16x32_bf16 v[232:235], a[8:11], v[60:63], v[232:235]
  v_cndmask_b32 v85, v85, v5, s[58:59]
  v_exp_f32 v85, v85
  v_mfma_f32_16x16x32_bf16 a[204:207], a[208:211], v[60:63], a[204:207]
  v_xor_b32 v4, 0x8000, v4
  v_cvt_pk_bf16_f32 v32, v64, v65
  v_cvt_pk_bf16_f32 v41, v82, v83
  v_mfma_f32_16x16x32_bf16 v[172:175], a[12:15], v[52:55], v[172:175]
  v_cndmask_b32 v86, v86, v5, s[60:61]
  v_exp_f32 v86, v86
  v_mfma_f32_16x16x32_bf16 v[204:207], a[12:15], v[56:59], v[204:207]
  v_cndmask_b32 v87, v87, v5, s[62:63]
  v_exp_f32 v87, v87
  v_mfma_f32_16x16x32_bf16 v[236:239], a[12:15], v[60:63], v[236:239]
  s_waitcnt lgkmcnt(0)
  v_exp_f32 v88, v88
  v_cvt_pk_bf16_f32 v42, v84, v85
  v_mfma_f32_16x16x32_bf16 v[176:179], a[16:19], v[52:55], v[176:179]
  ds_read_b128 a[32:35], v4 offset:0
  ds_read_b128 a[36:39], v4 offset:1024
  v_cvt_pk_bf16_f32 v43, v86, v87
  v_mfma_f32_16x16x32_bf16 v[208:211], a[16:19], v[56:59], v[208:211]
  v_exp_f32 v89, v89
  v_mfma_f32_16x16x32_bf16 v[240:243], a[16:19], v[60:63], v[240:243]
  v_exp_f32 v90, v90
  v_cvt_pk_bf16_f32 v44, v88, v89
  v_mfma_f32_16x16x32_bf16 v[180:183], a[20:23], v[52:55], v[180:183]
  v_exp_f32 v91, v91
  v_mfma_f32_16x16x32_bf16 v[212:215], a[20:23], v[56:59], v[212:215]
  v_exp_f32 v92, v92
  v_cvt_pk_bf16_f32 v45, v90, v91
  v_mfma_f32_16x16x32_bf16 v[244:247], a[20:23], v[60:63], v[244:247]
  ds_read_b128 a[40:43], v4 offset:2048
  ds_read_b128 a[44:47], v4 offset:3072
  v_mfma_f32_16x16x32_bf16 v[184:187], a[24:27], v[52:55], v[184:187]
  v_exp_f32 v93, v93
  v_mfma_f32_16x16x32_bf16 v[216:219], a[24:27], v[56:59], v[216:219]
  v_exp_f32 v94, v94
  v_cvt_pk_bf16_f32 v46, v92, v93
  v_mfma_f32_16x16x32_bf16 v[248:251], a[24:27], v[60:63], v[248:251]
  v_exp_f32 v95, v95
  v_mfma_f32_16x16x32_bf16 v[188:191], a[28:31], v[52:55], v[188:191]
  ds_read_b128 a[48:51], v4 offset:4096
  ds_read_b128 a[52:55], v4 offset:5120
  v_cvt_pk_bf16_f32 v47, v94, v95
  v_mfma_f32_16x16x32_bf16 v[220:223], a[28:31], v[56:59], v[220:223]
  s_waitcnt vmcnt(0)
  s_barrier
  v_mfma_f32_16x16x32_bf16 v[252:255], a[28:31], v[60:63], v[252:255]
  ds_read_b128 a[56:59], v4 offset:6144
  ds_read_b128 a[60:63], v4 offset:7168
  ds_read_b128 a[0:3], v4 offset:8192
  ds_read_b128 a[4:7], v4 offset:9216
  ds_read_b128 a[8:11], v4 offset:10240
  s_lshl_b32 s4, s25, 20
  s_lshl_b32 s5, s24, 15
  s_add_u32 s4, s4, s5
  s_lshl_b32 s5, s3, 11
  s_add_u32 s4, s4, s5
  v_accvgpr_read_b32 v6, a192
  v_accvgpr_read_b32 v8, a196
  s_mov_b32 s5, 0x5f800000
  v_cmp_ngt_f32 vcc, s5, v6
  v_rcp_f32 v6, v6
  s_or_b32 s89, s89, vcc_lo
  s_or_b32 s89, s89, vcc_hi
  v_mov_b32 v7, v6
  v_cmp_ngt_f32 vcc, s5, v8
  v_rcp_f32 v8, v8
  s_or_b32 s89, s89, vcc_lo
  s_or_b32 s89, s89, vcc_hi
  v_mov_b32 v9, v8
  v_pk_mul_f32 v[128:129], v[128:129], v[6:7]
  v_pk_mul_f32 v[130:131], v[130:131], v[6:7]
  v_pk_mul_f32 v[132:133], v[132:133], v[6:7]
  v_pk_mul_f32 v[134:135], v[134:135], v[6:7]
  v_cvt_pk_bf16_f32 v128, v128, v129
  v_cvt_pk_bf16_f32 v129, v130, v131
  v_cvt_pk_bf16_f32 v130, v132, v133
  v_cvt_pk_bf16_f32 v131, v134, v135
  buffer_store_dwordx4 v[128:131], v2, s[16:19], s4 offen offset:0 sc1
  v_pk_mul_f32 v[160:161], v[160:161], v[8:9]
  v_pk_mul_f32 v[162:163], v[162:163], v[8:9]
  v_pk_mul_f32 v[164:165], v[164:165], v[8:9]
  v_pk_mul_f32 v[166:167], v[166:167], v[8:9]
  v_cvt_pk_bf16_f32 v160, v160, v161
  v_cvt_pk_bf16_f32 v161, v162, v163
  v_cvt_pk_bf16_f32 v162, v164, v165
  v_cvt_pk_bf16_f32 v163, v166, v167
  buffer_store_dwordx4 v[160:163], v2, s[16:19], s4 offen offset:1024 sc1
  s_add_u32 s4, s4, 8192
  v_pk_mul_f32 v[136:137], v[136:137], v[6:7]
  v_pk_mul_f32 v[138:139], v[138:139], v[6:7]
  v_pk_mul_f32 v[140:141], v[140:141], v[6:7]
  v_pk_mul_f32 v[142:143], v[142:143], v[6:7]
  v_cvt_pk_bf16_f32 v136, v136, v137
  v_cvt_pk_bf16_f32 v137, v138, v139
  v_cvt_pk_bf16_f32 v138, v140, v141
  v_cvt_pk_bf16_f32 v139, v142, v143
  buffer_store_dwordx4 v[136:139], v2, s[16:19], s4 offen offset:0 sc1
  v_pk_mul_f32 v[168:169], v[168:169], v[8:9]
  v_pk_mul_f32 v[170:171], v[170:171], v[8:9]
  v_pk_mul_f32 v[172:173], v[172:173], v[8:9]
  v_pk_mul_f32 v[174:175], v[174:175], v[8:9]
  v_cvt_pk_bf16_f32 v168, v168, v169
  v_cvt_pk_bf16_f32 v169, v170, v171
  v_cvt_pk_bf16_f32 v170, v172, v173
  v_cvt_pk_bf16_f32 v171, v174, v175
  buffer_store_dwordx4 v[168:171], v2, s[16:19], s4 offen offset:1024 sc1
  s_add_u32 s4, s4, 8192
  v_pk_mul_f32 v[144:145], v[144:145], v[6:7]
  v_pk_mul_f32 v[146:147], v[146:147], v[6:7]
  v_pk_mul_f32 v[148:149], v[148:149], v[6:7]
  v_pk_mul_f32 v[150:151], v[150:151], v[6:7]
  v_cvt_pk_bf16_f32 v144, v144, v145
  v_cvt_pk_bf16_f32 v145, v146, v147
  v_cvt_pk_bf16_f32 v146, v148, v149
  v_cvt_pk_bf16_f32 v147, v150, v151
  buffer_store_dwordx4 v[144:147], v2, s[16:19], s4 offen offset:0 sc1
  v_pk_mul_f32 v[176:177], v[176:177], v[8:9]
  v_pk_mul_f32 v[178:179], v[178:179], v[8:9]
  v_pk_mul_f32 v[180:181], v[180:181], v[8:9]
  v_pk_mul_f32 v[182:183], v[182:183], v[8:9]
  v_cvt_pk_bf16_f32 v176, v176, v177
  v_cvt_pk_bf16_f32 v177, v178, v179
  v_cvt_pk_bf16_f32 v178, v180, v181
  v_cvt_pk_bf16_f32 v179, v182, v183
  buffer_store_dwordx4 v[176:179], v2, s[16:19], s4 offen offset:1024 sc1
  s_add_u32 s4, s4, 8192
  v_pk_mul_f32 v[152:153], v[152:153], v[6:7]
  v_pk_mul_f32 v[154:155], v[154:155], v[6:7]
  v_pk_mul_f32 v[156:157], v[156:157], v[6:7]
  v_pk_mul_f32 v[158:159], v[158:159], v[6:7]
  v_cvt_pk_bf16_f32 v152, v152, v153
  v_cvt_pk_bf16_f32 v153, v154, v155
  v_cvt_pk_bf16_f32 v154, v156, v157
  v_cvt_pk_bf16_f32 v155, v158, v159
  buffer_store_dwordx4 v[152:155], v2, s[16:19], s4 offen offset:0 sc1
  v_pk_mul_f32 v[184:185], v[184:185], v[8:9]
  v_pk_mul_f32 v[186:187], v[186:187], v[8:9]
  v_pk_mul_f32 v[188:189], v[188:189], v[8:9]
  v_pk_mul_f32 v[190:191], v[190:191], v[8:9]
  v_cvt_pk_bf16_f32 v184, v184, v185
  v_cvt_pk_bf16_f32 v185, v186, v187
  v_cvt_pk_bf16_f32 v186, v188, v189
  v_cvt_pk_bf16_f32 v187, v190, v191
  buffer_store_dwordx4 v[184:187], v2, s[16:19], s4 offen offset:1024 sc1
  s_branch La_e1
La_e0:
  s_waitcnt lgkmcnt(7)
  v_mfma_f32_16x16x32_bf16 v[104:107], a[32:35], a[176:179], v[28:31]
  buffer_load_dwordx2 v[12:13], v14, s[96:99], s91 offen sc1
  ds_read_b128 a[12:15], v3 offset:11264
  v_mfma_f32_16x16x32_bf16 v[104:107], a[36:39], a[180:183], v[104:107]
  v_cndmask_b32 v64, v64, v5, s[32:33]
  v_exp_f32 v64, v64
  v_mfma_f32_16x16x32_bf16 v[104:107], a[40:43], a[184:187], v[104:107]
  v_cndmask_b32 v65, v65, v5, s[34:35]
  v_exp_f32 v65, v65
  v_mfma_f32_16x16x32_bf16 v[104:107], a[44:47], a[188:191], v[104:107]
  s_waitcnt lgkmcnt(4)
  v_cndmask_b32 v66, v66, v5, s[36:37]
  v_exp_f32 v66, v66
  v_mfma_f32_16x16x32_bf16 v[108:111], a[48:51], a[176:179], v[28:31]
  v_cndmask_b32 v67, v67, v5, s[38:39]
  v_exp_f32 v67, v67
  v_mfma_f32_16x16x32_bf16 v[108:111], a[52:55], a[180:183], v[108:111]
  ds_read_b128 a[16:19], v3 offset:12288
  ds_read_b128 a[20:23], v3 offset:13312
  v_mfma_f32_16x16x32_bf16 v[108:111], a[56:59], a[184:187], v[108:111]
  v_cndmask_b32 v68, v68, v5, s[40:41]
  v_exp_f32 v68, v68
  v_mfma_f32_16x16x32_bf16 v[108:111], a[60:63], a[188:191], v[108:111]
  s_waitcnt lgkmcnt(2)
  v_cndmask_b32 v69, v69, v5, s[42:43]
  v_exp_f32 v69, v69
  v_mfma_f32_16x16x32_bf16 v[120:123], a[0:3], a[176:179], v[28:31]
  ds_read_b128 a[24:27], v3 offset:14336
  ds_read_b128 a[28:31], v3 offset:15360
  v_mfma_f32_16x16x32_bf16 v[120:123], a[4:7], a[180:183], v[120:123]
  v_cndmask_b32 v70, v70, v5, s[44:45]
  v_exp_f32 v70, v70
  v_mfma_f32_16x16x32_bf16 v[120:123], a[8:11], a[184:187], v[120:123]
  v_cndmask_b32 v71, v71, v5, s[46:47]
  v_exp_f32 v71, v71
  v_mfma_f32_16x16x32_bf16 v[120:123], a[12:15], a[188:191], v[120:123]
  s_waitcnt lgkmcnt(0)
  ds_read_b128 a[32:35], v4 offset:0
  ds_read_b128 a[36:39], v4 offset:1024
  v_mfma_f32_16x16x32_bf16 v[124:127], a[16:19], a[176:179], v[28:31]
  v_exp_f32 v72, v72
  v_mfma_f32_16x16x32_bf16 v[124:127], a[20:23], a[180:183], v[124:127]
  ds_read_b128 a[40:43], v4 offset:2048
  ds_read_b128 a[44:47], v4 offset:3072
  ds_read_b128 a[48:51], v4 offset:4096
  v_mfma_f32_16x16x32_bf16 v[124:127], a[24:27], a[184:187], v[124:127]
  ds_read_b128 a[52:55], v4 offset:5120
  ds_read_b128 a[56:59], v4 offset:6144
  ds_read_b128 a[60:63], v4 offset:7168
  v_exp_f32 v73, v73
  v_mfma_f32_16x16x32_bf16 v[124:127], a[28:31], a[188:191], v[124:127]
  s_waitcnt lgkmcnt(0)
  v_exp_f32 v74, v74
  v_mfma_f32_16x16x32_bf16 v[192:195], a[32:35], v[48:51], v[192:195]
  ds_read_b128 a[0:3], v4 offset:8192
  ds_read_b128 a[4:7], v4 offset:9216
  v_mfma_f32_16x16x32_bf16 v[224:227], a[32:35], v[52:55], v[224:227]
  v_exp_f32 v75, v75
  v_mfma_f32_16x16x32_bf16 a[200:203], a[208:211], v[48:51], a[200:203]
  v_exp_f32 v76, v76
  v_mfma_f32_16x16x32_bf16 v[196:199], a[36:39], v[48:51], v[196:199]
  ds_read_b128 a[8:11], v4 offset:10240
  ds_read_b128 a[12:15], v4 offset:11264
  v_mfma_f32_16x16x32_bf16 v[228:231], a[36:39], v[52:55], v[228:231]
  v_exp_f32 v77, v77
  v_mfma_f32_16x16x32_bf16 a[204:207], a[208:211], v[52:55], a[204:207]
  v_exp_f32 v78, v78
  v_mfma_f32_16x16x32_bf16 v[200:203], a[40:43], v[48:51], v[200:203]
  ds_read_b128 a[16:19], v4 offset:12288
  ds_read_b128 a[20:23], v4 offset:13312
  v_mfma_f32_16x16x32_bf16 v[232:235], a[40:43], v[52:55], v[232:235]
  v_exp_f32 v79, v79
  v_mfma_f32_16x16x32_bf16 v[204:207], a[44:47], v[48:51], v[204:207]
  ds_read_b128 a[24:27], v4 offset:14336
  v_cvt_pk_bf16_f32 v32, v64, v65
  v_mfma_f32_16x16x32_bf16 v[236:239], a[44:47], v[52:55], v[236:239]
  v_cndmask_b32 v80, v80, v5, s[48:49]
  v_exp_f32 v80, v80
  v_mfma_f32_16x16x32_bf16 v[208:211], a[48:51], v[48:51], v[208:211]
  v_cndmask_b32 v81, v81, v5, s[50:51]
  v_exp_f32 v81, v81
  v_mfma_f32_16x16x32_bf16 v[240:243], a[48:51], v[52:55], v[240:243]
  ds_read_b128 a[28:31], v4 offset:15360
  v_xor_b32 v4, 0x8000, v4
  v_cvt_pk_bf16_f32 v40, v80, v81
  v_mfma_f32_16x16x32_bf16 v[212:215], a[52:55], v[48:51], v[212:215]
  v_cndmask_b32 v82, v82, v5, s[52:53]
  v_exp_f32 v82, v82
  v_mfma_f32_16x16x32_bf16 v[244:247], a[52:55], v[52:55], v[244:247]
  v_cndmask_b32 v83, v83, v5, s[54:55]
  v_exp_f32 v83, v83
  v_mfma_f32_16x16x32_bf16 v[216:219], a[56:59], v[48:51], v[216:219]
  ds_read_b128 a[32:35], v4 offset:0
  ds_read_b128 a[36:39], v4 offset:1024
  v_cvt_pk_bf16_f32 v41, v82, v83
  v_mfma_f32_16x16x32_bf16 v[248:251], a[56:59], v[52:55], v[248:251]
  v_cndmask_b32 v84, v84, v5, s[56:57]
  v_exp_f32 v84, v84
  v_mfma_f32_16x16x32_bf16 v[220:223], a[60:63], v[48:51], v[220:223]
  v_cndmask_b32 v85, v85, v5, s[58:59]
  v_exp_f32 v85, v85
  v_mfma_f32_16x16x32_bf16 v[252:255], a[60:63], v[52:55], v[252:255]
  s_waitcnt lgkmcnt(2)
  ds_read_b128 a[40:43], v4 offset:2048
  v_cvt_pk_bf16_f32 v33, v66, v67
  v_cvt_pk_bf16_f32 v42, v84, v85
  v_mfma_f32_16x16x32_bf16 v[192:195], a[0:3], v[56:59], v[192:195]
  v_cndmask_b32 v86, v86, v5, s[60:61]
  v_exp_f32 v86, v86
  v_mfma_f32_16x16x32_bf16 v[224:227], a[0:3], v[60:63], v[224:227]
  v_cndmask_b32 v87, v87, v5, s[62:63]
  v_exp_f32 v87, v87
  v_mfma_f32_16x16x32_bf16 a[200:203], a[208:211], v[56:59], a[200:203]
  ds_read_b128 a[44:47], v4 offset:3072
  v_cvt_pk_bf16_f32 v34, v68, v69
  v_cvt_pk_bf16_f32 v43, v86, v87
  v_mfma_f32_16x16x32_bf16 v[196:199], a[4:7], v[56:59], v[196:199]
  v_exp_f32 v88, v88
  v_mfma_f32_16x16x32_bf16 v[228:231], a[4:7], v[60:63], v[228:231]
  ds_read_b128 a[48:51], v4 offset:4096
  v_cvt_pk_bf16_f32 v35, v70, v71
  v_mfma_f32_16x16x32_bf16 a[204:207], a[208:211], v[60:63], a[204:207]
  v_exp_f32 v89, v89
  v_mfma_f32_16x16x32_bf16 v[200:203], a[8:11], v[56:59], v[200:203]
  v_exp_f32 v90, v90
  v_cvt_pk_bf16_f32 v44, v88, v89
  v_mfma_f32_16x16x32_bf16 v[232:235], a[8:11], v[60:63], v[232:235]
  ds_read_b128 a[52:55], v4 offset:5120
  v_cvt_pk_bf16_f32 v36, v72, v73
  v_mfma_f32_16x16x32_bf16 v[204:207], a[12:15], v[56:59], v[204:207]
  v_exp_f32 v91, v91
  v_mfma_f32_16x16x32_bf16 v[236:239], a[12:15], v[60:63], v[236:239]
  v_exp_f32 v92, v92
  v_cvt_pk_bf16_f32 v45, v90, v91
  v_mfma_f32_16x16x32_bf16 v[208:211], a[16:19], v[56:59], v[208:211]
  ds_read_b128 a[56:59], v4 offset:6144
  ds_read_b128 a[60:63], v4 offset:7168
  v_mfma_f32_16x16x32_bf16 v[240:243], a[16:19], v[60:63], v[240:243]
  v_exp_f32 v93, v93
  v_mfma_f32_16x16x32_bf16 v[212:215], a[20:23], v[56:59], v[212:215]
  v_exp_f32 v94, v94
  v_cvt_pk_bf16_f32 v46, v92, v93
  v_mfma_f32_16x16x32_bf16 v[244:247], a[20:23], v[60:63], v[244:247]
  ds_read_b128 a[0:3], v4 offset:8192
  v_cvt_pk_bf16_f32 v37, v74, v75
  v_mfma_f32_16x16x32_bf16 v[216:219], a[24:27], v[56:59], v[216:219]
  v_exp_f32 v95, v95
  v_mfma_f32_16x16x32_bf16 v[248:251], a[24:27], v[60:63], v[248:251]
  ds_read_b128 a[4:7], v4 offset:9216
  v_cvt_pk_bf16_f32 v38, v76, v77
  v_cvt_pk_bf16_f32 v47, v94, v95
  v_mfma_f32_16x16x32_bf16 v[220:223], a[28:31], v[56:59], v[220:223]
  s_waitcnt vmcnt(0)
  s_barrier
  v_mfma_f32_16x16x32_bf16 v[252:255], a[28:31], v[60:63], v[252:255]
  ds_read_b128 a[8:11], v4 offset:10240
  v_cvt_pk_bf16_f32 v39, v78, v79
La_e1:
  s_mov_b32 s5, 0x40000
Lpoll_7:
  v_cmp_ne_u64 vcc, s[94:95], v[12:13]
  s_nop 0
  s_cbranch_vccz Lpolld_8
  s_sleep 4
  buffer_load_dwordx2 v[12:13], v14, s[96:99], s91 offen sc1
  s_sub_u32 s5, s5, 1
  s_waitcnt vmcnt(0)
  s_cbranch_scc0 Lpoll_7
Lpolld_8:
  v_accvgpr_read_b32 v10, a212
  v_accvgpr_read_b32 v11, a213
  v_accvgpr_read_b32 v12, a214
  v_accvgpr_read_b32 v13, a215
  s_mov_b32 s12, s80
  s_mov_b32 s13, s81
  s_mov_b32 s14, 2097152
  s_mov_b32 s15, 0x00020000
  s_lshl_b32 s93, s77, 20
  s_lshl_b32 s72, s76, 8
  s_add_u32 s93, s93, s72
  s_add_u32 s72, s73, s76
  s_and_b32 s31, s72, 3
  s_lshl_b32 s31, s31, 3
  s_or_b32 s31, s31, 0x80000
  s_bfe_u32 s30, 0x70702, s31
  s_add_u32 s30, s30, 0
  s_and_b32 s30, s30, 7
  s_lshl_b32 s72, s30, 17
  s_add_u32 s71, s93, s72
  s_add_u32 s8, s86, 83886080
  s_addc_u32 s9, s87, 0
  s_mov_b32 s10, 4194304
  s_mov_b32 s11, 0x00020000
  s_lshl_b32 s92, s73, 1
  s_add_u32 s92, s92, s77
  s_lshl_b32 s92, s92, 17
  s_add_u32 s92, s92, s79
  s_add_u32 s72, s73, s76
  s_and_b32 s1, s72, 3
  s_lshl_b32 s1, s1, 3
  s_or_b32 s1, s1, 0x80000
  s_bfe_u32 s0, 0x70702, s1
  s_add_u32 s0, s0, 0
  s_and_b32 s0, s0, 7
  s_lshl_b32 s72, s0, 14
  s_add_u32 s70, s92, s72
  s_waitcnt lgkmcnt(3)
  v_mfma_f32_16x16x32_bf16 v[192:195], a[32:35], v[32:35], v[192:195]
  s_add_u32 m0, s79, 147456
  ds_read_b128 a[12:15], v4 offset:11264
  v_cndmask_b32 v104, v104, v5, s[32:33]
  v_mfma_f32_16x16x32_bf16 v[224:227], a[32:35], v[36:39], v[224:227]
  v_exp_f32 v104, v104
  v_mfma_f32_16x16x32_bf16 a[200:203], a[208:211], v[32:35], a[200:203]
  v_cndmask_b32 v105, v105, v5, s[34:35]
  v_exp_f32 v105, v105
  v_mfma_f32_16x16x32_bf16 v[196:199], a[36:39], v[32:35], v[196:199]
  buffer_load_dwordx4 v10, s[12:15], s71 offen offset:0 lds
  ds_read_b128 a[16:19], v4 offset:12288
  v_mfma_f32_16x16x32_bf16 v[228:231], a[36:39], v[36:39], v[228:231]
  v_cndmask_b32 v106, v106, v5, s[36:37]
  v_exp_f32 v106, v106
  v_mfma_f32_16x16x32_bf16 a[204:207], a[208:211], v[36:39], a[204:207]
  buffer_load_dwordx4 v11, s[12:15], s71 offen offset:1024 lds
  v_cndmask_b32 v107, v107, v5, s[38:39]
  v_mfma_f32_16x16x32_bf16 v[200:203], a[40:43], v[32:35], v[200:203]
  v_exp_f32 v107, v107
  v_mfma_f32_16x16x32_bf16 v[232:235], a[40:43], v[36:39], v[232:235]
  ds_read_b128 a[20:23], v4 offset:13312
  v_cndmask_b32 v108, v108, v5, s[40:41]
  v_mfma_f32_16x16x32_bf16 v[204:207], a[44:47], v[32:35], v[204:207]
  v_exp_f32 v108, v108
  v_mfma_f32_16x16x32_bf16 v[236:239], a[44:47], v[36:39], v[236:239]
  buffer_load_dwordx4 v12, s[12:15], s71 offen offset:2048 lds
  ds_read_b128 a[24:27], v4 offset:14336
  v_mfma_f32_16x16x32_bf16 v[208:211], a[48:51], v[32:35], v[208:211]
  v_cndmask_b32 v109, v109, v5, s[42:43]
  v_exp_f32 v109, v109
  v_mfma_f32_16x16x32_bf16 v[240:243], a[48:51], v[36:39], v[240:243]
  ds_read_b128 a[28:31], v4 offset:15360
  v_xor_b32 v4, 0x4000, v4
  v_mfma_f32_16x16x32_bf16 v[212:215], a[52:55], v[32:35], v[212:215]
  v_cndmask_b32 v110, v110, v5, s[44:45]
  v_exp_f32 v110, v110
  v_mfma_f32_16x16x32_bf16 v[244:247], a[52:55], v[36:39], v[244:247]
  buffer_load_dwordx4 v13, s[12:15], s71 offen offset:3072 lds
  ds_read_b128 a[32:35], v4 offset:0
  v_mfma_f32_16x16x32_bf16 v[216:219], a[56:59], v[32:35], v[216:219]
  s_bfe_u32 s72, 0x3020106, s31
  v_cndmask_b32 v111, v111, v5, s[46:47]
  v_exp_f32 v111, v111
  v_mfma_f32_16x16x32_bf16 v[248:251], a[56:59], v[36:39], v[248:251]
  s_add_u32 s30, s30, s72
  s_add_u32 s31, s31, 8
  s_and_b32 s31, s31, 0x8001f
  v_mfma_f32_16x16x32_bf16 v[220:223], a[60:63], v[32:35], v[220:223]
  s_and_b32 s30, s30, 7
  s_lshl_b32 s72, s30, 17
  s_add_u32 s71, s93, s72
  v_mfma_f32_16x16x32_bf16 v[252:255], a[60:63], v[36:39], v[252:255]
  s_waitcnt lgkmcnt(1)
  v_cndmask_b32 v120, v120, v5, s[48:49]
  v_exp_f32 v120, v120
  v_mfma_f32_16x16x32_bf16 v[192:195], a[0:3], v[40:43], v[192:195]
  s_add_u32 m0, s79, 131072
  ds_read_b128 a[36:39], v4 offset:1024
  ds_read_b128 a[40:43], v4 offset:2048
  v_mfma_f32_16x16x32_bf16 v[224:227], a[0:3], v[44:47], v[224:227]
  v_cndmask_b32 v121, v121, v5, s[50:51]
  v_exp_f32 v121, v121
  v_mfma_f32_16x16x32_bf16 a[200:203], a[208:211], v[40:43], a[200:203]
  buffer_load_dwordx4 v2, s[8:11], s70 offen offset:0 sc1 lds
  ds_read_b128 a[44:47], v4 offset:3072
  v_mfma_f32_16x16x32_bf16 v[196:199], a[4:7], v[40:43], v[196:199]
  v_cndmask_b32 v122, v122, v5, s[52:53]
  v_exp_f32 v122, v122
  v_mfma_f32_16x16x32_bf16 v[228:231], a[4:7], v[44:47], v[228:231]
  buffer_load_dwordx4 v2, s[8:11], s70 offen offset:1024 sc1 lds
  ds_read_b128 a[48:51], v4 offset:4096
  v_mfma_f32_16x16x32_bf16 a[204:207], a[208:211], v[44:47], a[204:207]
  v_cndmask_b32 v123, v123, v5, s[54:55]
  v_exp_f32 v123, v123
  v_mfma_f32_16x16x32_bf16 v[200:203], a[8:11], v[40:43], v[200:203]
  buffer_load_dwordx4 v2, s[8:11], s70 offen offset:2048 sc1 lds
  ds_read_b128 a[52:55], v4 offset:5120
  v_cvt_pk_bf16_f32 v61, v122, v123
  v_mfma_f32_16x16x32_bf16 v[232:235], a[8:11], v[44:47], v[232:235]
  v_cndmask_b32 v124, v124, v5, s[56:57]
  v_exp_f32 v124, v124
  v_mfma_f32_16x16x32_bf16 v[204:207], a[12:15], v[40:43], v[204:207]
  ds_read_b128 a[56:59], v4 offset:6144
  v_cvt_pk_bf16_f32 v52, v104, v105
  v_mfma_f32_16x16x32_bf16 v[236:239], a[12:15], v[44:47], v[236:239]
  v_cndmask_b32 v125, v125, v5, s[58:59]
  v_exp_f32 v125, v125
  v_mfma_f32_16x16x32_bf16 v[208:211], a[16:19], v[40:43], v[208:211]
  buffer_load_dwordx4 v2, s[8:11], s70 offen offset:3072 sc1 lds
  ds_read_b128 a[60:63], v4 offset:7168
  v_cvt_pk_bf16_f32 v62, v124, v125
  v_mfma_f32_16x16x32_bf16 v[240:243], a[16:19], v[44:47], v[240:243]
  s_bfe_u32 s72, 0x3020106, s1
  v_cndmask_b32 v126, v126, v5, s[60:61]
  v_exp_f32 v126, v126
  v_mfma_f32_16x16x32_bf16 v[212:215], a[20:23], v[40:43], v[212:215]
  s_add_u32 s0, s0, s72
  s_add_u32 s1, s1, 8
  s_and_b32 s1, s1, 0x8001f
  v_mfma_f32_16x16x32_bf16 v[244:247], a[20:23], v[44:47], v[244:247]
  s_and_b32 s0, s0, 7
  v_cndmask_b32 v127, v127, v5, s[62:63]
  v_exp_f32 v127, v127
  v_mfma_f32_16x16x32_bf16 v[216:219], a[24:27], v[40:43], v[216:219]
  s_lshl_b32 s72, s0, 14
  s_add_u32 s70, s92, s72
  ds_read_b128 a[0:3], v4 offset:8192
  v_cvt_pk_bf16_f32 v63, v126, v127
  v_mfma_f32_16x16x32_bf16 v[248:251], a[24:27], v[44:47], v[248:251]
  ds_read_b128 a[4:7], v4 offset:9216
  v_cvt_pk_bf16_f32 v53, v106, v107
  v_mfma_f32_16x16x32_bf16 v[220:223], a[28:31], v[40:43], v[220:223]
  ds_read_b128 a[8:11], v4 offset:10240
  v_cvt_pk_bf16_f32 v54, v108, v109
  v_mfma_f32_16x16x32_bf16 v[252:255], a[28:31], v[44:47], v[252:255]
  v_cvt_pk_bf16_f32 v55, v110, v111
  v_cvt_pk_bf16_f32 v60, v120, v121
  s_waitcnt lgkmcnt(7)
  v_mfma_f32_16x16x32_bf16 v[224:227], a[32:35], v[52:55], v[224:227]
  s_add_u32 m0, s79, 49152
  ds_read_b128 a[12:15], v4 offset:11264
  v_mfma_f32_16x16x32_bf16 a[204:207], a[208:211], v[52:55], a[204:207]
  buffer_load_dwordx4 v10, s[12:15], s71 offen offset:0 lds
  v_mfma_f32_16x16x32_bf16 v[228:231], a[36:39], v[52:55], v[228:231]
  buffer_load_dwordx4 v11, s[12:15], s71 offen offset:1024 lds
  ds_read_b128 a[16:19], v4 offset:12288
  v_mfma_f32_16x16x32_bf16 v[232:235], a[40:43], v[52:55], v[232:235]
  buffer_load_dwordx4 v12, s[12:15], s71 offen offset:2048 lds
  ds_read_b128 a[20:23], v4 offset:13312
  v_mfma_f32_16x16x32_bf16 v[236:239], a[44:47], v[52:55], v[236:239]
  s_waitcnt lgkmcnt(6)
  ds_read_b128 a[24:27], v4 offset:14336
  v_mfma_f32_16x16x32_bf16 v[240:243], a[48:51], v[52:55], v[240:243]
  buffer_load_dwordx4 v13, s[12:15], s71 offen offset:3072 lds
  ds_read_b128 a[28:31], v4 offset:15360
  v_mfma_f32_16x16x32_bf16 v[244:247], a[52:55], v[52:55], v[244:247]
  s_bfe_u32 s72, 0x3020106, s31
  s_add_u32 s30, s30, s72
  s_add_u32 s31, s31, 8
  v_mfma_f32_16x16x32_bf16 v[248:251], a[56:59], v[52:55], v[248:251]
  s_and_b32 s31, s31, 0x8001f
  s_and_b32 s30, s30, 7
  s_lshl_b32 s72, s30, 17
  v_mfma_f32_16x16x32_bf16 v[252:255], a[60:63], v[52:55], v[252:255]
  s_waitcnt lgkmcnt(4)
  s_add_u32 s71, s93, s72
  s_add_u32 m0, s79, 32768
  v_mfma_f32_16x16x32_bf16 v[224:227], a[0:3], v[60:63], v[224:227]
  buffer_load_dwordx4 v2, s[8:11], s70 offen offset:0 sc1 lds
  v_mfma_f32_16x16x32_bf16 a[204:207], a[208:211], v[60:63], a[204:207]
  buffer_load_dwordx4 v2, s[8:11], s70 offen offset:1024 sc1 lds
  v_mfma_f32_16x16x32_bf16 v[228:231], a[4:7], v[60:63], v[228:231]
  buffer_load_dwordx4 v2, s[8:11], s70 offen offset:2048 sc1 lds
  v_mfma_f32_16x16x32_bf16 v[232:235], a[8:11], v[60:63], v[232:235]
  buffer_load_dwordx4 v2, s[8:11], s70 offen offset:3072 sc1 lds
  v_mfma_f32_16x16x32_bf16 v[236:239], a[12:15], v[60:63], v[236:239]
  s_waitcnt lgkmcnt(0)
  s_bfe_u32 s72, 0x3020106, s1
  s_add_u32 s0, s0, s72
  v_mfma_f32_16x16x32_bf16 v[240:243], a[16:19], v[60:63], v[240:243]
  s_add_u32 s1, s1, 8
  s_and_b32 s1, s1, 0x8001f
  s_and_b32 s0, s0, 7
  v_mfma_f32_16x16x32_bf16 v[244:247], a[20:23], v[60:63], v[244:247]
  s_lshl_b32 s72, s0, 14
  s_add_u32 s70, s92, s72
  v_mfma_f32_16x16x32_bf16 v[248:251], a[24:27], v[60:63], v[248:251]
  v_mfma_f32_16x16x32_bf16 v[252:255], a[28:31], v[60:63], v[252:255]
  s_sub_u32 s88, 15, s25
  s_lshl_b32 s4, s88, 20
  s_lshl_b32 s5, s24, 15
  s_add_u32 s4, s4, s5
  s_lshl_b32 s5, s3, 11
  s_add_u32 s4, s4, s5
  v_accvgpr_read_b32 v6, a200
  v_accvgpr_read_b32 v8, a204
  s_mov_b32 s5, 0x5f800000
  v_cmp_ngt_f32 vcc, s5, v6
  v_rcp_f32 v6, v6
  s_or_b32 s89, s89, vcc_lo
  s_or_b32 s89, s89, vcc_hi
  v_mov_b32 v7, v6
  v_cmp_ngt_f32 vcc, s5, v8
  v_rcp_f32 v8, v8
  s_or_b32 s89, s89, vcc_lo
  s_or_b32 s89, s89, vcc_hi
  v_mov_b32 v9, v8
  v_pk_mul_f32 v[192:193], v[192:193], v[6:7]
  v_pk_mul_f32 v[194:195], v[194:195], v[6:7]
  v_pk_mul_f32 v[196:197], v[196:197], v[6:7]
  v_pk_mul_f32 v[198:199], v[198:199], v[6:7]
  v_cvt_pk_bf16_f32 v192, v192, v193
  v_cvt_pk_bf16_f32 v193, v194, v195
  v_cvt_pk_bf16_f32 v194, v196, v197
  v_cvt_pk_bf16_f32 v195, v198, v199
  buffer_store_dwordx4 v[192:195], v2, s[16:19], s4 offen offset:0 sc1
  v_pk_mul_f32 v[224:225], v[224:225], v[8:9]
  v_pk_mul_f32 v[226:227], v[226:227], v[8:9]
  v_pk_mul_f32 v[228:229], v[228:229], v[8:9]
  v_pk_mul_f32 v[230:231], v[230:231], v[8:9]
  v_cvt_pk_bf16_f32 v224, v224, v225
  v_cvt_pk_bf16_f32 v225, v226, v227
  v_cvt_pk_bf16_f32 v226, v228, v229
  v_cvt_pk_bf16_f32 v227, v230, v231
  buffer_store_dwordx4 v[224:227], v2, s[16:19], s4 offen offset:1024 sc1
  s_add_u32 s4, s4, 8192
  v_pk_mul_f32 v[200:201], v[200:201], v[6:7]
  v_pk_mul_f32 v[202:203], v[202:203], v[6:7]
  v_pk_mul_f32 v[204:205], v[204:205], v[6:7]
  v_pk_mul_f32 v[206:207], v[206:207], v[6:7]
  v_cvt_pk_bf16_f32 v200, v200, v201
  v_cvt_pk_bf16_f32 v201, v202, v203
  v_cvt_pk_bf16_f32 v202, v204, v205
  v_cvt_pk_bf16_f32 v203, v206, v207
  buffer_store_dwordx4 v[200:203], v2, s[16:19], s4 offen offset:0 sc1
  v_pk_mul_f32 v[232:233], v[232:233], v[8:9]
  v_pk_mul_f32 v[234:235], v[234:235], v[8:9]
  v_pk_mul_f32 v[236:237], v[236:237], v[8:9]
  v_pk_mul_f32 v[238:239], v[238:239], v[8:9]
  v_cvt_pk_bf16_f32 v232, v232, v233
  v_cvt_pk_bf16_f32 v233, v234, v235
  v_cvt_pk_bf16_f32 v234, v236, v237
  v_cvt_pk_bf16_f32 v235, v238, v239
  buffer_store_dwordx4 v[232:235], v2, s[16:19], s4 offen offset:1024 sc1
  s_add_u32 s4, s4, 8192
  v_pk_mul_f32 v[208:209], v[208:209], v[6:7]
  v_pk_mul_f32 v[210:211], v[210:211], v[6:7]
  v_pk_mul_f32 v[212:213], v[212:213], v[6:7]
  v_pk_mul_f32 v[214:215], v[214:215], v[6:7]
  v_cvt_pk_bf16_f32 v208, v208, v209
  v_cvt_pk_bf16_f32 v209, v210, v211
  v_cvt_pk_bf16_f32 v210, v212, v213
  v_cvt_pk_bf16_f32 v211, v214, v215
  buffer_store_dwordx4 v[208:211], v2, s[16:19], s4 offen offset:0 sc1
  v_pk_mul_f32 v[240:241], v[240:241], v[8:9]
  v_pk_mul_f32 v[242:243], v[242:243], v[8:9]
  v_pk_mul_f32 v[244:245], v[244:245], v[8:9]
  v_pk_mul_f32 v[246:247], v[246:247], v[8:9]
  v_cvt_pk_bf16_f32 v240, v240, v241
  v_cvt_pk_bf16_f32 v241, v242, v243
  v_cvt_pk_bf16_f32 v242, v244, v245
  v_cvt_pk_bf16_f32 v243, v246, v247
  buffer_store_dwordx4 v[240:243], v2, s[16:19], s4 offen offset:1024 sc1
  s_add_u32 s4, s4, 8192
  v_pk_mul_f32 v[216:217], v[216:217], v[6:7]
  v_pk_mul_f32 v[218:219], v[218:219], v[6:7]
  v_pk_mul_f32 v[220:221], v[220:221], v[6:7]
  v_pk_mul_f32 v[222:223], v[222:223], v[6:7]
  v_cvt_pk_bf16_f32 v216, v216, v217
  v_cvt_pk_bf16_f32 v217, v218, v219
  v_cvt_pk_bf16_f32 v218, v220, v221
  v_cvt_pk_bf16_f32 v219, v222, v223
  buffer_store_dwordx4 v[216:219], v2, s[16:19], s4 offen offset:0 sc1
  v_pk_mul_f32 v[248:249], v[248:249], v[8:9]
  v_pk_mul_f32 v[250:251], v[250:251], v[8:9]
  v_pk_mul_f32 v[252:253], v[252:253], v[8:9]
  v_pk_mul_f32 v[254:255], v[254:255], v[8:9]
  v_cvt_pk_bf16_f32 v248, v248, v249
  v_cvt_pk_bf16_f32 v249, v250, v251
  v_cvt_pk_bf16_f32 v250, v252, v253
  v_cvt_pk_bf16_f32 v251, v254, v255
  buffer_store_dwordx4 v[248:251], v2, s[16:19], s4 offen offset:1024 sc1
  s_cmp_eq_u32 s89, 0
  s_cbranch_scc1 La_done
  s_waitcnt vmcnt(0)
  s_sub_u32 s6, 15, s25
La_sl_blk:
  v_mov_b32 v192, 0
  v_mov_b32 v193, 0
  v_mov_b32 v194, 0
  v_mov_b32 v195, 0
  v_mov_b32 v196, 0
  v_mov_b32 v197, 0
  v_mov_b32 v198, 0
  v_mov_b32 v199, 0
  v_mov_b32 v200, 0
  v_mov_b32 v201, 0
  v_mov_b32 v202, 0
  v_mov_b32 v203, 0
  v_mov_b32 v204, 0
  v_mov_b32 v205, 0
  v_mov_b32 v206, 0
  v_mov_b32 v207, 0
  v_mov_b32 v208, 0
  v_mov_b32 v209, 0
  v_mov_b32 v210, 0
  v_mov_b32 v211, 0
  v_mov_b32 v212, 0
  v_mov_b32 v213, 0
  v_mov_b32 v214, 0
  v_mov_b32 v215, 0
  v_mov_b32 v216, 0
  v_mov_b32 v217, 0
  v_mov_b32 v218, 0
  v_mov_b32 v219, 0
  v_mov_b32 v220, 0
  v_mov_b32 v221, 0
  v_mov_b32 v222, 0
  v_mov_b32 v223, 0
  v_mov_b32 v224, 0
  v_mov_b32 v225, 0
  v_mov_b32 v226, 0
  v_mov_b32 v227, 0
  v_mov_b32 v228, 0
  v_mov_b32 v229, 0
  v_mov_b32 v230, 0
  v_mov_b32 v231, 0
  v_mov_b32 v232, 0
  v_mov_b32 v233, 0
  v_mov_b32 v234, 0
  v_mov_b32 v235, 0
  v_mov_b32 v236, 0
  v_mov_b32 v237, 0
  v_mov_b32 v238, 0
  v_mov_b32 v239, 0
  v_mov_b32 v240, 0
  v_mov_b32 v241, 0
  v_mov_b32 v242, 0
  v_mov_b32 v243, 0
  v_mov_b32 v244, 0
  v_mov_b32 v245, 0
  v_mov_b32 v246, 0
  v_mov_b32 v247, 0
  v_mov_b32 v248, 0
  v_mov_b32 v249, 0
  v_mov_b32 v250, 0
  v_mov_b32 v251, 0
  v_mov_b32 v252, 0
  v_mov_b32 v253, 0
  v_mov_b32 v254, 0
  v_mov_b32 v255, 0
  v_mov_b32 v24, 0
  v_mov_b32 v25, 0
  v_mov_b32 v26, 0
  v_mov_b32 v27, 0
  v_mov_b32 v28, 0
  v_mov_b32 v29, 0
  v_mov_b32 v30, 0
  v_mov_b32 v31, 0
  v_mov_b32 v16, v5
  v_mov_b32 v17, v5
  v_and_b32 v20, 15, v1
  v_lshrrev_b32 v21, 4, v1
  v_sub_u32 v20, v20, v21
  v_lshlrev_b32 v20, 2, v20
  s_lshl_b32 s4, s6, 7
  s_add_u32 s4, s4, s3
  v_add_u32 v20, s4, v20
  v_add_u32 v21, 64, v20
  s_add_u32 s7, s6, 1
  s_lshl_b32 s7, s7, 2
  s_mov_b32 s90, 0
La_sl_loop:
  s_add_u32 s4, s90, 0
  buffer_load_dwordx4 a[0:3], v2, s[20:23], s4 offen offset:0 sc1
  buffer_load_dwordx4 a[4:7], v2, s[20:23], s4 offen offset:1024 sc1
  buffer_load_dwordx4 a[8:11], v2, s[20:23], s4 offen offset:2048 sc1
  buffer_load_dwordx4 a[12:15], v2, s[20:23], s4 offen offset:3072 sc1
  s_add_u32 s4, s90, 4096
  buffer_load_dwordx4 a[16:19], v2, s[20:23], s4 offen offset:0 sc1
  buffer_load_dwordx4 a[20:23], v2, s[20:23], s4 offen offset:1024 sc1
  buffer_load_dwordx4 a[24:27], v2, s[20:23], s4 offen offset:2048 sc1
  buffer_load_dwordx4 a[28:31], v2, s[20:23], s4 offen offset:3072 sc1
  s_add_u32 s4, s90, 16384
  buffer_load_dwordx4 a[32:35], v2, s[20:23], s4 offen offset:0 sc1
  buffer_load_dwordx4 a[36:39], v2, s[20:23], s4 offen offset:1024 sc1
  buffer_load_dwordx4 a[40:43], v2, s[20:23], s4 offen offset:2048 sc1
  buffer_load_dwordx4 a[44:47], v2, s[20:23], s4 offen offset:3072 sc1
  s_add_u32 s4, s90, 20480
  buffer_load_dwordx4 a[48:51], v2, s[20:23], s4 offen offset:0 sc1
  buffer_load_dwordx4 a[52:55], v2, s[20:23], s4 offen offset:1024 sc1
  buffer_load_dwordx4 a[56:59], v2, s[20:23], s4 offen offset:2048 sc1
  buffer_load_dwordx4 a[60:63], v2, s[20:23], s4 offen offset:3072 sc1
  s_waitcnt vmcnt(0)
  v_mfma_f32_16x16x32_bf16 v[64:67], a[0:3], a[160:163], 0
  v_mfma_f32_16x16x32_bf16 v[72:75], a[0:3], a[176:179], 0
  v_mfma_f32_16x16x32_bf16 v[64:67], a[4:7], a[164:167], v[64:67]
  v_mfma_f32_16x16x32_bf16 v[72:75], a[4:7], a[180:183], v[72:75]
  v_mfma_f32_16x16x32_bf16 v[64:67], a[8:11], a[168:171], v[64:67]
  v_mfma_f32_16x16x32_bf16 v[72:75], a[8:11], a[184:187], v[72:75]
  v_mfma_f32_16x16x32_bf16 v[64:67], a[12:15], a[172:175], v[64:67]
  v_mfma_f32_16x16x32_bf16 v[72:75], a[12:15], a[188:191], v[72:75]
  v_mfma_f32_16x16x32_bf16 v[68:71], a[16:19], a[160:163], 0
  v_mfma_f32_16x16x32_bf16 v[76:79], a[16:19], a[176:179], 0
  v_mfma_f32_16x16x32_bf16 v[68:71], a[20:23], a[164:167], v[68:71]
  v_mfma_f32_16x16x32_bf16 v[76:79], a[20:23], a[180:183], v[76:79]
  v_mfma_f32_16x16x32_bf16 v[68:71], a[24:27], a[168:171], v[68:71]
  v_mfma_f32_16x16x32_bf16 v[76:79], a[24:27], a[184:187], v[76:79]
  v_mfma_f32_16x16x32_bf16 v[68:71], a[28:31], a[172:175], v[68:71]
  v_mfma_f32_16x16x32_bf16 v[76:79], a[28:31], a[188:191], v[76:79]
  v_cmp_gt_i32 vcc, 0, v20
  s_nop 1
  v_cndmask_b32 v64, v64, v5, vcc
  v_cmp_gt_i32 vcc, 1, v20
  s_nop 1
  v_cndmask_b32 v65, v65, v5, vcc
  v_cmp_gt_i32 vcc, 2, v20
  s_nop 1
  v_cndmask_b32 v66, v66, v5, vcc
  v_cmp_gt_i32 vcc, 3, v20
  s_nop 1
  v_cndmask_b32 v67, v67, v5, vcc
  v_cmp_gt_i32 vcc, 16, v20
  s_nop 1
  v_cndmask_b32 v68, v68, v5, vcc
  v_cmp_gt_i32 vcc, 17, v20
  s_nop 1
  v_cndmask_b32 v69, v69, v5, vcc
  v_cmp_gt_i32 vcc, 18, v20
  s_nop 1
  v_cndmask_b32 v70, v70, v5, vcc
  v_cmp_gt_i32 vcc, 19, v20
  s_nop 1
  v_cndmask_b32 v71, v71, v5, vcc
  v_subrev_u32 v20, 32, v20
  v_max3_f32 v6, v64, v65, v66
  v_max3_f32 v7, v67, v68, v69
  v_max3_f32 v6, v6, v70, v71
  v_max_f32 v6, v6, v7
  v_cmp_gt_i32 vcc, 0, v21
  s_nop 1
  v_cndmask_b32 v72, v72, v5, vcc
  v_cmp_gt_i32 vcc, 1, v21
  s_nop 1
  v_cndmask_b32 v73, v73, v5, vcc
  v_cmp_gt_i32 vcc, 2, v21
  s_nop 1
  v_cndmask_b32 v74, v74, v5, vcc
  v_cmp_gt_i32 vcc, 3, v21
  s_nop 1
  v_cndmask_b32 v75, v75, v5, vcc
  v_cmp_gt_i32 vcc, 16, v21
  s_nop 1
  v_cndmask_b32 v76, v76, v5, vcc
  v_cmp_gt_i32 vcc, 17, v21
  s_nop 1
  v_cndmask_b32 v77, v77, v5, vcc
  v_cmp_gt_i32 vcc, 18, v21
  s_nop 1
  v_cndmask_b32 v78, v78, v5, vcc
  v_cmp_gt_i32 vcc, 19, v21
  s_nop 1
  v_cndmask_b32 v79, v79, v5, vcc
  v_subrev_u32 v21, 32, v21
  v_max3_f32 v8, v72, v73, v74
  v_max3_f32 v9, v75, v76, v77
  v_max3_f32 v8, v8, v78, v79
  v_max_f32 v8, v8, v9
  v_mov_b32 v7, v6
  v_mov_b32 v9, v8
  s_nop 0
  v_permlane32_swap_b32 v6, v7
  v_permlane32_swap_b32 v8, v9
  v_max_f32 v6, v6, v7
  v_max_f32 v8, v8, v9
  v_mov_b32 v7, v6
  v_mov_b32 v9, v8
  s_nop 0
  v_permlane16_swap_b32 v6, v7
  v_permlane16_swap_b32 v8, v9
  v_max_f32 v6, v6, v7
  v_max_f32 v8, v8, v9
  v_max_f32 v6, v6, v16
  v_sub_f32 v7, v16, v6
  v_exp_f32 v7, v7
  v_mov_b32 v16, v6
  v_sub_f32 v64, v64, v16
  v_sub_f32 v65, v65, v16
  v_sub_f32 v66, v66, v16
  v_sub_f32 v67, v67, v16
  v_sub_f32 v68, v68, v16
  v_sub_f32 v69, v69, v16
  v_sub_f32 v70, v70, v16
  v_sub_f32 v71, v71, v16
  v_exp_f32 v64, v64
  v_exp_f32 v65, v65
  v_exp_f32 v66, v66
  v_exp_f32 v67, v67
  v_exp_f32 v68, v68
  v_exp_f32 v69, v69
  v_exp_f32 v70, v70
  v_exp_f32 v71, v71
  v_mul_f32 v24, v24, v7
  v_mul_f32 v25, v25, v7
  v_mul_f32 v26, v26, v7
  v_mul_f32 v27, v27, v7
  v_mul_f32 v192, v192, v7
  v_mul_f32 v193, v193, v7
  v_mul_f32 v194, v194, v7
  v_mul_f32 v195, v195, v7
  v_mul_f32 v196, v196, v7
  v_mul_f32 v197, v197, v7
  v_mul_f32 v198, v198, v7
  v_mul_f32 v199, v199, v7
  v_mul_f32 v200, v200, v7
  v_mul_f32 v201, v201, v7
  v_mul_f32 v202, v202, v7
  v_mul_f32 v203, v203, v7
  v_mul_f32 v204, v204, v7
  v_mul_f32 v205, v205, v7
  v_mul_f32 v206, v206, v7
  v_mul_f32 v207, v207, v7
  v_mul_f32 v208, v208, v7
  v_mul_f32 v209, v209, v7
  v_mul_f32 v210, v210, v7
  v_mul_f32 v211, v211, v7
  v_mul_f32 v212, v212, v7
  v_mul_f32 v213, v213, v7
  v_mul_f32 v214, v214, v7
  v_mul_f32 v215, v215, v7
  v_mul_f32 v216, v216, v7
  v_mul_f32 v217, v217, v7
  v_mul_f32 v218, v218, v7
  v_mul_f32 v219, v219, v7
  v_mul_f32 v220, v220, v7
  v_mul_f32 v221, v221, v7
  v_mul_f32 v222, v222, v7
  v_mul_f32 v223, v223, v7
  v_cvt_pk_bf16_f32 v32, v64, v65
  v_cvt_pk_bf16_f32 v33, v66, v67
  v_cvt_pk_bf16_f32 v34, v68, v69
  v_cvt_pk_bf16_f32 v35, v70, v71
  v_max_f32 v8, v8, v17
  v_sub_f32 v9, v17, v8
  v_exp_f32 v9, v9
  v_mov_b32 v17, v8
  v_sub_f32 v72, v72, v17
  v_sub_f32 v73, v73, v17
  v_sub_f32 v74, v74, v17
  v_sub_f32 v75, v75, v17
  v_sub_f32 v76, v76, v17
  v_sub_f32 v77, v77, v17
  v_sub_f32 v78, v78, v17
  v_sub_f32 v79, v79, v17
  v_exp_f32 v72, v72
  v_exp_f32 v73, v73
  v_exp_f32 v74, v74
  v_exp_f32 v75, v75
  v_exp_f32 v76, v76
  v_exp_f32 v77, v77
  v_exp_f32 v78, v78
  v_exp_f32 v79, v79
  v_mul_f32 v28, v28, v9
  v_mul_f32 v29, v29, v9
  v_mul_f32 v30, v30, v9
  v_mul_f32 v31, v31, v9
  v_mul_f32 v224, v224, v9
  v_mul_f32 v225, v225, v9
  v_mul_f32 v226, v226, v9
  v_mul_f32 v227, v227, v9
  v_mul_f32 v228, v228, v9
  v_mul_f32 v229, v229, v9
  v_mul_f32 v230, v230, v9
  v_mul_f32 v231, v231, v9
  v_mul_f32 v232, v232, v9
  v_mul_f32 v233, v233, v9
  v_mul_f32 v234, v234, v9
  v_mul_f32 v235, v235, v9
  v_mul_f32 v236, v236, v9
  v_mul_f32 v237, v237, v9
  v_mul_f32 v238, v238, v9
  v_mul_f32 v239, v239, v9
  v_mul_f32 v240, v240, v9
  v_mul_f32 v241, v241, v9
  v_mul_f32 v242, v242, v9
  v_mul_f32 v243, v243, v9
  v_mul_f32 v244, v244, v9
  v_mul_f32 v245, v245, v9
  v_mul_f32 v246, v246, v9
  v_mul_f32 v247, v247, v9
  v_mul_f32 v248, v248, v9
  v_mul_f32 v249, v249, v9
  v_mul_f32 v250, v250, v9
  v_mul_f32 v251, v251, v9
  v_mul_f32 v252, v252, v9
  v_mul_f32 v253, v253, v9
  v_mul_f32 v254, v254, v9
  v_mul_f32 v255, v255, v9
  v_cvt_pk_bf16_f32 v36, v72, v73
  v_cvt_pk_bf16_f32 v37, v74, v75
  v_cvt_pk_bf16_f32 v38, v76, v77
  v_cvt_pk_bf16_f32 v39, v78, v79
  v_mfma_f32_16x16x32_bf16 v[24:27], a[208:211], v[32:35], v[24:27]
  v_mfma_f32_16x16x32_bf16 v[192:195], a[32:35], v[32:35], v[192:195]
  v_mfma_f32_16x16x32_bf16 v[196:199], a[36:39], v[32:35], v[196:199]
  v_mfma_f32_16x16x32_bf16 v[200:203], a[40:43], v[32:35], v[200:203]
  v_mfma_f32_16x16x32_bf16 v[204:207], a[44:47], v[32:35], v[204:207]
  v_mfma_f32_16x16x32_bf16 v[208:211], a[48:51], v[32:35], v[208:211]
  v_mfma_f32_16x16x32_bf16 v[212:215], a[52:55], v[32:35], v[212:215]
  v_mfma_f32_16x16x32_bf16 v[216:219], a[56:59], v[32:35], v[216:219]
  v_mfma_f32_16x16x32_bf16 v[220:223], a[60:63], v[32:35], v[220:223]
  v_mfma_f32_16x16x32_bf16 v[28:31], a[208:211], v[36:39], v[28:31]
  v_mfma_f32_16x16x32_bf16 v[224:227], a[32:35], v[36:39], v[224:227]
  v_mfma_f32_16x16x32_bf16 v[228:231], a[36:39], v[36:39], v[228:231]
  v_mfma_f32_16x16x32_bf16 v[232:235], a[40:43], v[36:39], v[232:235]
  v_mfma_f32_16x16x32_bf16 v[236:239], a[44:47], v[36:39], v[236:239]
  v_mfma_f32_16x16x32_bf16 v[240:243], a[48:51], v[36:39], v[240:243]
  v_mfma_f32_16x16x32_bf16 v[244:247], a[52:55], v[36:39], v[244:247]
  v_mfma_f32_16x16x32_bf16 v[248:251], a[56:59], v[36:39], v[248:251]
  v_mfma_f32_16x16x32_bf16 v[252:255], a[60:63], v[36:39], v[252:255]
  s_add_u32 s90, s90, 8192
  s_and_b32 s4, s90, 0x4000
  s_add_u32 s90, s90, s4
  s_sub_u32 s7, s7, 1
  s_cmp_lg_u32 s7, 0
  s_cbranch_scc1 La_sl_loop
  s_lshl_b32 s4, s6, 20
  s_lshl_b32 s5, s24, 15
  s_add_u32 s4, s4, s5
  s_lshl_b32 s5, s3, 11
  s_add_u32 s4, s4, s5
  v_rcp_f32 v6, v24
  s_nop 0
  v_mov_b32 v7, v6
  v_rcp_f32 v8, v28
  s_nop 0
  v_mov_b32 v9, v8
  v_pk_mul_f32 v[192:193], v[192:193], v[6:7]
  v_pk_mul_f32 v[194:195], v[194:195], v[6:7]
  v_pk_mul_f32 v[196:197], v[196:197], v[6:7]
  v_pk_mul_f32 v[198:199], v[198:199], v[6:7]
  v_cvt_pk_bf16_f32 v192, v192, v193
  v_cvt_pk_bf16_f32 v193, v194, v195
  v_cvt_pk_bf16_f32 v194, v196, v197
  v_cvt_pk_bf16_f32 v195, v198, v199
  buffer_store_dwordx4 v[192:195], v2, s[16:19], s4 offen offset:0 sc1
  v_pk_mul_f32 v[224:225], v[224:225], v[8:9]
  v_pk_mul_f32 v[226:227], v[226:227], v[8:9]
  v_pk_mul_f32 v[228:229], v[228:229], v[8:9]
  v_pk_mul_f32 v[230:231], v[230:231], v[8:9]
  v_cvt_pk_bf16_f32 v224, v224, v225
  v_cvt_pk_bf16_f32 v225, v226, v227
  v_cvt_pk_bf16_f32 v226, v228, v229
  v_cvt_pk_bf16_f32 v227, v230, v231
  buffer_store_dwordx4 v[224:227], v2, s[16:19], s4 offen offset:1024 sc1
  s_add_u32 s4, s4, 8192
  v_pk_mul_f32 v[200:201], v[200:201], v[6:7]
  v_pk_mul_f32 v[202:203], v[202:203], v[6:7]
  v_pk_mul_f32 v[204:205], v[204:205], v[6:7]
  v_pk_mul_f32 v[206:207], v[206:207], v[6:7]
  v_cvt_pk_bf16_f32 v200, v200, v201
  v_cvt_pk_bf16_f32 v201, v202, v203
  v_cvt_pk_bf16_f32 v202, v204, v205
  v_cvt_pk_bf16_f32 v203, v206, v207
  buffer_store_dwordx4 v[200:203], v2, s[16:19], s4 offen offset:0 sc1
  v_pk_mul_f32 v[232:233], v[232:233], v[8:9]
  v_pk_mul_f32 v[234:235], v[234:235], v[8:9]
  v_pk_mul_f32 v[236:237], v[236:237], v[8:9]
  v_pk_mul_f32 v[238:239], v[238:239], v[8:9]
  v_cvt_pk_bf16_f32 v232, v232, v233
  v_cvt_pk_bf16_f32 v233, v234, v235
  v_cvt_pk_bf16_f32 v234, v236, v237
  v_cvt_pk_bf16_f32 v235, v238, v239
  buffer_store_dwordx4 v[232:235], v2, s[16:19], s4 offen offset:1024 sc1
  s_add_u32 s4, s4, 8192
  v_pk_mul_f32 v[208:209], v[208:209], v[6:7]
  v_pk_mul_f32 v[210:211], v[210:211], v[6:7]
  v_pk_mul_f32 v[212:213], v[212:213], v[6:7]
  v_pk_mul_f32 v[214:215], v[214:215], v[6:7]
  v_cvt_pk_bf16_f32 v208, v208, v209
  v_cvt_pk_bf16_f32 v209, v210, v211
  v_cvt_pk_bf16_f32 v210, v212, v213
  v_cvt_pk_bf16_f32 v211, v214, v215
  buffer_store_dwordx4 v[208:211], v2, s[16:19], s4 offen offset:0 sc1
  v_pk_mul_f32 v[240:241], v[240:241], v[8:9]
  v_pk_mul_f32 v[242:243], v[242:243], v[8:9]
  v_pk_mul_f32 v[244:245], v[244:245], v[8:9]
  v_pk_mul_f32 v[246:247], v[246:247], v[8:9]
  v_cvt_pk_bf16_f32 v240, v240, v241
  v_cvt_pk_bf16_f32 v241, v242, v243
  v_cvt_pk_bf16_f32 v242, v244, v245
  v_cvt_pk_bf16_f32 v243, v246, v247
  buffer_store_dwordx4 v[240:243], v2, s[16:19], s4 offen offset:1024 sc1
  s_add_u32 s4, s4, 8192
  v_pk_mul_f32 v[216:217], v[216:217], v[6:7]
  v_pk_mul_f32 v[218:219], v[218:219], v[6:7]
  v_pk_mul_f32 v[220:221], v[220:221], v[6:7]
  v_pk_mul_f32 v[222:223], v[222:223], v[6:7]
  v_cvt_pk_bf16_f32 v216, v216, v217
  v_cvt_pk_bf16_f32 v217, v218, v219
  v_cvt_pk_bf16_f32 v218, v220, v221
  v_cvt_pk_bf16_f32 v219, v222, v223
  buffer_store_dwordx4 v[216:219], v2, s[16:19], s4 offen offset:0 sc1
  v_pk_mul_f32 v[248:249], v[248:249], v[8:9]
  v_pk_mul_f32 v[250:251], v[250:251], v[8:9]
  v_pk_mul_f32 v[252:253], v[252:253], v[8:9]
  v_pk_mul_f32 v[254:255], v[254:255], v[8:9]
  v_cvt_pk_bf16_f32 v248, v248, v249
  v_cvt_pk_bf16_f32 v249, v250, v251
  v_cvt_pk_bf16_f32 v250, v252, v253
  v_cvt_pk_bf16_f32 v251, v254, v255
  buffer_store_dwordx4 v[248:251], v2, s[16:19], s4 offen offset:1024 sc1
  s_cmp_eq_u32 s6, s25
  s_cbranch_scc1 La_done
  v_accvgpr_read_b32 v64, a128
  v_accvgpr_read_b32 v65, a129
  v_accvgpr_read_b32 v66, a130
  v_accvgpr_read_b32 v67, a131
  v_accvgpr_read_b32 v68, a132
  v_accvgpr_read_b32 v69, a133
  v_accvgpr_read_b32 v70, a134
  v_accvgpr_read_b32 v71, a135
  v_accvgpr_read_b32 v72, a136
  v_accvgpr_read_b32 v73, a137
  v_accvgpr_read_b32 v74, a138
  v_accvgpr_read_b32 v75, a139
  v_accvgpr_read_b32 v76, a140
  v_accvgpr_read_b32 v77, a141
  v_accvgpr_read_b32 v78, a142
  v_accvgpr_read_b32 v79, a143
  v_accvgpr_read_b32 v80, a144
  v_accvgpr_read_b32 v81, a145
  v_accvgpr_read_b32 v82, a146
  v_accvgpr_read_b32 v83, a147
  v_accvgpr_read_b32 v84, a148
  v_accvgpr_read_b32 v85, a149
  v_accvgpr_read_b32 v86, a150
  v_accvgpr_read_b32 v87, a151
  v_accvgpr_read_b32 v88, a152
  v_accvgpr_read_b32 v89, a153
  v_accvgpr_read_b32 v90, a154
  v_accvgpr_read_b32 v91, a155
  v_accvgpr_read_b32 v92, a156
  v_accvgpr_read_b32 v93, a157
  v_accvgpr_read_b32 v94, a158
  v_accvgpr_read_b32 v95, a159
  v_accvgpr_write_b32 a160, v64
  v_accvgpr_write_b32 a161, v65
  v_accvgpr_write_b32 a162, v66
  v_accvgpr_write_b32 a163, v67
  v_accvgpr_write_b32 a164, v68
  v_accvgpr_write_b32 a165, v69
  v_accvgpr_write_b32 a166, v70
  v_accvgpr_write_b32 a167, v71
  v_accvgpr_write_b32 a168, v72
  v_accvgpr_write_b32 a169, v73
  v_accvgpr_write_b32 a170, v74
  v_accvgpr_write_b32 a171, v75
  v_accvgpr_write_b32 a172, v76
  v_accvgpr_write_b32 a173, v77
  v_accvgpr_write_b32 a174, v78
  v_accvgpr_write_b32 a175, v79
  v_accvgpr_write_b32 a176, v80
  v_accvgpr_write_b32 a177, v81
  v_accvgpr_write_b32 a178, v82
  v_accvgpr_write_b32 a179, v83
  v_accvgpr_write_b32 a180, v84
  v_accvgpr_write_b32 a181, v85
  v_accvgpr_write_b32 a182, v86
  v_accvgpr_write_b32 a183, v87
  v_accvgpr_write_b32 a184, v88
  v_accvgpr_write_b32 a185, v89
  v_accvgpr_write_b32 a186, v90
  v_accvgpr_write_b32 a187, v91
  v_accvgpr_write_b32 a188, v92
  v_accvgpr_write_b32 a189, v93
  v_accvgpr_write_b32 a190, v94
  v_accvgpr_write_b32 a191, v95
  s_mov_b32 s6, s25
  s_branch La_sl_blk
La_done:
  s_lshr_b32 s4, s3, 1
  s_lshl_b32 s4, s4, 12
  s_add_u32 s4, s4, 131072
  s_lshl_b32 s5, s77, 11
  s_add_u32 s4, s4, s5
  v_add_u32 v16, s4, v2
  v_xor_b32 v17, 0x800, v16
  s_and_b32 s4, s3, 1
  s_lshl_b32 s4, s4, 13
  s_add_u32 s4, s4, 131072
  v_lshrrev_b32 v24, 2, v1
  v_and_b32 v25, 6, v24
  v_lshlrev_b32 v24, 7, v24
  v_and_b32 v26, 1, v1
  v_lshl_add_u32 v24, v26, 3, v24
  v_add_u32 v24, s4, v24
  v_bfe_u32 v26, v1, 1, 1
  v_xor_b32 v25, v25, v26
  v_xor_b32 v26, 0, v25
  v_lshl_add_u32 v18, v26, 4, v24
  v_xor_b32 v26, 2, v25
  v_lshl_add_u32 v19, v26, 4, v24
  v_xor_b32 v26, 4, v25
  v_lshl_add_u32 v20, v26, 4, v24
  v_xor_b32 v26, 6, v25
  v_lshl_add_u32 v21, v26, 4, v24
  s_mov_b32 s65, 0
  s_mov_b32 s67, 4294868992
  s_mov_b32 s68, 32768
  s_mov_b32 s65, 3
  s_waitcnt vmcnt(16)
  s_barrier
  ds_read_b128 a[64:67], v16 offset:0
  ds_read_b64_tr_b16 a[96:97], v18 offset:16384
  ds_read_b64_tr_b16 a[98:99], v18 offset:18432
  ds_read_b128 a[68:71], v16 offset:1024
  ds_read_b128 a[72:75], v17 offset:0
  ds_read_b128 a[76:79], v17 offset:1024
  ds_read_b64_tr_b16 a[100:101], v19 offset:16384
  ds_read_b64_tr_b16 a[102:103], v19 offset:18432
  ds_read_b64_tr_b16 a[104:105], v20 offset:16384
  ds_read_b64_tr_b16 a[106:107], v20 offset:18432
  ds_read_b64_tr_b16 a[108:109], v21 offset:16384
  ds_read_b64_tr_b16 a[110:111], v21 offset:18432
  s_waitcnt lgkmcnt(0)
  v_mfma_f32_16x16x32_bf16 v[32:35], a[96:99], a[64:67], 0
  s_add_u32 m0, s79, 81920
  ds_read_b128 a[80:83], v16 offset:8192
  ds_read_b64_tr_b16 a[112:113], v18 offset:20480
  v_mfma_f32_16x16x32_bf16 v[48:51], a[96:99], a[68:71], 0
  buffer_load_dwordx4 v10, s[12:15], s71 offen offset:0 lds
  ds_read_b64_tr_b16 a[114:115], v18 offset:22528
  v_mfma_f32_16x16x32_bf16 v[64:67], a[96:99], a[72:75], 0
  buffer_load_dwordx4 v11, s[12:15], s71 offen offset:1024 lds
  ds_read_b128 a[84:87], v16 offset:9216
  v_mfma_f32_16x16x32_bf16 v[80:83], a[96:99], a[76:79], 0
  buffer_load_dwordx4 v12, s[12:15], s71 offen offset:2048 lds
  ds_read_b128 a[88:91], v17 offset:8192
  v_mfma_f32_16x16x32_bf16 v[36:39], a[100:103], a[64:67], 0
  buffer_load_dwordx4 v13, s[12:15], s71 offen offset:3072 lds
  ds_read_b128 a[92:95], v17 offset:9216
  v_mfma_f32_16x16x32_bf16 v[52:55], a[100:103], a[68:71], 0
  s_bfe_u32 s72, 0x3020106, s31
  s_add_u32 s30, s30, s72
  s_add_u32 s31, s31, 8
  v_mfma_f32_16x16x32_bf16 v[68:71], a[100:103], a[72:75], 0
  s_and_b32 s31, s31, 0x8001f
  s_and_b32 s30, s30, 7
  s_lshl_b32 s72, s30, 17
  v_mfma_f32_16x16x32_bf16 v[84:87], a[100:103], a[76:79], 0
  s_add_u32 s71, s93, s72
  s_add_u32 m0, s79, 65536
  ds_read_b64_tr_b16 a[116:117], v19 offset:20480
  v_mfma_f32_16x16x32_bf16 v[40:43], a[104:107], a[64:67], 0
  buffer_load_dwordx4 v2, s[8:11], s70 offen offset:0 sc1 lds
  ds_read_b64_tr_b16 a[118:119], v19 offset:22528
  v_mfma_f32_16x16x32_bf16 v[56:59], a[104:107], a[68:71], 0
  buffer_load_dwordx4 v2, s[8:11], s70 offen offset:1024 sc1 lds
  ds_read_b64_tr_b16 a[120:121], v20 offset:20480
  v_mfma_f32_16x16x32_bf16 v[72:75], a[104:107], a[72:75], 0
  buffer_load_dwordx4 v2, s[8:11], s70 offen offset:2048 sc1 lds
  ds_read_b64_tr_b16 a[122:123], v20 offset:22528
  v_mfma_f32_16x16x32_bf16 v[88:91], a[104:107], a[76:79], 0
  buffer_load_dwordx4 v2, s[8:11], s70 offen offset:3072 sc1 lds
  ds_read_b64_tr_b16 a[124:125], v21 offset:20480
  v_mfma_f32_16x16x32_bf16 v[44:47], a[108:111], a[64:67], 0
  s_bfe_u32 s72, 0x3020106, s1
  s_add_u32 s0, s0, s72
  s_add_u32 s1, s1, 8
  v_mfma_f32_16x16x32_bf16 v[60:63], a[108:111], a[68:71], 0
  s_and_b32 s1, s1, 0x8001f
  s_and_b32 s0, s0, 7
  s_lshl_b32 s72, s0, 14
  v_mfma_f32_16x16x32_bf16 v[76:79], a[108:111], a[72:75], 0
  s_add_u32 s70, s92, s72
  s_add_u32 m0, s79, 114688
  ds_read_b64_tr_b16 a[126:127], v21 offset:22528
  v_mfma_f32_16x16x32_bf16 v[92:95], a[108:111], a[76:79], 0
  buffer_load_dwordx4 v10, s[12:15], s71 offen offset:0 lds
  buffer_load_dwordx4 v11, s[12:15], s71 offen offset:1024 lds
  buffer_load_dwordx4 v12, s[12:15], s71 offen offset:2048 lds
  buffer_load_dwordx4 v13, s[12:15], s71 offen offset:3072 lds
  s_bfe_u32 s72, 0x3020106, s31
  s_add_u32 s30, s30, s72
  s_add_u32 s31, s31, 8
  s_and_b32 s31, s31, 0x8001f
  s_and_b32 s30, s30, 7
  s_lshl_b32 s72, s30, 17
  s_add_u32 s71, s93, s72
  s_add_u32 m0, s79, 98304
  s_nop 0
  buffer_load_dwordx4 v2, s[8:11], s70 offen offset:0 sc1 lds
  buffer_load_dwordx4 v2, s[8:11], s70 offen offset:1024 sc1 lds
  buffer_load_dwordx4 v2, s[8:11], s70 offen offset:2048 sc1 lds
  buffer_load_dwordx4 v2, s[8:11], s70 offen offset:3072 sc1 lds
  s_bfe_u32 s72, 0x3020106, s1
  s_add_u32 s0, s0, s72
  s_add_u32 s1, s1, 8
  s_and_b32 s1, s1, 0x8001f
  s_and_b32 s0, s0, 7
  s_lshl_b32 s72, s0, 14
  s_add_u32 s70, s92, s72
  s_add_u32 s65, s65, 1
  s_cmp_eq_u32 s65, 4
  s_cselect_b32 s65, 0, s65
  s_cselect_b32 s66, s67, s68
  v_add_u32 v16, s66, v16
  v_add_u32 v17, s66, v17
  v_add_u32 v18, s66, v18
  v_add_u32 v19, s66, v19
  v_add_u32 v20, s66, v20
  v_add_u32 v21, s66, v21
  s_waitcnt vmcnt(16) lgkmcnt(0)
  s_barrier
  s_lshl_b32 s4, s24, 7
  s_lshl_b32 s5, s25, 12
  s_add_u32 s6, s4, 65536
  s_add_u32 s7, s6, 61440
  s_add_u32 s6, s6, s5
  s_sub_u32 s7, s7, s5
  v_mov_b32 v8, 0x40000000
  v_mov_b32 v6, s94
  v_cmp_eq_u32 vcc, 0, v0
  v_mov_b32 v7, s95
  s_nop 0
  v_cndmask_b32_e64 v8, v8, 0, vcc
  buffer_store_dwordx2 v[6:7], v8, s[96:99], s6 offen sc1
  buffer_store_dwordx2 v[6:7], v8, s[96:99], s7 offen sc1
  s_lshl_b32 s91, s73, 12
  s_add_u32 s91, s91, 65536
  v_and_b32 v14, 31, v1
  v_lshlrev_b32 v14, 7, v14
  s_add_u32 s16, s86, 100663296
  s_addc_u32 s17, s87, 0
  s_mov_b32 s18, 16777216
  s_mov_b32 s19, 0x00020000
  v_mfma_f32_16x16x32_bf16 v[32:35], a[112:115], a[80:83], v[32:35]
  s_add_u32 m0, s64, 16384
  ds_read_b128 a[64:67], v16 offset:0
  ds_read_b64_tr_b16 a[96:97], v18 offset:16384
  v_mfma_f32_16x16x32_bf16 v[48:51], a[112:115], a[84:87], v[48:51]
  buffer_load_dwordx4 v10, s[12:15], s71 offen offset:0 lds
  ds_read_b64_tr_b16 a[98:99], v18 offset:18432
  v_mfma_f32_16x16x32_bf16 v[64:67], a[112:115], a[88:91], v[64:67]
  ds_read_b128 a[68:71], v16 offset:1024
  ds_read_b128 a[72:75], v17 offset:0
  v_mfma_f32_16x16x32_bf16 v[80:83], a[112:115], a[92:95], v[80:83]
  buffer_load_dwordx4 v11, s[12:15], s71 offen offset:1024 lds
  ds_read_b128 a[76:79], v17 offset:1024
  v_mfma_f32_16x16x32_bf16 v[36:39], a[116:119], a[80:83], v[36:39]
  ds_read_b64_tr_b16 a[100:101], v19 offset:16384
  ds_read_b64_tr_b16 a[102:103], v19 offset:18432
  v_mfma_f32_16x16x32_bf16 v[52:55], a[116:119], a[84:87], v[52:55]
  ds_read_b64_tr_b16 a[104:105], v20 offset:16384
  ds_read_b64_tr_b16 a[106:107], v20 offset:18432
  v_mfma_f32_16x16x32_bf16 v[68:71], a[116:119], a[88:91], v[68:71]
  ds_read_b64_tr_b16 a[108:109], v21 offset:16384
  ds_read_b64_tr_b16 a[110:111], v21 offset:18432
  v_mfma_f32_16x16x32_bf16 v[84:87], a[116:119], a[92:95], v[84:87]
  buffer_load_dwordx4 v12, s[12:15], s71 offen offset:2048 lds
  v_mfma_f32_16x16x32_bf16 v[40:43], a[120:123], a[80:83], v[40:43]
  v_mfma_f32_16x16x32_bf16 v[56:59], a[120:123], a[84:87], v[56:59]
  v_mfma_f32_16x16x32_bf16 v[72:75], a[120:123], a[88:91], v[72:75]
  v_mfma_f32_16x16x32_bf16 v[88:91], a[120:123], a[92:95], v[88:91]
  buffer_load_dwordx4 v13, s[12:15], s71 offen offset:3072 lds
  v_mfma_f32_16x16x32_bf16 v[44:47], a[124:127], a[80:83], v[44:47]
  s_bfe_u32 s72, 0x3020106, s31
  s_add_u32 s30, s30, s72
  s_add_u32 s31, s31, 8
  v_mfma_f32_16x16x32_bf16 v[60:63], a[124:127], a[84:87], v[60:63]
  s_and_b32 s31, s31, 0x8001f
  s_and_b32 s30, s30, 7
  s_lshl_b32 s72, s30, 17
  v_mfma_f32_16x16x32_bf16 v[76:79], a[124:127], a[88:91], v[76:79]
  s_add_u32 s71, s93, s72
  v_mfma_f32_16x16x32_bf16 v[92:95], a[124:127], a[92:95], v[92:95]
  s_waitcnt lgkmcnt(0)
  v_mfma_f32_16x16x32_bf16 v[32:35], a[96:99], a[64:67], v[32:35]
  s_mov_b32 m0, s64
  ds_read_b128 a[80:83], v16 offset:8192
  ds_read_b64_tr_b16 a[112:113], v18 offset:20480
  v_mfma_f32_16x16x32_bf16 v[48:51], a[96:99], a[68:71], v[48:51]
  buffer_load_dwordx4 v2, s[8:11], s70 offen offset:0 sc1 lds
  ds_read_b64_tr_b16 a[114:115], v18 offset:22528
  v_mfma_f32_16x16x32_bf16 v[64:67], a[96:99], a[72:75], v[64:67]
  buffer_load_dwordx4 v2, s[8:11], s70 offen offset:1024 sc1 lds
  ds_read_b128 a[84:87], v16 offset:9216
  v_mfma_f32_16x16x32_bf16 v[80:83], a[96:99], a[76:79], v[80:83]
  ds_read_b128 a[88:91], v17 offset:8192
  ds_read_b128 a[92:95], v17 offset:9216
  v_mfma_f32_16x16x32_bf16 v[36:39], a[100:103], a[64:67], v[36:39]
  buffer_load_dwordx4 v2, s[8:11], s70 offen offset:2048 sc1 lds
  ds_read_b64_tr_b16 a[116:117], v19 offset:20480
  v_mfma_f32_16x16x32_bf16 v[52:55], a[100:103], a[68:71], v[52:55]
  ds_read_b64_tr_b16 a[118:119], v19 offset:22528
  ds_read_b64_tr_b16 a[120:121], v20 offset:20480
  v_mfma_f32_16x16x32_bf16 v[68:71], a[100:103], a[72:75], v[68:71]
  buffer_load_dwordx4 v2, s[8:11], s70 offen offset:3072 sc1 lds
  ds_read_b64_tr_b16 a[122:123], v20 offset:22528
  v_mfma_f32_16x16x32_bf16 v[84:87], a[100:103], a[76:79], v[84:87]
  s_bfe_u32 s72, 0x3020106, s1
  s_add_u32 s0, s0, s72
  s_add_u32 s1, s1, 8
  v_mfma_f32_16x16x32_bf16 v[40:43], a[104:107], a[64:67], v[40:43]
  s_and_b32 s1, s1, 0x8001f
  s_and_b32 s0, s0, 7
  s_lshl_b32 s72, s0, 14
  v_mfma_f32_16x16x32_bf16 v[56:59], a[104:107], a[68:71], v[56:59]
  s_add_u32 s70, s92, s72
  ds_read_b64_tr_b16 a[124:125], v21 offset:20480
  ds_read_b64_tr_b16 a[126:127], v21 offset:22528
  v_mfma_f32_16x16x32_bf16 v[72:75], a[104:107], a[72:75], v[72:75]
  s_add_u32 s64, s64, s66
  s_add_u32 s65, s65, 1
  s_cmp_eq_u32 s65, 4
  s_cselect_b32 s65, 0, s65
  s_cselect_b32 s66, s67, s68
  v_mfma_f32_16x16x32_bf16 v[88:91], a[104:107], a[76:79], v[88:91]
  v_add_u32 v16, s66, v16
  v_add_u32 v17, s66, v17
  v_mfma_f32_16x16x32_bf16 v[44:47], a[108:111], a[64:67], v[44:47]
  v_add_u32 v18, s66, v18
  v_add_u32 v19, s66, v19
  v_mfma_f32_16x16x32_bf16 v[60:63], a[108:111], a[68:71], v[60:63]
  v_add_u32 v20, s66, v20
  v_add_u32 v21, s66, v21
  v_mfma_f32_16x16x32_bf16 v[76:79], a[108:111], a[72:75], v[76:79]
  v_mfma_f32_16x16x32_bf16 v[92:95], a[108:111], a[76:79], v[92:95]
  s_waitcnt vmcnt(18) lgkmcnt(0)
  s_barrier
  v_mfma_f32_16x16x32_bf16 v[32:35], a[112:115], a[80:83], v[32:35]
  s_add_u32 m0, s64, 16384
  ds_read_b128 a[64:67], v16 offset:0
  ds_read_b64_tr_b16 a[96:97], v18 offset:16384
  v_mfma_f32_16x16x32_bf16 v[48:51], a[112:115], a[84:87], v[48:51]
  buffer_load_dwordx4 v10, s[12:15], s71 offen offset:0 lds
  ds_read_b64_tr_b16 a[98:99], v18 offset:18432
  v_mfma_f32_16x16x32_bf16 v[64:67], a[112:115], a[88:91], v[64:67]
  ds_read_b128 a[68:71], v16 offset:1024
  ds_read_b128 a[72:75], v17 offset:0
  v_mfma_f32_16x16x32_bf16 v[80:83], a[112:115], a[92:95], v[80:83]
  buffer_load_dwordx4 v11, s[12:15], s71 offen offset:1024 lds
  ds_read_b128 a[76:79], v17 offset:1024
  v_mfma_f32_16x16x32_bf16 v[36:39], a[116:119], a[80:83], v[36:39]
  ds_read_b64_tr_b16 a[100:101], v19 offset:16384
  ds_read_b64_tr_b16 a[102:103], v19 offset:18432
  v_mfma_f32_16x16x32_bf16 v[52:55], a[116:119], a[84:87], v[52:55]
  ds_read_b64_tr_b16 a[104:105], v20 offset:16384
  ds_read_b64_tr_b16 a[106:107], v20 offset:18432
  v_mfma_f32_16x16x32_bf16 v[68:71], a[116:119], a[88:91], v[68:71]
  ds_read_b64_tr_b16 a[108:109], v21 offset:16384
  ds_read_b64_tr_b16 a[110:111], v21 offset:18432
  v_mfma_f32_16x16x32_bf16 v[84:87], a[116:119], a[92:95], v[84:87]
  buffer_load_dwordx4 v12, s[12:15], s71 offen offset:2048 lds
  v_mfma_f32_16x16x32_bf16 v[40:43], a[120:123], a[80:83], v[40:43]
  v_mfma_f32_16x16x32_bf16 v[56:59], a[120:123], a[84:87], v[56:59]
  v_mfma_f32_16x16x32_bf16 v[72:75], a[120:123], a[88:91], v[72:75]
  v_mfma_f32_16x16x32_bf16 v[88:91], a[120:123], a[92:95], v[88:91]
  buffer_load_dwordx4 v13, s[12:15], s71 offen offset:3072 lds
  v_mfma_f32_16x16x32_bf16 v[44:47], a[124:127], a[80:83], v[44:47]
  s_bfe_u32 s72, 0x3020106, s31
  s_add_u32 s30, s30, s72
  s_add_u32 s31, s31, 8
  v_mfma_f32_16x16x32_bf16 v[60:63], a[124:127], a[84:87], v[60:63]
  s_and_b32 s31, s31, 0x8001f
  s_and_b32 s30, s30, 7
  s_lshl_b32 s72, s30, 17
  v_mfma_f32_16x16x32_bf16 v[76:79], a[124:127], a[88:91], v[76:79]
  s_add_u32 s71, s93, s72
  v_mfma_f32_16x16x32_bf16 v[92:95], a[124:127], a[92:95], v[92:95]
  s_waitcnt lgkmcnt(0)
  v_mfma_f32_16x16x32_bf16 v[32:35], a[96:99], a[64:67], v[32:35]
  s_mov_b32 m0, s64
  ds_read_b128 a[80:83], v16 offset:8192
  ds_read_b64_tr_b16 a[112:113], v18 offset:20480
  v_mfma_f32_16x16x32_bf16 v[48:51], a[96:99], a[68:71], v[48:51]
  buffer_load_dwordx4 v2, s[8:11], s70 offen offset:0 sc1 lds
  ds_read_b64_tr_b16 a[114:115], v18 offset:22528
  v_mfma_f32_16x16x32_bf16 v[64:67], a[96:99], a[72:75], v[64:67]
  buffer_load_dwordx4 v2, s[8:11], s70 offen offset:1024 sc1 lds
  ds_read_b128 a[84:87], v16 offset:9216
  v_mfma_f32_16x16x32_bf16 v[80:83], a[96:99], a[76:79], v[80:83]
  ds_read_b128 a[88:91], v17 offset:8192
  ds_read_b128 a[92:95], v17 offset:9216
  v_mfma_f32_16x16x32_bf16 v[36:39], a[100:103], a[64:67], v[36:39]
  buffer_load_dwordx4 v2, s[8:11], s70 offen offset:2048 sc1 lds
  ds_read_b64_tr_b16 a[116:117], v19 offset:20480
  v_mfma_f32_16x16x32_bf16 v[52:55], a[100:103], a[68:71], v[52:55]
  ds_read_b64_tr_b16 a[118:119], v19 offset:22528
  ds_read_b64_tr_b16 a[120:121], v20 offset:20480
  v_mfma_f32_16x16x32_bf16 v[68:71], a[100:103], a[72:75], v[68:71]
  buffer_load_dwordx4 v2, s[8:11], s70 offen offset:3072 sc1 lds
  ds_read_b64_tr_b16 a[122:123], v20 offset:22528
  v_mfma_f32_16x16x32_bf16 v[84:87], a[100:103], a[76:79], v[84:87]
  s_bfe_u32 s72, 0x3020106, s1
  s_add_u32 s0, s0, s72
  s_add_u32 s1, s1, 8
  v_mfma_f32_16x16x32_bf16 v[40:43], a[104:107], a[64:67], v[40:43]
  s_and_b32 s1, s1, 0x8001f
  s_and_b32 s0, s0, 7
  s_lshl_b32 s72, s0, 14
  v_mfma_f32_16x16x32_bf16 v[56:59], a[104:107], a[68:71], v[56:59]
  s_add_u32 s70, s92, s72
  ds_read_b64_tr_b16 a[124:125], v21 offset:20480
  ds_read_b64_tr_b16 a[126:127], v21 offset:22528
  v_mfma_f32_16x16x32_bf16 v[72:75], a[104:107], a[72:75], v[72:75]
  s_add_u32 s64, s64, s66
  s_add_u32 s65, s65, 1
  s_cmp_eq_u32 s65, 4
  s_cselect_b32 s65, 0, s65
  s_cselect_b32 s66, s67, s68
  v_mfma_f32_16x16x32_bf16 v[88:91], a[104:107], a[76:79], v[88:91]
  v_add_u32 v16, s66, v16
  v_add_u32 v17, s66, v17
  v_mfma_f32_16x16x32_bf16 v[44:47], a[108:111], a[64:67], v[44:47]
  v_add_u32 v18, s66, v18
  v_add_u32 v19, s66, v19
  v_mfma_f32_16x16x32_bf16 v[60:63], a[108:111], a[68:71], v[60:63]
  v_add_u32 v20, s66, v20
  v_add_u32 v21, s66, v21
  v_mfma_f32_16x16x32_bf16 v[76:79], a[108:111], a[72:75], v[76:79]
  v_mfma_f32_16x16x32_bf16 v[92:95], a[108:111], a[76:79], v[92:95]
  s_waitcnt vmcnt(18) lgkmcnt(0)
  s_barrier
  v_mfma_f32_16x16x32_bf16 v[32:35], a[112:115], a[80:83], v[32:35]
  s_add_u32 m0, s64, 16384
  ds_read_b128 a[64:67], v16 offset:0
  ds_read_b64_tr_b16 a[96:97], v18 offset:16384
  v_mfma_f32_16x16x32_bf16 v[48:51], a[112:115], a[84:87], v[48:51]
  buffer_load_dwordx4 v10, s[12:15], s71 offen offset:0 lds
  ds_read_b64_tr_b16 a[98:99], v18 offset:18432
  v_mfma_f32_16x16x32_bf16 v[64:67], a[112:115], a[88:91], v[64:67]
  ds_read_b128 a[68:71], v16 offset:1024
  ds_read_b128 a[72:75], v17 offset:0
  v_mfma_f32_16x16x32_bf16 v[80:83], a[112:115], a[92:95], v[80:83]
  buffer_load_dwordx4 v11, s[12:15], s71 offen offset:1024 lds
  ds_read_b128 a[76:79], v17 offset:1024
  v_mfma_f32_16x16x32_bf16 v[36:39], a[116:119], a[80:83], v[36:39]
  ds_read_b64_tr_b16 a[100:101], v19 offset:16384
  ds_read_b64_tr_b16 a[102:103], v19 offset:18432
  v_mfma_f32_16x16x32_bf16 v[52:55], a[116:119], a[84:87], v[52:55]
  ds_read_b64_tr_b16 a[104:105], v20 offset:16384
  ds_read_b64_tr_b16 a[106:107], v20 offset:18432
  v_mfma_f32_16x16x32_bf16 v[68:71], a[116:119], a[88:91], v[68:71]
  ds_read_b64_tr_b16 a[108:109], v21 offset:16384
  ds_read_b64_tr_b16 a[110:111], v21 offset:18432
  v_mfma_f32_16x16x32_bf16 v[84:87], a[116:119], a[92:95], v[84:87]
  buffer_load_dwordx4 v12, s[12:15], s71 offen offset:2048 lds
  v_mfma_f32_16x16x32_bf16 v[40:43], a[120:123], a[80:83], v[40:43]
  v_mfma_f32_16x16x32_bf16 v[56:59], a[120:123], a[84:87], v[56:59]
  v_mfma_f32_16x16x32_bf16 v[72:75], a[120:123], a[88:91], v[72:75]
  v_mfma_f32_16x16x32_bf16 v[88:91], a[120:123], a[92:95], v[88:91]
  buffer_load_dwordx4 v13, s[12:15], s71 offen offset:3072 lds
  v_mfma_f32_16x16x32_bf16 v[44:47], a[124:127], a[80:83], v[44:47]
  s_bfe_u32 s72, 0x3020106, s31
  s_add_u32 s30, s30, s72
  s_add_u32 s31, s31, 8
  v_mfma_f32_16x16x32_bf16 v[60:63], a[124:127], a[84:87], v[60:63]
  s_and_b32 s31, s31, 0x8001f
  s_and_b32 s30, s30, 7
  s_lshl_b32 s72, s30, 17
  v_mfma_f32_16x16x32_bf16 v[76:79], a[124:127], a[88:91], v[76:79]
  s_add_u32 s71, s93, s72
  v_mfma_f32_16x16x32_bf16 v[92:95], a[124:127], a[92:95], v[92:95]
  s_waitcnt lgkmcnt(0)
  v_mfma_f32_16x16x32_bf16 v[32:35], a[96:99], a[64:67], v[32:35]
  s_mov_b32 m0, s64
  ds_read_b128 a[80:83], v16 offset:8192
  ds_read_b64_tr_b16 a[112:113], v18 offset:20480
  v_mfma_f32_16x16x32_bf16 v[48:51], a[96:99], a[68:71], v[48:51]
  buffer_load_dwordx4 v2, s[8:11], s70 offen offset:0 sc1 lds
  ds_read_b64_tr_b16 a[114:115], v18 offset:22528
  v_mfma_f32_16x16x32_bf16 v[64:67], a[96:99], a[72:75], v[64:67]
  buffer_load_dwordx4 v2, s[8:11], s70 offen offset:1024 sc1 lds
  ds_read_b128 a[84:87], v16 offset:9216
  v_mfma_f32_16x16x32_bf16 v[80:83], a[96:99], a[76:79], v[80:83]
  ds_read_b128 a[88:91], v17 offset:8192
  ds_read_b128 a[92:95], v17 offset:9216
  v_mfma_f32_16x16x32_bf16 v[36:39], a[100:103], a[64:67], v[36:39]
  buffer_load_dwordx4 v2, s[8:11], s70 offen offset:2048 sc1 lds
  ds_read_b64_tr_b16 a[116:117], v19 offset:20480
  v_mfma_f32_16x16x32_bf16 v[52:55], a[100:103], a[68:71], v[52:55]
  ds_read_b64_tr_b16 a[118:119], v19 offset:22528
  ds_read_b64_tr_b16 a[120:121], v20 offset:20480
  v_mfma_f32_16x16x32_bf16 v[68:71], a[100:103], a[72:75], v[68:71]
  buffer_load_dwordx4 v2, s[8:11], s70 offen offset:3072 sc1 lds
  ds_read_b64_tr_b16 a[122:123], v20 offset:22528
  v_mfma_f32_16x16x32_bf16 v[84:87], a[100:103], a[76:79], v[84:87]
  s_bfe_u32 s72, 0x3020106, s1
  s_add_u32 s0, s0, s72
  s_add_u32 s1, s1, 8
  v_mfma_f32_16x16x32_bf16 v[40:43], a[104:107], a[64:67], v[40:43]
  s_and_b32 s1, s1, 0x8001f
  s_and_b32 s0, s0, 7
  s_lshl_b32 s72, s0, 14
  v_mfma_f32_16x16x32_bf16 v[56:59], a[104:107], a[68:71], v[56:59]
  s_add_u32 s70, s92, s72
  ds_read_b64_tr_b16 a[124:125], v21 offset:20480
  ds_read_b64_tr_b16 a[126:127], v21 offset:22528
  v_mfma_f32_16x16x32_bf16 v[72:75], a[104:107], a[72:75], v[72:75]
  s_add_u32 s64, s64, s66
  s_add_u32 s65, s65, 1
  s_cmp_eq_u32 s65, 4
  s_cselect_b32 s65, 0, s65
  s_cselect_b32 s66, s67, s68
  v_mfma_f32_16x16x32_bf16 v[88:91], a[104:107], a[76:79], v[88:91]
  v_add_u32 v16, s66, v16
  v_add_u32 v17, s66, v17
  v_mfma_f32_16x16x32_bf16 v[44:47], a[108:111], a[64:67], v[44:47]
  v_add_u32 v18, s66, v18
  v_add_u32 v19, s66, v19
  v_mfma_f32_16x16x32_bf16 v[60:63], a[108:111], a[68:71], v[60:63]
  v_add_u32 v20, s66, v20
  v_add_u32 v21, s66, v21
  v_mfma_f32_16x16x32_bf16 v[76:79], a[108:111], a[72:75], v[76:79]
  v_mfma_f32_16x16x32_bf16 v[92:95], a[108:111], a[76:79], v[92:95]
  s_waitcnt vmcnt(16) lgkmcnt(0)
  s_barrier
  v_mfma_f32_16x16x32_bf16 v[32:35], a[112:115], a[80:83], v[32:35]
  s_add_u32 m0, s64, 16384
  ds_read_b128 a[64:67], v16 offset:0
  ds_read_b64_tr_b16 a[96:97], v18 offset:16384
  v_mfma_f32_16x16x32_bf16 v[48:51], a[112:115], a[84:87], v[48:51]
  buffer_load_dwordx4 v10, s[12:15], s71 offen offset:0 lds
  ds_read_b64_tr_b16 a[98:99], v18 offset:18432
  v_mfma_f32_16x16x32_bf16 v[64:67], a[112:115], a[88:91], v[64:67]
  ds_read_b128 a[68:71], v16 offset:1024
  ds_read_b128 a[72:75], v17 offset:0
  v_mfma_f32_16x16x32_bf16 v[80:83], a[112:115], a[92:95], v[80:83]
  buffer_load_dwordx4 v11, s[12:15], s71 offen offset:1024 lds
  ds_read_b128 a[76:79], v17 offset:1024
  v_mfma_f32_16x16x32_bf16 v[36:39], a[116:119], a[80:83], v[36:39]
  ds_read_b64_tr_b16 a[100:101], v19 offset:16384
  ds_read_b64_tr_b16 a[102:103], v19 offset:18432
  v_mfma_f32_16x16x32_bf16 v[52:55], a[116:119], a[84:87], v[52:55]
  ds_read_b64_tr_b16 a[104:105], v20 offset:16384
  ds_read_b64_tr_b16 a[106:107], v20 offset:18432
  v_mfma_f32_16x16x32_bf16 v[68:71], a[116:119], a[88:91], v[68:71]
  ds_read_b64_tr_b16 a[108:109], v21 offset:16384
  ds_read_b64_tr_b16 a[110:111], v21 offset:18432
  v_mfma_f32_16x16x32_bf16 v[84:87], a[116:119], a[92:95], v[84:87]
  buffer_load_dwordx4 v12, s[12:15], s71 offen offset:2048 lds
  v_mfma_f32_16x16x32_bf16 v[40:43], a[120:123], a[80:83], v[40:43]
  v_mfma_f32_16x16x32_bf16 v[56:59], a[120:123], a[84:87], v[56:59]
  v_mfma_f32_16x16x32_bf16 v[72:75], a[120:123], a[88:91], v[72:75]
  v_mfma_f32_16x16x32_bf16 v[88:91], a[120:123], a[92:95], v[88:91]
  buffer_load_dwordx4 v13, s[12:15], s71 offen offset:3072 lds
  v_mfma_f32_16x16x32_bf16 v[44:47], a[124:127], a[80:83], v[44:47]
  s_bfe_u32 s72, 0x3020106, s31
  s_add_u32 s30, s30, s72
  s_add_u32 s31, s31, 8
  v_mfma_f32_16x16x32_bf16 v[60:63], a[124:127], a[84:87], v[60:63]
  s_and_b32 s31, s31, 0x8001f
  s_and_b32 s30, s30, 7
  s_lshl_b32 s72, s30, 17
  v_mfma_f32_16x16x32_bf16 v[76:79], a[124:127], a[88:91], v[76:79]
  s_add_u32 s71, s93, s72
  v_mfma_f32_16x16x32_bf16 v[92:95], a[124:127], a[92:95], v[92:95]
  s_waitcnt lgkmcnt(0)
  v_mfma_f32_16x16x32_bf16 v[32:35], a[96:99], a[64:67], v[32:35]
  s_mov_b32 m0, s64
  ds_read_b128 a[80:83], v16 offset:8192
  ds_read_b64_tr_b16 a[112:113], v18 offset:20480
  v_mfma_f32_16x16x32_bf16 v[48:51], a[96:99], a[68:71], v[48:51]
  buffer_load_dwordx4 v2, s[8:11], s70 offen offset:0 sc1 lds
  ds_read_b64_tr_b16 a[114:115], v18 offset:22528
  v_mfma_f32_16x16x32_bf16 v[64:67], a[96:99], a[72:75], v[64:67]
  buffer_load_dwordx4 v2, s[8:11], s70 offen offset:1024 sc1 lds
  ds_read_b128 a[84:87], v16 offset:9216
  v_mfma_f32_16x16x32_bf16 v[80:83], a[96:99], a[76:79], v[80:83]
  ds_read_b128 a[88:91], v17 offset:8192
  ds_read_b128 a[92:95], v17 offset:9216
  v_mfma_f32_16x16x32_bf16 v[36:39], a[100:103], a[64:67], v[36:39]
  buffer_load_dwordx4 v2, s[8:11], s70 offen offset:2048 sc1 lds
  ds_read_b64_tr_b16 a[116:117], v19 offset:20480
  v_mfma_f32_16x16x32_bf16 v[52:55], a[100:103], a[68:71], v[52:55]
  ds_read_b64_tr_b16 a[118:119], v19 offset:22528
  ds_read_b64_tr_b16 a[120:121], v20 offset:20480
  v_mfma_f32_16x16x32_bf16 v[68:71], a[100:103], a[72:75], v[68:71]
  buffer_load_dwordx4 v2, s[8:11], s70 offen offset:3072 sc1 lds
  ds_read_b64_tr_b16 a[122:123], v20 offset:22528
  v_mfma_f32_16x16x32_bf16 v[84:87], a[100:103], a[76:79], v[84:87]
  s_bfe_u32 s72, 0x3020106, s1
  s_add_u32 s0, s0, s72
  s_add_u32 s1, s1, 8
  v_mfma_f32_16x16x32_bf16 v[40:43], a[104:107], a[64:67], v[40:43]
  s_and_b32 s1, s1, 0x8001f
  s_and_b32 s0, s0, 7
  s_lshl_b32 s72, s0, 14
  v_mfma_f32_16x16x32_bf16 v[56:59], a[104:107], a[68:71], v[56:59]
  s_add_u32 s70, s92, s72
  ds_read_b64_tr_b16 a[124:125], v21 offset:20480
  ds_read_b64_tr_b16 a[126:127], v21 offset:22528
  v_mfma_f32_16x16x32_bf16 v[72:75], a[104:107], a[72:75], v[72:75]
  s_add_u32 s64, s64, s66
  s_add_u32 s65, s65, 1
  s_cmp_eq_u32 s65, 4
  s_cselect_b32 s65, 0, s65
  s_cselect_b32 s66, s67, s68
  v_mfma_f32_16x16x32_bf16 v[88:91], a[104:107], a[76:79], v[88:91]
  v_add_u32 v16, s66, v16
  v_add_u32 v17, s66, v17
  v_mfma_f32_16x16x32_bf16 v[44:47], a[108:111], a[64:67], v[44:47]
  v_add_u32 v18, s66, v18
  v_add_u32 v19, s66, v19
  v_mfma_f32_16x16x32_bf16 v[60:63], a[108:111], a[68:71], v[60:63]
  v_add_u32 v20, s66, v20
  v_add_u32 v21, s66, v21
  v_mfma_f32_16x16x32_bf16 v[76:79], a[108:111], a[72:75], v[76:79]
  v_mfma_f32_16x16x32_bf16 v[92:95], a[108:111], a[76:79], v[92:95]
  s_waitcnt vmcnt(16) lgkmcnt(0)
  s_barrier
  v_mfma_f32_16x16x32_bf16 v[32:35], a[112:115], a[80:83], v[32:35]
  s_mov_b32 s12, s74
  s_mov_b32 s13, s75
  s_mov_b32 s14, 8388608
  v_mfma_f32_16x16x32_bf16 v[48:51], a[112:115], a[84:87], v[48:51]
  s_mov_b32 s15, 0x00020000
  s_lshl_b32 s93, s77, 22
  s_lshl_b32 s72, s76, 8
  v_mfma_f32_16x16x32_bf16 v[64:67], a[112:115], a[88:91], v[64:67]
  s_add_u32 s93, s93, s72
  s_add_u32 s72, s73, s76
  s_and_b32 s31, s72, 3
  v_mfma_f32_16x16x32_bf16 v[80:83], a[112:115], a[92:95], v[80:83]
  s_lshl_b32 s31, s31, 3
  s_or_b32 s31, s31, 0x80000
  s_bfe_u32 s30, 0x1b1b02, s31
  v_mfma_f32_16x16x32_bf16 v[36:39], a[116:119], a[80:83], v[36:39]
  s_add_u32 s30, s30, 0
  s_cmp_ge_u32 s30, 28
  s_cselect_b32 s72, 28, 0
  v_mfma_f32_16x16x32_bf16 v[52:55], a[116:119], a[84:87], v[52:55]
  s_sub_u32 s30, s30, s72
  s_lshl_b32 s72, s30, 17
  s_add_u32 s71, s93, s72
  v_mfma_f32_16x16x32_bf16 v[68:71], a[116:119], a[88:91], v[68:71]
  s_add_u32 m0, s64, 16384
  ds_read_b128 a[64:67], v16 offset:0
  ds_read_b64_tr_b16 a[96:97], v18 offset:16384
  v_mfma_f32_16x16x32_bf16 v[84:87], a[116:119], a[92:95], v[84:87]
  buffer_load_dwordx4 v10, s[12:15], s71 offen offset:0 lds
  ds_read_b64_tr_b16 a[98:99], v18 offset:18432
  v_mfma_f32_16x16x32_bf16 v[40:43], a[120:123], a[80:83], v[40:43]
  buffer_load_dwordx4 v11, s[12:15], s71 offen offset:1024 lds
  ds_read_b128 a[68:71], v16 offset:1024
  v_mfma_f32_16x16x32_bf16 v[56:59], a[120:123], a[84:87], v[56:59]
  ds_read_b128 a[72:75], v17 offset:0
  ds_read_b128 a[76:79], v17 offset:1024
  v_mfma_f32_16x16x32_bf16 v[72:75], a[120:123], a[88:91], v[72:75]
  buffer_load_dwordx4 v12, s[12:15], s71 offen offset:2048 lds
  ds_read_b64_tr_b16 a[100:101], v19 offset:16384
  v_mfma_f32_16x16x32_bf16 v[88:91], a[120:123], a[92:95], v[88:91]
  ds_read_b64_tr_b16 a[102:103], v19 offset:18432
  ds_read_b64_tr_b16 a[104:105], v20 offset:16384
  v_mfma_f32_16x16x32_bf16 v[44:47], a[124:127], a[80:83], v[44:47]
  ds_read_b64_tr_b16 a[106:107], v20 offset:18432
  ds_read_b64_tr_b16 a[108:109], v21 offset:16384
  v_mfma_f32_16x16x32_bf16 v[60:63], a[124:127], a[84:87], v[60:63]
  ds_read_b64_tr_b16 a[110:111], v21 offset:18432
  v_mfma_f32_16x16x32_bf16 v[76:79], a[124:127], a[88:91], v[76:79]
  v_mfma_f32_16x16x32_bf16 v[92:95], a[124:127], a[92:95], v[92:95]
  s_waitcnt lgkmcnt(0)
  v_mfma_f32_16x16x32_bf16 v[32:35], a[96:99], a[64:67], v[32:35]
  buffer_load_dwordx4 v13, s[12:15], s71 offen offset:3072 lds
  ds_read_b128 a[80:83], v16 offset:8192
  v_mfma_f32_16x16x32_bf16 v[48:51], a[96:99], a[68:71], v[48:51]
  s_bfe_u32 s72, 0x302011a, s31
  s_add_u32 s30, s30, s72
  s_add_u32 s31, s31, 8
  v_mfma_f32_16x16x32_bf16 v[64:67], a[96:99], a[72:75], v[64:67]
  s_and_b32 s31, s31, 0x8001f
  s_cmp_ge_u32 s30, 28
  s_cselect_b32 s72, 28, 0
  v_mfma_f32_16x16x32_bf16 v[80:83], a[96:99], a[76:79], v[80:83]
  s_sub_u32 s30, s30, s72
  s_lshl_b32 s72, s30, 17
  s_add_u32 s71, s93, s72
  v_mfma_f32_16x16x32_bf16 v[36:39], a[100:103], a[64:67], v[36:39]
  buffer_load_dwordx2 v[6:7], v14, s[96:99], s91 offen sc1
  ds_read_b64_tr_b16 a[112:113], v18 offset:20480
  v_mfma_f32_16x16x32_bf16 v[52:55], a[100:103], a[68:71], v[52:55]
  s_add_u32 s64, s64, s66
  ds_read_b64_tr_b16 a[114:115], v18 offset:22528
  ds_read_b128 a[84:87], v16 offset:9216
  v_mfma_f32_16x16x32_bf16 v[68:71], a[100:103], a[72:75], v[68:71]
  s_add_u32 s65, s65, 1
  ds_read_b128 a[88:91], v17 offset:8192
  ds_read_b128 a[92:95], v17 offset:9216
  v_mfma_f32_16x16x32_bf16 v[84:87], a[100:103], a[76:79], v[84:87]
  s_cmp_eq_u32 s65, 4
  s_cselect_b32 s65, 0, s65
  s_cselect_b32 s66, s67, s68
  ds_read_b64_tr_b16 a[116:117], v19 offset:20480
  ds_read_b64_tr_b16 a[118:119], v19 offset:22528
  v_mfma_f32_16x16x32_bf16 v[40:43], a[104:107], a[64:67], v[40:43]
  ds_read_b64_tr_b16 a[120:121], v20 offset:20480
  ds_read_b64_tr_b16 a[122:123], v20 offset:22528
  v_mfma_f32_16x16x32_bf16 v[56:59], a[104:107], a[68:71], v[56:59]
  ds_read_b64_tr_b16 a[124:125], v21 offset:20480
  ds_read_b64_tr_b16 a[126:127], v21 offset:22528
  v_mfma_f32_16x16x32_bf16 v[72:75], a[104:107], a[72:75], v[72:75]
  v_add_u32 v16, s66, v16
  v_add_u32 v17, s66, v17
  v_mfma_f32_16x16x32_bf16 v[88:91], a[104:107], a[76:79], v[88:91]
  v_add_u32 v18, s66, v18
  v_add_u32 v19, s66, v19
  v_mfma_f32_16x16x32_bf16 v[44:47], a[108:111], a[64:67], v[44:47]
  v_add_u32 v20, s66, v20
  v_add_u32 v21, s66, v21
  v_mfma_f32_16x16x32_bf16 v[60:63], a[108:111], a[68:71], v[60:63]
  v_mfma_f32_16x16x32_bf16 v[76:79], a[108:111], a[72:75], v[76:79]
  v_mfma_f32_16x16x32_bf16 v[92:95], a[108:111], a[76:79], v[92:95]
  s_waitcnt vmcnt(0)
  v_cmp_ne_u64 vcc, s[94:95], v[6:7]
  s_nop 1
  v_cndmask_b32_e64 v8, 0, 1, vcc
  v_lshlrev_b32 v9, 2, v0
  ds_write_b32 v9, v8
  v_lshlrev_b32 v9, 4, v1
  s_waitcnt lgkmcnt(0)
  s_barrier
  ds_read_b128 v[160:163], v9
  s_waitcnt lgkmcnt(0)
  v_or3_b32 v160, v160, v161, v162
  v_or_b32 v160, v160, v163
  v_cmp_ne_u32 vcc, 0, v160
  s_nop 0
  s_cbranch_vccnz Lp6_late
  s_add_u32 s8, s86, 67108864
  s_addc_u32 s9, s87, 0
  s_mov_b32 s10, 16777216
  s_mov_b32 s11, 0x00020000
  s_lshl_b32 s92, s73, 1
  s_add_u32 s92, s92, s77
  s_lshl_b32 s92, s92, 19
  s_add_u32 s92, s92, s79
  s_add_u32 s72, s73, s76
  s_and_b32 s1, s72, 3
  s_lshl_b32 s1, s1, 3
  s_or_b32 s1, s1, 0x80000
  s_bfe_u32 s0, 0x1b1b02, s1
  s_add_u32 s0, s0, 0
  s_cmp_ge_u32 s0, 28
  s_cselect_b32 s72, 28, 0
  s_sub_u32 s0, s0, s72
  s_lshl_b32 s72, s0, 14
  s_add_u32 s70, s92, s72
  v_mfma_f32_16x16x32_bf16 v[32:35], a[112:115], a[80:83], v[32:35]
  s_add_u32 m0, s79, 131072
  ds_read_b128 a[64:67], v16 offset:0
  ds_read_b64_tr_b16 a[96:97], v18 offset:16384
  v_mfma_f32_16x16x32_bf16 v[48:51], a[112:115], a[84:87], v[48:51]
  buffer_load_dwordx4 v2, s[8:11], s70 offen offset:0 sc1 lds
  ds_read_b64_tr_b16 a[98:99], v18 offset:18432
  v_mfma_f32_16x16x32_bf16 v[64:67], a[112:115], a[88:91], v[64:67]
  buffer_load_dwordx4 v2, s[8:11], s70 offen offset:1024 sc1 lds
  ds_read_b128 a[68:71], v16 offset:1024
  v_mfma_f32_16x16x32_bf16 v[80:83], a[112:115], a[92:95], v[80:83]
  ds_read_b128 a[72:75], v17 offset:0
  ds_read_b128 a[76:79], v17 offset:1024
  v_mfma_f32_16x16x32_bf16 v[36:39], a[116:119], a[80:83], v[36:39]
  ds_read_b64_tr_b16 a[100:101], v19 offset:16384
  ds_read_b64_tr_b16 a[102:103], v19 offset:18432
  v_mfma_f32_16x16x32_bf16 v[52:55], a[116:119], a[84:87], v[52:55]
  buffer_load_dwordx4 v2, s[8:11], s70 offen offset:2048 sc1 lds
  ds_read_b64_tr_b16 a[104:105], v20 offset:16384
  v_mfma_f32_16x16x32_bf16 v[68:71], a[116:119], a[88:91], v[68:71]
  ds_read_b64_tr_b16 a[106:107], v20 offset:18432
  ds_read_b64_tr_b16 a[108:109], v21 offset:16384
  v_mfma_f32_16x16x32_bf16 v[84:87], a[116:119], a[92:95], v[84:87]
  buffer_load_dwordx4 v2, s[8:11], s70 offen offset:3072 sc1 lds
  ds_read_b64_tr_b16 a[110:111], v21 offset:18432
  v_mfma_f32_16x16x32_bf16 v[40:43], a[120:123], a[80:83], v[40:43]
  s_bfe_u32 s72, 0x302011a, s1
  s_add_u32 s0, s0, s72
  s_add_u32 s1, s1, 8
  v_mfma_f32_16x16x32_bf16 v[56:59], a[120:123], a[84:87], v[56:59]
  s_and_b32 s1, s1, 0x8001f
  s_cmp_ge_u32 s0, 28
  s_cselect_b32 s72, 28, 0
  v_mfma_f32_16x16x32_bf16 v[72:75], a[120:123], a[88:91], v[72:75]
  s_sub_u32 s0, s0, s72
  s_lshl_b32 s72, s0, 14
  s_add_u32 s70, s92, s72
  v_mfma_f32_16x16x32_bf16 v[88:91], a[120:123], a[92:95], v[88:91]
  s_add_u32 m0, s64, 16384
  v_mfma_f32_16x16x32_bf16 v[44:47], a[124:127], a[80:83], v[44:47]
  buffer_load_dwordx4 v10, s[12:15], s71 offen offset:0 lds
  v_mfma_f32_16x16x32_bf16 v[60:63], a[124:127], a[84:87], v[60:63]
  buffer_load_dwordx4 v11, s[12:15], s71 offen offset:1024 lds
  v_mfma_f32_16x16x32_bf16 v[76:79], a[124:127], a[88:91], v[76:79]
  v_mfma_f32_16x16x32_bf16 v[92:95], a[124:127], a[92:95], v[92:95]
  s_waitcnt lgkmcnt(0)
  v_mfma_f32_16x16x32_bf16 v[32:35], a[96:99], a[64:67], v[32:35]
  buffer_load_dwordx4 v12, s[12:15], s71 offen offset:2048 lds
  ds_read_b128 a[80:83], v16 offset:8192
  v_mfma_f32_16x16x32_bf16 v[48:51], a[96:99], a[68:71], v[48:51]
  buffer_load_dwordx4 v13, s[12:15], s71 offen offset:3072 lds
  ds_read_b64_tr_b16 a[112:113], v18 offset:20480
  v_mfma_f32_16x16x32_bf16 v[64:67], a[96:99], a[72:75], v[64:67]
  s_bfe_u32 s72, 0x302011a, s31
  s_add_u32 s30, s30, s72
  s_add_u32 s31, s31, 8
  v_mfma_f32_16x16x32_bf16 v[80:83], a[96:99], a[76:79], v[80:83]
  s_and_b32 s31, s31, 0x8001f
  s_cmp_ge_u32 s30, 28
  s_cselect_b32 s72, 28, 0
  v_mfma_f32_16x16x32_bf16 v[36:39], a[100:103], a[64:67], v[36:39]
  s_sub_u32 s30, s30, s72
  s_lshl_b32 s72, s30, 17
  s_add_u32 s71, s93, s72
  v_mfma_f32_16x16x32_bf16 v[52:55], a[100:103], a[68:71], v[52:55]
  s_mov_b32 m0, s64
  ds_read_b64_tr_b16 a[114:115], v18 offset:22528
  ds_read_b128 a[84:87], v16 offset:9216
  v_mfma_f32_16x16x32_bf16 v[68:71], a[100:103], a[72:75], v[68:71]
  buffer_load_dwordx4 v2, s[8:11], s70 offen offset:0 sc1 lds
  ds_read_b128 a[88:91], v17 offset:8192
  v_mfma_f32_16x16x32_bf16 v[84:87], a[100:103], a[76:79], v[84:87]
  buffer_load_dwordx4 v2, s[8:11], s70 offen offset:1024 sc1 lds
  ds_read_b128 a[92:95], v17 offset:9216
  v_mfma_f32_16x16x32_bf16 v[40:43], a[104:107], a[64:67], v[40:43]
  buffer_load_dwordx4 v2, s[8:11], s70 offen offset:2048 sc1 lds
  ds_read_b64_tr_b16 a[116:117], v19 offset:20480
  v_mfma_f32_16x16x32_bf16 v[56:59], a[104:107], a[68:71], v[56:59]
  buffer_load_dwordx4 v2, s[8:11], s70 offen offset:3072 sc1 lds
  ds_read_b64_tr_b16 a[118:119], v19 offset:22528
  v_mfma_f32_16x16x32_bf16 v[72:75], a[104:107], a[72:75], v[72:75]
  s_bfe_u32 s72, 0x302011a, s1
  s_add_u32 s0, s0, s72
  s_add_u32 s1, s1, 8
  v_mfma_f32_16x16x32_bf16 v[88:91], a[104:107], a[76:79], v[88:91]
  s_and_b32 s1, s1, 0x8001f
  s_cmp_ge_u32 s0, 28
  s_cselect_b32 s72, 28, 0
  v_mfma_f32_16x16x32_bf16 v[44:47], a[108:111], a[64:67], v[44:47]
  s_sub_u32 s0, s0, s72
  s_lshl_b32 s72, s0, 14
  s_add_u32 s70, s92, s72
  v_mfma_f32_16x16x32_bf16 v[60:63], a[108:111], a[68:71], v[60:63]
  s_add_u32 s64, s64, s66
  ds_read_b64_tr_b16 a[120:121], v20 offset:20480
  ds_read_b64_tr_b16 a[122:123], v20 offset:22528
  v_mfma_f32_16x16x32_bf16 v[76:79], a[108:111], a[72:75], v[76:79]
  s_add_u32 s65, s65, 1
  ds_read_b64_tr_b16 a[124:125], v21 offset:20480
  ds_read_b64_tr_b16 a[126:127], v21 offset:22528
  v_mfma_f32_16x16x32_bf16 v[92:95], a[108:111], a[76:79], v[92:95]
  s_cmp_eq_u32 s65, 4
  s_cselect_b32 s65, 0, s65
  s_cselect_b32 s66, s67, s68
  v_add_u32 v16, s66, v16
  v_add_u32 v17, s66, v17
  v_add_u32 v18, s66, v18
  v_add_u32 v19, s66, v19
  v_add_u32 v20, s66, v20
  v_add_u32 v21, s66, v21
  s_waitcnt vmcnt(12) lgkmcnt(0)
  s_barrier
  v_mfma_f32_16x16x32_bf16 v[32:35], a[112:115], a[80:83], v[32:35]
  s_add_u32 m0, s64, 16384
  ds_read_b128 a[64:67], v16 offset:0
  ds_read_b64_tr_b16 a[96:97], v18 offset:16384
  v_mfma_f32_16x16x32_bf16 v[48:51], a[112:115], a[84:87], v[48:51]
  buffer_load_dwordx4 v10, s[12:15], s71 offen offset:0 lds
  ds_read_b64_tr_b16 a[98:99], v18 offset:18432
  v_mfma_f32_16x16x32_bf16 v[64:67], a[112:115], a[88:91], v[64:67]
  ds_read_b128 a[68:71], v16 offset:1024
  ds_read_b128 a[72:75], v17 offset:0
  v_mfma_f32_16x16x32_bf16 v[80:83], a[112:115], a[92:95], v[80:83]
  buffer_load_dwordx4 v11, s[12:15], s71 offen offset:1024 lds
  ds_read_b128 a[76:79], v17 offset:1024
  v_mfma_f32_16x16x32_bf16 v[36:39], a[116:119], a[80:83], v[36:39]
  ds_read_b64_tr_b16 a[100:101], v19 offset:16384
  ds_read_b64_tr_b16 a[102:103], v19 offset:18432
  v_mfma_f32_16x16x32_bf16 v[52:55], a[116:119], a[84:87], v[52:55]
  ds_read_b64_tr_b16 a[104:105], v20 offset:16384
  ds_read_b64_tr_b16 a[106:107], v20 offset:18432
  v_mfma_f32_16x16x32_bf16 v[68:71], a[116:119], a[88:91], v[68:71]
  ds_read_b64_tr_b16 a[108:109], v21 offset:16384
  ds_read_b64_tr_b16 a[110:111], v21 offset:18432
  v_mfma_f32_16x16x32_bf16 v[84:87], a[116:119], a[92:95], v[84:87]
  buffer_load_dwordx4 v12, s[12:15], s71 offen offset:2048 lds
  v_mfma_f32_16x16x32_bf16 v[40:43], a[120:123], a[80:83], v[40:43]
  v_mfma_f32_16x16x32_bf16 v[56:59], a[120:123], a[84:87], v[56:59]
  v_mfma_f32_16x16x32_bf16 v[72:75], a[120:123], a[88:91], v[72:75]
  v_mfma_f32_16x16x32_bf16 v[88:91], a[120:123], a[92:95], v[88:91]
  buffer_load_dwordx4 v13, s[12:15], s71 offen offset:3072 lds
  v_mfma_f32_16x16x32_bf16 v[44:47], a[124:127], a[80:83], v[44:47]
  s_bfe_u32 s72, 0x302011a, s31
  s_add_u32 s30, s30, s72
  s_add_u32 s31, s31, 8
  v_mfma_f32_16x16x32_bf16 v[60:63], a[124:127], a[84:87], v[60:63]
  s_and_b32 s31, s31, 0x8001f
  s_cmp_ge_u32 s30, 28
  s_cselect_b32 s72, 28, 0
  v_mfma_f32_16x16x32_bf16 v[76:79], a[124:127], a[88:91], v[76:79]
  s_sub_u32 s30, s30, s72
  s_lshl_b32 s72, s30, 17
  s_add_u32 s71, s93, s72
  v_mfma_f32_16x16x32_bf16 v[92:95], a[124:127], a[92:95], v[92:95]
  s_waitcnt lgkmcnt(0)
  v_mfma_f32_16x16x32_bf16 v[32:35], a[96:99], a[64:67], v[32:35]
  s_mov_b32 m0, s64
  ds_read_b128 a[80:83], v16 offset:8192
  ds_read_b64_tr_b16 a[112:113], v18 offset:20480
  v_mfma_f32_16x16x32_bf16 v[48:51], a[96:99], a[68:71], v[48:51]
  buffer_load_dwordx4 v2, s[8:11], s70 offen offset:0 sc1 lds
  ds_read_b64_tr_b16 a[114:115], v18 offset:22528
  v_mfma_f32_16x16x32_bf16 v[64:67], a[96:99], a[72:75], v[64:67]
  buffer_load_dwordx4 v2, s[8:11], s70 offen offset:1024 sc1 lds
  ds_read_b128 a[84:87], v16 offset:9216
  v_mfma_f32_16x16x32_bf16 v[80:83], a[96:99], a[76:79], v[80:83]
  ds_read_b128 a[88:91], v17 offset:8192
  ds_read_b128 a[92:95], v17 offset:9216
  v_mfma_f32_16x16x32_bf16 v[36:39], a[100:103], a[64:67], v[36:39]
  buffer_load_dwordx4 v2, s[8:11], s70 offen offset:2048 sc1 lds
  ds_read_b64_tr_b16 a[116:117], v19 offset:20480
  v_mfma_f32_16x16x32_bf16 v[52:55], a[100:103], a[68:71], v[52:55]
  ds_read_b64_tr_b16 a[118:119], v19 offset:22528
  ds_read_b64_tr_b16 a[120:121], v20 offset:20480
  v_mfma_f32_16x16x32_bf16 v[68:71], a[100:103], a[72:75], v[68:71]
  buffer_load_dwordx4 v2, s[8:11], s70 offen offset:3072 sc1 lds
  ds_read_b64_tr_b16 a[122:123], v20 offset:22528
  v_mfma_f32_16x16x32_bf16 v[84:87], a[100:103], a[76:79], v[84:87]
  s_bfe_u32 s72, 0x302011a, s1
  s_add_u32 s0, s0, s72
  s_add_u32 s1, s1, 8
  v_mfma_f32_16x16x32_bf16 v[40:43], a[104:107], a[64:67], v[40:43]
  s_and_b32 s1, s1, 0x8001f
  s_cmp_ge_u32 s0, 28
  s_cselect_b32 s72, 28, 0
  v_mfma_f32_16x16x32_bf16 v[56:59], a[104:107], a[68:71], v[56:59]
  s_sub_u32 s0, s0, s72
  s_lshl_b32 s72, s0, 14
  s_add_u32 s70, s92, s72
  v_mfma_f32_16x16x32_bf16 v[72:75], a[104:107], a[72:75], v[72:75]
  s_add_u32 s64, s64, s66
  ds_read_b64_tr_b16 a[124:125], v21 offset:20480
  ds_read_b64_tr_b16 a[126:127], v21 offset:22528
  v_mfma_f32_16x16x32_bf16 v[88:91], a[104:107], a[76:79], v[88:91]
  s_add_u32 s65, s65, 1
  s_cmp_eq_u32 s65, 4
  s_cselect_b32 s65, 0, s65
  s_cselect_b32 s66, s67, s68
  v_mfma_f32_16x16x32_bf16 v[44:47], a[108:111], a[64:67], v[44:47]
  v_add_u32 v16, s66, v16
  v_add_u32 v17, s66, v17
  v_mfma_f32_16x16x32_bf16 v[60:63], a[108:111], a[68:71], v[60:63]
  v_add_u32 v18, s66, v18
  v_add_u32 v19, s66, v19
  v_mfma_f32_16x16x32_bf16 v[76:79], a[108:111], a[72:75], v[76:79]
  v_add_u32 v20, s66, v20
  v_add_u32 v21, s66, v21
  v_mfma_f32_16x16x32_bf16 v[92:95], a[108:111], a[76:79], v[92:95]
  s_waitcnt vmcnt(16) lgkmcnt(0)
  s_barrier
  v_mfma_f32_16x16x32_bf16 v[32:35], a[112:115], a[80:83], v[32:35]
  s_add_u32 m0, s64, 16384
  ds_read_b128 a[64:67], v16 offset:0
  ds_read_b64_tr_b16 a[96:97], v18 offset:16384
  v_mfma_f32_16x16x32_bf16 v[48:51], a[112:115], a[84:87], v[48:51]
  buffer_load_dwordx4 v10, s[12:15], s71 offen offset:0 lds
  ds_read_b64_tr_b16 a[98:99], v18 offset:18432
  v_mfma_f32_16x16x32_bf16 v[64:67], a[112:115], a[88:91], v[64:67]
  buffer_load_dwordx4 v11, s[12:15], s71 offen offset:1024 lds
  ds_read_b128 a[68:71], v16 offset:1024
  v_mfma_f32_16x16x32_bf16 v[80:83], a[112:115], a[92:95], v[80:83]
  buffer_load_dwordx4 v12, s[12:15], s71 offen offset:2048 lds
  ds_read_b128 a[72:75], v17 offset:0
  v_mfma_f32_16x16x32_bf16 v[36:39], a[116:119], a[80:83], v[36:39]
  ds_read_b128 a[76:79], v17 offset:1024
  ds_read_b64_tr_b16 a[100:101], v19 offset:16384
  v_mfma_f32_16x16x32_bf16 v[52:55], a[116:119], a[84:87], v[52:55]
  buffer_load_dwordx4 v13, s[12:15], s71 offen offset:3072 lds
  ds_read_b64_tr_b16 a[102:103], v19 offset:18432
  v_mfma_f32_16x16x32_bf16 v[68:71], a[116:119], a[88:91], v[68:71]
  s_bfe_u32 s72, 0x302011a, s31
  s_add_u32 s30, s30, s72
  s_add_u32 s31, s31, 8
  v_mfma_f32_16x16x32_bf16 v[84:87], a[116:119], a[92:95], v[84:87]
  s_and_b32 s31, s31, 0x8001f
  s_cmp_ge_u32 s30, 28
  s_cselect_b32 s72, 28, 0
  v_mfma_f32_16x16x32_bf16 v[40:43], a[120:123], a[80:83], v[40:43]
  s_sub_u32 s30, s30, s72
  s_lshl_b32 s72, s30, 17
  s_add_u32 s71, s93, s72
  v_mfma_f32_16x16x32_bf16 v[56:59], a[120:123], a[84:87], v[56:59]
  s_mov_b32 m0, s64
  ds_read_b64_tr_b16 a[104:105], v20 offset:16384
  ds_read_b64_tr_b16 a[106:107], v20 offset:18432
  v_mfma_f32_16x16x32_bf16 v[72:75], a[120:123], a[88:91], v[72:75]
  buffer_load_dwordx4 v2, s[8:11], s70 offen offset:0 sc1 lds
  ds_read_b64_tr_b16 a[108:109], v21 offset:16384
  v_mfma_f32_16x16x32_bf16 v[88:91], a[120:123], a[92:95], v[88:91]
  buffer_load_dwordx4 v2, s[8:11], s70 offen offset:1024 sc1 lds
  ds_read_b64_tr_b16 a[110:111], v21 offset:18432
  v_mfma_f32_16x16x32_bf16 v[44:47], a[124:127], a[80:83], v[44:47]
  buffer_load_dwordx4 v2, s[8:11], s70 offen offset:2048 sc1 lds
  v_mfma_f32_16x16x32_bf16 v[60:63], a[124:127], a[84:87], v[60:63]
  buffer_load_dwordx4 v2, s[8:11], s70 offen offset:3072 sc1 lds
  v_mfma_f32_16x16x32_bf16 v[76:79], a[124:127], a[88:91], v[76:79]
  s_bfe_u32 s72, 0x302011a, s1
  s_add_u32 s0, s0, s72
  s_add_u32 s1, s1, 8
  v_mfma_f32_16x16x32_bf16 v[92:95], a[124:127], a[92:95], v[92:95]
  s_and_b32 s1, s1, 0x8001f
  s_cmp_ge_u32 s0, 28
  s_cselect_b32 s72, 28, 0
  s_sub_u32 s0, s0, s72
  s_lshl_b32 s72, s0, 14
  s_add_u32 s70, s92, s72
  s_waitcnt lgkmcnt(0)
  s_lshl_b32 s6, s78, 1
  s_add_u32 s6, s6, s77
  s_xor_b32 s6, s6, 1
  s_lshl_b32 s6, s6, 2
  s_add_u32 s6, s6, s3
  s_lshl_b32 s6, s6, 13
  s_add_u32 s6, s6, 8388608
  s_add_u32 s7, s6, 4096
  v_mfma_f32_16x16x32_bf16 v[96:99], a[96:99], a[64:67], 0
  s_add_u32 s64, s64, s66
  ds_read_b128 a[80:83], v16 offset:8192
  ds_read_b64_tr_b16 a[112:113], v18 offset:20480
  v_mfma_f32_16x16x32_bf16 v[112:115], a[96:99], a[68:71], 0
  s_add_u32 s65, s65, 1
  ds_read_b64_tr_b16 a[114:115], v18 offset:22528
  ds_read_b128 a[84:87], v16 offset:9216
  v_mfma_f32_16x16x32_bf16 v[128:131], a[96:99], a[72:75], 0
  s_cmp_eq_u32 s65, 4
  s_cselect_b32 s65, 0, s65
  s_cselect_b32 s66, s67, s68
  ds_read_b128 a[88:91], v17 offset:8192
  ds_read_b128 a[92:95], v17 offset:9216
  v_mfma_f32_16x16x32_bf16 v[144:147], a[96:99], a[76:79], 0
  ds_read_b64_tr_b16 a[116:117], v19 offset:20480
  v_mfma_f32_16x16x32_bf16 v[100:103], a[100:103], a[64:67], 0
  ds_read_b64_tr_b16 a[118:119], v19 offset:22528
  ds_read_b64_tr_b16 a[120:121], v20 offset:20480
  v_mfma_f32_16x16x32_bf16 v[116:119], a[100:103], a[68:71], 0
  ds_read_b64_tr_b16 a[122:123], v20 offset:22528
  ds_read_b64_tr_b16 a[124:125], v21 offset:20480
  v_mfma_f32_16x16x32_bf16 v[132:135], a[100:103], a[72:75], 0
  buffer_store_dwordx4 v[64:67], v2, s[16:19], s6 offen offset:0 sc1
  ds_read_b64_tr_b16 a[126:127], v21 offset:22528
  v_mfma_f32_16x16x32_bf16 v[148:151], a[100:103], a[76:79], 0
  v_add_u32 v16, s66, v16
  v_add_u32 v17, s66, v17
  v_mfma_f32_16x16x32_bf16 v[104:107], a[104:107], a[64:67], 0
  v_add_u32 v18, s66, v18
  v_add_u32 v19, s66, v19
  v_mfma_f32_16x16x32_bf16 v[120:123], a[104:107], a[68:71], 0
  v_add_u32 v20, s66, v20
  v_add_u32 v21, s66, v21
  v_mfma_f32_16x16x32_bf16 v[136:139], a[104:107], a[72:75], 0
  buffer_store_dwordx4 v[68:71], v2, s[16:19], s6 offen offset:1024 sc1
  v_mfma_f32_16x16x32_bf16 v[152:155], a[104:107], a[76:79], 0
  buffer_store_dwordx4 v[72:75], v2, s[16:19], s6 offen offset:2048 sc1
  v_mfma_f32_16x16x32_bf16 v[108:111], a[108:111], a[64:67], 0
  buffer_store_dwordx4 v[76:79], v2, s[16:19], s6 offen offset:3072 sc1
  v_mfma_f32_16x16x32_bf16 v[124:127], a[108:111], a[68:71], 0
  buffer_store_dwordx4 v[80:83], v2, s[16:19], s7 offen offset:0 sc1
  v_mfma_f32_16x16x32_bf16 v[140:143], a[108:111], a[72:75], 0
  buffer_store_dwordx4 v[84:87], v2, s[16:19], s7 offen offset:1024 sc1
  v_mfma_f32_16x16x32_bf16 v[156:159], a[108:111], a[76:79], 0
  buffer_store_dwordx4 v[88:91], v2, s[16:19], s7 offen offset:2048 sc1
  buffer_store_dwordx4 v[92:95], v2, s[16:19], s7 offen offset:3072 sc1
  s_branch Lp7
Lp6_late:
  v_mfma_f32_16x16x32_bf16 v[32:35], a[112:115], a[80:83], v[32:35]
  s_add_u32 m0, s64, 16384
  ds_read_b128 a[64:67], v16 offset:0
  ds_read_b64_tr_b16 a[96:97], v18 offset:16384
  v_mfma_f32_16x16x32_bf16 v[48:51], a[112:115], a[84:87], v[48:51]
  buffer_load_dwordx4 v10, s[12:15], s71 offen offset:0 lds
  ds_read_b64_tr_b16 a[98:99], v18 offset:18432
  v_mfma_f32_16x16x32_bf16 v[64:67], a[112:115], a[88:91], v[64:67]
  ds_read_b128 a[68:71], v16 offset:1024
  ds_read_b128 a[72:75], v17 offset:0
  v_mfma_f32_16x16x32_bf16 v[80:83], a[112:115], a[92:95], v[80:83]
  ds_read_b128 a[76:79], v17 offset:1024
  ds_read_b64_tr_b16 a[100:101], v19 offset:16384
  v_mfma_f32_16x16x32_bf16 v[36:39], a[116:119], a[80:83], v[36:39]
  ds_read_b64_tr_b16 a[102:103], v19 offset:18432
  ds_read_b64_tr_b16 a[104:105], v20 offset:16384
  v_mfma_f32_16x16x32_bf16 v[52:55], a[116:119], a[84:87], v[52:55]
  ds_read_b64_tr_b16 a[106:107], v20 offset:18432
  ds_read_b64_tr_b16 a[108:109], v21 offset:16384
  v_mfma_f32_16x16x32_bf16 v[68:71], a[116:119], a[88:91], v[68:71]
  ds_read_b64_tr_b16 a[110:111], v21 offset:18432
  v_mfma_f32_16x16x32_bf16 v[84:87], a[116:119], a[92:95], v[84:87]
  buffer_load_dwordx4 v11, s[12:15], s71 offen offset:1024 lds
  v_mfma_f32_16x16x32_bf16 v[40:43], a[120:123], a[80:83], v[40:43]
  v_mfma_f32_16x16x32_bf16 v[56:59], a[120:123], a[84:87], v[56:59]
  v_mfma_f32_16x16x32_bf16 v[72:75], a[120:123], a[88:91], v[72:75]
  v_mfma_f32_16x16x32_bf16 v[88:91], a[120:123], a[92:95], v[88:91]
  v_mfma_f32_16x16x32_bf16 v[44:47], a[124:127], a[80:83], v[44:47]
  v_mfma_f32_16x16x32_bf16 v[60:63], a[124:127], a[84:87], v[60:63]
  v_mfma_f32_16x16x32_bf16 v[76:79], a[124:127], a[88:91], v[76:79]
  v_mfma_f32_16x16x32_bf16 v[92:95], a[124:127], a[92:95], v[92:95]
  s_waitcnt lgkmcnt(0)
  v_mfma_f32_16x16x32_bf16 v[32:35], a[96:99], a[64:67], v[32:35]
  buffer_load_dwordx4 v12, s[12:15], s71 offen offset:2048 lds
  ds_read_b128 a[80:83], v16 offset:8192
  v_mfma_f32_16x16x32_bf16 v[48:51], a[96:99], a[68:71], v[48:51]
  ds_read_b64_tr_b16 a[112:113], v18 offset:20480
  ds_read_b64_tr_b16 a[114:115], v18 offset:22528
  v_mfma_f32_16x16x32_bf16 v[64:67], a[96:99], a[72:75], v[64:67]
  ds_read_b128 a[84:87], v16 offset:9216
  ds_read_b128 a[88:91], v17 offset:8192
  v_mfma_f32_16x16x32_bf16 v[80:83], a[96:99], a[76:79], v[80:83]
  ds_read_b128 a[92:95], v17 offset:9216
  ds_read_b64_tr_b16 a[116:117], v19 offset:20480
  v_mfma_f32_16x16x32_bf16 v[36:39], a[100:103], a[64:67], v[36:39]
  buffer_load_dwordx4 v13, s[12:15], s71 offen offset:3072 lds
  ds_read_b64_tr_b16 a[118:119], v19 offset:22528
  v_mfma_f32_16x16x32_bf16 v[52:55], a[100:103], a[68:71], v[52:55]
  s_bfe_u32 s72, 0x302011a, s31
  s_add_u32 s30, s30, s72
  s_add_u32 s31, s31, 8
  v_mfma_f32_16x16x32_bf16 v[68:71], a[100:103], a[72:75], v[68:71]
  s_and_b32 s31, s31, 0x8001f
  s_cmp_ge_u32 s30, 28
  s_cselect_b32 s72, 28, 0
  v_mfma_f32_16x16x32_bf16 v[84:87], a[100:103], a[76:79], v[84:87]
  s_sub_u32 s30, s30, s72
  s_lshl_b32 s72, s30, 17
  s_add_u32 s71, s93, s72
  v_mfma_f32_16x16x32_bf16 v[40:43], a[104:107], a[64:67], v[40:43]
  s_add_u32 s64, s64, s66
  ds_read_b64_tr_b16 a[120:121], v20 offset:20480
  ds_read_b64_tr_b16 a[122:123], v20 offset:22528
  v_mfma_f32_16x16x32_bf16 v[56:59], a[104:107], a[68:71], v[56:59]
  s_add_u32 s65, s65, 1
  ds_read_b64_tr_b16 a[124:125], v21 offset:20480
  ds_read_b64_tr_b16 a[126:127], v21 offset:22528
  v_mfma_f32_16x16x32_bf16 v[72:75], a[104:107], a[72:75], v[72:75]
  s_cmp_eq_u32 s65, 4
  s_cselect_b32 s65, 0, s65
  s_cselect_b32 s66, s67, s68
  v_mfma_f32_16x16x32_bf16 v[88:91], a[104:107], a[76:79], v[88:91]
  v_add_u32 v16, s66, v16
  v_add_u32 v17, s66, v17
  v_mfma_f32_16x16x32_bf16 v[44:47], a[108:111], a[64:67], v[44:47]
  v_add_u32 v18, s66, v18
  v_add_u32 v19, s66, v19
  v_mfma_f32_16x16x32_bf16 v[60:63], a[108:111], a[68:71], v[60:63]
  v_add_u32 v20, s66, v20
  v_add_u32 v21, s66, v21
  v_mfma_f32_16x16x32_bf16 v[76:79], a[108:111], a[72:75], v[76:79]
  v_mfma_f32_16x16x32_bf16 v[92:95], a[108:111], a[76:79], v[92:95]
  s_waitcnt vmcnt(4) lgkmcnt(0)
  s_barrier
  v_mfma_f32_16x16x32_bf16 v[32:35], a[112:115], a[80:83], v[32:35]
  s_add_u32 m0, s64, 16384
  ds_read_b128 a[64:67], v16 offset:0
  ds_read_b64_tr_b16 a[96:97], v18 offset:16384
  v_mfma_f32_16x16x32_bf16 v[48:51], a[112:115], a[84:87], v[48:51]
  buffer_load_dwordx4 v10, s[12:15], s71 offen offset:0 lds
  ds_read_b64_tr_b16 a[98:99], v18 offset:18432
  v_mfma_f32_16x16x32_bf16 v[64:67], a[112:115], a[88:91], v[64:67]
  ds_read_b128 a[68:71], v16 offset:1024
  ds_read_b128 a[72:75], v17 offset:0
  v_mfma_f32_16x16x32_bf16 v[80:83], a[112:115], a[92:95], v[80:83]
  ds_read_b128 a[76:79], v17 offset:1024
  ds_read_b64_tr_b16 a[100:101], v19 offset:16384
  v_mfma_f32_16x16x32_bf16 v[36:39], a[116:119], a[80:83], v[36:39]
  ds_read_b64_tr_b16 a[102:103], v19 offset:18432
  ds_read_b64_tr_b16 a[104:105], v20 offset:16384
  v_mfma_f32_16x16x32_bf16 v[52:55], a[116:119], a[84:87], v[52:55]
  buffer_load_dwordx4 v11, s[12:15], s71 offen offset:1024 lds
  ds_read_b64_tr_b16 a[106:107], v20 offset:18432
  v_mfma_f32_16x16x32_bf16 v[68:71], a[116:119], a[88:91], v[68:71]
  ds_read_b64_tr_b16 a[108:109], v21 offset:16384
  ds_read_b64_tr_b16 a[110:111], v21 offset:18432
  v_mfma_f32_16x16x32_bf16 v[84:87], a[116:119], a[92:95], v[84:87]
  v_mfma_f32_16x16x32_bf16 v[40:43], a[120:123], a[80:83], v[40:43]
  v_mfma_f32_16x16x32_bf16 v[56:59], a[120:123], a[84:87], v[56:59]
  v_mfma_f32_16x16x32_bf16 v[72:75], a[120:123], a[88:91], v[72:75]
  buffer_load_dwordx4 v12, s[12:15], s71 offen offset:2048 lds
  v_mfma_f32_16x16x32_bf16 v[88:91], a[120:123], a[92:95], v[88:91]
  v_mfma_f32_16x16x32_bf16 v[44:47], a[124:127], a[80:83], v[44:47]
  v_mfma_f32_16x16x32_bf16 v[60:63], a[124:127], a[84:87], v[60:63]
  v_mfma_f32_16x16x32_bf16 v[76:79], a[124:127], a[88:91], v[76:79]
  v_mfma_f32_16x16x32_bf16 v[92:95], a[124:127], a[92:95], v[92:95]
  s_waitcnt lgkmcnt(0)
  v_mfma_f32_16x16x32_bf16 v[32:35], a[96:99], a[64:67], v[32:35]
  buffer_load_dwordx4 v13, s[12:15], s71 offen offset:3072 lds
  ds_read_b128 a[80:83], v16 offset:8192
  v_mfma_f32_16x16x32_bf16 v[48:51], a[96:99], a[68:71], v[48:51]
  s_bfe_u32 s72, 0x302011a, s31
  s_add_u32 s30, s30, s72
  s_add_u32 s31, s31, 8
  v_mfma_f32_16x16x32_bf16 v[64:67], a[96:99], a[72:75], v[64:67]
  s_and_b32 s31, s31, 0x8001f
  s_cmp_ge_u32 s30, 28
  s_cselect_b32 s72, 28, 0
  v_mfma_f32_16x16x32_bf16 v[80:83], a[96:99], a[76:79], v[80:83]
  s_sub_u32 s30, s30, s72
  s_lshl_b32 s72, s30, 17
  s_add_u32 s71, s93, s72
  v_mfma_f32_16x16x32_bf16 v[36:39], a[100:103], a[64:67], v[36:39]
  buffer_load_dwordx2 v[6:7], v14, s[96:99], s91 offen sc1
  ds_read_b64_tr_b16 a[112:113], v18 offset:20480
  v_mfma_f32_16x16x32_bf16 v[52:55], a[100:103], a[68:71], v[52:55]
  s_add_u32 s64, s64, s66
  ds_read_b64_tr_b16 a[114:115], v18 offset:22528
  ds_read_b128 a[84:87], v16 offset:9216
  v_mfma_f32_16x16x32_bf16 v[68:71], a[100:103], a[72:75], v[68:71]
  s_add_u32 s65, s65, 1
  ds_read_b128 a[88:91], v17 offset:8192
  ds_read_b128 a[92:95], v17 offset:9216
  v_mfma_f32_16x16x32_bf16 v[84:87], a[100:103], a[76:79], v[84:87]
  s_cmp_eq_u32 s65, 4
  s_cselect_b32 s65, 0, s65
  s_cselect_b32 s66, s67, s68
  ds_read_b64_tr_b16 a[116:117], v19 offset:20480
  ds_read_b64_tr_b16 a[118:119], v19 offset:22528
  v_mfma_f32_16x16x32_bf16 v[40:43], a[104:107], a[64:67], v[40:43]
  ds_read_b64_tr_b16 a[120:121], v20 offset:20480
  ds_read_b64_tr_b16 a[122:123], v20 offset:22528
  v_mfma_f32_16x16x32_bf16 v[56:59], a[104:107], a[68:71], v[56:59]
  ds_read_b64_tr_b16 a[124:125], v21 offset:20480
  ds_read_b64_tr_b16 a[126:127], v21 offset:22528
  v_mfma_f32_16x16x32_bf16 v[72:75], a[104:107], a[72:75], v[72:75]
  v_add_u32 v16, s66, v16
  v_add_u32 v17, s66, v17
  v_mfma_f32_16x16x32_bf16 v[88:91], a[104:107], a[76:79], v[88:91]
  v_add_u32 v18, s66, v18
  v_add_u32 v19, s66, v19
  v_mfma_f32_16x16x32_bf16 v[44:47], a[108:111], a[64:67], v[44:47]
  v_add_u32 v20, s66, v20
  v_add_u32 v21, s66, v21
  v_mfma_f32_16x16x32_bf16 v[60:63], a[108:111], a[68:71], v[60:63]
  v_mfma_f32_16x16x32_bf16 v[76:79], a[108:111], a[72:75], v[76:79]
  v_mfma_f32_16x16x32_bf16 v[92:95], a[108:111], a[76:79], v[92:95]
  s_waitcnt vmcnt(0) lgkmcnt(0)
  s_barrier
  s_mov_b32 s5, 0x40000
Lpoll_9:
  v_cmp_ne_u64 vcc, s[94:95], v[6:7]
  s_nop 0
  s_cbranch_vccz Lpolld_10
  s_sleep 4
  buffer_load_dwordx2 v[6:7], v14, s[96:99], s91 offen sc1
  s_sub_u32 s5, s5, 1
  s_waitcnt vmcnt(0)
  s_cbranch_scc0 Lpoll_9
Lpolld_10:
  s_add_u32 s8, s86, 67108864
  s_addc_u32 s9, s87, 0
  s_mov_b32 s10, 16777216
  s_mov_b32 s11, 0x00020000
  s_lshl_b32 s92, s73, 1
  s_add_u32 s92, s92, s77
  s_lshl_b32 s92, s92, 19
  s_add_u32 s92, s92, s79
  s_add_u32 s72, s73, s76
  s_and_b32 s1, s72, 3
  s_lshl_b32 s1, s1, 3
  s_or_b32 s1, s1, 0x80000
  s_bfe_u32 s0, 0x1b1b02, s1
  s_add_u32 s0, s0, 0
  s_cmp_ge_u32 s0, 28
  s_cselect_b32 s72, 28, 0
  s_sub_u32 s0, s0, s72
  s_lshl_b32 s72, s0, 14
  s_add_u32 s70, s92, s72
  v_mfma_f32_16x16x32_bf16 v[32:35], a[112:115], a[80:83], v[32:35]
  s_add_u32 m0, s79, 131072
  v_mfma_f32_16x16x32_bf16 v[48:51], a[112:115], a[84:87], v[48:51]
  buffer_load_dwordx4 v2, s[8:11], s70 offen offset:0 sc1 lds
  v_mfma_f32_16x16x32_bf16 v[64:67], a[112:115], a[88:91], v[64:67]
  buffer_load_dwordx4 v2, s[8:11], s70 offen offset:1024 sc1 lds
  v_mfma_f32_16x16x32_bf16 v[80:83], a[112:115], a[92:95], v[80:83]
  buffer_load_dwordx4 v2, s[8:11], s70 offen offset:2048 sc1 lds
  v_mfma_f32_16x16x32_bf16 v[36:39], a[116:119], a[80:83], v[36:39]
  buffer_load_dwordx4 v2, s[8:11], s70 offen offset:3072 sc1 lds
  v_mfma_f32_16x16x32_bf16 v[52:55], a[116:119], a[84:87], v[52:55]
  s_bfe_u32 s72, 0x302011a, s1
  s_add_u32 s0, s0, s72
  s_add_u32 s1, s1, 8
  v_mfma_f32_16x16x32_bf16 v[68:71], a[116:119], a[88:91], v[68:71]
  s_and_b32 s1, s1, 0x8001f
  s_cmp_ge_u32 s0, 28
  s_cselect_b32 s72, 28, 0
  v_mfma_f32_16x16x32_bf16 v[84:87], a[116:119], a[92:95], v[84:87]
  s_sub_u32 s0, s0, s72
  s_lshl_b32 s72, s0, 14
  s_add_u32 s70, s92, s72
  v_mfma_f32_16x16x32_bf16 v[40:43], a[120:123], a[80:83], v[40:43]
  s_add_u32 m0, s79, 32768
  v_mfma_f32_16x16x32_bf16 v[56:59], a[120:123], a[84:87], v[56:59]
  buffer_load_dwordx4 v2, s[8:11], s70 offen offset:0 sc1 lds
  v_mfma_f32_16x16x32_bf16 v[72:75], a[120:123], a[88:91], v[72:75]
  buffer_load_dwordx4 v2, s[8:11], s70 offen offset:1024 sc1 lds
  v_mfma_f32_16x16x32_bf16 v[88:91], a[120:123], a[92:95], v[88:91]
  buffer_load_dwordx4 v2, s[8:11], s70 offen offset:2048 sc1 lds
  v_mfma_f32_16x16x32_bf16 v[44:47], a[124:127], a[80:83], v[44:47]
  buffer_load_dwordx4 v2, s[8:11], s70 offen offset:3072 sc1 lds
  v_mfma_f32_16x16x32_bf16 v[60:63], a[124:127], a[84:87], v[60:63]
  s_bfe_u32 s72, 0x302011a, s1
  s_add_u32 s0, s0, s72
  s_add_u32 s1, s1, 8
  v_mfma_f32_16x16x32_bf16 v[76:79], a[124:127], a[88:91], v[76:79]
  s_and_b32 s1, s1, 0x8001f
  s_cmp_ge_u32 s0, 28
  s_cselect_b32 s72, 28, 0
  v_mfma_f32_16x16x32_bf16 v[92:95], a[124:127], a[92:95], v[92:95]
  s_sub_u32 s0, s0, s72
  s_lshl_b32 s72, s0, 14
  s_add_u32 s70, s92, s72
  s_add_u32 m0, s79, 65536
  s_nop 0
  buffer_load_dwordx4 v2, s[8:11], s70 offen offset:0 sc1 lds
  buffer_load_dwordx4 v2, s[8:11], s70 offen offset:1024 sc1 lds
  buffer_load_dwordx4 v2, s[8:11], s70 offen offset:2048 sc1 lds
  buffer_load_dwordx4 v2, s[8:11], s70 offen offset:3072 sc1 lds
  s_bfe_u32 s72, 0x302011a, s1
  s_add_u32 s0, s0, s72
  s_add_u32 s1, s1, 8
  s_and_b32 s1, s1, 0x8001f
  s_cmp_ge_u32 s0, 28
  s_cselect_b32 s72, 28, 0
  s_sub_u32 s0, s0, s72
  s_lshl_b32 s72, s0, 14
  s_add_u32 s70, s92, s72
  s_add_u32 m0, s79, 114688
  s_nop 0
  buffer_load_dwordx4 v10, s[12:15], s71 offen offset:0 lds
  buffer_load_dwordx4 v11, s[12:15], s71 offen offset:1024 lds
  buffer_load_dwordx4 v12, s[12:15], s71 offen offset:2048 lds
  buffer_load_dwordx4 v13, s[12:15], s71 offen offset:3072 lds
  s_bfe_u32 s72, 0x302011a, s31
  s_add_u32 s30, s30, s72
  s_add_u32 s31, s31, 8
  s_and_b32 s31, s31, 0x8001f
  s_cmp_ge_u32 s30, 28
  s_cselect_b32 s72, 28, 0
  s_sub_u32 s30, s30, s72
  s_lshl_b32 s72, s30, 17
  s_add_u32 s71, s93, s72
  s_add_u32 m0, s79, 98304
  s_nop 0
  buffer_load_dwordx4 v2, s[8:11], s70 offen offset:0 sc1 lds
  buffer_load_dwordx4 v2, s[8:11], s70 offen offset:1024 sc1 lds
  buffer_load_dwordx4 v2, s[8:11], s70 offen offset:2048 sc1 lds
  buffer_load_dwordx4 v2, s[8:11], s70 offen offset:3072 sc1 lds
  s_bfe_u32 s72, 0x302011a, s1
  s_add_u32 s0, s0, s72
  s_add_u32 s1, s1, 8
  s_and_b32 s1, s1, 0x8001f
  s_cmp_ge_u32 s0, 28
  s_cselect_b32 s72, 28, 0
  s_sub_u32 s0, s0, s72
  s_lshl_b32 s72, s0, 14
  s_add_u32 s70, s92, s72
  s_lshl_b32 s6, s78, 1
  s_add_u32 s6, s6, s77
  s_xor_b32 s6, s6, 1
  s_lshl_b32 s6, s6, 2
  s_add_u32 s6, s6, s3
  s_lshl_b32 s6, s6, 13
  s_add_u32 s6, s6, 8388608
  s_add_u32 s7, s6, 4096
  buffer_store_dwordx4 v[64:67], v2, s[16:19], s6 offen offset:0 sc1
  buffer_store_dwordx4 v[68:71], v2, s[16:19], s6 offen offset:1024 sc1
  buffer_store_dwordx4 v[72:75], v2, s[16:19], s6 offen offset:2048 sc1
  buffer_store_dwordx4 v[76:79], v2, s[16:19], s6 offen offset:3072 sc1
  buffer_store_dwordx4 v[80:83], v2, s[16:19], s7 offen offset:0 sc1
  buffer_store_dwordx4 v[84:87], v2, s[16:19], s7 offen offset:1024 sc1
  buffer_store_dwordx4 v[88:91], v2, s[16:19], s7 offen offset:2048 sc1
  buffer_store_dwordx4 v[92:95], v2, s[16:19], s7 offen offset:3072 sc1
  s_waitcnt vmcnt(24)
  s_barrier
  ds_read_b128 a[64:67], v16 offset:0
  ds_read_b64_tr_b16 a[96:97], v18 offset:16384
  ds_read_b64_tr_b16 a[98:99], v18 offset:18432
  ds_read_b128 a[68:71], v16 offset:1024
  ds_read_b128 a[72:75], v17 offset:0
  ds_read_b128 a[76:79], v17 offset:1024
  ds_read_b64_tr_b16 a[100:101], v19 offset:16384
  ds_read_b64_tr_b16 a[102:103], v19 offset:18432
  ds_read_b64_tr_b16 a[104:105], v20 offset:16384
  ds_read_b64_tr_b16 a[106:107], v20 offset:18432
  ds_read_b64_tr_b16 a[108:109], v21 offset:16384
  ds_read_b64_tr_b16 a[110:111], v21 offset:18432
  s_waitcnt lgkmcnt(0)
  v_mfma_f32_16x16x32_bf16 v[96:99], a[96:99], a[64:67], 0
  s_add_u32 s64, s64, s66
  ds_read_b128 a[80:83], v16 offset:8192
  ds_read_b64_tr_b16 a[112:113], v18 offset:20480
  v_mfma_f32_16x16x32_bf16 v[112:115], a[96:99], a[68:71], 0
  s_add_u32 s65, s65, 1
  ds_read_b64_tr_b16 a[114:115], v18 offset:22528
  ds_read_b128 a[84:87], v16 offset:9216
  v_mfma_f32_16x16x32_bf16 v[128:131], a[96:99], a[72:75], 0
  s_cmp_eq_u32 s65, 4
  s_cselect_b32 s65, 0, s65
  s_cselect_b32 s66, s67, s68
  ds_read_b128 a[88:91], v17 offset:8192
  ds_read_b128 a[92:95], v17 offset:9216
  v_mfma_f32_16x16x32_bf16 v[144:147], a[96:99], a[76:79], 0
  ds_read_b64_tr_b16 a[116:117], v19 offset:20480
  v_mfma_f32_16x16x32_bf16 v[100:103], a[100:103], a[64:67], 0
  ds_read_b64_tr_b16 a[118:119], v19 offset:22528
  ds_read_b64_tr_b16 a[120:121], v20 offset:20480
  v_mfma_f32_16x16x32_bf16 v[116:119], a[100:103], a[68:71], 0
  ds_read_b64_tr_b16 a[122:123], v20 offset:22528
  ds_read_b64_tr_b16 a[124:125], v21 offset:20480
  v_mfma_f32_16x16x32_bf16 v[132:135], a[100:103], a[72:75], 0
  ds_read_b64_tr_b16 a[126:127], v21 offset:22528
  v_mfma_f32_16x16x32_bf16 v[148:151], a[100:103], a[76:79], 0
  v_add_u32 v16, s66, v16
  v_add_u32 v17, s66, v17
  v_mfma_f32_16x16x32_bf16 v[104:107], a[104:107], a[64:67], 0
  v_add_u32 v18, s66, v18
  v_add_u32 v19, s66, v19
  v_mfma_f32_16x16x32_bf16 v[120:123], a[104:107], a[68:71], 0
  v_add_u32 v20, s66, v20
  v_add_u32 v21, s66, v21
  v_mfma_f32_16x16x32_bf16 v[136:139], a[104:107], a[72:75], 0
  v_mfma_f32_16x16x32_bf16 v[152:155], a[104:107], a[76:79], 0
  v_mfma_f32_16x16x32_bf16 v[108:111], a[108:111], a[64:67], 0
  v_mfma_f32_16x16x32_bf16 v[124:127], a[108:111], a[68:71], 0
  v_mfma_f32_16x16x32_bf16 v[140:143], a[108:111], a[72:75], 0
  v_mfma_f32_16x16x32_bf16 v[156:159], a[108:111], a[76:79], 0
Lp7:
  s_mov_b32 s69, 23
  s_waitcnt vmcnt(16) lgkmcnt(0)
  s_barrier
  .p2align 6
Lp7_loop:
  v_mfma_f32_16x16x32_bf16 v[96:99], a[112:115], a[80:83], v[96:99]
  s_add_u32 m0, s64, 16384
  ds_read_b128 a[64:67], v16 offset:0
  ds_read_b64_tr_b16 a[96:97], v18 offset:16384
  v_mfma_f32_16x16x32_bf16 v[112:115], a[112:115], a[84:87], v[112:115]
  buffer_load_dwordx4 v10, s[12:15], s71 offen offset:0 lds
  ds_read_b64_tr_b16 a[98:99], v18 offset:18432
  v_mfma_f32_16x16x32_bf16 v[128:131], a[112:115], a[88:91], v[128:131]
  ds_read_b128 a[68:71], v16 offset:1024
  ds_read_b128 a[72:75], v17 offset:0
  v_mfma_f32_16x16x32_bf16 v[144:147], a[112:115], a[92:95], v[144:147]
  buffer_load_dwordx4 v11, s[12:15], s71 offen offset:1024 lds
  ds_read_b128 a[76:79], v17 offset:1024
  v_mfma_f32_16x16x32_bf16 v[100:103], a[116:119], a[80:83], v[100:103]
  ds_read_b64_tr_b16 a[100:101], v19 offset:16384
  ds_read_b64_tr_b16 a[102:103], v19 offset:18432
  v_mfma_f32_16x16x32_bf16 v[116:119], a[116:119], a[84:87], v[116:119]
  ds_read_b64_tr_b16 a[104:105], v20 offset:16384
  ds_read_b64_tr_b16 a[106:107], v20 offset:18432
  v_mfma_f32_16x16x32_bf16 v[132:135], a[116:119], a[88:91], v[132:135]
  ds_read_b64_tr_b16 a[108:109], v21 offset:16384
  ds_read_b64_tr_b16 a[110:111], v21 offset:18432
  v_mfma_f32_16x16x32_bf16 v[148:151], a[116:119], a[92:95], v[148:151]
  buffer_load_dwordx4 v12, s[12:15], s71 offen offset:2048 lds
  v_mfma_f32_16x16x32_bf16 v[104:107], a[120:123], a[80:83], v[104:107]
  v_mfma_f32_16x16x32_bf16 v[120:123], a[120:123], a[84:87], v[120:123]
  v_mfma_f32_16x16x32_bf16 v[136:139], a[120:123], a[88:91], v[136:139]
  v_mfma_f32_16x16x32_bf16 v[152:155], a[120:123], a[92:95], v[152:155]
  buffer_load_dwordx4 v13, s[12:15], s71 offen offset:3072 lds
  v_mfma_f32_16x16x32_bf16 v[108:111], a[124:127], a[80:83], v[108:111]
  s_bfe_u32 s72, 0x302011a, s31
  s_add_u32 s30, s30, s72
  s_add_u32 s31, s31, 8
  v_mfma_f32_16x16x32_bf16 v[124:127], a[124:127], a[84:87], v[124:127]
  s_and_b32 s31, s31, 0x8001f
  s_cmp_ge_u32 s30, 28
  s_cselect_b32 s72, 28, 0
  v_mfma_f32_16x16x32_bf16 v[140:143], a[124:127], a[88:91], v[140:143]
  s_sub_u32 s30, s30, s72
  s_lshl_b32 s72, s30, 17
  s_add_u32 s71, s93, s72
  v_mfma_f32_16x16x32_bf16 v[156:159], a[124:127], a[92:95], v[156:159]
  s_waitcnt lgkmcnt(0)
  v_mfma_f32_16x16x32_bf16 v[96:99], a[96:99], a[64:67], v[96:99]
  s_mov_b32 m0, s64
  ds_read_b128 a[80:83], v16 offset:8192
  ds_read_b64_tr_b16 a[112:113], v18 offset:20480
  v_mfma_f32_16x16x32_bf16 v[112:115], a[96:99], a[68:71], v[112:115]
  buffer_load_dwordx4 v2, s[8:11], s70 offen offset:0 sc1 lds
  ds_read_b64_tr_b16 a[114:115], v18 offset:22528
  v_mfma_f32_16x16x32_bf16 v[128:131], a[96:99], a[72:75], v[128:131]
  buffer_load_dwordx4 v2, s[8:11], s70 offen offset:1024 sc1 lds
  ds_read_b128 a[84:87], v16 offset:9216
  v_mfma_f32_16x16x32_bf16 v[144:147], a[96:99], a[76:79], v[144:147]
  ds_read_b128 a[88:91], v17 offset:8192
  ds_read_b128 a[92:95], v17 offset:9216
  v_mfma_f32_16x16x32_bf16 v[100:103], a[100:103], a[64:67], v[100:103]
  buffer_load_dwordx4 v2, s[8:11], s70 offen offset:2048 sc1 lds
  ds_read_b64_tr_b16 a[116:117], v19 offset:20480
  v_mfma_f32_16x16x32_bf16 v[116:119], a[100:103], a[68:71], v[116:119]
  ds_read_b64_tr_b16 a[118:119], v19 offset:22528
  ds_read_b64_tr_b16 a[120:121], v20 offset:20480
  v_mfma_f32_16x16x32_bf16 v[132:135], a[100:103], a[72:75], v[132:135]
  buffer_load_dwordx4 v2, s[8:11], s70 offen offset:3072 sc1 lds
  ds_read_b64_tr_b16 a[122:123], v20 offset:22528
  v_mfma_f32_16x16x32_bf16 v[148:151], a[100:103], a[76:79], v[148:151]
  s_bfe_u32 s72, 0x302011a, s1
  s_add_u32 s0, s0, s72
  s_add_u32 s1, s1, 8
  v_mfma_f32_16x16x32_bf16 v[104:107], a[104:107], a[64:67], v[104:107]
  s_and_b32 s1, s1, 0x8001f
  s_cmp_ge_u32 s0, 28
  s_cselect_b32 s72, 28, 0
  v_mfma_f32_16x16x32_bf16 v[120:123], a[104:107], a[68:71], v[120:123]
  s_sub_u32 s0, s0, s72
  s_lshl_b32 s72, s0, 14
  s_add_u32 s70, s92, s72
  v_mfma_f32_16x16x32_bf16 v[136:139], a[104:107], a[72:75], v[136:139]
  s_add_u32 s64, s64, s66
  ds_read_b64_tr_b16 a[124:125], v21 offset:20480
  ds_read_b64_tr_b16 a[126:127], v21 offset:22528
  v_mfma_f32_16x16x32_bf16 v[152:155], a[104:107], a[76:79], v[152:155]
  s_add_u32 s65, s65, 1
  s_cmp_eq_u32 s65, 4
  s_cselect_b32 s65, 0, s65
  s_cselect_b32 s66, s67, s68
  v_mfma_f32_16x16x32_bf16 v[108:111], a[108:111], a[64:67], v[108:111]
  v_add_u32 v16, s66, v16
  v_add_u32 v17, s66, v17
  v_mfma_f32_16x16x32_bf16 v[124:127], a[108:111], a[68:71], v[124:127]
  s_waitcnt vmcnt(16) lgkmcnt(0)
  s_barrier
  v_add_u32 v18, s66, v18
  v_add_u32 v19, s66, v19
  v_mfma_f32_16x16x32_bf16 v[140:143], a[108:111], a[72:75], v[140:143]
  s_sub_u32 s69, s69, 1
  v_add_u32 v20, s66, v20
  v_add_u32 v21, s66, v21
  v_mfma_f32_16x16x32_bf16 v[156:159], a[108:111], a[76:79], v[156:159]
  s_cmp_lg_u32 s69, 0
  s_cbranch_scc1 Lp7_loop
  s_lshl_b32 s6, s78, 1
  s_add_u32 s6, s6, s77
  s_lshl_b32 s6, s6, 7
  s_add_u32 s6, s6, 163840
  v_mov_b32 v8, 0x40000000
  v_mov_b32 v6, s94
  v_cmp_eq_u32 vcc, 0, v0
  v_mov_b32 v7, s95
  s_nop 0
  v_cndmask_b32_e64 v8, v8, 0, vcc
  buffer_store_dwordx2 v[6:7], v8, s[96:99], s6 offen sc1
  s_lshl_b32 s90, s78, 1
  s_add_u32 s90, s90, s77
  s_xor_b32 s90, s90, 1
  s_lshl_b32 s90, s90, 7
  s_add_u32 s90, s90, 163840
  s_mov_b32 s20, s82
  s_mov_b32 s21, s83
  s_mov_b32 s22, 8388608
  s_mov_b32 s23, 0x00020000
  v_bfe_u32 v25, v1, 4, 1
  v_lshrrev_b32 v26, 5, v1
  v_lshl_or_b32 v25, v25, 1, v26
  v_lshlrev_b32 v25, 4, v25
  v_and_b32 v24, 15, v1
  v_lshl_add_u32 v26, v24, 14, v25
  v_lshl_add_u32 v27, v24, 12, v25
  v_mfma_f32_16x16x32_bf16 v[96:99], a[112:115], a[80:83], v[96:99]
  s_add_u32 m0, s64, 16384
  ds_read_b128 a[64:67], v16 offset:0
  ds_read_b64_tr_b16 a[96:97], v18 offset:16384
  v_mfma_f32_16x16x32_bf16 v[112:115], a[112:115], a[84:87], v[112:115]
  buffer_load_dwordx4 v10, s[12:15], s71 offen offset:0 lds
  ds_read_b64_tr_b16 a[98:99], v18 offset:18432
  v_mfma_f32_16x16x32_bf16 v[128:131], a[112:115], a[88:91], v[128:131]
  ds_read_b128 a[68:71], v16 offset:1024
  ds_read_b128 a[72:75], v17 offset:0
  v_mfma_f32_16x16x32_bf16 v[144:147], a[112:115], a[92:95], v[144:147]
  buffer_load_dwordx4 v11, s[12:15], s71 offen offset:1024 lds
  ds_read_b128 a[76:79], v17 offset:1024
  v_mfma_f32_16x16x32_bf16 v[100:103], a[116:119], a[80:83], v[100:103]
  ds_read_b64_tr_b16 a[100:101], v19 offset:16384
  ds_read_b64_tr_b16 a[102:103], v19 offset:18432
  v_mfma_f32_16x16x32_bf16 v[116:119], a[116:119], a[84:87], v[116:119]
  ds_read_b64_tr_b16 a[104:105], v20 offset:16384
  ds_read_b64_tr_b16 a[106:107], v20 offset:18432
  v_mfma_f32_16x16x32_bf16 v[132:135], a[116:119], a[88:91], v[132:135]
  ds_read_b64_tr_b16 a[108:109], v21 offset:16384
  ds_read_b64_tr_b16 a[110:111], v21 offset:18432
  v_mfma_f32_16x16x32_bf16 v[148:151], a[116:119], a[92:95], v[148:151]
  buffer_load_dwordx4 v12, s[12:15], s71 offen offset:2048 lds
  v_mfma_f32_16x16x32_bf16 v[104:107], a[120:123], a[80:83], v[104:107]
  v_mfma_f32_16x16x32_bf16 v[120:123], a[120:123], a[84:87], v[120:123]
  v_mfma_f32_16x16x32_bf16 v[136:139], a[120:123], a[88:91], v[136:139]
  v_mfma_f32_16x16x32_bf16 v[152:155], a[120:123], a[92:95], v[152:155]
  buffer_load_dwordx4 v13, s[12:15], s71 offen offset:3072 lds
  v_mfma_f32_16x16x32_bf16 v[108:111], a[124:127], a[80:83], v[108:111]
  s_bfe_u32 s72, 0x302011a, s31
  s_add_u32 s30, s30, s72
  s_add_u32 s31, s31, 8
  v_mfma_f32_16x16x32_bf16 v[124:127], a[124:127], a[84:87], v[124:127]
  s_and_b32 s31, s31, 0x8001f
  s_cmp_ge_u32 s30, 28
  s_cselect_b32 s72, 28, 0
  v_mfma_f32_16x16x32_bf16 v[140:143], a[124:127], a[88:91], v[140:143]
  s_sub_u32 s30, s30, s72
  s_lshl_b32 s72, s30, 17
  s_add_u32 s71, s93, s72
  v_mfma_f32_16x16x32_bf16 v[156:159], a[124:127], a[92:95], v[156:159]
  s_waitcnt lgkmcnt(0)
  v_mfma_f32_16x16x32_bf16 v[96:99], a[96:99], a[64:67], v[96:99]
  s_mov_b32 m0, s64
  ds_read_b128 a[80:83], v16 offset:8192
  ds_read_b64_tr_b16 a[112:113], v18 offset:20480
  v_mfma_f32_16x16x32_bf16 v[112:115], a[96:99], a[68:71], v[112:115]
  buffer_load_dwordx4 v2, s[8:11], s70 offen offset:0 sc1 lds
  ds_read_b64_tr_b16 a[114:115], v18 offset:22528
  v_mfma_f32_16x16x32_bf16 v[128:131], a[96:99], a[72:75], v[128:131]
  buffer_load_dwordx4 v2, s[8:11], s70 offen offset:1024 sc1 lds
  ds_read_b128 a[84:87], v16 offset:9216
  v_mfma_f32_16x16x32_bf16 v[144:147], a[96:99], a[76:79], v[144:147]
  ds_read_b128 a[88:91], v17 offset:8192
  ds_read_b128 a[92:95], v17 offset:9216
  v_mfma_f32_16x16x32_bf16 v[100:103], a[100:103], a[64:67], v[100:103]
  buffer_load_dwordx4 v2, s[8:11], s70 offen offset:2048 sc1 lds
  ds_read_b64_tr_b16 a[116:117], v19 offset:20480
  v_mfma_f32_16x16x32_bf16 v[116:119], a[100:103], a[68:71], v[116:119]
  ds_read_b64_tr_b16 a[118:119], v19 offset:22528
  ds_read_b64_tr_b16 a[120:121], v20 offset:20480
  v_mfma_f32_16x16x32_bf16 v[132:135], a[100:103], a[72:75], v[132:135]
  buffer_load_dwordx4 v2, s[8:11], s70 offen offset:3072 sc1 lds
  ds_read_b64_tr_b16 a[122:123], v20 offset:22528
  v_mfma_f32_16x16x32_bf16 v[148:151], a[100:103], a[76:79], v[148:151]
  s_bfe_u32 s72, 0x302011a, s1
  s_add_u32 s0, s0, s72
  s_add_u32 s1, s1, 8
  v_mfma_f32_16x16x32_bf16 v[104:107], a[104:107], a[64:67], v[104:107]
  s_and_b32 s1, s1, 0x8001f
  s_cmp_ge_u32 s0, 28
  s_cselect_b32 s72, 28, 0
  v_mfma_f32_16x16x32_bf16 v[120:123], a[104:107], a[68:71], v[120:123]
  s_sub_u32 s0, s0, s72
  s_lshl_b32 s72, s0, 14
  s_add_u32 s70, s92, s72
  v_mfma_f32_16x16x32_bf16 v[136:139], a[104:107], a[72:75], v[136:139]
  s_add_u32 s64, s64, s66
  ds_read_b64_tr_b16 a[124:125], v21 offset:20480
  ds_read_b64_tr_b16 a[126:127], v21 offset:22528
  v_mfma_f32_16x16x32_bf16 v[152:155], a[104:107], a[76:79], v[152:155]
  s_add_u32 s65, s65, 1
  s_cmp_eq_u32 s65, 4
  s_cselect_b32 s65, 0, s65
  s_cselect_b32 s66, s67, s68
  v_mfma_f32_16x16x32_bf16 v[108:111], a[108:111], a[64:67], v[108:111]
  v_add_u32 v16, s66, v16
  v_add_u32 v17, s66, v17
  v_mfma_f32_16x16x32_bf16 v[124:127], a[108:111], a[68:71], v[124:127]
  v_add_u32 v18, s66, v18
  v_add_u32 v19, s66, v19
  v_mfma_f32_16x16x32_bf16 v[140:143], a[108:111], a[72:75], v[140:143]
  v_add_u32 v20, s66, v20
  v_add_u32 v21, s66, v21
  v_mfma_f32_16x16x32_bf16 v[156:159], a[108:111], a[76:79], v[156:159]
  s_waitcnt vmcnt(17) lgkmcnt(0)
  s_barrier
  v_mfma_f32_16x16x32_bf16 v[96:99], a[112:115], a[80:83], v[96:99]
  buffer_load_dwordx2 v[6:7], off, s[96:99], s90 sc1
  ds_read_b128 a[64:67], v16 offset:0
  v_mfma_f32_16x16x32_bf16 v[112:115], a[112:115], a[84:87], v[112:115]
  s_and_b32 s88, s3, 1
  s_lshl_b32 s88, s88, 12
  s_lshr_b32 s72, s3, 1
  v_mfma_f32_16x16x32_bf16 v[128:131], a[112:115], a[88:91], v[128:131]
  s_lshl_b32 s72, s72, 13
  s_add_u32 s88, s88, s72
  s_lshl_b32 s72, s77, 11
  v_mfma_f32_16x16x32_bf16 v[144:147], a[112:115], a[92:95], v[144:147]
  s_add_u32 s88, s88, s72
  s_sub_u32 s88, s88, s79
  s_add_u32 s70, s92, s88
  v_mfma_f32_16x16x32_bf16 v[100:103], a[116:119], a[80:83], v[100:103]
  s_add_u32 s70, s70, 458752
  s_add_u32 s71, s93, 3670016
  s_add_u32 m0, s64, 16384
  v_mfma_f32_16x16x32_bf16 v[116:119], a[116:119], a[84:87], v[116:119]
  buffer_load_dwordx4 v10, s[12:15], s71 offen offset:0 lds
  ds_read_b64_tr_b16 a[96:97], v18 offset:16384
  v_mfma_f32_16x16x32_bf16 v[132:135], a[116:119], a[88:91], v[132:135]
  ds_read_b64_tr_b16 a[98:99], v18 offset:18432
  ds_read_b128 a[68:71], v16 offset:1024
  v_mfma_f32_16x16x32_bf16 v[148:151], a[116:119], a[92:95], v[148:151]
  buffer_load_dwordx4 v11, s[12:15], s71 offen offset:1024 lds
  ds_read_b128 a[72:75], v17 offset:0
  v_mfma_f32_16x16x32_bf16 v[104:107], a[120:123], a[80:83], v[104:107]
  ds_read_b128 a[76:79], v17 offset:1024
  ds_read_b64_tr_b16 a[100:101], v19 offset:16384
  v_mfma_f32_16x16x32_bf16 v[120:123], a[120:123], a[84:87], v[120:123]
  ds_read_b64_tr_b16 a[102:103], v19 offset:18432
  ds_read_b64_tr_b16 a[104:105], v20 offset:16384
  v_mfma_f32_16x16x32_bf16 v[136:139], a[120:123], a[88:91], v[136:139]
  ds_read_b64_tr_b16 a[106:107], v20 offset:18432
  ds_read_b64_tr_b16 a[108:109], v21 offset:16384
  v_mfma_f32_16x16x32_bf16 v[152:155], a[120:123], a[92:95], v[152:155]
  buffer_load_dwordx4 v12, s[12:15], s71 offen offset:2048 lds
  ds_read_b64_tr_b16 a[110:111], v21 offset:18432
  v_mfma_f32_16x16x32_bf16 v[108:111], a[124:127], a[80:83], v[108:111]
  v_mfma_f32_16x16x32_bf16 v[124:127], a[124:127], a[84:87], v[124:127]
  v_mfma_f32_16x16x32_bf16 v[140:143], a[124:127], a[88:91], v[140:143]
  v_mfma_f32_16x16x32_bf16 v[156:159], a[124:127], a[92:95], v[156:159]
  s_waitcnt lgkmcnt(0)
  v_mfma_f32_16x16x32_bf16 v[96:99], a[96:99], a[64:67], v[96:99]
  buffer_load_dwordx4 v13, s[12:15], s71 offen offset:3072 lds
  ds_read_b128 a[80:83], v16 offset:8192
  v_mfma_f32_16x16x32_bf16 v[112:115], a[96:99], a[68:71], v[112:115]
  s_add_u32 s71, s71, 131072
  s_add_u32 m0, s64, s88
  ds_read_b64_tr_b16 a[112:113], v18 offset:20480
  v_mfma_f32_16x16x32_bf16 v[128:131], a[96:99], a[72:75], v[128:131]
  ds_read_b64_tr_b16 a[114:115], v18 offset:22528
  ds_read_b128 a[84:87], v16 offset:9216
  v_mfma_f32_16x16x32_bf16 v[144:147], a[96:99], a[76:79], v[144:147]
  buffer_load_dwordx4 v2, s[8:11], s70 offen offset:0 sc1 lds
  ds_read_b128 a[88:91], v17 offset:8192
  v_mfma_f32_16x16x32_bf16 v[100:103], a[100:103], a[64:67], v[100:103]
  ds_read_b128 a[92:95], v17 offset:9216
  ds_read_b64_tr_b16 a[116:117], v19 offset:20480
  v_mfma_f32_16x16x32_bf16 v[116:119], a[100:103], a[68:71], v[116:119]
  ds_read_b64_tr_b16 a[118:119], v19 offset:22528
  ds_read_b64_tr_b16 a[120:121], v20 offset:20480
  v_mfma_f32_16x16x32_bf16 v[132:135], a[100:103], a[72:75], v[132:135]
  buffer_load_dwordx4 v2, s[8:11], s70 offen offset:1024 sc1 lds
  ds_read_b64_tr_b16 a[122:123], v20 offset:22528
  v_mfma_f32_16x16x32_bf16 v[148:151], a[100:103], a[76:79], v[148:151]
  s_add_u32 s70, s70, 16384
  ds_read_b64_tr_b16 a[124:125], v21 offset:20480
  ds_read_b64_tr_b16 a[126:127], v21 offset:22528
  v_mfma_f32_16x16x32_bf16 v[104:107], a[104:107], a[64:67], v[104:107]
  s_add_u32 s64, s64, s66
  s_add_u32 s65, s65, 1
  s_cmp_eq_u32 s65, 4
  s_cselect_b32 s65, 0, s65
  s_cselect_b32 s66, s67, s68
  v_mfma_f32_16x16x32_bf16 v[120:123], a[104:107], a[68:71], v[120:123]
  v_add_u32 v16, s66, v16
  v_add_u32 v17, s66, v17
  v_mfma_f32_16x16x32_bf16 v[136:139], a[104:107], a[72:75], v[136:139]
  v_add_u32 v18, s66, v18
  v_add_u32 v19, s66, v19
  v_mfma_f32_16x16x32_bf16 v[152:155], a[104:107], a[76:79], v[152:155]
  v_add_u32 v20, s66, v20
  v_add_u32 v21, s66, v21
  v_mfma_f32_16x16x32_bf16 v[108:111], a[108:111], a[64:67], v[108:111]
  v_mfma_f32_16x16x32_bf16 v[124:127], a[108:111], a[68:71], v[124:127]
  v_mfma_f32_16x16x32_bf16 v[140:143], a[108:111], a[72:75], v[140:143]
  v_mfma_f32_16x16x32_bf16 v[156:159], a[108:111], a[76:79], v[156:159]
  s_waitcnt vmcnt(6) lgkmcnt(0)
  s_barrier
  s_mov_b32 s5, 0x40000
Lpoll_11:
  v_cmp_ne_u64 vcc, s[94:95], v[6:7]
  s_nop 0
  s_cbranch_vccz Lpolld_12
  s_sleep 4
  buffer_load_dwordx2 v[6:7], off, s[96:99], s90 sc1
  s_sub_u32 s5, s5, 1
  s_waitcnt vmcnt(0)
  s_cbranch_scc0 Lpoll_11
Lpolld_12:
  v_mfma_f32_16x16x32_bf16 v[96:99], a[112:115], a[80:83], v[96:99]
  s_lshl_b32 s6, s78, 1
  s_add_u32 s6, s6, s77
  s_lshl_b32 s6, s6, 2
  v_mfma_f32_16x16x32_bf16 v[112:115], a[112:115], a[84:87], v[112:115]
  s_add_u32 s6, s6, s3
  s_lshl_b32 s6, s6, 13
  s_add_u32 s6, s6, 8388608
  v_mfma_f32_16x16x32_bf16 v[128:131], a[112:115], a[88:91], v[128:131]
  s_add_u32 s7, s6, 4096
  buffer_load_dwordx4 v[160:163], v2, s[16:19], s6 offen offset:0 sc1
  ds_read_b128 a[64:67], v16 offset:0
  v_mfma_f32_16x16x32_bf16 v[144:147], a[112:115], a[92:95], v[144:147]
  buffer_load_dwordx4 v[164:167], v2, s[16:19], s6 offen offset:1024 sc1
  ds_read_b64_tr_b16 a[96:97], v18 offset:16384
  v_mfma_f32_16x16x32_bf16 v[100:103], a[116:119], a[80:83], v[100:103]
  buffer_load_dwordx4 v[168:171], v2, s[16:19], s6 offen offset:2048 sc1
  ds_read_b64_tr_b16 a[98:99], v18 offset:18432
  v_mfma_f32_16x16x32_bf16 v[116:119], a[116:119], a[84:87], v[116:119]
  ds_read_b128 a[68:71], v16 offset:1024
  ds_read_b128 a[72:75], v17 offset:0
  v_mfma_f32_16x16x32_bf16 v[132:135], a[116:119], a[88:91], v[132:135]
  buffer_load_dwordx4 v[172:175], v2, s[16:19], s6 offen offset:3072 sc1
  ds_read_b128 a[76:79], v17 offset:1024
  v_mfma_f32_16x16x32_bf16 v[148:151], a[116:119], a[92:95], v[148:151]
  ds_read_b64_tr_b16 a[100:101], v19 offset:16384
  ds_read_b64_tr_b16 a[102:103], v19 offset:18432
  v_mfma_f32_16x16x32_bf16 v[104:107], a[120:123], a[80:83], v[104:107]
  buffer_load_dwordx4 v[176:179], v2, s[16:19], s7 offen offset:0 sc1
  ds_read_b64_tr_b16 a[104:105], v20 offset:16384
  v_mfma_f32_16x16x32_bf16 v[120:123], a[120:123], a[84:87], v[120:123]
  ds_read_b64_tr_b16 a[106:107], v20 offset:18432
  ds_read_b64_tr_b16 a[108:109], v21 offset:16384
  v_mfma_f32_16x16x32_bf16 v[136:139], a[120:123], a[88:91], v[136:139]
  buffer_load_dwordx4 v[180:183], v2, s[16:19], s7 offen offset:1024 sc1
  ds_read_b64_tr_b16 a[110:111], v21 offset:18432
  v_mfma_f32_16x16x32_bf16 v[152:155], a[120:123], a[92:95], v[152:155]
  v_mfma_f32_16x16x32_bf16 v[108:111], a[124:127], a[80:83], v[108:111]
  buffer_load_dwordx4 v[184:187], v2, s[16:19], s7 offen offset:2048 sc1
  v_mfma_f32_16x16x32_bf16 v[124:127], a[124:127], a[84:87], v[124:127]
  v_mfma_f32_16x16x32_bf16 v[140:143], a[124:127], a[88:91], v[140:143]
  v_mfma_f32_16x16x32_bf16 v[156:159], a[124:127], a[92:95], v[156:159]
  s_waitcnt lgkmcnt(0)
  v_mfma_f32_16x16x32_bf16 v[96:99], a[96:99], a[64:67], v[96:99]
  buffer_load_dwordx4 v[188:191], v2, s[16:19], s7 offen offset:3072 sc1
  ds_read_b128 a[80:83], v16 offset:8192
  v_mfma_f32_16x16x32_bf16 v[112:115], a[96:99], a[68:71], v[112:115]
  s_add_u32 m0, s64, 16384
  ds_read_b64_tr_b16 a[112:113], v18 offset:20480
  ds_read_b64_tr_b16 a[114:115], v18 offset:22528
  v_mfma_f32_16x16x32_bf16 v[128:131], a[96:99], a[72:75], v[128:131]
  buffer_load_dwordx4 v10, s[12:15], s71 offen offset:0 lds
  ds_read_b128 a[84:87], v16 offset:9216
  v_mfma_f32_16x16x32_bf16 v[144:147], a[96:99], a[76:79], v[144:147]
  buffer_load_dwordx4 v11, s[12:15], s71 offen offset:1024 lds
  ds_read_b128 a[88:91], v17 offset:8192
  v_mfma_f32_16x16x32_bf16 v[100:103], a[100:103], a[64:67], v[100:103]
  buffer_load_dwordx4 v12, s[12:15], s71 offen offset:2048 lds
  ds_read_b128 a[92:95], v17 offset:9216
  v_mfma_f32_16x16x32_bf16 v[116:119], a[100:103], a[68:71], v[116:119]
  buffer_load_dwordx4 v13, s[12:15], s71 offen offset:3072 lds
  ds_read_b64_tr_b16 a[116:117], v19 offset:20480
  v_mfma_f32_16x16x32_bf16 v[132:135], a[100:103], a[72:75], v[132:135]
  s_add_u32 s71, s71, 131072
  s_add_u32 m0, s64, s88
  ds_read_b64_tr_b16 a[118:119], v19 offset:22528
  v_mfma_f32_16x16x32_bf16 v[148:151], a[100:103], a[76:79], v[148:151]
  buffer_load_dwordx4 v2, s[8:11], s70 offen offset:0 sc1 lds
  ds_read_b64_tr_b16 a[120:121], v20 offset:20480
  v_mfma_f32_16x16x32_bf16 v[104:107], a[104:107], a[64:67], v[104:107]
  buffer_load_dwordx4 v2, s[8:11], s70 offen offset:1024 sc1 lds
  ds_read_b64_tr_b16 a[122:123], v20 offset:22528
  v_mfma_f32_16x16x32_bf16 v[120:123], a[104:107], a[68:71], v[120:123]
  s_add_u32 s70, s70, 16384
  ds_read_b64_tr_b16 a[124:125], v21 offset:20480
  ds_read_b64_tr_b16 a[126:127], v21 offset:22528
  v_mfma_f32_16x16x32_bf16 v[136:139], a[104:107], a[72:75], v[136:139]
  s_add_u32 s64, s64, s66
  s_add_u32 s65, s65, 1
  s_cmp_eq_u32 s65, 4
  s_cselect_b32 s65, 0, s65
  s_cselect_b32 s66, s67, s68
  v_mfma_f32_16x16x32_bf16 v[152:155], a[104:107], a[76:79], v[152:155]
  v_add_u32 v16, s66, v16
  v_add_u32 v17, s66, v17
  v_mfma_f32_16x16x32_bf16 v[108:111], a[108:111], a[64:67], v[108:111]
  v_add_u32 v18, s66, v18
  v_add_u32 v19, s66, v19
  v_mfma_f32_16x16x32_bf16 v[124:127], a[108:111], a[68:71], v[124:127]
  v_add_u32 v20, s66, v20
  v_add_u32 v21, s66, v21
  v_mfma_f32_16x16x32_bf16 v[140:143], a[108:111], a[72:75], v[140:143]
  v_mfma_f32_16x16x32_bf16 v[156:159], a[108:111], a[76:79], v[156:159]
  s_waitcnt vmcnt(20) lgkmcnt(0)
  s_barrier
  v_mfma_f32_16x16x32_bf16 v[96:99], a[112:115], a[80:83], v[96:99]
  s_add_u32 m0, s64, 16384
  ds_read_b128 a[64:67], v16 offset:0
  ds_read_b64_tr_b16 a[96:97], v18 offset:16384
  v_mfma_f32_16x16x32_bf16 v[112:115], a[112:115], a[84:87], v[112:115]
  buffer_load_dwordx4 v10, s[12:15], s71 offen offset:0 lds
  ds_read_b64_tr_b16 a[98:99], v18 offset:18432
  v_mfma_f32_16x16x32_bf16 v[128:131], a[112:115], a[88:91], v[128:131]
  ds_read_b128 a[68:71], v16 offset:1024
  ds_read_b128 a[72:75], v17 offset:0
  v_mfma_f32_16x16x32_bf16 v[144:147], a[112:115], a[92:95], v[144:147]
  ds_read_b128 a[76:79], v17 offset:1024
  ds_read_b64_tr_b16 a[100:101], v19 offset:16384
  v_mfma_f32_16x16x32_bf16 v[100:103], a[116:119], a[80:83], v[100:103]
  ds_read_b64_tr_b16 a[102:103], v19 offset:18432
  ds_read_b64_tr_b16 a[104:105], v20 offset:16384
  v_mfma_f32_16x16x32_bf16 v[116:119], a[116:119], a[84:87], v[116:119]
  buffer_load_dwordx4 v11, s[12:15], s71 offen offset:1024 lds
  ds_read_b64_tr_b16 a[106:107], v20 offset:18432
  v_mfma_f32_16x16x32_bf16 v[132:135], a[116:119], a[88:91], v[132:135]
  ds_read_b64_tr_b16 a[108:109], v21 offset:16384
  ds_read_b64_tr_b16 a[110:111], v21 offset:18432
  v_mfma_f32_16x16x32_bf16 v[148:151], a[116:119], a[92:95], v[148:151]
  v_mfma_f32_16x16x32_bf16 v[104:107], a[120:123], a[80:83], v[104:107]
  v_mfma_f32_16x16x32_bf16 v[120:123], a[120:123], a[84:87], v[120:123]
  v_mfma_f32_16x16x32_bf16 v[136:139], a[120:123], a[88:91], v[136:139]
  buffer_load_dwordx4 v12, s[12:15], s71 offen offset:2048 lds
  v_mfma_f32_16x16x32_bf16 v[152:155], a[120:123], a[92:95], v[152:155]
  v_mfma_f32_16x16x32_bf16 v[108:111], a[124:127], a[80:83], v[108:111]
  v_mfma_f32_16x16x32_bf16 v[124:127], a[124:127], a[84:87], v[124:127]
  v_mfma_f32_16x16x32_bf16 v[140:143], a[124:127], a[88:91], v[140:143]
  v_mfma_f32_16x16x32_bf16 v[156:159], a[124:127], a[92:95], v[156:159]
  s_waitcnt lgkmcnt(0)
  v_mfma_f32_16x16x32_bf16 v[96:99], a[96:99], a[64:67], v[96:99]
  buffer_load_dwordx4 v13, s[12:15], s71 offen offset:3072 lds
  ds_read_b128 a[80:83], v16 offset:8192
  v_mfma_f32_16x16x32_bf16 v[112:115], a[96:99], a[68:71], v[112:115]
  s_add_u32 s71, s71, 131072
  s_add_u32 m0, s64, s88
  ds_read_b64_tr_b16 a[112:113], v18 offset:20480
  v_mfma_f32_16x16x32_bf16 v[128:131], a[96:99], a[72:75], v[128:131]
  ds_read_b64_tr_b16 a[114:115], v18 offset:22528
  ds_read_b128 a[84:87], v16 offset:9216
  v_mfma_f32_16x16x32_bf16 v[144:147], a[96:99], a[76:79], v[144:147]
  buffer_load_dwordx4 v2, s[8:11], s70 offen offset:0 sc1 lds
  ds_read_b128 a[88:91], v17 offset:8192
  v_mfma_f32_16x16x32_bf16 v[100:103], a[100:103], a[64:67], v[100:103]
  ds_read_b128 a[92:95], v17 offset:9216
  ds_read_b64_tr_b16 a[116:117], v19 offset:20480
  v_mfma_f32_16x16x32_bf16 v[116:119], a[100:103], a[68:71], v[116:119]
  ds_read_b64_tr_b16 a[118:119], v19 offset:22528
  ds_read_b64_tr_b16 a[120:121], v20 offset:20480
  v_mfma_f32_16x16x32_bf16 v[132:135], a[100:103], a[72:75], v[132:135]
  buffer_load_dwordx4 v2, s[8:11], s70 offen offset:1024 sc1 lds
  ds_read_b64_tr_b16 a[122:123], v20 offset:22528
  v_mfma_f32_16x16x32_bf16 v[148:151], a[100:103], a[76:79], v[148:151]
  s_add_u32 s70, s70, 16384
  ds_read_b64_tr_b16 a[124:125], v21 offset:20480
  ds_read_b64_tr_b16 a[126:127], v21 offset:22528
  v_mfma_f32_16x16x32_bf16 v[104:107], a[104:107], a[64:67], v[104:107]
  s_add_u32 s64, s64, s66
  s_add_u32 s65, s65, 1
  s_cmp_eq_u32 s65, 4
  s_cselect_b32 s65, 0, s65
  s_cselect_b32 s66, s67, s68
  v_mfma_f32_16x16x32_bf16 v[120:123], a[104:107], a[68:71], v[120:123]
  v_add_u32 v16, s66, v16
  v_add_u32 v17, s66, v17
  v_mfma_f32_16x16x32_bf16 v[136:139], a[104:107], a[72:75], v[136:139]
  v_add_u32 v18, s66, v18
  v_add_u32 v19, s66, v19
  v_mfma_f32_16x16x32_bf16 v[152:155], a[104:107], a[76:79], v[152:155]
  v_add_u32 v20, s66, v20
  v_add_u32 v21, s66, v21
  v_mfma_f32_16x16x32_bf16 v[108:111], a[108:111], a[64:67], v[108:111]
  v_mfma_f32_16x16x32_bf16 v[124:127], a[108:111], a[68:71], v[124:127]
  v_mfma_f32_16x16x32_bf16 v[140:143], a[108:111], a[72:75], v[140:143]
  v_mfma_f32_16x16x32_bf16 v[156:159], a[108:111], a[76:79], v[156:159]
  s_waitcnt vmcnt(12) lgkmcnt(0)
  s_barrier
  s_lshl_b32 s4, s73, 19
  s_lshl_b32 s72, s76, 8
  s_add_u32 s4, s4, s72
  s_and_b32 s72, s3, 1
  s_lshl_b32 s72, s72, 7
  s_add_u32 s4, s4, s72
  s_lshr_b32 s72, s3, 1
  s_lshl_b32 s72, s72, 1
  s_add_u32 s72, s72, s77
  s_lshl_b32 s72, s72, 17
  s_add_u32 s4, s4, s72
  s_add_u32 s4, s4, 2048
  s_add_u32 s5, s4, 65536
  s_lshl_b32 s89, s78, 1
  s_add_u32 s89, s89, s77
  s_lshl_b32 s89, s89, 7
  s_add_u32 s89, s89, 131072
  s_lshl_b32 s90, s78, 1
  s_add_u32 s90, s90, s77
  s_xor_b32 s90, s90, 1
  s_lshl_b32 s90, s90, 7
  s_add_u32 s90, s90, 131072
  v_mfma_f32_16x16x32_bf16 v[96:99], a[112:115], a[80:83], v[96:99]
  s_add_u32 m0, s64, 16384
  ds_read_b128 a[64:67], v16 offset:0
  ds_read_b64_tr_b16 a[96:97], v18 offset:16384
  v_mfma_f32_16x16x32_bf16 v[112:115], a[112:115], a[84:87], v[112:115]
  buffer_load_dwordx4 v10, s[12:15], s71 offen offset:0 lds
  ds_read_b64_tr_b16 a[98:99], v18 offset:18432
  v_mfma_f32_16x16x32_bf16 v[128:131], a[112:115], a[88:91], v[128:131]
  buffer_load_dwordx4 v11, s[12:15], s71 offen offset:1024 lds
  ds_read_b128 a[68:71], v16 offset:1024
  v_mfma_f32_16x16x32_bf16 v[144:147], a[112:115], a[92:95], v[144:147]
  ds_read_b64_tr_b16 a[100:101], v19 offset:16384
  ds_read_b64_tr_b16 a[102:103], v19 offset:18432
  v_mfma_f32_16x16x32_bf16 v[100:103], a[116:119], a[80:83], v[100:103]
  ds_read_b64_tr_b16 a[104:105], v20 offset:16384
  ds_read_b64_tr_b16 a[106:107], v20 offset:18432
  v_mfma_f32_16x16x32_bf16 v[116:119], a[116:119], a[84:87], v[116:119]
  buffer_load_dwordx4 v12, s[12:15], s71 offen offset:2048 lds
  ds_read_b64_tr_b16 a[108:109], v21 offset:16384
  v_mfma_f32_16x16x32_bf16 v[132:135], a[116:119], a[88:91], v[132:135]
  ds_read_b64_tr_b16 a[110:111], v21 offset:18432
  v_mfma_f32_16x16x32_bf16 v[148:151], a[116:119], a[92:95], v[148:151]
  buffer_load_dwordx4 v13, s[12:15], s71 offen offset:3072 lds
  v_mfma_f32_16x16x32_bf16 v[104:107], a[120:123], a[80:83], v[104:107]
  s_add_u32 s71, s71, 131072
  s_add_u32 m0, s64, s88
  v_mfma_f32_16x16x32_bf16 v[120:123], a[120:123], a[84:87], v[120:123]
  v_mfma_f32_16x16x32_bf16 v[136:139], a[120:123], a[88:91], v[136:139]
  buffer_load_dwordx4 v2, s[8:11], s70 offen offset:0 sc1 lds
  v_mfma_f32_16x16x32_bf16 v[152:155], a[120:123], a[92:95], v[152:155]
  v_mfma_f32_16x16x32_bf16 v[108:111], a[124:127], a[80:83], v[108:111]
  buffer_load_dwordx4 v2, s[8:11], s70 offen offset:1024 sc1 lds
  v_mfma_f32_16x16x32_bf16 v[124:127], a[124:127], a[84:87], v[124:127]
  s_add_u32 s70, s70, 16384
  s_lshl_b32 s6, s78, 1
  s_add_u32 s6, s6, s77
  v_mfma_f32_16x16x32_bf16 v[140:143], a[124:127], a[88:91], v[140:143]
  s_xor_b32 s6, s6, 1
  s_lshl_b32 s6, s6, 2
  s_add_u32 s6, s6, s3
  v_mfma_f32_16x16x32_bf16 v[156:159], a[124:127], a[92:95], v[156:159]
  s_lshl_b32 s6, s6, 13
  s_add_u32 s7, s6, 4096
  s_waitcnt lgkmcnt(0)
  v_mfma_f32_16x16x32_bf16 v[96:99], a[96:99], a[64:67], v[96:99]
  buffer_store_dwordx4 v[128:131], v2, s[16:19], s6 offen offset:0 sc1
  ds_read_b128 a[80:83], v16 offset:8192
  v_mfma_f32_16x16x32_bf16 v[112:115], a[96:99], a[68:71], v[112:115]
  buffer_store_dwordx4 v[132:135], v2, s[16:19], s6 offen offset:1024 sc1
  ds_read_b64_tr_b16 a[112:113], v18 offset:20480
  v_mfma_f32_16x16x32_bf16 v[100:103], a[100:103], a[64:67], v[100:103]
  ds_read_b64_tr_b16 a[114:115], v18 offset:22528
  ds_read_b128 a[84:87], v16 offset:9216
  v_mfma_f32_16x16x32_bf16 v[116:119], a[100:103], a[68:71], v[116:119]
  buffer_store_dwordx4 v[136:139], v2, s[16:19], s6 offen offset:2048 sc1
  ds_read_b64_tr_b16 a[116:117], v19 offset:20480
  v_mfma_f32_16x16x32_bf16 v[104:107], a[104:107], a[64:67], v[104:107]
  ds_read_b64_tr_b16 a[118:119], v19 offset:22528
  ds_read_b64_tr_b16 a[120:121], v20 offset:20480
  v_mfma_f32_16x16x32_bf16 v[120:123], a[104:107], a[68:71], v[120:123]
  buffer_store_dwordx4 v[140:143], v2, s[16:19], s6 offen offset:3072 sc1
  ds_read_b64_tr_b16 a[122:123], v20 offset:22528
  v_mfma_f32_16x16x32_bf16 v[108:111], a[108:111], a[64:67], v[108:111]
  s_add_u32 s64, s64, s66
  ds_read_b64_tr_b16 a[124:125], v21 offset:20480
  ds_read_b64_tr_b16 a[126:127], v21 offset:22528
  v_mfma_f32_16x16x32_bf16 v[124:127], a[108:111], a[68:71], v[124:127]
  s_add_u32 s65, s65, 1
  s_cmp_eq_u32 s65, 4
  s_cselect_b32 s65, 0, s65
  s_cselect_b32 s66, s67, s68
  v_add_u32 v16, s66, v16
  v_add_u32 v17, s66, v17
  v_add_u32 v18, s66, v18
  v_add_u32 v19, s66, v19
  v_add_u32 v20, s66, v20
  v_add_u32 v21, s66, v21
  s_waitcnt vmcnt(16) lgkmcnt(0)
  s_barrier
  v_mfma_f32_16x16x32_bf16 v[96:99], a[112:115], a[80:83], v[96:99]
  buffer_store_dwordx4 v[144:147], v2, s[16:19], s7 offen offset:0 sc1
  ds_read_b128 a[64:67], v16 offset:0
  v_mfma_f32_16x16x32_bf16 v[112:115], a[112:115], a[84:87], v[112:115]
  buffer_store_dwordx4 v[148:151], v2, s[16:19], s7 offen offset:1024 sc1
  ds_read_b64_tr_b16 a[96:97], v18 offset:16384
  v_mfma_f32_16x16x32_bf16 v[100:103], a[116:119], a[80:83], v[100:103]
  ds_read_b64_tr_b16 a[98:99], v18 offset:18432
  ds_read_b128 a[68:71], v16 offset:1024
  v_mfma_f32_16x16x32_bf16 v[116:119], a[116:119], a[84:87], v[116:119]
  buffer_store_dwordx4 v[152:155], v2, s[16:19], s7 offen offset:2048 sc1
  ds_read_b64_tr_b16 a[100:101], v19 offset:16384
  v_mfma_f32_16x16x32_bf16 v[104:107], a[120:123], a[80:83], v[104:107]
  ds_read_b64_tr_b16 a[102:103], v19 offset:18432
  ds_read_b64_tr_b16 a[104:105], v20 offset:16384
  v_mfma_f32_16x16x32_bf16 v[120:123], a[120:123], a[84:87], v[120:123]
  buffer_store_dwordx4 v[156:159], v2, s[16:19], s7 offen offset:3072 sc1
  ds_read_b64_tr_b16 a[106:107], v20 offset:18432
  v_mfma_f32_16x16x32_bf16 v[108:111], a[124:127], a[80:83], v[108:111]
  ds_read_b64_tr_b16 a[108:109], v21 offset:16384
  ds_read_b64_tr_b16 a[110:111], v21 offset:18432
  v_mfma_f32_16x16x32_bf16 v[124:127], a[124:127], a[84:87], v[124:127]
  v_pk_add_f32 v[160:161], v[160:161], v[32:33]
  v_pk_add_f32 v[162:163], v[162:163], v[34:35]
  v_pk_add_f32 v[164:165], v[164:165], v[36:37]
  v_pk_add_f32 v[166:167], v[166:167], v[38:39]
  v_cvt_pk_bf16_f32 v160, v160, v161
  v_cvt_pk_bf16_f32 v161, v162, v163
  v_cvt_pk_bf16_f32 v162, v164, v165
  v_cvt_pk_bf16_f32 v163, v166, v167
  s_nop 0
  v_permlane16_swap_b32 v160, v162
  v_permlane16_swap_b32 v161, v163
  s_waitcnt lgkmcnt(0)
  v_mfma_f32_16x16x32_bf16 v[96:99], a[96:99], a[64:67], v[96:99]
  s_sub_u32 s70, s70, 65536
  s_xor_b32 s70, s70, 524288
  s_sub_u32 s71, s71, 524288
  v_mfma_f32_16x16x32_bf16 v[112:115], a[96:99], a[68:71], v[112:115]
  s_xor_b32 s71, s71, 4194304
  s_add_u32 m0, s64, 16384
  ds_read_b128 a[80:83], v16 offset:8192
  v_mfma_f32_16x16x32_bf16 v[100:103], a[100:103], a[64:67], v[100:103]
  buffer_load_dwordx4 v10, s[12:15], s71 offen offset:0 lds
  ds_read_b64_tr_b16 a[112:113], v18 offset:20480
  v_mfma_f32_16x16x32_bf16 v[116:119], a[100:103], a[68:71], v[116:119]
  buffer_load_dwordx4 v11, s[12:15], s71 offen offset:1024 lds
  ds_read_b64_tr_b16 a[114:115], v18 offset:22528
  v_mfma_f32_16x16x32_bf16 v[104:107], a[104:107], a[64:67], v[104:107]
  buffer_load_dwordx4 v12, s[12:15], s71 offen offset:2048 lds
  ds_read_b128 a[84:87], v16 offset:9216
  v_mfma_f32_16x16x32_bf16 v[120:123], a[104:107], a[68:71], v[120:123]
  buffer_load_dwordx4 v13, s[12:15], s71 offen offset:3072 lds
  ds_read_b64_tr_b16 a[116:117], v19 offset:20480
  v_mfma_f32_16x16x32_bf16 v[108:111], a[108:111], a[64:67], v[108:111]
  s_add_u32 s71, s71, 131072
  s_add_u32 m0, s64, s88
  ds_read_b64_tr_b16 a[118:119], v19 offset:22528
  ds_read_b64_tr_b16 a[120:121], v20 offset:20480
  v_mfma_f32_16x16x32_bf16 v[124:127], a[108:111], a[68:71], v[124:127]
  buffer_load_dwordx4 v2, s[8:11], s70 offen offset:0 sc1 lds
  buffer_load_dwordx4 v2, s[8:11], s70 offen offset:1024 sc1 lds
  ds_read_b64_tr_b16 a[122:123], v20 offset:22528
  ds_read_b64_tr_b16 a[124:125], v21 offset:20480
  ds_read_b64_tr_b16 a[126:127], v21 offset:22528
  s_add_u32 s70, s70, 16384
  s_add_u32 s64, s64, s66
  s_add_u32 s65, s65, 1
  s_cmp_eq_u32 s65, 4
  s_cselect_b32 s65, 0, s65
  s_cselect_b32 s66, s67, s68
  v_add_u32 v16, s66, v16
  v_add_u32 v17, s66, v17
  v_add_u32 v18, s66, v18
  v_add_u32 v19, s66, v19
  v_add_u32 v20, s66, v20
  v_add_u32 v21, s66, v21
  buffer_store_dwordx4 v[160:163], v27, s[20:23], s4 offen offset:0
  s_waitcnt vmcnt(21) lgkmcnt(0)
  s_barrier
  v_mfma_f32_16x16x32_bf16 v[96:99], a[112:115], a[80:83], v[96:99]
  s_add_u32 m0, s64, 16384
  ds_read_b128 a[64:67], v16 offset:0
  ds_read_b64_tr_b16 a[96:97], v18 offset:16384
  v_mfma_f32_16x16x32_bf16 v[112:115], a[112:115], a[84:87], v[112:115]
  buffer_load_dwordx4 v10, s[12:15], s71 offen offset:0 lds
  ds_read_b64_tr_b16 a[98:99], v18 offset:18432
  v_mfma_f32_16x16x32_bf16 v[100:103], a[116:119], a[80:83], v[100:103]
  buffer_load_dwordx4 v11, s[12:15], s71 offen offset:1024 lds
  ds_read_b128 a[68:71], v16 offset:1024
  v_mfma_f32_16x16x32_bf16 v[116:119], a[116:119], a[84:87], v[116:119]
  ds_read_b64_tr_b16 a[100:101], v19 offset:16384
  ds_read_b64_tr_b16 a[102:103], v19 offset:18432
  v_mfma_f32_16x16x32_bf16 v[104:107], a[120:123], a[80:83], v[104:107]
  buffer_load_dwordx4 v12, s[12:15], s71 offen offset:2048 lds
  ds_read_b64_tr_b16 a[104:105], v20 offset:16384
  v_mfma_f32_16x16x32_bf16 v[120:123], a[120:123], a[84:87], v[120:123]
  ds_read_b64_tr_b16 a[106:107], v20 offset:18432
  ds_read_b64_tr_b16 a[108:109], v21 offset:16384
  v_mfma_f32_16x16x32_bf16 v[108:111], a[124:127], a[80:83], v[108:111]
  ds_read_b64_tr_b16 a[110:111], v21 offset:18432
  v_pk_add_f32 v[168:169], v[168:169], v[40:41]
  v_mfma_f32_16x16x32_bf16 v[124:127], a[124:127], a[84:87], v[124:127]
  v_pk_add_f32 v[170:171], v[170:171], v[42:43]
  v_pk_add_f32 v[172:173], v[172:173], v[44:45]
  v_pk_add_f32 v[174:175], v[174:175], v[46:47]
  v_cvt_pk_bf16_f32 v168, v168, v169
  v_cvt_pk_bf16_f32 v169, v170, v171
  v_cvt_pk_bf16_f32 v170, v172, v173
  v_cvt_pk_bf16_f32 v171, v174, v175
  s_nop 0
  v_permlane16_swap_b32 v168, v170
  v_permlane16_swap_b32 v169, v171
  s_waitcnt lgkmcnt(0)
  v_mfma_f32_16x16x32_bf16 v[96:99], a[96:99], a[64:67], v[96:99]
  buffer_load_dwordx4 v13, s[12:15], s71 offen offset:3072 lds
  ds_read_b128 a[80:83], v16 offset:8192
  v_mfma_f32_16x16x32_bf16 v[112:115], a[96:99], a[68:71], v[112:115]
  s_add_u32 s71, s71, 131072
  s_add_u32 m0, s64, s88
  ds_read_b64_tr_b16 a[112:113], v18 offset:20480
  v_mfma_f32_16x16x32_bf16 v[100:103], a[100:103], a[64:67], v[100:103]
  buffer_load_dwordx4 v2, s[8:11], s70 offen offset:0 sc1 lds
  ds_read_b64_tr_b16 a[114:115], v18 offset:22528
  v_mfma_f32_16x16x32_bf16 v[116:119], a[100:103], a[68:71], v[116:119]
  ds_read_b128 a[84:87], v16 offset:9216
  ds_read_b64_tr_b16 a[116:117], v19 offset:20480
  v_mfma_f32_16x16x32_bf16 v[104:107], a[104:107], a[64:67], v[104:107]
  buffer_load_dwordx4 v2, s[8:11], s70 offen offset:1024 sc1 lds
  ds_read_b64_tr_b16 a[118:119], v19 offset:22528
  v_mfma_f32_16x16x32_bf16 v[120:123], a[104:107], a[68:71], v[120:123]
  s_add_u32 s70, s70, 16384
  ds_read_b64_tr_b16 a[120:121], v20 offset:20480
  ds_read_b64_tr_b16 a[122:123], v20 offset:22528
  v_mfma_f32_16x16x32_bf16 v[108:111], a[108:111], a[64:67], v[108:111]
  s_add_u32 s64, s64, s66
  ds_read_b64_tr_b16 a[124:125], v21 offset:20480
  ds_read_b64_tr_b16 a[126:127], v21 offset:22528
  v_mfma_f32_16x16x32_bf16 v[124:127], a[108:111], a[68:71], v[124:127]
  s_add_u32 s65, s65, 1
  s_cmp_eq_u32 s65, 4
  s_cselect_b32 s65, 0, s65
  s_cselect_b32 s66, s67, s68
  v_add_u32 v16, s66, v16
  v_add_u32 v17, s66, v17
  v_add_u32 v18, s66, v18
  v_add_u32 v19, s66, v19
  v_add_u32 v20, s66, v20
  v_add_u32 v21, s66, v21
  buffer_store_dwordx4 v[168:171], v27, s[20:23], s4 offen offset:64
  s_waitcnt vmcnt(14) lgkmcnt(0)
  s_barrier
  v_mov_b32 v8, 0x40000000
  v_mov_b32 v6, s94
  v_cmp_eq_u32 vcc, 0, v0
  v_mov_b32 v7, s95
  s_nop 0
  v_cndmask_b32_e64 v8, v8, 0, vcc
  buffer_store_dwordx2 v[6:7], v8, s[96:99], s89 offen sc1
  v_mfma_f32_16x16x32_bf16 v[96:99], a[112:115], a[80:83], v[96:99]
  s_add_u32 m0, s64, 16384
  ds_read_b128 a[64:67], v16 offset:0
  ds_read_b64_tr_b16 a[96:97], v18 offset:16384
  v_mfma_f32_16x16x32_bf16 v[112:115], a[112:115], a[84:87], v[112:115]
  buffer_load_dwordx4 v10, s[12:15], s71 offen offset:0 lds
  ds_read_b64_tr_b16 a[98:99], v18 offset:18432
  v_mfma_f32_16x16x32_bf16 v[100:103], a[116:119], a[80:83], v[100:103]
  buffer_load_dwordx4 v11, s[12:15], s71 offen offset:1024 lds
  ds_read_b128 a[68:71], v16 offset:1024
  v_mfma_f32_16x16x32_bf16 v[116:119], a[116:119], a[84:87], v[116:119]
  ds_read_b64_tr_b16 a[100:101], v19 offset:16384
  ds_read_b64_tr_b16 a[102:103], v19 offset:18432
  v_mfma_f32_16x16x32_bf16 v[104:107], a[120:123], a[80:83], v[104:107]
  buffer_load_dwordx4 v12, s[12:15], s71 offen offset:2048 lds
  ds_read_b64_tr_b16 a[104:105], v20 offset:16384
  v_mfma_f32_16x16x32_bf16 v[120:123], a[120:123], a[84:87], v[120:123]
  ds_read_b64_tr_b16 a[106:107], v20 offset:18432
  ds_read_b64_tr_b16 a[108:109], v21 offset:16384
  v_mfma_f32_16x16x32_bf16 v[108:111], a[124:127], a[80:83], v[108:111]
  ds_read_b64_tr_b16 a[110:111], v21 offset:18432
  v_pk_add_f32 v[176:177], v[176:177], v[48:49]
  v_mfma_f32_16x16x32_bf16 v[124:127], a[124:127], a[84:87], v[124:127]
  v_pk_add_f32 v[178:179], v[178:179], v[50:51]
  v_pk_add_f32 v[180:181], v[180:181], v[52:53]
  v_pk_add_f32 v[182:183], v[182:183], v[54:55]
  v_cvt_pk_bf16_f32 v176, v176, v177
  v_cvt_pk_bf16_f32 v177, v178, v179
  v_cvt_pk_bf16_f32 v178, v180, v181
  v_cvt_pk_bf16_f32 v179, v182, v183
  s_nop 0
  v_permlane16_swap_b32 v176, v178
  v_permlane16_swap_b32 v177, v179
  s_waitcnt lgkmcnt(0)
  v_mfma_f32_16x16x32_bf16 v[96:99], a[96:99], a[64:67], v[96:99]
  buffer_load_dwordx4 v13, s[12:15], s71 offen offset:3072 lds
  ds_read_b128 a[80:83], v16 offset:8192
  v_mfma_f32_16x16x32_bf16 v[112:115], a[96:99], a[68:71], v[112:115]
  s_add_u32 s71, s71, 131072
  s_add_u32 m0, s64, s88
  ds_read_b64_tr_b16 a[112:113], v18 offset:20480
  v_mfma_f32_16x16x32_bf16 v[100:103], a[100:103], a[64:67], v[100:103]
  buffer_load_dwordx4 v2, s[8:11], s70 offen offset:0 sc1 lds
  ds_read_b64_tr_b16 a[114:115], v18 offset:22528
  v_mfma_f32_16x16x32_bf16 v[116:119], a[100:103], a[68:71], v[116:119]
  ds_read_b128 a[84:87], v16 offset:9216
  ds_read_b64_tr_b16 a[116:117], v19 offset:20480
  v_mfma_f32_16x16x32_bf16 v[104:107], a[104:107], a[64:67], v[104:107]
  buffer_load_dwordx4 v2, s[8:11], s70 offen offset:1024 sc1 lds
  ds_read_b64_tr_b16 a[118:119], v19 offset:22528
  v_mfma_f32_16x16x32_bf16 v[120:123], a[104:107], a[68:71], v[120:123]
  s_add_u32 s70, s70, 16384
  ds_read_b64_tr_b16 a[120:121], v20 offset:20480
  ds_read_b64_tr_b16 a[122:123], v20 offset:22528
  v_mfma_f32_16x16x32_bf16 v[108:111], a[108:111], a[64:67], v[108:111]
  s_add_u32 s64, s64, s66
  ds_read_b64_tr_b16 a[124:125], v21 offset:20480
  ds_read_b64_tr_b16 a[126:127], v21 offset:22528
  v_mfma_f32_16x16x32_bf16 v[124:127], a[108:111], a[68:71], v[124:127]
  s_add_u32 s65, s65, 1
  s_cmp_eq_u32 s65, 4
  s_cselect_b32 s65, 0, s65
  s_cselect_b32 s66, s67, s68
  v_add_u32 v16, s66, v16
  v_add_u32 v17, s66, v17
  v_add_u32 v18, s66, v18
  v_add_u32 v19, s66, v19
  v_add_u32 v20, s66, v20
  v_add_u32 v21, s66, v21
  buffer_store_dwordx4 v[176:179], v27, s[20:23], s5 offen offset:0
  s_waitcnt vmcnt(16) lgkmcnt(0)
  s_barrier
  v_mfma_f32_16x16x32_bf16 v[96:99], a[112:115], a[80:83], v[96:99]
  s_add_u32 m0, s64, 16384
  ds_read_b128 a[64:67], v16 offset:0
  ds_read_b64_tr_b16 a[96:97], v18 offset:16384
  v_mfma_f32_16x16x32_bf16 v[112:115], a[112:115], a[84:87], v[112:115]
  buffer_load_dwordx4 v10, s[12:15], s71 offen offset:0 lds
  ds_read_b64_tr_b16 a[98:99], v18 offset:18432
  v_mfma_f32_16x16x32_bf16 v[100:103], a[116:119], a[80:83], v[100:103]
  buffer_load_dwordx4 v11, s[12:15], s71 offen offset:1024 lds
  ds_read_b128 a[68:71], v16 offset:1024
  v_mfma_f32_16x16x32_bf16 v[116:119], a[116:119], a[84:87], v[116:119]
  ds_read_b64_tr_b16 a[100:101], v19 offset:16384
  ds_read_b64_tr_b16 a[102:103], v19 offset:18432
  v_mfma_f32_16x16x32_bf16 v[104:107], a[120:123], a[80:83], v[104:107]
  buffer_load_dwordx4 v12, s[12:15], s71 offen offset:2048 lds
  ds_read_b64_tr_b16 a[104:105], v20 offset:16384
  v_mfma_f32_16x16x32_bf16 v[120:123], a[120:123], a[84:87], v[120:123]
  ds_read_b64_tr_b16 a[106:107], v20 offset:18432
  ds_read_b64_tr_b16 a[108:109], v21 offset:16384
  v_mfma_f32_16x16x32_bf16 v[108:111], a[124:127], a[80:83], v[108:111]
  ds_read_b64_tr_b16 a[110:111], v21 offset:18432
  v_pk_add_f32 v[184:185], v[184:185], v[56:57]
  v_mfma_f32_16x16x32_bf16 v[124:127], a[124:127], a[84:87], v[124:127]
  v_pk_add_f32 v[186:187], v[186:187], v[58:59]
  v_pk_add_f32 v[188:189], v[188:189], v[60:61]
  v_pk_add_f32 v[190:191], v[190:191], v[62:63]
  v_cvt_pk_bf16_f32 v184, v184, v185
  v_cvt_pk_bf16_f32 v185, v186, v187
  v_cvt_pk_bf16_f32 v186, v188, v189
  v_cvt_pk_bf16_f32 v187, v190, v191
  s_nop 0
  v_permlane16_swap_b32 v184, v186
  v_permlane16_swap_b32 v185, v187
  s_waitcnt lgkmcnt(0)
  v_mfma_f32_16x16x32_bf16 v[96:99], a[96:99], a[64:67], v[96:99]
  buffer_load_dwordx4 v13, s[12:15], s71 offen offset:3072 lds
  ds_read_b128 a[80:83], v16 offset:8192
  v_mfma_f32_16x16x32_bf16 v[112:115], a[96:99], a[68:71], v[112:115]
  s_add_u32 s71, s71, 131072
  s_add_u32 m0, s64, s88
  ds_read_b64_tr_b16 a[112:113], v18 offset:20480
  v_mfma_f32_16x16x32_bf16 v[100:103], a[100:103], a[64:67], v[100:103]
  buffer_load_dwordx4 v2, s[8:11], s70 offen offset:0 sc1 lds
  ds_read_b64_tr_b16 a[114:115], v18 offset:22528
  v_mfma_f32_16x16x32_bf16 v[116:119], a[100:103], a[68:71], v[116:119]
  ds_read_b128 a[84:87], v16 offset:9216
  ds_read_b64_tr_b16 a[116:117], v19 offset:20480
  v_mfma_f32_16x16x32_bf16 v[104:107], a[104:107], a[64:67], v[104:107]
  buffer_load_dwordx4 v2, s[8:11], s70 offen offset:1024 sc1 lds
  ds_read_b64_tr_b16 a[118:119], v19 offset:22528
  v_mfma_f32_16x16x32_bf16 v[120:123], a[104:107], a[68:71], v[120:123]
  s_add_u32 s70, s70, 16384
  ds_read_b64_tr_b16 a[120:121], v20 offset:20480
  ds_read_b64_tr_b16 a[122:123], v20 offset:22528
  v_mfma_f32_16x16x32_bf16 v[108:111], a[108:111], a[64:67], v[108:111]
  s_add_u32 s64, s64, s66
  ds_read_b64_tr_b16 a[124:125], v21 offset:20480
  ds_read_b64_tr_b16 a[126:127], v21 offset:22528
  v_mfma_f32_16x16x32_bf16 v[124:127], a[108:111], a[68:71], v[124:127]
  s_add_u32 s65, s65, 1
  s_cmp_eq_u32 s65, 4
  s_cselect_b32 s65, 0, s65
  s_cselect_b32 s66, s67, s68
  v_add_u32 v16, s66, v16
  v_add_u32 v17, s66, v17
  v_add_u32 v18, s66, v18
  v_add_u32 v19, s66, v19
  v_add_u32 v20, s66, v20
  v_add_u32 v21, s66, v21
  buffer_store_dwordx4 v[184:187], v27, s[20:23], s5 offen offset:64
  s_waitcnt vmcnt(16) lgkmcnt(0)
  s_barrier
  v_mfma_f32_16x16x32_bf16 v[96:99], a[112:115], a[80:83], v[96:99]
  buffer_load_dwordx2 v[6:7], off, s[96:99], s90 sc1
  ds_read_b128 a[64:67], v16 offset:0
  v_mfma_f32_16x16x32_bf16 v[112:115], a[112:115], a[84:87], v[112:115]
  ds_read_b64_tr_b16 a[96:97], v18 offset:16384
  ds_read_b64_tr_b16 a[98:99], v18 offset:18432
  v_mfma_f32_16x16x32_bf16 v[100:103], a[116:119], a[80:83], v[100:103]
  ds_read_b128 a[68:71], v16 offset:1024
  ds_read_b64_tr_b16 a[100:101], v19 offset:16384
  v_mfma_f32_16x16x32_bf16 v[116:119], a[116:119], a[84:87], v[116:119]
  ds_read_b64_tr_b16 a[102:103], v19 offset:18432
  ds_read_b64_tr_b16 a[104:105], v20 offset:16384
  v_mfma_f32_16x16x32_bf16 v[104:107], a[120:123], a[80:83], v[104:107]
  ds_read_b64_tr_b16 a[106:107], v20 offset:18432
  ds_read_b64_tr_b16 a[108:109], v21 offset:16384
  v_mfma_f32_16x16x32_bf16 v[120:123], a[120:123], a[84:87], v[120:123]
  ds_read_b64_tr_b16 a[110:111], v21 offset:18432
  v_mfma_f32_16x16x32_bf16 v[108:111], a[124:127], a[80:83], v[108:111]
  v_mfma_f32_16x16x32_bf16 v[124:127], a[124:127], a[84:87], v[124:127]
  s_waitcnt lgkmcnt(0)
  v_mfma_f32_16x16x32_bf16 v[96:99], a[96:99], a[64:67], v[96:99]
  s_add_u32 s64, s64, s66
  ds_read_b128 a[80:83], v16 offset:8192
  ds_read_b64_tr_b16 a[112:113], v18 offset:20480
  v_mfma_f32_16x16x32_bf16 v[112:115], a[96:99], a[68:71], v[112:115]
  s_add_u32 s65, s65, 1
  ds_read_b64_tr_b16 a[114:115], v18 offset:22528
  ds_read_b128 a[84:87], v16 offset:9216
  v_mfma_f32_16x16x32_bf16 v[100:103], a[100:103], a[64:67], v[100:103]
  s_cmp_eq_u32 s65, 4
  s_cselect_b32 s65, 0, s65
  s_cselect_b32 s66, s67, s68
  ds_read_b64_tr_b16 a[116:117], v19 offset:20480
  v_mfma_f32_16x16x32_bf16 v[116:119], a[100:103], a[68:71], v[116:119]
  ds_read_b64_tr_b16 a[118:119], v19 offset:22528
  ds_read_b64_tr_b16 a[120:121], v20 offset:20480
  v_mfma_f32_16x16x32_bf16 v[104:107], a[104:107], a[64:67], v[104:107]
  ds_read_b64_tr_b16 a[122:123], v20 offset:22528
  ds_read_b64_tr_b16 a[124:125], v21 offset:20480
  v_mfma_f32_16x16x32_bf16 v[120:123], a[104:107], a[68:71], v[120:123]
  ds_read_b64_tr_b16 a[126:127], v21 offset:22528
  v_mfma_f32_16x16x32_bf16 v[108:111], a[108:111], a[64:67], v[108:111]
  v_add_u32 v16, s66, v16
  v_add_u32 v17, s66, v17
  v_add_u32 v20, s66, v20
  v_mfma_f32_16x16x32_bf16 v[124:127], a[108:111], a[68:71], v[124:127]
  v_add_u32 v18, s66, v18
  v_add_u32 v19, s66, v19
  v_add_u32 v21, s66, v21
  s_waitcnt vmcnt(0) lgkmcnt(0)
  s_barrier
  s_mov_b32 s5, 0x40000
Lpoll_13:
  v_cmp_ne_u64 vcc, s[94:95], v[6:7]
  s_nop 0
  s_cbranch_vccz Lpolld_14
  s_sleep 4
  buffer_load_dwordx2 v[6:7], off, s[96:99], s90 sc1
  s_sub_u32 s5, s5, 1
  s_waitcnt vmcnt(0)
  s_cbranch_scc0 Lpoll_13
Lpolld_14:
  v_mfma_f32_16x16x32_bf16 v[96:99], a[112:115], a[80:83], v[96:99]
  s_lshl_b32 s6, s78, 1
  s_add_u32 s6, s6, s77
  s_lshl_b32 s6, s6, 2
  v_mfma_f32_16x16x32_bf16 v[112:115], a[112:115], a[84:87], v[112:115]
  s_add_u32 s6, s6, s3
  s_lshl_b32 s6, s6, 13
  s_add_u32 s7, s6, 4096
  v_mfma_f32_16x16x32_bf16 v[100:103], a[116:119], a[80:83], v[100:103]
  buffer_load_dwordx4 v[192:195], v2, s[16:19], s6 offen offset:0 sc1
  ds_read_b128 a[64:67], v16 offset:0
  v_mfma_f32_16x16x32_bf16 v[116:119], a[116:119], a[84:87], v[116:119]
  buffer_load_dwordx4 v[196:199], v2, s[16:19], s6 offen offset:1024 sc1
  ds_read_b64_tr_b16 a[96:97], v18 offset:16384
  v_mfma_f32_16x16x32_bf16 v[104:107], a[120:123], a[80:83], v[104:107]
  buffer_load_dwordx4 v[200:203], v2, s[16:19], s6 offen offset:2048 sc1
  ds_read_b64_tr_b16 a[98:99], v18 offset:18432
  v_mfma_f32_16x16x32_bf16 v[120:123], a[120:123], a[84:87], v[120:123]
  buffer_load_dwordx4 v[204:207], v2, s[16:19], s6 offen offset:3072 sc1
  ds_read_b128 a[68:71], v16 offset:1024
  v_mfma_f32_16x16x32_bf16 v[108:111], a[124:127], a[80:83], v[108:111]
  ds_read_b64_tr_b16 a[100:101], v19 offset:16384
  ds_read_b64_tr_b16 a[102:103], v19 offset:18432
  v_mfma_f32_16x16x32_bf16 v[124:127], a[124:127], a[84:87], v[124:127]
  ds_read_b64_tr_b16 a[104:105], v20 offset:16384
  ds_read_b64_tr_b16 a[106:107], v20 offset:18432
  ds_read_b64_tr_b16 a[108:109], v21 offset:16384
  ds_read_b64_tr_b16 a[110:111], v21 offset:18432
  s_waitcnt lgkmcnt(0)
  v_mfma_f32_16x16x32_bf16 v[96:99], a[96:99], a[64:67], v[96:99]
  buffer_load_dwordx4 v[208:211], v2, s[16:19], s7 offen offset:0 sc1
  ds_read_b128 a[80:83], v16 offset:8192
  v_mfma_f32_16x16x32_bf16 v[112:115], a[96:99], a[68:71], v[112:115]
  buffer_load_dwordx4 v[212:215], v2, s[16:19], s7 offen offset:1024 sc1
  ds_read_b64_tr_b16 a[112:113], v18 offset:20480
  v_mfma_f32_16x16x32_bf16 v[100:103], a[100:103], a[64:67], v[100:103]
  ds_read_b64_tr_b16 a[114:115], v18 offset:22528
  ds_read_b128 a[84:87], v16 offset:9216
  v_mfma_f32_16x16x32_bf16 v[116:119], a[100:103], a[68:71], v[116:119]
  buffer_load_dwordx4 v[216:219], v2, s[16:19], s7 offen offset:2048 sc1
  ds_read_b64_tr_b16 a[116:117], v19 offset:20480
  v_mfma_f32_16x16x32_bf16 v[104:107], a[104:107], a[64:67], v[104:107]
  ds_read_b64_tr_b16 a[118:119], v19 offset:22528
  ds_read_b64_tr_b16 a[120:121], v20 offset:20480
  v_mfma_f32_16x16x32_bf16 v[120:123], a[104:107], a[68:71], v[120:123]
  buffer_load_dwordx4 v[220:223], v2, s[16:19], s7 offen offset:3072 sc1
  ds_read_b64_tr_b16 a[122:123], v20 offset:22528
  v_mfma_f32_16x16x32_bf16 v[108:111], a[108:111], a[64:67], v[108:111]
  s_add_u32 s64, s64, s66
  ds_read_b64_tr_b16 a[124:125], v21 offset:20480
  ds_read_b64_tr_b16 a[126:127], v21 offset:22528
  v_mfma_f32_16x16x32_bf16 v[124:127], a[108:111], a[68:71], v[124:127]
  s_add_u32 s65, s65, 1
  s_cmp_eq_u32 s65, 4
  s_cselect_b32 s65, 0, s65
  s_cselect_b32 s66, s67, s68
  v_add_u32 v16, s66, v16
  v_add_u32 v17, s66, v17
  v_add_u32 v18, s66, v18
  v_add_u32 v19, s66, v19
  v_add_u32 v20, s66, v20
  v_add_u32 v21, s66, v21
  s_waitcnt vmcnt(8) lgkmcnt(0)
  s_barrier
  v_mfma_f32_16x16x32_bf16 v[96:99], a[112:115], a[80:83], v[96:99]
  ds_read_b128 a[64:67], v16 offset:0
  ds_read_b64_tr_b16 a[96:97], v18 offset:16384
  v_mfma_f32_16x16x32_bf16 v[112:115], a[112:115], a[84:87], v[112:115]
  ds_read_b64_tr_b16 a[98:99], v18 offset:18432
  ds_read_b128 a[68:71], v16 offset:1024
  v_mfma_f32_16x16x32_bf16 v[100:103], a[116:119], a[80:83], v[100:103]
  ds_read_b64_tr_b16 a[100:101], v19 offset:16384
  v_mfma_f32_16x16x32_bf16 v[116:119], a[116:119], a[84:87], v[116:119]
  ds_read_b64_tr_b16 a[102:103], v19 offset:18432
  ds_read_b64_tr_b16 a[104:105], v20 offset:16384
  v_mfma_f32_16x16x32_bf16 v[104:107], a[120:123], a[80:83], v[104:107]
  ds_read_b64_tr_b16 a[106:107], v20 offset:18432
  ds_read_b64_tr_b16 a[108:109], v21 offset:16384
  v_mfma_f32_16x16x32_bf16 v[120:123], a[120:123], a[84:87], v[120:123]
  ds_read_b64_tr_b16 a[110:111], v21 offset:18432
  v_mfma_f32_16x16x32_bf16 v[108:111], a[124:127], a[80:83], v[108:111]
  v_mfma_f32_16x16x32_bf16 v[124:127], a[124:127], a[84:87], v[124:127]
  s_waitcnt lgkmcnt(0)
  v_mfma_f32_16x16x32_bf16 v[96:99], a[96:99], a[64:67], v[96:99]
  ds_read_b128 a[80:83], v16 offset:8192
  ds_read_b64_tr_b16 a[112:113], v18 offset:20480
  v_mfma_f32_16x16x32_bf16 v[112:115], a[96:99], a[68:71], v[112:115]
  ds_read_b64_tr_b16 a[114:115], v18 offset:22528
  ds_read_b128 a[84:87], v16 offset:9216
  v_mfma_f32_16x16x32_bf16 v[100:103], a[100:103], a[64:67], v[100:103]
  ds_read_b64_tr_b16 a[116:117], v19 offset:20480
  v_mfma_f32_16x16x32_bf16 v[116:119], a[100:103], a[68:71], v[116:119]
  ds_read_b64_tr_b16 a[118:119], v19 offset:22528
  ds_read_b64_tr_b16 a[120:121], v20 offset:20480
  v_mfma_f32_16x16x32_bf16 v[104:107], a[104:107], a[64:67], v[104:107]
  ds_read_b64_tr_b16 a[122:123], v20 offset:22528
  ds_read_b64_tr_b16 a[124:125], v21 offset:20480
  v_mfma_f32_16x16x32_bf16 v[120:123], a[104:107], a[68:71], v[120:123]
  ds_read_b64_tr_b16 a[126:127], v21 offset:22528
  v_mfma_f32_16x16x32_bf16 v[108:111], a[108:111], a[64:67], v[108:111]
  v_mfma_f32_16x16x32_bf16 v[124:127], a[108:111], a[68:71], v[124:127]
  s_lshl_b32 s4, s73, 19
  s_lshl_b32 s72, s76, 8
  s_add_u32 s4, s4, s72
  s_and_b32 s72, s3, 1
  s_lshl_b32 s72, s72, 7
  s_add_u32 s4, s4, s72
  s_lshr_b32 s72, s3, 1
  s_lshl_b32 s72, s72, 1
  s_add_u32 s72, s72, s77
  s_lshl_b32 s72, s72, 12
  s_add_u32 s4, s4, s72
  s_add_u32 s5, s4, 262144
  s_waitcnt lgkmcnt(0)
  v_mfma_f32_16x16x32_bf16 v[96:99], a[112:115], a[80:83], v[96:99]
  v_mfma_f32_16x16x32_bf16 v[112:115], a[112:115], a[84:87], v[112:115]
  v_mfma_f32_16x16x32_bf16 v[100:103], a[116:119], a[80:83], v[100:103]
  v_mfma_f32_16x16x32_bf16 v[116:119], a[116:119], a[84:87], v[116:119]
  v_mfma_f32_16x16x32_bf16 v[104:107], a[120:123], a[80:83], v[104:107]
  v_mfma_f32_16x16x32_bf16 v[120:123], a[120:123], a[84:87], v[120:123]
  v_mfma_f32_16x16x32_bf16 v[108:111], a[124:127], a[80:83], v[108:111]
  v_mfma_f32_16x16x32_bf16 v[124:127], a[124:127], a[84:87], v[124:127]
  s_waitcnt vmcnt(0)
  v_pk_add_f32 v[192:193], v[192:193], v[96:97]
  s_nop 2
  v_pk_add_f32 v[200:201], v[200:201], v[104:105]
  v_pk_add_f32 v[208:209], v[208:209], v[112:113]
  v_pk_add_f32 v[216:217], v[216:217], v[120:121]
  v_pk_add_f32 v[194:195], v[194:195], v[98:99]
  v_pk_add_f32 v[202:203], v[202:203], v[106:107]
  v_pk_add_f32 v[210:211], v[210:211], v[114:115]
  v_pk_add_f32 v[218:219], v[218:219], v[122:123]
  v_pk_add_f32 v[196:197], v[196:197], v[100:101]
  v_pk_add_f32 v[204:205], v[204:205], v[108:109]
  v_pk_add_f32 v[212:213], v[212:213], v[116:117]
  v_pk_add_f32 v[220:221], v[220:221], v[124:125]
  v_pk_add_f32 v[198:199], v[198:199], v[102:103]
  v_pk_add_f32 v[206:207], v[206:207], v[110:111]
  v_pk_add_f32 v[214:215], v[214:215], v[118:119]
  v_pk_add_f32 v[222:223], v[222:223], v[126:127]
  v_cvt_pk_bf16_f32 v192, v192, v193
  v_cvt_pk_bf16_f32 v200, v200, v201
  v_cvt_pk_bf16_f32 v208, v208, v209
  v_cvt_pk_bf16_f32 v216, v216, v217
  v_cvt_pk_bf16_f32 v193, v194, v195
  v_cvt_pk_bf16_f32 v201, v202, v203
  v_cvt_pk_bf16_f32 v209, v210, v211
  v_cvt_pk_bf16_f32 v217, v218, v219
  v_cvt_pk_bf16_f32 v194, v196, v197
  v_cvt_pk_bf16_f32 v202, v204, v205
  v_cvt_pk_bf16_f32 v210, v212, v213
  v_cvt_pk_bf16_f32 v218, v220, v221
  v_cvt_pk_bf16_f32 v195, v198, v199
  v_cvt_pk_bf16_f32 v203, v206, v207
  v_cvt_pk_bf16_f32 v211, v214, v215
  v_cvt_pk_bf16_f32 v219, v222, v223
  v_permlane16_swap_b32 v192, v194
  v_permlane16_swap_b32 v200, v202
  v_permlane16_swap_b32 v208, v210
  v_permlane16_swap_b32 v216, v218
  v_permlane16_swap_b32 v193, v195
  v_permlane16_swap_b32 v201, v203
  v_permlane16_swap_b32 v209, v211
  v_permlane16_swap_b32 v217, v219
  buffer_store_dwordx4 v[192:195], v26, s[20:23], s4 offen offset:0
  buffer_store_dwordx4 v[200:203], v26, s[20:23], s4 offen offset:64
  buffer_store_dwordx4 v[208:211], v26, s[20:23], s5 offen offset:0
  buffer_store_dwordx4 v[216:219], v26, s[20:23], s5 offen offset:64
Lend:
  s_endpgm
.section .rodata,"a"
.p2align 6
.amdhsa_kernel concat_heads__compressed_kv_cla__sliding_local_dilated__prompt_kernel
  .amdhsa_next_free_vgpr 512
  .amdhsa_next_free_sgpr 102
  .amdhsa_accum_offset 256
  .amdhsa_group_segment_fixed_size 0
  .amdhsa_kernarg_size 96
  .amdhsa_user_sgpr_count 2
  .amdhsa_user_sgpr_kernarg_segment_ptr 1
  .amdhsa_system_sgpr_workgroup_id_x 1
.end_amdhsa_kernel
```

```asm
; @launch grid=(256,1,1) block=(256,1,1) lds=163840
.amdgcn_target "amdgcn-amd-amdhsa--gfx950"
.text
.globl concat_heads__compressed_kv_cla__sliding_local_dilated__prompt_kernel
.p2align 8
.type concat_heads__compressed_kv_cla__sliding_local_dilated__prompt_kernel,@function
concat_heads__compressed_kv_cla__sliding_local_dilated__prompt_kernel:
  s_cmp_ge_u32 s2, 256
  s_cbranch_scc1 Lend
  s_load_dwordx16 s[64:79], s[0:1], 0
  s_load_dwordx8 s[80:87], s[0:1], 64
  v_lshrrev_b32 v2, 6, v0
  v_and_b32 v1, 63, v0
  v_readfirstlane_b32 s3, v2
  v_lshlrev_b32 v2, 4, v1
  s_bfe_u32 s59, s2, 0x30003
  s_lshr_b32 s4, s2, 7
  s_lshl_b32 s4, s4, 3
  s_add_u32 s59, s59, s4
  s_lshr_b32 s4, s2, 3
  s_xor_b32 s4, s4, s2
  s_bitcmp1_b32 s4, 3
  s_cbranch_scc1 Lp2
  s_and_b32 s4, s2, 1
  s_lshl_b32 s4, s4, 2
  s_and_b32 s5, s59, 3
  s_add_u32 s61, s4, s5
  s_bfe_u32 s4, s2, 0x20001
  s_lshl_b32 s4, s4, 2
  s_lshr_b32 s5, s59, 2
  s_add_u32 s62, s4, s5
  s_lshl_b32 s4, s3, 13
  s_add_u32 s36, s4, 65536
  s_add_u32 s41, s4, 98304
  v_lshrrev_b32 v32, 3, v1
  v_and_b32 v33, 6, v32
  v_and_b32 v34, 7, v1
  v_xor_b32 v33, v33, v34
  v_lshlrev_b32 v33, 4, v33
  s_lshl_b32 s4, s61, 2
  s_add_u32 s4, s4, s3
  s_lshl_b32 s4, s4, 6
  v_add_u32 v34, s4, v32
  v_lshl_add_u32 v34, v34, 10, v33
  v_add_u32 v48, 0, v34
  v_add_u32 v49, 7168, v34
  v_add_u32 v50, 14336, v34
  v_add_u32 v51, 21504, v34
  v_add_u32 v52, 32768, v34
  v_add_u32 v53, 39936, v34
  v_add_u32 v54, 47104, v34
  v_add_u32 v55, 54272, v34
  v_lshrrev_b32 v34, 2, v32
  v_and_b32 v35, 3, v32
  v_lshl_add_u32 v34, v34, 3, v35
  s_lshl_b32 s4, s62, 2
  s_add_u32 s4, s4, s3
  s_lshl_b32 s4, s4, 7
  v_lshl_add_u32 v34, v34, 13, v33
  v_add_u32 v34, s4, v34
  v_add_u32 v56, 0, v34
  v_add_u32 v57, 130048, v34
  v_add_u32 v58, 30720, v34
  v_add_u32 v59, 160768, v34
  v_add_u32 v60, 262144, v34
  v_add_u32 v61, 392192, v34
  v_add_u32 v62, 292864, v34
  v_add_u32 v63, 422912, v34
  s_and_b32 s6, s2, 7
  s_add_u32 s4, s61, s62
  s_and_b32 s49, s4, 3
  s_lshl_b32 s49, s49, 3
  s_or_b32 s49, s49, 0x80000
  s_bfe_u32 s48, 0x70702, s49
  s_add_u32 s48, s48, s6
  s_and_b32 s48, s48, 7
  s_lshl_b32 s46, s48, 7
  s_waitcnt lgkmcnt(0)
  s_mov_b32 s8, s66
  s_mov_b32 s9, s67
  s_mov_b32 s10, 2097152
  s_mov_b32 s11, 0x00020000
  s_mov_b32 s12, s70
  s_mov_b32 s13, s71
  s_mov_b32 s14, 4194304
  s_mov_b32 s15, 0x00020000
  s_mov_b32 s50, 9
  s_add_u32 s96, s86, 125829120
  s_addc_u32 s97, s87, 0
  s_mov_b32 s98, 262144
  s_mov_b32 s99, 0x00020000
  s_or_b32 s4, s2, s3
  s_cbranch_scc1 Ltag_1
  s_mov_b32 s4, 196608
  buffer_load_dwordx2 v[22:23], off, s[96:99], s4 sc1
Ltag_1:
  s_mov_b32 m0, s36
  s_nop 0
  buffer_load_dwordx4 v48, s[8:11], s46 offen offset:0 lds
  buffer_load_dwordx4 v49, s[8:11], s46 offen offset:1024 lds
  buffer_load_dwordx4 v50, s[8:11], s46 offen offset:2048 lds
  buffer_load_dwordx4 v51, s[8:11], s46 offen offset:3072 lds
  s_add_u32 m0, s36, 4096
  s_nop 0
  buffer_load_dwordx4 v52, s[8:11], s46 offen offset:0 lds
  buffer_load_dwordx4 v53, s[8:11], s46 offen offset:1024 lds
  buffer_load_dwordx4 v54, s[8:11], s46 offen offset:2048 lds
  buffer_load_dwordx4 v55, s[8:11], s46 offen offset:3072 lds
  s_sub_u32 s50, s50, 1
  s_cmp_eq_u32 s50, 0
  s_cselect_b32 s12, s72, s12
  s_cselect_b32 s13, s73, s13
  s_lshl_b32 s47, s48, 19
  s_bfe_u32 s34, 0x3020106, s49
  s_add_u32 s48, s48, s34
  s_add_u32 s49, s49, 8
  s_and_b32 s49, s49, 0x8001f
  s_and_b32 s48, s48, 7
  s_lshl_b32 s46, s48, 7
  s_mov_b32 m0, s41
  s_nop 0
  buffer_load_dwordx4 v56, s[12:15], s47 offen offset:0 lds
  buffer_load_dwordx4 v57, s[12:15], s47 offen offset:1024 lds
  buffer_load_dwordx4 v58, s[12:15], s47 offen offset:2048 lds
  buffer_load_dwordx4 v59, s[12:15], s47 offen offset:3072 lds
  s_add_u32 m0, s41, 4096
  s_nop 0
  buffer_load_dwordx4 v60, s[12:15], s47 offen offset:0 lds
  buffer_load_dwordx4 v61, s[12:15], s47 offen offset:1024 lds
  buffer_load_dwordx4 v62, s[12:15], s47 offen offset:2048 lds
  buffer_load_dwordx4 v63, s[12:15], s47 offen offset:3072 lds
  s_lshr_b32 s4, s3, 1
  s_lshl_b32 s4, s4, 14
  s_add_u32 s4, s4, 65536
  v_and_b32 v32, 15, v1
  v_lshlrev_b32 v32, 7, v32
  v_lshrrev_b32 v33, 4, v1
  v_and_b32 v34, 6, v1
  v_xor_b32 v33, v33, v34
  v_lshl_add_u32 v32, v33, 4, v32
  v_add_u32 v16, s4, v32
  v_xor_b32 v17, 64, v16
  s_and_b32 s4, s3, 1
  s_lshl_b32 s4, s4, 14
  s_add_u32 s4, s4, 98304
  v_lshrrev_b32 v32, 2, v1
  v_and_b32 v33, 6, v32
  v_lshlrev_b32 v32, 7, v32
  v_and_b32 v34, 1, v1
  v_lshl_add_u32 v32, v34, 3, v32
  v_add_u32 v32, s4, v32
  v_bfe_u32 v34, v1, 1, 1
  v_xor_b32 v33, v33, v34
  v_xor_b32 v34, 0, v33
  v_lshl_add_u32 v18, v34, 4, v32
  v_xor_b32 v34, 2, v33
  v_lshl_add_u32 v19, v34, 4, v32
  v_xor_b32 v34, 4, v33
  v_lshl_add_u32 v20, v34, 4, v32
  s_add_u32 m0, s36, -65536
  s_nop 0
  buffer_load_dwordx4 v48, s[8:11], s46 offen offset:0 lds
  v_xor_b32 v34, 6, v33
  v_lshl_add_u32 v21, v34, 4, v32
  s_and_b32 s24, s2, 7
  s_lshr_b32 s4, s2, 6
  s_lshl_b32 s4, s4, 3
  s_add_u32 s24, s24, s4
  s_lshr_b32 s4, s2, 3
  s_and_b32 s25, s4, 6
  s_xor_b32 s4, s4, s2
  s_bfe_u32 s4, s4, 0x10003
  s_add_u32 s25, s25, s4
  v_lshrrev_b32 v24, 3, v1
  v_and_b32 v25, 6, v24
  v_and_b32 v26, 7, v1
  v_xor_b32 v25, v25, v26
  buffer_load_dwordx4 v49, s[8:11], s46 offen offset:1024 lds
  v_lshlrev_b32 v25, 4, v25
  s_and_b32 s4, s3, 1
  s_lshl_b32 s4, s4, 16
  s_lshr_b32 s5, s3, 1
  s_lshl_b32 s5, s5, 7
  s_add_u32 s4, s4, s5
  v_lshl_add_u32 v24, v24, 11, v25
  v_add_u32 v24, s4, v24
  v_add_u32 v25, 0, v24
  v_accvgpr_write_b32 a212, v25
  v_add_u32 v25, 15360, v24
  buffer_load_dwordx4 v50, s[8:11], s46 offen offset:2048 lds
  v_accvgpr_write_b32 a213, v25
  v_add_u32 v25, 30720, v24
  v_accvgpr_write_b32 a214, v25
  v_add_u32 v25, 46080, v24
  v_accvgpr_write_b32 a215, v25
  buffer_load_dwordx4 v51, s[8:11], s46 offen offset:3072 lds
  v_accvgpr_write_b32 a236, 0
  v_mov_b32 v27, 0x3f803f80
  v_accvgpr_write_b32 a208, v27
  v_accvgpr_write_b32 a237, 0
  v_accvgpr_write_b32 a209, v27
  s_add_u32 m0, s36, -61440
  s_nop 0
  buffer_load_dwordx4 v52, s[8:11], s46 offen offset:0 lds
  v_accvgpr_write_b32 a238, 0
  v_accvgpr_write_b32 a210, v27
  v_accvgpr_write_b32 a239, 0
  v_accvgpr_write_b32 a211, v27
  v_lshrrev_b32 v24, 3, v1
  buffer_load_dwordx4 v53, s[8:11], s46 offen offset:1024 lds
  v_and_b32 v25, 6, v24
  v_and_b32 v26, 7, v1
  v_xor_b32 v25, v25, v26
  v_lshlrev_b32 v25, 4, v25
  v_lshlrev_b32 v26, 2, v24
  buffer_load_dwordx4 v54, s[8:11], s46 offen offset:2048 lds
  v_add_u32 v26, s3, v26
  v_lshl_add_u32 v26, v26, 11, v25
  v_add_u32 v27, 0, v26
  v_accvgpr_write_b32 a222, v27
  v_add_u32 v27, 64512, v26
  buffer_load_dwordx4 v55, s[8:11], s46 offen offset:3072 lds
  v_accvgpr_write_b32 a223, v27
  v_add_u32 v27, 129024, v26
  v_accvgpr_write_b32 a224, v27
  v_add_u32 v27, 193536, v26
  v_accvgpr_write_b32 a225, v27
  s_sub_u32 s50, s50, 1
  s_cmp_eq_u32 s50, 0
  s_cselect_b32 s12, s72, s12
  s_cselect_b32 s13, s73, s13
  s_lshl_b32 s47, s48, 19
  s_bfe_u32 s34, 0x3020106, s49
  s_add_u32 s48, s48, s34
  s_add_u32 s49, s49, 8
  s_and_b32 s49, s49, 0x8001f
  s_and_b32 s48, s48, 7
  s_lshl_b32 s46, s48, 7
  s_add_u32 m0, s41, 32768
  s_nop 0
  buffer_load_dwordx4 v56, s[12:15], s47 offen offset:0 lds
  v_lshrrev_b32 v26, 2, v24
  v_and_b32 v27, 3, v24
  v_lshl_add_u32 v26, v26, 3, v27
  s_and_b32 s4, s3, 1
  s_lshl_b32 s4, s4, 18
  s_lshr_b32 s5, s3, 1
  s_lshl_b32 s5, s5, 7
  s_add_u32 s4, s4, s5
  s_lshl_b32 s5, s24, 8
  s_add_u32 s4, s4, s5
  v_lshl_add_u32 v26, v26, 13, v25
  v_add_u32 v26, s4, v26
  v_add_u32 v27, 0, v26
  buffer_load_dwordx4 v57, s[12:15], s47 offen offset:1024 lds
  v_accvgpr_write_b32 a226, v27
  v_add_u32 v27, 130048, v26
  v_accvgpr_write_b32 a227, v27
  v_add_u32 v27, 30720, v26
  v_accvgpr_write_b32 a228, v27
  buffer_load_dwordx4 v58, s[12:15], s47 offen offset:2048 lds
  v_add_u32 v27, 160768, v26
  v_accvgpr_write_b32 a229, v27
  s_lshl_b32 s4, s3, 13
  s_add_u32 s4, s4, 98304
  v_and_b32 v24, 15, v1
  v_lshlrev_b32 v24, 7, v24
  v_lshrrev_b32 v25, 4, v1
  v_and_b32 v26, 6, v1
  buffer_load_dwordx4 v59, s[12:15], s47 offen offset:3072 lds
  v_xor_b32 v25, v25, v26
  v_lshl_add_u32 v24, v25, 4, v24
  v_add_u32 v28, s4, v24
  v_xor_b32 v29, 64, v28
  v_lshrrev_b32 v24, 2, v1
  s_add_u32 m0, s41, 36864
  s_nop 0
  buffer_load_dwordx4 v60, s[12:15], s47 offen offset:0 lds
  v_and_b32 v25, 6, v24
  v_lshlrev_b32 v24, 7, v24
  v_and_b32 v26, 1, v1
  v_lshl_add_u32 v24, v26, 3, v24
  v_add_u32 v24, 0, v24
  buffer_load_dwordx4 v61, s[12:15], s47 offen offset:1024 lds
  v_bfe_u32 v26, v1, 1, 1
  v_xor_b32 v25, v25, v26
  v_xor_b32 v26, 0, v25
  v_lshl_add_u32 v30, v26, 4, v24
  v_xor_b32 v26, 2, v25
  buffer_load_dwordx4 v62, s[12:15], s47 offen offset:2048 lds
  v_lshl_add_u32 v31, v26, 4, v24
  v_xor_b32 v26, 4, v25
  v_lshl_add_u32 v32, v26, 4, v24
  v_xor_b32 v26, 6, v25
  v_lshl_add_u32 v33, v26, 4, v24
  buffer_load_dwordx4 v63, s[12:15], s47 offen offset:3072 lds
  v_accvgpr_write_b32 a230, v28
  v_accvgpr_write_b32 a231, v29
  v_accvgpr_write_b32 a232, v30
  v_accvgpr_write_b32 a233, v31
  v_accvgpr_write_b32 a234, v32
  v_accvgpr_write_b32 a235, v33
  s_and_b32 s4, s3, 1
  s_lshl_b32 s5, s62, 1
  s_add_u32 s4, s4, s5
  s_lshr_b32 s5, s3, 1
  s_lshl_b32 s6, s61, 1
  s_add_u32 s5, s5, s6
  s_add_u32 s16, s86, 16777216
  s_addc_u32 s17, s87, 0
  s_mov_b32 s18, 33554432
  s_mov_b32 s19, 0x00020000
  s_lshl_b32 s4, s4, 20
  s_lshl_b32 s5, s5, 16
  s_add_u32 s63, s4, s5
  s_mov_b32 s37, 0
  s_mov_b32 s39, 4294901760
  s_mov_b32 s40, 32768
  s_mov_b32 s37, 2
  s_mov_b32 s42, 0
  s_mov_b32 s44, 4294934528
  s_mov_b32 s45, 32768
  s_mov_b32 s43, s44
  s_or_b32 s4, s2, s3
  s_cbranch_scc1 Ltag_2
  s_mov_b32 s4, 196608
  s_mov_b32 s92, s84
  s_mov_b32 s93, s85
  s_mov_b32 s94, 256
  s_mov_b32 s95, 0x00020000
  s_waitcnt vmcnt(32)
  v_add_u32 v22, 1, v22
  v_or_b32 v23, 0x80000000, v23
  buffer_store_dwordx2 v[22:23], off, s[96:99], s4 sc1
  buffer_store_dwordx2 v[22:23], off, s[92:95], 0 sc1
Ltag_2:
  s_waitcnt vmcnt(16)
  s_barrier
  ds_read_b128 a[0:3], v16 offset:0
  ds_read_b64_tr_b16 a[64:65], v18 offset:0
  ds_read_b64_tr_b16 a[66:67], v18 offset:2048
  ds_read_b128 a[4:7], v16 offset:2048
  ds_read_b128 a[8:11], v16 offset:4096
  ds_read_b128 a[12:15], v16 offset:6144
  ds_read_b128 a[16:19], v16 offset:8192
  ds_read_b128 a[20:23], v16 offset:10240
  ds_read_b128 a[24:27], v16 offset:12288
  ds_read_b128 a[28:31], v16 offset:14336
  ds_read_b64_tr_b16 a[68:69], v19 offset:0
  ds_read_b64_tr_b16 a[70:71], v19 offset:2048
  ds_read_b64_tr_b16 a[72:73], v20 offset:0
  ds_read_b64_tr_b16 a[74:75], v20 offset:2048
  ds_read_b64_tr_b16 a[76:77], v21 offset:0
  ds_read_b64_tr_b16 a[78:79], v21 offset:2048
  ds_read_b64_tr_b16 a[80:81], v18 offset:8192
  ds_read_b64_tr_b16 a[82:83], v18 offset:10240
  ds_read_b64_tr_b16 a[84:85], v19 offset:8192
  ds_read_b64_tr_b16 a[86:87], v19 offset:10240
  ds_read_b64_tr_b16 a[88:89], v20 offset:8192
  ds_read_b64_tr_b16 a[90:91], v20 offset:10240
  ds_read_b64_tr_b16 a[92:93], v21 offset:8192
  ds_read_b64_tr_b16 a[94:95], v21 offset:10240
  s_waitcnt lgkmcnt(0)
  v_mfma_f32_16x16x32_bf16 v[64:67], a[64:67], a[0:3], 0
  s_add_u32 m0, s36, -32768
  ds_read_b128 a[32:35], v17 offset:0
  v_mfma_f32_16x16x32_bf16 v[96:99], a[64:67], a[4:7], 0
  buffer_load_dwordx4 v48, s[8:11], s46 offen offset:0 lds
  v_mfma_f32_16x16x32_bf16 v[128:131], a[64:67], a[8:11], 0
  ds_read_b64_tr_b16 a[96:97], v18 offset:4096
  v_mfma_f32_16x16x32_bf16 v[160:163], a[64:67], a[12:15], 0
  v_mfma_f32_16x16x32_bf16 v[192:195], a[64:67], a[16:19], 0
  ds_read_b64_tr_b16 a[98:99], v18 offset:6144
  v_mfma_f32_16x16x32_bf16 v[224:227], a[64:67], a[20:23], 0
  v_mfma_f32_16x16x32_bf16 a[128:131], a[64:67], a[24:27], 0
  ds_read_b128 a[36:39], v17 offset:2048
  v_mfma_f32_16x16x32_bf16 a[160:163], a[64:67], a[28:31], 0
  buffer_load_dwordx4 v49, s[8:11], s46 offen offset:1024 lds
  v_mfma_f32_16x16x32_bf16 v[68:71], a[68:71], a[0:3], 0
  v_mfma_f32_16x16x32_bf16 v[100:103], a[68:71], a[4:7], 0
  ds_read_b128 a[40:43], v17 offset:4096
  v_mfma_f32_16x16x32_bf16 v[132:135], a[68:71], a[8:11], 0
  v_mfma_f32_16x16x32_bf16 v[164:167], a[68:71], a[12:15], 0
  ds_read_b128 a[44:47], v17 offset:6144
  v_mfma_f32_16x16x32_bf16 v[196:199], a[68:71], a[16:19], 0
  v_mfma_f32_16x16x32_bf16 v[228:231], a[68:71], a[20:23], 0
  ds_read_b128 a[48:51], v17 offset:8192
  v_mfma_f32_16x16x32_bf16 a[132:135], a[68:71], a[24:27], 0
  buffer_load_dwordx4 v50, s[8:11], s46 offen offset:2048 lds
  v_mfma_f32_16x16x32_bf16 a[164:167], a[68:71], a[28:31], 0
  ds_read_b128 a[52:55], v17 offset:10240
  v_mfma_f32_16x16x32_bf16 v[72:75], a[72:75], a[0:3], 0
  v_mfma_f32_16x16x32_bf16 v[104:107], a[72:75], a[4:7], 0
  v_mfma_f32_16x16x32_bf16 v[136:139], a[72:75], a[8:11], 0
  ds_read_b128 a[56:59], v17 offset:12288
  v_mfma_f32_16x16x32_bf16 v[168:171], a[72:75], a[12:15], 0
  v_mfma_f32_16x16x32_bf16 v[200:203], a[72:75], a[16:19], 0
  ds_read_b128 a[60:63], v17 offset:14336
  v_mfma_f32_16x16x32_bf16 v[232:235], a[72:75], a[20:23], 0
  buffer_load_dwordx4 v51, s[8:11], s46 offen offset:3072 lds
  v_mfma_f32_16x16x32_bf16 a[136:139], a[72:75], a[24:27], 0
  s_add_u32 m0, s36, -28672
  ds_read_b64_tr_b16 a[100:101], v19 offset:4096
  v_mfma_f32_16x16x32_bf16 a[168:171], a[72:75], a[28:31], 0
  v_mfma_f32_16x16x32_bf16 v[76:79], a[76:79], a[0:3], 0
  ds_read_b64_tr_b16 a[102:103], v19 offset:6144
  v_mfma_f32_16x16x32_bf16 v[108:111], a[76:79], a[4:7], 0
  v_mfma_f32_16x16x32_bf16 v[140:143], a[76:79], a[8:11], 0
  v_mfma_f32_16x16x32_bf16 v[172:175], a[76:79], a[12:15], 0
  ds_read_b64_tr_b16 a[104:105], v20 offset:4096
  v_mfma_f32_16x16x32_bf16 v[204:207], a[76:79], a[16:19], 0
  buffer_load_dwordx4 v52, s[8:11], s46 offen offset:0 lds
  v_mfma_f32_16x16x32_bf16 v[236:239], a[76:79], a[20:23], 0
  ds_read_b64_tr_b16 a[106:107], v20 offset:6144
  v_mfma_f32_16x16x32_bf16 a[140:143], a[76:79], a[24:27], 0
  v_mfma_f32_16x16x32_bf16 a[172:175], a[76:79], a[28:31], 0
  ds_read_b64_tr_b16 a[108:109], v21 offset:4096
  v_mfma_f32_16x16x32_bf16 v[80:83], a[80:83], a[0:3], 0
  v_mfma_f32_16x16x32_bf16 v[112:115], a[80:83], a[4:7], 0
  ds_read_b64_tr_b16 a[110:111], v21 offset:6144
  v_mfma_f32_16x16x32_bf16 v[144:147], a[80:83], a[8:11], 0
  v_mfma_f32_16x16x32_bf16 v[176:179], a[80:83], a[12:15], 0
  buffer_load_dwordx4 v53, s[8:11], s46 offen offset:1024 lds
  v_mfma_f32_16x16x32_bf16 v[208:211], a[80:83], a[16:19], 0
  ds_read_b64_tr_b16 a[112:113], v18 offset:12288
  v_mfma_f32_16x16x32_bf16 v[240:243], a[80:83], a[20:23], 0
  v_mfma_f32_16x16x32_bf16 a[144:147], a[80:83], a[24:27], 0
  ds_read_b64_tr_b16 a[114:115], v18 offset:14336
  v_mfma_f32_16x16x32_bf16 a[176:179], a[80:83], a[28:31], 0
  v_mfma_f32_16x16x32_bf16 v[84:87], a[84:87], a[0:3], 0
  ds_read_b64_tr_b16 a[116:117], v19 offset:12288
  v_mfma_f32_16x16x32_bf16 v[116:119], a[84:87], a[4:7], 0
  v_mfma_f32_16x16x32_bf16 v[148:151], a[84:87], a[8:11], 0
  buffer_load_dwordx4 v54, s[8:11], s46 offen offset:2048 lds
  ds_read_b64_tr_b16 a[118:119], v19 offset:14336
  v_mfma_f32_16x16x32_bf16 v[180:183], a[84:87], a[12:15], 0
  v_mfma_f32_16x16x32_bf16 v[212:215], a[84:87], a[16:19], 0
  v_mfma_f32_16x16x32_bf16 v[244:247], a[84:87], a[20:23], 0
  ds_read_b64_tr_b16 a[120:121], v20 offset:12288
  v_mfma_f32_16x16x32_bf16 a[148:151], a[84:87], a[24:27], 0
  v_mfma_f32_16x16x32_bf16 a[180:183], a[84:87], a[28:31], 0
  ds_read_b64_tr_b16 a[122:123], v20 offset:14336
  v_mfma_f32_16x16x32_bf16 v[88:91], a[88:91], a[0:3], 0
  v_mfma_f32_16x16x32_bf16 v[120:123], a[88:91], a[4:7], 0
  buffer_load_dwordx4 v55, s[8:11], s46 offen offset:3072 lds
  ds_read_b64_tr_b16 a[124:125], v21 offset:12288
  v_mfma_f32_16x16x32_bf16 v[152:155], a[88:91], a[8:11], 0
  s_sub_u32 s50, s50, 1
  s_cmp_eq_u32 s50, 0
  s_cselect_b32 s12, s72, s12
  s_cselect_b32 s13, s73, s13
  v_mfma_f32_16x16x32_bf16 v[184:187], a[88:91], a[12:15], 0
  s_lshl_b32 s47, s48, 19
  s_bfe_u32 s34, 0x3020106, s49
  s_add_u32 s48, s48, s34
  v_mfma_f32_16x16x32_bf16 v[216:219], a[88:91], a[16:19], 0
  s_add_u32 s49, s49, 8
  s_and_b32 s49, s49, 0x8001f
  s_and_b32 s48, s48, 7
  v_mfma_f32_16x16x32_bf16 v[248:251], a[88:91], a[20:23], 0
  s_lshl_b32 s46, s48, 7
  ds_read_b64_tr_b16 a[126:127], v21 offset:14336
  v_mfma_f32_16x16x32_bf16 a[152:155], a[88:91], a[24:27], 0
  s_add_u32 s37, s37, 1
  s_cmp_eq_u32 s37, 3
  s_cselect_b32 s37, 0, s37
  s_cselect_b32 s38, s39, s40
  v_mfma_f32_16x16x32_bf16 a[184:187], a[88:91], a[28:31], 0
  s_sub_u32 s43, 0, s43
  v_mfma_f32_16x16x32_bf16 v[92:95], a[92:95], a[0:3], 0
  v_add_u32 v16, s38, v16
  v_add_u32 v17, s38, v17
  v_mfma_f32_16x16x32_bf16 v[124:127], a[92:95], a[4:7], 0
  v_add_u32 v18, s43, v18
  v_add_u32 v19, s43, v19
  v_mfma_f32_16x16x32_bf16 v[156:159], a[92:95], a[8:11], 0
  v_add_u32 v20, s43, v20
  v_add_u32 v21, s43, v21
  v_mfma_f32_16x16x32_bf16 v[188:191], a[92:95], a[12:15], 0
  v_mfma_f32_16x16x32_bf16 v[220:223], a[92:95], a[16:19], 0
  v_mfma_f32_16x16x32_bf16 v[252:255], a[92:95], a[20:23], 0
  v_mfma_f32_16x16x32_bf16 a[156:159], a[92:95], a[24:27], 0
  v_mfma_f32_16x16x32_bf16 a[188:191], a[92:95], a[28:31], 0
  s_mov_b32 s35, 6
  s_waitcnt vmcnt(8) lgkmcnt(0)
  s_barrier
  .p2align 6
Lp1wx_loop:
  v_mfma_f32_16x16x32_bf16 v[64:67], a[96:99], a[32:35], v[64:67]
  s_mov_b32 m0, s41
  ds_read_b128 a[0:3], v16 offset:0
  v_mfma_f32_16x16x32_bf16 v[96:99], a[96:99], a[36:39], v[96:99]
  buffer_load_dwordx4 v56, s[12:15], s47 offen offset:0 lds
  v_mfma_f32_16x16x32_bf16 v[128:131], a[96:99], a[40:43], v[128:131]
  ds_read_b64_tr_b16 a[64:65], v18 offset:0
  v_mfma_f32_16x16x32_bf16 v[160:163], a[96:99], a[44:47], v[160:163]
  v_mfma_f32_16x16x32_bf16 v[192:195], a[96:99], a[48:51], v[192:195]
  ds_read_b64_tr_b16 a[66:67], v18 offset:2048
  v_mfma_f32_16x16x32_bf16 v[224:227], a[96:99], a[52:55], v[224:227]
  v_mfma_f32_16x16x32_bf16 a[128:131], a[96:99], a[56:59], a[128:131]
  ds_read_b128 a[4:7], v16 offset:2048
  v_mfma_f32_16x16x32_bf16 a[160:163], a[96:99], a[60:63], a[160:163]
  buffer_load_dwordx4 v57, s[12:15], s47 offen offset:1024 lds
  v_mfma_f32_16x16x32_bf16 v[68:71], a[100:103], a[32:35], v[68:71]
  v_mfma_f32_16x16x32_bf16 v[100:103], a[100:103], a[36:39], v[100:103]
  ds_read_b128 a[8:11], v16 offset:4096
  v_mfma_f32_16x16x32_bf16 v[132:135], a[100:103], a[40:43], v[132:135]
  v_mfma_f32_16x16x32_bf16 v[164:167], a[100:103], a[44:47], v[164:167]
  ds_read_b128 a[12:15], v16 offset:6144
  v_mfma_f32_16x16x32_bf16 v[196:199], a[100:103], a[48:51], v[196:199]
  v_mfma_f32_16x16x32_bf16 v[228:231], a[100:103], a[52:55], v[228:231]
  ds_read_b128 a[16:19], v16 offset:8192
  v_mfma_f32_16x16x32_bf16 a[132:135], a[100:103], a[56:59], a[132:135]
  v_mfma_f32_16x16x32_bf16 a[164:167], a[100:103], a[60:63], a[164:167]
  buffer_load_dwordx4 v58, s[12:15], s47 offen offset:2048 lds
  ds_read_b128 a[20:23], v16 offset:10240
  v_mfma_f32_16x16x32_bf16 v[72:75], a[104:107], a[32:35], v[72:75]
  v_mfma_f32_16x16x32_bf16 v[104:107], a[104:107], a[36:39], v[104:107]
  v_mfma_f32_16x16x32_bf16 v[136:139], a[104:107], a[40:43], v[136:139]
  ds_read_b128 a[24:27], v16 offset:12288
  v_mfma_f32_16x16x32_bf16 v[168:171], a[104:107], a[44:47], v[168:171]
  v_mfma_f32_16x16x32_bf16 v[200:203], a[104:107], a[48:51], v[200:203]
  ds_read_b128 a[28:31], v16 offset:14336
  v_mfma_f32_16x16x32_bf16 v[232:235], a[104:107], a[52:55], v[232:235]
  v_mfma_f32_16x16x32_bf16 a[136:139], a[104:107], a[56:59], a[136:139]
  ds_read_b64_tr_b16 a[68:69], v19 offset:0
  v_mfma_f32_16x16x32_bf16 a[168:171], a[104:107], a[60:63], a[168:171]
  buffer_load_dwordx4 v59, s[12:15], s47 offen offset:3072 lds
  v_mfma_f32_16x16x32_bf16 v[76:79], a[108:111], a[32:35], v[76:79]
  s_add_u32 m0, s41, 4096
  ds_read_b64_tr_b16 a[70:71], v19 offset:2048
  v_mfma_f32_16x16x32_bf16 v[108:111], a[108:111], a[36:39], v[108:111]
  v_mfma_f32_16x16x32_bf16 v[140:143], a[108:111], a[40:43], v[140:143]
  v_mfma_f32_16x16x32_bf16 v[172:175], a[108:111], a[44:47], v[172:175]
  ds_read_b64_tr_b16 a[72:73], v20 offset:0
  v_mfma_f32_16x16x32_bf16 v[204:207], a[108:111], a[48:51], v[204:207]
  v_mfma_f32_16x16x32_bf16 v[236:239], a[108:111], a[52:55], v[236:239]
  ds_read_b64_tr_b16 a[74:75], v20 offset:2048
  v_mfma_f32_16x16x32_bf16 a[140:143], a[108:111], a[56:59], a[140:143]
  v_mfma_f32_16x16x32_bf16 a[172:175], a[108:111], a[60:63], a[172:175]
  buffer_load_dwordx4 v60, s[12:15], s47 offen offset:0 lds
  ds_read_b64_tr_b16 a[76:77], v21 offset:0
  v_mfma_f32_16x16x32_bf16 v[80:83], a[112:115], a[32:35], v[80:83]
  v_mfma_f32_16x16x32_bf16 v[112:115], a[112:115], a[36:39], v[112:115]
  ds_read_b64_tr_b16 a[78:79], v21 offset:2048
  v_mfma_f32_16x16x32_bf16 v[144:147], a[112:115], a[40:43], v[144:147]
  v_mfma_f32_16x16x32_bf16 v[176:179], a[112:115], a[44:47], v[176:179]
  v_mfma_f32_16x16x32_bf16 v[208:211], a[112:115], a[48:51], v[208:211]
  ds_read_b64_tr_b16 a[80:81], v18 offset:8192
  v_mfma_f32_16x16x32_bf16 v[240:243], a[112:115], a[52:55], v[240:243]
  v_mfma_f32_16x16x32_bf16 a[144:147], a[112:115], a[56:59], a[144:147]
  ds_read_b64_tr_b16 a[82:83], v18 offset:10240
  v_mfma_f32_16x16x32_bf16 a[176:179], a[112:115], a[60:63], a[176:179]
  buffer_load_dwordx4 v61, s[12:15], s47 offen offset:1024 lds
  v_mfma_f32_16x16x32_bf16 v[84:87], a[116:119], a[32:35], v[84:87]
  ds_read_b64_tr_b16 a[84:85], v19 offset:8192
  v_mfma_f32_16x16x32_bf16 v[116:119], a[116:119], a[36:39], v[116:119]
  v_mfma_f32_16x16x32_bf16 v[148:151], a[116:119], a[40:43], v[148:151]
  ds_read_b64_tr_b16 a[86:87], v19 offset:10240
  v_mfma_f32_16x16x32_bf16 v[180:183], a[116:119], a[44:47], v[180:183]
  v_mfma_f32_16x16x32_bf16 v[212:215], a[116:119], a[48:51], v[212:215]
  v_mfma_f32_16x16x32_bf16 v[244:247], a[116:119], a[52:55], v[244:247]
  ds_read_b64_tr_b16 a[88:89], v20 offset:8192
  v_mfma_f32_16x16x32_bf16 a[148:151], a[116:119], a[56:59], a[148:151]
  v_mfma_f32_16x16x32_bf16 a[180:183], a[116:119], a[60:63], a[180:183]
  buffer_load_dwordx4 v62, s[12:15], s47 offen offset:2048 lds
  ds_read_b64_tr_b16 a[90:91], v20 offset:10240
  v_mfma_f32_16x16x32_bf16 v[88:91], a[120:123], a[32:35], v[88:91]
  v_mfma_f32_16x16x32_bf16 v[120:123], a[120:123], a[36:39], v[120:123]
  ds_read_b64_tr_b16 a[92:93], v21 offset:8192
  v_mfma_f32_16x16x32_bf16 v[152:155], a[120:123], a[40:43], v[152:155]
  v_mfma_f32_16x16x32_bf16 v[184:187], a[120:123], a[44:47], v[184:187]
  ds_read_b64_tr_b16 a[94:95], v21 offset:10240
  v_mfma_f32_16x16x32_bf16 v[216:219], a[120:123], a[48:51], v[216:219]
  v_mfma_f32_16x16x32_bf16 v[248:251], a[120:123], a[52:55], v[248:251]
  v_mfma_f32_16x16x32_bf16 a[152:155], a[120:123], a[56:59], a[152:155]
  v_mfma_f32_16x16x32_bf16 a[184:187], a[120:123], a[60:63], a[184:187]
  buffer_load_dwordx4 v63, s[12:15], s47 offen offset:3072 lds
  v_mfma_f32_16x16x32_bf16 v[92:95], a[124:127], a[32:35], v[92:95]
  v_mfma_f32_16x16x32_bf16 v[124:127], a[124:127], a[36:39], v[124:127]
  v_mfma_f32_16x16x32_bf16 v[156:159], a[124:127], a[40:43], v[156:159]
  v_mfma_f32_16x16x32_bf16 v[188:191], a[124:127], a[44:47], v[188:191]
  v_mfma_f32_16x16x32_bf16 v[220:223], a[124:127], a[48:51], v[220:223]
  v_mfma_f32_16x16x32_bf16 v[252:255], a[124:127], a[52:55], v[252:255]
  v_mfma_f32_16x16x32_bf16 a[156:159], a[124:127], a[56:59], a[156:159]
  v_mfma_f32_16x16x32_bf16 a[188:191], a[124:127], a[60:63], a[188:191]
  s_waitcnt lgkmcnt(0)
  v_mfma_f32_16x16x32_bf16 v[64:67], a[64:67], a[0:3], v[64:67]
  s_mov_b32 m0, s36
  ds_read_b128 a[32:35], v17 offset:0
  v_mfma_f32_16x16x32_bf16 v[96:99], a[64:67], a[4:7], v[96:99]
  buffer_load_dwordx4 v48, s[8:11], s46 offen offset:0 lds
  v_mfma_f32_16x16x32_bf16 v[128:131], a[64:67], a[8:11], v[128:131]
  ds_read_b64_tr_b16 a[96:97], v18 offset:4096
  v_mfma_f32_16x16x32_bf16 v[160:163], a[64:67], a[12:15], v[160:163]
  v_mfma_f32_16x16x32_bf16 v[192:195], a[64:67], a[16:19], v[192:195]
  ds_read_b64_tr_b16 a[98:99], v18 offset:6144
  v_mfma_f32_16x16x32_bf16 v[224:227], a[64:67], a[20:23], v[224:227]
  v_mfma_f32_16x16x32_bf16 a[128:131], a[64:67], a[24:27], a[128:131]
  ds_read_b128 a[36:39], v17 offset:2048
  v_mfma_f32_16x16x32_bf16 a[160:163], a[64:67], a[28:31], a[160:163]
  buffer_load_dwordx4 v49, s[8:11], s46 offen offset:1024 lds
  v_mfma_f32_16x16x32_bf16 v[68:71], a[68:71], a[0:3], v[68:71]
  v_mfma_f32_16x16x32_bf16 v[100:103], a[68:71], a[4:7], v[100:103]
  ds_read_b128 a[40:43], v17 offset:4096
  v_mfma_f32_16x16x32_bf16 v[132:135], a[68:71], a[8:11], v[132:135]
  v_mfma_f32_16x16x32_bf16 v[164:167], a[68:71], a[12:15], v[164:167]
  ds_read_b128 a[44:47], v17 offset:6144
  v_mfma_f32_16x16x32_bf16 v[196:199], a[68:71], a[16:19], v[196:199]
  v_mfma_f32_16x16x32_bf16 v[228:231], a[68:71], a[20:23], v[228:231]
  ds_read_b128 a[48:51], v17 offset:8192
  v_mfma_f32_16x16x32_bf16 a[132:135], a[68:71], a[24:27], a[132:135]
  buffer_load_dwordx4 v50, s[8:11], s46 offen offset:2048 lds
  v_mfma_f32_16x16x32_bf16 a[164:167], a[68:71], a[28:31], a[164:167]
  ds_read_b128 a[52:55], v17 offset:10240
  v_mfma_f32_16x16x32_bf16 v[72:75], a[72:75], a[0:3], v[72:75]
  v_mfma_f32_16x16x32_bf16 v[104:107], a[72:75], a[4:7], v[104:107]
  v_mfma_f32_16x16x32_bf16 v[136:139], a[72:75], a[8:11], v[136:139]
  ds_read_b128 a[56:59], v17 offset:12288
  v_mfma_f32_16x16x32_bf16 v[168:171], a[72:75], a[12:15], v[168:171]
  v_mfma_f32_16x16x32_bf16 v[200:203], a[72:75], a[16:19], v[200:203]
  ds_read_b128 a[60:63], v17 offset:14336
  v_mfma_f32_16x16x32_bf16 v[232:235], a[72:75], a[20:23], v[232:235]
  buffer_load_dwordx4 v51, s[8:11], s46 offen offset:3072 lds
  v_mfma_f32_16x16x32_bf16 a[136:139], a[72:75], a[24:27], a[136:139]
  s_add_u32 m0, s36, 4096
  ds_read_b64_tr_b16 a[100:101], v19 offset:4096
  v_mfma_f32_16x16x32_bf16 a[168:171], a[72:75], a[28:31], a[168:171]
  v_mfma_f32_16x16x32_bf16 v[76:79], a[76:79], a[0:3], v[76:79]
  ds_read_b64_tr_b16 a[102:103], v19 offset:6144
  v_mfma_f32_16x16x32_bf16 v[108:111], a[76:79], a[4:7], v[108:111]
  v_mfma_f32_16x16x32_bf16 v[140:143], a[76:79], a[8:11], v[140:143]
  v_mfma_f32_16x16x32_bf16 v[172:175], a[76:79], a[12:15], v[172:175]
  ds_read_b64_tr_b16 a[104:105], v20 offset:4096
  v_mfma_f32_16x16x32_bf16 v[204:207], a[76:79], a[16:19], v[204:207]
  buffer_load_dwordx4 v52, s[8:11], s46 offen offset:0 lds
  v_mfma_f32_16x16x32_bf16 v[236:239], a[76:79], a[20:23], v[236:239]
  ds_read_b64_tr_b16 a[106:107], v20 offset:6144
  v_mfma_f32_16x16x32_bf16 a[140:143], a[76:79], a[24:27], a[140:143]
  v_mfma_f32_16x16x32_bf16 a[172:175], a[76:79], a[28:31], a[172:175]
  ds_read_b64_tr_b16 a[108:109], v21 offset:4096
  v_mfma_f32_16x16x32_bf16 v[80:83], a[80:83], a[0:3], v[80:83]
  v_mfma_f32_16x16x32_bf16 v[112:115], a[80:83], a[4:7], v[112:115]
  ds_read_b64_tr_b16 a[110:111], v21 offset:6144
  v_mfma_f32_16x16x32_bf16 v[144:147], a[80:83], a[8:11], v[144:147]
  v_mfma_f32_16x16x32_bf16 v[176:179], a[80:83], a[12:15], v[176:179]
  buffer_load_dwordx4 v53, s[8:11], s46 offen offset:1024 lds
  v_mfma_f32_16x16x32_bf16 v[208:211], a[80:83], a[16:19], v[208:211]
  ds_read_b64_tr_b16 a[112:113], v18 offset:12288
  v_mfma_f32_16x16x32_bf16 v[240:243], a[80:83], a[20:23], v[240:243]
  v_mfma_f32_16x16x32_bf16 a[144:147], a[80:83], a[24:27], a[144:147]
  ds_read_b64_tr_b16 a[114:115], v18 offset:14336
  v_mfma_f32_16x16x32_bf16 a[176:179], a[80:83], a[28:31], a[176:179]
  v_mfma_f32_16x16x32_bf16 v[84:87], a[84:87], a[0:3], v[84:87]
  ds_read_b64_tr_b16 a[116:117], v19 offset:12288
  v_mfma_f32_16x16x32_bf16 v[116:119], a[84:87], a[4:7], v[116:119]
  v_mfma_f32_16x16x32_bf16 v[148:151], a[84:87], a[8:11], v[148:151]
  buffer_load_dwordx4 v54, s[8:11], s46 offen offset:2048 lds
  ds_read_b64_tr_b16 a[118:119], v19 offset:14336
  v_mfma_f32_16x16x32_bf16 v[180:183], a[84:87], a[12:15], v[180:183]
  v_mfma_f32_16x16x32_bf16 v[212:215], a[84:87], a[16:19], v[212:215]
  v_mfma_f32_16x16x32_bf16 v[244:247], a[84:87], a[20:23], v[244:247]
  ds_read_b64_tr_b16 a[120:121], v20 offset:12288
  v_mfma_f32_16x16x32_bf16 a[148:151], a[84:87], a[24:27], a[148:151]
  v_mfma_f32_16x16x32_bf16 a[180:183], a[84:87], a[28:31], a[180:183]
  ds_read_b64_tr_b16 a[122:123], v20 offset:14336
  v_mfma_f32_16x16x32_bf16 v[88:91], a[88:91], a[0:3], v[88:91]
  v_mfma_f32_16x16x32_bf16 v[120:123], a[88:91], a[4:7], v[120:123]
  buffer_load_dwordx4 v55, s[8:11], s46 offen offset:3072 lds
  ds_read_b64_tr_b16 a[124:125], v21 offset:12288
  v_mfma_f32_16x16x32_bf16 v[152:155], a[88:91], a[8:11], v[152:155]
  s_sub_u32 s50, s50, 1
  s_cmp_eq_u32 s50, 0
  s_cselect_b32 s12, s72, s12
  s_cselect_b32 s13, s73, s13
  v_mfma_f32_16x16x32_bf16 v[184:187], a[88:91], a[12:15], v[184:187]
  s_lshl_b32 s47, s48, 19
  s_bfe_u32 s34, 0x3020106, s49
  s_add_u32 s48, s48, s34
  v_mfma_f32_16x16x32_bf16 v[216:219], a[88:91], a[16:19], v[216:219]
  s_add_u32 s49, s49, 8
  s_and_b32 s49, s49, 0x8001f
  s_and_b32 s48, s48, 7
  v_mfma_f32_16x16x32_bf16 v[248:251], a[88:91], a[20:23], v[248:251]
  s_lshl_b32 s46, s48, 7
  ds_read_b64_tr_b16 a[126:127], v21 offset:14336
  v_mfma_f32_16x16x32_bf16 a[152:155], a[88:91], a[24:27], a[152:155]
  s_add_u32 s36, s36, s38
  s_add_u32 s37, s37, 1
  s_cmp_eq_u32 s37, 3
  s_cselect_b32 s37, 0, s37
  s_cselect_b32 s38, s39, s40
  v_mfma_f32_16x16x32_bf16 a[184:187], a[88:91], a[28:31], a[184:187]
  s_add_u32 s41, s41, s43
  s_sub_u32 s43, 0, s43
  v_mfma_f32_16x16x32_bf16 v[92:95], a[92:95], a[0:3], v[92:95]
  v_add_u32 v16, s38, v16
  v_add_u32 v17, s38, v17
  v_mfma_f32_16x16x32_bf16 v[124:127], a[92:95], a[4:7], v[124:127]
  v_add_u32 v18, s43, v18
  v_add_u32 v19, s43, v19
  v_mfma_f32_16x16x32_bf16 v[156:159], a[92:95], a[8:11], v[156:159]
  v_add_u32 v20, s43, v20
  v_add_u32 v21, s43, v21
  v_mfma_f32_16x16x32_bf16 v[188:191], a[92:95], a[12:15], v[188:191]
  v_mfma_f32_16x16x32_bf16 v[220:223], a[92:95], a[16:19], v[220:223]
  v_mfma_f32_16x16x32_bf16 v[252:255], a[92:95], a[20:23], v[252:255]
  s_waitcnt vmcnt(8) lgkmcnt(0)
  s_barrier
  v_mfma_f32_16x16x32_bf16 a[156:159], a[92:95], a[24:27], a[156:159]
  s_sub_u32 s35, s35, 1
  v_mfma_f32_16x16x32_bf16 a[188:191], a[92:95], a[28:31], a[188:191]
  s_cmp_lg_u32 s35, 0
  s_cbranch_scc1 Lp1wx_loop
  v_mfma_f32_16x16x32_bf16 v[64:67], a[96:99], a[32:35], v[64:67]
  s_mov_b32 m0, s41
  ds_read_b128 a[0:3], v16 offset:0
  v_mfma_f32_16x16x32_bf16 v[96:99], a[96:99], a[36:39], v[96:99]
  buffer_load_dwordx4 v56, s[12:15], s47 offen offset:0 lds
  v_mfma_f32_16x16x32_bf16 v[128:131], a[96:99], a[40:43], v[128:131]
  ds_read_b64_tr_b16 a[64:65], v18 offset:0
  v_mfma_f32_16x16x32_bf16 v[160:163], a[96:99], a[44:47], v[160:163]
  buffer_load_dwordx4 v57, s[12:15], s47 offen offset:1024 lds
  v_mfma_f32_16x16x32_bf16 v[192:195], a[96:99], a[48:51], v[192:195]
  ds_read_b64_tr_b16 a[66:67], v18 offset:2048
  v_mfma_f32_16x16x32_bf16 v[224:227], a[96:99], a[52:55], v[224:227]
  v_mfma_f32_16x16x32_bf16 a[128:131], a[96:99], a[56:59], a[128:131]
  ds_read_b128 a[4:7], v16 offset:2048
  v_mfma_f32_16x16x32_bf16 a[160:163], a[96:99], a[60:63], a[160:163]
  buffer_load_dwordx4 v58, s[12:15], s47 offen offset:2048 lds
  v_mfma_f32_16x16x32_bf16 v[68:71], a[100:103], a[32:35], v[68:71]
  v_mfma_f32_16x16x32_bf16 v[100:103], a[100:103], a[36:39], v[100:103]
  ds_read_b128 a[8:11], v16 offset:4096
  v_mfma_f32_16x16x32_bf16 v[132:135], a[100:103], a[40:43], v[132:135]
  v_mfma_f32_16x16x32_bf16 v[164:167], a[100:103], a[44:47], v[164:167]
  buffer_load_dwordx4 v59, s[12:15], s47 offen offset:3072 lds
  ds_read_b128 a[12:15], v16 offset:6144
  v_mfma_f32_16x16x32_bf16 v[196:199], a[100:103], a[48:51], v[196:199]
  s_add_u32 m0, s41, 4096
  v_mfma_f32_16x16x32_bf16 v[228:231], a[100:103], a[52:55], v[228:231]
  ds_read_b128 a[16:19], v16 offset:8192
  v_mfma_f32_16x16x32_bf16 a[132:135], a[100:103], a[56:59], a[132:135]
  v_mfma_f32_16x16x32_bf16 a[164:167], a[100:103], a[60:63], a[164:167]
  buffer_load_dwordx4 v60, s[12:15], s47 offen offset:0 lds
  ds_read_b128 a[20:23], v16 offset:10240
  v_mfma_f32_16x16x32_bf16 v[72:75], a[104:107], a[32:35], v[72:75]
  v_mfma_f32_16x16x32_bf16 v[104:107], a[104:107], a[36:39], v[104:107]
  v_mfma_f32_16x16x32_bf16 v[136:139], a[104:107], a[40:43], v[136:139]
  ds_read_b128 a[24:27], v16 offset:12288
  v_mfma_f32_16x16x32_bf16 v[168:171], a[104:107], a[44:47], v[168:171]
  buffer_load_dwordx4 v61, s[12:15], s47 offen offset:1024 lds
  v_mfma_f32_16x16x32_bf16 v[200:203], a[104:107], a[48:51], v[200:203]
  ds_read_b128 a[28:31], v16 offset:14336
  v_mfma_f32_16x16x32_bf16 v[232:235], a[104:107], a[52:55], v[232:235]
  v_mfma_f32_16x16x32_bf16 a[136:139], a[104:107], a[56:59], a[136:139]
  ds_read_b64_tr_b16 a[68:69], v19 offset:0
  v_mfma_f32_16x16x32_bf16 a[168:171], a[104:107], a[60:63], a[168:171]
  buffer_load_dwordx4 v62, s[12:15], s47 offen offset:2048 lds
  v_mfma_f32_16x16x32_bf16 v[76:79], a[108:111], a[32:35], v[76:79]
  ds_read_b64_tr_b16 a[70:71], v19 offset:2048
  v_mfma_f32_16x16x32_bf16 v[108:111], a[108:111], a[36:39], v[108:111]
  v_mfma_f32_16x16x32_bf16 v[140:143], a[108:111], a[40:43], v[140:143]
  v_mfma_f32_16x16x32_bf16 v[172:175], a[108:111], a[44:47], v[172:175]
  buffer_load_dwordx4 v63, s[12:15], s47 offen offset:3072 lds
  ds_read_b64_tr_b16 a[72:73], v20 offset:0
  v_mfma_f32_16x16x32_bf16 v[204:207], a[108:111], a[48:51], v[204:207]
  s_mov_b32 m0, s36
  v_mfma_f32_16x16x32_bf16 v[236:239], a[108:111], a[52:55], v[236:239]
  ds_read_b64_tr_b16 a[74:75], v20 offset:2048
  v_mfma_f32_16x16x32_bf16 a[140:143], a[108:111], a[56:59], a[140:143]
  v_mfma_f32_16x16x32_bf16 a[172:175], a[108:111], a[60:63], a[172:175]
  buffer_load_dwordx4 v48, s[8:11], s46 offen offset:0 lds
  ds_read_b64_tr_b16 a[76:77], v21 offset:0
  v_mfma_f32_16x16x32_bf16 v[80:83], a[112:115], a[32:35], v[80:83]
  v_mfma_f32_16x16x32_bf16 v[112:115], a[112:115], a[36:39], v[112:115]
  ds_read_b64_tr_b16 a[78:79], v21 offset:2048
  v_mfma_f32_16x16x32_bf16 v[144:147], a[112:115], a[40:43], v[144:147]
  v_mfma_f32_16x16x32_bf16 v[176:179], a[112:115], a[44:47], v[176:179]
  buffer_load_dwordx4 v49, s[8:11], s46 offen offset:1024 lds
  v_mfma_f32_16x16x32_bf16 v[208:211], a[112:115], a[48:51], v[208:211]
  ds_read_b64_tr_b16 a[80:81], v18 offset:8192
  v_mfma_f32_16x16x32_bf16 v[240:243], a[112:115], a[52:55], v[240:243]
  v_mfma_f32_16x16x32_bf16 a[144:147], a[112:115], a[56:59], a[144:147]
  ds_read_b64_tr_b16 a[82:83], v18 offset:10240
  v_mfma_f32_16x16x32_bf16 a[176:179], a[112:115], a[60:63], a[176:179]
  buffer_load_dwordx4 v50, s[8:11], s46 offen offset:2048 lds
  v_mfma_f32_16x16x32_bf16 v[84:87], a[116:119], a[32:35], v[84:87]
  ds_read_b64_tr_b16 a[84:85], v19 offset:8192
  v_mfma_f32_16x16x32_bf16 v[116:119], a[116:119], a[36:39], v[116:119]
  v_mfma_f32_16x16x32_bf16 v[148:151], a[116:119], a[40:43], v[148:151]
  ds_read_b64_tr_b16 a[86:87], v19 offset:10240
  v_mfma_f32_16x16x32_bf16 v[180:183], a[116:119], a[44:47], v[180:183]
  buffer_load_dwordx4 v51, s[8:11], s46 offen offset:3072 lds
  v_mfma_f32_16x16x32_bf16 v[212:215], a[116:119], a[48:51], v[212:215]
  s_add_u32 m0, s36, 4096
  v_mfma_f32_16x16x32_bf16 v[244:247], a[116:119], a[52:55], v[244:247]
  ds_read_b64_tr_b16 a[88:89], v20 offset:8192
  v_mfma_f32_16x16x32_bf16 a[148:151], a[116:119], a[56:59], a[148:151]
  v_mfma_f32_16x16x32_bf16 a[180:183], a[116:119], a[60:63], a[180:183]
  buffer_load_dwordx4 v52, s[8:11], s46 offen offset:0 lds
  ds_read_b64_tr_b16 a[90:91], v20 offset:10240
  v_mfma_f32_16x16x32_bf16 v[88:91], a[120:123], a[32:35], v[88:91]
  v_mfma_f32_16x16x32_bf16 v[120:123], a[120:123], a[36:39], v[120:123]
  ds_read_b64_tr_b16 a[92:93], v21 offset:8192
  v_mfma_f32_16x16x32_bf16 v[152:155], a[120:123], a[40:43], v[152:155]
  v_mfma_f32_16x16x32_bf16 v[184:187], a[120:123], a[44:47], v[184:187]
  buffer_load_dwordx4 v53, s[8:11], s46 offen offset:1024 lds
  ds_read_b64_tr_b16 a[94:95], v21 offset:10240
  v_mfma_f32_16x16x32_bf16 v[216:219], a[120:123], a[48:51], v[216:219]
  v_mfma_f32_16x16x32_bf16 v[248:251], a[120:123], a[52:55], v[248:251]
  v_mfma_f32_16x16x32_bf16 a[152:155], a[120:123], a[56:59], a[152:155]
  v_mfma_f32_16x16x32_bf16 a[184:187], a[120:123], a[60:63], a[184:187]
  buffer_load_dwordx4 v54, s[8:11], s46 offen offset:2048 lds
  v_mfma_f32_16x16x32_bf16 v[92:95], a[124:127], a[32:35], v[92:95]
  v_mfma_f32_16x16x32_bf16 v[124:127], a[124:127], a[36:39], v[124:127]
  v_mfma_f32_16x16x32_bf16 v[156:159], a[124:127], a[40:43], v[156:159]
  v_mfma_f32_16x16x32_bf16 v[188:191], a[124:127], a[44:47], v[188:191]
  buffer_load_dwordx4 v55, s[8:11], s46 offen offset:3072 lds
  v_mfma_f32_16x16x32_bf16 v[220:223], a[124:127], a[48:51], v[220:223]
  s_sub_u32 s50, s50, 1
  s_cmp_eq_u32 s50, 0
  s_cselect_b32 s12, s72, s12
  s_cselect_b32 s13, s73, s13
  v_mfma_f32_16x16x32_bf16 v[252:255], a[124:127], a[52:55], v[252:255]
  s_lshl_b32 s47, s48, 19
  s_bfe_u32 s34, 0x3020106, s49
  s_add_u32 s48, s48, s34
  v_mfma_f32_16x16x32_bf16 a[156:159], a[124:127], a[56:59], a[156:159]
  s_add_u32 s49, s49, 8
  s_and_b32 s49, s49, 0x8001f
  s_and_b32 s48, s48, 7
  v_mfma_f32_16x16x32_bf16 a[188:191], a[124:127], a[60:63], a[188:191]
  s_lshl_b32 s46, s48, 7
  s_waitcnt lgkmcnt(0)
  v_mfma_f32_16x16x32_bf16 v[128:131], a[64:67], a[8:11], v[128:131]
  ds_read_b128 a[32:35], v17 offset:0
  ds_read_b64_tr_b16 a[96:97], v18 offset:4096
  v_mfma_f32_16x16x32_bf16 v[132:135], a[68:71], a[8:11], v[132:135]
  ds_read_b64_tr_b16 a[98:99], v18 offset:6144
  ds_read_b128 a[36:39], v17 offset:2048
  v_mfma_f32_16x16x32_bf16 a[128:131], a[64:67], a[24:27], a[128:131]
  ds_read_b128 a[40:43], v17 offset:4096
  ds_read_b128 a[44:47], v17 offset:6144
  v_mfma_f32_16x16x32_bf16 a[132:135], a[68:71], a[24:27], a[132:135]
  ds_read_b128 a[48:51], v17 offset:8192
  ds_read_b128 a[52:55], v17 offset:10240
  v_mfma_f32_16x16x32_bf16 v[136:139], a[72:75], a[8:11], v[136:139]
  ds_read_b128 a[56:59], v17 offset:12288
  ds_read_b128 a[60:63], v17 offset:14336
  v_mfma_f32_16x16x32_bf16 v[140:143], a[76:79], a[8:11], v[140:143]
  ds_read_b64_tr_b16 a[100:101], v19 offset:4096
  ds_read_b64_tr_b16 a[102:103], v19 offset:6144
  v_mfma_f32_16x16x32_bf16 a[136:139], a[72:75], a[24:27], a[136:139]
  ds_read_b64_tr_b16 a[104:105], v20 offset:4096
  v_mfma_f32_16x16x32_bf16 a[140:143], a[76:79], a[24:27], a[140:143]
  ds_read_b64_tr_b16 a[106:107], v20 offset:6144
  ds_read_b64_tr_b16 a[108:109], v21 offset:4096
  v_mfma_f32_16x16x32_bf16 v[144:147], a[80:83], a[8:11], v[144:147]
  ds_read_b64_tr_b16 a[110:111], v21 offset:6144
  ds_read_b64_tr_b16 a[112:113], v18 offset:12288
  v_mfma_f32_16x16x32_bf16 v[148:151], a[84:87], a[8:11], v[148:151]
  ds_read_b64_tr_b16 a[114:115], v18 offset:14336
  ds_read_b64_tr_b16 a[116:117], v19 offset:12288
  v_mfma_f32_16x16x32_bf16 a[144:147], a[80:83], a[24:27], a[144:147]
  ds_read_b64_tr_b16 a[118:119], v19 offset:14336
  ds_read_b64_tr_b16 a[120:121], v20 offset:12288
  v_mfma_f32_16x16x32_bf16 a[148:151], a[84:87], a[24:27], a[148:151]
  ds_read_b64_tr_b16 a[122:123], v20 offset:14336
  ds_read_b64_tr_b16 a[124:125], v21 offset:12288
  v_mfma_f32_16x16x32_bf16 v[152:155], a[88:91], a[8:11], v[152:155]
  ds_read_b64_tr_b16 a[126:127], v21 offset:14336
  v_mfma_f32_16x16x32_bf16 v[156:159], a[92:95], a[8:11], v[156:159]
  v_mfma_f32_16x16x32_bf16 a[152:155], a[88:91], a[24:27], a[152:155]
  v_mfma_f32_16x16x32_bf16 a[156:159], a[92:95], a[24:27], a[156:159]
  v_mfma_f32_16x16x32_bf16 v[160:163], a[64:67], a[12:15], v[160:163]
  v_mfma_f32_16x16x32_bf16 v[164:167], a[68:71], a[12:15], v[164:167]
  s_add_u32 s36, s36, s38
  s_add_u32 s37, s37, 1
  s_cmp_eq_u32 s37, 3
  s_cselect_b32 s37, 0, s37
  s_cselect_b32 s38, s39, s40
  v_add_u32 v16, s38, v16
  v_add_u32 v17, s38, v17
  s_add_u32 s41, s41, s43
  s_sub_u32 s43, 0, s43
  v_add_u32 v18, s43, v18
  v_add_u32 v19, s43, v19
  v_add_u32 v20, s43, v20
  v_add_u32 v21, s43, v21
  s_waitcnt vmcnt(8) lgkmcnt(0)
  s_barrier
  v_mfma_f32_16x16x32_bf16 v[128:131], a[96:99], a[40:43], v[128:131]
  s_mov_b32 m0, s41
  v_mfma_f32_16x16x32_bf16 v[132:135], a[100:103], a[40:43], v[132:135]
  buffer_load_dwordx4 v56, s[12:15], s47 offen offset:0 lds
  v_mfma_f32_16x16x32_bf16 a[128:131], a[96:99], a[56:59], a[128:131]
  v_mfma_f32_16x16x32_bf16 a[132:135], a[100:103], a[56:59], a[132:135]
  v_mfma_f32_16x16x32_bf16 v[136:139], a[104:107], a[40:43], v[136:139]
  v_mfma_f32_16x16x32_bf16 v[140:143], a[108:111], a[40:43], v[140:143]
  buffer_load_dwordx4 v57, s[12:15], s47 offen offset:1024 lds
  v_cvt_pk_bf16_f32 v128, v128, v129
  v_mfma_f32_16x16x32_bf16 a[136:139], a[104:107], a[56:59], a[136:139]
  v_cvt_pk_bf16_f32 v129, v130, v131
  v_cvt_pk_bf16_f32 v130, v132, v133
  v_mfma_f32_16x16x32_bf16 a[140:143], a[108:111], a[56:59], a[140:143]
  v_cvt_pk_bf16_f32 v131, v134, v135
  v_accvgpr_read_b32 v24, a128
  v_mfma_f32_16x16x32_bf16 v[144:147], a[112:115], a[40:43], v[144:147]
  v_accvgpr_read_b32 v25, a129
  v_accvgpr_read_b32 v26, a130
  v_mfma_f32_16x16x32_bf16 v[148:151], a[116:119], a[40:43], v[148:151]
  v_accvgpr_read_b32 v27, a131
  v_accvgpr_read_b32 v28, a132
  v_mfma_f32_16x16x32_bf16 a[144:147], a[112:115], a[56:59], a[144:147]
  v_accvgpr_read_b32 v29, a133
  v_accvgpr_read_b32 v30, a134
  v_mfma_f32_16x16x32_bf16 a[148:151], a[116:119], a[56:59], a[148:151]
  buffer_load_dwordx4 v58, s[12:15], s47 offen offset:2048 lds
  v_accvgpr_read_b32 v31, a135
  v_mfma_f32_16x16x32_bf16 v[152:155], a[120:123], a[40:43], v[152:155]
  v_cvt_pk_bf16_f32 v132, v24, v25
  v_cvt_pk_bf16_f32 v133, v26, v27
  v_mfma_f32_16x16x32_bf16 v[156:159], a[124:127], a[40:43], v[156:159]
  v_cvt_pk_bf16_f32 v134, v28, v29
  v_cvt_pk_bf16_f32 v135, v30, v31
  v_mfma_f32_16x16x32_bf16 a[152:155], a[120:123], a[56:59], a[152:155]
  s_add_u32 s60, s63, 8192
  buffer_store_dwordx4 v[128:131], v2, s[16:19], s60 offen offset:0 sc1
  v_cvt_pk_bf16_f32 v136, v136, v137
  v_mfma_f32_16x16x32_bf16 a[156:159], a[124:127], a[56:59], a[156:159]
  v_cvt_pk_bf16_f32 v137, v138, v139
  v_cvt_pk_bf16_f32 v138, v140, v141
  v_mfma_f32_16x16x32_bf16 v[160:163], a[96:99], a[44:47], v[160:163]
  v_cvt_pk_bf16_f32 v139, v142, v143
  v_mfma_f32_16x16x32_bf16 v[164:167], a[100:103], a[44:47], v[164:167]
  buffer_load_dwordx4 v59, s[12:15], s47 offen offset:3072 lds
  v_mfma_f32_16x16x32_bf16 a[160:163], a[64:67], a[28:31], a[160:163]
  s_add_u32 m0, s41, 4096
  v_mfma_f32_16x16x32_bf16 a[164:167], a[68:71], a[28:31], a[164:167]
  s_add_u32 s60, s63, 40960
  buffer_store_dwordx4 v[132:135], v2, s[16:19], s60 offen offset:0 sc1
  v_accvgpr_read_b32 v32, a136
  v_mfma_f32_16x16x32_bf16 a[160:163], a[96:99], a[60:63], a[160:163]
  v_accvgpr_read_b32 v33, a137
  v_accvgpr_read_b32 v34, a138
  v_mfma_f32_16x16x32_bf16 a[164:167], a[100:103], a[60:63], a[164:167]
  v_accvgpr_read_b32 v35, a139
  v_accvgpr_read_b32 v36, a140
  v_mfma_f32_16x16x32_bf16 v[168:171], a[72:75], a[12:15], v[168:171]
  buffer_load_dwordx4 v60, s[12:15], s47 offen offset:0 lds
  v_accvgpr_read_b32 v37, a141
  v_mfma_f32_16x16x32_bf16 v[172:175], a[76:79], a[12:15], v[172:175]
  v_accvgpr_read_b32 v38, a142
  v_accvgpr_read_b32 v39, a143
  v_mfma_f32_16x16x32_bf16 v[168:171], a[104:107], a[44:47], v[168:171]
  v_cvt_pk_bf16_f32 v140, v32, v33
  v_cvt_pk_bf16_f32 v141, v34, v35
  v_mfma_f32_16x16x32_bf16 v[172:175], a[108:111], a[44:47], v[172:175]
  v_cvt_pk_bf16_f32 v142, v36, v37
  v_cvt_pk_bf16_f32 v143, v38, v39
  v_mfma_f32_16x16x32_bf16 a[168:171], a[72:75], a[28:31], a[168:171]
  s_add_u32 s60, s63, 8192
  buffer_store_dwordx4 v[136:139], v2, s[16:19], s60 offen offset:1024 sc1
  v_cvt_pk_bf16_f32 v144, v144, v145
  v_mfma_f32_16x16x32_bf16 a[172:175], a[76:79], a[28:31], a[172:175]
  v_cvt_pk_bf16_f32 v145, v146, v147
  v_cvt_pk_bf16_f32 v146, v148, v149
  v_mfma_f32_16x16x32_bf16 a[168:171], a[104:107], a[60:63], a[168:171]
  buffer_load_dwordx4 v61, s[12:15], s47 offen offset:1024 lds
  v_cvt_pk_bf16_f32 v147, v150, v151
  v_mfma_f32_16x16x32_bf16 a[172:175], a[108:111], a[60:63], a[172:175]
  s_add_u32 s60, s63, 40960
  buffer_store_dwordx4 v[140:143], v2, s[16:19], s60 offen offset:1024 sc1
  v_accvgpr_read_b32 v40, a144
  v_mfma_f32_16x16x32_bf16 v[176:179], a[80:83], a[12:15], v[176:179]
  v_accvgpr_read_b32 v41, a145
  v_accvgpr_read_b32 v42, a146
  v_mfma_f32_16x16x32_bf16 v[180:183], a[84:87], a[12:15], v[180:183]
  v_accvgpr_read_b32 v43, a147
  v_accvgpr_read_b32 v44, a148
  v_mfma_f32_16x16x32_bf16 v[176:179], a[112:115], a[44:47], v[176:179]
  v_accvgpr_read_b32 v45, a149
  v_accvgpr_read_b32 v46, a150
  v_mfma_f32_16x16x32_bf16 v[180:183], a[116:119], a[44:47], v[180:183]
  v_accvgpr_read_b32 v47, a151
  v_cvt_pk_bf16_f32 v148, v40, v41
  v_mfma_f32_16x16x32_bf16 a[176:179], a[80:83], a[28:31], a[176:179]
  buffer_load_dwordx4 v62, s[12:15], s47 offen offset:2048 lds
  v_cvt_pk_bf16_f32 v149, v42, v43
  v_mfma_f32_16x16x32_bf16 a[180:183], a[84:87], a[28:31], a[180:183]
  v_cvt_pk_bf16_f32 v150, v44, v45
  v_cvt_pk_bf16_f32 v151, v46, v47
  v_mfma_f32_16x16x32_bf16 a[176:179], a[112:115], a[60:63], a[176:179]
  s_add_u32 s60, s63, 8192
  buffer_store_dwordx4 v[144:147], v2, s[16:19], s60 offen offset:2048 sc1
  v_cvt_pk_bf16_f32 v152, v152, v153
  v_mfma_f32_16x16x32_bf16 a[180:183], a[116:119], a[60:63], a[180:183]
  v_cvt_pk_bf16_f32 v153, v154, v155
  v_cvt_pk_bf16_f32 v154, v156, v157
  v_mfma_f32_16x16x32_bf16 v[184:187], a[88:91], a[12:15], v[184:187]
  v_cvt_pk_bf16_f32 v155, v158, v159
  v_mfma_f32_16x16x32_bf16 v[188:191], a[92:95], a[12:15], v[188:191]
  buffer_load_dwordx4 v63, s[12:15], s47 offen offset:3072 lds
  v_mfma_f32_16x16x32_bf16 v[184:187], a[120:123], a[44:47], v[184:187]
  s_mov_b32 m0, s36
  v_mfma_f32_16x16x32_bf16 v[188:191], a[124:127], a[44:47], v[188:191]
  s_add_u32 s60, s63, 40960
  buffer_store_dwordx4 v[148:151], v2, s[16:19], s60 offen offset:2048 sc1
  v_accvgpr_read_b32 v24, a152
  v_mfma_f32_16x16x32_bf16 a[184:187], a[88:91], a[28:31], a[184:187]
  v_accvgpr_read_b32 v25, a153
  v_accvgpr_read_b32 v26, a154
  v_mfma_f32_16x16x32_bf16 a[188:191], a[92:95], a[28:31], a[188:191]
  v_accvgpr_read_b32 v27, a155
  v_accvgpr_read_b32 v28, a156
  v_mfma_f32_16x16x32_bf16 a[184:187], a[120:123], a[60:63], a[184:187]
  v_accvgpr_read_b32 v29, a157
  v_accvgpr_read_b32 v30, a158
  v_mfma_f32_16x16x32_bf16 a[188:191], a[124:127], a[60:63], a[188:191]
  buffer_load_dwordx4 v48, s[8:11], s46 offen offset:0 lds
  v_accvgpr_read_b32 v31, a159
  v_mfma_f32_16x16x32_bf16 v[192:195], a[64:67], a[16:19], v[192:195]
  v_cvt_pk_bf16_f32 v156, v24, v25
  v_cvt_pk_bf16_f32 v157, v26, v27
  v_mfma_f32_16x16x32_bf16 v[196:199], a[68:71], a[16:19], v[196:199]
  v_cvt_pk_bf16_f32 v158, v28, v29
  v_cvt_pk_bf16_f32 v159, v30, v31
  v_mfma_f32_16x16x32_bf16 v[192:195], a[96:99], a[48:51], v[192:195]
  v_cvt_pk_bf16_f32 v160, v160, v161
  v_cvt_pk_bf16_f32 v161, v162, v163
  v_mfma_f32_16x16x32_bf16 v[196:199], a[100:103], a[48:51], v[196:199]
  v_cvt_pk_bf16_f32 v162, v164, v165
  v_cvt_pk_bf16_f32 v163, v166, v167
  v_mfma_f32_16x16x32_bf16 v[64:67], a[64:67], a[0:3], v[64:67]
  s_add_u32 s60, s63, 8192
  buffer_store_dwordx4 v[152:155], v2, s[16:19], s60 offen offset:3072 sc1
  v_accvgpr_read_b32 v32, a160
  v_mfma_f32_16x16x32_bf16 v[68:71], a[68:71], a[0:3], v[68:71]
  buffer_load_dwordx4 v49, s[8:11], s46 offen offset:1024 lds
  v_accvgpr_read_b32 v33, a161
  v_mfma_f32_16x16x32_bf16 v[64:67], a[96:99], a[32:35], v[64:67]
  v_accvgpr_read_b32 v34, a162
  v_accvgpr_read_b32 v35, a163
  v_mfma_f32_16x16x32_bf16 v[68:71], a[100:103], a[32:35], v[68:71]
  v_accvgpr_read_b32 v36, a164
  v_accvgpr_read_b32 v37, a165
  v_mfma_f32_16x16x32_bf16 v[200:203], a[72:75], a[16:19], v[200:203]
  v_accvgpr_read_b32 v38, a166
  v_accvgpr_read_b32 v39, a167
  v_mfma_f32_16x16x32_bf16 v[204:207], a[76:79], a[16:19], v[204:207]
  v_cvt_pk_bf16_f32 v164, v32, v33
  v_cvt_pk_bf16_f32 v165, v34, v35
  v_mfma_f32_16x16x32_bf16 v[200:203], a[104:107], a[48:51], v[200:203]
  buffer_load_dwordx4 v50, s[8:11], s46 offen offset:2048 lds
  v_cvt_pk_bf16_f32 v166, v36, v37
  v_mfma_f32_16x16x32_bf16 v[204:207], a[108:111], a[48:51], v[204:207]
  v_cvt_pk_bf16_f32 v167, v38, v39
  v_mfma_f32_16x16x32_bf16 v[72:75], a[72:75], a[0:3], v[72:75]
  s_add_u32 s60, s63, 40960
  buffer_store_dwordx4 v[156:159], v2, s[16:19], s60 offen offset:3072 sc1
  v_cvt_pk_bf16_f32 v168, v168, v169
  v_mfma_f32_16x16x32_bf16 v[76:79], a[76:79], a[0:3], v[76:79]
  v_cvt_pk_bf16_f32 v169, v170, v171
  v_cvt_pk_bf16_f32 v170, v172, v173
  v_mfma_f32_16x16x32_bf16 v[72:75], a[104:107], a[32:35], v[72:75]
  v_cvt_pk_bf16_f32 v171, v174, v175
  v_mfma_f32_16x16x32_bf16 v[76:79], a[108:111], a[32:35], v[76:79]
  s_add_u32 s60, s63, 12288
  buffer_store_dwordx4 v[160:163], v2, s[16:19], s60 offen offset:0 sc1
  v_accvgpr_read_b32 v40, a168
  v_mfma_f32_16x16x32_bf16 v[208:211], a[80:83], a[16:19], v[208:211]
  buffer_load_dwordx4 v51, s[8:11], s46 offen offset:3072 lds
  v_accvgpr_read_b32 v41, a169
  v_mfma_f32_16x16x32_bf16 v[212:215], a[84:87], a[16:19], v[212:215]
  s_add_u32 m0, s36, 4096
  v_accvgpr_read_b32 v42, a170
  v_accvgpr_read_b32 v43, a171
  v_mfma_f32_16x16x32_bf16 v[208:211], a[112:115], a[48:51], v[208:211]
  v_accvgpr_read_b32 v44, a172
  v_accvgpr_read_b32 v45, a173
  v_mfma_f32_16x16x32_bf16 v[212:215], a[116:119], a[48:51], v[212:215]
  v_accvgpr_read_b32 v46, a174
  v_accvgpr_read_b32 v47, a175
  v_mfma_f32_16x16x32_bf16 v[80:83], a[80:83], a[0:3], v[80:83]
  v_cvt_pk_bf16_f32 v172, v40, v41
  v_cvt_pk_bf16_f32 v173, v42, v43
  v_mfma_f32_16x16x32_bf16 v[84:87], a[84:87], a[0:3], v[84:87]
  v_cvt_pk_bf16_f32 v174, v44, v45
  v_cvt_pk_bf16_f32 v175, v46, v47
  v_mfma_f32_16x16x32_bf16 v[80:83], a[112:115], a[32:35], v[80:83]
  buffer_load_dwordx4 v52, s[8:11], s46 offen offset:0 lds
  v_mfma_f32_16x16x32_bf16 v[84:87], a[116:119], a[32:35], v[84:87]
  s_add_u32 s60, s63, 45056
  buffer_store_dwordx4 v[164:167], v2, s[16:19], s60 offen offset:0 sc1
  v_cvt_pk_bf16_f32 v176, v176, v177
  v_mfma_f32_16x16x32_bf16 v[216:219], a[88:91], a[16:19], v[216:219]
  v_cvt_pk_bf16_f32 v177, v178, v179
  v_cvt_pk_bf16_f32 v178, v180, v181
  v_mfma_f32_16x16x32_bf16 v[220:223], a[92:95], a[16:19], v[220:223]
  v_cvt_pk_bf16_f32 v179, v182, v183
  v_mfma_f32_16x16x32_bf16 v[216:219], a[120:123], a[48:51], v[216:219]
  s_add_u32 s60, s63, 12288
  buffer_store_dwordx4 v[168:171], v2, s[16:19], s60 offen offset:1024 sc1
  v_accvgpr_read_b32 v24, a176
  v_mfma_f32_16x16x32_bf16 v[220:223], a[124:127], a[48:51], v[220:223]
  buffer_load_dwordx4 v53, s[8:11], s46 offen offset:1024 lds
  v_accvgpr_read_b32 v25, a177
  v_mfma_f32_16x16x32_bf16 v[88:91], a[88:91], a[0:3], v[88:91]
  v_accvgpr_read_b32 v26, a178
  v_accvgpr_read_b32 v27, a179
  v_mfma_f32_16x16x32_bf16 v[92:95], a[92:95], a[0:3], v[92:95]
  v_accvgpr_read_b32 v28, a180
  v_accvgpr_read_b32 v29, a181
  v_mfma_f32_16x16x32_bf16 v[224:227], a[64:67], a[20:23], v[224:227]
  v_accvgpr_read_b32 v30, a182
  v_accvgpr_read_b32 v31, a183
  v_mfma_f32_16x16x32_bf16 v[228:231], a[68:71], a[20:23], v[228:231]
  v_cvt_pk_bf16_f32 v180, v24, v25
  v_cvt_pk_bf16_f32 v181, v26, v27
  v_mfma_f32_16x16x32_bf16 v[96:99], a[64:67], a[4:7], v[96:99]
  v_cvt_pk_bf16_f32 v182, v28, v29
  v_cvt_pk_bf16_f32 v183, v30, v31
  v_mfma_f32_16x16x32_bf16 v[100:103], a[68:71], a[4:7], v[100:103]
  buffer_load_dwordx4 v54, s[8:11], s46 offen offset:2048 lds
  v_mfma_f32_16x16x32_bf16 v[232:235], a[72:75], a[20:23], v[232:235]
  s_add_u32 s60, s63, 45056
  buffer_store_dwordx4 v[172:175], v2, s[16:19], s60 offen offset:1024 sc1
  v_cvt_pk_bf16_f32 v184, v184, v185
  v_mfma_f32_16x16x32_bf16 v[236:239], a[76:79], a[20:23], v[236:239]
  v_cvt_pk_bf16_f32 v185, v186, v187
  v_cvt_pk_bf16_f32 v186, v188, v189
  v_mfma_f32_16x16x32_bf16 v[104:107], a[72:75], a[4:7], v[104:107]
  v_cvt_pk_bf16_f32 v187, v190, v191
  v_accvgpr_read_b32 v32, a184
  v_mfma_f32_16x16x32_bf16 v[108:111], a[76:79], a[4:7], v[108:111]
  v_accvgpr_read_b32 v33, a185
  v_accvgpr_read_b32 v34, a186
  v_mfma_f32_16x16x32_bf16 v[240:243], a[80:83], a[20:23], v[240:243]
  v_accvgpr_read_b32 v35, a187
  v_accvgpr_read_b32 v36, a188
  v_mfma_f32_16x16x32_bf16 v[244:247], a[84:87], a[20:23], v[244:247]
  buffer_load_dwordx4 v55, s[8:11], s46 offen offset:3072 lds
  v_accvgpr_read_b32 v37, a189
  v_mfma_f32_16x16x32_bf16 v[112:115], a[80:83], a[4:7], v[112:115]
  s_sub_u32 s50, s50, 1
  s_cmp_eq_u32 s50, 0
  s_cselect_b32 s12, s72, s12
  s_cselect_b32 s13, s73, s13
  v_mfma_f32_16x16x32_bf16 v[116:119], a[84:87], a[4:7], v[116:119]
  s_lshl_b32 s47, s48, 19
  s_bfe_u32 s34, 0x3020106, s49
  s_add_u32 s48, s48, s34
  v_mfma_f32_16x16x32_bf16 v[248:251], a[88:91], a[20:23], v[248:251]
  s_add_u32 s49, s49, 8
  s_and_b32 s49, s49, 0x8001f
  s_and_b32 s48, s48, 7
  v_mfma_f32_16x16x32_bf16 v[252:255], a[92:95], a[20:23], v[252:255]
  s_lshl_b32 s46, s48, 7
  v_accvgpr_read_b32 v38, a190
  v_accvgpr_read_b32 v39, a191
  v_mfma_f32_16x16x32_bf16 v[120:123], a[88:91], a[4:7], v[120:123]
  v_cvt_pk_bf16_f32 v188, v32, v33
  v_cvt_pk_bf16_f32 v189, v34, v35
  v_mfma_f32_16x16x32_bf16 v[124:127], a[92:95], a[4:7], v[124:127]
  v_cvt_pk_bf16_f32 v190, v36, v37
  v_cvt_pk_bf16_f32 v191, v38, v39
  v_mfma_f32_16x16x32_bf16 v[88:91], a[120:123], a[32:35], v[88:91]
  ds_read_b128 a[0:3], v16 offset:0
  ds_read_b64_tr_b16 a[64:65], v18 offset:0
  v_mfma_f32_16x16x32_bf16 v[92:95], a[124:127], a[32:35], v[92:95]
  ds_read_b64_tr_b16 a[66:67], v18 offset:2048
  ds_read_b128 a[4:7], v16 offset:2048
  v_mfma_f32_16x16x32_bf16 v[224:227], a[96:99], a[52:55], v[224:227]
  ds_read_b128 a[8:11], v16 offset:4096
  ds_read_b128 a[12:15], v16 offset:6144
  v_mfma_f32_16x16x32_bf16 v[228:231], a[100:103], a[52:55], v[228:231]
  ds_read_b128 a[16:19], v16 offset:8192
  ds_read_b128 a[20:23], v16 offset:10240
  v_mfma_f32_16x16x32_bf16 v[96:99], a[96:99], a[36:39], v[96:99]
  ds_read_b128 a[24:27], v16 offset:12288
  ds_read_b128 a[28:31], v16 offset:14336
  v_mfma_f32_16x16x32_bf16 v[100:103], a[100:103], a[36:39], v[100:103]
  ds_read_b64_tr_b16 a[68:69], v19 offset:0
  ds_read_b64_tr_b16 a[70:71], v19 offset:2048
  v_mfma_f32_16x16x32_bf16 v[232:235], a[104:107], a[52:55], v[232:235]
  ds_read_b64_tr_b16 a[72:73], v20 offset:0
  ds_read_b64_tr_b16 a[74:75], v20 offset:2048
  v_mfma_f32_16x16x32_bf16 v[236:239], a[108:111], a[52:55], v[236:239]
  ds_read_b64_tr_b16 a[76:77], v21 offset:0
  ds_read_b64_tr_b16 a[78:79], v21 offset:2048
  v_mfma_f32_16x16x32_bf16 v[104:107], a[104:107], a[36:39], v[104:107]
  ds_read_b64_tr_b16 a[80:81], v18 offset:8192
  ds_read_b64_tr_b16 a[82:83], v18 offset:10240
  v_mfma_f32_16x16x32_bf16 v[108:111], a[108:111], a[36:39], v[108:111]
  ds_read_b64_tr_b16 a[84:85], v19 offset:8192
  ds_read_b64_tr_b16 a[86:87], v19 offset:10240
  v_mfma_f32_16x16x32_bf16 v[240:243], a[112:115], a[52:55], v[240:243]
  ds_read_b64_tr_b16 a[88:89], v20 offset:8192
  ds_read_b64_tr_b16 a[90:91], v20 offset:10240
  v_mfma_f32_16x16x32_bf16 v[244:247], a[116:119], a[52:55], v[244:247]
  ds_read_b64_tr_b16 a[92:93], v21 offset:8192
  ds_read_b64_tr_b16 a[94:95], v21 offset:10240
  v_mfma_f32_16x16x32_bf16 v[112:115], a[112:115], a[36:39], v[112:115]
  v_cvt_pk_bf16_f32 v192, v192, v193
  v_cvt_pk_bf16_f32 v193, v194, v195
  v_mfma_f32_16x16x32_bf16 v[116:119], a[116:119], a[36:39], v[116:119]
  v_cvt_pk_bf16_f32 v194, v196, v197
  v_cvt_pk_bf16_f32 v195, v198, v199
  v_mfma_f32_16x16x32_bf16 v[248:251], a[120:123], a[52:55], v[248:251]
  v_cvt_pk_bf16_f32 v196, v64, v65
  v_cvt_pk_bf16_f32 v197, v66, v67
  v_mfma_f32_16x16x32_bf16 v[252:255], a[124:127], a[52:55], v[252:255]
  v_cvt_pk_bf16_f32 v198, v68, v69
  v_cvt_pk_bf16_f32 v199, v70, v71
  v_mfma_f32_16x16x32_bf16 v[120:123], a[120:123], a[36:39], v[120:123]
  v_cvt_pk_bf16_f32 v200, v200, v201
  v_cvt_pk_bf16_f32 v201, v202, v203
  v_mfma_f32_16x16x32_bf16 v[124:127], a[124:127], a[36:39], v[124:127]
  v_cvt_pk_bf16_f32 v202, v204, v205
  v_cvt_pk_bf16_f32 v203, v206, v207
  s_waitcnt lgkmcnt(0)
  v_mfma_f32_16x16x32_bf16 a[128:131], a[24:27], a[64:67], 0
  ds_read_b128 a[32:35], v17 offset:0
  ds_read_b64_tr_b16 a[96:97], v18 offset:4096
  v_mfma_f32_16x16x32_bf16 a[132:135], a[24:27], a[68:71], 0
  ds_read_b64_tr_b16 a[98:99], v18 offset:6144
  ds_read_b128 a[36:39], v17 offset:2048
  v_mfma_f32_16x16x32_bf16 a[136:139], a[24:27], a[72:75], 0
  ds_read_b128 a[40:43], v17 offset:4096
  ds_read_b128 a[44:47], v17 offset:6144
  v_mfma_f32_16x16x32_bf16 a[140:143], a[24:27], a[76:79], 0
  ds_read_b128 a[48:51], v17 offset:8192
  ds_read_b128 a[52:55], v17 offset:10240
  v_mfma_f32_16x16x32_bf16 a[144:147], a[24:27], a[80:83], 0
  ds_read_b128 a[56:59], v17 offset:12288
  ds_read_b128 a[60:63], v17 offset:14336
  v_mfma_f32_16x16x32_bf16 a[148:151], a[24:27], a[84:87], 0
  ds_read_b64_tr_b16 a[100:101], v19 offset:4096
  ds_read_b64_tr_b16 a[102:103], v19 offset:6144
  v_mfma_f32_16x16x32_bf16 a[152:155], a[24:27], a[88:91], 0
  ds_read_b64_tr_b16 a[104:105], v20 offset:4096
  v_cvt_pk_bf16_f32 v204, v72, v73
  v_mfma_f32_16x16x32_bf16 a[156:159], a[24:27], a[92:95], 0
  ds_read_b64_tr_b16 a[106:107], v20 offset:6144
  ds_read_b64_tr_b16 a[108:109], v21 offset:4096
  v_mfma_f32_16x16x32_bf16 a[160:163], a[28:31], a[64:67], 0
  ds_read_b64_tr_b16 a[110:111], v21 offset:6144
  ds_read_b64_tr_b16 a[112:113], v18 offset:12288
  v_mfma_f32_16x16x32_bf16 a[164:167], a[28:31], a[68:71], 0
  ds_read_b64_tr_b16 a[114:115], v18 offset:14336
  ds_read_b64_tr_b16 a[116:117], v19 offset:12288
  v_mfma_f32_16x16x32_bf16 a[168:171], a[28:31], a[72:75], 0
  ds_read_b64_tr_b16 a[118:119], v19 offset:14336
  ds_read_b64_tr_b16 a[120:121], v20 offset:12288
  v_mfma_f32_16x16x32_bf16 a[172:175], a[28:31], a[76:79], 0
  ds_read_b64_tr_b16 a[122:123], v20 offset:14336
  ds_read_b64_tr_b16 a[124:125], v21 offset:12288
  v_mfma_f32_16x16x32_bf16 a[176:179], a[28:31], a[80:83], 0
  ds_read_b64_tr_b16 a[126:127], v21 offset:14336
  v_cvt_pk_bf16_f32 v205, v74, v75
  v_mfma_f32_16x16x32_bf16 a[180:183], a[28:31], a[84:87], 0
  v_cvt_pk_bf16_f32 v206, v76, v77
  v_cvt_pk_bf16_f32 v207, v78, v79
  v_mfma_f32_16x16x32_bf16 a[184:187], a[28:31], a[88:91], 0
  v_cvt_pk_bf16_f32 v208, v208, v209
  v_cvt_pk_bf16_f32 v209, v210, v211
  v_mfma_f32_16x16x32_bf16 a[188:191], a[28:31], a[92:95], 0
  v_cvt_pk_bf16_f32 v210, v212, v213
  v_cvt_pk_bf16_f32 v211, v214, v215
  v_mfma_f32_16x16x32_bf16 v[128:131], a[8:11], a[64:67], 0
  v_cvt_pk_bf16_f32 v212, v80, v81
  v_cvt_pk_bf16_f32 v213, v82, v83
  v_mfma_f32_16x16x32_bf16 v[132:135], a[8:11], a[68:71], 0
  v_cvt_pk_bf16_f32 v214, v84, v85
  v_cvt_pk_bf16_f32 v215, v86, v87
  v_mfma_f32_16x16x32_bf16 v[136:139], a[8:11], a[72:75], 0
  v_cvt_pk_bf16_f32 v216, v216, v217
  v_cvt_pk_bf16_f32 v217, v218, v219
  v_mfma_f32_16x16x32_bf16 v[140:143], a[8:11], a[76:79], 0
  s_add_u32 s36, s36, s38
  s_add_u32 s37, s37, 1
  s_cmp_eq_u32 s37, 3
  s_cselect_b32 s37, 0, s37
  s_cselect_b32 s38, s39, s40
  v_add_u32 v16, s38, v16
  v_add_u32 v17, s38, v17
  s_add_u32 s41, s41, s43
  s_sub_u32 s43, 0, s43
  v_add_u32 v18, s43, v18
  v_add_u32 v19, s43, v19
  v_add_u32 v20, s43, v20
  v_add_u32 v21, s43, v21
  s_waitcnt vmcnt(8) lgkmcnt(0)
  s_barrier
  v_mfma_f32_16x16x32_bf16 a[128:131], a[56:59], a[96:99], a[128:131]
  s_mov_b32 m0, s41
  v_cvt_pk_bf16_f32 v218, v220, v221
  v_cvt_pk_bf16_f32 v219, v222, v223
  v_mfma_f32_16x16x32_bf16 a[132:135], a[56:59], a[100:103], a[132:135]
  v_cvt_pk_bf16_f32 v220, v88, v89
  v_cvt_pk_bf16_f32 v221, v90, v91
  v_mfma_f32_16x16x32_bf16 a[136:139], a[56:59], a[104:107], a[136:139]
  v_cvt_pk_bf16_f32 v222, v92, v93
  v_cvt_pk_bf16_f32 v223, v94, v95
  v_mfma_f32_16x16x32_bf16 a[140:143], a[56:59], a[108:111], a[140:143]
  v_cvt_pk_bf16_f32 v224, v224, v225
  v_cvt_pk_bf16_f32 v225, v226, v227
  v_mfma_f32_16x16x32_bf16 a[144:147], a[56:59], a[112:115], a[144:147]
  v_cvt_pk_bf16_f32 v226, v228, v229
  v_cvt_pk_bf16_f32 v227, v230, v231
  v_mfma_f32_16x16x32_bf16 a[148:151], a[56:59], a[116:119], a[148:151]
  v_cvt_pk_bf16_f32 v228, v96, v97
  v_cvt_pk_bf16_f32 v229, v98, v99
  v_mfma_f32_16x16x32_bf16 a[152:155], a[56:59], a[120:123], a[152:155]
  v_cvt_pk_bf16_f32 v230, v100, v101
  v_cvt_pk_bf16_f32 v231, v102, v103
  v_mfma_f32_16x16x32_bf16 a[156:159], a[56:59], a[124:127], a[156:159]
  v_cvt_pk_bf16_f32 v232, v232, v233
  v_cvt_pk_bf16_f32 v233, v234, v235
  v_mfma_f32_16x16x32_bf16 a[160:163], a[60:63], a[96:99], a[160:163]
  v_cvt_pk_bf16_f32 v234, v236, v237
  v_cvt_pk_bf16_f32 v235, v238, v239
  v_mfma_f32_16x16x32_bf16 a[164:167], a[60:63], a[100:103], a[164:167]
  v_cvt_pk_bf16_f32 v236, v104, v105
  v_cvt_pk_bf16_f32 v237, v106, v107
  v_mfma_f32_16x16x32_bf16 a[168:171], a[60:63], a[104:107], a[168:171]
  v_cvt_pk_bf16_f32 v238, v108, v109
  v_cvt_pk_bf16_f32 v239, v110, v111
  v_mfma_f32_16x16x32_bf16 a[172:175], a[60:63], a[108:111], a[172:175]
  v_cvt_pk_bf16_f32 v240, v240, v241
  v_cvt_pk_bf16_f32 v241, v242, v243
  v_mfma_f32_16x16x32_bf16 a[176:179], a[60:63], a[112:115], a[176:179]
  v_cvt_pk_bf16_f32 v242, v244, v245
  v_cvt_pk_bf16_f32 v243, v246, v247
  v_mfma_f32_16x16x32_bf16 a[180:183], a[60:63], a[116:119], a[180:183]
  v_cvt_pk_bf16_f32 v244, v112, v113
  v_cvt_pk_bf16_f32 v245, v114, v115
  v_mfma_f32_16x16x32_bf16 a[184:187], a[60:63], a[120:123], a[184:187]
  v_cvt_pk_bf16_f32 v246, v116, v117
  v_cvt_pk_bf16_f32 v247, v118, v119
  v_mfma_f32_16x16x32_bf16 a[188:191], a[60:63], a[124:127], a[188:191]
  v_cvt_pk_bf16_f32 v248, v248, v249
  v_cvt_pk_bf16_f32 v249, v250, v251
  v_mfma_f32_16x16x32_bf16 v[128:131], a[40:43], a[96:99], v[128:131]
  v_cvt_pk_bf16_f32 v250, v252, v253
  v_cvt_pk_bf16_f32 v251, v254, v255
  v_mfma_f32_16x16x32_bf16 v[132:135], a[40:43], a[100:103], v[132:135]
  v_cvt_pk_bf16_f32 v252, v120, v121
  v_cvt_pk_bf16_f32 v253, v122, v123
  v_mfma_f32_16x16x32_bf16 v[136:139], a[40:43], a[104:107], v[136:139]
  v_cvt_pk_bf16_f32 v254, v124, v125
  v_cvt_pk_bf16_f32 v255, v126, v127
  v_mfma_f32_16x16x32_bf16 v[140:143], a[40:43], a[108:111], v[140:143]
  s_add_u32 s60, s63, 12288
  buffer_store_dwordx4 v[176:179], v2, s[16:19], s60 offen offset:2048 sc1
  v_mfma_f32_16x16x32_bf16 v[144:147], a[8:11], a[80:83], 0
  s_add_u32 s60, s63, 45056
  buffer_store_dwordx4 v[180:183], v2, s[16:19], s60 offen offset:2048 sc1
  v_mfma_f32_16x16x32_bf16 v[148:151], a[8:11], a[84:87], 0
  s_add_u32 s60, s63, 12288
  buffer_store_dwordx4 v[184:187], v2, s[16:19], s60 offen offset:3072 sc1
  v_mfma_f32_16x16x32_bf16 v[144:147], a[40:43], a[112:115], v[144:147]
  s_add_u32 s60, s63, 45056
  buffer_store_dwordx4 v[188:191], v2, s[16:19], s60 offen offset:3072 sc1
  v_mfma_f32_16x16x32_bf16 v[148:151], a[40:43], a[116:119], v[148:151]
  s_add_u32 s60, s63, 32768
  buffer_store_dwordx4 v[192:195], v2, s[16:19], s60 offen offset:0 sc1
  v_mfma_f32_16x16x32_bf16 v[152:155], a[8:11], a[88:91], 0
  s_add_u32 s60, s63, 0
  buffer_store_dwordx4 v[196:199], v2, s[16:19], s60 offen offset:0 sc1
  v_mfma_f32_16x16x32_bf16 v[156:159], a[8:11], a[92:95], 0
  buffer_load_dwordx4 v56, s[12:15], s47 offen offset:0 lds
  v_mfma_f32_16x16x32_bf16 v[152:155], a[40:43], a[120:123], v[152:155]
  s_add_u32 s60, s63, 32768
  buffer_store_dwordx4 v[200:203], v2, s[16:19], s60 offen offset:1024 sc1
  v_mfma_f32_16x16x32_bf16 v[156:159], a[40:43], a[124:127], v[156:159]
  buffer_load_dwordx4 v57, s[12:15], s47 offen offset:1024 lds
  v_mfma_f32_16x16x32_bf16 v[160:163], a[12:15], a[64:67], 0
  buffer_load_dwordx4 v58, s[12:15], s47 offen offset:2048 lds
  v_mfma_f32_16x16x32_bf16 v[164:167], a[12:15], a[68:71], 0
  buffer_load_dwordx4 v59, s[12:15], s47 offen offset:3072 lds
  v_mfma_f32_16x16x32_bf16 v[160:163], a[44:47], a[96:99], v[160:163]
  s_add_u32 m0, s41, 4096
  v_mfma_f32_16x16x32_bf16 v[164:167], a[44:47], a[100:103], v[164:167]
  s_add_u32 s60, s63, 0
  buffer_store_dwordx4 v[204:207], v2, s[16:19], s60 offen offset:1024 sc1
  v_mfma_f32_16x16x32_bf16 v[168:171], a[12:15], a[72:75], 0
  buffer_load_dwordx4 v60, s[12:15], s47 offen offset:0 lds
  v_mfma_f32_16x16x32_bf16 v[172:175], a[12:15], a[76:79], 0
  buffer_load_dwordx4 v61, s[12:15], s47 offen offset:1024 lds
  v_mfma_f32_16x16x32_bf16 v[168:171], a[44:47], a[104:107], v[168:171]
  buffer_load_dwordx4 v62, s[12:15], s47 offen offset:2048 lds
  v_mfma_f32_16x16x32_bf16 v[172:175], a[44:47], a[108:111], v[172:175]
  s_add_u32 s60, s63, 32768
  buffer_store_dwordx4 v[208:211], v2, s[16:19], s60 offen offset:2048 sc1
  v_mfma_f32_16x16x32_bf16 v[64:67], a[0:3], a[64:67], 0
  v_mfma_f32_16x16x32_bf16 v[68:71], a[0:3], a[68:71], 0
  v_mfma_f32_16x16x32_bf16 v[64:67], a[32:35], a[96:99], v[64:67]
  buffer_load_dwordx4 v63, s[12:15], s47 offen offset:3072 lds
  v_mfma_f32_16x16x32_bf16 v[68:71], a[32:35], a[100:103], v[68:71]
  s_add_u32 s60, s63, 0
  buffer_store_dwordx4 v[212:215], v2, s[16:19], s60 offen offset:2048 sc1
  s_mov_b32 m0, s36
  s_nop 0
  buffer_load_dwordx4 v48, s[8:11], s46 offen offset:0 lds
  buffer_load_dwordx4 v49, s[8:11], s46 offen offset:1024 lds
  buffer_load_dwordx4 v50, s[8:11], s46 offen offset:2048 lds
  buffer_load_dwordx4 v51, s[8:11], s46 offen offset:3072 lds
  v_mfma_f32_16x16x32_bf16 v[72:75], a[0:3], a[72:75], 0
  s_add_u32 m0, s36, 4096
  v_mfma_f32_16x16x32_bf16 v[76:79], a[0:3], a[76:79], 0
  v_mfma_f32_16x16x32_bf16 v[72:75], a[32:35], a[104:107], v[72:75]
  v_mfma_f32_16x16x32_bf16 v[76:79], a[32:35], a[108:111], v[76:79]
  v_mfma_f32_16x16x32_bf16 v[80:83], a[0:3], a[80:83], 0
  s_add_u32 s60, s63, 32768
  buffer_store_dwordx4 v[216:219], v2, s[16:19], s60 offen offset:3072 sc1
  v_mfma_f32_16x16x32_bf16 v[84:87], a[0:3], a[84:87], 0
  v_mfma_f32_16x16x32_bf16 v[80:83], a[32:35], a[112:115], v[80:83]
  v_mfma_f32_16x16x32_bf16 v[84:87], a[32:35], a[116:119], v[84:87]
  v_mfma_f32_16x16x32_bf16 v[88:91], a[0:3], a[88:91], 0
  s_add_u32 s60, s63, 0
  buffer_store_dwordx4 v[220:223], v2, s[16:19], s60 offen offset:3072 sc1
  v_mfma_f32_16x16x32_bf16 v[92:95], a[0:3], a[92:95], 0
  v_mfma_f32_16x16x32_bf16 v[88:91], a[32:35], a[120:123], v[88:91]
  v_mfma_f32_16x16x32_bf16 v[92:95], a[32:35], a[124:127], v[92:95]
  v_mfma_f32_16x16x32_bf16 v[96:99], a[4:7], a[64:67], 0
  s_add_u32 s60, s63, 36864
  buffer_store_dwordx4 v[224:227], v2, s[16:19], s60 offen offset:0 sc1
  v_mfma_f32_16x16x32_bf16 v[100:103], a[4:7], a[68:71], 0
  v_mfma_f32_16x16x32_bf16 v[96:99], a[36:39], a[96:99], v[96:99]
  v_mfma_f32_16x16x32_bf16 v[100:103], a[36:39], a[100:103], v[100:103]
  v_mfma_f32_16x16x32_bf16 v[104:107], a[4:7], a[72:75], 0
  s_add_u32 s60, s63, 4096
  buffer_store_dwordx4 v[228:231], v2, s[16:19], s60 offen offset:0 sc1
  v_mfma_f32_16x16x32_bf16 v[108:111], a[4:7], a[76:79], 0
  v_mfma_f32_16x16x32_bf16 v[104:107], a[36:39], a[104:107], v[104:107]
  v_mfma_f32_16x16x32_bf16 v[108:111], a[36:39], a[108:111], v[108:111]
  v_mfma_f32_16x16x32_bf16 v[112:115], a[4:7], a[80:83], 0
  v_mfma_f32_16x16x32_bf16 v[116:119], a[4:7], a[84:87], 0
  s_add_u32 s60, s63, 36864
  buffer_store_dwordx4 v[232:235], v2, s[16:19], s60 offen offset:1024 sc1
  v_mfma_f32_16x16x32_bf16 v[112:115], a[36:39], a[112:115], v[112:115]
  v_mfma_f32_16x16x32_bf16 v[116:119], a[36:39], a[116:119], v[116:119]
  v_mfma_f32_16x16x32_bf16 v[120:123], a[4:7], a[88:91], 0
  v_mfma_f32_16x16x32_bf16 v[124:127], a[4:7], a[92:95], 0
  s_add_u32 s60, s63, 4096
  buffer_store_dwordx4 v[236:239], v2, s[16:19], s60 offen offset:1024 sc1
  v_mfma_f32_16x16x32_bf16 v[120:123], a[36:39], a[120:123], v[120:123]
  buffer_load_dwordx4 v52, s[8:11], s46 offen offset:0 lds
  v_mfma_f32_16x16x32_bf16 v[124:127], a[36:39], a[124:127], v[124:127]
  v_mfma_f32_16x16x32_bf16 v[176:179], a[12:15], a[80:83], 0
  v_mfma_f32_16x16x32_bf16 v[180:183], a[12:15], a[84:87], 0
  s_add_u32 s60, s63, 36864
  buffer_store_dwordx4 v[240:243], v2, s[16:19], s60 offen offset:2048 sc1
  v_mfma_f32_16x16x32_bf16 v[176:179], a[44:47], a[112:115], v[176:179]
  v_mfma_f32_16x16x32_bf16 v[180:183], a[44:47], a[116:119], v[180:183]
  v_mfma_f32_16x16x32_bf16 v[184:187], a[12:15], a[88:91], 0
  buffer_load_dwordx4 v53, s[8:11], s46 offen offset:1024 lds
  v_mfma_f32_16x16x32_bf16 v[188:191], a[12:15], a[92:95], 0
  v_mfma_f32_16x16x32_bf16 v[192:195], a[16:19], a[64:67], 0
  s_add_u32 s60, s63, 4096
  buffer_store_dwordx4 v[244:247], v2, s[16:19], s60 offen offset:2048 sc1
  v_mfma_f32_16x16x32_bf16 v[196:199], a[16:19], a[68:71], 0
  v_mfma_f32_16x16x32_bf16 v[200:203], a[16:19], a[72:75], 0
  v_mfma_f32_16x16x32_bf16 v[204:207], a[16:19], a[76:79], 0
  buffer_load_dwordx4 v54, s[8:11], s46 offen offset:2048 lds
  v_mfma_f32_16x16x32_bf16 v[208:211], a[16:19], a[80:83], 0
  s_add_u32 s60, s63, 36864
  buffer_store_dwordx4 v[248:251], v2, s[16:19], s60 offen offset:3072 sc1
  v_mfma_f32_16x16x32_bf16 v[212:215], a[16:19], a[84:87], 0
  v_mfma_f32_16x16x32_bf16 v[216:219], a[16:19], a[88:91], 0
  v_mfma_f32_16x16x32_bf16 v[220:223], a[16:19], a[92:95], 0
  v_mfma_f32_16x16x32_bf16 v[224:227], a[20:23], a[64:67], 0
  s_add_u32 s60, s63, 4096
  buffer_store_dwordx4 v[252:255], v2, s[16:19], s60 offen offset:3072 sc1
  v_mfma_f32_16x16x32_bf16 v[228:231], a[20:23], a[68:71], 0
  buffer_load_dwordx4 v55, s[8:11], s46 offen offset:3072 lds
  v_mfma_f32_16x16x32_bf16 v[232:235], a[20:23], a[72:75], 0
  s_sub_u32 s50, s50, 1
  s_cmp_eq_u32 s50, 0
  s_cselect_b32 s12, s72, s12
  s_cselect_b32 s13, s73, s13
  v_mfma_f32_16x16x32_bf16 v[236:239], a[20:23], a[76:79], 0
  s_lshl_b32 s47, s48, 19
  s_bfe_u32 s34, 0x3020106, s49
  s_add_u32 s48, s48, s34
  v_mfma_f32_16x16x32_bf16 v[240:243], a[20:23], a[80:83], 0
  s_add_u32 s49, s49, 8
  s_and_b32 s49, s49, 0x8001f
  s_and_b32 s48, s48, 7
  v_mfma_f32_16x16x32_bf16 v[244:247], a[20:23], a[84:87], 0
  s_lshl_b32 s46, s48, 7
  v_mfma_f32_16x16x32_bf16 v[248:251], a[20:23], a[88:91], 0
  v_mfma_f32_16x16x32_bf16 v[252:255], a[20:23], a[92:95], 0
  v_mfma_f32_16x16x32_bf16 v[184:187], a[44:47], a[120:123], v[184:187]
  ds_read_b128 a[0:3], v16 offset:0
  ds_read_b64_tr_b16 a[64:65], v18 offset:0
  v_mfma_f32_16x16x32_bf16 v[188:191], a[44:47], a[124:127], v[188:191]
  ds_read_b64_tr_b16 a[66:67], v18 offset:2048
  ds_read_b128 a[4:7], v16 offset:2048
  v_mfma_f32_16x16x32_bf16 v[192:195], a[48:51], a[96:99], v[192:195]
  ds_read_b128 a[8:11], v16 offset:4096
  ds_read_b128 a[12:15], v16 offset:6144
  v_mfma_f32_16x16x32_bf16 v[196:199], a[48:51], a[100:103], v[196:199]
  ds_read_b128 a[16:19], v16 offset:8192
  ds_read_b128 a[20:23], v16 offset:10240
  v_mfma_f32_16x16x32_bf16 v[200:203], a[48:51], a[104:107], v[200:203]
  ds_read_b128 a[24:27], v16 offset:12288
  ds_read_b128 a[28:31], v16 offset:14336
  v_mfma_f32_16x16x32_bf16 v[204:207], a[48:51], a[108:111], v[204:207]
  ds_read_b64_tr_b16 a[68:69], v19 offset:0
  ds_read_b64_tr_b16 a[70:71], v19 offset:2048
  v_mfma_f32_16x16x32_bf16 v[208:211], a[48:51], a[112:115], v[208:211]
  ds_read_b64_tr_b16 a[72:73], v20 offset:0
  ds_read_b64_tr_b16 a[74:75], v20 offset:2048
  v_mfma_f32_16x16x32_bf16 v[212:215], a[48:51], a[116:119], v[212:215]
  ds_read_b64_tr_b16 a[76:77], v21 offset:0
  ds_read_b64_tr_b16 a[78:79], v21 offset:2048
  v_mfma_f32_16x16x32_bf16 v[216:219], a[48:51], a[120:123], v[216:219]
  ds_read_b64_tr_b16 a[80:81], v18 offset:8192
  ds_read_b64_tr_b16 a[82:83], v18 offset:10240
  v_mfma_f32_16x16x32_bf16 v[220:223], a[48:51], a[124:127], v[220:223]
  ds_read_b64_tr_b16 a[84:85], v19 offset:8192
  ds_read_b64_tr_b16 a[86:87], v19 offset:10240
  v_mfma_f32_16x16x32_bf16 v[224:227], a[52:55], a[96:99], v[224:227]
  ds_read_b64_tr_b16 a[88:89], v20 offset:8192
  ds_read_b64_tr_b16 a[90:91], v20 offset:10240
  v_mfma_f32_16x16x32_bf16 v[228:231], a[52:55], a[100:103], v[228:231]
  ds_read_b64_tr_b16 a[92:93], v21 offset:8192
  ds_read_b64_tr_b16 a[94:95], v21 offset:10240
  v_mfma_f32_16x16x32_bf16 v[232:235], a[52:55], a[104:107], v[232:235]
  v_mfma_f32_16x16x32_bf16 v[236:239], a[52:55], a[108:111], v[236:239]
  v_mfma_f32_16x16x32_bf16 v[240:243], a[52:55], a[112:115], v[240:243]
  v_mfma_f32_16x16x32_bf16 v[244:247], a[52:55], a[116:119], v[244:247]
  v_mfma_f32_16x16x32_bf16 v[248:251], a[52:55], a[120:123], v[248:251]
  v_mfma_f32_16x16x32_bf16 v[252:255], a[52:55], a[124:127], v[252:255]
  s_add_u32 s63, s63, 0x4000
  s_waitcnt lgkmcnt(0)
  v_mfma_f32_16x16x32_bf16 v[64:67], a[0:3], a[64:67], v[64:67]
  s_add_u32 s36, s36, s38
  s_add_u32 s37, s37, 1
  ds_read_b128 a[32:35], v17 offset:0
  v_mfma_f32_16x16x32_bf16 v[96:99], a[4:7], a[64:67], v[96:99]
  s_cmp_eq_u32 s37, 3
  s_cselect_b32 s37, 0, s37
  s_cselect_b32 s38, s39, s40
  v_mfma_f32_16x16x32_bf16 v[128:131], a[8:11], a[64:67], v[128:131]
  s_add_u32 s41, s41, s43
  s_sub_u32 s43, 0, s43
  ds_read_b64_tr_b16 a[96:97], v18 offset:4096
  v_mfma_f32_16x16x32_bf16 v[160:163], a[12:15], a[64:67], v[160:163]
  v_mfma_f32_16x16x32_bf16 v[192:195], a[16:19], a[64:67], v[192:195]
  ds_read_b64_tr_b16 a[98:99], v18 offset:6144
  v_mfma_f32_16x16x32_bf16 v[224:227], a[20:23], a[64:67], v[224:227]
  v_mfma_f32_16x16x32_bf16 a[128:131], a[24:27], a[64:67], a[128:131]
  ds_read_b128 a[36:39], v17 offset:2048
  v_mfma_f32_16x16x32_bf16 a[160:163], a[28:31], a[64:67], a[160:163]
  v_mfma_f32_16x16x32_bf16 v[68:71], a[0:3], a[68:71], v[68:71]
  v_mfma_f32_16x16x32_bf16 v[100:103], a[4:7], a[68:71], v[100:103]
  ds_read_b128 a[40:43], v17 offset:4096
  v_mfma_f32_16x16x32_bf16 v[132:135], a[8:11], a[68:71], v[132:135]
  v_mfma_f32_16x16x32_bf16 v[164:167], a[12:15], a[68:71], v[164:167]
  ds_read_b128 a[44:47], v17 offset:6144
  v_mfma_f32_16x16x32_bf16 v[196:199], a[16:19], a[68:71], v[196:199]
  v_mfma_f32_16x16x32_bf16 v[228:231], a[20:23], a[68:71], v[228:231]
  ds_read_b128 a[48:51], v17 offset:8192
  v_mfma_f32_16x16x32_bf16 a[132:135], a[24:27], a[68:71], a[132:135]
  v_mfma_f32_16x16x32_bf16 a[164:167], a[28:31], a[68:71], a[164:167]
  ds_read_b128 a[52:55], v17 offset:10240
  v_mfma_f32_16x16x32_bf16 v[72:75], a[0:3], a[72:75], v[72:75]
  v_mfma_f32_16x16x32_bf16 v[104:107], a[4:7], a[72:75], v[104:107]
  v_mfma_f32_16x16x32_bf16 v[136:139], a[8:11], a[72:75], v[136:139]
  ds_read_b128 a[56:59], v17 offset:12288
  v_mfma_f32_16x16x32_bf16 v[168:171], a[12:15], a[72:75], v[168:171]
  v_mfma_f32_16x16x32_bf16 v[200:203], a[16:19], a[72:75], v[200:203]
  ds_read_b128 a[60:63], v17 offset:14336
  v_mfma_f32_16x16x32_bf16 v[232:235], a[20:23], a[72:75], v[232:235]
  v_mfma_f32_16x16x32_bf16 a[136:139], a[24:27], a[72:75], a[136:139]
  ds_read_b64_tr_b16 a[100:101], v19 offset:4096
  v_mfma_f32_16x16x32_bf16 a[168:171], a[28:31], a[72:75], a[168:171]
  v_mfma_f32_16x16x32_bf16 v[76:79], a[0:3], a[76:79], v[76:79]
  ds_read_b64_tr_b16 a[102:103], v19 offset:6144
  v_mfma_f32_16x16x32_bf16 v[108:111], a[4:7], a[76:79], v[108:111]
  v_mfma_f32_16x16x32_bf16 v[140:143], a[8:11], a[76:79], v[140:143]
  v_mfma_f32_16x16x32_bf16 v[172:175], a[12:15], a[76:79], v[172:175]
  ds_read_b64_tr_b16 a[104:105], v20 offset:4096
  v_mfma_f32_16x16x32_bf16 v[204:207], a[16:19], a[76:79], v[204:207]
  v_mfma_f32_16x16x32_bf16 v[236:239], a[20:23], a[76:79], v[236:239]
  ds_read_b64_tr_b16 a[106:107], v20 offset:6144
  v_mfma_f32_16x16x32_bf16 a[140:143], a[24:27], a[76:79], a[140:143]
  v_mfma_f32_16x16x32_bf16 a[172:175], a[28:31], a[76:79], a[172:175]
  ds_read_b64_tr_b16 a[108:109], v21 offset:4096
  v_mfma_f32_16x16x32_bf16 v[80:83], a[0:3], a[80:83], v[80:83]
  v_mfma_f32_16x16x32_bf16 v[112:115], a[4:7], a[80:83], v[112:115]
  ds_read_b64_tr_b16 a[110:111], v21 offset:6144
  v_mfma_f32_16x16x32_bf16 v[144:147], a[8:11], a[80:83], v[144:147]
  v_mfma_f32_16x16x32_bf16 v[176:179], a[12:15], a[80:83], v[176:179]
  v_mfma_f32_16x16x32_bf16 v[208:211], a[16:19], a[80:83], v[208:211]
  ds_read_b64_tr_b16 a[112:113], v18 offset:12288
  v_mfma_f32_16x16x32_bf16 v[240:243], a[20:23], a[80:83], v[240:243]
  v_mfma_f32_16x16x32_bf16 a[144:147], a[24:27], a[80:83], a[144:147]
  ds_read_b64_tr_b16 a[114:115], v18 offset:14336
  v_mfma_f32_16x16x32_bf16 a[176:179], a[28:31], a[80:83], a[176:179]
  v_mfma_f32_16x16x32_bf16 v[84:87], a[0:3], a[84:87], v[84:87]
  ds_read_b64_tr_b16 a[116:117], v19 offset:12288
  v_mfma_f32_16x16x32_bf16 v[116:119], a[4:7], a[84:87], v[116:119]
  v_mfma_f32_16x16x32_bf16 v[148:151], a[8:11], a[84:87], v[148:151]
  ds_read_b64_tr_b16 a[118:119], v19 offset:14336
  v_mfma_f32_16x16x32_bf16 v[180:183], a[12:15], a[84:87], v[180:183]
  v_mfma_f32_16x16x32_bf16 v[212:215], a[16:19], a[84:87], v[212:215]
  v_mfma_f32_16x16x32_bf16 v[244:247], a[20:23], a[84:87], v[244:247]
  ds_read_b64_tr_b16 a[120:121], v20 offset:12288
  v_mfma_f32_16x16x32_bf16 a[148:151], a[24:27], a[84:87], a[148:151]
  v_mfma_f32_16x16x32_bf16 a[180:183], a[28:31], a[84:87], a[180:183]
  ds_read_b64_tr_b16 a[122:123], v20 offset:14336
  v_mfma_f32_16x16x32_bf16 v[88:91], a[0:3], a[88:91], v[88:91]
  v_mfma_f32_16x16x32_bf16 v[120:123], a[4:7], a[88:91], v[120:123]
  ds_read_b64_tr_b16 a[124:125], v21 offset:12288
  v_mfma_f32_16x16x32_bf16 v[152:155], a[8:11], a[88:91], v[152:155]
  v_mfma_f32_16x16x32_bf16 v[184:187], a[12:15], a[88:91], v[184:187]
  ds_read_b64_tr_b16 a[126:127], v21 offset:14336
  v_mfma_f32_16x16x32_bf16 v[216:219], a[16:19], a[88:91], v[216:219]
  v_add_u32 v16, s38, v16
  v_add_u32 v17, s38, v17
  v_mfma_f32_16x16x32_bf16 v[248:251], a[20:23], a[88:91], v[248:251]
  v_add_u32 v18, s43, v18
  v_add_u32 v19, s43, v19
  v_mfma_f32_16x16x32_bf16 a[152:155], a[24:27], a[88:91], a[152:155]
  v_add_u32 v20, s43, v20
  v_add_u32 v21, s43, v21
  v_mfma_f32_16x16x32_bf16 a[184:187], a[28:31], a[88:91], a[184:187]
  v_mfma_f32_16x16x32_bf16 v[92:95], a[0:3], a[92:95], v[92:95]
  v_mfma_f32_16x16x32_bf16 v[124:127], a[4:7], a[92:95], v[124:127]
  v_mfma_f32_16x16x32_bf16 v[156:159], a[8:11], a[92:95], v[156:159]
  v_mfma_f32_16x16x32_bf16 v[188:191], a[12:15], a[92:95], v[188:191]
  v_mfma_f32_16x16x32_bf16 v[220:223], a[16:19], a[92:95], v[220:223]
  v_mfma_f32_16x16x32_bf16 v[252:255], a[20:23], a[92:95], v[252:255]
  v_mfma_f32_16x16x32_bf16 a[156:159], a[24:27], a[92:95], a[156:159]
  v_mfma_f32_16x16x32_bf16 a[188:191], a[28:31], a[92:95], a[188:191]
  s_mov_b32 s35, 4
  s_waitcnt vmcnt(8) lgkmcnt(0)
  s_barrier
  .p2align 6
Lp1xw_loop:
  v_mfma_f32_16x16x32_bf16 v[64:67], a[32:35], a[96:99], v[64:67]
  s_mov_b32 m0, s41
  ds_read_b128 a[0:3], v16 offset:0
  v_mfma_f32_16x16x32_bf16 v[96:99], a[36:39], a[96:99], v[96:99]
  buffer_load_dwordx4 v56, s[12:15], s47 offen offset:0 lds
  v_mfma_f32_16x16x32_bf16 v[128:131], a[40:43], a[96:99], v[128:131]
  ds_read_b64_tr_b16 a[64:65], v18 offset:0
  v_mfma_f32_16x16x32_bf16 v[160:163], a[44:47], a[96:99], v[160:163]
  v_mfma_f32_16x16x32_bf16 v[192:195], a[48:51], a[96:99], v[192:195]
  ds_read_b64_tr_b16 a[66:67], v18 offset:2048
  v_mfma_f32_16x16x32_bf16 v[224:227], a[52:55], a[96:99], v[224:227]
  v_mfma_f32_16x16x32_bf16 a[128:131], a[56:59], a[96:99], a[128:131]
  ds_read_b128 a[4:7], v16 offset:2048
  v_mfma_f32_16x16x32_bf16 a[160:163], a[60:63], a[96:99], a[160:163]
  buffer_load_dwordx4 v57, s[12:15], s47 offen offset:1024 lds
  v_mfma_f32_16x16x32_bf16 v[68:71], a[32:35], a[100:103], v[68:71]
  v_mfma_f32_16x16x32_bf16 v[100:103], a[36:39], a[100:103], v[100:103]
  ds_read_b128 a[8:11], v16 offset:4096
  v_mfma_f32_16x16x32_bf16 v[132:135], a[40:43], a[100:103], v[132:135]
  v_mfma_f32_16x16x32_bf16 v[164:167], a[44:47], a[100:103], v[164:167]
  ds_read_b128 a[12:15], v16 offset:6144
  v_mfma_f32_16x16x32_bf16 v[196:199], a[48:51], a[100:103], v[196:199]
  v_mfma_f32_16x16x32_bf16 v[228:231], a[52:55], a[100:103], v[228:231]
  ds_read_b128 a[16:19], v16 offset:8192
  v_mfma_f32_16x16x32_bf16 a[132:135], a[56:59], a[100:103], a[132:135]
  v_mfma_f32_16x16x32_bf16 a[164:167], a[60:63], a[100:103], a[164:167]
  buffer_load_dwordx4 v58, s[12:15], s47 offen offset:2048 lds
  ds_read_b128 a[20:23], v16 offset:10240
  v_mfma_f32_16x16x32_bf16 v[72:75], a[32:35], a[104:107], v[72:75]
  v_mfma_f32_16x16x32_bf16 v[104:107], a[36:39], a[104:107], v[104:107]
  v_mfma_f32_16x16x32_bf16 v[136:139], a[40:43], a[104:107], v[136:139]
  ds_read_b128 a[24:27], v16 offset:12288
  v_mfma_f32_16x16x32_bf16 v[168:171], a[44:47], a[104:107], v[168:171]
  v_mfma_f32_16x16x32_bf16 v[200:203], a[48:51], a[104:107], v[200:203]
  ds_read_b128 a[28:31], v16 offset:14336
  v_mfma_f32_16x16x32_bf16 v[232:235], a[52:55], a[104:107], v[232:235]
  v_mfma_f32_16x16x32_bf16 a[136:139], a[56:59], a[104:107], a[136:139]
  ds_read_b64_tr_b16 a[68:69], v19 offset:0
  v_mfma_f32_16x16x32_bf16 a[168:171], a[60:63], a[104:107], a[168:171]
  buffer_load_dwordx4 v59, s[12:15], s47 offen offset:3072 lds
  v_mfma_f32_16x16x32_bf16 v[76:79], a[32:35], a[108:111], v[76:79]
  s_add_u32 m0, s41, 4096
  ds_read_b64_tr_b16 a[70:71], v19 offset:2048
  v_mfma_f32_16x16x32_bf16 v[108:111], a[36:39], a[108:111], v[108:111]
  v_mfma_f32_16x16x32_bf16 v[140:143], a[40:43], a[108:111], v[140:143]
  v_mfma_f32_16x16x32_bf16 v[172:175], a[44:47], a[108:111], v[172:175]
  ds_read_b64_tr_b16 a[72:73], v20 offset:0
  v_mfma_f32_16x16x32_bf16 v[204:207], a[48:51], a[108:111], v[204:207]
  v_mfma_f32_16x16x32_bf16 v[236:239], a[52:55], a[108:111], v[236:239]
  ds_read_b64_tr_b16 a[74:75], v20 offset:2048
  v_mfma_f32_16x16x32_bf16 a[140:143], a[56:59], a[108:111], a[140:143]
  v_mfma_f32_16x16x32_bf16 a[172:175], a[60:63], a[108:111], a[172:175]
  buffer_load_dwordx4 v60, s[12:15], s47 offen offset:0 lds
  ds_read_b64_tr_b16 a[76:77], v21 offset:0
  v_mfma_f32_16x16x32_bf16 v[80:83], a[32:35], a[112:115], v[80:83]
  v_mfma_f32_16x16x32_bf16 v[112:115], a[36:39], a[112:115], v[112:115]
  ds_read_b64_tr_b16 a[78:79], v21 offset:2048
  v_mfma_f32_16x16x32_bf16 v[144:147], a[40:43], a[112:115], v[144:147]
  v_mfma_f32_16x16x32_bf16 v[176:179], a[44:47], a[112:115], v[176:179]
  v_mfma_f32_16x16x32_bf16 v[208:211], a[48:51], a[112:115], v[208:211]
  ds_read_b64_tr_b16 a[80:81], v18 offset:8192
  v_mfma_f32_16x16x32_bf16 v[240:243], a[52:55], a[112:115], v[240:243]
  v_mfma_f32_16x16x32_bf16 a[144:147], a[56:59], a[112:115], a[144:147]
  ds_read_b64_tr_b16 a[82:83], v18 offset:10240
  v_mfma_f32_16x16x32_bf16 a[176:179], a[60:63], a[112:115], a[176:179]
  buffer_load_dwordx4 v61, s[12:15], s47 offen offset:1024 lds
  v_mfma_f32_16x16x32_bf16 v[84:87], a[32:35], a[116:119], v[84:87]
  ds_read_b64_tr_b16 a[84:85], v19 offset:8192
  v_mfma_f32_16x16x32_bf16 v[116:119], a[36:39], a[116:119], v[116:119]
  v_mfma_f32_16x16x32_bf16 v[148:151], a[40:43], a[116:119], v[148:151]
  ds_read_b64_tr_b16 a[86:87], v19 offset:10240
  v_mfma_f32_16x16x32_bf16 v[180:183], a[44:47], a[116:119], v[180:183]
  v_mfma_f32_16x16x32_bf16 v[212:215], a[48:51], a[116:119], v[212:215]
  v_mfma_f32_16x16x32_bf16 v[244:247], a[52:55], a[116:119], v[244:247]
  ds_read_b64_tr_b16 a[88:89], v20 offset:8192
  v_mfma_f32_16x16x32_bf16 a[148:151], a[56:59], a[116:119], a[148:151]
  v_mfma_f32_16x16x32_bf16 a[180:183], a[60:63], a[116:119], a[180:183]
  buffer_load_dwordx4 v62, s[12:15], s47 offen offset:2048 lds
  ds_read_b64_tr_b16 a[90:91], v20 offset:10240
  v_mfma_f32_16x16x32_bf16 v[88:91], a[32:35], a[120:123], v[88:91]
  v_mfma_f32_16x16x32_bf16 v[120:123], a[36:39], a[120:123], v[120:123]
  ds_read_b64_tr_b16 a[92:93], v21 offset:8192
  v_mfma_f32_16x16x32_bf16 v[152:155], a[40:43], a[120:123], v[152:155]
  v_mfma_f32_16x16x32_bf16 v[184:187], a[44:47], a[120:123], v[184:187]
  ds_read_b64_tr_b16 a[94:95], v21 offset:10240
  v_mfma_f32_16x16x32_bf16 v[216:219], a[48:51], a[120:123], v[216:219]
  v_mfma_f32_16x16x32_bf16 v[248:251], a[52:55], a[120:123], v[248:251]
  v_mfma_f32_16x16x32_bf16 a[152:155], a[56:59], a[120:123], a[152:155]
  v_mfma_f32_16x16x32_bf16 a[184:187], a[60:63], a[120:123], a[184:187]
  buffer_load_dwordx4 v63, s[12:15], s47 offen offset:3072 lds
  v_mfma_f32_16x16x32_bf16 v[92:95], a[32:35], a[124:127], v[92:95]
  v_mfma_f32_16x16x32_bf16 v[124:127], a[36:39], a[124:127], v[124:127]
  v_mfma_f32_16x16x32_bf16 v[156:159], a[40:43], a[124:127], v[156:159]
  v_mfma_f32_16x16x32_bf16 v[188:191], a[44:47], a[124:127], v[188:191]
  v_mfma_f32_16x16x32_bf16 v[220:223], a[48:51], a[124:127], v[220:223]
  v_mfma_f32_16x16x32_bf16 v[252:255], a[52:55], a[124:127], v[252:255]
  v_mfma_f32_16x16x32_bf16 a[156:159], a[56:59], a[124:127], a[156:159]
  v_mfma_f32_16x16x32_bf16 a[188:191], a[60:63], a[124:127], a[188:191]
  s_waitcnt lgkmcnt(0)
  v_mfma_f32_16x16x32_bf16 v[64:67], a[0:3], a[64:67], v[64:67]
  s_mov_b32 m0, s36
  ds_read_b128 a[32:35], v17 offset:0
  v_mfma_f32_16x16x32_bf16 v[96:99], a[4:7], a[64:67], v[96:99]
  buffer_load_dwordx4 v48, s[8:11], s46 offen offset:0 lds
  v_mfma_f32_16x16x32_bf16 v[128:131], a[8:11], a[64:67], v[128:131]
  ds_read_b64_tr_b16 a[96:97], v18 offset:4096
  v_mfma_f32_16x16x32_bf16 v[160:163], a[12:15], a[64:67], v[160:163]
  v_mfma_f32_16x16x32_bf16 v[192:195], a[16:19], a[64:67], v[192:195]
  ds_read_b64_tr_b16 a[98:99], v18 offset:6144
  v_mfma_f32_16x16x32_bf16 v[224:227], a[20:23], a[64:67], v[224:227]
  v_mfma_f32_16x16x32_bf16 a[128:131], a[24:27], a[64:67], a[128:131]
  ds_read_b128 a[36:39], v17 offset:2048
  v_mfma_f32_16x16x32_bf16 a[160:163], a[28:31], a[64:67], a[160:163]
  buffer_load_dwordx4 v49, s[8:11], s46 offen offset:1024 lds
  v_mfma_f32_16x16x32_bf16 v[68:71], a[0:3], a[68:71], v[68:71]
  v_mfma_f32_16x16x32_bf16 v[100:103], a[4:7], a[68:71], v[100:103]
  ds_read_b128 a[40:43], v17 offset:4096
  v_mfma_f32_16x16x32_bf16 v[132:135], a[8:11], a[68:71], v[132:135]
  v_mfma_f32_16x16x32_bf16 v[164:167], a[12:15], a[68:71], v[164:167]
  ds_read_b128 a[44:47], v17 offset:6144
  v_mfma_f32_16x16x32_bf16 v[196:199], a[16:19], a[68:71], v[196:199]
  v_mfma_f32_16x16x32_bf16 v[228:231], a[20:23], a[68:71], v[228:231]
  ds_read_b128 a[48:51], v17 offset:8192
  v_mfma_f32_16x16x32_bf16 a[132:135], a[24:27], a[68:71], a[132:135]
  buffer_load_dwordx4 v50, s[8:11], s46 offen offset:2048 lds
  v_mfma_f32_16x16x32_bf16 a[164:167], a[28:31], a[68:71], a[164:167]
  ds_read_b128 a[52:55], v17 offset:10240
  v_mfma_f32_16x16x32_bf16 v[72:75], a[0:3], a[72:75], v[72:75]
  v_mfma_f32_16x16x32_bf16 v[104:107], a[4:7], a[72:75], v[104:107]
  v_mfma_f32_16x16x32_bf16 v[136:139], a[8:11], a[72:75], v[136:139]
  ds_read_b128 a[56:59], v17 offset:12288
  v_mfma_f32_16x16x32_bf16 v[168:171], a[12:15], a[72:75], v[168:171]
  v_mfma_f32_16x16x32_bf16 v[200:203], a[16:19], a[72:75], v[200:203]
  ds_read_b128 a[60:63], v17 offset:14336
  v_mfma_f32_16x16x32_bf16 v[232:235], a[20:23], a[72:75], v[232:235]
  buffer_load_dwordx4 v51, s[8:11], s46 offen offset:3072 lds
  v_mfma_f32_16x16x32_bf16 a[136:139], a[24:27], a[72:75], a[136:139]
  s_add_u32 m0, s36, 4096
  ds_read_b64_tr_b16 a[100:101], v19 offset:4096
  v_mfma_f32_16x16x32_bf16 a[168:171], a[28:31], a[72:75], a[168:171]
  v_mfma_f32_16x16x32_bf16 v[76:79], a[0:3], a[76:79], v[76:79]
  ds_read_b64_tr_b16 a[102:103], v19 offset:6144
  v_mfma_f32_16x16x32_bf16 v[108:111], a[4:7], a[76:79], v[108:111]
  v_mfma_f32_16x16x32_bf16 v[140:143], a[8:11], a[76:79], v[140:143]
  v_mfma_f32_16x16x32_bf16 v[172:175], a[12:15], a[76:79], v[172:175]
  ds_read_b64_tr_b16 a[104:105], v20 offset:4096
  v_mfma_f32_16x16x32_bf16 v[204:207], a[16:19], a[76:79], v[204:207]
  buffer_load_dwordx4 v52, s[8:11], s46 offen offset:0 lds
  v_mfma_f32_16x16x32_bf16 v[236:239], a[20:23], a[76:79], v[236:239]
  ds_read_b64_tr_b16 a[106:107], v20 offset:6144
  v_mfma_f32_16x16x32_bf16 a[140:143], a[24:27], a[76:79], a[140:143]
  v_mfma_f32_16x16x32_bf16 a[172:175], a[28:31], a[76:79], a[172:175]
  ds_read_b64_tr_b16 a[108:109], v21 offset:4096
  v_mfma_f32_16x16x32_bf16 v[80:83], a[0:3], a[80:83], v[80:83]
  v_mfma_f32_16x16x32_bf16 v[112:115], a[4:7], a[80:83], v[112:115]
  ds_read_b64_tr_b16 a[110:111], v21 offset:6144
  v_mfma_f32_16x16x32_bf16 v[144:147], a[8:11], a[80:83], v[144:147]
  v_mfma_f32_16x16x32_bf16 v[176:179], a[12:15], a[80:83], v[176:179]
  buffer_load_dwordx4 v53, s[8:11], s46 offen offset:1024 lds
  v_mfma_f32_16x16x32_bf16 v[208:211], a[16:19], a[80:83], v[208:211]
  ds_read_b64_tr_b16 a[112:113], v18 offset:12288
  v_mfma_f32_16x16x32_bf16 v[240:243], a[20:23], a[80:83], v[240:243]
  v_mfma_f32_16x16x32_bf16 a[144:147], a[24:27], a[80:83], a[144:147]
  ds_read_b64_tr_b16 a[114:115], v18 offset:14336
  v_mfma_f32_16x16x32_bf16 a[176:179], a[28:31], a[80:83], a[176:179]
  v_mfma_f32_16x16x32_bf16 v[84:87], a[0:3], a[84:87], v[84:87]
  ds_read_b64_tr_b16 a[116:117], v19 offset:12288
  v_mfma_f32_16x16x32_bf16 v[116:119], a[4:7], a[84:87], v[116:119]
  v_mfma_f32_16x16x32_bf16 v[148:151], a[8:11], a[84:87], v[148:151]
  buffer_load_dwordx4 v54, s[8:11], s46 offen offset:2048 lds
  ds_read_b64_tr_b16 a[118:119], v19 offset:14336
  v_mfma_f32_16x16x32_bf16 v[180:183], a[12:15], a[84:87], v[180:183]
  v_mfma_f32_16x16x32_bf16 v[212:215], a[16:19], a[84:87], v[212:215]
  v_mfma_f32_16x16x32_bf16 v[244:247], a[20:23], a[84:87], v[244:247]
  ds_read_b64_tr_b16 a[120:121], v20 offset:12288
  v_mfma_f32_16x16x32_bf16 a[148:151], a[24:27], a[84:87], a[148:151]
  v_mfma_f32_16x16x32_bf16 a[180:183], a[28:31], a[84:87], a[180:183]
  ds_read_b64_tr_b16 a[122:123], v20 offset:14336
  v_mfma_f32_16x16x32_bf16 v[88:91], a[0:3], a[88:91], v[88:91]
  v_mfma_f32_16x16x32_bf16 v[120:123], a[4:7], a[88:91], v[120:123]
  buffer_load_dwordx4 v55, s[8:11], s46 offen offset:3072 lds
  ds_read_b64_tr_b16 a[124:125], v21 offset:12288
  v_mfma_f32_16x16x32_bf16 v[152:155], a[8:11], a[88:91], v[152:155]
  s_sub_u32 s50, s50, 1
  s_cmp_eq_u32 s50, 0
  s_cselect_b32 s12, s72, s12
  s_cselect_b32 s13, s73, s13
  v_mfma_f32_16x16x32_bf16 v[184:187], a[12:15], a[88:91], v[184:187]
  s_lshl_b32 s47, s48, 19
  s_bfe_u32 s34, 0x3020106, s49
  s_add_u32 s48, s48, s34
  v_mfma_f32_16x16x32_bf16 v[216:219], a[16:19], a[88:91], v[216:219]
  s_add_u32 s49, s49, 8
  s_and_b32 s49, s49, 0x8001f
  s_and_b32 s48, s48, 7
  v_mfma_f32_16x16x32_bf16 v[248:251], a[20:23], a[88:91], v[248:251]
  s_lshl_b32 s46, s48, 7
  ds_read_b64_tr_b16 a[126:127], v21 offset:14336
  v_mfma_f32_16x16x32_bf16 a[152:155], a[24:27], a[88:91], a[152:155]
  s_add_u32 s36, s36, s38
  s_add_u32 s37, s37, 1
  s_cmp_eq_u32 s37, 3
  s_cselect_b32 s37, 0, s37
  s_cselect_b32 s38, s39, s40
  v_mfma_f32_16x16x32_bf16 a[184:187], a[28:31], a[88:91], a[184:187]
  s_add_u32 s41, s41, s43
  s_sub_u32 s43, 0, s43
  v_mfma_f32_16x16x32_bf16 v[92:95], a[0:3], a[92:95], v[92:95]
  v_add_u32 v16, s38, v16
  v_add_u32 v17, s38, v17
  v_mfma_f32_16x16x32_bf16 v[124:127], a[4:7], a[92:95], v[124:127]
  v_add_u32 v18, s43, v18
  v_add_u32 v19, s43, v19
  v_mfma_f32_16x16x32_bf16 v[156:159], a[8:11], a[92:95], v[156:159]
  v_add_u32 v20, s43, v20
  v_add_u32 v21, s43, v21
  v_mfma_f32_16x16x32_bf16 v[188:191], a[12:15], a[92:95], v[188:191]
  v_mfma_f32_16x16x32_bf16 v[220:223], a[16:19], a[92:95], v[220:223]
  v_mfma_f32_16x16x32_bf16 v[252:255], a[20:23], a[92:95], v[252:255]
  s_waitcnt vmcnt(8) lgkmcnt(0)
  s_barrier
  v_mfma_f32_16x16x32_bf16 a[156:159], a[24:27], a[92:95], a[156:159]
  s_sub_u32 s35, s35, 1
  v_mfma_f32_16x16x32_bf16 a[188:191], a[28:31], a[92:95], a[188:191]
  s_cmp_lg_u32 s35, 0
  s_cbranch_scc1 Lp1xw_loop
  v_accvgpr_read_b32 v4, a222
  v_accvgpr_read_b32 v5, a223
  v_accvgpr_read_b32 v6, a224
  v_accvgpr_read_b32 v7, a225
  v_accvgpr_read_b32 v8, a226
  v_accvgpr_read_b32 v9, a227
  v_accvgpr_read_b32 v10, a228
  v_accvgpr_read_b32 v11, a229
  s_mov_b32 s8, s64
  s_mov_b32 s9, s65
  s_mov_b32 s10, 4194304
  s_mov_b32 s11, 0x00020000
  s_mov_b32 s20, s68
  s_mov_b32 s21, s69
  s_mov_b32 s22, 8388608
  s_mov_b32 s23, 0x00020000
  s_and_b32 s4, s2, 7
  s_lshl_b32 s4, s4, 1
  s_lshr_b32 s5, s2, 6
  s_lshr_b32 s30, s2, 4
  s_add_u32 s5, s5, s30
  s_and_b32 s53, s5, 3
  s_lshl_b32 s53, s53, 3
  s_or_b32 s53, s53, 0x80000
  s_bfe_u32 s52, 0xf0f02, s53
  s_add_u32 s52, s52, s4
  s_and_b32 s52, s52, 15
  s_mov_b32 s54, s52
  s_mov_b32 s55, s53
  s_lshl_b32 s29, s52, 7
  s_lshl_b32 s28, s54, 19
  s_lshl_b32 s30, s25, 18
  s_and_b32 s31, s25, 1
  s_lshl_b32 s31, s31, 1
  s_add_u32 s31, s31, 14
  s_sub_u32 s31, s31, s25
  s_lshl_b32 s31, s31, 18
  s_or_b32 s26, s30, s29
  s_or_b32 s27, s31, s29
  s_lshl_b32 s68, s3, 12
  s_lshl_b32 s88, s3, 13
  s_add_u32 s88, s88, 98304
  v_mfma_f32_16x16x32_bf16 v[64:67], a[32:35], a[96:99], v[64:67]
  s_mov_b32 m0, s41
  ds_read_b128 a[0:3], v16 offset:0
  v_mfma_f32_16x16x32_bf16 v[96:99], a[36:39], a[96:99], v[96:99]
  buffer_load_dwordx4 v56, s[12:15], s47 offen offset:0 lds
  v_mfma_f32_16x16x32_bf16 v[128:131], a[40:43], a[96:99], v[128:131]
  ds_read_b64_tr_b16 a[64:65], v18 offset:0
  v_mfma_f32_16x16x32_bf16 v[160:163], a[44:47], a[96:99], v[160:163]
  v_mfma_f32_16x16x32_bf16 v[192:195], a[48:51], a[96:99], v[192:195]
  ds_read_b64_tr_b16 a[66:67], v18 offset:2048
  v_mfma_f32_16x16x32_bf16 v[224:227], a[52:55], a[96:99], v[224:227]
  v_mfma_f32_16x16x32_bf16 a[128:131], a[56:59], a[96:99], a[128:131]
  ds_read_b128 a[4:7], v16 offset:2048
  v_mfma_f32_16x16x32_bf16 a[160:163], a[60:63], a[96:99], a[160:163]
  buffer_load_dwordx4 v57, s[12:15], s47 offen offset:1024 lds
  v_mfma_f32_16x16x32_bf16 v[68:71], a[32:35], a[100:103], v[68:71]
  v_mfma_f32_16x16x32_bf16 v[100:103], a[36:39], a[100:103], v[100:103]
  ds_read_b128 a[8:11], v16 offset:4096
  v_mfma_f32_16x16x32_bf16 v[132:135], a[40:43], a[100:103], v[132:135]
  v_mfma_f32_16x16x32_bf16 v[164:167], a[44:47], a[100:103], v[164:167]
  ds_read_b128 a[12:15], v16 offset:6144
  v_mfma_f32_16x16x32_bf16 v[196:199], a[48:51], a[100:103], v[196:199]
  v_mfma_f32_16x16x32_bf16 v[228:231], a[52:55], a[100:103], v[228:231]
  ds_read_b128 a[16:19], v16 offset:8192
  v_mfma_f32_16x16x32_bf16 a[132:135], a[56:59], a[100:103], a[132:135]
  v_mfma_f32_16x16x32_bf16 a[164:167], a[60:63], a[100:103], a[164:167]
  buffer_load_dwordx4 v58, s[12:15], s47 offen offset:2048 lds
  ds_read_b128 a[20:23], v16 offset:10240
  v_mfma_f32_16x16x32_bf16 v[72:75], a[32:35], a[104:107], v[72:75]
  v_mfma_f32_16x16x32_bf16 v[104:107], a[36:39], a[104:107], v[104:107]
  v_mfma_f32_16x16x32_bf16 v[136:139], a[40:43], a[104:107], v[136:139]
  ds_read_b128 a[24:27], v16 offset:12288
  v_mfma_f32_16x16x32_bf16 v[168:171], a[44:47], a[104:107], v[168:171]
  v_mfma_f32_16x16x32_bf16 v[200:203], a[48:51], a[104:107], v[200:203]
  ds_read_b128 a[28:31], v16 offset:14336
  v_mfma_f32_16x16x32_bf16 v[232:235], a[52:55], a[104:107], v[232:235]
  v_mfma_f32_16x16x32_bf16 a[136:139], a[56:59], a[104:107], a[136:139]
  ds_read_b64_tr_b16 a[68:69], v19 offset:0
  v_mfma_f32_16x16x32_bf16 a[168:171], a[60:63], a[104:107], a[168:171]
  buffer_load_dwordx4 v59, s[12:15], s47 offen offset:3072 lds
  v_mfma_f32_16x16x32_bf16 v[76:79], a[32:35], a[108:111], v[76:79]
  s_add_u32 m0, s41, 4096
  ds_read_b64_tr_b16 a[70:71], v19 offset:2048
  v_mfma_f32_16x16x32_bf16 v[108:111], a[36:39], a[108:111], v[108:111]
  v_mfma_f32_16x16x32_bf16 v[140:143], a[40:43], a[108:111], v[140:143]
  v_mfma_f32_16x16x32_bf16 v[172:175], a[44:47], a[108:111], v[172:175]
  ds_read_b64_tr_b16 a[72:73], v20 offset:0
  v_mfma_f32_16x16x32_bf16 v[204:207], a[48:51], a[108:111], v[204:207]
  v_mfma_f32_16x16x32_bf16 v[236:239], a[52:55], a[108:111], v[236:239]
  ds_read_b64_tr_b16 a[74:75], v20 offset:2048
  v_mfma_f32_16x16x32_bf16 a[140:143], a[56:59], a[108:111], a[140:143]
  v_mfma_f32_16x16x32_bf16 a[172:175], a[60:63], a[108:111], a[172:175]
  buffer_load_dwordx4 v60, s[12:15], s47 offen offset:0 lds
  ds_read_b64_tr_b16 a[76:77], v21 offset:0
  v_mfma_f32_16x16x32_bf16 v[80:83], a[32:35], a[112:115], v[80:83]
  v_mfma_f32_16x16x32_bf16 v[112:115], a[36:39], a[112:115], v[112:115]
  ds_read_b64_tr_b16 a[78:79], v21 offset:2048
  v_mfma_f32_16x16x32_bf16 v[144:147], a[40:43], a[112:115], v[144:147]
  v_mfma_f32_16x16x32_bf16 v[176:179], a[44:47], a[112:115], v[176:179]
  v_mfma_f32_16x16x32_bf16 v[208:211], a[48:51], a[112:115], v[208:211]
  ds_read_b64_tr_b16 a[80:81], v18 offset:8192
  v_mfma_f32_16x16x32_bf16 v[240:243], a[52:55], a[112:115], v[240:243]
  v_mfma_f32_16x16x32_bf16 a[144:147], a[56:59], a[112:115], a[144:147]
  ds_read_b64_tr_b16 a[82:83], v18 offset:10240
  v_mfma_f32_16x16x32_bf16 a[176:179], a[60:63], a[112:115], a[176:179]
  buffer_load_dwordx4 v61, s[12:15], s47 offen offset:1024 lds
  v_mfma_f32_16x16x32_bf16 v[84:87], a[32:35], a[116:119], v[84:87]
  ds_read_b64_tr_b16 a[84:85], v19 offset:8192
  v_mfma_f32_16x16x32_bf16 v[116:119], a[36:39], a[116:119], v[116:119]
  v_mfma_f32_16x16x32_bf16 v[148:151], a[40:43], a[116:119], v[148:151]
  ds_read_b64_tr_b16 a[86:87], v19 offset:10240
  v_mfma_f32_16x16x32_bf16 v[180:183], a[44:47], a[116:119], v[180:183]
  v_mfma_f32_16x16x32_bf16 v[212:215], a[48:51], a[116:119], v[212:215]
  v_mfma_f32_16x16x32_bf16 v[244:247], a[52:55], a[116:119], v[244:247]
  ds_read_b64_tr_b16 a[88:89], v20 offset:8192
  v_mfma_f32_16x16x32_bf16 a[148:151], a[56:59], a[116:119], a[148:151]
  v_mfma_f32_16x16x32_bf16 a[180:183], a[60:63], a[116:119], a[180:183]
  buffer_load_dwordx4 v62, s[12:15], s47 offen offset:2048 lds
  ds_read_b64_tr_b16 a[90:91], v20 offset:10240
  v_mfma_f32_16x16x32_bf16 v[88:91], a[32:35], a[120:123], v[88:91]
  v_mfma_f32_16x16x32_bf16 v[120:123], a[36:39], a[120:123], v[120:123]
  ds_read_b64_tr_b16 a[92:93], v21 offset:8192
  v_mfma_f32_16x16x32_bf16 v[152:155], a[40:43], a[120:123], v[152:155]
  v_mfma_f32_16x16x32_bf16 v[184:187], a[44:47], a[120:123], v[184:187]
  ds_read_b64_tr_b16 a[94:95], v21 offset:10240
  v_mfma_f32_16x16x32_bf16 v[216:219], a[48:51], a[120:123], v[216:219]
  v_mfma_f32_16x16x32_bf16 v[248:251], a[52:55], a[120:123], v[248:251]
  v_mfma_f32_16x16x32_bf16 a[152:155], a[56:59], a[120:123], a[152:155]
  v_mfma_f32_16x16x32_bf16 a[184:187], a[60:63], a[120:123], a[184:187]
  buffer_load_dwordx4 v63, s[12:15], s47 offen offset:3072 lds
  v_mfma_f32_16x16x32_bf16 v[92:95], a[32:35], a[124:127], v[92:95]
  v_mfma_f32_16x16x32_bf16 v[124:127], a[36:39], a[124:127], v[124:127]
  v_mfma_f32_16x16x32_bf16 v[156:159], a[40:43], a[124:127], v[156:159]
  v_mfma_f32_16x16x32_bf16 v[188:191], a[44:47], a[124:127], v[188:191]
  v_mfma_f32_16x16x32_bf16 v[220:223], a[48:51], a[124:127], v[220:223]
  v_mfma_f32_16x16x32_bf16 v[252:255], a[52:55], a[124:127], v[252:255]
  v_mfma_f32_16x16x32_bf16 a[156:159], a[56:59], a[124:127], a[156:159]
  v_mfma_f32_16x16x32_bf16 a[188:191], a[60:63], a[124:127], a[188:191]
  s_waitcnt lgkmcnt(0)
  v_mfma_f32_16x16x32_bf16 v[64:67], a[0:3], a[64:67], v[64:67]
  s_mov_b32 m0, s68
  ds_read_b128 a[32:35], v17 offset:0
  v_mfma_f32_16x16x32_bf16 v[96:99], a[4:7], a[64:67], v[96:99]
  buffer_load_dwordx4 v8, s[20:23], s28 offen offset:0 lds
  v_mfma_f32_16x16x32_bf16 v[128:131], a[8:11], a[64:67], v[128:131]
  ds_read_b64_tr_b16 a[96:97], v18 offset:4096
  v_mfma_f32_16x16x32_bf16 v[160:163], a[12:15], a[64:67], v[160:163]
  v_mfma_f32_16x16x32_bf16 v[192:195], a[16:19], a[64:67], v[192:195]
  ds_read_b64_tr_b16 a[98:99], v18 offset:6144
  v_mfma_f32_16x16x32_bf16 v[224:227], a[20:23], a[64:67], v[224:227]
  v_mfma_f32_16x16x32_bf16 a[128:131], a[24:27], a[64:67], a[128:131]
  ds_read_b128 a[36:39], v17 offset:2048
  v_mfma_f32_16x16x32_bf16 a[160:163], a[28:31], a[64:67], a[160:163]
  buffer_load_dwordx4 v9, s[20:23], s28 offen offset:1024 lds
  v_mfma_f32_16x16x32_bf16 v[68:71], a[0:3], a[68:71], v[68:71]
  v_mfma_f32_16x16x32_bf16 v[100:103], a[4:7], a[68:71], v[100:103]
  ds_read_b128 a[40:43], v17 offset:4096
  v_mfma_f32_16x16x32_bf16 v[132:135], a[8:11], a[68:71], v[132:135]
  v_mfma_f32_16x16x32_bf16 v[164:167], a[12:15], a[68:71], v[164:167]
  ds_read_b128 a[44:47], v17 offset:6144
  v_mfma_f32_16x16x32_bf16 v[196:199], a[16:19], a[68:71], v[196:199]
  v_mfma_f32_16x16x32_bf16 v[228:231], a[20:23], a[68:71], v[228:231]
  ds_read_b128 a[48:51], v17 offset:8192
  v_mfma_f32_16x16x32_bf16 a[132:135], a[24:27], a[68:71], a[132:135]
  buffer_load_dwordx4 v10, s[20:23], s28 offen offset:2048 lds
  v_mfma_f32_16x16x32_bf16 a[164:167], a[28:31], a[68:71], a[164:167]
  ds_read_b128 a[52:55], v17 offset:10240
  v_mfma_f32_16x16x32_bf16 v[72:75], a[0:3], a[72:75], v[72:75]
  v_mfma_f32_16x16x32_bf16 v[104:107], a[4:7], a[72:75], v[104:107]
  v_mfma_f32_16x16x32_bf16 v[136:139], a[8:11], a[72:75], v[136:139]
  ds_read_b128 a[56:59], v17 offset:12288
  v_mfma_f32_16x16x32_bf16 v[168:171], a[12:15], a[72:75], v[168:171]
  v_mfma_f32_16x16x32_bf16 v[200:203], a[16:19], a[72:75], v[200:203]
  ds_read_b128 a[60:63], v17 offset:14336
  v_mfma_f32_16x16x32_bf16 v[232:235], a[20:23], a[72:75], v[232:235]
  buffer_load_dwordx4 v11, s[20:23], s28 offen offset:3072 lds
  v_mfma_f32_16x16x32_bf16 a[136:139], a[24:27], a[72:75], a[136:139]
  s_bfe_u32 s56, 0x302010e, s55
  s_add_u32 s54, s54, s56
  s_add_u32 s55, s55, 8
  v_mfma_f32_16x16x32_bf16 a[168:171], a[28:31], a[72:75], a[168:171]
  s_and_b32 s55, s55, 0x8001f
  s_and_b32 s54, s54, 15
  s_lshl_b32 s28, s54, 19
  v_mfma_f32_16x16x32_bf16 v[76:79], a[0:3], a[76:79], v[76:79]
  s_add_u32 m0, s68, 16384
  ds_read_b64_tr_b16 a[100:101], v19 offset:4096
  ds_read_b64_tr_b16 a[102:103], v19 offset:6144
  v_mfma_f32_16x16x32_bf16 v[108:111], a[4:7], a[76:79], v[108:111]
  v_mfma_f32_16x16x32_bf16 v[140:143], a[8:11], a[76:79], v[140:143]
  v_mfma_f32_16x16x32_bf16 v[172:175], a[12:15], a[76:79], v[172:175]
  ds_read_b64_tr_b16 a[104:105], v20 offset:4096
  v_mfma_f32_16x16x32_bf16 v[204:207], a[16:19], a[76:79], v[204:207]
  buffer_load_dwordx4 v8, s[20:23], s28 offen offset:0 lds
  v_mfma_f32_16x16x32_bf16 v[236:239], a[20:23], a[76:79], v[236:239]
  ds_read_b64_tr_b16 a[106:107], v20 offset:6144
  v_mfma_f32_16x16x32_bf16 a[140:143], a[24:27], a[76:79], a[140:143]
  v_mfma_f32_16x16x32_bf16 a[172:175], a[28:31], a[76:79], a[172:175]
  ds_read_b64_tr_b16 a[108:109], v21 offset:4096
  v_mfma_f32_16x16x32_bf16 v[80:83], a[0:3], a[80:83], v[80:83]
  v_mfma_f32_16x16x32_bf16 v[112:115], a[4:7], a[80:83], v[112:115]
  ds_read_b64_tr_b16 a[110:111], v21 offset:6144
  v_mfma_f32_16x16x32_bf16 v[144:147], a[8:11], a[80:83], v[144:147]
  v_mfma_f32_16x16x32_bf16 v[176:179], a[12:15], a[80:83], v[176:179]
  buffer_load_dwordx4 v9, s[20:23], s28 offen offset:1024 lds
  v_mfma_f32_16x16x32_bf16 v[208:211], a[16:19], a[80:83], v[208:211]
  ds_read_b64_tr_b16 a[112:113], v18 offset:12288
  v_mfma_f32_16x16x32_bf16 v[240:243], a[20:23], a[80:83], v[240:243]
  v_mfma_f32_16x16x32_bf16 a[144:147], a[24:27], a[80:83], a[144:147]
  ds_read_b64_tr_b16 a[114:115], v18 offset:14336
  v_mfma_f32_16x16x32_bf16 a[176:179], a[28:31], a[80:83], a[176:179]
  v_mfma_f32_16x16x32_bf16 v[84:87], a[0:3], a[84:87], v[84:87]
  ds_read_b64_tr_b16 a[116:117], v19 offset:12288
  v_mfma_f32_16x16x32_bf16 v[116:119], a[4:7], a[84:87], v[116:119]
  v_mfma_f32_16x16x32_bf16 v[148:151], a[8:11], a[84:87], v[148:151]
  buffer_load_dwordx4 v10, s[20:23], s28 offen offset:2048 lds
  ds_read_b64_tr_b16 a[118:119], v19 offset:14336
  v_mfma_f32_16x16x32_bf16 v[180:183], a[12:15], a[84:87], v[180:183]
  v_mfma_f32_16x16x32_bf16 v[212:215], a[16:19], a[84:87], v[212:215]
  v_mfma_f32_16x16x32_bf16 v[244:247], a[20:23], a[84:87], v[244:247]
  ds_read_b64_tr_b16 a[120:121], v20 offset:12288
  v_mfma_f32_16x16x32_bf16 a[148:151], a[24:27], a[84:87], a[148:151]
  v_mfma_f32_16x16x32_bf16 a[180:183], a[28:31], a[84:87], a[180:183]
  ds_read_b64_tr_b16 a[122:123], v20 offset:14336
  v_mfma_f32_16x16x32_bf16 v[88:91], a[0:3], a[88:91], v[88:91]
  v_mfma_f32_16x16x32_bf16 v[120:123], a[4:7], a[88:91], v[120:123]
  buffer_load_dwordx4 v11, s[20:23], s28 offen offset:3072 lds
  ds_read_b64_tr_b16 a[124:125], v21 offset:12288
  v_mfma_f32_16x16x32_bf16 v[152:155], a[8:11], a[88:91], v[152:155]
  s_bfe_u32 s56, 0x302010e, s55
  s_add_u32 s54, s54, s56
  s_add_u32 s55, s55, 8
  v_mfma_f32_16x16x32_bf16 v[184:187], a[12:15], a[88:91], v[184:187]
  s_and_b32 s55, s55, 0x8001f
  s_and_b32 s54, s54, 15
  s_lshl_b32 s28, s54, 19
  v_mfma_f32_16x16x32_bf16 v[216:219], a[16:19], a[88:91], v[216:219]
  s_add_u32 s36, s36, s38
  s_add_u32 s37, s37, 1
  ds_read_b64_tr_b16 a[126:127], v21 offset:14336
  v_mfma_f32_16x16x32_bf16 v[248:251], a[20:23], a[88:91], v[248:251]
  s_cmp_eq_u32 s37, 3
  s_cselect_b32 s37, 0, s37
  s_cselect_b32 s38, s39, s40
  v_mfma_f32_16x16x32_bf16 a[152:155], a[24:27], a[88:91], a[152:155]
  s_add_u32 s41, s41, s43
  s_sub_u32 s43, 0, s43
  v_mfma_f32_16x16x32_bf16 a[184:187], a[28:31], a[88:91], a[184:187]
  v_add_u32 v16, s38, v16
  v_add_u32 v17, s38, v17
  v_mfma_f32_16x16x32_bf16 v[92:95], a[0:3], a[92:95], v[92:95]
  v_add_u32 v18, s43, v18
  v_add_u32 v19, s43, v19
  v_mfma_f32_16x16x32_bf16 v[124:127], a[4:7], a[92:95], v[124:127]
  v_add_u32 v20, s43, v20
  v_add_u32 v21, s43, v21
  v_mfma_f32_16x16x32_bf16 v[156:159], a[8:11], a[92:95], v[156:159]
  v_mfma_f32_16x16x32_bf16 v[188:191], a[12:15], a[92:95], v[188:191]
  v_mfma_f32_16x16x32_bf16 v[220:223], a[16:19], a[92:95], v[220:223]
  v_mfma_f32_16x16x32_bf16 v[252:255], a[20:23], a[92:95], v[252:255]
  v_mfma_f32_16x16x32_bf16 a[156:159], a[24:27], a[92:95], a[156:159]
  v_mfma_f32_16x16x32_bf16 a[188:191], a[28:31], a[92:95], a[188:191]
  s_waitcnt vmcnt(8) lgkmcnt(0)
  s_barrier
  v_mfma_f32_16x16x32_bf16 v[64:67], a[32:35], a[96:99], v[64:67]
  s_mov_b32 m0, s88
  ds_read_b128 a[0:3], v16 offset:0
  v_mfma_f32_16x16x32_bf16 v[96:99], a[36:39], a[96:99], v[96:99]
  buffer_load_dwordx4 v4, s[8:11], s26 offen offset:0 lds
  v_mfma_f32_16x16x32_bf16 v[128:131], a[40:43], a[96:99], v[128:131]
  ds_read_b64_tr_b16 a[64:65], v18 offset:0
  v_mfma_f32_16x16x32_bf16 v[160:163], a[44:47], a[96:99], v[160:163]
  v_mfma_f32_16x16x32_bf16 v[192:195], a[48:51], a[96:99], v[192:195]
  ds_read_b64_tr_b16 a[66:67], v18 offset:2048
  v_mfma_f32_16x16x32_bf16 v[224:227], a[52:55], a[96:99], v[224:227]
  v_mfma_f32_16x16x32_bf16 a[128:131], a[56:59], a[96:99], a[128:131]
  ds_read_b128 a[4:7], v16 offset:2048
  v_mfma_f32_16x16x32_bf16 a[160:163], a[60:63], a[96:99], a[160:163]
  buffer_load_dwordx4 v5, s[8:11], s26 offen offset:1024 lds
  v_mfma_f32_16x16x32_bf16 v[68:71], a[32:35], a[100:103], v[68:71]
  v_mfma_f32_16x16x32_bf16 v[100:103], a[36:39], a[100:103], v[100:103]
  ds_read_b128 a[8:11], v16 offset:4096
  v_mfma_f32_16x16x32_bf16 v[132:135], a[40:43], a[100:103], v[132:135]
  v_mfma_f32_16x16x32_bf16 v[164:167], a[44:47], a[100:103], v[164:167]
  ds_read_b128 a[12:15], v16 offset:6144
  v_mfma_f32_16x16x32_bf16 v[196:199], a[48:51], a[100:103], v[196:199]
  v_mfma_f32_16x16x32_bf16 v[228:231], a[52:55], a[100:103], v[228:231]
  ds_read_b128 a[16:19], v16 offset:8192
  v_mfma_f32_16x16x32_bf16 a[132:135], a[56:59], a[100:103], a[132:135]
  v_mfma_f32_16x16x32_bf16 a[164:167], a[60:63], a[100:103], a[164:167]
  buffer_load_dwordx4 v6, s[8:11], s26 offen offset:2048 lds
  ds_read_b128 a[20:23], v16 offset:10240
  v_mfma_f32_16x16x32_bf16 v[72:75], a[32:35], a[104:107], v[72:75]
  v_mfma_f32_16x16x32_bf16 v[104:107], a[36:39], a[104:107], v[104:107]
  v_mfma_f32_16x16x32_bf16 v[136:139], a[40:43], a[104:107], v[136:139]
  ds_read_b128 a[24:27], v16 offset:12288
  v_mfma_f32_16x16x32_bf16 v[168:171], a[44:47], a[104:107], v[168:171]
  v_mfma_f32_16x16x32_bf16 v[200:203], a[48:51], a[104:107], v[200:203]
  ds_read_b128 a[28:31], v16 offset:14336
  v_mfma_f32_16x16x32_bf16 v[232:235], a[52:55], a[104:107], v[232:235]
  v_mfma_f32_16x16x32_bf16 a[136:139], a[56:59], a[104:107], a[136:139]
  ds_read_b64_tr_b16 a[68:69], v19 offset:0
  v_mfma_f32_16x16x32_bf16 a[168:171], a[60:63], a[104:107], a[168:171]
  buffer_load_dwordx4 v7, s[8:11], s26 offen offset:3072 lds
  v_mfma_f32_16x16x32_bf16 v[76:79], a[32:35], a[108:111], v[76:79]
  s_add_u32 m0, s88, 4096
  ds_read_b64_tr_b16 a[70:71], v19 offset:2048
  v_mfma_f32_16x16x32_bf16 v[108:111], a[36:39], a[108:111], v[108:111]
  v_mfma_f32_16x16x32_bf16 v[140:143], a[40:43], a[108:111], v[140:143]
  v_mfma_f32_16x16x32_bf16 v[172:175], a[44:47], a[108:111], v[172:175]
  ds_read_b64_tr_b16 a[72:73], v20 offset:0
  v_mfma_f32_16x16x32_bf16 v[204:207], a[48:51], a[108:111], v[204:207]
  v_mfma_f32_16x16x32_bf16 v[236:239], a[52:55], a[108:111], v[236:239]
  ds_read_b64_tr_b16 a[74:75], v20 offset:2048
  v_mfma_f32_16x16x32_bf16 a[140:143], a[56:59], a[108:111], a[140:143]
  v_mfma_f32_16x16x32_bf16 a[172:175], a[60:63], a[108:111], a[172:175]
  buffer_load_dwordx4 v4, s[8:11], s27 offen offset:0 lds
  ds_read_b64_tr_b16 a[76:77], v21 offset:0
  v_mfma_f32_16x16x32_bf16 v[80:83], a[32:35], a[112:115], v[80:83]
  v_mfma_f32_16x16x32_bf16 v[112:115], a[36:39], a[112:115], v[112:115]
  ds_read_b64_tr_b16 a[78:79], v21 offset:2048
  v_mfma_f32_16x16x32_bf16 v[144:147], a[40:43], a[112:115], v[144:147]
  v_mfma_f32_16x16x32_bf16 v[176:179], a[44:47], a[112:115], v[176:179]
  v_mfma_f32_16x16x32_bf16 v[208:211], a[48:51], a[112:115], v[208:211]
  ds_read_b64_tr_b16 a[80:81], v18 offset:8192
  v_mfma_f32_16x16x32_bf16 v[240:243], a[52:55], a[112:115], v[240:243]
  v_mfma_f32_16x16x32_bf16 a[144:147], a[56:59], a[112:115], a[144:147]
  ds_read_b64_tr_b16 a[82:83], v18 offset:10240
  v_mfma_f32_16x16x32_bf16 a[176:179], a[60:63], a[112:115], a[176:179]
  buffer_load_dwordx4 v5, s[8:11], s27 offen offset:1024 lds
  v_mfma_f32_16x16x32_bf16 v[84:87], a[32:35], a[116:119], v[84:87]
  ds_read_b64_tr_b16 a[84:85], v19 offset:8192
  v_mfma_f32_16x16x32_bf16 v[116:119], a[36:39], a[116:119], v[116:119]
  v_mfma_f32_16x16x32_bf16 v[148:151], a[40:43], a[116:119], v[148:151]
  ds_read_b64_tr_b16 a[86:87], v19 offset:10240
  v_mfma_f32_16x16x32_bf16 v[180:183], a[44:47], a[116:119], v[180:183]
  v_mfma_f32_16x16x32_bf16 v[212:215], a[48:51], a[116:119], v[212:215]
  v_mfma_f32_16x16x32_bf16 v[244:247], a[52:55], a[116:119], v[244:247]
  ds_read_b64_tr_b16 a[88:89], v20 offset:8192
  v_mfma_f32_16x16x32_bf16 a[148:151], a[56:59], a[116:119], a[148:151]
  v_mfma_f32_16x16x32_bf16 a[180:183], a[60:63], a[116:119], a[180:183]
  buffer_load_dwordx4 v6, s[8:11], s27 offen offset:2048 lds
  ds_read_b64_tr_b16 a[90:91], v20 offset:10240
  v_mfma_f32_16x16x32_bf16 v[88:91], a[32:35], a[120:123], v[88:91]
  v_mfma_f32_16x16x32_bf16 v[120:123], a[36:39], a[120:123], v[120:123]
  ds_read_b64_tr_b16 a[92:93], v21 offset:8192
  v_mfma_f32_16x16x32_bf16 v[152:155], a[40:43], a[120:123], v[152:155]
  v_mfma_f32_16x16x32_bf16 v[184:187], a[44:47], a[120:123], v[184:187]
  ds_read_b64_tr_b16 a[94:95], v21 offset:10240
  v_mfma_f32_16x16x32_bf16 v[216:219], a[48:51], a[120:123], v[216:219]
  v_mfma_f32_16x16x32_bf16 v[248:251], a[52:55], a[120:123], v[248:251]
  v_mfma_f32_16x16x32_bf16 a[152:155], a[56:59], a[120:123], a[152:155]
  v_mfma_f32_16x16x32_bf16 a[184:187], a[60:63], a[120:123], a[184:187]
  buffer_load_dwordx4 v7, s[8:11], s27 offen offset:3072 lds
  v_mfma_f32_16x16x32_bf16 v[92:95], a[32:35], a[124:127], v[92:95]
  s_bfe_u32 s29, 0x302010e, s53
  s_add_u32 s52, s52, s29
  s_add_u32 s53, s53, 8
  v_mfma_f32_16x16x32_bf16 v[124:127], a[36:39], a[124:127], v[124:127]
  s_and_b32 s53, s53, 0x8001f
  s_and_b32 s52, s52, 15
  s_lshl_b32 s29, s52, 7
  v_mfma_f32_16x16x32_bf16 v[156:159], a[40:43], a[124:127], v[156:159]
  s_or_b32 s26, s30, s29
  s_or_b32 s27, s31, s29
  v_mfma_f32_16x16x32_bf16 v[188:191], a[44:47], a[124:127], v[188:191]
  v_mfma_f32_16x16x32_bf16 v[220:223], a[48:51], a[124:127], v[220:223]
  v_mfma_f32_16x16x32_bf16 v[252:255], a[52:55], a[124:127], v[252:255]
  v_mfma_f32_16x16x32_bf16 a[156:159], a[56:59], a[124:127], a[156:159]
  v_mfma_f32_16x16x32_bf16 a[188:191], a[60:63], a[124:127], a[188:191]
  s_waitcnt lgkmcnt(0)
  v_mfma_f32_16x16x32_bf16 v[128:131], a[8:11], a[64:67], v[128:131]
  ds_read_b128 a[32:35], v17 offset:0
  ds_read_b64_tr_b16 a[96:97], v18 offset:4096
  v_mfma_f32_16x16x32_bf16 v[160:163], a[12:15], a[64:67], v[160:163]
  ds_read_b64_tr_b16 a[98:99], v18 offset:6144
  ds_read_b128 a[36:39], v17 offset:2048
  v_mfma_f32_16x16x32_bf16 v[132:135], a[8:11], a[68:71], v[132:135]
  ds_read_b128 a[40:43], v17 offset:4096
  ds_read_b128 a[44:47], v17 offset:6144
  v_mfma_f32_16x16x32_bf16 v[164:167], a[12:15], a[68:71], v[164:167]
  ds_read_b128 a[48:51], v17 offset:8192
  ds_read_b128 a[52:55], v17 offset:10240
  v_mfma_f32_16x16x32_bf16 v[136:139], a[8:11], a[72:75], v[136:139]
  ds_read_b128 a[56:59], v17 offset:12288
  ds_read_b128 a[60:63], v17 offset:14336
  v_mfma_f32_16x16x32_bf16 v[168:171], a[12:15], a[72:75], v[168:171]
  ds_read_b64_tr_b16 a[100:101], v19 offset:4096
  ds_read_b64_tr_b16 a[102:103], v19 offset:6144
  v_mfma_f32_16x16x32_bf16 v[140:143], a[8:11], a[76:79], v[140:143]
  ds_read_b64_tr_b16 a[104:105], v20 offset:4096
  v_mfma_f32_16x16x32_bf16 v[172:175], a[12:15], a[76:79], v[172:175]
  ds_read_b64_tr_b16 a[106:107], v20 offset:6144
  ds_read_b64_tr_b16 a[108:109], v21 offset:4096
  v_mfma_f32_16x16x32_bf16 v[144:147], a[8:11], a[80:83], v[144:147]
  ds_read_b64_tr_b16 a[110:111], v21 offset:6144
  ds_read_b64_tr_b16 a[112:113], v18 offset:12288
  v_mfma_f32_16x16x32_bf16 v[176:179], a[12:15], a[80:83], v[176:179]
  ds_read_b64_tr_b16 a[114:115], v18 offset:14336
  ds_read_b64_tr_b16 a[116:117], v19 offset:12288
  v_mfma_f32_16x16x32_bf16 v[148:151], a[8:11], a[84:87], v[148:151]
  ds_read_b64_tr_b16 a[118:119], v19 offset:14336
  ds_read_b64_tr_b16 a[120:121], v20 offset:12288
  v_mfma_f32_16x16x32_bf16 v[180:183], a[12:15], a[84:87], v[180:183]
  ds_read_b64_tr_b16 a[122:123], v20 offset:14336
  ds_read_b64_tr_b16 a[124:125], v21 offset:12288
  v_mfma_f32_16x16x32_bf16 v[152:155], a[8:11], a[88:91], v[152:155]
  ds_read_b64_tr_b16 a[126:127], v21 offset:14336
  v_mfma_f32_16x16x32_bf16 v[184:187], a[12:15], a[88:91], v[184:187]
  v_mfma_f32_16x16x32_bf16 v[156:159], a[8:11], a[92:95], v[156:159]
  v_mfma_f32_16x16x32_bf16 v[188:191], a[12:15], a[92:95], v[188:191]
  v_mfma_f32_16x16x32_bf16 v[192:195], a[16:19], a[64:67], v[192:195]
  v_mfma_f32_16x16x32_bf16 v[224:227], a[20:23], a[64:67], v[224:227]
  s_waitcnt lgkmcnt(0)
  s_barrier
  s_mov_b32 s12, s84
  s_mov_b32 s13, s85
  s_mov_b32 s14, 256
  s_mov_b32 s15, 0x00020000
  buffer_load_dwordx2 v[22:23], off, s[12:15], 0 sc1
  v_mfma_f32_16x16x32_bf16 v[128:131], a[40:43], a[96:99], v[128:131]
  s_add_u32 m0, s88, 32768
  v_mfma_f32_16x16x32_bf16 v[160:163], a[44:47], a[96:99], v[160:163]
  buffer_load_dwordx4 v4, s[8:11], s26 offen offset:0 lds
  v_mfma_f32_16x16x32_bf16 v[132:135], a[40:43], a[100:103], v[132:135]
  v_mfma_f32_16x16x32_bf16 v[164:167], a[44:47], a[100:103], v[164:167]
  v_mfma_f32_16x16x32_bf16 v[136:139], a[40:43], a[104:107], v[136:139]
  v_mfma_f32_16x16x32_bf16 v[168:171], a[44:47], a[104:107], v[168:171]
  buffer_load_dwordx4 v5, s[8:11], s26 offen offset:1024 lds
  v_cvt_pk_bf16_f32 v128, v128, v129
  v_mfma_f32_16x16x32_bf16 v[140:143], a[40:43], a[108:111], v[140:143]
  v_cvt_pk_bf16_f32 v129, v130, v131
  v_cvt_pk_bf16_f32 v130, v160, v161
  v_mfma_f32_16x16x32_bf16 v[172:175], a[44:47], a[108:111], v[172:175]
  v_cvt_pk_bf16_f32 v131, v162, v163
  v_cvt_pk_bf16_f32 v132, v132, v133
  v_mfma_f32_16x16x32_bf16 v[144:147], a[40:43], a[112:115], v[144:147]
  v_cvt_pk_bf16_f32 v133, v134, v135
  v_cvt_pk_bf16_f32 v134, v164, v165
  v_mfma_f32_16x16x32_bf16 v[176:179], a[44:47], a[112:115], v[176:179]
  v_cvt_pk_bf16_f32 v135, v166, v167
  v_mfma_f32_16x16x32_bf16 v[148:151], a[40:43], a[116:119], v[148:151]
  buffer_load_dwordx4 v6, s[8:11], s26 offen offset:2048 lds
  v_mfma_f32_16x16x32_bf16 v[180:183], a[44:47], a[116:119], v[180:183]
  s_add_u32 s60, s63, 8192
  buffer_store_dwordx4 v[128:131], v2, s[16:19], s60 offen offset:0 sc1
  v_cvt_pk_bf16_f32 v136, v136, v137
  v_mfma_f32_16x16x32_bf16 v[152:155], a[40:43], a[120:123], v[152:155]
  v_cvt_pk_bf16_f32 v137, v138, v139
  v_cvt_pk_bf16_f32 v138, v168, v169
  v_mfma_f32_16x16x32_bf16 v[184:187], a[44:47], a[120:123], v[184:187]
  v_cvt_pk_bf16_f32 v139, v170, v171
  v_cvt_pk_bf16_f32 v140, v140, v141
  v_mfma_f32_16x16x32_bf16 v[156:159], a[40:43], a[124:127], v[156:159]
  v_cvt_pk_bf16_f32 v141, v142, v143
  v_cvt_pk_bf16_f32 v142, v172, v173
  v_mfma_f32_16x16x32_bf16 v[188:191], a[44:47], a[124:127], v[188:191]
  v_cvt_pk_bf16_f32 v143, v174, v175
  v_cvt_pk_bf16_f32 v144, v144, v145
  v_mfma_f32_16x16x32_bf16 v[192:195], a[48:51], a[96:99], v[192:195]
  buffer_load_dwordx4 v7, s[8:11], s26 offen offset:3072 lds
  v_cvt_pk_bf16_f32 v145, v146, v147
  v_mfma_f32_16x16x32_bf16 v[224:227], a[52:55], a[96:99], v[224:227]
  s_add_u32 m0, s88, 36864
  v_cvt_pk_bf16_f32 v146, v176, v177
  v_cvt_pk_bf16_f32 v147, v178, v179
  v_mfma_f32_16x16x32_bf16 a[128:131], a[24:27], a[64:67], a[128:131]
  s_add_u32 s60, s63, 8192
  buffer_store_dwordx4 v[132:135], v2, s[16:19], s60 offen offset:1024 sc1
  v_cvt_pk_bf16_f32 v148, v148, v149
  v_mfma_f32_16x16x32_bf16 a[160:163], a[28:31], a[64:67], a[160:163]
  v_cvt_pk_bf16_f32 v149, v150, v151
  v_cvt_pk_bf16_f32 v150, v180, v181
  v_mfma_f32_16x16x32_bf16 a[128:131], a[56:59], a[96:99], a[128:131]
  v_cvt_pk_bf16_f32 v151, v182, v183
  v_cvt_pk_bf16_f32 v152, v152, v153
  v_mfma_f32_16x16x32_bf16 a[160:163], a[60:63], a[96:99], a[160:163]
  buffer_load_dwordx4 v4, s[8:11], s27 offen offset:0 lds
  v_cvt_pk_bf16_f32 v153, v154, v155
  v_mfma_f32_16x16x32_bf16 v[196:199], a[16:19], a[68:71], v[196:199]
  v_cvt_pk_bf16_f32 v154, v184, v185
  v_cvt_pk_bf16_f32 v155, v186, v187
  v_mfma_f32_16x16x32_bf16 v[228:231], a[20:23], a[68:71], v[228:231]
  v_cvt_pk_bf16_f32 v156, v156, v157
  v_cvt_pk_bf16_f32 v157, v158, v159
  v_mfma_f32_16x16x32_bf16 v[196:199], a[48:51], a[100:103], v[196:199]
  v_cvt_pk_bf16_f32 v158, v188, v189
  v_cvt_pk_bf16_f32 v159, v190, v191
  v_mfma_f32_16x16x32_bf16 v[228:231], a[52:55], a[100:103], v[228:231]
  v_cvt_pk_bf16_f32 v192, v192, v193
  v_cvt_pk_bf16_f32 v193, v194, v195
  v_mfma_f32_16x16x32_bf16 a[132:135], a[24:27], a[68:71], a[132:135]
  v_cvt_pk_bf16_f32 v194, v224, v225
  v_cvt_pk_bf16_f32 v195, v226, v227
  v_mfma_f32_16x16x32_bf16 a[164:167], a[28:31], a[68:71], a[164:167]
  buffer_load_dwordx4 v5, s[8:11], s27 offen offset:1024 lds
  v_mfma_f32_16x16x32_bf16 a[132:135], a[56:59], a[100:103], a[132:135]
  s_add_u32 s60, s63, 8192
  buffer_store_dwordx4 v[136:139], v2, s[16:19], s60 offen offset:2048 sc1
  v_accvgpr_read_b32 v24, a128
  v_mfma_f32_16x16x32_bf16 a[164:167], a[60:63], a[100:103], a[164:167]
  v_accvgpr_read_b32 v25, a129
  v_accvgpr_read_b32 v26, a130
  v_mfma_f32_16x16x32_bf16 v[200:203], a[16:19], a[72:75], v[200:203]
  v_accvgpr_read_b32 v27, a131
  v_accvgpr_read_b32 v28, a160
  v_mfma_f32_16x16x32_bf16 v[232:235], a[20:23], a[72:75], v[232:235]
  v_accvgpr_read_b32 v29, a161
  v_accvgpr_read_b32 v30, a162
  v_mfma_f32_16x16x32_bf16 v[200:203], a[48:51], a[104:107], v[200:203]
  buffer_load_dwordx4 v6, s[8:11], s27 offen offset:2048 lds
  v_accvgpr_read_b32 v31, a163
  v_mfma_f32_16x16x32_bf16 v[232:235], a[52:55], a[104:107], v[232:235]
  v_cvt_pk_bf16_f32 v224, v24, v25
  v_cvt_pk_bf16_f32 v225, v26, v27
  v_mfma_f32_16x16x32_bf16 a[136:139], a[24:27], a[72:75], a[136:139]
  v_cvt_pk_bf16_f32 v226, v28, v29
  v_cvt_pk_bf16_f32 v227, v30, v31
  v_mfma_f32_16x16x32_bf16 a[168:171], a[28:31], a[72:75], a[168:171]
  v_cvt_pk_bf16_f32 v196, v196, v197
  v_cvt_pk_bf16_f32 v197, v198, v199
  v_mfma_f32_16x16x32_bf16 a[136:139], a[56:59], a[104:107], a[136:139]
  v_cvt_pk_bf16_f32 v198, v228, v229
  v_cvt_pk_bf16_f32 v199, v230, v231
  v_mfma_f32_16x16x32_bf16 a[168:171], a[60:63], a[104:107], a[168:171]
  v_accvgpr_read_b32 v32, a132
  v_accvgpr_read_b32 v33, a133
  v_mfma_f32_16x16x32_bf16 v[204:207], a[16:19], a[76:79], v[204:207]
  buffer_load_dwordx4 v7, s[8:11], s27 offen offset:3072 lds
  v_accvgpr_read_b32 v34, a134
  v_mfma_f32_16x16x32_bf16 v[236:239], a[20:23], a[76:79], v[236:239]
  s_bfe_u32 s29, 0x302010e, s53
  s_add_u32 s52, s52, s29
  s_add_u32 s53, s53, 8
  v_mfma_f32_16x16x32_bf16 v[204:207], a[48:51], a[108:111], v[204:207]
  s_and_b32 s53, s53, 0x8001f
  s_and_b32 s52, s52, 15
  s_lshl_b32 s29, s52, 7
  v_mfma_f32_16x16x32_bf16 v[236:239], a[52:55], a[108:111], v[236:239]
  s_or_b32 s26, s30, s29
  s_or_b32 s27, s31, s29
  s_add_u32 m0, s68, 32768
  v_mfma_f32_16x16x32_bf16 a[140:143], a[24:27], a[76:79], a[140:143]
  v_accvgpr_read_b32 v35, a135
  v_accvgpr_read_b32 v36, a164
  v_mfma_f32_16x16x32_bf16 a[172:175], a[28:31], a[76:79], a[172:175]
  buffer_load_dwordx4 v8, s[20:23], s28 offen offset:0 lds
  v_accvgpr_read_b32 v37, a165
  v_mfma_f32_16x16x32_bf16 a[140:143], a[56:59], a[108:111], a[140:143]
  v_accvgpr_read_b32 v38, a166
  v_accvgpr_read_b32 v39, a167
  v_mfma_f32_16x16x32_bf16 a[172:175], a[60:63], a[108:111], a[172:175]
  v_cvt_pk_bf16_f32 v228, v32, v33
  v_cvt_pk_bf16_f32 v229, v34, v35
  v_mfma_f32_16x16x32_bf16 v[208:211], a[16:19], a[80:83], v[208:211]
  v_cvt_pk_bf16_f32 v230, v36, v37
  v_cvt_pk_bf16_f32 v231, v38, v39
  v_mfma_f32_16x16x32_bf16 v[240:243], a[20:23], a[80:83], v[240:243]
  s_add_u32 s60, s63, 8192
  buffer_store_dwordx4 v[140:143], v2, s[16:19], s60 offen offset:3072 sc1
  v_cvt_pk_bf16_f32 v200, v200, v201
  v_mfma_f32_16x16x32_bf16 v[208:211], a[48:51], a[112:115], v[208:211]
  v_cvt_pk_bf16_f32 v201, v202, v203
  v_cvt_pk_bf16_f32 v202, v232, v233
  v_mfma_f32_16x16x32_bf16 v[240:243], a[52:55], a[112:115], v[240:243]
  buffer_load_dwordx4 v9, s[20:23], s28 offen offset:1024 lds
  v_cvt_pk_bf16_f32 v203, v234, v235
  v_mfma_f32_16x16x32_bf16 a[144:147], a[24:27], a[80:83], a[144:147]
  v_accvgpr_read_b32 v40, a136
  v_accvgpr_read_b32 v41, a137
  v_mfma_f32_16x16x32_bf16 a[176:179], a[28:31], a[80:83], a[176:179]
  v_accvgpr_read_b32 v42, a138
  v_accvgpr_read_b32 v43, a139
  v_mfma_f32_16x16x32_bf16 a[144:147], a[56:59], a[112:115], a[144:147]
  v_accvgpr_read_b32 v44, a168
  v_accvgpr_read_b32 v45, a169
  v_mfma_f32_16x16x32_bf16 a[176:179], a[60:63], a[112:115], a[176:179]
  v_accvgpr_read_b32 v46, a170
  v_accvgpr_read_b32 v47, a171
  v_mfma_f32_16x16x32_bf16 v[212:215], a[16:19], a[84:87], v[212:215]
  buffer_load_dwordx4 v10, s[20:23], s28 offen offset:2048 lds
  v_cvt_pk_bf16_f32 v232, v40, v41
  v_mfma_f32_16x16x32_bf16 v[244:247], a[20:23], a[84:87], v[244:247]
  v_cvt_pk_bf16_f32 v233, v42, v43
  v_cvt_pk_bf16_f32 v234, v44, v45
  v_mfma_f32_16x16x32_bf16 v[212:215], a[48:51], a[116:119], v[212:215]
  v_cvt_pk_bf16_f32 v235, v46, v47
  v_cvt_pk_bf16_f32 v204, v204, v205
  v_mfma_f32_16x16x32_bf16 v[244:247], a[52:55], a[116:119], v[244:247]
  v_cvt_pk_bf16_f32 v205, v206, v207
  v_cvt_pk_bf16_f32 v206, v236, v237
  v_mfma_f32_16x16x32_bf16 a[148:151], a[24:27], a[84:87], a[148:151]
  v_cvt_pk_bf16_f32 v207, v238, v239
  v_accvgpr_read_b32 v24, a140
  v_mfma_f32_16x16x32_bf16 a[180:183], a[28:31], a[84:87], a[180:183]
  buffer_load_dwordx4 v11, s[20:23], s28 offen offset:3072 lds
  v_accvgpr_read_b32 v25, a141
  v_mfma_f32_16x16x32_bf16 a[148:151], a[56:59], a[116:119], a[148:151]
  s_bfe_u32 s56, 0x302010e, s55
  s_add_u32 s54, s54, s56
  s_add_u32 s55, s55, 8
  v_mfma_f32_16x16x32_bf16 a[180:183], a[60:63], a[116:119], a[180:183]
  s_and_b32 s55, s55, 0x8001f
  s_and_b32 s54, s54, 15
  s_lshl_b32 s28, s54, 19
  v_mfma_f32_16x16x32_bf16 v[216:219], a[16:19], a[88:91], v[216:219]
  s_add_u32 m0, s88, -32768
  v_accvgpr_read_b32 v26, a142
  v_accvgpr_read_b32 v27, a143
  v_mfma_f32_16x16x32_bf16 v[248:251], a[20:23], a[88:91], v[248:251]
  v_accvgpr_read_b32 v28, a172
  v_accvgpr_read_b32 v29, a173
  v_mfma_f32_16x16x32_bf16 v[216:219], a[48:51], a[120:123], v[216:219]
  v_accvgpr_read_b32 v30, a174
  v_accvgpr_read_b32 v31, a175
  v_mfma_f32_16x16x32_bf16 v[248:251], a[52:55], a[120:123], v[248:251]
  buffer_load_dwordx4 v4, s[8:11], s26 offen offset:0 lds
  v_cvt_pk_bf16_f32 v236, v24, v25
  v_mfma_f32_16x16x32_bf16 a[152:155], a[24:27], a[88:91], a[152:155]
  v_cvt_pk_bf16_f32 v237, v26, v27
  v_cvt_pk_bf16_f32 v238, v28, v29
  v_mfma_f32_16x16x32_bf16 a[184:187], a[28:31], a[88:91], a[184:187]
  v_cvt_pk_bf16_f32 v239, v30, v31
  v_mfma_f32_16x16x32_bf16 a[152:155], a[56:59], a[120:123], a[152:155]
  s_add_u32 s60, s63, 12288
  buffer_store_dwordx4 v[144:147], v2, s[16:19], s60 offen offset:0 sc1
  v_cvt_pk_bf16_f32 v208, v208, v209
  v_mfma_f32_16x16x32_bf16 a[184:187], a[60:63], a[120:123], a[184:187]
  v_cvt_pk_bf16_f32 v209, v210, v211
  v_cvt_pk_bf16_f32 v210, v240, v241
  v_mfma_f32_16x16x32_bf16 v[220:223], a[16:19], a[92:95], v[220:223]
  buffer_load_dwordx4 v5, s[8:11], s26 offen offset:1024 lds
  v_cvt_pk_bf16_f32 v211, v242, v243
  v_mfma_f32_16x16x32_bf16 v[252:255], a[20:23], a[92:95], v[252:255]
  v_accvgpr_read_b32 v32, a144
  v_accvgpr_read_b32 v33, a145
  v_mfma_f32_16x16x32_bf16 v[220:223], a[48:51], a[124:127], v[220:223]
  v_accvgpr_read_b32 v34, a146
  v_accvgpr_read_b32 v35, a147
  v_mfma_f32_16x16x32_bf16 v[252:255], a[52:55], a[124:127], v[252:255]
  v_accvgpr_read_b32 v36, a176
  v_accvgpr_read_b32 v37, a177
  v_mfma_f32_16x16x32_bf16 a[156:159], a[24:27], a[92:95], a[156:159]
  v_accvgpr_read_b32 v38, a178
  v_accvgpr_read_b32 v39, a179
  v_mfma_f32_16x16x32_bf16 a[188:191], a[28:31], a[92:95], a[188:191]
  v_cvt_pk_bf16_f32 v240, v32, v33
  v_cvt_pk_bf16_f32 v241, v34, v35
  v_mfma_f32_16x16x32_bf16 a[156:159], a[56:59], a[124:127], a[156:159]
  buffer_load_dwordx4 v6, s[8:11], s26 offen offset:2048 lds
  v_cvt_pk_bf16_f32 v242, v36, v37
  v_mfma_f32_16x16x32_bf16 a[188:191], a[60:63], a[124:127], a[188:191]
  v_cvt_pk_bf16_f32 v243, v38, v39
  v_cvt_pk_bf16_f32 v212, v212, v213
  v_mfma_f32_16x16x32_bf16 v[64:67], a[0:3], a[64:67], v[64:67]
  v_cvt_pk_bf16_f32 v213, v214, v215
  v_cvt_pk_bf16_f32 v214, v244, v245
  v_mfma_f32_16x16x32_bf16 v[96:99], a[4:7], a[64:67], v[96:99]
  v_cvt_pk_bf16_f32 v215, v246, v247
  v_mfma_f32_16x16x32_bf16 v[64:67], a[32:35], a[96:99], v[64:67]
  s_add_u32 s60, s63, 12288
  buffer_store_dwordx4 v[148:151], v2, s[16:19], s60 offen offset:1024 sc1
  v_accvgpr_read_b32 v40, a148
  v_mfma_f32_16x16x32_bf16 v[96:99], a[36:39], a[96:99], v[96:99]
  buffer_load_dwordx4 v7, s[8:11], s26 offen offset:3072 lds
  v_accvgpr_read_b32 v41, a149
  v_mfma_f32_16x16x32_bf16 v[68:71], a[0:3], a[68:71], v[68:71]
  s_add_u32 m0, s88, -28672
  v_accvgpr_read_b32 v42, a150
  v_accvgpr_read_b32 v43, a151
  v_mfma_f32_16x16x32_bf16 v[100:103], a[4:7], a[68:71], v[100:103]
  v_accvgpr_read_b32 v44, a180
  v_accvgpr_read_b32 v45, a181
  v_mfma_f32_16x16x32_bf16 v[68:71], a[32:35], a[100:103], v[68:71]
  v_accvgpr_read_b32 v46, a182
  v_accvgpr_read_b32 v47, a183
  v_mfma_f32_16x16x32_bf16 v[100:103], a[36:39], a[100:103], v[100:103]
  v_cvt_pk_bf16_f32 v244, v40, v41
  v_cvt_pk_bf16_f32 v245, v42, v43
  v_mfma_f32_16x16x32_bf16 v[72:75], a[0:3], a[72:75], v[72:75]
  v_cvt_pk_bf16_f32 v246, v44, v45
  v_cvt_pk_bf16_f32 v247, v46, v47
  v_mfma_f32_16x16x32_bf16 v[104:107], a[4:7], a[72:75], v[104:107]
  buffer_load_dwordx4 v4, s[8:11], s27 offen offset:0 lds
  v_cvt_pk_bf16_f32 v216, v216, v217
  v_mfma_f32_16x16x32_bf16 v[72:75], a[32:35], a[104:107], v[72:75]
  v_cvt_pk_bf16_f32 v217, v218, v219
  v_cvt_pk_bf16_f32 v218, v248, v249
  v_mfma_f32_16x16x32_bf16 v[104:107], a[36:39], a[104:107], v[104:107]
  v_cvt_pk_bf16_f32 v219, v250, v251
  v_accvgpr_read_b32 v24, a152
  v_mfma_f32_16x16x32_bf16 v[76:79], a[0:3], a[76:79], v[76:79]
  v_accvgpr_read_b32 v25, a153
  v_accvgpr_read_b32 v26, a154
  v_mfma_f32_16x16x32_bf16 v[108:111], a[4:7], a[76:79], v[108:111]
  v_accvgpr_read_b32 v27, a155
  v_accvgpr_read_b32 v28, a184
  v_mfma_f32_16x16x32_bf16 v[76:79], a[32:35], a[108:111], v[76:79]
  buffer_load_dwordx4 v5, s[8:11], s27 offen offset:1024 lds
  v_accvgpr_read_b32 v29, a185
  v_mfma_f32_16x16x32_bf16 v[108:111], a[36:39], a[108:111], v[108:111]
  v_accvgpr_read_b32 v30, a186
  v_accvgpr_read_b32 v31, a187
  v_mfma_f32_16x16x32_bf16 v[80:83], a[0:3], a[80:83], v[80:83]
  v_cvt_pk_bf16_f32 v248, v24, v25
  v_cvt_pk_bf16_f32 v249, v26, v27
  v_mfma_f32_16x16x32_bf16 v[112:115], a[4:7], a[80:83], v[112:115]
  v_cvt_pk_bf16_f32 v250, v28, v29
  v_cvt_pk_bf16_f32 v251, v30, v31
  v_mfma_f32_16x16x32_bf16 v[80:83], a[32:35], a[112:115], v[80:83]
  v_cvt_pk_bf16_f32 v220, v220, v221
  v_cvt_pk_bf16_f32 v221, v222, v223
  v_mfma_f32_16x16x32_bf16 v[112:115], a[36:39], a[112:115], v[112:115]
  v_cvt_pk_bf16_f32 v222, v252, v253
  v_cvt_pk_bf16_f32 v223, v254, v255
  v_mfma_f32_16x16x32_bf16 v[84:87], a[0:3], a[84:87], v[84:87]
  buffer_load_dwordx4 v6, s[8:11], s27 offen offset:2048 lds
  v_mfma_f32_16x16x32_bf16 v[116:119], a[4:7], a[84:87], v[116:119]
  s_add_u32 s60, s63, 12288
  buffer_store_dwordx4 v[152:155], v2, s[16:19], s60 offen offset:2048 sc1
  v_accvgpr_read_b32 v32, a156
  v_mfma_f32_16x16x32_bf16 v[84:87], a[32:35], a[116:119], v[84:87]
  v_accvgpr_read_b32 v33, a157
  v_accvgpr_read_b32 v34, a158
  v_mfma_f32_16x16x32_bf16 v[116:119], a[36:39], a[116:119], v[116:119]
  v_accvgpr_read_b32 v35, a159
  v_accvgpr_read_b32 v36, a188
  v_mfma_f32_16x16x32_bf16 v[88:91], a[0:3], a[88:91], v[88:91]
  v_accvgpr_read_b32 v37, a189
  v_accvgpr_read_b32 v38, a190
  v_mfma_f32_16x16x32_bf16 v[120:123], a[4:7], a[88:91], v[120:123]
  buffer_load_dwordx4 v7, s[8:11], s27 offen offset:3072 lds
  v_accvgpr_read_b32 v39, a191
  v_mfma_f32_16x16x32_bf16 v[88:91], a[32:35], a[120:123], v[88:91]
  s_bfe_u32 s29, 0x302010e, s53
  s_add_u32 s52, s52, s29
  s_add_u32 s53, s53, 8
  v_mfma_f32_16x16x32_bf16 v[120:123], a[36:39], a[120:123], v[120:123]
  s_and_b32 s53, s53, 0x8001f
  s_and_b32 s52, s52, 15
  s_lshl_b32 s29, s52, 7
  v_mfma_f32_16x16x32_bf16 v[92:95], a[0:3], a[92:95], v[92:95]
  s_or_b32 s26, s30, s29
  s_or_b32 s27, s31, s29
  v_cvt_pk_bf16_f32 v252, v32, v33
  v_mfma_f32_16x16x32_bf16 v[124:127], a[4:7], a[92:95], v[124:127]
  v_cvt_pk_bf16_f32 v253, v34, v35
  v_cvt_pk_bf16_f32 v254, v36, v37
  v_mfma_f32_16x16x32_bf16 v[92:95], a[32:35], a[124:127], v[92:95]
  v_cvt_pk_bf16_f32 v255, v38, v39
  v_cvt_pk_bf16_f32 v160, v64, v65
  v_mfma_f32_16x16x32_bf16 v[124:127], a[36:39], a[124:127], v[124:127]
  v_cvt_pk_bf16_f32 v161, v66, v67
  v_cvt_pk_bf16_f32 v162, v96, v97
  v_cvt_pk_bf16_f32 v163, v98, v99
  v_cvt_pk_bf16_f32 v164, v68, v69
  v_cvt_pk_bf16_f32 v165, v70, v71
  v_cvt_pk_bf16_f32 v166, v100, v101
  v_cvt_pk_bf16_f32 v167, v102, v103
  s_add_u32 s60, s63, 12288
  buffer_store_dwordx4 v[156:159], v2, s[16:19], s60 offen offset:3072 sc1
  v_cvt_pk_bf16_f32 v168, v72, v73
  v_cvt_pk_bf16_f32 v169, v74, v75
  v_cvt_pk_bf16_f32 v170, v104, v105
  v_cvt_pk_bf16_f32 v171, v106, v107
  v_cvt_pk_bf16_f32 v172, v76, v77
  v_cvt_pk_bf16_f32 v173, v78, v79
  v_cvt_pk_bf16_f32 v174, v108, v109
  v_cvt_pk_bf16_f32 v175, v110, v111
  v_cvt_pk_bf16_f32 v176, v80, v81
  v_cvt_pk_bf16_f32 v177, v82, v83
  v_cvt_pk_bf16_f32 v178, v112, v113
  v_cvt_pk_bf16_f32 v179, v114, v115
  v_cvt_pk_bf16_f32 v180, v84, v85
  v_cvt_pk_bf16_f32 v181, v86, v87
  v_cvt_pk_bf16_f32 v182, v116, v117
  v_cvt_pk_bf16_f32 v183, v118, v119
  v_cvt_pk_bf16_f32 v184, v88, v89
  v_cvt_pk_bf16_f32 v185, v90, v91
  v_cvt_pk_bf16_f32 v186, v120, v121
  v_cvt_pk_bf16_f32 v187, v122, v123
  v_cvt_pk_bf16_f32 v188, v92, v93
  v_cvt_pk_bf16_f32 v189, v94, v95
  v_cvt_pk_bf16_f32 v190, v124, v125
  v_cvt_pk_bf16_f32 v191, v126, v127
  s_lshl_b32 s34, s62, 4
  s_add_u32 s34, s34, s61
  s_lshl_b32 s34, s34, 7
  s_branch Lp3
Lp2:
  s_and_b32 s4, s2, 1
  s_lshl_b32 s4, s4, 2
  s_and_b32 s5, s59, 3
  s_add_u32 s32, s4, s5
  s_bfe_u32 s4, s2, 0x20001
  s_lshl_b32 s4, s4, 2
  s_lshr_b32 s5, s59, 2
  s_add_u32 s33, s4, s5
  s_and_b32 s4, s2, 7
  s_lshl_b32 s4, s4, 1
  s_add_u32 s5, s32, s33
  s_and_b32 s49, s5, 3
  s_lshl_b32 s49, s49, 3
  s_or_b32 s49, s49, 0x80000
  s_bfe_u32 s48, 0xf0f02, s49
  s_add_u32 s48, s48, s4
  s_and_b32 s48, s48, 15
  s_lshl_b32 s46, s48, 7
  s_lshl_b32 s36, s3, 13
  s_mul_i32 s41, s3, 6144
  s_add_u32 s41, s41, 104448
  s_mul_i32 s4, s3, 7168
  s_sub_u32 s50, 32768, s4
  v_lshrrev_b32 v240, 3, v1
  v_and_b32 v241, 6, v240
  v_and_b32 v242, 7, v1
  v_xor_b32 v241, v241, v242
  v_lshlrev_b32 v241, 4, v241
  s_lshl_b32 s4, s3, 6
  s_add_u32 s4, s4, 16
  v_add_u32 v242, s4, v240
  v_lshl_add_u32 v242, v242, 11, v241
  v_add_u32 v224, 0, v242
  v_add_u32 v225, 15360, v242
  v_add_u32 v226, 30720, v242
  v_add_u32 v227, 46080, v242
  v_add_u32 v228, 65536, v242
  v_add_u32 v229, 80896, v242
  v_add_u32 v230, 96256, v242
  v_add_u32 v231, 111616, v242
  s_lshl_b32 s4, s3, 14
  s_cmp_eq_u32 s32, 0
  s_cselect_b32 s4, 0x40000000, s4
  v_lshl_add_u32 v242, v240, 11, v241
  v_add_u32 v232, s4, v242
  v_lshrrev_b32 v242, 2, v240
  v_and_b32 v243, 3, v240
  v_lshl_add_u32 v242, v242, 3, v243
  v_mul_u32_u24 v242, 6144, v242
  v_add_u32 v242, v242, v241
  s_lshl_b32 s4, s33, 7
  v_add_u32 v242, s4, v242
  s_mul_i32 s6, s3, 6
  s_add_u32 s7, s6, 0
  s_bfe_u32 s4, s7, 0x10002
  s_lshl_b32 s4, s4, 5
  s_and_b32 s5, s7, 1
  s_lshl_b32 s5, s5, 4
  s_add_u32 s4, s4, s5
  s_bfe_u32 s5, s7, 0x10001
  s_lshl_b32 s5, s5, 2
  s_add_u32 s4, s4, s5
  s_mul_i32 s4, s4, 6144
  s_lshr_b32 s5, s7, 3
  s_lshl_b32 s5, s5, 11
  s_add_u32 s4, s4, s5
  s_add_u32 s4, s4, 2048
  v_add_u32 v233, s4, v242
  s_add_u32 s7, s6, 1
  s_bfe_u32 s4, s7, 0x10002
  s_lshl_b32 s4, s4, 5
  s_and_b32 s5, s7, 1
  s_lshl_b32 s5, s5, 4
  s_add_u32 s4, s4, s5
  s_bfe_u32 s5, s7, 0x10001
  s_lshl_b32 s5, s5, 2
  s_add_u32 s4, s4, s5
  s_mul_i32 s4, s4, 6144
  s_lshr_b32 s5, s7, 3
  s_lshl_b32 s5, s5, 11
  s_add_u32 s4, s4, s5
  s_add_u32 s4, s4, 1024
  v_add_u32 v234, s4, v242
  s_add_u32 s7, s6, 2
  s_bfe_u32 s4, s7, 0x10002
  s_lshl_b32 s4, s4, 5
  s_and_b32 s5, s7, 1
  s_lshl_b32 s5, s5, 4
  s_add_u32 s4, s4, s5
  s_bfe_u32 s5, s7, 0x10001
  s_lshl_b32 s5, s5, 2
  s_add_u32 s4, s4, s5
  s_mul_i32 s4, s4, 6144
  s_lshr_b32 s5, s7, 3
  s_lshl_b32 s5, s5, 11
  s_add_u32 s4, s4, s5
  s_add_u32 s4, s4, 0
  v_add_u32 v235, s4, v242
  s_add_u32 s7, s6, 3
  s_bfe_u32 s4, s7, 0x10002
  s_lshl_b32 s4, s4, 5
  s_and_b32 s5, s7, 1
  s_lshl_b32 s5, s5, 4
  s_add_u32 s4, s4, s5
  s_bfe_u32 s5, s7, 0x10001
  s_lshl_b32 s5, s5, 2
  s_add_u32 s4, s4, s5
  s_mul_i32 s4, s4, 6144
  s_lshr_b32 s5, s7, 3
  s_lshl_b32 s5, s5, 11
  s_add_u32 s4, s4, s5
  s_add_u32 s4, s4, 2048
  v_add_u32 v236, s4, v242
  s_add_u32 s7, s6, 4
  s_bfe_u32 s4, s7, 0x10002
  s_lshl_b32 s4, s4, 5
  s_and_b32 s5, s7, 1
  s_lshl_b32 s5, s5, 4
  s_add_u32 s4, s4, s5
  s_bfe_u32 s5, s7, 0x10001
  s_lshl_b32 s5, s5, 2
  s_add_u32 s4, s4, s5
  s_mul_i32 s4, s4, 6144
  s_lshr_b32 s5, s7, 3
  s_lshl_b32 s5, s5, 11
  s_add_u32 s4, s4, s5
  s_add_u32 s4, s4, 1024
  v_add_u32 v237, s4, v242
  s_add_u32 s7, s6, 5
  s_bfe_u32 s4, s7, 0x10002
  s_lshl_b32 s4, s4, 5
  s_and_b32 s5, s7, 1
  s_lshl_b32 s5, s5, 4
  s_add_u32 s4, s4, s5
  s_bfe_u32 s5, s7, 0x10001
  s_lshl_b32 s5, s5, 2
  s_add_u32 s4, s4, s5
  s_mul_i32 s4, s4, 6144
  s_lshr_b32 s5, s7, 3
  s_lshl_b32 s5, s5, 11
  s_add_u32 s4, s4, s5
  s_add_u32 s4, s4, 0
  v_add_u32 v238, s4, v242
  s_waitcnt lgkmcnt(0)
  s_lshl_b32 s10, s32, 19
  s_add_u32 s8, s76, s10
  s_addc_u32 s9, s77, 0
  s_sub_u32 s8, s8, 32768
  s_subb_u32 s9, s9, 0
  s_mov_b32 s10, 557056
  s_mov_b32 s11, 0x00020000
  s_sub_u32 s12, s78, 2048
  s_subb_u32 s13, s79, 0
  s_mov_b32 s14, 6293504
  s_mov_b32 s15, 0x00020000
  s_add_u32 s96, s86, 125829120
  s_addc_u32 s97, s87, 0
  s_mov_b32 s98, 262144
  s_mov_b32 s99, 0x00020000
  s_cmp_ge_u32 s3, 2
  s_cbranch_scc1 Lp2_r1
  s_and_b32 s4, s2, 7
  s_lshl_b32 s4, s4, 4
  s_add_u32 s4, s4, s59
  s_lshl_b32 s4, s4, 2
  s_add_u32 s4, s4, s3
  s_lshl_b32 s51, s4, 13
  s_add_u32 m0, s36, s50
  s_nop 0
  buffer_load_dwordx4 v232, s[8:11], s46 offen offset:0 lds
  s_mov_b32 m0, s36
  s_nop 0
  buffer_load_dwordx4 v224, s[8:11], s46 offen offset:0 lds
  buffer_load_dwordx4 v225, s[8:11], s46 offen offset:1024 lds
  buffer_load_dwordx4 v226, s[8:11], s46 offen offset:2048 lds
  buffer_load_dwordx4 v227, s[8:11], s46 offen offset:3072 lds
  s_add_u32 m0, s36, 4096
  s_nop 0
  buffer_load_dwordx4 v228, s[8:11], s46 offen offset:0 lds
  buffer_load_dwordx4 v229, s[8:11], s46 offen offset:1024 lds
  buffer_load_dwordx4 v230, s[8:11], s46 offen offset:2048 lds
  buffer_load_dwordx4 v231, s[8:11], s46 offen offset:3072 lds
  s_mul_i32 s47, s48, 393216
  s_bfe_u32 s34, 0x302010e, s49
  s_add_u32 s48, s48, s34
  s_add_u32 s49, s49, 8
  s_and_b32 s49, s49, 0x8001f
  s_and_b32 s48, s48, 15
  s_lshl_b32 s46, s48, 7
  s_mov_b32 m0, s41
  s_nop 0
  buffer_load_dwordx4 v233, s[12:15], s47 offen offset:0 lds
  buffer_load_dwordx4 v234, s[12:15], s47 offen offset:1024 lds
  buffer_load_dwordx4 v235, s[12:15], s47 offen offset:2048 lds
  s_add_u32 m0, s41, 3072
  s_nop 0
  buffer_load_dwordx4 v236, s[12:15], s47 offen offset:0 lds
  buffer_load_dwordx4 v237, s[12:15], s47 offen offset:1024 lds
  buffer_load_dwordx4 v238, s[12:15], s47 offen offset:2048 lds
  s_lshr_b32 s4, s3, 1
  s_lshl_b32 s4, s4, 14
  v_and_b32 v240, 15, v1
  v_lshlrev_b32 v240, 7, v240
  v_lshrrev_b32 v241, 4, v1
  v_and_b32 v242, 6, v1
  v_xor_b32 v241, v241, v242
  v_lshl_add_u32 v240, v241, 4, v240
  v_add_u32 v16, s4, v240
  v_xor_b32 v17, 64, v16
  v_and_b32 v240, 15, v1
  v_lshlrev_b32 v240, 7, v240
  v_lshrrev_b32 v241, 4, v1
  v_and_b32 v242, 6, v1
  v_xor_b32 v241, v241, v242
  v_lshl_add_u32 v240, v241, 4, v240
  v_add_u32 v18, 32768, v240
  v_xor_b32 v19, 64, v18
  v_lshrrev_b32 v240, 2, v1
  v_and_b32 v241, 6, v240
  v_lshlrev_b32 v240, 7, v240
  v_and_b32 v242, 1, v1
  v_lshl_add_u32 v240, v242, 3, v240
  v_add_u32 v240, 104448, v240
  v_bfe_u32 v242, v1, 1, 1
  v_xor_b32 v241, v241, v242
  v_xor_b32 v242, 0, v241
  v_lshl_add_u32 v20, v242, 4, v240
  v_xor_b32 v242, 2, v241
  s_add_u32 m0, s36, s50
  s_add_u32 m0, m0, 34816
  s_nop 0
  buffer_load_dwordx4 v232, s[8:11], s46 offen offset:0 lds
  v_lshl_add_u32 v21, v242, 4, v240
  s_and_b32 s4, s3, 1
  s_lshl_b32 s4, s4, 6
  v_xor_b32 v20, s4, v20
  v_xor_b32 v21, s4, v21
  s_and_b32 s24, s2, 7
  s_lshr_b32 s4, s2, 6
  s_lshl_b32 s4, s4, 3
  s_add_u32 s24, s24, s4
  s_lshr_b32 s4, s2, 3
  s_and_b32 s25, s4, 6
  s_xor_b32 s4, s4, s2
  s_bfe_u32 s4, s4, 0x10003
  s_add_u32 s25, s25, s4
  v_lshrrev_b32 v24, 3, v1
  v_and_b32 v25, 6, v24
  v_and_b32 v26, 7, v1
  v_xor_b32 v25, v25, v26
  v_lshlrev_b32 v25, 4, v25
  s_and_b32 s4, s3, 1
  s_lshl_b32 s4, s4, 16
  s_lshr_b32 s5, s3, 1
  s_lshl_b32 s5, s5, 7
  s_add_u32 s4, s4, s5
  v_lshl_add_u32 v24, v24, 11, v25
  v_add_u32 v24, s4, v24
  s_add_u32 m0, s36, 34816
  s_nop 0
  buffer_load_dwordx4 v224, s[8:11], s46 offen offset:0 lds
  v_add_u32 v25, 0, v24
  v_accvgpr_write_b32 a212, v25
  v_add_u32 v25, 15360, v24
  v_accvgpr_write_b32 a213, v25
  v_add_u32 v25, 30720, v24
  v_accvgpr_write_b32 a214, v25
  v_add_u32 v25, 46080, v24
  buffer_load_dwordx4 v225, s[8:11], s46 offen offset:1024 lds
  v_accvgpr_write_b32 a215, v25
  v_accvgpr_write_b32 a236, 0
  v_mov_b32 v27, 0x3f803f80
  v_accvgpr_write_b32 a208, v27
  v_accvgpr_write_b32 a237, 0
  v_accvgpr_write_b32 a209, v27
  v_accvgpr_write_b32 a238, 0
  buffer_load_dwordx4 v226, s[8:11], s46 offen offset:2048 lds
  v_accvgpr_write_b32 a210, v27
  v_accvgpr_write_b32 a239, 0
  v_accvgpr_write_b32 a211, v27
  v_lshrrev_b32 v24, 3, v1
  v_and_b32 v25, 6, v24
  v_and_b32 v26, 7, v1
  v_xor_b32 v25, v25, v26
  buffer_load_dwordx4 v227, s[8:11], s46 offen offset:3072 lds
  v_lshlrev_b32 v25, 4, v25
  v_lshlrev_b32 v26, 2, v24
  v_add_u32 v26, s3, v26
  v_lshl_add_u32 v26, v26, 11, v25
  v_add_u32 v27, 0, v26
  v_accvgpr_write_b32 a222, v27
  v_add_u32 v27, 64512, v26
  s_add_u32 m0, s36, 38912
  s_nop 0
  buffer_load_dwordx4 v228, s[8:11], s46 offen offset:0 lds
  v_accvgpr_write_b32 a223, v27
  v_add_u32 v27, 129024, v26
  v_accvgpr_write_b32 a224, v27
  v_add_u32 v27, 193536, v26
  v_accvgpr_write_b32 a225, v27
  v_lshrrev_b32 v26, 2, v24
  v_and_b32 v27, 3, v24
  buffer_load_dwordx4 v229, s[8:11], s46 offen offset:1024 lds
  v_lshl_add_u32 v26, v26, 3, v27
  s_and_b32 s4, s3, 1
  s_lshl_b32 s4, s4, 18
  s_lshr_b32 s5, s3, 1
  s_lshl_b32 s5, s5, 7
  s_add_u32 s4, s4, s5
  s_lshl_b32 s5, s24, 8
  s_add_u32 s4, s4, s5
  v_lshl_add_u32 v26, v26, 13, v25
  v_add_u32 v26, s4, v26
  v_add_u32 v27, 0, v26
  v_accvgpr_write_b32 a226, v27
  v_add_u32 v27, 130048, v26
  v_accvgpr_write_b32 a227, v27
  v_add_u32 v27, 30720, v26
  buffer_load_dwordx4 v230, s[8:11], s46 offen offset:2048 lds
  v_accvgpr_write_b32 a228, v27
  v_add_u32 v27, 160768, v26
  v_accvgpr_write_b32 a229, v27
  s_lshl_b32 s4, s3, 13
  s_add_u32 s4, s4, 98304
  v_and_b32 v24, 15, v1
  v_lshlrev_b32 v24, 7, v24
  v_lshrrev_b32 v25, 4, v1
  v_and_b32 v26, 6, v1
  v_xor_b32 v25, v25, v26
  buffer_load_dwordx4 v231, s[8:11], s46 offen offset:3072 lds
  v_lshl_add_u32 v24, v25, 4, v24
  v_add_u32 v28, s4, v24
  v_xor_b32 v29, 64, v28
  v_lshrrev_b32 v24, 2, v1
  v_and_b32 v25, 6, v24
  v_lshlrev_b32 v24, 7, v24
  v_and_b32 v26, 1, v1
  s_mul_i32 s47, s48, 393216
  s_bfe_u32 s34, 0x302010e, s49
  s_add_u32 s48, s48, s34
  s_add_u32 s49, s49, 8
  s_and_b32 s49, s49, 0x8001f
  s_and_b32 s48, s48, 15
  s_lshl_b32 s46, s48, 7
  s_add_u32 m0, s41, 24576
  s_nop 0
  buffer_load_dwordx4 v233, s[12:15], s47 offen offset:0 lds
  v_lshl_add_u32 v24, v26, 3, v24
  v_add_u32 v24, 0, v24
  v_bfe_u32 v26, v1, 1, 1
  v_xor_b32 v25, v25, v26
  v_xor_b32 v26, 0, v25
  v_lshl_add_u32 v30, v26, 4, v24
  v_xor_b32 v26, 2, v25
  buffer_load_dwordx4 v234, s[12:15], s47 offen offset:1024 lds
  v_lshl_add_u32 v31, v26, 4, v24
  v_xor_b32 v26, 4, v25
  v_lshl_add_u32 v32, v26, 4, v24
  v_xor_b32 v26, 6, v25
  v_lshl_add_u32 v33, v26, 4, v24
  v_accvgpr_write_b32 a230, v28
  v_accvgpr_write_b32 a231, v29
  buffer_load_dwordx4 v235, s[12:15], s47 offen offset:2048 lds
  v_accvgpr_write_b32 a232, v30
  v_accvgpr_write_b32 a233, v31
  v_accvgpr_write_b32 a234, v32
  v_accvgpr_write_b32 a235, v33
  v_and_b32 v253, 15, v1
  v_lshrrev_b32 v254, 4, v1
  v_lshlrev_b32 v254, 2, v254
  s_add_u32 m0, s41, 27648
  s_nop 0
  buffer_load_dwordx4 v236, s[12:15], s47 offen offset:0 lds
  v_sub_u32 v253, v253, v254
  v_mov_b32 v254, 0xf149f2ca
  s_lshr_b32 s4, s3, 1
  s_or_b32 s4, s4, s32
  s_cselect_b64 s[6:7], 0, -1
  v_subrev_u32 v255, 0, v253
  v_and_b32 v252, 0x80000001, v255
  v_cmp_ne_u32 vcc, 0, v252
  s_nop 1
  v_cndmask_b32 v244, 0, v254, vcc
  v_add_u32 v255, 1, v255
  v_and_b32 v252, 0x80000001, v255
  v_cmp_ne_u32 vcc, 0x80000001, v252
  s_nop 1
  v_cndmask_b32 v240, 0, v254, vcc
  v_cndmask_b32 v248, v240, v254, s[6:7]
  v_subrev_u32 v255, 1, v253
  buffer_load_dwordx4 v237, s[12:15], s47 offen offset:1024 lds
  v_and_b32 v252, 0x80000001, v255
  v_cmp_ne_u32 vcc, 0, v252
  s_nop 1
  v_cndmask_b32 v245, 0, v254, vcc
  v_add_u32 v255, 1, v255
  v_and_b32 v252, 0x80000001, v255
  v_cmp_ne_u32 vcc, 0x80000001, v252
  s_nop 1
  v_cndmask_b32 v241, 0, v254, vcc
  v_cndmask_b32 v249, v241, v254, s[6:7]
  v_subrev_u32 v255, 2, v253
  v_and_b32 v252, 0x80000001, v255
  v_cmp_ne_u32 vcc, 0, v252
  s_nop 1
  v_cndmask_b32 v246, 0, v254, vcc
  v_add_u32 v255, 1, v255
  buffer_load_dwordx4 v238, s[12:15], s47 offen offset:2048 lds
  v_and_b32 v252, 0x80000001, v255
  v_cmp_ne_u32 vcc, 0x80000001, v252
  s_nop 1
  v_cndmask_b32 v242, 0, v254, vcc
  v_cndmask_b32 v250, v242, v254, s[6:7]
  v_subrev_u32 v255, 3, v253
  v_and_b32 v252, 0x80000001, v255
  v_cmp_ne_u32 vcc, 0, v252
  s_nop 1
  v_cndmask_b32 v247, 0, v254, vcc
  v_add_u32 v255, 1, v255
  v_and_b32 v252, 0x80000001, v255
  v_cmp_ne_u32 vcc, 0x80000001, v252
  s_nop 1
  v_cndmask_b32 v243, 0, v254, vcc
  v_cndmask_b32 v251, v243, v254, s[6:7]
  s_and_b32 s4, s3, 1
  s_lshl_b32 s4, s4, 12
  s_add_u32 s4, s4, 49152
  v_add_u32 v252, s4, v2
  s_lshr_b32 s5, s3, 1
  s_lshl_b32 s5, s5, 11
  v_add_u32 v253, s5, v252
  s_add_u32 s16, s86, 83886080
  s_addc_u32 s17, s87, 0
  s_mov_b32 s18, 4194304
  s_mov_b32 s19, 0x00020000
  s_lshl_b32 s57, s32, 19
  s_lshl_b32 s5, s5, 7
  s_add_u32 s57, s57, s5
  s_lshl_b32 s4, s33, 14
  s_add_u32 s57, s57, s4
  s_and_b32 s4, s3, 1
  s_lshl_b32 s4, s4, 13
  s_add_u32 s57, s57, s4
  s_add_u32 s58, s57, 4096
  s_mov_b32 s37, 0
  s_mov_b32 s39, 4294897664
  s_mov_b32 s40, 34816
  s_mov_b32 s42, 0
  s_mov_b32 s44, 4294942720
  s_mov_b32 s45, 24576
  s_mov_b32 s43, s44
  s_mov_b32 s52, s72
  s_mov_b32 s53, s73
  s_mov_b32 s54, 4194304
  s_mov_b32 s55, 0x00020000
  s_lshl_b32 s1, s51, 1
  s_mov_b32 s56, s51
  s_mov_b32 s0, 0
  s_waitcnt vmcnt(15)
  s_barrier
  ds_read_b128 a[0:3], v16 offset:0
  ds_read_b64_tr_b16 a[72:73], v20 offset:0
  ds_read_b64_tr_b16 a[74:75], v20 offset:2048
  ds_read_b128 a[4:7], v16 offset:2048
  ds_read_b128 a[8:11], v16 offset:4096
  ds_read_b128 a[12:15], v16 offset:6144
  ds_read_b128 a[16:19], v16 offset:8192
  ds_read_b128 a[20:23], v16 offset:10240
  ds_read_b128 a[24:27], v16 offset:12288
  ds_read_b128 a[28:31], v16 offset:14336
  ds_read_b64_tr_b16 a[76:77], v21 offset:0
  ds_read_b64_tr_b16 a[78:79], v21 offset:2048
  ds_read_b64_tr_b16 a[80:81], v20 offset:8192
  ds_read_b64_tr_b16 a[82:83], v20 offset:10240
  ds_read_b128 a[32:35], v18 offset:0
  ds_read_b64_tr_b16 a[84:85], v21 offset:8192
  ds_read_b64_tr_b16 a[86:87], v21 offset:10240
  ds_read_b64_tr_b16 a[88:89], v20 offset:16384
  ds_read_b64_tr_b16 a[90:91], v20 offset:18432
  ds_read_b64_tr_b16 a[92:93], v21 offset:16384
  ds_read_b64_tr_b16 a[94:95], v21 offset:18432
  s_waitcnt lgkmcnt(0)
  v_mfma_f32_16x16x32_bf16 v[24:27], a[72:75], a[0:3], 0
  s_add_u32 m0, s36, s50
  s_add_u32 m0, m0, 69632
  ds_read_b128 a[36:39], v17 offset:0
  v_mfma_f32_16x16x32_bf16 v[28:31], a[72:75], a[4:7], 0
  buffer_load_dwordx4 v232, s[8:11], s46 offen offset:0 lds
  ds_read_b64_tr_b16 a[96:97], v20 offset:4096
  v_mfma_f32_16x16x32_bf16 v[32:35], a[72:75], a[8:11], 0
  s_add_u32 m0, s36, 69632
  v_mfma_f32_16x16x32_bf16 v[36:39], a[72:75], a[12:15], 0
  ds_read_b64_tr_b16 a[98:99], v20 offset:6144
  v_mfma_f32_16x16x32_bf16 v[40:43], a[72:75], a[16:19], 0
  buffer_load_dwordx4 v224, s[8:11], s46 offen offset:0 lds
  v_mfma_f32_16x16x32_bf16 v[44:47], a[72:75], a[20:23], 0
  ds_read_b128 a[40:43], v17 offset:2048
  v_mfma_f32_16x16x32_bf16 v[48:51], a[72:75], a[24:27], 0
  v_mfma_f32_16x16x32_bf16 v[52:55], a[72:75], a[28:31], 0
  ds_read_b128 a[44:47], v17 offset:4096
  v_mfma_f32_16x16x32_bf16 v[56:59], a[76:79], a[0:3], 0
  v_mfma_f32_16x16x32_bf16 v[60:63], a[76:79], a[4:7], 0
  buffer_load_dwordx4 v225, s[8:11], s46 offen offset:1024 lds
  ds_read_b128 a[48:51], v17 offset:6144
  v_mfma_f32_16x16x32_bf16 v[64:67], a[76:79], a[8:11], 0
  v_mfma_f32_16x16x32_bf16 v[68:71], a[76:79], a[12:15], 0
  ds_read_b128 a[52:55], v17 offset:8192
  v_mfma_f32_16x16x32_bf16 v[72:75], a[76:79], a[16:19], 0
  v_mfma_f32_16x16x32_bf16 v[76:79], a[76:79], a[20:23], 0
  ds_read_b128 a[56:59], v17 offset:10240
  v_mfma_f32_16x16x32_bf16 v[80:83], a[76:79], a[24:27], 0
  buffer_load_dwordx4 v226, s[8:11], s46 offen offset:2048 lds
  v_mfma_f32_16x16x32_bf16 v[84:87], a[76:79], a[28:31], 0
  ds_read_b128 a[60:63], v17 offset:12288
  v_mfma_f32_16x16x32_bf16 v[88:91], a[80:83], a[0:3], 0
  v_mfma_f32_16x16x32_bf16 v[92:95], a[80:83], a[4:7], 0
  ds_read_b128 a[64:67], v17 offset:14336
  v_mfma_f32_16x16x32_bf16 v[96:99], a[80:83], a[8:11], 0
  v_mfma_f32_16x16x32_bf16 v[100:103], a[80:83], a[12:15], 0
  buffer_load_dwordx4 v227, s[8:11], s46 offen offset:3072 lds
  ds_read_b64_tr_b16 a[100:101], v21 offset:4096
  v_mfma_f32_16x16x32_bf16 v[104:107], a[80:83], a[16:19], 0
  s_add_u32 m0, s36, 73728
  ds_read_b64_tr_b16 a[102:103], v21 offset:6144
  v_mfma_f32_16x16x32_bf16 v[108:111], a[80:83], a[20:23], 0
  v_mfma_f32_16x16x32_bf16 v[112:115], a[80:83], a[24:27], 0
  ds_read_b64_tr_b16 a[104:105], v20 offset:12288
  v_mfma_f32_16x16x32_bf16 v[116:119], a[80:83], a[28:31], 0
  buffer_load_dwordx4 v228, s[8:11], s46 offen offset:0 lds
  v_mfma_f32_16x16x32_bf16 v[216:219], a[80:83], a[32:35], 0
  ds_read_b64_tr_b16 a[106:107], v20 offset:14336
  v_mfma_f32_16x16x32_bf16 v[120:123], a[84:87], a[0:3], 0
  v_mfma_f32_16x16x32_bf16 v[124:127], a[84:87], a[4:7], 0
  ds_read_b128 a[68:71], v19 offset:0
  v_mfma_f32_16x16x32_bf16 v[128:131], a[84:87], a[8:11], 0
  v_mfma_f32_16x16x32_bf16 v[132:135], a[84:87], a[12:15], 0
  buffer_load_dwordx4 v229, s[8:11], s46 offen offset:1024 lds
  ds_read_b64_tr_b16 a[108:109], v21 offset:12288
  v_mfma_f32_16x16x32_bf16 v[136:139], a[84:87], a[16:19], 0
  v_mfma_f32_16x16x32_bf16 v[140:143], a[84:87], a[20:23], 0
  ds_read_b64_tr_b16 a[110:111], v21 offset:14336
  v_mfma_f32_16x16x32_bf16 v[144:147], a[84:87], a[24:27], 0
  v_mfma_f32_16x16x32_bf16 v[148:151], a[84:87], a[28:31], 0
  ds_read_b64_tr_b16 a[112:113], v20 offset:20480
  v_mfma_f32_16x16x32_bf16 v[220:223], a[84:87], a[32:35], 0
  buffer_load_dwordx4 v230, s[8:11], s46 offen offset:2048 lds
  v_mfma_f32_16x16x32_bf16 v[152:155], a[0:3], a[88:91], 0
  ds_read_b64_tr_b16 a[114:115], v20 offset:22528
  v_mfma_f32_16x16x32_bf16 v[156:159], a[4:7], a[88:91], 0
  v_mfma_f32_16x16x32_bf16 v[160:163], a[8:11], a[88:91], 0
  ds_read_b64_tr_b16 a[116:117], v21 offset:20480
  v_mfma_f32_16x16x32_bf16 v[164:167], a[12:15], a[88:91], 0
  v_mfma_f32_16x16x32_bf16 v[168:171], a[16:19], a[88:91], 0
  buffer_load_dwordx4 v231, s[8:11], s46 offen offset:3072 lds
  ds_read_b64_tr_b16 a[118:119], v21 offset:22528
  v_mfma_f32_16x16x32_bf16 v[172:175], a[20:23], a[88:91], 0
  s_mul_i32 s47, s48, 393216
  s_bfe_u32 s34, 0x302010e, s49
  s_add_u32 s48, s48, s34
  v_mfma_f32_16x16x32_bf16 v[176:179], a[24:27], a[88:91], 0
  s_add_u32 s49, s49, 8
  s_and_b32 s49, s49, 0x8001f
  s_and_b32 s48, s48, 15
  v_mfma_f32_16x16x32_bf16 v[180:183], a[28:31], a[88:91], 0
  s_lshl_b32 s46, s48, 7
  v_mfma_f32_16x16x32_bf16 v[184:187], a[0:3], a[92:95], 0
  s_add_u32 s37, s37, 1
  s_cmp_eq_u32 s37, 3
  s_cselect_b32 s37, 0, s37
  s_cselect_b32 s38, s39, s40
  v_mfma_f32_16x16x32_bf16 v[188:191], a[4:7], a[92:95], 0
  s_sub_u32 s43, 0, s43
  v_mfma_f32_16x16x32_bf16 v[192:195], a[8:11], a[92:95], 0
  v_add_u32 v16, s38, v16
  v_add_u32 v17, s38, v17
  v_mfma_f32_16x16x32_bf16 v[196:199], a[12:15], a[92:95], 0
  v_add_u32 v18, s38, v18
  v_add_u32 v19, s38, v19
  v_mfma_f32_16x16x32_bf16 v[200:203], a[16:19], a[92:95], 0
  v_add_u32 v20, s43, v20
  v_add_u32 v21, s43, v21
  v_mfma_f32_16x16x32_bf16 v[204:207], a[20:23], a[92:95], 0
  v_mfma_f32_16x16x32_bf16 v[208:211], a[24:27], a[92:95], 0
  v_mfma_f32_16x16x32_bf16 v[212:215], a[28:31], a[92:95], 0
  s_mov_b32 s35, 13
  s_waitcnt vmcnt(9) lgkmcnt(0)
  s_barrier
  .p2align 6
Lp2r0_loop:
  v_mfma_f32_16x16x32_bf16 v[24:27], a[96:99], a[36:39], v[24:27]
  buffer_load_dwordx4 a[192:195], v2, s[52:55], s51 offen offset:0
  ds_read_b128 a[0:3], v16 offset:0
  v_mfma_f32_16x16x32_bf16 v[28:31], a[96:99], a[40:43], v[28:31]
  ds_read_b64_tr_b16 a[72:73], v20 offset:0
  v_mfma_f32_16x16x32_bf16 v[32:35], a[96:99], a[44:47], v[32:35]
  v_mfma_f32_16x16x32_bf16 v[36:39], a[96:99], a[48:51], v[36:39]
  ds_read_b64_tr_b16 a[74:75], v20 offset:2048
  v_mfma_f32_16x16x32_bf16 v[40:43], a[96:99], a[52:55], v[40:43]
  buffer_load_dwordx4 a[192:195], v2, s[52:55], s51 offen offset:1024
  v_mfma_f32_16x16x32_bf16 v[44:47], a[96:99], a[56:59], v[44:47]
  ds_read_b128 a[4:7], v16 offset:2048
  v_mfma_f32_16x16x32_bf16 v[48:51], a[96:99], a[60:63], v[48:51]
  v_mfma_f32_16x16x32_bf16 v[52:55], a[96:99], a[64:67], v[52:55]
  ds_read_b128 a[8:11], v16 offset:4096
  v_mfma_f32_16x16x32_bf16 v[56:59], a[100:103], a[36:39], v[56:59]
  v_mfma_f32_16x16x32_bf16 v[60:63], a[100:103], a[40:43], v[60:63]
  buffer_load_dwordx4 a[192:195], v2, s[52:55], s51 offen offset:2048
  ds_read_b128 a[12:15], v16 offset:6144
  v_mfma_f32_16x16x32_bf16 v[64:67], a[100:103], a[44:47], v[64:67]
  v_mfma_f32_16x16x32_bf16 v[68:71], a[100:103], a[48:51], v[68:71]
  ds_read_b128 a[16:19], v16 offset:8192
  v_mfma_f32_16x16x32_bf16 v[72:75], a[100:103], a[52:55], v[72:75]
  v_mfma_f32_16x16x32_bf16 v[76:79], a[100:103], a[56:59], v[76:79]
  ds_read_b128 a[20:23], v16 offset:10240
  v_mfma_f32_16x16x32_bf16 v[80:83], a[100:103], a[60:63], v[80:83]
  buffer_load_dwordx4 a[192:195], v2, s[52:55], s51 offen offset:3072
  v_mfma_f32_16x16x32_bf16 v[84:87], a[100:103], a[64:67], v[84:87]
  s_add_u32 s51, s51, 4096
  s_add_u32 s0, s0, 1
  s_cmp_eq_u32 s0, 2
  s_cselect_b32 s52, s68, s52
  s_cselect_b32 s53, s69, s53
  s_cselect_b32 s51, s1, s51
  s_cselect_b32 s54, 0, s54
  v_mfma_f32_16x16x32_bf16 v[88:91], a[104:107], a[36:39], v[88:91]
  s_cmp_eq_u32 s0, 6
  s_cselect_b32 s52, s64, s52
  s_cselect_b32 s53, s65, s53
  s_cselect_b32 s51, s56, s51
  s_cselect_b32 s54, 0, s54
  v_mfma_f32_16x16x32_bf16 v[92:95], a[104:107], a[40:43], v[92:95]
  s_cmp_eq_u32 s0, 8
  s_cselect_b32 s54, 0, s54
  s_mov_b32 m0, s41
  v_mfma_f32_16x16x32_bf16 v[96:99], a[104:107], a[44:47], v[96:99]
  ds_read_b128 a[24:27], v16 offset:12288
  ds_read_b128 a[28:31], v16 offset:14336
  v_mfma_f32_16x16x32_bf16 v[100:103], a[104:107], a[48:51], v[100:103]
  buffer_load_dwordx4 v233, s[12:15], s47 offen offset:0 lds
  ds_read_b64_tr_b16 a[76:77], v21 offset:0
  v_mfma_f32_16x16x32_bf16 v[104:107], a[104:107], a[52:55], v[104:107]
  ds_read_b64_tr_b16 a[78:79], v21 offset:2048
  v_mfma_f32_16x16x32_bf16 v[108:111], a[104:107], a[56:59], v[108:111]
  v_mfma_f32_16x16x32_bf16 v[112:115], a[104:107], a[60:63], v[112:115]
  ds_read_b64_tr_b16 a[80:81], v20 offset:8192
  v_mfma_f32_16x16x32_bf16 v[116:119], a[104:107], a[64:67], v[116:119]
  v_mfma_f32_16x16x32_bf16 v[216:219], a[104:107], a[68:71], v[216:219]
  buffer_load_dwordx4 v234, s[12:15], s47 offen offset:1024 lds
  ds_read_b64_tr_b16 a[82:83], v20 offset:10240
  v_mfma_f32_16x16x32_bf16 v[120:123], a[108:111], a[36:39], v[120:123]
  v_mfma_f32_16x16x32_bf16 v[124:127], a[108:111], a[40:43], v[124:127]
  ds_read_b128 a[32:35], v18 offset:0
  v_mfma_f32_16x16x32_bf16 v[128:131], a[108:111], a[44:47], v[128:131]
  v_mfma_f32_16x16x32_bf16 v[132:135], a[108:111], a[48:51], v[132:135]
  ds_read_b64_tr_b16 a[84:85], v21 offset:8192
  v_mfma_f32_16x16x32_bf16 v[136:139], a[108:111], a[52:55], v[136:139]
  buffer_load_dwordx4 v235, s[12:15], s47 offen offset:2048 lds
  v_mfma_f32_16x16x32_bf16 v[140:143], a[108:111], a[56:59], v[140:143]
  s_add_u32 m0, s41, 3072
  ds_read_b64_tr_b16 a[86:87], v21 offset:10240
  v_mfma_f32_16x16x32_bf16 v[144:147], a[108:111], a[60:63], v[144:147]
  v_mfma_f32_16x16x32_bf16 v[148:151], a[108:111], a[64:67], v[148:151]
  ds_read_b64_tr_b16 a[88:89], v20 offset:16384
  v_mfma_f32_16x16x32_bf16 v[220:223], a[108:111], a[68:71], v[220:223]
  v_mfma_f32_16x16x32_bf16 v[152:155], a[36:39], a[112:115], v[152:155]
  buffer_load_dwordx4 v236, s[12:15], s47 offen offset:0 lds
  ds_read_b64_tr_b16 a[90:91], v20 offset:18432
  v_mfma_f32_16x16x32_bf16 v[156:159], a[40:43], a[112:115], v[156:159]
  v_mfma_f32_16x16x32_bf16 v[160:163], a[44:47], a[112:115], v[160:163]
  ds_read_b64_tr_b16 a[92:93], v21 offset:16384
  v_mfma_f32_16x16x32_bf16 v[164:167], a[48:51], a[112:115], v[164:167]
  v_mfma_f32_16x16x32_bf16 v[168:171], a[52:55], a[112:115], v[168:171]
  ds_read_b64_tr_b16 a[94:95], v21 offset:18432
  v_mfma_f32_16x16x32_bf16 v[172:175], a[56:59], a[112:115], v[172:175]
  buffer_load_dwordx4 v237, s[12:15], s47 offen offset:1024 lds
  v_mfma_f32_16x16x32_bf16 v[176:179], a[60:63], a[112:115], v[176:179]
  v_mfma_f32_16x16x32_bf16 v[180:183], a[64:67], a[112:115], v[180:183]
  v_mfma_f32_16x16x32_bf16 v[184:187], a[36:39], a[116:119], v[184:187]
  v_mfma_f32_16x16x32_bf16 v[188:191], a[40:43], a[116:119], v[188:191]
  v_mfma_f32_16x16x32_bf16 v[192:195], a[44:47], a[116:119], v[192:195]
  buffer_load_dwordx4 v238, s[12:15], s47 offen offset:2048 lds
  v_mfma_f32_16x16x32_bf16 v[196:199], a[48:51], a[116:119], v[196:199]
  v_mfma_f32_16x16x32_bf16 v[200:203], a[52:55], a[116:119], v[200:203]
  v_mfma_f32_16x16x32_bf16 v[204:207], a[56:59], a[116:119], v[204:207]
  v_mfma_f32_16x16x32_bf16 v[208:211], a[60:63], a[116:119], v[208:211]
  v_mfma_f32_16x16x32_bf16 v[212:215], a[64:67], a[116:119], v[212:215]
  s_waitcnt lgkmcnt(0)
  v_mfma_f32_16x16x32_bf16 v[24:27], a[72:75], a[0:3], v[24:27]
  s_add_u32 m0, s36, s50
  ds_read_b128 a[36:39], v17 offset:0
  v_mfma_f32_16x16x32_bf16 v[28:31], a[72:75], a[4:7], v[28:31]
  buffer_load_dwordx4 v232, s[8:11], s46 offen offset:0 lds
  ds_read_b64_tr_b16 a[96:97], v20 offset:4096
  v_mfma_f32_16x16x32_bf16 v[32:35], a[72:75], a[8:11], v[32:35]
  s_mov_b32 m0, s36
  v_mfma_f32_16x16x32_bf16 v[36:39], a[72:75], a[12:15], v[36:39]
  ds_read_b64_tr_b16 a[98:99], v20 offset:6144
  v_mfma_f32_16x16x32_bf16 v[40:43], a[72:75], a[16:19], v[40:43]
  buffer_load_dwordx4 v224, s[8:11], s46 offen offset:0 lds
  v_mfma_f32_16x16x32_bf16 v[44:47], a[72:75], a[20:23], v[44:47]
  ds_read_b128 a[40:43], v17 offset:2048
  v_mfma_f32_16x16x32_bf16 v[48:51], a[72:75], a[24:27], v[48:51]
  v_mfma_f32_16x16x32_bf16 v[52:55], a[72:75], a[28:31], v[52:55]
  ds_read_b128 a[44:47], v17 offset:4096
  v_mfma_f32_16x16x32_bf16 v[56:59], a[76:79], a[0:3], v[56:59]
  v_mfma_f32_16x16x32_bf16 v[60:63], a[76:79], a[4:7], v[60:63]
  buffer_load_dwordx4 v225, s[8:11], s46 offen offset:1024 lds
  ds_read_b128 a[48:51], v17 offset:6144
  v_mfma_f32_16x16x32_bf16 v[64:67], a[76:79], a[8:11], v[64:67]
  v_mfma_f32_16x16x32_bf16 v[68:71], a[76:79], a[12:15], v[68:71]
  ds_read_b128 a[52:55], v17 offset:8192
  v_mfma_f32_16x16x32_bf16 v[72:75], a[76:79], a[16:19], v[72:75]
  v_mfma_f32_16x16x32_bf16 v[76:79], a[76:79], a[20:23], v[76:79]
  ds_read_b128 a[56:59], v17 offset:10240
  v_mfma_f32_16x16x32_bf16 v[80:83], a[76:79], a[24:27], v[80:83]
  buffer_load_dwordx4 v226, s[8:11], s46 offen offset:2048 lds
  v_mfma_f32_16x16x32_bf16 v[84:87], a[76:79], a[28:31], v[84:87]
  ds_read_b128 a[60:63], v17 offset:12288
  v_mfma_f32_16x16x32_bf16 v[88:91], a[80:83], a[0:3], v[88:91]
  v_mfma_f32_16x16x32_bf16 v[92:95], a[80:83], a[4:7], v[92:95]
  ds_read_b128 a[64:67], v17 offset:14336
  v_mfma_f32_16x16x32_bf16 v[96:99], a[80:83], a[8:11], v[96:99]
  v_mfma_f32_16x16x32_bf16 v[100:103], a[80:83], a[12:15], v[100:103]
  buffer_load_dwordx4 v227, s[8:11], s46 offen offset:3072 lds
  ds_read_b64_tr_b16 a[100:101], v21 offset:4096
  v_mfma_f32_16x16x32_bf16 v[104:107], a[80:83], a[16:19], v[104:107]
  s_add_u32 m0, s36, 4096
  ds_read_b64_tr_b16 a[102:103], v21 offset:6144
  v_mfma_f32_16x16x32_bf16 v[108:111], a[80:83], a[20:23], v[108:111]
  v_mfma_f32_16x16x32_bf16 v[112:115], a[80:83], a[24:27], v[112:115]
  ds_read_b64_tr_b16 a[104:105], v20 offset:12288
  v_mfma_f32_16x16x32_bf16 v[116:119], a[80:83], a[28:31], v[116:119]
  buffer_load_dwordx4 v228, s[8:11], s46 offen offset:0 lds
  v_mfma_f32_16x16x32_bf16 v[216:219], a[80:83], a[32:35], v[216:219]
  ds_read_b64_tr_b16 a[106:107], v20 offset:14336
  v_mfma_f32_16x16x32_bf16 v[120:123], a[84:87], a[0:3], v[120:123]
  v_mfma_f32_16x16x32_bf16 v[124:127], a[84:87], a[4:7], v[124:127]
  ds_read_b128 a[68:71], v19 offset:0
  v_mfma_f32_16x16x32_bf16 v[128:131], a[84:87], a[8:11], v[128:131]
  v_mfma_f32_16x16x32_bf16 v[132:135], a[84:87], a[12:15], v[132:135]
  buffer_load_dwordx4 v229, s[8:11], s46 offen offset:1024 lds
  ds_read_b64_tr_b16 a[108:109], v21 offset:12288
  v_mfma_f32_16x16x32_bf16 v[136:139], a[84:87], a[16:19], v[136:139]
  v_mfma_f32_16x16x32_bf16 v[140:143], a[84:87], a[20:23], v[140:143]
  ds_read_b64_tr_b16 a[110:111], v21 offset:14336
  v_mfma_f32_16x16x32_bf16 v[144:147], a[84:87], a[24:27], v[144:147]
  v_mfma_f32_16x16x32_bf16 v[148:151], a[84:87], a[28:31], v[148:151]
  ds_read_b64_tr_b16 a[112:113], v20 offset:20480
  v_mfma_f32_16x16x32_bf16 v[220:223], a[84:87], a[32:35], v[220:223]
  buffer_load_dwordx4 v230, s[8:11], s46 offen offset:2048 lds
  v_mfma_f32_16x16x32_bf16 v[152:155], a[0:3], a[88:91], v[152:155]
  ds_read_b64_tr_b16 a[114:115], v20 offset:22528
  v_mfma_f32_16x16x32_bf16 v[156:159], a[4:7], a[88:91], v[156:159]
  v_mfma_f32_16x16x32_bf16 v[160:163], a[8:11], a[88:91], v[160:163]
  ds_read_b64_tr_b16 a[116:117], v21 offset:20480
  v_mfma_f32_16x16x32_bf16 v[164:167], a[12:15], a[88:91], v[164:167]
  v_mfma_f32_16x16x32_bf16 v[168:171], a[16:19], a[88:91], v[168:171]
  buffer_load_dwordx4 v231, s[8:11], s46 offen offset:3072 lds
  ds_read_b64_tr_b16 a[118:119], v21 offset:22528
  v_mfma_f32_16x16x32_bf16 v[172:175], a[20:23], a[88:91], v[172:175]
  s_mul_i32 s47, s48, 393216
  s_bfe_u32 s34, 0x302010e, s49
  s_add_u32 s48, s48, s34
  v_mfma_f32_16x16x32_bf16 v[176:179], a[24:27], a[88:91], v[176:179]
  s_add_u32 s49, s49, 8
  s_and_b32 s49, s49, 0x8001f
  s_and_b32 s48, s48, 15
  v_mfma_f32_16x16x32_bf16 v[180:183], a[28:31], a[88:91], v[180:183]
  s_lshl_b32 s46, s48, 7
  v_mfma_f32_16x16x32_bf16 v[184:187], a[0:3], a[92:95], v[184:187]
  s_add_u32 s36, s36, s38
  s_add_u32 s37, s37, 1
  s_cmp_eq_u32 s37, 3
  s_cselect_b32 s37, 0, s37
  s_cselect_b32 s38, s39, s40
  v_mfma_f32_16x16x32_bf16 v[188:191], a[4:7], a[92:95], v[188:191]
  s_add_u32 s41, s41, s43
  s_sub_u32 s43, 0, s43
  v_mfma_f32_16x16x32_bf16 v[192:195], a[8:11], a[92:95], v[192:195]
  v_add_u32 v16, s38, v16
  v_add_u32 v17, s38, v17
  v_mfma_f32_16x16x32_bf16 v[196:199], a[12:15], a[92:95], v[196:199]
  v_add_u32 v18, s38, v18
  v_add_u32 v19, s38, v19
  v_mfma_f32_16x16x32_bf16 v[200:203], a[16:19], a[92:95], v[200:203]
  v_add_u32 v20, s43, v20
  v_add_u32 v21, s43, v21
  v_mfma_f32_16x16x32_bf16 v[204:207], a[20:23], a[92:95], v[204:207]
  s_waitcnt vmcnt(9) lgkmcnt(0)
  s_barrier
  v_mfma_f32_16x16x32_bf16 v[208:211], a[24:27], a[92:95], v[208:211]
  s_sub_u32 s35, s35, 1
  v_mfma_f32_16x16x32_bf16 v[212:215], a[28:31], a[92:95], v[212:215]
  s_cmp_lg_u32 s35, 0
  s_cbranch_scc1 Lp2r0_loop
  v_accvgpr_read_b32 v4, a222
  v_accvgpr_read_b32 v5, a223
  v_accvgpr_read_b32 v6, a224
  v_accvgpr_read_b32 v7, a225
  v_accvgpr_read_b32 v8, a226
  v_accvgpr_read_b32 v9, a227
  v_accvgpr_read_b32 v10, a228
  v_accvgpr_read_b32 v11, a229
  s_mov_b32 s8, s64
  s_mov_b32 s9, s65
  s_mov_b32 s10, 4194304
  s_mov_b32 s11, 0x00020000
  s_mov_b32 s20, s68
  s_mov_b32 s21, s69
  s_mov_b32 s22, 8388608
  s_mov_b32 s23, 0x00020000
  s_and_b32 s4, s2, 7
  s_lshl_b32 s4, s4, 1
  s_lshr_b32 s5, s2, 6
  s_lshr_b32 s30, s2, 4
  s_add_u32 s5, s5, s30
  s_and_b32 s53, s5, 3
  s_lshl_b32 s53, s53, 3
  s_or_b32 s53, s53, 0x80000
  s_bfe_u32 s52, 0xf0f02, s53
  s_add_u32 s52, s52, s4
  s_and_b32 s52, s52, 15
  s_mov_b32 s54, s52
  s_mov_b32 s55, s53
  s_lshl_b32 s29, s52, 7
  s_lshl_b32 s28, s54, 19
  s_lshl_b32 s30, s25, 18
  s_and_b32 s31, s25, 1
  s_lshl_b32 s31, s31, 1
  s_add_u32 s31, s31, 14
  s_sub_u32 s31, s31, s25
  s_lshl_b32 s31, s31, 18
  s_or_b32 s26, s30, s29
  s_or_b32 s27, s31, s29
  s_lshl_b32 s68, s3, 12
  s_lshl_b32 s88, s3, 13
  s_add_u32 s88, s88, 98304
  v_mfma_f32_16x16x32_bf16 v[24:27], a[96:99], a[36:39], v[24:27]
  s_mov_b32 m0, s41
  ds_read_b128 a[0:3], v16 offset:0
  v_mfma_f32_16x16x32_bf16 v[28:31], a[96:99], a[40:43], v[28:31]
  buffer_load_dwordx4 v233, s[12:15], s47 offen offset:0 lds
  ds_read_b64_tr_b16 a[72:73], v20 offset:0
  v_mfma_f32_16x16x32_bf16 v[32:35], a[96:99], a[44:47], v[32:35]
  v_mfma_f32_16x16x32_bf16 v[36:39], a[96:99], a[48:51], v[36:39]
  ds_read_b64_tr_b16 a[74:75], v20 offset:2048
  v_mfma_f32_16x16x32_bf16 v[40:43], a[96:99], a[52:55], v[40:43]
  v_mfma_f32_16x16x32_bf16 v[44:47], a[96:99], a[56:59], v[44:47]
  ds_read_b128 a[4:7], v16 offset:2048
  v_mfma_f32_16x16x32_bf16 v[48:51], a[96:99], a[60:63], v[48:51]
  v_mfma_f32_16x16x32_bf16 v[52:55], a[96:99], a[64:67], v[52:55]
  ds_read_b128 a[8:11], v16 offset:4096
  v_mfma_f32_16x16x32_bf16 v[56:59], a[100:103], a[36:39], v[56:59]
  v_mfma_f32_16x16x32_bf16 v[60:63], a[100:103], a[40:43], v[60:63]
  ds_read_b128 a[12:15], v16 offset:6144
  v_mfma_f32_16x16x32_bf16 v[64:67], a[100:103], a[44:47], v[64:67]
  v_mfma_f32_16x16x32_bf16 v[68:71], a[100:103], a[48:51], v[68:71]
  ds_read_b128 a[16:19], v16 offset:8192
  v_mfma_f32_16x16x32_bf16 v[72:75], a[100:103], a[52:55], v[72:75]
  v_mfma_f32_16x16x32_bf16 v[76:79], a[100:103], a[56:59], v[76:79]
  ds_read_b128 a[20:23], v16 offset:10240
  v_mfma_f32_16x16x32_bf16 v[80:83], a[100:103], a[60:63], v[80:83]
  v_mfma_f32_16x16x32_bf16 v[84:87], a[100:103], a[64:67], v[84:87]
  ds_read_b128 a[24:27], v16 offset:12288
  v_mfma_f32_16x16x32_bf16 v[88:91], a[104:107], a[36:39], v[88:91]
  buffer_load_dwordx4 v234, s[12:15], s47 offen offset:1024 lds
  v_mfma_f32_16x16x32_bf16 v[92:95], a[104:107], a[40:43], v[92:95]
  ds_read_b128 a[28:31], v16 offset:14336
  v_mfma_f32_16x16x32_bf16 v[96:99], a[104:107], a[44:47], v[96:99]
  v_mfma_f32_16x16x32_bf16 v[100:103], a[104:107], a[48:51], v[100:103]
  ds_read_b64_tr_b16 a[76:77], v21 offset:0
  v_mfma_f32_16x16x32_bf16 v[104:107], a[104:107], a[52:55], v[104:107]
  ds_read_b64_tr_b16 a[78:79], v21 offset:2048
  v_mfma_f32_16x16x32_bf16 v[108:111], a[104:107], a[56:59], v[108:111]
  v_mfma_f32_16x16x32_bf16 v[112:115], a[104:107], a[60:63], v[112:115]
  ds_read_b64_tr_b16 a[80:81], v20 offset:8192
  v_mfma_f32_16x16x32_bf16 v[116:119], a[104:107], a[64:67], v[116:119]
  v_mfma_f32_16x16x32_bf16 v[216:219], a[104:107], a[68:71], v[216:219]
  ds_read_b64_tr_b16 a[82:83], v20 offset:10240
  v_mfma_f32_16x16x32_bf16 v[120:123], a[108:111], a[36:39], v[120:123]
  v_mfma_f32_16x16x32_bf16 v[124:127], a[108:111], a[40:43], v[124:127]
  ds_read_b128 a[32:35], v18 offset:0
  v_mfma_f32_16x16x32_bf16 v[128:131], a[108:111], a[44:47], v[128:131]
  v_mfma_f32_16x16x32_bf16 v[132:135], a[108:111], a[48:51], v[132:135]
  ds_read_b64_tr_b16 a[84:85], v21 offset:8192
  v_mfma_f32_16x16x32_bf16 v[136:139], a[108:111], a[52:55], v[136:139]
  v_mfma_f32_16x16x32_bf16 v[140:143], a[108:111], a[56:59], v[140:143]
  ds_read_b64_tr_b16 a[86:87], v21 offset:10240
  v_mfma_f32_16x16x32_bf16 v[144:147], a[108:111], a[60:63], v[144:147]
  v_mfma_f32_16x16x32_bf16 v[148:151], a[108:111], a[64:67], v[148:151]
  buffer_load_dwordx4 v235, s[12:15], s47 offen offset:2048 lds
  ds_read_b64_tr_b16 a[88:89], v20 offset:16384
  v_mfma_f32_16x16x32_bf16 v[220:223], a[108:111], a[68:71], v[220:223]
  v_mfma_f32_16x16x32_bf16 v[152:155], a[36:39], a[112:115], v[152:155]
  ds_read_b64_tr_b16 a[90:91], v20 offset:18432
  v_mfma_f32_16x16x32_bf16 v[156:159], a[40:43], a[112:115], v[156:159]
  v_mfma_f32_16x16x32_bf16 v[160:163], a[44:47], a[112:115], v[160:163]
  ds_read_b64_tr_b16 a[92:93], v21 offset:16384
  v_mfma_f32_16x16x32_bf16 v[164:167], a[48:51], a[112:115], v[164:167]
  v_mfma_f32_16x16x32_bf16 v[168:171], a[52:55], a[112:115], v[168:171]
  ds_read_b64_tr_b16 a[94:95], v21 offset:18432
  v_mfma_f32_16x16x32_bf16 v[172:175], a[56:59], a[112:115], v[172:175]
  v_mfma_f32_16x16x32_bf16 v[176:179], a[60:63], a[112:115], v[176:179]
  v_mfma_f32_16x16x32_bf16 v[180:183], a[64:67], a[112:115], v[180:183]
  v_mfma_f32_16x16x32_bf16 v[184:187], a[36:39], a[116:119], v[184:187]
  v_mfma_f32_16x16x32_bf16 v[188:191], a[40:43], a[116:119], v[188:191]
  v_mfma_f32_16x16x32_bf16 v[192:195], a[44:47], a[116:119], v[192:195]
  v_mfma_f32_16x16x32_bf16 v[196:199], a[48:51], a[116:119], v[196:199]
  v_mfma_f32_16x16x32_bf16 v[200:203], a[52:55], a[116:119], v[200:203]
  v_mfma_f32_16x16x32_bf16 v[204:207], a[56:59], a[116:119], v[204:207]
  v_mfma_f32_16x16x32_bf16 v[208:211], a[60:63], a[116:119], v[208:211]
  v_mfma_f32_16x16x32_bf16 v[212:215], a[64:67], a[116:119], v[212:215]
  s_waitcnt lgkmcnt(0)
  v_mfma_f32_16x16x32_bf16 v[24:27], a[72:75], a[0:3], v[24:27]
  s_add_u32 m0, s41, 3072
  ds_read_b128 a[36:39], v17 offset:0
  v_mfma_f32_16x16x32_bf16 v[28:31], a[72:75], a[4:7], v[28:31]
  buffer_load_dwordx4 v236, s[12:15], s47 offen offset:0 lds
  ds_read_b64_tr_b16 a[96:97], v20 offset:4096
  v_mfma_f32_16x16x32_bf16 v[32:35], a[72:75], a[8:11], v[32:35]
  v_mfma_f32_16x16x32_bf16 v[36:39], a[72:75], a[12:15], v[36:39]
  ds_read_b64_tr_b16 a[98:99], v20 offset:6144
  v_mfma_f32_16x16x32_bf16 v[40:43], a[72:75], a[16:19], v[40:43]
  v_mfma_f32_16x16x32_bf16 v[44:47], a[72:75], a[20:23], v[44:47]
  ds_read_b128 a[40:43], v17 offset:2048
  v_mfma_f32_16x16x32_bf16 v[48:51], a[72:75], a[24:27], v[48:51]
  v_mfma_f32_16x16x32_bf16 v[52:55], a[72:75], a[28:31], v[52:55]
  ds_read_b128 a[44:47], v17 offset:4096
  v_mfma_f32_16x16x32_bf16 v[56:59], a[76:79], a[0:3], v[56:59]
  v_mfma_f32_16x16x32_bf16 v[60:63], a[76:79], a[4:7], v[60:63]
  ds_read_b128 a[48:51], v17 offset:6144
  v_mfma_f32_16x16x32_bf16 v[64:67], a[76:79], a[8:11], v[64:67]
  v_mfma_f32_16x16x32_bf16 v[68:71], a[76:79], a[12:15], v[68:71]
  ds_read_b128 a[52:55], v17 offset:8192
  v_mfma_f32_16x16x32_bf16 v[72:75], a[76:79], a[16:19], v[72:75]
  v_mfma_f32_16x16x32_bf16 v[76:79], a[76:79], a[20:23], v[76:79]
  ds_read_b128 a[56:59], v17 offset:10240
  v_mfma_f32_16x16x32_bf16 v[80:83], a[76:79], a[24:27], v[80:83]
  buffer_load_dwordx4 v237, s[12:15], s47 offen offset:1024 lds
  v_mfma_f32_16x16x32_bf16 v[84:87], a[76:79], a[28:31], v[84:87]
  ds_read_b128 a[60:63], v17 offset:12288
  v_mfma_f32_16x16x32_bf16 v[88:91], a[80:83], a[0:3], v[88:91]
  v_mfma_f32_16x16x32_bf16 v[92:95], a[80:83], a[4:7], v[92:95]
  ds_read_b128 a[64:67], v17 offset:14336
  v_mfma_f32_16x16x32_bf16 v[96:99], a[80:83], a[8:11], v[96:99]
  v_mfma_f32_16x16x32_bf16 v[100:103], a[80:83], a[12:15], v[100:103]
  ds_read_b64_tr_b16 a[100:101], v21 offset:4096
  v_mfma_f32_16x16x32_bf16 v[104:107], a[80:83], a[16:19], v[104:107]
  ds_read_b64_tr_b16 a[102:103], v21 offset:6144
  v_mfma_f32_16x16x32_bf16 v[108:111], a[80:83], a[20:23], v[108:111]
  v_mfma_f32_16x16x32_bf16 v[112:115], a[80:83], a[24:27], v[112:115]
  ds_read_b64_tr_b16 a[104:105], v20 offset:12288
  v_mfma_f32_16x16x32_bf16 v[116:119], a[80:83], a[28:31], v[116:119]
  v_mfma_f32_16x16x32_bf16 v[216:219], a[80:83], a[32:35], v[216:219]
  ds_read_b64_tr_b16 a[106:107], v20 offset:14336
  v_mfma_f32_16x16x32_bf16 v[120:123], a[84:87], a[0:3], v[120:123]
  v_mfma_f32_16x16x32_bf16 v[124:127], a[84:87], a[4:7], v[124:127]
  ds_read_b128 a[68:71], v19 offset:0
  v_mfma_f32_16x16x32_bf16 v[128:131], a[84:87], a[8:11], v[128:131]
  v_mfma_f32_16x16x32_bf16 v[132:135], a[84:87], a[12:15], v[132:135]
  buffer_load_dwordx4 v238, s[12:15], s47 offen offset:2048 lds
  ds_read_b64_tr_b16 a[108:109], v21 offset:12288
  v_mfma_f32_16x16x32_bf16 v[136:139], a[84:87], a[16:19], v[136:139]
  s_add_u32 s36, s36, s38
  s_add_u32 s37, s37, 1
  s_cmp_eq_u32 s37, 3
  s_cselect_b32 s37, 0, s37
  s_cselect_b32 s38, s39, s40
  v_mfma_f32_16x16x32_bf16 v[140:143], a[84:87], a[20:23], v[140:143]
  s_add_u32 s41, s41, s43
  s_sub_u32 s43, 0, s43
  ds_read_b64_tr_b16 a[110:111], v21 offset:14336
  v_mfma_f32_16x16x32_bf16 v[144:147], a[84:87], a[24:27], v[144:147]
  v_mfma_f32_16x16x32_bf16 v[148:151], a[84:87], a[28:31], v[148:151]
  ds_read_b64_tr_b16 a[112:113], v20 offset:20480
  v_mfma_f32_16x16x32_bf16 v[220:223], a[84:87], a[32:35], v[220:223]
  v_mfma_f32_16x16x32_bf16 v[152:155], a[0:3], a[88:91], v[152:155]
  ds_read_b64_tr_b16 a[114:115], v20 offset:22528
  v_mfma_f32_16x16x32_bf16 v[156:159], a[4:7], a[88:91], v[156:159]
  v_mfma_f32_16x16x32_bf16 v[160:163], a[8:11], a[88:91], v[160:163]
  ds_read_b64_tr_b16 a[116:117], v21 offset:20480
  v_mfma_f32_16x16x32_bf16 v[164:167], a[12:15], a[88:91], v[164:167]
  v_mfma_f32_16x16x32_bf16 v[168:171], a[16:19], a[88:91], v[168:171]
  ds_read_b64_tr_b16 a[118:119], v21 offset:22528
  v_mfma_f32_16x16x32_bf16 v[172:175], a[20:23], a[88:91], v[172:175]
  v_add_u32 v16, s38, v16
  v_add_u32 v17, s38, v17
  v_mfma_f32_16x16x32_bf16 v[176:179], a[24:27], a[88:91], v[176:179]
  v_add_u32 v18, s38, v18
  v_add_u32 v19, s38, v19
  v_mfma_f32_16x16x32_bf16 v[180:183], a[28:31], a[88:91], v[180:183]
  v_add_u32 v20, s43, v20
  v_add_u32 v21, s43, v21
  v_mfma_f32_16x16x32_bf16 v[184:187], a[0:3], a[92:95], v[184:187]
  v_mfma_f32_16x16x32_bf16 v[188:191], a[4:7], a[92:95], v[188:191]
  v_mfma_f32_16x16x32_bf16 v[192:195], a[8:11], a[92:95], v[192:195]
  v_mfma_f32_16x16x32_bf16 v[196:199], a[12:15], a[92:95], v[196:199]
  v_mfma_f32_16x16x32_bf16 v[200:203], a[16:19], a[92:95], v[200:203]
  v_mfma_f32_16x16x32_bf16 v[204:207], a[20:23], a[92:95], v[204:207]
  v_mfma_f32_16x16x32_bf16 v[208:211], a[24:27], a[92:95], v[208:211]
  v_mfma_f32_16x16x32_bf16 v[212:215], a[28:31], a[92:95], v[212:215]
  s_waitcnt vmcnt(0) lgkmcnt(0)
  s_barrier
  s_mov_b32 s6, 0x3e8293ee
  s_mov_b32 s7, s6
  v_mfma_f32_16x16x32_bf16 v[24:27], a[96:99], a[36:39], v[24:27]
  ds_read_b128 a[0:3], v16 offset:0
  v_mfma_f32_16x16x32_bf16 v[28:31], a[96:99], a[40:43], v[28:31]
  ds_read_b64_tr_b16 a[72:73], v20 offset:0
  v_mfma_f32_16x16x32_bf16 v[32:35], a[96:99], a[44:47], v[32:35]
  v_mfma_f32_16x16x32_bf16 v[36:39], a[96:99], a[48:51], v[36:39]
  ds_read_b64_tr_b16 a[74:75], v20 offset:2048
  v_mfma_f32_16x16x32_bf16 v[40:43], a[96:99], a[52:55], v[40:43]
  v_mfma_f32_16x16x32_bf16 v[44:47], a[96:99], a[56:59], v[44:47]
  ds_read_b128 a[4:7], v16 offset:2048
  v_mfma_f32_16x16x32_bf16 v[48:51], a[96:99], a[60:63], v[48:51]
  v_mfma_f32_16x16x32_bf16 v[52:55], a[96:99], a[64:67], v[52:55]
  ds_read_b128 a[8:11], v16 offset:4096
  v_mfma_f32_16x16x32_bf16 v[56:59], a[100:103], a[36:39], v[56:59]
  v_mfma_f32_16x16x32_bf16 v[60:63], a[100:103], a[40:43], v[60:63]
  ds_read_b128 a[12:15], v16 offset:6144
  v_mfma_f32_16x16x32_bf16 v[64:67], a[100:103], a[44:47], v[64:67]
  v_mfma_f32_16x16x32_bf16 v[68:71], a[100:103], a[48:51], v[68:71]
  ds_read_b128 a[16:19], v16 offset:8192
  v_mfma_f32_16x16x32_bf16 v[72:75], a[100:103], a[52:55], v[72:75]
  v_mfma_f32_16x16x32_bf16 v[76:79], a[100:103], a[56:59], v[76:79]
  ds_read_b128 a[20:23], v16 offset:10240
  v_mfma_f32_16x16x32_bf16 v[80:83], a[100:103], a[60:63], v[80:83]
  v_mfma_f32_16x16x32_bf16 v[84:87], a[100:103], a[64:67], v[84:87]
  ds_read_b128 a[24:27], v16 offset:12288
  v_mfma_f32_16x16x32_bf16 v[88:91], a[104:107], a[36:39], v[88:91]
  v_mfma_f32_16x16x32_bf16 v[92:95], a[104:107], a[40:43], v[92:95]
  ds_read_b128 a[28:31], v16 offset:14336
  v_mfma_f32_16x16x32_bf16 v[96:99], a[104:107], a[44:47], v[96:99]
  v_mfma_f32_16x16x32_bf16 v[100:103], a[104:107], a[48:51], v[100:103]
  ds_read_b64_tr_b16 a[76:77], v21 offset:0
  v_mfma_f32_16x16x32_bf16 v[104:107], a[104:107], a[52:55], v[104:107]
  ds_read_b64_tr_b16 a[78:79], v21 offset:2048
  v_mfma_f32_16x16x32_bf16 v[108:111], a[104:107], a[56:59], v[108:111]
  v_mfma_f32_16x16x32_bf16 v[112:115], a[104:107], a[60:63], v[112:115]
  ds_read_b64_tr_b16 a[80:81], v20 offset:8192
  v_mfma_f32_16x16x32_bf16 v[116:119], a[104:107], a[64:67], v[116:119]
  v_mfma_f32_16x16x32_bf16 v[216:219], a[104:107], a[68:71], v[216:219]
  ds_read_b64_tr_b16 a[82:83], v20 offset:10240
  v_mfma_f32_16x16x32_bf16 v[120:123], a[108:111], a[36:39], v[120:123]
  v_mfma_f32_16x16x32_bf16 v[124:127], a[108:111], a[40:43], v[124:127]
  ds_read_b128 a[32:35], v18 offset:0
  v_mfma_f32_16x16x32_bf16 v[128:131], a[108:111], a[44:47], v[128:131]
  v_mfma_f32_16x16x32_bf16 v[132:135], a[108:111], a[48:51], v[132:135]
  ds_read_b64_tr_b16 a[84:85], v21 offset:8192
  v_mfma_f32_16x16x32_bf16 v[136:139], a[108:111], a[52:55], v[136:139]
  v_mfma_f32_16x16x32_bf16 v[140:143], a[108:111], a[56:59], v[140:143]
  ds_read_b64_tr_b16 a[86:87], v21 offset:10240
  v_mfma_f32_16x16x32_bf16 v[144:147], a[108:111], a[60:63], v[144:147]
  v_mfma_f32_16x16x32_bf16 v[148:151], a[108:111], a[64:67], v[148:151]
  ds_read_b64_tr_b16 a[88:89], v20 offset:16384
  v_mfma_f32_16x16x32_bf16 v[220:223], a[108:111], a[68:71], v[220:223]
  v_mfma_f32_16x16x32_bf16 v[152:155], a[36:39], a[112:115], v[152:155]
  ds_read_b64_tr_b16 a[90:91], v20 offset:18432
  v_mfma_f32_16x16x32_bf16 v[156:159], a[40:43], a[112:115], v[156:159]
  v_mfma_f32_16x16x32_bf16 v[160:163], a[44:47], a[112:115], v[160:163]
  ds_read_b64_tr_b16 a[92:93], v21 offset:16384
  v_mfma_f32_16x16x32_bf16 v[164:167], a[48:51], a[112:115], v[164:167]
  v_mfma_f32_16x16x32_bf16 v[168:171], a[52:55], a[112:115], v[168:171]
  ds_read_b64_tr_b16 a[94:95], v21 offset:18432
  v_mfma_f32_16x16x32_bf16 v[172:175], a[56:59], a[112:115], v[172:175]
  v_mfma_f32_16x16x32_bf16 v[176:179], a[60:63], a[112:115], v[176:179]
  v_mfma_f32_16x16x32_bf16 v[180:183], a[64:67], a[112:115], v[180:183]
  v_mfma_f32_16x16x32_bf16 v[184:187], a[36:39], a[116:119], v[184:187]
  v_mfma_f32_16x16x32_bf16 v[188:191], a[40:43], a[116:119], v[188:191]
  v_mfma_f32_16x16x32_bf16 v[192:195], a[44:47], a[116:119], v[192:195]
  v_mfma_f32_16x16x32_bf16 v[196:199], a[48:51], a[116:119], v[196:199]
  v_mfma_f32_16x16x32_bf16 v[200:203], a[52:55], a[116:119], v[200:203]
  v_mfma_f32_16x16x32_bf16 v[204:207], a[56:59], a[116:119], v[204:207]
  v_mfma_f32_16x16x32_bf16 v[208:211], a[60:63], a[116:119], v[208:211]
  v_mfma_f32_16x16x32_bf16 v[212:215], a[64:67], a[116:119], v[212:215]
  s_waitcnt lgkmcnt(0)
  v_mfma_f32_16x16x32_bf16 v[24:27], a[72:75], a[0:3], v[24:27]
  ds_read_b128 a[36:39], v17 offset:0
  ds_read_b64_tr_b16 a[96:97], v20 offset:4096
  v_mfma_f32_16x16x32_bf16 v[56:59], a[76:79], a[0:3], v[56:59]
  ds_read_b64_tr_b16 a[98:99], v20 offset:6144
  ds_read_b128 a[40:43], v17 offset:2048
  v_mfma_f32_16x16x32_bf16 v[28:31], a[72:75], a[4:7], v[28:31]
  ds_read_b128 a[44:47], v17 offset:4096
  ds_read_b128 a[48:51], v17 offset:6144
  v_mfma_f32_16x16x32_bf16 v[60:63], a[76:79], a[4:7], v[60:63]
  ds_read_b128 a[52:55], v17 offset:8192
  ds_read_b128 a[56:59], v17 offset:10240
  v_mfma_f32_16x16x32_bf16 v[32:35], a[72:75], a[8:11], v[32:35]
  ds_read_b128 a[60:63], v17 offset:12288
  ds_read_b128 a[64:67], v17 offset:14336
  v_mfma_f32_16x16x32_bf16 v[64:67], a[76:79], a[8:11], v[64:67]
  ds_read_b64_tr_b16 a[100:101], v21 offset:4096
  ds_read_b64_tr_b16 a[102:103], v21 offset:6144
  v_mfma_f32_16x16x32_bf16 v[36:39], a[72:75], a[12:15], v[36:39]
  ds_read_b64_tr_b16 a[104:105], v20 offset:12288
  ds_read_b64_tr_b16 a[106:107], v20 offset:14336
  v_mfma_f32_16x16x32_bf16 v[68:71], a[76:79], a[12:15], v[68:71]
  ds_read_b128 a[68:71], v19 offset:0
  ds_read_b64_tr_b16 a[108:109], v21 offset:12288
  v_mfma_f32_16x16x32_bf16 v[40:43], a[72:75], a[16:19], v[40:43]
  ds_read_b64_tr_b16 a[110:111], v21 offset:14336
  ds_read_b64_tr_b16 a[112:113], v20 offset:20480
  v_mfma_f32_16x16x32_bf16 v[72:75], a[76:79], a[16:19], v[72:75]
  ds_read_b64_tr_b16 a[114:115], v20 offset:22528
  ds_read_b64_tr_b16 a[116:117], v21 offset:20480
  v_mfma_f32_16x16x32_bf16 v[44:47], a[72:75], a[20:23], v[44:47]
  ds_read_b64_tr_b16 a[118:119], v21 offset:22528
  v_mfma_f32_16x16x32_bf16 v[76:79], a[76:79], a[20:23], v[76:79]
  v_mfma_f32_16x16x32_bf16 v[48:51], a[72:75], a[24:27], v[48:51]
  v_mfma_f32_16x16x32_bf16 v[80:83], a[76:79], a[24:27], v[80:83]
  v_mfma_f32_16x16x32_bf16 v[52:55], a[72:75], a[28:31], v[52:55]
  v_mfma_f32_16x16x32_bf16 v[84:87], a[76:79], a[28:31], v[84:87]
  s_waitcnt lgkmcnt(0)
  s_barrier
  s_mov_b32 s12, s84
  s_mov_b32 s13, s85
  s_mov_b32 s14, 256
  s_mov_b32 s15, 0x00020000
  buffer_load_dwordx2 v[22:23], off, s[12:15], 0 sc1
  v_mfma_f32_16x16x32_bf16 v[24:27], a[96:99], a[36:39], v[24:27]
  s_mov_b32 m0, s68
  v_mfma_f32_16x16x32_bf16 v[56:59], a[100:103], a[36:39], v[56:59]
  buffer_load_dwordx4 v8, s[20:23], s28 offen offset:0 lds
  v_mfma_f32_16x16x32_bf16 v[28:31], a[96:99], a[40:43], v[28:31]
  v_mfma_f32_16x16x32_bf16 v[60:63], a[100:103], a[40:43], v[60:63]
  v_mfma_f32_16x16x32_bf16 v[32:35], a[96:99], a[44:47], v[32:35]
  v_mfma_f32_16x16x32_bf16 v[64:67], a[100:103], a[44:47], v[64:67]
  buffer_load_dwordx4 v9, s[20:23], s28 offen offset:1024 lds
  v_pk_mul_f32 v[24:25], v[24:25], s[6:7]
  v_mfma_f32_16x16x32_bf16 v[36:39], a[96:99], a[48:51], v[36:39]
  v_pk_mul_f32 v[26:27], v[26:27], s[6:7]
  v_pk_mul_f32 v[56:57], v[56:57], s[6:7]
  v_mfma_f32_16x16x32_bf16 v[68:71], a[100:103], a[48:51], v[68:71]
  v_pk_mul_f32 v[58:59], v[58:59], s[6:7]
  v_cvt_pk_bf16_f32 v24, v24, v25
  v_mfma_f32_16x16x32_bf16 v[40:43], a[96:99], a[52:55], v[40:43]
  v_cvt_pk_bf16_f32 v25, v26, v27
  v_cvt_pk_bf16_f32 v26, v56, v57
  v_mfma_f32_16x16x32_bf16 v[72:75], a[100:103], a[52:55], v[72:75]
  v_cvt_pk_bf16_f32 v27, v58, v59
  v_pk_mul_f32 v[28:29], v[28:29], s[6:7]
  v_mfma_f32_16x16x32_bf16 v[44:47], a[96:99], a[56:59], v[44:47]
  buffer_load_dwordx4 v10, s[20:23], s28 offen offset:2048 lds
  v_pk_mul_f32 v[30:31], v[30:31], s[6:7]
  v_mfma_f32_16x16x32_bf16 v[76:79], a[100:103], a[56:59], v[76:79]
  v_pk_mul_f32 v[60:61], v[60:61], s[6:7]
  v_pk_mul_f32 v[62:63], v[62:63], s[6:7]
  v_mfma_f32_16x16x32_bf16 v[48:51], a[96:99], a[60:63], v[48:51]
  v_cvt_pk_bf16_f32 v28, v28, v29
  v_cvt_pk_bf16_f32 v29, v30, v31
  v_mfma_f32_16x16x32_bf16 v[80:83], a[100:103], a[60:63], v[80:83]
  v_cvt_pk_bf16_f32 v30, v60, v61
  v_cvt_pk_bf16_f32 v31, v62, v63
  v_mfma_f32_16x16x32_bf16 v[52:55], a[96:99], a[64:67], v[52:55]
  v_pk_mul_f32 v[32:33], v[32:33], s[6:7]
  v_pk_mul_f32 v[34:35], v[34:35], s[6:7]
  v_mfma_f32_16x16x32_bf16 v[84:87], a[100:103], a[64:67], v[84:87]
  buffer_load_dwordx4 v11, s[20:23], s28 offen offset:3072 lds
  v_pk_mul_f32 v[64:65], v[64:65], s[6:7]
  v_mfma_f32_16x16x32_bf16 v[216:219], a[80:83], a[32:35], v[216:219]
  s_bfe_u32 s56, 0x302010e, s55
  s_add_u32 s54, s54, s56
  s_add_u32 s55, s55, 8
  v_mfma_f32_16x16x32_bf16 v[220:223], a[84:87], a[32:35], v[220:223]
  s_and_b32 s55, s55, 0x8001f
  s_and_b32 s54, s54, 15
  s_lshl_b32 s28, s54, 19
  v_mfma_f32_16x16x32_bf16 v[216:219], a[104:107], a[68:71], v[216:219]
  s_add_u32 m0, s68, 16384
  v_pk_mul_f32 v[66:67], v[66:67], s[6:7]
  v_cvt_pk_bf16_f32 v32, v32, v33
  v_mfma_f32_16x16x32_bf16 v[220:223], a[108:111], a[68:71], v[220:223]
  v_cvt_pk_bf16_f32 v33, v34, v35
  v_cvt_pk_bf16_f32 v34, v64, v65
  v_mfma_f32_16x16x32_bf16 v[88:91], a[80:83], a[0:3], v[88:91]
  buffer_load_dwordx4 v8, s[20:23], s28 offen offset:0 lds
  v_cvt_pk_bf16_f32 v35, v66, v67
  v_mfma_f32_16x16x32_bf16 v[120:123], a[84:87], a[0:3], v[120:123]
  v_pk_mul_f32 v[36:37], v[36:37], s[6:7]
  v_pk_mul_f32 v[38:39], v[38:39], s[6:7]
  v_mfma_f32_16x16x32_bf16 v[88:91], a[104:107], a[36:39], v[88:91]
  v_pk_mul_f32 v[68:69], v[68:69], s[6:7]
  v_pk_mul_f32 v[70:71], v[70:71], s[6:7]
  v_mfma_f32_16x16x32_bf16 v[120:123], a[108:111], a[36:39], v[120:123]
  v_cvt_pk_bf16_f32 v36, v36, v37
  v_cvt_pk_bf16_f32 v37, v38, v39
  v_mfma_f32_16x16x32_bf16 v[92:95], a[80:83], a[4:7], v[92:95]
  v_cvt_pk_bf16_f32 v38, v68, v69
  v_cvt_pk_bf16_f32 v39, v70, v71
  v_mfma_f32_16x16x32_bf16 v[124:127], a[84:87], a[4:7], v[124:127]
  buffer_load_dwordx4 v9, s[20:23], s28 offen offset:1024 lds
  v_pk_mul_f32 v[40:41], v[40:41], s[6:7]
  v_mfma_f32_16x16x32_bf16 v[92:95], a[104:107], a[40:43], v[92:95]
  v_pk_mul_f32 v[42:43], v[42:43], s[6:7]
  v_pk_mul_f32 v[72:73], v[72:73], s[6:7]
  v_mfma_f32_16x16x32_bf16 v[124:127], a[108:111], a[40:43], v[124:127]
  v_pk_mul_f32 v[74:75], v[74:75], s[6:7]
  v_cvt_pk_bf16_f32 v40, v40, v41
  v_mfma_f32_16x16x32_bf16 v[96:99], a[80:83], a[8:11], v[96:99]
  v_cvt_pk_bf16_f32 v41, v42, v43
  v_cvt_pk_bf16_f32 v42, v72, v73
  v_mfma_f32_16x16x32_bf16 v[128:131], a[84:87], a[8:11], v[128:131]
  v_cvt_pk_bf16_f32 v43, v74, v75
  v_pk_mul_f32 v[44:45], v[44:45], s[6:7]
  v_mfma_f32_16x16x32_bf16 v[96:99], a[104:107], a[44:47], v[96:99]
  v_pk_mul_f32 v[46:47], v[46:47], s[6:7]
  v_pk_mul_f32 v[76:77], v[76:77], s[6:7]
  v_mfma_f32_16x16x32_bf16 v[128:131], a[108:111], a[44:47], v[128:131]
  buffer_load_dwordx4 v10, s[20:23], s28 offen offset:2048 lds
  v_pk_mul_f32 v[78:79], v[78:79], s[6:7]
  v_mfma_f32_16x16x32_bf16 v[100:103], a[80:83], a[12:15], v[100:103]
  v_cvt_pk_bf16_f32 v44, v44, v45
  v_cvt_pk_bf16_f32 v45, v46, v47
  v_mfma_f32_16x16x32_bf16 v[132:135], a[84:87], a[12:15], v[132:135]
  v_cvt_pk_bf16_f32 v46, v76, v77
  v_cvt_pk_bf16_f32 v47, v78, v79
  v_mfma_f32_16x16x32_bf16 v[100:103], a[104:107], a[48:51], v[100:103]
  v_pk_mul_f32 v[48:49], v[48:49], s[6:7]
  v_pk_mul_f32 v[50:51], v[50:51], s[6:7]
  v_mfma_f32_16x16x32_bf16 v[132:135], a[108:111], a[48:51], v[132:135]
  v_pk_mul_f32 v[80:81], v[80:81], s[6:7]
  v_pk_mul_f32 v[82:83], v[82:83], s[6:7]
  v_mfma_f32_16x16x32_bf16 v[104:107], a[80:83], a[16:19], v[104:107]
  buffer_load_dwordx4 v11, s[20:23], s28 offen offset:3072 lds
  v_cvt_pk_bf16_f32 v48, v48, v49
  v_mfma_f32_16x16x32_bf16 v[136:139], a[84:87], a[16:19], v[136:139]
  s_bfe_u32 s56, 0x302010e, s55
  s_add_u32 s54, s54, s56
  s_add_u32 s55, s55, 8
  v_mfma_f32_16x16x32_bf16 v[104:107], a[104:107], a[52:55], v[104:107]
  s_and_b32 s55, s55, 0x8001f
  s_and_b32 s54, s54, 15
  s_lshl_b32 s28, s54, 19
  v_mfma_f32_16x16x32_bf16 v[136:139], a[108:111], a[52:55], v[136:139]
  s_mov_b32 m0, s88
  v_cvt_pk_bf16_f32 v49, v50, v51
  v_cvt_pk_bf16_f32 v50, v80, v81
  v_mfma_f32_16x16x32_bf16 v[108:111], a[80:83], a[20:23], v[108:111]
  v_cvt_pk_bf16_f32 v51, v82, v83
  v_pk_mul_f32 v[52:53], v[52:53], s[6:7]
  v_mfma_f32_16x16x32_bf16 v[140:143], a[84:87], a[20:23], v[140:143]
  buffer_load_dwordx4 v4, s[8:11], s26 offen offset:0 lds
  v_pk_mul_f32 v[54:55], v[54:55], s[6:7]
  v_mfma_f32_16x16x32_bf16 v[108:111], a[104:107], a[56:59], v[108:111]
  v_pk_mul_f32 v[84:85], v[84:85], s[6:7]
  v_pk_mul_f32 v[86:87], v[86:87], s[6:7]
  v_mfma_f32_16x16x32_bf16 v[140:143], a[108:111], a[56:59], v[140:143]
  v_cvt_pk_bf16_f32 v52, v52, v53
  v_cvt_pk_bf16_f32 v53, v54, v55
  v_mfma_f32_16x16x32_bf16 v[112:115], a[80:83], a[24:27], v[112:115]
  v_cvt_pk_bf16_f32 v54, v84, v85
  v_cvt_pk_bf16_f32 v55, v86, v87
  v_mfma_f32_16x16x32_bf16 v[144:147], a[84:87], a[24:27], v[144:147]
  v_cvt_pk_bf16_f32 v216, v216, v217
  v_cvt_pk_bf16_f32 v217, v218, v219
  v_mfma_f32_16x16x32_bf16 v[112:115], a[104:107], a[60:63], v[112:115]
  buffer_load_dwordx4 v5, s[8:11], s26 offen offset:1024 lds
  v_cvt_pk_bf16_f32 v218, v220, v221
  v_mfma_f32_16x16x32_bf16 v[144:147], a[108:111], a[60:63], v[144:147]
  v_cvt_pk_bf16_f32 v219, v222, v223
  v_mfma_f32_16x16x32_bf16 v[116:119], a[80:83], a[28:31], v[116:119]
  ds_write_b128 v252, v[216:219]
  v_cvt_pk_bf16_f32 v88, v88, v89
  v_mfma_f32_16x16x32_bf16 v[148:151], a[84:87], a[28:31], v[148:151]
  v_cvt_pk_bf16_f32 v89, v90, v91
  v_cvt_pk_bf16_f32 v90, v120, v121
  v_mfma_f32_16x16x32_bf16 v[116:119], a[104:107], a[64:67], v[116:119]
  v_cvt_pk_bf16_f32 v91, v122, v123
  v_cvt_pk_bf16_f32 v92, v92, v93
  v_mfma_f32_16x16x32_bf16 v[148:151], a[108:111], a[64:67], v[148:151]
  buffer_load_dwordx4 v6, s[8:11], s26 offen offset:2048 lds
  v_cvt_pk_bf16_f32 v93, v94, v95
  v_mfma_f32_16x16x32_bf16 v[180:183], a[28:31], a[88:91], v[180:183]
  v_cvt_pk_bf16_f32 v94, v124, v125
  v_cvt_pk_bf16_f32 v95, v126, v127
  v_mfma_f32_16x16x32_bf16 v[212:215], a[28:31], a[92:95], v[212:215]
  v_cvt_pk_bf16_f32 v96, v96, v97
  v_cvt_pk_bf16_f32 v97, v98, v99
  v_mfma_f32_16x16x32_bf16 v[180:183], a[64:67], a[112:115], v[180:183]
  v_cvt_pk_bf16_f32 v98, v128, v129
  v_cvt_pk_bf16_f32 v99, v130, v131
  v_mfma_f32_16x16x32_bf16 v[212:215], a[64:67], a[116:119], v[212:215]
  v_cvt_pk_bf16_f32 v100, v100, v101
  v_cvt_pk_bf16_f32 v101, v102, v103
  v_mfma_f32_16x16x32_bf16 v[176:179], a[24:27], a[88:91], v[176:179]
  v_cvt_pk_bf16_f32 v102, v132, v133
  v_cvt_pk_bf16_f32 v103, v134, v135
  v_mfma_f32_16x16x32_bf16 v[208:211], a[24:27], a[92:95], v[208:211]
  buffer_load_dwordx4 v7, s[8:11], s26 offen offset:3072 lds
  v_cvt_pk_bf16_f32 v104, v104, v105
  v_mfma_f32_16x16x32_bf16 v[176:179], a[60:63], a[112:115], v[176:179]
  s_add_u32 m0, s88, 4096
  v_cvt_pk_bf16_f32 v105, v106, v107
  v_cvt_pk_bf16_f32 v106, v136, v137
  v_mfma_f32_16x16x32_bf16 v[208:211], a[60:63], a[116:119], v[208:211]
  v_cvt_pk_bf16_f32 v107, v138, v139
  v_cvt_pk_bf16_f32 v108, v108, v109
  v_mfma_f32_16x16x32_bf16 v[172:175], a[20:23], a[88:91], v[172:175]
  v_cvt_pk_bf16_f32 v109, v110, v111
  v_cvt_pk_bf16_f32 v110, v140, v141
  v_mfma_f32_16x16x32_bf16 v[204:207], a[20:23], a[92:95], v[204:207]
  v_cvt_pk_bf16_f32 v111, v142, v143
  v_cvt_pk_bf16_f32 v112, v112, v113
  v_mfma_f32_16x16x32_bf16 v[172:175], a[56:59], a[112:115], v[172:175]
  buffer_load_dwordx4 v4, s[8:11], s27 offen offset:0 lds
  v_cvt_pk_bf16_f32 v113, v114, v115
  v_mfma_f32_16x16x32_bf16 v[204:207], a[56:59], a[116:119], v[204:207]
  v_cvt_pk_bf16_f32 v114, v144, v145
  v_cvt_pk_bf16_f32 v115, v146, v147
  v_mfma_f32_16x16x32_bf16 v[168:171], a[16:19], a[88:91], v[168:171]
  v_cvt_pk_bf16_f32 v116, v116, v117
  v_cvt_pk_bf16_f32 v117, v118, v119
  v_mfma_f32_16x16x32_bf16 v[200:203], a[16:19], a[92:95], v[200:203]
  v_cvt_pk_bf16_f32 v118, v148, v149
  v_cvt_pk_bf16_f32 v119, v150, v151
  v_mfma_f32_16x16x32_bf16 v[168:171], a[52:55], a[112:115], v[168:171]
  ds_write_b128 v252, v[116:119] offset:2048
  v_cvt_pk_bf16_f32 v72, v180, v181
  v_mfma_f32_16x16x32_bf16 v[200:203], a[52:55], a[116:119], v[200:203]
  buffer_load_dwordx4 v5, s[8:11], s27 offen offset:1024 lds
  v_cvt_pk_bf16_f32 v73, v182, v183
  v_mfma_f32_16x16x32_bf16 v[164:167], a[12:15], a[88:91], v[164:167]
  v_cvt_pk_bf16_f32 v136, v212, v213
  v_cvt_pk_bf16_f32 v137, v214, v215
  v_mfma_f32_16x16x32_bf16 v[196:199], a[12:15], a[92:95], v[196:199]
  ds_write_b64 v252, v[72:73] offset:3072
  ds_write_b64 v252, v[136:137] offset:3080
  v_mfma_f32_16x16x32_bf16 v[164:167], a[48:51], a[112:115], v[164:167]
  v_cvt_pk_bf16_f32 v70, v176, v177
  v_cvt_pk_bf16_f32 v71, v178, v179
  v_mfma_f32_16x16x32_bf16 v[196:199], a[48:51], a[116:119], v[196:199]
  v_cvt_pk_bf16_f32 v134, v208, v209
  v_cvt_pk_bf16_f32 v135, v210, v211
  v_mfma_f32_16x16x32_bf16 v[160:163], a[8:11], a[88:91], v[160:163]
  buffer_load_dwordx4 v6, s[8:11], s27 offen offset:2048 lds
  v_cvt_pk_bf16_f32 v68, v172, v173
  v_mfma_f32_16x16x32_bf16 v[192:195], a[8:11], a[92:95], v[192:195]
  v_cvt_pk_bf16_f32 v69, v174, v175
  v_cvt_pk_bf16_f32 v132, v204, v205
  v_mfma_f32_16x16x32_bf16 v[160:163], a[44:47], a[112:115], v[160:163]
  v_cvt_pk_bf16_f32 v133, v206, v207
  v_cvt_pk_bf16_f32 v66, v168, v169
  v_mfma_f32_16x16x32_bf16 v[192:195], a[44:47], a[116:119], v[192:195]
  v_cvt_pk_bf16_f32 v67, v170, v171
  v_cvt_pk_bf16_f32 v130, v200, v201
  v_mfma_f32_16x16x32_bf16 v[156:159], a[4:7], a[88:91], v[156:159]
  v_cvt_pk_bf16_f32 v131, v202, v203
  v_cvt_pk_bf16_f32 v64, v164, v165
  v_mfma_f32_16x16x32_bf16 v[188:191], a[4:7], a[92:95], v[188:191]
  buffer_load_dwordx4 v7, s[8:11], s27 offen offset:3072 lds
  v_cvt_pk_bf16_f32 v65, v166, v167
  v_mfma_f32_16x16x32_bf16 v[156:159], a[40:43], a[112:115], v[156:159]
  s_bfe_u32 s29, 0x302010e, s53
  s_add_u32 s52, s52, s29
  s_add_u32 s53, s53, 8
  v_mfma_f32_16x16x32_bf16 v[188:191], a[40:43], a[116:119], v[188:191]
  s_and_b32 s53, s53, 0x8001f
  s_and_b32 s52, s52, 15
  s_lshl_b32 s29, s52, 7
  v_mfma_f32_16x16x32_bf16 v[152:155], a[0:3], a[88:91], v[152:155]
  s_or_b32 s26, s30, s29
  s_or_b32 s27, s31, s29
  v_cvt_pk_bf16_f32 v128, v196, v197
  v_mfma_f32_16x16x32_bf16 v[184:187], a[0:3], a[92:95], v[184:187]
  v_cvt_pk_bf16_f32 v129, v198, v199
  v_cvt_pk_bf16_f32 v62, v160, v161
  v_mfma_f32_16x16x32_bf16 v[152:155], a[36:39], a[112:115], v[152:155]
  v_cvt_pk_bf16_f32 v63, v162, v163
  v_cvt_pk_bf16_f32 v126, v192, v193
  v_mfma_f32_16x16x32_bf16 v[184:187], a[36:39], a[116:119], v[184:187]
  v_cvt_pk_bf16_f32 v127, v194, v195
  v_cvt_pk_bf16_f32 v60, v156, v157
  v_cvt_pk_bf16_f32 v61, v158, v159
  v_cvt_pk_bf16_f32 v124, v188, v189
  v_cvt_pk_bf16_f32 v125, v190, v191
  v_cvt_pk_bf16_f32 v58, v152, v153
  v_cvt_pk_bf16_f32 v59, v154, v155
  s_nop 0
  v_cvt_pk_bf16_f32 v122, v184, v185
  v_cvt_pk_bf16_f32 v123, v186, v187
  s_waitcnt lgkmcnt(0)
  s_barrier
  s_branch Lp2_at
Lp2_r1:
  s_and_b32 s4, s2, 7
  s_lshl_b32 s4, s4, 4
  s_add_u32 s4, s4, s59
  s_lshl_b32 s4, s4, 2
  s_add_u32 s4, s4, s3
  s_lshl_b32 s51, s4, 13
  s_mov_b32 m0, s36
  s_nop 0
  buffer_load_dwordx4 v224, s[8:11], s46 offen offset:0 lds
  buffer_load_dwordx4 v225, s[8:11], s46 offen offset:1024 lds
  buffer_load_dwordx4 v226, s[8:11], s46 offen offset:2048 lds
  buffer_load_dwordx4 v227, s[8:11], s46 offen offset:3072 lds
  s_add_u32 m0, s36, 4096
  s_nop 0
  buffer_load_dwordx4 v228, s[8:11], s46 offen offset:0 lds
  buffer_load_dwordx4 v229, s[8:11], s46 offen offset:1024 lds
  buffer_load_dwordx4 v230, s[8:11], s46 offen offset:2048 lds
  buffer_load_dwordx4 v231, s[8:11], s46 offen offset:3072 lds
  s_mul_i32 s47, s48, 393216
  s_bfe_u32 s34, 0x302010e, s49
  s_add_u32 s48, s48, s34
  s_add_u32 s49, s49, 8
  s_and_b32 s49, s49, 0x8001f
  s_and_b32 s48, s48, 15
  s_lshl_b32 s46, s48, 7
  s_mov_b32 m0, s41
  s_nop 0
  buffer_load_dwordx4 v233, s[12:15], s47 offen offset:0 lds
  buffer_load_dwordx4 v234, s[12:15], s47 offen offset:1024 lds
  buffer_load_dwordx4 v235, s[12:15], s47 offen offset:2048 lds
  s_add_u32 m0, s41, 3072
  s_nop 0
  buffer_load_dwordx4 v236, s[12:15], s47 offen offset:0 lds
  buffer_load_dwordx4 v237, s[12:15], s47 offen offset:1024 lds
  buffer_load_dwordx4 v238, s[12:15], s47 offen offset:2048 lds
  s_lshr_b32 s4, s3, 1
  s_lshl_b32 s4, s4, 14
  v_and_b32 v240, 15, v1
  v_lshlrev_b32 v240, 7, v240
  v_lshrrev_b32 v241, 4, v1
  v_and_b32 v242, 6, v1
  v_xor_b32 v241, v241, v242
  v_lshl_add_u32 v240, v241, 4, v240
  v_add_u32 v16, s4, v240
  v_xor_b32 v17, 64, v16
  v_and_b32 v240, 15, v1
  v_lshlrev_b32 v240, 7, v240
  v_lshrrev_b32 v241, 4, v1
  v_and_b32 v242, 6, v1
  v_xor_b32 v241, v241, v242
  v_lshl_add_u32 v240, v241, 4, v240
  v_add_u32 v18, 32768, v240
  v_xor_b32 v19, 64, v18
  v_lshrrev_b32 v240, 2, v1
  v_and_b32 v241, 6, v240
  v_lshlrev_b32 v240, 7, v240
  v_and_b32 v242, 1, v1
  v_lshl_add_u32 v240, v242, 3, v240
  v_add_u32 v240, 104448, v240
  v_bfe_u32 v242, v1, 1, 1
  v_xor_b32 v241, v241, v242
  v_xor_b32 v242, 0, v241
  v_lshl_add_u32 v20, v242, 4, v240
  v_xor_b32 v242, 2, v241
  s_add_u32 m0, s36, 34816
  s_nop 0
  buffer_load_dwordx4 v224, s[8:11], s46 offen offset:0 lds
  v_lshl_add_u32 v21, v242, 4, v240
  s_and_b32 s4, s3, 1
  s_lshl_b32 s4, s4, 6
  v_xor_b32 v20, s4, v20
  v_xor_b32 v21, s4, v21
  s_and_b32 s24, s2, 7
  s_lshr_b32 s4, s2, 6
  s_lshl_b32 s4, s4, 3
  s_add_u32 s24, s24, s4
  s_lshr_b32 s4, s2, 3
  s_and_b32 s25, s4, 6
  s_xor_b32 s4, s4, s2
  s_bfe_u32 s4, s4, 0x10003
  s_add_u32 s25, s25, s4
  v_lshrrev_b32 v24, 3, v1
  v_and_b32 v25, 6, v24
  v_and_b32 v26, 7, v1
  v_xor_b32 v25, v25, v26
  v_lshlrev_b32 v25, 4, v25
  s_and_b32 s4, s3, 1
  s_lshl_b32 s4, s4, 16
  s_lshr_b32 s5, s3, 1
  s_lshl_b32 s5, s5, 7
  s_add_u32 s4, s4, s5
  v_lshl_add_u32 v24, v24, 11, v25
  v_add_u32 v24, s4, v24
  buffer_load_dwordx4 v225, s[8:11], s46 offen offset:1024 lds
  v_add_u32 v25, 0, v24
  v_accvgpr_write_b32 a212, v25
  v_add_u32 v25, 15360, v24
  v_accvgpr_write_b32 a213, v25
  v_add_u32 v25, 30720, v24
  v_accvgpr_write_b32 a214, v25
  v_add_u32 v25, 46080, v24
  v_accvgpr_write_b32 a215, v25
  buffer_load_dwordx4 v226, s[8:11], s46 offen offset:2048 lds
  v_accvgpr_write_b32 a236, 0
  v_mov_b32 v27, 0x3f803f80
  v_accvgpr_write_b32 a208, v27
  v_accvgpr_write_b32 a237, 0
  v_accvgpr_write_b32 a209, v27
  v_accvgpr_write_b32 a238, 0
  v_accvgpr_write_b32 a210, v27
  buffer_load_dwordx4 v227, s[8:11], s46 offen offset:3072 lds
  v_accvgpr_write_b32 a239, 0
  v_accvgpr_write_b32 a211, v27
  v_lshrrev_b32 v24, 3, v1
  v_and_b32 v25, 6, v24
  v_and_b32 v26, 7, v1
  v_xor_b32 v25, v25, v26
  v_lshlrev_b32 v25, 4, v25
  v_lshlrev_b32 v26, 2, v24
  s_add_u32 m0, s36, 38912
  s_nop 0
  buffer_load_dwordx4 v228, s[8:11], s46 offen offset:0 lds
  v_add_u32 v26, s3, v26
  v_lshl_add_u32 v26, v26, 11, v25
  v_add_u32 v27, 0, v26
  v_accvgpr_write_b32 a222, v27
  v_add_u32 v27, 64512, v26
  v_accvgpr_write_b32 a223, v27
  v_add_u32 v27, 129024, v26
  buffer_load_dwordx4 v229, s[8:11], s46 offen offset:1024 lds
  v_accvgpr_write_b32 a224, v27
  v_add_u32 v27, 193536, v26
  v_accvgpr_write_b32 a225, v27
  v_lshrrev_b32 v26, 2, v24
  v_and_b32 v27, 3, v24
  v_lshl_add_u32 v26, v26, 3, v27
  s_and_b32 s4, s3, 1
  s_lshl_b32 s4, s4, 18
  s_lshr_b32 s5, s3, 1
  s_lshl_b32 s5, s5, 7
  s_add_u32 s4, s4, s5
  s_lshl_b32 s5, s24, 8
  s_add_u32 s4, s4, s5
  v_lshl_add_u32 v26, v26, 13, v25
  v_add_u32 v26, s4, v26
  v_add_u32 v27, 0, v26
  buffer_load_dwordx4 v230, s[8:11], s46 offen offset:2048 lds
  v_accvgpr_write_b32 a226, v27
  v_add_u32 v27, 130048, v26
  v_accvgpr_write_b32 a227, v27
  v_add_u32 v27, 30720, v26
  v_accvgpr_write_b32 a228, v27
  v_add_u32 v27, 160768, v26
  v_accvgpr_write_b32 a229, v27
  s_lshl_b32 s4, s3, 13
  s_add_u32 s4, s4, 98304
  v_and_b32 v24, 15, v1
  buffer_load_dwordx4 v231, s[8:11], s46 offen offset:3072 lds
  v_lshlrev_b32 v24, 7, v24
  v_lshrrev_b32 v25, 4, v1
  v_and_b32 v26, 6, v1
  v_xor_b32 v25, v25, v26
  v_lshl_add_u32 v24, v25, 4, v24
  v_add_u32 v28, s4, v24
  v_xor_b32 v29, 64, v28
  v_lshrrev_b32 v24, 2, v1
  s_mul_i32 s47, s48, 393216
  s_bfe_u32 s34, 0x302010e, s49
  s_add_u32 s48, s48, s34
  s_add_u32 s49, s49, 8
  s_and_b32 s49, s49, 0x8001f
  s_and_b32 s48, s48, 15
  s_lshl_b32 s46, s48, 7
  s_add_u32 m0, s41, 24576
  s_nop 0
  buffer_load_dwordx4 v233, s[12:15], s47 offen offset:0 lds
  v_and_b32 v25, 6, v24
  v_lshlrev_b32 v24, 7, v24
  v_and_b32 v26, 1, v1
  v_lshl_add_u32 v24, v26, 3, v24
  v_add_u32 v24, 0, v24
  v_bfe_u32 v26, v1, 1, 1
  v_xor_b32 v25, v25, v26
  buffer_load_dwordx4 v234, s[12:15], s47 offen offset:1024 lds
  v_xor_b32 v26, 0, v25
  v_lshl_add_u32 v30, v26, 4, v24
  v_xor_b32 v26, 2, v25
  v_lshl_add_u32 v31, v26, 4, v24
  v_xor_b32 v26, 4, v25
  v_lshl_add_u32 v32, v26, 4, v24
  v_xor_b32 v26, 6, v25
  v_lshl_add_u32 v33, v26, 4, v24
  buffer_load_dwordx4 v235, s[12:15], s47 offen offset:2048 lds
  v_accvgpr_write_b32 a230, v28
  v_accvgpr_write_b32 a231, v29
  v_accvgpr_write_b32 a232, v30
  v_accvgpr_write_b32 a233, v31
  v_accvgpr_write_b32 a234, v32
  v_accvgpr_write_b32 a235, v33
  v_and_b32 v253, 15, v1
  s_add_u32 m0, s41, 27648
  s_nop 0
  buffer_load_dwordx4 v236, s[12:15], s47 offen offset:0 lds
  v_lshrrev_b32 v254, 4, v1
  v_lshlrev_b32 v254, 2, v254
  v_sub_u32 v253, v253, v254
  v_mov_b32 v254, 0xf149f2ca
  s_lshr_b32 s4, s3, 1
  s_or_b32 s4, s4, s32
  s_cselect_b64 s[6:7], 0, -1
  v_subrev_u32 v255, 0, v253
  v_and_b32 v252, 0x80000001, v255
  v_cmp_ne_u32 vcc, 0, v252
  s_nop 1
  v_cndmask_b32 v244, 0, v254, vcc
  v_add_u32 v255, 1, v255
  v_and_b32 v252, 0x80000001, v255
  v_cmp_ne_u32 vcc, 0x80000001, v252
  s_nop 1
  v_cndmask_b32 v240, 0, v254, vcc
  v_cndmask_b32 v248, v240, v254, s[6:7]
  buffer_load_dwordx4 v237, s[12:15], s47 offen offset:1024 lds
  v_subrev_u32 v255, 1, v253
  v_and_b32 v252, 0x80000001, v255
  v_cmp_ne_u32 vcc, 0, v252
  s_nop 1
  v_cndmask_b32 v245, 0, v254, vcc
  v_add_u32 v255, 1, v255
  v_and_b32 v252, 0x80000001, v255
  v_cmp_ne_u32 vcc, 0x80000001, v252
  s_nop 1
  v_cndmask_b32 v241, 0, v254, vcc
  v_cndmask_b32 v249, v241, v254, s[6:7]
  v_subrev_u32 v255, 2, v253
  v_and_b32 v252, 0x80000001, v255
  v_cmp_ne_u32 vcc, 0, v252
  s_nop 1
  v_cndmask_b32 v246, 0, v254, vcc
  buffer_load_dwordx4 v238, s[12:15], s47 offen offset:2048 lds
  v_add_u32 v255, 1, v255
  v_and_b32 v252, 0x80000001, v255
  v_cmp_ne_u32 vcc, 0x80000001, v252
  s_nop 1
  v_cndmask_b32 v242, 0, v254, vcc
  v_cndmask_b32 v250, v242, v254, s[6:7]
  v_subrev_u32 v255, 3, v253
  v_and_b32 v252, 0x80000001, v255
  v_cmp_ne_u32 vcc, 0, v252
  s_nop 1
  v_cndmask_b32 v247, 0, v254, vcc
  v_add_u32 v255, 1, v255
  v_and_b32 v252, 0x80000001, v255
  v_cmp_ne_u32 vcc, 0x80000001, v252
  s_nop 1
  v_cndmask_b32 v243, 0, v254, vcc
  v_cndmask_b32 v251, v243, v254, s[6:7]
  s_and_b32 s4, s3, 1
  s_lshl_b32 s4, s4, 12
  s_add_u32 s4, s4, 49152
  v_add_u32 v252, s4, v2
  s_lshr_b32 s5, s3, 1
  s_lshl_b32 s5, s5, 11
  v_add_u32 v253, s5, v252
  s_add_u32 s16, s86, 83886080
  s_addc_u32 s17, s87, 0
  s_mov_b32 s18, 4194304
  s_mov_b32 s19, 0x00020000
  s_lshl_b32 s57, s32, 19
  s_lshl_b32 s5, s5, 7
  s_add_u32 s57, s57, s5
  s_lshl_b32 s4, s33, 14
  s_add_u32 s57, s57, s4
  s_and_b32 s4, s3, 1
  s_lshl_b32 s4, s4, 13
  s_add_u32 s57, s57, s4
  s_add_u32 s58, s57, 4096
  s_mov_b32 s37, 0
  s_mov_b32 s39, 4294897664
  s_mov_b32 s40, 34816
  s_mov_b32 s42, 0
  s_mov_b32 s44, 4294942720
  s_mov_b32 s45, 24576
  s_mov_b32 s43, s44
  s_mov_b32 s52, s72
  s_mov_b32 s53, s73
  s_mov_b32 s54, 4194304
  s_mov_b32 s55, 0x00020000
  s_lshl_b32 s1, s51, 1
  s_mov_b32 s56, s51
  s_mov_b32 s0, 0
  s_waitcnt vmcnt(14)
  s_barrier
  ds_read_b128 a[0:3], v16 offset:0
  ds_read_b64_tr_b16 a[72:73], v20 offset:0
  ds_read_b64_tr_b16 a[74:75], v20 offset:2048
  ds_read_b128 a[4:7], v16 offset:2048
  ds_read_b128 a[8:11], v16 offset:4096
  ds_read_b128 a[12:15], v16 offset:6144
  ds_read_b128 a[16:19], v16 offset:8192
  ds_read_b128 a[20:23], v16 offset:10240
  ds_read_b128 a[24:27], v16 offset:12288
  ds_read_b128 a[28:31], v16 offset:14336
  ds_read_b64_tr_b16 a[76:77], v21 offset:0
  ds_read_b64_tr_b16 a[78:79], v21 offset:2048
  ds_read_b64_tr_b16 a[80:81], v20 offset:8192
  ds_read_b64_tr_b16 a[82:83], v20 offset:10240
  ds_read_b64_tr_b16 a[84:85], v21 offset:8192
  ds_read_b64_tr_b16 a[86:87], v21 offset:10240
  ds_read_b64_tr_b16 a[88:89], v20 offset:16384
  ds_read_b64_tr_b16 a[90:91], v20 offset:18432
  ds_read_b128 a[32:35], v18 offset:0
  ds_read_b64_tr_b16 a[92:93], v21 offset:16384
  ds_read_b64_tr_b16 a[94:95], v21 offset:18432
  s_waitcnt lgkmcnt(0)
  v_mfma_f32_16x16x32_bf16 v[24:27], a[72:75], a[0:3], 0
  s_add_u32 m0, s36, 69632
  ds_read_b128 a[36:39], v17 offset:0
  v_mfma_f32_16x16x32_bf16 v[28:31], a[72:75], a[4:7], 0
  buffer_load_dwordx4 v224, s[8:11], s46 offen offset:0 lds
  ds_read_b64_tr_b16 a[96:97], v20 offset:4096
  v_mfma_f32_16x16x32_bf16 v[32:35], a[72:75], a[8:11], 0
  v_mfma_f32_16x16x32_bf16 v[36:39], a[72:75], a[12:15], 0
  ds_read_b64_tr_b16 a[98:99], v20 offset:6144
  v_mfma_f32_16x16x32_bf16 v[40:43], a[72:75], a[16:19], 0
  v_mfma_f32_16x16x32_bf16 v[44:47], a[72:75], a[20:23], 0
  buffer_load_dwordx4 v225, s[8:11], s46 offen offset:1024 lds
  ds_read_b128 a[40:43], v17 offset:2048
  v_mfma_f32_16x16x32_bf16 v[48:51], a[72:75], a[24:27], 0
  v_mfma_f32_16x16x32_bf16 v[52:55], a[72:75], a[28:31], 0
  ds_read_b128 a[44:47], v17 offset:4096
  v_mfma_f32_16x16x32_bf16 v[56:59], a[76:79], a[0:3], 0
  v_mfma_f32_16x16x32_bf16 v[60:63], a[76:79], a[4:7], 0
  ds_read_b128 a[48:51], v17 offset:6144
  v_mfma_f32_16x16x32_bf16 v[64:67], a[76:79], a[8:11], 0
  buffer_load_dwordx4 v226, s[8:11], s46 offen offset:2048 lds
  v_mfma_f32_16x16x32_bf16 v[68:71], a[76:79], a[12:15], 0
  ds_read_b128 a[52:55], v17 offset:8192
  v_mfma_f32_16x16x32_bf16 v[72:75], a[76:79], a[16:19], 0
  v_mfma_f32_16x16x32_bf16 v[76:79], a[76:79], a[20:23], 0
  ds_read_b128 a[56:59], v17 offset:10240
  v_mfma_f32_16x16x32_bf16 v[80:83], a[76:79], a[24:27], 0
  v_mfma_f32_16x16x32_bf16 v[84:87], a[76:79], a[28:31], 0
  ds_read_b128 a[60:63], v17 offset:12288
  v_mfma_f32_16x16x32_bf16 v[88:91], a[80:83], a[0:3], 0
  buffer_load_dwordx4 v227, s[8:11], s46 offen offset:3072 lds
  v_mfma_f32_16x16x32_bf16 v[92:95], a[80:83], a[4:7], 0
  s_add_u32 m0, s36, 73728
  ds_read_b128 a[64:67], v17 offset:14336
  v_mfma_f32_16x16x32_bf16 v[96:99], a[80:83], a[8:11], 0
  v_mfma_f32_16x16x32_bf16 v[100:103], a[80:83], a[12:15], 0
  ds_read_b64_tr_b16 a[100:101], v21 offset:4096
  v_mfma_f32_16x16x32_bf16 v[104:107], a[80:83], a[16:19], 0
  ds_read_b64_tr_b16 a[102:103], v21 offset:6144
  v_mfma_f32_16x16x32_bf16 v[108:111], a[80:83], a[20:23], 0
  buffer_load_dwordx4 v228, s[8:11], s46 offen offset:0 lds
  v_mfma_f32_16x16x32_bf16 v[112:115], a[80:83], a[24:27], 0
  ds_read_b64_tr_b16 a[104:105], v20 offset:12288
  v_mfma_f32_16x16x32_bf16 v[116:119], a[80:83], a[28:31], 0
  v_mfma_f32_16x16x32_bf16 v[120:123], a[84:87], a[0:3], 0
  ds_read_b64_tr_b16 a[106:107], v20 offset:14336
  v_mfma_f32_16x16x32_bf16 v[124:127], a[84:87], a[4:7], 0
  v_mfma_f32_16x16x32_bf16 v[128:131], a[84:87], a[8:11], 0
  buffer_load_dwordx4 v229, s[8:11], s46 offen offset:1024 lds
  ds_read_b64_tr_b16 a[108:109], v21 offset:12288
  v_mfma_f32_16x16x32_bf16 v[132:135], a[84:87], a[12:15], 0
  v_mfma_f32_16x16x32_bf16 v[136:139], a[84:87], a[16:19], 0
  ds_read_b64_tr_b16 a[110:111], v21 offset:14336
  v_mfma_f32_16x16x32_bf16 v[140:143], a[84:87], a[20:23], 0
  v_mfma_f32_16x16x32_bf16 v[144:147], a[84:87], a[24:27], 0
  ds_read_b64_tr_b16 a[112:113], v20 offset:20480
  v_mfma_f32_16x16x32_bf16 v[148:151], a[84:87], a[28:31], 0
  v_mfma_f32_16x16x32_bf16 v[152:155], a[0:3], a[88:91], 0
  buffer_load_dwordx4 v230, s[8:11], s46 offen offset:2048 lds
  ds_read_b64_tr_b16 a[114:115], v20 offset:22528
  v_mfma_f32_16x16x32_bf16 v[156:159], a[4:7], a[88:91], 0
  v_mfma_f32_16x16x32_bf16 v[160:163], a[8:11], a[88:91], 0
  ds_read_b128 a[68:71], v19 offset:0
  v_mfma_f32_16x16x32_bf16 v[164:167], a[12:15], a[88:91], 0
  v_mfma_f32_16x16x32_bf16 v[168:171], a[16:19], a[88:91], 0
  ds_read_b64_tr_b16 a[116:117], v21 offset:20480
  v_mfma_f32_16x16x32_bf16 v[172:175], a[20:23], a[88:91], 0
  buffer_load_dwordx4 v231, s[8:11], s46 offen offset:3072 lds
  v_mfma_f32_16x16x32_bf16 v[176:179], a[24:27], a[88:91], 0
  s_mul_i32 s47, s48, 393216
  s_bfe_u32 s34, 0x302010e, s49
  s_add_u32 s48, s48, s34
  v_mfma_f32_16x16x32_bf16 v[180:183], a[28:31], a[88:91], 0
  s_add_u32 s49, s49, 8
  s_and_b32 s49, s49, 0x8001f
  s_and_b32 s48, s48, 15
  v_mfma_f32_16x16x32_bf16 v[216:219], a[32:35], a[88:91], 0
  s_lshl_b32 s46, s48, 7
  ds_read_b64_tr_b16 a[118:119], v21 offset:22528
  v_mfma_f32_16x16x32_bf16 v[184:187], a[0:3], a[92:95], 0
  s_add_u32 s37, s37, 1
  s_cmp_eq_u32 s37, 3
  s_cselect_b32 s37, 0, s37
  s_cselect_b32 s38, s39, s40
  v_mfma_f32_16x16x32_bf16 v[188:191], a[4:7], a[92:95], 0
  s_sub_u32 s43, 0, s43
  v_mfma_f32_16x16x32_bf16 v[192:195], a[8:11], a[92:95], 0
  v_add_u32 v16, s38, v16
  v_add_u32 v17, s38, v17
  v_mfma_f32_16x16x32_bf16 v[196:199], a[12:15], a[92:95], 0
  v_add_u32 v18, s38, v18
  v_add_u32 v19, s38, v19
  v_mfma_f32_16x16x32_bf16 v[200:203], a[16:19], a[92:95], 0
  v_add_u32 v20, s43, v20
  v_add_u32 v21, s43, v21
  v_mfma_f32_16x16x32_bf16 v[204:207], a[20:23], a[92:95], 0
  v_mfma_f32_16x16x32_bf16 v[208:211], a[24:27], a[92:95], 0
  v_mfma_f32_16x16x32_bf16 v[212:215], a[28:31], a[92:95], 0
  v_mfma_f32_16x16x32_bf16 v[220:223], a[32:35], a[92:95], 0
  s_mov_b32 s35, 13
  s_waitcnt vmcnt(8) lgkmcnt(0)
  s_barrier
  .p2align 6
Lp2r1_loop:
  v_mfma_f32_16x16x32_bf16 v[24:27], a[96:99], a[36:39], v[24:27]
  buffer_load_dwordx4 a[192:195], v2, s[52:55], s51 offen offset:0
  ds_read_b128 a[0:3], v16 offset:0
  v_mfma_f32_16x16x32_bf16 v[28:31], a[96:99], a[40:43], v[28:31]
  ds_read_b64_tr_b16 a[72:73], v20 offset:0
  v_mfma_f32_16x16x32_bf16 v[32:35], a[96:99], a[44:47], v[32:35]
  v_mfma_f32_16x16x32_bf16 v[36:39], a[96:99], a[48:51], v[36:39]
  ds_read_b64_tr_b16 a[74:75], v20 offset:2048
  v_mfma_f32_16x16x32_bf16 v[40:43], a[96:99], a[52:55], v[40:43]
  v_mfma_f32_16x16x32_bf16 v[44:47], a[96:99], a[56:59], v[44:47]
  buffer_load_dwordx4 a[192:195], v2, s[52:55], s51 offen offset:1024
  ds_read_b128 a[4:7], v16 offset:2048
  v_mfma_f32_16x16x32_bf16 v[48:51], a[96:99], a[60:63], v[48:51]
  v_mfma_f32_16x16x32_bf16 v[52:55], a[96:99], a[64:67], v[52:55]
  ds_read_b128 a[8:11], v16 offset:4096
  v_mfma_f32_16x16x32_bf16 v[56:59], a[100:103], a[36:39], v[56:59]
  v_mfma_f32_16x16x32_bf16 v[60:63], a[100:103], a[40:43], v[60:63]
  ds_read_b128 a[12:15], v16 offset:6144
  v_mfma_f32_16x16x32_bf16 v[64:67], a[100:103], a[44:47], v[64:67]
  buffer_load_dwordx4 a[192:195], v2, s[52:55], s51 offen offset:2048
  v_mfma_f32_16x16x32_bf16 v[68:71], a[100:103], a[48:51], v[68:71]
  ds_read_b128 a[16:19], v16 offset:8192
  v_mfma_f32_16x16x32_bf16 v[72:75], a[100:103], a[52:55], v[72:75]
  v_mfma_f32_16x16x32_bf16 v[76:79], a[100:103], a[56:59], v[76:79]
  ds_read_b128 a[20:23], v16 offset:10240
  v_mfma_f32_16x16x32_bf16 v[80:83], a[100:103], a[60:63], v[80:83]
  v_mfma_f32_16x16x32_bf16 v[84:87], a[100:103], a[64:67], v[84:87]
  ds_read_b128 a[24:27], v16 offset:12288
  v_mfma_f32_16x16x32_bf16 v[88:91], a[104:107], a[36:39], v[88:91]
  buffer_load_dwordx4 a[192:195], v2, s[52:55], s51 offen offset:3072
  v_mfma_f32_16x16x32_bf16 v[92:95], a[104:107], a[40:43], v[92:95]
  s_add_u32 s51, s51, 4096
  s_add_u32 s0, s0, 1
  s_cmp_eq_u32 s0, 2
  s_cselect_b32 s52, s68, s52
  s_cselect_b32 s53, s69, s53
  s_cselect_b32 s51, s1, s51
  s_cselect_b32 s54, 0, s54
  v_mfma_f32_16x16x32_bf16 v[96:99], a[104:107], a[44:47], v[96:99]
  s_cmp_eq_u32 s0, 6
  s_cselect_b32 s52, s64, s52
  s_cselect_b32 s53, s65, s53
  s_cselect_b32 s51, s56, s51
  s_cselect_b32 s54, 0, s54
  v_mfma_f32_16x16x32_bf16 v[100:103], a[104:107], a[48:51], v[100:103]
  s_cmp_eq_u32 s0, 8
  s_cselect_b32 s54, 0, s54
  s_mov_b32 m0, s41
  v_mfma_f32_16x16x32_bf16 v[104:107], a[104:107], a[52:55], v[104:107]
  ds_read_b128 a[28:31], v16 offset:14336
  ds_read_b64_tr_b16 a[76:77], v21 offset:0
  v_mfma_f32_16x16x32_bf16 v[108:111], a[104:107], a[56:59], v[108:111]
  buffer_load_dwordx4 v233, s[12:15], s47 offen offset:0 lds
  ds_read_b64_tr_b16 a[78:79], v21 offset:2048
  v_mfma_f32_16x16x32_bf16 v[112:115], a[104:107], a[60:63], v[112:115]
  ds_read_b64_tr_b16 a[80:81], v20 offset:8192
  v_mfma_f32_16x16x32_bf16 v[116:119], a[104:107], a[64:67], v[116:119]
  v_mfma_f32_16x16x32_bf16 v[120:123], a[108:111], a[36:39], v[120:123]
  ds_read_b64_tr_b16 a[82:83], v20 offset:10240
  v_mfma_f32_16x16x32_bf16 v[124:127], a[108:111], a[40:43], v[124:127]
  v_mfma_f32_16x16x32_bf16 v[128:131], a[108:111], a[44:47], v[128:131]
  ds_read_b64_tr_b16 a[84:85], v21 offset:8192
  v_mfma_f32_16x16x32_bf16 v[132:135], a[108:111], a[48:51], v[132:135]
  buffer_load_dwordx4 v234, s[12:15], s47 offen offset:1024 lds
  v_mfma_f32_16x16x32_bf16 v[136:139], a[108:111], a[52:55], v[136:139]
  ds_read_b64_tr_b16 a[86:87], v21 offset:10240
  v_mfma_f32_16x16x32_bf16 v[140:143], a[108:111], a[56:59], v[140:143]
  v_mfma_f32_16x16x32_bf16 v[144:147], a[108:111], a[60:63], v[144:147]
  ds_read_b64_tr_b16 a[88:89], v20 offset:16384
  v_mfma_f32_16x16x32_bf16 v[148:151], a[108:111], a[64:67], v[148:151]
  v_mfma_f32_16x16x32_bf16 v[152:155], a[36:39], a[112:115], v[152:155]
  buffer_load_dwordx4 v235, s[12:15], s47 offen offset:2048 lds
  ds_read_b64_tr_b16 a[90:91], v20 offset:18432
  v_mfma_f32_16x16x32_bf16 v[156:159], a[40:43], a[112:115], v[156:159]
  s_add_u32 m0, s41, 3072
  v_mfma_f32_16x16x32_bf16 v[160:163], a[44:47], a[112:115], v[160:163]
  ds_read_b128 a[32:35], v18 offset:0
  v_mfma_f32_16x16x32_bf16 v[164:167], a[48:51], a[112:115], v[164:167]
  v_mfma_f32_16x16x32_bf16 v[168:171], a[52:55], a[112:115], v[168:171]
  ds_read_b64_tr_b16 a[92:93], v21 offset:16384
  v_mfma_f32_16x16x32_bf16 v[172:175], a[56:59], a[112:115], v[172:175]
  v_mfma_f32_16x16x32_bf16 v[176:179], a[60:63], a[112:115], v[176:179]
  buffer_load_dwordx4 v236, s[12:15], s47 offen offset:0 lds
  ds_read_b64_tr_b16 a[94:95], v21 offset:18432
  v_mfma_f32_16x16x32_bf16 v[180:183], a[64:67], a[112:115], v[180:183]
  v_mfma_f32_16x16x32_bf16 v[216:219], a[68:71], a[112:115], v[216:219]
  v_mfma_f32_16x16x32_bf16 v[184:187], a[36:39], a[116:119], v[184:187]
  v_mfma_f32_16x16x32_bf16 v[188:191], a[40:43], a[116:119], v[188:191]
  v_mfma_f32_16x16x32_bf16 v[192:195], a[44:47], a[116:119], v[192:195]
  buffer_load_dwordx4 v237, s[12:15], s47 offen offset:1024 lds
  v_mfma_f32_16x16x32_bf16 v[196:199], a[48:51], a[116:119], v[196:199]
  v_mfma_f32_16x16x32_bf16 v[200:203], a[52:55], a[116:119], v[200:203]
  v_mfma_f32_16x16x32_bf16 v[204:207], a[56:59], a[116:119], v[204:207]
  v_mfma_f32_16x16x32_bf16 v[208:211], a[60:63], a[116:119], v[208:211]
  v_mfma_f32_16x16x32_bf16 v[212:215], a[64:67], a[116:119], v[212:215]
  v_mfma_f32_16x16x32_bf16 v[220:223], a[68:71], a[116:119], v[220:223]
  s_waitcnt lgkmcnt(0)
  v_mfma_f32_16x16x32_bf16 v[24:27], a[72:75], a[0:3], v[24:27]
  buffer_load_dwordx4 v238, s[12:15], s47 offen offset:2048 lds
  ds_read_b128 a[36:39], v17 offset:0
  v_mfma_f32_16x16x32_bf16 v[28:31], a[72:75], a[4:7], v[28:31]
  s_mov_b32 m0, s36
  ds_read_b64_tr_b16 a[96:97], v20 offset:4096
  v_mfma_f32_16x16x32_bf16 v[32:35], a[72:75], a[8:11], v[32:35]
  v_mfma_f32_16x16x32_bf16 v[36:39], a[72:75], a[12:15], v[36:39]
  ds_read_b64_tr_b16 a[98:99], v20 offset:6144
  v_mfma_f32_16x16x32_bf16 v[40:43], a[72:75], a[16:19], v[40:43]
  buffer_load_dwordx4 v224, s[8:11], s46 offen offset:0 lds
  v_mfma_f32_16x16x32_bf16 v[44:47], a[72:75], a[20:23], v[44:47]
  ds_read_b128 a[40:43], v17 offset:2048
  v_mfma_f32_16x16x32_bf16 v[48:51], a[72:75], a[24:27], v[48:51]
  v_mfma_f32_16x16x32_bf16 v[52:55], a[72:75], a[28:31], v[52:55]
  ds_read_b128 a[44:47], v17 offset:4096
  v_mfma_f32_16x16x32_bf16 v[56:59], a[76:79], a[0:3], v[56:59]
  v_mfma_f32_16x16x32_bf16 v[60:63], a[76:79], a[4:7], v[60:63]
  buffer_load_dwordx4 v225, s[8:11], s46 offen offset:1024 lds
  ds_read_b128 a[48:51], v17 offset:6144
  v_mfma_f32_16x16x32_bf16 v[64:67], a[76:79], a[8:11], v[64:67]
  v_mfma_f32_16x16x32_bf16 v[68:71], a[76:79], a[12:15], v[68:71]
  ds_read_b128 a[52:55], v17 offset:8192
  v_mfma_f32_16x16x32_bf16 v[72:75], a[76:79], a[16:19], v[72:75]
  v_mfma_f32_16x16x32_bf16 v[76:79], a[76:79], a[20:23], v[76:79]
  ds_read_b128 a[56:59], v17 offset:10240
  v_mfma_f32_16x16x32_bf16 v[80:83], a[76:79], a[24:27], v[80:83]
  buffer_load_dwordx4 v226, s[8:11], s46 offen offset:2048 lds
  v_mfma_f32_16x16x32_bf16 v[84:87], a[76:79], a[28:31], v[84:87]
  ds_read_b128 a[60:63], v17 offset:12288
  v_mfma_f32_16x16x32_bf16 v[88:91], a[80:83], a[0:3], v[88:91]
  v_mfma_f32_16x16x32_bf16 v[92:95], a[80:83], a[4:7], v[92:95]
  ds_read_b128 a[64:67], v17 offset:14336
  v_mfma_f32_16x16x32_bf16 v[96:99], a[80:83], a[8:11], v[96:99]
  v_mfma_f32_16x16x32_bf16 v[100:103], a[80:83], a[12:15], v[100:103]
  buffer_load_dwordx4 v227, s[8:11], s46 offen offset:3072 lds
  ds_read_b64_tr_b16 a[100:101], v21 offset:4096
  v_mfma_f32_16x16x32_bf16 v[104:107], a[80:83], a[16:19], v[104:107]
  s_add_u32 m0, s36, 4096
  ds_read_b64_tr_b16 a[102:103], v21 offset:6144
  v_mfma_f32_16x16x32_bf16 v[108:111], a[80:83], a[20:23], v[108:111]
  v_mfma_f32_16x16x32_bf16 v[112:115], a[80:83], a[24:27], v[112:115]
  ds_read_b64_tr_b16 a[104:105], v20 offset:12288
  v_mfma_f32_16x16x32_bf16 v[116:119], a[80:83], a[28:31], v[116:119]
  buffer_load_dwordx4 v228, s[8:11], s46 offen offset:0 lds
  v_mfma_f32_16x16x32_bf16 v[120:123], a[84:87], a[0:3], v[120:123]
  ds_read_b64_tr_b16 a[106:107], v20 offset:14336
  v_mfma_f32_16x16x32_bf16 v[124:127], a[84:87], a[4:7], v[124:127]
  v_mfma_f32_16x16x32_bf16 v[128:131], a[84:87], a[8:11], v[128:131]
  ds_read_b64_tr_b16 a[108:109], v21 offset:12288
  v_mfma_f32_16x16x32_bf16 v[132:135], a[84:87], a[12:15], v[132:135]
  v_mfma_f32_16x16x32_bf16 v[136:139], a[84:87], a[16:19], v[136:139]
  buffer_load_dwordx4 v229, s[8:11], s46 offen offset:1024 lds
  ds_read_b64_tr_b16 a[110:111], v21 offset:14336
  v_mfma_f32_16x16x32_bf16 v[140:143], a[84:87], a[20:23], v[140:143]
  v_mfma_f32_16x16x32_bf16 v[144:147], a[84:87], a[24:27], v[144:147]
  ds_read_b64_tr_b16 a[112:113], v20 offset:20480
  v_mfma_f32_16x16x32_bf16 v[148:151], a[84:87], a[28:31], v[148:151]
  v_mfma_f32_16x16x32_bf16 v[152:155], a[0:3], a[88:91], v[152:155]
  ds_read_b64_tr_b16 a[114:115], v20 offset:22528
  v_mfma_f32_16x16x32_bf16 v[156:159], a[4:7], a[88:91], v[156:159]
  buffer_load_dwordx4 v230, s[8:11], s46 offen offset:2048 lds
  v_mfma_f32_16x16x32_bf16 v[160:163], a[8:11], a[88:91], v[160:163]
  ds_read_b128 a[68:71], v19 offset:0
  v_mfma_f32_16x16x32_bf16 v[164:167], a[12:15], a[88:91], v[164:167]
  v_mfma_f32_16x16x32_bf16 v[168:171], a[16:19], a[88:91], v[168:171]
  ds_read_b64_tr_b16 a[116:117], v21 offset:20480
  v_mfma_f32_16x16x32_bf16 v[172:175], a[20:23], a[88:91], v[172:175]
  v_mfma_f32_16x16x32_bf16 v[176:179], a[24:27], a[88:91], v[176:179]
  buffer_load_dwordx4 v231, s[8:11], s46 offen offset:3072 lds
  ds_read_b64_tr_b16 a[118:119], v21 offset:22528
  v_mfma_f32_16x16x32_bf16 v[180:183], a[28:31], a[88:91], v[180:183]
  s_mul_i32 s47, s48, 393216
  s_bfe_u32 s34, 0x302010e, s49
  s_add_u32 s48, s48, s34
  v_mfma_f32_16x16x32_bf16 v[216:219], a[32:35], a[88:91], v[216:219]
  s_add_u32 s49, s49, 8
  s_and_b32 s49, s49, 0x8001f
  s_and_b32 s48, s48, 15
  v_mfma_f32_16x16x32_bf16 v[184:187], a[0:3], a[92:95], v[184:187]
  s_lshl_b32 s46, s48, 7
  v_mfma_f32_16x16x32_bf16 v[188:191], a[4:7], a[92:95], v[188:191]
  s_add_u32 s36, s36, s38
  s_add_u32 s37, s37, 1
  s_cmp_eq_u32 s37, 3
  s_cselect_b32 s37, 0, s37
  s_cselect_b32 s38, s39, s40
  v_mfma_f32_16x16x32_bf16 v[192:195], a[8:11], a[92:95], v[192:195]
  s_add_u32 s41, s41, s43
  s_sub_u32 s43, 0, s43
  v_mfma_f32_16x16x32_bf16 v[196:199], a[12:15], a[92:95], v[196:199]
  v_add_u32 v16, s38, v16
  v_add_u32 v17, s38, v17
  v_mfma_f32_16x16x32_bf16 v[200:203], a[16:19], a[92:95], v[200:203]
  v_add_u32 v18, s38, v18
  v_add_u32 v19, s38, v19
  v_mfma_f32_16x16x32_bf16 v[204:207], a[20:23], a[92:95], v[204:207]
  v_add_u32 v20, s43, v20
  v_add_u32 v21, s43, v21
  v_mfma_f32_16x16x32_bf16 v[208:211], a[24:27], a[92:95], v[208:211]
  s_waitcnt vmcnt(8) lgkmcnt(0)
  s_barrier
  v_mfma_f32_16x16x32_bf16 v[212:215], a[28:31], a[92:95], v[212:215]
  s_sub_u32 s35, s35, 1
  v_mfma_f32_16x16x32_bf16 v[220:223], a[32:35], a[92:95], v[220:223]
  s_cmp_lg_u32 s35, 0
  s_cbranch_scc1 Lp2r1_loop
  v_accvgpr_read_b32 v4, a222
  v_accvgpr_read_b32 v5, a223
  v_accvgpr_read_b32 v6, a224
  v_accvgpr_read_b32 v7, a225
  v_accvgpr_read_b32 v8, a226
  v_accvgpr_read_b32 v9, a227
  v_accvgpr_read_b32 v10, a228
  v_accvgpr_read_b32 v11, a229
  s_mov_b32 s8, s64
  s_mov_b32 s9, s65
  s_mov_b32 s10, 4194304
  s_mov_b32 s11, 0x00020000
  s_mov_b32 s20, s68
  s_mov_b32 s21, s69
  s_mov_b32 s22, 8388608
  s_mov_b32 s23, 0x00020000
  s_and_b32 s4, s2, 7
  s_lshl_b32 s4, s4, 1
  s_lshr_b32 s5, s2, 6
  s_lshr_b32 s30, s2, 4
  s_add_u32 s5, s5, s30
  s_and_b32 s53, s5, 3
  s_lshl_b32 s53, s53, 3
  s_or_b32 s53, s53, 0x80000
  s_bfe_u32 s52, 0xf0f02, s53
  s_add_u32 s52, s52, s4
  s_and_b32 s52, s52, 15
  s_mov_b32 s54, s52
  s_mov_b32 s55, s53
  s_lshl_b32 s29, s52, 7
  s_lshl_b32 s28, s54, 19
  s_lshl_b32 s30, s25, 18
  s_and_b32 s31, s25, 1
  s_lshl_b32 s31, s31, 1
  s_add_u32 s31, s31, 14
  s_sub_u32 s31, s31, s25
  s_lshl_b32 s31, s31, 18
  s_or_b32 s26, s30, s29
  s_or_b32 s27, s31, s29
  s_lshl_b32 s68, s3, 12
  s_lshl_b32 s88, s3, 13
  s_add_u32 s88, s88, 98304
  v_mfma_f32_16x16x32_bf16 v[24:27], a[96:99], a[36:39], v[24:27]
  s_mov_b32 m0, s41
  ds_read_b128 a[0:3], v16 offset:0
  v_mfma_f32_16x16x32_bf16 v[28:31], a[96:99], a[40:43], v[28:31]
  buffer_load_dwordx4 v233, s[12:15], s47 offen offset:0 lds
  ds_read_b64_tr_b16 a[72:73], v20 offset:0
  v_mfma_f32_16x16x32_bf16 v[32:35], a[96:99], a[44:47], v[32:35]
  v_mfma_f32_16x16x32_bf16 v[36:39], a[96:99], a[48:51], v[36:39]
  ds_read_b64_tr_b16 a[74:75], v20 offset:2048
  v_mfma_f32_16x16x32_bf16 v[40:43], a[96:99], a[52:55], v[40:43]
  v_mfma_f32_16x16x32_bf16 v[44:47], a[96:99], a[56:59], v[44:47]
  ds_read_b128 a[4:7], v16 offset:2048
  v_mfma_f32_16x16x32_bf16 v[48:51], a[96:99], a[60:63], v[48:51]
  v_mfma_f32_16x16x32_bf16 v[52:55], a[96:99], a[64:67], v[52:55]
  ds_read_b128 a[8:11], v16 offset:4096
  v_mfma_f32_16x16x32_bf16 v[56:59], a[100:103], a[36:39], v[56:59]
  v_mfma_f32_16x16x32_bf16 v[60:63], a[100:103], a[40:43], v[60:63]
  ds_read_b128 a[12:15], v16 offset:6144
  v_mfma_f32_16x16x32_bf16 v[64:67], a[100:103], a[44:47], v[64:67]
  v_mfma_f32_16x16x32_bf16 v[68:71], a[100:103], a[48:51], v[68:71]
  ds_read_b128 a[16:19], v16 offset:8192
  v_mfma_f32_16x16x32_bf16 v[72:75], a[100:103], a[52:55], v[72:75]
  v_mfma_f32_16x16x32_bf16 v[76:79], a[100:103], a[56:59], v[76:79]
  ds_read_b128 a[20:23], v16 offset:10240
  v_mfma_f32_16x16x32_bf16 v[80:83], a[100:103], a[60:63], v[80:83]
  v_mfma_f32_16x16x32_bf16 v[84:87], a[100:103], a[64:67], v[84:87]
  ds_read_b128 a[24:27], v16 offset:12288
  v_mfma_f32_16x16x32_bf16 v[88:91], a[104:107], a[36:39], v[88:91]
  buffer_load_dwordx4 v234, s[12:15], s47 offen offset:1024 lds
  v_mfma_f32_16x16x32_bf16 v[92:95], a[104:107], a[40:43], v[92:95]
  ds_read_b128 a[28:31], v16 offset:14336
  v_mfma_f32_16x16x32_bf16 v[96:99], a[104:107], a[44:47], v[96:99]
  v_mfma_f32_16x16x32_bf16 v[100:103], a[104:107], a[48:51], v[100:103]
  ds_read_b64_tr_b16 a[76:77], v21 offset:0
  v_mfma_f32_16x16x32_bf16 v[104:107], a[104:107], a[52:55], v[104:107]
  ds_read_b64_tr_b16 a[78:79], v21 offset:2048
  v_mfma_f32_16x16x32_bf16 v[108:111], a[104:107], a[56:59], v[108:111]
  v_mfma_f32_16x16x32_bf16 v[112:115], a[104:107], a[60:63], v[112:115]
  ds_read_b64_tr_b16 a[80:81], v20 offset:8192
  v_mfma_f32_16x16x32_bf16 v[116:119], a[104:107], a[64:67], v[116:119]
  v_mfma_f32_16x16x32_bf16 v[120:123], a[108:111], a[36:39], v[120:123]
  ds_read_b64_tr_b16 a[82:83], v20 offset:10240
  v_mfma_f32_16x16x32_bf16 v[124:127], a[108:111], a[40:43], v[124:127]
  v_mfma_f32_16x16x32_bf16 v[128:131], a[108:111], a[44:47], v[128:131]
  ds_read_b64_tr_b16 a[84:85], v21 offset:8192
  v_mfma_f32_16x16x32_bf16 v[132:135], a[108:111], a[48:51], v[132:135]
  v_mfma_f32_16x16x32_bf16 v[136:139], a[108:111], a[52:55], v[136:139]
  ds_read_b64_tr_b16 a[86:87], v21 offset:10240
  v_mfma_f32_16x16x32_bf16 v[140:143], a[108:111], a[56:59], v[140:143]
  v_mfma_f32_16x16x32_bf16 v[144:147], a[108:111], a[60:63], v[144:147]
  ds_read_b64_tr_b16 a[88:89], v20 offset:16384
  v_mfma_f32_16x16x32_bf16 v[148:151], a[108:111], a[64:67], v[148:151]
  v_mfma_f32_16x16x32_bf16 v[152:155], a[36:39], a[112:115], v[152:155]
  buffer_load_dwordx4 v235, s[12:15], s47 offen offset:2048 lds
  ds_read_b64_tr_b16 a[90:91], v20 offset:18432
  v_mfma_f32_16x16x32_bf16 v[156:159], a[40:43], a[112:115], v[156:159]
  v_mfma_f32_16x16x32_bf16 v[160:163], a[44:47], a[112:115], v[160:163]
  ds_read_b128 a[32:35], v18 offset:0
  v_mfma_f32_16x16x32_bf16 v[164:167], a[48:51], a[112:115], v[164:167]
  v_mfma_f32_16x16x32_bf16 v[168:171], a[52:55], a[112:115], v[168:171]
  ds_read_b64_tr_b16 a[92:93], v21 offset:16384
  v_mfma_f32_16x16x32_bf16 v[172:175], a[56:59], a[112:115], v[172:175]
  v_mfma_f32_16x16x32_bf16 v[176:179], a[60:63], a[112:115], v[176:179]
  ds_read_b64_tr_b16 a[94:95], v21 offset:18432
  v_mfma_f32_16x16x32_bf16 v[180:183], a[64:67], a[112:115], v[180:183]
  v_mfma_f32_16x16x32_bf16 v[216:219], a[68:71], a[112:115], v[216:219]
  v_mfma_f32_16x16x32_bf16 v[184:187], a[36:39], a[116:119], v[184:187]
  v_mfma_f32_16x16x32_bf16 v[188:191], a[40:43], a[116:119], v[188:191]
  v_mfma_f32_16x16x32_bf16 v[192:195], a[44:47], a[116:119], v[192:195]
  v_mfma_f32_16x16x32_bf16 v[196:199], a[48:51], a[116:119], v[196:199]
  v_mfma_f32_16x16x32_bf16 v[200:203], a[52:55], a[116:119], v[200:203]
  v_mfma_f32_16x16x32_bf16 v[204:207], a[56:59], a[116:119], v[204:207]
  v_mfma_f32_16x16x32_bf16 v[208:211], a[60:63], a[116:119], v[208:211]
  v_mfma_f32_16x16x32_bf16 v[212:215], a[64:67], a[116:119], v[212:215]
  v_mfma_f32_16x16x32_bf16 v[220:223], a[68:71], a[116:119], v[220:223]
  s_waitcnt lgkmcnt(0)
  v_mfma_f32_16x16x32_bf16 v[24:27], a[72:75], a[0:3], v[24:27]
  s_add_u32 m0, s41, 3072
  ds_read_b128 a[36:39], v17 offset:0
  v_mfma_f32_16x16x32_bf16 v[28:31], a[72:75], a[4:7], v[28:31]
  buffer_load_dwordx4 v236, s[12:15], s47 offen offset:0 lds
  ds_read_b64_tr_b16 a[96:97], v20 offset:4096
  v_mfma_f32_16x16x32_bf16 v[32:35], a[72:75], a[8:11], v[32:35]
  v_mfma_f32_16x16x32_bf16 v[36:39], a[72:75], a[12:15], v[36:39]
  ds_read_b64_tr_b16 a[98:99], v20 offset:6144
  v_mfma_f32_16x16x32_bf16 v[40:43], a[72:75], a[16:19], v[40:43]
  v_mfma_f32_16x16x32_bf16 v[44:47], a[72:75], a[20:23], v[44:47]
  ds_read_b128 a[40:43], v17 offset:2048
  v_mfma_f32_16x16x32_bf16 v[48:51], a[72:75], a[24:27], v[48:51]
  v_mfma_f32_16x16x32_bf16 v[52:55], a[72:75], a[28:31], v[52:55]
  ds_read_b128 a[44:47], v17 offset:4096
  v_mfma_f32_16x16x32_bf16 v[56:59], a[76:79], a[0:3], v[56:59]
  v_mfma_f32_16x16x32_bf16 v[60:63], a[76:79], a[4:7], v[60:63]
  ds_read_b128 a[48:51], v17 offset:6144
  v_mfma_f32_16x16x32_bf16 v[64:67], a[76:79], a[8:11], v[64:67]
  v_mfma_f32_16x16x32_bf16 v[68:71], a[76:79], a[12:15], v[68:71]
  ds_read_b128 a[52:55], v17 offset:8192
  v_mfma_f32_16x16x32_bf16 v[72:75], a[76:79], a[16:19], v[72:75]
  v_mfma_f32_16x16x32_bf16 v[76:79], a[76:79], a[20:23], v[76:79]
  ds_read_b128 a[56:59], v17 offset:10240
  v_mfma_f32_16x16x32_bf16 v[80:83], a[76:79], a[24:27], v[80:83]
  buffer_load_dwordx4 v237, s[12:15], s47 offen offset:1024 lds
  v_mfma_f32_16x16x32_bf16 v[84:87], a[76:79], a[28:31], v[84:87]
  ds_read_b128 a[60:63], v17 offset:12288
  v_mfma_f32_16x16x32_bf16 v[88:91], a[80:83], a[0:3], v[88:91]
  v_mfma_f32_16x16x32_bf16 v[92:95], a[80:83], a[4:7], v[92:95]
  ds_read_b128 a[64:67], v17 offset:14336
  v_mfma_f32_16x16x32_bf16 v[96:99], a[80:83], a[8:11], v[96:99]
  v_mfma_f32_16x16x32_bf16 v[100:103], a[80:83], a[12:15], v[100:103]
  ds_read_b64_tr_b16 a[100:101], v21 offset:4096
  v_mfma_f32_16x16x32_bf16 v[104:107], a[80:83], a[16:19], v[104:107]
  ds_read_b64_tr_b16 a[102:103], v21 offset:6144
  v_mfma_f32_16x16x32_bf16 v[108:111], a[80:83], a[20:23], v[108:111]
  v_mfma_f32_16x16x32_bf16 v[112:115], a[80:83], a[24:27], v[112:115]
  ds_read_b64_tr_b16 a[104:105], v20 offset:12288
  v_mfma_f32_16x16x32_bf16 v[116:119], a[80:83], a[28:31], v[116:119]
  v_mfma_f32_16x16x32_bf16 v[120:123], a[84:87], a[0:3], v[120:123]
  ds_read_b64_tr_b16 a[106:107], v20 offset:14336
  v_mfma_f32_16x16x32_bf16 v[124:127], a[84:87], a[4:7], v[124:127]
  v_mfma_f32_16x16x32_bf16 v[128:131], a[84:87], a[8:11], v[128:131]
  ds_read_b64_tr_b16 a[108:109], v21 offset:12288
  v_mfma_f32_16x16x32_bf16 v[132:135], a[84:87], a[12:15], v[132:135]
  v_mfma_f32_16x16x32_bf16 v[136:139], a[84:87], a[16:19], v[136:139]
  buffer_load_dwordx4 v238, s[12:15], s47 offen offset:2048 lds
  ds_read_b64_tr_b16 a[110:111], v21 offset:14336
  v_mfma_f32_16x16x32_bf16 v[140:143], a[84:87], a[20:23], v[140:143]
  s_add_u32 s36, s36, s38
  s_add_u32 s37, s37, 1
  s_cmp_eq_u32 s37, 3
  s_cselect_b32 s37, 0, s37
  s_cselect_b32 s38, s39, s40
  v_mfma_f32_16x16x32_bf16 v[144:147], a[84:87], a[24:27], v[144:147]
  s_add_u32 s41, s41, s43
  s_sub_u32 s43, 0, s43
  ds_read_b64_tr_b16 a[112:113], v20 offset:20480
  v_mfma_f32_16x16x32_bf16 v[148:151], a[84:87], a[28:31], v[148:151]
  v_mfma_f32_16x16x32_bf16 v[152:155], a[0:3], a[88:91], v[152:155]
  ds_read_b64_tr_b16 a[114:115], v20 offset:22528
  v_mfma_f32_16x16x32_bf16 v[156:159], a[4:7], a[88:91], v[156:159]
  v_mfma_f32_16x16x32_bf16 v[160:163], a[8:11], a[88:91], v[160:163]
  ds_read_b128 a[68:71], v19 offset:0
  v_mfma_f32_16x16x32_bf16 v[164:167], a[12:15], a[88:91], v[164:167]
  v_mfma_f32_16x16x32_bf16 v[168:171], a[16:19], a[88:91], v[168:171]
  ds_read_b64_tr_b16 a[116:117], v21 offset:20480
  v_mfma_f32_16x16x32_bf16 v[172:175], a[20:23], a[88:91], v[172:175]
  v_mfma_f32_16x16x32_bf16 v[176:179], a[24:27], a[88:91], v[176:179]
  ds_read_b64_tr_b16 a[118:119], v21 offset:22528
  v_mfma_f32_16x16x32_bf16 v[180:183], a[28:31], a[88:91], v[180:183]
  v_add_u32 v16, s38, v16
  v_add_u32 v17, s38, v17
  v_mfma_f32_16x16x32_bf16 v[216:219], a[32:35], a[88:91], v[216:219]
  v_add_u32 v18, s38, v18
  v_add_u32 v19, s38, v19
  v_mfma_f32_16x16x32_bf16 v[184:187], a[0:3], a[92:95], v[184:187]
  v_add_u32 v20, s43, v20
  v_add_u32 v21, s43, v21
  v_mfma_f32_16x16x32_bf16 v[188:191], a[4:7], a[92:95], v[188:191]
  v_mfma_f32_16x16x32_bf16 v[192:195], a[8:11], a[92:95], v[192:195]
  v_mfma_f32_16x16x32_bf16 v[196:199], a[12:15], a[92:95], v[196:199]
  v_mfma_f32_16x16x32_bf16 v[200:203], a[16:19], a[92:95], v[200:203]
  v_mfma_f32_16x16x32_bf16 v[204:207], a[20:23], a[92:95], v[204:207]
  v_mfma_f32_16x16x32_bf16 v[208:211], a[24:27], a[92:95], v[208:211]
  v_mfma_f32_16x16x32_bf16 v[212:215], a[28:31], a[92:95], v[212:215]
  v_mfma_f32_16x16x32_bf16 v[220:223], a[32:35], a[92:95], v[220:223]
  s_waitcnt vmcnt(0) lgkmcnt(0)
  s_barrier
  s_mov_b32 s6, 0x3e8293ee
  s_mov_b32 s7, s6
  v_mfma_f32_16x16x32_bf16 v[24:27], a[96:99], a[36:39], v[24:27]
  ds_read_b128 a[0:3], v16 offset:0
  v_mfma_f32_16x16x32_bf16 v[28:31], a[96:99], a[40:43], v[28:31]
  ds_read_b64_tr_b16 a[72:73], v20 offset:0
  v_mfma_f32_16x16x32_bf16 v[32:35], a[96:99], a[44:47], v[32:35]
  v_mfma_f32_16x16x32_bf16 v[36:39], a[96:99], a[48:51], v[36:39]
  ds_read_b64_tr_b16 a[74:75], v20 offset:2048
  v_mfma_f32_16x16x32_bf16 v[40:43], a[96:99], a[52:55], v[40:43]
  v_mfma_f32_16x16x32_bf16 v[44:47], a[96:99], a[56:59], v[44:47]
  ds_read_b128 a[4:7], v16 offset:2048
  v_mfma_f32_16x16x32_bf16 v[48:51], a[96:99], a[60:63], v[48:51]
  v_mfma_f32_16x16x32_bf16 v[52:55], a[96:99], a[64:67], v[52:55]
  ds_read_b128 a[8:11], v16 offset:4096
  v_mfma_f32_16x16x32_bf16 v[56:59], a[100:103], a[36:39], v[56:59]
  v_mfma_f32_16x16x32_bf16 v[60:63], a[100:103], a[40:43], v[60:63]
  ds_read_b128 a[12:15], v16 offset:6144
  v_mfma_f32_16x16x32_bf16 v[64:67], a[100:103], a[44:47], v[64:67]
  v_mfma_f32_16x16x32_bf16 v[68:71], a[100:103], a[48:51], v[68:71]
  ds_read_b128 a[16:19], v16 offset:8192
  v_mfma_f32_16x16x32_bf16 v[72:75], a[100:103], a[52:55], v[72:75]
  v_mfma_f32_16x16x32_bf16 v[76:79], a[100:103], a[56:59], v[76:79]
  ds_read_b128 a[20:23], v16 offset:10240
  v_mfma_f32_16x16x32_bf16 v[80:83], a[100:103], a[60:63], v[80:83]
  v_mfma_f32_16x16x32_bf16 v[84:87], a[100:103], a[64:67], v[84:87]
  ds_read_b128 a[24:27], v16 offset:12288
  v_mfma_f32_16x16x32_bf16 v[88:91], a[104:107], a[36:39], v[88:91]
  v_mfma_f32_16x16x32_bf16 v[92:95], a[104:107], a[40:43], v[92:95]
  ds_read_b128 a[28:31], v16 offset:14336
  v_mfma_f32_16x16x32_bf16 v[96:99], a[104:107], a[44:47], v[96:99]
  v_mfma_f32_16x16x32_bf16 v[100:103], a[104:107], a[48:51], v[100:103]
  ds_read_b64_tr_b16 a[76:77], v21 offset:0
  v_mfma_f32_16x16x32_bf16 v[104:107], a[104:107], a[52:55], v[104:107]
  ds_read_b64_tr_b16 a[78:79], v21 offset:2048
  v_mfma_f32_16x16x32_bf16 v[108:111], a[104:107], a[56:59], v[108:111]
  v_mfma_f32_16x16x32_bf16 v[112:115], a[104:107], a[60:63], v[112:115]
  ds_read_b64_tr_b16 a[80:81], v20 offset:8192
  v_mfma_f32_16x16x32_bf16 v[116:119], a[104:107], a[64:67], v[116:119]
  v_mfma_f32_16x16x32_bf16 v[120:123], a[108:111], a[36:39], v[120:123]
  ds_read_b64_tr_b16 a[82:83], v20 offset:10240
  v_mfma_f32_16x16x32_bf16 v[124:127], a[108:111], a[40:43], v[124:127]
  v_mfma_f32_16x16x32_bf16 v[128:131], a[108:111], a[44:47], v[128:131]
  ds_read_b64_tr_b16 a[84:85], v21 offset:8192
  v_mfma_f32_16x16x32_bf16 v[132:135], a[108:111], a[48:51], v[132:135]
  v_mfma_f32_16x16x32_bf16 v[136:139], a[108:111], a[52:55], v[136:139]
  ds_read_b64_tr_b16 a[86:87], v21 offset:10240
  v_mfma_f32_16x16x32_bf16 v[140:143], a[108:111], a[56:59], v[140:143]
  v_mfma_f32_16x16x32_bf16 v[144:147], a[108:111], a[60:63], v[144:147]
  ds_read_b64_tr_b16 a[88:89], v20 offset:16384
  v_mfma_f32_16x16x32_bf16 v[148:151], a[108:111], a[64:67], v[148:151]
  v_mfma_f32_16x16x32_bf16 v[152:155], a[36:39], a[112:115], v[152:155]
  ds_read_b64_tr_b16 a[90:91], v20 offset:18432
  v_mfma_f32_16x16x32_bf16 v[156:159], a[40:43], a[112:115], v[156:159]
  v_mfma_f32_16x16x32_bf16 v[160:163], a[44:47], a[112:115], v[160:163]
  ds_read_b128 a[32:35], v18 offset:0
  v_mfma_f32_16x16x32_bf16 v[164:167], a[48:51], a[112:115], v[164:167]
  v_mfma_f32_16x16x32_bf16 v[168:171], a[52:55], a[112:115], v[168:171]
  ds_read_b64_tr_b16 a[92:93], v21 offset:16384
  v_mfma_f32_16x16x32_bf16 v[172:175], a[56:59], a[112:115], v[172:175]
  v_mfma_f32_16x16x32_bf16 v[176:179], a[60:63], a[112:115], v[176:179]
  ds_read_b64_tr_b16 a[94:95], v21 offset:18432
  v_mfma_f32_16x16x32_bf16 v[180:183], a[64:67], a[112:115], v[180:183]
  v_mfma_f32_16x16x32_bf16 v[216:219], a[68:71], a[112:115], v[216:219]
  v_mfma_f32_16x16x32_bf16 v[184:187], a[36:39], a[116:119], v[184:187]
  v_mfma_f32_16x16x32_bf16 v[188:191], a[40:43], a[116:119], v[188:191]
  v_mfma_f32_16x16x32_bf16 v[192:195], a[44:47], a[116:119], v[192:195]
  v_mfma_f32_16x16x32_bf16 v[196:199], a[48:51], a[116:119], v[196:199]
  v_mfma_f32_16x16x32_bf16 v[200:203], a[52:55], a[116:119], v[200:203]
  v_mfma_f32_16x16x32_bf16 v[204:207], a[56:59], a[116:119], v[204:207]
  v_mfma_f32_16x16x32_bf16 v[208:211], a[60:63], a[116:119], v[208:211]
  v_mfma_f32_16x16x32_bf16 v[212:215], a[64:67], a[116:119], v[212:215]
  v_mfma_f32_16x16x32_bf16 v[220:223], a[68:71], a[116:119], v[220:223]
  s_waitcnt lgkmcnt(0)
  v_mfma_f32_16x16x32_bf16 v[24:27], a[72:75], a[0:3], v[24:27]
  ds_read_b128 a[36:39], v17 offset:0
  ds_read_b64_tr_b16 a[96:97], v20 offset:4096
  v_mfma_f32_16x16x32_bf16 v[56:59], a[76:79], a[0:3], v[56:59]
  ds_read_b64_tr_b16 a[98:99], v20 offset:6144
  ds_read_b128 a[40:43], v17 offset:2048
  v_mfma_f32_16x16x32_bf16 v[28:31], a[72:75], a[4:7], v[28:31]
  ds_read_b128 a[44:47], v17 offset:4096
  ds_read_b128 a[48:51], v17 offset:6144
  v_mfma_f32_16x16x32_bf16 v[60:63], a[76:79], a[4:7], v[60:63]
  ds_read_b128 a[52:55], v17 offset:8192
  ds_read_b128 a[56:59], v17 offset:10240
  v_mfma_f32_16x16x32_bf16 v[32:35], a[72:75], a[8:11], v[32:35]
  ds_read_b128 a[60:63], v17 offset:12288
  ds_read_b128 a[64:67], v17 offset:14336
  v_mfma_f32_16x16x32_bf16 v[64:67], a[76:79], a[8:11], v[64:67]
  ds_read_b64_tr_b16 a[100:101], v21 offset:4096
  ds_read_b64_tr_b16 a[102:103], v21 offset:6144
  v_mfma_f32_16x16x32_bf16 v[36:39], a[72:75], a[12:15], v[36:39]
  ds_read_b64_tr_b16 a[104:105], v20 offset:12288
  ds_read_b64_tr_b16 a[106:107], v20 offset:14336
  v_mfma_f32_16x16x32_bf16 v[68:71], a[76:79], a[12:15], v[68:71]
  ds_read_b64_tr_b16 a[108:109], v21 offset:12288
  ds_read_b64_tr_b16 a[110:111], v21 offset:14336
  v_mfma_f32_16x16x32_bf16 v[40:43], a[72:75], a[16:19], v[40:43]
  ds_read_b64_tr_b16 a[112:113], v20 offset:20480
  ds_read_b64_tr_b16 a[114:115], v20 offset:22528
  v_mfma_f32_16x16x32_bf16 v[72:75], a[76:79], a[16:19], v[72:75]
  ds_read_b128 a[68:71], v19 offset:0
  ds_read_b64_tr_b16 a[116:117], v21 offset:20480
  v_mfma_f32_16x16x32_bf16 v[44:47], a[72:75], a[20:23], v[44:47]
  ds_read_b64_tr_b16 a[118:119], v21 offset:22528
  v_mfma_f32_16x16x32_bf16 v[76:79], a[76:79], a[20:23], v[76:79]
  v_mfma_f32_16x16x32_bf16 v[48:51], a[72:75], a[24:27], v[48:51]
  v_mfma_f32_16x16x32_bf16 v[80:83], a[76:79], a[24:27], v[80:83]
  v_mfma_f32_16x16x32_bf16 v[52:55], a[72:75], a[28:31], v[52:55]
  v_mfma_f32_16x16x32_bf16 v[84:87], a[76:79], a[28:31], v[84:87]
  s_waitcnt lgkmcnt(0)
  s_barrier
  s_mov_b32 s12, s84
  s_mov_b32 s13, s85
  s_mov_b32 s14, 256
  s_mov_b32 s15, 0x00020000
  buffer_load_dwordx2 v[22:23], off, s[12:15], 0 sc1
  v_mfma_f32_16x16x32_bf16 v[24:27], a[96:99], a[36:39], v[24:27]
  s_mov_b32 m0, s68
  v_mfma_f32_16x16x32_bf16 v[56:59], a[100:103], a[36:39], v[56:59]
  buffer_load_dwordx4 v8, s[20:23], s28 offen offset:0 lds
  v_mfma_f32_16x16x32_bf16 v[28:31], a[96:99], a[40:43], v[28:31]
  v_mfma_f32_16x16x32_bf16 v[60:63], a[100:103], a[40:43], v[60:63]
  v_mfma_f32_16x16x32_bf16 v[32:35], a[96:99], a[44:47], v[32:35]
  v_mfma_f32_16x16x32_bf16 v[64:67], a[100:103], a[44:47], v[64:67]
  buffer_load_dwordx4 v9, s[20:23], s28 offen offset:1024 lds
  v_pk_mul_f32 v[24:25], v[24:25], s[6:7]
  v_mfma_f32_16x16x32_bf16 v[36:39], a[96:99], a[48:51], v[36:39]
  v_pk_mul_f32 v[26:27], v[26:27], s[6:7]
  v_pk_mul_f32 v[56:57], v[56:57], s[6:7]
  v_mfma_f32_16x16x32_bf16 v[68:71], a[100:103], a[48:51], v[68:71]
  v_pk_mul_f32 v[58:59], v[58:59], s[6:7]
  v_cvt_pk_bf16_f32 v24, v24, v25
  v_mfma_f32_16x16x32_bf16 v[40:43], a[96:99], a[52:55], v[40:43]
  v_cvt_pk_bf16_f32 v25, v26, v27
  v_cvt_pk_bf16_f32 v26, v56, v57
  v_mfma_f32_16x16x32_bf16 v[72:75], a[100:103], a[52:55], v[72:75]
  v_cvt_pk_bf16_f32 v27, v58, v59
  v_pk_mul_f32 v[28:29], v[28:29], s[6:7]
  v_mfma_f32_16x16x32_bf16 v[44:47], a[96:99], a[56:59], v[44:47]
  buffer_load_dwordx4 v10, s[20:23], s28 offen offset:2048 lds
  v_pk_mul_f32 v[30:31], v[30:31], s[6:7]
  v_mfma_f32_16x16x32_bf16 v[76:79], a[100:103], a[56:59], v[76:79]
  v_pk_mul_f32 v[60:61], v[60:61], s[6:7]
  v_pk_mul_f32 v[62:63], v[62:63], s[6:7]
  v_mfma_f32_16x16x32_bf16 v[48:51], a[96:99], a[60:63], v[48:51]
  v_cvt_pk_bf16_f32 v28, v28, v29
  v_cvt_pk_bf16_f32 v29, v30, v31
  v_mfma_f32_16x16x32_bf16 v[80:83], a[100:103], a[60:63], v[80:83]
  v_cvt_pk_bf16_f32 v30, v60, v61
  v_cvt_pk_bf16_f32 v31, v62, v63
  v_mfma_f32_16x16x32_bf16 v[52:55], a[96:99], a[64:67], v[52:55]
  v_pk_mul_f32 v[32:33], v[32:33], s[6:7]
  v_pk_mul_f32 v[34:35], v[34:35], s[6:7]
  v_mfma_f32_16x16x32_bf16 v[84:87], a[100:103], a[64:67], v[84:87]
  buffer_load_dwordx4 v11, s[20:23], s28 offen offset:3072 lds
  v_pk_mul_f32 v[64:65], v[64:65], s[6:7]
  v_mfma_f32_16x16x32_bf16 v[88:91], a[80:83], a[0:3], v[88:91]
  s_bfe_u32 s56, 0x302010e, s55
  s_add_u32 s54, s54, s56
  s_add_u32 s55, s55, 8
  v_mfma_f32_16x16x32_bf16 v[120:123], a[84:87], a[0:3], v[120:123]
  s_and_b32 s55, s55, 0x8001f
  s_and_b32 s54, s54, 15
  s_lshl_b32 s28, s54, 19
  v_mfma_f32_16x16x32_bf16 v[88:91], a[104:107], a[36:39], v[88:91]
  s_add_u32 m0, s68, 16384
  v_pk_mul_f32 v[66:67], v[66:67], s[6:7]
  v_cvt_pk_bf16_f32 v32, v32, v33
  v_mfma_f32_16x16x32_bf16 v[120:123], a[108:111], a[36:39], v[120:123]
  v_cvt_pk_bf16_f32 v33, v34, v35
  v_cvt_pk_bf16_f32 v34, v64, v65
  v_mfma_f32_16x16x32_bf16 v[92:95], a[80:83], a[4:7], v[92:95]
  buffer_load_dwordx4 v8, s[20:23], s28 offen offset:0 lds
  v_cvt_pk_bf16_f32 v35, v66, v67
  v_mfma_f32_16x16x32_bf16 v[124:127], a[84:87], a[4:7], v[124:127]
  v_pk_mul_f32 v[36:37], v[36:37], s[6:7]
  v_pk_mul_f32 v[38:39], v[38:39], s[6:7]
  v_mfma_f32_16x16x32_bf16 v[92:95], a[104:107], a[40:43], v[92:95]
  v_pk_mul_f32 v[68:69], v[68:69], s[6:7]
  v_pk_mul_f32 v[70:71], v[70:71], s[6:7]
  v_mfma_f32_16x16x32_bf16 v[124:127], a[108:111], a[40:43], v[124:127]
  v_cvt_pk_bf16_f32 v36, v36, v37
  v_cvt_pk_bf16_f32 v37, v38, v39
  v_mfma_f32_16x16x32_bf16 v[96:99], a[80:83], a[8:11], v[96:99]
  v_cvt_pk_bf16_f32 v38, v68, v69
  v_cvt_pk_bf16_f32 v39, v70, v71
  v_mfma_f32_16x16x32_bf16 v[128:131], a[84:87], a[8:11], v[128:131]
  buffer_load_dwordx4 v9, s[20:23], s28 offen offset:1024 lds
  v_pk_mul_f32 v[40:41], v[40:41], s[6:7]
  v_mfma_f32_16x16x32_bf16 v[96:99], a[104:107], a[44:47], v[96:99]
  v_pk_mul_f32 v[42:43], v[42:43], s[6:7]
  v_pk_mul_f32 v[72:73], v[72:73], s[6:7]
  v_mfma_f32_16x16x32_bf16 v[128:131], a[108:111], a[44:47], v[128:131]
  v_pk_mul_f32 v[74:75], v[74:75], s[6:7]
  v_cvt_pk_bf16_f32 v40, v40, v41
  v_mfma_f32_16x16x32_bf16 v[100:103], a[80:83], a[12:15], v[100:103]
  v_cvt_pk_bf16_f32 v41, v42, v43
  v_cvt_pk_bf16_f32 v42, v72, v73
  v_mfma_f32_16x16x32_bf16 v[132:135], a[84:87], a[12:15], v[132:135]
  v_cvt_pk_bf16_f32 v43, v74, v75
  v_pk_mul_f32 v[44:45], v[44:45], s[6:7]
  v_mfma_f32_16x16x32_bf16 v[100:103], a[104:107], a[48:51], v[100:103]
  v_pk_mul_f32 v[46:47], v[46:47], s[6:7]
  v_pk_mul_f32 v[76:77], v[76:77], s[6:7]
  v_mfma_f32_16x16x32_bf16 v[132:135], a[108:111], a[48:51], v[132:135]
  buffer_load_dwordx4 v10, s[20:23], s28 offen offset:2048 lds
  v_pk_mul_f32 v[78:79], v[78:79], s[6:7]
  v_mfma_f32_16x16x32_bf16 v[104:107], a[80:83], a[16:19], v[104:107]
  v_cvt_pk_bf16_f32 v44, v44, v45
  v_cvt_pk_bf16_f32 v45, v46, v47
  v_mfma_f32_16x16x32_bf16 v[136:139], a[84:87], a[16:19], v[136:139]
  v_cvt_pk_bf16_f32 v46, v76, v77
  v_cvt_pk_bf16_f32 v47, v78, v79
  v_mfma_f32_16x16x32_bf16 v[104:107], a[104:107], a[52:55], v[104:107]
  v_pk_mul_f32 v[48:49], v[48:49], s[6:7]
  v_pk_mul_f32 v[50:51], v[50:51], s[6:7]
  v_mfma_f32_16x16x32_bf16 v[136:139], a[108:111], a[52:55], v[136:139]
  v_pk_mul_f32 v[80:81], v[80:81], s[6:7]
  v_pk_mul_f32 v[82:83], v[82:83], s[6:7]
  v_mfma_f32_16x16x32_bf16 v[108:111], a[80:83], a[20:23], v[108:111]
  buffer_load_dwordx4 v11, s[20:23], s28 offen offset:3072 lds
  v_cvt_pk_bf16_f32 v48, v48, v49
  v_mfma_f32_16x16x32_bf16 v[140:143], a[84:87], a[20:23], v[140:143]
  s_bfe_u32 s56, 0x302010e, s55
  s_add_u32 s54, s54, s56
  s_add_u32 s55, s55, 8
  v_mfma_f32_16x16x32_bf16 v[108:111], a[104:107], a[56:59], v[108:111]
  s_and_b32 s55, s55, 0x8001f
  s_and_b32 s54, s54, 15
  s_lshl_b32 s28, s54, 19
  v_mfma_f32_16x16x32_bf16 v[140:143], a[108:111], a[56:59], v[140:143]
  s_mov_b32 m0, s88
  v_cvt_pk_bf16_f32 v49, v50, v51
  v_cvt_pk_bf16_f32 v50, v80, v81
  v_mfma_f32_16x16x32_bf16 v[112:115], a[80:83], a[24:27], v[112:115]
  v_cvt_pk_bf16_f32 v51, v82, v83
  v_pk_mul_f32 v[52:53], v[52:53], s[6:7]
  v_mfma_f32_16x16x32_bf16 v[144:147], a[84:87], a[24:27], v[144:147]
  buffer_load_dwordx4 v4, s[8:11], s26 offen offset:0 lds
  v_pk_mul_f32 v[54:55], v[54:55], s[6:7]
  v_mfma_f32_16x16x32_bf16 v[112:115], a[104:107], a[60:63], v[112:115]
  v_pk_mul_f32 v[84:85], v[84:85], s[6:7]
  v_pk_mul_f32 v[86:87], v[86:87], s[6:7]
  v_mfma_f32_16x16x32_bf16 v[144:147], a[108:111], a[60:63], v[144:147]
  v_cvt_pk_bf16_f32 v52, v52, v53
  v_cvt_pk_bf16_f32 v53, v54, v55
  v_mfma_f32_16x16x32_bf16 v[116:119], a[80:83], a[28:31], v[116:119]
  v_cvt_pk_bf16_f32 v54, v84, v85
  v_cvt_pk_bf16_f32 v55, v86, v87
  v_mfma_f32_16x16x32_bf16 v[148:151], a[84:87], a[28:31], v[148:151]
  v_cvt_pk_bf16_f32 v88, v88, v89
  v_cvt_pk_bf16_f32 v89, v90, v91
  v_mfma_f32_16x16x32_bf16 v[116:119], a[104:107], a[64:67], v[116:119]
  buffer_load_dwordx4 v5, s[8:11], s26 offen offset:1024 lds
  v_cvt_pk_bf16_f32 v90, v120, v121
  v_mfma_f32_16x16x32_bf16 v[148:151], a[108:111], a[64:67], v[148:151]
  v_cvt_pk_bf16_f32 v91, v122, v123
  v_cvt_pk_bf16_f32 v92, v92, v93
  v_mfma_f32_16x16x32_bf16 v[216:219], a[32:35], a[88:91], v[216:219]
  v_cvt_pk_bf16_f32 v93, v94, v95
  v_cvt_pk_bf16_f32 v94, v124, v125
  v_mfma_f32_16x16x32_bf16 v[220:223], a[32:35], a[92:95], v[220:223]
  v_cvt_pk_bf16_f32 v95, v126, v127
  v_cvt_pk_bf16_f32 v96, v96, v97
  v_mfma_f32_16x16x32_bf16 v[216:219], a[68:71], a[112:115], v[216:219]
  v_cvt_pk_bf16_f32 v97, v98, v99
  v_cvt_pk_bf16_f32 v98, v128, v129
  v_mfma_f32_16x16x32_bf16 v[220:223], a[68:71], a[116:119], v[220:223]
  buffer_load_dwordx4 v6, s[8:11], s26 offen offset:2048 lds
  v_cvt_pk_bf16_f32 v99, v130, v131
  v_mfma_f32_16x16x32_bf16 v[180:183], a[28:31], a[88:91], v[180:183]
  v_cvt_pk_bf16_f32 v100, v100, v101
  v_cvt_pk_bf16_f32 v101, v102, v103
  v_mfma_f32_16x16x32_bf16 v[212:215], a[28:31], a[92:95], v[212:215]
  v_cvt_pk_bf16_f32 v102, v132, v133
  v_cvt_pk_bf16_f32 v103, v134, v135
  v_mfma_f32_16x16x32_bf16 v[180:183], a[64:67], a[112:115], v[180:183]
  v_cvt_pk_bf16_f32 v104, v104, v105
  v_cvt_pk_bf16_f32 v105, v106, v107
  v_mfma_f32_16x16x32_bf16 v[212:215], a[64:67], a[116:119], v[212:215]
  v_cvt_pk_bf16_f32 v106, v136, v137
  v_cvt_pk_bf16_f32 v107, v138, v139
  v_mfma_f32_16x16x32_bf16 v[176:179], a[24:27], a[88:91], v[176:179]
  v_cvt_pk_bf16_f32 v108, v108, v109
  v_cvt_pk_bf16_f32 v109, v110, v111
  v_mfma_f32_16x16x32_bf16 v[208:211], a[24:27], a[92:95], v[208:211]
  buffer_load_dwordx4 v7, s[8:11], s26 offen offset:3072 lds
  v_cvt_pk_bf16_f32 v110, v140, v141
  v_mfma_f32_16x16x32_bf16 v[176:179], a[60:63], a[112:115], v[176:179]
  s_add_u32 m0, s88, 4096
  v_cvt_pk_bf16_f32 v111, v142, v143
  v_cvt_pk_bf16_f32 v112, v112, v113
  v_mfma_f32_16x16x32_bf16 v[208:211], a[60:63], a[116:119], v[208:211]
  v_cvt_pk_bf16_f32 v113, v114, v115
  v_cvt_pk_bf16_f32 v114, v144, v145
  v_mfma_f32_16x16x32_bf16 v[172:175], a[20:23], a[88:91], v[172:175]
  v_cvt_pk_bf16_f32 v115, v146, v147
  v_cvt_pk_bf16_f32 v116, v116, v117
  v_mfma_f32_16x16x32_bf16 v[204:207], a[20:23], a[92:95], v[204:207]
  v_cvt_pk_bf16_f32 v117, v118, v119
  v_cvt_pk_bf16_f32 v118, v148, v149
  v_mfma_f32_16x16x32_bf16 v[172:175], a[56:59], a[112:115], v[172:175]
  buffer_load_dwordx4 v4, s[8:11], s27 offen offset:0 lds
  v_cvt_pk_bf16_f32 v119, v150, v151
  v_mfma_f32_16x16x32_bf16 v[204:207], a[56:59], a[116:119], v[204:207]
  v_cvt_pk_bf16_f32 v216, v216, v217
  v_cvt_pk_bf16_f32 v217, v218, v219
  v_mfma_f32_16x16x32_bf16 v[168:171], a[16:19], a[88:91], v[168:171]
  v_cvt_pk_bf16_f32 v218, v220, v221
  v_cvt_pk_bf16_f32 v219, v222, v223
  v_mfma_f32_16x16x32_bf16 v[200:203], a[16:19], a[92:95], v[200:203]
  ds_write_b128 v252, v[216:219] offset:1024
  v_cvt_pk_bf16_f32 v72, v180, v181
  v_mfma_f32_16x16x32_bf16 v[168:171], a[52:55], a[112:115], v[168:171]
  v_cvt_pk_bf16_f32 v73, v182, v183
  v_cvt_pk_bf16_f32 v136, v212, v213
  v_mfma_f32_16x16x32_bf16 v[200:203], a[52:55], a[116:119], v[200:203]
  buffer_load_dwordx4 v5, s[8:11], s27 offen offset:1024 lds
  v_cvt_pk_bf16_f32 v137, v214, v215
  v_mfma_f32_16x16x32_bf16 v[164:167], a[12:15], a[88:91], v[164:167]
  v_cvt_pk_bf16_f32 v70, v176, v177
  v_cvt_pk_bf16_f32 v71, v178, v179
  v_mfma_f32_16x16x32_bf16 v[196:199], a[12:15], a[92:95], v[196:199]
  v_cvt_pk_bf16_f32 v134, v208, v209
  v_cvt_pk_bf16_f32 v135, v210, v211
  v_mfma_f32_16x16x32_bf16 v[164:167], a[48:51], a[112:115], v[164:167]
  v_cvt_pk_bf16_f32 v68, v172, v173
  v_cvt_pk_bf16_f32 v69, v174, v175
  v_mfma_f32_16x16x32_bf16 v[196:199], a[48:51], a[116:119], v[196:199]
  v_cvt_pk_bf16_f32 v132, v204, v205
  v_cvt_pk_bf16_f32 v133, v206, v207
  v_mfma_f32_16x16x32_bf16 v[160:163], a[8:11], a[88:91], v[160:163]
  buffer_load_dwordx4 v6, s[8:11], s27 offen offset:2048 lds
  v_cvt_pk_bf16_f32 v66, v168, v169
  v_mfma_f32_16x16x32_bf16 v[192:195], a[8:11], a[92:95], v[192:195]
  v_cvt_pk_bf16_f32 v67, v170, v171
  v_cvt_pk_bf16_f32 v130, v200, v201
  v_mfma_f32_16x16x32_bf16 v[160:163], a[44:47], a[112:115], v[160:163]
  v_cvt_pk_bf16_f32 v131, v202, v203
  v_mfma_f32_16x16x32_bf16 v[192:195], a[44:47], a[116:119], v[192:195]
  v_cvt_pk_bf16_f32 v64, v164, v165
  v_cvt_pk_bf16_f32 v65, v166, v167
  v_mfma_f32_16x16x32_bf16 v[156:159], a[4:7], a[88:91], v[156:159]
  v_cvt_pk_bf16_f32 v128, v196, v197
  v_cvt_pk_bf16_f32 v129, v198, v199
  v_mfma_f32_16x16x32_bf16 v[188:191], a[4:7], a[92:95], v[188:191]
  buffer_load_dwordx4 v7, s[8:11], s27 offen offset:3072 lds
  v_mfma_f32_16x16x32_bf16 v[156:159], a[40:43], a[112:115], v[156:159]
  s_bfe_u32 s29, 0x302010e, s53
  s_add_u32 s52, s52, s29
  s_add_u32 s53, s53, 8
  v_mfma_f32_16x16x32_bf16 v[188:191], a[40:43], a[116:119], v[188:191]
  s_and_b32 s53, s53, 0x8001f
  s_and_b32 s52, s52, 15
  s_lshl_b32 s29, s52, 7
  v_mfma_f32_16x16x32_bf16 v[152:155], a[0:3], a[88:91], v[152:155]
  s_or_b32 s26, s30, s29
  s_or_b32 s27, s31, s29
  v_cvt_pk_bf16_f32 v62, v160, v161
  v_mfma_f32_16x16x32_bf16 v[184:187], a[0:3], a[92:95], v[184:187]
  v_cvt_pk_bf16_f32 v63, v162, v163
  v_cvt_pk_bf16_f32 v126, v192, v193
  v_mfma_f32_16x16x32_bf16 v[152:155], a[36:39], a[112:115], v[152:155]
  v_cvt_pk_bf16_f32 v127, v194, v195
  v_mfma_f32_16x16x32_bf16 v[184:187], a[36:39], a[116:119], v[184:187]
  v_cvt_pk_bf16_f32 v60, v156, v157
  v_cvt_pk_bf16_f32 v61, v158, v159
  v_cvt_pk_bf16_f32 v124, v188, v189
  v_cvt_pk_bf16_f32 v125, v190, v191
  s_nop 1
  v_cvt_pk_bf16_f32 v58, v152, v153
  v_cvt_pk_bf16_f32 v59, v154, v155
  v_cvt_pk_bf16_f32 v122, v184, v185
  v_cvt_pk_bf16_f32 v123, v186, v187
  s_waitcnt lgkmcnt(0)
  s_barrier
Lp2_at:
  ds_read_b128 v[76:79], v253
  ds_read_b64 v[56:57], v253 offset:1024
  ds_read_b64 v[120:121], v253 offset:1032
  v_mfma_f32_16x16x32_bf16 v[208:211], v[112:115], v[52:55], v[240:243]
  s_add_u32 m0, s88, 32768
  s_nop 0
  buffer_load_dwordx4 v4, s[8:11], s26 offen offset:0 lds
  v_mfma_f32_16x16x32_bf16 v[212:215], v[116:119], v[52:55], v[244:247]
  v_mfma_f32_16x16x32_bf16 v[200:203], v[108:111], v[48:51], v[240:243]
  v_mfma_f32_16x16x32_bf16 v[204:207], v[112:115], v[48:51], v[244:247]
  v_mfma_f32_16x16x32_bf16 v[192:195], v[104:107], v[44:47], v[240:243]
  v_mfma_f32_16x16x32_bf16 v[196:199], v[108:111], v[44:47], v[244:247]
  v_mfma_f32_16x16x32_bf16 v[184:187], v[100:103], v[40:43], v[240:243]
  v_mfma_f32_16x16x32_bf16 v[188:191], v[104:107], v[40:43], v[244:247]
  v_mfma_f32_16x16x32_bf16 v[176:179], v[96:99], v[36:39], v[240:243]
  v_mfma_f32_16x16x32_bf16 v[180:183], v[100:103], v[36:39], v[244:247]
  v_mfma_f32_16x16x32_bf16 v[168:171], v[92:95], v[32:35], v[240:243]
  v_mfma_f32_16x16x32_bf16 v[172:175], v[96:99], v[32:35], v[244:247]
  v_mfma_f32_16x16x32_bf16 v[160:163], v[88:91], v[28:31], v[240:243]
  buffer_load_dwordx4 v5, s[8:11], s26 offen offset:1024 lds
  v_mfma_f32_16x16x32_bf16 v[164:167], v[92:95], v[28:31], v[244:247]
  s_waitcnt lgkmcnt(0)
  v_mfma_f32_16x16x32_bf16 v[152:155], v[76:79], v[24:27], v[248:251]
  v_mfma_f32_16x16x32_bf16 v[156:159], v[88:91], v[24:27], v[244:247]
  v_max3_f32 v238, v208, v209, v210
  v_max3_f32 v239, v211, v212, v213
  v_max3_f32 v238, v238, v214, v215
  v_max_f32 v238, v238, v239
  v_max3_f32 v236, v200, v201, v202
  v_max3_f32 v237, v203, v204, v205
  v_max3_f32 v236, v236, v206, v207
  v_max_f32 v236, v236, v237
  v_max3_f32 v234, v192, v193, v194
  v_max3_f32 v235, v195, v196, v197
  buffer_load_dwordx4 v6, s[8:11], s26 offen offset:2048 lds
  v_max3_f32 v234, v234, v198, v199
  v_max_f32 v234, v234, v235
  v_max3_f32 v232, v184, v185, v186
  v_max3_f32 v233, v187, v188, v189
  v_max3_f32 v232, v232, v190, v191
  v_max_f32 v232, v232, v233
  v_max3_f32 v230, v176, v177, v178
  v_max3_f32 v231, v179, v180, v181
  v_max3_f32 v230, v230, v182, v183
  v_max_f32 v230, v230, v231
  v_max3_f32 v228, v168, v169, v170
  v_max3_f32 v229, v171, v172, v173
  buffer_load_dwordx4 v7, s[8:11], s26 offen offset:3072 lds
  v_max3_f32 v228, v228, v174, v175
  v_max_f32 v228, v228, v229
  v_max3_f32 v226, v160, v161, v162
  v_max3_f32 v227, v163, v164, v165
  v_max3_f32 v226, v226, v166, v167
  v_max_f32 v226, v226, v227
  v_max3_f32 v224, v152, v153, v154
  v_max3_f32 v225, v155, v156, v157
  v_max3_f32 v224, v224, v158, v159
  v_max_f32 v224, v224, v225
  v_mov_b32 v239, v238
  v_mov_b32 v237, v236
  v_mov_b32 v235, v234
  s_add_u32 m0, s88, 36864
  s_nop 0
  buffer_load_dwordx4 v4, s[8:11], s27 offen offset:0 lds
  v_mov_b32 v233, v232
  v_mov_b32 v231, v230
  v_mov_b32 v229, v228
  v_mov_b32 v227, v226
  v_mov_b32 v225, v224
  v_permlane32_swap_b32 v238, v239
  v_permlane32_swap_b32 v236, v237
  v_permlane32_swap_b32 v234, v235
  v_permlane32_swap_b32 v232, v233
  v_permlane32_swap_b32 v230, v231
  v_permlane32_swap_b32 v228, v229
  v_permlane32_swap_b32 v226, v227
  buffer_load_dwordx4 v5, s[8:11], s27 offen offset:1024 lds
  v_permlane32_swap_b32 v224, v225
  v_max_f32 v238, v238, v239
  v_max_f32 v236, v236, v237
  v_max_f32 v234, v234, v235
  v_max_f32 v232, v232, v233
  v_max_f32 v230, v230, v231
  v_max_f32 v228, v228, v229
  v_max_f32 v226, v226, v227
  v_max_f32 v224, v224, v225
  v_mov_b32 v239, v238
  v_mov_b32 v237, v236
  v_mov_b32 v235, v234
  buffer_load_dwordx4 v6, s[8:11], s27 offen offset:2048 lds
  v_mov_b32 v233, v232
  v_mov_b32 v231, v230
  v_mov_b32 v229, v228
  v_mov_b32 v227, v226
  v_mov_b32 v225, v224
  v_permlane16_swap_b32 v238, v239
  v_permlane16_swap_b32 v236, v237
  v_permlane16_swap_b32 v234, v235
  v_permlane16_swap_b32 v232, v233
  v_permlane16_swap_b32 v230, v231
  v_permlane16_swap_b32 v228, v229
  v_permlane16_swap_b32 v226, v227
  buffer_load_dwordx4 v7, s[8:11], s27 offen offset:3072 lds
  v_permlane16_swap_b32 v224, v225
  v_max_f32 v238, v238, v239
  v_max_f32 v236, v236, v237
  v_max_f32 v234, v234, v235
  v_max_f32 v232, v232, v233
  v_max_f32 v230, v230, v231
  v_max_f32 v228, v228, v229
  v_max_f32 v226, v226, v227
  v_max_f32 v224, v224, v225
  v_sub_f32 v208, v208, v238
  v_sub_f32 v209, v209, v238
  v_sub_f32 v210, v210, v238
  v_sub_f32 v211, v211, v238
  s_bfe_u32 s29, 0x302010e, s53
  s_add_u32 s52, s52, s29
  s_add_u32 s53, s53, 8
  s_and_b32 s53, s53, 0x8001f
  s_and_b32 s52, s52, 15
  s_lshl_b32 s29, s52, 7
  s_or_b32 s26, s30, s29
  s_or_b32 s27, s31, s29
  s_add_u32 m0, s68, 32768
  s_nop 0
  buffer_load_dwordx4 v8, s[20:23], s28 offen offset:0 lds
  v_sub_f32 v212, v212, v238
  v_sub_f32 v213, v213, v238
  v_sub_f32 v214, v214, v238
  v_sub_f32 v215, v215, v238
  v_exp_f32 v208, v208
  v_exp_f32 v209, v209
  v_exp_f32 v210, v210
  v_exp_f32 v211, v211
  v_exp_f32 v212, v212
  v_exp_f32 v213, v213
  v_exp_f32 v214, v214
  v_exp_f32 v215, v215
  buffer_load_dwordx4 v9, s[20:23], s28 offen offset:1024 lds
  v_sub_f32 v200, v200, v236
  v_sub_f32 v201, v201, v236
  v_sub_f32 v202, v202, v236
  v_sub_f32 v203, v203, v236
  v_sub_f32 v204, v204, v236
  v_sub_f32 v205, v205, v236
  v_sub_f32 v206, v206, v236
  v_sub_f32 v207, v207, v236
  v_exp_f32 v200, v200
  v_exp_f32 v201, v201
  v_exp_f32 v202, v202
  v_exp_f32 v203, v203
  buffer_load_dwordx4 v10, s[20:23], s28 offen offset:2048 lds
  v_exp_f32 v204, v204
  v_exp_f32 v205, v205
  v_exp_f32 v206, v206
  v_exp_f32 v207, v207
  v_cvt_pk_bf16_f32 v116, v208, v209
  v_cvt_pk_bf16_f32 v117, v210, v211
  v_cvt_pk_bf16_f32 v118, v212, v213
  v_cvt_pk_bf16_f32 v119, v214, v215
  s_nop 1
  v_mfma_f32_16x16x32_bf16 v[52:55], a[208:211], v[116:119], 0
  v_mfma_f32_16x16x32_bf16 v[208:211], v[70:73], v[116:119], 0
  v_mfma_f32_16x16x32_bf16 v[212:215], v[134:137], v[116:119], 0
  v_sub_f32 v192, v192, v234
  buffer_load_dwordx4 v11, s[20:23], s28 offen offset:3072 lds
  v_sub_f32 v193, v193, v234
  v_sub_f32 v194, v194, v234
  v_sub_f32 v195, v195, v234
  v_sub_f32 v196, v196, v234
  v_sub_f32 v197, v197, v234
  v_sub_f32 v198, v198, v234
  v_sub_f32 v199, v199, v234
  v_exp_f32 v192, v192
  v_exp_f32 v193, v193
  v_exp_f32 v194, v194
  v_exp_f32 v195, v195
  v_exp_f32 v196, v196
  v_exp_f32 v197, v197
  s_bfe_u32 s56, 0x302010e, s55
  s_add_u32 s54, s54, s56
  s_add_u32 s55, s55, 8
  s_and_b32 s55, s55, 0x8001f
  s_and_b32 s54, s54, 15
  s_lshl_b32 s28, s54, 19
  s_add_u32 m0, s88, -32768
  s_nop 0
  buffer_load_dwordx4 v4, s[8:11], s26 offen offset:0 lds
  v_exp_f32 v198, v198
  v_exp_f32 v199, v199
  v_cvt_pk_bf16_f32 v112, v200, v201
  v_cvt_pk_bf16_f32 v113, v202, v203
  v_cvt_pk_bf16_f32 v114, v204, v205
  v_cvt_pk_bf16_f32 v115, v206, v207
  s_nop 1
  v_mfma_f32_16x16x32_bf16 v[48:51], a[208:211], v[112:115], 0
  v_mfma_f32_16x16x32_bf16 v[200:203], v[68:71], v[112:115], 0
  v_mfma_f32_16x16x32_bf16 v[204:207], v[132:135], v[112:115], 0
  v_sub_f32 v184, v184, v232
  v_sub_f32 v185, v185, v232
  v_sub_f32 v186, v186, v232
  buffer_load_dwordx4 v5, s[8:11], s26 offen offset:1024 lds
  v_sub_f32 v187, v187, v232
  v_sub_f32 v188, v188, v232
  v_sub_f32 v189, v189, v232
  v_sub_f32 v190, v190, v232
  v_sub_f32 v191, v191, v232
  v_exp_f32 v184, v184
  v_exp_f32 v185, v185
  v_exp_f32 v186, v186
  v_exp_f32 v187, v187
  v_exp_f32 v188, v188
  v_exp_f32 v189, v189
  v_exp_f32 v190, v190
  buffer_load_dwordx4 v6, s[8:11], s26 offen offset:2048 lds
  v_exp_f32 v191, v191
  v_cvt_pk_bf16_f32 v108, v192, v193
  v_cvt_pk_bf16_f32 v109, v194, v195
  v_cvt_pk_bf16_f32 v110, v196, v197
  v_cvt_pk_bf16_f32 v111, v198, v199
  s_nop 1
  v_mfma_f32_16x16x32_bf16 v[44:47], a[208:211], v[108:111], 0
  v_mfma_f32_16x16x32_bf16 v[192:195], v[66:69], v[108:111], 0
  v_mfma_f32_16x16x32_bf16 v[196:199], v[130:133], v[108:111], 0
  v_sub_f32 v176, v176, v230
  v_sub_f32 v177, v177, v230
  v_sub_f32 v178, v178, v230
  v_sub_f32 v179, v179, v230
  buffer_load_dwordx4 v7, s[8:11], s26 offen offset:3072 lds
  v_sub_f32 v180, v180, v230
  v_sub_f32 v181, v181, v230
  v_sub_f32 v182, v182, v230
  v_sub_f32 v183, v183, v230
  v_exp_f32 v176, v176
  v_exp_f32 v177, v177
  v_exp_f32 v178, v178
  v_exp_f32 v179, v179
  v_exp_f32 v180, v180
  v_exp_f32 v181, v181
  v_exp_f32 v182, v182
  v_exp_f32 v183, v183
  v_cvt_pk_bf16_f32 v104, v184, v185
  s_add_u32 m0, s88, -28672
  s_nop 0
  buffer_load_dwordx4 v4, s[8:11], s27 offen offset:0 lds
  v_cvt_pk_bf16_f32 v105, v186, v187
  v_cvt_pk_bf16_f32 v106, v188, v189
  v_cvt_pk_bf16_f32 v107, v190, v191
  s_nop 1
  v_mfma_f32_16x16x32_bf16 v[40:43], a[208:211], v[104:107], 0
  v_mfma_f32_16x16x32_bf16 v[184:187], v[64:67], v[104:107], 0
  v_mfma_f32_16x16x32_bf16 v[188:191], v[128:131], v[104:107], 0
  v_sub_f32 v168, v168, v228
  v_sub_f32 v169, v169, v228
  v_sub_f32 v170, v170, v228
  v_sub_f32 v171, v171, v228
  v_sub_f32 v172, v172, v228
  v_sub_f32 v173, v173, v228
  buffer_load_dwordx4 v5, s[8:11], s27 offen offset:1024 lds
  v_sub_f32 v174, v174, v228
  v_sub_f32 v175, v175, v228
  v_exp_f32 v168, v168
  v_exp_f32 v169, v169
  v_exp_f32 v170, v170
  v_exp_f32 v171, v171
  v_exp_f32 v172, v172
  v_exp_f32 v173, v173
  v_exp_f32 v174, v174
  v_exp_f32 v175, v175
  v_cvt_pk_bf16_f32 v100, v176, v177
  v_cvt_pk_bf16_f32 v101, v178, v179
  buffer_load_dwordx4 v6, s[8:11], s27 offen offset:2048 lds
  v_cvt_pk_bf16_f32 v102, v180, v181
  v_cvt_pk_bf16_f32 v103, v182, v183
  s_nop 1
  v_mfma_f32_16x16x32_bf16 v[36:39], a[208:211], v[100:103], 0
  v_mfma_f32_16x16x32_bf16 v[176:179], v[62:65], v[100:103], 0
  v_mfma_f32_16x16x32_bf16 v[180:183], v[126:129], v[100:103], 0
  v_sub_f32 v160, v160, v226
  v_sub_f32 v161, v161, v226
  v_sub_f32 v162, v162, v226
  v_sub_f32 v163, v163, v226
  v_sub_f32 v164, v164, v226
  v_sub_f32 v165, v165, v226
  v_sub_f32 v166, v166, v226
  buffer_load_dwordx4 v7, s[8:11], s27 offen offset:3072 lds
  s_bfe_u32 s29, 0x302010e, s53
  s_add_u32 s52, s52, s29
  s_add_u32 s53, s53, 8
  s_and_b32 s53, s53, 0x8001f
  s_and_b32 s52, s52, 15
  s_lshl_b32 s29, s52, 7
  s_or_b32 s26, s30, s29
  s_or_b32 s27, s31, s29
  v_sub_f32 v167, v167, v226
  v_exp_f32 v160, v160
  v_exp_f32 v161, v161
  v_exp_f32 v162, v162
  v_exp_f32 v163, v163
  v_exp_f32 v164, v164
  v_exp_f32 v165, v165
  v_exp_f32 v166, v166
  v_exp_f32 v167, v167
  v_cvt_pk_bf16_f32 v96, v168, v169
  v_cvt_pk_bf16_f32 v97, v170, v171
  v_cvt_pk_bf16_f32 v98, v172, v173
  v_cvt_pk_bf16_f32 v99, v174, v175
  s_nop 1
  v_mfma_f32_16x16x32_bf16 v[32:35], a[208:211], v[96:99], 0
  v_mfma_f32_16x16x32_bf16 v[168:171], v[60:63], v[96:99], 0
  v_mfma_f32_16x16x32_bf16 v[172:175], v[124:127], v[96:99], 0
  v_sub_f32 v152, v152, v224
  v_sub_f32 v153, v153, v224
  v_sub_f32 v154, v154, v224
  v_sub_f32 v155, v155, v224
  v_sub_f32 v156, v156, v224
  v_sub_f32 v157, v157, v224
  v_sub_f32 v158, v158, v224
  v_sub_f32 v159, v159, v224
  v_exp_f32 v152, v152
  v_exp_f32 v153, v153
  v_exp_f32 v154, v154
  v_exp_f32 v155, v155
  v_exp_f32 v156, v156
  v_exp_f32 v157, v157
  v_exp_f32 v158, v158
  v_exp_f32 v159, v159
  v_cvt_pk_bf16_f32 v92, v160, v161
  v_cvt_pk_bf16_f32 v93, v162, v163
  v_cvt_pk_bf16_f32 v94, v164, v165
  v_cvt_pk_bf16_f32 v95, v166, v167
  s_nop 1
  v_mfma_f32_16x16x32_bf16 v[28:31], a[208:211], v[92:95], 0
  v_mfma_f32_16x16x32_bf16 v[160:163], v[58:61], v[92:95], 0
  v_mfma_f32_16x16x32_bf16 v[164:167], v[122:125], v[92:95], 0
  v_cvt_pk_bf16_f32 v88, v152, v153
  v_cvt_pk_bf16_f32 v89, v154, v155
  v_cvt_pk_bf16_f32 v90, v156, v157
  v_cvt_pk_bf16_f32 v91, v158, v159
  s_nop 1
  v_mfma_f32_16x16x32_bf16 v[24:27], a[208:211], v[88:91], 0
  v_mfma_f32_16x16x32_bf16 v[152:155], v[56:59], v[88:91], 0
  v_mfma_f32_16x16x32_bf16 v[156:159], v[120:123], v[88:91], 0
  v_rcp_f32 v52, v52
  v_rcp_f32 v48, v48
  v_rcp_f32 v44, v44
  v_rcp_f32 v40, v40
  v_rcp_f32 v36, v36
  v_rcp_f32 v32, v32
  v_rcp_f32 v28, v28
  v_rcp_f32 v24, v24
  v_mov_b32 v53, v52
  v_mov_b32 v49, v48
  v_mov_b32 v45, v44
  v_mov_b32 v41, v40
  v_mov_b32 v37, v36
  v_mov_b32 v33, v32
  v_mov_b32 v29, v28
  v_mov_b32 v25, v24
  v_pk_mul_f32 v[208:209], v[208:209], v[52:53]
  v_pk_mul_f32 v[210:211], v[210:211], v[52:53]
  v_pk_mul_f32 v[212:213], v[212:213], v[52:53]
  v_pk_mul_f32 v[214:215], v[214:215], v[52:53]
  v_cvt_pk_bf16_f32 v208, v208, v209
  v_cvt_pk_bf16_f32 v209, v210, v211
  v_cvt_pk_bf16_f32 v210, v212, v213
  v_cvt_pk_bf16_f32 v211, v214, v215
  buffer_store_dwordx4 v[208:211], v2, s[16:19], s58 offen offset:3072 sc1
  v_pk_mul_f32 v[200:201], v[200:201], v[48:49]
  v_pk_mul_f32 v[202:203], v[202:203], v[48:49]
  v_pk_mul_f32 v[204:205], v[204:205], v[48:49]
  v_pk_mul_f32 v[206:207], v[206:207], v[48:49]
  v_cvt_pk_bf16_f32 v200, v200, v201
  v_cvt_pk_bf16_f32 v201, v202, v203
  v_cvt_pk_bf16_f32 v202, v204, v205
  v_cvt_pk_bf16_f32 v203, v206, v207
  buffer_store_dwordx4 v[200:203], v2, s[16:19], s58 offen offset:2048 sc1
  v_pk_mul_f32 v[192:193], v[192:193], v[44:45]
  v_pk_mul_f32 v[194:195], v[194:195], v[44:45]
  v_pk_mul_f32 v[196:197], v[196:197], v[44:45]
  v_pk_mul_f32 v[198:199], v[198:199], v[44:45]
  v_cvt_pk_bf16_f32 v192, v192, v193
  v_cvt_pk_bf16_f32 v193, v194, v195
  v_cvt_pk_bf16_f32 v194, v196, v197
  v_cvt_pk_bf16_f32 v195, v198, v199
  buffer_store_dwordx4 v[192:195], v2, s[16:19], s58 offen offset:1024 sc1
  v_pk_mul_f32 v[184:185], v[184:185], v[40:41]
  v_pk_mul_f32 v[186:187], v[186:187], v[40:41]
  v_pk_mul_f32 v[188:189], v[188:189], v[40:41]
  v_pk_mul_f32 v[190:191], v[190:191], v[40:41]
  v_cvt_pk_bf16_f32 v184, v184, v185
  v_cvt_pk_bf16_f32 v185, v186, v187
  v_cvt_pk_bf16_f32 v186, v188, v189
  v_cvt_pk_bf16_f32 v187, v190, v191
  buffer_store_dwordx4 v[184:187], v2, s[16:19], s58 offen offset:0 sc1
  v_pk_mul_f32 v[176:177], v[176:177], v[36:37]
  v_pk_mul_f32 v[178:179], v[178:179], v[36:37]
  v_pk_mul_f32 v[180:181], v[180:181], v[36:37]
  v_pk_mul_f32 v[182:183], v[182:183], v[36:37]
  v_cvt_pk_bf16_f32 v176, v176, v177
  v_cvt_pk_bf16_f32 v177, v178, v179
  v_cvt_pk_bf16_f32 v178, v180, v181
  v_cvt_pk_bf16_f32 v179, v182, v183
  buffer_store_dwordx4 v[176:179], v2, s[16:19], s57 offen offset:3072 sc1
  v_pk_mul_f32 v[168:169], v[168:169], v[32:33]
  v_pk_mul_f32 v[170:171], v[170:171], v[32:33]
  v_pk_mul_f32 v[172:173], v[172:173], v[32:33]
  v_pk_mul_f32 v[174:175], v[174:175], v[32:33]
  v_cvt_pk_bf16_f32 v168, v168, v169
  v_cvt_pk_bf16_f32 v169, v170, v171
  v_cvt_pk_bf16_f32 v170, v172, v173
  v_cvt_pk_bf16_f32 v171, v174, v175
  buffer_store_dwordx4 v[168:171], v2, s[16:19], s57 offen offset:2048 sc1
  v_pk_mul_f32 v[160:161], v[160:161], v[28:29]
  v_pk_mul_f32 v[162:163], v[162:163], v[28:29]
  v_pk_mul_f32 v[164:165], v[164:165], v[28:29]
  v_pk_mul_f32 v[166:167], v[166:167], v[28:29]
  v_cvt_pk_bf16_f32 v160, v160, v161
  v_cvt_pk_bf16_f32 v161, v162, v163
  v_cvt_pk_bf16_f32 v162, v164, v165
  v_cvt_pk_bf16_f32 v163, v166, v167
  buffer_store_dwordx4 v[160:163], v2, s[16:19], s57 offen offset:1024 sc1
  v_pk_mul_f32 v[152:153], v[152:153], v[24:25]
  v_pk_mul_f32 v[154:155], v[154:155], v[24:25]
  v_pk_mul_f32 v[156:157], v[156:157], v[24:25]
  v_pk_mul_f32 v[158:159], v[158:159], v[24:25]
  v_cvt_pk_bf16_f32 v152, v152, v153
  v_cvt_pk_bf16_f32 v153, v154, v155
  v_cvt_pk_bf16_f32 v154, v156, v157
  v_cvt_pk_bf16_f32 v155, v158, v159
  buffer_store_dwordx4 v[152:155], v2, s[16:19], s57 offen offset:0 sc1
  s_lshl_b32 s34, s32, 4
  s_add_u32 s34, s34, s33
  s_lshl_b32 s34, s34, 7
  s_add_u32 s34, s34, 32768
  s_mov_b32 s63, 0x70000000
Lp3:
  v_accvgpr_read_b32 v16, a230
  v_accvgpr_read_b32 v17, a231
  v_accvgpr_read_b32 v18, a232
  v_accvgpr_read_b32 v19, a233
  v_accvgpr_read_b32 v20, a234
  v_accvgpr_read_b32 v21, a235
  s_mov_b32 s89, 0
  s_mov_b32 s91, 4294901760
  s_mov_b32 s92, 32768
  s_mov_b32 s89, 1
  s_mov_b32 s69, 0
  s_mov_b32 s71, 4294934528
  s_mov_b32 s72, 16384
  s_waitcnt vmcnt(28)
  s_barrier
  ds_read_b128 a[0:3], v16 offset:0
  ds_read_b64_tr_b16 a[32:33], v18 offset:0
  ds_read_b64_tr_b16 a[34:35], v18 offset:2048
  ds_read_b128 a[4:7], v16 offset:2048
  ds_read_b128 a[8:11], v16 offset:4096
  ds_read_b128 a[12:15], v16 offset:6144
  ds_read_b64_tr_b16 a[36:37], v19 offset:0
  ds_read_b64_tr_b16 a[38:39], v19 offset:2048
  ds_read_b64_tr_b16 a[40:41], v20 offset:0
  ds_read_b64_tr_b16 a[42:43], v20 offset:2048
  ds_read_b64_tr_b16 a[44:45], v21 offset:0
  ds_read_b64_tr_b16 a[46:47], v21 offset:2048
  ds_read_b64_tr_b16 a[48:49], v18 offset:8192
  ds_read_b64_tr_b16 a[50:51], v18 offset:10240
  ds_read_b64_tr_b16 a[52:53], v19 offset:8192
  ds_read_b64_tr_b16 a[54:55], v19 offset:10240
  ds_read_b64_tr_b16 a[56:57], v20 offset:8192
  ds_read_b64_tr_b16 a[58:59], v20 offset:10240
  ds_read_b64_tr_b16 a[60:61], v21 offset:8192
  ds_read_b64_tr_b16 a[62:63], v21 offset:10240
  s_waitcnt lgkmcnt(0)
  v_mfma_f32_16x16x32_bf16 v[32:35], a[32:35], a[0:3], 0
  s_add_u32 s60, s63, 32768
  buffer_store_dwordx4 v[192:195], v2, s[16:19], s60 offen offset:0 sc1
  ds_read_b128 a[16:19], v17 offset:0
  v_mfma_f32_16x16x32_bf16 v[64:67], a[32:35], a[4:7], 0
  s_add_u32 s60, s63, 40960
  ds_read_b64_tr_b16 a[64:65], v18 offset:4096
  v_mfma_f32_16x16x32_bf16 v[96:99], a[32:35], a[8:11], 0
  ds_read_b64_tr_b16 a[66:67], v18 offset:6144
  v_mfma_f32_16x16x32_bf16 v[128:131], a[32:35], a[12:15], 0
  buffer_store_dwordx4 v[224:227], v2, s[16:19], s60 offen offset:0 sc1
  ds_read_b128 a[20:23], v17 offset:2048
  v_mfma_f32_16x16x32_bf16 v[36:39], a[36:39], a[0:3], 0
  s_add_u32 s60, s63, 32768
  ds_read_b128 a[24:27], v17 offset:4096
  v_mfma_f32_16x16x32_bf16 v[68:71], a[36:39], a[4:7], 0
  ds_read_b128 a[28:31], v17 offset:6144
  v_mfma_f32_16x16x32_bf16 v[100:103], a[36:39], a[8:11], 0
  buffer_store_dwordx4 v[196:199], v2, s[16:19], s60 offen offset:1024 sc1
  ds_read_b64_tr_b16 a[68:69], v19 offset:4096
  v_mfma_f32_16x16x32_bf16 v[132:135], a[36:39], a[12:15], 0
  s_add_u32 s60, s63, 40960
  ds_read_b64_tr_b16 a[70:71], v19 offset:6144
  v_mfma_f32_16x16x32_bf16 v[40:43], a[40:43], a[0:3], 0
  ds_read_b64_tr_b16 a[72:73], v20 offset:4096
  v_mfma_f32_16x16x32_bf16 v[72:75], a[40:43], a[4:7], 0
  buffer_store_dwordx4 v[228:231], v2, s[16:19], s60 offen offset:1024 sc1
  ds_read_b64_tr_b16 a[74:75], v20 offset:6144
  v_mfma_f32_16x16x32_bf16 v[104:107], a[40:43], a[8:11], 0
  s_add_u32 s60, s63, 32768
  v_mfma_f32_16x16x32_bf16 v[136:139], a[40:43], a[12:15], 0
  ds_read_b64_tr_b16 a[76:77], v21 offset:4096
  v_mfma_f32_16x16x32_bf16 v[44:47], a[44:47], a[0:3], 0
  buffer_store_dwordx4 v[200:203], v2, s[16:19], s60 offen offset:2048 sc1
  ds_read_b64_tr_b16 a[78:79], v21 offset:6144
  v_mfma_f32_16x16x32_bf16 v[76:79], a[44:47], a[4:7], 0
  s_add_u32 s60, s63, 40960
  ds_read_b64_tr_b16 a[80:81], v18 offset:12288
  v_mfma_f32_16x16x32_bf16 v[108:111], a[44:47], a[8:11], 0
  ds_read_b64_tr_b16 a[82:83], v18 offset:14336
  v_mfma_f32_16x16x32_bf16 v[140:143], a[44:47], a[12:15], 0
  buffer_store_dwordx4 v[232:235], v2, s[16:19], s60 offen offset:2048 sc1
  ds_read_b64_tr_b16 a[84:85], v19 offset:12288
  v_mfma_f32_16x16x32_bf16 v[48:51], a[48:51], a[0:3], 0
  s_add_u32 s60, s63, 32768
  ds_read_b64_tr_b16 a[86:87], v19 offset:14336
  v_mfma_f32_16x16x32_bf16 v[80:83], a[48:51], a[4:7], 0
  ds_read_b64_tr_b16 a[88:89], v20 offset:12288
  v_mfma_f32_16x16x32_bf16 v[112:115], a[48:51], a[8:11], 0
  buffer_store_dwordx4 v[204:207], v2, s[16:19], s60 offen offset:3072 sc1
  ds_read_b64_tr_b16 a[90:91], v20 offset:14336
  v_mfma_f32_16x16x32_bf16 v[144:147], a[48:51], a[12:15], 0
  s_add_u32 s60, s63, 40960
  ds_read_b64_tr_b16 a[92:93], v21 offset:12288
  v_mfma_f32_16x16x32_bf16 v[52:55], a[52:55], a[0:3], 0
  ds_read_b64_tr_b16 a[94:95], v21 offset:14336
  v_mfma_f32_16x16x32_bf16 v[84:87], a[52:55], a[4:7], 0
  buffer_store_dwordx4 v[236:239], v2, s[16:19], s60 offen offset:3072 sc1
  v_mfma_f32_16x16x32_bf16 v[116:119], a[52:55], a[8:11], 0
  s_add_u32 s89, s89, 1
  s_cmp_eq_u32 s89, 3
  s_cselect_b32 s89, 0, s89
  s_cselect_b32 s90, s91, s92
  v_mfma_f32_16x16x32_bf16 v[148:151], a[52:55], a[12:15], 0
  s_add_u32 s69, s69, 1
  s_cmp_eq_u32 s69, 3
  s_cselect_b32 s69, 0, s69
  s_cselect_b32 s70, s71, s72
  v_mfma_f32_16x16x32_bf16 v[56:59], a[56:59], a[0:3], 0
  v_add_u32 v16, s90, v16
  v_add_u32 v17, s90, v17
  v_mfma_f32_16x16x32_bf16 v[88:91], a[56:59], a[4:7], 0
  v_add_u32 v18, s70, v18
  v_add_u32 v19, s70, v19
  v_mfma_f32_16x16x32_bf16 v[120:123], a[56:59], a[8:11], 0
  v_add_u32 v20, s70, v20
  v_add_u32 v21, s70, v21
  v_mfma_f32_16x16x32_bf16 v[152:155], a[56:59], a[12:15], 0
  v_mfma_f32_16x16x32_bf16 v[60:63], a[60:63], a[0:3], 0
  v_mfma_f32_16x16x32_bf16 v[92:95], a[60:63], a[4:7], 0
  v_mfma_f32_16x16x32_bf16 v[124:127], a[60:63], a[8:11], 0
  v_mfma_f32_16x16x32_bf16 v[156:159], a[60:63], a[12:15], 0
  s_waitcnt vmcnt(20) lgkmcnt(0)
  s_barrier
  v_mfma_f32_16x16x32_bf16 v[32:35], a[64:67], a[16:19], v[32:35]
  s_mov_b32 m0, s68
  ds_read_b128 a[0:3], v16 offset:0
  v_mfma_f32_16x16x32_bf16 v[64:67], a[64:67], a[20:23], v[64:67]
  buffer_load_dwordx4 v8, s[20:23], s28 offen offset:0 lds
  ds_read_b64_tr_b16 a[32:33], v18 offset:0
  v_mfma_f32_16x16x32_bf16 v[96:99], a[64:67], a[24:27], v[96:99]
  ds_read_b64_tr_b16 a[34:35], v18 offset:2048
  v_mfma_f32_16x16x32_bf16 v[128:131], a[64:67], a[28:31], v[128:131]
  ds_read_b128 a[4:7], v16 offset:2048
  v_mfma_f32_16x16x32_bf16 v[36:39], a[68:71], a[16:19], v[36:39]
  ds_read_b128 a[8:11], v16 offset:4096
  v_mfma_f32_16x16x32_bf16 v[68:71], a[68:71], a[20:23], v[68:71]
  buffer_load_dwordx4 v9, s[20:23], s28 offen offset:1024 lds
  ds_read_b128 a[12:15], v16 offset:6144
  v_mfma_f32_16x16x32_bf16 v[100:103], a[68:71], a[24:27], v[100:103]
  ds_read_b64_tr_b16 a[36:37], v19 offset:0
  v_mfma_f32_16x16x32_bf16 v[132:135], a[68:71], a[28:31], v[132:135]
  ds_read_b64_tr_b16 a[38:39], v19 offset:2048
  v_mfma_f32_16x16x32_bf16 v[40:43], a[72:75], a[16:19], v[40:43]
  ds_read_b64_tr_b16 a[40:41], v20 offset:0
  v_mfma_f32_16x16x32_bf16 v[72:75], a[72:75], a[20:23], v[72:75]
  ds_read_b64_tr_b16 a[42:43], v20 offset:2048
  v_mfma_f32_16x16x32_bf16 v[104:107], a[72:75], a[24:27], v[104:107]
  buffer_load_dwordx4 v10, s[20:23], s28 offen offset:2048 lds
  v_mfma_f32_16x16x32_bf16 v[136:139], a[72:75], a[28:31], v[136:139]
  ds_read_b64_tr_b16 a[44:45], v21 offset:0
  v_mfma_f32_16x16x32_bf16 v[44:47], a[76:79], a[16:19], v[44:47]
  ds_read_b64_tr_b16 a[46:47], v21 offset:2048
  v_mfma_f32_16x16x32_bf16 v[76:79], a[76:79], a[20:23], v[76:79]
  ds_read_b64_tr_b16 a[48:49], v18 offset:8192
  v_mfma_f32_16x16x32_bf16 v[108:111], a[76:79], a[24:27], v[108:111]
  ds_read_b64_tr_b16 a[50:51], v18 offset:10240
  v_mfma_f32_16x16x32_bf16 v[140:143], a[76:79], a[28:31], v[140:143]
  buffer_load_dwordx4 v11, s[20:23], s28 offen offset:3072 lds
  ds_read_b64_tr_b16 a[52:53], v19 offset:8192
  v_mfma_f32_16x16x32_bf16 v[48:51], a[80:83], a[16:19], v[48:51]
  s_bfe_u32 s56, 0x302010e, s55
  s_add_u32 s54, s54, s56
  s_add_u32 s55, s55, 8
  v_mfma_f32_16x16x32_bf16 v[80:83], a[80:83], a[20:23], v[80:83]
  s_and_b32 s55, s55, 0x8001f
  s_and_b32 s54, s54, 15
  s_lshl_b32 s28, s54, 19
  v_mfma_f32_16x16x32_bf16 v[112:115], a[80:83], a[24:27], v[112:115]
  s_mov_b32 m0, s88
  ds_read_b64_tr_b16 a[54:55], v19 offset:10240
  ds_read_b64_tr_b16 a[56:57], v20 offset:8192
  v_mfma_f32_16x16x32_bf16 v[144:147], a[80:83], a[28:31], v[144:147]
  ds_read_b64_tr_b16 a[58:59], v20 offset:10240
  ds_read_b64_tr_b16 a[60:61], v21 offset:8192
  v_mfma_f32_16x16x32_bf16 v[52:55], a[84:87], a[16:19], v[52:55]
  buffer_load_dwordx4 v4, s[8:11], s26 offen offset:0 lds
  ds_read_b64_tr_b16 a[62:63], v21 offset:10240
  v_mfma_f32_16x16x32_bf16 v[84:87], a[84:87], a[20:23], v[84:87]
  v_mfma_f32_16x16x32_bf16 v[116:119], a[84:87], a[24:27], v[116:119]
  v_mfma_f32_16x16x32_bf16 v[148:151], a[84:87], a[28:31], v[148:151]
  v_mfma_f32_16x16x32_bf16 v[56:59], a[88:91], a[16:19], v[56:59]
  v_mfma_f32_16x16x32_bf16 v[88:91], a[88:91], a[20:23], v[88:91]
  buffer_load_dwordx4 v5, s[8:11], s26 offen offset:1024 lds
  v_mfma_f32_16x16x32_bf16 v[120:123], a[88:91], a[24:27], v[120:123]
  v_mfma_f32_16x16x32_bf16 v[152:155], a[88:91], a[28:31], v[152:155]
  v_mfma_f32_16x16x32_bf16 v[60:63], a[92:95], a[16:19], v[60:63]
  v_mfma_f32_16x16x32_bf16 v[92:95], a[92:95], a[20:23], v[92:95]
  v_mfma_f32_16x16x32_bf16 v[124:127], a[92:95], a[24:27], v[124:127]
  v_mfma_f32_16x16x32_bf16 v[156:159], a[92:95], a[28:31], v[156:159]
  s_waitcnt lgkmcnt(0)
  v_mfma_f32_16x16x32_bf16 v[32:35], a[32:35], a[0:3], v[32:35]
  buffer_load_dwordx4 v6, s[8:11], s26 offen offset:2048 lds
  ds_read_b128 a[16:19], v17 offset:0
  v_mfma_f32_16x16x32_bf16 v[64:67], a[32:35], a[4:7], v[64:67]
  ds_read_b64_tr_b16 a[64:65], v18 offset:4096
  v_mfma_f32_16x16x32_bf16 v[96:99], a[32:35], a[8:11], v[96:99]
  ds_read_b64_tr_b16 a[66:67], v18 offset:6144
  v_mfma_f32_16x16x32_bf16 v[128:131], a[32:35], a[12:15], v[128:131]
  ds_read_b128 a[20:23], v17 offset:2048
  v_mfma_f32_16x16x32_bf16 v[36:39], a[36:39], a[0:3], v[36:39]
  buffer_load_dwordx4 v7, s[8:11], s26 offen offset:3072 lds
  ds_read_b128 a[24:27], v17 offset:4096
  v_mfma_f32_16x16x32_bf16 v[68:71], a[36:39], a[4:7], v[68:71]
  s_add_u32 m0, s88, 4096
  ds_read_b128 a[28:31], v17 offset:6144
  v_mfma_f32_16x16x32_bf16 v[100:103], a[36:39], a[8:11], v[100:103]
  ds_read_b64_tr_b16 a[68:69], v19 offset:4096
  v_mfma_f32_16x16x32_bf16 v[132:135], a[36:39], a[12:15], v[132:135]
  ds_read_b64_tr_b16 a[70:71], v19 offset:6144
  v_mfma_f32_16x16x32_bf16 v[40:43], a[40:43], a[0:3], v[40:43]
  buffer_load_dwordx4 v4, s[8:11], s27 offen offset:0 lds
  ds_read_b64_tr_b16 a[72:73], v20 offset:4096
  v_mfma_f32_16x16x32_bf16 v[72:75], a[40:43], a[4:7], v[72:75]
  ds_read_b64_tr_b16 a[74:75], v20 offset:6144
  v_mfma_f32_16x16x32_bf16 v[104:107], a[40:43], a[8:11], v[104:107]
  v_mfma_f32_16x16x32_bf16 v[136:139], a[40:43], a[12:15], v[136:139]
  ds_read_b64_tr_b16 a[76:77], v21 offset:4096
  v_mfma_f32_16x16x32_bf16 v[44:47], a[44:47], a[0:3], v[44:47]
  buffer_load_dwordx4 v5, s[8:11], s27 offen offset:1024 lds
  ds_read_b64_tr_b16 a[78:79], v21 offset:6144
  v_mfma_f32_16x16x32_bf16 v[76:79], a[44:47], a[4:7], v[76:79]
  ds_read_b64_tr_b16 a[80:81], v18 offset:12288
  v_mfma_f32_16x16x32_bf16 v[108:111], a[44:47], a[8:11], v[108:111]
  ds_read_b64_tr_b16 a[82:83], v18 offset:14336
  v_mfma_f32_16x16x32_bf16 v[140:143], a[44:47], a[12:15], v[140:143]
  ds_read_b64_tr_b16 a[84:85], v19 offset:12288
  v_mfma_f32_16x16x32_bf16 v[48:51], a[48:51], a[0:3], v[48:51]
  buffer_load_dwordx4 v6, s[8:11], s27 offen offset:2048 lds
  ds_read_b64_tr_b16 a[86:87], v19 offset:14336
  v_mfma_f32_16x16x32_bf16 v[80:83], a[48:51], a[4:7], v[80:83]
  ds_read_b64_tr_b16 a[88:89], v20 offset:12288
  v_mfma_f32_16x16x32_bf16 v[112:115], a[48:51], a[8:11], v[112:115]
  ds_read_b64_tr_b16 a[90:91], v20 offset:14336
  v_mfma_f32_16x16x32_bf16 v[144:147], a[48:51], a[12:15], v[144:147]
  ds_read_b64_tr_b16 a[92:93], v21 offset:12288
  v_mfma_f32_16x16x32_bf16 v[52:55], a[52:55], a[0:3], v[52:55]
  buffer_load_dwordx4 v7, s[8:11], s27 offen offset:3072 lds
  ds_read_b64_tr_b16 a[94:95], v21 offset:14336
  v_mfma_f32_16x16x32_bf16 v[84:87], a[52:55], a[4:7], v[84:87]
  s_bfe_u32 s29, 0x302010e, s53
  s_add_u32 s52, s52, s29
  s_add_u32 s53, s53, 8
  v_mfma_f32_16x16x32_bf16 v[116:119], a[52:55], a[8:11], v[116:119]
  s_and_b32 s53, s53, 0x8001f
  s_and_b32 s52, s52, 15
  s_lshl_b32 s29, s52, 7
  v_mfma_f32_16x16x32_bf16 v[148:151], a[52:55], a[12:15], v[148:151]
  s_or_b32 s26, s30, s29
  s_or_b32 s27, s31, s29
  v_mfma_f32_16x16x32_bf16 v[56:59], a[56:59], a[0:3], v[56:59]
  s_add_u32 s88, s88, s90
  s_add_u32 s89, s89, 1
  s_cmp_eq_u32 s89, 3
  s_cselect_b32 s89, 0, s89
  s_cselect_b32 s90, s91, s92
  v_mfma_f32_16x16x32_bf16 v[88:91], a[56:59], a[4:7], v[88:91]
  s_add_u32 s68, s68, s70
  s_add_u32 s69, s69, 1
  s_cmp_eq_u32 s69, 3
  s_cselect_b32 s69, 0, s69
  s_cselect_b32 s70, s71, s72
  v_mfma_f32_16x16x32_bf16 v[120:123], a[56:59], a[8:11], v[120:123]
  v_add_u32 v16, s90, v16
  v_add_u32 v17, s90, v17
  v_mfma_f32_16x16x32_bf16 v[152:155], a[56:59], a[12:15], v[152:155]
  v_add_u32 v18, s70, v18
  v_add_u32 v19, s70, v19
  v_mfma_f32_16x16x32_bf16 v[60:63], a[60:63], a[0:3], v[60:63]
  v_add_u32 v20, s70, v20
  v_add_u32 v21, s70, v21
  v_mfma_f32_16x16x32_bf16 v[92:95], a[60:63], a[4:7], v[92:95]
  v_mfma_f32_16x16x32_bf16 v[124:127], a[60:63], a[8:11], v[124:127]
  v_mfma_f32_16x16x32_bf16 v[156:159], a[60:63], a[12:15], v[156:159]
  s_waitcnt vmcnt(20) lgkmcnt(0)
  s_barrier
  v_mfma_f32_16x16x32_bf16 v[32:35], a[64:67], a[16:19], v[32:35]
  s_mov_b32 m0, s68
  ds_read_b128 a[0:3], v16 offset:0
  v_mfma_f32_16x16x32_bf16 v[64:67], a[64:67], a[20:23], v[64:67]
  buffer_load_dwordx4 v8, s[20:23], s28 offen offset:0 lds
  ds_read_b64_tr_b16 a[32:33], v18 offset:0
  v_mfma_f32_16x16x32_bf16 v[96:99], a[64:67], a[24:27], v[96:99]
  ds_read_b64_tr_b16 a[34:35], v18 offset:2048
  v_mfma_f32_16x16x32_bf16 v[128:131], a[64:67], a[28:31], v[128:131]
  buffer_load_dwordx4 v9, s[20:23], s28 offen offset:1024 lds
  ds_read_b128 a[4:7], v16 offset:2048
  v_mfma_f32_16x16x32_bf16 v[36:39], a[68:71], a[16:19], v[36:39]
  ds_read_b128 a[8:11], v16 offset:4096
  v_mfma_f32_16x16x32_bf16 v[68:71], a[68:71], a[20:23], v[68:71]
  ds_read_b128 a[12:15], v16 offset:6144
  v_mfma_f32_16x16x32_bf16 v[100:103], a[68:71], a[24:27], v[100:103]
  buffer_load_dwordx4 v10, s[20:23], s28 offen offset:2048 lds
  ds_read_b64_tr_b16 a[36:37], v19 offset:0
  v_mfma_f32_16x16x32_bf16 v[132:135], a[68:71], a[28:31], v[132:135]
  ds_read_b64_tr_b16 a[38:39], v19 offset:2048
  v_mfma_f32_16x16x32_bf16 v[40:43], a[72:75], a[16:19], v[40:43]
  ds_read_b64_tr_b16 a[40:41], v20 offset:0
  v_mfma_f32_16x16x32_bf16 v[72:75], a[72:75], a[20:23], v[72:75]
  buffer_load_dwordx4 v11, s[20:23], s28 offen offset:3072 lds
  ds_read_b64_tr_b16 a[42:43], v20 offset:2048
  v_mfma_f32_16x16x32_bf16 v[104:107], a[72:75], a[24:27], v[104:107]
  s_bfe_u32 s56, 0x302010e, s55
  s_add_u32 s54, s54, s56
  s_add_u32 s55, s55, 8
  v_mfma_f32_16x16x32_bf16 v[136:139], a[72:75], a[28:31], v[136:139]
  s_and_b32 s55, s55, 0x8001f
  s_and_b32 s54, s54, 15
  s_lshl_b32 s28, s54, 19
  v_mfma_f32_16x16x32_bf16 v[44:47], a[76:79], a[16:19], v[44:47]
  s_mov_b32 m0, s88
  ds_read_b64_tr_b16 a[44:45], v21 offset:0
  ds_read_b64_tr_b16 a[46:47], v21 offset:2048
  v_mfma_f32_16x16x32_bf16 v[76:79], a[76:79], a[20:23], v[76:79]
  buffer_load_dwordx4 v4, s[8:11], s26 offen offset:0 lds
  ds_read_b64_tr_b16 a[48:49], v18 offset:8192
  v_mfma_f32_16x16x32_bf16 v[108:111], a[76:79], a[24:27], v[108:111]
  ds_read_b64_tr_b16 a[50:51], v18 offset:10240
  v_mfma_f32_16x16x32_bf16 v[140:143], a[76:79], a[28:31], v[140:143]
  buffer_load_dwordx4 v5, s[8:11], s26 offen offset:1024 lds
  ds_read_b64_tr_b16 a[52:53], v19 offset:8192
  v_mfma_f32_16x16x32_bf16 v[48:51], a[80:83], a[16:19], v[48:51]
  ds_read_b64_tr_b16 a[54:55], v19 offset:10240
  v_mfma_f32_16x16x32_bf16 v[80:83], a[80:83], a[20:23], v[80:83]
  ds_read_b64_tr_b16 a[56:57], v20 offset:8192
  v_mfma_f32_16x16x32_bf16 v[112:115], a[80:83], a[24:27], v[112:115]
  buffer_load_dwordx4 v6, s[8:11], s26 offen offset:2048 lds
  ds_read_b64_tr_b16 a[58:59], v20 offset:10240
  v_mfma_f32_16x16x32_bf16 v[144:147], a[80:83], a[28:31], v[144:147]
  ds_read_b64_tr_b16 a[60:61], v21 offset:8192
  v_mfma_f32_16x16x32_bf16 v[52:55], a[84:87], a[16:19], v[52:55]
  ds_read_b64_tr_b16 a[62:63], v21 offset:10240
  v_mfma_f32_16x16x32_bf16 v[84:87], a[84:87], a[20:23], v[84:87]
  buffer_load_dwordx4 v7, s[8:11], s26 offen offset:3072 lds
  v_mfma_f32_16x16x32_bf16 v[116:119], a[84:87], a[24:27], v[116:119]
  s_add_u32 m0, s88, 4096
  v_mfma_f32_16x16x32_bf16 v[148:151], a[84:87], a[28:31], v[148:151]
  v_mfma_f32_16x16x32_bf16 v[56:59], a[88:91], a[16:19], v[56:59]
  buffer_load_dwordx4 v4, s[8:11], s27 offen offset:0 lds
  v_mfma_f32_16x16x32_bf16 v[88:91], a[88:91], a[20:23], v[88:91]
  v_mfma_f32_16x16x32_bf16 v[120:123], a[88:91], a[24:27], v[120:123]
  v_mfma_f32_16x16x32_bf16 v[152:155], a[88:91], a[28:31], v[152:155]
  buffer_load_dwordx4 v5, s[8:11], s27 offen offset:1024 lds
  v_mfma_f32_16x16x32_bf16 v[60:63], a[92:95], a[16:19], v[60:63]
  v_mfma_f32_16x16x32_bf16 v[92:95], a[92:95], a[20:23], v[92:95]
  v_mfma_f32_16x16x32_bf16 v[124:127], a[92:95], a[24:27], v[124:127]
  v_mfma_f32_16x16x32_bf16 v[156:159], a[92:95], a[28:31], v[156:159]
  s_waitcnt lgkmcnt(0)
  v_mfma_f32_16x16x32_bf16 v[32:35], a[32:35], a[0:3], v[32:35]
  buffer_load_dwordx4 v6, s[8:11], s27 offen offset:2048 lds
  ds_read_b128 a[16:19], v17 offset:0
  v_mfma_f32_16x16x32_bf16 v[64:67], a[32:35], a[4:7], v[64:67]
  ds_read_b64_tr_b16 a[64:65], v18 offset:4096
  v_mfma_f32_16x16x32_bf16 v[96:99], a[32:35], a[8:11], v[96:99]
  buffer_load_dwordx4 v7, s[8:11], s27 offen offset:3072 lds
  ds_read_b64_tr_b16 a[66:67], v18 offset:6144
  v_mfma_f32_16x16x32_bf16 v[128:131], a[32:35], a[12:15], v[128:131]
  s_bfe_u32 s29, 0x302010e, s53
  s_add_u32 s52, s52, s29
  s_add_u32 s53, s53, 8
  v_mfma_f32_16x16x32_bf16 v[36:39], a[36:39], a[0:3], v[36:39]
  s_and_b32 s53, s53, 0x8001f
  s_and_b32 s52, s52, 15
  s_lshl_b32 s29, s52, 7
  v_mfma_f32_16x16x32_bf16 v[68:71], a[36:39], a[4:7], v[68:71]
  s_or_b32 s26, s30, s29
  s_or_b32 s27, s31, s29
  s_add_u32 s60, s63, 36864
  v_mfma_f32_16x16x32_bf16 v[100:103], a[36:39], a[8:11], v[100:103]
  buffer_store_dwordx4 v[208:211], v2, s[16:19], s60 offen offset:0 sc1
  ds_read_b128 a[20:23], v17 offset:2048
  v_mfma_f32_16x16x32_bf16 v[132:135], a[36:39], a[12:15], v[132:135]
  s_add_u32 s60, s63, 45056
  buffer_store_dwordx4 v[240:243], v2, s[16:19], s60 offen offset:0 sc1
  ds_read_b128 a[24:27], v17 offset:4096
  v_mfma_f32_16x16x32_bf16 v[40:43], a[40:43], a[0:3], v[40:43]
  s_add_u32 s60, s63, 36864
  ds_read_b128 a[28:31], v17 offset:6144
  ds_read_b64_tr_b16 a[68:69], v19 offset:4096
  v_mfma_f32_16x16x32_bf16 v[72:75], a[40:43], a[4:7], v[72:75]
  ds_read_b64_tr_b16 a[70:71], v19 offset:6144
  ds_read_b64_tr_b16 a[72:73], v20 offset:4096
  v_mfma_f32_16x16x32_bf16 v[104:107], a[40:43], a[8:11], v[104:107]
  buffer_store_dwordx4 v[212:215], v2, s[16:19], s60 offen offset:1024 sc1
  ds_read_b64_tr_b16 a[74:75], v20 offset:6144
  v_mfma_f32_16x16x32_bf16 v[136:139], a[40:43], a[12:15], v[136:139]
  s_add_u32 s60, s63, 45056
  ds_read_b64_tr_b16 a[76:77], v21 offset:4096
  v_mfma_f32_16x16x32_bf16 v[44:47], a[44:47], a[0:3], v[44:47]
  buffer_store_dwordx4 v[244:247], v2, s[16:19], s60 offen offset:1024 sc1
  ds_read_b64_tr_b16 a[78:79], v21 offset:6144
  v_mfma_f32_16x16x32_bf16 v[76:79], a[44:47], a[4:7], v[76:79]
  s_add_u32 s60, s63, 36864
  ds_read_b64_tr_b16 a[80:81], v18 offset:12288
  v_mfma_f32_16x16x32_bf16 v[108:111], a[44:47], a[8:11], v[108:111]
  ds_read_b64_tr_b16 a[82:83], v18 offset:14336
  v_mfma_f32_16x16x32_bf16 v[140:143], a[44:47], a[12:15], v[140:143]
  buffer_store_dwordx4 v[216:219], v2, s[16:19], s60 offen offset:2048 sc1
  ds_read_b64_tr_b16 a[84:85], v19 offset:12288
  v_mfma_f32_16x16x32_bf16 v[48:51], a[48:51], a[0:3], v[48:51]
  s_add_u32 s60, s63, 45056
  ds_read_b64_tr_b16 a[86:87], v19 offset:14336
  v_mfma_f32_16x16x32_bf16 v[80:83], a[48:51], a[4:7], v[80:83]
  buffer_store_dwordx4 v[248:251], v2, s[16:19], s60 offen offset:2048 sc1
  ds_read_b64_tr_b16 a[88:89], v20 offset:12288
  v_mfma_f32_16x16x32_bf16 v[112:115], a[48:51], a[8:11], v[112:115]
  s_add_u32 s60, s63, 36864
  ds_read_b64_tr_b16 a[90:91], v20 offset:14336
  v_mfma_f32_16x16x32_bf16 v[144:147], a[48:51], a[12:15], v[144:147]
  ds_read_b64_tr_b16 a[92:93], v21 offset:12288
  v_mfma_f32_16x16x32_bf16 v[52:55], a[52:55], a[0:3], v[52:55]
  buffer_store_dwordx4 v[220:223], v2, s[16:19], s60 offen offset:3072 sc1
  ds_read_b64_tr_b16 a[94:95], v21 offset:14336
  v_mfma_f32_16x16x32_bf16 v[84:87], a[52:55], a[4:7], v[84:87]
  s_add_u32 s60, s63, 45056
  v_mfma_f32_16x16x32_bf16 v[116:119], a[52:55], a[8:11], v[116:119]
  buffer_store_dwordx4 v[252:255], v2, s[16:19], s60 offen offset:3072 sc1
  v_mfma_f32_16x16x32_bf16 v[148:151], a[52:55], a[12:15], v[148:151]
  s_add_u32 s88, s88, s90
  s_add_u32 s89, s89, 1
  s_cmp_eq_u32 s89, 3
  s_cselect_b32 s89, 0, s89
  s_cselect_b32 s90, s91, s92
  v_mfma_f32_16x16x32_bf16 v[56:59], a[56:59], a[0:3], v[56:59]
  s_add_u32 s68, s68, s70
  s_add_u32 s69, s69, 1
  s_cmp_eq_u32 s69, 3
  s_cselect_b32 s69, 0, s69
  s_cselect_b32 s70, s71, s72
  v_mfma_f32_16x16x32_bf16 v[88:91], a[56:59], a[4:7], v[88:91]
  v_add_u32 v16, s90, v16
  v_add_u32 v17, s90, v17
  v_mfma_f32_16x16x32_bf16 v[120:123], a[56:59], a[8:11], v[120:123]
  v_add_u32 v18, s70, v18
  v_add_u32 v19, s70, v19
  v_mfma_f32_16x16x32_bf16 v[152:155], a[56:59], a[12:15], v[152:155]
  v_add_u32 v20, s70, v20
  v_add_u32 v21, s70, v21
  v_mfma_f32_16x16x32_bf16 v[60:63], a[60:63], a[0:3], v[60:63]
  v_mfma_f32_16x16x32_bf16 v[92:95], a[60:63], a[4:7], v[92:95]
  v_mfma_f32_16x16x32_bf16 v[124:127], a[60:63], a[8:11], v[124:127]
  v_mfma_f32_16x16x32_bf16 v[156:159], a[60:63], a[12:15], v[156:159]
  s_waitcnt vmcnt(20) lgkmcnt(0)
  s_barrier
  v_mfma_f32_16x16x32_bf16 v[32:35], a[64:67], a[16:19], v[32:35]
  s_mov_b32 m0, s68
  ds_read_b128 a[0:3], v16 offset:0
  v_mfma_f32_16x16x32_bf16 v[64:67], a[64:67], a[20:23], v[64:67]
  buffer_load_dwordx4 v8, s[20:23], s28 offen offset:0 lds
  ds_read_b64_tr_b16 a[32:33], v18 offset:0
  v_mfma_f32_16x16x32_bf16 v[96:99], a[64:67], a[24:27], v[96:99]
  ds_read_b64_tr_b16 a[34:35], v18 offset:2048
  v_mfma_f32_16x16x32_bf16 v[128:131], a[64:67], a[28:31], v[128:131]
  ds_read_b128 a[4:7], v16 offset:2048
  v_mfma_f32_16x16x32_bf16 v[36:39], a[68:71], a[16:19], v[36:39]
  ds_read_b128 a[8:11], v16 offset:4096
  v_mfma_f32_16x16x32_bf16 v[68:71], a[68:71], a[20:23], v[68:71]
  buffer_load_dwordx4 v9, s[20:23], s28 offen offset:1024 lds
  ds_read_b128 a[12:15], v16 offset:6144
  v_mfma_f32_16x16x32_bf16 v[100:103], a[68:71], a[24:27], v[100:103]
  ds_read_b64_tr_b16 a[36:37], v19 offset:0
  v_mfma_f32_16x16x32_bf16 v[132:135], a[68:71], a[28:31], v[132:135]
  ds_read_b64_tr_b16 a[38:39], v19 offset:2048
  v_mfma_f32_16x16x32_bf16 v[40:43], a[72:75], a[16:19], v[40:43]
  ds_read_b64_tr_b16 a[40:41], v20 offset:0
  v_mfma_f32_16x16x32_bf16 v[72:75], a[72:75], a[20:23], v[72:75]
  ds_read_b64_tr_b16 a[42:43], v20 offset:2048
  v_mfma_f32_16x16x32_bf16 v[104:107], a[72:75], a[24:27], v[104:107]
  buffer_load_dwordx4 v10, s[20:23], s28 offen offset:2048 lds
  v_mfma_f32_16x16x32_bf16 v[136:139], a[72:75], a[28:31], v[136:139]
  ds_read_b64_tr_b16 a[44:45], v21 offset:0
  v_mfma_f32_16x16x32_bf16 v[44:47], a[76:79], a[16:19], v[44:47]
  ds_read_b64_tr_b16 a[46:47], v21 offset:2048
  v_mfma_f32_16x16x32_bf16 v[76:79], a[76:79], a[20:23], v[76:79]
  ds_read_b64_tr_b16 a[48:49], v18 offset:8192
  v_mfma_f32_16x16x32_bf16 v[108:111], a[76:79], a[24:27], v[108:111]
  ds_read_b64_tr_b16 a[50:51], v18 offset:10240
  v_mfma_f32_16x16x32_bf16 v[140:143], a[76:79], a[28:31], v[140:143]
  buffer_load_dwordx4 v11, s[20:23], s28 offen offset:3072 lds
  ds_read_b64_tr_b16 a[52:53], v19 offset:8192
  v_mfma_f32_16x16x32_bf16 v[48:51], a[80:83], a[16:19], v[48:51]
  s_bfe_u32 s56, 0x302010e, s55
  s_add_u32 s54, s54, s56
  s_add_u32 s55, s55, 8
  v_mfma_f32_16x16x32_bf16 v[80:83], a[80:83], a[20:23], v[80:83]
  s_and_b32 s55, s55, 0x8001f
  s_and_b32 s54, s54, 15
  s_lshl_b32 s28, s54, 19
  v_mfma_f32_16x16x32_bf16 v[112:115], a[80:83], a[24:27], v[112:115]
  s_mov_b32 m0, s88
  ds_read_b64_tr_b16 a[54:55], v19 offset:10240
  ds_read_b64_tr_b16 a[56:57], v20 offset:8192
  v_mfma_f32_16x16x32_bf16 v[144:147], a[80:83], a[28:31], v[144:147]
  ds_read_b64_tr_b16 a[58:59], v20 offset:10240
  ds_read_b64_tr_b16 a[60:61], v21 offset:8192
  v_mfma_f32_16x16x32_bf16 v[52:55], a[84:87], a[16:19], v[52:55]
  buffer_load_dwordx4 v4, s[8:11], s26 offen offset:0 lds
  ds_read_b64_tr_b16 a[62:63], v21 offset:10240
  v_mfma_f32_16x16x32_bf16 v[84:87], a[84:87], a[20:23], v[84:87]
  v_mfma_f32_16x16x32_bf16 v[116:119], a[84:87], a[24:27], v[116:119]
  v_mfma_f32_16x16x32_bf16 v[148:151], a[84:87], a[28:31], v[148:151]
  v_mfma_f32_16x16x32_bf16 v[56:59], a[88:91], a[16:19], v[56:59]
  v_mfma_f32_16x16x32_bf16 v[88:91], a[88:91], a[20:23], v[88:91]
  buffer_load_dwordx4 v5, s[8:11], s26 offen offset:1024 lds
  v_mfma_f32_16x16x32_bf16 v[120:123], a[88:91], a[24:27], v[120:123]
  v_mfma_f32_16x16x32_bf16 v[152:155], a[88:91], a[28:31], v[152:155]
  v_mfma_f32_16x16x32_bf16 v[60:63], a[92:95], a[16:19], v[60:63]
  v_mfma_f32_16x16x32_bf16 v[92:95], a[92:95], a[20:23], v[92:95]
  v_mfma_f32_16x16x32_bf16 v[124:127], a[92:95], a[24:27], v[124:127]
  v_mfma_f32_16x16x32_bf16 v[156:159], a[92:95], a[28:31], v[156:159]
  s_waitcnt lgkmcnt(0)
  v_mfma_f32_16x16x32_bf16 v[32:35], a[32:35], a[0:3], v[32:35]
  buffer_load_dwordx4 v6, s[8:11], s26 offen offset:2048 lds
  ds_read_b128 a[16:19], v17 offset:0
  v_mfma_f32_16x16x32_bf16 v[64:67], a[32:35], a[4:7], v[64:67]
  ds_read_b64_tr_b16 a[64:65], v18 offset:4096
  v_mfma_f32_16x16x32_bf16 v[96:99], a[32:35], a[8:11], v[96:99]
  ds_read_b64_tr_b16 a[66:67], v18 offset:6144
  v_mfma_f32_16x16x32_bf16 v[128:131], a[32:35], a[12:15], v[128:131]
  ds_read_b128 a[20:23], v17 offset:2048
  v_mfma_f32_16x16x32_bf16 v[36:39], a[36:39], a[0:3], v[36:39]
  buffer_load_dwordx4 v7, s[8:11], s26 offen offset:3072 lds
  ds_read_b128 a[24:27], v17 offset:4096
  v_mfma_f32_16x16x32_bf16 v[68:71], a[36:39], a[4:7], v[68:71]
  s_add_u32 m0, s88, 4096
  ds_read_b128 a[28:31], v17 offset:6144
  v_mfma_f32_16x16x32_bf16 v[100:103], a[36:39], a[8:11], v[100:103]
  ds_read_b64_tr_b16 a[68:69], v19 offset:4096
  v_mfma_f32_16x16x32_bf16 v[132:135], a[36:39], a[12:15], v[132:135]
  ds_read_b64_tr_b16 a[70:71], v19 offset:6144
  v_mfma_f32_16x16x32_bf16 v[40:43], a[40:43], a[0:3], v[40:43]
  buffer_load_dwordx4 v4, s[8:11], s27 offen offset:0 lds
  ds_read_b64_tr_b16 a[72:73], v20 offset:4096
  v_mfma_f32_16x16x32_bf16 v[72:75], a[40:43], a[4:7], v[72:75]
  ds_read_b64_tr_b16 a[74:75], v20 offset:6144
  v_mfma_f32_16x16x32_bf16 v[104:107], a[40:43], a[8:11], v[104:107]
  v_mfma_f32_16x16x32_bf16 v[136:139], a[40:43], a[12:15], v[136:139]
  ds_read_b64_tr_b16 a[76:77], v21 offset:4096
  v_mfma_f32_16x16x32_bf16 v[44:47], a[44:47], a[0:3], v[44:47]
  buffer_load_dwordx4 v5, s[8:11], s27 offen offset:1024 lds
  ds_read_b64_tr_b16 a[78:79], v21 offset:6144
  v_mfma_f32_16x16x32_bf16 v[76:79], a[44:47], a[4:7], v[76:79]
  ds_read_b64_tr_b16 a[80:81], v18 offset:12288
  v_mfma_f32_16x16x32_bf16 v[108:111], a[44:47], a[8:11], v[108:111]
  ds_read_b64_tr_b16 a[82:83], v18 offset:14336
  v_mfma_f32_16x16x32_bf16 v[140:143], a[44:47], a[12:15], v[140:143]
  ds_read_b64_tr_b16 a[84:85], v19 offset:12288
  v_mfma_f32_16x16x32_bf16 v[48:51], a[48:51], a[0:3], v[48:51]
  buffer_load_dwordx4 v6, s[8:11], s27 offen offset:2048 lds
  ds_read_b64_tr_b16 a[86:87], v19 offset:14336
  v_mfma_f32_16x16x32_bf16 v[80:83], a[48:51], a[4:7], v[80:83]
  ds_read_b64_tr_b16 a[88:89], v20 offset:12288
  v_mfma_f32_16x16x32_bf16 v[112:115], a[48:51], a[8:11], v[112:115]
  ds_read_b64_tr_b16 a[90:91], v20 offset:14336
  v_mfma_f32_16x16x32_bf16 v[144:147], a[48:51], a[12:15], v[144:147]
  ds_read_b64_tr_b16 a[92:93], v21 offset:12288
  v_mfma_f32_16x16x32_bf16 v[52:55], a[52:55], a[0:3], v[52:55]
  buffer_load_dwordx4 v7, s[8:11], s27 offen offset:3072 lds
  ds_read_b64_tr_b16 a[94:95], v21 offset:14336
  v_mfma_f32_16x16x32_bf16 v[84:87], a[52:55], a[4:7], v[84:87]
  s_bfe_u32 s29, 0x302010e, s53
  s_add_u32 s52, s52, s29
  s_add_u32 s53, s53, 8
  v_mfma_f32_16x16x32_bf16 v[116:119], a[52:55], a[8:11], v[116:119]
  s_and_b32 s53, s53, 0x8001f
  s_and_b32 s52, s52, 15
  s_lshl_b32 s29, s52, 7
  v_mfma_f32_16x16x32_bf16 v[148:151], a[52:55], a[12:15], v[148:151]
  s_or_b32 s26, s30, s29
  s_or_b32 s27, s31, s29
  v_mfma_f32_16x16x32_bf16 v[56:59], a[56:59], a[0:3], v[56:59]
  s_add_u32 s88, s88, s90
  s_add_u32 s89, s89, 1
  s_cmp_eq_u32 s89, 3
  s_cselect_b32 s89, 0, s89
  s_cselect_b32 s90, s91, s92
  v_mfma_f32_16x16x32_bf16 v[88:91], a[56:59], a[4:7], v[88:91]
  s_add_u32 s68, s68, s70
  s_add_u32 s69, s69, 1
  s_cmp_eq_u32 s69, 3
  s_cselect_b32 s69, 0, s69
  s_cselect_b32 s70, s71, s72
  v_mfma_f32_16x16x32_bf16 v[120:123], a[56:59], a[8:11], v[120:123]
  v_add_u32 v16, s90, v16
  v_add_u32 v17, s90, v17
  v_mfma_f32_16x16x32_bf16 v[152:155], a[56:59], a[12:15], v[152:155]
  v_add_u32 v18, s70, v18
  v_add_u32 v19, s70, v19
  v_mfma_f32_16x16x32_bf16 v[60:63], a[60:63], a[0:3], v[60:63]
  v_add_u32 v20, s70, v20
  v_add_u32 v21, s70, v21
  v_mfma_f32_16x16x32_bf16 v[92:95], a[60:63], a[4:7], v[92:95]
  v_mfma_f32_16x16x32_bf16 v[124:127], a[60:63], a[8:11], v[124:127]
  v_mfma_f32_16x16x32_bf16 v[156:159], a[60:63], a[12:15], v[156:159]
  s_waitcnt vmcnt(20) lgkmcnt(0)
  s_barrier
  v_mfma_f32_16x16x32_bf16 v[32:35], a[64:67], a[16:19], v[32:35]
  s_mov_b32 m0, s68
  ds_read_b128 a[0:3], v16 offset:0
  v_mfma_f32_16x16x32_bf16 v[64:67], a[64:67], a[20:23], v[64:67]
  buffer_load_dwordx4 v8, s[20:23], s28 offen offset:0 lds
  ds_read_b64_tr_b16 a[32:33], v18 offset:0
  v_mfma_f32_16x16x32_bf16 v[96:99], a[64:67], a[24:27], v[96:99]
  ds_read_b64_tr_b16 a[34:35], v18 offset:2048
  v_mfma_f32_16x16x32_bf16 v[128:131], a[64:67], a[28:31], v[128:131]
  buffer_load_dwordx4 v9, s[20:23], s28 offen offset:1024 lds
  ds_read_b128 a[4:7], v16 offset:2048
  v_mfma_f32_16x16x32_bf16 v[36:39], a[68:71], a[16:19], v[36:39]
  ds_read_b128 a[8:11], v16 offset:4096
  v_mfma_f32_16x16x32_bf16 v[68:71], a[68:71], a[20:23], v[68:71]
  ds_read_b128 a[12:15], v16 offset:6144
  v_mfma_f32_16x16x32_bf16 v[100:103], a[68:71], a[24:27], v[100:103]
  buffer_load_dwordx4 v10, s[20:23], s28 offen offset:2048 lds
  ds_read_b64_tr_b16 a[36:37], v19 offset:0
  v_mfma_f32_16x16x32_bf16 v[132:135], a[68:71], a[28:31], v[132:135]
  ds_read_b64_tr_b16 a[38:39], v19 offset:2048
  v_mfma_f32_16x16x32_bf16 v[40:43], a[72:75], a[16:19], v[40:43]
  ds_read_b64_tr_b16 a[40:41], v20 offset:0
  v_mfma_f32_16x16x32_bf16 v[72:75], a[72:75], a[20:23], v[72:75]
  buffer_load_dwordx4 v11, s[20:23], s28 offen offset:3072 lds
  ds_read_b64_tr_b16 a[42:43], v20 offset:2048
  v_mfma_f32_16x16x32_bf16 v[104:107], a[72:75], a[24:27], v[104:107]
  s_bfe_u32 s56, 0x302010e, s55
  s_add_u32 s54, s54, s56
  s_add_u32 s55, s55, 8
  v_mfma_f32_16x16x32_bf16 v[136:139], a[72:75], a[28:31], v[136:139]
  s_and_b32 s55, s55, 0x8001f
  s_and_b32 s54, s54, 15
  s_lshl_b32 s28, s54, 19
  v_mfma_f32_16x16x32_bf16 v[44:47], a[76:79], a[16:19], v[44:47]
  s_mov_b32 m0, s88
  ds_read_b64_tr_b16 a[44:45], v21 offset:0
  ds_read_b64_tr_b16 a[46:47], v21 offset:2048
  v_mfma_f32_16x16x32_bf16 v[76:79], a[76:79], a[20:23], v[76:79]
  buffer_load_dwordx4 v4, s[8:11], s26 offen offset:0 lds
  ds_read_b64_tr_b16 a[48:49], v18 offset:8192
  v_mfma_f32_16x16x32_bf16 v[108:111], a[76:79], a[24:27], v[108:111]
  ds_read_b64_tr_b16 a[50:51], v18 offset:10240
  v_mfma_f32_16x16x32_bf16 v[140:143], a[76:79], a[28:31], v[140:143]
  buffer_load_dwordx4 v5, s[8:11], s26 offen offset:1024 lds
  ds_read_b64_tr_b16 a[52:53], v19 offset:8192
  v_mfma_f32_16x16x32_bf16 v[48:51], a[80:83], a[16:19], v[48:51]
  ds_read_b64_tr_b16 a[54:55], v19 offset:10240
  v_mfma_f32_16x16x32_bf16 v[80:83], a[80:83], a[20:23], v[80:83]
  ds_read_b64_tr_b16 a[56:57], v20 offset:8192
  v_mfma_f32_16x16x32_bf16 v[112:115], a[80:83], a[24:27], v[112:115]
  buffer_load_dwordx4 v6, s[8:11], s26 offen offset:2048 lds
  ds_read_b64_tr_b16 a[58:59], v20 offset:10240
  v_mfma_f32_16x16x32_bf16 v[144:147], a[80:83], a[28:31], v[144:147]
  ds_read_b64_tr_b16 a[60:61], v21 offset:8192
  v_mfma_f32_16x16x32_bf16 v[52:55], a[84:87], a[16:19], v[52:55]
  ds_read_b64_tr_b16 a[62:63], v21 offset:10240
  v_mfma_f32_16x16x32_bf16 v[84:87], a[84:87], a[20:23], v[84:87]
  buffer_load_dwordx4 v7, s[8:11], s26 offen offset:3072 lds
  v_mfma_f32_16x16x32_bf16 v[116:119], a[84:87], a[24:27], v[116:119]
  s_add_u32 m0, s88, 4096
  v_mfma_f32_16x16x32_bf16 v[148:151], a[84:87], a[28:31], v[148:151]
  v_mfma_f32_16x16x32_bf16 v[56:59], a[88:91], a[16:19], v[56:59]
  buffer_load_dwordx4 v4, s[8:11], s27 offen offset:0 lds
  v_mfma_f32_16x16x32_bf16 v[88:91], a[88:91], a[20:23], v[88:91]
  v_mfma_f32_16x16x32_bf16 v[120:123], a[88:91], a[24:27], v[120:123]
  v_mfma_f32_16x16x32_bf16 v[152:155], a[88:91], a[28:31], v[152:155]
  buffer_load_dwordx4 v5, s[8:11], s27 offen offset:1024 lds
  v_mfma_f32_16x16x32_bf16 v[60:63], a[92:95], a[16:19], v[60:63]
  v_mfma_f32_16x16x32_bf16 v[92:95], a[92:95], a[20:23], v[92:95]
  v_mfma_f32_16x16x32_bf16 v[124:127], a[92:95], a[24:27], v[124:127]
  v_mfma_f32_16x16x32_bf16 v[156:159], a[92:95], a[28:31], v[156:159]
  s_waitcnt lgkmcnt(0)
  v_mfma_f32_16x16x32_bf16 v[32:35], a[32:35], a[0:3], v[32:35]
  buffer_load_dwordx4 v6, s[8:11], s27 offen offset:2048 lds
  ds_read_b128 a[16:19], v17 offset:0
  v_mfma_f32_16x16x32_bf16 v[64:67], a[32:35], a[4:7], v[64:67]
  ds_read_b64_tr_b16 a[64:65], v18 offset:4096
  v_mfma_f32_16x16x32_bf16 v[96:99], a[32:35], a[8:11], v[96:99]
  buffer_load_dwordx4 v7, s[8:11], s27 offen offset:3072 lds
  ds_read_b64_tr_b16 a[66:67], v18 offset:6144
  v_mfma_f32_16x16x32_bf16 v[128:131], a[32:35], a[12:15], v[128:131]
  s_bfe_u32 s29, 0x302010e, s53
  s_add_u32 s52, s52, s29
  s_add_u32 s53, s53, 8
  v_mfma_f32_16x16x32_bf16 v[36:39], a[36:39], a[0:3], v[36:39]
  s_and_b32 s53, s53, 0x8001f
  s_and_b32 s52, s52, 15
  s_lshl_b32 s29, s52, 7
  v_mfma_f32_16x16x32_bf16 v[68:71], a[36:39], a[4:7], v[68:71]
  s_or_b32 s26, s30, s29
  s_or_b32 s27, s31, s29
  s_add_u32 s60, s63, 0
  v_mfma_f32_16x16x32_bf16 v[100:103], a[36:39], a[8:11], v[100:103]
  buffer_store_dwordx4 v[160:163], v2, s[16:19], s60 offen offset:0 sc1
  ds_read_b128 a[20:23], v17 offset:2048
  v_mfma_f32_16x16x32_bf16 v[132:135], a[36:39], a[12:15], v[132:135]
  buffer_store_dwordx4 v[164:167], v2, s[16:19], s60 offen offset:1024 sc1
  ds_read_b128 a[24:27], v17 offset:4096
  v_mfma_f32_16x16x32_bf16 v[40:43], a[40:43], a[0:3], v[40:43]
  ds_read_b128 a[28:31], v17 offset:6144
  ds_read_b64_tr_b16 a[68:69], v19 offset:4096
  v_mfma_f32_16x16x32_bf16 v[72:75], a[40:43], a[4:7], v[72:75]
  ds_read_b64_tr_b16 a[70:71], v19 offset:6144
  ds_read_b64_tr_b16 a[72:73], v20 offset:4096
  v_mfma_f32_16x16x32_bf16 v[104:107], a[40:43], a[8:11], v[104:107]
  buffer_store_dwordx4 v[168:171], v2, s[16:19], s60 offen offset:2048 sc1
  ds_read_b64_tr_b16 a[74:75], v20 offset:6144
  v_mfma_f32_16x16x32_bf16 v[136:139], a[40:43], a[12:15], v[136:139]
  ds_read_b64_tr_b16 a[76:77], v21 offset:4096
  v_mfma_f32_16x16x32_bf16 v[44:47], a[44:47], a[0:3], v[44:47]
  buffer_store_dwordx4 v[172:175], v2, s[16:19], s60 offen offset:3072 sc1
  ds_read_b64_tr_b16 a[78:79], v21 offset:6144
  v_mfma_f32_16x16x32_bf16 v[76:79], a[44:47], a[4:7], v[76:79]
  s_add_u32 s60, s63, 4096
  ds_read_b64_tr_b16 a[80:81], v18 offset:12288
  v_mfma_f32_16x16x32_bf16 v[108:111], a[44:47], a[8:11], v[108:111]
  ds_read_b64_tr_b16 a[82:83], v18 offset:14336
  v_mfma_f32_16x16x32_bf16 v[140:143], a[44:47], a[12:15], v[140:143]
  buffer_store_dwordx4 v[176:179], v2, s[16:19], s60 offen offset:0 sc1
  ds_read_b64_tr_b16 a[84:85], v19 offset:12288
  v_mfma_f32_16x16x32_bf16 v[48:51], a[48:51], a[0:3], v[48:51]
  ds_read_b64_tr_b16 a[86:87], v19 offset:14336
  v_mfma_f32_16x16x32_bf16 v[80:83], a[48:51], a[4:7], v[80:83]
  buffer_store_dwordx4 v[180:183], v2, s[16:19], s60 offen offset:1024 sc1
  ds_read_b64_tr_b16 a[88:89], v20 offset:12288
  v_mfma_f32_16x16x32_bf16 v[112:115], a[48:51], a[8:11], v[112:115]
  ds_read_b64_tr_b16 a[90:91], v20 offset:14336
  v_mfma_f32_16x16x32_bf16 v[144:147], a[48:51], a[12:15], v[144:147]
  ds_read_b64_tr_b16 a[92:93], v21 offset:12288
  v_mfma_f32_16x16x32_bf16 v[52:55], a[52:55], a[0:3], v[52:55]
  buffer_store_dwordx4 v[184:187], v2, s[16:19], s60 offen offset:2048 sc1
  ds_read_b64_tr_b16 a[94:95], v21 offset:14336
  v_mfma_f32_16x16x32_bf16 v[84:87], a[52:55], a[4:7], v[84:87]
  v_mfma_f32_16x16x32_bf16 v[116:119], a[52:55], a[8:11], v[116:119]
  buffer_store_dwordx4 v[188:191], v2, s[16:19], s60 offen offset:3072 sc1
  v_mfma_f32_16x16x32_bf16 v[148:151], a[52:55], a[12:15], v[148:151]
  s_add_u32 s88, s88, s90
  s_add_u32 s89, s89, 1
  s_cmp_eq_u32 s89, 3
  s_cselect_b32 s89, 0, s89
  s_cselect_b32 s90, s91, s92
  v_mfma_f32_16x16x32_bf16 v[56:59], a[56:59], a[0:3], v[56:59]
  s_add_u32 s68, s68, s70
  s_add_u32 s69, s69, 1
  s_cmp_eq_u32 s69, 3
  s_cselect_b32 s69, 0, s69
  s_cselect_b32 s70, s71, s72
  v_mfma_f32_16x16x32_bf16 v[88:91], a[56:59], a[4:7], v[88:91]
  v_add_u32 v16, s90, v16
  v_add_u32 v17, s90, v17
  v_mfma_f32_16x16x32_bf16 v[120:123], a[56:59], a[8:11], v[120:123]
  v_add_u32 v18, s70, v18
  v_add_u32 v19, s70, v19
  v_mfma_f32_16x16x32_bf16 v[152:155], a[56:59], a[12:15], v[152:155]
  v_add_u32 v20, s70, v20
  v_add_u32 v21, s70, v21
  v_mfma_f32_16x16x32_bf16 v[60:63], a[60:63], a[0:3], v[60:63]
  v_mfma_f32_16x16x32_bf16 v[92:95], a[60:63], a[4:7], v[92:95]
  v_mfma_f32_16x16x32_bf16 v[124:127], a[60:63], a[8:11], v[124:127]
  v_mfma_f32_16x16x32_bf16 v[156:159], a[60:63], a[12:15], v[156:159]
  s_waitcnt vmcnt(20) lgkmcnt(0)
  s_barrier
  v_mfma_f32_16x16x32_bf16 v[32:35], a[64:67], a[16:19], v[32:35]
  s_mov_b32 m0, s68
  ds_read_b128 a[0:3], v16 offset:0
  v_mfma_f32_16x16x32_bf16 v[64:67], a[64:67], a[20:23], v[64:67]
  buffer_load_dwordx4 v8, s[20:23], s28 offen offset:0 lds
  ds_read_b64_tr_b16 a[32:33], v18 offset:0
  v_mfma_f32_16x16x32_bf16 v[96:99], a[64:67], a[24:27], v[96:99]
  ds_read_b64_tr_b16 a[34:35], v18 offset:2048
  v_mfma_f32_16x16x32_bf16 v[128:131], a[64:67], a[28:31], v[128:131]
  ds_read_b128 a[4:7], v16 offset:2048
  v_mfma_f32_16x16x32_bf16 v[36:39], a[68:71], a[16:19], v[36:39]
  ds_read_b128 a[8:11], v16 offset:4096
  v_mfma_f32_16x16x32_bf16 v[68:71], a[68:71], a[20:23], v[68:71]
  buffer_load_dwordx4 v9, s[20:23], s28 offen offset:1024 lds
  ds_read_b128 a[12:15], v16 offset:6144
  v_mfma_f32_16x16x32_bf16 v[100:103], a[68:71], a[24:27], v[100:103]
  ds_read_b64_tr_b16 a[36:37], v19 offset:0
  v_mfma_f32_16x16x32_bf16 v[132:135], a[68:71], a[28:31], v[132:135]
  ds_read_b64_tr_b16 a[38:39], v19 offset:2048
  v_mfma_f32_16x16x32_bf16 v[40:43], a[72:75], a[16:19], v[40:43]
  ds_read_b64_tr_b16 a[40:41], v20 offset:0
  v_mfma_f32_16x16x32_bf16 v[72:75], a[72:75], a[20:23], v[72:75]
  ds_read_b64_tr_b16 a[42:43], v20 offset:2048
  v_mfma_f32_16x16x32_bf16 v[104:107], a[72:75], a[24:27], v[104:107]
  buffer_load_dwordx4 v10, s[20:23], s28 offen offset:2048 lds
  v_mfma_f32_16x16x32_bf16 v[136:139], a[72:75], a[28:31], v[136:139]
  ds_read_b64_tr_b16 a[44:45], v21 offset:0
  v_mfma_f32_16x16x32_bf16 v[44:47], a[76:79], a[16:19], v[44:47]
  ds_read_b64_tr_b16 a[46:47], v21 offset:2048
  v_mfma_f32_16x16x32_bf16 v[76:79], a[76:79], a[20:23], v[76:79]
  ds_read_b64_tr_b16 a[48:49], v18 offset:8192
  v_mfma_f32_16x16x32_bf16 v[108:111], a[76:79], a[24:27], v[108:111]
  ds_read_b64_tr_b16 a[50:51], v18 offset:10240
  v_mfma_f32_16x16x32_bf16 v[140:143], a[76:79], a[28:31], v[140:143]
  buffer_load_dwordx4 v11, s[20:23], s28 offen offset:3072 lds
  ds_read_b64_tr_b16 a[52:53], v19 offset:8192
  v_mfma_f32_16x16x32_bf16 v[48:51], a[80:83], a[16:19], v[48:51]
  s_bfe_u32 s56, 0x302010e, s55
  s_add_u32 s54, s54, s56
  s_add_u32 s55, s55, 8
  v_mfma_f32_16x16x32_bf16 v[80:83], a[80:83], a[20:23], v[80:83]
  s_and_b32 s55, s55, 0x8001f
  s_and_b32 s54, s54, 15
  s_lshl_b32 s28, s54, 19
  v_mfma_f32_16x16x32_bf16 v[112:115], a[80:83], a[24:27], v[112:115]
  s_mov_b32 m0, s88
  ds_read_b64_tr_b16 a[54:55], v19 offset:10240
  ds_read_b64_tr_b16 a[56:57], v20 offset:8192
  v_mfma_f32_16x16x32_bf16 v[144:147], a[80:83], a[28:31], v[144:147]
  ds_read_b64_tr_b16 a[58:59], v20 offset:10240
  ds_read_b64_tr_b16 a[60:61], v21 offset:8192
  v_mfma_f32_16x16x32_bf16 v[52:55], a[84:87], a[16:19], v[52:55]
  buffer_load_dwordx4 v4, s[8:11], s26 offen offset:0 lds
  ds_read_b64_tr_b16 a[62:63], v21 offset:10240
  v_mfma_f32_16x16x32_bf16 v[84:87], a[84:87], a[20:23], v[84:87]
  v_mfma_f32_16x16x32_bf16 v[116:119], a[84:87], a[24:27], v[116:119]
  v_mfma_f32_16x16x32_bf16 v[148:151], a[84:87], a[28:31], v[148:151]
  v_mfma_f32_16x16x32_bf16 v[56:59], a[88:91], a[16:19], v[56:59]
  v_mfma_f32_16x16x32_bf16 v[88:91], a[88:91], a[20:23], v[88:91]
  buffer_load_dwordx4 v5, s[8:11], s26 offen offset:1024 lds
  v_mfma_f32_16x16x32_bf16 v[120:123], a[88:91], a[24:27], v[120:123]
  v_mfma_f32_16x16x32_bf16 v[152:155], a[88:91], a[28:31], v[152:155]
  v_mfma_f32_16x16x32_bf16 v[60:63], a[92:95], a[16:19], v[60:63]
  v_mfma_f32_16x16x32_bf16 v[92:95], a[92:95], a[20:23], v[92:95]
  v_mfma_f32_16x16x32_bf16 v[124:127], a[92:95], a[24:27], v[124:127]
  v_mfma_f32_16x16x32_bf16 v[156:159], a[92:95], a[28:31], v[156:159]
  s_waitcnt lgkmcnt(0)
  v_mfma_f32_16x16x32_bf16 v[32:35], a[32:35], a[0:3], v[32:35]
  buffer_load_dwordx4 v6, s[8:11], s26 offen offset:2048 lds
  ds_read_b128 a[16:19], v17 offset:0
  v_mfma_f32_16x16x32_bf16 v[64:67], a[32:35], a[4:7], v[64:67]
  ds_read_b64_tr_b16 a[64:65], v18 offset:4096
  v_mfma_f32_16x16x32_bf16 v[96:99], a[32:35], a[8:11], v[96:99]
  ds_read_b64_tr_b16 a[66:67], v18 offset:6144
  v_mfma_f32_16x16x32_bf16 v[128:131], a[32:35], a[12:15], v[128:131]
  ds_read_b128 a[20:23], v17 offset:2048
  v_mfma_f32_16x16x32_bf16 v[36:39], a[36:39], a[0:3], v[36:39]
  buffer_load_dwordx4 v7, s[8:11], s26 offen offset:3072 lds
  ds_read_b128 a[24:27], v17 offset:4096
  v_mfma_f32_16x16x32_bf16 v[68:71], a[36:39], a[4:7], v[68:71]
  s_add_u32 m0, s88, 4096
  ds_read_b128 a[28:31], v17 offset:6144
  v_mfma_f32_16x16x32_bf16 v[100:103], a[36:39], a[8:11], v[100:103]
  ds_read_b64_tr_b16 a[68:69], v19 offset:4096
  v_mfma_f32_16x16x32_bf16 v[132:135], a[36:39], a[12:15], v[132:135]
  ds_read_b64_tr_b16 a[70:71], v19 offset:6144
  v_mfma_f32_16x16x32_bf16 v[40:43], a[40:43], a[0:3], v[40:43]
  buffer_load_dwordx4 v4, s[8:11], s27 offen offset:0 lds
  ds_read_b64_tr_b16 a[72:73], v20 offset:4096
  v_mfma_f32_16x16x32_bf16 v[72:75], a[40:43], a[4:7], v[72:75]
  ds_read_b64_tr_b16 a[74:75], v20 offset:6144
  v_mfma_f32_16x16x32_bf16 v[104:107], a[40:43], a[8:11], v[104:107]
  v_mfma_f32_16x16x32_bf16 v[136:139], a[40:43], a[12:15], v[136:139]
  ds_read_b64_tr_b16 a[76:77], v21 offset:4096
  v_mfma_f32_16x16x32_bf16 v[44:47], a[44:47], a[0:3], v[44:47]
  buffer_load_dwordx4 v5, s[8:11], s27 offen offset:1024 lds
  ds_read_b64_tr_b16 a[78:79], v21 offset:6144
  v_mfma_f32_16x16x32_bf16 v[76:79], a[44:47], a[4:7], v[76:79]
  ds_read_b64_tr_b16 a[80:81], v18 offset:12288
  v_mfma_f32_16x16x32_bf16 v[108:111], a[44:47], a[8:11], v[108:111]
  ds_read_b64_tr_b16 a[82:83], v18 offset:14336
  v_mfma_f32_16x16x32_bf16 v[140:143], a[44:47], a[12:15], v[140:143]
  ds_read_b64_tr_b16 a[84:85], v19 offset:12288
  v_mfma_f32_16x16x32_bf16 v[48:51], a[48:51], a[0:3], v[48:51]
  buffer_load_dwordx4 v6, s[8:11], s27 offen offset:2048 lds
  ds_read_b64_tr_b16 a[86:87], v19 offset:14336
  v_mfma_f32_16x16x32_bf16 v[80:83], a[48:51], a[4:7], v[80:83]
  ds_read_b64_tr_b16 a[88:89], v20 offset:12288
  v_mfma_f32_16x16x32_bf16 v[112:115], a[48:51], a[8:11], v[112:115]
  ds_read_b64_tr_b16 a[90:91], v20 offset:14336
  v_mfma_f32_16x16x32_bf16 v[144:147], a[48:51], a[12:15], v[144:147]
  ds_read_b64_tr_b16 a[92:93], v21 offset:12288
  v_mfma_f32_16x16x32_bf16 v[52:55], a[52:55], a[0:3], v[52:55]
  buffer_load_dwordx4 v7, s[8:11], s27 offen offset:3072 lds
  ds_read_b64_tr_b16 a[94:95], v21 offset:14336
  v_mfma_f32_16x16x32_bf16 v[84:87], a[52:55], a[4:7], v[84:87]
  s_bfe_u32 s29, 0x302010e, s53
  s_add_u32 s52, s52, s29
  s_add_u32 s53, s53, 8
  v_mfma_f32_16x16x32_bf16 v[116:119], a[52:55], a[8:11], v[116:119]
  s_and_b32 s53, s53, 0x8001f
  s_and_b32 s52, s52, 15
  s_lshl_b32 s29, s52, 7
  v_mfma_f32_16x16x32_bf16 v[148:151], a[52:55], a[12:15], v[148:151]
  s_or_b32 s26, s30, s29
  s_or_b32 s27, s31, s29
  v_mfma_f32_16x16x32_bf16 v[56:59], a[56:59], a[0:3], v[56:59]
  s_add_u32 s88, s88, s90
  s_add_u32 s89, s89, 1
  s_cmp_eq_u32 s89, 3
  s_cselect_b32 s89, 0, s89
  s_cselect_b32 s90, s91, s92
  v_mfma_f32_16x16x32_bf16 v[88:91], a[56:59], a[4:7], v[88:91]
  s_add_u32 s68, s68, s70
  s_add_u32 s69, s69, 1
  s_cmp_eq_u32 s69, 3
  s_cselect_b32 s69, 0, s69
  s_cselect_b32 s70, s71, s72
  v_mfma_f32_16x16x32_bf16 v[120:123], a[56:59], a[8:11], v[120:123]
  v_add_u32 v16, s90, v16
  v_add_u32 v17, s90, v17
  v_mfma_f32_16x16x32_bf16 v[152:155], a[56:59], a[12:15], v[152:155]
  v_add_u32 v18, s70, v18
  v_add_u32 v19, s70, v19
  v_mfma_f32_16x16x32_bf16 v[60:63], a[60:63], a[0:3], v[60:63]
  v_add_u32 v20, s70, v20
  v_add_u32 v21, s70, v21
  v_mfma_f32_16x16x32_bf16 v[92:95], a[60:63], a[4:7], v[92:95]
  v_mfma_f32_16x16x32_bf16 v[124:127], a[60:63], a[8:11], v[124:127]
  v_mfma_f32_16x16x32_bf16 v[156:159], a[60:63], a[12:15], v[156:159]
  s_waitcnt vmcnt(12) lgkmcnt(0)
  s_barrier
  s_mov_b32 s5, 0x40000
Ltg_3:
  v_readfirstlane_b32 s94, v22
  v_readfirstlane_b32 s95, v23
  s_nop 0
  s_cmp_lg_u32 s95, 0
  s_cbranch_scc1 Lpolld_4
  s_sleep 4
  s_mov_b32 s12, s84
  s_mov_b32 s13, s85
  s_mov_b32 s14, 256
  s_mov_b32 s15, 0x00020000
  buffer_load_dwordx2 v[22:23], off, s[12:15], 0 sc1
  s_sub_u32 s5, s5, 1
  s_waitcnt vmcnt(0)
  s_cbranch_scc0 Ltg_3
Lpolld_4:
  v_mov_b32 v3, 0x40000000
  v_mov_b32 v22, s94
  v_cmp_eq_u32 vcc, 0, v0
  v_mov_b32 v23, s95
  s_nop 0
  v_cndmask_b32_e64 v3, v3, 0, vcc
  buffer_store_dwordx2 v[22:23], v3, s[96:99], s34 offen sc1
  v_mfma_f32_16x16x32_bf16 v[32:35], a[64:67], a[16:19], v[32:35]
  s_mov_b32 m0, s68
  ds_read_b128 a[0:3], v16 offset:0
  v_mfma_f32_16x16x32_bf16 v[64:67], a[64:67], a[20:23], v[64:67]
  buffer_load_dwordx4 v8, s[20:23], s28 offen offset:0 lds
  ds_read_b64_tr_b16 a[32:33], v18 offset:0
  v_mfma_f32_16x16x32_bf16 v[96:99], a[64:67], a[24:27], v[96:99]
  ds_read_b64_tr_b16 a[34:35], v18 offset:2048
  v_mfma_f32_16x16x32_bf16 v[128:131], a[64:67], a[28:31], v[128:131]
  ds_read_b128 a[4:7], v16 offset:2048
  v_mfma_f32_16x16x32_bf16 v[36:39], a[68:71], a[16:19], v[36:39]
  ds_read_b128 a[8:11], v16 offset:4096
  v_mfma_f32_16x16x32_bf16 v[68:71], a[68:71], a[20:23], v[68:71]
  buffer_load_dwordx4 v9, s[20:23], s28 offen offset:1024 lds
  ds_read_b128 a[12:15], v16 offset:6144
  v_mfma_f32_16x16x32_bf16 v[100:103], a[68:71], a[24:27], v[100:103]
  ds_read_b64_tr_b16 a[36:37], v19 offset:0
  v_mfma_f32_16x16x32_bf16 v[132:135], a[68:71], a[28:31], v[132:135]
  ds_read_b64_tr_b16 a[38:39], v19 offset:2048
  v_mfma_f32_16x16x32_bf16 v[40:43], a[72:75], a[16:19], v[40:43]
  ds_read_b64_tr_b16 a[40:41], v20 offset:0
  v_mfma_f32_16x16x32_bf16 v[72:75], a[72:75], a[20:23], v[72:75]
  ds_read_b64_tr_b16 a[42:43], v20 offset:2048
  v_mfma_f32_16x16x32_bf16 v[104:107], a[72:75], a[24:27], v[104:107]
  buffer_load_dwordx4 v10, s[20:23], s28 offen offset:2048 lds
  v_mfma_f32_16x16x32_bf16 v[136:139], a[72:75], a[28:31], v[136:139]
  ds_read_b64_tr_b16 a[44:45], v21 offset:0
  v_mfma_f32_16x16x32_bf16 v[44:47], a[76:79], a[16:19], v[44:47]
  ds_read_b64_tr_b16 a[46:47], v21 offset:2048
  v_mfma_f32_16x16x32_bf16 v[76:79], a[76:79], a[20:23], v[76:79]
  ds_read_b64_tr_b16 a[48:49], v18 offset:8192
  v_mfma_f32_16x16x32_bf16 v[108:111], a[76:79], a[24:27], v[108:111]
  ds_read_b64_tr_b16 a[50:51], v18 offset:10240
  v_mfma_f32_16x16x32_bf16 v[140:143], a[76:79], a[28:31], v[140:143]
  buffer_load_dwordx4 v11, s[20:23], s28 offen offset:3072 lds
  ds_read_b64_tr_b16 a[52:53], v19 offset:8192
  v_mfma_f32_16x16x32_bf16 v[48:51], a[80:83], a[16:19], v[48:51]
  s_bfe_u32 s56, 0x302010e, s55
  s_add_u32 s54, s54, s56
  s_add_u32 s55, s55, 8
  v_mfma_f32_16x16x32_bf16 v[80:83], a[80:83], a[20:23], v[80:83]
  s_and_b32 s55, s55, 0x8001f
  s_and_b32 s54, s54, 15
  s_lshl_b32 s28, s54, 19
  v_mfma_f32_16x16x32_bf16 v[112:115], a[80:83], a[24:27], v[112:115]
  s_mov_b32 m0, s88
  ds_read_b64_tr_b16 a[54:55], v19 offset:10240
  ds_read_b64_tr_b16 a[56:57], v20 offset:8192
  v_mfma_f32_16x16x32_bf16 v[144:147], a[80:83], a[28:31], v[144:147]
  ds_read_b64_tr_b16 a[58:59], v20 offset:10240
  ds_read_b64_tr_b16 a[60:61], v21 offset:8192
  v_mfma_f32_16x16x32_bf16 v[52:55], a[84:87], a[16:19], v[52:55]
  buffer_load_dwordx4 v4, s[8:11], s26 offen offset:0 lds
  ds_read_b64_tr_b16 a[62:63], v21 offset:10240
  v_mfma_f32_16x16x32_bf16 v[84:87], a[84:87], a[20:23], v[84:87]
  v_mfma_f32_16x16x32_bf16 v[116:119], a[84:87], a[24:27], v[116:119]
  v_mfma_f32_16x16x32_bf16 v[148:151], a[84:87], a[28:31], v[148:151]
  v_mfma_f32_16x16x32_bf16 v[56:59], a[88:91], a[16:19], v[56:59]
  v_mfma_f32_16x16x32_bf16 v[88:91], a[88:91], a[20:23], v[88:91]
  buffer_load_dwordx4 v5, s[8:11], s26 offen offset:1024 lds
  v_mfma_f32_16x16x32_bf16 v[120:123], a[88:91], a[24:27], v[120:123]
  v_mfma_f32_16x16x32_bf16 v[152:155], a[88:91], a[28:31], v[152:155]
  v_mfma_f32_16x16x32_bf16 v[60:63], a[92:95], a[16:19], v[60:63]
  v_mfma_f32_16x16x32_bf16 v[92:95], a[92:95], a[20:23], v[92:95]
  v_mfma_f32_16x16x32_bf16 v[124:127], a[92:95], a[24:27], v[124:127]
  v_mfma_f32_16x16x32_bf16 v[156:159], a[92:95], a[28:31], v[156:159]
  s_waitcnt lgkmcnt(0)
  v_mfma_f32_16x16x32_bf16 v[32:35], a[32:35], a[0:3], v[32:35]
  buffer_load_dwordx4 v6, s[8:11], s26 offen offset:2048 lds
  ds_read_b128 a[16:19], v17 offset:0
  v_mfma_f32_16x16x32_bf16 v[64:67], a[32:35], a[4:7], v[64:67]
  ds_read_b64_tr_b16 a[64:65], v18 offset:4096
  v_mfma_f32_16x16x32_bf16 v[96:99], a[32:35], a[8:11], v[96:99]
  ds_read_b64_tr_b16 a[66:67], v18 offset:6144
  v_mfma_f32_16x16x32_bf16 v[128:131], a[32:35], a[12:15], v[128:131]
  ds_read_b128 a[20:23], v17 offset:2048
  v_mfma_f32_16x16x32_bf16 v[36:39], a[36:39], a[0:3], v[36:39]
  buffer_load_dwordx4 v7, s[8:11], s26 offen offset:3072 lds
  ds_read_b128 a[24:27], v17 offset:4096
  v_mfma_f32_16x16x32_bf16 v[68:71], a[36:39], a[4:7], v[68:71]
  s_add_u32 m0, s88, 4096
  ds_read_b128 a[28:31], v17 offset:6144
  v_mfma_f32_16x16x32_bf16 v[100:103], a[36:39], a[8:11], v[100:103]
  ds_read_b64_tr_b16 a[68:69], v19 offset:4096
  v_mfma_f32_16x16x32_bf16 v[132:135], a[36:39], a[12:15], v[132:135]
  ds_read_b64_tr_b16 a[70:71], v19 offset:6144
  v_mfma_f32_16x16x32_bf16 v[40:43], a[40:43], a[0:3], v[40:43]
  buffer_load_dwordx4 v4, s[8:11], s27 offen offset:0 lds
  ds_read_b64_tr_b16 a[72:73], v20 offset:4096
  v_mfma_f32_16x16x32_bf16 v[72:75], a[40:43], a[4:7], v[72:75]
  ds_read_b64_tr_b16 a[74:75], v20 offset:6144
  v_mfma_f32_16x16x32_bf16 v[104:107], a[40:43], a[8:11], v[104:107]
  v_mfma_f32_16x16x32_bf16 v[136:139], a[40:43], a[12:15], v[136:139]
  ds_read_b64_tr_b16 a[76:77], v21 offset:4096
  v_mfma_f32_16x16x32_bf16 v[44:47], a[44:47], a[0:3], v[44:47]
  buffer_load_dwordx4 v5, s[8:11], s27 offen offset:1024 lds
  ds_read_b64_tr_b16 a[78:79], v21 offset:6144
  v_mfma_f32_16x16x32_bf16 v[76:79], a[44:47], a[4:7], v[76:79]
  ds_read_b64_tr_b16 a[80:81], v18 offset:12288
  v_mfma_f32_16x16x32_bf16 v[108:111], a[44:47], a[8:11], v[108:111]
  ds_read_b64_tr_b16 a[82:83], v18 offset:14336
  v_mfma_f32_16x16x32_bf16 v[140:143], a[44:47], a[12:15], v[140:143]
  ds_read_b64_tr_b16 a[84:85], v19 offset:12288
  v_mfma_f32_16x16x32_bf16 v[48:51], a[48:51], a[0:3], v[48:51]
  buffer_load_dwordx4 v6, s[8:11], s27 offen offset:2048 lds
  ds_read_b64_tr_b16 a[86:87], v19 offset:14336
  v_mfma_f32_16x16x32_bf16 v[80:83], a[48:51], a[4:7], v[80:83]
  ds_read_b64_tr_b16 a[88:89], v20 offset:12288
  v_mfma_f32_16x16x32_bf16 v[112:115], a[48:51], a[8:11], v[112:115]
  ds_read_b64_tr_b16 a[90:91], v20 offset:14336
  v_mfma_f32_16x16x32_bf16 v[144:147], a[48:51], a[12:15], v[144:147]
  ds_read_b64_tr_b16 a[92:93], v21 offset:12288
  v_mfma_f32_16x16x32_bf16 v[52:55], a[52:55], a[0:3], v[52:55]
  buffer_load_dwordx4 v7, s[8:11], s27 offen offset:3072 lds
  ds_read_b64_tr_b16 a[94:95], v21 offset:14336
  v_mfma_f32_16x16x32_bf16 v[84:87], a[52:55], a[4:7], v[84:87]
  s_bfe_u32 s29, 0x302010e, s53
  s_add_u32 s52, s52, s29
  s_add_u32 s53, s53, 8
  v_mfma_f32_16x16x32_bf16 v[116:119], a[52:55], a[8:11], v[116:119]
  s_and_b32 s53, s53, 0x8001f
  s_and_b32 s52, s52, 15
  s_lshl_b32 s29, s52, 7
  v_mfma_f32_16x16x32_bf16 v[148:151], a[52:55], a[12:15], v[148:151]
  s_or_b32 s26, s30, s29
  s_or_b32 s27, s31, s29
  v_mfma_f32_16x16x32_bf16 v[56:59], a[56:59], a[0:3], v[56:59]
  s_add_u32 s88, s88, s90
  s_add_u32 s89, s89, 1
  s_cmp_eq_u32 s89, 3
  s_cselect_b32 s89, 0, s89
  s_cselect_b32 s90, s91, s92
  v_mfma_f32_16x16x32_bf16 v[88:91], a[56:59], a[4:7], v[88:91]
  s_add_u32 s68, s68, s70
  s_add_u32 s69, s69, 1
  s_cmp_eq_u32 s69, 3
  s_cselect_b32 s69, 0, s69
  s_cselect_b32 s70, s71, s72
  v_mfma_f32_16x16x32_bf16 v[120:123], a[56:59], a[8:11], v[120:123]
  v_add_u32 v16, s90, v16
  v_add_u32 v17, s90, v17
  v_mfma_f32_16x16x32_bf16 v[152:155], a[56:59], a[12:15], v[152:155]
  v_add_u32 v18, s70, v18
  v_add_u32 v19, s70, v19
  v_mfma_f32_16x16x32_bf16 v[60:63], a[60:63], a[0:3], v[60:63]
  v_add_u32 v20, s70, v20
  v_add_u32 v21, s70, v21
  v_mfma_f32_16x16x32_bf16 v[92:95], a[60:63], a[4:7], v[92:95]
  v_mfma_f32_16x16x32_bf16 v[124:127], a[60:63], a[8:11], v[124:127]
  v_mfma_f32_16x16x32_bf16 v[156:159], a[60:63], a[12:15], v[156:159]
  s_mov_b32 s35, 6
  s_waitcnt vmcnt(12) lgkmcnt(0)
  s_barrier
  .p2align 6
Lp3_loop:
  v_mfma_f32_16x16x32_bf16 v[32:35], a[64:67], a[16:19], v[32:35]
  s_mov_b32 m0, s68
  ds_read_b128 a[0:3], v16 offset:0
  v_mfma_f32_16x16x32_bf16 v[64:67], a[64:67], a[20:23], v[64:67]
  buffer_load_dwordx4 v8, s[20:23], s28 offen offset:0 lds
  ds_read_b64_tr_b16 a[32:33], v18 offset:0
  v_mfma_f32_16x16x32_bf16 v[96:99], a[64:67], a[24:27], v[96:99]
  ds_read_b64_tr_b16 a[34:35], v18 offset:2048
  v_mfma_f32_16x16x32_bf16 v[128:131], a[64:67], a[28:31], v[128:131]
  ds_read_b128 a[4:7], v16 offset:2048
  v_mfma_f32_16x16x32_bf16 v[36:39], a[68:71], a[16:19], v[36:39]
  ds_read_b128 a[8:11], v16 offset:4096
  v_mfma_f32_16x16x32_bf16 v[68:71], a[68:71], a[20:23], v[68:71]
  buffer_load_dwordx4 v9, s[20:23], s28 offen offset:1024 lds
  ds_read_b128 a[12:15], v16 offset:6144
  v_mfma_f32_16x16x32_bf16 v[100:103], a[68:71], a[24:27], v[100:103]
  ds_read_b64_tr_b16 a[36:37], v19 offset:0
  v_mfma_f32_16x16x32_bf16 v[132:135], a[68:71], a[28:31], v[132:135]
  ds_read_b64_tr_b16 a[38:39], v19 offset:2048
  v_mfma_f32_16x16x32_bf16 v[40:43], a[72:75], a[16:19], v[40:43]
  ds_read_b64_tr_b16 a[40:41], v20 offset:0
  v_mfma_f32_16x16x32_bf16 v[72:75], a[72:75], a[20:23], v[72:75]
  ds_read_b64_tr_b16 a[42:43], v20 offset:2048
  v_mfma_f32_16x16x32_bf16 v[104:107], a[72:75], a[24:27], v[104:107]
  buffer_load_dwordx4 v10, s[20:23], s28 offen offset:2048 lds
  v_mfma_f32_16x16x32_bf16 v[136:139], a[72:75], a[28:31], v[136:139]
  ds_read_b64_tr_b16 a[44:45], v21 offset:0
  v_mfma_f32_16x16x32_bf16 v[44:47], a[76:79], a[16:19], v[44:47]
  ds_read_b64_tr_b16 a[46:47], v21 offset:2048
  v_mfma_f32_16x16x32_bf16 v[76:79], a[76:79], a[20:23], v[76:79]
  ds_read_b64_tr_b16 a[48:49], v18 offset:8192
  v_mfma_f32_16x16x32_bf16 v[108:111], a[76:79], a[24:27], v[108:111]
  ds_read_b64_tr_b16 a[50:51], v18 offset:10240
  v_mfma_f32_16x16x32_bf16 v[140:143], a[76:79], a[28:31], v[140:143]
  buffer_load_dwordx4 v11, s[20:23], s28 offen offset:3072 lds
  ds_read_b64_tr_b16 a[52:53], v19 offset:8192
  v_mfma_f32_16x16x32_bf16 v[48:51], a[80:83], a[16:19], v[48:51]
  s_bfe_u32 s56, 0x302010e, s55
  s_add_u32 s54, s54, s56
  s_add_u32 s55, s55, 8
  v_mfma_f32_16x16x32_bf16 v[80:83], a[80:83], a[20:23], v[80:83]
  s_and_b32 s55, s55, 0x8001f
  s_and_b32 s54, s54, 15
  s_lshl_b32 s28, s54, 19
  v_mfma_f32_16x16x32_bf16 v[112:115], a[80:83], a[24:27], v[112:115]
  s_mov_b32 m0, s88
  ds_read_b64_tr_b16 a[54:55], v19 offset:10240
  ds_read_b64_tr_b16 a[56:57], v20 offset:8192
  v_mfma_f32_16x16x32_bf16 v[144:147], a[80:83], a[28:31], v[144:147]
  ds_read_b64_tr_b16 a[58:59], v20 offset:10240
  ds_read_b64_tr_b16 a[60:61], v21 offset:8192
  v_mfma_f32_16x16x32_bf16 v[52:55], a[84:87], a[16:19], v[52:55]
  buffer_load_dwordx4 v4, s[8:11], s26 offen offset:0 lds
  ds_read_b64_tr_b16 a[62:63], v21 offset:10240
  v_mfma_f32_16x16x32_bf16 v[84:87], a[84:87], a[20:23], v[84:87]
  v_mfma_f32_16x16x32_bf16 v[116:119], a[84:87], a[24:27], v[116:119]
  v_mfma_f32_16x16x32_bf16 v[148:151], a[84:87], a[28:31], v[148:151]
  v_mfma_f32_16x16x32_bf16 v[56:59], a[88:91], a[16:19], v[56:59]
  v_mfma_f32_16x16x32_bf16 v[88:91], a[88:91], a[20:23], v[88:91]
  buffer_load_dwordx4 v5, s[8:11], s26 offen offset:1024 lds
  v_mfma_f32_16x16x32_bf16 v[120:123], a[88:91], a[24:27], v[120:123]
  v_mfma_f32_16x16x32_bf16 v[152:155], a[88:91], a[28:31], v[152:155]
  v_mfma_f32_16x16x32_bf16 v[60:63], a[92:95], a[16:19], v[60:63]
  v_mfma_f32_16x16x32_bf16 v[92:95], a[92:95], a[20:23], v[92:95]
  v_mfma_f32_16x16x32_bf16 v[124:127], a[92:95], a[24:27], v[124:127]
  v_mfma_f32_16x16x32_bf16 v[156:159], a[92:95], a[28:31], v[156:159]
  s_waitcnt lgkmcnt(0)
  v_mfma_f32_16x16x32_bf16 v[32:35], a[32:35], a[0:3], v[32:35]
  buffer_load_dwordx4 v6, s[8:11], s26 offen offset:2048 lds
  ds_read_b128 a[16:19], v17 offset:0
  v_mfma_f32_16x16x32_bf16 v[64:67], a[32:35], a[4:7], v[64:67]
  ds_read_b64_tr_b16 a[64:65], v18 offset:4096
  v_mfma_f32_16x16x32_bf16 v[96:99], a[32:35], a[8:11], v[96:99]
  ds_read_b64_tr_b16 a[66:67], v18 offset:6144
  v_mfma_f32_16x16x32_bf16 v[128:131], a[32:35], a[12:15], v[128:131]
  ds_read_b128 a[20:23], v17 offset:2048
  v_mfma_f32_16x16x32_bf16 v[36:39], a[36:39], a[0:3], v[36:39]
  buffer_load_dwordx4 v7, s[8:11], s26 offen offset:3072 lds
  ds_read_b128 a[24:27], v17 offset:4096
  v_mfma_f32_16x16x32_bf16 v[68:71], a[36:39], a[4:7], v[68:71]
  s_add_u32 m0, s88, 4096
  ds_read_b128 a[28:31], v17 offset:6144
  v_mfma_f32_16x16x32_bf16 v[100:103], a[36:39], a[8:11], v[100:103]
  ds_read_b64_tr_b16 a[68:69], v19 offset:4096
  v_mfma_f32_16x16x32_bf16 v[132:135], a[36:39], a[12:15], v[132:135]
  ds_read_b64_tr_b16 a[70:71], v19 offset:6144
  v_mfma_f32_16x16x32_bf16 v[40:43], a[40:43], a[0:3], v[40:43]
  buffer_load_dwordx4 v4, s[8:11], s27 offen offset:0 lds
  ds_read_b64_tr_b16 a[72:73], v20 offset:4096
  v_mfma_f32_16x16x32_bf16 v[72:75], a[40:43], a[4:7], v[72:75]
  ds_read_b64_tr_b16 a[74:75], v20 offset:6144
  v_mfma_f32_16x16x32_bf16 v[104:107], a[40:43], a[8:11], v[104:107]
  v_mfma_f32_16x16x32_bf16 v[136:139], a[40:43], a[12:15], v[136:139]
  ds_read_b64_tr_b16 a[76:77], v21 offset:4096
  v_mfma_f32_16x16x32_bf16 v[44:47], a[44:47], a[0:3], v[44:47]
  buffer_load_dwordx4 v5, s[8:11], s27 offen offset:1024 lds
  ds_read_b64_tr_b16 a[78:79], v21 offset:6144
  v_mfma_f32_16x16x32_bf16 v[76:79], a[44:47], a[4:7], v[76:79]
  ds_read_b64_tr_b16 a[80:81], v18 offset:12288
  v_mfma_f32_16x16x32_bf16 v[108:111], a[44:47], a[8:11], v[108:111]
  ds_read_b64_tr_b16 a[82:83], v18 offset:14336
  v_mfma_f32_16x16x32_bf16 v[140:143], a[44:47], a[12:15], v[140:143]
  ds_read_b64_tr_b16 a[84:85], v19 offset:12288
  v_mfma_f32_16x16x32_bf16 v[48:51], a[48:51], a[0:3], v[48:51]
  buffer_load_dwordx4 v6, s[8:11], s27 offen offset:2048 lds
  ds_read_b64_tr_b16 a[86:87], v19 offset:14336
  v_mfma_f32_16x16x32_bf16 v[80:83], a[48:51], a[4:7], v[80:83]
  ds_read_b64_tr_b16 a[88:89], v20 offset:12288
  v_mfma_f32_16x16x32_bf16 v[112:115], a[48:51], a[8:11], v[112:115]
  ds_read_b64_tr_b16 a[90:91], v20 offset:14336
  v_mfma_f32_16x16x32_bf16 v[144:147], a[48:51], a[12:15], v[144:147]
  ds_read_b64_tr_b16 a[92:93], v21 offset:12288
  v_mfma_f32_16x16x32_bf16 v[52:55], a[52:55], a[0:3], v[52:55]
  buffer_load_dwordx4 v7, s[8:11], s27 offen offset:3072 lds
  ds_read_b64_tr_b16 a[94:95], v21 offset:14336
  v_mfma_f32_16x16x32_bf16 v[84:87], a[52:55], a[4:7], v[84:87]
  s_bfe_u32 s29, 0x302010e, s53
  s_add_u32 s52, s52, s29
  s_add_u32 s53, s53, 8
  v_mfma_f32_16x16x32_bf16 v[116:119], a[52:55], a[8:11], v[116:119]
  s_and_b32 s53, s53, 0x8001f
  s_and_b32 s52, s52, 15
  s_lshl_b32 s29, s52, 7
  v_mfma_f32_16x16x32_bf16 v[148:151], a[52:55], a[12:15], v[148:151]
  s_or_b32 s26, s30, s29
  s_or_b32 s27, s31, s29
  v_mfma_f32_16x16x32_bf16 v[56:59], a[56:59], a[0:3], v[56:59]
  s_add_u32 s88, s88, s90
  s_add_u32 s89, s89, 1
  s_cmp_eq_u32 s89, 3
  s_cselect_b32 s89, 0, s89
  s_cselect_b32 s90, s91, s92
  v_mfma_f32_16x16x32_bf16 v[88:91], a[56:59], a[4:7], v[88:91]
  s_add_u32 s68, s68, s70
  s_add_u32 s69, s69, 1
  s_cmp_eq_u32 s69, 3
  s_cselect_b32 s69, 0, s69
  s_cselect_b32 s70, s71, s72
  v_mfma_f32_16x16x32_bf16 v[120:123], a[56:59], a[8:11], v[120:123]
  v_add_u32 v16, s90, v16
  v_add_u32 v17, s90, v17
  v_mfma_f32_16x16x32_bf16 v[152:155], a[56:59], a[12:15], v[152:155]
  v_add_u32 v18, s70, v18
  v_add_u32 v19, s70, v19
  v_mfma_f32_16x16x32_bf16 v[60:63], a[60:63], a[0:3], v[60:63]
  v_add_u32 v20, s70, v20
  v_add_u32 v21, s70, v21
  v_mfma_f32_16x16x32_bf16 v[92:95], a[60:63], a[4:7], v[92:95]
  s_waitcnt vmcnt(12) lgkmcnt(0)
  s_barrier
  v_mfma_f32_16x16x32_bf16 v[124:127], a[60:63], a[8:11], v[124:127]
  s_sub_u32 s35, s35, 1
  v_mfma_f32_16x16x32_bf16 v[156:159], a[60:63], a[12:15], v[156:159]
  s_cmp_lg_u32 s35, 0
  s_cbranch_scc1 Lp3_loop
  s_lshr_b32 s34, s24, 1
  s_lshl_b32 s34, s34, 11
  v_and_b32 v3, 7, v1
  v_lshlrev_b32 v3, 7, v3
  v_mfma_f32_16x16x32_bf16 v[32:35], a[64:67], a[16:19], v[32:35]
  buffer_load_dwordx2 v[22:23], v3, s[96:99], s34 offen sc1
  ds_read_b128 a[0:3], v16 offset:0
  v_mfma_f32_16x16x32_bf16 v[64:67], a[64:67], a[20:23], v[64:67]
  s_mov_b32 m0, s68
  ds_read_b64_tr_b16 a[32:33], v18 offset:0
  v_mfma_f32_16x16x32_bf16 v[96:99], a[64:67], a[24:27], v[96:99]
  ds_read_b64_tr_b16 a[34:35], v18 offset:2048
  v_mfma_f32_16x16x32_bf16 v[128:131], a[64:67], a[28:31], v[128:131]
  ds_read_b128 a[4:7], v16 offset:2048
  v_mfma_f32_16x16x32_bf16 v[36:39], a[68:71], a[16:19], v[36:39]
  buffer_load_dwordx4 v8, s[20:23], s28 offen offset:0 lds
  ds_read_b128 a[8:11], v16 offset:4096
  v_mfma_f32_16x16x32_bf16 v[68:71], a[68:71], a[20:23], v[68:71]
  ds_read_b128 a[12:15], v16 offset:6144
  v_mfma_f32_16x16x32_bf16 v[100:103], a[68:71], a[24:27], v[100:103]
  ds_read_b64_tr_b16 a[36:37], v19 offset:0
  v_mfma_f32_16x16x32_bf16 v[132:135], a[68:71], a[28:31], v[132:135]
  ds_read_b64_tr_b16 a[38:39], v19 offset:2048
  v_mfma_f32_16x16x32_bf16 v[40:43], a[72:75], a[16:19], v[40:43]
  buffer_load_dwordx4 v9, s[20:23], s28 offen offset:1024 lds
  ds_read_b64_tr_b16 a[40:41], v20 offset:0
  v_mfma_f32_16x16x32_bf16 v[72:75], a[72:75], a[20:23], v[72:75]
  ds_read_b64_tr_b16 a[42:43], v20 offset:2048
  v_mfma_f32_16x16x32_bf16 v[104:107], a[72:75], a[24:27], v[104:107]
  v_mfma_f32_16x16x32_bf16 v[136:139], a[72:75], a[28:31], v[136:139]
  ds_read_b64_tr_b16 a[44:45], v21 offset:0
  v_mfma_f32_16x16x32_bf16 v[44:47], a[76:79], a[16:19], v[44:47]
  ds_read_b64_tr_b16 a[46:47], v21 offset:2048
  v_mfma_f32_16x16x32_bf16 v[76:79], a[76:79], a[20:23], v[76:79]
  buffer_load_dwordx4 v10, s[20:23], s28 offen offset:2048 lds
  ds_read_b64_tr_b16 a[48:49], v18 offset:8192
  v_mfma_f32_16x16x32_bf16 v[108:111], a[76:79], a[24:27], v[108:111]
  ds_read_b64_tr_b16 a[50:51], v18 offset:10240
  v_mfma_f32_16x16x32_bf16 v[140:143], a[76:79], a[28:31], v[140:143]
  ds_read_b64_tr_b16 a[52:53], v19 offset:8192
  v_mfma_f32_16x16x32_bf16 v[48:51], a[80:83], a[16:19], v[48:51]
  ds_read_b64_tr_b16 a[54:55], v19 offset:10240
  v_mfma_f32_16x16x32_bf16 v[80:83], a[80:83], a[20:23], v[80:83]
  buffer_load_dwordx4 v11, s[20:23], s28 offen offset:3072 lds
  ds_read_b64_tr_b16 a[56:57], v20 offset:8192
  v_mfma_f32_16x16x32_bf16 v[112:115], a[80:83], a[24:27], v[112:115]
  s_bfe_u32 s56, 0x302010e, s55
  s_add_u32 s54, s54, s56
  s_add_u32 s55, s55, 8
  v_mfma_f32_16x16x32_bf16 v[144:147], a[80:83], a[28:31], v[144:147]
  s_and_b32 s55, s55, 0x8001f
  s_and_b32 s54, s54, 15
  s_lshl_b32 s28, s54, 19
  v_mfma_f32_16x16x32_bf16 v[52:55], a[84:87], a[16:19], v[52:55]
  s_mov_b32 m0, s88
  ds_read_b64_tr_b16 a[58:59], v20 offset:10240
  ds_read_b64_tr_b16 a[60:61], v21 offset:8192
  v_mfma_f32_16x16x32_bf16 v[84:87], a[84:87], a[20:23], v[84:87]
  ds_read_b64_tr_b16 a[62:63], v21 offset:10240
  v_mfma_f32_16x16x32_bf16 v[116:119], a[84:87], a[24:27], v[116:119]
  buffer_load_dwordx4 v4, s[8:11], s26 offen offset:0 lds
  v_mfma_f32_16x16x32_bf16 v[148:151], a[84:87], a[28:31], v[148:151]
  v_mfma_f32_16x16x32_bf16 v[56:59], a[88:91], a[16:19], v[56:59]
  v_mfma_f32_16x16x32_bf16 v[88:91], a[88:91], a[20:23], v[88:91]
  v_mfma_f32_16x16x32_bf16 v[120:123], a[88:91], a[24:27], v[120:123]
  buffer_load_dwordx4 v5, s[8:11], s26 offen offset:1024 lds
  v_mfma_f32_16x16x32_bf16 v[152:155], a[88:91], a[28:31], v[152:155]
  v_mfma_f32_16x16x32_bf16 v[60:63], a[92:95], a[16:19], v[60:63]
  v_mfma_f32_16x16x32_bf16 v[92:95], a[92:95], a[20:23], v[92:95]
  v_mfma_f32_16x16x32_bf16 v[124:127], a[92:95], a[24:27], v[124:127]
  v_mfma_f32_16x16x32_bf16 v[156:159], a[92:95], a[28:31], v[156:159]
  s_waitcnt lgkmcnt(0)
  v_mfma_f32_16x16x32_bf16 v[32:35], a[32:35], a[0:3], v[32:35]
  buffer_load_dwordx4 v6, s[8:11], s26 offen offset:2048 lds
  ds_read_b128 a[16:19], v17 offset:0
  v_mfma_f32_16x16x32_bf16 v[64:67], a[32:35], a[4:7], v[64:67]
  ds_read_b64_tr_b16 a[64:65], v18 offset:4096
  v_mfma_f32_16x16x32_bf16 v[96:99], a[32:35], a[8:11], v[96:99]
  ds_read_b64_tr_b16 a[66:67], v18 offset:6144
  v_mfma_f32_16x16x32_bf16 v[128:131], a[32:35], a[12:15], v[128:131]
  ds_read_b128 a[20:23], v17 offset:2048
  v_mfma_f32_16x16x32_bf16 v[36:39], a[36:39], a[0:3], v[36:39]
  buffer_load_dwordx4 v7, s[8:11], s26 offen offset:3072 lds
  ds_read_b128 a[24:27], v17 offset:4096
  v_mfma_f32_16x16x32_bf16 v[68:71], a[36:39], a[4:7], v[68:71]
  s_add_u32 m0, s88, 4096
  ds_read_b128 a[28:31], v17 offset:6144
  v_mfma_f32_16x16x32_bf16 v[100:103], a[36:39], a[8:11], v[100:103]
  ds_read_b64_tr_b16 a[68:69], v19 offset:4096
  v_mfma_f32_16x16x32_bf16 v[132:135], a[36:39], a[12:15], v[132:135]
  ds_read_b64_tr_b16 a[70:71], v19 offset:6144
  v_mfma_f32_16x16x32_bf16 v[40:43], a[40:43], a[0:3], v[40:43]
  buffer_load_dwordx4 v4, s[8:11], s27 offen offset:0 lds
  ds_read_b64_tr_b16 a[72:73], v20 offset:4096
  v_mfma_f32_16x16x32_bf16 v[72:75], a[40:43], a[4:7], v[72:75]
  ds_read_b64_tr_b16 a[74:75], v20 offset:6144
  v_mfma_f32_16x16x32_bf16 v[104:107], a[40:43], a[8:11], v[104:107]
  v_mfma_f32_16x16x32_bf16 v[136:139], a[40:43], a[12:15], v[136:139]
  ds_read_b64_tr_b16 a[76:77], v21 offset:4096
  v_mfma_f32_16x16x32_bf16 v[44:47], a[44:47], a[0:3], v[44:47]
  buffer_load_dwordx4 v5, s[8:11], s27 offen offset:1024 lds
  ds_read_b64_tr_b16 a[78:79], v21 offset:6144
  v_mfma_f32_16x16x32_bf16 v[76:79], a[44:47], a[4:7], v[76:79]
  ds_read_b64_tr_b16 a[80:81], v18 offset:12288
  v_mfma_f32_16x16x32_bf16 v[108:111], a[44:47], a[8:11], v[108:111]
  ds_read_b64_tr_b16 a[82:83], v18 offset:14336
  v_mfma_f32_16x16x32_bf16 v[140:143], a[44:47], a[12:15], v[140:143]
  ds_read_b64_tr_b16 a[84:85], v19 offset:12288
  v_mfma_f32_16x16x32_bf16 v[48:51], a[48:51], a[0:3], v[48:51]
  buffer_load_dwordx4 v6, s[8:11], s27 offen offset:2048 lds
  ds_read_b64_tr_b16 a[86:87], v19 offset:14336
  v_mfma_f32_16x16x32_bf16 v[80:83], a[48:51], a[4:7], v[80:83]
  ds_read_b64_tr_b16 a[88:89], v20 offset:12288
  v_mfma_f32_16x16x32_bf16 v[112:115], a[48:51], a[8:11], v[112:115]
  ds_read_b64_tr_b16 a[90:91], v20 offset:14336
  v_mfma_f32_16x16x32_bf16 v[144:147], a[48:51], a[12:15], v[144:147]
  ds_read_b64_tr_b16 a[92:93], v21 offset:12288
  v_mfma_f32_16x16x32_bf16 v[52:55], a[52:55], a[0:3], v[52:55]
  buffer_load_dwordx4 v7, s[8:11], s27 offen offset:3072 lds
  ds_read_b64_tr_b16 a[94:95], v21 offset:14336
  v_mfma_f32_16x16x32_bf16 v[84:87], a[52:55], a[4:7], v[84:87]
  s_bfe_u32 s29, 0x302010e, s53
  s_add_u32 s52, s52, s29
  s_add_u32 s53, s53, 8
  v_mfma_f32_16x16x32_bf16 v[116:119], a[52:55], a[8:11], v[116:119]
  s_and_b32 s53, s53, 0x8001f
  s_and_b32 s52, s52, 15
  s_lshl_b32 s29, s52, 7
  v_mfma_f32_16x16x32_bf16 v[148:151], a[52:55], a[12:15], v[148:151]
  s_or_b32 s26, s30, s29
  s_or_b32 s27, s31, s29
  v_mfma_f32_16x16x32_bf16 v[56:59], a[56:59], a[0:3], v[56:59]
  s_add_u32 s88, s88, s90
  s_add_u32 s89, s89, 1
  s_cmp_eq_u32 s89, 3
  s_cselect_b32 s89, 0, s89
  s_cselect_b32 s90, s91, s92
  v_mfma_f32_16x16x32_bf16 v[88:91], a[56:59], a[4:7], v[88:91]
  s_add_u32 s68, s68, s70
  s_add_u32 s69, s69, 1
  s_cmp_eq_u32 s69, 3
  s_cselect_b32 s69, 0, s69
  s_cselect_b32 s70, s71, s72
  v_mfma_f32_16x16x32_bf16 v[120:123], a[56:59], a[8:11], v[120:123]
  v_add_u32 v16, s90, v16
  v_add_u32 v17, s90, v17
  v_mfma_f32_16x16x32_bf16 v[152:155], a[56:59], a[12:15], v[152:155]
  v_add_u32 v18, s70, v18
  v_add_u32 v19, s70, v19
  v_mfma_f32_16x16x32_bf16 v[60:63], a[60:63], a[0:3], v[60:63]
  v_add_u32 v20, s70, v20
  v_add_u32 v21, s70, v21
  v_mfma_f32_16x16x32_bf16 v[92:95], a[60:63], a[4:7], v[92:95]
  v_mfma_f32_16x16x32_bf16 v[124:127], a[60:63], a[8:11], v[124:127]
  v_mfma_f32_16x16x32_bf16 v[156:159], a[60:63], a[12:15], v[156:159]
  s_waitcnt vmcnt(12) lgkmcnt(0)
  s_barrier
  s_mov_b32 s5, 0x40000
Lpoll_5:
  v_cmp_ne_u64 vcc, s[94:95], v[22:23]
  s_nop 0
  s_cbranch_vccz Lpolld_6
  s_sleep 4
  buffer_load_dwordx2 v[22:23], v3, s[96:99], s34 offen sc1
  s_sub_u32 s5, s5, 1
  s_waitcnt vmcnt(0)
  s_cbranch_scc0 Lpoll_5
Lpolld_6:
  s_lshl_b32 s4, s24, 20
  s_and_b32 s5, s25, 1
  s_lshl_b32 s5, s5, 1
  s_add_u32 s5, s5, 14
  s_sub_u32 s5, s5, s25
  s_add_u32 s5, s5, 1
  s_lshl_b32 s5, s5, 16
  s_add_u32 s20, s86, 16777216
  s_addc_u32 s21, s87, 0
  s_add_u32 s20, s20, s4
  s_addc_u32 s21, s21, 0
  s_mov_b32 s22, s5
  s_mov_b32 s23, 0x00020000
  s_lshl_b32 s28, s3, 12
  s_add_u32 s26, s28, 0xc000
  s_add_u32 s27, s28, 0x10000
  s_add_u32 s29, s28, 0x4000
  s_and_b32 s4, s2, 1
  s_lshl_b32 s4, s4, 3
  s_bfe_u32 s5, s2, 0x30003
  s_add_u32 s73, s4, s5
  s_bfe_u32 s4, s2, 0x10001
  s_lshl_b32 s4, s4, 2
  s_lshr_b32 s5, s2, 6
  s_add_u32 s76, s4, s5
  s_bfe_u32 s77, s2, 0x10002
  s_lshl_b32 s78, s73, 3
  s_add_u32 s78, s78, s76
  s_lshl_b32 s79, s3, 12
  s_add_u32 s64, s79, 131072
  v_mfma_f32_16x16x32_bf16 v[32:35], a[64:67], a[16:19], v[32:35]
  s_mov_b32 m0, s26
  ds_read_b128 a[0:3], v16 offset:0
  v_mfma_f32_16x16x32_bf16 v[64:67], a[64:67], a[20:23], v[64:67]
  buffer_load_dwordx4 v2, s[20:23], s28 offen offset:0 sc1 lds
  ds_read_b64_tr_b16 a[32:33], v18 offset:0
  v_mfma_f32_16x16x32_bf16 v[96:99], a[64:67], a[24:27], v[96:99]
  ds_read_b64_tr_b16 a[34:35], v18 offset:2048
  v_mfma_f32_16x16x32_bf16 v[128:131], a[64:67], a[28:31], v[128:131]
  ds_read_b128 a[4:7], v16 offset:2048
  v_mfma_f32_16x16x32_bf16 v[36:39], a[68:71], a[16:19], v[36:39]
  ds_read_b128 a[8:11], v16 offset:4096
  v_mfma_f32_16x16x32_bf16 v[68:71], a[68:71], a[20:23], v[68:71]
  ds_read_b128 a[12:15], v16 offset:6144
  v_mfma_f32_16x16x32_bf16 v[100:103], a[68:71], a[24:27], v[100:103]
  ds_read_b64_tr_b16 a[36:37], v19 offset:0
  v_mfma_f32_16x16x32_bf16 v[132:135], a[68:71], a[28:31], v[132:135]
  ds_read_b64_tr_b16 a[38:39], v19 offset:2048
  v_mfma_f32_16x16x32_bf16 v[40:43], a[72:75], a[16:19], v[40:43]
  ds_read_b64_tr_b16 a[40:41], v20 offset:0
  v_mfma_f32_16x16x32_bf16 v[72:75], a[72:75], a[20:23], v[72:75]
  ds_read_b64_tr_b16 a[42:43], v20 offset:2048
  v_mfma_f32_16x16x32_bf16 v[104:107], a[72:75], a[24:27], v[104:107]
  v_mfma_f32_16x16x32_bf16 v[136:139], a[72:75], a[28:31], v[136:139]
  ds_read_b64_tr_b16 a[44:45], v21 offset:0
  v_mfma_f32_16x16x32_bf16 v[44:47], a[76:79], a[16:19], v[44:47]
  ds_read_b64_tr_b16 a[46:47], v21 offset:2048
  v_mfma_f32_16x16x32_bf16 v[76:79], a[76:79], a[20:23], v[76:79]
  ds_read_b64_tr_b16 a[48:49], v18 offset:8192
  v_mfma_f32_16x16x32_bf16 v[108:111], a[76:79], a[24:27], v[108:111]
  ds_read_b64_tr_b16 a[50:51], v18 offset:10240
  v_mfma_f32_16x16x32_bf16 v[140:143], a[76:79], a[28:31], v[140:143]
  buffer_load_dwordx4 v2, s[20:23], s28 offen offset:1024 sc1 lds
  ds_read_b64_tr_b16 a[52:53], v19 offset:8192
  v_mfma_f32_16x16x32_bf16 v[48:51], a[80:83], a[16:19], v[48:51]
  ds_read_b64_tr_b16 a[54:55], v19 offset:10240
  v_mfma_f32_16x16x32_bf16 v[80:83], a[80:83], a[20:23], v[80:83]
  ds_read_b64_tr_b16 a[56:57], v20 offset:8192
  v_mfma_f32_16x16x32_bf16 v[112:115], a[80:83], a[24:27], v[112:115]
  ds_read_b64_tr_b16 a[58:59], v20 offset:10240
  v_mfma_f32_16x16x32_bf16 v[144:147], a[80:83], a[28:31], v[144:147]
  ds_read_b64_tr_b16 a[60:61], v21 offset:8192
  v_mfma_f32_16x16x32_bf16 v[52:55], a[84:87], a[16:19], v[52:55]
  ds_read_b64_tr_b16 a[62:63], v21 offset:10240
  v_mfma_f32_16x16x32_bf16 v[84:87], a[84:87], a[20:23], v[84:87]
  v_mfma_f32_16x16x32_bf16 v[116:119], a[84:87], a[24:27], v[116:119]
  v_mfma_f32_16x16x32_bf16 v[148:151], a[84:87], a[28:31], v[148:151]
  v_mfma_f32_16x16x32_bf16 v[56:59], a[88:91], a[16:19], v[56:59]
  v_mfma_f32_16x16x32_bf16 v[88:91], a[88:91], a[20:23], v[88:91]
  v_mfma_f32_16x16x32_bf16 v[120:123], a[88:91], a[24:27], v[120:123]
  v_mfma_f32_16x16x32_bf16 v[152:155], a[88:91], a[28:31], v[152:155]
  v_mfma_f32_16x16x32_bf16 v[60:63], a[92:95], a[16:19], v[60:63]
  v_mfma_f32_16x16x32_bf16 v[92:95], a[92:95], a[20:23], v[92:95]
  v_mfma_f32_16x16x32_bf16 v[124:127], a[92:95], a[24:27], v[124:127]
  v_mfma_f32_16x16x32_bf16 v[156:159], a[92:95], a[28:31], v[156:159]
  s_waitcnt lgkmcnt(0)
  v_mfma_f32_16x16x32_bf16 v[32:35], a[32:35], a[0:3], v[32:35]
  buffer_load_dwordx4 v2, s[20:23], s28 offen offset:2048 sc1 lds
  ds_read_b128 a[16:19], v17 offset:0
  v_mfma_f32_16x16x32_bf16 v[64:67], a[32:35], a[4:7], v[64:67]
  ds_read_b64_tr_b16 a[64:65], v18 offset:4096
  v_mfma_f32_16x16x32_bf16 v[96:99], a[32:35], a[8:11], v[96:99]
  ds_read_b64_tr_b16 a[66:67], v18 offset:6144
  v_mfma_f32_16x16x32_bf16 v[128:131], a[32:35], a[12:15], v[128:131]
  ds_read_b128 a[20:23], v17 offset:2048
  v_mfma_f32_16x16x32_bf16 v[36:39], a[36:39], a[0:3], v[36:39]
  ds_read_b128 a[24:27], v17 offset:4096
  v_mfma_f32_16x16x32_bf16 v[68:71], a[36:39], a[4:7], v[68:71]
  ds_read_b128 a[28:31], v17 offset:6144
  v_mfma_f32_16x16x32_bf16 v[100:103], a[36:39], a[8:11], v[100:103]
  ds_read_b64_tr_b16 a[68:69], v19 offset:4096
  v_mfma_f32_16x16x32_bf16 v[132:135], a[36:39], a[12:15], v[132:135]
  ds_read_b64_tr_b16 a[70:71], v19 offset:6144
  v_mfma_f32_16x16x32_bf16 v[40:43], a[40:43], a[0:3], v[40:43]
  ds_read_b64_tr_b16 a[72:73], v20 offset:4096
  v_mfma_f32_16x16x32_bf16 v[72:75], a[40:43], a[4:7], v[72:75]
  ds_read_b64_tr_b16 a[74:75], v20 offset:6144
  v_mfma_f32_16x16x32_bf16 v[104:107], a[40:43], a[8:11], v[104:107]
  v_mfma_f32_16x16x32_bf16 v[136:139], a[40:43], a[12:15], v[136:139]
  ds_read_b64_tr_b16 a[76:77], v21 offset:4096
  v_mfma_f32_16x16x32_bf16 v[44:47], a[44:47], a[0:3], v[44:47]
  buffer_load_dwordx4 v2, s[20:23], s28 offen offset:3072 sc1 lds
  ds_read_b64_tr_b16 a[78:79], v21 offset:6144
  v_mfma_f32_16x16x32_bf16 v[76:79], a[44:47], a[4:7], v[76:79]
  s_xor_b32 s26, s26, 0x4000
  s_add_u32 s28, s28, 0x8000
  ds_read_b64_tr_b16 a[80:81], v18 offset:12288
  v_mfma_f32_16x16x32_bf16 v[108:111], a[44:47], a[8:11], v[108:111]
  s_add_u32 s88, s88, s90
  s_add_u32 s89, s89, 1
  ds_read_b64_tr_b16 a[82:83], v18 offset:14336
  v_mfma_f32_16x16x32_bf16 v[140:143], a[44:47], a[12:15], v[140:143]
  s_cmp_eq_u32 s89, 3
  s_cselect_b32 s89, 0, s89
  s_cselect_b32 s90, s91, s92
  ds_read_b64_tr_b16 a[84:85], v19 offset:12288
  v_mfma_f32_16x16x32_bf16 v[48:51], a[48:51], a[0:3], v[48:51]
  s_add_u32 s68, s68, s70
  s_add_u32 s69, s69, 1
  ds_read_b64_tr_b16 a[86:87], v19 offset:14336
  v_mfma_f32_16x16x32_bf16 v[80:83], a[48:51], a[4:7], v[80:83]
  s_cmp_eq_u32 s69, 3
  s_cselect_b32 s69, 0, s69
  s_cselect_b32 s70, s71, s72
  ds_read_b64_tr_b16 a[88:89], v20 offset:12288
  v_mfma_f32_16x16x32_bf16 v[112:115], a[48:51], a[8:11], v[112:115]
  ds_read_b64_tr_b16 a[90:91], v20 offset:14336
  v_mfma_f32_16x16x32_bf16 v[144:147], a[48:51], a[12:15], v[144:147]
  ds_read_b64_tr_b16 a[92:93], v21 offset:12288
  v_mfma_f32_16x16x32_bf16 v[52:55], a[52:55], a[0:3], v[52:55]
  ds_read_b64_tr_b16 a[94:95], v21 offset:14336
  v_mfma_f32_16x16x32_bf16 v[84:87], a[52:55], a[4:7], v[84:87]
  v_add_u32 v16, s90, v16
  v_add_u32 v17, s90, v17
  v_mfma_f32_16x16x32_bf16 v[116:119], a[52:55], a[8:11], v[116:119]
  v_add_u32 v18, s70, v18
  v_add_u32 v19, s70, v19
  v_mfma_f32_16x16x32_bf16 v[148:151], a[52:55], a[12:15], v[148:151]
  v_add_u32 v20, s70, v20
  v_add_u32 v21, s70, v21
  v_mfma_f32_16x16x32_bf16 v[56:59], a[56:59], a[0:3], v[56:59]
  v_mfma_f32_16x16x32_bf16 v[88:91], a[56:59], a[4:7], v[88:91]
  v_mfma_f32_16x16x32_bf16 v[120:123], a[56:59], a[8:11], v[120:123]
  v_mfma_f32_16x16x32_bf16 v[152:155], a[56:59], a[12:15], v[152:155]
  v_mfma_f32_16x16x32_bf16 v[60:63], a[60:63], a[0:3], v[60:63]
  v_mfma_f32_16x16x32_bf16 v[92:95], a[60:63], a[4:7], v[92:95]
  v_mfma_f32_16x16x32_bf16 v[124:127], a[60:63], a[8:11], v[124:127]
  v_mfma_f32_16x16x32_bf16 v[156:159], a[60:63], a[12:15], v[156:159]
  s_waitcnt vmcnt(4) lgkmcnt(0)
  s_barrier
  s_mov_b32 s6, 0x3e0293ee
  s_mov_b32 s7, s6
  v_mfma_f32_16x16x32_bf16 v[32:35], a[64:67], a[16:19], v[32:35]
  s_mov_b32 m0, s26
  ds_read_b128 a[0:3], v16 offset:0
  v_mfma_f32_16x16x32_bf16 v[64:67], a[64:67], a[20:23], v[64:67]
  buffer_load_dwordx4 v2, s[20:23], s28 offen offset:0 sc1 lds
  ds_read_b64_tr_b16 a[32:33], v18 offset:0
  v_mfma_f32_16x16x32_bf16 v[96:99], a[64:67], a[24:27], v[96:99]
  ds_read_b64_tr_b16 a[34:35], v18 offset:2048
  v_mfma_f32_16x16x32_bf16 v[128:131], a[64:67], a[28:31], v[128:131]
  buffer_load_dwordx4 v2, s[20:23], s28 offen offset:1024 sc1 lds
  ds_read_b128 a[4:7], v16 offset:2048
  v_mfma_f32_16x16x32_bf16 v[36:39], a[68:71], a[16:19], v[36:39]
  ds_read_b128 a[8:11], v16 offset:4096
  v_mfma_f32_16x16x32_bf16 v[68:71], a[68:71], a[20:23], v[68:71]
  ds_read_b128 a[12:15], v16 offset:6144
  v_mfma_f32_16x16x32_bf16 v[100:103], a[68:71], a[24:27], v[100:103]
  ds_read_b64_tr_b16 a[36:37], v19 offset:0
  v_mfma_f32_16x16x32_bf16 v[132:135], a[68:71], a[28:31], v[132:135]
  buffer_load_dwordx4 v2, s[20:23], s28 offen offset:2048 sc1 lds
  ds_read_b64_tr_b16 a[38:39], v19 offset:2048
  v_mfma_f32_16x16x32_bf16 v[40:43], a[72:75], a[16:19], v[40:43]
  ds_read_b64_tr_b16 a[40:41], v20 offset:0
  v_mfma_f32_16x16x32_bf16 v[72:75], a[72:75], a[20:23], v[72:75]
  ds_read_b64_tr_b16 a[42:43], v20 offset:2048
  v_mfma_f32_16x16x32_bf16 v[104:107], a[72:75], a[24:27], v[104:107]
  v_mfma_f32_16x16x32_bf16 v[136:139], a[72:75], a[28:31], v[136:139]
  buffer_load_dwordx4 v2, s[20:23], s28 offen offset:3072 sc1 lds
  ds_read_b64_tr_b16 a[44:45], v21 offset:0
  v_mfma_f32_16x16x32_bf16 v[44:47], a[76:79], a[16:19], v[44:47]
  s_xor_b32 s26, s26, 0x8000
  s_add_u32 s28, s28, 0x8000
  s_mov_b32 m0, s27
  v_mfma_f32_16x16x32_bf16 v[76:79], a[76:79], a[20:23], v[76:79]
  ds_read_b64_tr_b16 a[46:47], v21 offset:2048
  ds_read_b64_tr_b16 a[48:49], v18 offset:8192
  v_mfma_f32_16x16x32_bf16 v[108:111], a[76:79], a[24:27], v[108:111]
  ds_read_b64_tr_b16 a[50:51], v18 offset:10240
  v_mfma_f32_16x16x32_bf16 v[140:143], a[76:79], a[28:31], v[140:143]
  buffer_load_dwordx4 v2, s[20:23], s29 offen offset:0 sc1 lds
  ds_read_b64_tr_b16 a[52:53], v19 offset:8192
  v_mfma_f32_16x16x32_bf16 v[48:51], a[80:83], a[16:19], v[48:51]
  ds_read_b64_tr_b16 a[54:55], v19 offset:10240
  v_mfma_f32_16x16x32_bf16 v[80:83], a[80:83], a[20:23], v[80:83]
  ds_read_b64_tr_b16 a[56:57], v20 offset:8192
  v_mfma_f32_16x16x32_bf16 v[112:115], a[80:83], a[24:27], v[112:115]
  ds_read_b64_tr_b16 a[58:59], v20 offset:10240
  v_mfma_f32_16x16x32_bf16 v[144:147], a[80:83], a[28:31], v[144:147]
  buffer_load_dwordx4 v2, s[20:23], s29 offen offset:1024 sc1 lds
  ds_read_b64_tr_b16 a[60:61], v21 offset:8192
  v_mfma_f32_16x16x32_bf16 v[52:55], a[84:87], a[16:19], v[52:55]
  ds_read_b64_tr_b16 a[62:63], v21 offset:10240
  v_mfma_f32_16x16x32_bf16 v[84:87], a[84:87], a[20:23], v[84:87]
  v_mfma_f32_16x16x32_bf16 v[116:119], a[84:87], a[24:27], v[116:119]
  v_mfma_f32_16x16x32_bf16 v[148:151], a[84:87], a[28:31], v[148:151]
  buffer_load_dwordx4 v2, s[20:23], s29 offen offset:2048 sc1 lds
  v_mfma_f32_16x16x32_bf16 v[56:59], a[88:91], a[16:19], v[56:59]
  v_mfma_f32_16x16x32_bf16 v[88:91], a[88:91], a[20:23], v[88:91]
  v_mfma_f32_16x16x32_bf16 v[120:123], a[88:91], a[24:27], v[120:123]
  v_mfma_f32_16x16x32_bf16 v[152:155], a[88:91], a[28:31], v[152:155]
  buffer_load_dwordx4 v2, s[20:23], s29 offen offset:3072 sc1 lds
  v_mfma_f32_16x16x32_bf16 v[60:63], a[92:95], a[16:19], v[60:63]
  s_xor_b32 s27, s27, 0x4000
  s_add_u32 s29, s29, 0x8000
  v_mfma_f32_16x16x32_bf16 v[92:95], a[92:95], a[20:23], v[92:95]
  v_mfma_f32_16x16x32_bf16 v[124:127], a[92:95], a[24:27], v[124:127]
  v_mfma_f32_16x16x32_bf16 v[156:159], a[92:95], a[28:31], v[156:159]
  s_waitcnt lgkmcnt(0)
  v_mfma_f32_16x16x32_bf16 v[32:35], a[32:35], a[0:3], v[32:35]
  ds_read_b128 a[16:19], v17 offset:0
  ds_read_b64_tr_b16 a[64:65], v18 offset:4096
  v_mfma_f32_16x16x32_bf16 v[36:39], a[36:39], a[0:3], v[36:39]
  ds_read_b64_tr_b16 a[66:67], v18 offset:6144
  ds_read_b128 a[20:23], v17 offset:2048
  v_mfma_f32_16x16x32_bf16 v[40:43], a[40:43], a[0:3], v[40:43]
  ds_read_b128 a[24:27], v17 offset:4096
  ds_read_b128 a[28:31], v17 offset:6144
  v_mfma_f32_16x16x32_bf16 v[44:47], a[44:47], a[0:3], v[44:47]
  ds_read_b64_tr_b16 a[68:69], v19 offset:4096
  ds_read_b64_tr_b16 a[70:71], v19 offset:6144
  v_mfma_f32_16x16x32_bf16 v[48:51], a[48:51], a[0:3], v[48:51]
  ds_read_b64_tr_b16 a[72:73], v20 offset:4096
  ds_read_b64_tr_b16 a[74:75], v20 offset:6144
  v_mfma_f32_16x16x32_bf16 v[52:55], a[52:55], a[0:3], v[52:55]
  ds_read_b64_tr_b16 a[76:77], v21 offset:4096
  v_mfma_f32_16x16x32_bf16 v[56:59], a[56:59], a[0:3], v[56:59]
  ds_read_b64_tr_b16 a[78:79], v21 offset:6144
  ds_read_b64_tr_b16 a[80:81], v18 offset:12288
  v_mfma_f32_16x16x32_bf16 v[60:63], a[60:63], a[0:3], v[60:63]
  ds_read_b64_tr_b16 a[82:83], v18 offset:14336
  ds_read_b64_tr_b16 a[84:85], v19 offset:12288
  v_mfma_f32_16x16x32_bf16 v[64:67], a[32:35], a[4:7], v[64:67]
  ds_read_b64_tr_b16 a[86:87], v19 offset:14336
  ds_read_b64_tr_b16 a[88:89], v20 offset:12288
  v_mfma_f32_16x16x32_bf16 v[68:71], a[36:39], a[4:7], v[68:71]
  ds_read_b64_tr_b16 a[90:91], v20 offset:14336
  ds_read_b64_tr_b16 a[92:93], v21 offset:12288
  v_mfma_f32_16x16x32_bf16 v[72:75], a[40:43], a[4:7], v[72:75]
  ds_read_b64_tr_b16 a[94:95], v21 offset:14336
  v_mfma_f32_16x16x32_bf16 v[76:79], a[44:47], a[4:7], v[76:79]
  v_mfma_f32_16x16x32_bf16 v[80:83], a[48:51], a[4:7], v[80:83]
  v_mfma_f32_16x16x32_bf16 v[84:87], a[52:55], a[4:7], v[84:87]
  v_mfma_f32_16x16x32_bf16 v[88:91], a[56:59], a[4:7], v[88:91]
  v_mfma_f32_16x16x32_bf16 v[92:95], a[60:63], a[4:7], v[92:95]
  s_waitcnt lgkmcnt(0)
  v_mfma_f32_16x16x32_bf16 v[32:35], a[64:67], a[16:19], v[32:35]
  v_mfma_f32_16x16x32_bf16 v[36:39], a[68:71], a[16:19], v[36:39]
  v_mfma_f32_16x16x32_bf16 v[40:43], a[72:75], a[16:19], v[40:43]
  v_mfma_f32_16x16x32_bf16 v[44:47], a[76:79], a[16:19], v[44:47]
  v_mfma_f32_16x16x32_bf16 v[48:51], a[80:83], a[16:19], v[48:51]
  v_mfma_f32_16x16x32_bf16 v[52:55], a[84:87], a[16:19], v[52:55]
  s_nop 2
  v_pk_mul_f32 v[32:33], v[32:33], s[6:7]
  v_pk_mul_f32 v[34:35], v[34:35], s[6:7]
  v_mfma_f32_16x16x32_bf16 v[56:59], a[88:91], a[16:19], v[56:59]
  v_pk_mul_f32 v[36:37], v[36:37], s[6:7]
  v_pk_mul_f32 v[38:39], v[38:39], s[6:7]
  v_mfma_f32_16x16x32_bf16 v[60:63], a[92:95], a[16:19], v[60:63]
  v_cvt_pk_bf16_f32 v32, v32, v33
  v_cvt_pk_bf16_f32 v33, v34, v35
  v_mfma_f32_16x16x32_bf16 v[64:67], a[64:67], a[20:23], v[64:67]
  v_cvt_pk_bf16_f32 v34, v36, v37
  v_cvt_pk_bf16_f32 v35, v38, v39
  v_mfma_f32_16x16x32_bf16 v[68:71], a[68:71], a[20:23], v[68:71]
  v_accvgpr_write_b32 a128, v32
  v_accvgpr_write_b32 a129, v33
  v_mfma_f32_16x16x32_bf16 v[72:75], a[72:75], a[20:23], v[72:75]
  v_accvgpr_write_b32 a130, v34
  v_accvgpr_write_b32 a131, v35
  v_mfma_f32_16x16x32_bf16 v[76:79], a[76:79], a[20:23], v[76:79]
  v_pk_mul_f32 v[40:41], v[40:41], s[6:7]
  v_pk_mul_f32 v[42:43], v[42:43], s[6:7]
  v_mfma_f32_16x16x32_bf16 v[80:83], a[80:83], a[20:23], v[80:83]
  v_pk_mul_f32 v[44:45], v[44:45], s[6:7]
  v_pk_mul_f32 v[46:47], v[46:47], s[6:7]
  v_mfma_f32_16x16x32_bf16 v[84:87], a[84:87], a[20:23], v[84:87]
  v_cvt_pk_bf16_f32 v40, v40, v41
  v_cvt_pk_bf16_f32 v41, v42, v43
  v_mfma_f32_16x16x32_bf16 v[88:91], a[88:91], a[20:23], v[88:91]
  v_cvt_pk_bf16_f32 v42, v44, v45
  v_cvt_pk_bf16_f32 v43, v46, v47
  v_mfma_f32_16x16x32_bf16 v[92:95], a[92:95], a[20:23], v[92:95]
  v_accvgpr_write_b32 a132, v40
  v_accvgpr_write_b32 a133, v41
  v_mfma_f32_16x16x32_bf16 v[96:99], a[32:35], a[8:11], v[96:99]
  v_accvgpr_write_b32 a134, v42
  v_accvgpr_write_b32 a135, v43
  v_mfma_f32_16x16x32_bf16 v[100:103], a[36:39], a[8:11], v[100:103]
  v_mfma_f32_32x32x16_bf16 v[160:175], a[236:239], a[236:239], 0
  v_pk_mul_f32 v[48:49], v[48:49], s[6:7]
  v_mfma_f32_16x16x32_bf16 v[96:99], a[64:67], a[24:27], v[96:99]
  v_pk_mul_f32 v[50:51], v[50:51], s[6:7]
  v_pk_mul_f32 v[52:53], v[52:53], s[6:7]
  v_mfma_f32_16x16x32_bf16 v[100:103], a[68:71], a[24:27], v[100:103]
  v_pk_mul_f32 v[54:55], v[54:55], s[6:7]
  v_cvt_pk_bf16_f32 v48, v48, v49
  v_mfma_f32_16x16x32_bf16 v[104:107], a[40:43], a[8:11], v[104:107]
  v_cvt_pk_bf16_f32 v49, v50, v51
  v_cvt_pk_bf16_f32 v50, v52, v53
  v_mfma_f32_16x16x32_bf16 v[108:111], a[44:47], a[8:11], v[108:111]
  v_cvt_pk_bf16_f32 v51, v54, v55
  v_accvgpr_write_b32 a136, v48
  v_mfma_f32_16x16x32_bf16 v[104:107], a[72:75], a[24:27], v[104:107]
  v_accvgpr_write_b32 a137, v49
  v_accvgpr_write_b32 a138, v50
  v_mfma_f32_16x16x32_bf16 v[108:111], a[76:79], a[24:27], v[108:111]
  v_accvgpr_write_b32 a139, v51
  v_pk_mul_f32 v[56:57], v[56:57], s[6:7]
  v_mfma_f32_16x16x32_bf16 v[112:115], a[48:51], a[8:11], v[112:115]
  v_pk_mul_f32 v[58:59], v[58:59], s[6:7]
  v_pk_mul_f32 v[60:61], v[60:61], s[6:7]
  v_mfma_f32_16x16x32_bf16 v[116:119], a[52:55], a[8:11], v[116:119]
  v_pk_mul_f32 v[62:63], v[62:63], s[6:7]
  v_cvt_pk_bf16_f32 v56, v56, v57
  v_mfma_f32_16x16x32_bf16 v[112:115], a[80:83], a[24:27], v[112:115]
  v_cvt_pk_bf16_f32 v57, v58, v59
  v_cvt_pk_bf16_f32 v58, v60, v61
  v_mfma_f32_16x16x32_bf16 v[116:119], a[84:87], a[24:27], v[116:119]
  v_cvt_pk_bf16_f32 v59, v62, v63
  v_accvgpr_write_b32 a140, v56
  v_mfma_f32_16x16x32_bf16 v[120:123], a[56:59], a[8:11], v[120:123]
  v_accvgpr_write_b32 a141, v57
  v_accvgpr_write_b32 a142, v58
  v_mfma_f32_16x16x32_bf16 v[124:127], a[60:63], a[8:11], v[124:127]
  v_accvgpr_write_b32 a143, v59
  v_mfma_f32_32x32x16_bf16 v[176:191], a[236:239], a[236:239], 0
  v_mfma_f32_16x16x32_bf16 v[120:123], a[88:91], a[24:27], v[120:123]
  v_pk_mul_f32 v[64:65], v[64:65], s[6:7]
  v_pk_mul_f32 v[66:67], v[66:67], s[6:7]
  v_mfma_f32_16x16x32_bf16 v[124:127], a[92:95], a[24:27], v[124:127]
  v_pk_mul_f32 v[68:69], v[68:69], s[6:7]
  v_pk_mul_f32 v[70:71], v[70:71], s[6:7]
  v_mfma_f32_16x16x32_bf16 v[128:131], a[32:35], a[12:15], v[128:131]
  v_cvt_pk_bf16_f32 v64, v64, v65
  v_cvt_pk_bf16_f32 v65, v66, v67
  v_mfma_f32_16x16x32_bf16 v[132:135], a[36:39], a[12:15], v[132:135]
  v_cvt_pk_bf16_f32 v66, v68, v69
  v_cvt_pk_bf16_f32 v67, v70, v71
  v_mfma_f32_16x16x32_bf16 v[128:131], a[64:67], a[28:31], v[128:131]
  v_accvgpr_write_b32 a144, v64
  v_accvgpr_write_b32 a145, v65
  v_mfma_f32_16x16x32_bf16 v[132:135], a[68:71], a[28:31], v[132:135]
  v_accvgpr_write_b32 a146, v66
  v_accvgpr_write_b32 a147, v67
  v_mfma_f32_16x16x32_bf16 v[136:139], a[40:43], a[12:15], v[136:139]
  v_pk_mul_f32 v[72:73], v[72:73], s[6:7]
  v_pk_mul_f32 v[74:75], v[74:75], s[6:7]
  v_mfma_f32_16x16x32_bf16 v[140:143], a[44:47], a[12:15], v[140:143]
  v_pk_mul_f32 v[76:77], v[76:77], s[6:7]
  v_pk_mul_f32 v[78:79], v[78:79], s[6:7]
  v_mfma_f32_16x16x32_bf16 v[136:139], a[72:75], a[28:31], v[136:139]
  v_cvt_pk_bf16_f32 v72, v72, v73
  v_cvt_pk_bf16_f32 v73, v74, v75
  v_mfma_f32_16x16x32_bf16 v[140:143], a[76:79], a[28:31], v[140:143]
  v_cvt_pk_bf16_f32 v74, v76, v77
  v_cvt_pk_bf16_f32 v75, v78, v79
  v_mfma_f32_16x16x32_bf16 v[144:147], a[48:51], a[12:15], v[144:147]
  v_accvgpr_write_b32 a148, v72
  v_accvgpr_write_b32 a149, v73
  v_mfma_f32_16x16x32_bf16 v[148:151], a[52:55], a[12:15], v[148:151]
  v_accvgpr_write_b32 a150, v74
  v_accvgpr_write_b32 a151, v75
  v_mfma_f32_16x16x32_bf16 v[144:147], a[80:83], a[28:31], v[144:147]
  v_mfma_f32_32x32x16_bf16 v[192:207], a[236:239], a[236:239], 0
  v_pk_mul_f32 v[80:81], v[80:81], s[6:7]
  v_mfma_f32_16x16x32_bf16 v[148:151], a[84:87], a[28:31], v[148:151]
  v_pk_mul_f32 v[82:83], v[82:83], s[6:7]
  v_pk_mul_f32 v[84:85], v[84:85], s[6:7]
  v_mfma_f32_16x16x32_bf16 v[152:155], a[56:59], a[12:15], v[152:155]
  v_pk_mul_f32 v[86:87], v[86:87], s[6:7]
  v_cvt_pk_bf16_f32 v80, v80, v81
  v_mfma_f32_16x16x32_bf16 v[156:159], a[60:63], a[12:15], v[156:159]
  v_cvt_pk_bf16_f32 v81, v82, v83
  v_cvt_pk_bf16_f32 v82, v84, v85
  v_mfma_f32_16x16x32_bf16 v[152:155], a[88:91], a[28:31], v[152:155]
  v_cvt_pk_bf16_f32 v83, v86, v87
  v_accvgpr_write_b32 a152, v80
  v_mfma_f32_16x16x32_bf16 v[156:159], a[92:95], a[28:31], v[156:159]
  v_accvgpr_write_b32 a153, v81
  v_accvgpr_write_b32 a154, v82
  v_accvgpr_write_b32 a155, v83
  v_pk_mul_f32 v[88:89], v[88:89], s[6:7]
  v_pk_mul_f32 v[90:91], v[90:91], s[6:7]
  v_pk_mul_f32 v[92:93], v[92:93], s[6:7]
  v_pk_mul_f32 v[94:95], v[94:95], s[6:7]
  v_cvt_pk_bf16_f32 v88, v88, v89
  v_cvt_pk_bf16_f32 v89, v90, v91
  v_cvt_pk_bf16_f32 v90, v92, v93
  v_cvt_pk_bf16_f32 v91, v94, v95
  v_accvgpr_write_b32 a156, v88
  v_accvgpr_write_b32 a157, v89
  v_accvgpr_write_b32 a158, v90
  v_accvgpr_write_b32 a159, v91
  v_mfma_f32_32x32x16_bf16 v[208:223], a[236:239], a[236:239], 0
  v_pk_mul_f32 v[96:97], v[96:97], s[6:7]
  v_pk_mul_f32 v[98:99], v[98:99], s[6:7]
  v_pk_mul_f32 v[100:101], v[100:101], s[6:7]
  v_pk_mul_f32 v[102:103], v[102:103], s[6:7]
  v_cvt_pk_bf16_f32 v96, v96, v97
  v_cvt_pk_bf16_f32 v97, v98, v99
  v_cvt_pk_bf16_f32 v98, v100, v101
  v_cvt_pk_bf16_f32 v99, v102, v103
  v_accvgpr_write_b32 a160, v96
  v_accvgpr_write_b32 a161, v97
  v_accvgpr_write_b32 a162, v98
  v_accvgpr_write_b32 a163, v99
  v_pk_mul_f32 v[104:105], v[104:105], s[6:7]
  v_pk_mul_f32 v[106:107], v[106:107], s[6:7]
  v_pk_mul_f32 v[108:109], v[108:109], s[6:7]
  v_pk_mul_f32 v[110:111], v[110:111], s[6:7]
  v_cvt_pk_bf16_f32 v104, v104, v105
  v_cvt_pk_bf16_f32 v105, v106, v107
  v_cvt_pk_bf16_f32 v106, v108, v109
  v_cvt_pk_bf16_f32 v107, v110, v111
  v_accvgpr_write_b32 a164, v104
  v_accvgpr_write_b32 a165, v105
  v_accvgpr_write_b32 a166, v106
  v_accvgpr_write_b32 a167, v107
  v_mfma_f32_32x32x16_bf16 v[224:239], a[236:239], a[236:239], 0
  v_pk_mul_f32 v[112:113], v[112:113], s[6:7]
  v_pk_mul_f32 v[114:115], v[114:115], s[6:7]
  v_pk_mul_f32 v[116:117], v[116:117], s[6:7]
  v_pk_mul_f32 v[118:119], v[118:119], s[6:7]
  v_cvt_pk_bf16_f32 v112, v112, v113
  v_cvt_pk_bf16_f32 v113, v114, v115
  v_cvt_pk_bf16_f32 v114, v116, v117
  v_cvt_pk_bf16_f32 v115, v118, v119
  v_accvgpr_write_b32 a168, v112
  v_accvgpr_write_b32 a169, v113
  v_accvgpr_write_b32 a170, v114
  v_accvgpr_write_b32 a171, v115
  v_pk_mul_f32 v[120:121], v[120:121], s[6:7]
  v_pk_mul_f32 v[122:123], v[122:123], s[6:7]
  v_pk_mul_f32 v[124:125], v[124:125], s[6:7]
  v_pk_mul_f32 v[126:127], v[126:127], s[6:7]
  v_cvt_pk_bf16_f32 v120, v120, v121
  v_cvt_pk_bf16_f32 v121, v122, v123
  v_cvt_pk_bf16_f32 v122, v124, v125
  v_cvt_pk_bf16_f32 v123, v126, v127
  v_accvgpr_write_b32 a172, v120
  v_accvgpr_write_b32 a173, v121
  v_accvgpr_write_b32 a174, v122
  v_accvgpr_write_b32 a175, v123
  v_mfma_f32_32x32x16_bf16 v[240:255], a[236:239], a[236:239], 0
  v_pk_mul_f32 v[128:129], v[128:129], s[6:7]
  v_pk_mul_f32 v[130:131], v[130:131], s[6:7]
  v_pk_mul_f32 v[132:133], v[132:133], s[6:7]
  v_pk_mul_f32 v[134:135], v[134:135], s[6:7]
  v_cvt_pk_bf16_f32 v128, v128, v129
  v_cvt_pk_bf16_f32 v129, v130, v131
  v_cvt_pk_bf16_f32 v130, v132, v133
  v_cvt_pk_bf16_f32 v131, v134, v135
  v_accvgpr_write_b32 a176, v128
  v_accvgpr_write_b32 a177, v129
  v_accvgpr_write_b32 a178, v130
  v_accvgpr_write_b32 a179, v131
  v_pk_mul_f32 v[136:137], v[136:137], s[6:7]
  v_pk_mul_f32 v[138:139], v[138:139], s[6:7]
  v_pk_mul_f32 v[140:141], v[140:141], s[6:7]
  v_pk_mul_f32 v[142:143], v[142:143], s[6:7]
  v_cvt_pk_bf16_f32 v136, v136, v137
  v_cvt_pk_bf16_f32 v137, v138, v139
  v_cvt_pk_bf16_f32 v138, v140, v141
  v_cvt_pk_bf16_f32 v139, v142, v143
  v_accvgpr_write_b32 a180, v136
  v_accvgpr_write_b32 a181, v137
  v_accvgpr_write_b32 a182, v138
  v_accvgpr_write_b32 a183, v139
  v_mfma_f32_32x32x16_bf16 v[128:143], a[236:239], a[236:239], 0
  v_pk_mul_f32 v[144:145], v[144:145], s[6:7]
  v_pk_mul_f32 v[146:147], v[146:147], s[6:7]
  v_pk_mul_f32 v[148:149], v[148:149], s[6:7]
  v_pk_mul_f32 v[150:151], v[150:151], s[6:7]
  v_cvt_pk_bf16_f32 v144, v144, v145
  v_cvt_pk_bf16_f32 v145, v146, v147
  v_cvt_pk_bf16_f32 v146, v148, v149
  v_cvt_pk_bf16_f32 v147, v150, v151
  v_accvgpr_write_b32 a184, v144
  v_accvgpr_write_b32 a185, v145
  v_accvgpr_write_b32 a186, v146
  v_accvgpr_write_b32 a187, v147
  v_pk_mul_f32 v[152:153], v[152:153], s[6:7]
  v_pk_mul_f32 v[154:155], v[154:155], s[6:7]
  v_pk_mul_f32 v[156:157], v[156:157], s[6:7]
  v_pk_mul_f32 v[158:159], v[158:159], s[6:7]
  v_cvt_pk_bf16_f32 v152, v152, v153
  v_cvt_pk_bf16_f32 v153, v154, v155
  v_cvt_pk_bf16_f32 v154, v156, v157
  v_cvt_pk_bf16_f32 v155, v158, v159
  v_accvgpr_write_b32 a188, v152
  v_accvgpr_write_b32 a189, v153
  v_accvgpr_write_b32 a190, v154
  v_accvgpr_write_b32 a191, v155
  v_mfma_f32_32x32x16_bf16 v[144:159], a[236:239], a[236:239], 0
  v_add_u32 v3, 0xc000, v2
  v_add_u32 v4, 0x10000, v2
  v_mov_b32 v5, 0xf149f2ca
  s_mov_b32 s89, 0
  v_mfma_f32_32x32x16_bf16 a[192:207], a[236:239], a[236:239], 0
  s_waitcnt vmcnt(8)
  s_barrier
  ds_read_b128 a[32:35], v3 offset:0
  ds_read_b128 a[36:39], v3 offset:1024
  ds_read_b128 a[40:43], v3 offset:2048
  ds_read_b128 a[44:47], v3 offset:3072
  ds_read_b128 a[48:51], v3 offset:4096
  ds_read_b128 a[52:55], v3 offset:5120
  ds_read_b128 a[56:59], v3 offset:6144
  ds_read_b128 a[60:63], v3 offset:7168
  s_waitcnt lgkmcnt(6)
  v_mfma_f32_16x16x32_bf16 v[64:67], a[32:35], a[128:131], 0
  s_lshl_b32 s4, s2, 2
  s_add_u32 s4, s4, s3
  s_lshl_b32 s6, s4, 13
  v_mfma_f32_16x16x32_bf16 v[72:75], a[32:35], a[144:147], 0
  s_lshl_b32 s7, s4, 11
  s_mov_b32 s8, s74
  s_mov_b32 s9, s75
  v_mfma_f32_16x16x32_bf16 v[80:83], a[32:35], a[160:163], 0
  s_mov_b32 s10, 8388608
  s_mov_b32 s11, 0x00020000
  s_mov_b32 s12, s80
  v_mfma_f32_16x16x32_bf16 v[88:91], a[32:35], a[176:179], 0
  s_mov_b32 s13, s81
  s_mov_b32 s14, 2097152
  ds_read_b128 a[0:3], v3 offset:8192
  v_mfma_f32_16x16x32_bf16 v[64:67], a[36:39], a[132:135], v[64:67]
  s_mov_b32 s15, 0x00020000
  s_add_u32 s16, s86, 67108864
  s_addc_u32 s17, s87, 0
  v_mfma_f32_16x16x32_bf16 v[72:75], a[36:39], a[148:151], v[72:75]
  s_mov_b32 s18, 16777216
  s_mov_b32 s19, 0x00020000
  v_mfma_f32_16x16x32_bf16 v[80:83], a[36:39], a[164:167], v[80:83]
  v_and_b32 v6, 15, v1
  v_lshrrev_b32 v7, 4, v1
  v_mfma_f32_16x16x32_bf16 v[88:91], a[36:39], a[180:183], v[88:91]
  s_waitcnt lgkmcnt(5)
  ds_read_b128 a[4:7], v3 offset:9216
  v_sub_u32 v6, v6, v7
  v_mfma_f32_16x16x32_bf16 v[64:67], a[40:43], a[136:139], v[64:67]
  v_lshlrev_b32 v6, 2, v6
  v_add_u32 v6, s3, v6
  v_mfma_f32_16x16x32_bf16 v[72:75], a[40:43], a[152:155], v[72:75]
  v_cmp_gt_i32 s[32:33], 0, v6
  v_cmp_gt_i32 s[34:35], 1, v6
  v_mfma_f32_16x16x32_bf16 v[80:83], a[40:43], a[168:171], v[80:83]
  v_cmp_gt_i32 s[36:37], 2, v6
  v_cmp_gt_i32 s[38:39], 3, v6
  v_mfma_f32_16x16x32_bf16 v[88:91], a[40:43], a[184:187], v[88:91]
  ds_read_b128 a[8:11], v3 offset:10240
  v_cmp_gt_i32 s[40:41], 16, v6
  v_mfma_f32_16x16x32_bf16 v[64:67], a[44:47], a[140:143], v[64:67]
  v_cmp_gt_i32 s[42:43], 17, v6
  v_cmp_gt_i32 s[44:45], 18, v6
  v_mfma_f32_16x16x32_bf16 v[72:75], a[44:47], a[156:159], v[72:75]
  v_cmp_gt_i32 s[46:47], 19, v6
  v_cmp_gt_i32 s[48:49], 32, v6
  v_mfma_f32_16x16x32_bf16 v[80:83], a[44:47], a[172:175], v[80:83]
  v_cmp_gt_i32 s[50:51], 33, v6
  v_cmp_gt_i32 s[52:53], 34, v6
  v_mfma_f32_16x16x32_bf16 v[88:91], a[44:47], a[188:191], v[88:91]
  s_waitcnt lgkmcnt(5)
  ds_read_b128 a[12:15], v3 offset:11264
  v_cmp_gt_i32 s[54:55], 35, v6
  v_mfma_f32_16x16x32_bf16 v[68:71], a[48:51], a[128:131], 0
  v_cmp_gt_i32 s[56:57], 48, v6
  v_cmp_gt_i32 s[58:59], 49, v6
  v_mfma_f32_16x16x32_bf16 v[76:79], a[48:51], a[144:147], 0
  s_mov_b32 s30, 0x8000
  v_cmp_gt_i32 s[60:61], 50, v6
  v_cmp_gt_i32 s[62:63], 51, v6
  v_mfma_f32_16x16x32_bf16 v[84:87], a[48:51], a[160:163], 0
  s_mov_b32 s31, 0x4000
  v_mfma_f32_16x16x32_bf16 v[92:95], a[48:51], a[176:179], 0
  ds_read_b128 a[16:19], v3 offset:12288
  v_mfma_f32_16x16x32_bf16 v[68:71], a[52:55], a[132:135], v[68:71]
  v_mfma_f32_16x16x32_bf16 v[76:79], a[52:55], a[148:151], v[76:79]
  v_mfma_f32_16x16x32_bf16 v[84:87], a[52:55], a[164:167], v[84:87]
  v_mfma_f32_16x16x32_bf16 v[92:95], a[52:55], a[180:183], v[92:95]
  s_waitcnt lgkmcnt(5)
  ds_read_b128 a[20:23], v3 offset:13312
  v_mfma_f32_16x16x32_bf16 v[68:71], a[56:59], a[136:139], v[68:71]
  v_mfma_f32_16x16x32_bf16 v[76:79], a[56:59], a[152:155], v[76:79]
  v_mfma_f32_16x16x32_bf16 v[84:87], a[56:59], a[168:171], v[84:87]
  v_mfma_f32_16x16x32_bf16 v[92:95], a[56:59], a[184:187], v[92:95]
  ds_read_b128 a[24:27], v3 offset:14336
  v_mfma_f32_16x16x32_bf16 v[68:71], a[60:63], a[140:143], v[68:71]
  v_mfma_f32_16x16x32_bf16 v[76:79], a[60:63], a[156:159], v[76:79]
  v_mfma_f32_16x16x32_bf16 v[84:87], a[60:63], a[172:175], v[84:87]
  v_mfma_f32_16x16x32_bf16 v[92:95], a[60:63], a[188:191], v[92:95]
  ds_read_b128 a[28:31], v3 offset:15360
  s_cmp_lg_u32 s25, 0
  s_nop 0
  s_cbranch_scc1 La_nomask0
  v_cndmask_b32 v64, v64, v5, s[32:33]
  v_cndmask_b32 v65, v65, v5, s[34:35]
  v_cndmask_b32 v66, v66, v5, s[36:37]
  v_cndmask_b32 v67, v67, v5, s[38:39]
  v_cndmask_b32 v68, v68, v5, s[40:41]
  v_cndmask_b32 v69, v69, v5, s[42:43]
  v_cndmask_b32 v70, v70, v5, s[44:45]
  v_cndmask_b32 v71, v71, v5, s[46:47]
La_nomask0:
  v_max3_f32 v6, v64, v65, v66
  v_max3_f32 v7, v67, v68, v69
  v_max3_f32 v6, v6, v70, v71
  v_max_f32 v6, v6, v7
  v_max3_f32 v8, v72, v73, v74
  v_max3_f32 v9, v75, v76, v77
  v_max3_f32 v8, v8, v78, v79
  v_max_f32 v8, v8, v9
  v_max3_f32 v10, v80, v81, v82
  v_max3_f32 v11, v83, v84, v85
  v_max3_f32 v10, v10, v86, v87
  v_max_f32 v10, v10, v11
  v_max3_f32 v12, v88, v89, v90
  v_max3_f32 v13, v91, v92, v93
  v_max3_f32 v12, v12, v94, v95
  v_max_f32 v12, v12, v13
  v_mov_b32 v7, v6
  v_mov_b32 v9, v8
  v_mov_b32 v11, v10
  v_mov_b32 v13, v12
  v_permlane32_swap_b32 v6, v7
  v_permlane32_swap_b32 v8, v9
  v_permlane32_swap_b32 v10, v11
  v_permlane32_swap_b32 v12, v13
  v_max_f32 v6, v6, v7
  v_max_f32 v8, v8, v9
  v_max_f32 v10, v10, v11
  v_max_f32 v12, v12, v13
  v_mov_b32 v7, v6
  v_mov_b32 v9, v8
  v_mov_b32 v11, v10
  v_mov_b32 v13, v12
  v_permlane16_swap_b32 v6, v7
  v_permlane16_swap_b32 v8, v9
  v_permlane16_swap_b32 v10, v11
  v_permlane16_swap_b32 v12, v13
  v_max_f32 v6, v6, v7
  v_max_f32 v8, v8, v9
  v_max_f32 v10, v10, v11
  v_max_f32 v12, v12, v13
  v_sub_f32 v16, 0, v6
  v_sub_f32 v17, 0, v6
  v_sub_f32 v18, 0, v6
  v_sub_f32 v19, 0, v6
  v_sub_f32 v20, 0, v8
  v_sub_f32 v21, 0, v8
  v_sub_f32 v22, 0, v8
  v_sub_f32 v23, 0, v8
  v_sub_f32 v24, 0, v10
  v_sub_f32 v25, 0, v10
  v_sub_f32 v26, 0, v10
  v_sub_f32 v27, 0, v10
  v_sub_f32 v28, 0, v12
  v_sub_f32 v29, 0, v12
  v_sub_f32 v30, 0, v12
  v_sub_f32 v31, 0, v12
  v_pk_add_f32 v[64:65], v[64:65], v[16:17]
  v_pk_add_f32 v[66:67], v[66:67], v[16:17]
  v_pk_add_f32 v[68:69], v[68:69], v[16:17]
  v_pk_add_f32 v[70:71], v[70:71], v[16:17]
  v_pk_add_f32 v[72:73], v[72:73], v[20:21]
  v_pk_add_f32 v[74:75], v[74:75], v[20:21]
  v_pk_add_f32 v[76:77], v[76:77], v[20:21]
  v_pk_add_f32 v[78:79], v[78:79], v[20:21]
  v_pk_add_f32 v[80:81], v[80:81], v[24:25]
  v_pk_add_f32 v[82:83], v[82:83], v[24:25]
  v_pk_add_f32 v[84:85], v[84:85], v[24:25]
  v_pk_add_f32 v[86:87], v[86:87], v[24:25]
  v_pk_add_f32 v[88:89], v[88:89], v[28:29]
  v_pk_add_f32 v[90:91], v[90:91], v[28:29]
  v_pk_add_f32 v[92:93], v[92:93], v[28:29]
  v_pk_add_f32 v[94:95], v[94:95], v[28:29]
  s_lshl_b32 s88, s25, 1
  s_waitcnt vmcnt(0)
  s_barrier
  s_waitcnt lgkmcnt(4)
  v_mfma_f32_16x16x32_bf16 v[96:99], a[0:3], a[128:131], v[16:19]
  s_mov_b32 m0, s26
  v_exp_f32 v64, v64
  v_mfma_f32_16x16x32_bf16 v[96:99], a[4:7], a[132:135], v[96:99]
  buffer_load_dwordx4 v2, s[20:23], s28 offen offset:0 sc1 lds
  v_exp_f32 v65, v65
  v_mfma_f32_16x16x32_bf16 v[96:99], a[8:11], a[136:139], v[96:99]
  buffer_load_dwordx4 v2, s[20:23], s28 offen offset:1024 sc1 lds
  v_exp_f32 v66, v66
  v_mfma_f32_16x16x32_bf16 v[96:99], a[12:15], a[140:143], v[96:99]
  buffer_load_dwordx4 v2, s[20:23], s28 offen offset:2048 sc1 lds
  v_exp_f32 v67, v67
  v_mfma_f32_16x16x32_bf16 v[104:107], a[0:3], a[144:147], v[20:23]
  v_exp_f32 v68, v68
  v_cvt_pk_bf16_f32 v32, v64, v65
  v_mfma_f32_16x16x32_bf16 v[104:107], a[4:7], a[148:151], v[104:107]
  buffer_load_dwordx4 v2, s[20:23], s28 offen offset:3072 sc1 lds
  v_exp_f32 v69, v69
  v_mfma_f32_16x16x32_bf16 v[104:107], a[8:11], a[152:155], v[104:107]
  s_xor_b32 s26, s26, 0x4000
  v_exp_f32 v70, v70
  v_cvt_pk_bf16_f32 v33, v66, v67
  v_mfma_f32_16x16x32_bf16 v[104:107], a[12:15], a[156:159], v[104:107]
  s_add_u32 s28, s28, 0x8000
  v_exp_f32 v71, v71
  v_cvt_pk_bf16_f32 v34, v68, v69
  v_mfma_f32_16x16x32_bf16 v[112:115], a[0:3], a[160:163], v[24:27]
  s_mov_b32 m0, s27
  v_exp_f32 v72, v72
  v_cvt_pk_bf16_f32 v35, v70, v71
  v_mfma_f32_16x16x32_bf16 v[112:115], a[4:7], a[164:167], v[112:115]
  buffer_load_dwordx4 v2, s[20:23], s29 offen offset:0 sc1 lds
  v_exp_f32 v73, v73
  v_mfma_f32_16x16x32_bf16 v[112:115], a[8:11], a[168:171], v[112:115]
  buffer_load_dwordx4 v2, s[20:23], s29 offen offset:1024 sc1 lds
  v_exp_f32 v74, v74
  v_mfma_f32_16x16x32_bf16 v[112:115], a[12:15], a[172:175], v[112:115]
  buffer_load_dwordx4 v2, s[20:23], s29 offen offset:2048 sc1 lds
  v_exp_f32 v75, v75
  v_mfma_f32_16x16x32_bf16 v[120:123], a[0:3], a[176:179], v[28:31]
  buffer_load_dwordx4 v2, s[20:23], s29 offen offset:3072 sc1 lds
  v_exp_f32 v76, v76
  v_mfma_f32_16x16x32_bf16 v[120:123], a[4:7], a[180:183], v[120:123]
  s_xor_b32 s27, s27, 0x8000
  v_exp_f32 v77, v77
  v_cvt_pk_bf16_f32 v36, v72, v73
  v_mfma_f32_16x16x32_bf16 v[120:123], a[8:11], a[184:187], v[120:123]
  s_add_u32 s29, s29, 0x8000
  v_exp_f32 v78, v78
  v_cvt_pk_bf16_f32 v37, v74, v75
  v_mfma_f32_16x16x32_bf16 v[120:123], a[12:15], a[188:191], v[120:123]
  s_waitcnt lgkmcnt(0)
  v_exp_f32 v79, v79
  v_cvt_pk_bf16_f32 v38, v76, v77
  v_mfma_f32_16x16x32_bf16 v[100:103], a[16:19], a[128:131], v[16:19]
  s_mov_b32 m0, s26
  v_exp_f32 v80, v80
  v_cvt_pk_bf16_f32 v39, v78, v79
  v_mfma_f32_16x16x32_bf16 v[100:103], a[20:23], a[132:135], v[100:103]
  buffer_load_dwordx4 v2, s[20:23], s28 offen offset:0 sc1 lds
  v_exp_f32 v81, v81
  v_mfma_f32_16x16x32_bf16 v[100:103], a[24:27], a[136:139], v[100:103]
  buffer_load_dwordx4 v2, s[20:23], s28 offen offset:1024 sc1 lds
  v_exp_f32 v82, v82
  v_cvt_pk_bf16_f32 v40, v80, v81
  v_mfma_f32_16x16x32_bf16 v[100:103], a[28:31], a[140:143], v[100:103]
  buffer_load_dwordx4 v2, s[20:23], s28 offen offset:2048 sc1 lds
  v_exp_f32 v83, v83
  v_mfma_f32_16x16x32_bf16 v[108:111], a[16:19], a[144:147], v[20:23]
  buffer_load_dwordx4 v2, s[20:23], s28 offen offset:3072 sc1 lds
  v_exp_f32 v84, v84
  v_cvt_pk_bf16_f32 v41, v82, v83
  v_mfma_f32_16x16x32_bf16 v[108:111], a[20:23], a[148:151], v[108:111]
  s_xor_b32 s26, s26, 0x8000
  v_exp_f32 v85, v85
  v_xor_b32 v3, 0x4000, v3
  v_mfma_f32_16x16x32_bf16 v[108:111], a[24:27], a[152:155], v[108:111]
  s_add_u32 s28, s28, 0x8000
  ds_read_b128 a[32:35], v3 offset:0
  v_exp_f32 v86, v86
  v_cvt_pk_bf16_f32 v42, v84, v85
  v_mfma_f32_16x16x32_bf16 v[108:111], a[28:31], a[156:159], v[108:111]
  s_mov_b32 m0, s27
  ds_read_b128 a[36:39], v3 offset:1024
  v_exp_f32 v87, v87
  v_mfma_f32_16x16x32_bf16 v[116:119], a[16:19], a[160:163], v[24:27]
  buffer_load_dwordx4 v2, s[20:23], s29 offen offset:0 sc1 lds
  v_exp_f32 v88, v88
  v_cvt_pk_bf16_f32 v43, v86, v87
  v_mfma_f32_16x16x32_bf16 v[116:119], a[20:23], a[164:167], v[116:119]
  buffer_load_dwordx4 v2, s[20:23], s29 offen offset:1024 sc1 lds
  v_exp_f32 v89, v89
  v_mfma_f32_16x16x32_bf16 v[116:119], a[24:27], a[168:171], v[116:119]
  buffer_load_dwordx4 v2, s[20:23], s29 offen offset:2048 sc1 lds
  v_exp_f32 v90, v90
  v_cvt_pk_bf16_f32 v44, v88, v89
  v_mfma_f32_16x16x32_bf16 v[116:119], a[28:31], a[172:175], v[116:119]
  buffer_load_dwordx4 v2, s[20:23], s29 offen offset:3072 sc1 lds
  v_exp_f32 v91, v91
  v_mfma_f32_16x16x32_bf16 v[124:127], a[16:19], a[176:179], v[28:31]
  s_xor_b32 s27, s27, 0x4000
  ds_read_b128 a[40:43], v3 offset:2048
  v_exp_f32 v92, v92
  v_cvt_pk_bf16_f32 v45, v90, v91
  v_mfma_f32_16x16x32_bf16 v[124:127], a[20:23], a[180:183], v[124:127]
  s_add_u32 s29, s29, 0x8000
  ds_read_b128 a[44:47], v3 offset:3072
  v_exp_f32 v93, v93
  v_mfma_f32_16x16x32_bf16 v[124:127], a[24:27], a[184:187], v[124:127]
  ds_read_b128 a[48:51], v3 offset:4096
  v_exp_f32 v94, v94
  v_cvt_pk_bf16_f32 v46, v92, v93
  v_mfma_f32_16x16x32_bf16 v[124:127], a[28:31], a[188:191], v[124:127]
  ds_read_b128 a[52:55], v3 offset:5120
  ds_read_b128 a[56:59], v3 offset:6144
  ds_read_b128 a[60:63], v3 offset:7168
  ds_read_b128 a[0:3], v4 offset:0
  ds_read_b128 a[4:7], v4 offset:1024
  ds_read_b128 a[8:11], v4 offset:2048
  v_exp_f32 v95, v95
  s_nop 0
  v_cvt_pk_bf16_f32 v47, v94, v95
  s_cmp_eq_u32 s25, 0
  s_cbranch_scc1 La_d1
  .p2align 6
La_lo:
  s_waitcnt lgkmcnt(7)
  v_mfma_f32_16x16x32_bf16 v[64:67], a[32:35], a[128:131], v[16:19]
  v_exp_f32 v96, v96
  v_mfma_f32_16x16x32_bf16 v[64:67], a[36:39], a[132:135], v[64:67]
  ds_read_b128 a[12:15], v4 offset:3072
  v_mfma_f32_16x16x32_bf16 v[64:67], a[40:43], a[136:139], v[64:67]
  v_exp_f32 v97, v97
  v_mfma_f32_16x16x32_bf16 v[64:67], a[44:47], a[140:143], v[64:67]
  v_cvt_pk_bf16_f32 v48, v96, v97
  v_mfma_f32_16x16x32_bf16 v[72:75], a[32:35], a[144:147], v[20:23]
  v_exp_f32 v98, v98
  v_mfma_f32_16x16x32_bf16 v[72:75], a[36:39], a[148:151], v[72:75]
  ds_read_b128 a[16:19], v4 offset:4096
  v_mfma_f32_16x16x32_bf16 v[72:75], a[40:43], a[152:155], v[72:75]
  v_exp_f32 v99, v99
  v_mfma_f32_16x16x32_bf16 v[72:75], a[44:47], a[156:159], v[72:75]
  v_cvt_pk_bf16_f32 v49, v98, v99
  v_mfma_f32_16x16x32_bf16 v[80:83], a[32:35], a[160:163], v[24:27]
  v_exp_f32 v100, v100
  v_mfma_f32_16x16x32_bf16 v[80:83], a[36:39], a[164:167], v[80:83]
  ds_read_b128 a[20:23], v4 offset:5120
  v_mfma_f32_16x16x32_bf16 v[80:83], a[40:43], a[168:171], v[80:83]
  v_exp_f32 v101, v101
  v_mfma_f32_16x16x32_bf16 v[80:83], a[44:47], a[172:175], v[80:83]
  v_cvt_pk_bf16_f32 v50, v100, v101
  v_mfma_f32_16x16x32_bf16 v[88:91], a[32:35], a[176:179], v[28:31]
  v_exp_f32 v102, v102
  v_mfma_f32_16x16x32_bf16 v[88:91], a[36:39], a[180:183], v[88:91]
  ds_read_b128 a[24:27], v4 offset:6144
  v_mfma_f32_16x16x32_bf16 v[88:91], a[40:43], a[184:187], v[88:91]
  v_exp_f32 v103, v103
  v_mfma_f32_16x16x32_bf16 v[88:91], a[44:47], a[188:191], v[88:91]
  s_waitcnt lgkmcnt(7)
  v_cvt_pk_bf16_f32 v51, v102, v103
  v_mfma_f32_16x16x32_bf16 v[68:71], a[48:51], a[128:131], v[16:19]
  v_exp_f32 v104, v104
  v_mfma_f32_16x16x32_bf16 v[68:71], a[52:55], a[132:135], v[68:71]
  ds_read_b128 a[28:31], v4 offset:7168
  v_mfma_f32_16x16x32_bf16 v[68:71], a[56:59], a[136:139], v[68:71]
  v_exp_f32 v105, v105
  v_mfma_f32_16x16x32_bf16 v[68:71], a[60:63], a[140:143], v[68:71]
  v_cvt_pk_bf16_f32 v52, v104, v105
  v_mfma_f32_16x16x32_bf16 v[76:79], a[48:51], a[144:147], v[20:23]
  v_exp_f32 v106, v106
  v_mfma_f32_16x16x32_bf16 v[76:79], a[52:55], a[148:151], v[76:79]
  ds_read_b128 a[32:35], v3 offset:8192
  v_mfma_f32_16x16x32_bf16 v[76:79], a[56:59], a[152:155], v[76:79]
  v_exp_f32 v107, v107
  v_mfma_f32_16x16x32_bf16 v[76:79], a[60:63], a[156:159], v[76:79]
  v_cvt_pk_bf16_f32 v53, v106, v107
  v_mfma_f32_16x16x32_bf16 v[84:87], a[48:51], a[160:163], v[24:27]
  v_exp_f32 v108, v108
  v_mfma_f32_16x16x32_bf16 v[84:87], a[52:55], a[164:167], v[84:87]
  ds_read_b128 a[36:39], v3 offset:9216
  v_mfma_f32_16x16x32_bf16 v[84:87], a[56:59], a[168:171], v[84:87]
  v_exp_f32 v109, v109
  v_mfma_f32_16x16x32_bf16 v[84:87], a[60:63], a[172:175], v[84:87]
  v_cvt_pk_bf16_f32 v54, v108, v109
  v_mfma_f32_16x16x32_bf16 v[92:95], a[48:51], a[176:179], v[28:31]
  v_exp_f32 v110, v110
  v_mfma_f32_16x16x32_bf16 v[92:95], a[52:55], a[180:183], v[92:95]
  ds_read_b128 a[40:43], v3 offset:10240
  v_mfma_f32_16x16x32_bf16 v[92:95], a[56:59], a[184:187], v[92:95]
  v_exp_f32 v111, v111
  v_mfma_f32_16x16x32_bf16 v[92:95], a[60:63], a[188:191], v[92:95]
  s_waitcnt lgkmcnt(7)
  v_cvt_pk_bf16_f32 v55, v110, v111
  v_mfma_f32_16x16x32_bf16 v[128:131], a[0:3], v[32:35], v[128:131]
  ds_read_b128 a[44:47], v3 offset:11264
  v_mfma_f32_16x16x32_bf16 v[160:163], a[0:3], v[36:39], v[160:163]
  v_exp_f32 v112, v112
  v_mfma_f32_16x16x32_bf16 v[192:195], a[0:3], v[40:43], v[192:195]
  s_sub_u32 s88, s88, 1
  v_mfma_f32_16x16x32_bf16 v[224:227], a[0:3], v[44:47], v[224:227]
  v_exp_f32 v113, v113
  v_mfma_f32_16x16x32_bf16 a[192:195], a[208:211], v[32:35], a[192:195]
  v_cvt_pk_bf16_f32 v56, v112, v113
  v_mfma_f32_16x16x32_bf16 v[132:135], a[4:7], v[32:35], v[132:135]
  v_exp_f32 v114, v114
  v_mfma_f32_16x16x32_bf16 v[164:167], a[4:7], v[36:39], v[164:167]
  ds_read_b128 a[48:51], v3 offset:12288
  v_mfma_f32_16x16x32_bf16 v[196:199], a[4:7], v[40:43], v[196:199]
  v_exp_f32 v115, v115
  v_mfma_f32_16x16x32_bf16 v[228:231], a[4:7], v[44:47], v[228:231]
  v_cvt_pk_bf16_f32 v57, v114, v115
  v_mfma_f32_16x16x32_bf16 a[196:199], a[208:211], v[36:39], a[196:199]
  v_exp_f32 v116, v116
  v_mfma_f32_16x16x32_bf16 v[136:139], a[8:11], v[32:35], v[136:139]
  ds_read_b128 a[52:55], v3 offset:13312
  v_mfma_f32_16x16x32_bf16 v[168:171], a[8:11], v[36:39], v[168:171]
  v_exp_f32 v117, v117
  v_mfma_f32_16x16x32_bf16 v[200:203], a[8:11], v[40:43], v[200:203]
  v_cvt_pk_bf16_f32 v58, v116, v117
  v_mfma_f32_16x16x32_bf16 v[232:235], a[8:11], v[44:47], v[232:235]
  v_exp_f32 v118, v118
  v_mfma_f32_16x16x32_bf16 a[200:203], a[208:211], v[40:43], a[200:203]
  v_mfma_f32_16x16x32_bf16 v[140:143], a[12:15], v[32:35], v[140:143]
  v_exp_f32 v119, v119
  v_mfma_f32_16x16x32_bf16 v[172:175], a[12:15], v[36:39], v[172:175]
  ds_read_b128 a[56:59], v3 offset:14336
  v_cvt_pk_bf16_f32 v59, v118, v119
  v_mfma_f32_16x16x32_bf16 v[204:207], a[12:15], v[40:43], v[204:207]
  v_exp_f32 v120, v120
  v_mfma_f32_16x16x32_bf16 v[236:239], a[12:15], v[44:47], v[236:239]
  v_mfma_f32_16x16x32_bf16 a[204:207], a[208:211], v[44:47], a[204:207]
  s_waitcnt lgkmcnt(7)
  v_exp_f32 v121, v121
  v_mfma_f32_16x16x32_bf16 v[144:147], a[16:19], v[32:35], v[144:147]
  ds_read_b128 a[60:63], v3 offset:15360
  v_cvt_pk_bf16_f32 v60, v120, v121
  v_mfma_f32_16x16x32_bf16 v[176:179], a[16:19], v[36:39], v[176:179]
  v_exp_f32 v122, v122
  v_mfma_f32_16x16x32_bf16 v[208:211], a[16:19], v[40:43], v[208:211]
  v_mfma_f32_16x16x32_bf16 v[240:243], a[16:19], v[44:47], v[240:243]
  v_exp_f32 v123, v123
  v_mfma_f32_16x16x32_bf16 v[148:151], a[20:23], v[32:35], v[148:151]
  ds_read_b128 a[0:3], v4 offset:8192
  v_cvt_pk_bf16_f32 v61, v122, v123
  v_mfma_f32_16x16x32_bf16 v[180:183], a[20:23], v[36:39], v[180:183]
  v_exp_f32 v124, v124
  v_mfma_f32_16x16x32_bf16 v[212:215], a[20:23], v[40:43], v[212:215]
  v_mfma_f32_16x16x32_bf16 v[244:247], a[20:23], v[44:47], v[244:247]
  v_exp_f32 v125, v125
  v_mfma_f32_16x16x32_bf16 v[152:155], a[24:27], v[32:35], v[152:155]
  ds_read_b128 a[4:7], v4 offset:9216
  v_cvt_pk_bf16_f32 v62, v124, v125
  v_mfma_f32_16x16x32_bf16 v[184:187], a[24:27], v[36:39], v[184:187]
  v_exp_f32 v126, v126
  v_mfma_f32_16x16x32_bf16 v[216:219], a[24:27], v[40:43], v[216:219]
  v_mfma_f32_16x16x32_bf16 v[248:251], a[24:27], v[44:47], v[248:251]
  v_exp_f32 v127, v127
  v_mfma_f32_16x16x32_bf16 v[156:159], a[28:31], v[32:35], v[156:159]
  ds_read_b128 a[8:11], v4 offset:10240
  v_cvt_pk_bf16_f32 v63, v126, v127
  v_mfma_f32_16x16x32_bf16 v[188:191], a[28:31], v[36:39], v[188:191]
  v_mfma_f32_16x16x32_bf16 v[220:223], a[28:31], v[40:43], v[220:223]
  s_waitcnt vmcnt(8)
  s_barrier
  v_mfma_f32_16x16x32_bf16 v[252:255], a[28:31], v[44:47], v[252:255]
  s_cmp_eq_u32 s88, 0
  s_cbranch_scc1 La_d0
  s_waitcnt lgkmcnt(7)
  v_mfma_f32_16x16x32_bf16 v[96:99], a[32:35], a[128:131], v[16:19]
  s_mov_b32 m0, s26
  v_exp_f32 v64, v64
  v_mfma_f32_16x16x32_bf16 v[96:99], a[36:39], a[132:135], v[96:99]
  buffer_load_dwordx4 v2, s[20:23], s28 offen offset:0 sc1 lds
  ds_read_b128 a[12:15], v4 offset:11264
  v_mfma_f32_16x16x32_bf16 v[96:99], a[40:43], a[136:139], v[96:99]
  v_exp_f32 v65, v65
  v_mfma_f32_16x16x32_bf16 v[96:99], a[44:47], a[140:143], v[96:99]
  v_cvt_pk_bf16_f32 v32, v64, v65
  v_mfma_f32_16x16x32_bf16 v[104:107], a[32:35], a[144:147], v[20:23]
  v_exp_f32 v66, v66
  v_mfma_f32_16x16x32_bf16 v[104:107], a[36:39], a[148:151], v[104:107]
  ds_read_b128 a[16:19], v4 offset:12288
  v_mfma_f32_16x16x32_bf16 v[104:107], a[40:43], a[152:155], v[104:107]
  v_exp_f32 v67, v67
  v_mfma_f32_16x16x32_bf16 v[104:107], a[44:47], a[156:159], v[104:107]
  v_cvt_pk_bf16_f32 v33, v66, v67
  v_mfma_f32_16x16x32_bf16 v[112:115], a[32:35], a[160:163], v[24:27]
  v_exp_f32 v68, v68
  v_mfma_f32_16x16x32_bf16 v[112:115], a[36:39], a[164:167], v[112:115]
  buffer_load_dwordx4 v2, s[20:23], s28 offen offset:1024 sc1 lds
  ds_read_b128 a[20:23], v4 offset:13312
  v_mfma_f32_16x16x32_bf16 v[112:115], a[40:43], a[168:171], v[112:115]
  v_exp_f32 v69, v69
  v_mfma_f32_16x16x32_bf16 v[112:115], a[44:47], a[172:175], v[112:115]
  v_cvt_pk_bf16_f32 v34, v68, v69
  v_mfma_f32_16x16x32_bf16 v[120:123], a[32:35], a[176:179], v[28:31]
  v_exp_f32 v70, v70
  v_mfma_f32_16x16x32_bf16 v[120:123], a[36:39], a[180:183], v[120:123]
  ds_read_b128 a[24:27], v4 offset:14336
  v_mfma_f32_16x16x32_bf16 v[120:123], a[40:43], a[184:187], v[120:123]
  v_exp_f32 v71, v71
  v_mfma_f32_16x16x32_bf16 v[120:123], a[44:47], a[188:191], v[120:123]
  s_waitcnt lgkmcnt(7)
  v_cvt_pk_bf16_f32 v35, v70, v71
  v_mfma_f32_16x16x32_bf16 v[100:103], a[48:51], a[128:131], v[16:19]
  v_exp_f32 v72, v72
  v_mfma_f32_16x16x32_bf16 v[100:103], a[52:55], a[132:135], v[100:103]
  buffer_load_dwordx4 v2, s[20:23], s28 offen offset:2048 sc1 lds
  ds_read_b128 a[28:31], v4 offset:15360
  v_mfma_f32_16x16x32_bf16 v[100:103], a[56:59], a[136:139], v[100:103]
  v_exp_f32 v73, v73
  v_mfma_f32_16x16x32_bf16 v[100:103], a[60:63], a[140:143], v[100:103]
  v_xor_b32 v3, s30, v3
  v_cvt_pk_bf16_f32 v36, v72, v73
  v_mfma_f32_16x16x32_bf16 v[108:111], a[48:51], a[144:147], v[20:23]
  v_exp_f32 v74, v74
  v_mfma_f32_16x16x32_bf16 v[108:111], a[52:55], a[148:151], v[108:111]
  ds_read_b128 a[32:35], v3 offset:0
  v_mfma_f32_16x16x32_bf16 v[108:111], a[56:59], a[152:155], v[108:111]
  v_exp_f32 v75, v75
  v_mfma_f32_16x16x32_bf16 v[108:111], a[60:63], a[156:159], v[108:111]
  v_cvt_pk_bf16_f32 v37, v74, v75
  v_mfma_f32_16x16x32_bf16 v[116:119], a[48:51], a[160:163], v[24:27]
  v_exp_f32 v76, v76
  v_mfma_f32_16x16x32_bf16 v[116:119], a[52:55], a[164:167], v[116:119]
  buffer_load_dwordx4 v2, s[20:23], s28 offen offset:3072 sc1 lds
  ds_read_b128 a[36:39], v3 offset:1024
  v_mfma_f32_16x16x32_bf16 v[116:119], a[56:59], a[168:171], v[116:119]
  s_xor_b32 s26, s26, s31
  v_exp_f32 v77, v77
  v_mfma_f32_16x16x32_bf16 v[116:119], a[60:63], a[172:175], v[116:119]
  s_add_u32 s28, s28, 0x8000
  s_mov_b32 m0, s27
  v_cvt_pk_bf16_f32 v38, v76, v77
  v_mfma_f32_16x16x32_bf16 v[124:127], a[48:51], a[176:179], v[28:31]
  v_exp_f32 v78, v78
  v_mfma_f32_16x16x32_bf16 v[124:127], a[52:55], a[180:183], v[124:127]
  ds_read_b128 a[40:43], v3 offset:2048
  v_mfma_f32_16x16x32_bf16 v[124:127], a[56:59], a[184:187], v[124:127]
  v_exp_f32 v79, v79
  v_mfma_f32_16x16x32_bf16 v[124:127], a[60:63], a[188:191], v[124:127]
  s_waitcnt lgkmcnt(7)
  v_cvt_pk_bf16_f32 v39, v78, v79
  v_mfma_f32_16x16x32_bf16 v[128:131], a[0:3], v[48:51], v[128:131]
  buffer_load_dwordx4 v2, s[20:23], s29 offen offset:0 sc1 lds
  ds_read_b128 a[44:47], v3 offset:3072
  v_mfma_f32_16x16x32_bf16 v[160:163], a[0:3], v[52:55], v[160:163]
  v_exp_f32 v80, v80
  v_mfma_f32_16x16x32_bf16 v[192:195], a[0:3], v[56:59], v[192:195]
  v_mfma_f32_16x16x32_bf16 v[224:227], a[0:3], v[60:63], v[224:227]
  v_exp_f32 v81, v81
  v_mfma_f32_16x16x32_bf16 a[192:195], a[208:211], v[48:51], a[192:195]
  v_cvt_pk_bf16_f32 v40, v80, v81
  v_mfma_f32_16x16x32_bf16 v[132:135], a[4:7], v[48:51], v[132:135]
  v_exp_f32 v82, v82
  v_mfma_f32_16x16x32_bf16 v[164:167], a[4:7], v[52:55], v[164:167]
  ds_read_b128 a[48:51], v3 offset:4096
  v_mfma_f32_16x16x32_bf16 v[196:199], a[4:7], v[56:59], v[196:199]
  v_exp_f32 v83, v83
  v_mfma_f32_16x16x32_bf16 v[228:231], a[4:7], v[60:63], v[228:231]
  buffer_load_dwordx4 v2, s[20:23], s29 offen offset:1024 sc1 lds
  v_cvt_pk_bf16_f32 v41, v82, v83
  v_mfma_f32_16x16x32_bf16 a[196:199], a[208:211], v[52:55], a[196:199]
  v_exp_f32 v84, v84
  v_mfma_f32_16x16x32_bf16 v[136:139], a[8:11], v[48:51], v[136:139]
  ds_read_b128 a[52:55], v3 offset:5120
  v_mfma_f32_16x16x32_bf16 v[168:171], a[8:11], v[52:55], v[168:171]
  v_exp_f32 v85, v85
  v_mfma_f32_16x16x32_bf16 v[200:203], a[8:11], v[56:59], v[200:203]
  v_cvt_pk_bf16_f32 v42, v84, v85
  v_mfma_f32_16x16x32_bf16 v[232:235], a[8:11], v[60:63], v[232:235]
  v_exp_f32 v86, v86
  v_mfma_f32_16x16x32_bf16 a[200:203], a[208:211], v[56:59], a[200:203]
  v_mfma_f32_16x16x32_bf16 v[140:143], a[12:15], v[48:51], v[140:143]
  v_exp_f32 v87, v87
  v_mfma_f32_16x16x32_bf16 v[172:175], a[12:15], v[52:55], v[172:175]
  buffer_load_dwordx4 v2, s[20:23], s29 offen offset:2048 sc1 lds
  ds_read_b128 a[56:59], v3 offset:6144
  v_mfma_f32_16x16x32_bf16 v[204:207], a[12:15], v[56:59], v[204:207]
  v_exp_f32 v88, v88
  v_mfma_f32_16x16x32_bf16 v[236:239], a[12:15], v[60:63], v[236:239]
  v_cvt_pk_bf16_f32 v43, v86, v87
  v_mfma_f32_16x16x32_bf16 a[204:207], a[208:211], v[60:63], a[204:207]
  s_waitcnt lgkmcnt(7)
  v_exp_f32 v89, v89
  v_mfma_f32_16x16x32_bf16 v[144:147], a[16:19], v[48:51], v[144:147]
  ds_read_b128 a[60:63], v3 offset:7168
  v_cvt_pk_bf16_f32 v44, v88, v89
  v_mfma_f32_16x16x32_bf16 v[176:179], a[16:19], v[52:55], v[176:179]
  v_exp_f32 v90, v90
  v_mfma_f32_16x16x32_bf16 v[208:211], a[16:19], v[56:59], v[208:211]
  v_mfma_f32_16x16x32_bf16 v[240:243], a[16:19], v[60:63], v[240:243]
  v_exp_f32 v91, v91
  v_mfma_f32_16x16x32_bf16 v[148:151], a[20:23], v[48:51], v[148:151]
  buffer_load_dwordx4 v2, s[20:23], s29 offen offset:3072 sc1 lds
  v_xor_b32 v4, s31, v4
  v_mfma_f32_16x16x32_bf16 v[180:183], a[20:23], v[52:55], v[180:183]
  s_xor_b32 s27, s27, s30
  v_exp_f32 v92, v92
  v_mfma_f32_16x16x32_bf16 v[212:215], a[20:23], v[56:59], v[212:215]
  s_add_u32 s29, s29, 0x8000
  ds_read_b128 a[0:3], v4 offset:0
  v_cvt_pk_bf16_f32 v45, v90, v91
  v_mfma_f32_16x16x32_bf16 v[244:247], a[20:23], v[60:63], v[244:247]
  v_exp_f32 v93, v93
  v_mfma_f32_16x16x32_bf16 v[152:155], a[24:27], v[48:51], v[152:155]
  ds_read_b128 a[4:7], v4 offset:1024
  v_cvt_pk_bf16_f32 v46, v92, v93
  v_mfma_f32_16x16x32_bf16 v[184:187], a[24:27], v[52:55], v[184:187]
  v_exp_f32 v94, v94
  v_mfma_f32_16x16x32_bf16 v[216:219], a[24:27], v[56:59], v[216:219]
  v_mfma_f32_16x16x32_bf16 v[248:251], a[24:27], v[60:63], v[248:251]
  v_exp_f32 v95, v95
  v_mfma_f32_16x16x32_bf16 v[156:159], a[28:31], v[48:51], v[156:159]
  ds_read_b128 a[8:11], v4 offset:2048
  v_cvt_pk_bf16_f32 v47, v94, v95
  v_mfma_f32_16x16x32_bf16 v[188:191], a[28:31], v[52:55], v[188:191]
  v_mfma_f32_16x16x32_bf16 v[220:223], a[28:31], v[56:59], v[220:223]
  v_mfma_f32_16x16x32_bf16 v[252:255], a[28:31], v[60:63], v[252:255]
  s_xor_b32 s30, s30, 0xc000
  s_xor_b32 s31, s31, 0xc000
  s_branch La_lo
La_d0:
  s_waitcnt lgkmcnt(7)
  v_mfma_f32_16x16x32_bf16 v[96:99], a[32:35], a[128:131], v[16:19]
  s_mov_b32 m0, s26
  ds_read_b128 a[12:15], v4 offset:11264
  v_cndmask_b32 v64, v64, v5, s[32:33]
  v_mfma_f32_16x16x32_bf16 v[96:99], a[36:39], a[132:135], v[96:99]
  v_exp_f32 v64, v64
  v_mfma_f32_16x16x32_bf16 v[96:99], a[40:43], a[136:139], v[96:99]
  v_cndmask_b32 v65, v65, v5, s[34:35]
  v_exp_f32 v65, v65
  v_mfma_f32_16x16x32_bf16 v[96:99], a[44:47], a[140:143], v[96:99]
  buffer_load_dwordx4 v2, s[20:23], s28 offen offset:0 sc1 lds
  v_cndmask_b32 v66, v66, v5, s[36:37]
  v_mfma_f32_16x16x32_bf16 v[104:107], a[32:35], a[144:147], v[20:23]
  v_exp_f32 v66, v66
  v_mfma_f32_16x16x32_bf16 v[104:107], a[36:39], a[148:151], v[104:107]
  ds_read_b128 a[16:19], v4 offset:12288
  v_cndmask_b32 v67, v67, v5, s[38:39]
  v_mfma_f32_16x16x32_bf16 v[104:107], a[40:43], a[152:155], v[104:107]
  v_exp_f32 v67, v67
  v_mfma_f32_16x16x32_bf16 v[104:107], a[44:47], a[156:159], v[104:107]
  v_cndmask_b32 v68, v68, v5, s[40:41]
  v_cndmask_b32 v69, v69, v5, s[42:43]
  v_mfma_f32_16x16x32_bf16 v[112:115], a[32:35], a[160:163], v[24:27]
  v_exp_f32 v68, v68
  v_mfma_f32_16x16x32_bf16 v[112:115], a[36:39], a[164:167], v[112:115]
  buffer_load_dwordx4 v2, s[20:23], s28 offen offset:1024 sc1 lds
  ds_read_b128 a[20:23], v4 offset:13312
  v_mfma_f32_16x16x32_bf16 v[112:115], a[40:43], a[168:171], v[112:115]
  v_exp_f32 v69, v69
  v_mfma_f32_16x16x32_bf16 v[112:115], a[44:47], a[172:175], v[112:115]
  v_cndmask_b32 v70, v70, v5, s[44:45]
  v_cvt_pk_bf16_f32 v32, v64, v65
  v_mfma_f32_16x16x32_bf16 v[120:123], a[32:35], a[176:179], v[28:31]
  v_exp_f32 v70, v70
  v_mfma_f32_16x16x32_bf16 v[120:123], a[36:39], a[180:183], v[120:123]
  ds_read_b128 a[24:27], v4 offset:14336
  v_cndmask_b32 v71, v71, v5, s[46:47]
  v_mfma_f32_16x16x32_bf16 v[120:123], a[40:43], a[184:187], v[120:123]
  v_exp_f32 v71, v71
  v_mfma_f32_16x16x32_bf16 v[120:123], a[44:47], a[188:191], v[120:123]
  s_waitcnt lgkmcnt(7)
  v_cvt_pk_bf16_f32 v33, v66, v67
  v_cvt_pk_bf16_f32 v34, v68, v69
  v_mfma_f32_16x16x32_bf16 v[100:103], a[48:51], a[128:131], v[16:19]
  v_exp_f32 v72, v72
  v_mfma_f32_16x16x32_bf16 v[100:103], a[52:55], a[132:135], v[100:103]
  buffer_load_dwordx4 v2, s[20:23], s28 offen offset:2048 sc1 lds
  ds_read_b128 a[28:31], v4 offset:15360
  v_mfma_f32_16x16x32_bf16 v[100:103], a[56:59], a[136:139], v[100:103]
  v_exp_f32 v73, v73
  v_mfma_f32_16x16x32_bf16 v[100:103], a[60:63], a[140:143], v[100:103]
  v_xor_b32 v3, 0x4000, v3
  v_cvt_pk_bf16_f32 v35, v70, v71
  v_mfma_f32_16x16x32_bf16 v[108:111], a[48:51], a[144:147], v[20:23]
  v_exp_f32 v74, v74
  v_mfma_f32_16x16x32_bf16 v[108:111], a[52:55], a[148:151], v[108:111]
  ds_read_b128 a[32:35], v3 offset:0
  v_cvt_pk_bf16_f32 v36, v72, v73
  v_mfma_f32_16x16x32_bf16 v[108:111], a[56:59], a[152:155], v[108:111]
  v_exp_f32 v75, v75
  v_mfma_f32_16x16x32_bf16 v[108:111], a[60:63], a[156:159], v[108:111]
  v_cvt_pk_bf16_f32 v37, v74, v75
  v_mfma_f32_16x16x32_bf16 v[116:119], a[48:51], a[160:163], v[24:27]
  v_exp_f32 v76, v76
  v_mfma_f32_16x16x32_bf16 v[116:119], a[52:55], a[164:167], v[116:119]
  buffer_load_dwordx4 v2, s[20:23], s28 offen offset:3072 sc1 lds
  ds_read_b128 a[36:39], v3 offset:1024
  v_mfma_f32_16x16x32_bf16 v[116:119], a[56:59], a[168:171], v[116:119]
  s_xor_b32 s26, s26, 0x8000
  v_exp_f32 v77, v77
  v_mfma_f32_16x16x32_bf16 v[116:119], a[60:63], a[172:175], v[116:119]
  s_add_u32 s28, s28, 0x8000
  s_mov_b32 m0, s27
  v_cvt_pk_bf16_f32 v38, v76, v77
  v_mfma_f32_16x16x32_bf16 v[124:127], a[48:51], a[176:179], v[28:31]
  v_exp_f32 v78, v78
  v_mfma_f32_16x16x32_bf16 v[124:127], a[52:55], a[180:183], v[124:127]
  ds_read_b128 a[40:43], v3 offset:2048
  v_mfma_f32_16x16x32_bf16 v[124:127], a[56:59], a[184:187], v[124:127]
  v_exp_f32 v79, v79
  v_mfma_f32_16x16x32_bf16 v[124:127], a[60:63], a[188:191], v[124:127]
  s_waitcnt lgkmcnt(7)
  v_cvt_pk_bf16_f32 v39, v78, v79
  v_mfma_f32_16x16x32_bf16 v[128:131], a[0:3], v[48:51], v[128:131]
  buffer_load_dwordx4 v2, s[20:23], s29 offen offset:0 sc1 lds
  ds_read_b128 a[44:47], v3 offset:3072
  v_mfma_f32_16x16x32_bf16 v[160:163], a[0:3], v[52:55], v[160:163]
  v_exp_f32 v80, v80
  v_mfma_f32_16x16x32_bf16 v[192:195], a[0:3], v[56:59], v[192:195]
  v_mfma_f32_16x16x32_bf16 v[224:227], a[0:3], v[60:63], v[224:227]
  v_exp_f32 v81, v81
  v_mfma_f32_16x16x32_bf16 a[192:195], a[208:211], v[48:51], a[192:195]
  v_cvt_pk_bf16_f32 v40, v80, v81
  v_mfma_f32_16x16x32_bf16 v[132:135], a[4:7], v[48:51], v[132:135]
  v_exp_f32 v82, v82
  v_mfma_f32_16x16x32_bf16 v[164:167], a[4:7], v[52:55], v[164:167]
  ds_read_b128 a[48:51], v3 offset:4096
  v_mfma_f32_16x16x32_bf16 v[196:199], a[4:7], v[56:59], v[196:199]
  v_exp_f32 v83, v83
  v_mfma_f32_16x16x32_bf16 v[228:231], a[4:7], v[60:63], v[228:231]
  buffer_load_dwordx4 v2, s[20:23], s29 offen offset:1024 sc1 lds
  v_cvt_pk_bf16_f32 v41, v82, v83
  v_mfma_f32_16x16x32_bf16 a[196:199], a[208:211], v[52:55], a[196:199]
  v_exp_f32 v84, v84
  v_mfma_f32_16x16x32_bf16 v[136:139], a[8:11], v[48:51], v[136:139]
  ds_read_b128 a[52:55], v3 offset:5120
  v_mfma_f32_16x16x32_bf16 v[168:171], a[8:11], v[52:55], v[168:171]
  v_exp_f32 v85, v85
  v_mfma_f32_16x16x32_bf16 v[200:203], a[8:11], v[56:59], v[200:203]
  v_cvt_pk_bf16_f32 v42, v84, v85
  v_mfma_f32_16x16x32_bf16 v[232:235], a[8:11], v[60:63], v[232:235]
  v_exp_f32 v86, v86
  v_mfma_f32_16x16x32_bf16 a[200:203], a[208:211], v[56:59], a[200:203]
  v_mfma_f32_16x16x32_bf16 v[140:143], a[12:15], v[48:51], v[140:143]
  v_exp_f32 v87, v87
  v_mfma_f32_16x16x32_bf16 v[172:175], a[12:15], v[52:55], v[172:175]
  buffer_load_dwordx4 v2, s[20:23], s29 offen offset:2048 sc1 lds
  ds_read_b128 a[56:59], v3 offset:6144
  v_mfma_f32_16x16x32_bf16 v[204:207], a[12:15], v[56:59], v[204:207]
  v_exp_f32 v88, v88
  v_mfma_f32_16x16x32_bf16 v[236:239], a[12:15], v[60:63], v[236:239]
  v_cvt_pk_bf16_f32 v43, v86, v87
  v_mfma_f32_16x16x32_bf16 a[204:207], a[208:211], v[60:63], a[204:207]
  s_waitcnt lgkmcnt(7)
  v_exp_f32 v89, v89
  v_mfma_f32_16x16x32_bf16 v[144:147], a[16:19], v[48:51], v[144:147]
  ds_read_b128 a[60:63], v3 offset:7168
  v_cvt_pk_bf16_f32 v44, v88, v89
  v_mfma_f32_16x16x32_bf16 v[176:179], a[16:19], v[52:55], v[176:179]
  v_exp_f32 v90, v90
  v_mfma_f32_16x16x32_bf16 v[208:211], a[16:19], v[56:59], v[208:211]
  v_mfma_f32_16x16x32_bf16 v[240:243], a[16:19], v[60:63], v[240:243]
  v_exp_f32 v91, v91
  v_mfma_f32_16x16x32_bf16 v[148:151], a[20:23], v[48:51], v[148:151]
  buffer_load_dwordx4 v2, s[20:23], s29 offen offset:3072 sc1 lds
  v_xor_b32 v4, 0x8000, v4
  v_mfma_f32_16x16x32_bf16 v[180:183], a[20:23], v[52:55], v[180:183]
  s_xor_b32 s27, s27, 0x4000
  v_exp_f32 v92, v92
  v_mfma_f32_16x16x32_bf16 v[212:215], a[20:23], v[56:59], v[212:215]
  s_add_u32 s29, s29, 0x8000
  ds_read_b128 a[0:3], v4 offset:0
  v_cvt_pk_bf16_f32 v45, v90, v91
  v_mfma_f32_16x16x32_bf16 v[244:247], a[20:23], v[60:63], v[244:247]
  v_exp_f32 v93, v93
  v_mfma_f32_16x16x32_bf16 v[152:155], a[24:27], v[48:51], v[152:155]
  ds_read_b128 a[4:7], v4 offset:1024
  v_cvt_pk_bf16_f32 v46, v92, v93
  v_mfma_f32_16x16x32_bf16 v[184:187], a[24:27], v[52:55], v[184:187]
  v_exp_f32 v94, v94
  v_mfma_f32_16x16x32_bf16 v[216:219], a[24:27], v[56:59], v[216:219]
  v_mfma_f32_16x16x32_bf16 v[248:251], a[24:27], v[60:63], v[248:251]
  v_exp_f32 v95, v95
  v_mfma_f32_16x16x32_bf16 v[156:159], a[28:31], v[48:51], v[156:159]
  ds_read_b128 a[8:11], v4 offset:2048
  v_cvt_pk_bf16_f32 v47, v94, v95
  v_mfma_f32_16x16x32_bf16 v[188:191], a[28:31], v[52:55], v[188:191]
  v_mfma_f32_16x16x32_bf16 v[220:223], a[28:31], v[56:59], v[220:223]
  v_mfma_f32_16x16x32_bf16 v[252:255], a[28:31], v[60:63], v[252:255]
La_d1:
  s_waitcnt lgkmcnt(7)
  v_mfma_f32_16x16x32_bf16 v[72:75], a[32:35], a[144:147], v[20:23]
  buffer_load_dwordx4 a[64:67], v2, s[8:11], s6 offen offset:0
  ds_read_b128 a[12:15], v4 offset:3072
  v_mfma_f32_16x16x32_bf16 v[72:75], a[36:39], a[148:151], v[72:75]
  v_cndmask_b32 v96, v96, v5, s[48:49]
  v_exp_f32 v96, v96
  v_mfma_f32_16x16x32_bf16 v[72:75], a[40:43], a[152:155], v[72:75]
  v_cndmask_b32 v97, v97, v5, s[50:51]
  v_exp_f32 v97, v97
  v_mfma_f32_16x16x32_bf16 v[72:75], a[44:47], a[156:159], v[72:75]
  v_cndmask_b32 v98, v98, v5, s[52:53]
  v_exp_f32 v98, v98
  v_mfma_f32_16x16x32_bf16 v[80:83], a[32:35], a[160:163], v[24:27]
  ds_read_b128 a[16:19], v4 offset:4096
  v_cndmask_b32 v99, v99, v5, s[54:55]
  v_mfma_f32_16x16x32_bf16 v[80:83], a[36:39], a[164:167], v[80:83]
  v_exp_f32 v99, v99
  v_mfma_f32_16x16x32_bf16 v[80:83], a[40:43], a[168:171], v[80:83]
  buffer_load_dwordx4 a[64:67], v2, s[8:11], s6 offen offset:1024
  ds_read_b128 a[20:23], v4 offset:5120
  v_mfma_f32_16x16x32_bf16 v[80:83], a[44:47], a[172:175], v[80:83]
  v_cndmask_b32 v100, v100, v5, s[56:57]
  v_exp_f32 v100, v100
  v_mfma_f32_16x16x32_bf16 v[88:91], a[32:35], a[176:179], v[28:31]
  v_cndmask_b32 v101, v101, v5, s[58:59]
  v_cndmask_b32 v102, v102, v5, s[60:61]
  v_mfma_f32_16x16x32_bf16 v[88:91], a[36:39], a[180:183], v[88:91]
  v_exp_f32 v101, v101
  v_mfma_f32_16x16x32_bf16 v[88:91], a[40:43], a[184:187], v[88:91]
  v_exp_f32 v102, v102
  v_mfma_f32_16x16x32_bf16 v[88:91], a[44:47], a[188:191], v[88:91]
  s_waitcnt lgkmcnt(6)
  buffer_load_dwordx4 a[64:67], v2, s[8:11], s6 offen offset:2048
  ds_read_b128 a[24:27], v4 offset:6144
  v_mfma_f32_16x16x32_bf16 v[76:79], a[48:51], a[144:147], v[20:23]
  v_cndmask_b32 v103, v103, v5, s[62:63]
  v_exp_f32 v103, v103
  v_mfma_f32_16x16x32_bf16 v[76:79], a[52:55], a[148:151], v[76:79]
  ds_read_b128 a[28:31], v4 offset:7168
  v_cvt_pk_bf16_f32 v48, v96, v97
  v_mfma_f32_16x16x32_bf16 v[76:79], a[56:59], a[152:155], v[76:79]
  v_exp_f32 v104, v104
  v_mfma_f32_16x16x32_bf16 v[76:79], a[60:63], a[156:159], v[76:79]
  ds_read_b128 a[32:35], v3 offset:8192
  v_cvt_pk_bf16_f32 v49, v98, v99
  v_mfma_f32_16x16x32_bf16 v[84:87], a[48:51], a[160:163], v[24:27]
  v_exp_f32 v105, v105
  v_mfma_f32_16x16x32_bf16 v[84:87], a[52:55], a[164:167], v[84:87]
  buffer_load_dwordx4 a[64:67], v2, s[8:11], s6 offen offset:3072
  v_cvt_pk_bf16_f32 v50, v100, v101
  v_mfma_f32_16x16x32_bf16 v[84:87], a[56:59], a[168:171], v[84:87]
  s_add_u32 s6, s6, 4096
  v_exp_f32 v106, v106
  v_mfma_f32_16x16x32_bf16 v[84:87], a[60:63], a[172:175], v[84:87]
  v_exp_f32 v107, v107
  v_mfma_f32_16x16x32_bf16 v[92:95], a[48:51], a[176:179], v[28:31]
  ds_read_b128 a[36:39], v3 offset:9216
  v_cvt_pk_bf16_f32 v51, v102, v103
  v_mfma_f32_16x16x32_bf16 v[92:95], a[52:55], a[180:183], v[92:95]
  v_exp_f32 v108, v108
  v_mfma_f32_16x16x32_bf16 v[92:95], a[56:59], a[184:187], v[92:95]
  buffer_load_dwordx4 a[64:67], v2, s[8:11], s6 offen offset:0
  ds_read_b128 a[40:43], v3 offset:10240
  v_mfma_f32_16x16x32_bf16 v[92:95], a[60:63], a[188:191], v[92:95]
  s_waitcnt lgkmcnt(7)
  v_exp_f32 v109, v109
  v_mfma_f32_16x16x32_bf16 v[128:131], a[0:3], v[32:35], v[128:131]
  ds_read_b128 a[44:47], v3 offset:11264
  v_cvt_pk_bf16_f32 v52, v104, v105
  v_mfma_f32_16x16x32_bf16 v[160:163], a[0:3], v[36:39], v[160:163]
  v_exp_f32 v110, v110
  v_mfma_f32_16x16x32_bf16 v[192:195], a[0:3], v[40:43], v[192:195]
  v_cvt_pk_bf16_f32 v53, v106, v107
  v_cvt_pk_bf16_f32 v54, v108, v109
  v_mfma_f32_16x16x32_bf16 v[224:227], a[0:3], v[44:47], v[224:227]
  v_exp_f32 v111, v111
  v_mfma_f32_16x16x32_bf16 a[192:195], a[208:211], v[32:35], a[192:195]
  buffer_load_dwordx4 a[64:67], v2, s[8:11], s6 offen offset:1024
  v_cvt_pk_bf16_f32 v55, v110, v111
  v_mfma_f32_16x16x32_bf16 v[132:135], a[4:7], v[32:35], v[132:135]
  v_exp_f32 v112, v112
  v_mfma_f32_16x16x32_bf16 v[164:167], a[4:7], v[36:39], v[164:167]
  v_exp_f32 v113, v113
  v_mfma_f32_16x16x32_bf16 v[196:199], a[4:7], v[40:43], v[196:199]
  ds_read_b128 a[48:51], v3 offset:12288
  v_cvt_pk_bf16_f32 v56, v112, v113
  v_mfma_f32_16x16x32_bf16 v[228:231], a[4:7], v[44:47], v[228:231]
  v_exp_f32 v114, v114
  v_mfma_f32_16x16x32_bf16 a[196:199], a[208:211], v[36:39], a[196:199]
  buffer_load_dwordx4 a[64:67], v2, s[8:11], s6 offen offset:2048
  v_mfma_f32_16x16x32_bf16 v[136:139], a[8:11], v[32:35], v[136:139]
  v_exp_f32 v115, v115
  v_mfma_f32_16x16x32_bf16 v[168:171], a[8:11], v[36:39], v[168:171]
  ds_read_b128 a[52:55], v3 offset:13312
  v_cvt_pk_bf16_f32 v57, v114, v115
  v_mfma_f32_16x16x32_bf16 v[200:203], a[8:11], v[40:43], v[200:203]
  v_exp_f32 v116, v116
  v_mfma_f32_16x16x32_bf16 v[232:235], a[8:11], v[44:47], v[232:235]
  v_mfma_f32_16x16x32_bf16 a[200:203], a[208:211], v[40:43], a[200:203]
  v_exp_f32 v117, v117
  v_mfma_f32_16x16x32_bf16 v[140:143], a[12:15], v[32:35], v[140:143]
  v_exp_f32 v118, v118
  v_mfma_f32_16x16x32_bf16 v[172:175], a[12:15], v[36:39], v[172:175]
  buffer_load_dwordx4 a[64:67], v2, s[8:11], s6 offen offset:3072
  ds_read_b128 a[56:59], v3 offset:14336
  v_mfma_f32_16x16x32_bf16 v[204:207], a[12:15], v[40:43], v[204:207]
  v_exp_f32 v119, v119
  v_mfma_f32_16x16x32_bf16 v[236:239], a[12:15], v[44:47], v[236:239]
  v_cvt_pk_bf16_f32 v58, v116, v117
  v_cvt_pk_bf16_f32 v59, v118, v119
  v_mfma_f32_16x16x32_bf16 a[204:207], a[208:211], v[44:47], a[204:207]
  s_waitcnt lgkmcnt(7)
  v_exp_f32 v120, v120
  v_mfma_f32_16x16x32_bf16 v[144:147], a[16:19], v[32:35], v[144:147]
  buffer_load_dwordx4 a[64:67], v2, s[12:15], s7 offen offset:0
  ds_read_b128 a[60:63], v3 offset:15360
  v_mfma_f32_16x16x32_bf16 v[176:179], a[16:19], v[36:39], v[176:179]
  v_exp_f32 v121, v121
  v_mfma_f32_16x16x32_bf16 v[208:211], a[16:19], v[40:43], v[208:211]
  v_cvt_pk_bf16_f32 v60, v120, v121
  v_mfma_f32_16x16x32_bf16 v[240:243], a[16:19], v[44:47], v[240:243]
  v_exp_f32 v122, v122
  v_mfma_f32_16x16x32_bf16 v[148:151], a[20:23], v[32:35], v[148:151]
  v_exp_f32 v123, v123
  v_mfma_f32_16x16x32_bf16 v[180:183], a[20:23], v[36:39], v[180:183]
  ds_read_b128 a[0:3], v4 offset:8192
  v_cvt_pk_bf16_f32 v61, v122, v123
  v_mfma_f32_16x16x32_bf16 v[212:215], a[20:23], v[40:43], v[212:215]
  v_exp_f32 v124, v124
  v_mfma_f32_16x16x32_bf16 v[244:247], a[20:23], v[44:47], v[244:247]
  buffer_load_dwordx4 a[64:67], v2, s[12:15], s7 offen offset:1024
  v_mfma_f32_16x16x32_bf16 v[152:155], a[24:27], v[32:35], v[152:155]
  v_exp_f32 v125, v125
  v_mfma_f32_16x16x32_bf16 v[184:187], a[24:27], v[36:39], v[184:187]
  ds_read_b128 a[4:7], v4 offset:9216
  v_cvt_pk_bf16_f32 v62, v124, v125
  v_mfma_f32_16x16x32_bf16 v[216:219], a[24:27], v[40:43], v[216:219]
  v_exp_f32 v126, v126
  v_mfma_f32_16x16x32_bf16 v[248:251], a[24:27], v[44:47], v[248:251]
  v_mfma_f32_16x16x32_bf16 v[156:159], a[28:31], v[32:35], v[156:159]
  v_exp_f32 v127, v127
  v_mfma_f32_16x16x32_bf16 v[188:191], a[28:31], v[36:39], v[188:191]
  ds_read_b128 a[8:11], v4 offset:10240
  v_cvt_pk_bf16_f32 v63, v126, v127
  v_mfma_f32_16x16x32_bf16 v[220:223], a[28:31], v[40:43], v[220:223]
  s_waitcnt vmcnt(22)
  s_barrier
  v_mfma_f32_16x16x32_bf16 v[252:255], a[28:31], v[44:47], v[252:255]
  s_waitcnt lgkmcnt(7)
  v_mfma_f32_16x16x32_bf16 v[104:107], a[32:35], a[144:147], v[20:23]
  s_mov_b32 m0, s26
  ds_read_b128 a[12:15], v4 offset:11264
  v_cndmask_b32 v72, v72, v5, s[32:33]
  v_mfma_f32_16x16x32_bf16 v[104:107], a[36:39], a[148:151], v[104:107]
  v_exp_f32 v72, v72
  v_mfma_f32_16x16x32_bf16 v[104:107], a[40:43], a[152:155], v[104:107]
  v_cndmask_b32 v73, v73, v5, s[34:35]
  v_exp_f32 v73, v73
  v_mfma_f32_16x16x32_bf16 v[104:107], a[44:47], a[156:159], v[104:107]
  buffer_load_dwordx4 v2, s[20:23], s28 offen offset:0 sc1 lds
  ds_read_b128 a[16:19], v4 offset:12288
  v_mfma_f32_16x16x32_bf16 v[112:115], a[32:35], a[160:163], v[24:27]
  v_cndmask_b32 v74, v74, v5, s[36:37]
  v_exp_f32 v74, v74
  v_mfma_f32_16x16x32_bf16 v[112:115], a[36:39], a[164:167], v[112:115]
  v_cvt_pk_bf16_f32 v36, v72, v73
  v_mfma_f32_16x16x32_bf16 v[112:115], a[40:43], a[168:171], v[112:115]
  ds_read_b128 a[20:23], v4 offset:13312
  v_cndmask_b32 v75, v75, v5, s[38:39]
  v_mfma_f32_16x16x32_bf16 v[112:115], a[44:47], a[172:175], v[112:115]
  v_exp_f32 v75, v75
  v_mfma_f32_16x16x32_bf16 v[120:123], a[32:35], a[176:179], v[28:31]
  buffer_load_dwordx4 v2, s[20:23], s28 offen offset:1024 sc1 lds
  v_cndmask_b32 v76, v76, v5, s[40:41]
  v_mfma_f32_16x16x32_bf16 v[120:123], a[36:39], a[180:183], v[120:123]
  v_exp_f32 v76, v76
  v_mfma_f32_16x16x32_bf16 v[120:123], a[40:43], a[184:187], v[120:123]
  ds_read_b128 a[24:27], v4 offset:14336
  v_cndmask_b32 v79, v79, v5, s[46:47]
  v_mfma_f32_16x16x32_bf16 v[120:123], a[44:47], a[188:191], v[120:123]
  s_waitcnt lgkmcnt(7)
  v_cndmask_b32 v77, v77, v5, s[42:43]
  v_cndmask_b32 v78, v78, v5, s[44:45]
  v_mfma_f32_16x16x32_bf16 v[108:111], a[48:51], a[144:147], v[20:23]
  v_exp_f32 v77, v77
  v_mfma_f32_16x16x32_bf16 v[108:111], a[52:55], a[148:151], v[108:111]
  ds_read_b128 a[28:31], v4 offset:15360
  v_xor_b32 v4, 0x4000, v4
  v_mfma_f32_16x16x32_bf16 v[108:111], a[56:59], a[152:155], v[108:111]
  v_exp_f32 v78, v78
  v_mfma_f32_16x16x32_bf16 v[108:111], a[60:63], a[156:159], v[108:111]
  buffer_load_dwordx4 v2, s[20:23], s28 offen offset:2048 sc1 lds
  v_xor_b32 v3, 0x8000, v3
  v_mfma_f32_16x16x32_bf16 v[116:119], a[48:51], a[160:163], v[24:27]
  v_exp_f32 v79, v79
  v_mfma_f32_16x16x32_bf16 v[116:119], a[52:55], a[164:167], v[116:119]
  ds_read_b128 a[32:35], v3 offset:0
  v_cvt_pk_bf16_f32 v37, v74, v75
  v_mfma_f32_16x16x32_bf16 v[116:119], a[56:59], a[168:171], v[116:119]
  ds_read_b128 a[36:39], v3 offset:1024
  v_cvt_pk_bf16_f32 v38, v76, v77
  v_mfma_f32_16x16x32_bf16 v[116:119], a[60:63], a[172:175], v[116:119]
  v_exp_f32 v80, v80
  v_mfma_f32_16x16x32_bf16 v[124:127], a[48:51], a[176:179], v[28:31]
  v_cvt_pk_bf16_f32 v39, v78, v79
  v_mfma_f32_16x16x32_bf16 v[124:127], a[52:55], a[180:183], v[124:127]
  v_exp_f32 v81, v81
  v_mfma_f32_16x16x32_bf16 v[124:127], a[56:59], a[184:187], v[124:127]
  buffer_load_dwordx4 v2, s[20:23], s28 offen offset:3072 sc1 lds
  ds_read_b128 a[40:43], v3 offset:2048
  v_mfma_f32_16x16x32_bf16 v[124:127], a[60:63], a[188:191], v[124:127]
  s_waitcnt lgkmcnt(7)
  s_xor_b32 s26, s26, 0x4000
  s_add_u32 s28, s28, 0x8000
  v_mfma_f32_16x16x32_bf16 v[128:131], a[0:3], v[48:51], v[128:131]
  s_mov_b32 m0, s27
  v_exp_f32 v82, v82
  v_mfma_f32_16x16x32_bf16 v[160:163], a[0:3], v[52:55], v[160:163]
  ds_read_b128 a[44:47], v3 offset:3072
  v_cvt_pk_bf16_f32 v40, v80, v81
  v_mfma_f32_16x16x32_bf16 v[192:195], a[0:3], v[56:59], v[192:195]
  v_exp_f32 v83, v83
  v_mfma_f32_16x16x32_bf16 v[224:227], a[0:3], v[60:63], v[224:227]
  v_cvt_pk_bf16_f32 v41, v82, v83
  v_mfma_f32_16x16x32_bf16 a[192:195], a[208:211], v[48:51], a[192:195]
  buffer_load_dwordx4 v2, s[20:23], s29 offen offset:0 sc1 lds
  v_mfma_f32_16x16x32_bf16 v[132:135], a[4:7], v[48:51], v[132:135]
  v_exp_f32 v84, v84
  v_mfma_f32_16x16x32_bf16 v[164:167], a[4:7], v[52:55], v[164:167]
  ds_read_b128 a[48:51], v3 offset:4096
  v_mfma_f32_16x16x32_bf16 v[196:199], a[4:7], v[56:59], v[196:199]
  v_exp_f32 v85, v85
  v_mfma_f32_16x16x32_bf16 v[228:231], a[4:7], v[60:63], v[228:231]
  v_cvt_pk_bf16_f32 v42, v84, v85
  v_mfma_f32_16x16x32_bf16 a[196:199], a[208:211], v[52:55], a[196:199]
  v_exp_f32 v86, v86
  v_mfma_f32_16x16x32_bf16 v[136:139], a[8:11], v[48:51], v[136:139]
  ds_read_b128 a[52:55], v3 offset:5120
  v_mfma_f32_16x16x32_bf16 v[168:171], a[8:11], v[52:55], v[168:171]
  buffer_load_dwordx4 v2, s[20:23], s29 offen offset:1024 sc1 lds
  v_mfma_f32_16x16x32_bf16 v[200:203], a[8:11], v[56:59], v[200:203]
  v_exp_f32 v87, v87
  v_mfma_f32_16x16x32_bf16 v[232:235], a[8:11], v[60:63], v[232:235]
  v_cvt_pk_bf16_f32 v43, v86, v87
  v_mfma_f32_16x16x32_bf16 a[200:203], a[208:211], v[56:59], a[200:203]
  v_exp_f32 v88, v88
  v_mfma_f32_16x16x32_bf16 v[140:143], a[12:15], v[48:51], v[140:143]
  ds_read_b128 a[56:59], v3 offset:6144
  v_mfma_f32_16x16x32_bf16 v[172:175], a[12:15], v[52:55], v[172:175]
  v_mfma_f32_16x16x32_bf16 v[204:207], a[12:15], v[56:59], v[204:207]
  v_exp_f32 v89, v89
  v_mfma_f32_16x16x32_bf16 v[236:239], a[12:15], v[60:63], v[236:239]
  buffer_load_dwordx4 v2, s[20:23], s29 offen offset:2048 sc1 lds
  v_cvt_pk_bf16_f32 v44, v88, v89
  v_mfma_f32_16x16x32_bf16 a[204:207], a[208:211], v[60:63], a[204:207]
  s_waitcnt lgkmcnt(7)
  v_exp_f32 v90, v90
  v_mfma_f32_16x16x32_bf16 v[144:147], a[16:19], v[48:51], v[144:147]
  ds_read_b128 a[60:63], v3 offset:7168
  v_mfma_f32_16x16x32_bf16 v[176:179], a[16:19], v[52:55], v[176:179]
  v_exp_f32 v91, v91
  v_mfma_f32_16x16x32_bf16 v[208:211], a[16:19], v[56:59], v[208:211]
  v_cvt_pk_bf16_f32 v45, v90, v91
  v_mfma_f32_16x16x32_bf16 v[240:243], a[16:19], v[60:63], v[240:243]
  v_mfma_f32_16x16x32_bf16 v[148:151], a[20:23], v[48:51], v[148:151]
  v_exp_f32 v92, v92
  v_mfma_f32_16x16x32_bf16 v[180:183], a[20:23], v[52:55], v[180:183]
  buffer_load_dwordx4 v2, s[20:23], s29 offen offset:3072 sc1 lds
  ds_read_b128 a[0:3], v3 offset:8192
  v_mfma_f32_16x16x32_bf16 v[212:215], a[20:23], v[56:59], v[212:215]
  s_xor_b32 s27, s27, 0x8000
  v_exp_f32 v93, v93
  v_mfma_f32_16x16x32_bf16 v[244:247], a[20:23], v[60:63], v[244:247]
  s_add_u32 s29, s29, 0x8000
  v_cvt_pk_bf16_f32 v46, v92, v93
  v_mfma_f32_16x16x32_bf16 v[152:155], a[24:27], v[48:51], v[152:155]
  ds_read_b128 a[4:7], v3 offset:9216
  v_mfma_f32_16x16x32_bf16 v[184:187], a[24:27], v[52:55], v[184:187]
  v_exp_f32 v94, v94
  v_mfma_f32_16x16x32_bf16 v[216:219], a[24:27], v[56:59], v[216:219]
  v_mfma_f32_16x16x32_bf16 v[248:251], a[24:27], v[60:63], v[248:251]
  v_exp_f32 v95, v95
  v_mfma_f32_16x16x32_bf16 v[156:159], a[28:31], v[48:51], v[156:159]
  ds_read_b128 a[8:11], v3 offset:10240
  v_cvt_pk_bf16_f32 v47, v94, v95
  v_mfma_f32_16x16x32_bf16 v[188:191], a[28:31], v[52:55], v[188:191]
  v_mfma_f32_16x16x32_bf16 v[220:223], a[28:31], v[56:59], v[220:223]
  s_waitcnt vmcnt(22)
  s_barrier
  v_mfma_f32_16x16x32_bf16 v[252:255], a[28:31], v[60:63], v[252:255]
  s_lshr_b32 s91, s73, 1
  s_lshl_b32 s91, s91, 11
  s_add_u32 s91, s91, 32768
  v_and_b32 v14, 15, v1
  v_lshlrev_b32 v14, 7, v14
  s_waitcnt lgkmcnt(3)
  v_mfma_f32_16x16x32_bf16 v[64:67], a[32:35], a[160:163], v[24:27]
  s_mov_b32 m0, s26
  ds_read_b128 a[12:15], v3 offset:11264
  v_cndmask_b32 v104, v104, v5, s[48:49]
  v_mfma_f32_16x16x32_bf16 v[64:67], a[36:39], a[164:167], v[64:67]
  v_exp_f32 v104, v104
  v_mfma_f32_16x16x32_bf16 v[64:67], a[40:43], a[168:171], v[64:67]
  v_cndmask_b32 v105, v105, v5, s[50:51]
  v_exp_f32 v105, v105
  v_mfma_f32_16x16x32_bf16 v[64:67], a[44:47], a[172:175], v[64:67]
  buffer_load_dwordx4 v2, s[20:23], s28 offen offset:0 sc1 lds
  ds_read_b128 a[16:19], v3 offset:12288
  v_mfma_f32_16x16x32_bf16 v[72:75], a[32:35], a[176:179], v[28:31]
  v_cndmask_b32 v106, v106, v5, s[52:53]
  v_exp_f32 v106, v106
  v_mfma_f32_16x16x32_bf16 v[72:75], a[36:39], a[180:183], v[72:75]
  ds_read_b128 a[20:23], v3 offset:13312
  v_cndmask_b32 v107, v107, v5, s[54:55]
  v_mfma_f32_16x16x32_bf16 v[72:75], a[40:43], a[184:187], v[72:75]
  buffer_load_dwordx4 v2, s[20:23], s28 offen offset:1024 sc1 lds
  ds_read_b128 a[24:27], v3 offset:14336
  v_mfma_f32_16x16x32_bf16 v[72:75], a[44:47], a[188:191], v[72:75]
  v_exp_f32 v107, v107
  v_mfma_f32_16x16x32_bf16 v[68:71], a[48:51], a[160:163], v[24:27]
  ds_read_b128 a[28:31], v3 offset:15360
  v_cndmask_b32 v108, v108, v5, s[56:57]
  v_mfma_f32_16x16x32_bf16 v[68:71], a[52:55], a[164:167], v[68:71]
  v_exp_f32 v108, v108
  v_mfma_f32_16x16x32_bf16 v[68:71], a[56:59], a[168:171], v[68:71]
  ds_read_b128 a[32:35], v4 offset:0
  v_cndmask_b32 v109, v109, v5, s[58:59]
  v_mfma_f32_16x16x32_bf16 v[68:71], a[60:63], a[172:175], v[68:71]
  v_exp_f32 v109, v109
  v_mfma_f32_16x16x32_bf16 v[76:79], a[48:51], a[176:179], v[28:31]
  ds_read_b128 a[36:39], v4 offset:1024
  v_cvt_pk_bf16_f32 v52, v104, v105
  v_mfma_f32_16x16x32_bf16 v[76:79], a[52:55], a[180:183], v[76:79]
  buffer_load_dwordx4 v2, s[20:23], s28 offen offset:2048 sc1 lds
  v_cndmask_b32 v110, v110, v5, s[60:61]
  v_mfma_f32_16x16x32_bf16 v[76:79], a[56:59], a[184:187], v[76:79]
  v_exp_f32 v110, v110
  v_mfma_f32_16x16x32_bf16 v[76:79], a[60:63], a[188:191], v[76:79]
  s_waitcnt lgkmcnt(2)
  ds_read_b128 a[40:43], v4 offset:2048
  v_cndmask_b32 v111, v111, v5, s[62:63]
  v_mfma_f32_16x16x32_bf16 v[80:83], a[0:3], a[160:163], v[24:27]
  v_exp_f32 v111, v111
  v_mfma_f32_16x16x32_bf16 v[80:83], a[4:7], a[164:167], v[80:83]
  ds_read_b128 a[44:47], v4 offset:3072
  v_cvt_pk_bf16_f32 v53, v106, v107
  v_mfma_f32_16x16x32_bf16 v[80:83], a[8:11], a[168:171], v[80:83]
  ds_read_b128 a[48:51], v4 offset:4096
  v_cvt_pk_bf16_f32 v54, v108, v109
  v_mfma_f32_16x16x32_bf16 v[80:83], a[12:15], a[172:175], v[80:83]
  v_exp_f32 v112, v112
  v_mfma_f32_16x16x32_bf16 v[88:91], a[0:3], a[176:179], v[28:31]
  buffer_load_dwordx4 v2, s[20:23], s28 offen offset:3072 sc1 lds
  ds_read_b128 a[52:55], v4 offset:5120
  v_mfma_f32_16x16x32_bf16 v[88:91], a[4:7], a[180:183], v[88:91]
  s_xor_b32 s26, s26, 0x8000
  v_exp_f32 v113, v113
  v_mfma_f32_16x16x32_bf16 v[88:91], a[8:11], a[184:187], v[88:91]
  s_add_u32 s28, s28, 0x8000
  s_mov_b32 m0, s27
  ds_read_b128 a[56:59], v4 offset:6144
  v_mfma_f32_16x16x32_bf16 v[88:91], a[12:15], a[188:191], v[88:91]
  v_exp_f32 v114, v114
  v_mfma_f32_16x16x32_bf16 v[84:87], a[16:19], a[160:163], v[24:27]
  ds_read_b128 a[60:63], v4 offset:7168
  v_cvt_pk_bf16_f32 v55, v110, v111
  v_mfma_f32_16x16x32_bf16 v[84:87], a[20:23], a[164:167], v[84:87]
  v_xor_b32 v3, 0x4000, v3
  v_cvt_pk_bf16_f32 v56, v112, v113
  v_mfma_f32_16x16x32_bf16 v[84:87], a[24:27], a[168:171], v[84:87]
  v_exp_f32 v115, v115
  v_mfma_f32_16x16x32_bf16 v[84:87], a[28:31], a[172:175], v[84:87]
  buffer_load_dwordx4 v2, s[20:23], s29 offen offset:0 sc1 lds
  ds_read_b128 a[0:3], v3 offset:0
  v_mfma_f32_16x16x32_bf16 v[92:95], a[16:19], a[176:179], v[28:31]
  v_exp_f32 v116, v116
  v_mfma_f32_16x16x32_bf16 v[92:95], a[20:23], a[180:183], v[92:95]
  ds_read_b128 a[4:7], v3 offset:1024
  v_cvt_pk_bf16_f32 v57, v114, v115
  v_mfma_f32_16x16x32_bf16 v[92:95], a[24:27], a[184:187], v[92:95]
  v_exp_f32 v117, v117
  v_mfma_f32_16x16x32_bf16 v[92:95], a[28:31], a[188:191], v[92:95]
  s_waitcnt lgkmcnt(6)
  ds_read_b128 a[8:11], v3 offset:2048
  v_cvt_pk_bf16_f32 v58, v116, v117
  v_mfma_f32_16x16x32_bf16 v[160:163], a[32:35], v[36:39], v[160:163]
  ds_read_b128 a[12:15], v3 offset:3072
  v_mfma_f32_16x16x32_bf16 v[192:195], a[32:35], v[40:43], v[192:195]
  v_exp_f32 v118, v118
  v_mfma_f32_16x16x32_bf16 v[224:227], a[32:35], v[44:47], v[224:227]
  buffer_load_dwordx4 v2, s[20:23], s29 offen offset:1024 sc1 lds
  v_mfma_f32_16x16x32_bf16 a[196:199], a[208:211], v[36:39], a[196:199]
  v_exp_f32 v119, v119
  v_mfma_f32_16x16x32_bf16 v[164:167], a[36:39], v[36:39], v[164:167]
  ds_read_b128 a[16:19], v3 offset:4096
  v_cvt_pk_bf16_f32 v59, v118, v119
  v_mfma_f32_16x16x32_bf16 v[196:199], a[36:39], v[40:43], v[196:199]
  v_mfma_f32_16x16x32_bf16 v[228:231], a[36:39], v[44:47], v[228:231]
  v_exp_f32 v120, v120
  v_mfma_f32_16x16x32_bf16 a[200:203], a[208:211], v[40:43], a[200:203]
  v_mfma_f32_16x16x32_bf16 v[168:171], a[40:43], v[36:39], v[168:171]
  v_exp_f32 v121, v121
  v_mfma_f32_16x16x32_bf16 v[200:203], a[40:43], v[40:43], v[200:203]
  buffer_load_dwordx4 v2, s[20:23], s29 offen offset:2048 sc1 lds
  ds_read_b128 a[20:23], v3 offset:5120
  v_mfma_f32_16x16x32_bf16 v[232:235], a[40:43], v[44:47], v[232:235]
  v_exp_f32 v122, v122
  v_mfma_f32_16x16x32_bf16 a[204:207], a[208:211], v[44:47], a[204:207]
  v_cvt_pk_bf16_f32 v60, v120, v121
  v_mfma_f32_16x16x32_bf16 v[172:175], a[44:47], v[36:39], v[172:175]
  ds_read_b128 a[24:27], v3 offset:6144
  v_mfma_f32_16x16x32_bf16 v[204:207], a[44:47], v[40:43], v[204:207]
  v_exp_f32 v123, v123
  v_mfma_f32_16x16x32_bf16 v[236:239], a[44:47], v[44:47], v[236:239]
  s_waitcnt lgkmcnt(7)
  v_cvt_pk_bf16_f32 v61, v122, v123
  v_mfma_f32_16x16x32_bf16 v[176:179], a[48:51], v[36:39], v[176:179]
  v_exp_f32 v124, v124
  v_mfma_f32_16x16x32_bf16 v[208:211], a[48:51], v[40:43], v[208:211]
  buffer_load_dwordx4 v2, s[20:23], s29 offen offset:3072 sc1 lds
  ds_read_b128 a[28:31], v3 offset:7168
  v_mfma_f32_16x16x32_bf16 v[240:243], a[48:51], v[44:47], v[240:243]
  s_xor_b32 s27, s27, 0x4000
  v_exp_f32 v125, v125
  v_mfma_f32_16x16x32_bf16 v[180:183], a[52:55], v[36:39], v[180:183]
  s_add_u32 s29, s29, 0x8000
  ds_read_b128 a[32:35], v3 offset:8192
  v_cvt_pk_bf16_f32 v62, v124, v125
  v_mfma_f32_16x16x32_bf16 v[212:215], a[52:55], v[40:43], v[212:215]
  v_mfma_f32_16x16x32_bf16 v[244:247], a[52:55], v[44:47], v[244:247]
  v_exp_f32 v126, v126
  v_mfma_f32_16x16x32_bf16 v[184:187], a[56:59], v[36:39], v[184:187]
  ds_read_b128 a[36:39], v3 offset:9216
  v_mfma_f32_16x16x32_bf16 v[216:219], a[56:59], v[40:43], v[216:219]
  v_exp_f32 v127, v127
  v_mfma_f32_16x16x32_bf16 v[248:251], a[56:59], v[44:47], v[248:251]
  v_cvt_pk_bf16_f32 v63, v126, v127
  v_mfma_f32_16x16x32_bf16 v[188:191], a[60:63], v[36:39], v[188:191]
  ds_read_b128 a[40:43], v3 offset:10240
  v_mfma_f32_16x16x32_bf16 v[220:223], a[60:63], v[40:43], v[220:223]
  s_waitcnt vmcnt(12)
  s_barrier
  v_mfma_f32_16x16x32_bf16 v[252:255], a[60:63], v[44:47], v[252:255]
  s_waitcnt lgkmcnt(3)
  v_mfma_f32_16x16x32_bf16 v[96:99], a[0:3], a[160:163], v[24:27]
  s_mov_b32 m0, s26
  v_exp_f32 v64, v64
  v_mfma_f32_16x16x32_bf16 v[96:99], a[4:7], a[164:167], v[96:99]
  v_exp_f32 v65, v65
  v_mfma_f32_16x16x32_bf16 v[96:99], a[8:11], a[168:171], v[96:99]
  buffer_load_dwordx4 v2, s[20:23], s28 offen offset:0 sc1 lds
  ds_read_b128 a[44:47], v3 offset:11264
  v_mfma_f32_16x16x32_bf16 v[96:99], a[12:15], a[172:175], v[96:99]
  v_exp_f32 v66, v66
  v_mfma_f32_16x16x32_bf16 v[104:107], a[0:3], a[176:179], v[28:31]
  ds_read_b128 a[48:51], v3 offset:12288
  ds_read_b128 a[52:55], v3 offset:13312
  v_mfma_f32_16x16x32_bf16 v[104:107], a[4:7], a[180:183], v[104:107]
  v_exp_f32 v67, v67
  v_mfma_f32_16x16x32_bf16 v[104:107], a[8:11], a[184:187], v[104:107]
  ds_read_b128 a[56:59], v3 offset:14336
  v_cvt_pk_bf16_f32 v32, v64, v65
  v_mfma_f32_16x16x32_bf16 v[104:107], a[12:15], a[188:191], v[104:107]
  v_exp_f32 v68, v68
  v_mfma_f32_16x16x32_bf16 v[100:103], a[16:19], a[160:163], v[24:27]
  v_exp_f32 v69, v69
  v_mfma_f32_16x16x32_bf16 v[100:103], a[20:23], a[164:167], v[100:103]
  ds_read_b128 a[60:63], v3 offset:15360
  v_cvt_pk_bf16_f32 v33, v66, v67
  v_mfma_f32_16x16x32_bf16 v[100:103], a[24:27], a[168:171], v[100:103]
  v_exp_f32 v70, v70
  v_mfma_f32_16x16x32_bf16 v[100:103], a[28:31], a[172:175], v[100:103]
  ds_read_b128 a[0:3], v4 offset:8192
  v_cvt_pk_bf16_f32 v34, v68, v69
  v_mfma_f32_16x16x32_bf16 v[108:111], a[16:19], a[176:179], v[28:31]
  v_exp_f32 v71, v71
  v_mfma_f32_16x16x32_bf16 v[108:111], a[20:23], a[180:183], v[108:111]
  buffer_load_dwordx4 v2, s[20:23], s28 offen offset:1024 sc1 lds
  ds_read_b128 a[4:7], v4 offset:9216
  v_mfma_f32_16x16x32_bf16 v[108:111], a[24:27], a[184:187], v[108:111]
  v_exp_f32 v72, v72
  v_mfma_f32_16x16x32_bf16 v[108:111], a[28:31], a[188:191], v[108:111]
  s_waitcnt lgkmcnt(2)
  ds_read_b128 a[8:11], v4 offset:10240
  v_cvt_pk_bf16_f32 v35, v70, v71
  v_mfma_f32_16x16x32_bf16 v[112:115], a[32:35], a[160:163], v[24:27]
  v_exp_f32 v73, v73
  v_mfma_f32_16x16x32_bf16 v[112:115], a[36:39], a[164:167], v[112:115]
  v_exp_f32 v74, v74
  v_mfma_f32_16x16x32_bf16 v[112:115], a[40:43], a[168:171], v[112:115]
  ds_read_b128 a[12:15], v4 offset:11264
  ds_read_b128 a[16:19], v4 offset:12288
  v_mfma_f32_16x16x32_bf16 v[112:115], a[44:47], a[172:175], v[112:115]
  v_exp_f32 v75, v75
  v_mfma_f32_16x16x32_bf16 v[120:123], a[32:35], a[176:179], v[28:31]
  ds_read_b128 a[20:23], v4 offset:13312
  v_cvt_pk_bf16_f32 v36, v72, v73
  v_mfma_f32_16x16x32_bf16 v[120:123], a[36:39], a[180:183], v[120:123]
  v_exp_f32 v76, v76
  v_mfma_f32_16x16x32_bf16 v[120:123], a[40:43], a[184:187], v[120:123]
  ds_read_b128 a[24:27], v4 offset:14336
  v_cvt_pk_bf16_f32 v37, v74, v75
  v_mfma_f32_16x16x32_bf16 v[120:123], a[44:47], a[188:191], v[120:123]
  v_exp_f32 v77, v77
  v_mfma_f32_16x16x32_bf16 v[116:119], a[48:51], a[160:163], v[24:27]
  v_exp_f32 v78, v78
  v_mfma_f32_16x16x32_bf16 v[116:119], a[52:55], a[164:167], v[116:119]
  ds_read_b128 a[28:31], v4 offset:15360
  v_xor_b32 v4, 0x8000, v4
  v_mfma_f32_16x16x32_bf16 v[116:119], a[56:59], a[168:171], v[116:119]
  v_exp_f32 v79, v79
  v_mfma_f32_16x16x32_bf16 v[116:119], a[60:63], a[172:175], v[116:119]
  buffer_load_dwordx4 v2, s[20:23], s28 offen offset:2048 sc1 lds
  v_xor_b32 v3, 0x8000, v3
  v_mfma_f32_16x16x32_bf16 v[124:127], a[48:51], a[176:179], v[28:31]
  v_exp_f32 v80, v80
  v_mfma_f32_16x16x32_bf16 v[124:127], a[52:55], a[180:183], v[124:127]
  ds_read_b128 a[32:35], v3 offset:0
  ds_read_b128 a[36:39], v3 offset:1024
  v_mfma_f32_16x16x32_bf16 v[124:127], a[56:59], a[184:187], v[124:127]
  v_exp_f32 v81, v81
  v_mfma_f32_16x16x32_bf16 v[124:127], a[60:63], a[188:191], v[124:127]
  s_waitcnt lgkmcnt(6)
  ds_read_b128 a[40:43], v3 offset:2048
  v_cvt_pk_bf16_f32 v38, v76, v77
  v_mfma_f32_16x16x32_bf16 v[160:163], a[0:3], v[52:55], v[160:163]
  v_exp_f32 v82, v82
  v_mfma_f32_16x16x32_bf16 v[192:195], a[0:3], v[56:59], v[192:195]
  v_exp_f32 v83, v83
  v_mfma_f32_16x16x32_bf16 v[224:227], a[0:3], v[60:63], v[224:227]
  ds_read_b128 a[44:47], v3 offset:3072
  v_cvt_pk_bf16_f32 v39, v78, v79
  v_mfma_f32_16x16x32_bf16 a[196:199], a[208:211], v[52:55], a[196:199]
  v_exp_f32 v84, v84
  v_mfma_f32_16x16x32_bf16 v[164:167], a[4:7], v[52:55], v[164:167]
  ds_read_b128 a[48:51], v3 offset:4096
  v_cvt_pk_bf16_f32 v40, v80, v81
  v_mfma_f32_16x16x32_bf16 v[196:199], a[4:7], v[56:59], v[196:199]
  v_exp_f32 v85, v85
  v_mfma_f32_16x16x32_bf16 v[228:231], a[4:7], v[60:63], v[228:231]
  v_cvt_pk_bf16_f32 v41, v82, v83
  v_cvt_pk_bf16_f32 v42, v84, v85
  v_mfma_f32_16x16x32_bf16 a[200:203], a[208:211], v[56:59], a[200:203]
  v_exp_f32 v86, v86
  v_mfma_f32_16x16x32_bf16 v[168:171], a[8:11], v[52:55], v[168:171]
  v_exp_f32 v87, v87
  v_mfma_f32_16x16x32_bf16 v[200:203], a[8:11], v[56:59], v[200:203]
  buffer_load_dwordx4 v2, s[20:23], s28 offen offset:3072 sc1 lds
  ds_read_b128 a[52:55], v3 offset:5120
  v_mfma_f32_16x16x32_bf16 v[232:235], a[8:11], v[60:63], v[232:235]
  s_xor_b32 s26, s26, 0x4000
  v_exp_f32 v88, v88
  v_mfma_f32_16x16x32_bf16 a[204:207], a[208:211], v[60:63], a[204:207]
  s_add_u32 s28, s28, 0x8000
  v_cvt_pk_bf16_f32 v43, v86, v87
  v_mfma_f32_16x16x32_bf16 v[172:175], a[12:15], v[52:55], v[172:175]
  v_exp_f32 v89, v89
  v_mfma_f32_16x16x32_bf16 v[204:207], a[12:15], v[56:59], v[204:207]
  ds_read_b128 a[56:59], v3 offset:6144
  v_cvt_pk_bf16_f32 v44, v88, v89
  v_mfma_f32_16x16x32_bf16 v[236:239], a[12:15], v[60:63], v[236:239]
  s_waitcnt lgkmcnt(7)
  v_exp_f32 v90, v90
  v_mfma_f32_16x16x32_bf16 v[176:179], a[16:19], v[52:55], v[176:179]
  ds_read_b128 a[60:63], v3 offset:7168
  v_mfma_f32_16x16x32_bf16 v[208:211], a[16:19], v[56:59], v[208:211]
  v_exp_f32 v91, v91
  v_mfma_f32_16x16x32_bf16 v[240:243], a[16:19], v[60:63], v[240:243]
  v_exp_f32 v92, v92
  v_mfma_f32_16x16x32_bf16 v[180:183], a[20:23], v[52:55], v[180:183]
  ds_read_b128 a[0:3], v3 offset:8192
  v_cvt_pk_bf16_f32 v45, v90, v91
  v_mfma_f32_16x16x32_bf16 v[212:215], a[20:23], v[56:59], v[212:215]
  v_exp_f32 v93, v93
  v_mfma_f32_16x16x32_bf16 v[244:247], a[20:23], v[60:63], v[244:247]
  v_cvt_pk_bf16_f32 v46, v92, v93
  v_mfma_f32_16x16x32_bf16 v[184:187], a[24:27], v[52:55], v[184:187]
  v_exp_f32 v94, v94
  v_mfma_f32_16x16x32_bf16 v[216:219], a[24:27], v[56:59], v[216:219]
  ds_read_b128 a[4:7], v3 offset:9216
  v_mfma_f32_16x16x32_bf16 v[248:251], a[24:27], v[60:63], v[248:251]
  v_exp_f32 v95, v95
  v_mfma_f32_16x16x32_bf16 v[188:191], a[28:31], v[52:55], v[188:191]
  ds_read_b128 a[8:11], v3 offset:10240
  v_cvt_pk_bf16_f32 v47, v94, v95
  v_mfma_f32_16x16x32_bf16 v[220:223], a[28:31], v[56:59], v[220:223]
  s_waitcnt vmcnt(8)
  s_barrier
  v_mfma_f32_16x16x32_bf16 v[252:255], a[28:31], v[60:63], v[252:255]
  s_lshl_b32 s4, s25, 20
  s_lshl_b32 s5, s24, 15
  s_add_u32 s4, s4, s5
  s_lshl_b32 s5, s3, 11
  s_add_u32 s4, s4, s5
  v_accvgpr_read_b32 v6, a192
  v_accvgpr_read_b32 v8, a196
  s_mov_b32 s5, 0x5f800000
  v_cmp_ngt_f32 vcc, s5, v6
  v_rcp_f32 v6, v6
  s_or_b32 s89, s89, vcc_lo
  s_or_b32 s89, s89, vcc_hi
  v_mov_b32 v7, v6
  v_cmp_ngt_f32 vcc, s5, v8
  v_rcp_f32 v8, v8
  s_or_b32 s89, s89, vcc_lo
  s_or_b32 s89, s89, vcc_hi
  v_mov_b32 v9, v8
  v_pk_mul_f32 v[128:129], v[128:129], v[6:7]
  v_pk_mul_f32 v[130:131], v[130:131], v[6:7]
  v_pk_mul_f32 v[132:133], v[132:133], v[6:7]
  v_pk_mul_f32 v[134:135], v[134:135], v[6:7]
  v_cvt_pk_bf16_f32 v128, v128, v129
  v_cvt_pk_bf16_f32 v129, v130, v131
  v_cvt_pk_bf16_f32 v130, v132, v133
  v_cvt_pk_bf16_f32 v131, v134, v135
  buffer_store_dwordx4 v[128:131], v2, s[16:19], s4 offen offset:0 sc1
  v_pk_mul_f32 v[160:161], v[160:161], v[8:9]
  v_pk_mul_f32 v[162:163], v[162:163], v[8:9]
  v_pk_mul_f32 v[164:165], v[164:165], v[8:9]
  v_pk_mul_f32 v[166:167], v[166:167], v[8:9]
  v_cvt_pk_bf16_f32 v160, v160, v161
  v_cvt_pk_bf16_f32 v161, v162, v163
  v_cvt_pk_bf16_f32 v162, v164, v165
  v_cvt_pk_bf16_f32 v163, v166, v167
  buffer_store_dwordx4 v[160:163], v2, s[16:19], s4 offen offset:1024 sc1
  s_add_u32 s4, s4, 8192
  v_pk_mul_f32 v[136:137], v[136:137], v[6:7]
  v_pk_mul_f32 v[138:139], v[138:139], v[6:7]
  v_pk_mul_f32 v[140:141], v[140:141], v[6:7]
  v_pk_mul_f32 v[142:143], v[142:143], v[6:7]
  v_cvt_pk_bf16_f32 v136, v136, v137
  v_cvt_pk_bf16_f32 v137, v138, v139
  v_cvt_pk_bf16_f32 v138, v140, v141
  v_cvt_pk_bf16_f32 v139, v142, v143
  buffer_store_dwordx4 v[136:139], v2, s[16:19], s4 offen offset:0 sc1
  v_pk_mul_f32 v[168:169], v[168:169], v[8:9]
  v_pk_mul_f32 v[170:171], v[170:171], v[8:9]
  v_pk_mul_f32 v[172:173], v[172:173], v[8:9]
  v_pk_mul_f32 v[174:175], v[174:175], v[8:9]
  v_cvt_pk_bf16_f32 v168, v168, v169
  v_cvt_pk_bf16_f32 v169, v170, v171
  v_cvt_pk_bf16_f32 v170, v172, v173
  v_cvt_pk_bf16_f32 v171, v174, v175
  buffer_store_dwordx4 v[168:171], v2, s[16:19], s4 offen offset:1024 sc1
  s_add_u32 s4, s4, 8192
  v_pk_mul_f32 v[144:145], v[144:145], v[6:7]
  v_pk_mul_f32 v[146:147], v[146:147], v[6:7]
  v_pk_mul_f32 v[148:149], v[148:149], v[6:7]
  v_pk_mul_f32 v[150:151], v[150:151], v[6:7]
  v_cvt_pk_bf16_f32 v144, v144, v145
  v_cvt_pk_bf16_f32 v145, v146, v147
  v_cvt_pk_bf16_f32 v146, v148, v149
  v_cvt_pk_bf16_f32 v147, v150, v151
  buffer_store_dwordx4 v[144:147], v2, s[16:19], s4 offen offset:0 sc1
  v_pk_mul_f32 v[176:177], v[176:177], v[8:9]
  v_pk_mul_f32 v[178:179], v[178:179], v[8:9]
  v_pk_mul_f32 v[180:181], v[180:181], v[8:9]
  v_pk_mul_f32 v[182:183], v[182:183], v[8:9]
  v_cvt_pk_bf16_f32 v176, v176, v177
  v_cvt_pk_bf16_f32 v177, v178, v179
  v_cvt_pk_bf16_f32 v178, v180, v181
  v_cvt_pk_bf16_f32 v179, v182, v183
  buffer_store_dwordx4 v[176:179], v2, s[16:19], s4 offen offset:1024 sc1
  s_add_u32 s4, s4, 8192
  v_pk_mul_f32 v[152:153], v[152:153], v[6:7]
  v_pk_mul_f32 v[154:155], v[154:155], v[6:7]
  v_pk_mul_f32 v[156:157], v[156:157], v[6:7]
  v_pk_mul_f32 v[158:159], v[158:159], v[6:7]
  v_cvt_pk_bf16_f32 v152, v152, v153
  v_cvt_pk_bf16_f32 v153, v154, v155
  v_cvt_pk_bf16_f32 v154, v156, v157
  v_cvt_pk_bf16_f32 v155, v158, v159
  buffer_store_dwordx4 v[152:155], v2, s[16:19], s4 offen offset:0 sc1
  v_pk_mul_f32 v[184:185], v[184:185], v[8:9]
  v_pk_mul_f32 v[186:187], v[186:187], v[8:9]
  v_pk_mul_f32 v[188:189], v[188:189], v[8:9]
  v_pk_mul_f32 v[190:191], v[190:191], v[8:9]
  v_cvt_pk_bf16_f32 v184, v184, v185
  v_cvt_pk_bf16_f32 v185, v186, v187
  v_cvt_pk_bf16_f32 v186, v188, v189
  v_cvt_pk_bf16_f32 v187, v190, v191
  buffer_store_dwordx4 v[184:187], v2, s[16:19], s4 offen offset:1024 sc1
  s_and_b32 s88, s25, 1
  s_lshl_b32 s88, s88, 1
  s_add_u32 s88, s88, 14
  s_sub_u32 s88, s88, s25
  s_sub_u32 s88, s88, s25
  s_sub_u32 s88, s88, 1
  .p2align 6
La_so:
  s_waitcnt lgkmcnt(3)
  v_mfma_f32_16x16x32_bf16 v[64:67], a[32:35], a[160:163], v[24:27]
  s_mov_b32 m0, s26
  v_exp_f32 v96, v96
  v_mfma_f32_16x16x32_bf16 v[64:67], a[36:39], a[164:167], v[64:67]
  buffer_load_dwordx4 v2, s[20:23], s28 offen offset:0 sc1 lds
  ds_read_b128 a[12:15], v3 offset:11264
  v_mfma_f32_16x16x32_bf16 v[64:67], a[40:43], a[168:171], v[64:67]
  v_exp_f32 v97, v97
  v_mfma_f32_16x16x32_bf16 v[64:67], a[44:47], a[172:175], v[64:67]
  ds_read_b128 a[16:19], v3 offset:12288
  v_cvt_pk_bf16_f32 v48, v96, v97
  v_mfma_f32_16x16x32_bf16 v[72:75], a[32:35], a[176:179], v[28:31]
  v_exp_f32 v98, v98
  v_mfma_f32_16x16x32_bf16 v[72:75], a[36:39], a[180:183], v[72:75]
  ds_read_b128 a[20:23], v3 offset:13312
  v_mfma_f32_16x16x32_bf16 v[72:75], a[40:43], a[184:187], v[72:75]
  v_exp_f32 v99, v99
  v_mfma_f32_16x16x32_bf16 v[72:75], a[44:47], a[188:191], v[72:75]
  ds_read_b128 a[24:27], v3 offset:14336
  v_cvt_pk_bf16_f32 v49, v98, v99
  v_mfma_f32_16x16x32_bf16 v[68:71], a[48:51], a[160:163], v[24:27]
  v_exp_f32 v100, v100
  v_mfma_f32_16x16x32_bf16 v[68:71], a[52:55], a[164:167], v[68:71]
  buffer_load_dwordx4 v2, s[20:23], s28 offen offset:1024 sc1 lds
  ds_read_b128 a[28:31], v3 offset:15360
  v_mfma_f32_16x16x32_bf16 v[68:71], a[56:59], a[168:171], v[68:71]
  v_exp_f32 v101, v101
  v_mfma_f32_16x16x32_bf16 v[68:71], a[60:63], a[172:175], v[68:71]
  ds_read_b128 a[32:35], v4 offset:0
  v_cvt_pk_bf16_f32 v50, v100, v101
  v_mfma_f32_16x16x32_bf16 v[76:79], a[48:51], a[176:179], v[28:31]
  v_exp_f32 v102, v102
  v_mfma_f32_16x16x32_bf16 v[76:79], a[52:55], a[180:183], v[76:79]
  ds_read_b128 a[36:39], v4 offset:1024
  v_mfma_f32_16x16x32_bf16 v[76:79], a[56:59], a[184:187], v[76:79]
  v_exp_f32 v103, v103
  v_mfma_f32_16x16x32_bf16 v[76:79], a[60:63], a[188:191], v[76:79]
  s_waitcnt lgkmcnt(2)
  ds_read_b128 a[40:43], v4 offset:2048
  v_cvt_pk_bf16_f32 v51, v102, v103
  v_mfma_f32_16x16x32_bf16 v[80:83], a[0:3], a[160:163], v[24:27]
  v_exp_f32 v104, v104
  v_mfma_f32_16x16x32_bf16 v[80:83], a[4:7], a[164:167], v[80:83]
  buffer_load_dwordx4 v2, s[20:23], s28 offen offset:2048 sc1 lds
  ds_read_b128 a[44:47], v4 offset:3072
  v_mfma_f32_16x16x32_bf16 v[80:83], a[8:11], a[168:171], v[80:83]
  v_exp_f32 v105, v105
  v_mfma_f32_16x16x32_bf16 v[80:83], a[12:15], a[172:175], v[80:83]
  ds_read_b128 a[48:51], v4 offset:4096
  v_cvt_pk_bf16_f32 v52, v104, v105
  v_mfma_f32_16x16x32_bf16 v[88:91], a[0:3], a[176:179], v[28:31]
  v_exp_f32 v106, v106
  v_mfma_f32_16x16x32_bf16 v[88:91], a[4:7], a[180:183], v[88:91]
  ds_read_b128 a[52:55], v4 offset:5120
  v_mfma_f32_16x16x32_bf16 v[88:91], a[8:11], a[184:187], v[88:91]
  v_exp_f32 v107, v107
  v_mfma_f32_16x16x32_bf16 v[88:91], a[12:15], a[188:191], v[88:91]
  ds_read_b128 a[56:59], v4 offset:6144
  v_cvt_pk_bf16_f32 v53, v106, v107
  v_mfma_f32_16x16x32_bf16 v[84:87], a[16:19], a[160:163], v[24:27]
  v_exp_f32 v108, v108
  v_mfma_f32_16x16x32_bf16 v[84:87], a[20:23], a[164:167], v[84:87]
  buffer_load_dwordx4 v2, s[20:23], s28 offen offset:3072 sc1 lds
  ds_read_b128 a[60:63], v4 offset:7168
  v_mfma_f32_16x16x32_bf16 v[84:87], a[24:27], a[168:171], v[84:87]
  s_xor_b32 s26, s26, 0x8000
  v_exp_f32 v109, v109
  v_mfma_f32_16x16x32_bf16 v[84:87], a[28:31], a[172:175], v[84:87]
  s_add_u32 s28, s28, 0x8000
  s_mov_b32 m0, s27
  ds_read_b128 a[0:3], v4 offset:8192
  v_mfma_f32_16x16x32_bf16 v[92:95], a[16:19], a[176:179], v[28:31]
  v_exp_f32 v110, v110
  v_mfma_f32_16x16x32_bf16 v[92:95], a[20:23], a[180:183], v[92:95]
  ds_read_b128 a[4:7], v4 offset:9216
  v_cvt_pk_bf16_f32 v54, v108, v109
  v_mfma_f32_16x16x32_bf16 v[92:95], a[24:27], a[184:187], v[92:95]
  v_exp_f32 v111, v111
  v_mfma_f32_16x16x32_bf16 v[92:95], a[28:31], a[188:191], v[92:95]
  s_waitcnt lgkmcnt(2)
  ds_read_b128 a[8:11], v4 offset:10240
  v_cvt_pk_bf16_f32 v55, v110, v111
  v_mfma_f32_16x16x32_bf16 v[192:195], a[32:35], v[32:35], v[192:195]
  buffer_load_dwordx4 v2, s[20:23], s29 offen offset:0 sc1 lds
  ds_read_b128 a[12:15], v4 offset:11264
  v_mfma_f32_16x16x32_bf16 v[224:227], a[32:35], v[36:39], v[224:227]
  v_exp_f32 v112, v112
  v_mfma_f32_16x16x32_bf16 a[200:203], a[208:211], v[32:35], a[200:203]
  s_sub_u32 s88, s88, 1
  v_mfma_f32_16x16x32_bf16 v[196:199], a[36:39], v[32:35], v[196:199]
  v_exp_f32 v113, v113
  v_mfma_f32_16x16x32_bf16 v[228:231], a[36:39], v[36:39], v[228:231]
  ds_read_b128 a[16:19], v4 offset:12288
  v_cvt_pk_bf16_f32 v56, v112, v113
  v_mfma_f32_16x16x32_bf16 a[204:207], a[208:211], v[36:39], a[204:207]
  v_exp_f32 v114, v114
  v_mfma_f32_16x16x32_bf16 v[200:203], a[40:43], v[32:35], v[200:203]
  ds_read_b128 a[20:23], v4 offset:13312
  v_mfma_f32_16x16x32_bf16 v[232:235], a[40:43], v[36:39], v[232:235]
  v_exp_f32 v115, v115
  v_mfma_f32_16x16x32_bf16 v[204:207], a[44:47], v[32:35], v[204:207]
  buffer_load_dwordx4 v2, s[20:23], s29 offen offset:1024 sc1 lds
  ds_read_b128 a[24:27], v4 offset:14336
  v_mfma_f32_16x16x32_bf16 v[236:239], a[44:47], v[36:39], v[236:239]
  v_exp_f32 v116, v116
  v_mfma_f32_16x16x32_bf16 v[208:211], a[48:51], v[32:35], v[208:211]
  ds_read_b128 a[28:31], v4 offset:15360
  v_xor_b32 v4, 0x4000, v4
  v_mfma_f32_16x16x32_bf16 v[240:243], a[48:51], v[36:39], v[240:243]
  v_exp_f32 v117, v117
  v_mfma_f32_16x16x32_bf16 v[212:215], a[52:55], v[32:35], v[212:215]
  v_xor_b32 v3, 0x4000, v3
  v_cvt_pk_bf16_f32 v57, v114, v115
  v_mfma_f32_16x16x32_bf16 v[244:247], a[52:55], v[36:39], v[244:247]
  v_exp_f32 v118, v118
  v_mfma_f32_16x16x32_bf16 v[216:219], a[56:59], v[32:35], v[216:219]
  ds_read_b128 a[32:35], v3 offset:0
  ds_read_b128 a[36:39], v3 offset:1024
  v_mfma_f32_16x16x32_bf16 v[248:251], a[56:59], v[36:39], v[248:251]
  v_exp_f32 v119, v119
  v_mfma_f32_16x16x32_bf16 v[220:223], a[60:63], v[32:35], v[220:223]
  buffer_load_dwordx4 v2, s[20:23], s29 offen offset:2048 sc1 lds
  ds_read_b128 a[40:43], v3 offset:2048
  v_mfma_f32_16x16x32_bf16 v[252:255], a[60:63], v[36:39], v[252:255]
  s_waitcnt lgkmcnt(3)
  v_exp_f32 v120, v120
  v_mfma_f32_16x16x32_bf16 v[192:195], a[0:3], v[40:43], v[192:195]
  ds_read_b128 a[44:47], v3 offset:3072
  v_cvt_pk_bf16_f32 v58, v116, v117
  v_mfma_f32_16x16x32_bf16 v[224:227], a[0:3], v[44:47], v[224:227]
  v_exp_f32 v121, v121
  v_mfma_f32_16x16x32_bf16 a[200:203], a[208:211], v[40:43], a[200:203]
  v_cvt_pk_bf16_f32 v59, v118, v119
  v_cvt_pk_bf16_f32 v60, v120, v121
  v_mfma_f32_16x16x32_bf16 v[196:199], a[4:7], v[40:43], v[196:199]
  v_exp_f32 v122, v122
  v_mfma_f32_16x16x32_bf16 v[228:231], a[4:7], v[44:47], v[228:231]
  ds_read_b128 a[48:51], v3 offset:4096
  v_mfma_f32_16x16x32_bf16 a[204:207], a[208:211], v[44:47], a[204:207]
  v_exp_f32 v123, v123
  v_mfma_f32_16x16x32_bf16 v[200:203], a[8:11], v[40:43], v[200:203]
  buffer_load_dwordx4 v2, s[20:23], s29 offen offset:3072 sc1 lds
  ds_read_b128 a[52:55], v3 offset:5120
  v_mfma_f32_16x16x32_bf16 v[232:235], a[8:11], v[44:47], v[232:235]
  s_xor_b32 s27, s27, 0x8000
  v_exp_f32 v124, v124
  v_mfma_f32_16x16x32_bf16 v[204:207], a[12:15], v[40:43], v[204:207]
  s_add_u32 s29, s29, 0x8000
  ds_read_b128 a[56:59], v3 offset:6144
  v_cvt_pk_bf16_f32 v61, v122, v123
  v_mfma_f32_16x16x32_bf16 v[236:239], a[12:15], v[44:47], v[236:239]
  v_exp_f32 v125, v125
  v_mfma_f32_16x16x32_bf16 v[208:211], a[16:19], v[40:43], v[208:211]
  ds_read_b128 a[60:63], v3 offset:7168
  v_cvt_pk_bf16_f32 v62, v124, v125
  v_mfma_f32_16x16x32_bf16 v[240:243], a[16:19], v[44:47], v[240:243]
  v_exp_f32 v126, v126
  v_mfma_f32_16x16x32_bf16 v[212:215], a[20:23], v[40:43], v[212:215]
  ds_read_b128 a[0:3], v3 offset:8192
  v_mfma_f32_16x16x32_bf16 v[244:247], a[20:23], v[44:47], v[244:247]
  v_exp_f32 v127, v127
  v_mfma_f32_16x16x32_bf16 v[216:219], a[24:27], v[40:43], v[216:219]
  ds_read_b128 a[4:7], v3 offset:9216
  v_cvt_pk_bf16_f32 v63, v126, v127
  v_mfma_f32_16x16x32_bf16 v[248:251], a[24:27], v[44:47], v[248:251]
  v_mfma_f32_16x16x32_bf16 v[220:223], a[28:31], v[40:43], v[220:223]
  s_waitcnt vmcnt(8)
  s_barrier
  v_mfma_f32_16x16x32_bf16 v[252:255], a[28:31], v[44:47], v[252:255]
  ds_read_b128 a[8:11], v3 offset:10240
  s_cmp_eq_u32 s88, 0
  s_cbranch_scc1 La_e0
  s_waitcnt lgkmcnt(3)
  v_mfma_f32_16x16x32_bf16 v[96:99], a[32:35], a[160:163], v[24:27]
  s_mov_b32 m0, s26
  v_exp_f32 v64, v64
  v_mfma_f32_16x16x32_bf16 v[96:99], a[36:39], a[164:167], v[96:99]
  buffer_load_dwordx4 v2, s[20:23], s28 offen offset:0 sc1 lds
  ds_read_b128 a[12:15], v3 offset:11264
  v_mfma_f32_16x16x32_bf16 v[96:99], a[40:43], a[168:171], v[96:99]
  v_exp_f32 v65, v65
  v_mfma_f32_16x16x32_bf16 v[96:99], a[44:47], a[172:175], v[96:99]
  ds_read_b128 a[16:19], v3 offset:12288
  v_cvt_pk_bf16_f32 v32, v64, v65
  v_mfma_f32_16x16x32_bf16 v[104:107], a[32:35], a[176:179], v[28:31]
  v_exp_f32 v66, v66
  v_mfma_f32_16x16x32_bf16 v[104:107], a[36:39], a[180:183], v[104:107]
  ds_read_b128 a[20:23], v3 offset:13312
  v_mfma_f32_16x16x32_bf16 v[104:107], a[40:43], a[184:187], v[104:107]
  v_exp_f32 v67, v67
  v_mfma_f32_16x16x32_bf16 v[104:107], a[44:47], a[188:191], v[104:107]
  ds_read_b128 a[24:27], v3 offset:14336
  v_cvt_pk_bf16_f32 v33, v66, v67
  v_mfma_f32_16x16x32_bf16 v[100:103], a[48:51], a[160:163], v[24:27]
  v_exp_f32 v68, v68
  v_mfma_f32_16x16x32_bf16 v[100:103], a[52:55], a[164:167], v[100:103]
  buffer_load_dwordx4 v2, s[20:23], s28 offen offset:1024 sc1 lds
  ds_read_b128 a[28:31], v3 offset:15360
  v_mfma_f32_16x16x32_bf16 v[100:103], a[56:59], a[168:171], v[100:103]
  v_exp_f32 v69, v69
  v_mfma_f32_16x16x32_bf16 v[100:103], a[60:63], a[172:175], v[100:103]
  ds_read_b128 a[32:35], v4 offset:0
  v_cvt_pk_bf16_f32 v34, v68, v69
  v_mfma_f32_16x16x32_bf16 v[108:111], a[48:51], a[176:179], v[28:31]
  v_exp_f32 v70, v70
  v_mfma_f32_16x16x32_bf16 v[108:111], a[52:55], a[180:183], v[108:111]
  ds_read_b128 a[36:39], v4 offset:1024
  v_mfma_f32_16x16x32_bf16 v[108:111], a[56:59], a[184:187], v[108:111]
  v_exp_f32 v71, v71
  v_mfma_f32_16x16x32_bf16 v[108:111], a[60:63], a[188:191], v[108:111]
  s_waitcnt lgkmcnt(2)
  ds_read_b128 a[40:43], v4 offset:2048
  v_cvt_pk_bf16_f32 v35, v70, v71
  v_mfma_f32_16x16x32_bf16 v[112:115], a[0:3], a[160:163], v[24:27]
  v_exp_f32 v72, v72
  v_mfma_f32_16x16x32_bf16 v[112:115], a[4:7], a[164:167], v[112:115]
  buffer_load_dwordx4 v2, s[20:23], s28 offen offset:2048 sc1 lds
  ds_read_b128 a[44:47], v4 offset:3072
  v_mfma_f32_16x16x32_bf16 v[112:115], a[8:11], a[168:171], v[112:115]
  v_exp_f32 v73, v73
  v_mfma_f32_16x16x32_bf16 v[112:115], a[12:15], a[172:175], v[112:115]
  ds_read_b128 a[48:51], v4 offset:4096
  v_cvt_pk_bf16_f32 v36, v72, v73
  v_mfma_f32_16x16x32_bf16 v[120:123], a[0:3], a[176:179], v[28:31]
  v_exp_f32 v74, v74
  v_mfma_f32_16x16x32_bf16 v[120:123], a[4:7], a[180:183], v[120:123]
  ds_read_b128 a[52:55], v4 offset:5120
  v_mfma_f32_16x16x32_bf16 v[120:123], a[8:11], a[184:187], v[120:123]
  v_exp_f32 v75, v75
  v_mfma_f32_16x16x32_bf16 v[120:123], a[12:15], a[188:191], v[120:123]
  ds_read_b128 a[56:59], v4 offset:6144
  v_cvt_pk_bf16_f32 v37, v74, v75
  v_mfma_f32_16x16x32_bf16 v[116:119], a[16:19], a[160:163], v[24:27]
  v_exp_f32 v76, v76
  v_mfma_f32_16x16x32_bf16 v[116:119], a[20:23], a[164:167], v[116:119]
  buffer_load_dwordx4 v2, s[20:23], s28 offen offset:3072 sc1 lds
  ds_read_b128 a[60:63], v4 offset:7168
  v_mfma_f32_16x16x32_bf16 v[116:119], a[24:27], a[168:171], v[116:119]
  s_xor_b32 s26, s26, 0x4000
  v_exp_f32 v77, v77
  v_mfma_f32_16x16x32_bf16 v[116:119], a[28:31], a[172:175], v[116:119]
  s_add_u32 s28, s28, 0x8000
  s_mov_b32 m0, s27
  ds_read_b128 a[0:3], v4 offset:8192
  v_mfma_f32_16x16x32_bf16 v[124:127], a[16:19], a[176:179], v[28:31]
  v_exp_f32 v78, v78
  v_mfma_f32_16x16x32_bf16 v[124:127], a[20:23], a[180:183], v[124:127]
  ds_read_b128 a[4:7], v4 offset:9216
  v_cvt_pk_bf16_f32 v38, v76, v77
  v_mfma_f32_16x16x32_bf16 v[124:127], a[24:27], a[184:187], v[124:127]
  v_exp_f32 v79, v79
  v_mfma_f32_16x16x32_bf16 v[124:127], a[28:31], a[188:191], v[124:127]
  s_waitcnt lgkmcnt(2)
  ds_read_b128 a[8:11], v4 offset:10240
  v_cvt_pk_bf16_f32 v39, v78, v79
  v_mfma_f32_16x16x32_bf16 v[192:195], a[32:35], v[48:51], v[192:195]
  buffer_load_dwordx4 v2, s[20:23], s29 offen offset:0 sc1 lds
  ds_read_b128 a[12:15], v4 offset:11264
  v_mfma_f32_16x16x32_bf16 v[224:227], a[32:35], v[52:55], v[224:227]
  v_exp_f32 v80, v80
  v_mfma_f32_16x16x32_bf16 a[200:203], a[208:211], v[48:51], a[200:203]
  v_mfma_f32_16x16x32_bf16 v[196:199], a[36:39], v[48:51], v[196:199]
  v_exp_f32 v81, v81
  v_mfma_f32_16x16x32_bf16 v[228:231], a[36:39], v[52:55], v[228:231]
  ds_read_b128 a[16:19], v4 offset:12288
  v_cvt_pk_bf16_f32 v40, v80, v81
  v_mfma_f32_16x16x32_bf16 a[204:207], a[208:211], v[52:55], a[204:207]
  v_exp_f32 v82, v82
  v_mfma_f32_16x16x32_bf16 v[200:203], a[40:43], v[48:51], v[200:203]
  ds_read_b128 a[20:23], v4 offset:13312
  v_mfma_f32_16x16x32_bf16 v[232:235], a[40:43], v[52:55], v[232:235]
  v_exp_f32 v83, v83
  v_mfma_f32_16x16x32_bf16 v[204:207], a[44:47], v[48:51], v[204:207]
  buffer_load_dwordx4 v2, s[20:23], s29 offen offset:1024 sc1 lds
  ds_read_b128 a[24:27], v4 offset:14336
  v_mfma_f32_16x16x32_bf16 v[236:239], a[44:47], v[52:55], v[236:239]
  v_exp_f32 v84, v84
  v_mfma_f32_16x16x32_bf16 v[208:211], a[48:51], v[48:51], v[208:211]
  ds_read_b128 a[28:31], v4 offset:15360
  v_xor_b32 v4, 0x8000, v4
  v_mfma_f32_16x16x32_bf16 v[240:243], a[48:51], v[52:55], v[240:243]
  v_exp_f32 v85, v85
  v_mfma_f32_16x16x32_bf16 v[212:215], a[52:55], v[48:51], v[212:215]
  v_xor_b32 v3, 0x8000, v3
  v_cvt_pk_bf16_f32 v41, v82, v83
  v_mfma_f32_16x16x32_bf16 v[244:247], a[52:55], v[52:55], v[244:247]
  v_exp_f32 v86, v86
  v_mfma_f32_16x16x32_bf16 v[216:219], a[56:59], v[48:51], v[216:219]
  ds_read_b128 a[32:35], v3 offset:0
  ds_read_b128 a[36:39], v3 offset:1024
  v_mfma_f32_16x16x32_bf16 v[248:251], a[56:59], v[52:55], v[248:251]
  v_exp_f32 v87, v87
  v_mfma_f32_16x16x32_bf16 v[220:223], a[60:63], v[48:51], v[220:223]
  buffer_load_dwordx4 v2, s[20:23], s29 offen offset:2048 sc1 lds
  ds_read_b128 a[40:43], v3 offset:2048
  v_mfma_f32_16x16x32_bf16 v[252:255], a[60:63], v[52:55], v[252:255]
  s_waitcnt lgkmcnt(3)
  v_exp_f32 v88, v88
  v_mfma_f32_16x16x32_bf16 v[192:195], a[0:3], v[56:59], v[192:195]
  ds_read_b128 a[44:47], v3 offset:3072
  v_cvt_pk_bf16_f32 v42, v84, v85
  v_mfma_f32_16x16x32_bf16 v[224:227], a[0:3], v[60:63], v[224:227]
  v_exp_f32 v89, v89
  v_mfma_f32_16x16x32_bf16 a[200:203], a[208:211], v[56:59], a[200:203]
  v_cvt_pk_bf16_f32 v43, v86, v87
  v_cvt_pk_bf16_f32 v44, v88, v89
  v_mfma_f32_16x16x32_bf16 v[196:199], a[4:7], v[56:59], v[196:199]
  v_exp_f32 v90, v90
  v_mfma_f32_16x16x32_bf16 v[228:231], a[4:7], v[60:63], v[228:231]
  ds_read_b128 a[48:51], v3 offset:4096
  v_mfma_f32_16x16x32_bf16 a[204:207], a[208:211], v[60:63], a[204:207]
  v_exp_f32 v91, v91
  v_mfma_f32_16x16x32_bf16 v[200:203], a[8:11], v[56:59], v[200:203]
  buffer_load_dwordx4 v2, s[20:23], s29 offen offset:3072 sc1 lds
  ds_read_b128 a[52:55], v3 offset:5120
  v_mfma_f32_16x16x32_bf16 v[232:235], a[8:11], v[60:63], v[232:235]
  s_xor_b32 s27, s27, 0x4000
  v_exp_f32 v92, v92
  v_mfma_f32_16x16x32_bf16 v[204:207], a[12:15], v[56:59], v[204:207]
  s_add_u32 s29, s29, 0x8000
  ds_read_b128 a[56:59], v3 offset:6144
  v_cvt_pk_bf16_f32 v45, v90, v91
  v_mfma_f32_16x16x32_bf16 v[236:239], a[12:15], v[60:63], v[236:239]
  v_exp_f32 v93, v93
  v_mfma_f32_16x16x32_bf16 v[208:211], a[16:19], v[56:59], v[208:211]
  ds_read_b128 a[60:63], v3 offset:7168
  v_cvt_pk_bf16_f32 v46, v92, v93
  v_mfma_f32_16x16x32_bf16 v[240:243], a[16:19], v[60:63], v[240:243]
  v_exp_f32 v94, v94
  v_mfma_f32_16x16x32_bf16 v[212:215], a[20:23], v[56:59], v[212:215]
  ds_read_b128 a[0:3], v3 offset:8192
  v_mfma_f32_16x16x32_bf16 v[244:247], a[20:23], v[60:63], v[244:247]
  v_exp_f32 v95, v95
  v_mfma_f32_16x16x32_bf16 v[216:219], a[24:27], v[56:59], v[216:219]
  ds_read_b128 a[4:7], v3 offset:9216
  v_cvt_pk_bf16_f32 v47, v94, v95
  v_mfma_f32_16x16x32_bf16 v[248:251], a[24:27], v[60:63], v[248:251]
  v_mfma_f32_16x16x32_bf16 v[220:223], a[28:31], v[56:59], v[220:223]
  s_waitcnt vmcnt(12)
  s_barrier
  v_mfma_f32_16x16x32_bf16 v[252:255], a[28:31], v[60:63], v[252:255]
  ds_read_b128 a[8:11], v3 offset:10240
  s_branch La_so
La_e0:
  s_waitcnt lgkmcnt(7)
  v_mfma_f32_16x16x32_bf16 v[104:107], a[32:35], a[176:179], v[28:31]
  buffer_load_dwordx2 v[12:13], v14, s[96:99], s91 offen sc1
  ds_read_b128 a[12:15], v3 offset:11264
  v_mfma_f32_16x16x32_bf16 v[104:107], a[36:39], a[180:183], v[104:107]
  v_cndmask_b32 v64, v64, v5, s[32:33]
  v_exp_f32 v64, v64
  v_mfma_f32_16x16x32_bf16 v[104:107], a[40:43], a[184:187], v[104:107]
  v_cndmask_b32 v65, v65, v5, s[34:35]
  v_exp_f32 v65, v65
  v_mfma_f32_16x16x32_bf16 v[104:107], a[44:47], a[188:191], v[104:107]
  s_waitcnt lgkmcnt(4)
  v_cndmask_b32 v66, v66, v5, s[36:37]
  v_exp_f32 v66, v66
  v_mfma_f32_16x16x32_bf16 v[108:111], a[48:51], a[176:179], v[28:31]
  v_cndmask_b32 v67, v67, v5, s[38:39]
  v_exp_f32 v67, v67
  v_mfma_f32_16x16x32_bf16 v[108:111], a[52:55], a[180:183], v[108:111]
  ds_read_b128 a[16:19], v3 offset:12288
  ds_read_b128 a[20:23], v3 offset:13312
  v_mfma_f32_16x16x32_bf16 v[108:111], a[56:59], a[184:187], v[108:111]
  v_cndmask_b32 v68, v68, v5, s[40:41]
  v_exp_f32 v68, v68
  v_mfma_f32_16x16x32_bf16 v[108:111], a[60:63], a[188:191], v[108:111]
  s_waitcnt lgkmcnt(2)
  v_cndmask_b32 v69, v69, v5, s[42:43]
  v_exp_f32 v69, v69
  v_mfma_f32_16x16x32_bf16 v[120:123], a[0:3], a[176:179], v[28:31]
  ds_read_b128 a[24:27], v3 offset:14336
  ds_read_b128 a[28:31], v3 offset:15360
  v_mfma_f32_16x16x32_bf16 v[120:123], a[4:7], a[180:183], v[120:123]
  v_cndmask_b32 v70, v70, v5, s[44:45]
  v_exp_f32 v70, v70
  v_mfma_f32_16x16x32_bf16 v[120:123], a[8:11], a[184:187], v[120:123]
  v_cndmask_b32 v71, v71, v5, s[46:47]
  v_exp_f32 v71, v71
  v_mfma_f32_16x16x32_bf16 v[120:123], a[12:15], a[188:191], v[120:123]
  s_waitcnt lgkmcnt(0)
  ds_read_b128 a[32:35], v4 offset:0
  ds_read_b128 a[36:39], v4 offset:1024
  v_mfma_f32_16x16x32_bf16 v[124:127], a[16:19], a[176:179], v[28:31]
  v_exp_f32 v72, v72
  v_mfma_f32_16x16x32_bf16 v[124:127], a[20:23], a[180:183], v[124:127]
  ds_read_b128 a[40:43], v4 offset:2048
  ds_read_b128 a[44:47], v4 offset:3072
  ds_read_b128 a[48:51], v4 offset:4096
  v_mfma_f32_16x16x32_bf16 v[124:127], a[24:27], a[184:187], v[124:127]
  ds_read_b128 a[52:55], v4 offset:5120
  ds_read_b128 a[56:59], v4 offset:6144
  ds_read_b128 a[60:63], v4 offset:7168
  v_exp_f32 v73, v73
  v_mfma_f32_16x16x32_bf16 v[124:127], a[28:31], a[188:191], v[124:127]
  s_waitcnt lgkmcnt(0)
  v_exp_f32 v74, v74
  v_mfma_f32_16x16x32_bf16 v[192:195], a[32:35], v[48:51], v[192:195]
  ds_read_b128 a[0:3], v4 offset:8192
  ds_read_b128 a[4:7], v4 offset:9216
  v_mfma_f32_16x16x32_bf16 v[224:227], a[32:35], v[52:55], v[224:227]
  v_exp_f32 v75, v75
  v_mfma_f32_16x16x32_bf16 a[200:203], a[208:211], v[48:51], a[200:203]
  v_exp_f32 v76, v76
  v_mfma_f32_16x16x32_bf16 v[196:199], a[36:39], v[48:51], v[196:199]
  ds_read_b128 a[8:11], v4 offset:10240
  ds_read_b128 a[12:15], v4 offset:11264
  v_mfma_f32_16x16x32_bf16 v[228:231], a[36:39], v[52:55], v[228:231]
  v_exp_f32 v77, v77
  v_mfma_f32_16x16x32_bf16 a[204:207], a[208:211], v[52:55], a[204:207]
  v_exp_f32 v78, v78
  v_mfma_f32_16x16x32_bf16 v[200:203], a[40:43], v[48:51], v[200:203]
  ds_read_b128 a[16:19], v4 offset:12288
  ds_read_b128 a[20:23], v4 offset:13312
  v_mfma_f32_16x16x32_bf16 v[232:235], a[40:43], v[52:55], v[232:235]
  v_exp_f32 v79, v79
  v_mfma_f32_16x16x32_bf16 v[204:207], a[44:47], v[48:51], v[204:207]
  ds_read_b128 a[24:27], v4 offset:14336
  v_cvt_pk_bf16_f32 v32, v64, v65
  v_mfma_f32_16x16x32_bf16 v[236:239], a[44:47], v[52:55], v[236:239]
  v_cndmask_b32 v80, v80, v5, s[48:49]
  v_exp_f32 v80, v80
  v_mfma_f32_16x16x32_bf16 v[208:211], a[48:51], v[48:51], v[208:211]
  v_cndmask_b32 v81, v81, v5, s[50:51]
  v_exp_f32 v81, v81
  v_mfma_f32_16x16x32_bf16 v[240:243], a[48:51], v[52:55], v[240:243]
  ds_read_b128 a[28:31], v4 offset:15360
  v_xor_b32 v4, 0x8000, v4
  v_cvt_pk_bf16_f32 v40, v80, v81
  v_mfma_f32_16x16x32_bf16 v[212:215], a[52:55], v[48:51], v[212:215]
  v_cndmask_b32 v82, v82, v5, s[52:53]
  v_exp_f32 v82, v82
  v_mfma_f32_16x16x32_bf16 v[244:247], a[52:55], v[52:55], v[244:247]
  v_cndmask_b32 v83, v83, v5, s[54:55]
  v_exp_f32 v83, v83
  v_mfma_f32_16x16x32_bf16 v[216:219], a[56:59], v[48:51], v[216:219]
  ds_read_b128 a[32:35], v4 offset:0
  ds_read_b128 a[36:39], v4 offset:1024
  v_cvt_pk_bf16_f32 v41, v82, v83
  v_mfma_f32_16x16x32_bf16 v[248:251], a[56:59], v[52:55], v[248:251]
  v_cndmask_b32 v84, v84, v5, s[56:57]
  v_exp_f32 v84, v84
  v_mfma_f32_16x16x32_bf16 v[220:223], a[60:63], v[48:51], v[220:223]
  v_cndmask_b32 v85, v85, v5, s[58:59]
  v_exp_f32 v85, v85
  v_mfma_f32_16x16x32_bf16 v[252:255], a[60:63], v[52:55], v[252:255]
  s_waitcnt lgkmcnt(2)
  ds_read_b128 a[40:43], v4 offset:2048
  v_cvt_pk_bf16_f32 v33, v66, v67
  v_cvt_pk_bf16_f32 v42, v84, v85
  v_mfma_f32_16x16x32_bf16 v[192:195], a[0:3], v[56:59], v[192:195]
  v_cndmask_b32 v86, v86, v5, s[60:61]
  v_exp_f32 v86, v86
  v_mfma_f32_16x16x32_bf16 v[224:227], a[0:3], v[60:63], v[224:227]
  v_cndmask_b32 v87, v87, v5, s[62:63]
  v_exp_f32 v87, v87
  v_mfma_f32_16x16x32_bf16 a[200:203], a[208:211], v[56:59], a[200:203]
  ds_read_b128 a[44:47], v4 offset:3072
  v_cvt_pk_bf16_f32 v34, v68, v69
  v_cvt_pk_bf16_f32 v43, v86, v87
  v_mfma_f32_16x16x32_bf16 v[196:199], a[4:7], v[56:59], v[196:199]
  v_exp_f32 v88, v88
  v_mfma_f32_16x16x32_bf16 v[228:231], a[4:7], v[60:63], v[228:231]
  ds_read_b128 a[48:51], v4 offset:4096
  v_cvt_pk_bf16_f32 v35, v70, v71
  v_mfma_f32_16x16x32_bf16 a[204:207], a[208:211], v[60:63], a[204:207]
  v_exp_f32 v89, v89
  v_mfma_f32_16x16x32_bf16 v[200:203], a[8:11], v[56:59], v[200:203]
  v_exp_f32 v90, v90
  v_cvt_pk_bf16_f32 v44, v88, v89
  v_mfma_f32_16x16x32_bf16 v[232:235], a[8:11], v[60:63], v[232:235]
  ds_read_b128 a[52:55], v4 offset:5120
  v_cvt_pk_bf16_f32 v36, v72, v73
  v_mfma_f32_16x16x32_bf16 v[204:207], a[12:15], v[56:59], v[204:207]
  v_exp_f32 v91, v91
  v_mfma_f32_16x16x32_bf16 v[236:239], a[12:15], v[60:63], v[236:239]
  v_exp_f32 v92, v92
  v_cvt_pk_bf16_f32 v45, v90, v91
  v_mfma_f32_16x16x32_bf16 v[208:211], a[16:19], v[56:59], v[208:211]
  ds_read_b128 a[56:59], v4 offset:6144
  ds_read_b128 a[60:63], v4 offset:7168
  v_mfma_f32_16x16x32_bf16 v[240:243], a[16:19], v[60:63], v[240:243]
  v_exp_f32 v93, v93
  v_mfma_f32_16x16x32_bf16 v[212:215], a[20:23], v[56:59], v[212:215]
  v_exp_f32 v94, v94
  v_cvt_pk_bf16_f32 v46, v92, v93
  v_mfma_f32_16x16x32_bf16 v[244:247], a[20:23], v[60:63], v[244:247]
  ds_read_b128 a[0:3], v4 offset:8192
  v_cvt_pk_bf16_f32 v37, v74, v75
  v_mfma_f32_16x16x32_bf16 v[216:219], a[24:27], v[56:59], v[216:219]
  v_exp_f32 v95, v95
  v_mfma_f32_16x16x32_bf16 v[248:251], a[24:27], v[60:63], v[248:251]
  ds_read_b128 a[4:7], v4 offset:9216
  v_cvt_pk_bf16_f32 v38, v76, v77
  v_cvt_pk_bf16_f32 v47, v94, v95
  v_mfma_f32_16x16x32_bf16 v[220:223], a[28:31], v[56:59], v[220:223]
  s_waitcnt vmcnt(0)
  s_barrier
  v_mfma_f32_16x16x32_bf16 v[252:255], a[28:31], v[60:63], v[252:255]
  ds_read_b128 a[8:11], v4 offset:10240
  v_cvt_pk_bf16_f32 v39, v78, v79
La_e1:
  s_mov_b32 s5, 0x40000
Lpoll_7:
  v_cmp_ne_u64 vcc, s[94:95], v[12:13]
  s_nop 0
  s_cbranch_vccz Lpolld_8
  s_sleep 4
  buffer_load_dwordx2 v[12:13], v14, s[96:99], s91 offen sc1
  s_sub_u32 s5, s5, 1
  s_waitcnt vmcnt(0)
  s_cbranch_scc0 Lpoll_7
Lpolld_8:
  v_accvgpr_read_b32 v10, a212
  v_accvgpr_read_b32 v11, a213
  v_accvgpr_read_b32 v12, a214
  v_accvgpr_read_b32 v13, a215
  s_mov_b32 s12, s80
  s_mov_b32 s13, s81
  s_mov_b32 s14, 2097152
  s_mov_b32 s15, 0x00020000
  s_lshl_b32 s93, s77, 20
  s_lshl_b32 s72, s76, 8
  s_add_u32 s93, s93, s72
  s_add_u32 s72, s73, s76
  s_and_b32 s31, s72, 3
  s_lshl_b32 s31, s31, 3
  s_or_b32 s31, s31, 0x80000
  s_bfe_u32 s30, 0x70702, s31
  s_add_u32 s30, s30, 0
  s_and_b32 s30, s30, 7
  s_lshl_b32 s72, s30, 17
  s_add_u32 s71, s93, s72
  s_add_u32 s8, s86, 83886080
  s_addc_u32 s9, s87, 0
  s_mov_b32 s10, 4194304
  s_mov_b32 s11, 0x00020000
  s_lshl_b32 s92, s73, 1
  s_add_u32 s92, s92, s77
  s_lshl_b32 s92, s92, 17
  s_add_u32 s92, s92, s79
  s_add_u32 s72, s73, s76
  s_and_b32 s1, s72, 3
  s_lshl_b32 s1, s1, 3
  s_or_b32 s1, s1, 0x80000
  s_bfe_u32 s0, 0x70702, s1
  s_add_u32 s0, s0, 0
  s_and_b32 s0, s0, 7
  s_lshl_b32 s72, s0, 14
  s_add_u32 s70, s92, s72
  s_waitcnt lgkmcnt(3)
  v_mfma_f32_16x16x32_bf16 v[192:195], a[32:35], v[32:35], v[192:195]
  s_add_u32 m0, s79, 147456
  ds_read_b128 a[12:15], v4 offset:11264
  v_cndmask_b32 v104, v104, v5, s[32:33]
  v_mfma_f32_16x16x32_bf16 v[224:227], a[32:35], v[36:39], v[224:227]
  v_exp_f32 v104, v104
  v_mfma_f32_16x16x32_bf16 a[200:203], a[208:211], v[32:35], a[200:203]
  v_cndmask_b32 v105, v105, v5, s[34:35]
  v_exp_f32 v105, v105
  v_mfma_f32_16x16x32_bf16 v[196:199], a[36:39], v[32:35], v[196:199]
  buffer_load_dwordx4 v10, s[12:15], s71 offen offset:0 lds
  ds_read_b128 a[16:19], v4 offset:12288
  v_mfma_f32_16x16x32_bf16 v[228:231], a[36:39], v[36:39], v[228:231]
  v_cndmask_b32 v106, v106, v5, s[36:37]
  v_exp_f32 v106, v106
  v_mfma_f32_16x16x32_bf16 a[204:207], a[208:211], v[36:39], a[204:207]
  buffer_load_dwordx4 v11, s[12:15], s71 offen offset:1024 lds
  v_cndmask_b32 v107, v107, v5, s[38:39]
  v_mfma_f32_16x16x32_bf16 v[200:203], a[40:43], v[32:35], v[200:203]
  v_exp_f32 v107, v107
  v_mfma_f32_16x16x32_bf16 v[232:235], a[40:43], v[36:39], v[232:235]
  ds_read_b128 a[20:23], v4 offset:13312
  v_cndmask_b32 v108, v108, v5, s[40:41]
  v_mfma_f32_16x16x32_bf16 v[204:207], a[44:47], v[32:35], v[204:207]
  v_exp_f32 v108, v108
  v_mfma_f32_16x16x32_bf16 v[236:239], a[44:47], v[36:39], v[236:239]
  buffer_load_dwordx4 v12, s[12:15], s71 offen offset:2048 lds
  ds_read_b128 a[24:27], v4 offset:14336
  v_mfma_f32_16x16x32_bf16 v[208:211], a[48:51], v[32:35], v[208:211]
  v_cndmask_b32 v109, v109, v5, s[42:43]
  v_exp_f32 v109, v109
  v_mfma_f32_16x16x32_bf16 v[240:243], a[48:51], v[36:39], v[240:243]
  ds_read_b128 a[28:31], v4 offset:15360
  v_xor_b32 v4, 0x4000, v4
  v_mfma_f32_16x16x32_bf16 v[212:215], a[52:55], v[32:35], v[212:215]
  v_cndmask_b32 v110, v110, v5, s[44:45]
  v_exp_f32 v110, v110
  v_mfma_f32_16x16x32_bf16 v[244:247], a[52:55], v[36:39], v[244:247]
  buffer_load_dwordx4 v13, s[12:15], s71 offen offset:3072 lds
  ds_read_b128 a[32:35], v4 offset:0
  v_mfma_f32_16x16x32_bf16 v[216:219], a[56:59], v[32:35], v[216:219]
  s_bfe_u32 s72, 0x3020106, s31
  v_cndmask_b32 v111, v111, v5, s[46:47]
  v_exp_f32 v111, v111
  v_mfma_f32_16x16x32_bf16 v[248:251], a[56:59], v[36:39], v[248:251]
  s_add_u32 s30, s30, s72
  s_add_u32 s31, s31, 8
  s_and_b32 s31, s31, 0x8001f
  v_mfma_f32_16x16x32_bf16 v[220:223], a[60:63], v[32:35], v[220:223]
  s_and_b32 s30, s30, 7
  s_lshl_b32 s72, s30, 17
  s_add_u32 s71, s93, s72
  v_mfma_f32_16x16x32_bf16 v[252:255], a[60:63], v[36:39], v[252:255]
  s_waitcnt lgkmcnt(1)
  v_cndmask_b32 v120, v120, v5, s[48:49]
  v_exp_f32 v120, v120
  v_mfma_f32_16x16x32_bf16 v[192:195], a[0:3], v[40:43], v[192:195]
  s_add_u32 m0, s79, 131072
  ds_read_b128 a[36:39], v4 offset:1024
  ds_read_b128 a[40:43], v4 offset:2048
  v_mfma_f32_16x16x32_bf16 v[224:227], a[0:3], v[44:47], v[224:227]
  v_cndmask_b32 v121, v121, v5, s[50:51]
  v_exp_f32 v121, v121
  v_mfma_f32_16x16x32_bf16 a[200:203], a[208:211], v[40:43], a[200:203]
  buffer_load_dwordx4 v2, s[8:11], s70 offen offset:0 sc1 lds
  ds_read_b128 a[44:47], v4 offset:3072
  v_mfma_f32_16x16x32_bf16 v[196:199], a[4:7], v[40:43], v[196:199]
  v_cndmask_b32 v122, v122, v5, s[52:53]
  v_exp_f32 v122, v122
  v_mfma_f32_16x16x32_bf16 v[228:231], a[4:7], v[44:47], v[228:231]
  buffer_load_dwordx4 v2, s[8:11], s70 offen offset:1024 sc1 lds
  ds_read_b128 a[48:51], v4 offset:4096
  v_mfma_f32_16x16x32_bf16 a[204:207], a[208:211], v[44:47], a[204:207]
  v_cndmask_b32 v123, v123, v5, s[54:55]
  v_exp_f32 v123, v123
  v_mfma_f32_16x16x32_bf16 v[200:203], a[8:11], v[40:43], v[200:203]
  buffer_load_dwordx4 v2, s[8:11], s70 offen offset:2048 sc1 lds
  ds_read_b128 a[52:55], v4 offset:5120
  v_cvt_pk_bf16_f32 v61, v122, v123
  v_mfma_f32_16x16x32_bf16 v[232:235], a[8:11], v[44:47], v[232:235]
  v_cndmask_b32 v124, v124, v5, s[56:57]
  v_exp_f32 v124, v124
  v_mfma_f32_16x16x32_bf16 v[204:207], a[12:15], v[40:43], v[204:207]
  ds_read_b128 a[56:59], v4 offset:6144
  v_cvt_pk_bf16_f32 v52, v104, v105
  v_mfma_f32_16x16x32_bf16 v[236:239], a[12:15], v[44:47], v[236:239]
  v_cndmask_b32 v125, v125, v5, s[58:59]
  v_exp_f32 v125, v125
  v_mfma_f32_16x16x32_bf16 v[208:211], a[16:19], v[40:43], v[208:211]
  buffer_load_dwordx4 v2, s[8:11], s70 offen offset:3072 sc1 lds
  ds_read_b128 a[60:63], v4 offset:7168
  v_cvt_pk_bf16_f32 v62, v124, v125
  v_mfma_f32_16x16x32_bf16 v[240:243], a[16:19], v[44:47], v[240:243]
  s_bfe_u32 s72, 0x3020106, s1
  v_cndmask_b32 v126, v126, v5, s[60:61]
  v_exp_f32 v126, v126
  v_mfma_f32_16x16x32_bf16 v[212:215], a[20:23], v[40:43], v[212:215]
  s_add_u32 s0, s0, s72
  s_add_u32 s1, s1, 8
  s_and_b32 s1, s1, 0x8001f
  v_mfma_f32_16x16x32_bf16 v[244:247], a[20:23], v[44:47], v[244:247]
  s_and_b32 s0, s0, 7
  v_cndmask_b32 v127, v127, v5, s[62:63]
  v_exp_f32 v127, v127
  v_mfma_f32_16x16x32_bf16 v[216:219], a[24:27], v[40:43], v[216:219]
  s_lshl_b32 s72, s0, 14
  s_add_u32 s70, s92, s72
  ds_read_b128 a[0:3], v4 offset:8192
  v_cvt_pk_bf16_f32 v63, v126, v127
  v_mfma_f32_16x16x32_bf16 v[248:251], a[24:27], v[44:47], v[248:251]
  ds_read_b128 a[4:7], v4 offset:9216
  v_cvt_pk_bf16_f32 v53, v106, v107
  v_mfma_f32_16x16x32_bf16 v[220:223], a[28:31], v[40:43], v[220:223]
  ds_read_b128 a[8:11], v4 offset:10240
  v_cvt_pk_bf16_f32 v54, v108, v109
  v_mfma_f32_16x16x32_bf16 v[252:255], a[28:31], v[44:47], v[252:255]
  v_cvt_pk_bf16_f32 v55, v110, v111
  v_cvt_pk_bf16_f32 v60, v120, v121
  s_waitcnt lgkmcnt(7)
  v_mfma_f32_16x16x32_bf16 v[224:227], a[32:35], v[52:55], v[224:227]
  s_add_u32 m0, s79, 49152
  ds_read_b128 a[12:15], v4 offset:11264
  v_mfma_f32_16x16x32_bf16 a[204:207], a[208:211], v[52:55], a[204:207]
  buffer_load_dwordx4 v10, s[12:15], s71 offen offset:0 lds
  v_mfma_f32_16x16x32_bf16 v[228:231], a[36:39], v[52:55], v[228:231]
  buffer_load_dwordx4 v11, s[12:15], s71 offen offset:1024 lds
  ds_read_b128 a[16:19], v4 offset:12288
  v_mfma_f32_16x16x32_bf16 v[232:235], a[40:43], v[52:55], v[232:235]
  buffer_load_dwordx4 v12, s[12:15], s71 offen offset:2048 lds
  ds_read_b128 a[20:23], v4 offset:13312
  v_mfma_f32_16x16x32_bf16 v[236:239], a[44:47], v[52:55], v[236:239]
  s_waitcnt lgkmcnt(6)
  ds_read_b128 a[24:27], v4 offset:14336
  v_mfma_f32_16x16x32_bf16 v[240:243], a[48:51], v[52:55], v[240:243]
  buffer_load_dwordx4 v13, s[12:15], s71 offen offset:3072 lds
  ds_read_b128 a[28:31], v4 offset:15360
  v_mfma_f32_16x16x32_bf16 v[244:247], a[52:55], v[52:55], v[244:247]
  s_bfe_u32 s72, 0x3020106, s31
  s_add_u32 s30, s30, s72
  s_add_u32 s31, s31, 8
  v_mfma_f32_16x16x32_bf16 v[248:251], a[56:59], v[52:55], v[248:251]
  s_and_b32 s31, s31, 0x8001f
  s_and_b32 s30, s30, 7
  s_lshl_b32 s72, s30, 17
  v_mfma_f32_16x16x32_bf16 v[252:255], a[60:63], v[52:55], v[252:255]
  s_waitcnt lgkmcnt(4)
  s_add_u32 s71, s93, s72
  s_add_u32 m0, s79, 32768
  v_mfma_f32_16x16x32_bf16 v[224:227], a[0:3], v[60:63], v[224:227]
  buffer_load_dwordx4 v2, s[8:11], s70 offen offset:0 sc1 lds
  v_mfma_f32_16x16x32_bf16 a[204:207], a[208:211], v[60:63], a[204:207]
  buffer_load_dwordx4 v2, s[8:11], s70 offen offset:1024 sc1 lds
  v_mfma_f32_16x16x32_bf16 v[228:231], a[4:7], v[60:63], v[228:231]
  buffer_load_dwordx4 v2, s[8:11], s70 offen offset:2048 sc1 lds
  v_mfma_f32_16x16x32_bf16 v[232:235], a[8:11], v[60:63], v[232:235]
  buffer_load_dwordx4 v2, s[8:11], s70 offen offset:3072 sc1 lds
  v_mfma_f32_16x16x32_bf16 v[236:239], a[12:15], v[60:63], v[236:239]
  s_waitcnt lgkmcnt(0)
  s_bfe_u32 s72, 0x3020106, s1
  s_add_u32 s0, s0, s72
  v_mfma_f32_16x16x32_bf16 v[240:243], a[16:19], v[60:63], v[240:243]
  s_add_u32 s1, s1, 8
  s_and_b32 s1, s1, 0x8001f
  s_and_b32 s0, s0, 7
  v_mfma_f32_16x16x32_bf16 v[244:247], a[20:23], v[60:63], v[244:247]
  s_lshl_b32 s72, s0, 14
  s_add_u32 s70, s92, s72
  v_mfma_f32_16x16x32_bf16 v[248:251], a[24:27], v[60:63], v[248:251]
  v_mfma_f32_16x16x32_bf16 v[252:255], a[28:31], v[60:63], v[252:255]
  s_and_b32 s88, s25, 1
  s_lshl_b32 s88, s88, 1
  s_add_u32 s88, s88, 14
  s_sub_u32 s88, s88, s25
  s_lshl_b32 s4, s88, 20
  s_lshl_b32 s5, s24, 15
  s_add_u32 s4, s4, s5
  s_lshl_b32 s5, s3, 11
  s_add_u32 s4, s4, s5
  v_accvgpr_read_b32 v6, a200
  v_accvgpr_read_b32 v8, a204
  s_mov_b32 s5, 0x5f800000
  v_cmp_ngt_f32 vcc, s5, v6
  v_rcp_f32 v6, v6
  s_or_b32 s89, s89, vcc_lo
  s_or_b32 s89, s89, vcc_hi
  v_mov_b32 v7, v6
  v_cmp_ngt_f32 vcc, s5, v8
  v_rcp_f32 v8, v8
  s_or_b32 s89, s89, vcc_lo
  s_or_b32 s89, s89, vcc_hi
  v_mov_b32 v9, v8
  v_pk_mul_f32 v[192:193], v[192:193], v[6:7]
  v_pk_mul_f32 v[194:195], v[194:195], v[6:7]
  v_pk_mul_f32 v[196:197], v[196:197], v[6:7]
  v_pk_mul_f32 v[198:199], v[198:199], v[6:7]
  v_cvt_pk_bf16_f32 v192, v192, v193
  v_cvt_pk_bf16_f32 v193, v194, v195
  v_cvt_pk_bf16_f32 v194, v196, v197
  v_cvt_pk_bf16_f32 v195, v198, v199
  buffer_store_dwordx4 v[192:195], v2, s[16:19], s4 offen offset:0 sc1
  v_pk_mul_f32 v[224:225], v[224:225], v[8:9]
  v_pk_mul_f32 v[226:227], v[226:227], v[8:9]
  v_pk_mul_f32 v[228:229], v[228:229], v[8:9]
  v_pk_mul_f32 v[230:231], v[230:231], v[8:9]
  v_cvt_pk_bf16_f32 v224, v224, v225
  v_cvt_pk_bf16_f32 v225, v226, v227
  v_cvt_pk_bf16_f32 v226, v228, v229
  v_cvt_pk_bf16_f32 v227, v230, v231
  buffer_store_dwordx4 v[224:227], v2, s[16:19], s4 offen offset:1024 sc1
  s_add_u32 s4, s4, 8192
  v_pk_mul_f32 v[200:201], v[200:201], v[6:7]
  v_pk_mul_f32 v[202:203], v[202:203], v[6:7]
  v_pk_mul_f32 v[204:205], v[204:205], v[6:7]
  v_pk_mul_f32 v[206:207], v[206:207], v[6:7]
  v_cvt_pk_bf16_f32 v200, v200, v201
  v_cvt_pk_bf16_f32 v201, v202, v203
  v_cvt_pk_bf16_f32 v202, v204, v205
  v_cvt_pk_bf16_f32 v203, v206, v207
  buffer_store_dwordx4 v[200:203], v2, s[16:19], s4 offen offset:0 sc1
  v_pk_mul_f32 v[232:233], v[232:233], v[8:9]
  v_pk_mul_f32 v[234:235], v[234:235], v[8:9]
  v_pk_mul_f32 v[236:237], v[236:237], v[8:9]
  v_pk_mul_f32 v[238:239], v[238:239], v[8:9]
  v_cvt_pk_bf16_f32 v232, v232, v233
  v_cvt_pk_bf16_f32 v233, v234, v235
  v_cvt_pk_bf16_f32 v234, v236, v237
  v_cvt_pk_bf16_f32 v235, v238, v239
  buffer_store_dwordx4 v[232:235], v2, s[16:19], s4 offen offset:1024 sc1
  s_add_u32 s4, s4, 8192
  v_pk_mul_f32 v[208:209], v[208:209], v[6:7]
  v_pk_mul_f32 v[210:211], v[210:211], v[6:7]
  v_pk_mul_f32 v[212:213], v[212:213], v[6:7]
  v_pk_mul_f32 v[214:215], v[214:215], v[6:7]
  v_cvt_pk_bf16_f32 v208, v208, v209
  v_cvt_pk_bf16_f32 v209, v210, v211
  v_cvt_pk_bf16_f32 v210, v212, v213
  v_cvt_pk_bf16_f32 v211, v214, v215
  buffer_store_dwordx4 v[208:211], v2, s[16:19], s4 offen offset:0 sc1
  v_pk_mul_f32 v[240:241], v[240:241], v[8:9]
  v_pk_mul_f32 v[242:243], v[242:243], v[8:9]
  v_pk_mul_f32 v[244:245], v[244:245], v[8:9]
  v_pk_mul_f32 v[246:247], v[246:247], v[8:9]
  v_cvt_pk_bf16_f32 v240, v240, v241
  v_cvt_pk_bf16_f32 v241, v242, v243
  v_cvt_pk_bf16_f32 v242, v244, v245
  v_cvt_pk_bf16_f32 v243, v246, v247
  buffer_store_dwordx4 v[240:243], v2, s[16:19], s4 offen offset:1024 sc1
  s_add_u32 s4, s4, 8192
  v_pk_mul_f32 v[216:217], v[216:217], v[6:7]
  v_pk_mul_f32 v[218:219], v[218:219], v[6:7]
  v_pk_mul_f32 v[220:221], v[220:221], v[6:7]
  v_pk_mul_f32 v[222:223], v[222:223], v[6:7]
  v_cvt_pk_bf16_f32 v216, v216, v217
  v_cvt_pk_bf16_f32 v217, v218, v219
  v_cvt_pk_bf16_f32 v218, v220, v221
  v_cvt_pk_bf16_f32 v219, v222, v223
  buffer_store_dwordx4 v[216:219], v2, s[16:19], s4 offen offset:0 sc1
  v_pk_mul_f32 v[248:249], v[248:249], v[8:9]
  v_pk_mul_f32 v[250:251], v[250:251], v[8:9]
  v_pk_mul_f32 v[252:253], v[252:253], v[8:9]
  v_pk_mul_f32 v[254:255], v[254:255], v[8:9]
  v_cvt_pk_bf16_f32 v248, v248, v249
  v_cvt_pk_bf16_f32 v249, v250, v251
  v_cvt_pk_bf16_f32 v250, v252, v253
  v_cvt_pk_bf16_f32 v251, v254, v255
  buffer_store_dwordx4 v[248:251], v2, s[16:19], s4 offen offset:1024 sc1
  s_cmp_eq_u32 s89, 0
  s_cbranch_scc1 La_done
  s_waitcnt vmcnt(0)
  s_and_b32 s6, s25, 1
  s_lshl_b32 s6, s6, 1
  s_add_u32 s6, s6, 14
  s_sub_u32 s6, s6, s25
La_sl_blk:
  v_mov_b32 v192, 0
  v_mov_b32 v193, 0
  v_mov_b32 v194, 0
  v_mov_b32 v195, 0
  v_mov_b32 v196, 0
  v_mov_b32 v197, 0
  v_mov_b32 v198, 0
  v_mov_b32 v199, 0
  v_mov_b32 v200, 0
  v_mov_b32 v201, 0
  v_mov_b32 v202, 0
  v_mov_b32 v203, 0
  v_mov_b32 v204, 0
  v_mov_b32 v205, 0
  v_mov_b32 v206, 0
  v_mov_b32 v207, 0
  v_mov_b32 v208, 0
  v_mov_b32 v209, 0
  v_mov_b32 v210, 0
  v_mov_b32 v211, 0
  v_mov_b32 v212, 0
  v_mov_b32 v213, 0
  v_mov_b32 v214, 0
  v_mov_b32 v215, 0
  v_mov_b32 v216, 0
  v_mov_b32 v217, 0
  v_mov_b32 v218, 0
  v_mov_b32 v219, 0
  v_mov_b32 v220, 0
  v_mov_b32 v221, 0
  v_mov_b32 v222, 0
  v_mov_b32 v223, 0
  v_mov_b32 v224, 0
  v_mov_b32 v225, 0
  v_mov_b32 v226, 0
  v_mov_b32 v227, 0
  v_mov_b32 v228, 0
  v_mov_b32 v229, 0
  v_mov_b32 v230, 0
  v_mov_b32 v231, 0
  v_mov_b32 v232, 0
  v_mov_b32 v233, 0
  v_mov_b32 v234, 0
  v_mov_b32 v235, 0
  v_mov_b32 v236, 0
  v_mov_b32 v237, 0
  v_mov_b32 v238, 0
  v_mov_b32 v239, 0
  v_mov_b32 v240, 0
  v_mov_b32 v241, 0
  v_mov_b32 v242, 0
  v_mov_b32 v243, 0
  v_mov_b32 v244, 0
  v_mov_b32 v245, 0
  v_mov_b32 v246, 0
  v_mov_b32 v247, 0
  v_mov_b32 v248, 0
  v_mov_b32 v249, 0
  v_mov_b32 v250, 0
  v_mov_b32 v251, 0
  v_mov_b32 v252, 0
  v_mov_b32 v253, 0
  v_mov_b32 v254, 0
  v_mov_b32 v255, 0
  v_mov_b32 v24, 0
  v_mov_b32 v25, 0
  v_mov_b32 v26, 0
  v_mov_b32 v27, 0
  v_mov_b32 v28, 0
  v_mov_b32 v29, 0
  v_mov_b32 v30, 0
  v_mov_b32 v31, 0
  v_mov_b32 v16, v5
  v_mov_b32 v17, v5
  v_and_b32 v20, 15, v1
  v_lshrrev_b32 v21, 4, v1
  v_sub_u32 v20, v20, v21
  v_lshlrev_b32 v20, 2, v20
  s_lshl_b32 s4, s6, 7
  s_add_u32 s4, s4, s3
  v_add_u32 v20, s4, v20
  v_add_u32 v21, 64, v20
  s_add_u32 s7, s6, 1
  s_lshl_b32 s7, s7, 2
  s_mov_b32 s90, 0
La_sl_loop:
  s_add_u32 s4, s90, 0
  buffer_load_dwordx4 a[0:3], v2, s[20:23], s4 offen offset:0 sc1
  buffer_load_dwordx4 a[4:7], v2, s[20:23], s4 offen offset:1024 sc1
  buffer_load_dwordx4 a[8:11], v2, s[20:23], s4 offen offset:2048 sc1
  buffer_load_dwordx4 a[12:15], v2, s[20:23], s4 offen offset:3072 sc1
  s_add_u32 s4, s90, 4096
  buffer_load_dwordx4 a[16:19], v2, s[20:23], s4 offen offset:0 sc1
  buffer_load_dwordx4 a[20:23], v2, s[20:23], s4 offen offset:1024 sc1
  buffer_load_dwordx4 a[24:27], v2, s[20:23], s4 offen offset:2048 sc1
  buffer_load_dwordx4 a[28:31], v2, s[20:23], s4 offen offset:3072 sc1
  s_add_u32 s4, s90, 16384
  buffer_load_dwordx4 a[32:35], v2, s[20:23], s4 offen offset:0 sc1
  buffer_load_dwordx4 a[36:39], v2, s[20:23], s4 offen offset:1024 sc1
  buffer_load_dwordx4 a[40:43], v2, s[20:23], s4 offen offset:2048 sc1
  buffer_load_dwordx4 a[44:47], v2, s[20:23], s4 offen offset:3072 sc1
  s_add_u32 s4, s90, 20480
  buffer_load_dwordx4 a[48:51], v2, s[20:23], s4 offen offset:0 sc1
  buffer_load_dwordx4 a[52:55], v2, s[20:23], s4 offen offset:1024 sc1
  buffer_load_dwordx4 a[56:59], v2, s[20:23], s4 offen offset:2048 sc1
  buffer_load_dwordx4 a[60:63], v2, s[20:23], s4 offen offset:3072 sc1
  s_waitcnt vmcnt(0)
  v_mfma_f32_16x16x32_bf16 v[64:67], a[0:3], a[160:163], 0
  v_mfma_f32_16x16x32_bf16 v[72:75], a[0:3], a[176:179], 0
  v_mfma_f32_16x16x32_bf16 v[64:67], a[4:7], a[164:167], v[64:67]
  v_mfma_f32_16x16x32_bf16 v[72:75], a[4:7], a[180:183], v[72:75]
  v_mfma_f32_16x16x32_bf16 v[64:67], a[8:11], a[168:171], v[64:67]
  v_mfma_f32_16x16x32_bf16 v[72:75], a[8:11], a[184:187], v[72:75]
  v_mfma_f32_16x16x32_bf16 v[64:67], a[12:15], a[172:175], v[64:67]
  v_mfma_f32_16x16x32_bf16 v[72:75], a[12:15], a[188:191], v[72:75]
  v_mfma_f32_16x16x32_bf16 v[68:71], a[16:19], a[160:163], 0
  v_mfma_f32_16x16x32_bf16 v[76:79], a[16:19], a[176:179], 0
  v_mfma_f32_16x16x32_bf16 v[68:71], a[20:23], a[164:167], v[68:71]
  v_mfma_f32_16x16x32_bf16 v[76:79], a[20:23], a[180:183], v[76:79]
  v_mfma_f32_16x16x32_bf16 v[68:71], a[24:27], a[168:171], v[68:71]
  v_mfma_f32_16x16x32_bf16 v[76:79], a[24:27], a[184:187], v[76:79]
  v_mfma_f32_16x16x32_bf16 v[68:71], a[28:31], a[172:175], v[68:71]
  v_mfma_f32_16x16x32_bf16 v[76:79], a[28:31], a[188:191], v[76:79]
  v_cmp_gt_i32 vcc, 0, v20
  s_nop 1
  v_cndmask_b32 v64, v64, v5, vcc
  v_cmp_gt_i32 vcc, 1, v20
  s_nop 1
  v_cndmask_b32 v65, v65, v5, vcc
  v_cmp_gt_i32 vcc, 2, v20
  s_nop 1
  v_cndmask_b32 v66, v66, v5, vcc
  v_cmp_gt_i32 vcc, 3, v20
  s_nop 1
  v_cndmask_b32 v67, v67, v5, vcc
  v_cmp_gt_i32 vcc, 16, v20
  s_nop 1
  v_cndmask_b32 v68, v68, v5, vcc
  v_cmp_gt_i32 vcc, 17, v20
  s_nop 1
  v_cndmask_b32 v69, v69, v5, vcc
  v_cmp_gt_i32 vcc, 18, v20
  s_nop 1
  v_cndmask_b32 v70, v70, v5, vcc
  v_cmp_gt_i32 vcc, 19, v20
  s_nop 1
  v_cndmask_b32 v71, v71, v5, vcc
  v_subrev_u32 v20, 32, v20
  v_max3_f32 v6, v64, v65, v66
  v_max3_f32 v7, v67, v68, v69
  v_max3_f32 v6, v6, v70, v71
  v_max_f32 v6, v6, v7
  v_cmp_gt_i32 vcc, 0, v21
  s_nop 1
  v_cndmask_b32 v72, v72, v5, vcc
  v_cmp_gt_i32 vcc, 1, v21
  s_nop 1
  v_cndmask_b32 v73, v73, v5, vcc
  v_cmp_gt_i32 vcc, 2, v21
  s_nop 1
  v_cndmask_b32 v74, v74, v5, vcc
  v_cmp_gt_i32 vcc, 3, v21
  s_nop 1
  v_cndmask_b32 v75, v75, v5, vcc
  v_cmp_gt_i32 vcc, 16, v21
  s_nop 1
  v_cndmask_b32 v76, v76, v5, vcc
  v_cmp_gt_i32 vcc, 17, v21
  s_nop 1
  v_cndmask_b32 v77, v77, v5, vcc
  v_cmp_gt_i32 vcc, 18, v21
  s_nop 1
  v_cndmask_b32 v78, v78, v5, vcc
  v_cmp_gt_i32 vcc, 19, v21
  s_nop 1
  v_cndmask_b32 v79, v79, v5, vcc
  v_subrev_u32 v21, 32, v21
  v_max3_f32 v8, v72, v73, v74
  v_max3_f32 v9, v75, v76, v77
  v_max3_f32 v8, v8, v78, v79
  v_max_f32 v8, v8, v9
  v_mov_b32 v7, v6
  v_mov_b32 v9, v8
  s_nop 0
  v_permlane32_swap_b32 v6, v7
  v_permlane32_swap_b32 v8, v9
  v_max_f32 v6, v6, v7
  v_max_f32 v8, v8, v9
  v_mov_b32 v7, v6
  v_mov_b32 v9, v8
  s_nop 0
  v_permlane16_swap_b32 v6, v7
  v_permlane16_swap_b32 v8, v9
  v_max_f32 v6, v6, v7
  v_max_f32 v8, v8, v9
  v_max_f32 v6, v6, v16
  v_sub_f32 v7, v16, v6
  v_exp_f32 v7, v7
  v_mov_b32 v16, v6
  v_sub_f32 v64, v64, v16
  v_sub_f32 v65, v65, v16
  v_sub_f32 v66, v66, v16
  v_sub_f32 v67, v67, v16
  v_sub_f32 v68, v68, v16
  v_sub_f32 v69, v69, v16
  v_sub_f32 v70, v70, v16
  v_sub_f32 v71, v71, v16
  v_exp_f32 v64, v64
  v_exp_f32 v65, v65
  v_exp_f32 v66, v66
  v_exp_f32 v67, v67
  v_exp_f32 v68, v68
  v_exp_f32 v69, v69
  v_exp_f32 v70, v70
  v_exp_f32 v71, v71
  v_mul_f32 v24, v24, v7
  v_mul_f32 v25, v25, v7
  v_mul_f32 v26, v26, v7
  v_mul_f32 v27, v27, v7
  v_mul_f32 v192, v192, v7
  v_mul_f32 v193, v193, v7
  v_mul_f32 v194, v194, v7
  v_mul_f32 v195, v195, v7
  v_mul_f32 v196, v196, v7
  v_mul_f32 v197, v197, v7
  v_mul_f32 v198, v198, v7
  v_mul_f32 v199, v199, v7
  v_mul_f32 v200, v200, v7
  v_mul_f32 v201, v201, v7
  v_mul_f32 v202, v202, v7
  v_mul_f32 v203, v203, v7
  v_mul_f32 v204, v204, v7
  v_mul_f32 v205, v205, v7
  v_mul_f32 v206, v206, v7
  v_mul_f32 v207, v207, v7
  v_mul_f32 v208, v208, v7
  v_mul_f32 v209, v209, v7
  v_mul_f32 v210, v210, v7
  v_mul_f32 v211, v211, v7
  v_mul_f32 v212, v212, v7
  v_mul_f32 v213, v213, v7
  v_mul_f32 v214, v214, v7
  v_mul_f32 v215, v215, v7
  v_mul_f32 v216, v216, v7
  v_mul_f32 v217, v217, v7
  v_mul_f32 v218, v218, v7
  v_mul_f32 v219, v219, v7
  v_mul_f32 v220, v220, v7
  v_mul_f32 v221, v221, v7
  v_mul_f32 v222, v222, v7
  v_mul_f32 v223, v223, v7
  v_cvt_pk_bf16_f32 v32, v64, v65
  v_cvt_pk_bf16_f32 v33, v66, v67
  v_cvt_pk_bf16_f32 v34, v68, v69
  v_cvt_pk_bf16_f32 v35, v70, v71
  v_max_f32 v8, v8, v17
  v_sub_f32 v9, v17, v8
  v_exp_f32 v9, v9
  v_mov_b32 v17, v8
  v_sub_f32 v72, v72, v17
  v_sub_f32 v73, v73, v17
  v_sub_f32 v74, v74, v17
  v_sub_f32 v75, v75, v17
  v_sub_f32 v76, v76, v17
  v_sub_f32 v77, v77, v17
  v_sub_f32 v78, v78, v17
  v_sub_f32 v79, v79, v17
  v_exp_f32 v72, v72
  v_exp_f32 v73, v73
  v_exp_f32 v74, v74
  v_exp_f32 v75, v75
  v_exp_f32 v76, v76
  v_exp_f32 v77, v77
  v_exp_f32 v78, v78
  v_exp_f32 v79, v79
  v_mul_f32 v28, v28, v9
  v_mul_f32 v29, v29, v9
  v_mul_f32 v30, v30, v9
  v_mul_f32 v31, v31, v9
  v_mul_f32 v224, v224, v9
  v_mul_f32 v225, v225, v9
  v_mul_f32 v226, v226, v9
  v_mul_f32 v227, v227, v9
  v_mul_f32 v228, v228, v9
  v_mul_f32 v229, v229, v9
  v_mul_f32 v230, v230, v9
  v_mul_f32 v231, v231, v9
  v_mul_f32 v232, v232, v9
  v_mul_f32 v233, v233, v9
  v_mul_f32 v234, v234, v9
  v_mul_f32 v235, v235, v9
  v_mul_f32 v236, v236, v9
  v_mul_f32 v237, v237, v9
  v_mul_f32 v238, v238, v9
  v_mul_f32 v239, v239, v9
  v_mul_f32 v240, v240, v9
  v_mul_f32 v241, v241, v9
  v_mul_f32 v242, v242, v9
  v_mul_f32 v243, v243, v9
  v_mul_f32 v244, v244, v9
  v_mul_f32 v245, v245, v9
  v_mul_f32 v246, v246, v9
  v_mul_f32 v247, v247, v9
  v_mul_f32 v248, v248, v9
  v_mul_f32 v249, v249, v9
  v_mul_f32 v250, v250, v9
  v_mul_f32 v251, v251, v9
  v_mul_f32 v252, v252, v9
  v_mul_f32 v253, v253, v9
  v_mul_f32 v254, v254, v9
  v_mul_f32 v255, v255, v9
  v_cvt_pk_bf16_f32 v36, v72, v73
  v_cvt_pk_bf16_f32 v37, v74, v75
  v_cvt_pk_bf16_f32 v38, v76, v77
  v_cvt_pk_bf16_f32 v39, v78, v79
  v_mfma_f32_16x16x32_bf16 v[24:27], a[208:211], v[32:35], v[24:27]
  v_mfma_f32_16x16x32_bf16 v[192:195], a[32:35], v[32:35], v[192:195]
  v_mfma_f32_16x16x32_bf16 v[196:199], a[36:39], v[32:35], v[196:199]
  v_mfma_f32_16x16x32_bf16 v[200:203], a[40:43], v[32:35], v[200:203]
  v_mfma_f32_16x16x32_bf16 v[204:207], a[44:47], v[32:35], v[204:207]
  v_mfma_f32_16x16x32_bf16 v[208:211], a[48:51], v[32:35], v[208:211]
  v_mfma_f32_16x16x32_bf16 v[212:215], a[52:55], v[32:35], v[212:215]
  v_mfma_f32_16x16x32_bf16 v[216:219], a[56:59], v[32:35], v[216:219]
  v_mfma_f32_16x16x32_bf16 v[220:223], a[60:63], v[32:35], v[220:223]
  v_mfma_f32_16x16x32_bf16 v[28:31], a[208:211], v[36:39], v[28:31]
  v_mfma_f32_16x16x32_bf16 v[224:227], a[32:35], v[36:39], v[224:227]
  v_mfma_f32_16x16x32_bf16 v[228:231], a[36:39], v[36:39], v[228:231]
  v_mfma_f32_16x16x32_bf16 v[232:235], a[40:43], v[36:39], v[232:235]
  v_mfma_f32_16x16x32_bf16 v[236:239], a[44:47], v[36:39], v[236:239]
  v_mfma_f32_16x16x32_bf16 v[240:243], a[48:51], v[36:39], v[240:243]
  v_mfma_f32_16x16x32_bf16 v[244:247], a[52:55], v[36:39], v[244:247]
  v_mfma_f32_16x16x32_bf16 v[248:251], a[56:59], v[36:39], v[248:251]
  v_mfma_f32_16x16x32_bf16 v[252:255], a[60:63], v[36:39], v[252:255]
  s_add_u32 s90, s90, 8192
  s_and_b32 s4, s90, 0x4000
  s_add_u32 s90, s90, s4
  s_sub_u32 s7, s7, 1
  s_cmp_lg_u32 s7, 0
  s_cbranch_scc1 La_sl_loop
  s_lshl_b32 s4, s6, 20
  s_lshl_b32 s5, s24, 15
  s_add_u32 s4, s4, s5
  s_lshl_b32 s5, s3, 11
  s_add_u32 s4, s4, s5
  v_rcp_f32 v6, v24
  s_nop 0
  v_mov_b32 v7, v6
  v_rcp_f32 v8, v28
  s_nop 0
  v_mov_b32 v9, v8
  v_pk_mul_f32 v[192:193], v[192:193], v[6:7]
  v_pk_mul_f32 v[194:195], v[194:195], v[6:7]
  v_pk_mul_f32 v[196:197], v[196:197], v[6:7]
  v_pk_mul_f32 v[198:199], v[198:199], v[6:7]
  v_cvt_pk_bf16_f32 v192, v192, v193
  v_cvt_pk_bf16_f32 v193, v194, v195
  v_cvt_pk_bf16_f32 v194, v196, v197
  v_cvt_pk_bf16_f32 v195, v198, v199
  buffer_store_dwordx4 v[192:195], v2, s[16:19], s4 offen offset:0 sc1
  v_pk_mul_f32 v[224:225], v[224:225], v[8:9]
  v_pk_mul_f32 v[226:227], v[226:227], v[8:9]
  v_pk_mul_f32 v[228:229], v[228:229], v[8:9]
  v_pk_mul_f32 v[230:231], v[230:231], v[8:9]
  v_cvt_pk_bf16_f32 v224, v224, v225
  v_cvt_pk_bf16_f32 v225, v226, v227
  v_cvt_pk_bf16_f32 v226, v228, v229
  v_cvt_pk_bf16_f32 v227, v230, v231
  buffer_store_dwordx4 v[224:227], v2, s[16:19], s4 offen offset:1024 sc1
  s_add_u32 s4, s4, 8192
  v_pk_mul_f32 v[200:201], v[200:201], v[6:7]
  v_pk_mul_f32 v[202:203], v[202:203], v[6:7]
  v_pk_mul_f32 v[204:205], v[204:205], v[6:7]
  v_pk_mul_f32 v[206:207], v[206:207], v[6:7]
  v_cvt_pk_bf16_f32 v200, v200, v201
  v_cvt_pk_bf16_f32 v201, v202, v203
  v_cvt_pk_bf16_f32 v202, v204, v205
  v_cvt_pk_bf16_f32 v203, v206, v207
  buffer_store_dwordx4 v[200:203], v2, s[16:19], s4 offen offset:0 sc1
  v_pk_mul_f32 v[232:233], v[232:233], v[8:9]
  v_pk_mul_f32 v[234:235], v[234:235], v[8:9]
  v_pk_mul_f32 v[236:237], v[236:237], v[8:9]
  v_pk_mul_f32 v[238:239], v[238:239], v[8:9]
  v_cvt_pk_bf16_f32 v232, v232, v233
  v_cvt_pk_bf16_f32 v233, v234, v235
  v_cvt_pk_bf16_f32 v234, v236, v237
  v_cvt_pk_bf16_f32 v235, v238, v239
  buffer_store_dwordx4 v[232:235], v2, s[16:19], s4 offen offset:1024 sc1
  s_add_u32 s4, s4, 8192
  v_pk_mul_f32 v[208:209], v[208:209], v[6:7]
  v_pk_mul_f32 v[210:211], v[210:211], v[6:7]
  v_pk_mul_f32 v[212:213], v[212:213], v[6:7]
  v_pk_mul_f32 v[214:215], v[214:215], v[6:7]
  v_cvt_pk_bf16_f32 v208, v208, v209
  v_cvt_pk_bf16_f32 v209, v210, v211
  v_cvt_pk_bf16_f32 v210, v212, v213
  v_cvt_pk_bf16_f32 v211, v214, v215
  buffer_store_dwordx4 v[208:211], v2, s[16:19], s4 offen offset:0 sc1
  v_pk_mul_f32 v[240:241], v[240:241], v[8:9]
  v_pk_mul_f32 v[242:243], v[242:243], v[8:9]
  v_pk_mul_f32 v[244:245], v[244:245], v[8:9]
  v_pk_mul_f32 v[246:247], v[246:247], v[8:9]
  v_cvt_pk_bf16_f32 v240, v240, v241
  v_cvt_pk_bf16_f32 v241, v242, v243
  v_cvt_pk_bf16_f32 v242, v244, v245
  v_cvt_pk_bf16_f32 v243, v246, v247
  buffer_store_dwordx4 v[240:243], v2, s[16:19], s4 offen offset:1024 sc1
  s_add_u32 s4, s4, 8192
  v_pk_mul_f32 v[216:217], v[216:217], v[6:7]
  v_pk_mul_f32 v[218:219], v[218:219], v[6:7]
  v_pk_mul_f32 v[220:221], v[220:221], v[6:7]
  v_pk_mul_f32 v[222:223], v[222:223], v[6:7]
  v_cvt_pk_bf16_f32 v216, v216, v217
  v_cvt_pk_bf16_f32 v217, v218, v219
  v_cvt_pk_bf16_f32 v218, v220, v221
  v_cvt_pk_bf16_f32 v219, v222, v223
  buffer_store_dwordx4 v[216:219], v2, s[16:19], s4 offen offset:0 sc1
  v_pk_mul_f32 v[248:249], v[248:249], v[8:9]
  v_pk_mul_f32 v[250:251], v[250:251], v[8:9]
  v_pk_mul_f32 v[252:253], v[252:253], v[8:9]
  v_pk_mul_f32 v[254:255], v[254:255], v[8:9]
  v_cvt_pk_bf16_f32 v248, v248, v249
  v_cvt_pk_bf16_f32 v249, v250, v251
  v_cvt_pk_bf16_f32 v250, v252, v253
  v_cvt_pk_bf16_f32 v251, v254, v255
  buffer_store_dwordx4 v[248:251], v2, s[16:19], s4 offen offset:1024 sc1
  s_cmp_eq_u32 s6, s25
  s_cbranch_scc1 La_done
  v_accvgpr_read_b32 v64, a128
  v_accvgpr_read_b32 v65, a129
  v_accvgpr_read_b32 v66, a130
  v_accvgpr_read_b32 v67, a131
  v_accvgpr_read_b32 v68, a132
  v_accvgpr_read_b32 v69, a133
  v_accvgpr_read_b32 v70, a134
  v_accvgpr_read_b32 v71, a135
  v_accvgpr_read_b32 v72, a136
  v_accvgpr_read_b32 v73, a137
  v_accvgpr_read_b32 v74, a138
  v_accvgpr_read_b32 v75, a139
  v_accvgpr_read_b32 v76, a140
  v_accvgpr_read_b32 v77, a141
  v_accvgpr_read_b32 v78, a142
  v_accvgpr_read_b32 v79, a143
  v_accvgpr_read_b32 v80, a144
  v_accvgpr_read_b32 v81, a145
  v_accvgpr_read_b32 v82, a146
  v_accvgpr_read_b32 v83, a147
  v_accvgpr_read_b32 v84, a148
  v_accvgpr_read_b32 v85, a149
  v_accvgpr_read_b32 v86, a150
  v_accvgpr_read_b32 v87, a151
  v_accvgpr_read_b32 v88, a152
  v_accvgpr_read_b32 v89, a153
  v_accvgpr_read_b32 v90, a154
  v_accvgpr_read_b32 v91, a155
  v_accvgpr_read_b32 v92, a156
  v_accvgpr_read_b32 v93, a157
  v_accvgpr_read_b32 v94, a158
  v_accvgpr_read_b32 v95, a159
  v_accvgpr_write_b32 a160, v64
  v_accvgpr_write_b32 a161, v65
  v_accvgpr_write_b32 a162, v66
  v_accvgpr_write_b32 a163, v67
  v_accvgpr_write_b32 a164, v68
  v_accvgpr_write_b32 a165, v69
  v_accvgpr_write_b32 a166, v70
  v_accvgpr_write_b32 a167, v71
  v_accvgpr_write_b32 a168, v72
  v_accvgpr_write_b32 a169, v73
  v_accvgpr_write_b32 a170, v74
  v_accvgpr_write_b32 a171, v75
  v_accvgpr_write_b32 a172, v76
  v_accvgpr_write_b32 a173, v77
  v_accvgpr_write_b32 a174, v78
  v_accvgpr_write_b32 a175, v79
  v_accvgpr_write_b32 a176, v80
  v_accvgpr_write_b32 a177, v81
  v_accvgpr_write_b32 a178, v82
  v_accvgpr_write_b32 a179, v83
  v_accvgpr_write_b32 a180, v84
  v_accvgpr_write_b32 a181, v85
  v_accvgpr_write_b32 a182, v86
  v_accvgpr_write_b32 a183, v87
  v_accvgpr_write_b32 a184, v88
  v_accvgpr_write_b32 a185, v89
  v_accvgpr_write_b32 a186, v90
  v_accvgpr_write_b32 a187, v91
  v_accvgpr_write_b32 a188, v92
  v_accvgpr_write_b32 a189, v93
  v_accvgpr_write_b32 a190, v94
  v_accvgpr_write_b32 a191, v95
  s_mov_b32 s6, s25
  s_branch La_sl_blk
La_done:
  s_lshr_b32 s4, s3, 1
  s_lshl_b32 s4, s4, 12
  s_add_u32 s4, s4, 131072
  s_lshl_b32 s5, s77, 11
  s_add_u32 s4, s4, s5
  v_add_u32 v16, s4, v2
  v_xor_b32 v17, 0x800, v16
  s_and_b32 s4, s3, 1
  s_lshl_b32 s4, s4, 13
  s_add_u32 s4, s4, 131072
  v_lshrrev_b32 v24, 2, v1
  v_and_b32 v25, 6, v24
  v_lshlrev_b32 v24, 7, v24
  v_and_b32 v26, 1, v1
  v_lshl_add_u32 v24, v26, 3, v24
  v_add_u32 v24, s4, v24
  v_bfe_u32 v26, v1, 1, 1
  v_xor_b32 v25, v25, v26
  v_xor_b32 v26, 0, v25
  v_lshl_add_u32 v18, v26, 4, v24
  v_xor_b32 v26, 2, v25
  v_lshl_add_u32 v19, v26, 4, v24
  v_xor_b32 v26, 4, v25
  v_lshl_add_u32 v20, v26, 4, v24
  v_xor_b32 v26, 6, v25
  v_lshl_add_u32 v21, v26, 4, v24
  s_mov_b32 s65, 0
  s_mov_b32 s67, 4294868992
  s_mov_b32 s68, 32768
  s_mov_b32 s65, 3
  s_waitcnt vmcnt(16)
  s_barrier
  ds_read_b128 a[64:67], v16 offset:0
  ds_read_b64_tr_b16 a[96:97], v18 offset:16384
  ds_read_b64_tr_b16 a[98:99], v18 offset:18432
  ds_read_b128 a[68:71], v16 offset:1024
  ds_read_b128 a[72:75], v17 offset:0
  ds_read_b128 a[76:79], v17 offset:1024
  ds_read_b64_tr_b16 a[100:101], v19 offset:16384
  ds_read_b64_tr_b16 a[102:103], v19 offset:18432
  ds_read_b64_tr_b16 a[104:105], v20 offset:16384
  ds_read_b64_tr_b16 a[106:107], v20 offset:18432
  ds_read_b64_tr_b16 a[108:109], v21 offset:16384
  ds_read_b64_tr_b16 a[110:111], v21 offset:18432
  s_waitcnt lgkmcnt(0)
  v_mfma_f32_16x16x32_bf16 v[32:35], a[96:99], a[64:67], 0
  s_add_u32 m0, s79, 81920
  ds_read_b128 a[80:83], v16 offset:8192
  ds_read_b64_tr_b16 a[112:113], v18 offset:20480
  v_mfma_f32_16x16x32_bf16 v[48:51], a[96:99], a[68:71], 0
  buffer_load_dwordx4 v10, s[12:15], s71 offen offset:0 lds
  ds_read_b64_tr_b16 a[114:115], v18 offset:22528
  v_mfma_f32_16x16x32_bf16 v[64:67], a[96:99], a[72:75], 0
  buffer_load_dwordx4 v11, s[12:15], s71 offen offset:1024 lds
  ds_read_b128 a[84:87], v16 offset:9216
  v_mfma_f32_16x16x32_bf16 v[80:83], a[96:99], a[76:79], 0
  buffer_load_dwordx4 v12, s[12:15], s71 offen offset:2048 lds
  ds_read_b128 a[88:91], v17 offset:8192
  v_mfma_f32_16x16x32_bf16 v[36:39], a[100:103], a[64:67], 0
  buffer_load_dwordx4 v13, s[12:15], s71 offen offset:3072 lds
  ds_read_b128 a[92:95], v17 offset:9216
  v_mfma_f32_16x16x32_bf16 v[52:55], a[100:103], a[68:71], 0
  s_bfe_u32 s72, 0x3020106, s31
  s_add_u32 s30, s30, s72
  s_add_u32 s31, s31, 8
  v_mfma_f32_16x16x32_bf16 v[68:71], a[100:103], a[72:75], 0
  s_and_b32 s31, s31, 0x8001f
  s_and_b32 s30, s30, 7
  s_lshl_b32 s72, s30, 17
  v_mfma_f32_16x16x32_bf16 v[84:87], a[100:103], a[76:79], 0
  s_add_u32 s71, s93, s72
  s_add_u32 m0, s79, 65536
  ds_read_b64_tr_b16 a[116:117], v19 offset:20480
  v_mfma_f32_16x16x32_bf16 v[40:43], a[104:107], a[64:67], 0
  buffer_load_dwordx4 v2, s[8:11], s70 offen offset:0 sc1 lds
  ds_read_b64_tr_b16 a[118:119], v19 offset:22528
  v_mfma_f32_16x16x32_bf16 v[56:59], a[104:107], a[68:71], 0
  buffer_load_dwordx4 v2, s[8:11], s70 offen offset:1024 sc1 lds
  ds_read_b64_tr_b16 a[120:121], v20 offset:20480
  v_mfma_f32_16x16x32_bf16 v[72:75], a[104:107], a[72:75], 0
  buffer_load_dwordx4 v2, s[8:11], s70 offen offset:2048 sc1 lds
  ds_read_b64_tr_b16 a[122:123], v20 offset:22528
  v_mfma_f32_16x16x32_bf16 v[88:91], a[104:107], a[76:79], 0
  buffer_load_dwordx4 v2, s[8:11], s70 offen offset:3072 sc1 lds
  ds_read_b64_tr_b16 a[124:125], v21 offset:20480
  v_mfma_f32_16x16x32_bf16 v[44:47], a[108:111], a[64:67], 0
  s_bfe_u32 s72, 0x3020106, s1
  s_add_u32 s0, s0, s72
  s_add_u32 s1, s1, 8
  v_mfma_f32_16x16x32_bf16 v[60:63], a[108:111], a[68:71], 0
  s_and_b32 s1, s1, 0x8001f
  s_and_b32 s0, s0, 7
  s_lshl_b32 s72, s0, 14
  v_mfma_f32_16x16x32_bf16 v[76:79], a[108:111], a[72:75], 0
  s_add_u32 s70, s92, s72
  s_add_u32 m0, s79, 114688
  ds_read_b64_tr_b16 a[126:127], v21 offset:22528
  v_mfma_f32_16x16x32_bf16 v[92:95], a[108:111], a[76:79], 0
  buffer_load_dwordx4 v10, s[12:15], s71 offen offset:0 lds
  buffer_load_dwordx4 v11, s[12:15], s71 offen offset:1024 lds
  buffer_load_dwordx4 v12, s[12:15], s71 offen offset:2048 lds
  buffer_load_dwordx4 v13, s[12:15], s71 offen offset:3072 lds
  s_bfe_u32 s72, 0x3020106, s31
  s_add_u32 s30, s30, s72
  s_add_u32 s31, s31, 8
  s_and_b32 s31, s31, 0x8001f
  s_and_b32 s30, s30, 7
  s_lshl_b32 s72, s30, 17
  s_add_u32 s71, s93, s72
  s_add_u32 m0, s79, 98304
  s_nop 0
  buffer_load_dwordx4 v2, s[8:11], s70 offen offset:0 sc1 lds
  buffer_load_dwordx4 v2, s[8:11], s70 offen offset:1024 sc1 lds
  buffer_load_dwordx4 v2, s[8:11], s70 offen offset:2048 sc1 lds
  buffer_load_dwordx4 v2, s[8:11], s70 offen offset:3072 sc1 lds
  s_bfe_u32 s72, 0x3020106, s1
  s_add_u32 s0, s0, s72
  s_add_u32 s1, s1, 8
  s_and_b32 s1, s1, 0x8001f
  s_and_b32 s0, s0, 7
  s_lshl_b32 s72, s0, 14
  s_add_u32 s70, s92, s72
  s_add_u32 s65, s65, 1
  s_cmp_eq_u32 s65, 4
  s_cselect_b32 s65, 0, s65
  s_cselect_b32 s66, s67, s68
  v_add_u32 v16, s66, v16
  v_add_u32 v17, s66, v17
  v_add_u32 v18, s66, v18
  v_add_u32 v19, s66, v19
  v_add_u32 v20, s66, v20
  v_add_u32 v21, s66, v21
  s_waitcnt vmcnt(16) lgkmcnt(0)
  s_barrier
  s_lshl_b32 s4, s24, 7
  s_lshl_b32 s5, s25, 12
  s_add_u32 s6, s4, 65536
  s_and_b32 s7, s25, 1
  s_lshl_b32 s7, s7, 1
  s_add_u32 s7, s7, 14
  s_sub_u32 s7, s7, s25
  s_lshl_b32 s7, s7, 12
  s_add_u32 s7, s7, s6
  s_add_u32 s6, s6, s5
  v_mov_b32 v8, 0x40000000
  v_mov_b32 v6, s94
  v_cmp_eq_u32 vcc, 0, v0
  v_mov_b32 v7, s95
  s_nop 0
  v_cndmask_b32_e64 v8, v8, 0, vcc
  buffer_store_dwordx2 v[6:7], v8, s[96:99], s6 offen sc1
  buffer_store_dwordx2 v[6:7], v8, s[96:99], s7 offen sc1
  s_lshl_b32 s91, s73, 12
  s_add_u32 s91, s91, 65536
  v_and_b32 v14, 31, v1
  v_lshlrev_b32 v14, 7, v14
  s_add_u32 s16, s86, 100663296
  s_addc_u32 s17, s87, 0
  s_mov_b32 s18, 16777216
  s_mov_b32 s19, 0x00020000
  v_mfma_f32_16x16x32_bf16 v[32:35], a[112:115], a[80:83], v[32:35]
  s_add_u32 m0, s64, 16384
  ds_read_b128 a[64:67], v16 offset:0
  ds_read_b64_tr_b16 a[96:97], v18 offset:16384
  v_mfma_f32_16x16x32_bf16 v[48:51], a[112:115], a[84:87], v[48:51]
  buffer_load_dwordx4 v10, s[12:15], s71 offen offset:0 lds
  ds_read_b64_tr_b16 a[98:99], v18 offset:18432
  v_mfma_f32_16x16x32_bf16 v[64:67], a[112:115], a[88:91], v[64:67]
  ds_read_b128 a[68:71], v16 offset:1024
  ds_read_b128 a[72:75], v17 offset:0
  v_mfma_f32_16x16x32_bf16 v[80:83], a[112:115], a[92:95], v[80:83]
  buffer_load_dwordx4 v11, s[12:15], s71 offen offset:1024 lds
  ds_read_b128 a[76:79], v17 offset:1024
  v_mfma_f32_16x16x32_bf16 v[36:39], a[116:119], a[80:83], v[36:39]
  ds_read_b64_tr_b16 a[100:101], v19 offset:16384
  ds_read_b64_tr_b16 a[102:103], v19 offset:18432
  v_mfma_f32_16x16x32_bf16 v[52:55], a[116:119], a[84:87], v[52:55]
  ds_read_b64_tr_b16 a[104:105], v20 offset:16384
  ds_read_b64_tr_b16 a[106:107], v20 offset:18432
  v_mfma_f32_16x16x32_bf16 v[68:71], a[116:119], a[88:91], v[68:71]
  ds_read_b64_tr_b16 a[108:109], v21 offset:16384
  ds_read_b64_tr_b16 a[110:111], v21 offset:18432
  v_mfma_f32_16x16x32_bf16 v[84:87], a[116:119], a[92:95], v[84:87]
  buffer_load_dwordx4 v12, s[12:15], s71 offen offset:2048 lds
  v_mfma_f32_16x16x32_bf16 v[40:43], a[120:123], a[80:83], v[40:43]
  v_mfma_f32_16x16x32_bf16 v[56:59], a[120:123], a[84:87], v[56:59]
  v_mfma_f32_16x16x32_bf16 v[72:75], a[120:123], a[88:91], v[72:75]
  v_mfma_f32_16x16x32_bf16 v[88:91], a[120:123], a[92:95], v[88:91]
  buffer_load_dwordx4 v13, s[12:15], s71 offen offset:3072 lds
  v_mfma_f32_16x16x32_bf16 v[44:47], a[124:127], a[80:83], v[44:47]
  s_bfe_u32 s72, 0x3020106, s31
  s_add_u32 s30, s30, s72
  s_add_u32 s31, s31, 8
  v_mfma_f32_16x16x32_bf16 v[60:63], a[124:127], a[84:87], v[60:63]
  s_and_b32 s31, s31, 0x8001f
  s_and_b32 s30, s30, 7
  s_lshl_b32 s72, s30, 17
  v_mfma_f32_16x16x32_bf16 v[76:79], a[124:127], a[88:91], v[76:79]
  s_add_u32 s71, s93, s72
  v_mfma_f32_16x16x32_bf16 v[92:95], a[124:127], a[92:95], v[92:95]
  s_waitcnt lgkmcnt(0)
  v_mfma_f32_16x16x32_bf16 v[32:35], a[96:99], a[64:67], v[32:35]
  s_mov_b32 m0, s64
  ds_read_b128 a[80:83], v16 offset:8192
  ds_read_b64_tr_b16 a[112:113], v18 offset:20480
  v_mfma_f32_16x16x32_bf16 v[48:51], a[96:99], a[68:71], v[48:51]
  buffer_load_dwordx4 v2, s[8:11], s70 offen offset:0 sc1 lds
  ds_read_b64_tr_b16 a[114:115], v18 offset:22528
  v_mfma_f32_16x16x32_bf16 v[64:67], a[96:99], a[72:75], v[64:67]
  buffer_load_dwordx4 v2, s[8:11], s70 offen offset:1024 sc1 lds
  ds_read_b128 a[84:87], v16 offset:9216
  v_mfma_f32_16x16x32_bf16 v[80:83], a[96:99], a[76:79], v[80:83]
  ds_read_b128 a[88:91], v17 offset:8192
  ds_read_b128 a[92:95], v17 offset:9216
  v_mfma_f32_16x16x32_bf16 v[36:39], a[100:103], a[64:67], v[36:39]
  buffer_load_dwordx4 v2, s[8:11], s70 offen offset:2048 sc1 lds
  ds_read_b64_tr_b16 a[116:117], v19 offset:20480
  v_mfma_f32_16x16x32_bf16 v[52:55], a[100:103], a[68:71], v[52:55]
  ds_read_b64_tr_b16 a[118:119], v19 offset:22528
  ds_read_b64_tr_b16 a[120:121], v20 offset:20480
  v_mfma_f32_16x16x32_bf16 v[68:71], a[100:103], a[72:75], v[68:71]
  buffer_load_dwordx4 v2, s[8:11], s70 offen offset:3072 sc1 lds
  ds_read_b64_tr_b16 a[122:123], v20 offset:22528
  v_mfma_f32_16x16x32_bf16 v[84:87], a[100:103], a[76:79], v[84:87]
  s_bfe_u32 s72, 0x3020106, s1
  s_add_u32 s0, s0, s72
  s_add_u32 s1, s1, 8
  v_mfma_f32_16x16x32_bf16 v[40:43], a[104:107], a[64:67], v[40:43]
  s_and_b32 s1, s1, 0x8001f
  s_and_b32 s0, s0, 7
  s_lshl_b32 s72, s0, 14
  v_mfma_f32_16x16x32_bf16 v[56:59], a[104:107], a[68:71], v[56:59]
  s_add_u32 s70, s92, s72
  ds_read_b64_tr_b16 a[124:125], v21 offset:20480
  ds_read_b64_tr_b16 a[126:127], v21 offset:22528
  v_mfma_f32_16x16x32_bf16 v[72:75], a[104:107], a[72:75], v[72:75]
  s_add_u32 s64, s64, s66
  s_add_u32 s65, s65, 1
  s_cmp_eq_u32 s65, 4
  s_cselect_b32 s65, 0, s65
  s_cselect_b32 s66, s67, s68
  v_mfma_f32_16x16x32_bf16 v[88:91], a[104:107], a[76:79], v[88:91]
  v_add_u32 v16, s66, v16
  v_add_u32 v17, s66, v17
  v_mfma_f32_16x16x32_bf16 v[44:47], a[108:111], a[64:67], v[44:47]
  v_add_u32 v18, s66, v18
  v_add_u32 v19, s66, v19
  v_mfma_f32_16x16x32_bf16 v[60:63], a[108:111], a[68:71], v[60:63]
  v_add_u32 v20, s66, v20
  v_add_u32 v21, s66, v21
  v_mfma_f32_16x16x32_bf16 v[76:79], a[108:111], a[72:75], v[76:79]
  v_mfma_f32_16x16x32_bf16 v[92:95], a[108:111], a[76:79], v[92:95]
  s_waitcnt vmcnt(18) lgkmcnt(0)
  s_barrier
  v_mfma_f32_16x16x32_bf16 v[32:35], a[112:115], a[80:83], v[32:35]
  s_add_u32 m0, s64, 16384
  ds_read_b128 a[64:67], v16 offset:0
  ds_read_b64_tr_b16 a[96:97], v18 offset:16384
  v_mfma_f32_16x16x32_bf16 v[48:51], a[112:115], a[84:87], v[48:51]
  buffer_load_dwordx4 v10, s[12:15], s71 offen offset:0 lds
  ds_read_b64_tr_b16 a[98:99], v18 offset:18432
  v_mfma_f32_16x16x32_bf16 v[64:67], a[112:115], a[88:91], v[64:67]
  ds_read_b128 a[68:71], v16 offset:1024
  ds_read_b128 a[72:75], v17 offset:0
  v_mfma_f32_16x16x32_bf16 v[80:83], a[112:115], a[92:95], v[80:83]
  buffer_load_dwordx4 v11, s[12:15], s71 offen offset:1024 lds
  ds_read_b128 a[76:79], v17 offset:1024
  v_mfma_f32_16x16x32_bf16 v[36:39], a[116:119], a[80:83], v[36:39]
  ds_read_b64_tr_b16 a[100:101], v19 offset:16384
  ds_read_b64_tr_b16 a[102:103], v19 offset:18432
  v_mfma_f32_16x16x32_bf16 v[52:55], a[116:119], a[84:87], v[52:55]
  ds_read_b64_tr_b16 a[104:105], v20 offset:16384
  ds_read_b64_tr_b16 a[106:107], v20 offset:18432
  v_mfma_f32_16x16x32_bf16 v[68:71], a[116:119], a[88:91], v[68:71]
  ds_read_b64_tr_b16 a[108:109], v21 offset:16384
  ds_read_b64_tr_b16 a[110:111], v21 offset:18432
  v_mfma_f32_16x16x32_bf16 v[84:87], a[116:119], a[92:95], v[84:87]
  buffer_load_dwordx4 v12, s[12:15], s71 offen offset:2048 lds
  v_mfma_f32_16x16x32_bf16 v[40:43], a[120:123], a[80:83], v[40:43]
  v_mfma_f32_16x16x32_bf16 v[56:59], a[120:123], a[84:87], v[56:59]
  v_mfma_f32_16x16x32_bf16 v[72:75], a[120:123], a[88:91], v[72:75]
  v_mfma_f32_16x16x32_bf16 v[88:91], a[120:123], a[92:95], v[88:91]
  buffer_load_dwordx4 v13, s[12:15], s71 offen offset:3072 lds
  v_mfma_f32_16x16x32_bf16 v[44:47], a[124:127], a[80:83], v[44:47]
  s_bfe_u32 s72, 0x3020106, s31
  s_add_u32 s30, s30, s72
  s_add_u32 s31, s31, 8
  v_mfma_f32_16x16x32_bf16 v[60:63], a[124:127], a[84:87], v[60:63]
  s_and_b32 s31, s31, 0x8001f
  s_and_b32 s30, s30, 7
  s_lshl_b32 s72, s30, 17
  v_mfma_f32_16x16x32_bf16 v[76:79], a[124:127], a[88:91], v[76:79]
  s_add_u32 s71, s93, s72
  v_mfma_f32_16x16x32_bf16 v[92:95], a[124:127], a[92:95], v[92:95]
  s_waitcnt lgkmcnt(0)
  v_mfma_f32_16x16x32_bf16 v[32:35], a[96:99], a[64:67], v[32:35]
  s_mov_b32 m0, s64
  ds_read_b128 a[80:83], v16 offset:8192
  ds_read_b64_tr_b16 a[112:113], v18 offset:20480
  v_mfma_f32_16x16x32_bf16 v[48:51], a[96:99], a[68:71], v[48:51]
  buffer_load_dwordx4 v2, s[8:11], s70 offen offset:0 sc1 lds
  ds_read_b64_tr_b16 a[114:115], v18 offset:22528
  v_mfma_f32_16x16x32_bf16 v[64:67], a[96:99], a[72:75], v[64:67]
  buffer_load_dwordx4 v2, s[8:11], s70 offen offset:1024 sc1 lds
  ds_read_b128 a[84:87], v16 offset:9216
  v_mfma_f32_16x16x32_bf16 v[80:83], a[96:99], a[76:79], v[80:83]
  ds_read_b128 a[88:91], v17 offset:8192
  ds_read_b128 a[92:95], v17 offset:9216
  v_mfma_f32_16x16x32_bf16 v[36:39], a[100:103], a[64:67], v[36:39]
  buffer_load_dwordx4 v2, s[8:11], s70 offen offset:2048 sc1 lds
  ds_read_b64_tr_b16 a[116:117], v19 offset:20480
  v_mfma_f32_16x16x32_bf16 v[52:55], a[100:103], a[68:71], v[52:55]
  ds_read_b64_tr_b16 a[118:119], v19 offset:22528
  ds_read_b64_tr_b16 a[120:121], v20 offset:20480
  v_mfma_f32_16x16x32_bf16 v[68:71], a[100:103], a[72:75], v[68:71]
  buffer_load_dwordx4 v2, s[8:11], s70 offen offset:3072 sc1 lds
  ds_read_b64_tr_b16 a[122:123], v20 offset:22528
  v_mfma_f32_16x16x32_bf16 v[84:87], a[100:103], a[76:79], v[84:87]
  s_bfe_u32 s72, 0x3020106, s1
  s_add_u32 s0, s0, s72
  s_add_u32 s1, s1, 8
  v_mfma_f32_16x16x32_bf16 v[40:43], a[104:107], a[64:67], v[40:43]
  s_and_b32 s1, s1, 0x8001f
  s_and_b32 s0, s0, 7
  s_lshl_b32 s72, s0, 14
  v_mfma_f32_16x16x32_bf16 v[56:59], a[104:107], a[68:71], v[56:59]
  s_add_u32 s70, s92, s72
  ds_read_b64_tr_b16 a[124:125], v21 offset:20480
  ds_read_b64_tr_b16 a[126:127], v21 offset:22528
  v_mfma_f32_16x16x32_bf16 v[72:75], a[104:107], a[72:75], v[72:75]
  s_add_u32 s64, s64, s66
  s_add_u32 s65, s65, 1
  s_cmp_eq_u32 s65, 4
  s_cselect_b32 s65, 0, s65
  s_cselect_b32 s66, s67, s68
  v_mfma_f32_16x16x32_bf16 v[88:91], a[104:107], a[76:79], v[88:91]
  v_add_u32 v16, s66, v16
  v_add_u32 v17, s66, v17
  v_mfma_f32_16x16x32_bf16 v[44:47], a[108:111], a[64:67], v[44:47]
  v_add_u32 v18, s66, v18
  v_add_u32 v19, s66, v19
  v_mfma_f32_16x16x32_bf16 v[60:63], a[108:111], a[68:71], v[60:63]
  v_add_u32 v20, s66, v20
  v_add_u32 v21, s66, v21
  v_mfma_f32_16x16x32_bf16 v[76:79], a[108:111], a[72:75], v[76:79]
  v_mfma_f32_16x16x32_bf16 v[92:95], a[108:111], a[76:79], v[92:95]
  s_waitcnt vmcnt(18) lgkmcnt(0)
  s_barrier
  v_mfma_f32_16x16x32_bf16 v[32:35], a[112:115], a[80:83], v[32:35]
  s_add_u32 m0, s64, 16384
  ds_read_b128 a[64:67], v16 offset:0
  ds_read_b64_tr_b16 a[96:97], v18 offset:16384
  v_mfma_f32_16x16x32_bf16 v[48:51], a[112:115], a[84:87], v[48:51]
  buffer_load_dwordx4 v10, s[12:15], s71 offen offset:0 lds
  ds_read_b64_tr_b16 a[98:99], v18 offset:18432
  v_mfma_f32_16x16x32_bf16 v[64:67], a[112:115], a[88:91], v[64:67]
  ds_read_b128 a[68:71], v16 offset:1024
  ds_read_b128 a[72:75], v17 offset:0
  v_mfma_f32_16x16x32_bf16 v[80:83], a[112:115], a[92:95], v[80:83]
  buffer_load_dwordx4 v11, s[12:15], s71 offen offset:1024 lds
  ds_read_b128 a[76:79], v17 offset:1024
  v_mfma_f32_16x16x32_bf16 v[36:39], a[116:119], a[80:83], v[36:39]
  ds_read_b64_tr_b16 a[100:101], v19 offset:16384
  ds_read_b64_tr_b16 a[102:103], v19 offset:18432
  v_mfma_f32_16x16x32_bf16 v[52:55], a[116:119], a[84:87], v[52:55]
  ds_read_b64_tr_b16 a[104:105], v20 offset:16384
  ds_read_b64_tr_b16 a[106:107], v20 offset:18432
  v_mfma_f32_16x16x32_bf16 v[68:71], a[116:119], a[88:91], v[68:71]
  ds_read_b64_tr_b16 a[108:109], v21 offset:16384
  ds_read_b64_tr_b16 a[110:111], v21 offset:18432
  v_mfma_f32_16x16x32_bf16 v[84:87], a[116:119], a[92:95], v[84:87]
  buffer_load_dwordx4 v12, s[12:15], s71 offen offset:2048 lds
  v_mfma_f32_16x16x32_bf16 v[40:43], a[120:123], a[80:83], v[40:43]
  v_mfma_f32_16x16x32_bf16 v[56:59], a[120:123], a[84:87], v[56:59]
  v_mfma_f32_16x16x32_bf16 v[72:75], a[120:123], a[88:91], v[72:75]
  v_mfma_f32_16x16x32_bf16 v[88:91], a[120:123], a[92:95], v[88:91]
  buffer_load_dwordx4 v13, s[12:15], s71 offen offset:3072 lds
  v_mfma_f32_16x16x32_bf16 v[44:47], a[124:127], a[80:83], v[44:47]
  s_bfe_u32 s72, 0x3020106, s31
  s_add_u32 s30, s30, s72
  s_add_u32 s31, s31, 8
  v_mfma_f32_16x16x32_bf16 v[60:63], a[124:127], a[84:87], v[60:63]
  s_and_b32 s31, s31, 0x8001f
  s_and_b32 s30, s30, 7
  s_lshl_b32 s72, s30, 17
  v_mfma_f32_16x16x32_bf16 v[76:79], a[124:127], a[88:91], v[76:79]
  s_add_u32 s71, s93, s72
  v_mfma_f32_16x16x32_bf16 v[92:95], a[124:127], a[92:95], v[92:95]
  s_waitcnt lgkmcnt(0)
  v_mfma_f32_16x16x32_bf16 v[32:35], a[96:99], a[64:67], v[32:35]
  s_mov_b32 m0, s64
  ds_read_b128 a[80:83], v16 offset:8192
  ds_read_b64_tr_b16 a[112:113], v18 offset:20480
  v_mfma_f32_16x16x32_bf16 v[48:51], a[96:99], a[68:71], v[48:51]
  buffer_load_dwordx4 v2, s[8:11], s70 offen offset:0 sc1 lds
  ds_read_b64_tr_b16 a[114:115], v18 offset:22528
  v_mfma_f32_16x16x32_bf16 v[64:67], a[96:99], a[72:75], v[64:67]
  buffer_load_dwordx4 v2, s[8:11], s70 offen offset:1024 sc1 lds
  ds_read_b128 a[84:87], v16 offset:9216
  v_mfma_f32_16x16x32_bf16 v[80:83], a[96:99], a[76:79], v[80:83]
  ds_read_b128 a[88:91], v17 offset:8192
  ds_read_b128 a[92:95], v17 offset:9216
  v_mfma_f32_16x16x32_bf16 v[36:39], a[100:103], a[64:67], v[36:39]
  buffer_load_dwordx4 v2, s[8:11], s70 offen offset:2048 sc1 lds
  ds_read_b64_tr_b16 a[116:117], v19 offset:20480
  v_mfma_f32_16x16x32_bf16 v[52:55], a[100:103], a[68:71], v[52:55]
  ds_read_b64_tr_b16 a[118:119], v19 offset:22528
  ds_read_b64_tr_b16 a[120:121], v20 offset:20480
  v_mfma_f32_16x16x32_bf16 v[68:71], a[100:103], a[72:75], v[68:71]
  buffer_load_dwordx4 v2, s[8:11], s70 offen offset:3072 sc1 lds
  ds_read_b64_tr_b16 a[122:123], v20 offset:22528
  v_mfma_f32_16x16x32_bf16 v[84:87], a[100:103], a[76:79], v[84:87]
  s_bfe_u32 s72, 0x3020106, s1
  s_add_u32 s0, s0, s72
  s_add_u32 s1, s1, 8
  v_mfma_f32_16x16x32_bf16 v[40:43], a[104:107], a[64:67], v[40:43]
  s_and_b32 s1, s1, 0x8001f
  s_and_b32 s0, s0, 7
  s_lshl_b32 s72, s0, 14
  v_mfma_f32_16x16x32_bf16 v[56:59], a[104:107], a[68:71], v[56:59]
  s_add_u32 s70, s92, s72
  ds_read_b64_tr_b16 a[124:125], v21 offset:20480
  ds_read_b64_tr_b16 a[126:127], v21 offset:22528
  v_mfma_f32_16x16x32_bf16 v[72:75], a[104:107], a[72:75], v[72:75]
  s_add_u32 s64, s64, s66
  s_add_u32 s65, s65, 1
  s_cmp_eq_u32 s65, 4
  s_cselect_b32 s65, 0, s65
  s_cselect_b32 s66, s67, s68
  v_mfma_f32_16x16x32_bf16 v[88:91], a[104:107], a[76:79], v[88:91]
  v_add_u32 v16, s66, v16
  v_add_u32 v17, s66, v17
  v_mfma_f32_16x16x32_bf16 v[44:47], a[108:111], a[64:67], v[44:47]
  v_add_u32 v18, s66, v18
  v_add_u32 v19, s66, v19
  v_mfma_f32_16x16x32_bf16 v[60:63], a[108:111], a[68:71], v[60:63]
  v_add_u32 v20, s66, v20
  v_add_u32 v21, s66, v21
  v_mfma_f32_16x16x32_bf16 v[76:79], a[108:111], a[72:75], v[76:79]
  v_mfma_f32_16x16x32_bf16 v[92:95], a[108:111], a[76:79], v[92:95]
  s_waitcnt vmcnt(16) lgkmcnt(0)
  s_barrier
  v_mfma_f32_16x16x32_bf16 v[32:35], a[112:115], a[80:83], v[32:35]
  s_add_u32 m0, s64, 16384
  ds_read_b128 a[64:67], v16 offset:0
  ds_read_b64_tr_b16 a[96:97], v18 offset:16384
  v_mfma_f32_16x16x32_bf16 v[48:51], a[112:115], a[84:87], v[48:51]
  buffer_load_dwordx4 v10, s[12:15], s71 offen offset:0 lds
  ds_read_b64_tr_b16 a[98:99], v18 offset:18432
  v_mfma_f32_16x16x32_bf16 v[64:67], a[112:115], a[88:91], v[64:67]
  ds_read_b128 a[68:71], v16 offset:1024
  ds_read_b128 a[72:75], v17 offset:0
  v_mfma_f32_16x16x32_bf16 v[80:83], a[112:115], a[92:95], v[80:83]
  buffer_load_dwordx4 v11, s[12:15], s71 offen offset:1024 lds
  ds_read_b128 a[76:79], v17 offset:1024
  v_mfma_f32_16x16x32_bf16 v[36:39], a[116:119], a[80:83], v[36:39]
  ds_read_b64_tr_b16 a[100:101], v19 offset:16384
  ds_read_b64_tr_b16 a[102:103], v19 offset:18432
  v_mfma_f32_16x16x32_bf16 v[52:55], a[116:119], a[84:87], v[52:55]
  ds_read_b64_tr_b16 a[104:105], v20 offset:16384
  ds_read_b64_tr_b16 a[106:107], v20 offset:18432
  v_mfma_f32_16x16x32_bf16 v[68:71], a[116:119], a[88:91], v[68:71]
  ds_read_b64_tr_b16 a[108:109], v21 offset:16384
  ds_read_b64_tr_b16 a[110:111], v21 offset:18432
  v_mfma_f32_16x16x32_bf16 v[84:87], a[116:119], a[92:95], v[84:87]
  buffer_load_dwordx4 v12, s[12:15], s71 offen offset:2048 lds
  v_mfma_f32_16x16x32_bf16 v[40:43], a[120:123], a[80:83], v[40:43]
  v_mfma_f32_16x16x32_bf16 v[56:59], a[120:123], a[84:87], v[56:59]
  v_mfma_f32_16x16x32_bf16 v[72:75], a[120:123], a[88:91], v[72:75]
  v_mfma_f32_16x16x32_bf16 v[88:91], a[120:123], a[92:95], v[88:91]
  buffer_load_dwordx4 v13, s[12:15], s71 offen offset:3072 lds
  v_mfma_f32_16x16x32_bf16 v[44:47], a[124:127], a[80:83], v[44:47]
  s_bfe_u32 s72, 0x3020106, s31
  s_add_u32 s30, s30, s72
  s_add_u32 s31, s31, 8
  v_mfma_f32_16x16x32_bf16 v[60:63], a[124:127], a[84:87], v[60:63]
  s_and_b32 s31, s31, 0x8001f
  s_and_b32 s30, s30, 7
  s_lshl_b32 s72, s30, 17
  v_mfma_f32_16x16x32_bf16 v[76:79], a[124:127], a[88:91], v[76:79]
  s_add_u32 s71, s93, s72
  v_mfma_f32_16x16x32_bf16 v[92:95], a[124:127], a[92:95], v[92:95]
  s_waitcnt lgkmcnt(0)
  v_mfma_f32_16x16x32_bf16 v[32:35], a[96:99], a[64:67], v[32:35]
  s_mov_b32 m0, s64
  ds_read_b128 a[80:83], v16 offset:8192
  ds_read_b64_tr_b16 a[112:113], v18 offset:20480
  v_mfma_f32_16x16x32_bf16 v[48:51], a[96:99], a[68:71], v[48:51]
  buffer_load_dwordx4 v2, s[8:11], s70 offen offset:0 sc1 lds
  ds_read_b64_tr_b16 a[114:115], v18 offset:22528
  v_mfma_f32_16x16x32_bf16 v[64:67], a[96:99], a[72:75], v[64:67]
  buffer_load_dwordx4 v2, s[8:11], s70 offen offset:1024 sc1 lds
  ds_read_b128 a[84:87], v16 offset:9216
  v_mfma_f32_16x16x32_bf16 v[80:83], a[96:99], a[76:79], v[80:83]
  ds_read_b128 a[88:91], v17 offset:8192
  ds_read_b128 a[92:95], v17 offset:9216
  v_mfma_f32_16x16x32_bf16 v[36:39], a[100:103], a[64:67], v[36:39]
  buffer_load_dwordx4 v2, s[8:11], s70 offen offset:2048 sc1 lds
  ds_read_b64_tr_b16 a[116:117], v19 offset:20480
  v_mfma_f32_16x16x32_bf16 v[52:55], a[100:103], a[68:71], v[52:55]
  ds_read_b64_tr_b16 a[118:119], v19 offset:22528
  ds_read_b64_tr_b16 a[120:121], v20 offset:20480
  v_mfma_f32_16x16x32_bf16 v[68:71], a[100:103], a[72:75], v[68:71]
  buffer_load_dwordx4 v2, s[8:11], s70 offen offset:3072 sc1 lds
  ds_read_b64_tr_b16 a[122:123], v20 offset:22528
  v_mfma_f32_16x16x32_bf16 v[84:87], a[100:103], a[76:79], v[84:87]
  s_bfe_u32 s72, 0x3020106, s1
  s_add_u32 s0, s0, s72
  s_add_u32 s1, s1, 8
  v_mfma_f32_16x16x32_bf16 v[40:43], a[104:107], a[64:67], v[40:43]
  s_and_b32 s1, s1, 0x8001f
  s_and_b32 s0, s0, 7
  s_lshl_b32 s72, s0, 14
  v_mfma_f32_16x16x32_bf16 v[56:59], a[104:107], a[68:71], v[56:59]
  s_add_u32 s70, s92, s72
  ds_read_b64_tr_b16 a[124:125], v21 offset:20480
  ds_read_b64_tr_b16 a[126:127], v21 offset:22528
  v_mfma_f32_16x16x32_bf16 v[72:75], a[104:107], a[72:75], v[72:75]
  s_add_u32 s64, s64, s66
  s_add_u32 s65, s65, 1
  s_cmp_eq_u32 s65, 4
  s_cselect_b32 s65, 0, s65
  s_cselect_b32 s66, s67, s68
  v_mfma_f32_16x16x32_bf16 v[88:91], a[104:107], a[76:79], v[88:91]
  v_add_u32 v16, s66, v16
  v_add_u32 v17, s66, v17
  v_mfma_f32_16x16x32_bf16 v[44:47], a[108:111], a[64:67], v[44:47]
  v_add_u32 v18, s66, v18
  v_add_u32 v19, s66, v19
  v_mfma_f32_16x16x32_bf16 v[60:63], a[108:111], a[68:71], v[60:63]
  v_add_u32 v20, s66, v20
  v_add_u32 v21, s66, v21
  v_mfma_f32_16x16x32_bf16 v[76:79], a[108:111], a[72:75], v[76:79]
  v_mfma_f32_16x16x32_bf16 v[92:95], a[108:111], a[76:79], v[92:95]
  s_waitcnt vmcnt(16) lgkmcnt(0)
  s_barrier
  v_mfma_f32_16x16x32_bf16 v[32:35], a[112:115], a[80:83], v[32:35]
  s_mov_b32 s12, s74
  s_mov_b32 s13, s75
  s_mov_b32 s14, 8388608
  v_mfma_f32_16x16x32_bf16 v[48:51], a[112:115], a[84:87], v[48:51]
  s_mov_b32 s15, 0x00020000
  s_lshl_b32 s93, s77, 22
  s_lshl_b32 s72, s76, 8
  v_mfma_f32_16x16x32_bf16 v[64:67], a[112:115], a[88:91], v[64:67]
  s_add_u32 s93, s93, s72
  s_add_u32 s72, s73, s76
  s_and_b32 s31, s72, 3
  v_mfma_f32_16x16x32_bf16 v[80:83], a[112:115], a[92:95], v[80:83]
  s_lshl_b32 s31, s31, 3
  s_or_b32 s31, s31, 0x80000
  s_bfe_u32 s30, 0x1b1b02, s31
  v_mfma_f32_16x16x32_bf16 v[36:39], a[116:119], a[80:83], v[36:39]
  s_add_u32 s30, s30, 0
  s_cmp_ge_u32 s30, 28
  s_cselect_b32 s72, 28, 0
  v_mfma_f32_16x16x32_bf16 v[52:55], a[116:119], a[84:87], v[52:55]
  s_sub_u32 s30, s30, s72
  s_lshl_b32 s72, s30, 17
  s_add_u32 s71, s93, s72
  v_mfma_f32_16x16x32_bf16 v[68:71], a[116:119], a[88:91], v[68:71]
  s_add_u32 m0, s64, 16384
  ds_read_b128 a[64:67], v16 offset:0
  ds_read_b64_tr_b16 a[96:97], v18 offset:16384
  v_mfma_f32_16x16x32_bf16 v[84:87], a[116:119], a[92:95], v[84:87]
  buffer_load_dwordx4 v10, s[12:15], s71 offen offset:0 lds
  ds_read_b64_tr_b16 a[98:99], v18 offset:18432
  v_mfma_f32_16x16x32_bf16 v[40:43], a[120:123], a[80:83], v[40:43]
  buffer_load_dwordx4 v11, s[12:15], s71 offen offset:1024 lds
  ds_read_b128 a[68:71], v16 offset:1024
  v_mfma_f32_16x16x32_bf16 v[56:59], a[120:123], a[84:87], v[56:59]
  ds_read_b128 a[72:75], v17 offset:0
  ds_read_b128 a[76:79], v17 offset:1024
  v_mfma_f32_16x16x32_bf16 v[72:75], a[120:123], a[88:91], v[72:75]
  buffer_load_dwordx4 v12, s[12:15], s71 offen offset:2048 lds
  ds_read_b64_tr_b16 a[100:101], v19 offset:16384
  v_mfma_f32_16x16x32_bf16 v[88:91], a[120:123], a[92:95], v[88:91]
  ds_read_b64_tr_b16 a[102:103], v19 offset:18432
  ds_read_b64_tr_b16 a[104:105], v20 offset:16384
  v_mfma_f32_16x16x32_bf16 v[44:47], a[124:127], a[80:83], v[44:47]
  ds_read_b64_tr_b16 a[106:107], v20 offset:18432
  ds_read_b64_tr_b16 a[108:109], v21 offset:16384
  v_mfma_f32_16x16x32_bf16 v[60:63], a[124:127], a[84:87], v[60:63]
  ds_read_b64_tr_b16 a[110:111], v21 offset:18432
  v_mfma_f32_16x16x32_bf16 v[76:79], a[124:127], a[88:91], v[76:79]
  v_mfma_f32_16x16x32_bf16 v[92:95], a[124:127], a[92:95], v[92:95]
  s_waitcnt lgkmcnt(0)
  v_mfma_f32_16x16x32_bf16 v[32:35], a[96:99], a[64:67], v[32:35]
  buffer_load_dwordx4 v13, s[12:15], s71 offen offset:3072 lds
  ds_read_b128 a[80:83], v16 offset:8192
  v_mfma_f32_16x16x32_bf16 v[48:51], a[96:99], a[68:71], v[48:51]
  s_bfe_u32 s72, 0x302011a, s31
  s_add_u32 s30, s30, s72
  s_add_u32 s31, s31, 8
  v_mfma_f32_16x16x32_bf16 v[64:67], a[96:99], a[72:75], v[64:67]
  s_and_b32 s31, s31, 0x8001f
  s_cmp_ge_u32 s30, 28
  s_cselect_b32 s72, 28, 0
  v_mfma_f32_16x16x32_bf16 v[80:83], a[96:99], a[76:79], v[80:83]
  s_sub_u32 s30, s30, s72
  s_lshl_b32 s72, s30, 17
  s_add_u32 s71, s93, s72
  v_mfma_f32_16x16x32_bf16 v[36:39], a[100:103], a[64:67], v[36:39]
  buffer_load_dwordx2 v[6:7], v14, s[96:99], s91 offen sc1
  ds_read_b64_tr_b16 a[112:113], v18 offset:20480
  v_mfma_f32_16x16x32_bf16 v[52:55], a[100:103], a[68:71], v[52:55]
  s_add_u32 s64, s64, s66
  ds_read_b64_tr_b16 a[114:115], v18 offset:22528
  ds_read_b128 a[84:87], v16 offset:9216
  v_mfma_f32_16x16x32_bf16 v[68:71], a[100:103], a[72:75], v[68:71]
  s_add_u32 s65, s65, 1
  ds_read_b128 a[88:91], v17 offset:8192
  ds_read_b128 a[92:95], v17 offset:9216
  v_mfma_f32_16x16x32_bf16 v[84:87], a[100:103], a[76:79], v[84:87]
  s_cmp_eq_u32 s65, 4
  s_cselect_b32 s65, 0, s65
  s_cselect_b32 s66, s67, s68
  ds_read_b64_tr_b16 a[116:117], v19 offset:20480
  ds_read_b64_tr_b16 a[118:119], v19 offset:22528
  v_mfma_f32_16x16x32_bf16 v[40:43], a[104:107], a[64:67], v[40:43]
  ds_read_b64_tr_b16 a[120:121], v20 offset:20480
  ds_read_b64_tr_b16 a[122:123], v20 offset:22528
  v_mfma_f32_16x16x32_bf16 v[56:59], a[104:107], a[68:71], v[56:59]
  ds_read_b64_tr_b16 a[124:125], v21 offset:20480
  ds_read_b64_tr_b16 a[126:127], v21 offset:22528
  v_mfma_f32_16x16x32_bf16 v[72:75], a[104:107], a[72:75], v[72:75]
  v_add_u32 v16, s66, v16
  v_add_u32 v17, s66, v17
  v_mfma_f32_16x16x32_bf16 v[88:91], a[104:107], a[76:79], v[88:91]
  v_add_u32 v18, s66, v18
  v_add_u32 v19, s66, v19
  v_mfma_f32_16x16x32_bf16 v[44:47], a[108:111], a[64:67], v[44:47]
  v_add_u32 v20, s66, v20
  v_add_u32 v21, s66, v21
  v_mfma_f32_16x16x32_bf16 v[60:63], a[108:111], a[68:71], v[60:63]
  v_mfma_f32_16x16x32_bf16 v[76:79], a[108:111], a[72:75], v[76:79]
  v_mfma_f32_16x16x32_bf16 v[92:95], a[108:111], a[76:79], v[92:95]
  s_waitcnt vmcnt(0)
  v_cmp_ne_u64 vcc, s[94:95], v[6:7]
  s_nop 1
  v_cndmask_b32_e64 v8, 0, 1, vcc
  v_lshlrev_b32 v9, 2, v0
  ds_write_b32 v9, v8
  v_lshlrev_b32 v9, 4, v1
  s_waitcnt lgkmcnt(0)
  s_barrier
  ds_read_b128 v[160:163], v9
  s_waitcnt lgkmcnt(0)
  v_or3_b32 v160, v160, v161, v162
  v_or_b32 v160, v160, v163
  v_cmp_ne_u32 vcc, 0, v160
  s_nop 0
  s_cbranch_vccnz Lp6_late
  s_add_u32 s8, s86, 67108864
  s_addc_u32 s9, s87, 0
  s_mov_b32 s10, 16777216
  s_mov_b32 s11, 0x00020000
  s_lshl_b32 s92, s73, 1
  s_add_u32 s92, s92, s77
  s_lshl_b32 s92, s92, 19
  s_add_u32 s92, s92, s79
  s_add_u32 s72, s73, s76
  s_and_b32 s1, s72, 3
  s_lshl_b32 s1, s1, 3
  s_or_b32 s1, s1, 0x80000
  s_bfe_u32 s0, 0x1b1b02, s1
  s_add_u32 s0, s0, 0
  s_cmp_ge_u32 s0, 28
  s_cselect_b32 s72, 28, 0
  s_sub_u32 s0, s0, s72
  s_lshl_b32 s72, s0, 14
  s_add_u32 s70, s92, s72
  v_mfma_f32_16x16x32_bf16 v[32:35], a[112:115], a[80:83], v[32:35]
  s_add_u32 m0, s79, 131072
  ds_read_b128 a[64:67], v16 offset:0
  ds_read_b64_tr_b16 a[96:97], v18 offset:16384
  v_mfma_f32_16x16x32_bf16 v[48:51], a[112:115], a[84:87], v[48:51]
  buffer_load_dwordx4 v2, s[8:11], s70 offen offset:0 sc1 lds
  ds_read_b64_tr_b16 a[98:99], v18 offset:18432
  v_mfma_f32_16x16x32_bf16 v[64:67], a[112:115], a[88:91], v[64:67]
  buffer_load_dwordx4 v2, s[8:11], s70 offen offset:1024 sc1 lds
  ds_read_b128 a[68:71], v16 offset:1024
  v_mfma_f32_16x16x32_bf16 v[80:83], a[112:115], a[92:95], v[80:83]
  ds_read_b128 a[72:75], v17 offset:0
  ds_read_b128 a[76:79], v17 offset:1024
  v_mfma_f32_16x16x32_bf16 v[36:39], a[116:119], a[80:83], v[36:39]
  ds_read_b64_tr_b16 a[100:101], v19 offset:16384
  ds_read_b64_tr_b16 a[102:103], v19 offset:18432
  v_mfma_f32_16x16x32_bf16 v[52:55], a[116:119], a[84:87], v[52:55]
  buffer_load_dwordx4 v2, s[8:11], s70 offen offset:2048 sc1 lds
  ds_read_b64_tr_b16 a[104:105], v20 offset:16384
  v_mfma_f32_16x16x32_bf16 v[68:71], a[116:119], a[88:91], v[68:71]
  ds_read_b64_tr_b16 a[106:107], v20 offset:18432
  ds_read_b64_tr_b16 a[108:109], v21 offset:16384
  v_mfma_f32_16x16x32_bf16 v[84:87], a[116:119], a[92:95], v[84:87]
  buffer_load_dwordx4 v2, s[8:11], s70 offen offset:3072 sc1 lds
  ds_read_b64_tr_b16 a[110:111], v21 offset:18432
  v_mfma_f32_16x16x32_bf16 v[40:43], a[120:123], a[80:83], v[40:43]
  s_bfe_u32 s72, 0x302011a, s1
  s_add_u32 s0, s0, s72
  s_add_u32 s1, s1, 8
  v_mfma_f32_16x16x32_bf16 v[56:59], a[120:123], a[84:87], v[56:59]
  s_and_b32 s1, s1, 0x8001f
  s_cmp_ge_u32 s0, 28
  s_cselect_b32 s72, 28, 0
  v_mfma_f32_16x16x32_bf16 v[72:75], a[120:123], a[88:91], v[72:75]
  s_sub_u32 s0, s0, s72
  s_lshl_b32 s72, s0, 14
  s_add_u32 s70, s92, s72
  v_mfma_f32_16x16x32_bf16 v[88:91], a[120:123], a[92:95], v[88:91]
  s_add_u32 m0, s64, 16384
  v_mfma_f32_16x16x32_bf16 v[44:47], a[124:127], a[80:83], v[44:47]
  buffer_load_dwordx4 v10, s[12:15], s71 offen offset:0 lds
  v_mfma_f32_16x16x32_bf16 v[60:63], a[124:127], a[84:87], v[60:63]
  buffer_load_dwordx4 v11, s[12:15], s71 offen offset:1024 lds
  v_mfma_f32_16x16x32_bf16 v[76:79], a[124:127], a[88:91], v[76:79]
  v_mfma_f32_16x16x32_bf16 v[92:95], a[124:127], a[92:95], v[92:95]
  s_waitcnt lgkmcnt(0)
  v_mfma_f32_16x16x32_bf16 v[32:35], a[96:99], a[64:67], v[32:35]
  buffer_load_dwordx4 v12, s[12:15], s71 offen offset:2048 lds
  ds_read_b128 a[80:83], v16 offset:8192
  v_mfma_f32_16x16x32_bf16 v[48:51], a[96:99], a[68:71], v[48:51]
  buffer_load_dwordx4 v13, s[12:15], s71 offen offset:3072 lds
  ds_read_b64_tr_b16 a[112:113], v18 offset:20480
  v_mfma_f32_16x16x32_bf16 v[64:67], a[96:99], a[72:75], v[64:67]
  s_bfe_u32 s72, 0x302011a, s31
  s_add_u32 s30, s30, s72
  s_add_u32 s31, s31, 8
  v_mfma_f32_16x16x32_bf16 v[80:83], a[96:99], a[76:79], v[80:83]
  s_and_b32 s31, s31, 0x8001f
  s_cmp_ge_u32 s30, 28
  s_cselect_b32 s72, 28, 0
  v_mfma_f32_16x16x32_bf16 v[36:39], a[100:103], a[64:67], v[36:39]
  s_sub_u32 s30, s30, s72
  s_lshl_b32 s72, s30, 17
  s_add_u32 s71, s93, s72
  v_mfma_f32_16x16x32_bf16 v[52:55], a[100:103], a[68:71], v[52:55]
  s_mov_b32 m0, s64
  ds_read_b64_tr_b16 a[114:115], v18 offset:22528
  ds_read_b128 a[84:87], v16 offset:9216
  v_mfma_f32_16x16x32_bf16 v[68:71], a[100:103], a[72:75], v[68:71]
  buffer_load_dwordx4 v2, s[8:11], s70 offen offset:0 sc1 lds
  ds_read_b128 a[88:91], v17 offset:8192
  v_mfma_f32_16x16x32_bf16 v[84:87], a[100:103], a[76:79], v[84:87]
  buffer_load_dwordx4 v2, s[8:11], s70 offen offset:1024 sc1 lds
  ds_read_b128 a[92:95], v17 offset:9216
  v_mfma_f32_16x16x32_bf16 v[40:43], a[104:107], a[64:67], v[40:43]
  buffer_load_dwordx4 v2, s[8:11], s70 offen offset:2048 sc1 lds
  ds_read_b64_tr_b16 a[116:117], v19 offset:20480
  v_mfma_f32_16x16x32_bf16 v[56:59], a[104:107], a[68:71], v[56:59]
  buffer_load_dwordx4 v2, s[8:11], s70 offen offset:3072 sc1 lds
  ds_read_b64_tr_b16 a[118:119], v19 offset:22528
  v_mfma_f32_16x16x32_bf16 v[72:75], a[104:107], a[72:75], v[72:75]
  s_bfe_u32 s72, 0x302011a, s1
  s_add_u32 s0, s0, s72
  s_add_u32 s1, s1, 8
  v_mfma_f32_16x16x32_bf16 v[88:91], a[104:107], a[76:79], v[88:91]
  s_and_b32 s1, s1, 0x8001f
  s_cmp_ge_u32 s0, 28
  s_cselect_b32 s72, 28, 0
  v_mfma_f32_16x16x32_bf16 v[44:47], a[108:111], a[64:67], v[44:47]
  s_sub_u32 s0, s0, s72
  s_lshl_b32 s72, s0, 14
  s_add_u32 s70, s92, s72
  v_mfma_f32_16x16x32_bf16 v[60:63], a[108:111], a[68:71], v[60:63]
  s_add_u32 s64, s64, s66
  ds_read_b64_tr_b16 a[120:121], v20 offset:20480
  ds_read_b64_tr_b16 a[122:123], v20 offset:22528
  v_mfma_f32_16x16x32_bf16 v[76:79], a[108:111], a[72:75], v[76:79]
  s_add_u32 s65, s65, 1
  ds_read_b64_tr_b16 a[124:125], v21 offset:20480
  ds_read_b64_tr_b16 a[126:127], v21 offset:22528
  v_mfma_f32_16x16x32_bf16 v[92:95], a[108:111], a[76:79], v[92:95]
  s_cmp_eq_u32 s65, 4
  s_cselect_b32 s65, 0, s65
  s_cselect_b32 s66, s67, s68
  v_add_u32 v16, s66, v16
  v_add_u32 v17, s66, v17
  v_add_u32 v18, s66, v18
  v_add_u32 v19, s66, v19
  v_add_u32 v20, s66, v20
  v_add_u32 v21, s66, v21
  s_waitcnt vmcnt(12) lgkmcnt(0)
  s_barrier
  v_mfma_f32_16x16x32_bf16 v[32:35], a[112:115], a[80:83], v[32:35]
  s_add_u32 m0, s64, 16384
  ds_read_b128 a[64:67], v16 offset:0
  ds_read_b64_tr_b16 a[96:97], v18 offset:16384
  v_mfma_f32_16x16x32_bf16 v[48:51], a[112:115], a[84:87], v[48:51]
  buffer_load_dwordx4 v10, s[12:15], s71 offen offset:0 lds
  ds_read_b64_tr_b16 a[98:99], v18 offset:18432
  v_mfma_f32_16x16x32_bf16 v[64:67], a[112:115], a[88:91], v[64:67]
  ds_read_b128 a[68:71], v16 offset:1024
  ds_read_b128 a[72:75], v17 offset:0
  v_mfma_f32_16x16x32_bf16 v[80:83], a[112:115], a[92:95], v[80:83]
  buffer_load_dwordx4 v11, s[12:15], s71 offen offset:1024 lds
  ds_read_b128 a[76:79], v17 offset:1024
  v_mfma_f32_16x16x32_bf16 v[36:39], a[116:119], a[80:83], v[36:39]
  ds_read_b64_tr_b16 a[100:101], v19 offset:16384
  ds_read_b64_tr_b16 a[102:103], v19 offset:18432
  v_mfma_f32_16x16x32_bf16 v[52:55], a[116:119], a[84:87], v[52:55]
  ds_read_b64_tr_b16 a[104:105], v20 offset:16384
  ds_read_b64_tr_b16 a[106:107], v20 offset:18432
  v_mfma_f32_16x16x32_bf16 v[68:71], a[116:119], a[88:91], v[68:71]
  ds_read_b64_tr_b16 a[108:109], v21 offset:16384
  ds_read_b64_tr_b16 a[110:111], v21 offset:18432
  v_mfma_f32_16x16x32_bf16 v[84:87], a[116:119], a[92:95], v[84:87]
  buffer_load_dwordx4 v12, s[12:15], s71 offen offset:2048 lds
  v_mfma_f32_16x16x32_bf16 v[40:43], a[120:123], a[80:83], v[40:43]
  v_mfma_f32_16x16x32_bf16 v[56:59], a[120:123], a[84:87], v[56:59]
  v_mfma_f32_16x16x32_bf16 v[72:75], a[120:123], a[88:91], v[72:75]
  v_mfma_f32_16x16x32_bf16 v[88:91], a[120:123], a[92:95], v[88:91]
  buffer_load_dwordx4 v13, s[12:15], s71 offen offset:3072 lds
  v_mfma_f32_16x16x32_bf16 v[44:47], a[124:127], a[80:83], v[44:47]
  s_bfe_u32 s72, 0x302011a, s31
  s_add_u32 s30, s30, s72
  s_add_u32 s31, s31, 8
  v_mfma_f32_16x16x32_bf16 v[60:63], a[124:127], a[84:87], v[60:63]
  s_and_b32 s31, s31, 0x8001f
  s_cmp_ge_u32 s30, 28
  s_cselect_b32 s72, 28, 0
  v_mfma_f32_16x16x32_bf16 v[76:79], a[124:127], a[88:91], v[76:79]
  s_sub_u32 s30, s30, s72
  s_lshl_b32 s72, s30, 17
  s_add_u32 s71, s93, s72
  v_mfma_f32_16x16x32_bf16 v[92:95], a[124:127], a[92:95], v[92:95]
  s_waitcnt lgkmcnt(0)
  v_mfma_f32_16x16x32_bf16 v[32:35], a[96:99], a[64:67], v[32:35]
  s_mov_b32 m0, s64
  ds_read_b128 a[80:83], v16 offset:8192
  ds_read_b64_tr_b16 a[112:113], v18 offset:20480
  v_mfma_f32_16x16x32_bf16 v[48:51], a[96:99], a[68:71], v[48:51]
  buffer_load_dwordx4 v2, s[8:11], s70 offen offset:0 sc1 lds
  ds_read_b64_tr_b16 a[114:115], v18 offset:22528
  v_mfma_f32_16x16x32_bf16 v[64:67], a[96:99], a[72:75], v[64:67]
  buffer_load_dwordx4 v2, s[8:11], s70 offen offset:1024 sc1 lds
  ds_read_b128 a[84:87], v16 offset:9216
  v_mfma_f32_16x16x32_bf16 v[80:83], a[96:99], a[76:79], v[80:83]
  ds_read_b128 a[88:91], v17 offset:8192
  ds_read_b128 a[92:95], v17 offset:9216
  v_mfma_f32_16x16x32_bf16 v[36:39], a[100:103], a[64:67], v[36:39]
  buffer_load_dwordx4 v2, s[8:11], s70 offen offset:2048 sc1 lds
  ds_read_b64_tr_b16 a[116:117], v19 offset:20480
  v_mfma_f32_16x16x32_bf16 v[52:55], a[100:103], a[68:71], v[52:55]
  ds_read_b64_tr_b16 a[118:119], v19 offset:22528
  ds_read_b64_tr_b16 a[120:121], v20 offset:20480
  v_mfma_f32_16x16x32_bf16 v[68:71], a[100:103], a[72:75], v[68:71]
  buffer_load_dwordx4 v2, s[8:11], s70 offen offset:3072 sc1 lds
  ds_read_b64_tr_b16 a[122:123], v20 offset:22528
  v_mfma_f32_16x16x32_bf16 v[84:87], a[100:103], a[76:79], v[84:87]
  s_bfe_u32 s72, 0x302011a, s1
  s_add_u32 s0, s0, s72
  s_add_u32 s1, s1, 8
  v_mfma_f32_16x16x32_bf16 v[40:43], a[104:107], a[64:67], v[40:43]
  s_and_b32 s1, s1, 0x8001f
  s_cmp_ge_u32 s0, 28
  s_cselect_b32 s72, 28, 0
  v_mfma_f32_16x16x32_bf16 v[56:59], a[104:107], a[68:71], v[56:59]
  s_sub_u32 s0, s0, s72
  s_lshl_b32 s72, s0, 14
  s_add_u32 s70, s92, s72
  v_mfma_f32_16x16x32_bf16 v[72:75], a[104:107], a[72:75], v[72:75]
  s_add_u32 s64, s64, s66
  ds_read_b64_tr_b16 a[124:125], v21 offset:20480
  ds_read_b64_tr_b16 a[126:127], v21 offset:22528
  v_mfma_f32_16x16x32_bf16 v[88:91], a[104:107], a[76:79], v[88:91]
  s_add_u32 s65, s65, 1
  s_cmp_eq_u32 s65, 4
  s_cselect_b32 s65, 0, s65
  s_cselect_b32 s66, s67, s68
  v_mfma_f32_16x16x32_bf16 v[44:47], a[108:111], a[64:67], v[44:47]
  v_add_u32 v16, s66, v16
  v_add_u32 v17, s66, v17
  v_mfma_f32_16x16x32_bf16 v[60:63], a[108:111], a[68:71], v[60:63]
  v_add_u32 v18, s66, v18
  v_add_u32 v19, s66, v19
  v_mfma_f32_16x16x32_bf16 v[76:79], a[108:111], a[72:75], v[76:79]
  v_add_u32 v20, s66, v20
  v_add_u32 v21, s66, v21
  v_mfma_f32_16x16x32_bf16 v[92:95], a[108:111], a[76:79], v[92:95]
  s_waitcnt vmcnt(16) lgkmcnt(0)
  s_barrier
  v_mfma_f32_16x16x32_bf16 v[32:35], a[112:115], a[80:83], v[32:35]
  s_add_u32 m0, s64, 16384
  ds_read_b128 a[64:67], v16 offset:0
  ds_read_b64_tr_b16 a[96:97], v18 offset:16384
  v_mfma_f32_16x16x32_bf16 v[48:51], a[112:115], a[84:87], v[48:51]
  buffer_load_dwordx4 v10, s[12:15], s71 offen offset:0 lds
  ds_read_b64_tr_b16 a[98:99], v18 offset:18432
  v_mfma_f32_16x16x32_bf16 v[64:67], a[112:115], a[88:91], v[64:67]
  buffer_load_dwordx4 v11, s[12:15], s71 offen offset:1024 lds
  ds_read_b128 a[68:71], v16 offset:1024
  v_mfma_f32_16x16x32_bf16 v[80:83], a[112:115], a[92:95], v[80:83]
  buffer_load_dwordx4 v12, s[12:15], s71 offen offset:2048 lds
  ds_read_b128 a[72:75], v17 offset:0
  v_mfma_f32_16x16x32_bf16 v[36:39], a[116:119], a[80:83], v[36:39]
  ds_read_b128 a[76:79], v17 offset:1024
  ds_read_b64_tr_b16 a[100:101], v19 offset:16384
  v_mfma_f32_16x16x32_bf16 v[52:55], a[116:119], a[84:87], v[52:55]
  buffer_load_dwordx4 v13, s[12:15], s71 offen offset:3072 lds
  ds_read_b64_tr_b16 a[102:103], v19 offset:18432
  v_mfma_f32_16x16x32_bf16 v[68:71], a[116:119], a[88:91], v[68:71]
  s_bfe_u32 s72, 0x302011a, s31
  s_add_u32 s30, s30, s72
  s_add_u32 s31, s31, 8
  v_mfma_f32_16x16x32_bf16 v[84:87], a[116:119], a[92:95], v[84:87]
  s_and_b32 s31, s31, 0x8001f
  s_cmp_ge_u32 s30, 28
  s_cselect_b32 s72, 28, 0
  v_mfma_f32_16x16x32_bf16 v[40:43], a[120:123], a[80:83], v[40:43]
  s_sub_u32 s30, s30, s72
  s_lshl_b32 s72, s30, 17
  s_add_u32 s71, s93, s72
  v_mfma_f32_16x16x32_bf16 v[56:59], a[120:123], a[84:87], v[56:59]
  s_mov_b32 m0, s64
  ds_read_b64_tr_b16 a[104:105], v20 offset:16384
  ds_read_b64_tr_b16 a[106:107], v20 offset:18432
  v_mfma_f32_16x16x32_bf16 v[72:75], a[120:123], a[88:91], v[72:75]
  buffer_load_dwordx4 v2, s[8:11], s70 offen offset:0 sc1 lds
  ds_read_b64_tr_b16 a[108:109], v21 offset:16384
  v_mfma_f32_16x16x32_bf16 v[88:91], a[120:123], a[92:95], v[88:91]
  buffer_load_dwordx4 v2, s[8:11], s70 offen offset:1024 sc1 lds
  ds_read_b64_tr_b16 a[110:111], v21 offset:18432
  v_mfma_f32_16x16x32_bf16 v[44:47], a[124:127], a[80:83], v[44:47]
  buffer_load_dwordx4 v2, s[8:11], s70 offen offset:2048 sc1 lds
  v_mfma_f32_16x16x32_bf16 v[60:63], a[124:127], a[84:87], v[60:63]
  buffer_load_dwordx4 v2, s[8:11], s70 offen offset:3072 sc1 lds
  v_mfma_f32_16x16x32_bf16 v[76:79], a[124:127], a[88:91], v[76:79]
  s_bfe_u32 s72, 0x302011a, s1
  s_add_u32 s0, s0, s72
  s_add_u32 s1, s1, 8
  v_mfma_f32_16x16x32_bf16 v[92:95], a[124:127], a[92:95], v[92:95]
  s_and_b32 s1, s1, 0x8001f
  s_cmp_ge_u32 s0, 28
  s_cselect_b32 s72, 28, 0
  s_sub_u32 s0, s0, s72
  s_lshl_b32 s72, s0, 14
  s_add_u32 s70, s92, s72
  s_waitcnt lgkmcnt(0)
  s_lshl_b32 s6, s78, 1
  s_add_u32 s6, s6, s77
  s_xor_b32 s6, s6, 1
  s_lshl_b32 s6, s6, 2
  s_add_u32 s6, s6, s3
  s_lshl_b32 s6, s6, 13
  s_add_u32 s6, s6, 8388608
  s_add_u32 s7, s6, 4096
  v_mfma_f32_16x16x32_bf16 v[96:99], a[96:99], a[64:67], 0
  s_add_u32 s64, s64, s66
  ds_read_b128 a[80:83], v16 offset:8192
  ds_read_b64_tr_b16 a[112:113], v18 offset:20480
  v_mfma_f32_16x16x32_bf16 v[112:115], a[96:99], a[68:71], 0
  s_add_u32 s65, s65, 1
  ds_read_b64_tr_b16 a[114:115], v18 offset:22528
  ds_read_b128 a[84:87], v16 offset:9216
  v_mfma_f32_16x16x32_bf16 v[128:131], a[96:99], a[72:75], 0
  s_cmp_eq_u32 s65, 4
  s_cselect_b32 s65, 0, s65
  s_cselect_b32 s66, s67, s68
  ds_read_b128 a[88:91], v17 offset:8192
  ds_read_b128 a[92:95], v17 offset:9216
  v_mfma_f32_16x16x32_bf16 v[144:147], a[96:99], a[76:79], 0
  ds_read_b64_tr_b16 a[116:117], v19 offset:20480
  v_mfma_f32_16x16x32_bf16 v[100:103], a[100:103], a[64:67], 0
  ds_read_b64_tr_b16 a[118:119], v19 offset:22528
  ds_read_b64_tr_b16 a[120:121], v20 offset:20480
  v_mfma_f32_16x16x32_bf16 v[116:119], a[100:103], a[68:71], 0
  ds_read_b64_tr_b16 a[122:123], v20 offset:22528
  ds_read_b64_tr_b16 a[124:125], v21 offset:20480
  v_mfma_f32_16x16x32_bf16 v[132:135], a[100:103], a[72:75], 0
  buffer_store_dwordx4 v[64:67], v2, s[16:19], s6 offen offset:0 sc1
  ds_read_b64_tr_b16 a[126:127], v21 offset:22528
  v_mfma_f32_16x16x32_bf16 v[148:151], a[100:103], a[76:79], 0
  v_add_u32 v16, s66, v16
  v_add_u32 v17, s66, v17
  v_mfma_f32_16x16x32_bf16 v[104:107], a[104:107], a[64:67], 0
  v_add_u32 v18, s66, v18
  v_add_u32 v19, s66, v19
  v_mfma_f32_16x16x32_bf16 v[120:123], a[104:107], a[68:71], 0
  v_add_u32 v20, s66, v20
  v_add_u32 v21, s66, v21
  v_mfma_f32_16x16x32_bf16 v[136:139], a[104:107], a[72:75], 0
  buffer_store_dwordx4 v[68:71], v2, s[16:19], s6 offen offset:1024 sc1
  v_mfma_f32_16x16x32_bf16 v[152:155], a[104:107], a[76:79], 0
  buffer_store_dwordx4 v[72:75], v2, s[16:19], s6 offen offset:2048 sc1
  v_mfma_f32_16x16x32_bf16 v[108:111], a[108:111], a[64:67], 0
  buffer_store_dwordx4 v[76:79], v2, s[16:19], s6 offen offset:3072 sc1
  v_mfma_f32_16x16x32_bf16 v[124:127], a[108:111], a[68:71], 0
  buffer_store_dwordx4 v[80:83], v2, s[16:19], s7 offen offset:0 sc1
  v_mfma_f32_16x16x32_bf16 v[140:143], a[108:111], a[72:75], 0
  buffer_store_dwordx4 v[84:87], v2, s[16:19], s7 offen offset:1024 sc1
  v_mfma_f32_16x16x32_bf16 v[156:159], a[108:111], a[76:79], 0
  buffer_store_dwordx4 v[88:91], v2, s[16:19], s7 offen offset:2048 sc1
  buffer_store_dwordx4 v[92:95], v2, s[16:19], s7 offen offset:3072 sc1
  s_branch Lp7
Lp6_late:
  v_mfma_f32_16x16x32_bf16 v[32:35], a[112:115], a[80:83], v[32:35]
  s_add_u32 m0, s64, 16384
  ds_read_b128 a[64:67], v16 offset:0
  ds_read_b64_tr_b16 a[96:97], v18 offset:16384
  v_mfma_f32_16x16x32_bf16 v[48:51], a[112:115], a[84:87], v[48:51]
  buffer_load_dwordx4 v10, s[12:15], s71 offen offset:0 lds
  ds_read_b64_tr_b16 a[98:99], v18 offset:18432
  v_mfma_f32_16x16x32_bf16 v[64:67], a[112:115], a[88:91], v[64:67]
  ds_read_b128 a[68:71], v16 offset:1024
  ds_read_b128 a[72:75], v17 offset:0
  v_mfma_f32_16x16x32_bf16 v[80:83], a[112:115], a[92:95], v[80:83]
  ds_read_b128 a[76:79], v17 offset:1024
  ds_read_b64_tr_b16 a[100:101], v19 offset:16384
  v_mfma_f32_16x16x32_bf16 v[36:39], a[116:119], a[80:83], v[36:39]
  ds_read_b64_tr_b16 a[102:103], v19 offset:18432
  ds_read_b64_tr_b16 a[104:105], v20 offset:16384
  v_mfma_f32_16x16x32_bf16 v[52:55], a[116:119], a[84:87], v[52:55]
  ds_read_b64_tr_b16 a[106:107], v20 offset:18432
  ds_read_b64_tr_b16 a[108:109], v21 offset:16384
  v_mfma_f32_16x16x32_bf16 v[68:71], a[116:119], a[88:91], v[68:71]
  ds_read_b64_tr_b16 a[110:111], v21 offset:18432
  v_mfma_f32_16x16x32_bf16 v[84:87], a[116:119], a[92:95], v[84:87]
  buffer_load_dwordx4 v11, s[12:15], s71 offen offset:1024 lds
  v_mfma_f32_16x16x32_bf16 v[40:43], a[120:123], a[80:83], v[40:43]
  v_mfma_f32_16x16x32_bf16 v[56:59], a[120:123], a[84:87], v[56:59]
  v_mfma_f32_16x16x32_bf16 v[72:75], a[120:123], a[88:91], v[72:75]
  v_mfma_f32_16x16x32_bf16 v[88:91], a[120:123], a[92:95], v[88:91]
  v_mfma_f32_16x16x32_bf16 v[44:47], a[124:127], a[80:83], v[44:47]
  v_mfma_f32_16x16x32_bf16 v[60:63], a[124:127], a[84:87], v[60:63]
  v_mfma_f32_16x16x32_bf16 v[76:79], a[124:127], a[88:91], v[76:79]
  v_mfma_f32_16x16x32_bf16 v[92:95], a[124:127], a[92:95], v[92:95]
  s_waitcnt lgkmcnt(0)
  v_mfma_f32_16x16x32_bf16 v[32:35], a[96:99], a[64:67], v[32:35]
  buffer_load_dwordx4 v12, s[12:15], s71 offen offset:2048 lds
  ds_read_b128 a[80:83], v16 offset:8192
  v_mfma_f32_16x16x32_bf16 v[48:51], a[96:99], a[68:71], v[48:51]
  ds_read_b64_tr_b16 a[112:113], v18 offset:20480
  ds_read_b64_tr_b16 a[114:115], v18 offset:22528
  v_mfma_f32_16x16x32_bf16 v[64:67], a[96:99], a[72:75], v[64:67]
  ds_read_b128 a[84:87], v16 offset:9216
  ds_read_b128 a[88:91], v17 offset:8192
  v_mfma_f32_16x16x32_bf16 v[80:83], a[96:99], a[76:79], v[80:83]
  ds_read_b128 a[92:95], v17 offset:9216
  ds_read_b64_tr_b16 a[116:117], v19 offset:20480
  v_mfma_f32_16x16x32_bf16 v[36:39], a[100:103], a[64:67], v[36:39]
  buffer_load_dwordx4 v13, s[12:15], s71 offen offset:3072 lds
  ds_read_b64_tr_b16 a[118:119], v19 offset:22528
  v_mfma_f32_16x16x32_bf16 v[52:55], a[100:103], a[68:71], v[52:55]
  s_bfe_u32 s72, 0x302011a, s31
  s_add_u32 s30, s30, s72
  s_add_u32 s31, s31, 8
  v_mfma_f32_16x16x32_bf16 v[68:71], a[100:103], a[72:75], v[68:71]
  s_and_b32 s31, s31, 0x8001f
  s_cmp_ge_u32 s30, 28
  s_cselect_b32 s72, 28, 0
  v_mfma_f32_16x16x32_bf16 v[84:87], a[100:103], a[76:79], v[84:87]
  s_sub_u32 s30, s30, s72
  s_lshl_b32 s72, s30, 17
  s_add_u32 s71, s93, s72
  v_mfma_f32_16x16x32_bf16 v[40:43], a[104:107], a[64:67], v[40:43]
  s_add_u32 s64, s64, s66
  ds_read_b64_tr_b16 a[120:121], v20 offset:20480
  ds_read_b64_tr_b16 a[122:123], v20 offset:22528
  v_mfma_f32_16x16x32_bf16 v[56:59], a[104:107], a[68:71], v[56:59]
  s_add_u32 s65, s65, 1
  ds_read_b64_tr_b16 a[124:125], v21 offset:20480
  ds_read_b64_tr_b16 a[126:127], v21 offset:22528
  v_mfma_f32_16x16x32_bf16 v[72:75], a[104:107], a[72:75], v[72:75]
  s_cmp_eq_u32 s65, 4
  s_cselect_b32 s65, 0, s65
  s_cselect_b32 s66, s67, s68
  v_mfma_f32_16x16x32_bf16 v[88:91], a[104:107], a[76:79], v[88:91]
  v_add_u32 v16, s66, v16
  v_add_u32 v17, s66, v17
  v_mfma_f32_16x16x32_bf16 v[44:47], a[108:111], a[64:67], v[44:47]
  v_add_u32 v18, s66, v18
  v_add_u32 v19, s66, v19
  v_mfma_f32_16x16x32_bf16 v[60:63], a[108:111], a[68:71], v[60:63]
  v_add_u32 v20, s66, v20
  v_add_u32 v21, s66, v21
  v_mfma_f32_16x16x32_bf16 v[76:79], a[108:111], a[72:75], v[76:79]
  v_mfma_f32_16x16x32_bf16 v[92:95], a[108:111], a[76:79], v[92:95]
  s_waitcnt vmcnt(4) lgkmcnt(0)
  s_barrier
  v_mfma_f32_16x16x32_bf16 v[32:35], a[112:115], a[80:83], v[32:35]
  s_add_u32 m0, s64, 16384
  ds_read_b128 a[64:67], v16 offset:0
  ds_read_b64_tr_b16 a[96:97], v18 offset:16384
  v_mfma_f32_16x16x32_bf16 v[48:51], a[112:115], a[84:87], v[48:51]
  buffer_load_dwordx4 v10, s[12:15], s71 offen offset:0 lds
  ds_read_b64_tr_b16 a[98:99], v18 offset:18432
  v_mfma_f32_16x16x32_bf16 v[64:67], a[112:115], a[88:91], v[64:67]
  ds_read_b128 a[68:71], v16 offset:1024
  ds_read_b128 a[72:75], v17 offset:0
  v_mfma_f32_16x16x32_bf16 v[80:83], a[112:115], a[92:95], v[80:83]
  ds_read_b128 a[76:79], v17 offset:1024
  ds_read_b64_tr_b16 a[100:101], v19 offset:16384
  v_mfma_f32_16x16x32_bf16 v[36:39], a[116:119], a[80:83], v[36:39]
  ds_read_b64_tr_b16 a[102:103], v19 offset:18432
  ds_read_b64_tr_b16 a[104:105], v20 offset:16384
  v_mfma_f32_16x16x32_bf16 v[52:55], a[116:119], a[84:87], v[52:55]
  buffer_load_dwordx4 v11, s[12:15], s71 offen offset:1024 lds
  ds_read_b64_tr_b16 a[106:107], v20 offset:18432
  v_mfma_f32_16x16x32_bf16 v[68:71], a[116:119], a[88:91], v[68:71]
  ds_read_b64_tr_b16 a[108:109], v21 offset:16384
  ds_read_b64_tr_b16 a[110:111], v21 offset:18432
  v_mfma_f32_16x16x32_bf16 v[84:87], a[116:119], a[92:95], v[84:87]
  v_mfma_f32_16x16x32_bf16 v[40:43], a[120:123], a[80:83], v[40:43]
  v_mfma_f32_16x16x32_bf16 v[56:59], a[120:123], a[84:87], v[56:59]
  v_mfma_f32_16x16x32_bf16 v[72:75], a[120:123], a[88:91], v[72:75]
  buffer_load_dwordx4 v12, s[12:15], s71 offen offset:2048 lds
  v_mfma_f32_16x16x32_bf16 v[88:91], a[120:123], a[92:95], v[88:91]
  v_mfma_f32_16x16x32_bf16 v[44:47], a[124:127], a[80:83], v[44:47]
  v_mfma_f32_16x16x32_bf16 v[60:63], a[124:127], a[84:87], v[60:63]
  v_mfma_f32_16x16x32_bf16 v[76:79], a[124:127], a[88:91], v[76:79]
  v_mfma_f32_16x16x32_bf16 v[92:95], a[124:127], a[92:95], v[92:95]
  s_waitcnt lgkmcnt(0)
  v_mfma_f32_16x16x32_bf16 v[32:35], a[96:99], a[64:67], v[32:35]
  buffer_load_dwordx4 v13, s[12:15], s71 offen offset:3072 lds
  ds_read_b128 a[80:83], v16 offset:8192
  v_mfma_f32_16x16x32_bf16 v[48:51], a[96:99], a[68:71], v[48:51]
  s_bfe_u32 s72, 0x302011a, s31
  s_add_u32 s30, s30, s72
  s_add_u32 s31, s31, 8
  v_mfma_f32_16x16x32_bf16 v[64:67], a[96:99], a[72:75], v[64:67]
  s_and_b32 s31, s31, 0x8001f
  s_cmp_ge_u32 s30, 28
  s_cselect_b32 s72, 28, 0
  v_mfma_f32_16x16x32_bf16 v[80:83], a[96:99], a[76:79], v[80:83]
  s_sub_u32 s30, s30, s72
  s_lshl_b32 s72, s30, 17
  s_add_u32 s71, s93, s72
  v_mfma_f32_16x16x32_bf16 v[36:39], a[100:103], a[64:67], v[36:39]
  buffer_load_dwordx2 v[6:7], v14, s[96:99], s91 offen sc1
  ds_read_b64_tr_b16 a[112:113], v18 offset:20480
  v_mfma_f32_16x16x32_bf16 v[52:55], a[100:103], a[68:71], v[52:55]
  s_add_u32 s64, s64, s66
  ds_read_b64_tr_b16 a[114:115], v18 offset:22528
  ds_read_b128 a[84:87], v16 offset:9216
  v_mfma_f32_16x16x32_bf16 v[68:71], a[100:103], a[72:75], v[68:71]
  s_add_u32 s65, s65, 1
  ds_read_b128 a[88:91], v17 offset:8192
  ds_read_b128 a[92:95], v17 offset:9216
  v_mfma_f32_16x16x32_bf16 v[84:87], a[100:103], a[76:79], v[84:87]
  s_cmp_eq_u32 s65, 4
  s_cselect_b32 s65, 0, s65
  s_cselect_b32 s66, s67, s68
  ds_read_b64_tr_b16 a[116:117], v19 offset:20480
  ds_read_b64_tr_b16 a[118:119], v19 offset:22528
  v_mfma_f32_16x16x32_bf16 v[40:43], a[104:107], a[64:67], v[40:43]
  ds_read_b64_tr_b16 a[120:121], v20 offset:20480
  ds_read_b64_tr_b16 a[122:123], v20 offset:22528
  v_mfma_f32_16x16x32_bf16 v[56:59], a[104:107], a[68:71], v[56:59]
  ds_read_b64_tr_b16 a[124:125], v21 offset:20480
  ds_read_b64_tr_b16 a[126:127], v21 offset:22528
  v_mfma_f32_16x16x32_bf16 v[72:75], a[104:107], a[72:75], v[72:75]
  v_add_u32 v16, s66, v16
  v_add_u32 v17, s66, v17
  v_mfma_f32_16x16x32_bf16 v[88:91], a[104:107], a[76:79], v[88:91]
  v_add_u32 v18, s66, v18
  v_add_u32 v19, s66, v19
  v_mfma_f32_16x16x32_bf16 v[44:47], a[108:111], a[64:67], v[44:47]
  v_add_u32 v20, s66, v20
  v_add_u32 v21, s66, v21
  v_mfma_f32_16x16x32_bf16 v[60:63], a[108:111], a[68:71], v[60:63]
  v_mfma_f32_16x16x32_bf16 v[76:79], a[108:111], a[72:75], v[76:79]
  v_mfma_f32_16x16x32_bf16 v[92:95], a[108:111], a[76:79], v[92:95]
  s_waitcnt vmcnt(0) lgkmcnt(0)
  s_barrier
  s_mov_b32 s5, 0x40000
Lpoll_9:
  v_cmp_ne_u64 vcc, s[94:95], v[6:7]
  s_nop 0
  s_cbranch_vccz Lpolld_10
  s_sleep 4
  buffer_load_dwordx2 v[6:7], v14, s[96:99], s91 offen sc1
  s_sub_u32 s5, s5, 1
  s_waitcnt vmcnt(0)
  s_cbranch_scc0 Lpoll_9
Lpolld_10:
  s_add_u32 s8, s86, 67108864
  s_addc_u32 s9, s87, 0
  s_mov_b32 s10, 16777216
  s_mov_b32 s11, 0x00020000
  s_lshl_b32 s92, s73, 1
  s_add_u32 s92, s92, s77
  s_lshl_b32 s92, s92, 19
  s_add_u32 s92, s92, s79
  s_add_u32 s72, s73, s76
  s_and_b32 s1, s72, 3
  s_lshl_b32 s1, s1, 3
  s_or_b32 s1, s1, 0x80000
  s_bfe_u32 s0, 0x1b1b02, s1
  s_add_u32 s0, s0, 0
  s_cmp_ge_u32 s0, 28
  s_cselect_b32 s72, 28, 0
  s_sub_u32 s0, s0, s72
  s_lshl_b32 s72, s0, 14
  s_add_u32 s70, s92, s72
  v_mfma_f32_16x16x32_bf16 v[32:35], a[112:115], a[80:83], v[32:35]
  s_add_u32 m0, s79, 131072
  v_mfma_f32_16x16x32_bf16 v[48:51], a[112:115], a[84:87], v[48:51]
  buffer_load_dwordx4 v2, s[8:11], s70 offen offset:0 sc1 lds
  v_mfma_f32_16x16x32_bf16 v[64:67], a[112:115], a[88:91], v[64:67]
  buffer_load_dwordx4 v2, s[8:11], s70 offen offset:1024 sc1 lds
  v_mfma_f32_16x16x32_bf16 v[80:83], a[112:115], a[92:95], v[80:83]
  buffer_load_dwordx4 v2, s[8:11], s70 offen offset:2048 sc1 lds
  v_mfma_f32_16x16x32_bf16 v[36:39], a[116:119], a[80:83], v[36:39]
  buffer_load_dwordx4 v2, s[8:11], s70 offen offset:3072 sc1 lds
  v_mfma_f32_16x16x32_bf16 v[52:55], a[116:119], a[84:87], v[52:55]
  s_bfe_u32 s72, 0x302011a, s1
  s_add_u32 s0, s0, s72
  s_add_u32 s1, s1, 8
  v_mfma_f32_16x16x32_bf16 v[68:71], a[116:119], a[88:91], v[68:71]
  s_and_b32 s1, s1, 0x8001f
  s_cmp_ge_u32 s0, 28
  s_cselect_b32 s72, 28, 0
  v_mfma_f32_16x16x32_bf16 v[84:87], a[116:119], a[92:95], v[84:87]
  s_sub_u32 s0, s0, s72
  s_lshl_b32 s72, s0, 14
  s_add_u32 s70, s92, s72
  v_mfma_f32_16x16x32_bf16 v[40:43], a[120:123], a[80:83], v[40:43]
  s_add_u32 m0, s79, 32768
  v_mfma_f32_16x16x32_bf16 v[56:59], a[120:123], a[84:87], v[56:59]
  buffer_load_dwordx4 v2, s[8:11], s70 offen offset:0 sc1 lds
  v_mfma_f32_16x16x32_bf16 v[72:75], a[120:123], a[88:91], v[72:75]
  buffer_load_dwordx4 v2, s[8:11], s70 offen offset:1024 sc1 lds
  v_mfma_f32_16x16x32_bf16 v[88:91], a[120:123], a[92:95], v[88:91]
  buffer_load_dwordx4 v2, s[8:11], s70 offen offset:2048 sc1 lds
  v_mfma_f32_16x16x32_bf16 v[44:47], a[124:127], a[80:83], v[44:47]
  buffer_load_dwordx4 v2, s[8:11], s70 offen offset:3072 sc1 lds
  v_mfma_f32_16x16x32_bf16 v[60:63], a[124:127], a[84:87], v[60:63]
  s_bfe_u32 s72, 0x302011a, s1
  s_add_u32 s0, s0, s72
  s_add_u32 s1, s1, 8
  v_mfma_f32_16x16x32_bf16 v[76:79], a[124:127], a[88:91], v[76:79]
  s_and_b32 s1, s1, 0x8001f
  s_cmp_ge_u32 s0, 28
  s_cselect_b32 s72, 28, 0
  v_mfma_f32_16x16x32_bf16 v[92:95], a[124:127], a[92:95], v[92:95]
  s_sub_u32 s0, s0, s72
  s_lshl_b32 s72, s0, 14
  s_add_u32 s70, s92, s72
  s_add_u32 m0, s79, 65536
  s_nop 0
  buffer_load_dwordx4 v2, s[8:11], s70 offen offset:0 sc1 lds
  buffer_load_dwordx4 v2, s[8:11], s70 offen offset:1024 sc1 lds
  buffer_load_dwordx4 v2, s[8:11], s70 offen offset:2048 sc1 lds
  buffer_load_dwordx4 v2, s[8:11], s70 offen offset:3072 sc1 lds
  s_bfe_u32 s72, 0x302011a, s1
  s_add_u32 s0, s0, s72
  s_add_u32 s1, s1, 8
  s_and_b32 s1, s1, 0x8001f
  s_cmp_ge_u32 s0, 28
  s_cselect_b32 s72, 28, 0
  s_sub_u32 s0, s0, s72
  s_lshl_b32 s72, s0, 14
  s_add_u32 s70, s92, s72
  s_add_u32 m0, s79, 114688
  s_nop 0
  buffer_load_dwordx4 v10, s[12:15], s71 offen offset:0 lds
  buffer_load_dwordx4 v11, s[12:15], s71 offen offset:1024 lds
  buffer_load_dwordx4 v12, s[12:15], s71 offen offset:2048 lds
  buffer_load_dwordx4 v13, s[12:15], s71 offen offset:3072 lds
  s_bfe_u32 s72, 0x302011a, s31
  s_add_u32 s30, s30, s72
  s_add_u32 s31, s31, 8
  s_and_b32 s31, s31, 0x8001f
  s_cmp_ge_u32 s30, 28
  s_cselect_b32 s72, 28, 0
  s_sub_u32 s30, s30, s72
  s_lshl_b32 s72, s30, 17
  s_add_u32 s71, s93, s72
  s_add_u32 m0, s79, 98304
  s_nop 0
  buffer_load_dwordx4 v2, s[8:11], s70 offen offset:0 sc1 lds
  buffer_load_dwordx4 v2, s[8:11], s70 offen offset:1024 sc1 lds
  buffer_load_dwordx4 v2, s[8:11], s70 offen offset:2048 sc1 lds
  buffer_load_dwordx4 v2, s[8:11], s70 offen offset:3072 sc1 lds
  s_bfe_u32 s72, 0x302011a, s1
  s_add_u32 s0, s0, s72
  s_add_u32 s1, s1, 8
  s_and_b32 s1, s1, 0x8001f
  s_cmp_ge_u32 s0, 28
  s_cselect_b32 s72, 28, 0
  s_sub_u32 s0, s0, s72
  s_lshl_b32 s72, s0, 14
  s_add_u32 s70, s92, s72
  s_lshl_b32 s6, s78, 1
  s_add_u32 s6, s6, s77
  s_xor_b32 s6, s6, 1
  s_lshl_b32 s6, s6, 2
  s_add_u32 s6, s6, s3
  s_lshl_b32 s6, s6, 13
  s_add_u32 s6, s6, 8388608
  s_add_u32 s7, s6, 4096
  buffer_store_dwordx4 v[64:67], v2, s[16:19], s6 offen offset:0 sc1
  buffer_store_dwordx4 v[68:71], v2, s[16:19], s6 offen offset:1024 sc1
  buffer_store_dwordx4 v[72:75], v2, s[16:19], s6 offen offset:2048 sc1
  buffer_store_dwordx4 v[76:79], v2, s[16:19], s6 offen offset:3072 sc1
  buffer_store_dwordx4 v[80:83], v2, s[16:19], s7 offen offset:0 sc1
  buffer_store_dwordx4 v[84:87], v2, s[16:19], s7 offen offset:1024 sc1
  buffer_store_dwordx4 v[88:91], v2, s[16:19], s7 offen offset:2048 sc1
  buffer_store_dwordx4 v[92:95], v2, s[16:19], s7 offen offset:3072 sc1
  s_waitcnt vmcnt(24)
  s_barrier
  ds_read_b128 a[64:67], v16 offset:0
  ds_read_b64_tr_b16 a[96:97], v18 offset:16384
  ds_read_b64_tr_b16 a[98:99], v18 offset:18432
  ds_read_b128 a[68:71], v16 offset:1024
  ds_read_b128 a[72:75], v17 offset:0
  ds_read_b128 a[76:79], v17 offset:1024
  ds_read_b64_tr_b16 a[100:101], v19 offset:16384
  ds_read_b64_tr_b16 a[102:103], v19 offset:18432
  ds_read_b64_tr_b16 a[104:105], v20 offset:16384
  ds_read_b64_tr_b16 a[106:107], v20 offset:18432
  ds_read_b64_tr_b16 a[108:109], v21 offset:16384
  ds_read_b64_tr_b16 a[110:111], v21 offset:18432
  s_waitcnt lgkmcnt(0)
  v_mfma_f32_16x16x32_bf16 v[96:99], a[96:99], a[64:67], 0
  s_add_u32 s64, s64, s66
  ds_read_b128 a[80:83], v16 offset:8192
  ds_read_b64_tr_b16 a[112:113], v18 offset:20480
  v_mfma_f32_16x16x32_bf16 v[112:115], a[96:99], a[68:71], 0
  s_add_u32 s65, s65, 1
  ds_read_b64_tr_b16 a[114:115], v18 offset:22528
  ds_read_b128 a[84:87], v16 offset:9216
  v_mfma_f32_16x16x32_bf16 v[128:131], a[96:99], a[72:75], 0
  s_cmp_eq_u32 s65, 4
  s_cselect_b32 s65, 0, s65
  s_cselect_b32 s66, s67, s68
  ds_read_b128 a[88:91], v17 offset:8192
  ds_read_b128 a[92:95], v17 offset:9216
  v_mfma_f32_16x16x32_bf16 v[144:147], a[96:99], a[76:79], 0
  ds_read_b64_tr_b16 a[116:117], v19 offset:20480
  v_mfma_f32_16x16x32_bf16 v[100:103], a[100:103], a[64:67], 0
  ds_read_b64_tr_b16 a[118:119], v19 offset:22528
  ds_read_b64_tr_b16 a[120:121], v20 offset:20480
  v_mfma_f32_16x16x32_bf16 v[116:119], a[100:103], a[68:71], 0
  ds_read_b64_tr_b16 a[122:123], v20 offset:22528
  ds_read_b64_tr_b16 a[124:125], v21 offset:20480
  v_mfma_f32_16x16x32_bf16 v[132:135], a[100:103], a[72:75], 0
  ds_read_b64_tr_b16 a[126:127], v21 offset:22528
  v_mfma_f32_16x16x32_bf16 v[148:151], a[100:103], a[76:79], 0
  v_add_u32 v16, s66, v16
  v_add_u32 v17, s66, v17
  v_mfma_f32_16x16x32_bf16 v[104:107], a[104:107], a[64:67], 0
  v_add_u32 v18, s66, v18
  v_add_u32 v19, s66, v19
  v_mfma_f32_16x16x32_bf16 v[120:123], a[104:107], a[68:71], 0
  v_add_u32 v20, s66, v20
  v_add_u32 v21, s66, v21
  v_mfma_f32_16x16x32_bf16 v[136:139], a[104:107], a[72:75], 0
  v_mfma_f32_16x16x32_bf16 v[152:155], a[104:107], a[76:79], 0
  v_mfma_f32_16x16x32_bf16 v[108:111], a[108:111], a[64:67], 0
  v_mfma_f32_16x16x32_bf16 v[124:127], a[108:111], a[68:71], 0
  v_mfma_f32_16x16x32_bf16 v[140:143], a[108:111], a[72:75], 0
  v_mfma_f32_16x16x32_bf16 v[156:159], a[108:111], a[76:79], 0
Lp7:
  s_mov_b32 s69, 23
  s_waitcnt vmcnt(16) lgkmcnt(0)
  s_barrier
  .p2align 6
Lp7_loop:
  v_mfma_f32_16x16x32_bf16 v[96:99], a[112:115], a[80:83], v[96:99]
  s_add_u32 m0, s64, 16384
  ds_read_b128 a[64:67], v16 offset:0
  ds_read_b64_tr_b16 a[96:97], v18 offset:16384
  v_mfma_f32_16x16x32_bf16 v[112:115], a[112:115], a[84:87], v[112:115]
  buffer_load_dwordx4 v10, s[12:15], s71 offen offset:0 lds
  ds_read_b64_tr_b16 a[98:99], v18 offset:18432
  v_mfma_f32_16x16x32_bf16 v[128:131], a[112:115], a[88:91], v[128:131]
  ds_read_b128 a[68:71], v16 offset:1024
  ds_read_b128 a[72:75], v17 offset:0
  v_mfma_f32_16x16x32_bf16 v[144:147], a[112:115], a[92:95], v[144:147]
  buffer_load_dwordx4 v11, s[12:15], s71 offen offset:1024 lds
  ds_read_b128 a[76:79], v17 offset:1024
  v_mfma_f32_16x16x32_bf16 v[100:103], a[116:119], a[80:83], v[100:103]
  ds_read_b64_tr_b16 a[100:101], v19 offset:16384
  ds_read_b64_tr_b16 a[102:103], v19 offset:18432
  v_mfma_f32_16x16x32_bf16 v[116:119], a[116:119], a[84:87], v[116:119]
  ds_read_b64_tr_b16 a[104:105], v20 offset:16384
  ds_read_b64_tr_b16 a[106:107], v20 offset:18432
  v_mfma_f32_16x16x32_bf16 v[132:135], a[116:119], a[88:91], v[132:135]
  ds_read_b64_tr_b16 a[108:109], v21 offset:16384
  ds_read_b64_tr_b16 a[110:111], v21 offset:18432
  v_mfma_f32_16x16x32_bf16 v[148:151], a[116:119], a[92:95], v[148:151]
  buffer_load_dwordx4 v12, s[12:15], s71 offen offset:2048 lds
  v_mfma_f32_16x16x32_bf16 v[104:107], a[120:123], a[80:83], v[104:107]
  v_mfma_f32_16x16x32_bf16 v[120:123], a[120:123], a[84:87], v[120:123]
  v_mfma_f32_16x16x32_bf16 v[136:139], a[120:123], a[88:91], v[136:139]
  v_mfma_f32_16x16x32_bf16 v[152:155], a[120:123], a[92:95], v[152:155]
  buffer_load_dwordx4 v13, s[12:15], s71 offen offset:3072 lds
  v_mfma_f32_16x16x32_bf16 v[108:111], a[124:127], a[80:83], v[108:111]
  s_bfe_u32 s72, 0x302011a, s31
  s_add_u32 s30, s30, s72
  s_add_u32 s31, s31, 8
  v_mfma_f32_16x16x32_bf16 v[124:127], a[124:127], a[84:87], v[124:127]
  s_and_b32 s31, s31, 0x8001f
  s_cmp_ge_u32 s30, 28
  s_cselect_b32 s72, 28, 0
  v_mfma_f32_16x16x32_bf16 v[140:143], a[124:127], a[88:91], v[140:143]
  s_sub_u32 s30, s30, s72
  s_lshl_b32 s72, s30, 17
  s_add_u32 s71, s93, s72
  v_mfma_f32_16x16x32_bf16 v[156:159], a[124:127], a[92:95], v[156:159]
  s_waitcnt lgkmcnt(0)
  v_mfma_f32_16x16x32_bf16 v[96:99], a[96:99], a[64:67], v[96:99]
  s_mov_b32 m0, s64
  ds_read_b128 a[80:83], v16 offset:8192
  ds_read_b64_tr_b16 a[112:113], v18 offset:20480
  v_mfma_f32_16x16x32_bf16 v[112:115], a[96:99], a[68:71], v[112:115]
  buffer_load_dwordx4 v2, s[8:11], s70 offen offset:0 sc1 lds
  ds_read_b64_tr_b16 a[114:115], v18 offset:22528
  v_mfma_f32_16x16x32_bf16 v[128:131], a[96:99], a[72:75], v[128:131]
  buffer_load_dwordx4 v2, s[8:11], s70 offen offset:1024 sc1 lds
  ds_read_b128 a[84:87], v16 offset:9216
  v_mfma_f32_16x16x32_bf16 v[144:147], a[96:99], a[76:79], v[144:147]
  ds_read_b128 a[88:91], v17 offset:8192
  ds_read_b128 a[92:95], v17 offset:9216
  v_mfma_f32_16x16x32_bf16 v[100:103], a[100:103], a[64:67], v[100:103]
  buffer_load_dwordx4 v2, s[8:11], s70 offen offset:2048 sc1 lds
  ds_read_b64_tr_b16 a[116:117], v19 offset:20480
  v_mfma_f32_16x16x32_bf16 v[116:119], a[100:103], a[68:71], v[116:119]
  ds_read_b64_tr_b16 a[118:119], v19 offset:22528
  ds_read_b64_tr_b16 a[120:121], v20 offset:20480
  v_mfma_f32_16x16x32_bf16 v[132:135], a[100:103], a[72:75], v[132:135]
  buffer_load_dwordx4 v2, s[8:11], s70 offen offset:3072 sc1 lds
  ds_read_b64_tr_b16 a[122:123], v20 offset:22528
  v_mfma_f32_16x16x32_bf16 v[148:151], a[100:103], a[76:79], v[148:151]
  s_bfe_u32 s72, 0x302011a, s1
  s_add_u32 s0, s0, s72
  s_add_u32 s1, s1, 8
  v_mfma_f32_16x16x32_bf16 v[104:107], a[104:107], a[64:67], v[104:107]
  s_and_b32 s1, s1, 0x8001f
  s_cmp_ge_u32 s0, 28
  s_cselect_b32 s72, 28, 0
  v_mfma_f32_16x16x32_bf16 v[120:123], a[104:107], a[68:71], v[120:123]
  s_sub_u32 s0, s0, s72
  s_lshl_b32 s72, s0, 14
  s_add_u32 s70, s92, s72
  v_mfma_f32_16x16x32_bf16 v[136:139], a[104:107], a[72:75], v[136:139]
  s_add_u32 s64, s64, s66
  ds_read_b64_tr_b16 a[124:125], v21 offset:20480
  ds_read_b64_tr_b16 a[126:127], v21 offset:22528
  v_mfma_f32_16x16x32_bf16 v[152:155], a[104:107], a[76:79], v[152:155]
  s_add_u32 s65, s65, 1
  s_cmp_eq_u32 s65, 4
  s_cselect_b32 s65, 0, s65
  s_cselect_b32 s66, s67, s68
  v_mfma_f32_16x16x32_bf16 v[108:111], a[108:111], a[64:67], v[108:111]
  v_add_u32 v16, s66, v16
  v_add_u32 v17, s66, v17
  v_mfma_f32_16x16x32_bf16 v[124:127], a[108:111], a[68:71], v[124:127]
  s_waitcnt vmcnt(16) lgkmcnt(0)
  s_barrier
  v_add_u32 v18, s66, v18
  v_add_u32 v19, s66, v19
  v_mfma_f32_16x16x32_bf16 v[140:143], a[108:111], a[72:75], v[140:143]
  s_sub_u32 s69, s69, 1
  v_add_u32 v20, s66, v20
  v_add_u32 v21, s66, v21
  v_mfma_f32_16x16x32_bf16 v[156:159], a[108:111], a[76:79], v[156:159]
  s_cmp_lg_u32 s69, 0
  s_cbranch_scc1 Lp7_loop
  s_lshl_b32 s6, s78, 1
  s_add_u32 s6, s6, s77
  s_lshl_b32 s6, s6, 7
  s_add_u32 s6, s6, 163840
  v_mov_b32 v8, 0x40000000
  v_mov_b32 v6, s94
  v_cmp_eq_u32 vcc, 0, v0
  v_mov_b32 v7, s95
  s_nop 0
  v_cndmask_b32_e64 v8, v8, 0, vcc
  buffer_store_dwordx2 v[6:7], v8, s[96:99], s6 offen sc1
  s_lshl_b32 s90, s78, 1
  s_add_u32 s90, s90, s77
  s_xor_b32 s90, s90, 1
  s_lshl_b32 s90, s90, 7
  s_add_u32 s90, s90, 163840
  s_mov_b32 s20, s82
  s_mov_b32 s21, s83
  s_mov_b32 s22, 8388608
  s_mov_b32 s23, 0x00020000
  v_bfe_u32 v25, v1, 4, 1
  v_lshrrev_b32 v26, 5, v1
  v_lshl_or_b32 v25, v25, 1, v26
  v_lshlrev_b32 v25, 4, v25
  v_and_b32 v24, 15, v1
  v_lshl_add_u32 v26, v24, 14, v25
  v_lshl_add_u32 v27, v24, 12, v25
  v_mfma_f32_16x16x32_bf16 v[96:99], a[112:115], a[80:83], v[96:99]
  s_add_u32 m0, s64, 16384
  ds_read_b128 a[64:67], v16 offset:0
  ds_read_b64_tr_b16 a[96:97], v18 offset:16384
  v_mfma_f32_16x16x32_bf16 v[112:115], a[112:115], a[84:87], v[112:115]
  buffer_load_dwordx4 v10, s[12:15], s71 offen offset:0 lds
  ds_read_b64_tr_b16 a[98:99], v18 offset:18432
  v_mfma_f32_16x16x32_bf16 v[128:131], a[112:115], a[88:91], v[128:131]
  ds_read_b128 a[68:71], v16 offset:1024
  ds_read_b128 a[72:75], v17 offset:0
  v_mfma_f32_16x16x32_bf16 v[144:147], a[112:115], a[92:95], v[144:147]
  buffer_load_dwordx4 v11, s[12:15], s71 offen offset:1024 lds
  ds_read_b128 a[76:79], v17 offset:1024
  v_mfma_f32_16x16x32_bf16 v[100:103], a[116:119], a[80:83], v[100:103]
  ds_read_b64_tr_b16 a[100:101], v19 offset:16384
  ds_read_b64_tr_b16 a[102:103], v19 offset:18432
  v_mfma_f32_16x16x32_bf16 v[116:119], a[116:119], a[84:87], v[116:119]
  ds_read_b64_tr_b16 a[104:105], v20 offset:16384
  ds_read_b64_tr_b16 a[106:107], v20 offset:18432
  v_mfma_f32_16x16x32_bf16 v[132:135], a[116:119], a[88:91], v[132:135]
  ds_read_b64_tr_b16 a[108:109], v21 offset:16384
  ds_read_b64_tr_b16 a[110:111], v21 offset:18432
  v_mfma_f32_16x16x32_bf16 v[148:151], a[116:119], a[92:95], v[148:151]
  buffer_load_dwordx4 v12, s[12:15], s71 offen offset:2048 lds
  v_mfma_f32_16x16x32_bf16 v[104:107], a[120:123], a[80:83], v[104:107]
  v_mfma_f32_16x16x32_bf16 v[120:123], a[120:123], a[84:87], v[120:123]
  v_mfma_f32_16x16x32_bf16 v[136:139], a[120:123], a[88:91], v[136:139]
  v_mfma_f32_16x16x32_bf16 v[152:155], a[120:123], a[92:95], v[152:155]
  buffer_load_dwordx4 v13, s[12:15], s71 offen offset:3072 lds
  v_mfma_f32_16x16x32_bf16 v[108:111], a[124:127], a[80:83], v[108:111]
  s_bfe_u32 s72, 0x302011a, s31
  s_add_u32 s30, s30, s72
  s_add_u32 s31, s31, 8
  v_mfma_f32_16x16x32_bf16 v[124:127], a[124:127], a[84:87], v[124:127]
  s_and_b32 s31, s31, 0x8001f
  s_cmp_ge_u32 s30, 28
  s_cselect_b32 s72, 28, 0
  v_mfma_f32_16x16x32_bf16 v[140:143], a[124:127], a[88:91], v[140:143]
  s_sub_u32 s30, s30, s72
  s_lshl_b32 s72, s30, 17
  s_add_u32 s71, s93, s72
  v_mfma_f32_16x16x32_bf16 v[156:159], a[124:127], a[92:95], v[156:159]
  s_waitcnt lgkmcnt(0)
  v_mfma_f32_16x16x32_bf16 v[96:99], a[96:99], a[64:67], v[96:99]
  s_mov_b32 m0, s64
  ds_read_b128 a[80:83], v16 offset:8192
  ds_read_b64_tr_b16 a[112:113], v18 offset:20480
  v_mfma_f32_16x16x32_bf16 v[112:115], a[96:99], a[68:71], v[112:115]
  buffer_load_dwordx4 v2, s[8:11], s70 offen offset:0 sc1 lds
  ds_read_b64_tr_b16 a[114:115], v18 offset:22528
  v_mfma_f32_16x16x32_bf16 v[128:131], a[96:99], a[72:75], v[128:131]
  buffer_load_dwordx4 v2, s[8:11], s70 offen offset:1024 sc1 lds
  ds_read_b128 a[84:87], v16 offset:9216
  v_mfma_f32_16x16x32_bf16 v[144:147], a[96:99], a[76:79], v[144:147]
  ds_read_b128 a[88:91], v17 offset:8192
  ds_read_b128 a[92:95], v17 offset:9216
  v_mfma_f32_16x16x32_bf16 v[100:103], a[100:103], a[64:67], v[100:103]
  buffer_load_dwordx4 v2, s[8:11], s70 offen offset:2048 sc1 lds
  ds_read_b64_tr_b16 a[116:117], v19 offset:20480
  v_mfma_f32_16x16x32_bf16 v[116:119], a[100:103], a[68:71], v[116:119]
  ds_read_b64_tr_b16 a[118:119], v19 offset:22528
  ds_read_b64_tr_b16 a[120:121], v20 offset:20480
  v_mfma_f32_16x16x32_bf16 v[132:135], a[100:103], a[72:75], v[132:135]
  buffer_load_dwordx4 v2, s[8:11], s70 offen offset:3072 sc1 lds
  ds_read_b64_tr_b16 a[122:123], v20 offset:22528
  v_mfma_f32_16x16x32_bf16 v[148:151], a[100:103], a[76:79], v[148:151]
  s_bfe_u32 s72, 0x302011a, s1
  s_add_u32 s0, s0, s72
  s_add_u32 s1, s1, 8
  v_mfma_f32_16x16x32_bf16 v[104:107], a[104:107], a[64:67], v[104:107]
  s_and_b32 s1, s1, 0x8001f
  s_cmp_ge_u32 s0, 28
  s_cselect_b32 s72, 28, 0
  v_mfma_f32_16x16x32_bf16 v[120:123], a[104:107], a[68:71], v[120:123]
  s_sub_u32 s0, s0, s72
  s_lshl_b32 s72, s0, 14
  s_add_u32 s70, s92, s72
  v_mfma_f32_16x16x32_bf16 v[136:139], a[104:107], a[72:75], v[136:139]
  s_add_u32 s64, s64, s66
  ds_read_b64_tr_b16 a[124:125], v21 offset:20480
  ds_read_b64_tr_b16 a[126:127], v21 offset:22528
  v_mfma_f32_16x16x32_bf16 v[152:155], a[104:107], a[76:79], v[152:155]
  s_add_u32 s65, s65, 1
  s_cmp_eq_u32 s65, 4
  s_cselect_b32 s65, 0, s65
  s_cselect_b32 s66, s67, s68
  v_mfma_f32_16x16x32_bf16 v[108:111], a[108:111], a[64:67], v[108:111]
  v_add_u32 v16, s66, v16
  v_add_u32 v17, s66, v17
  v_mfma_f32_16x16x32_bf16 v[124:127], a[108:111], a[68:71], v[124:127]
  v_add_u32 v18, s66, v18
  v_add_u32 v19, s66, v19
  v_mfma_f32_16x16x32_bf16 v[140:143], a[108:111], a[72:75], v[140:143]
  v_add_u32 v20, s66, v20
  v_add_u32 v21, s66, v21
  v_mfma_f32_16x16x32_bf16 v[156:159], a[108:111], a[76:79], v[156:159]
  s_waitcnt vmcnt(17) lgkmcnt(0)
  s_barrier
  v_mfma_f32_16x16x32_bf16 v[96:99], a[112:115], a[80:83], v[96:99]
  buffer_load_dwordx2 v[6:7], off, s[96:99], s90 sc1
  ds_read_b128 a[64:67], v16 offset:0
  v_mfma_f32_16x16x32_bf16 v[112:115], a[112:115], a[84:87], v[112:115]
  s_and_b32 s88, s3, 1
  s_lshl_b32 s88, s88, 12
  s_lshr_b32 s72, s3, 1
  v_mfma_f32_16x16x32_bf16 v[128:131], a[112:115], a[88:91], v[128:131]
  s_lshl_b32 s72, s72, 13
  s_add_u32 s88, s88, s72
  s_lshl_b32 s72, s77, 11
  v_mfma_f32_16x16x32_bf16 v[144:147], a[112:115], a[92:95], v[144:147]
  s_add_u32 s88, s88, s72
  s_sub_u32 s88, s88, s79
  s_add_u32 s70, s92, s88
  v_mfma_f32_16x16x32_bf16 v[100:103], a[116:119], a[80:83], v[100:103]
  s_add_u32 s70, s70, 458752
  s_add_u32 s71, s93, 3670016
  s_add_u32 m0, s64, 16384
  v_mfma_f32_16x16x32_bf16 v[116:119], a[116:119], a[84:87], v[116:119]
  buffer_load_dwordx4 v10, s[12:15], s71 offen offset:0 lds
  ds_read_b64_tr_b16 a[96:97], v18 offset:16384
  v_mfma_f32_16x16x32_bf16 v[132:135], a[116:119], a[88:91], v[132:135]
  ds_read_b64_tr_b16 a[98:99], v18 offset:18432
  ds_read_b128 a[68:71], v16 offset:1024
  v_mfma_f32_16x16x32_bf16 v[148:151], a[116:119], a[92:95], v[148:151]
  buffer_load_dwordx4 v11, s[12:15], s71 offen offset:1024 lds
  ds_read_b128 a[72:75], v17 offset:0
  v_mfma_f32_16x16x32_bf16 v[104:107], a[120:123], a[80:83], v[104:107]
  ds_read_b128 a[76:79], v17 offset:1024
  ds_read_b64_tr_b16 a[100:101], v19 offset:16384
  v_mfma_f32_16x16x32_bf16 v[120:123], a[120:123], a[84:87], v[120:123]
  ds_read_b64_tr_b16 a[102:103], v19 offset:18432
  ds_read_b64_tr_b16 a[104:105], v20 offset:16384
  v_mfma_f32_16x16x32_bf16 v[136:139], a[120:123], a[88:91], v[136:139]
  ds_read_b64_tr_b16 a[106:107], v20 offset:18432
  ds_read_b64_tr_b16 a[108:109], v21 offset:16384
  v_mfma_f32_16x16x32_bf16 v[152:155], a[120:123], a[92:95], v[152:155]
  buffer_load_dwordx4 v12, s[12:15], s71 offen offset:2048 lds
  ds_read_b64_tr_b16 a[110:111], v21 offset:18432
  v_mfma_f32_16x16x32_bf16 v[108:111], a[124:127], a[80:83], v[108:111]
  v_mfma_f32_16x16x32_bf16 v[124:127], a[124:127], a[84:87], v[124:127]
  v_mfma_f32_16x16x32_bf16 v[140:143], a[124:127], a[88:91], v[140:143]
  v_mfma_f32_16x16x32_bf16 v[156:159], a[124:127], a[92:95], v[156:159]
  s_waitcnt lgkmcnt(0)
  v_mfma_f32_16x16x32_bf16 v[96:99], a[96:99], a[64:67], v[96:99]
  buffer_load_dwordx4 v13, s[12:15], s71 offen offset:3072 lds
  ds_read_b128 a[80:83], v16 offset:8192
  v_mfma_f32_16x16x32_bf16 v[112:115], a[96:99], a[68:71], v[112:115]
  s_add_u32 s71, s71, 131072
  s_add_u32 m0, s64, s88
  ds_read_b64_tr_b16 a[112:113], v18 offset:20480
  v_mfma_f32_16x16x32_bf16 v[128:131], a[96:99], a[72:75], v[128:131]
  ds_read_b64_tr_b16 a[114:115], v18 offset:22528
  ds_read_b128 a[84:87], v16 offset:9216
  v_mfma_f32_16x16x32_bf16 v[144:147], a[96:99], a[76:79], v[144:147]
  buffer_load_dwordx4 v2, s[8:11], s70 offen offset:0 sc1 lds
  ds_read_b128 a[88:91], v17 offset:8192
  v_mfma_f32_16x16x32_bf16 v[100:103], a[100:103], a[64:67], v[100:103]
  ds_read_b128 a[92:95], v17 offset:9216
  ds_read_b64_tr_b16 a[116:117], v19 offset:20480
  v_mfma_f32_16x16x32_bf16 v[116:119], a[100:103], a[68:71], v[116:119]
  ds_read_b64_tr_b16 a[118:119], v19 offset:22528
  ds_read_b64_tr_b16 a[120:121], v20 offset:20480
  v_mfma_f32_16x16x32_bf16 v[132:135], a[100:103], a[72:75], v[132:135]
  buffer_load_dwordx4 v2, s[8:11], s70 offen offset:1024 sc1 lds
  ds_read_b64_tr_b16 a[122:123], v20 offset:22528
  v_mfma_f32_16x16x32_bf16 v[148:151], a[100:103], a[76:79], v[148:151]
  s_add_u32 s70, s70, 16384
  ds_read_b64_tr_b16 a[124:125], v21 offset:20480
  ds_read_b64_tr_b16 a[126:127], v21 offset:22528
  v_mfma_f32_16x16x32_bf16 v[104:107], a[104:107], a[64:67], v[104:107]
  s_add_u32 s64, s64, s66
  s_add_u32 s65, s65, 1
  s_cmp_eq_u32 s65, 4
  s_cselect_b32 s65, 0, s65
  s_cselect_b32 s66, s67, s68
  v_mfma_f32_16x16x32_bf16 v[120:123], a[104:107], a[68:71], v[120:123]
  v_add_u32 v16, s66, v16
  v_add_u32 v17, s66, v17
  v_mfma_f32_16x16x32_bf16 v[136:139], a[104:107], a[72:75], v[136:139]
  v_add_u32 v18, s66, v18
  v_add_u32 v19, s66, v19
  v_mfma_f32_16x16x32_bf16 v[152:155], a[104:107], a[76:79], v[152:155]
  v_add_u32 v20, s66, v20
  v_add_u32 v21, s66, v21
  v_mfma_f32_16x16x32_bf16 v[108:111], a[108:111], a[64:67], v[108:111]
  v_mfma_f32_16x16x32_bf16 v[124:127], a[108:111], a[68:71], v[124:127]
  v_mfma_f32_16x16x32_bf16 v[140:143], a[108:111], a[72:75], v[140:143]
  v_mfma_f32_16x16x32_bf16 v[156:159], a[108:111], a[76:79], v[156:159]
  s_waitcnt vmcnt(6) lgkmcnt(0)
  s_barrier
  s_mov_b32 s5, 0x40000
Lpoll_11:
  v_cmp_ne_u64 vcc, s[94:95], v[6:7]
  s_nop 0
  s_cbranch_vccz Lpolld_12
  s_sleep 4
  buffer_load_dwordx2 v[6:7], off, s[96:99], s90 sc1
  s_sub_u32 s5, s5, 1
  s_waitcnt vmcnt(0)
  s_cbranch_scc0 Lpoll_11
Lpolld_12:
  v_mfma_f32_16x16x32_bf16 v[96:99], a[112:115], a[80:83], v[96:99]
  s_lshl_b32 s6, s78, 1
  s_add_u32 s6, s6, s77
  s_lshl_b32 s6, s6, 2
  v_mfma_f32_16x16x32_bf16 v[112:115], a[112:115], a[84:87], v[112:115]
  s_add_u32 s6, s6, s3
  s_lshl_b32 s6, s6, 13
  s_add_u32 s6, s6, 8388608
  v_mfma_f32_16x16x32_bf16 v[128:131], a[112:115], a[88:91], v[128:131]
  s_add_u32 s7, s6, 4096
  buffer_load_dwordx4 v[160:163], v2, s[16:19], s6 offen offset:0 sc1
  ds_read_b128 a[64:67], v16 offset:0
  v_mfma_f32_16x16x32_bf16 v[144:147], a[112:115], a[92:95], v[144:147]
  buffer_load_dwordx4 v[164:167], v2, s[16:19], s6 offen offset:1024 sc1
  ds_read_b64_tr_b16 a[96:97], v18 offset:16384
  v_mfma_f32_16x16x32_bf16 v[100:103], a[116:119], a[80:83], v[100:103]
  buffer_load_dwordx4 v[168:171], v2, s[16:19], s6 offen offset:2048 sc1
  ds_read_b64_tr_b16 a[98:99], v18 offset:18432
  v_mfma_f32_16x16x32_bf16 v[116:119], a[116:119], a[84:87], v[116:119]
  ds_read_b128 a[68:71], v16 offset:1024
  ds_read_b128 a[72:75], v17 offset:0
  v_mfma_f32_16x16x32_bf16 v[132:135], a[116:119], a[88:91], v[132:135]
  buffer_load_dwordx4 v[172:175], v2, s[16:19], s6 offen offset:3072 sc1
  ds_read_b128 a[76:79], v17 offset:1024
  v_mfma_f32_16x16x32_bf16 v[148:151], a[116:119], a[92:95], v[148:151]
  ds_read_b64_tr_b16 a[100:101], v19 offset:16384
  ds_read_b64_tr_b16 a[102:103], v19 offset:18432
  v_mfma_f32_16x16x32_bf16 v[104:107], a[120:123], a[80:83], v[104:107]
  buffer_load_dwordx4 v[176:179], v2, s[16:19], s7 offen offset:0 sc1
  ds_read_b64_tr_b16 a[104:105], v20 offset:16384
  v_mfma_f32_16x16x32_bf16 v[120:123], a[120:123], a[84:87], v[120:123]
  ds_read_b64_tr_b16 a[106:107], v20 offset:18432
  ds_read_b64_tr_b16 a[108:109], v21 offset:16384
  v_mfma_f32_16x16x32_bf16 v[136:139], a[120:123], a[88:91], v[136:139]
  buffer_load_dwordx4 v[180:183], v2, s[16:19], s7 offen offset:1024 sc1
  ds_read_b64_tr_b16 a[110:111], v21 offset:18432
  v_mfma_f32_16x16x32_bf16 v[152:155], a[120:123], a[92:95], v[152:155]
  v_mfma_f32_16x16x32_bf16 v[108:111], a[124:127], a[80:83], v[108:111]
  buffer_load_dwordx4 v[184:187], v2, s[16:19], s7 offen offset:2048 sc1
  v_mfma_f32_16x16x32_bf16 v[124:127], a[124:127], a[84:87], v[124:127]
  v_mfma_f32_16x16x32_bf16 v[140:143], a[124:127], a[88:91], v[140:143]
  v_mfma_f32_16x16x32_bf16 v[156:159], a[124:127], a[92:95], v[156:159]
  s_waitcnt lgkmcnt(0)
  v_mfma_f32_16x16x32_bf16 v[96:99], a[96:99], a[64:67], v[96:99]
  buffer_load_dwordx4 v[188:191], v2, s[16:19], s7 offen offset:3072 sc1
  ds_read_b128 a[80:83], v16 offset:8192
  v_mfma_f32_16x16x32_bf16 v[112:115], a[96:99], a[68:71], v[112:115]
  s_add_u32 m0, s64, 16384
  ds_read_b64_tr_b16 a[112:113], v18 offset:20480
  ds_read_b64_tr_b16 a[114:115], v18 offset:22528
  v_mfma_f32_16x16x32_bf16 v[128:131], a[96:99], a[72:75], v[128:131]
  buffer_load_dwordx4 v10, s[12:15], s71 offen offset:0 lds
  ds_read_b128 a[84:87], v16 offset:9216
  v_mfma_f32_16x16x32_bf16 v[144:147], a[96:99], a[76:79], v[144:147]
  buffer_load_dwordx4 v11, s[12:15], s71 offen offset:1024 lds
  ds_read_b128 a[88:91], v17 offset:8192
  v_mfma_f32_16x16x32_bf16 v[100:103], a[100:103], a[64:67], v[100:103]
  buffer_load_dwordx4 v12, s[12:15], s71 offen offset:2048 lds
  ds_read_b128 a[92:95], v17 offset:9216
  v_mfma_f32_16x16x32_bf16 v[116:119], a[100:103], a[68:71], v[116:119]
  buffer_load_dwordx4 v13, s[12:15], s71 offen offset:3072 lds
  ds_read_b64_tr_b16 a[116:117], v19 offset:20480
  v_mfma_f32_16x16x32_bf16 v[132:135], a[100:103], a[72:75], v[132:135]
  s_add_u32 s71, s71, 131072
  s_add_u32 m0, s64, s88
  ds_read_b64_tr_b16 a[118:119], v19 offset:22528
  v_mfma_f32_16x16x32_bf16 v[148:151], a[100:103], a[76:79], v[148:151]
  buffer_load_dwordx4 v2, s[8:11], s70 offen offset:0 sc1 lds
  ds_read_b64_tr_b16 a[120:121], v20 offset:20480
  v_mfma_f32_16x16x32_bf16 v[104:107], a[104:107], a[64:67], v[104:107]
  buffer_load_dwordx4 v2, s[8:11], s70 offen offset:1024 sc1 lds
  ds_read_b64_tr_b16 a[122:123], v20 offset:22528
  v_mfma_f32_16x16x32_bf16 v[120:123], a[104:107], a[68:71], v[120:123]
  s_add_u32 s70, s70, 16384
  ds_read_b64_tr_b16 a[124:125], v21 offset:20480
  ds_read_b64_tr_b16 a[126:127], v21 offset:22528
  v_mfma_f32_16x16x32_bf16 v[136:139], a[104:107], a[72:75], v[136:139]
  s_add_u32 s64, s64, s66
  s_add_u32 s65, s65, 1
  s_cmp_eq_u32 s65, 4
  s_cselect_b32 s65, 0, s65
  s_cselect_b32 s66, s67, s68
  v_mfma_f32_16x16x32_bf16 v[152:155], a[104:107], a[76:79], v[152:155]
  v_add_u32 v16, s66, v16
  v_add_u32 v17, s66, v17
  v_mfma_f32_16x16x32_bf16 v[108:111], a[108:111], a[64:67], v[108:111]
  v_add_u32 v18, s66, v18
  v_add_u32 v19, s66, v19
  v_mfma_f32_16x16x32_bf16 v[124:127], a[108:111], a[68:71], v[124:127]
  v_add_u32 v20, s66, v20
  v_add_u32 v21, s66, v21
  v_mfma_f32_16x16x32_bf16 v[140:143], a[108:111], a[72:75], v[140:143]
  v_mfma_f32_16x16x32_bf16 v[156:159], a[108:111], a[76:79], v[156:159]
  s_waitcnt vmcnt(20) lgkmcnt(0)
  s_barrier
  v_mfma_f32_16x16x32_bf16 v[96:99], a[112:115], a[80:83], v[96:99]
  s_add_u32 m0, s64, 16384
  ds_read_b128 a[64:67], v16 offset:0
  ds_read_b64_tr_b16 a[96:97], v18 offset:16384
  v_mfma_f32_16x16x32_bf16 v[112:115], a[112:115], a[84:87], v[112:115]
  buffer_load_dwordx4 v10, s[12:15], s71 offen offset:0 lds
  ds_read_b64_tr_b16 a[98:99], v18 offset:18432
  v_mfma_f32_16x16x32_bf16 v[128:131], a[112:115], a[88:91], v[128:131]
  ds_read_b128 a[68:71], v16 offset:1024
  ds_read_b128 a[72:75], v17 offset:0
  v_mfma_f32_16x16x32_bf16 v[144:147], a[112:115], a[92:95], v[144:147]
  ds_read_b128 a[76:79], v17 offset:1024
  ds_read_b64_tr_b16 a[100:101], v19 offset:16384
  v_mfma_f32_16x16x32_bf16 v[100:103], a[116:119], a[80:83], v[100:103]
  ds_read_b64_tr_b16 a[102:103], v19 offset:18432
  ds_read_b64_tr_b16 a[104:105], v20 offset:16384
  v_mfma_f32_16x16x32_bf16 v[116:119], a[116:119], a[84:87], v[116:119]
  buffer_load_dwordx4 v11, s[12:15], s71 offen offset:1024 lds
  ds_read_b64_tr_b16 a[106:107], v20 offset:18432
  v_mfma_f32_16x16x32_bf16 v[132:135], a[116:119], a[88:91], v[132:135]
  ds_read_b64_tr_b16 a[108:109], v21 offset:16384
  ds_read_b64_tr_b16 a[110:111], v21 offset:18432
  v_mfma_f32_16x16x32_bf16 v[148:151], a[116:119], a[92:95], v[148:151]
  v_mfma_f32_16x16x32_bf16 v[104:107], a[120:123], a[80:83], v[104:107]
  v_mfma_f32_16x16x32_bf16 v[120:123], a[120:123], a[84:87], v[120:123]
  v_mfma_f32_16x16x32_bf16 v[136:139], a[120:123], a[88:91], v[136:139]
  buffer_load_dwordx4 v12, s[12:15], s71 offen offset:2048 lds
  v_mfma_f32_16x16x32_bf16 v[152:155], a[120:123], a[92:95], v[152:155]
  v_mfma_f32_16x16x32_bf16 v[108:111], a[124:127], a[80:83], v[108:111]
  v_mfma_f32_16x16x32_bf16 v[124:127], a[124:127], a[84:87], v[124:127]
  v_mfma_f32_16x16x32_bf16 v[140:143], a[124:127], a[88:91], v[140:143]
  v_mfma_f32_16x16x32_bf16 v[156:159], a[124:127], a[92:95], v[156:159]
  s_waitcnt lgkmcnt(0)
  v_mfma_f32_16x16x32_bf16 v[96:99], a[96:99], a[64:67], v[96:99]
  buffer_load_dwordx4 v13, s[12:15], s71 offen offset:3072 lds
  ds_read_b128 a[80:83], v16 offset:8192
  v_mfma_f32_16x16x32_bf16 v[112:115], a[96:99], a[68:71], v[112:115]
  s_add_u32 s71, s71, 131072
  s_add_u32 m0, s64, s88
  ds_read_b64_tr_b16 a[112:113], v18 offset:20480
  v_mfma_f32_16x16x32_bf16 v[128:131], a[96:99], a[72:75], v[128:131]
  ds_read_b64_tr_b16 a[114:115], v18 offset:22528
  ds_read_b128 a[84:87], v16 offset:9216
  v_mfma_f32_16x16x32_bf16 v[144:147], a[96:99], a[76:79], v[144:147]
  buffer_load_dwordx4 v2, s[8:11], s70 offen offset:0 sc1 lds
  ds_read_b128 a[88:91], v17 offset:8192
  v_mfma_f32_16x16x32_bf16 v[100:103], a[100:103], a[64:67], v[100:103]
  ds_read_b128 a[92:95], v17 offset:9216
  ds_read_b64_tr_b16 a[116:117], v19 offset:20480
  v_mfma_f32_16x16x32_bf16 v[116:119], a[100:103], a[68:71], v[116:119]
  ds_read_b64_tr_b16 a[118:119], v19 offset:22528
  ds_read_b64_tr_b16 a[120:121], v20 offset:20480
  v_mfma_f32_16x16x32_bf16 v[132:135], a[100:103], a[72:75], v[132:135]
  buffer_load_dwordx4 v2, s[8:11], s70 offen offset:1024 sc1 lds
  ds_read_b64_tr_b16 a[122:123], v20 offset:22528
  v_mfma_f32_16x16x32_bf16 v[148:151], a[100:103], a[76:79], v[148:151]
  s_add_u32 s70, s70, 16384
  ds_read_b64_tr_b16 a[124:125], v21 offset:20480
  ds_read_b64_tr_b16 a[126:127], v21 offset:22528
  v_mfma_f32_16x16x32_bf16 v[104:107], a[104:107], a[64:67], v[104:107]
  s_add_u32 s64, s64, s66
  s_add_u32 s65, s65, 1
  s_cmp_eq_u32 s65, 4
  s_cselect_b32 s65, 0, s65
  s_cselect_b32 s66, s67, s68
  v_mfma_f32_16x16x32_bf16 v[120:123], a[104:107], a[68:71], v[120:123]
  v_add_u32 v16, s66, v16
  v_add_u32 v17, s66, v17
  v_mfma_f32_16x16x32_bf16 v[136:139], a[104:107], a[72:75], v[136:139]
  v_add_u32 v18, s66, v18
  v_add_u32 v19, s66, v19
  v_mfma_f32_16x16x32_bf16 v[152:155], a[104:107], a[76:79], v[152:155]
  v_add_u32 v20, s66, v20
  v_add_u32 v21, s66, v21
  v_mfma_f32_16x16x32_bf16 v[108:111], a[108:111], a[64:67], v[108:111]
  v_mfma_f32_16x16x32_bf16 v[124:127], a[108:111], a[68:71], v[124:127]
  v_mfma_f32_16x16x32_bf16 v[140:143], a[108:111], a[72:75], v[140:143]
  v_mfma_f32_16x16x32_bf16 v[156:159], a[108:111], a[76:79], v[156:159]
  s_waitcnt vmcnt(12) lgkmcnt(0)
  s_barrier
  s_lshl_b32 s4, s73, 19
  s_lshl_b32 s72, s76, 8
  s_add_u32 s4, s4, s72
  s_and_b32 s72, s3, 1
  s_lshl_b32 s72, s72, 7
  s_add_u32 s4, s4, s72
  s_lshr_b32 s72, s3, 1
  s_lshl_b32 s72, s72, 1
  s_add_u32 s72, s72, s77
  s_lshl_b32 s72, s72, 17
  s_add_u32 s4, s4, s72
  s_add_u32 s4, s4, 2048
  s_add_u32 s5, s4, 65536
  s_lshl_b32 s89, s78, 1
  s_add_u32 s89, s89, s77
  s_lshl_b32 s89, s89, 7
  s_add_u32 s89, s89, 131072
  s_lshl_b32 s90, s78, 1
  s_add_u32 s90, s90, s77
  s_xor_b32 s90, s90, 1
  s_lshl_b32 s90, s90, 7
  s_add_u32 s90, s90, 131072
  v_mfma_f32_16x16x32_bf16 v[96:99], a[112:115], a[80:83], v[96:99]
  s_add_u32 m0, s64, 16384
  ds_read_b128 a[64:67], v16 offset:0
  ds_read_b64_tr_b16 a[96:97], v18 offset:16384
  v_mfma_f32_16x16x32_bf16 v[112:115], a[112:115], a[84:87], v[112:115]
  buffer_load_dwordx4 v10, s[12:15], s71 offen offset:0 lds
  ds_read_b64_tr_b16 a[98:99], v18 offset:18432
  v_mfma_f32_16x16x32_bf16 v[128:131], a[112:115], a[88:91], v[128:131]
  buffer_load_dwordx4 v11, s[12:15], s71 offen offset:1024 lds
  ds_read_b128 a[68:71], v16 offset:1024
  v_mfma_f32_16x16x32_bf16 v[144:147], a[112:115], a[92:95], v[144:147]
  ds_read_b64_tr_b16 a[100:101], v19 offset:16384
  ds_read_b64_tr_b16 a[102:103], v19 offset:18432
  v_mfma_f32_16x16x32_bf16 v[100:103], a[116:119], a[80:83], v[100:103]
  ds_read_b64_tr_b16 a[104:105], v20 offset:16384
  ds_read_b64_tr_b16 a[106:107], v20 offset:18432
  v_mfma_f32_16x16x32_bf16 v[116:119], a[116:119], a[84:87], v[116:119]
  buffer_load_dwordx4 v12, s[12:15], s71 offen offset:2048 lds
  ds_read_b64_tr_b16 a[108:109], v21 offset:16384
  v_mfma_f32_16x16x32_bf16 v[132:135], a[116:119], a[88:91], v[132:135]
  ds_read_b64_tr_b16 a[110:111], v21 offset:18432
  v_mfma_f32_16x16x32_bf16 v[148:151], a[116:119], a[92:95], v[148:151]
  buffer_load_dwordx4 v13, s[12:15], s71 offen offset:3072 lds
  v_mfma_f32_16x16x32_bf16 v[104:107], a[120:123], a[80:83], v[104:107]
  s_add_u32 s71, s71, 131072
  s_add_u32 m0, s64, s88
  v_mfma_f32_16x16x32_bf16 v[120:123], a[120:123], a[84:87], v[120:123]
  v_mfma_f32_16x16x32_bf16 v[136:139], a[120:123], a[88:91], v[136:139]
  buffer_load_dwordx4 v2, s[8:11], s70 offen offset:0 sc1 lds
  v_mfma_f32_16x16x32_bf16 v[152:155], a[120:123], a[92:95], v[152:155]
  v_mfma_f32_16x16x32_bf16 v[108:111], a[124:127], a[80:83], v[108:111]
  buffer_load_dwordx4 v2, s[8:11], s70 offen offset:1024 sc1 lds
  v_mfma_f32_16x16x32_bf16 v[124:127], a[124:127], a[84:87], v[124:127]
  s_add_u32 s70, s70, 16384
  s_lshl_b32 s6, s78, 1
  s_add_u32 s6, s6, s77
  v_mfma_f32_16x16x32_bf16 v[140:143], a[124:127], a[88:91], v[140:143]
  s_xor_b32 s6, s6, 1
  s_lshl_b32 s6, s6, 2
  s_add_u32 s6, s6, s3
  v_mfma_f32_16x16x32_bf16 v[156:159], a[124:127], a[92:95], v[156:159]
  s_lshl_b32 s6, s6, 13
  s_add_u32 s7, s6, 4096
  s_waitcnt lgkmcnt(0)
  v_mfma_f32_16x16x32_bf16 v[96:99], a[96:99], a[64:67], v[96:99]
  buffer_store_dwordx4 v[128:131], v2, s[16:19], s6 offen offset:0 sc1
  ds_read_b128 a[80:83], v16 offset:8192
  v_mfma_f32_16x16x32_bf16 v[112:115], a[96:99], a[68:71], v[112:115]
  buffer_store_dwordx4 v[132:135], v2, s[16:19], s6 offen offset:1024 sc1
  ds_read_b64_tr_b16 a[112:113], v18 offset:20480
  v_mfma_f32_16x16x32_bf16 v[100:103], a[100:103], a[64:67], v[100:103]
  ds_read_b64_tr_b16 a[114:115], v18 offset:22528
  ds_read_b128 a[84:87], v16 offset:9216
  v_mfma_f32_16x16x32_bf16 v[116:119], a[100:103], a[68:71], v[116:119]
  buffer_store_dwordx4 v[136:139], v2, s[16:19], s6 offen offset:2048 sc1
  ds_read_b64_tr_b16 a[116:117], v19 offset:20480
  v_mfma_f32_16x16x32_bf16 v[104:107], a[104:107], a[64:67], v[104:107]
  ds_read_b64_tr_b16 a[118:119], v19 offset:22528
  ds_read_b64_tr_b16 a[120:121], v20 offset:20480
  v_mfma_f32_16x16x32_bf16 v[120:123], a[104:107], a[68:71], v[120:123]
  buffer_store_dwordx4 v[140:143], v2, s[16:19], s6 offen offset:3072 sc1
  ds_read_b64_tr_b16 a[122:123], v20 offset:22528
  v_mfma_f32_16x16x32_bf16 v[108:111], a[108:111], a[64:67], v[108:111]
  s_add_u32 s64, s64, s66
  ds_read_b64_tr_b16 a[124:125], v21 offset:20480
  ds_read_b64_tr_b16 a[126:127], v21 offset:22528
  v_mfma_f32_16x16x32_bf16 v[124:127], a[108:111], a[68:71], v[124:127]
  s_add_u32 s65, s65, 1
  s_cmp_eq_u32 s65, 4
  s_cselect_b32 s65, 0, s65
  s_cselect_b32 s66, s67, s68
  v_add_u32 v16, s66, v16
  v_add_u32 v17, s66, v17
  v_add_u32 v18, s66, v18
  v_add_u32 v19, s66, v19
  v_add_u32 v20, s66, v20
  v_add_u32 v21, s66, v21
  s_waitcnt vmcnt(16) lgkmcnt(0)
  s_barrier
  v_mfma_f32_16x16x32_bf16 v[96:99], a[112:115], a[80:83], v[96:99]
  buffer_store_dwordx4 v[144:147], v2, s[16:19], s7 offen offset:0 sc1
  ds_read_b128 a[64:67], v16 offset:0
  v_mfma_f32_16x16x32_bf16 v[112:115], a[112:115], a[84:87], v[112:115]
  buffer_store_dwordx4 v[148:151], v2, s[16:19], s7 offen offset:1024 sc1
  ds_read_b64_tr_b16 a[96:97], v18 offset:16384
  v_mfma_f32_16x16x32_bf16 v[100:103], a[116:119], a[80:83], v[100:103]
  ds_read_b64_tr_b16 a[98:99], v18 offset:18432
  ds_read_b128 a[68:71], v16 offset:1024
  v_mfma_f32_16x16x32_bf16 v[116:119], a[116:119], a[84:87], v[116:119]
  buffer_store_dwordx4 v[152:155], v2, s[16:19], s7 offen offset:2048 sc1
  ds_read_b64_tr_b16 a[100:101], v19 offset:16384
  v_mfma_f32_16x16x32_bf16 v[104:107], a[120:123], a[80:83], v[104:107]
  ds_read_b64_tr_b16 a[102:103], v19 offset:18432
  ds_read_b64_tr_b16 a[104:105], v20 offset:16384
  v_mfma_f32_16x16x32_bf16 v[120:123], a[120:123], a[84:87], v[120:123]
  buffer_store_dwordx4 v[156:159], v2, s[16:19], s7 offen offset:3072 sc1
  ds_read_b64_tr_b16 a[106:107], v20 offset:18432
  v_mfma_f32_16x16x32_bf16 v[108:111], a[124:127], a[80:83], v[108:111]
  ds_read_b64_tr_b16 a[108:109], v21 offset:16384
  ds_read_b64_tr_b16 a[110:111], v21 offset:18432
  v_mfma_f32_16x16x32_bf16 v[124:127], a[124:127], a[84:87], v[124:127]
  v_pk_add_f32 v[160:161], v[160:161], v[32:33]
  v_pk_add_f32 v[162:163], v[162:163], v[34:35]
  v_pk_add_f32 v[164:165], v[164:165], v[36:37]
  v_pk_add_f32 v[166:167], v[166:167], v[38:39]
  v_cvt_pk_bf16_f32 v160, v160, v161
  v_cvt_pk_bf16_f32 v161, v162, v163
  v_cvt_pk_bf16_f32 v162, v164, v165
  v_cvt_pk_bf16_f32 v163, v166, v167
  s_nop 0
  v_permlane16_swap_b32 v160, v162
  v_permlane16_swap_b32 v161, v163
  s_waitcnt lgkmcnt(0)
  v_mfma_f32_16x16x32_bf16 v[96:99], a[96:99], a[64:67], v[96:99]
  s_sub_u32 s70, s70, 65536
  s_xor_b32 s70, s70, 524288
  s_sub_u32 s71, s71, 524288
  v_mfma_f32_16x16x32_bf16 v[112:115], a[96:99], a[68:71], v[112:115]
  s_xor_b32 s71, s71, 4194304
  s_add_u32 m0, s64, 16384
  ds_read_b128 a[80:83], v16 offset:8192
  v_mfma_f32_16x16x32_bf16 v[100:103], a[100:103], a[64:67], v[100:103]
  buffer_load_dwordx4 v10, s[12:15], s71 offen offset:0 lds
  ds_read_b64_tr_b16 a[112:113], v18 offset:20480
  v_mfma_f32_16x16x32_bf16 v[116:119], a[100:103], a[68:71], v[116:119]
  buffer_load_dwordx4 v11, s[12:15], s71 offen offset:1024 lds
  ds_read_b64_tr_b16 a[114:115], v18 offset:22528
  v_mfma_f32_16x16x32_bf16 v[104:107], a[104:107], a[64:67], v[104:107]
  buffer_load_dwordx4 v12, s[12:15], s71 offen offset:2048 lds
  ds_read_b128 a[84:87], v16 offset:9216
  v_mfma_f32_16x16x32_bf16 v[120:123], a[104:107], a[68:71], v[120:123]
  buffer_load_dwordx4 v13, s[12:15], s71 offen offset:3072 lds
  ds_read_b64_tr_b16 a[116:117], v19 offset:20480
  v_mfma_f32_16x16x32_bf16 v[108:111], a[108:111], a[64:67], v[108:111]
  s_add_u32 s71, s71, 131072
  s_add_u32 m0, s64, s88
  ds_read_b64_tr_b16 a[118:119], v19 offset:22528
  ds_read_b64_tr_b16 a[120:121], v20 offset:20480
  v_mfma_f32_16x16x32_bf16 v[124:127], a[108:111], a[68:71], v[124:127]
  buffer_load_dwordx4 v2, s[8:11], s70 offen offset:0 sc1 lds
  buffer_load_dwordx4 v2, s[8:11], s70 offen offset:1024 sc1 lds
  ds_read_b64_tr_b16 a[122:123], v20 offset:22528
  ds_read_b64_tr_b16 a[124:125], v21 offset:20480
  ds_read_b64_tr_b16 a[126:127], v21 offset:22528
  s_add_u32 s70, s70, 16384
  s_add_u32 s64, s64, s66
  s_add_u32 s65, s65, 1
  s_cmp_eq_u32 s65, 4
  s_cselect_b32 s65, 0, s65
  s_cselect_b32 s66, s67, s68
  v_add_u32 v16, s66, v16
  v_add_u32 v17, s66, v17
  v_add_u32 v18, s66, v18
  v_add_u32 v19, s66, v19
  v_add_u32 v20, s66, v20
  v_add_u32 v21, s66, v21
  buffer_store_dwordx4 v[160:163], v27, s[20:23], s4 offen offset:0
  s_waitcnt vmcnt(21) lgkmcnt(0)
  s_barrier
  v_mfma_f32_16x16x32_bf16 v[96:99], a[112:115], a[80:83], v[96:99]
  s_add_u32 m0, s64, 16384
  ds_read_b128 a[64:67], v16 offset:0
  ds_read_b64_tr_b16 a[96:97], v18 offset:16384
  v_mfma_f32_16x16x32_bf16 v[112:115], a[112:115], a[84:87], v[112:115]
  buffer_load_dwordx4 v10, s[12:15], s71 offen offset:0 lds
  ds_read_b64_tr_b16 a[98:99], v18 offset:18432
  v_mfma_f32_16x16x32_bf16 v[100:103], a[116:119], a[80:83], v[100:103]
  buffer_load_dwordx4 v11, s[12:15], s71 offen offset:1024 lds
  ds_read_b128 a[68:71], v16 offset:1024
  v_mfma_f32_16x16x32_bf16 v[116:119], a[116:119], a[84:87], v[116:119]
  ds_read_b64_tr_b16 a[100:101], v19 offset:16384
  ds_read_b64_tr_b16 a[102:103], v19 offset:18432
  v_mfma_f32_16x16x32_bf16 v[104:107], a[120:123], a[80:83], v[104:107]
  buffer_load_dwordx4 v12, s[12:15], s71 offen offset:2048 lds
  ds_read_b64_tr_b16 a[104:105], v20 offset:16384
  v_mfma_f32_16x16x32_bf16 v[120:123], a[120:123], a[84:87], v[120:123]
  ds_read_b64_tr_b16 a[106:107], v20 offset:18432
  ds_read_b64_tr_b16 a[108:109], v21 offset:16384
  v_mfma_f32_16x16x32_bf16 v[108:111], a[124:127], a[80:83], v[108:111]
  ds_read_b64_tr_b16 a[110:111], v21 offset:18432
  v_pk_add_f32 v[168:169], v[168:169], v[40:41]
  v_mfma_f32_16x16x32_bf16 v[124:127], a[124:127], a[84:87], v[124:127]
  v_pk_add_f32 v[170:171], v[170:171], v[42:43]
  v_pk_add_f32 v[172:173], v[172:173], v[44:45]
  v_pk_add_f32 v[174:175], v[174:175], v[46:47]
  v_cvt_pk_bf16_f32 v168, v168, v169
  v_cvt_pk_bf16_f32 v169, v170, v171
  v_cvt_pk_bf16_f32 v170, v172, v173
  v_cvt_pk_bf16_f32 v171, v174, v175
  s_nop 0
  v_permlane16_swap_b32 v168, v170
  v_permlane16_swap_b32 v169, v171
  s_waitcnt lgkmcnt(0)
  v_mfma_f32_16x16x32_bf16 v[96:99], a[96:99], a[64:67], v[96:99]
  buffer_load_dwordx4 v13, s[12:15], s71 offen offset:3072 lds
  ds_read_b128 a[80:83], v16 offset:8192
  v_mfma_f32_16x16x32_bf16 v[112:115], a[96:99], a[68:71], v[112:115]
  s_add_u32 s71, s71, 131072
  s_add_u32 m0, s64, s88
  ds_read_b64_tr_b16 a[112:113], v18 offset:20480
  v_mfma_f32_16x16x32_bf16 v[100:103], a[100:103], a[64:67], v[100:103]
  buffer_load_dwordx4 v2, s[8:11], s70 offen offset:0 sc1 lds
  ds_read_b64_tr_b16 a[114:115], v18 offset:22528
  v_mfma_f32_16x16x32_bf16 v[116:119], a[100:103], a[68:71], v[116:119]
  ds_read_b128 a[84:87], v16 offset:9216
  ds_read_b64_tr_b16 a[116:117], v19 offset:20480
  v_mfma_f32_16x16x32_bf16 v[104:107], a[104:107], a[64:67], v[104:107]
  buffer_load_dwordx4 v2, s[8:11], s70 offen offset:1024 sc1 lds
  ds_read_b64_tr_b16 a[118:119], v19 offset:22528
  v_mfma_f32_16x16x32_bf16 v[120:123], a[104:107], a[68:71], v[120:123]
  s_add_u32 s70, s70, 16384
  ds_read_b64_tr_b16 a[120:121], v20 offset:20480
  ds_read_b64_tr_b16 a[122:123], v20 offset:22528
  v_mfma_f32_16x16x32_bf16 v[108:111], a[108:111], a[64:67], v[108:111]
  s_add_u32 s64, s64, s66
  ds_read_b64_tr_b16 a[124:125], v21 offset:20480
  ds_read_b64_tr_b16 a[126:127], v21 offset:22528
  v_mfma_f32_16x16x32_bf16 v[124:127], a[108:111], a[68:71], v[124:127]
  s_add_u32 s65, s65, 1
  s_cmp_eq_u32 s65, 4
  s_cselect_b32 s65, 0, s65
  s_cselect_b32 s66, s67, s68
  v_add_u32 v16, s66, v16
  v_add_u32 v17, s66, v17
  v_add_u32 v18, s66, v18
  v_add_u32 v19, s66, v19
  v_add_u32 v20, s66, v20
  v_add_u32 v21, s66, v21
  buffer_store_dwordx4 v[168:171], v27, s[20:23], s4 offen offset:64
  s_waitcnt vmcnt(14) lgkmcnt(0)
  s_barrier
  v_mov_b32 v8, 0x40000000
  v_mov_b32 v6, s94
  v_cmp_eq_u32 vcc, 0, v0
  v_mov_b32 v7, s95
  s_nop 0
  v_cndmask_b32_e64 v8, v8, 0, vcc
  buffer_store_dwordx2 v[6:7], v8, s[96:99], s89 offen sc1
  v_mfma_f32_16x16x32_bf16 v[96:99], a[112:115], a[80:83], v[96:99]
  s_add_u32 m0, s64, 16384
  ds_read_b128 a[64:67], v16 offset:0
  ds_read_b64_tr_b16 a[96:97], v18 offset:16384
  v_mfma_f32_16x16x32_bf16 v[112:115], a[112:115], a[84:87], v[112:115]
  buffer_load_dwordx4 v10, s[12:15], s71 offen offset:0 lds
  ds_read_b64_tr_b16 a[98:99], v18 offset:18432
  v_mfma_f32_16x16x32_bf16 v[100:103], a[116:119], a[80:83], v[100:103]
  buffer_load_dwordx4 v11, s[12:15], s71 offen offset:1024 lds
  ds_read_b128 a[68:71], v16 offset:1024
  v_mfma_f32_16x16x32_bf16 v[116:119], a[116:119], a[84:87], v[116:119]
  ds_read_b64_tr_b16 a[100:101], v19 offset:16384
  ds_read_b64_tr_b16 a[102:103], v19 offset:18432
  v_mfma_f32_16x16x32_bf16 v[104:107], a[120:123], a[80:83], v[104:107]
  buffer_load_dwordx4 v12, s[12:15], s71 offen offset:2048 lds
  ds_read_b64_tr_b16 a[104:105], v20 offset:16384
  v_mfma_f32_16x16x32_bf16 v[120:123], a[120:123], a[84:87], v[120:123]
  ds_read_b64_tr_b16 a[106:107], v20 offset:18432
  ds_read_b64_tr_b16 a[108:109], v21 offset:16384
  v_mfma_f32_16x16x32_bf16 v[108:111], a[124:127], a[80:83], v[108:111]
  ds_read_b64_tr_b16 a[110:111], v21 offset:18432
  v_pk_add_f32 v[176:177], v[176:177], v[48:49]
  v_mfma_f32_16x16x32_bf16 v[124:127], a[124:127], a[84:87], v[124:127]
  v_pk_add_f32 v[178:179], v[178:179], v[50:51]
  v_pk_add_f32 v[180:181], v[180:181], v[52:53]
  v_pk_add_f32 v[182:183], v[182:183], v[54:55]
  v_cvt_pk_bf16_f32 v176, v176, v177
  v_cvt_pk_bf16_f32 v177, v178, v179
  v_cvt_pk_bf16_f32 v178, v180, v181
  v_cvt_pk_bf16_f32 v179, v182, v183
  s_nop 0
  v_permlane16_swap_b32 v176, v178
  v_permlane16_swap_b32 v177, v179
  s_waitcnt lgkmcnt(0)
  v_mfma_f32_16x16x32_bf16 v[96:99], a[96:99], a[64:67], v[96:99]
  buffer_load_dwordx4 v13, s[12:15], s71 offen offset:3072 lds
  ds_read_b128 a[80:83], v16 offset:8192
  v_mfma_f32_16x16x32_bf16 v[112:115], a[96:99], a[68:71], v[112:115]
  s_add_u32 s71, s71, 131072
  s_add_u32 m0, s64, s88
  ds_read_b64_tr_b16 a[112:113], v18 offset:20480
  v_mfma_f32_16x16x32_bf16 v[100:103], a[100:103], a[64:67], v[100:103]
  buffer_load_dwordx4 v2, s[8:11], s70 offen offset:0 sc1 lds
  ds_read_b64_tr_b16 a[114:115], v18 offset:22528
  v_mfma_f32_16x16x32_bf16 v[116:119], a[100:103], a[68:71], v[116:119]
  ds_read_b128 a[84:87], v16 offset:9216
  ds_read_b64_tr_b16 a[116:117], v19 offset:20480
  v_mfma_f32_16x16x32_bf16 v[104:107], a[104:107], a[64:67], v[104:107]
  buffer_load_dwordx4 v2, s[8:11], s70 offen offset:1024 sc1 lds
  ds_read_b64_tr_b16 a[118:119], v19 offset:22528
  v_mfma_f32_16x16x32_bf16 v[120:123], a[104:107], a[68:71], v[120:123]
  s_add_u32 s70, s70, 16384
  ds_read_b64_tr_b16 a[120:121], v20 offset:20480
  ds_read_b64_tr_b16 a[122:123], v20 offset:22528
  v_mfma_f32_16x16x32_bf16 v[108:111], a[108:111], a[64:67], v[108:111]
  s_add_u32 s64, s64, s66
  ds_read_b64_tr_b16 a[124:125], v21 offset:20480
  ds_read_b64_tr_b16 a[126:127], v21 offset:22528
  v_mfma_f32_16x16x32_bf16 v[124:127], a[108:111], a[68:71], v[124:127]
  s_add_u32 s65, s65, 1
  s_cmp_eq_u32 s65, 4
  s_cselect_b32 s65, 0, s65
  s_cselect_b32 s66, s67, s68
  v_add_u32 v16, s66, v16
  v_add_u32 v17, s66, v17
  v_add_u32 v18, s66, v18
  v_add_u32 v19, s66, v19
  v_add_u32 v20, s66, v20
  v_add_u32 v21, s66, v21
  buffer_store_dwordx4 v[176:179], v27, s[20:23], s5 offen offset:0
  s_waitcnt vmcnt(16) lgkmcnt(0)
  s_barrier
  v_mfma_f32_16x16x32_bf16 v[96:99], a[112:115], a[80:83], v[96:99]
  s_add_u32 m0, s64, 16384
  ds_read_b128 a[64:67], v16 offset:0
  ds_read_b64_tr_b16 a[96:97], v18 offset:16384
  v_mfma_f32_16x16x32_bf16 v[112:115], a[112:115], a[84:87], v[112:115]
  buffer_load_dwordx4 v10, s[12:15], s71 offen offset:0 lds
  ds_read_b64_tr_b16 a[98:99], v18 offset:18432
  v_mfma_f32_16x16x32_bf16 v[100:103], a[116:119], a[80:83], v[100:103]
  buffer_load_dwordx4 v11, s[12:15], s71 offen offset:1024 lds
  ds_read_b128 a[68:71], v16 offset:1024
  v_mfma_f32_16x16x32_bf16 v[116:119], a[116:119], a[84:87], v[116:119]
  ds_read_b64_tr_b16 a[100:101], v19 offset:16384
  ds_read_b64_tr_b16 a[102:103], v19 offset:18432
  v_mfma_f32_16x16x32_bf16 v[104:107], a[120:123], a[80:83], v[104:107]
  buffer_load_dwordx4 v12, s[12:15], s71 offen offset:2048 lds
  ds_read_b64_tr_b16 a[104:105], v20 offset:16384
  v_mfma_f32_16x16x32_bf16 v[120:123], a[120:123], a[84:87], v[120:123]
  ds_read_b64_tr_b16 a[106:107], v20 offset:18432
  ds_read_b64_tr_b16 a[108:109], v21 offset:16384
  v_mfma_f32_16x16x32_bf16 v[108:111], a[124:127], a[80:83], v[108:111]
  ds_read_b64_tr_b16 a[110:111], v21 offset:18432
  v_pk_add_f32 v[184:185], v[184:185], v[56:57]
  v_mfma_f32_16x16x32_bf16 v[124:127], a[124:127], a[84:87], v[124:127]
  v_pk_add_f32 v[186:187], v[186:187], v[58:59]
  v_pk_add_f32 v[188:189], v[188:189], v[60:61]
  v_pk_add_f32 v[190:191], v[190:191], v[62:63]
  v_cvt_pk_bf16_f32 v184, v184, v185
  v_cvt_pk_bf16_f32 v185, v186, v187
  v_cvt_pk_bf16_f32 v186, v188, v189
  v_cvt_pk_bf16_f32 v187, v190, v191
  s_nop 0
  v_permlane16_swap_b32 v184, v186
  v_permlane16_swap_b32 v185, v187
  s_waitcnt lgkmcnt(0)
  v_mfma_f32_16x16x32_bf16 v[96:99], a[96:99], a[64:67], v[96:99]
  buffer_load_dwordx4 v13, s[12:15], s71 offen offset:3072 lds
  ds_read_b128 a[80:83], v16 offset:8192
  v_mfma_f32_16x16x32_bf16 v[112:115], a[96:99], a[68:71], v[112:115]
  s_add_u32 s71, s71, 131072
  s_add_u32 m0, s64, s88
  ds_read_b64_tr_b16 a[112:113], v18 offset:20480
  v_mfma_f32_16x16x32_bf16 v[100:103], a[100:103], a[64:67], v[100:103]
  buffer_load_dwordx4 v2, s[8:11], s70 offen offset:0 sc1 lds
  ds_read_b64_tr_b16 a[114:115], v18 offset:22528
  v_mfma_f32_16x16x32_bf16 v[116:119], a[100:103], a[68:71], v[116:119]
  ds_read_b128 a[84:87], v16 offset:9216
  ds_read_b64_tr_b16 a[116:117], v19 offset:20480
  v_mfma_f32_16x16x32_bf16 v[104:107], a[104:107], a[64:67], v[104:107]
  buffer_load_dwordx4 v2, s[8:11], s70 offen offset:1024 sc1 lds
  ds_read_b64_tr_b16 a[118:119], v19 offset:22528
  v_mfma_f32_16x16x32_bf16 v[120:123], a[104:107], a[68:71], v[120:123]
  s_add_u32 s70, s70, 16384
  ds_read_b64_tr_b16 a[120:121], v20 offset:20480
  ds_read_b64_tr_b16 a[122:123], v20 offset:22528
  v_mfma_f32_16x16x32_bf16 v[108:111], a[108:111], a[64:67], v[108:111]
  s_add_u32 s64, s64, s66
  ds_read_b64_tr_b16 a[124:125], v21 offset:20480
  ds_read_b64_tr_b16 a[126:127], v21 offset:22528
  v_mfma_f32_16x16x32_bf16 v[124:127], a[108:111], a[68:71], v[124:127]
  s_add_u32 s65, s65, 1
  s_cmp_eq_u32 s65, 4
  s_cselect_b32 s65, 0, s65
  s_cselect_b32 s66, s67, s68
  v_add_u32 v16, s66, v16
  v_add_u32 v17, s66, v17
  v_add_u32 v18, s66, v18
  v_add_u32 v19, s66, v19
  v_add_u32 v20, s66, v20
  v_add_u32 v21, s66, v21
  buffer_store_dwordx4 v[184:187], v27, s[20:23], s5 offen offset:64
  s_waitcnt vmcnt(16) lgkmcnt(0)
  s_barrier
  v_mfma_f32_16x16x32_bf16 v[96:99], a[112:115], a[80:83], v[96:99]
  buffer_load_dwordx2 v[6:7], off, s[96:99], s90 sc1
  ds_read_b128 a[64:67], v16 offset:0
  v_mfma_f32_16x16x32_bf16 v[112:115], a[112:115], a[84:87], v[112:115]
  ds_read_b64_tr_b16 a[96:97], v18 offset:16384
  ds_read_b64_tr_b16 a[98:99], v18 offset:18432
  v_mfma_f32_16x16x32_bf16 v[100:103], a[116:119], a[80:83], v[100:103]
  ds_read_b128 a[68:71], v16 offset:1024
  ds_read_b64_tr_b16 a[100:101], v19 offset:16384
  v_mfma_f32_16x16x32_bf16 v[116:119], a[116:119], a[84:87], v[116:119]
  ds_read_b64_tr_b16 a[102:103], v19 offset:18432
  ds_read_b64_tr_b16 a[104:105], v20 offset:16384
  v_mfma_f32_16x16x32_bf16 v[104:107], a[120:123], a[80:83], v[104:107]
  ds_read_b64_tr_b16 a[106:107], v20 offset:18432
  ds_read_b64_tr_b16 a[108:109], v21 offset:16384
  v_mfma_f32_16x16x32_bf16 v[120:123], a[120:123], a[84:87], v[120:123]
  ds_read_b64_tr_b16 a[110:111], v21 offset:18432
  v_mfma_f32_16x16x32_bf16 v[108:111], a[124:127], a[80:83], v[108:111]
  v_mfma_f32_16x16x32_bf16 v[124:127], a[124:127], a[84:87], v[124:127]
  s_waitcnt lgkmcnt(0)
  v_mfma_f32_16x16x32_bf16 v[96:99], a[96:99], a[64:67], v[96:99]
  s_add_u32 s64, s64, s66
  ds_read_b128 a[80:83], v16 offset:8192
  ds_read_b64_tr_b16 a[112:113], v18 offset:20480
  v_mfma_f32_16x16x32_bf16 v[112:115], a[96:99], a[68:71], v[112:115]
  s_add_u32 s65, s65, 1
  ds_read_b64_tr_b16 a[114:115], v18 offset:22528
  ds_read_b128 a[84:87], v16 offset:9216
  v_mfma_f32_16x16x32_bf16 v[100:103], a[100:103], a[64:67], v[100:103]
  s_cmp_eq_u32 s65, 4
  s_cselect_b32 s65, 0, s65
  s_cselect_b32 s66, s67, s68
  ds_read_b64_tr_b16 a[116:117], v19 offset:20480
  v_mfma_f32_16x16x32_bf16 v[116:119], a[100:103], a[68:71], v[116:119]
  ds_read_b64_tr_b16 a[118:119], v19 offset:22528
  ds_read_b64_tr_b16 a[120:121], v20 offset:20480
  v_mfma_f32_16x16x32_bf16 v[104:107], a[104:107], a[64:67], v[104:107]
  ds_read_b64_tr_b16 a[122:123], v20 offset:22528
  ds_read_b64_tr_b16 a[124:125], v21 offset:20480
  v_mfma_f32_16x16x32_bf16 v[120:123], a[104:107], a[68:71], v[120:123]
  ds_read_b64_tr_b16 a[126:127], v21 offset:22528
  v_mfma_f32_16x16x32_bf16 v[108:111], a[108:111], a[64:67], v[108:111]
  v_add_u32 v16, s66, v16
  v_add_u32 v17, s66, v17
  v_add_u32 v20, s66, v20
  v_mfma_f32_16x16x32_bf16 v[124:127], a[108:111], a[68:71], v[124:127]
  v_add_u32 v18, s66, v18
  v_add_u32 v19, s66, v19
  v_add_u32 v21, s66, v21
  s_waitcnt vmcnt(0) lgkmcnt(0)
  s_barrier
  s_mov_b32 s5, 0x40000
Lpoll_13:
  v_cmp_ne_u64 vcc, s[94:95], v[6:7]
  s_nop 0
  s_cbranch_vccz Lpolld_14
  s_sleep 4
  buffer_load_dwordx2 v[6:7], off, s[96:99], s90 sc1
  s_sub_u32 s5, s5, 1
  s_waitcnt vmcnt(0)
  s_cbranch_scc0 Lpoll_13
Lpolld_14:
  v_mfma_f32_16x16x32_bf16 v[96:99], a[112:115], a[80:83], v[96:99]
  s_lshl_b32 s6, s78, 1
  s_add_u32 s6, s6, s77
  s_lshl_b32 s6, s6, 2
  v_mfma_f32_16x16x32_bf16 v[112:115], a[112:115], a[84:87], v[112:115]
  s_add_u32 s6, s6, s3
  s_lshl_b32 s6, s6, 13
  s_add_u32 s7, s6, 4096
  v_mfma_f32_16x16x32_bf16 v[100:103], a[116:119], a[80:83], v[100:103]
  buffer_load_dwordx4 v[192:195], v2, s[16:19], s6 offen offset:0 sc1
  ds_read_b128 a[64:67], v16 offset:0
  v_mfma_f32_16x16x32_bf16 v[116:119], a[116:119], a[84:87], v[116:119]
  buffer_load_dwordx4 v[196:199], v2, s[16:19], s6 offen offset:1024 sc1
  ds_read_b64_tr_b16 a[96:97], v18 offset:16384
  v_mfma_f32_16x16x32_bf16 v[104:107], a[120:123], a[80:83], v[104:107]
  buffer_load_dwordx4 v[200:203], v2, s[16:19], s6 offen offset:2048 sc1
  ds_read_b64_tr_b16 a[98:99], v18 offset:18432
  v_mfma_f32_16x16x32_bf16 v[120:123], a[120:123], a[84:87], v[120:123]
  buffer_load_dwordx4 v[204:207], v2, s[16:19], s6 offen offset:3072 sc1
  ds_read_b128 a[68:71], v16 offset:1024
  v_mfma_f32_16x16x32_bf16 v[108:111], a[124:127], a[80:83], v[108:111]
  ds_read_b64_tr_b16 a[100:101], v19 offset:16384
  ds_read_b64_tr_b16 a[102:103], v19 offset:18432
  v_mfma_f32_16x16x32_bf16 v[124:127], a[124:127], a[84:87], v[124:127]
  ds_read_b64_tr_b16 a[104:105], v20 offset:16384
  ds_read_b64_tr_b16 a[106:107], v20 offset:18432
  ds_read_b64_tr_b16 a[108:109], v21 offset:16384
  ds_read_b64_tr_b16 a[110:111], v21 offset:18432
  s_waitcnt lgkmcnt(0)
  v_mfma_f32_16x16x32_bf16 v[96:99], a[96:99], a[64:67], v[96:99]
  buffer_load_dwordx4 v[208:211], v2, s[16:19], s7 offen offset:0 sc1
  ds_read_b128 a[80:83], v16 offset:8192
  v_mfma_f32_16x16x32_bf16 v[112:115], a[96:99], a[68:71], v[112:115]
  buffer_load_dwordx4 v[212:215], v2, s[16:19], s7 offen offset:1024 sc1
  ds_read_b64_tr_b16 a[112:113], v18 offset:20480
  v_mfma_f32_16x16x32_bf16 v[100:103], a[100:103], a[64:67], v[100:103]
  ds_read_b64_tr_b16 a[114:115], v18 offset:22528
  ds_read_b128 a[84:87], v16 offset:9216
  v_mfma_f32_16x16x32_bf16 v[116:119], a[100:103], a[68:71], v[116:119]
  buffer_load_dwordx4 v[216:219], v2, s[16:19], s7 offen offset:2048 sc1
  ds_read_b64_tr_b16 a[116:117], v19 offset:20480
  v_mfma_f32_16x16x32_bf16 v[104:107], a[104:107], a[64:67], v[104:107]
  ds_read_b64_tr_b16 a[118:119], v19 offset:22528
  ds_read_b64_tr_b16 a[120:121], v20 offset:20480
  v_mfma_f32_16x16x32_bf16 v[120:123], a[104:107], a[68:71], v[120:123]
  buffer_load_dwordx4 v[220:223], v2, s[16:19], s7 offen offset:3072 sc1
  ds_read_b64_tr_b16 a[122:123], v20 offset:22528
  v_mfma_f32_16x16x32_bf16 v[108:111], a[108:111], a[64:67], v[108:111]
  s_add_u32 s64, s64, s66
  ds_read_b64_tr_b16 a[124:125], v21 offset:20480
  ds_read_b64_tr_b16 a[126:127], v21 offset:22528
  v_mfma_f32_16x16x32_bf16 v[124:127], a[108:111], a[68:71], v[124:127]
  s_add_u32 s65, s65, 1
  s_cmp_eq_u32 s65, 4
  s_cselect_b32 s65, 0, s65
  s_cselect_b32 s66, s67, s68
  v_add_u32 v16, s66, v16
  v_add_u32 v17, s66, v17
  v_add_u32 v18, s66, v18
  v_add_u32 v19, s66, v19
  v_add_u32 v20, s66, v20
  v_add_u32 v21, s66, v21
  s_waitcnt vmcnt(8) lgkmcnt(0)
  s_barrier
  v_mfma_f32_16x16x32_bf16 v[96:99], a[112:115], a[80:83], v[96:99]
  ds_read_b128 a[64:67], v16 offset:0
  ds_read_b64_tr_b16 a[96:97], v18 offset:16384
  v_mfma_f32_16x16x32_bf16 v[112:115], a[112:115], a[84:87], v[112:115]
  ds_read_b64_tr_b16 a[98:99], v18 offset:18432
  ds_read_b128 a[68:71], v16 offset:1024
  v_mfma_f32_16x16x32_bf16 v[100:103], a[116:119], a[80:83], v[100:103]
  ds_read_b64_tr_b16 a[100:101], v19 offset:16384
  v_mfma_f32_16x16x32_bf16 v[116:119], a[116:119], a[84:87], v[116:119]
  ds_read_b64_tr_b16 a[102:103], v19 offset:18432
  ds_read_b64_tr_b16 a[104:105], v20 offset:16384
  v_mfma_f32_16x16x32_bf16 v[104:107], a[120:123], a[80:83], v[104:107]
  ds_read_b64_tr_b16 a[106:107], v20 offset:18432
  ds_read_b64_tr_b16 a[108:109], v21 offset:16384
  v_mfma_f32_16x16x32_bf16 v[120:123], a[120:123], a[84:87], v[120:123]
  ds_read_b64_tr_b16 a[110:111], v21 offset:18432
  v_mfma_f32_16x16x32_bf16 v[108:111], a[124:127], a[80:83], v[108:111]
  v_mfma_f32_16x16x32_bf16 v[124:127], a[124:127], a[84:87], v[124:127]
  s_waitcnt lgkmcnt(0)
  v_mfma_f32_16x16x32_bf16 v[96:99], a[96:99], a[64:67], v[96:99]
  ds_read_b128 a[80:83], v16 offset:8192
  ds_read_b64_tr_b16 a[112:113], v18 offset:20480
  v_mfma_f32_16x16x32_bf16 v[112:115], a[96:99], a[68:71], v[112:115]
  ds_read_b64_tr_b16 a[114:115], v18 offset:22528
  ds_read_b128 a[84:87], v16 offset:9216
  v_mfma_f32_16x16x32_bf16 v[100:103], a[100:103], a[64:67], v[100:103]
  ds_read_b64_tr_b16 a[116:117], v19 offset:20480
  v_mfma_f32_16x16x32_bf16 v[116:119], a[100:103], a[68:71], v[116:119]
  ds_read_b64_tr_b16 a[118:119], v19 offset:22528
  ds_read_b64_tr_b16 a[120:121], v20 offset:20480
  v_mfma_f32_16x16x32_bf16 v[104:107], a[104:107], a[64:67], v[104:107]
  ds_read_b64_tr_b16 a[122:123], v20 offset:22528
  ds_read_b64_tr_b16 a[124:125], v21 offset:20480
  v_mfma_f32_16x16x32_bf16 v[120:123], a[104:107], a[68:71], v[120:123]
  ds_read_b64_tr_b16 a[126:127], v21 offset:22528
  v_mfma_f32_16x16x32_bf16 v[108:111], a[108:111], a[64:67], v[108:111]
  v_mfma_f32_16x16x32_bf16 v[124:127], a[108:111], a[68:71], v[124:127]
  s_lshl_b32 s4, s73, 19
  s_lshl_b32 s72, s76, 8
  s_add_u32 s4, s4, s72
  s_and_b32 s72, s3, 1
  s_lshl_b32 s72, s72, 7
  s_add_u32 s4, s4, s72
  s_lshr_b32 s72, s3, 1
  s_lshl_b32 s72, s72, 1
  s_add_u32 s72, s72, s77
  s_lshl_b32 s72, s72, 12
  s_add_u32 s4, s4, s72
  s_add_u32 s5, s4, 262144
  s_waitcnt lgkmcnt(0)
  v_mfma_f32_16x16x32_bf16 v[96:99], a[112:115], a[80:83], v[96:99]
  v_mfma_f32_16x16x32_bf16 v[112:115], a[112:115], a[84:87], v[112:115]
  v_mfma_f32_16x16x32_bf16 v[100:103], a[116:119], a[80:83], v[100:103]
  v_mfma_f32_16x16x32_bf16 v[116:119], a[116:119], a[84:87], v[116:119]
  v_mfma_f32_16x16x32_bf16 v[104:107], a[120:123], a[80:83], v[104:107]
  v_mfma_f32_16x16x32_bf16 v[120:123], a[120:123], a[84:87], v[120:123]
  v_mfma_f32_16x16x32_bf16 v[108:111], a[124:127], a[80:83], v[108:111]
  v_mfma_f32_16x16x32_bf16 v[124:127], a[124:127], a[84:87], v[124:127]
  s_waitcnt vmcnt(0)
  v_pk_add_f32 v[192:193], v[192:193], v[96:97]
  s_nop 2
  v_pk_add_f32 v[200:201], v[200:201], v[104:105]
  v_pk_add_f32 v[208:209], v[208:209], v[112:113]
  v_pk_add_f32 v[216:217], v[216:217], v[120:121]
  v_pk_add_f32 v[194:195], v[194:195], v[98:99]
  v_pk_add_f32 v[202:203], v[202:203], v[106:107]
  v_pk_add_f32 v[210:211], v[210:211], v[114:115]
  v_pk_add_f32 v[218:219], v[218:219], v[122:123]
  v_pk_add_f32 v[196:197], v[196:197], v[100:101]
  v_pk_add_f32 v[204:205], v[204:205], v[108:109]
  v_pk_add_f32 v[212:213], v[212:213], v[116:117]
  v_pk_add_f32 v[220:221], v[220:221], v[124:125]
  v_pk_add_f32 v[198:199], v[198:199], v[102:103]
  v_pk_add_f32 v[206:207], v[206:207], v[110:111]
  v_pk_add_f32 v[214:215], v[214:215], v[118:119]
  v_pk_add_f32 v[222:223], v[222:223], v[126:127]
  v_cvt_pk_bf16_f32 v192, v192, v193
  v_cvt_pk_bf16_f32 v200, v200, v201
  v_cvt_pk_bf16_f32 v208, v208, v209
  v_cvt_pk_bf16_f32 v216, v216, v217
  v_cvt_pk_bf16_f32 v193, v194, v195
  v_cvt_pk_bf16_f32 v201, v202, v203
  v_cvt_pk_bf16_f32 v209, v210, v211
  v_cvt_pk_bf16_f32 v217, v218, v219
  v_cvt_pk_bf16_f32 v194, v196, v197
  v_cvt_pk_bf16_f32 v202, v204, v205
  v_cvt_pk_bf16_f32 v210, v212, v213
  v_cvt_pk_bf16_f32 v218, v220, v221
  v_cvt_pk_bf16_f32 v195, v198, v199
  v_cvt_pk_bf16_f32 v203, v206, v207
  v_cvt_pk_bf16_f32 v211, v214, v215
  v_cvt_pk_bf16_f32 v219, v222, v223
  v_permlane16_swap_b32 v192, v194
  v_permlane16_swap_b32 v200, v202
  v_permlane16_swap_b32 v208, v210
  v_permlane16_swap_b32 v216, v218
  v_permlane16_swap_b32 v193, v195
  v_permlane16_swap_b32 v201, v203
  v_permlane16_swap_b32 v209, v211
  v_permlane16_swap_b32 v217, v219
  buffer_store_dwordx4 v[192:195], v26, s[20:23], s4 offen offset:0
  buffer_store_dwordx4 v[200:203], v26, s[20:23], s4 offen offset:64
  buffer_store_dwordx4 v[208:211], v26, s[20:23], s5 offen offset:0
  buffer_store_dwordx4 v[216:219], v26, s[20:23], s5 offen offset:64
Lend:
  s_endpgm
.section .rodata,"a"
.p2align 6
.amdhsa_kernel concat_heads__compressed_kv_cla__sliding_local_dilated__prompt_kernel
  .amdhsa_next_free_vgpr 512
  .amdhsa_next_free_sgpr 102
  .amdhsa_accum_offset 256
  .amdhsa_group_segment_fixed_size 0
  .amdhsa_kernarg_size 96
  .amdhsa_user_sgpr_count 2
  .amdhsa_user_sgpr_kernarg_segment_ptr 1
  .amdhsa_system_sgpr_workgroup_id_x 1
.end_amdhsa_kernel
```

```asm
; @launch grid=(256,1,1) block=(256,1,1) lds=163840
.amdgcn_target "amdgcn-amd-amdhsa--gfx950"
.text
.globl concat_heads__compressed_kv_cla__sliding_local_dilated__prompt_kernel
.p2align 8
.type concat_heads__compressed_kv_cla__sliding_local_dilated__prompt_kernel,@function
concat_heads__compressed_kv_cla__sliding_local_dilated__prompt_kernel:
  s_cmp_ge_u32 s2, 256
  s_cbranch_scc1 Lend
  s_load_dwordx16 s[64:79], s[0:1], 0
  s_load_dwordx8 s[80:87], s[0:1], 64
  v_lshrrev_b32 v2, 6, v0
  v_and_b32 v1, 63, v0
  v_readfirstlane_b32 s3, v2
  v_lshlrev_b32 v2, 4, v1
  s_bfe_u32 s59, s2, 0x30003
  s_lshr_b32 s4, s2, 7
  s_lshl_b32 s4, s4, 3
  s_add_u32 s59, s59, s4
  s_lshr_b32 s4, s2, 3
  s_xor_b32 s4, s4, s2
  s_bitcmp1_b32 s4, 3
  s_cbranch_scc1 Lp2
  s_and_b32 s4, s2, 1
  s_lshl_b32 s4, s4, 2
  s_and_b32 s5, s59, 3
  s_add_u32 s61, s4, s5
  s_bfe_u32 s4, s2, 0x20001
  s_lshl_b32 s4, s4, 2
  s_lshr_b32 s5, s59, 2
  s_add_u32 s62, s4, s5
  s_lshl_b32 s4, s3, 13
  s_add_u32 s36, s4, 65536
  s_add_u32 s41, s4, 98304
  v_lshrrev_b32 v32, 3, v1
  v_and_b32 v33, 6, v32
  v_and_b32 v34, 7, v1
  v_xor_b32 v33, v33, v34
  v_lshlrev_b32 v33, 4, v33
  s_lshl_b32 s4, s61, 2
  s_add_u32 s4, s4, s3
  s_lshl_b32 s4, s4, 6
  v_add_u32 v34, s4, v32
  v_lshl_add_u32 v34, v34, 10, v33
  v_add_u32 v48, 0, v34
  v_add_u32 v49, 7168, v34
  v_add_u32 v50, 14336, v34
  v_add_u32 v51, 21504, v34
  v_add_u32 v52, 32768, v34
  v_add_u32 v53, 39936, v34
  v_add_u32 v54, 47104, v34
  v_add_u32 v55, 54272, v34
  v_lshrrev_b32 v34, 2, v32
  v_and_b32 v35, 3, v32
  v_lshl_add_u32 v34, v34, 3, v35
  s_lshl_b32 s4, s62, 2
  s_add_u32 s4, s4, s3
  s_lshl_b32 s4, s4, 7
  v_lshl_add_u32 v34, v34, 13, v33
  v_add_u32 v34, s4, v34
  v_add_u32 v56, 0, v34
  v_add_u32 v57, 130048, v34
  v_add_u32 v58, 30720, v34
  v_add_u32 v59, 160768, v34
  v_add_u32 v60, 262144, v34
  v_add_u32 v61, 392192, v34
  v_add_u32 v62, 292864, v34
  v_add_u32 v63, 422912, v34
  s_and_b32 s6, s2, 7
  s_add_u32 s4, s61, s62
  s_and_b32 s49, s4, 3
  s_lshl_b32 s49, s49, 3
  s_or_b32 s49, s49, 0x80000
  s_bfe_u32 s48, 0x70702, s49
  s_add_u32 s48, s48, s6
  s_and_b32 s48, s48, 7
  s_lshl_b32 s46, s48, 7
  s_waitcnt lgkmcnt(0)
  s_mov_b32 s8, s66
  s_mov_b32 s9, s67
  s_mov_b32 s10, 2097152
  s_mov_b32 s11, 0x00020000
  s_mov_b32 s12, s70
  s_mov_b32 s13, s71
  s_mov_b32 s14, 4194304
  s_mov_b32 s15, 0x00020000
  s_mov_b32 s50, 9
  s_add_u32 s96, s86, 125829120
  s_addc_u32 s97, s87, 0
  s_mov_b32 s98, 262144
  s_mov_b32 s99, 0x00020000
  s_or_b32 s4, s2, s3
  s_cbranch_scc1 Ltag_1
  s_mov_b32 s4, 196608
  buffer_load_dwordx2 v[22:23], off, s[96:99], s4 sc1
Ltag_1:
  s_mov_b32 m0, s36
  s_nop 0
  buffer_load_dwordx4 v48, s[8:11], s46 offen offset:0 lds
  buffer_load_dwordx4 v49, s[8:11], s46 offen offset:1024 lds
  buffer_load_dwordx4 v50, s[8:11], s46 offen offset:2048 lds
  buffer_load_dwordx4 v51, s[8:11], s46 offen offset:3072 lds
  s_add_u32 m0, s36, 4096
  s_nop 0
  buffer_load_dwordx4 v52, s[8:11], s46 offen offset:0 lds
  buffer_load_dwordx4 v53, s[8:11], s46 offen offset:1024 lds
  buffer_load_dwordx4 v54, s[8:11], s46 offen offset:2048 lds
  buffer_load_dwordx4 v55, s[8:11], s46 offen offset:3072 lds
  s_sub_u32 s50, s50, 1
  s_cmp_eq_u32 s50, 0
  s_cselect_b32 s12, s72, s12
  s_cselect_b32 s13, s73, s13
  s_lshl_b32 s47, s48, 19
  s_bfe_u32 s34, 0x3020106, s49
  s_add_u32 s48, s48, s34
  s_add_u32 s49, s49, 8
  s_and_b32 s49, s49, 0x8001f
  s_and_b32 s48, s48, 7
  s_lshl_b32 s46, s48, 7
  s_mov_b32 m0, s41
  s_nop 0
  buffer_load_dwordx4 v56, s[12:15], s47 offen offset:0 lds
  buffer_load_dwordx4 v57, s[12:15], s47 offen offset:1024 lds
  buffer_load_dwordx4 v58, s[12:15], s47 offen offset:2048 lds
  buffer_load_dwordx4 v59, s[12:15], s47 offen offset:3072 lds
  s_add_u32 m0, s41, 4096
  s_nop 0
  buffer_load_dwordx4 v60, s[12:15], s47 offen offset:0 lds
  buffer_load_dwordx4 v61, s[12:15], s47 offen offset:1024 lds
  buffer_load_dwordx4 v62, s[12:15], s47 offen offset:2048 lds
  buffer_load_dwordx4 v63, s[12:15], s47 offen offset:3072 lds
  s_lshr_b32 s4, s3, 1
  s_lshl_b32 s4, s4, 14
  s_add_u32 s4, s4, 65536
  v_and_b32 v32, 15, v1
  v_lshlrev_b32 v32, 7, v32
  v_lshrrev_b32 v33, 4, v1
  v_and_b32 v34, 6, v1
  v_xor_b32 v33, v33, v34
  v_lshl_add_u32 v32, v33, 4, v32
  v_add_u32 v16, s4, v32
  v_xor_b32 v17, 64, v16
  s_and_b32 s4, s3, 1
  s_lshl_b32 s4, s4, 14
  s_add_u32 s4, s4, 98304
  v_lshrrev_b32 v32, 2, v1
  v_and_b32 v33, 6, v32
  v_lshlrev_b32 v32, 7, v32
  v_and_b32 v34, 1, v1
  v_lshl_add_u32 v32, v34, 3, v32
  v_add_u32 v32, s4, v32
  v_bfe_u32 v34, v1, 1, 1
  v_xor_b32 v33, v33, v34
  v_xor_b32 v34, 0, v33
  v_lshl_add_u32 v18, v34, 4, v32
  v_xor_b32 v34, 2, v33
  v_lshl_add_u32 v19, v34, 4, v32
  v_xor_b32 v34, 4, v33
  v_lshl_add_u32 v20, v34, 4, v32
  v_xor_b32 v34, 6, v33
  s_add_u32 m0, s36, -65536
  s_nop 0
  buffer_load_dwordx4 v48, s[8:11], s46 offen offset:0 lds
  v_lshl_add_u32 v21, v34, 4, v32
  s_and_b32 s24, s2, 7
  s_lshr_b32 s4, s2, 6
  s_lshl_b32 s4, s4, 3
  s_add_u32 s24, s24, s4
  s_lshr_b32 s4, s2, 3
  s_and_b32 s25, s4, 6
  s_xor_b32 s4, s4, s2
  s_bfe_u32 s4, s4, 0x10003
  s_add_u32 s25, s25, s4
  v_accvgpr_write_b32 a244, -1
  v_accvgpr_write_b32 a245, -1
  v_accvgpr_write_b32 a246, -1
  v_accvgpr_write_b32 a247, -1
  v_lshrrev_b32 v24, 3, v1
  buffer_load_dwordx4 v49, s[8:11], s46 offen offset:1024 lds
  v_and_b32 v25, 6, v24
  v_and_b32 v26, 7, v1
  v_xor_b32 v25, v25, v26
  v_lshlrev_b32 v25, 4, v25
  s_and_b32 s4, s3, 1
  s_lshl_b32 s4, s4, 16
  s_lshr_b32 s5, s3, 1
  s_lshl_b32 s5, s5, 7
  s_add_u32 s4, s4, s5
  v_lshl_add_u32 v24, v24, 11, v25
  v_add_u32 v24, s4, v24
  buffer_load_dwordx4 v50, s[8:11], s46 offen offset:2048 lds
  v_add_u32 v25, 0, v24
  v_accvgpr_write_b32 a212, v25
  v_add_u32 v25, 15360, v24
  v_accvgpr_write_b32 a213, v25
  v_add_u32 v25, 30720, v24
  buffer_load_dwordx4 v51, s[8:11], s46 offen offset:3072 lds
  v_accvgpr_write_b32 a214, v25
  v_add_u32 v25, 46080, v24
  v_accvgpr_write_b32 a215, v25
  v_accvgpr_write_b32 a236, 0
  v_mov_b32 v27, 0x3f803f80
  v_accvgpr_write_b32 a208, v27
  s_add_u32 m0, s36, -61440
  s_nop 0
  buffer_load_dwordx4 v52, s[8:11], s46 offen offset:0 lds
  v_accvgpr_write_b32 a237, 0
  v_accvgpr_write_b32 a209, v27
  v_accvgpr_write_b32 a238, 0
  v_accvgpr_write_b32 a210, v27
  v_accvgpr_write_b32 a239, 0
  buffer_load_dwordx4 v53, s[8:11], s46 offen offset:1024 lds
  v_accvgpr_write_b32 a211, v27
  v_lshrrev_b32 v24, 3, v1
  v_and_b32 v25, 6, v24
  v_and_b32 v26, 7, v1
  v_xor_b32 v25, v25, v26
  buffer_load_dwordx4 v54, s[8:11], s46 offen offset:2048 lds
  v_lshlrev_b32 v25, 4, v25
  v_lshlrev_b32 v26, 2, v24
  v_add_u32 v26, s3, v26
  v_lshl_add_u32 v26, v26, 11, v25
  v_add_u32 v27, 0, v26
  buffer_load_dwordx4 v55, s[8:11], s46 offen offset:3072 lds
  v_accvgpr_write_b32 a222, v27
  v_add_u32 v27, 64512, v26
  v_accvgpr_write_b32 a223, v27
  v_add_u32 v27, 129024, v26
  v_accvgpr_write_b32 a224, v27
  v_add_u32 v27, 193536, v26
  s_sub_u32 s50, s50, 1
  s_cmp_eq_u32 s50, 0
  s_cselect_b32 s12, s72, s12
  s_cselect_b32 s13, s73, s13
  s_lshl_b32 s47, s48, 19
  s_bfe_u32 s34, 0x3020106, s49
  s_add_u32 s48, s48, s34
  s_add_u32 s49, s49, 8
  s_and_b32 s49, s49, 0x8001f
  s_and_b32 s48, s48, 7
  s_lshl_b32 s46, s48, 7
  s_add_u32 m0, s41, 32768
  s_nop 0
  buffer_load_dwordx4 v56, s[12:15], s47 offen offset:0 lds
  v_accvgpr_write_b32 a225, v27
  v_lshrrev_b32 v26, 2, v24
  v_and_b32 v27, 3, v24
  v_lshl_add_u32 v26, v26, 3, v27
  s_and_b32 s4, s3, 1
  s_lshl_b32 s4, s4, 18
  s_lshr_b32 s5, s3, 1
  s_lshl_b32 s5, s5, 7
  s_add_u32 s4, s4, s5
  s_lshl_b32 s5, s24, 8
  s_add_u32 s4, s4, s5
  v_lshl_add_u32 v26, v26, 13, v25
  v_add_u32 v26, s4, v26
  buffer_load_dwordx4 v57, s[12:15], s47 offen offset:1024 lds
  v_add_u32 v27, 0, v26
  v_accvgpr_write_b32 a226, v27
  v_add_u32 v27, 130048, v26
  v_accvgpr_write_b32 a227, v27
  v_add_u32 v27, 30720, v26
  buffer_load_dwordx4 v58, s[12:15], s47 offen offset:2048 lds
  v_accvgpr_write_b32 a228, v27
  v_add_u32 v27, 160768, v26
  v_accvgpr_write_b32 a229, v27
  s_lshl_b32 s4, s3, 13
  s_add_u32 s4, s4, 98304
  v_and_b32 v24, 15, v1
  v_lshlrev_b32 v24, 7, v24
  v_lshrrev_b32 v25, 4, v1
  buffer_load_dwordx4 v59, s[12:15], s47 offen offset:3072 lds
  v_and_b32 v26, 6, v1
  v_xor_b32 v25, v25, v26
  v_lshl_add_u32 v24, v25, 4, v24
  v_add_u32 v28, s4, v24
  v_xor_b32 v29, 64, v28
  v_lshrrev_b32 v24, 2, v1
  s_add_u32 m0, s41, 36864
  s_nop 0
  buffer_load_dwordx4 v60, s[12:15], s47 offen offset:0 lds
  v_and_b32 v25, 6, v24
  v_lshlrev_b32 v24, 7, v24
  v_and_b32 v26, 1, v1
  v_lshl_add_u32 v24, v26, 3, v24
  v_add_u32 v24, 0, v24
  buffer_load_dwordx4 v61, s[12:15], s47 offen offset:1024 lds
  v_bfe_u32 v26, v1, 1, 1
  v_xor_b32 v25, v25, v26
  v_xor_b32 v26, 0, v25
  v_lshl_add_u32 v30, v26, 4, v24
  v_xor_b32 v26, 2, v25
  buffer_load_dwordx4 v62, s[12:15], s47 offen offset:2048 lds
  v_lshl_add_u32 v31, v26, 4, v24
  v_xor_b32 v26, 4, v25
  v_lshl_add_u32 v32, v26, 4, v24
  v_xor_b32 v26, 6, v25
  v_lshl_add_u32 v33, v26, 4, v24
  buffer_load_dwordx4 v63, s[12:15], s47 offen offset:3072 lds
  v_accvgpr_write_b32 a230, v28
  v_accvgpr_write_b32 a231, v29
  v_accvgpr_write_b32 a232, v30
  v_accvgpr_write_b32 a233, v31
  v_accvgpr_write_b32 a234, v32
  v_accvgpr_write_b32 a235, v33
  s_and_b32 s4, s3, 1
  s_lshl_b32 s5, s62, 1
  s_add_u32 s4, s4, s5
  s_lshr_b32 s5, s3, 1
  s_lshl_b32 s6, s61, 1
  s_add_u32 s5, s5, s6
  s_add_u32 s16, s86, 16777216
  s_addc_u32 s17, s87, 0
  s_mov_b32 s18, 33554432
  s_mov_b32 s19, 0x00020000
  s_lshl_b32 s4, s4, 20
  s_lshl_b32 s5, s5, 16
  s_add_u32 s63, s4, s5
  s_mov_b32 s37, 0
  s_mov_b32 s39, 4294901760
  s_mov_b32 s40, 32768
  s_mov_b32 s37, 2
  s_mov_b32 s42, 0
  s_mov_b32 s44, 4294934528
  s_mov_b32 s45, 32768
  s_mov_b32 s43, s44
  s_or_b32 s4, s2, s3
  s_cbranch_scc1 Ltag_2
  s_mov_b32 s4, 196608
  s_mov_b32 s92, s84
  s_mov_b32 s93, s85
  s_mov_b32 s94, 256
  s_mov_b32 s95, 0x00020000
  s_waitcnt vmcnt(32)
  v_add_u32 v22, 1, v22
  v_or_b32 v23, 0x80000000, v23
  buffer_store_dwordx2 v[22:23], off, s[96:99], s4 sc1
  buffer_store_dwordx2 v[22:23], off, s[92:95], 0 sc1
Ltag_2:
  s_waitcnt vmcnt(16)
  s_barrier
  ds_read_b128 a[0:3], v16 offset:0
  ds_read_b64_tr_b16 a[64:65], v18 offset:0
  ds_read_b64_tr_b16 a[66:67], v18 offset:2048
  ds_read_b128 a[4:7], v16 offset:2048
  ds_read_b128 a[8:11], v16 offset:4096
  ds_read_b128 a[12:15], v16 offset:6144
  ds_read_b128 a[16:19], v16 offset:8192
  ds_read_b128 a[20:23], v16 offset:10240
  ds_read_b128 a[24:27], v16 offset:12288
  ds_read_b128 a[28:31], v16 offset:14336
  ds_read_b64_tr_b16 a[68:69], v19 offset:0
  ds_read_b64_tr_b16 a[70:71], v19 offset:2048
  ds_read_b64_tr_b16 a[72:73], v20 offset:0
  ds_read_b64_tr_b16 a[74:75], v20 offset:2048
  ds_read_b64_tr_b16 a[76:77], v21 offset:0
  ds_read_b64_tr_b16 a[78:79], v21 offset:2048
  ds_read_b64_tr_b16 a[80:81], v18 offset:8192
  ds_read_b64_tr_b16 a[82:83], v18 offset:10240
  ds_read_b64_tr_b16 a[84:85], v19 offset:8192
  ds_read_b64_tr_b16 a[86:87], v19 offset:10240
  ds_read_b64_tr_b16 a[88:89], v20 offset:8192
  ds_read_b64_tr_b16 a[90:91], v20 offset:10240
  ds_read_b64_tr_b16 a[92:93], v21 offset:8192
  ds_read_b64_tr_b16 a[94:95], v21 offset:10240
  s_waitcnt lgkmcnt(0)
  v_mfma_f32_16x16x32_bf16 v[64:67], a[64:67], a[0:3], 0
  s_add_u32 m0, s36, -32768
  ds_read_b128 a[32:35], v17 offset:0
  v_mfma_f32_16x16x32_bf16 v[96:99], a[64:67], a[4:7], 0
  buffer_load_dwordx4 v48, s[8:11], s46 offen offset:0 lds
  v_mfma_f32_16x16x32_bf16 v[128:131], a[64:67], a[8:11], 0
  ds_read_b64_tr_b16 a[96:97], v18 offset:4096
  v_mfma_f32_16x16x32_bf16 v[160:163], a[64:67], a[12:15], 0
  v_mfma_f32_16x16x32_bf16 v[192:195], a[64:67], a[16:19], 0
  ds_read_b64_tr_b16 a[98:99], v18 offset:6144
  v_mfma_f32_16x16x32_bf16 v[224:227], a[64:67], a[20:23], 0
  v_mfma_f32_16x16x32_bf16 a[128:131], a[64:67], a[24:27], 0
  ds_read_b128 a[36:39], v17 offset:2048
  v_mfma_f32_16x16x32_bf16 a[160:163], a[64:67], a[28:31], 0
  buffer_load_dwordx4 v49, s[8:11], s46 offen offset:1024 lds
  v_mfma_f32_16x16x32_bf16 v[68:71], a[68:71], a[0:3], 0
  v_mfma_f32_16x16x32_bf16 v[100:103], a[68:71], a[4:7], 0
  ds_read_b128 a[40:43], v17 offset:4096
  v_mfma_f32_16x16x32_bf16 v[132:135], a[68:71], a[8:11], 0
  v_mfma_f32_16x16x32_bf16 v[164:167], a[68:71], a[12:15], 0
  ds_read_b128 a[44:47], v17 offset:6144
  v_mfma_f32_16x16x32_bf16 v[196:199], a[68:71], a[16:19], 0
  v_mfma_f32_16x16x32_bf16 v[228:231], a[68:71], a[20:23], 0
  ds_read_b128 a[48:51], v17 offset:8192
  v_mfma_f32_16x16x32_bf16 a[132:135], a[68:71], a[24:27], 0
  buffer_load_dwordx4 v50, s[8:11], s46 offen offset:2048 lds
  v_mfma_f32_16x16x32_bf16 a[164:167], a[68:71], a[28:31], 0
  ds_read_b128 a[52:55], v17 offset:10240
  v_mfma_f32_16x16x32_bf16 v[72:75], a[72:75], a[0:3], 0
  v_mfma_f32_16x16x32_bf16 v[104:107], a[72:75], a[4:7], 0
  v_mfma_f32_16x16x32_bf16 v[136:139], a[72:75], a[8:11], 0
  ds_read_b128 a[56:59], v17 offset:12288
  v_mfma_f32_16x16x32_bf16 v[168:171], a[72:75], a[12:15], 0
  v_mfma_f32_16x16x32_bf16 v[200:203], a[72:75], a[16:19], 0
  ds_read_b128 a[60:63], v17 offset:14336
  v_mfma_f32_16x16x32_bf16 v[232:235], a[72:75], a[20:23], 0
  buffer_load_dwordx4 v51, s[8:11], s46 offen offset:3072 lds
  v_mfma_f32_16x16x32_bf16 a[136:139], a[72:75], a[24:27], 0
  s_add_u32 m0, s36, -28672
  ds_read_b64_tr_b16 a[100:101], v19 offset:4096
  v_mfma_f32_16x16x32_bf16 a[168:171], a[72:75], a[28:31], 0
  v_mfma_f32_16x16x32_bf16 v[76:79], a[76:79], a[0:3], 0
  ds_read_b64_tr_b16 a[102:103], v19 offset:6144
  v_mfma_f32_16x16x32_bf16 v[108:111], a[76:79], a[4:7], 0
  v_mfma_f32_16x16x32_bf16 v[140:143], a[76:79], a[8:11], 0
  v_mfma_f32_16x16x32_bf16 v[172:175], a[76:79], a[12:15], 0
  ds_read_b64_tr_b16 a[104:105], v20 offset:4096
  v_mfma_f32_16x16x32_bf16 v[204:207], a[76:79], a[16:19], 0
  buffer_load_dwordx4 v52, s[8:11], s46 offen offset:0 lds
  v_mfma_f32_16x16x32_bf16 v[236:239], a[76:79], a[20:23], 0
  ds_read_b64_tr_b16 a[106:107], v20 offset:6144
  v_mfma_f32_16x16x32_bf16 a[140:143], a[76:79], a[24:27], 0
  v_mfma_f32_16x16x32_bf16 a[172:175], a[76:79], a[28:31], 0
  ds_read_b64_tr_b16 a[108:109], v21 offset:4096
  v_mfma_f32_16x16x32_bf16 v[80:83], a[80:83], a[0:3], 0
  v_mfma_f32_16x16x32_bf16 v[112:115], a[80:83], a[4:7], 0
  ds_read_b64_tr_b16 a[110:111], v21 offset:6144
  v_mfma_f32_16x16x32_bf16 v[144:147], a[80:83], a[8:11], 0
  v_mfma_f32_16x16x32_bf16 v[176:179], a[80:83], a[12:15], 0
  buffer_load_dwordx4 v53, s[8:11], s46 offen offset:1024 lds
  v_mfma_f32_16x16x32_bf16 v[208:211], a[80:83], a[16:19], 0
  ds_read_b64_tr_b16 a[112:113], v18 offset:12288
  v_mfma_f32_16x16x32_bf16 v[240:243], a[80:83], a[20:23], 0
  v_mfma_f32_16x16x32_bf16 a[144:147], a[80:83], a[24:27], 0
  ds_read_b64_tr_b16 a[114:115], v18 offset:14336
  v_mfma_f32_16x16x32_bf16 a[176:179], a[80:83], a[28:31], 0
  v_mfma_f32_16x16x32_bf16 v[84:87], a[84:87], a[0:3], 0
  ds_read_b64_tr_b16 a[116:117], v19 offset:12288
  v_mfma_f32_16x16x32_bf16 v[116:119], a[84:87], a[4:7], 0
  v_mfma_f32_16x16x32_bf16 v[148:151], a[84:87], a[8:11], 0
  buffer_load_dwordx4 v54, s[8:11], s46 offen offset:2048 lds
  ds_read_b64_tr_b16 a[118:119], v19 offset:14336
  v_mfma_f32_16x16x32_bf16 v[180:183], a[84:87], a[12:15], 0
  v_mfma_f32_16x16x32_bf16 v[212:215], a[84:87], a[16:19], 0
  v_mfma_f32_16x16x32_bf16 v[244:247], a[84:87], a[20:23], 0
  ds_read_b64_tr_b16 a[120:121], v20 offset:12288
  v_mfma_f32_16x16x32_bf16 a[148:151], a[84:87], a[24:27], 0
  v_mfma_f32_16x16x32_bf16 a[180:183], a[84:87], a[28:31], 0
  ds_read_b64_tr_b16 a[122:123], v20 offset:14336
  v_mfma_f32_16x16x32_bf16 v[88:91], a[88:91], a[0:3], 0
  v_mfma_f32_16x16x32_bf16 v[120:123], a[88:91], a[4:7], 0
  buffer_load_dwordx4 v55, s[8:11], s46 offen offset:3072 lds
  ds_read_b64_tr_b16 a[124:125], v21 offset:12288
  v_mfma_f32_16x16x32_bf16 v[152:155], a[88:91], a[8:11], 0
  s_sub_u32 s50, s50, 1
  s_cmp_eq_u32 s50, 0
  s_cselect_b32 s12, s72, s12
  s_cselect_b32 s13, s73, s13
  v_mfma_f32_16x16x32_bf16 v[184:187], a[88:91], a[12:15], 0
  s_lshl_b32 s47, s48, 19
  s_bfe_u32 s34, 0x3020106, s49
  s_add_u32 s48, s48, s34
  v_mfma_f32_16x16x32_bf16 v[216:219], a[88:91], a[16:19], 0
  s_add_u32 s49, s49, 8
  s_and_b32 s49, s49, 0x8001f
  s_and_b32 s48, s48, 7
  v_mfma_f32_16x16x32_bf16 v[248:251], a[88:91], a[20:23], 0
  s_lshl_b32 s46, s48, 7
  ds_read_b64_tr_b16 a[126:127], v21 offset:14336
  v_mfma_f32_16x16x32_bf16 a[152:155], a[88:91], a[24:27], 0
  s_add_u32 s37, s37, 1
  s_cmp_eq_u32 s37, 3
  s_cselect_b32 s37, 0, s37
  s_cselect_b32 s38, s39, s40
  v_mfma_f32_16x16x32_bf16 a[184:187], a[88:91], a[28:31], 0
  s_sub_u32 s43, 0, s43
  v_mfma_f32_16x16x32_bf16 v[92:95], a[92:95], a[0:3], 0
  v_add_u32 v16, s38, v16
  v_add_u32 v17, s38, v17
  v_mfma_f32_16x16x32_bf16 v[124:127], a[92:95], a[4:7], 0
  v_add_u32 v18, s43, v18
  v_add_u32 v19, s43, v19
  v_mfma_f32_16x16x32_bf16 v[156:159], a[92:95], a[8:11], 0
  v_add_u32 v20, s43, v20
  v_add_u32 v21, s43, v21
  v_mfma_f32_16x16x32_bf16 v[188:191], a[92:95], a[12:15], 0
  v_mfma_f32_16x16x32_bf16 v[220:223], a[92:95], a[16:19], 0
  v_mfma_f32_16x16x32_bf16 v[252:255], a[92:95], a[20:23], 0
  v_mfma_f32_16x16x32_bf16 a[156:159], a[92:95], a[24:27], 0
  v_mfma_f32_16x16x32_bf16 a[188:191], a[92:95], a[28:31], 0
  s_mov_b32 s35, 6
  s_waitcnt vmcnt(8) lgkmcnt(0)
  s_barrier
  .p2align 6
Lp1wx_loop:
  v_mfma_f32_16x16x32_bf16 v[64:67], a[96:99], a[32:35], v[64:67]
  s_mov_b32 m0, s41
  ds_read_b128 a[0:3], v16 offset:0
  v_mfma_f32_16x16x32_bf16 v[96:99], a[96:99], a[36:39], v[96:99]
  buffer_load_dwordx4 v56, s[12:15], s47 offen offset:0 lds
  v_mfma_f32_16x16x32_bf16 v[128:131], a[96:99], a[40:43], v[128:131]
  ds_read_b64_tr_b16 a[64:65], v18 offset:0
  v_mfma_f32_16x16x32_bf16 v[160:163], a[96:99], a[44:47], v[160:163]
  v_mfma_f32_16x16x32_bf16 v[192:195], a[96:99], a[48:51], v[192:195]
  ds_read_b64_tr_b16 a[66:67], v18 offset:2048
  v_mfma_f32_16x16x32_bf16 v[224:227], a[96:99], a[52:55], v[224:227]
  v_mfma_f32_16x16x32_bf16 a[128:131], a[96:99], a[56:59], a[128:131]
  ds_read_b128 a[4:7], v16 offset:2048
  v_mfma_f32_16x16x32_bf16 a[160:163], a[96:99], a[60:63], a[160:163]
  buffer_load_dwordx4 v57, s[12:15], s47 offen offset:1024 lds
  v_mfma_f32_16x16x32_bf16 v[68:71], a[100:103], a[32:35], v[68:71]
  v_mfma_f32_16x16x32_bf16 v[100:103], a[100:103], a[36:39], v[100:103]
  ds_read_b128 a[8:11], v16 offset:4096
  v_mfma_f32_16x16x32_bf16 v[132:135], a[100:103], a[40:43], v[132:135]
  v_mfma_f32_16x16x32_bf16 v[164:167], a[100:103], a[44:47], v[164:167]
  ds_read_b128 a[12:15], v16 offset:6144
  v_mfma_f32_16x16x32_bf16 v[196:199], a[100:103], a[48:51], v[196:199]
  v_mfma_f32_16x16x32_bf16 v[228:231], a[100:103], a[52:55], v[228:231]
  ds_read_b128 a[16:19], v16 offset:8192
  v_mfma_f32_16x16x32_bf16 a[132:135], a[100:103], a[56:59], a[132:135]
  v_mfma_f32_16x16x32_bf16 a[164:167], a[100:103], a[60:63], a[164:167]
  buffer_load_dwordx4 v58, s[12:15], s47 offen offset:2048 lds
  ds_read_b128 a[20:23], v16 offset:10240
  v_mfma_f32_16x16x32_bf16 v[72:75], a[104:107], a[32:35], v[72:75]
  v_mfma_f32_16x16x32_bf16 v[104:107], a[104:107], a[36:39], v[104:107]
  v_mfma_f32_16x16x32_bf16 v[136:139], a[104:107], a[40:43], v[136:139]
  ds_read_b128 a[24:27], v16 offset:12288
  v_mfma_f32_16x16x32_bf16 v[168:171], a[104:107], a[44:47], v[168:171]
  v_mfma_f32_16x16x32_bf16 v[200:203], a[104:107], a[48:51], v[200:203]
  ds_read_b128 a[28:31], v16 offset:14336
  v_mfma_f32_16x16x32_bf16 v[232:235], a[104:107], a[52:55], v[232:235]
  v_mfma_f32_16x16x32_bf16 a[136:139], a[104:107], a[56:59], a[136:139]
  ds_read_b64_tr_b16 a[68:69], v19 offset:0
  v_mfma_f32_16x16x32_bf16 a[168:171], a[104:107], a[60:63], a[168:171]
  buffer_load_dwordx4 v59, s[12:15], s47 offen offset:3072 lds
  v_mfma_f32_16x16x32_bf16 v[76:79], a[108:111], a[32:35], v[76:79]
  s_add_u32 m0, s41, 4096
  ds_read_b64_tr_b16 a[70:71], v19 offset:2048
  v_mfma_f32_16x16x32_bf16 v[108:111], a[108:111], a[36:39], v[108:111]
  v_mfma_f32_16x16x32_bf16 v[140:143], a[108:111], a[40:43], v[140:143]
  v_mfma_f32_16x16x32_bf16 v[172:175], a[108:111], a[44:47], v[172:175]
  ds_read_b64_tr_b16 a[72:73], v20 offset:0
  v_mfma_f32_16x16x32_bf16 v[204:207], a[108:111], a[48:51], v[204:207]
  v_mfma_f32_16x16x32_bf16 v[236:239], a[108:111], a[52:55], v[236:239]
  ds_read_b64_tr_b16 a[74:75], v20 offset:2048
  v_mfma_f32_16x16x32_bf16 a[140:143], a[108:111], a[56:59], a[140:143]
  v_mfma_f32_16x16x32_bf16 a[172:175], a[108:111], a[60:63], a[172:175]
  buffer_load_dwordx4 v60, s[12:15], s47 offen offset:0 lds
  ds_read_b64_tr_b16 a[76:77], v21 offset:0
  v_mfma_f32_16x16x32_bf16 v[80:83], a[112:115], a[32:35], v[80:83]
  v_mfma_f32_16x16x32_bf16 v[112:115], a[112:115], a[36:39], v[112:115]
  ds_read_b64_tr_b16 a[78:79], v21 offset:2048
  v_mfma_f32_16x16x32_bf16 v[144:147], a[112:115], a[40:43], v[144:147]
  v_mfma_f32_16x16x32_bf16 v[176:179], a[112:115], a[44:47], v[176:179]
  v_mfma_f32_16x16x32_bf16 v[208:211], a[112:115], a[48:51], v[208:211]
  ds_read_b64_tr_b16 a[80:81], v18 offset:8192
  v_mfma_f32_16x16x32_bf16 v[240:243], a[112:115], a[52:55], v[240:243]
  v_mfma_f32_16x16x32_bf16 a[144:147], a[112:115], a[56:59], a[144:147]
  ds_read_b64_tr_b16 a[82:83], v18 offset:10240
  v_mfma_f32_16x16x32_bf16 a[176:179], a[112:115], a[60:63], a[176:179]
  buffer_load_dwordx4 v61, s[12:15], s47 offen offset:1024 lds
  v_mfma_f32_16x16x32_bf16 v[84:87], a[116:119], a[32:35], v[84:87]
  ds_read_b64_tr_b16 a[84:85], v19 offset:8192
  v_mfma_f32_16x16x32_bf16 v[116:119], a[116:119], a[36:39], v[116:119]
  v_mfma_f32_16x16x32_bf16 v[148:151], a[116:119], a[40:43], v[148:151]
  ds_read_b64_tr_b16 a[86:87], v19 offset:10240
  v_mfma_f32_16x16x32_bf16 v[180:183], a[116:119], a[44:47], v[180:183]
  v_mfma_f32_16x16x32_bf16 v[212:215], a[116:119], a[48:51], v[212:215]
  v_mfma_f32_16x16x32_bf16 v[244:247], a[116:119], a[52:55], v[244:247]
  ds_read_b64_tr_b16 a[88:89], v20 offset:8192
  v_mfma_f32_16x16x32_bf16 a[148:151], a[116:119], a[56:59], a[148:151]
  v_mfma_f32_16x16x32_bf16 a[180:183], a[116:119], a[60:63], a[180:183]
  buffer_load_dwordx4 v62, s[12:15], s47 offen offset:2048 lds
  ds_read_b64_tr_b16 a[90:91], v20 offset:10240
  v_mfma_f32_16x16x32_bf16 v[88:91], a[120:123], a[32:35], v[88:91]
  v_mfma_f32_16x16x32_bf16 v[120:123], a[120:123], a[36:39], v[120:123]
  ds_read_b64_tr_b16 a[92:93], v21 offset:8192
  v_mfma_f32_16x16x32_bf16 v[152:155], a[120:123], a[40:43], v[152:155]
  v_mfma_f32_16x16x32_bf16 v[184:187], a[120:123], a[44:47], v[184:187]
  ds_read_b64_tr_b16 a[94:95], v21 offset:10240
  v_mfma_f32_16x16x32_bf16 v[216:219], a[120:123], a[48:51], v[216:219]
  v_mfma_f32_16x16x32_bf16 v[248:251], a[120:123], a[52:55], v[248:251]
  v_mfma_f32_16x16x32_bf16 a[152:155], a[120:123], a[56:59], a[152:155]
  v_mfma_f32_16x16x32_bf16 a[184:187], a[120:123], a[60:63], a[184:187]
  buffer_load_dwordx4 v63, s[12:15], s47 offen offset:3072 lds
  v_mfma_f32_16x16x32_bf16 v[92:95], a[124:127], a[32:35], v[92:95]
  v_mfma_f32_16x16x32_bf16 v[124:127], a[124:127], a[36:39], v[124:127]
  v_mfma_f32_16x16x32_bf16 v[156:159], a[124:127], a[40:43], v[156:159]
  v_mfma_f32_16x16x32_bf16 v[188:191], a[124:127], a[44:47], v[188:191]
  v_mfma_f32_16x16x32_bf16 v[220:223], a[124:127], a[48:51], v[220:223]
  v_mfma_f32_16x16x32_bf16 v[252:255], a[124:127], a[52:55], v[252:255]
  v_mfma_f32_16x16x32_bf16 a[156:159], a[124:127], a[56:59], a[156:159]
  v_mfma_f32_16x16x32_bf16 a[188:191], a[124:127], a[60:63], a[188:191]
  s_waitcnt lgkmcnt(0)
  v_mfma_f32_16x16x32_bf16 v[64:67], a[64:67], a[0:3], v[64:67]
  s_mov_b32 m0, s36
  ds_read_b128 a[32:35], v17 offset:0
  v_mfma_f32_16x16x32_bf16 v[96:99], a[64:67], a[4:7], v[96:99]
  buffer_load_dwordx4 v48, s[8:11], s46 offen offset:0 lds
  v_mfma_f32_16x16x32_bf16 v[128:131], a[64:67], a[8:11], v[128:131]
  ds_read_b64_tr_b16 a[96:97], v18 offset:4096
  v_mfma_f32_16x16x32_bf16 v[160:163], a[64:67], a[12:15], v[160:163]
  v_mfma_f32_16x16x32_bf16 v[192:195], a[64:67], a[16:19], v[192:195]
  ds_read_b64_tr_b16 a[98:99], v18 offset:6144
  v_mfma_f32_16x16x32_bf16 v[224:227], a[64:67], a[20:23], v[224:227]
  v_mfma_f32_16x16x32_bf16 a[128:131], a[64:67], a[24:27], a[128:131]
  ds_read_b128 a[36:39], v17 offset:2048
  v_mfma_f32_16x16x32_bf16 a[160:163], a[64:67], a[28:31], a[160:163]
  buffer_load_dwordx4 v49, s[8:11], s46 offen offset:1024 lds
  v_mfma_f32_16x16x32_bf16 v[68:71], a[68:71], a[0:3], v[68:71]
  v_mfma_f32_16x16x32_bf16 v[100:103], a[68:71], a[4:7], v[100:103]
  ds_read_b128 a[40:43], v17 offset:4096
  v_mfma_f32_16x16x32_bf16 v[132:135], a[68:71], a[8:11], v[132:135]
  v_mfma_f32_16x16x32_bf16 v[164:167], a[68:71], a[12:15], v[164:167]
  ds_read_b128 a[44:47], v17 offset:6144
  v_mfma_f32_16x16x32_bf16 v[196:199], a[68:71], a[16:19], v[196:199]
  v_mfma_f32_16x16x32_bf16 v[228:231], a[68:71], a[20:23], v[228:231]
  ds_read_b128 a[48:51], v17 offset:8192
  v_mfma_f32_16x16x32_bf16 a[132:135], a[68:71], a[24:27], a[132:135]
  buffer_load_dwordx4 v50, s[8:11], s46 offen offset:2048 lds
  v_mfma_f32_16x16x32_bf16 a[164:167], a[68:71], a[28:31], a[164:167]
  ds_read_b128 a[52:55], v17 offset:10240
  v_mfma_f32_16x16x32_bf16 v[72:75], a[72:75], a[0:3], v[72:75]
  v_mfma_f32_16x16x32_bf16 v[104:107], a[72:75], a[4:7], v[104:107]
  v_mfma_f32_16x16x32_bf16 v[136:139], a[72:75], a[8:11], v[136:139]
  ds_read_b128 a[56:59], v17 offset:12288
  v_mfma_f32_16x16x32_bf16 v[168:171], a[72:75], a[12:15], v[168:171]
  v_mfma_f32_16x16x32_bf16 v[200:203], a[72:75], a[16:19], v[200:203]
  ds_read_b128 a[60:63], v17 offset:14336
  v_mfma_f32_16x16x32_bf16 v[232:235], a[72:75], a[20:23], v[232:235]
  buffer_load_dwordx4 v51, s[8:11], s46 offen offset:3072 lds
  v_mfma_f32_16x16x32_bf16 a[136:139], a[72:75], a[24:27], a[136:139]
  s_add_u32 m0, s36, 4096
  ds_read_b64_tr_b16 a[100:101], v19 offset:4096
  v_mfma_f32_16x16x32_bf16 a[168:171], a[72:75], a[28:31], a[168:171]
  v_mfma_f32_16x16x32_bf16 v[76:79], a[76:79], a[0:3], v[76:79]
  ds_read_b64_tr_b16 a[102:103], v19 offset:6144
  v_mfma_f32_16x16x32_bf16 v[108:111], a[76:79], a[4:7], v[108:111]
  v_mfma_f32_16x16x32_bf16 v[140:143], a[76:79], a[8:11], v[140:143]
  v_mfma_f32_16x16x32_bf16 v[172:175], a[76:79], a[12:15], v[172:175]
  ds_read_b64_tr_b16 a[104:105], v20 offset:4096
  v_mfma_f32_16x16x32_bf16 v[204:207], a[76:79], a[16:19], v[204:207]
  buffer_load_dwordx4 v52, s[8:11], s46 offen offset:0 lds
  v_mfma_f32_16x16x32_bf16 v[236:239], a[76:79], a[20:23], v[236:239]
  ds_read_b64_tr_b16 a[106:107], v20 offset:6144
  v_mfma_f32_16x16x32_bf16 a[140:143], a[76:79], a[24:27], a[140:143]
  v_mfma_f32_16x16x32_bf16 a[172:175], a[76:79], a[28:31], a[172:175]
  ds_read_b64_tr_b16 a[108:109], v21 offset:4096
  v_mfma_f32_16x16x32_bf16 v[80:83], a[80:83], a[0:3], v[80:83]
  v_mfma_f32_16x16x32_bf16 v[112:115], a[80:83], a[4:7], v[112:115]
  ds_read_b64_tr_b16 a[110:111], v21 offset:6144
  v_mfma_f32_16x16x32_bf16 v[144:147], a[80:83], a[8:11], v[144:147]
  v_mfma_f32_16x16x32_bf16 v[176:179], a[80:83], a[12:15], v[176:179]
  buffer_load_dwordx4 v53, s[8:11], s46 offen offset:1024 lds
  v_mfma_f32_16x16x32_bf16 v[208:211], a[80:83], a[16:19], v[208:211]
  ds_read_b64_tr_b16 a[112:113], v18 offset:12288
  v_mfma_f32_16x16x32_bf16 v[240:243], a[80:83], a[20:23], v[240:243]
  v_mfma_f32_16x16x32_bf16 a[144:147], a[80:83], a[24:27], a[144:147]
  ds_read_b64_tr_b16 a[114:115], v18 offset:14336
  v_mfma_f32_16x16x32_bf16 a[176:179], a[80:83], a[28:31], a[176:179]
  v_mfma_f32_16x16x32_bf16 v[84:87], a[84:87], a[0:3], v[84:87]
  ds_read_b64_tr_b16 a[116:117], v19 offset:12288
  v_mfma_f32_16x16x32_bf16 v[116:119], a[84:87], a[4:7], v[116:119]
  v_mfma_f32_16x16x32_bf16 v[148:151], a[84:87], a[8:11], v[148:151]
  buffer_load_dwordx4 v54, s[8:11], s46 offen offset:2048 lds
  ds_read_b64_tr_b16 a[118:119], v19 offset:14336
  v_mfma_f32_16x16x32_bf16 v[180:183], a[84:87], a[12:15], v[180:183]
  v_mfma_f32_16x16x32_bf16 v[212:215], a[84:87], a[16:19], v[212:215]
  v_mfma_f32_16x16x32_bf16 v[244:247], a[84:87], a[20:23], v[244:247]
  ds_read_b64_tr_b16 a[120:121], v20 offset:12288
  v_mfma_f32_16x16x32_bf16 a[148:151], a[84:87], a[24:27], a[148:151]
  v_mfma_f32_16x16x32_bf16 a[180:183], a[84:87], a[28:31], a[180:183]
  ds_read_b64_tr_b16 a[122:123], v20 offset:14336
  v_mfma_f32_16x16x32_bf16 v[88:91], a[88:91], a[0:3], v[88:91]
  v_mfma_f32_16x16x32_bf16 v[120:123], a[88:91], a[4:7], v[120:123]
  buffer_load_dwordx4 v55, s[8:11], s46 offen offset:3072 lds
  ds_read_b64_tr_b16 a[124:125], v21 offset:12288
  v_mfma_f32_16x16x32_bf16 v[152:155], a[88:91], a[8:11], v[152:155]
  s_sub_u32 s50, s50, 1
  s_cmp_eq_u32 s50, 0
  s_cselect_b32 s12, s72, s12
  s_cselect_b32 s13, s73, s13
  v_mfma_f32_16x16x32_bf16 v[184:187], a[88:91], a[12:15], v[184:187]
  s_lshl_b32 s47, s48, 19
  s_bfe_u32 s34, 0x3020106, s49
  s_add_u32 s48, s48, s34
  v_mfma_f32_16x16x32_bf16 v[216:219], a[88:91], a[16:19], v[216:219]
  s_add_u32 s49, s49, 8
  s_and_b32 s49, s49, 0x8001f
  s_and_b32 s48, s48, 7
  v_mfma_f32_16x16x32_bf16 v[248:251], a[88:91], a[20:23], v[248:251]
  s_lshl_b32 s46, s48, 7
  ds_read_b64_tr_b16 a[126:127], v21 offset:14336
  v_mfma_f32_16x16x32_bf16 a[152:155], a[88:91], a[24:27], a[152:155]
  s_add_u32 s36, s36, s38
  s_add_u32 s37, s37, 1
  s_cmp_eq_u32 s37, 3
  s_cselect_b32 s37, 0, s37
  s_cselect_b32 s38, s39, s40
  v_mfma_f32_16x16x32_bf16 a[184:187], a[88:91], a[28:31], a[184:187]
  s_add_u32 s41, s41, s43
  s_sub_u32 s43, 0, s43
  v_mfma_f32_16x16x32_bf16 v[92:95], a[92:95], a[0:3], v[92:95]
  v_add_u32 v16, s38, v16
  v_add_u32 v17, s38, v17
  v_mfma_f32_16x16x32_bf16 v[124:127], a[92:95], a[4:7], v[124:127]
  v_add_u32 v18, s43, v18
  v_add_u32 v19, s43, v19
  v_mfma_f32_16x16x32_bf16 v[156:159], a[92:95], a[8:11], v[156:159]
  v_add_u32 v20, s43, v20
  v_add_u32 v21, s43, v21
  v_mfma_f32_16x16x32_bf16 v[188:191], a[92:95], a[12:15], v[188:191]
  v_mfma_f32_16x16x32_bf16 v[220:223], a[92:95], a[16:19], v[220:223]
  v_mfma_f32_16x16x32_bf16 v[252:255], a[92:95], a[20:23], v[252:255]
  s_waitcnt vmcnt(8) lgkmcnt(0)
  s_barrier
  v_mfma_f32_16x16x32_bf16 a[156:159], a[92:95], a[24:27], a[156:159]
  s_sub_u32 s35, s35, 1
  v_mfma_f32_16x16x32_bf16 a[188:191], a[92:95], a[28:31], a[188:191]
  s_cmp_lg_u32 s35, 0
  s_cbranch_scc1 Lp1wx_loop
  v_mfma_f32_16x16x32_bf16 v[64:67], a[96:99], a[32:35], v[64:67]
  s_mov_b32 m0, s41
  ds_read_b128 a[0:3], v16 offset:0
  v_mfma_f32_16x16x32_bf16 v[96:99], a[96:99], a[36:39], v[96:99]
  buffer_load_dwordx4 v56, s[12:15], s47 offen offset:0 lds
  v_mfma_f32_16x16x32_bf16 v[128:131], a[96:99], a[40:43], v[128:131]
  ds_read_b64_tr_b16 a[64:65], v18 offset:0
  v_mfma_f32_16x16x32_bf16 v[160:163], a[96:99], a[44:47], v[160:163]
  buffer_load_dwordx4 v57, s[12:15], s47 offen offset:1024 lds
  v_mfma_f32_16x16x32_bf16 v[192:195], a[96:99], a[48:51], v[192:195]
  ds_read_b64_tr_b16 a[66:67], v18 offset:2048
  v_mfma_f32_16x16x32_bf16 v[224:227], a[96:99], a[52:55], v[224:227]
  v_mfma_f32_16x16x32_bf16 a[128:131], a[96:99], a[56:59], a[128:131]
  ds_read_b128 a[4:7], v16 offset:2048
  v_mfma_f32_16x16x32_bf16 a[160:163], a[96:99], a[60:63], a[160:163]
  buffer_load_dwordx4 v58, s[12:15], s47 offen offset:2048 lds
  v_mfma_f32_16x16x32_bf16 v[68:71], a[100:103], a[32:35], v[68:71]
  v_mfma_f32_16x16x32_bf16 v[100:103], a[100:103], a[36:39], v[100:103]
  ds_read_b128 a[8:11], v16 offset:4096
  v_mfma_f32_16x16x32_bf16 v[132:135], a[100:103], a[40:43], v[132:135]
  v_mfma_f32_16x16x32_bf16 v[164:167], a[100:103], a[44:47], v[164:167]
  buffer_load_dwordx4 v59, s[12:15], s47 offen offset:3072 lds
  ds_read_b128 a[12:15], v16 offset:6144
  v_mfma_f32_16x16x32_bf16 v[196:199], a[100:103], a[48:51], v[196:199]
  s_add_u32 m0, s41, 4096
  v_mfma_f32_16x16x32_bf16 v[228:231], a[100:103], a[52:55], v[228:231]
  ds_read_b128 a[16:19], v16 offset:8192
  v_mfma_f32_16x16x32_bf16 a[132:135], a[100:103], a[56:59], a[132:135]
  v_mfma_f32_16x16x32_bf16 a[164:167], a[100:103], a[60:63], a[164:167]
  buffer_load_dwordx4 v60, s[12:15], s47 offen offset:0 lds
  ds_read_b128 a[20:23], v16 offset:10240
  v_mfma_f32_16x16x32_bf16 v[72:75], a[104:107], a[32:35], v[72:75]
  v_mfma_f32_16x16x32_bf16 v[104:107], a[104:107], a[36:39], v[104:107]
  v_mfma_f32_16x16x32_bf16 v[136:139], a[104:107], a[40:43], v[136:139]
  ds_read_b128 a[24:27], v16 offset:12288
  v_mfma_f32_16x16x32_bf16 v[168:171], a[104:107], a[44:47], v[168:171]
  buffer_load_dwordx4 v61, s[12:15], s47 offen offset:1024 lds
  v_mfma_f32_16x16x32_bf16 v[200:203], a[104:107], a[48:51], v[200:203]
  ds_read_b128 a[28:31], v16 offset:14336
  v_mfma_f32_16x16x32_bf16 v[232:235], a[104:107], a[52:55], v[232:235]
  v_mfma_f32_16x16x32_bf16 a[136:139], a[104:107], a[56:59], a[136:139]
  ds_read_b64_tr_b16 a[68:69], v19 offset:0
  v_mfma_f32_16x16x32_bf16 a[168:171], a[104:107], a[60:63], a[168:171]
  buffer_load_dwordx4 v62, s[12:15], s47 offen offset:2048 lds
  v_mfma_f32_16x16x32_bf16 v[76:79], a[108:111], a[32:35], v[76:79]
  ds_read_b64_tr_b16 a[70:71], v19 offset:2048
  v_mfma_f32_16x16x32_bf16 v[108:111], a[108:111], a[36:39], v[108:111]
  v_mfma_f32_16x16x32_bf16 v[140:143], a[108:111], a[40:43], v[140:143]
  v_mfma_f32_16x16x32_bf16 v[172:175], a[108:111], a[44:47], v[172:175]
  buffer_load_dwordx4 v63, s[12:15], s47 offen offset:3072 lds
  ds_read_b64_tr_b16 a[72:73], v20 offset:0
  v_mfma_f32_16x16x32_bf16 v[204:207], a[108:111], a[48:51], v[204:207]
  s_mov_b32 m0, s36
  v_mfma_f32_16x16x32_bf16 v[236:239], a[108:111], a[52:55], v[236:239]
  ds_read_b64_tr_b16 a[74:75], v20 offset:2048
  v_mfma_f32_16x16x32_bf16 a[140:143], a[108:111], a[56:59], a[140:143]
  v_mfma_f32_16x16x32_bf16 a[172:175], a[108:111], a[60:63], a[172:175]
  buffer_load_dwordx4 v48, s[8:11], s46 offen offset:0 lds
  ds_read_b64_tr_b16 a[76:77], v21 offset:0
  v_mfma_f32_16x16x32_bf16 v[80:83], a[112:115], a[32:35], v[80:83]
  v_mfma_f32_16x16x32_bf16 v[112:115], a[112:115], a[36:39], v[112:115]
  ds_read_b64_tr_b16 a[78:79], v21 offset:2048
  v_mfma_f32_16x16x32_bf16 v[144:147], a[112:115], a[40:43], v[144:147]
  v_mfma_f32_16x16x32_bf16 v[176:179], a[112:115], a[44:47], v[176:179]
  buffer_load_dwordx4 v49, s[8:11], s46 offen offset:1024 lds
  v_mfma_f32_16x16x32_bf16 v[208:211], a[112:115], a[48:51], v[208:211]
  ds_read_b64_tr_b16 a[80:81], v18 offset:8192
  v_mfma_f32_16x16x32_bf16 v[240:243], a[112:115], a[52:55], v[240:243]
  v_mfma_f32_16x16x32_bf16 a[144:147], a[112:115], a[56:59], a[144:147]
  ds_read_b64_tr_b16 a[82:83], v18 offset:10240
  v_mfma_f32_16x16x32_bf16 a[176:179], a[112:115], a[60:63], a[176:179]
  buffer_load_dwordx4 v50, s[8:11], s46 offen offset:2048 lds
  v_mfma_f32_16x16x32_bf16 v[84:87], a[116:119], a[32:35], v[84:87]
  ds_read_b64_tr_b16 a[84:85], v19 offset:8192
  v_mfma_f32_16x16x32_bf16 v[116:119], a[116:119], a[36:39], v[116:119]
  v_mfma_f32_16x16x32_bf16 v[148:151], a[116:119], a[40:43], v[148:151]
  ds_read_b64_tr_b16 a[86:87], v19 offset:10240
  v_mfma_f32_16x16x32_bf16 v[180:183], a[116:119], a[44:47], v[180:183]
  buffer_load_dwordx4 v51, s[8:11], s46 offen offset:3072 lds
  v_mfma_f32_16x16x32_bf16 v[212:215], a[116:119], a[48:51], v[212:215]
  s_add_u32 m0, s36, 4096
  v_mfma_f32_16x16x32_bf16 v[244:247], a[116:119], a[52:55], v[244:247]
  ds_read_b64_tr_b16 a[88:89], v20 offset:8192
  v_mfma_f32_16x16x32_bf16 a[148:151], a[116:119], a[56:59], a[148:151]
  v_mfma_f32_16x16x32_bf16 a[180:183], a[116:119], a[60:63], a[180:183]
  buffer_load_dwordx4 v52, s[8:11], s46 offen offset:0 lds
  ds_read_b64_tr_b16 a[90:91], v20 offset:10240
  v_mfma_f32_16x16x32_bf16 v[88:91], a[120:123], a[32:35], v[88:91]
  v_mfma_f32_16x16x32_bf16 v[120:123], a[120:123], a[36:39], v[120:123]
  ds_read_b64_tr_b16 a[92:93], v21 offset:8192
  v_mfma_f32_16x16x32_bf16 v[152:155], a[120:123], a[40:43], v[152:155]
  v_mfma_f32_16x16x32_bf16 v[184:187], a[120:123], a[44:47], v[184:187]
  buffer_load_dwordx4 v53, s[8:11], s46 offen offset:1024 lds
  ds_read_b64_tr_b16 a[94:95], v21 offset:10240
  v_mfma_f32_16x16x32_bf16 v[216:219], a[120:123], a[48:51], v[216:219]
  v_mfma_f32_16x16x32_bf16 v[248:251], a[120:123], a[52:55], v[248:251]
  v_mfma_f32_16x16x32_bf16 a[152:155], a[120:123], a[56:59], a[152:155]
  v_mfma_f32_16x16x32_bf16 a[184:187], a[120:123], a[60:63], a[184:187]
  buffer_load_dwordx4 v54, s[8:11], s46 offen offset:2048 lds
  v_mfma_f32_16x16x32_bf16 v[92:95], a[124:127], a[32:35], v[92:95]
  v_mfma_f32_16x16x32_bf16 v[124:127], a[124:127], a[36:39], v[124:127]
  v_mfma_f32_16x16x32_bf16 v[156:159], a[124:127], a[40:43], v[156:159]
  v_mfma_f32_16x16x32_bf16 v[188:191], a[124:127], a[44:47], v[188:191]
  buffer_load_dwordx4 v55, s[8:11], s46 offen offset:3072 lds
  v_mfma_f32_16x16x32_bf16 v[220:223], a[124:127], a[48:51], v[220:223]
  s_sub_u32 s50, s50, 1
  s_cmp_eq_u32 s50, 0
  s_cselect_b32 s12, s72, s12
  s_cselect_b32 s13, s73, s13
  v_mfma_f32_16x16x32_bf16 v[252:255], a[124:127], a[52:55], v[252:255]
  s_lshl_b32 s47, s48, 19
  s_bfe_u32 s34, 0x3020106, s49
  s_add_u32 s48, s48, s34
  v_mfma_f32_16x16x32_bf16 a[156:159], a[124:127], a[56:59], a[156:159]
  s_add_u32 s49, s49, 8
  s_and_b32 s49, s49, 0x8001f
  s_and_b32 s48, s48, 7
  v_mfma_f32_16x16x32_bf16 a[188:191], a[124:127], a[60:63], a[188:191]
  s_lshl_b32 s46, s48, 7
  s_waitcnt lgkmcnt(0)
  v_mfma_f32_16x16x32_bf16 v[128:131], a[64:67], a[8:11], v[128:131]
  ds_read_b128 a[32:35], v17 offset:0
  ds_read_b64_tr_b16 a[96:97], v18 offset:4096
  v_mfma_f32_16x16x32_bf16 v[132:135], a[68:71], a[8:11], v[132:135]
  ds_read_b64_tr_b16 a[98:99], v18 offset:6144
  ds_read_b128 a[36:39], v17 offset:2048
  v_mfma_f32_16x16x32_bf16 a[128:131], a[64:67], a[24:27], a[128:131]
  ds_read_b128 a[40:43], v17 offset:4096
  ds_read_b128 a[44:47], v17 offset:6144
  v_mfma_f32_16x16x32_bf16 a[132:135], a[68:71], a[24:27], a[132:135]
  ds_read_b128 a[48:51], v17 offset:8192
  ds_read_b128 a[52:55], v17 offset:10240
  v_mfma_f32_16x16x32_bf16 v[136:139], a[72:75], a[8:11], v[136:139]
  ds_read_b128 a[56:59], v17 offset:12288
  ds_read_b128 a[60:63], v17 offset:14336
  v_mfma_f32_16x16x32_bf16 v[140:143], a[76:79], a[8:11], v[140:143]
  ds_read_b64_tr_b16 a[100:101], v19 offset:4096
  ds_read_b64_tr_b16 a[102:103], v19 offset:6144
  v_mfma_f32_16x16x32_bf16 a[136:139], a[72:75], a[24:27], a[136:139]
  ds_read_b64_tr_b16 a[104:105], v20 offset:4096
  v_mfma_f32_16x16x32_bf16 a[140:143], a[76:79], a[24:27], a[140:143]
  ds_read_b64_tr_b16 a[106:107], v20 offset:6144
  ds_read_b64_tr_b16 a[108:109], v21 offset:4096
  v_mfma_f32_16x16x32_bf16 v[144:147], a[80:83], a[8:11], v[144:147]
  ds_read_b64_tr_b16 a[110:111], v21 offset:6144
  ds_read_b64_tr_b16 a[112:113], v18 offset:12288
  v_mfma_f32_16x16x32_bf16 v[148:151], a[84:87], a[8:11], v[148:151]
  ds_read_b64_tr_b16 a[114:115], v18 offset:14336
  ds_read_b64_tr_b16 a[116:117], v19 offset:12288
  v_mfma_f32_16x16x32_bf16 a[144:147], a[80:83], a[24:27], a[144:147]
  ds_read_b64_tr_b16 a[118:119], v19 offset:14336
  ds_read_b64_tr_b16 a[120:121], v20 offset:12288
  v_mfma_f32_16x16x32_bf16 a[148:151], a[84:87], a[24:27], a[148:151]
  ds_read_b64_tr_b16 a[122:123], v20 offset:14336
  ds_read_b64_tr_b16 a[124:125], v21 offset:12288
  v_mfma_f32_16x16x32_bf16 v[152:155], a[88:91], a[8:11], v[152:155]
  ds_read_b64_tr_b16 a[126:127], v21 offset:14336
  v_mfma_f32_16x16x32_bf16 v[156:159], a[92:95], a[8:11], v[156:159]
  v_mfma_f32_16x16x32_bf16 a[152:155], a[88:91], a[24:27], a[152:155]
  v_mfma_f32_16x16x32_bf16 a[156:159], a[92:95], a[24:27], a[156:159]
  v_mfma_f32_16x16x32_bf16 v[160:163], a[64:67], a[12:15], v[160:163]
  v_mfma_f32_16x16x32_bf16 v[164:167], a[68:71], a[12:15], v[164:167]
  s_add_u32 s36, s36, s38
  s_add_u32 s37, s37, 1
  s_cmp_eq_u32 s37, 3
  s_cselect_b32 s37, 0, s37
  s_cselect_b32 s38, s39, s40
  v_add_u32 v16, s38, v16
  v_add_u32 v17, s38, v17
  s_add_u32 s41, s41, s43
  s_sub_u32 s43, 0, s43
  v_add_u32 v18, s43, v18
  v_add_u32 v19, s43, v19
  v_add_u32 v20, s43, v20
  v_add_u32 v21, s43, v21
  s_waitcnt vmcnt(8) lgkmcnt(0)
  s_barrier
  v_mfma_f32_16x16x32_bf16 v[128:131], a[96:99], a[40:43], v[128:131]
  s_mov_b32 m0, s41
  v_mfma_f32_16x16x32_bf16 v[132:135], a[100:103], a[40:43], v[132:135]
  buffer_load_dwordx4 v56, s[12:15], s47 offen offset:0 lds
  v_mfma_f32_16x16x32_bf16 a[128:131], a[96:99], a[56:59], a[128:131]
  v_mfma_f32_16x16x32_bf16 a[132:135], a[100:103], a[56:59], a[132:135]
  v_mfma_f32_16x16x32_bf16 v[136:139], a[104:107], a[40:43], v[136:139]
  v_mfma_f32_16x16x32_bf16 v[140:143], a[108:111], a[40:43], v[140:143]
  buffer_load_dwordx4 v57, s[12:15], s47 offen offset:1024 lds
  v_cvt_pk_bf16_f32 v128, v128, v129
  v_mfma_f32_16x16x32_bf16 a[136:139], a[104:107], a[56:59], a[136:139]
  v_cvt_pk_bf16_f32 v129, v130, v131
  v_cvt_pk_bf16_f32 v130, v132, v133
  v_mfma_f32_16x16x32_bf16 a[140:143], a[108:111], a[56:59], a[140:143]
  v_cvt_pk_bf16_f32 v131, v134, v135
  v_accvgpr_read_b32 v24, a128
  v_mfma_f32_16x16x32_bf16 v[144:147], a[112:115], a[40:43], v[144:147]
  v_accvgpr_read_b32 v25, a129
  v_accvgpr_read_b32 v26, a130
  v_mfma_f32_16x16x32_bf16 v[148:151], a[116:119], a[40:43], v[148:151]
  v_accvgpr_read_b32 v27, a131
  v_accvgpr_read_b32 v28, a132
  v_mfma_f32_16x16x32_bf16 a[144:147], a[112:115], a[56:59], a[144:147]
  v_accvgpr_read_b32 v29, a133
  v_accvgpr_read_b32 v30, a134
  v_mfma_f32_16x16x32_bf16 a[148:151], a[116:119], a[56:59], a[148:151]
  buffer_load_dwordx4 v58, s[12:15], s47 offen offset:2048 lds
  v_accvgpr_read_b32 v31, a135
  v_mfma_f32_16x16x32_bf16 v[152:155], a[120:123], a[40:43], v[152:155]
  v_cvt_pk_bf16_f32 v132, v24, v25
  v_cvt_pk_bf16_f32 v133, v26, v27
  v_mfma_f32_16x16x32_bf16 v[156:159], a[124:127], a[40:43], v[156:159]
  v_cvt_pk_bf16_f32 v134, v28, v29
  v_cvt_pk_bf16_f32 v135, v30, v31
  v_mfma_f32_16x16x32_bf16 a[152:155], a[120:123], a[56:59], a[152:155]
  s_add_u32 s60, s63, 8192
  buffer_store_dwordx4 v[128:131], v2, s[16:19], s60 offen offset:0 sc1
  v_cvt_pk_bf16_f32 v136, v136, v137
  v_mfma_f32_16x16x32_bf16 a[156:159], a[124:127], a[56:59], a[156:159]
  v_cvt_pk_bf16_f32 v137, v138, v139
  v_cvt_pk_bf16_f32 v138, v140, v141
  v_mfma_f32_16x16x32_bf16 v[160:163], a[96:99], a[44:47], v[160:163]
  v_cvt_pk_bf16_f32 v139, v142, v143
  v_mfma_f32_16x16x32_bf16 v[164:167], a[100:103], a[44:47], v[164:167]
  buffer_load_dwordx4 v59, s[12:15], s47 offen offset:3072 lds
  v_mfma_f32_16x16x32_bf16 a[160:163], a[64:67], a[28:31], a[160:163]
  s_add_u32 m0, s41, 4096
  v_mfma_f32_16x16x32_bf16 a[164:167], a[68:71], a[28:31], a[164:167]
  s_add_u32 s60, s63, 40960
  buffer_store_dwordx4 v[132:135], v2, s[16:19], s60 offen offset:0 sc1
  v_accvgpr_read_b32 v32, a136
  v_mfma_f32_16x16x32_bf16 a[160:163], a[96:99], a[60:63], a[160:163]
  v_accvgpr_read_b32 v33, a137
  v_accvgpr_read_b32 v34, a138
  v_mfma_f32_16x16x32_bf16 a[164:167], a[100:103], a[60:63], a[164:167]
  v_accvgpr_read_b32 v35, a139
  v_accvgpr_read_b32 v36, a140
  v_mfma_f32_16x16x32_bf16 v[168:171], a[72:75], a[12:15], v[168:171]
  buffer_load_dwordx4 v60, s[12:15], s47 offen offset:0 lds
  v_accvgpr_read_b32 v37, a141
  v_mfma_f32_16x16x32_bf16 v[172:175], a[76:79], a[12:15], v[172:175]
  v_accvgpr_read_b32 v38, a142
  v_accvgpr_read_b32 v39, a143
  v_mfma_f32_16x16x32_bf16 v[168:171], a[104:107], a[44:47], v[168:171]
  v_cvt_pk_bf16_f32 v140, v32, v33
  v_cvt_pk_bf16_f32 v141, v34, v35
  v_mfma_f32_16x16x32_bf16 v[172:175], a[108:111], a[44:47], v[172:175]
  v_cvt_pk_bf16_f32 v142, v36, v37
  v_cvt_pk_bf16_f32 v143, v38, v39
  v_mfma_f32_16x16x32_bf16 a[168:171], a[72:75], a[28:31], a[168:171]
  s_add_u32 s60, s63, 8192
  buffer_store_dwordx4 v[136:139], v2, s[16:19], s60 offen offset:1024 sc1
  v_cvt_pk_bf16_f32 v144, v144, v145
  v_mfma_f32_16x16x32_bf16 a[172:175], a[76:79], a[28:31], a[172:175]
  v_cvt_pk_bf16_f32 v145, v146, v147
  v_cvt_pk_bf16_f32 v146, v148, v149
  v_mfma_f32_16x16x32_bf16 a[168:171], a[104:107], a[60:63], a[168:171]
  buffer_load_dwordx4 v61, s[12:15], s47 offen offset:1024 lds
  v_cvt_pk_bf16_f32 v147, v150, v151
  v_mfma_f32_16x16x32_bf16 a[172:175], a[108:111], a[60:63], a[172:175]
  s_add_u32 s60, s63, 40960
  buffer_store_dwordx4 v[140:143], v2, s[16:19], s60 offen offset:1024 sc1
  v_accvgpr_read_b32 v40, a144
  v_mfma_f32_16x16x32_bf16 v[176:179], a[80:83], a[12:15], v[176:179]
  v_accvgpr_read_b32 v41, a145
  v_accvgpr_read_b32 v42, a146
  v_mfma_f32_16x16x32_bf16 v[180:183], a[84:87], a[12:15], v[180:183]
  v_accvgpr_read_b32 v43, a147
  v_accvgpr_read_b32 v44, a148
  v_mfma_f32_16x16x32_bf16 v[176:179], a[112:115], a[44:47], v[176:179]
  v_accvgpr_read_b32 v45, a149
  v_accvgpr_read_b32 v46, a150
  v_mfma_f32_16x16x32_bf16 v[180:183], a[116:119], a[44:47], v[180:183]
  v_accvgpr_read_b32 v47, a151
  v_cvt_pk_bf16_f32 v148, v40, v41
  v_mfma_f32_16x16x32_bf16 a[176:179], a[80:83], a[28:31], a[176:179]
  buffer_load_dwordx4 v62, s[12:15], s47 offen offset:2048 lds
  v_cvt_pk_bf16_f32 v149, v42, v43
  v_mfma_f32_16x16x32_bf16 a[180:183], a[84:87], a[28:31], a[180:183]
  v_cvt_pk_bf16_f32 v150, v44, v45
  v_cvt_pk_bf16_f32 v151, v46, v47
  v_mfma_f32_16x16x32_bf16 a[176:179], a[112:115], a[60:63], a[176:179]
  s_add_u32 s60, s63, 8192
  buffer_store_dwordx4 v[144:147], v2, s[16:19], s60 offen offset:2048 sc1
  v_cvt_pk_bf16_f32 v152, v152, v153
  v_mfma_f32_16x16x32_bf16 a[180:183], a[116:119], a[60:63], a[180:183]
  v_cvt_pk_bf16_f32 v153, v154, v155
  v_cvt_pk_bf16_f32 v154, v156, v157
  v_mfma_f32_16x16x32_bf16 v[184:187], a[88:91], a[12:15], v[184:187]
  v_cvt_pk_bf16_f32 v155, v158, v159
  v_mfma_f32_16x16x32_bf16 v[188:191], a[92:95], a[12:15], v[188:191]
  buffer_load_dwordx4 v63, s[12:15], s47 offen offset:3072 lds
  v_mfma_f32_16x16x32_bf16 v[184:187], a[120:123], a[44:47], v[184:187]
  s_mov_b32 m0, s36
  v_mfma_f32_16x16x32_bf16 v[188:191], a[124:127], a[44:47], v[188:191]
  s_add_u32 s60, s63, 40960
  buffer_store_dwordx4 v[148:151], v2, s[16:19], s60 offen offset:2048 sc1
  v_accvgpr_read_b32 v24, a152
  v_mfma_f32_16x16x32_bf16 a[184:187], a[88:91], a[28:31], a[184:187]
  v_accvgpr_read_b32 v25, a153
  v_accvgpr_read_b32 v26, a154
  v_mfma_f32_16x16x32_bf16 a[188:191], a[92:95], a[28:31], a[188:191]
  v_accvgpr_read_b32 v27, a155
  v_accvgpr_read_b32 v28, a156
  v_mfma_f32_16x16x32_bf16 a[184:187], a[120:123], a[60:63], a[184:187]
  v_accvgpr_read_b32 v29, a157
  v_accvgpr_read_b32 v30, a158
  v_mfma_f32_16x16x32_bf16 a[188:191], a[124:127], a[60:63], a[188:191]
  buffer_load_dwordx4 v48, s[8:11], s46 offen offset:0 lds
  v_accvgpr_read_b32 v31, a159
  v_mfma_f32_16x16x32_bf16 v[192:195], a[64:67], a[16:19], v[192:195]
  v_cvt_pk_bf16_f32 v156, v24, v25
  v_cvt_pk_bf16_f32 v157, v26, v27
  v_mfma_f32_16x16x32_bf16 v[196:199], a[68:71], a[16:19], v[196:199]
  v_cvt_pk_bf16_f32 v158, v28, v29
  v_cvt_pk_bf16_f32 v159, v30, v31
  v_mfma_f32_16x16x32_bf16 v[192:195], a[96:99], a[48:51], v[192:195]
  v_cvt_pk_bf16_f32 v160, v160, v161
  v_cvt_pk_bf16_f32 v161, v162, v163
  v_mfma_f32_16x16x32_bf16 v[196:199], a[100:103], a[48:51], v[196:199]
  v_cvt_pk_bf16_f32 v162, v164, v165
  v_cvt_pk_bf16_f32 v163, v166, v167
  v_mfma_f32_16x16x32_bf16 v[64:67], a[64:67], a[0:3], v[64:67]
  s_add_u32 s60, s63, 8192
  buffer_store_dwordx4 v[152:155], v2, s[16:19], s60 offen offset:3072 sc1
  v_accvgpr_read_b32 v32, a160
  v_mfma_f32_16x16x32_bf16 v[68:71], a[68:71], a[0:3], v[68:71]
  buffer_load_dwordx4 v49, s[8:11], s46 offen offset:1024 lds
  v_accvgpr_read_b32 v33, a161
  v_mfma_f32_16x16x32_bf16 v[64:67], a[96:99], a[32:35], v[64:67]
  v_accvgpr_read_b32 v34, a162
  v_accvgpr_read_b32 v35, a163
  v_mfma_f32_16x16x32_bf16 v[68:71], a[100:103], a[32:35], v[68:71]
  v_accvgpr_read_b32 v36, a164
  v_accvgpr_read_b32 v37, a165
  v_mfma_f32_16x16x32_bf16 v[200:203], a[72:75], a[16:19], v[200:203]
  v_accvgpr_read_b32 v38, a166
  v_accvgpr_read_b32 v39, a167
  v_mfma_f32_16x16x32_bf16 v[204:207], a[76:79], a[16:19], v[204:207]
  v_cvt_pk_bf16_f32 v164, v32, v33
  v_cvt_pk_bf16_f32 v165, v34, v35
  v_mfma_f32_16x16x32_bf16 v[200:203], a[104:107], a[48:51], v[200:203]
  buffer_load_dwordx4 v50, s[8:11], s46 offen offset:2048 lds
  v_cvt_pk_bf16_f32 v166, v36, v37
  v_mfma_f32_16x16x32_bf16 v[204:207], a[108:111], a[48:51], v[204:207]
  v_cvt_pk_bf16_f32 v167, v38, v39
  v_mfma_f32_16x16x32_bf16 v[72:75], a[72:75], a[0:3], v[72:75]
  s_add_u32 s60, s63, 40960
  buffer_store_dwordx4 v[156:159], v2, s[16:19], s60 offen offset:3072 sc1
  v_cvt_pk_bf16_f32 v168, v168, v169
  v_mfma_f32_16x16x32_bf16 v[76:79], a[76:79], a[0:3], v[76:79]
  v_cvt_pk_bf16_f32 v169, v170, v171
  v_cvt_pk_bf16_f32 v170, v172, v173
  v_mfma_f32_16x16x32_bf16 v[72:75], a[104:107], a[32:35], v[72:75]
  v_cvt_pk_bf16_f32 v171, v174, v175
  v_mfma_f32_16x16x32_bf16 v[76:79], a[108:111], a[32:35], v[76:79]
  s_add_u32 s60, s63, 12288
  buffer_store_dwordx4 v[160:163], v2, s[16:19], s60 offen offset:0 sc1
  v_accvgpr_read_b32 v40, a168
  v_mfma_f32_16x16x32_bf16 v[208:211], a[80:83], a[16:19], v[208:211]
  buffer_load_dwordx4 v51, s[8:11], s46 offen offset:3072 lds
  v_accvgpr_read_b32 v41, a169
  v_mfma_f32_16x16x32_bf16 v[212:215], a[84:87], a[16:19], v[212:215]
  s_add_u32 m0, s36, 4096
  v_accvgpr_read_b32 v42, a170
  v_accvgpr_read_b32 v43, a171
  v_mfma_f32_16x16x32_bf16 v[208:211], a[112:115], a[48:51], v[208:211]
  v_accvgpr_read_b32 v44, a172
  v_accvgpr_read_b32 v45, a173
  v_mfma_f32_16x16x32_bf16 v[212:215], a[116:119], a[48:51], v[212:215]
  v_accvgpr_read_b32 v46, a174
  v_accvgpr_read_b32 v47, a175
  v_mfma_f32_16x16x32_bf16 v[80:83], a[80:83], a[0:3], v[80:83]
  v_cvt_pk_bf16_f32 v172, v40, v41
  v_cvt_pk_bf16_f32 v173, v42, v43
  v_mfma_f32_16x16x32_bf16 v[84:87], a[84:87], a[0:3], v[84:87]
  v_cvt_pk_bf16_f32 v174, v44, v45
  v_cvt_pk_bf16_f32 v175, v46, v47
  v_mfma_f32_16x16x32_bf16 v[80:83], a[112:115], a[32:35], v[80:83]
  buffer_load_dwordx4 v52, s[8:11], s46 offen offset:0 lds
  v_mfma_f32_16x16x32_bf16 v[84:87], a[116:119], a[32:35], v[84:87]
  s_add_u32 s60, s63, 45056
  buffer_store_dwordx4 v[164:167], v2, s[16:19], s60 offen offset:0 sc1
  v_cvt_pk_bf16_f32 v176, v176, v177
  v_mfma_f32_16x16x32_bf16 v[216:219], a[88:91], a[16:19], v[216:219]
  v_cvt_pk_bf16_f32 v177, v178, v179
  v_cvt_pk_bf16_f32 v178, v180, v181
  v_mfma_f32_16x16x32_bf16 v[220:223], a[92:95], a[16:19], v[220:223]
  v_cvt_pk_bf16_f32 v179, v182, v183
  v_mfma_f32_16x16x32_bf16 v[216:219], a[120:123], a[48:51], v[216:219]
  s_add_u32 s60, s63, 12288
  buffer_store_dwordx4 v[168:171], v2, s[16:19], s60 offen offset:1024 sc1
  v_accvgpr_read_b32 v24, a176
  v_mfma_f32_16x16x32_bf16 v[220:223], a[124:127], a[48:51], v[220:223]
  buffer_load_dwordx4 v53, s[8:11], s46 offen offset:1024 lds
  v_accvgpr_read_b32 v25, a177
  v_mfma_f32_16x16x32_bf16 v[88:91], a[88:91], a[0:3], v[88:91]
  v_accvgpr_read_b32 v26, a178
  v_accvgpr_read_b32 v27, a179
  v_mfma_f32_16x16x32_bf16 v[92:95], a[92:95], a[0:3], v[92:95]
  v_accvgpr_read_b32 v28, a180
  v_accvgpr_read_b32 v29, a181
  v_mfma_f32_16x16x32_bf16 v[224:227], a[64:67], a[20:23], v[224:227]
  v_accvgpr_read_b32 v30, a182
  v_accvgpr_read_b32 v31, a183
  v_mfma_f32_16x16x32_bf16 v[228:231], a[68:71], a[20:23], v[228:231]
  v_cvt_pk_bf16_f32 v180, v24, v25
  v_cvt_pk_bf16_f32 v181, v26, v27
  v_mfma_f32_16x16x32_bf16 v[96:99], a[64:67], a[4:7], v[96:99]
  v_cvt_pk_bf16_f32 v182, v28, v29
  v_cvt_pk_bf16_f32 v183, v30, v31
  v_mfma_f32_16x16x32_bf16 v[100:103], a[68:71], a[4:7], v[100:103]
  buffer_load_dwordx4 v54, s[8:11], s46 offen offset:2048 lds
  v_mfma_f32_16x16x32_bf16 v[232:235], a[72:75], a[20:23], v[232:235]
  s_add_u32 s60, s63, 45056
  buffer_store_dwordx4 v[172:175], v2, s[16:19], s60 offen offset:1024 sc1
  v_cvt_pk_bf16_f32 v184, v184, v185
  v_mfma_f32_16x16x32_bf16 v[236:239], a[76:79], a[20:23], v[236:239]
  v_cvt_pk_bf16_f32 v185, v186, v187
  v_cvt_pk_bf16_f32 v186, v188, v189
  v_mfma_f32_16x16x32_bf16 v[104:107], a[72:75], a[4:7], v[104:107]
  v_cvt_pk_bf16_f32 v187, v190, v191
  v_accvgpr_read_b32 v32, a184
  v_mfma_f32_16x16x32_bf16 v[108:111], a[76:79], a[4:7], v[108:111]
  v_accvgpr_read_b32 v33, a185
  v_accvgpr_read_b32 v34, a186
  v_mfma_f32_16x16x32_bf16 v[240:243], a[80:83], a[20:23], v[240:243]
  v_accvgpr_read_b32 v35, a187
  v_accvgpr_read_b32 v36, a188
  v_mfma_f32_16x16x32_bf16 v[244:247], a[84:87], a[20:23], v[244:247]
  buffer_load_dwordx4 v55, s[8:11], s46 offen offset:3072 lds
  v_accvgpr_read_b32 v37, a189
  v_mfma_f32_16x16x32_bf16 v[112:115], a[80:83], a[4:7], v[112:115]
  s_sub_u32 s50, s50, 1
  s_cmp_eq_u32 s50, 0
  s_cselect_b32 s12, s72, s12
  s_cselect_b32 s13, s73, s13
  v_mfma_f32_16x16x32_bf16 v[116:119], a[84:87], a[4:7], v[116:119]
  s_lshl_b32 s47, s48, 19
  s_bfe_u32 s34, 0x3020106, s49
  s_add_u32 s48, s48, s34
  v_mfma_f32_16x16x32_bf16 v[248:251], a[88:91], a[20:23], v[248:251]
  s_add_u32 s49, s49, 8
  s_and_b32 s49, s49, 0x8001f
  s_and_b32 s48, s48, 7
  v_mfma_f32_16x16x32_bf16 v[252:255], a[92:95], a[20:23], v[252:255]
  s_lshl_b32 s46, s48, 7
  v_accvgpr_read_b32 v38, a190
  v_accvgpr_read_b32 v39, a191
  v_mfma_f32_16x16x32_bf16 v[120:123], a[88:91], a[4:7], v[120:123]
  v_cvt_pk_bf16_f32 v188, v32, v33
  v_cvt_pk_bf16_f32 v189, v34, v35
  v_mfma_f32_16x16x32_bf16 v[124:127], a[92:95], a[4:7], v[124:127]
  v_cvt_pk_bf16_f32 v190, v36, v37
  v_cvt_pk_bf16_f32 v191, v38, v39
  v_mfma_f32_16x16x32_bf16 v[88:91], a[120:123], a[32:35], v[88:91]
  ds_read_b128 a[0:3], v16 offset:0
  ds_read_b64_tr_b16 a[64:65], v18 offset:0
  v_mfma_f32_16x16x32_bf16 v[92:95], a[124:127], a[32:35], v[92:95]
  ds_read_b64_tr_b16 a[66:67], v18 offset:2048
  ds_read_b128 a[4:7], v16 offset:2048
  v_mfma_f32_16x16x32_bf16 v[224:227], a[96:99], a[52:55], v[224:227]
  ds_read_b128 a[8:11], v16 offset:4096
  ds_read_b128 a[12:15], v16 offset:6144
  v_mfma_f32_16x16x32_bf16 v[228:231], a[100:103], a[52:55], v[228:231]
  ds_read_b128 a[16:19], v16 offset:8192
  ds_read_b128 a[20:23], v16 offset:10240
  v_mfma_f32_16x16x32_bf16 v[96:99], a[96:99], a[36:39], v[96:99]
  ds_read_b128 a[24:27], v16 offset:12288
  ds_read_b128 a[28:31], v16 offset:14336
  v_mfma_f32_16x16x32_bf16 v[100:103], a[100:103], a[36:39], v[100:103]
  ds_read_b64_tr_b16 a[68:69], v19 offset:0
  ds_read_b64_tr_b16 a[70:71], v19 offset:2048
  v_mfma_f32_16x16x32_bf16 v[232:235], a[104:107], a[52:55], v[232:235]
  ds_read_b64_tr_b16 a[72:73], v20 offset:0
  ds_read_b64_tr_b16 a[74:75], v20 offset:2048
  v_mfma_f32_16x16x32_bf16 v[236:239], a[108:111], a[52:55], v[236:239]
  ds_read_b64_tr_b16 a[76:77], v21 offset:0
  ds_read_b64_tr_b16 a[78:79], v21 offset:2048
  v_mfma_f32_16x16x32_bf16 v[104:107], a[104:107], a[36:39], v[104:107]
  ds_read_b64_tr_b16 a[80:81], v18 offset:8192
  ds_read_b64_tr_b16 a[82:83], v18 offset:10240
  v_mfma_f32_16x16x32_bf16 v[108:111], a[108:111], a[36:39], v[108:111]
  ds_read_b64_tr_b16 a[84:85], v19 offset:8192
  ds_read_b64_tr_b16 a[86:87], v19 offset:10240
  v_mfma_f32_16x16x32_bf16 v[240:243], a[112:115], a[52:55], v[240:243]
  ds_read_b64_tr_b16 a[88:89], v20 offset:8192
  ds_read_b64_tr_b16 a[90:91], v20 offset:10240
  v_mfma_f32_16x16x32_bf16 v[244:247], a[116:119], a[52:55], v[244:247]
  ds_read_b64_tr_b16 a[92:93], v21 offset:8192
  ds_read_b64_tr_b16 a[94:95], v21 offset:10240
  v_mfma_f32_16x16x32_bf16 v[112:115], a[112:115], a[36:39], v[112:115]
  v_cvt_pk_bf16_f32 v192, v192, v193
  v_cvt_pk_bf16_f32 v193, v194, v195
  v_mfma_f32_16x16x32_bf16 v[116:119], a[116:119], a[36:39], v[116:119]
  v_cvt_pk_bf16_f32 v194, v196, v197
  v_cvt_pk_bf16_f32 v195, v198, v199
  v_mfma_f32_16x16x32_bf16 v[248:251], a[120:123], a[52:55], v[248:251]
  v_cvt_pk_bf16_f32 v196, v64, v65
  v_cvt_pk_bf16_f32 v197, v66, v67
  v_mfma_f32_16x16x32_bf16 v[252:255], a[124:127], a[52:55], v[252:255]
  v_cvt_pk_bf16_f32 v198, v68, v69
  v_cvt_pk_bf16_f32 v199, v70, v71
  v_mfma_f32_16x16x32_bf16 v[120:123], a[120:123], a[36:39], v[120:123]
  v_cvt_pk_bf16_f32 v200, v200, v201
  v_cvt_pk_bf16_f32 v201, v202, v203
  v_mfma_f32_16x16x32_bf16 v[124:127], a[124:127], a[36:39], v[124:127]
  v_cvt_pk_bf16_f32 v202, v204, v205
  v_cvt_pk_bf16_f32 v203, v206, v207
  s_waitcnt lgkmcnt(0)
  v_mfma_f32_16x16x32_bf16 a[128:131], a[24:27], a[64:67], 0
  ds_read_b128 a[32:35], v17 offset:0
  ds_read_b64_tr_b16 a[96:97], v18 offset:4096
  v_mfma_f32_16x16x32_bf16 a[132:135], a[24:27], a[68:71], 0
  ds_read_b64_tr_b16 a[98:99], v18 offset:6144
  ds_read_b128 a[36:39], v17 offset:2048
  v_mfma_f32_16x16x32_bf16 a[136:139], a[24:27], a[72:75], 0
  ds_read_b128 a[40:43], v17 offset:4096
  ds_read_b128 a[44:47], v17 offset:6144
  v_mfma_f32_16x16x32_bf16 a[140:143], a[24:27], a[76:79], 0
  ds_read_b128 a[48:51], v17 offset:8192
  ds_read_b128 a[52:55], v17 offset:10240
  v_mfma_f32_16x16x32_bf16 a[144:147], a[24:27], a[80:83], 0
  ds_read_b128 a[56:59], v17 offset:12288
  ds_read_b128 a[60:63], v17 offset:14336
  v_mfma_f32_16x16x32_bf16 a[148:151], a[24:27], a[84:87], 0
  ds_read_b64_tr_b16 a[100:101], v19 offset:4096
  ds_read_b64_tr_b16 a[102:103], v19 offset:6144
  v_mfma_f32_16x16x32_bf16 a[152:155], a[24:27], a[88:91], 0
  ds_read_b64_tr_b16 a[104:105], v20 offset:4096
  v_cvt_pk_bf16_f32 v204, v72, v73
  v_mfma_f32_16x16x32_bf16 a[156:159], a[24:27], a[92:95], 0
  ds_read_b64_tr_b16 a[106:107], v20 offset:6144
  ds_read_b64_tr_b16 a[108:109], v21 offset:4096
  v_mfma_f32_16x16x32_bf16 a[160:163], a[28:31], a[64:67], 0
  ds_read_b64_tr_b16 a[110:111], v21 offset:6144
  ds_read_b64_tr_b16 a[112:113], v18 offset:12288
  v_mfma_f32_16x16x32_bf16 a[164:167], a[28:31], a[68:71], 0
  ds_read_b64_tr_b16 a[114:115], v18 offset:14336
  ds_read_b64_tr_b16 a[116:117], v19 offset:12288
  v_mfma_f32_16x16x32_bf16 a[168:171], a[28:31], a[72:75], 0
  ds_read_b64_tr_b16 a[118:119], v19 offset:14336
  ds_read_b64_tr_b16 a[120:121], v20 offset:12288
  v_mfma_f32_16x16x32_bf16 a[172:175], a[28:31], a[76:79], 0
  ds_read_b64_tr_b16 a[122:123], v20 offset:14336
  ds_read_b64_tr_b16 a[124:125], v21 offset:12288
  v_mfma_f32_16x16x32_bf16 a[176:179], a[28:31], a[80:83], 0
  ds_read_b64_tr_b16 a[126:127], v21 offset:14336
  v_cvt_pk_bf16_f32 v205, v74, v75
  v_mfma_f32_16x16x32_bf16 a[180:183], a[28:31], a[84:87], 0
  v_cvt_pk_bf16_f32 v206, v76, v77
  v_cvt_pk_bf16_f32 v207, v78, v79
  v_mfma_f32_16x16x32_bf16 a[184:187], a[28:31], a[88:91], 0
  v_cvt_pk_bf16_f32 v208, v208, v209
  v_cvt_pk_bf16_f32 v209, v210, v211
  v_mfma_f32_16x16x32_bf16 a[188:191], a[28:31], a[92:95], 0
  v_cvt_pk_bf16_f32 v210, v212, v213
  v_cvt_pk_bf16_f32 v211, v214, v215
  v_mfma_f32_16x16x32_bf16 v[128:131], a[8:11], a[64:67], 0
  v_cvt_pk_bf16_f32 v212, v80, v81
  v_cvt_pk_bf16_f32 v213, v82, v83
  v_mfma_f32_16x16x32_bf16 v[132:135], a[8:11], a[68:71], 0
  v_cvt_pk_bf16_f32 v214, v84, v85
  v_cvt_pk_bf16_f32 v215, v86, v87
  v_mfma_f32_16x16x32_bf16 v[136:139], a[8:11], a[72:75], 0
  v_cvt_pk_bf16_f32 v216, v216, v217
  v_cvt_pk_bf16_f32 v217, v218, v219
  v_mfma_f32_16x16x32_bf16 v[140:143], a[8:11], a[76:79], 0
  s_add_u32 s36, s36, s38
  s_add_u32 s37, s37, 1
  s_cmp_eq_u32 s37, 3
  s_cselect_b32 s37, 0, s37
  s_cselect_b32 s38, s39, s40
  v_add_u32 v16, s38, v16
  v_add_u32 v17, s38, v17
  s_add_u32 s41, s41, s43
  s_sub_u32 s43, 0, s43
  v_add_u32 v18, s43, v18
  v_add_u32 v19, s43, v19
  v_add_u32 v20, s43, v20
  v_add_u32 v21, s43, v21
  s_waitcnt vmcnt(8) lgkmcnt(0)
  s_barrier
  v_mfma_f32_16x16x32_bf16 a[128:131], a[56:59], a[96:99], a[128:131]
  s_mov_b32 m0, s41
  v_cvt_pk_bf16_f32 v218, v220, v221
  v_cvt_pk_bf16_f32 v219, v222, v223
  v_mfma_f32_16x16x32_bf16 a[132:135], a[56:59], a[100:103], a[132:135]
  v_cvt_pk_bf16_f32 v220, v88, v89
  v_cvt_pk_bf16_f32 v221, v90, v91
  v_mfma_f32_16x16x32_bf16 a[136:139], a[56:59], a[104:107], a[136:139]
  v_cvt_pk_bf16_f32 v222, v92, v93
  v_cvt_pk_bf16_f32 v223, v94, v95
  v_mfma_f32_16x16x32_bf16 a[140:143], a[56:59], a[108:111], a[140:143]
  v_cvt_pk_bf16_f32 v224, v224, v225
  v_cvt_pk_bf16_f32 v225, v226, v227
  v_mfma_f32_16x16x32_bf16 a[144:147], a[56:59], a[112:115], a[144:147]
  v_cvt_pk_bf16_f32 v226, v228, v229
  v_cvt_pk_bf16_f32 v227, v230, v231
  v_mfma_f32_16x16x32_bf16 a[148:151], a[56:59], a[116:119], a[148:151]
  v_cvt_pk_bf16_f32 v228, v96, v97
  v_cvt_pk_bf16_f32 v229, v98, v99
  v_mfma_f32_16x16x32_bf16 a[152:155], a[56:59], a[120:123], a[152:155]
  v_cvt_pk_bf16_f32 v230, v100, v101
  v_cvt_pk_bf16_f32 v231, v102, v103
  v_mfma_f32_16x16x32_bf16 a[156:159], a[56:59], a[124:127], a[156:159]
  v_cvt_pk_bf16_f32 v232, v232, v233
  v_cvt_pk_bf16_f32 v233, v234, v235
  v_mfma_f32_16x16x32_bf16 a[160:163], a[60:63], a[96:99], a[160:163]
  v_cvt_pk_bf16_f32 v234, v236, v237
  v_cvt_pk_bf16_f32 v235, v238, v239
  v_mfma_f32_16x16x32_bf16 a[164:167], a[60:63], a[100:103], a[164:167]
  v_cvt_pk_bf16_f32 v236, v104, v105
  v_cvt_pk_bf16_f32 v237, v106, v107
  v_mfma_f32_16x16x32_bf16 a[168:171], a[60:63], a[104:107], a[168:171]
  v_cvt_pk_bf16_f32 v238, v108, v109
  v_cvt_pk_bf16_f32 v239, v110, v111
  v_mfma_f32_16x16x32_bf16 a[172:175], a[60:63], a[108:111], a[172:175]
  v_cvt_pk_bf16_f32 v240, v240, v241
  v_cvt_pk_bf16_f32 v241, v242, v243
  v_mfma_f32_16x16x32_bf16 a[176:179], a[60:63], a[112:115], a[176:179]
  v_cvt_pk_bf16_f32 v242, v244, v245
  v_cvt_pk_bf16_f32 v243, v246, v247
  v_mfma_f32_16x16x32_bf16 a[180:183], a[60:63], a[116:119], a[180:183]
  v_cvt_pk_bf16_f32 v244, v112, v113
  v_cvt_pk_bf16_f32 v245, v114, v115
  v_mfma_f32_16x16x32_bf16 a[184:187], a[60:63], a[120:123], a[184:187]
  v_cvt_pk_bf16_f32 v246, v116, v117
  v_cvt_pk_bf16_f32 v247, v118, v119
  v_mfma_f32_16x16x32_bf16 a[188:191], a[60:63], a[124:127], a[188:191]
  v_cvt_pk_bf16_f32 v248, v248, v249
  v_cvt_pk_bf16_f32 v249, v250, v251
  v_mfma_f32_16x16x32_bf16 v[128:131], a[40:43], a[96:99], v[128:131]
  v_cvt_pk_bf16_f32 v250, v252, v253
  v_cvt_pk_bf16_f32 v251, v254, v255
  v_mfma_f32_16x16x32_bf16 v[132:135], a[40:43], a[100:103], v[132:135]
  v_cvt_pk_bf16_f32 v252, v120, v121
  v_cvt_pk_bf16_f32 v253, v122, v123
  v_mfma_f32_16x16x32_bf16 v[136:139], a[40:43], a[104:107], v[136:139]
  v_cvt_pk_bf16_f32 v254, v124, v125
  v_cvt_pk_bf16_f32 v255, v126, v127
  v_mfma_f32_16x16x32_bf16 v[140:143], a[40:43], a[108:111], v[140:143]
  s_add_u32 s60, s63, 12288
  buffer_store_dwordx4 v[176:179], v2, s[16:19], s60 offen offset:2048 sc1
  v_mfma_f32_16x16x32_bf16 v[144:147], a[8:11], a[80:83], 0
  s_add_u32 s60, s63, 45056
  buffer_store_dwordx4 v[180:183], v2, s[16:19], s60 offen offset:2048 sc1
  v_mfma_f32_16x16x32_bf16 v[148:151], a[8:11], a[84:87], 0
  s_add_u32 s60, s63, 12288
  buffer_store_dwordx4 v[184:187], v2, s[16:19], s60 offen offset:3072 sc1
  v_mfma_f32_16x16x32_bf16 v[144:147], a[40:43], a[112:115], v[144:147]
  s_add_u32 s60, s63, 45056
  buffer_store_dwordx4 v[188:191], v2, s[16:19], s60 offen offset:3072 sc1
  v_mfma_f32_16x16x32_bf16 v[148:151], a[40:43], a[116:119], v[148:151]
  s_add_u32 s60, s63, 32768
  buffer_store_dwordx4 v[192:195], v2, s[16:19], s60 offen offset:0 sc1
  v_mfma_f32_16x16x32_bf16 v[152:155], a[8:11], a[88:91], 0
  s_add_u32 s60, s63, 0
  buffer_store_dwordx4 v[196:199], v2, s[16:19], s60 offen offset:0 sc1
  v_mfma_f32_16x16x32_bf16 v[156:159], a[8:11], a[92:95], 0
  buffer_load_dwordx4 v56, s[12:15], s47 offen offset:0 lds
  v_mfma_f32_16x16x32_bf16 v[152:155], a[40:43], a[120:123], v[152:155]
  s_add_u32 s60, s63, 32768
  buffer_store_dwordx4 v[200:203], v2, s[16:19], s60 offen offset:1024 sc1
  v_mfma_f32_16x16x32_bf16 v[156:159], a[40:43], a[124:127], v[156:159]
  buffer_load_dwordx4 v57, s[12:15], s47 offen offset:1024 lds
  v_mfma_f32_16x16x32_bf16 v[160:163], a[12:15], a[64:67], 0
  buffer_load_dwordx4 v58, s[12:15], s47 offen offset:2048 lds
  v_mfma_f32_16x16x32_bf16 v[164:167], a[12:15], a[68:71], 0
  buffer_load_dwordx4 v59, s[12:15], s47 offen offset:3072 lds
  v_mfma_f32_16x16x32_bf16 v[160:163], a[44:47], a[96:99], v[160:163]
  s_add_u32 m0, s41, 4096
  v_mfma_f32_16x16x32_bf16 v[164:167], a[44:47], a[100:103], v[164:167]
  s_add_u32 s60, s63, 0
  buffer_store_dwordx4 v[204:207], v2, s[16:19], s60 offen offset:1024 sc1
  v_mfma_f32_16x16x32_bf16 v[168:171], a[12:15], a[72:75], 0
  buffer_load_dwordx4 v60, s[12:15], s47 offen offset:0 lds
  v_mfma_f32_16x16x32_bf16 v[172:175], a[12:15], a[76:79], 0
  buffer_load_dwordx4 v61, s[12:15], s47 offen offset:1024 lds
  v_mfma_f32_16x16x32_bf16 v[168:171], a[44:47], a[104:107], v[168:171]
  buffer_load_dwordx4 v62, s[12:15], s47 offen offset:2048 lds
  v_mfma_f32_16x16x32_bf16 v[172:175], a[44:47], a[108:111], v[172:175]
  s_add_u32 s60, s63, 32768
  buffer_store_dwordx4 v[208:211], v2, s[16:19], s60 offen offset:2048 sc1
  v_mfma_f32_16x16x32_bf16 v[64:67], a[0:3], a[64:67], 0
  v_mfma_f32_16x16x32_bf16 v[68:71], a[0:3], a[68:71], 0
  v_mfma_f32_16x16x32_bf16 v[64:67], a[32:35], a[96:99], v[64:67]
  buffer_load_dwordx4 v63, s[12:15], s47 offen offset:3072 lds
  v_mfma_f32_16x16x32_bf16 v[68:71], a[32:35], a[100:103], v[68:71]
  s_add_u32 s60, s63, 0
  buffer_store_dwordx4 v[212:215], v2, s[16:19], s60 offen offset:2048 sc1
  s_mov_b32 m0, s36
  s_nop 0
  buffer_load_dwordx4 v48, s[8:11], s46 offen offset:0 lds
  buffer_load_dwordx4 v49, s[8:11], s46 offen offset:1024 lds
  buffer_load_dwordx4 v50, s[8:11], s46 offen offset:2048 lds
  buffer_load_dwordx4 v51, s[8:11], s46 offen offset:3072 lds
  v_mfma_f32_16x16x32_bf16 v[72:75], a[0:3], a[72:75], 0
  s_add_u32 m0, s36, 4096
  v_mfma_f32_16x16x32_bf16 v[76:79], a[0:3], a[76:79], 0
  v_mfma_f32_16x16x32_bf16 v[72:75], a[32:35], a[104:107], v[72:75]
  v_mfma_f32_16x16x32_bf16 v[76:79], a[32:35], a[108:111], v[76:79]
  v_mfma_f32_16x16x32_bf16 v[80:83], a[0:3], a[80:83], 0
  s_add_u32 s60, s63, 32768
  buffer_store_dwordx4 v[216:219], v2, s[16:19], s60 offen offset:3072 sc1
  v_mfma_f32_16x16x32_bf16 v[84:87], a[0:3], a[84:87], 0
  v_mfma_f32_16x16x32_bf16 v[80:83], a[32:35], a[112:115], v[80:83]
  v_mfma_f32_16x16x32_bf16 v[84:87], a[32:35], a[116:119], v[84:87]
  v_mfma_f32_16x16x32_bf16 v[88:91], a[0:3], a[88:91], 0
  s_add_u32 s60, s63, 0
  buffer_store_dwordx4 v[220:223], v2, s[16:19], s60 offen offset:3072 sc1
  v_mfma_f32_16x16x32_bf16 v[92:95], a[0:3], a[92:95], 0
  v_mfma_f32_16x16x32_bf16 v[88:91], a[32:35], a[120:123], v[88:91]
  v_mfma_f32_16x16x32_bf16 v[92:95], a[32:35], a[124:127], v[92:95]
  v_mfma_f32_16x16x32_bf16 v[96:99], a[4:7], a[64:67], 0
  s_add_u32 s60, s63, 36864
  buffer_store_dwordx4 v[224:227], v2, s[16:19], s60 offen offset:0 sc1
  v_mfma_f32_16x16x32_bf16 v[100:103], a[4:7], a[68:71], 0
  v_mfma_f32_16x16x32_bf16 v[96:99], a[36:39], a[96:99], v[96:99]
  v_mfma_f32_16x16x32_bf16 v[100:103], a[36:39], a[100:103], v[100:103]
  v_mfma_f32_16x16x32_bf16 v[104:107], a[4:7], a[72:75], 0
  s_add_u32 s60, s63, 4096
  buffer_store_dwordx4 v[228:231], v2, s[16:19], s60 offen offset:0 sc1
  v_mfma_f32_16x16x32_bf16 v[108:111], a[4:7], a[76:79], 0
  v_mfma_f32_16x16x32_bf16 v[104:107], a[36:39], a[104:107], v[104:107]
  v_mfma_f32_16x16x32_bf16 v[108:111], a[36:39], a[108:111], v[108:111]
  v_mfma_f32_16x16x32_bf16 v[112:115], a[4:7], a[80:83], 0
  v_mfma_f32_16x16x32_bf16 v[116:119], a[4:7], a[84:87], 0
  s_add_u32 s60, s63, 36864
  buffer_store_dwordx4 v[232:235], v2, s[16:19], s60 offen offset:1024 sc1
  v_mfma_f32_16x16x32_bf16 v[112:115], a[36:39], a[112:115], v[112:115]
  v_mfma_f32_16x16x32_bf16 v[116:119], a[36:39], a[116:119], v[116:119]
  v_mfma_f32_16x16x32_bf16 v[120:123], a[4:7], a[88:91], 0
  v_mfma_f32_16x16x32_bf16 v[124:127], a[4:7], a[92:95], 0
  s_add_u32 s60, s63, 4096
  buffer_store_dwordx4 v[236:239], v2, s[16:19], s60 offen offset:1024 sc1
  v_mfma_f32_16x16x32_bf16 v[120:123], a[36:39], a[120:123], v[120:123]
  buffer_load_dwordx4 v52, s[8:11], s46 offen offset:0 lds
  v_mfma_f32_16x16x32_bf16 v[124:127], a[36:39], a[124:127], v[124:127]
  v_mfma_f32_16x16x32_bf16 v[176:179], a[12:15], a[80:83], 0
  v_mfma_f32_16x16x32_bf16 v[180:183], a[12:15], a[84:87], 0
  s_add_u32 s60, s63, 36864
  buffer_store_dwordx4 v[240:243], v2, s[16:19], s60 offen offset:2048 sc1
  v_mfma_f32_16x16x32_bf16 v[176:179], a[44:47], a[112:115], v[176:179]
  v_mfma_f32_16x16x32_bf16 v[180:183], a[44:47], a[116:119], v[180:183]
  v_mfma_f32_16x16x32_bf16 v[184:187], a[12:15], a[88:91], 0
  buffer_load_dwordx4 v53, s[8:11], s46 offen offset:1024 lds
  v_mfma_f32_16x16x32_bf16 v[188:191], a[12:15], a[92:95], 0
  v_mfma_f32_16x16x32_bf16 v[192:195], a[16:19], a[64:67], 0
  s_add_u32 s60, s63, 4096
  buffer_store_dwordx4 v[244:247], v2, s[16:19], s60 offen offset:2048 sc1
  v_mfma_f32_16x16x32_bf16 v[196:199], a[16:19], a[68:71], 0
  v_mfma_f32_16x16x32_bf16 v[200:203], a[16:19], a[72:75], 0
  v_mfma_f32_16x16x32_bf16 v[204:207], a[16:19], a[76:79], 0
  buffer_load_dwordx4 v54, s[8:11], s46 offen offset:2048 lds
  v_mfma_f32_16x16x32_bf16 v[208:211], a[16:19], a[80:83], 0
  s_add_u32 s60, s63, 36864
  buffer_store_dwordx4 v[248:251], v2, s[16:19], s60 offen offset:3072 sc1
  v_mfma_f32_16x16x32_bf16 v[212:215], a[16:19], a[84:87], 0
  v_mfma_f32_16x16x32_bf16 v[216:219], a[16:19], a[88:91], 0
  v_mfma_f32_16x16x32_bf16 v[220:223], a[16:19], a[92:95], 0
  v_mfma_f32_16x16x32_bf16 v[224:227], a[20:23], a[64:67], 0
  s_add_u32 s60, s63, 4096
  buffer_store_dwordx4 v[252:255], v2, s[16:19], s60 offen offset:3072 sc1
  v_mfma_f32_16x16x32_bf16 v[228:231], a[20:23], a[68:71], 0
  buffer_load_dwordx4 v55, s[8:11], s46 offen offset:3072 lds
  v_mfma_f32_16x16x32_bf16 v[232:235], a[20:23], a[72:75], 0
  s_sub_u32 s50, s50, 1
  s_cmp_eq_u32 s50, 0
  s_cselect_b32 s12, s72, s12
  s_cselect_b32 s13, s73, s13
  v_mfma_f32_16x16x32_bf16 v[236:239], a[20:23], a[76:79], 0
  s_lshl_b32 s47, s48, 19
  s_bfe_u32 s34, 0x3020106, s49
  s_add_u32 s48, s48, s34
  v_mfma_f32_16x16x32_bf16 v[240:243], a[20:23], a[80:83], 0
  s_add_u32 s49, s49, 8
  s_and_b32 s49, s49, 0x8001f
  s_and_b32 s48, s48, 7
  v_mfma_f32_16x16x32_bf16 v[244:247], a[20:23], a[84:87], 0
  s_lshl_b32 s46, s48, 7
  v_mfma_f32_16x16x32_bf16 v[248:251], a[20:23], a[88:91], 0
  v_mfma_f32_16x16x32_bf16 v[252:255], a[20:23], a[92:95], 0
  v_mfma_f32_16x16x32_bf16 v[184:187], a[44:47], a[120:123], v[184:187]
  ds_read_b128 a[0:3], v16 offset:0
  ds_read_b64_tr_b16 a[64:65], v18 offset:0
  v_mfma_f32_16x16x32_bf16 v[188:191], a[44:47], a[124:127], v[188:191]
  ds_read_b64_tr_b16 a[66:67], v18 offset:2048
  ds_read_b128 a[4:7], v16 offset:2048
  v_mfma_f32_16x16x32_bf16 v[192:195], a[48:51], a[96:99], v[192:195]
  ds_read_b128 a[8:11], v16 offset:4096
  ds_read_b128 a[12:15], v16 offset:6144
  v_mfma_f32_16x16x32_bf16 v[196:199], a[48:51], a[100:103], v[196:199]
  ds_read_b128 a[16:19], v16 offset:8192
  ds_read_b128 a[20:23], v16 offset:10240
  v_mfma_f32_16x16x32_bf16 v[200:203], a[48:51], a[104:107], v[200:203]
  ds_read_b128 a[24:27], v16 offset:12288
  ds_read_b128 a[28:31], v16 offset:14336
  v_mfma_f32_16x16x32_bf16 v[204:207], a[48:51], a[108:111], v[204:207]
  ds_read_b64_tr_b16 a[68:69], v19 offset:0
  ds_read_b64_tr_b16 a[70:71], v19 offset:2048
  v_mfma_f32_16x16x32_bf16 v[208:211], a[48:51], a[112:115], v[208:211]
  ds_read_b64_tr_b16 a[72:73], v20 offset:0
  ds_read_b64_tr_b16 a[74:75], v20 offset:2048
  v_mfma_f32_16x16x32_bf16 v[212:215], a[48:51], a[116:119], v[212:215]
  ds_read_b64_tr_b16 a[76:77], v21 offset:0
  ds_read_b64_tr_b16 a[78:79], v21 offset:2048
  v_mfma_f32_16x16x32_bf16 v[216:219], a[48:51], a[120:123], v[216:219]
  ds_read_b64_tr_b16 a[80:81], v18 offset:8192
  ds_read_b64_tr_b16 a[82:83], v18 offset:10240
  v_mfma_f32_16x16x32_bf16 v[220:223], a[48:51], a[124:127], v[220:223]
  ds_read_b64_tr_b16 a[84:85], v19 offset:8192
  ds_read_b64_tr_b16 a[86:87], v19 offset:10240
  v_mfma_f32_16x16x32_bf16 v[224:227], a[52:55], a[96:99], v[224:227]
  ds_read_b64_tr_b16 a[88:89], v20 offset:8192
  ds_read_b64_tr_b16 a[90:91], v20 offset:10240
  v_mfma_f32_16x16x32_bf16 v[228:231], a[52:55], a[100:103], v[228:231]
  ds_read_b64_tr_b16 a[92:93], v21 offset:8192
  ds_read_b64_tr_b16 a[94:95], v21 offset:10240
  v_mfma_f32_16x16x32_bf16 v[232:235], a[52:55], a[104:107], v[232:235]
  v_mfma_f32_16x16x32_bf16 v[236:239], a[52:55], a[108:111], v[236:239]
  v_mfma_f32_16x16x32_bf16 v[240:243], a[52:55], a[112:115], v[240:243]
  v_mfma_f32_16x16x32_bf16 v[244:247], a[52:55], a[116:119], v[244:247]
  v_mfma_f32_16x16x32_bf16 v[248:251], a[52:55], a[120:123], v[248:251]
  v_mfma_f32_16x16x32_bf16 v[252:255], a[52:55], a[124:127], v[252:255]
  s_add_u32 s63, s63, 0x4000
  s_waitcnt lgkmcnt(0)
  v_mfma_f32_16x16x32_bf16 v[64:67], a[0:3], a[64:67], v[64:67]
  s_add_u32 s36, s36, s38
  s_add_u32 s37, s37, 1
  ds_read_b128 a[32:35], v17 offset:0
  v_mfma_f32_16x16x32_bf16 v[96:99], a[4:7], a[64:67], v[96:99]
  s_cmp_eq_u32 s37, 3
  s_cselect_b32 s37, 0, s37
  s_cselect_b32 s38, s39, s40
  v_mfma_f32_16x16x32_bf16 v[128:131], a[8:11], a[64:67], v[128:131]
  s_add_u32 s41, s41, s43
  s_sub_u32 s43, 0, s43
  ds_read_b64_tr_b16 a[96:97], v18 offset:4096
  v_mfma_f32_16x16x32_bf16 v[160:163], a[12:15], a[64:67], v[160:163]
  v_mfma_f32_16x16x32_bf16 v[192:195], a[16:19], a[64:67], v[192:195]
  ds_read_b64_tr_b16 a[98:99], v18 offset:6144
  v_mfma_f32_16x16x32_bf16 v[224:227], a[20:23], a[64:67], v[224:227]
  v_mfma_f32_16x16x32_bf16 a[128:131], a[24:27], a[64:67], a[128:131]
  ds_read_b128 a[36:39], v17 offset:2048
  v_mfma_f32_16x16x32_bf16 a[160:163], a[28:31], a[64:67], a[160:163]
  v_mfma_f32_16x16x32_bf16 v[68:71], a[0:3], a[68:71], v[68:71]
  v_mfma_f32_16x16x32_bf16 v[100:103], a[4:7], a[68:71], v[100:103]
  ds_read_b128 a[40:43], v17 offset:4096
  v_mfma_f32_16x16x32_bf16 v[132:135], a[8:11], a[68:71], v[132:135]
  v_mfma_f32_16x16x32_bf16 v[164:167], a[12:15], a[68:71], v[164:167]
  ds_read_b128 a[44:47], v17 offset:6144
  v_mfma_f32_16x16x32_bf16 v[196:199], a[16:19], a[68:71], v[196:199]
  v_mfma_f32_16x16x32_bf16 v[228:231], a[20:23], a[68:71], v[228:231]
  ds_read_b128 a[48:51], v17 offset:8192
  v_mfma_f32_16x16x32_bf16 a[132:135], a[24:27], a[68:71], a[132:135]
  v_mfma_f32_16x16x32_bf16 a[164:167], a[28:31], a[68:71], a[164:167]
  ds_read_b128 a[52:55], v17 offset:10240
  v_mfma_f32_16x16x32_bf16 v[72:75], a[0:3], a[72:75], v[72:75]
  v_mfma_f32_16x16x32_bf16 v[104:107], a[4:7], a[72:75], v[104:107]
  v_mfma_f32_16x16x32_bf16 v[136:139], a[8:11], a[72:75], v[136:139]
  ds_read_b128 a[56:59], v17 offset:12288
  v_mfma_f32_16x16x32_bf16 v[168:171], a[12:15], a[72:75], v[168:171]
  v_mfma_f32_16x16x32_bf16 v[200:203], a[16:19], a[72:75], v[200:203]
  ds_read_b128 a[60:63], v17 offset:14336
  v_mfma_f32_16x16x32_bf16 v[232:235], a[20:23], a[72:75], v[232:235]
  v_mfma_f32_16x16x32_bf16 a[136:139], a[24:27], a[72:75], a[136:139]
  ds_read_b64_tr_b16 a[100:101], v19 offset:4096
  v_mfma_f32_16x16x32_bf16 a[168:171], a[28:31], a[72:75], a[168:171]
  v_mfma_f32_16x16x32_bf16 v[76:79], a[0:3], a[76:79], v[76:79]
  ds_read_b64_tr_b16 a[102:103], v19 offset:6144
  v_mfma_f32_16x16x32_bf16 v[108:111], a[4:7], a[76:79], v[108:111]
  v_mfma_f32_16x16x32_bf16 v[140:143], a[8:11], a[76:79], v[140:143]
  v_mfma_f32_16x16x32_bf16 v[172:175], a[12:15], a[76:79], v[172:175]
  ds_read_b64_tr_b16 a[104:105], v20 offset:4096
  v_mfma_f32_16x16x32_bf16 v[204:207], a[16:19], a[76:79], v[204:207]
  v_mfma_f32_16x16x32_bf16 v[236:239], a[20:23], a[76:79], v[236:239]
  ds_read_b64_tr_b16 a[106:107], v20 offset:6144
  v_mfma_f32_16x16x32_bf16 a[140:143], a[24:27], a[76:79], a[140:143]
  v_mfma_f32_16x16x32_bf16 a[172:175], a[28:31], a[76:79], a[172:175]
  ds_read_b64_tr_b16 a[108:109], v21 offset:4096
  v_mfma_f32_16x16x32_bf16 v[80:83], a[0:3], a[80:83], v[80:83]
  v_mfma_f32_16x16x32_bf16 v[112:115], a[4:7], a[80:83], v[112:115]
  ds_read_b64_tr_b16 a[110:111], v21 offset:6144
  v_mfma_f32_16x16x32_bf16 v[144:147], a[8:11], a[80:83], v[144:147]
  v_mfma_f32_16x16x32_bf16 v[176:179], a[12:15], a[80:83], v[176:179]
  v_mfma_f32_16x16x32_bf16 v[208:211], a[16:19], a[80:83], v[208:211]
  ds_read_b64_tr_b16 a[112:113], v18 offset:12288
  v_mfma_f32_16x16x32_bf16 v[240:243], a[20:23], a[80:83], v[240:243]
  v_mfma_f32_16x16x32_bf16 a[144:147], a[24:27], a[80:83], a[144:147]
  ds_read_b64_tr_b16 a[114:115], v18 offset:14336
  v_mfma_f32_16x16x32_bf16 a[176:179], a[28:31], a[80:83], a[176:179]
  v_mfma_f32_16x16x32_bf16 v[84:87], a[0:3], a[84:87], v[84:87]
  ds_read_b64_tr_b16 a[116:117], v19 offset:12288
  v_mfma_f32_16x16x32_bf16 v[116:119], a[4:7], a[84:87], v[116:119]
  v_mfma_f32_16x16x32_bf16 v[148:151], a[8:11], a[84:87], v[148:151]
  ds_read_b64_tr_b16 a[118:119], v19 offset:14336
  v_mfma_f32_16x16x32_bf16 v[180:183], a[12:15], a[84:87], v[180:183]
  v_mfma_f32_16x16x32_bf16 v[212:215], a[16:19], a[84:87], v[212:215]
  v_mfma_f32_16x16x32_bf16 v[244:247], a[20:23], a[84:87], v[244:247]
  ds_read_b64_tr_b16 a[120:121], v20 offset:12288
  v_mfma_f32_16x16x32_bf16 a[148:151], a[24:27], a[84:87], a[148:151]
  v_mfma_f32_16x16x32_bf16 a[180:183], a[28:31], a[84:87], a[180:183]
  ds_read_b64_tr_b16 a[122:123], v20 offset:14336
  v_mfma_f32_16x16x32_bf16 v[88:91], a[0:3], a[88:91], v[88:91]
  v_mfma_f32_16x16x32_bf16 v[120:123], a[4:7], a[88:91], v[120:123]
  ds_read_b64_tr_b16 a[124:125], v21 offset:12288
  v_mfma_f32_16x16x32_bf16 v[152:155], a[8:11], a[88:91], v[152:155]
  v_mfma_f32_16x16x32_bf16 v[184:187], a[12:15], a[88:91], v[184:187]
  ds_read_b64_tr_b16 a[126:127], v21 offset:14336
  v_mfma_f32_16x16x32_bf16 v[216:219], a[16:19], a[88:91], v[216:219]
  v_add_u32 v16, s38, v16
  v_add_u32 v17, s38, v17
  v_mfma_f32_16x16x32_bf16 v[248:251], a[20:23], a[88:91], v[248:251]
  v_add_u32 v18, s43, v18
  v_add_u32 v19, s43, v19
  v_mfma_f32_16x16x32_bf16 a[152:155], a[24:27], a[88:91], a[152:155]
  v_add_u32 v20, s43, v20
  v_add_u32 v21, s43, v21
  v_mfma_f32_16x16x32_bf16 a[184:187], a[28:31], a[88:91], a[184:187]
  v_mfma_f32_16x16x32_bf16 v[92:95], a[0:3], a[92:95], v[92:95]
  v_mfma_f32_16x16x32_bf16 v[124:127], a[4:7], a[92:95], v[124:127]
  v_mfma_f32_16x16x32_bf16 v[156:159], a[8:11], a[92:95], v[156:159]
  v_mfma_f32_16x16x32_bf16 v[188:191], a[12:15], a[92:95], v[188:191]
  v_mfma_f32_16x16x32_bf16 v[220:223], a[16:19], a[92:95], v[220:223]
  v_mfma_f32_16x16x32_bf16 v[252:255], a[20:23], a[92:95], v[252:255]
  v_mfma_f32_16x16x32_bf16 a[156:159], a[24:27], a[92:95], a[156:159]
  v_mfma_f32_16x16x32_bf16 a[188:191], a[28:31], a[92:95], a[188:191]
  s_mov_b32 s35, 4
  s_waitcnt vmcnt(8) lgkmcnt(0)
  s_barrier
  .p2align 6
Lp1xw_loop:
  v_mfma_f32_16x16x32_bf16 v[64:67], a[32:35], a[96:99], v[64:67]
  s_mov_b32 m0, s41
  ds_read_b128 a[0:3], v16 offset:0
  v_mfma_f32_16x16x32_bf16 v[96:99], a[36:39], a[96:99], v[96:99]
  buffer_load_dwordx4 v56, s[12:15], s47 offen offset:0 lds
  v_mfma_f32_16x16x32_bf16 v[128:131], a[40:43], a[96:99], v[128:131]
  ds_read_b64_tr_b16 a[64:65], v18 offset:0
  v_mfma_f32_16x16x32_bf16 v[160:163], a[44:47], a[96:99], v[160:163]
  v_mfma_f32_16x16x32_bf16 v[192:195], a[48:51], a[96:99], v[192:195]
  ds_read_b64_tr_b16 a[66:67], v18 offset:2048
  v_mfma_f32_16x16x32_bf16 v[224:227], a[52:55], a[96:99], v[224:227]
  v_mfma_f32_16x16x32_bf16 a[128:131], a[56:59], a[96:99], a[128:131]
  ds_read_b128 a[4:7], v16 offset:2048
  v_mfma_f32_16x16x32_bf16 a[160:163], a[60:63], a[96:99], a[160:163]
  buffer_load_dwordx4 v57, s[12:15], s47 offen offset:1024 lds
  v_mfma_f32_16x16x32_bf16 v[68:71], a[32:35], a[100:103], v[68:71]
  v_mfma_f32_16x16x32_bf16 v[100:103], a[36:39], a[100:103], v[100:103]
  ds_read_b128 a[8:11], v16 offset:4096
  v_mfma_f32_16x16x32_bf16 v[132:135], a[40:43], a[100:103], v[132:135]
  v_mfma_f32_16x16x32_bf16 v[164:167], a[44:47], a[100:103], v[164:167]
  ds_read_b128 a[12:15], v16 offset:6144
  v_mfma_f32_16x16x32_bf16 v[196:199], a[48:51], a[100:103], v[196:199]
  v_mfma_f32_16x16x32_bf16 v[228:231], a[52:55], a[100:103], v[228:231]
  ds_read_b128 a[16:19], v16 offset:8192
  v_mfma_f32_16x16x32_bf16 a[132:135], a[56:59], a[100:103], a[132:135]
  v_mfma_f32_16x16x32_bf16 a[164:167], a[60:63], a[100:103], a[164:167]
  buffer_load_dwordx4 v58, s[12:15], s47 offen offset:2048 lds
  ds_read_b128 a[20:23], v16 offset:10240
  v_mfma_f32_16x16x32_bf16 v[72:75], a[32:35], a[104:107], v[72:75]
  v_mfma_f32_16x16x32_bf16 v[104:107], a[36:39], a[104:107], v[104:107]
  v_mfma_f32_16x16x32_bf16 v[136:139], a[40:43], a[104:107], v[136:139]
  ds_read_b128 a[24:27], v16 offset:12288
  v_mfma_f32_16x16x32_bf16 v[168:171], a[44:47], a[104:107], v[168:171]
  v_mfma_f32_16x16x32_bf16 v[200:203], a[48:51], a[104:107], v[200:203]
  ds_read_b128 a[28:31], v16 offset:14336
  v_mfma_f32_16x16x32_bf16 v[232:235], a[52:55], a[104:107], v[232:235]
  v_mfma_f32_16x16x32_bf16 a[136:139], a[56:59], a[104:107], a[136:139]
  ds_read_b64_tr_b16 a[68:69], v19 offset:0
  v_mfma_f32_16x16x32_bf16 a[168:171], a[60:63], a[104:107], a[168:171]
  buffer_load_dwordx4 v59, s[12:15], s47 offen offset:3072 lds
  v_mfma_f32_16x16x32_bf16 v[76:79], a[32:35], a[108:111], v[76:79]
  s_add_u32 m0, s41, 4096
  ds_read_b64_tr_b16 a[70:71], v19 offset:2048
  v_mfma_f32_16x16x32_bf16 v[108:111], a[36:39], a[108:111], v[108:111]
  v_mfma_f32_16x16x32_bf16 v[140:143], a[40:43], a[108:111], v[140:143]
  v_mfma_f32_16x16x32_bf16 v[172:175], a[44:47], a[108:111], v[172:175]
  ds_read_b64_tr_b16 a[72:73], v20 offset:0
  v_mfma_f32_16x16x32_bf16 v[204:207], a[48:51], a[108:111], v[204:207]
  v_mfma_f32_16x16x32_bf16 v[236:239], a[52:55], a[108:111], v[236:239]
  ds_read_b64_tr_b16 a[74:75], v20 offset:2048
  v_mfma_f32_16x16x32_bf16 a[140:143], a[56:59], a[108:111], a[140:143]
  v_mfma_f32_16x16x32_bf16 a[172:175], a[60:63], a[108:111], a[172:175]
  buffer_load_dwordx4 v60, s[12:15], s47 offen offset:0 lds
  ds_read_b64_tr_b16 a[76:77], v21 offset:0
  v_mfma_f32_16x16x32_bf16 v[80:83], a[32:35], a[112:115], v[80:83]
  v_mfma_f32_16x16x32_bf16 v[112:115], a[36:39], a[112:115], v[112:115]
  ds_read_b64_tr_b16 a[78:79], v21 offset:2048
  v_mfma_f32_16x16x32_bf16 v[144:147], a[40:43], a[112:115], v[144:147]
  v_mfma_f32_16x16x32_bf16 v[176:179], a[44:47], a[112:115], v[176:179]
  v_mfma_f32_16x16x32_bf16 v[208:211], a[48:51], a[112:115], v[208:211]
  ds_read_b64_tr_b16 a[80:81], v18 offset:8192
  v_mfma_f32_16x16x32_bf16 v[240:243], a[52:55], a[112:115], v[240:243]
  v_mfma_f32_16x16x32_bf16 a[144:147], a[56:59], a[112:115], a[144:147]
  ds_read_b64_tr_b16 a[82:83], v18 offset:10240
  v_mfma_f32_16x16x32_bf16 a[176:179], a[60:63], a[112:115], a[176:179]
  buffer_load_dwordx4 v61, s[12:15], s47 offen offset:1024 lds
  v_mfma_f32_16x16x32_bf16 v[84:87], a[32:35], a[116:119], v[84:87]
  ds_read_b64_tr_b16 a[84:85], v19 offset:8192
  v_mfma_f32_16x16x32_bf16 v[116:119], a[36:39], a[116:119], v[116:119]
  v_mfma_f32_16x16x32_bf16 v[148:151], a[40:43], a[116:119], v[148:151]
  ds_read_b64_tr_b16 a[86:87], v19 offset:10240
  v_mfma_f32_16x16x32_bf16 v[180:183], a[44:47], a[116:119], v[180:183]
  v_mfma_f32_16x16x32_bf16 v[212:215], a[48:51], a[116:119], v[212:215]
  v_mfma_f32_16x16x32_bf16 v[244:247], a[52:55], a[116:119], v[244:247]
  ds_read_b64_tr_b16 a[88:89], v20 offset:8192
  v_mfma_f32_16x16x32_bf16 a[148:151], a[56:59], a[116:119], a[148:151]
  v_mfma_f32_16x16x32_bf16 a[180:183], a[60:63], a[116:119], a[180:183]
  buffer_load_dwordx4 v62, s[12:15], s47 offen offset:2048 lds
  ds_read_b64_tr_b16 a[90:91], v20 offset:10240
  v_mfma_f32_16x16x32_bf16 v[88:91], a[32:35], a[120:123], v[88:91]
  v_mfma_f32_16x16x32_bf16 v[120:123], a[36:39], a[120:123], v[120:123]
  ds_read_b64_tr_b16 a[92:93], v21 offset:8192
  v_mfma_f32_16x16x32_bf16 v[152:155], a[40:43], a[120:123], v[152:155]
  v_mfma_f32_16x16x32_bf16 v[184:187], a[44:47], a[120:123], v[184:187]
  ds_read_b64_tr_b16 a[94:95], v21 offset:10240
  v_mfma_f32_16x16x32_bf16 v[216:219], a[48:51], a[120:123], v[216:219]
  v_mfma_f32_16x16x32_bf16 v[248:251], a[52:55], a[120:123], v[248:251]
  v_mfma_f32_16x16x32_bf16 a[152:155], a[56:59], a[120:123], a[152:155]
  v_mfma_f32_16x16x32_bf16 a[184:187], a[60:63], a[120:123], a[184:187]
  buffer_load_dwordx4 v63, s[12:15], s47 offen offset:3072 lds
  v_mfma_f32_16x16x32_bf16 v[92:95], a[32:35], a[124:127], v[92:95]
  v_mfma_f32_16x16x32_bf16 v[124:127], a[36:39], a[124:127], v[124:127]
  v_mfma_f32_16x16x32_bf16 v[156:159], a[40:43], a[124:127], v[156:159]
  v_mfma_f32_16x16x32_bf16 v[188:191], a[44:47], a[124:127], v[188:191]
  v_mfma_f32_16x16x32_bf16 v[220:223], a[48:51], a[124:127], v[220:223]
  v_mfma_f32_16x16x32_bf16 v[252:255], a[52:55], a[124:127], v[252:255]
  v_mfma_f32_16x16x32_bf16 a[156:159], a[56:59], a[124:127], a[156:159]
  v_mfma_f32_16x16x32_bf16 a[188:191], a[60:63], a[124:127], a[188:191]
  s_waitcnt lgkmcnt(0)
  v_mfma_f32_16x16x32_bf16 v[64:67], a[0:3], a[64:67], v[64:67]
  s_mov_b32 m0, s36
  ds_read_b128 a[32:35], v17 offset:0
  v_mfma_f32_16x16x32_bf16 v[96:99], a[4:7], a[64:67], v[96:99]
  buffer_load_dwordx4 v48, s[8:11], s46 offen offset:0 lds
  v_mfma_f32_16x16x32_bf16 v[128:131], a[8:11], a[64:67], v[128:131]
  ds_read_b64_tr_b16 a[96:97], v18 offset:4096
  v_mfma_f32_16x16x32_bf16 v[160:163], a[12:15], a[64:67], v[160:163]
  v_mfma_f32_16x16x32_bf16 v[192:195], a[16:19], a[64:67], v[192:195]
  ds_read_b64_tr_b16 a[98:99], v18 offset:6144
  v_mfma_f32_16x16x32_bf16 v[224:227], a[20:23], a[64:67], v[224:227]
  v_mfma_f32_16x16x32_bf16 a[128:131], a[24:27], a[64:67], a[128:131]
  ds_read_b128 a[36:39], v17 offset:2048
  v_mfma_f32_16x16x32_bf16 a[160:163], a[28:31], a[64:67], a[160:163]
  buffer_load_dwordx4 v49, s[8:11], s46 offen offset:1024 lds
  v_mfma_f32_16x16x32_bf16 v[68:71], a[0:3], a[68:71], v[68:71]
  v_mfma_f32_16x16x32_bf16 v[100:103], a[4:7], a[68:71], v[100:103]
  ds_read_b128 a[40:43], v17 offset:4096
  v_mfma_f32_16x16x32_bf16 v[132:135], a[8:11], a[68:71], v[132:135]
  v_mfma_f32_16x16x32_bf16 v[164:167], a[12:15], a[68:71], v[164:167]
  ds_read_b128 a[44:47], v17 offset:6144
  v_mfma_f32_16x16x32_bf16 v[196:199], a[16:19], a[68:71], v[196:199]
  v_mfma_f32_16x16x32_bf16 v[228:231], a[20:23], a[68:71], v[228:231]
  ds_read_b128 a[48:51], v17 offset:8192
  v_mfma_f32_16x16x32_bf16 a[132:135], a[24:27], a[68:71], a[132:135]
  buffer_load_dwordx4 v50, s[8:11], s46 offen offset:2048 lds
  v_mfma_f32_16x16x32_bf16 a[164:167], a[28:31], a[68:71], a[164:167]
  ds_read_b128 a[52:55], v17 offset:10240
  v_mfma_f32_16x16x32_bf16 v[72:75], a[0:3], a[72:75], v[72:75]
  v_mfma_f32_16x16x32_bf16 v[104:107], a[4:7], a[72:75], v[104:107]
  v_mfma_f32_16x16x32_bf16 v[136:139], a[8:11], a[72:75], v[136:139]
  ds_read_b128 a[56:59], v17 offset:12288
  v_mfma_f32_16x16x32_bf16 v[168:171], a[12:15], a[72:75], v[168:171]
  v_mfma_f32_16x16x32_bf16 v[200:203], a[16:19], a[72:75], v[200:203]
  ds_read_b128 a[60:63], v17 offset:14336
  v_mfma_f32_16x16x32_bf16 v[232:235], a[20:23], a[72:75], v[232:235]
  buffer_load_dwordx4 v51, s[8:11], s46 offen offset:3072 lds
  v_mfma_f32_16x16x32_bf16 a[136:139], a[24:27], a[72:75], a[136:139]
  s_add_u32 m0, s36, 4096
  ds_read_b64_tr_b16 a[100:101], v19 offset:4096
  v_mfma_f32_16x16x32_bf16 a[168:171], a[28:31], a[72:75], a[168:171]
  v_mfma_f32_16x16x32_bf16 v[76:79], a[0:3], a[76:79], v[76:79]
  ds_read_b64_tr_b16 a[102:103], v19 offset:6144
  v_mfma_f32_16x16x32_bf16 v[108:111], a[4:7], a[76:79], v[108:111]
  v_mfma_f32_16x16x32_bf16 v[140:143], a[8:11], a[76:79], v[140:143]
  v_mfma_f32_16x16x32_bf16 v[172:175], a[12:15], a[76:79], v[172:175]
  ds_read_b64_tr_b16 a[104:105], v20 offset:4096
  v_mfma_f32_16x16x32_bf16 v[204:207], a[16:19], a[76:79], v[204:207]
  buffer_load_dwordx4 v52, s[8:11], s46 offen offset:0 lds
  v_mfma_f32_16x16x32_bf16 v[236:239], a[20:23], a[76:79], v[236:239]
  ds_read_b64_tr_b16 a[106:107], v20 offset:6144
  v_mfma_f32_16x16x32_bf16 a[140:143], a[24:27], a[76:79], a[140:143]
  v_mfma_f32_16x16x32_bf16 a[172:175], a[28:31], a[76:79], a[172:175]
  ds_read_b64_tr_b16 a[108:109], v21 offset:4096
  v_mfma_f32_16x16x32_bf16 v[80:83], a[0:3], a[80:83], v[80:83]
  v_mfma_f32_16x16x32_bf16 v[112:115], a[4:7], a[80:83], v[112:115]
  ds_read_b64_tr_b16 a[110:111], v21 offset:6144
  v_mfma_f32_16x16x32_bf16 v[144:147], a[8:11], a[80:83], v[144:147]
  v_mfma_f32_16x16x32_bf16 v[176:179], a[12:15], a[80:83], v[176:179]
  buffer_load_dwordx4 v53, s[8:11], s46 offen offset:1024 lds
  v_mfma_f32_16x16x32_bf16 v[208:211], a[16:19], a[80:83], v[208:211]
  ds_read_b64_tr_b16 a[112:113], v18 offset:12288
  v_mfma_f32_16x16x32_bf16 v[240:243], a[20:23], a[80:83], v[240:243]
  v_mfma_f32_16x16x32_bf16 a[144:147], a[24:27], a[80:83], a[144:147]
  ds_read_b64_tr_b16 a[114:115], v18 offset:14336
  v_mfma_f32_16x16x32_bf16 a[176:179], a[28:31], a[80:83], a[176:179]
  v_mfma_f32_16x16x32_bf16 v[84:87], a[0:3], a[84:87], v[84:87]
  ds_read_b64_tr_b16 a[116:117], v19 offset:12288
  v_mfma_f32_16x16x32_bf16 v[116:119], a[4:7], a[84:87], v[116:119]
  v_mfma_f32_16x16x32_bf16 v[148:151], a[8:11], a[84:87], v[148:151]
  buffer_load_dwordx4 v54, s[8:11], s46 offen offset:2048 lds
  ds_read_b64_tr_b16 a[118:119], v19 offset:14336
  v_mfma_f32_16x16x32_bf16 v[180:183], a[12:15], a[84:87], v[180:183]
  v_mfma_f32_16x16x32_bf16 v[212:215], a[16:19], a[84:87], v[212:215]
  v_mfma_f32_16x16x32_bf16 v[244:247], a[20:23], a[84:87], v[244:247]
  ds_read_b64_tr_b16 a[120:121], v20 offset:12288
  v_mfma_f32_16x16x32_bf16 a[148:151], a[24:27], a[84:87], a[148:151]
  v_mfma_f32_16x16x32_bf16 a[180:183], a[28:31], a[84:87], a[180:183]
  ds_read_b64_tr_b16 a[122:123], v20 offset:14336
  v_mfma_f32_16x16x32_bf16 v[88:91], a[0:3], a[88:91], v[88:91]
  v_mfma_f32_16x16x32_bf16 v[120:123], a[4:7], a[88:91], v[120:123]
  buffer_load_dwordx4 v55, s[8:11], s46 offen offset:3072 lds
  ds_read_b64_tr_b16 a[124:125], v21 offset:12288
  v_mfma_f32_16x16x32_bf16 v[152:155], a[8:11], a[88:91], v[152:155]
  s_sub_u32 s50, s50, 1
  s_cmp_eq_u32 s50, 0
  s_cselect_b32 s12, s72, s12
  s_cselect_b32 s13, s73, s13
  v_mfma_f32_16x16x32_bf16 v[184:187], a[12:15], a[88:91], v[184:187]
  s_lshl_b32 s47, s48, 19
  s_bfe_u32 s34, 0x3020106, s49
  s_add_u32 s48, s48, s34
  v_mfma_f32_16x16x32_bf16 v[216:219], a[16:19], a[88:91], v[216:219]
  s_add_u32 s49, s49, 8
  s_and_b32 s49, s49, 0x8001f
  s_and_b32 s48, s48, 7
  v_mfma_f32_16x16x32_bf16 v[248:251], a[20:23], a[88:91], v[248:251]
  s_lshl_b32 s46, s48, 7
  ds_read_b64_tr_b16 a[126:127], v21 offset:14336
  v_mfma_f32_16x16x32_bf16 a[152:155], a[24:27], a[88:91], a[152:155]
  s_add_u32 s36, s36, s38
  s_add_u32 s37, s37, 1
  s_cmp_eq_u32 s37, 3
  s_cselect_b32 s37, 0, s37
  s_cselect_b32 s38, s39, s40
  v_mfma_f32_16x16x32_bf16 a[184:187], a[28:31], a[88:91], a[184:187]
  s_add_u32 s41, s41, s43
  s_sub_u32 s43, 0, s43
  v_mfma_f32_16x16x32_bf16 v[92:95], a[0:3], a[92:95], v[92:95]
  v_add_u32 v16, s38, v16
  v_add_u32 v17, s38, v17
  v_mfma_f32_16x16x32_bf16 v[124:127], a[4:7], a[92:95], v[124:127]
  v_add_u32 v18, s43, v18
  v_add_u32 v19, s43, v19
  v_mfma_f32_16x16x32_bf16 v[156:159], a[8:11], a[92:95], v[156:159]
  v_add_u32 v20, s43, v20
  v_add_u32 v21, s43, v21
  v_mfma_f32_16x16x32_bf16 v[188:191], a[12:15], a[92:95], v[188:191]
  v_mfma_f32_16x16x32_bf16 v[220:223], a[16:19], a[92:95], v[220:223]
  v_mfma_f32_16x16x32_bf16 v[252:255], a[20:23], a[92:95], v[252:255]
  s_waitcnt vmcnt(8) lgkmcnt(0)
  s_barrier
  v_mfma_f32_16x16x32_bf16 a[156:159], a[24:27], a[92:95], a[156:159]
  s_sub_u32 s35, s35, 1
  v_mfma_f32_16x16x32_bf16 a[188:191], a[28:31], a[92:95], a[188:191]
  s_cmp_lg_u32 s35, 0
  s_cbranch_scc1 Lp1xw_loop
  v_accvgpr_read_b32 v4, a222
  v_accvgpr_read_b32 v5, a223
  v_accvgpr_read_b32 v6, a224
  v_accvgpr_read_b32 v7, a225
  v_accvgpr_read_b32 v8, a226
  v_accvgpr_read_b32 v9, a227
  v_accvgpr_read_b32 v10, a228
  v_accvgpr_read_b32 v11, a229
  s_mov_b32 s8, s64
  s_mov_b32 s9, s65
  s_mov_b32 s10, 4194304
  s_mov_b32 s11, 0x00020000
  s_mov_b32 s20, s68
  s_mov_b32 s21, s69
  s_mov_b32 s22, 8388608
  s_mov_b32 s23, 0x00020000
  s_and_b32 s4, s2, 7
  s_lshl_b32 s4, s4, 1
  s_lshr_b32 s5, s2, 6
  s_lshr_b32 s30, s2, 4
  s_add_u32 s5, s5, s30
  s_and_b32 s53, s5, 3
  s_lshl_b32 s53, s53, 3
  s_or_b32 s53, s53, 0x80000
  s_bfe_u32 s52, 0xf0f02, s53
  s_add_u32 s52, s52, s4
  s_and_b32 s52, s52, 15
  s_mov_b32 s54, s52
  s_mov_b32 s55, s53
  s_lshl_b32 s29, s52, 7
  s_lshl_b32 s28, s54, 19
  s_lshl_b32 s30, s25, 18
  s_and_b32 s31, s25, 1
  s_lshl_b32 s31, s31, 1
  s_add_u32 s31, s31, 14
  s_sub_u32 s31, s31, s25
  s_lshl_b32 s31, s31, 18
  s_or_b32 s26, s30, s29
  s_or_b32 s27, s31, s29
  s_lshl_b32 s68, s3, 12
  s_lshl_b32 s88, s3, 13
  s_add_u32 s88, s88, 98304
  v_mfma_f32_16x16x32_bf16 v[64:67], a[32:35], a[96:99], v[64:67]
  s_mov_b32 m0, s41
  ds_read_b128 a[0:3], v16 offset:0
  v_mfma_f32_16x16x32_bf16 v[96:99], a[36:39], a[96:99], v[96:99]
  buffer_load_dwordx4 v56, s[12:15], s47 offen offset:0 lds
  v_mfma_f32_16x16x32_bf16 v[128:131], a[40:43], a[96:99], v[128:131]
  ds_read_b64_tr_b16 a[64:65], v18 offset:0
  v_mfma_f32_16x16x32_bf16 v[160:163], a[44:47], a[96:99], v[160:163]
  v_mfma_f32_16x16x32_bf16 v[192:195], a[48:51], a[96:99], v[192:195]
  ds_read_b64_tr_b16 a[66:67], v18 offset:2048
  v_mfma_f32_16x16x32_bf16 v[224:227], a[52:55], a[96:99], v[224:227]
  v_mfma_f32_16x16x32_bf16 a[128:131], a[56:59], a[96:99], a[128:131]
  ds_read_b128 a[4:7], v16 offset:2048
  v_mfma_f32_16x16x32_bf16 a[160:163], a[60:63], a[96:99], a[160:163]
  buffer_load_dwordx4 v57, s[12:15], s47 offen offset:1024 lds
  v_mfma_f32_16x16x32_bf16 v[68:71], a[32:35], a[100:103], v[68:71]
  v_mfma_f32_16x16x32_bf16 v[100:103], a[36:39], a[100:103], v[100:103]
  ds_read_b128 a[8:11], v16 offset:4096
  v_mfma_f32_16x16x32_bf16 v[132:135], a[40:43], a[100:103], v[132:135]
  v_mfma_f32_16x16x32_bf16 v[164:167], a[44:47], a[100:103], v[164:167]
  ds_read_b128 a[12:15], v16 offset:6144
  v_mfma_f32_16x16x32_bf16 v[196:199], a[48:51], a[100:103], v[196:199]
  v_mfma_f32_16x16x32_bf16 v[228:231], a[52:55], a[100:103], v[228:231]
  ds_read_b128 a[16:19], v16 offset:8192
  v_mfma_f32_16x16x32_bf16 a[132:135], a[56:59], a[100:103], a[132:135]
  v_mfma_f32_16x16x32_bf16 a[164:167], a[60:63], a[100:103], a[164:167]
  buffer_load_dwordx4 v58, s[12:15], s47 offen offset:2048 lds
  ds_read_b128 a[20:23], v16 offset:10240
  v_mfma_f32_16x16x32_bf16 v[72:75], a[32:35], a[104:107], v[72:75]
  v_mfma_f32_16x16x32_bf16 v[104:107], a[36:39], a[104:107], v[104:107]
  v_mfma_f32_16x16x32_bf16 v[136:139], a[40:43], a[104:107], v[136:139]
  ds_read_b128 a[24:27], v16 offset:12288
  v_mfma_f32_16x16x32_bf16 v[168:171], a[44:47], a[104:107], v[168:171]
  v_mfma_f32_16x16x32_bf16 v[200:203], a[48:51], a[104:107], v[200:203]
  ds_read_b128 a[28:31], v16 offset:14336
  v_mfma_f32_16x16x32_bf16 v[232:235], a[52:55], a[104:107], v[232:235]
  v_mfma_f32_16x16x32_bf16 a[136:139], a[56:59], a[104:107], a[136:139]
  ds_read_b64_tr_b16 a[68:69], v19 offset:0
  v_mfma_f32_16x16x32_bf16 a[168:171], a[60:63], a[104:107], a[168:171]
  buffer_load_dwordx4 v59, s[12:15], s47 offen offset:3072 lds
  v_mfma_f32_16x16x32_bf16 v[76:79], a[32:35], a[108:111], v[76:79]
  s_add_u32 m0, s41, 4096
  ds_read_b64_tr_b16 a[70:71], v19 offset:2048
  v_mfma_f32_16x16x32_bf16 v[108:111], a[36:39], a[108:111], v[108:111]
  v_mfma_f32_16x16x32_bf16 v[140:143], a[40:43], a[108:111], v[140:143]
  v_mfma_f32_16x16x32_bf16 v[172:175], a[44:47], a[108:111], v[172:175]
  ds_read_b64_tr_b16 a[72:73], v20 offset:0
  v_mfma_f32_16x16x32_bf16 v[204:207], a[48:51], a[108:111], v[204:207]
  v_mfma_f32_16x16x32_bf16 v[236:239], a[52:55], a[108:111], v[236:239]
  ds_read_b64_tr_b16 a[74:75], v20 offset:2048
  v_mfma_f32_16x16x32_bf16 a[140:143], a[56:59], a[108:111], a[140:143]
  v_mfma_f32_16x16x32_bf16 a[172:175], a[60:63], a[108:111], a[172:175]
  buffer_load_dwordx4 v60, s[12:15], s47 offen offset:0 lds
  ds_read_b64_tr_b16 a[76:77], v21 offset:0
  v_mfma_f32_16x16x32_bf16 v[80:83], a[32:35], a[112:115], v[80:83]
  v_mfma_f32_16x16x32_bf16 v[112:115], a[36:39], a[112:115], v[112:115]
  ds_read_b64_tr_b16 a[78:79], v21 offset:2048
  v_mfma_f32_16x16x32_bf16 v[144:147], a[40:43], a[112:115], v[144:147]
  v_mfma_f32_16x16x32_bf16 v[176:179], a[44:47], a[112:115], v[176:179]
  v_mfma_f32_16x16x32_bf16 v[208:211], a[48:51], a[112:115], v[208:211]
  ds_read_b64_tr_b16 a[80:81], v18 offset:8192
  v_mfma_f32_16x16x32_bf16 v[240:243], a[52:55], a[112:115], v[240:243]
  v_mfma_f32_16x16x32_bf16 a[144:147], a[56:59], a[112:115], a[144:147]
  ds_read_b64_tr_b16 a[82:83], v18 offset:10240
  v_mfma_f32_16x16x32_bf16 a[176:179], a[60:63], a[112:115], a[176:179]
  buffer_load_dwordx4 v61, s[12:15], s47 offen offset:1024 lds
  v_mfma_f32_16x16x32_bf16 v[84:87], a[32:35], a[116:119], v[84:87]
  ds_read_b64_tr_b16 a[84:85], v19 offset:8192
  v_mfma_f32_16x16x32_bf16 v[116:119], a[36:39], a[116:119], v[116:119]
  v_mfma_f32_16x16x32_bf16 v[148:151], a[40:43], a[116:119], v[148:151]
  ds_read_b64_tr_b16 a[86:87], v19 offset:10240
  v_mfma_f32_16x16x32_bf16 v[180:183], a[44:47], a[116:119], v[180:183]
  v_mfma_f32_16x16x32_bf16 v[212:215], a[48:51], a[116:119], v[212:215]
  v_mfma_f32_16x16x32_bf16 v[244:247], a[52:55], a[116:119], v[244:247]
  ds_read_b64_tr_b16 a[88:89], v20 offset:8192
  v_mfma_f32_16x16x32_bf16 a[148:151], a[56:59], a[116:119], a[148:151]
  v_mfma_f32_16x16x32_bf16 a[180:183], a[60:63], a[116:119], a[180:183]
  buffer_load_dwordx4 v62, s[12:15], s47 offen offset:2048 lds
  ds_read_b64_tr_b16 a[90:91], v20 offset:10240
  v_mfma_f32_16x16x32_bf16 v[88:91], a[32:35], a[120:123], v[88:91]
  v_mfma_f32_16x16x32_bf16 v[120:123], a[36:39], a[120:123], v[120:123]
  ds_read_b64_tr_b16 a[92:93], v21 offset:8192
  v_mfma_f32_16x16x32_bf16 v[152:155], a[40:43], a[120:123], v[152:155]
  v_mfma_f32_16x16x32_bf16 v[184:187], a[44:47], a[120:123], v[184:187]
  ds_read_b64_tr_b16 a[94:95], v21 offset:10240
  v_mfma_f32_16x16x32_bf16 v[216:219], a[48:51], a[120:123], v[216:219]
  v_mfma_f32_16x16x32_bf16 v[248:251], a[52:55], a[120:123], v[248:251]
  v_mfma_f32_16x16x32_bf16 a[152:155], a[56:59], a[120:123], a[152:155]
  v_mfma_f32_16x16x32_bf16 a[184:187], a[60:63], a[120:123], a[184:187]
  buffer_load_dwordx4 v63, s[12:15], s47 offen offset:3072 lds
  v_mfma_f32_16x16x32_bf16 v[92:95], a[32:35], a[124:127], v[92:95]
  v_mfma_f32_16x16x32_bf16 v[124:127], a[36:39], a[124:127], v[124:127]
  v_mfma_f32_16x16x32_bf16 v[156:159], a[40:43], a[124:127], v[156:159]
  v_mfma_f32_16x16x32_bf16 v[188:191], a[44:47], a[124:127], v[188:191]
  v_mfma_f32_16x16x32_bf16 v[220:223], a[48:51], a[124:127], v[220:223]
  v_mfma_f32_16x16x32_bf16 v[252:255], a[52:55], a[124:127], v[252:255]
  v_mfma_f32_16x16x32_bf16 a[156:159], a[56:59], a[124:127], a[156:159]
  v_mfma_f32_16x16x32_bf16 a[188:191], a[60:63], a[124:127], a[188:191]
  s_waitcnt lgkmcnt(0)
  v_mfma_f32_16x16x32_bf16 v[64:67], a[0:3], a[64:67], v[64:67]
  s_mov_b32 m0, s68
  ds_read_b128 a[32:35], v17 offset:0
  v_mfma_f32_16x16x32_bf16 v[96:99], a[4:7], a[64:67], v[96:99]
  buffer_load_dwordx4 v8, s[20:23], s28 offen offset:0 lds
  v_mfma_f32_16x16x32_bf16 v[128:131], a[8:11], a[64:67], v[128:131]
  ds_read_b64_tr_b16 a[96:97], v18 offset:4096
  v_mfma_f32_16x16x32_bf16 v[160:163], a[12:15], a[64:67], v[160:163]
  v_mfma_f32_16x16x32_bf16 v[192:195], a[16:19], a[64:67], v[192:195]
  ds_read_b64_tr_b16 a[98:99], v18 offset:6144
  v_mfma_f32_16x16x32_bf16 v[224:227], a[20:23], a[64:67], v[224:227]
  v_mfma_f32_16x16x32_bf16 a[128:131], a[24:27], a[64:67], a[128:131]
  ds_read_b128 a[36:39], v17 offset:2048
  v_mfma_f32_16x16x32_bf16 a[160:163], a[28:31], a[64:67], a[160:163]
  buffer_load_dwordx4 v9, s[20:23], s28 offen offset:1024 lds
  v_mfma_f32_16x16x32_bf16 v[68:71], a[0:3], a[68:71], v[68:71]
  v_mfma_f32_16x16x32_bf16 v[100:103], a[4:7], a[68:71], v[100:103]
  ds_read_b128 a[40:43], v17 offset:4096
  v_mfma_f32_16x16x32_bf16 v[132:135], a[8:11], a[68:71], v[132:135]
  v_mfma_f32_16x16x32_bf16 v[164:167], a[12:15], a[68:71], v[164:167]
  ds_read_b128 a[44:47], v17 offset:6144
  v_mfma_f32_16x16x32_bf16 v[196:199], a[16:19], a[68:71], v[196:199]
  v_mfma_f32_16x16x32_bf16 v[228:231], a[20:23], a[68:71], v[228:231]
  ds_read_b128 a[48:51], v17 offset:8192
  v_mfma_f32_16x16x32_bf16 a[132:135], a[24:27], a[68:71], a[132:135]
  buffer_load_dwordx4 v10, s[20:23], s28 offen offset:2048 lds
  v_mfma_f32_16x16x32_bf16 a[164:167], a[28:31], a[68:71], a[164:167]
  ds_read_b128 a[52:55], v17 offset:10240
  v_mfma_f32_16x16x32_bf16 v[72:75], a[0:3], a[72:75], v[72:75]
  v_mfma_f32_16x16x32_bf16 v[104:107], a[4:7], a[72:75], v[104:107]
  v_mfma_f32_16x16x32_bf16 v[136:139], a[8:11], a[72:75], v[136:139]
  ds_read_b128 a[56:59], v17 offset:12288
  v_mfma_f32_16x16x32_bf16 v[168:171], a[12:15], a[72:75], v[168:171]
  v_mfma_f32_16x16x32_bf16 v[200:203], a[16:19], a[72:75], v[200:203]
  ds_read_b128 a[60:63], v17 offset:14336
  v_mfma_f32_16x16x32_bf16 v[232:235], a[20:23], a[72:75], v[232:235]
  buffer_load_dwordx4 v11, s[20:23], s28 offen offset:3072 lds
  v_mfma_f32_16x16x32_bf16 a[136:139], a[24:27], a[72:75], a[136:139]
  s_bfe_u32 s56, 0x302010e, s55
  s_add_u32 s54, s54, s56
  s_add_u32 s55, s55, 8
  v_mfma_f32_16x16x32_bf16 a[168:171], a[28:31], a[72:75], a[168:171]
  s_and_b32 s55, s55, 0x8001f
  s_and_b32 s54, s54, 15
  s_lshl_b32 s28, s54, 19
  v_mfma_f32_16x16x32_bf16 v[76:79], a[0:3], a[76:79], v[76:79]
  s_add_u32 m0, s68, 16384
  ds_read_b64_tr_b16 a[100:101], v19 offset:4096
  ds_read_b64_tr_b16 a[102:103], v19 offset:6144
  v_mfma_f32_16x16x32_bf16 v[108:111], a[4:7], a[76:79], v[108:111]
  v_mfma_f32_16x16x32_bf16 v[140:143], a[8:11], a[76:79], v[140:143]
  v_mfma_f32_16x16x32_bf16 v[172:175], a[12:15], a[76:79], v[172:175]
  ds_read_b64_tr_b16 a[104:105], v20 offset:4096
  v_mfma_f32_16x16x32_bf16 v[204:207], a[16:19], a[76:79], v[204:207]
  buffer_load_dwordx4 v8, s[20:23], s28 offen offset:0 lds
  v_mfma_f32_16x16x32_bf16 v[236:239], a[20:23], a[76:79], v[236:239]
  ds_read_b64_tr_b16 a[106:107], v20 offset:6144
  v_mfma_f32_16x16x32_bf16 a[140:143], a[24:27], a[76:79], a[140:143]
  v_mfma_f32_16x16x32_bf16 a[172:175], a[28:31], a[76:79], a[172:175]
  ds_read_b64_tr_b16 a[108:109], v21 offset:4096
  v_mfma_f32_16x16x32_bf16 v[80:83], a[0:3], a[80:83], v[80:83]
  v_mfma_f32_16x16x32_bf16 v[112:115], a[4:7], a[80:83], v[112:115]
  ds_read_b64_tr_b16 a[110:111], v21 offset:6144
  v_mfma_f32_16x16x32_bf16 v[144:147], a[8:11], a[80:83], v[144:147]
  v_mfma_f32_16x16x32_bf16 v[176:179], a[12:15], a[80:83], v[176:179]
  buffer_load_dwordx4 v9, s[20:23], s28 offen offset:1024 lds
  v_mfma_f32_16x16x32_bf16 v[208:211], a[16:19], a[80:83], v[208:211]
  ds_read_b64_tr_b16 a[112:113], v18 offset:12288
  v_mfma_f32_16x16x32_bf16 v[240:243], a[20:23], a[80:83], v[240:243]
  v_mfma_f32_16x16x32_bf16 a[144:147], a[24:27], a[80:83], a[144:147]
  ds_read_b64_tr_b16 a[114:115], v18 offset:14336
  v_mfma_f32_16x16x32_bf16 a[176:179], a[28:31], a[80:83], a[176:179]
  v_mfma_f32_16x16x32_bf16 v[84:87], a[0:3], a[84:87], v[84:87]
  ds_read_b64_tr_b16 a[116:117], v19 offset:12288
  v_mfma_f32_16x16x32_bf16 v[116:119], a[4:7], a[84:87], v[116:119]
  v_mfma_f32_16x16x32_bf16 v[148:151], a[8:11], a[84:87], v[148:151]
  buffer_load_dwordx4 v10, s[20:23], s28 offen offset:2048 lds
  ds_read_b64_tr_b16 a[118:119], v19 offset:14336
  v_mfma_f32_16x16x32_bf16 v[180:183], a[12:15], a[84:87], v[180:183]
  v_mfma_f32_16x16x32_bf16 v[212:215], a[16:19], a[84:87], v[212:215]
  v_mfma_f32_16x16x32_bf16 v[244:247], a[20:23], a[84:87], v[244:247]
  ds_read_b64_tr_b16 a[120:121], v20 offset:12288
  v_mfma_f32_16x16x32_bf16 a[148:151], a[24:27], a[84:87], a[148:151]
  v_mfma_f32_16x16x32_bf16 a[180:183], a[28:31], a[84:87], a[180:183]
  ds_read_b64_tr_b16 a[122:123], v20 offset:14336
  v_mfma_f32_16x16x32_bf16 v[88:91], a[0:3], a[88:91], v[88:91]
  v_mfma_f32_16x16x32_bf16 v[120:123], a[4:7], a[88:91], v[120:123]
  buffer_load_dwordx4 v11, s[20:23], s28 offen offset:3072 lds
  ds_read_b64_tr_b16 a[124:125], v21 offset:12288
  v_mfma_f32_16x16x32_bf16 v[152:155], a[8:11], a[88:91], v[152:155]
  s_bfe_u32 s56, 0x302010e, s55
  s_add_u32 s54, s54, s56
  s_add_u32 s55, s55, 8
  v_mfma_f32_16x16x32_bf16 v[184:187], a[12:15], a[88:91], v[184:187]
  s_and_b32 s55, s55, 0x8001f
  s_and_b32 s54, s54, 15
  s_lshl_b32 s28, s54, 19
  v_mfma_f32_16x16x32_bf16 v[216:219], a[16:19], a[88:91], v[216:219]
  s_add_u32 s36, s36, s38
  s_add_u32 s37, s37, 1
  ds_read_b64_tr_b16 a[126:127], v21 offset:14336
  v_mfma_f32_16x16x32_bf16 v[248:251], a[20:23], a[88:91], v[248:251]
  s_cmp_eq_u32 s37, 3
  s_cselect_b32 s37, 0, s37
  s_cselect_b32 s38, s39, s40
  v_mfma_f32_16x16x32_bf16 a[152:155], a[24:27], a[88:91], a[152:155]
  s_add_u32 s41, s41, s43
  s_sub_u32 s43, 0, s43
  v_mfma_f32_16x16x32_bf16 a[184:187], a[28:31], a[88:91], a[184:187]
  v_add_u32 v16, s38, v16
  v_add_u32 v17, s38, v17
  v_mfma_f32_16x16x32_bf16 v[92:95], a[0:3], a[92:95], v[92:95]
  v_add_u32 v18, s43, v18
  v_add_u32 v19, s43, v19
  v_mfma_f32_16x16x32_bf16 v[124:127], a[4:7], a[92:95], v[124:127]
  v_add_u32 v20, s43, v20
  v_add_u32 v21, s43, v21
  v_mfma_f32_16x16x32_bf16 v[156:159], a[8:11], a[92:95], v[156:159]
  v_mfma_f32_16x16x32_bf16 v[188:191], a[12:15], a[92:95], v[188:191]
  v_mfma_f32_16x16x32_bf16 v[220:223], a[16:19], a[92:95], v[220:223]
  v_mfma_f32_16x16x32_bf16 v[252:255], a[20:23], a[92:95], v[252:255]
  v_mfma_f32_16x16x32_bf16 a[156:159], a[24:27], a[92:95], a[156:159]
  v_mfma_f32_16x16x32_bf16 a[188:191], a[28:31], a[92:95], a[188:191]
  s_waitcnt vmcnt(8) lgkmcnt(0)
  s_barrier
  v_mfma_f32_16x16x32_bf16 v[64:67], a[32:35], a[96:99], v[64:67]
  s_mov_b32 m0, s88
  ds_read_b128 a[0:3], v16 offset:0
  v_mfma_f32_16x16x32_bf16 v[96:99], a[36:39], a[96:99], v[96:99]
  buffer_load_dwordx4 v4, s[8:11], s26 offen offset:0 lds
  v_mfma_f32_16x16x32_bf16 v[128:131], a[40:43], a[96:99], v[128:131]
  ds_read_b64_tr_b16 a[64:65], v18 offset:0
  v_mfma_f32_16x16x32_bf16 v[160:163], a[44:47], a[96:99], v[160:163]
  v_mfma_f32_16x16x32_bf16 v[192:195], a[48:51], a[96:99], v[192:195]
  ds_read_b64_tr_b16 a[66:67], v18 offset:2048
  v_mfma_f32_16x16x32_bf16 v[224:227], a[52:55], a[96:99], v[224:227]
  v_mfma_f32_16x16x32_bf16 a[128:131], a[56:59], a[96:99], a[128:131]
  ds_read_b128 a[4:7], v16 offset:2048
  v_mfma_f32_16x16x32_bf16 a[160:163], a[60:63], a[96:99], a[160:163]
  buffer_load_dwordx4 v5, s[8:11], s26 offen offset:1024 lds
  v_mfma_f32_16x16x32_bf16 v[68:71], a[32:35], a[100:103], v[68:71]
  v_mfma_f32_16x16x32_bf16 v[100:103], a[36:39], a[100:103], v[100:103]
  ds_read_b128 a[8:11], v16 offset:4096
  v_mfma_f32_16x16x32_bf16 v[132:135], a[40:43], a[100:103], v[132:135]
  v_mfma_f32_16x16x32_bf16 v[164:167], a[44:47], a[100:103], v[164:167]
  ds_read_b128 a[12:15], v16 offset:6144
  v_mfma_f32_16x16x32_bf16 v[196:199], a[48:51], a[100:103], v[196:199]
  v_mfma_f32_16x16x32_bf16 v[228:231], a[52:55], a[100:103], v[228:231]
  ds_read_b128 a[16:19], v16 offset:8192
  v_mfma_f32_16x16x32_bf16 a[132:135], a[56:59], a[100:103], a[132:135]
  v_mfma_f32_16x16x32_bf16 a[164:167], a[60:63], a[100:103], a[164:167]
  buffer_load_dwordx4 v6, s[8:11], s26 offen offset:2048 lds
  ds_read_b128 a[20:23], v16 offset:10240
  v_mfma_f32_16x16x32_bf16 v[72:75], a[32:35], a[104:107], v[72:75]
  v_mfma_f32_16x16x32_bf16 v[104:107], a[36:39], a[104:107], v[104:107]
  v_mfma_f32_16x16x32_bf16 v[136:139], a[40:43], a[104:107], v[136:139]
  ds_read_b128 a[24:27], v16 offset:12288
  v_mfma_f32_16x16x32_bf16 v[168:171], a[44:47], a[104:107], v[168:171]
  v_mfma_f32_16x16x32_bf16 v[200:203], a[48:51], a[104:107], v[200:203]
  ds_read_b128 a[28:31], v16 offset:14336
  v_mfma_f32_16x16x32_bf16 v[232:235], a[52:55], a[104:107], v[232:235]
  v_mfma_f32_16x16x32_bf16 a[136:139], a[56:59], a[104:107], a[136:139]
  ds_read_b64_tr_b16 a[68:69], v19 offset:0
  v_mfma_f32_16x16x32_bf16 a[168:171], a[60:63], a[104:107], a[168:171]
  buffer_load_dwordx4 v7, s[8:11], s26 offen offset:3072 lds
  v_mfma_f32_16x16x32_bf16 v[76:79], a[32:35], a[108:111], v[76:79]
  s_add_u32 m0, s88, 4096
  ds_read_b64_tr_b16 a[70:71], v19 offset:2048
  v_mfma_f32_16x16x32_bf16 v[108:111], a[36:39], a[108:111], v[108:111]
  v_mfma_f32_16x16x32_bf16 v[140:143], a[40:43], a[108:111], v[140:143]
  v_mfma_f32_16x16x32_bf16 v[172:175], a[44:47], a[108:111], v[172:175]
  ds_read_b64_tr_b16 a[72:73], v20 offset:0
  v_mfma_f32_16x16x32_bf16 v[204:207], a[48:51], a[108:111], v[204:207]
  v_mfma_f32_16x16x32_bf16 v[236:239], a[52:55], a[108:111], v[236:239]
  ds_read_b64_tr_b16 a[74:75], v20 offset:2048
  v_mfma_f32_16x16x32_bf16 a[140:143], a[56:59], a[108:111], a[140:143]
  v_mfma_f32_16x16x32_bf16 a[172:175], a[60:63], a[108:111], a[172:175]
  buffer_load_dwordx4 v4, s[8:11], s27 offen offset:0 lds
  ds_read_b64_tr_b16 a[76:77], v21 offset:0
  v_mfma_f32_16x16x32_bf16 v[80:83], a[32:35], a[112:115], v[80:83]
  v_mfma_f32_16x16x32_bf16 v[112:115], a[36:39], a[112:115], v[112:115]
  ds_read_b64_tr_b16 a[78:79], v21 offset:2048
  v_mfma_f32_16x16x32_bf16 v[144:147], a[40:43], a[112:115], v[144:147]
  v_mfma_f32_16x16x32_bf16 v[176:179], a[44:47], a[112:115], v[176:179]
  v_mfma_f32_16x16x32_bf16 v[208:211], a[48:51], a[112:115], v[208:211]
  ds_read_b64_tr_b16 a[80:81], v18 offset:8192
  v_mfma_f32_16x16x32_bf16 v[240:243], a[52:55], a[112:115], v[240:243]
  v_mfma_f32_16x16x32_bf16 a[144:147], a[56:59], a[112:115], a[144:147]
  ds_read_b64_tr_b16 a[82:83], v18 offset:10240
  v_mfma_f32_16x16x32_bf16 a[176:179], a[60:63], a[112:115], a[176:179]
  buffer_load_dwordx4 v5, s[8:11], s27 offen offset:1024 lds
  v_mfma_f32_16x16x32_bf16 v[84:87], a[32:35], a[116:119], v[84:87]
  ds_read_b64_tr_b16 a[84:85], v19 offset:8192
  v_mfma_f32_16x16x32_bf16 v[116:119], a[36:39], a[116:119], v[116:119]
  v_mfma_f32_16x16x32_bf16 v[148:151], a[40:43], a[116:119], v[148:151]
  ds_read_b64_tr_b16 a[86:87], v19 offset:10240
  v_mfma_f32_16x16x32_bf16 v[180:183], a[44:47], a[116:119], v[180:183]
  v_mfma_f32_16x16x32_bf16 v[212:215], a[48:51], a[116:119], v[212:215]
  v_mfma_f32_16x16x32_bf16 v[244:247], a[52:55], a[116:119], v[244:247]
  ds_read_b64_tr_b16 a[88:89], v20 offset:8192
  v_mfma_f32_16x16x32_bf16 a[148:151], a[56:59], a[116:119], a[148:151]
  v_mfma_f32_16x16x32_bf16 a[180:183], a[60:63], a[116:119], a[180:183]
  buffer_load_dwordx4 v6, s[8:11], s27 offen offset:2048 lds
  ds_read_b64_tr_b16 a[90:91], v20 offset:10240
  v_mfma_f32_16x16x32_bf16 v[88:91], a[32:35], a[120:123], v[88:91]
  v_mfma_f32_16x16x32_bf16 v[120:123], a[36:39], a[120:123], v[120:123]
  ds_read_b64_tr_b16 a[92:93], v21 offset:8192
  v_mfma_f32_16x16x32_bf16 v[152:155], a[40:43], a[120:123], v[152:155]
  v_mfma_f32_16x16x32_bf16 v[184:187], a[44:47], a[120:123], v[184:187]
  ds_read_b64_tr_b16 a[94:95], v21 offset:10240
  v_mfma_f32_16x16x32_bf16 v[216:219], a[48:51], a[120:123], v[216:219]
  v_mfma_f32_16x16x32_bf16 v[248:251], a[52:55], a[120:123], v[248:251]
  v_mfma_f32_16x16x32_bf16 a[152:155], a[56:59], a[120:123], a[152:155]
  v_mfma_f32_16x16x32_bf16 a[184:187], a[60:63], a[120:123], a[184:187]
  buffer_load_dwordx4 v7, s[8:11], s27 offen offset:3072 lds
  v_mfma_f32_16x16x32_bf16 v[92:95], a[32:35], a[124:127], v[92:95]
  s_bfe_u32 s29, 0x302010e, s53
  s_add_u32 s52, s52, s29
  s_add_u32 s53, s53, 8
  v_mfma_f32_16x16x32_bf16 v[124:127], a[36:39], a[124:127], v[124:127]
  s_and_b32 s53, s53, 0x8001f
  s_and_b32 s52, s52, 15
  s_lshl_b32 s29, s52, 7
  v_mfma_f32_16x16x32_bf16 v[156:159], a[40:43], a[124:127], v[156:159]
  s_or_b32 s26, s30, s29
  s_or_b32 s27, s31, s29
  v_mfma_f32_16x16x32_bf16 v[188:191], a[44:47], a[124:127], v[188:191]
  v_mfma_f32_16x16x32_bf16 v[220:223], a[48:51], a[124:127], v[220:223]
  v_mfma_f32_16x16x32_bf16 v[252:255], a[52:55], a[124:127], v[252:255]
  v_mfma_f32_16x16x32_bf16 a[156:159], a[56:59], a[124:127], a[156:159]
  v_mfma_f32_16x16x32_bf16 a[188:191], a[60:63], a[124:127], a[188:191]
  s_waitcnt lgkmcnt(0)
  v_mfma_f32_16x16x32_bf16 v[128:131], a[8:11], a[64:67], v[128:131]
  ds_read_b128 a[32:35], v17 offset:0
  ds_read_b64_tr_b16 a[96:97], v18 offset:4096
  v_mfma_f32_16x16x32_bf16 v[160:163], a[12:15], a[64:67], v[160:163]
  ds_read_b64_tr_b16 a[98:99], v18 offset:6144
  ds_read_b128 a[36:39], v17 offset:2048
  v_mfma_f32_16x16x32_bf16 v[132:135], a[8:11], a[68:71], v[132:135]
  ds_read_b128 a[40:43], v17 offset:4096
  ds_read_b128 a[44:47], v17 offset:6144
  v_mfma_f32_16x16x32_bf16 v[164:167], a[12:15], a[68:71], v[164:167]
  ds_read_b128 a[48:51], v17 offset:8192
  ds_read_b128 a[52:55], v17 offset:10240
  v_mfma_f32_16x16x32_bf16 v[136:139], a[8:11], a[72:75], v[136:139]
  ds_read_b128 a[56:59], v17 offset:12288
  ds_read_b128 a[60:63], v17 offset:14336
  v_mfma_f32_16x16x32_bf16 v[168:171], a[12:15], a[72:75], v[168:171]
  ds_read_b64_tr_b16 a[100:101], v19 offset:4096
  ds_read_b64_tr_b16 a[102:103], v19 offset:6144
  v_mfma_f32_16x16x32_bf16 v[140:143], a[8:11], a[76:79], v[140:143]
  ds_read_b64_tr_b16 a[104:105], v20 offset:4096
  v_mfma_f32_16x16x32_bf16 v[172:175], a[12:15], a[76:79], v[172:175]
  ds_read_b64_tr_b16 a[106:107], v20 offset:6144
  ds_read_b64_tr_b16 a[108:109], v21 offset:4096
  v_mfma_f32_16x16x32_bf16 v[144:147], a[8:11], a[80:83], v[144:147]
  ds_read_b64_tr_b16 a[110:111], v21 offset:6144
  ds_read_b64_tr_b16 a[112:113], v18 offset:12288
  v_mfma_f32_16x16x32_bf16 v[176:179], a[12:15], a[80:83], v[176:179]
  ds_read_b64_tr_b16 a[114:115], v18 offset:14336
  ds_read_b64_tr_b16 a[116:117], v19 offset:12288
  v_mfma_f32_16x16x32_bf16 v[148:151], a[8:11], a[84:87], v[148:151]
  ds_read_b64_tr_b16 a[118:119], v19 offset:14336
  ds_read_b64_tr_b16 a[120:121], v20 offset:12288
  v_mfma_f32_16x16x32_bf16 v[180:183], a[12:15], a[84:87], v[180:183]
  ds_read_b64_tr_b16 a[122:123], v20 offset:14336
  ds_read_b64_tr_b16 a[124:125], v21 offset:12288
  v_mfma_f32_16x16x32_bf16 v[152:155], a[8:11], a[88:91], v[152:155]
  ds_read_b64_tr_b16 a[126:127], v21 offset:14336
  v_mfma_f32_16x16x32_bf16 v[184:187], a[12:15], a[88:91], v[184:187]
  v_mfma_f32_16x16x32_bf16 v[156:159], a[8:11], a[92:95], v[156:159]
  v_mfma_f32_16x16x32_bf16 v[188:191], a[12:15], a[92:95], v[188:191]
  v_mfma_f32_16x16x32_bf16 v[192:195], a[16:19], a[64:67], v[192:195]
  v_mfma_f32_16x16x32_bf16 v[224:227], a[20:23], a[64:67], v[224:227]
  s_waitcnt lgkmcnt(0)
  s_barrier
  s_mov_b32 s12, s84
  s_mov_b32 s13, s85
  s_mov_b32 s14, 256
  s_mov_b32 s15, 0x00020000
  buffer_load_dwordx2 v[22:23], off, s[12:15], 0 sc1
  v_mfma_f32_16x16x32_bf16 v[128:131], a[40:43], a[96:99], v[128:131]
  s_add_u32 m0, s88, 32768
  v_mfma_f32_16x16x32_bf16 v[160:163], a[44:47], a[96:99], v[160:163]
  buffer_load_dwordx4 v4, s[8:11], s26 offen offset:0 lds
  v_mfma_f32_16x16x32_bf16 v[132:135], a[40:43], a[100:103], v[132:135]
  v_mfma_f32_16x16x32_bf16 v[164:167], a[44:47], a[100:103], v[164:167]
  v_mfma_f32_16x16x32_bf16 v[136:139], a[40:43], a[104:107], v[136:139]
  v_mfma_f32_16x16x32_bf16 v[168:171], a[44:47], a[104:107], v[168:171]
  buffer_load_dwordx4 v5, s[8:11], s26 offen offset:1024 lds
  v_cvt_pk_bf16_f32 v128, v128, v129
  v_mfma_f32_16x16x32_bf16 v[140:143], a[40:43], a[108:111], v[140:143]
  v_cvt_pk_bf16_f32 v129, v130, v131
  v_cvt_pk_bf16_f32 v130, v160, v161
  v_mfma_f32_16x16x32_bf16 v[172:175], a[44:47], a[108:111], v[172:175]
  v_cvt_pk_bf16_f32 v131, v162, v163
  v_cvt_pk_bf16_f32 v132, v132, v133
  v_mfma_f32_16x16x32_bf16 v[144:147], a[40:43], a[112:115], v[144:147]
  v_cvt_pk_bf16_f32 v133, v134, v135
  v_cvt_pk_bf16_f32 v134, v164, v165
  v_mfma_f32_16x16x32_bf16 v[176:179], a[44:47], a[112:115], v[176:179]
  v_cvt_pk_bf16_f32 v135, v166, v167
  v_mfma_f32_16x16x32_bf16 v[148:151], a[40:43], a[116:119], v[148:151]
  buffer_load_dwordx4 v6, s[8:11], s26 offen offset:2048 lds
  v_mfma_f32_16x16x32_bf16 v[180:183], a[44:47], a[116:119], v[180:183]
  s_add_u32 s60, s63, 8192
  buffer_store_dwordx4 v[128:131], v2, s[16:19], s60 offen offset:0 sc1
  v_cvt_pk_bf16_f32 v136, v136, v137
  v_mfma_f32_16x16x32_bf16 v[152:155], a[40:43], a[120:123], v[152:155]
  v_cvt_pk_bf16_f32 v137, v138, v139
  v_cvt_pk_bf16_f32 v138, v168, v169
  v_mfma_f32_16x16x32_bf16 v[184:187], a[44:47], a[120:123], v[184:187]
  v_cvt_pk_bf16_f32 v139, v170, v171
  v_cvt_pk_bf16_f32 v140, v140, v141
  v_mfma_f32_16x16x32_bf16 v[156:159], a[40:43], a[124:127], v[156:159]
  v_cvt_pk_bf16_f32 v141, v142, v143
  v_cvt_pk_bf16_f32 v142, v172, v173
  v_mfma_f32_16x16x32_bf16 v[188:191], a[44:47], a[124:127], v[188:191]
  v_cvt_pk_bf16_f32 v143, v174, v175
  v_cvt_pk_bf16_f32 v144, v144, v145
  v_mfma_f32_16x16x32_bf16 v[192:195], a[48:51], a[96:99], v[192:195]
  buffer_load_dwordx4 v7, s[8:11], s26 offen offset:3072 lds
  v_cvt_pk_bf16_f32 v145, v146, v147
  v_mfma_f32_16x16x32_bf16 v[224:227], a[52:55], a[96:99], v[224:227]
  s_add_u32 m0, s88, 36864
  v_cvt_pk_bf16_f32 v146, v176, v177
  v_cvt_pk_bf16_f32 v147, v178, v179
  v_mfma_f32_16x16x32_bf16 a[128:131], a[24:27], a[64:67], a[128:131]
  s_add_u32 s60, s63, 8192
  buffer_store_dwordx4 v[132:135], v2, s[16:19], s60 offen offset:1024 sc1
  v_cvt_pk_bf16_f32 v148, v148, v149
  v_mfma_f32_16x16x32_bf16 a[160:163], a[28:31], a[64:67], a[160:163]
  v_cvt_pk_bf16_f32 v149, v150, v151
  v_cvt_pk_bf16_f32 v150, v180, v181
  v_mfma_f32_16x16x32_bf16 a[128:131], a[56:59], a[96:99], a[128:131]
  v_cvt_pk_bf16_f32 v151, v182, v183
  v_cvt_pk_bf16_f32 v152, v152, v153
  v_mfma_f32_16x16x32_bf16 a[160:163], a[60:63], a[96:99], a[160:163]
  buffer_load_dwordx4 v4, s[8:11], s27 offen offset:0 lds
  v_cvt_pk_bf16_f32 v153, v154, v155
  v_mfma_f32_16x16x32_bf16 v[196:199], a[16:19], a[68:71], v[196:199]
  v_cvt_pk_bf16_f32 v154, v184, v185
  v_cvt_pk_bf16_f32 v155, v186, v187
  v_mfma_f32_16x16x32_bf16 v[228:231], a[20:23], a[68:71], v[228:231]
  v_cvt_pk_bf16_f32 v156, v156, v157
  v_cvt_pk_bf16_f32 v157, v158, v159
  v_mfma_f32_16x16x32_bf16 v[196:199], a[48:51], a[100:103], v[196:199]
  v_cvt_pk_bf16_f32 v158, v188, v189
  v_cvt_pk_bf16_f32 v159, v190, v191
  v_mfma_f32_16x16x32_bf16 v[228:231], a[52:55], a[100:103], v[228:231]
  v_cvt_pk_bf16_f32 v192, v192, v193
  v_cvt_pk_bf16_f32 v193, v194, v195
  v_mfma_f32_16x16x32_bf16 a[132:135], a[24:27], a[68:71], a[132:135]
  v_cvt_pk_bf16_f32 v194, v224, v225
  v_cvt_pk_bf16_f32 v195, v226, v227
  v_mfma_f32_16x16x32_bf16 a[164:167], a[28:31], a[68:71], a[164:167]
  buffer_load_dwordx4 v5, s[8:11], s27 offen offset:1024 lds
  v_mfma_f32_16x16x32_bf16 a[132:135], a[56:59], a[100:103], a[132:135]
  s_add_u32 s60, s63, 8192
  buffer_store_dwordx4 v[136:139], v2, s[16:19], s60 offen offset:2048 sc1
  v_accvgpr_read_b32 v24, a128
  v_mfma_f32_16x16x32_bf16 a[164:167], a[60:63], a[100:103], a[164:167]
  v_accvgpr_read_b32 v25, a129
  v_accvgpr_read_b32 v26, a130
  v_mfma_f32_16x16x32_bf16 v[200:203], a[16:19], a[72:75], v[200:203]
  v_accvgpr_read_b32 v27, a131
  v_accvgpr_read_b32 v28, a160
  v_mfma_f32_16x16x32_bf16 v[232:235], a[20:23], a[72:75], v[232:235]
  v_accvgpr_read_b32 v29, a161
  v_accvgpr_read_b32 v30, a162
  v_mfma_f32_16x16x32_bf16 v[200:203], a[48:51], a[104:107], v[200:203]
  buffer_load_dwordx4 v6, s[8:11], s27 offen offset:2048 lds
  v_accvgpr_read_b32 v31, a163
  v_mfma_f32_16x16x32_bf16 v[232:235], a[52:55], a[104:107], v[232:235]
  v_cvt_pk_bf16_f32 v224, v24, v25
  v_cvt_pk_bf16_f32 v225, v26, v27
  v_mfma_f32_16x16x32_bf16 a[136:139], a[24:27], a[72:75], a[136:139]
  v_cvt_pk_bf16_f32 v226, v28, v29
  v_cvt_pk_bf16_f32 v227, v30, v31
  v_mfma_f32_16x16x32_bf16 a[168:171], a[28:31], a[72:75], a[168:171]
  v_cvt_pk_bf16_f32 v196, v196, v197
  v_cvt_pk_bf16_f32 v197, v198, v199
  v_mfma_f32_16x16x32_bf16 a[136:139], a[56:59], a[104:107], a[136:139]
  v_cvt_pk_bf16_f32 v198, v228, v229
  v_cvt_pk_bf16_f32 v199, v230, v231
  v_mfma_f32_16x16x32_bf16 a[168:171], a[60:63], a[104:107], a[168:171]
  v_accvgpr_read_b32 v32, a132
  v_accvgpr_read_b32 v33, a133
  v_mfma_f32_16x16x32_bf16 v[204:207], a[16:19], a[76:79], v[204:207]
  buffer_load_dwordx4 v7, s[8:11], s27 offen offset:3072 lds
  v_accvgpr_read_b32 v34, a134
  v_mfma_f32_16x16x32_bf16 v[236:239], a[20:23], a[76:79], v[236:239]
  s_bfe_u32 s29, 0x302010e, s53
  s_add_u32 s52, s52, s29
  s_add_u32 s53, s53, 8
  v_mfma_f32_16x16x32_bf16 v[204:207], a[48:51], a[108:111], v[204:207]
  s_and_b32 s53, s53, 0x8001f
  s_and_b32 s52, s52, 15
  s_lshl_b32 s29, s52, 7
  v_mfma_f32_16x16x32_bf16 v[236:239], a[52:55], a[108:111], v[236:239]
  s_or_b32 s26, s30, s29
  s_or_b32 s27, s31, s29
  s_add_u32 m0, s68, 32768
  v_mfma_f32_16x16x32_bf16 a[140:143], a[24:27], a[76:79], a[140:143]
  v_accvgpr_read_b32 v35, a135
  v_accvgpr_read_b32 v36, a164
  v_mfma_f32_16x16x32_bf16 a[172:175], a[28:31], a[76:79], a[172:175]
  buffer_load_dwordx4 v8, s[20:23], s28 offen offset:0 lds
  v_accvgpr_read_b32 v37, a165
  v_mfma_f32_16x16x32_bf16 a[140:143], a[56:59], a[108:111], a[140:143]
  v_accvgpr_read_b32 v38, a166
  v_accvgpr_read_b32 v39, a167
  v_mfma_f32_16x16x32_bf16 a[172:175], a[60:63], a[108:111], a[172:175]
  v_cvt_pk_bf16_f32 v228, v32, v33
  v_cvt_pk_bf16_f32 v229, v34, v35
  v_mfma_f32_16x16x32_bf16 v[208:211], a[16:19], a[80:83], v[208:211]
  v_cvt_pk_bf16_f32 v230, v36, v37
  v_cvt_pk_bf16_f32 v231, v38, v39
  v_mfma_f32_16x16x32_bf16 v[240:243], a[20:23], a[80:83], v[240:243]
  s_add_u32 s60, s63, 8192
  buffer_store_dwordx4 v[140:143], v2, s[16:19], s60 offen offset:3072 sc1
  v_cvt_pk_bf16_f32 v200, v200, v201
  v_mfma_f32_16x16x32_bf16 v[208:211], a[48:51], a[112:115], v[208:211]
  v_cvt_pk_bf16_f32 v201, v202, v203
  v_cvt_pk_bf16_f32 v202, v232, v233
  v_mfma_f32_16x16x32_bf16 v[240:243], a[52:55], a[112:115], v[240:243]
  buffer_load_dwordx4 v9, s[20:23], s28 offen offset:1024 lds
  v_cvt_pk_bf16_f32 v203, v234, v235
  v_mfma_f32_16x16x32_bf16 a[144:147], a[24:27], a[80:83], a[144:147]
  v_accvgpr_read_b32 v40, a136
  v_accvgpr_read_b32 v41, a137
  v_mfma_f32_16x16x32_bf16 a[176:179], a[28:31], a[80:83], a[176:179]
  v_accvgpr_read_b32 v42, a138
  v_accvgpr_read_b32 v43, a139
  v_mfma_f32_16x16x32_bf16 a[144:147], a[56:59], a[112:115], a[144:147]
  v_accvgpr_read_b32 v44, a168
  v_accvgpr_read_b32 v45, a169
  v_mfma_f32_16x16x32_bf16 a[176:179], a[60:63], a[112:115], a[176:179]
  v_accvgpr_read_b32 v46, a170
  v_accvgpr_read_b32 v47, a171
  v_mfma_f32_16x16x32_bf16 v[212:215], a[16:19], a[84:87], v[212:215]
  buffer_load_dwordx4 v10, s[20:23], s28 offen offset:2048 lds
  v_cvt_pk_bf16_f32 v232, v40, v41
  v_mfma_f32_16x16x32_bf16 v[244:247], a[20:23], a[84:87], v[244:247]
  v_cvt_pk_bf16_f32 v233, v42, v43
  v_cvt_pk_bf16_f32 v234, v44, v45
  v_mfma_f32_16x16x32_bf16 v[212:215], a[48:51], a[116:119], v[212:215]
  v_cvt_pk_bf16_f32 v235, v46, v47
  v_cvt_pk_bf16_f32 v204, v204, v205
  v_mfma_f32_16x16x32_bf16 v[244:247], a[52:55], a[116:119], v[244:247]
  v_cvt_pk_bf16_f32 v205, v206, v207
  v_cvt_pk_bf16_f32 v206, v236, v237
  v_mfma_f32_16x16x32_bf16 a[148:151], a[24:27], a[84:87], a[148:151]
  v_cvt_pk_bf16_f32 v207, v238, v239
  v_accvgpr_read_b32 v24, a140
  v_mfma_f32_16x16x32_bf16 a[180:183], a[28:31], a[84:87], a[180:183]
  buffer_load_dwordx4 v11, s[20:23], s28 offen offset:3072 lds
  v_accvgpr_read_b32 v25, a141
  v_mfma_f32_16x16x32_bf16 a[148:151], a[56:59], a[116:119], a[148:151]
  s_bfe_u32 s56, 0x302010e, s55
  s_add_u32 s54, s54, s56
  s_add_u32 s55, s55, 8
  v_mfma_f32_16x16x32_bf16 a[180:183], a[60:63], a[116:119], a[180:183]
  s_and_b32 s55, s55, 0x8001f
  s_and_b32 s54, s54, 15
  s_lshl_b32 s28, s54, 19
  v_mfma_f32_16x16x32_bf16 v[216:219], a[16:19], a[88:91], v[216:219]
  s_add_u32 m0, s88, -32768
  v_accvgpr_read_b32 v26, a142
  v_accvgpr_read_b32 v27, a143
  v_mfma_f32_16x16x32_bf16 v[248:251], a[20:23], a[88:91], v[248:251]
  v_accvgpr_read_b32 v28, a172
  v_accvgpr_read_b32 v29, a173
  v_mfma_f32_16x16x32_bf16 v[216:219], a[48:51], a[120:123], v[216:219]
  v_accvgpr_read_b32 v30, a174
  v_accvgpr_read_b32 v31, a175
  v_mfma_f32_16x16x32_bf16 v[248:251], a[52:55], a[120:123], v[248:251]
  buffer_load_dwordx4 v4, s[8:11], s26 offen offset:0 lds
  v_cvt_pk_bf16_f32 v236, v24, v25
  v_mfma_f32_16x16x32_bf16 a[152:155], a[24:27], a[88:91], a[152:155]
  v_cvt_pk_bf16_f32 v237, v26, v27
  v_cvt_pk_bf16_f32 v238, v28, v29
  v_mfma_f32_16x16x32_bf16 a[184:187], a[28:31], a[88:91], a[184:187]
  v_cvt_pk_bf16_f32 v239, v30, v31
  v_mfma_f32_16x16x32_bf16 a[152:155], a[56:59], a[120:123], a[152:155]
  s_add_u32 s60, s63, 12288
  buffer_store_dwordx4 v[144:147], v2, s[16:19], s60 offen offset:0 sc1
  v_cvt_pk_bf16_f32 v208, v208, v209
  v_mfma_f32_16x16x32_bf16 a[184:187], a[60:63], a[120:123], a[184:187]
  v_cvt_pk_bf16_f32 v209, v210, v211
  v_cvt_pk_bf16_f32 v210, v240, v241
  v_mfma_f32_16x16x32_bf16 v[220:223], a[16:19], a[92:95], v[220:223]
  buffer_load_dwordx4 v5, s[8:11], s26 offen offset:1024 lds
  v_cvt_pk_bf16_f32 v211, v242, v243
  v_mfma_f32_16x16x32_bf16 v[252:255], a[20:23], a[92:95], v[252:255]
  v_accvgpr_read_b32 v32, a144
  v_accvgpr_read_b32 v33, a145
  v_mfma_f32_16x16x32_bf16 v[220:223], a[48:51], a[124:127], v[220:223]
  v_accvgpr_read_b32 v34, a146
  v_accvgpr_read_b32 v35, a147
  v_mfma_f32_16x16x32_bf16 v[252:255], a[52:55], a[124:127], v[252:255]
  v_accvgpr_read_b32 v36, a176
  v_accvgpr_read_b32 v37, a177
  v_mfma_f32_16x16x32_bf16 a[156:159], a[24:27], a[92:95], a[156:159]
  v_accvgpr_read_b32 v38, a178
  v_accvgpr_read_b32 v39, a179
  v_mfma_f32_16x16x32_bf16 a[188:191], a[28:31], a[92:95], a[188:191]
  v_cvt_pk_bf16_f32 v240, v32, v33
  v_cvt_pk_bf16_f32 v241, v34, v35
  v_mfma_f32_16x16x32_bf16 a[156:159], a[56:59], a[124:127], a[156:159]
  buffer_load_dwordx4 v6, s[8:11], s26 offen offset:2048 lds
  v_cvt_pk_bf16_f32 v242, v36, v37
  v_mfma_f32_16x16x32_bf16 a[188:191], a[60:63], a[124:127], a[188:191]
  v_cvt_pk_bf16_f32 v243, v38, v39
  v_cvt_pk_bf16_f32 v212, v212, v213
  v_mfma_f32_16x16x32_bf16 v[64:67], a[0:3], a[64:67], v[64:67]
  v_cvt_pk_bf16_f32 v213, v214, v215
  v_cvt_pk_bf16_f32 v214, v244, v245
  v_mfma_f32_16x16x32_bf16 v[96:99], a[4:7], a[64:67], v[96:99]
  v_cvt_pk_bf16_f32 v215, v246, v247
  v_mfma_f32_16x16x32_bf16 v[64:67], a[32:35], a[96:99], v[64:67]
  s_add_u32 s60, s63, 12288
  buffer_store_dwordx4 v[148:151], v2, s[16:19], s60 offen offset:1024 sc1
  v_accvgpr_read_b32 v40, a148
  v_mfma_f32_16x16x32_bf16 v[96:99], a[36:39], a[96:99], v[96:99]
  buffer_load_dwordx4 v7, s[8:11], s26 offen offset:3072 lds
  v_accvgpr_read_b32 v41, a149
  v_mfma_f32_16x16x32_bf16 v[68:71], a[0:3], a[68:71], v[68:71]
  s_add_u32 m0, s88, -28672
  v_accvgpr_read_b32 v42, a150
  v_accvgpr_read_b32 v43, a151
  v_mfma_f32_16x16x32_bf16 v[100:103], a[4:7], a[68:71], v[100:103]
  v_accvgpr_read_b32 v44, a180
  v_accvgpr_read_b32 v45, a181
  v_mfma_f32_16x16x32_bf16 v[68:71], a[32:35], a[100:103], v[68:71]
  v_accvgpr_read_b32 v46, a182
  v_accvgpr_read_b32 v47, a183
  v_mfma_f32_16x16x32_bf16 v[100:103], a[36:39], a[100:103], v[100:103]
  v_cvt_pk_bf16_f32 v244, v40, v41
  v_cvt_pk_bf16_f32 v245, v42, v43
  v_mfma_f32_16x16x32_bf16 v[72:75], a[0:3], a[72:75], v[72:75]
  v_cvt_pk_bf16_f32 v246, v44, v45
  v_cvt_pk_bf16_f32 v247, v46, v47
  v_mfma_f32_16x16x32_bf16 v[104:107], a[4:7], a[72:75], v[104:107]
  buffer_load_dwordx4 v4, s[8:11], s27 offen offset:0 lds
  v_cvt_pk_bf16_f32 v216, v216, v217
  v_mfma_f32_16x16x32_bf16 v[72:75], a[32:35], a[104:107], v[72:75]
  v_cvt_pk_bf16_f32 v217, v218, v219
  v_cvt_pk_bf16_f32 v218, v248, v249
  v_mfma_f32_16x16x32_bf16 v[104:107], a[36:39], a[104:107], v[104:107]
  v_cvt_pk_bf16_f32 v219, v250, v251
  v_accvgpr_read_b32 v24, a152
  v_mfma_f32_16x16x32_bf16 v[76:79], a[0:3], a[76:79], v[76:79]
  v_accvgpr_read_b32 v25, a153
  v_accvgpr_read_b32 v26, a154
  v_mfma_f32_16x16x32_bf16 v[108:111], a[4:7], a[76:79], v[108:111]
  v_accvgpr_read_b32 v27, a155
  v_accvgpr_read_b32 v28, a184
  v_mfma_f32_16x16x32_bf16 v[76:79], a[32:35], a[108:111], v[76:79]
  buffer_load_dwordx4 v5, s[8:11], s27 offen offset:1024 lds
  v_accvgpr_read_b32 v29, a185
  v_mfma_f32_16x16x32_bf16 v[108:111], a[36:39], a[108:111], v[108:111]
  v_accvgpr_read_b32 v30, a186
  v_accvgpr_read_b32 v31, a187
  v_mfma_f32_16x16x32_bf16 v[80:83], a[0:3], a[80:83], v[80:83]
  v_cvt_pk_bf16_f32 v248, v24, v25
  v_cvt_pk_bf16_f32 v249, v26, v27
  v_mfma_f32_16x16x32_bf16 v[112:115], a[4:7], a[80:83], v[112:115]
  v_cvt_pk_bf16_f32 v250, v28, v29
  v_cvt_pk_bf16_f32 v251, v30, v31
  v_mfma_f32_16x16x32_bf16 v[80:83], a[32:35], a[112:115], v[80:83]
  v_cvt_pk_bf16_f32 v220, v220, v221
  v_cvt_pk_bf16_f32 v221, v222, v223
  v_mfma_f32_16x16x32_bf16 v[112:115], a[36:39], a[112:115], v[112:115]
  v_cvt_pk_bf16_f32 v222, v252, v253
  v_cvt_pk_bf16_f32 v223, v254, v255
  v_mfma_f32_16x16x32_bf16 v[84:87], a[0:3], a[84:87], v[84:87]
  buffer_load_dwordx4 v6, s[8:11], s27 offen offset:2048 lds
  v_mfma_f32_16x16x32_bf16 v[116:119], a[4:7], a[84:87], v[116:119]
  s_add_u32 s60, s63, 12288
  buffer_store_dwordx4 v[152:155], v2, s[16:19], s60 offen offset:2048 sc1
  v_accvgpr_read_b32 v32, a156
  v_mfma_f32_16x16x32_bf16 v[84:87], a[32:35], a[116:119], v[84:87]
  v_accvgpr_read_b32 v33, a157
  v_accvgpr_read_b32 v34, a158
  v_mfma_f32_16x16x32_bf16 v[116:119], a[36:39], a[116:119], v[116:119]
  v_accvgpr_read_b32 v35, a159
  v_accvgpr_read_b32 v36, a188
  v_mfma_f32_16x16x32_bf16 v[88:91], a[0:3], a[88:91], v[88:91]
  v_accvgpr_read_b32 v37, a189
  v_accvgpr_read_b32 v38, a190
  v_mfma_f32_16x16x32_bf16 v[120:123], a[4:7], a[88:91], v[120:123]
  buffer_load_dwordx4 v7, s[8:11], s27 offen offset:3072 lds
  v_accvgpr_read_b32 v39, a191
  v_mfma_f32_16x16x32_bf16 v[88:91], a[32:35], a[120:123], v[88:91]
  s_bfe_u32 s29, 0x302010e, s53
  s_add_u32 s52, s52, s29
  s_add_u32 s53, s53, 8
  v_mfma_f32_16x16x32_bf16 v[120:123], a[36:39], a[120:123], v[120:123]
  s_and_b32 s53, s53, 0x8001f
  s_and_b32 s52, s52, 15
  s_lshl_b32 s29, s52, 7
  v_mfma_f32_16x16x32_bf16 v[92:95], a[0:3], a[92:95], v[92:95]
  s_or_b32 s26, s30, s29
  s_or_b32 s27, s31, s29
  v_cvt_pk_bf16_f32 v252, v32, v33
  v_mfma_f32_16x16x32_bf16 v[124:127], a[4:7], a[92:95], v[124:127]
  v_cvt_pk_bf16_f32 v253, v34, v35
  v_cvt_pk_bf16_f32 v254, v36, v37
  v_mfma_f32_16x16x32_bf16 v[92:95], a[32:35], a[124:127], v[92:95]
  v_cvt_pk_bf16_f32 v255, v38, v39
  v_cvt_pk_bf16_f32 v160, v64, v65
  v_mfma_f32_16x16x32_bf16 v[124:127], a[36:39], a[124:127], v[124:127]
  v_cvt_pk_bf16_f32 v161, v66, v67
  v_cvt_pk_bf16_f32 v162, v96, v97
  v_cvt_pk_bf16_f32 v163, v98, v99
  v_cvt_pk_bf16_f32 v164, v68, v69
  v_cvt_pk_bf16_f32 v165, v70, v71
  v_cvt_pk_bf16_f32 v166, v100, v101
  v_cvt_pk_bf16_f32 v167, v102, v103
  s_add_u32 s60, s63, 12288
  buffer_store_dwordx4 v[156:159], v2, s[16:19], s60 offen offset:3072 sc1
  v_cvt_pk_bf16_f32 v168, v72, v73
  v_cvt_pk_bf16_f32 v169, v74, v75
  v_cvt_pk_bf16_f32 v170, v104, v105
  v_cvt_pk_bf16_f32 v171, v106, v107
  v_cvt_pk_bf16_f32 v172, v76, v77
  v_cvt_pk_bf16_f32 v173, v78, v79
  v_cvt_pk_bf16_f32 v174, v108, v109
  v_cvt_pk_bf16_f32 v175, v110, v111
  v_cvt_pk_bf16_f32 v176, v80, v81
  v_cvt_pk_bf16_f32 v177, v82, v83
  v_cvt_pk_bf16_f32 v178, v112, v113
  v_cvt_pk_bf16_f32 v179, v114, v115
  v_cvt_pk_bf16_f32 v180, v84, v85
  v_cvt_pk_bf16_f32 v181, v86, v87
  v_cvt_pk_bf16_f32 v182, v116, v117
  v_cvt_pk_bf16_f32 v183, v118, v119
  v_cvt_pk_bf16_f32 v184, v88, v89
  v_cvt_pk_bf16_f32 v185, v90, v91
  v_cvt_pk_bf16_f32 v186, v120, v121
  v_cvt_pk_bf16_f32 v187, v122, v123
  v_cvt_pk_bf16_f32 v188, v92, v93
  v_cvt_pk_bf16_f32 v189, v94, v95
  v_cvt_pk_bf16_f32 v190, v124, v125
  v_cvt_pk_bf16_f32 v191, v126, v127
  s_lshl_b32 s34, s62, 4
  s_add_u32 s34, s34, s61
  s_lshl_b32 s34, s34, 7
  s_branch Lp3
Lp2:
  s_and_b32 s4, s2, 1
  s_lshl_b32 s4, s4, 2
  s_and_b32 s5, s59, 3
  s_add_u32 s32, s4, s5
  s_bfe_u32 s4, s2, 0x20001
  s_lshl_b32 s4, s4, 2
  s_lshr_b32 s5, s59, 2
  s_add_u32 s33, s4, s5
  s_and_b32 s4, s2, 7
  s_lshl_b32 s4, s4, 1
  s_add_u32 s5, s32, s33
  s_and_b32 s49, s5, 3
  s_lshl_b32 s49, s49, 3
  s_or_b32 s49, s49, 0x80000
  s_bfe_u32 s48, 0xf0f02, s49
  s_add_u32 s48, s48, s4
  s_and_b32 s48, s48, 15
  s_lshl_b32 s46, s48, 7
  s_lshl_b32 s36, s3, 13
  s_mul_i32 s41, s3, 6144
  s_add_u32 s41, s41, 104448
  s_mul_i32 s4, s3, 7168
  s_sub_u32 s50, 32768, s4
  v_lshrrev_b32 v240, 3, v1
  v_and_b32 v241, 6, v240
  v_and_b32 v242, 7, v1
  v_xor_b32 v241, v241, v242
  v_lshlrev_b32 v241, 4, v241
  s_lshl_b32 s4, s3, 6
  s_add_u32 s4, s4, 16
  v_add_u32 v242, s4, v240
  v_lshl_add_u32 v242, v242, 11, v241
  v_add_u32 v224, 0, v242
  v_add_u32 v225, 15360, v242
  v_add_u32 v226, 30720, v242
  v_add_u32 v227, 46080, v242
  v_add_u32 v228, 65536, v242
  v_add_u32 v229, 80896, v242
  v_add_u32 v230, 96256, v242
  v_add_u32 v231, 111616, v242
  s_lshl_b32 s4, s3, 14
  s_cmp_eq_u32 s32, 0
  s_cselect_b32 s4, 0x40000000, s4
  v_lshl_add_u32 v242, v240, 11, v241
  v_add_u32 v232, s4, v242
  v_lshrrev_b32 v242, 2, v240
  v_and_b32 v243, 3, v240
  v_lshl_add_u32 v242, v242, 3, v243
  v_mul_u32_u24 v242, 6144, v242
  v_add_u32 v242, v242, v241
  s_lshl_b32 s4, s33, 7
  v_add_u32 v242, s4, v242
  s_mul_i32 s6, s3, 6
  s_add_u32 s7, s6, 0
  s_bfe_u32 s4, s7, 0x10002
  s_lshl_b32 s4, s4, 5
  s_and_b32 s5, s7, 1
  s_lshl_b32 s5, s5, 4
  s_add_u32 s4, s4, s5
  s_bfe_u32 s5, s7, 0x10001
  s_lshl_b32 s5, s5, 2
  s_add_u32 s4, s4, s5
  s_mul_i32 s4, s4, 6144
  s_lshr_b32 s5, s7, 3
  s_lshl_b32 s5, s5, 11
  s_add_u32 s4, s4, s5
  s_add_u32 s4, s4, 2048
  v_add_u32 v233, s4, v242
  s_add_u32 s7, s6, 1
  s_bfe_u32 s4, s7, 0x10002
  s_lshl_b32 s4, s4, 5
  s_and_b32 s5, s7, 1
  s_lshl_b32 s5, s5, 4
  s_add_u32 s4, s4, s5
  s_bfe_u32 s5, s7, 0x10001
  s_lshl_b32 s5, s5, 2
  s_add_u32 s4, s4, s5
  s_mul_i32 s4, s4, 6144
  s_lshr_b32 s5, s7, 3
  s_lshl_b32 s5, s5, 11
  s_add_u32 s4, s4, s5
  s_add_u32 s4, s4, 1024
  v_add_u32 v234, s4, v242
  s_add_u32 s7, s6, 2
  s_bfe_u32 s4, s7, 0x10002
  s_lshl_b32 s4, s4, 5
  s_and_b32 s5, s7, 1
  s_lshl_b32 s5, s5, 4
  s_add_u32 s4, s4, s5
  s_bfe_u32 s5, s7, 0x10001
  s_lshl_b32 s5, s5, 2
  s_add_u32 s4, s4, s5
  s_mul_i32 s4, s4, 6144
  s_lshr_b32 s5, s7, 3
  s_lshl_b32 s5, s5, 11
  s_add_u32 s4, s4, s5
  s_add_u32 s4, s4, 0
  v_add_u32 v235, s4, v242
  s_add_u32 s7, s6, 3
  s_bfe_u32 s4, s7, 0x10002
  s_lshl_b32 s4, s4, 5
  s_and_b32 s5, s7, 1
  s_lshl_b32 s5, s5, 4
  s_add_u32 s4, s4, s5
  s_bfe_u32 s5, s7, 0x10001
  s_lshl_b32 s5, s5, 2
  s_add_u32 s4, s4, s5
  s_mul_i32 s4, s4, 6144
  s_lshr_b32 s5, s7, 3
  s_lshl_b32 s5, s5, 11
  s_add_u32 s4, s4, s5
  s_add_u32 s4, s4, 2048
  v_add_u32 v236, s4, v242
  s_add_u32 s7, s6, 4
  s_bfe_u32 s4, s7, 0x10002
  s_lshl_b32 s4, s4, 5
  s_and_b32 s5, s7, 1
  s_lshl_b32 s5, s5, 4
  s_add_u32 s4, s4, s5
  s_bfe_u32 s5, s7, 0x10001
  s_lshl_b32 s5, s5, 2
  s_add_u32 s4, s4, s5
  s_mul_i32 s4, s4, 6144
  s_lshr_b32 s5, s7, 3
  s_lshl_b32 s5, s5, 11
  s_add_u32 s4, s4, s5
  s_add_u32 s4, s4, 1024
  v_add_u32 v237, s4, v242
  s_add_u32 s7, s6, 5
  s_bfe_u32 s4, s7, 0x10002
  s_lshl_b32 s4, s4, 5
  s_and_b32 s5, s7, 1
  s_lshl_b32 s5, s5, 4
  s_add_u32 s4, s4, s5
  s_bfe_u32 s5, s7, 0x10001
  s_lshl_b32 s5, s5, 2
  s_add_u32 s4, s4, s5
  s_mul_i32 s4, s4, 6144
  s_lshr_b32 s5, s7, 3
  s_lshl_b32 s5, s5, 11
  s_add_u32 s4, s4, s5
  s_add_u32 s4, s4, 0
  v_add_u32 v238, s4, v242
  s_waitcnt lgkmcnt(0)
  s_lshl_b32 s10, s32, 19
  s_add_u32 s8, s76, s10
  s_addc_u32 s9, s77, 0
  s_sub_u32 s8, s8, 32768
  s_subb_u32 s9, s9, 0
  s_mov_b32 s10, 557056
  s_mov_b32 s11, 0x00020000
  s_sub_u32 s12, s78, 2048
  s_subb_u32 s13, s79, 0
  s_mov_b32 s14, 6293504
  s_mov_b32 s15, 0x00020000
  s_add_u32 s96, s86, 125829120
  s_addc_u32 s97, s87, 0
  s_mov_b32 s98, 262144
  s_mov_b32 s99, 0x00020000
  s_cmp_ge_u32 s3, 2
  s_cbranch_scc1 Lp2_r1
  s_and_b32 s4, s2, 7
  s_lshl_b32 s4, s4, 4
  s_add_u32 s4, s4, s59
  s_lshl_b32 s4, s4, 2
  s_add_u32 s4, s4, s3
  s_lshl_b32 s51, s4, 13
  s_add_u32 m0, s36, s50
  s_nop 0
  buffer_load_dwordx4 v232, s[8:11], s46 offen offset:0 lds
  s_mov_b32 m0, s36
  s_nop 0
  buffer_load_dwordx4 v224, s[8:11], s46 offen offset:0 lds
  buffer_load_dwordx4 v225, s[8:11], s46 offen offset:1024 lds
  buffer_load_dwordx4 v226, s[8:11], s46 offen offset:2048 lds
  buffer_load_dwordx4 v227, s[8:11], s46 offen offset:3072 lds
  s_add_u32 m0, s36, 4096
  s_nop 0
  buffer_load_dwordx4 v228, s[8:11], s46 offen offset:0 lds
  buffer_load_dwordx4 v229, s[8:11], s46 offen offset:1024 lds
  buffer_load_dwordx4 v230, s[8:11], s46 offen offset:2048 lds
  buffer_load_dwordx4 v231, s[8:11], s46 offen offset:3072 lds
  s_mul_i32 s47, s48, 393216
  s_bfe_u32 s34, 0x302010e, s49
  s_add_u32 s48, s48, s34
  s_add_u32 s49, s49, 8
  s_and_b32 s49, s49, 0x8001f
  s_and_b32 s48, s48, 15
  s_lshl_b32 s46, s48, 7
  s_mov_b32 m0, s41
  s_nop 0
  buffer_load_dwordx4 v233, s[12:15], s47 offen offset:0 lds
  buffer_load_dwordx4 v234, s[12:15], s47 offen offset:1024 lds
  buffer_load_dwordx4 v235, s[12:15], s47 offen offset:2048 lds
  s_add_u32 m0, s41, 3072
  s_nop 0
  buffer_load_dwordx4 v236, s[12:15], s47 offen offset:0 lds
  buffer_load_dwordx4 v237, s[12:15], s47 offen offset:1024 lds
  buffer_load_dwordx4 v238, s[12:15], s47 offen offset:2048 lds
  s_lshr_b32 s4, s3, 1
  s_lshl_b32 s4, s4, 14
  v_and_b32 v240, 15, v1
  v_lshlrev_b32 v240, 7, v240
  v_lshrrev_b32 v241, 4, v1
  v_and_b32 v242, 6, v1
  v_xor_b32 v241, v241, v242
  v_lshl_add_u32 v240, v241, 4, v240
  v_add_u32 v16, s4, v240
  v_xor_b32 v17, 64, v16
  v_and_b32 v240, 15, v1
  v_lshlrev_b32 v240, 7, v240
  v_lshrrev_b32 v241, 4, v1
  v_and_b32 v242, 6, v1
  v_xor_b32 v241, v241, v242
  v_lshl_add_u32 v240, v241, 4, v240
  v_add_u32 v18, 32768, v240
  v_xor_b32 v19, 64, v18
  v_lshrrev_b32 v240, 2, v1
  v_and_b32 v241, 6, v240
  v_lshlrev_b32 v240, 7, v240
  v_and_b32 v242, 1, v1
  v_lshl_add_u32 v240, v242, 3, v240
  v_add_u32 v240, 104448, v240
  v_bfe_u32 v242, v1, 1, 1
  v_xor_b32 v241, v241, v242
  v_xor_b32 v242, 0, v241
  v_lshl_add_u32 v20, v242, 4, v240
  v_xor_b32 v242, 2, v241
  v_lshl_add_u32 v21, v242, 4, v240
  s_and_b32 s4, s3, 1
  s_lshl_b32 s4, s4, 6
  v_xor_b32 v20, s4, v20
  s_add_u32 m0, s36, s50
  s_add_u32 m0, m0, 34816
  s_nop 0
  buffer_load_dwordx4 v232, s[8:11], s46 offen offset:0 lds
  v_xor_b32 v21, s4, v21
  s_and_b32 s24, s2, 7
  s_lshr_b32 s4, s2, 6
  s_lshl_b32 s4, s4, 3
  s_add_u32 s24, s24, s4
  s_lshr_b32 s4, s2, 3
  s_and_b32 s25, s4, 6
  s_xor_b32 s4, s4, s2
  s_bfe_u32 s4, s4, 0x10003
  s_add_u32 s25, s25, s4
  v_accvgpr_write_b32 a244, -1
  v_accvgpr_write_b32 a245, -1
  v_accvgpr_write_b32 a246, -1
  v_accvgpr_write_b32 a247, -1
  v_lshrrev_b32 v24, 3, v1
  v_and_b32 v25, 6, v24
  v_and_b32 v26, 7, v1
  s_add_u32 m0, s36, 34816
  s_nop 0
  buffer_load_dwordx4 v224, s[8:11], s46 offen offset:0 lds
  v_xor_b32 v25, v25, v26
  v_lshlrev_b32 v25, 4, v25
  s_and_b32 s4, s3, 1
  s_lshl_b32 s4, s4, 16
  s_lshr_b32 s5, s3, 1
  s_lshl_b32 s5, s5, 7
  s_add_u32 s4, s4, s5
  v_lshl_add_u32 v24, v24, 11, v25
  v_add_u32 v24, s4, v24
  v_add_u32 v25, 0, v24
  v_accvgpr_write_b32 a212, v25
  v_add_u32 v25, 15360, v24
  v_accvgpr_write_b32 a213, v25
  buffer_load_dwordx4 v225, s[8:11], s46 offen offset:1024 lds
  v_add_u32 v25, 30720, v24
  v_accvgpr_write_b32 a214, v25
  v_add_u32 v25, 46080, v24
  v_accvgpr_write_b32 a215, v25
  v_accvgpr_write_b32 a236, 0
  v_mov_b32 v27, 0x3f803f80
  v_accvgpr_write_b32 a208, v27
  buffer_load_dwordx4 v226, s[8:11], s46 offen offset:2048 lds
  v_accvgpr_write_b32 a237, 0
  v_accvgpr_write_b32 a209, v27
  v_accvgpr_write_b32 a238, 0
  v_accvgpr_write_b32 a210, v27
  v_accvgpr_write_b32 a239, 0
  v_accvgpr_write_b32 a211, v27
  v_lshrrev_b32 v24, 3, v1
  buffer_load_dwordx4 v227, s[8:11], s46 offen offset:3072 lds
  v_and_b32 v25, 6, v24
  v_and_b32 v26, 7, v1
  v_xor_b32 v25, v25, v26
  v_lshlrev_b32 v25, 4, v25
  v_lshlrev_b32 v26, 2, v24
  v_add_u32 v26, s3, v26
  v_lshl_add_u32 v26, v26, 11, v25
  v_add_u32 v27, 0, v26
  s_add_u32 m0, s36, 38912
  s_nop 0
  buffer_load_dwordx4 v228, s[8:11], s46 offen offset:0 lds
  v_accvgpr_write_b32 a222, v27
  v_add_u32 v27, 64512, v26
  v_accvgpr_write_b32 a223, v27
  v_add_u32 v27, 129024, v26
  v_accvgpr_write_b32 a224, v27
  v_add_u32 v27, 193536, v26
  v_accvgpr_write_b32 a225, v27
  buffer_load_dwordx4 v229, s[8:11], s46 offen offset:1024 lds
  v_lshrrev_b32 v26, 2, v24
  v_and_b32 v27, 3, v24
  v_lshl_add_u32 v26, v26, 3, v27
  s_and_b32 s4, s3, 1
  s_lshl_b32 s4, s4, 18
  s_lshr_b32 s5, s3, 1
  s_lshl_b32 s5, s5, 7
  s_add_u32 s4, s4, s5
  s_lshl_b32 s5, s24, 8
  s_add_u32 s4, s4, s5
  v_lshl_add_u32 v26, v26, 13, v25
  v_add_u32 v26, s4, v26
  v_add_u32 v27, 0, v26
  v_accvgpr_write_b32 a226, v27
  v_add_u32 v27, 130048, v26
  buffer_load_dwordx4 v230, s[8:11], s46 offen offset:2048 lds
  v_accvgpr_write_b32 a227, v27
  v_add_u32 v27, 30720, v26
  v_accvgpr_write_b32 a228, v27
  v_add_u32 v27, 160768, v26
  v_accvgpr_write_b32 a229, v27
  s_lshl_b32 s4, s3, 13
  s_add_u32 s4, s4, 98304
  v_and_b32 v24, 15, v1
  v_lshlrev_b32 v24, 7, v24
  v_lshrrev_b32 v25, 4, v1
  buffer_load_dwordx4 v231, s[8:11], s46 offen offset:3072 lds
  v_and_b32 v26, 6, v1
  v_xor_b32 v25, v25, v26
  v_lshl_add_u32 v24, v25, 4, v24
  v_add_u32 v28, s4, v24
  v_xor_b32 v29, 64, v28
  v_lshrrev_b32 v24, 2, v1
  v_and_b32 v25, 6, v24
  s_mul_i32 s47, s48, 393216
  s_bfe_u32 s34, 0x302010e, s49
  s_add_u32 s48, s48, s34
  s_add_u32 s49, s49, 8
  s_and_b32 s49, s49, 0x8001f
  s_and_b32 s48, s48, 15
  s_lshl_b32 s46, s48, 7
  s_add_u32 m0, s41, 24576
  s_nop 0
  buffer_load_dwordx4 v233, s[12:15], s47 offen offset:0 lds
  v_lshlrev_b32 v24, 7, v24
  v_and_b32 v26, 1, v1
  v_lshl_add_u32 v24, v26, 3, v24
  v_add_u32 v24, 0, v24
  v_bfe_u32 v26, v1, 1, 1
  v_xor_b32 v25, v25, v26
  v_xor_b32 v26, 0, v25
  v_lshl_add_u32 v30, v26, 4, v24
  buffer_load_dwordx4 v234, s[12:15], s47 offen offset:1024 lds
  v_xor_b32 v26, 2, v25
  v_lshl_add_u32 v31, v26, 4, v24
  v_xor_b32 v26, 4, v25
  v_lshl_add_u32 v32, v26, 4, v24
  v_xor_b32 v26, 6, v25
  v_lshl_add_u32 v33, v26, 4, v24
  v_accvgpr_write_b32 a230, v28
  buffer_load_dwordx4 v235, s[12:15], s47 offen offset:2048 lds
  v_accvgpr_write_b32 a231, v29
  v_accvgpr_write_b32 a232, v30
  v_accvgpr_write_b32 a233, v31
  v_accvgpr_write_b32 a234, v32
  v_accvgpr_write_b32 a235, v33
  v_and_b32 v253, 15, v1
  v_lshrrev_b32 v254, 4, v1
  s_add_u32 m0, s41, 27648
  s_nop 0
  buffer_load_dwordx4 v236, s[12:15], s47 offen offset:0 lds
  v_lshlrev_b32 v254, 2, v254
  v_sub_u32 v253, v253, v254
  v_mov_b32 v254, 0xf149f2ca
  s_lshr_b32 s4, s3, 1
  s_or_b32 s4, s4, s32
  s_cselect_b64 s[6:7], 0, -1
  v_subrev_u32 v255, 0, v253
  v_and_b32 v252, 0x80000001, v255
  v_cmp_ne_u32 vcc, 0, v252
  s_nop 1
  v_cndmask_b32 v244, 0, v254, vcc
  v_add_u32 v255, 1, v255
  v_and_b32 v252, 0x80000001, v255
  v_cmp_ne_u32 vcc, 0x80000001, v252
  s_nop 1
  v_cndmask_b32 v240, 0, v254, vcc
  v_cndmask_b32 v248, v240, v254, s[6:7]
  buffer_load_dwordx4 v237, s[12:15], s47 offen offset:1024 lds
  v_subrev_u32 v255, 1, v253
  v_and_b32 v252, 0x80000001, v255
  v_cmp_ne_u32 vcc, 0, v252
  s_nop 1
  v_cndmask_b32 v245, 0, v254, vcc
  v_add_u32 v255, 1, v255
  v_and_b32 v252, 0x80000001, v255
  v_cmp_ne_u32 vcc, 0x80000001, v252
  s_nop 1
  v_cndmask_b32 v241, 0, v254, vcc
  v_cndmask_b32 v249, v241, v254, s[6:7]
  v_subrev_u32 v255, 2, v253
  v_and_b32 v252, 0x80000001, v255
  v_cmp_ne_u32 vcc, 0, v252
  s_nop 1
  v_cndmask_b32 v246, 0, v254, vcc
  buffer_load_dwordx4 v238, s[12:15], s47 offen offset:2048 lds
  v_add_u32 v255, 1, v255
  v_and_b32 v252, 0x80000001, v255
  v_cmp_ne_u32 vcc, 0x80000001, v252
  s_nop 1
  v_cndmask_b32 v242, 0, v254, vcc
  v_cndmask_b32 v250, v242, v254, s[6:7]
  v_subrev_u32 v255, 3, v253
  v_and_b32 v252, 0x80000001, v255
  v_cmp_ne_u32 vcc, 0, v252
  s_nop 1
  v_cndmask_b32 v247, 0, v254, vcc
  v_add_u32 v255, 1, v255
  v_and_b32 v252, 0x80000001, v255
  v_cmp_ne_u32 vcc, 0x80000001, v252
  s_nop 1
  v_cndmask_b32 v243, 0, v254, vcc
  v_cndmask_b32 v251, v243, v254, s[6:7]
  s_and_b32 s4, s3, 1
  s_lshl_b32 s4, s4, 12
  s_add_u32 s4, s4, 49152
  v_add_u32 v252, s4, v2
  s_lshr_b32 s5, s3, 1
  s_lshl_b32 s5, s5, 11
  v_add_u32 v253, s5, v252
  s_add_u32 s16, s86, 83886080
  s_addc_u32 s17, s87, 0
  s_mov_b32 s18, 4194304
  s_mov_b32 s19, 0x00020000
  s_lshl_b32 s57, s32, 19
  s_lshl_b32 s5, s5, 7
  s_add_u32 s57, s57, s5
  s_lshl_b32 s4, s33, 14
  s_add_u32 s57, s57, s4
  s_and_b32 s4, s3, 1
  s_lshl_b32 s4, s4, 13
  s_add_u32 s57, s57, s4
  s_add_u32 s58, s57, 4096
  s_mov_b32 s37, 0
  s_mov_b32 s39, 4294897664
  s_mov_b32 s40, 34816
  s_mov_b32 s42, 0
  s_mov_b32 s44, 4294942720
  s_mov_b32 s45, 24576
  s_mov_b32 s43, s44
  s_mov_b32 s52, s72
  s_mov_b32 s53, s73
  s_mov_b32 s54, 4194304
  s_mov_b32 s55, 0x00020000
  s_lshl_b32 s1, s51, 1
  s_mov_b32 s56, s51
  s_mov_b32 s0, 0
  s_waitcnt vmcnt(15)
  s_barrier
  ds_read_b128 a[0:3], v16 offset:0
  ds_read_b64_tr_b16 a[72:73], v20 offset:0
  ds_read_b64_tr_b16 a[74:75], v20 offset:2048
  ds_read_b128 a[4:7], v16 offset:2048
  ds_read_b128 a[8:11], v16 offset:4096
  ds_read_b128 a[12:15], v16 offset:6144
  ds_read_b128 a[16:19], v16 offset:8192
  ds_read_b128 a[20:23], v16 offset:10240
  ds_read_b128 a[24:27], v16 offset:12288
  ds_read_b128 a[28:31], v16 offset:14336
  ds_read_b64_tr_b16 a[76:77], v21 offset:0
  ds_read_b64_tr_b16 a[78:79], v21 offset:2048
  ds_read_b64_tr_b16 a[80:81], v20 offset:8192
  ds_read_b64_tr_b16 a[82:83], v20 offset:10240
  ds_read_b128 a[32:35], v18 offset:0
  ds_read_b64_tr_b16 a[84:85], v21 offset:8192
  ds_read_b64_tr_b16 a[86:87], v21 offset:10240
  ds_read_b64_tr_b16 a[88:89], v20 offset:16384
  ds_read_b64_tr_b16 a[90:91], v20 offset:18432
  ds_read_b64_tr_b16 a[92:93], v21 offset:16384
  ds_read_b64_tr_b16 a[94:95], v21 offset:18432
  s_waitcnt lgkmcnt(0)
  v_mfma_f32_16x16x32_bf16 v[24:27], a[72:75], a[0:3], 0
  s_add_u32 m0, s36, s50
  s_add_u32 m0, m0, 69632
  ds_read_b128 a[36:39], v17 offset:0
  v_mfma_f32_16x16x32_bf16 v[28:31], a[72:75], a[4:7], 0
  buffer_load_dwordx4 v232, s[8:11], s46 offen offset:0 lds
  ds_read_b64_tr_b16 a[96:97], v20 offset:4096
  v_mfma_f32_16x16x32_bf16 v[32:35], a[72:75], a[8:11], 0
  s_add_u32 m0, s36, 69632
  v_mfma_f32_16x16x32_bf16 v[36:39], a[72:75], a[12:15], 0
  ds_read_b64_tr_b16 a[98:99], v20 offset:6144
  v_mfma_f32_16x16x32_bf16 v[40:43], a[72:75], a[16:19], 0
  buffer_load_dwordx4 v224, s[8:11], s46 offen offset:0 lds
  v_mfma_f32_16x16x32_bf16 v[44:47], a[72:75], a[20:23], 0
  ds_read_b128 a[40:43], v17 offset:2048
  v_mfma_f32_16x16x32_bf16 v[48:51], a[72:75], a[24:27], 0
  v_mfma_f32_16x16x32_bf16 v[52:55], a[72:75], a[28:31], 0
  ds_read_b128 a[44:47], v17 offset:4096
  v_mfma_f32_16x16x32_bf16 v[56:59], a[76:79], a[0:3], 0
  v_mfma_f32_16x16x32_bf16 v[60:63], a[76:79], a[4:7], 0
  buffer_load_dwordx4 v225, s[8:11], s46 offen offset:1024 lds
  ds_read_b128 a[48:51], v17 offset:6144
  v_mfma_f32_16x16x32_bf16 v[64:67], a[76:79], a[8:11], 0
  v_mfma_f32_16x16x32_bf16 v[68:71], a[76:79], a[12:15], 0
  ds_read_b128 a[52:55], v17 offset:8192
  v_mfma_f32_16x16x32_bf16 v[72:75], a[76:79], a[16:19], 0
  v_mfma_f32_16x16x32_bf16 v[76:79], a[76:79], a[20:23], 0
  ds_read_b128 a[56:59], v17 offset:10240
  v_mfma_f32_16x16x32_bf16 v[80:83], a[76:79], a[24:27], 0
  buffer_load_dwordx4 v226, s[8:11], s46 offen offset:2048 lds
  v_mfma_f32_16x16x32_bf16 v[84:87], a[76:79], a[28:31], 0
  ds_read_b128 a[60:63], v17 offset:12288
  v_mfma_f32_16x16x32_bf16 v[88:91], a[80:83], a[0:3], 0
  v_mfma_f32_16x16x32_bf16 v[92:95], a[80:83], a[4:7], 0
  ds_read_b128 a[64:67], v17 offset:14336
  v_mfma_f32_16x16x32_bf16 v[96:99], a[80:83], a[8:11], 0
  v_mfma_f32_16x16x32_bf16 v[100:103], a[80:83], a[12:15], 0
  buffer_load_dwordx4 v227, s[8:11], s46 offen offset:3072 lds
  ds_read_b64_tr_b16 a[100:101], v21 offset:4096
  v_mfma_f32_16x16x32_bf16 v[104:107], a[80:83], a[16:19], 0
  s_add_u32 m0, s36, 73728
  ds_read_b64_tr_b16 a[102:103], v21 offset:6144
  v_mfma_f32_16x16x32_bf16 v[108:111], a[80:83], a[20:23], 0
  v_mfma_f32_16x16x32_bf16 v[112:115], a[80:83], a[24:27], 0
  ds_read_b64_tr_b16 a[104:105], v20 offset:12288
  v_mfma_f32_16x16x32_bf16 v[116:119], a[80:83], a[28:31], 0
  buffer_load_dwordx4 v228, s[8:11], s46 offen offset:0 lds
  v_mfma_f32_16x16x32_bf16 v[216:219], a[80:83], a[32:35], 0
  ds_read_b64_tr_b16 a[106:107], v20 offset:14336
  v_mfma_f32_16x16x32_bf16 v[120:123], a[84:87], a[0:3], 0
  v_mfma_f32_16x16x32_bf16 v[124:127], a[84:87], a[4:7], 0
  ds_read_b128 a[68:71], v19 offset:0
  v_mfma_f32_16x16x32_bf16 v[128:131], a[84:87], a[8:11], 0
  v_mfma_f32_16x16x32_bf16 v[132:135], a[84:87], a[12:15], 0
  buffer_load_dwordx4 v229, s[8:11], s46 offen offset:1024 lds
  ds_read_b64_tr_b16 a[108:109], v21 offset:12288
  v_mfma_f32_16x16x32_bf16 v[136:139], a[84:87], a[16:19], 0
  v_mfma_f32_16x16x32_bf16 v[140:143], a[84:87], a[20:23], 0
  ds_read_b64_tr_b16 a[110:111], v21 offset:14336
  v_mfma_f32_16x16x32_bf16 v[144:147], a[84:87], a[24:27], 0
  v_mfma_f32_16x16x32_bf16 v[148:151], a[84:87], a[28:31], 0
  ds_read_b64_tr_b16 a[112:113], v20 offset:20480
  v_mfma_f32_16x16x32_bf16 v[220:223], a[84:87], a[32:35], 0
  buffer_load_dwordx4 v230, s[8:11], s46 offen offset:2048 lds
  v_mfma_f32_16x16x32_bf16 v[152:155], a[0:3], a[88:91], 0
  ds_read_b64_tr_b16 a[114:115], v20 offset:22528
  v_mfma_f32_16x16x32_bf16 v[156:159], a[4:7], a[88:91], 0
  v_mfma_f32_16x16x32_bf16 v[160:163], a[8:11], a[88:91], 0
  ds_read_b64_tr_b16 a[116:117], v21 offset:20480
  v_mfma_f32_16x16x32_bf16 v[164:167], a[12:15], a[88:91], 0
  v_mfma_f32_16x16x32_bf16 v[168:171], a[16:19], a[88:91], 0
  buffer_load_dwordx4 v231, s[8:11], s46 offen offset:3072 lds
  ds_read_b64_tr_b16 a[118:119], v21 offset:22528
  v_mfma_f32_16x16x32_bf16 v[172:175], a[20:23], a[88:91], 0
  s_mul_i32 s47, s48, 393216
  s_bfe_u32 s34, 0x302010e, s49
  s_add_u32 s48, s48, s34
  v_mfma_f32_16x16x32_bf16 v[176:179], a[24:27], a[88:91], 0
  s_add_u32 s49, s49, 8
  s_and_b32 s49, s49, 0x8001f
  s_and_b32 s48, s48, 15
  v_mfma_f32_16x16x32_bf16 v[180:183], a[28:31], a[88:91], 0
  s_lshl_b32 s46, s48, 7
  v_mfma_f32_16x16x32_bf16 v[184:187], a[0:3], a[92:95], 0
  s_add_u32 s37, s37, 1
  s_cmp_eq_u32 s37, 3
  s_cselect_b32 s37, 0, s37
  s_cselect_b32 s38, s39, s40
  v_mfma_f32_16x16x32_bf16 v[188:191], a[4:7], a[92:95], 0
  s_sub_u32 s43, 0, s43
  v_mfma_f32_16x16x32_bf16 v[192:195], a[8:11], a[92:95], 0
  v_add_u32 v16, s38, v16
  v_add_u32 v17, s38, v17
  v_mfma_f32_16x16x32_bf16 v[196:199], a[12:15], a[92:95], 0
  v_add_u32 v18, s38, v18
  v_add_u32 v19, s38, v19
  v_mfma_f32_16x16x32_bf16 v[200:203], a[16:19], a[92:95], 0
  v_add_u32 v20, s43, v20
  v_add_u32 v21, s43, v21
  v_mfma_f32_16x16x32_bf16 v[204:207], a[20:23], a[92:95], 0
  v_mfma_f32_16x16x32_bf16 v[208:211], a[24:27], a[92:95], 0
  v_mfma_f32_16x16x32_bf16 v[212:215], a[28:31], a[92:95], 0
  s_mov_b32 s35, 13
  s_waitcnt vmcnt(9) lgkmcnt(0)
  s_barrier
  .p2align 6
Lp2r0_loop:
  v_mfma_f32_16x16x32_bf16 v[24:27], a[96:99], a[36:39], v[24:27]
  buffer_load_dwordx4 a[192:195], v2, s[52:55], s51 offen offset:0
  ds_read_b128 a[0:3], v16 offset:0
  v_mfma_f32_16x16x32_bf16 v[28:31], a[96:99], a[40:43], v[28:31]
  ds_read_b64_tr_b16 a[72:73], v20 offset:0
  v_mfma_f32_16x16x32_bf16 v[32:35], a[96:99], a[44:47], v[32:35]
  v_mfma_f32_16x16x32_bf16 v[36:39], a[96:99], a[48:51], v[36:39]
  ds_read_b64_tr_b16 a[74:75], v20 offset:2048
  v_mfma_f32_16x16x32_bf16 v[40:43], a[96:99], a[52:55], v[40:43]
  buffer_load_dwordx4 a[192:195], v2, s[52:55], s51 offen offset:1024
  v_mfma_f32_16x16x32_bf16 v[44:47], a[96:99], a[56:59], v[44:47]
  ds_read_b128 a[4:7], v16 offset:2048
  v_mfma_f32_16x16x32_bf16 v[48:51], a[96:99], a[60:63], v[48:51]
  v_mfma_f32_16x16x32_bf16 v[52:55], a[96:99], a[64:67], v[52:55]
  ds_read_b128 a[8:11], v16 offset:4096
  v_mfma_f32_16x16x32_bf16 v[56:59], a[100:103], a[36:39], v[56:59]
  v_mfma_f32_16x16x32_bf16 v[60:63], a[100:103], a[40:43], v[60:63]
  buffer_load_dwordx4 a[192:195], v2, s[52:55], s51 offen offset:2048
  ds_read_b128 a[12:15], v16 offset:6144
  v_mfma_f32_16x16x32_bf16 v[64:67], a[100:103], a[44:47], v[64:67]
  v_mfma_f32_16x16x32_bf16 v[68:71], a[100:103], a[48:51], v[68:71]
  ds_read_b128 a[16:19], v16 offset:8192
  v_mfma_f32_16x16x32_bf16 v[72:75], a[100:103], a[52:55], v[72:75]
  v_mfma_f32_16x16x32_bf16 v[76:79], a[100:103], a[56:59], v[76:79]
  ds_read_b128 a[20:23], v16 offset:10240
  v_mfma_f32_16x16x32_bf16 v[80:83], a[100:103], a[60:63], v[80:83]
  buffer_load_dwordx4 a[192:195], v2, s[52:55], s51 offen offset:3072
  v_mfma_f32_16x16x32_bf16 v[84:87], a[100:103], a[64:67], v[84:87]
  s_add_u32 s51, s51, 4096
  s_add_u32 s0, s0, 1
  s_cmp_eq_u32 s0, 2
  s_cselect_b32 s52, s68, s52
  s_cselect_b32 s53, s69, s53
  s_cselect_b32 s51, s1, s51
  s_cselect_b32 s54, 0, s54
  v_mfma_f32_16x16x32_bf16 v[88:91], a[104:107], a[36:39], v[88:91]
  s_cmp_eq_u32 s0, 6
  s_cselect_b32 s52, s64, s52
  s_cselect_b32 s53, s65, s53
  s_cselect_b32 s51, s56, s51
  s_cselect_b32 s54, 0, s54
  v_mfma_f32_16x16x32_bf16 v[92:95], a[104:107], a[40:43], v[92:95]
  s_cmp_eq_u32 s0, 8
  s_cselect_b32 s54, 0, s54
  s_mov_b32 m0, s41
  v_mfma_f32_16x16x32_bf16 v[96:99], a[104:107], a[44:47], v[96:99]
  ds_read_b128 a[24:27], v16 offset:12288
  ds_read_b128 a[28:31], v16 offset:14336
  v_mfma_f32_16x16x32_bf16 v[100:103], a[104:107], a[48:51], v[100:103]
  buffer_load_dwordx4 v233, s[12:15], s47 offen offset:0 lds
  ds_read_b64_tr_b16 a[76:77], v21 offset:0
  v_mfma_f32_16x16x32_bf16 v[104:107], a[104:107], a[52:55], v[104:107]
  ds_read_b64_tr_b16 a[78:79], v21 offset:2048
  v_mfma_f32_16x16x32_bf16 v[108:111], a[104:107], a[56:59], v[108:111]
  v_mfma_f32_16x16x32_bf16 v[112:115], a[104:107], a[60:63], v[112:115]
  ds_read_b64_tr_b16 a[80:81], v20 offset:8192
  v_mfma_f32_16x16x32_bf16 v[116:119], a[104:107], a[64:67], v[116:119]
  v_mfma_f32_16x16x32_bf16 v[216:219], a[104:107], a[68:71], v[216:219]
  buffer_load_dwordx4 v234, s[12:15], s47 offen offset:1024 lds
  ds_read_b64_tr_b16 a[82:83], v20 offset:10240
  v_mfma_f32_16x16x32_bf16 v[120:123], a[108:111], a[36:39], v[120:123]
  v_mfma_f32_16x16x32_bf16 v[124:127], a[108:111], a[40:43], v[124:127]
  ds_read_b128 a[32:35], v18 offset:0
  v_mfma_f32_16x16x32_bf16 v[128:131], a[108:111], a[44:47], v[128:131]
  v_mfma_f32_16x16x32_bf16 v[132:135], a[108:111], a[48:51], v[132:135]
  ds_read_b64_tr_b16 a[84:85], v21 offset:8192
  v_mfma_f32_16x16x32_bf16 v[136:139], a[108:111], a[52:55], v[136:139]
  buffer_load_dwordx4 v235, s[12:15], s47 offen offset:2048 lds
  v_mfma_f32_16x16x32_bf16 v[140:143], a[108:111], a[56:59], v[140:143]
  s_add_u32 m0, s41, 3072
  ds_read_b64_tr_b16 a[86:87], v21 offset:10240
  v_mfma_f32_16x16x32_bf16 v[144:147], a[108:111], a[60:63], v[144:147]
  v_mfma_f32_16x16x32_bf16 v[148:151], a[108:111], a[64:67], v[148:151]
  ds_read_b64_tr_b16 a[88:89], v20 offset:16384
  v_mfma_f32_16x16x32_bf16 v[220:223], a[108:111], a[68:71], v[220:223]
  v_mfma_f32_16x16x32_bf16 v[152:155], a[36:39], a[112:115], v[152:155]
  buffer_load_dwordx4 v236, s[12:15], s47 offen offset:0 lds
  ds_read_b64_tr_b16 a[90:91], v20 offset:18432
  v_mfma_f32_16x16x32_bf16 v[156:159], a[40:43], a[112:115], v[156:159]
  v_mfma_f32_16x16x32_bf16 v[160:163], a[44:47], a[112:115], v[160:163]
  ds_read_b64_tr_b16 a[92:93], v21 offset:16384
  v_mfma_f32_16x16x32_bf16 v[164:167], a[48:51], a[112:115], v[164:167]
  v_mfma_f32_16x16x32_bf16 v[168:171], a[52:55], a[112:115], v[168:171]
  ds_read_b64_tr_b16 a[94:95], v21 offset:18432
  v_mfma_f32_16x16x32_bf16 v[172:175], a[56:59], a[112:115], v[172:175]
  buffer_load_dwordx4 v237, s[12:15], s47 offen offset:1024 lds
  v_mfma_f32_16x16x32_bf16 v[176:179], a[60:63], a[112:115], v[176:179]
  v_mfma_f32_16x16x32_bf16 v[180:183], a[64:67], a[112:115], v[180:183]
  v_mfma_f32_16x16x32_bf16 v[184:187], a[36:39], a[116:119], v[184:187]
  v_mfma_f32_16x16x32_bf16 v[188:191], a[40:43], a[116:119], v[188:191]
  v_mfma_f32_16x16x32_bf16 v[192:195], a[44:47], a[116:119], v[192:195]
  buffer_load_dwordx4 v238, s[12:15], s47 offen offset:2048 lds
  v_mfma_f32_16x16x32_bf16 v[196:199], a[48:51], a[116:119], v[196:199]
  v_mfma_f32_16x16x32_bf16 v[200:203], a[52:55], a[116:119], v[200:203]
  v_mfma_f32_16x16x32_bf16 v[204:207], a[56:59], a[116:119], v[204:207]
  v_mfma_f32_16x16x32_bf16 v[208:211], a[60:63], a[116:119], v[208:211]
  v_mfma_f32_16x16x32_bf16 v[212:215], a[64:67], a[116:119], v[212:215]
  s_waitcnt lgkmcnt(0)
  v_mfma_f32_16x16x32_bf16 v[24:27], a[72:75], a[0:3], v[24:27]
  s_add_u32 m0, s36, s50
  ds_read_b128 a[36:39], v17 offset:0
  v_mfma_f32_16x16x32_bf16 v[28:31], a[72:75], a[4:7], v[28:31]
  buffer_load_dwordx4 v232, s[8:11], s46 offen offset:0 lds
  ds_read_b64_tr_b16 a[96:97], v20 offset:4096
  v_mfma_f32_16x16x32_bf16 v[32:35], a[72:75], a[8:11], v[32:35]
  s_mov_b32 m0, s36
  v_mfma_f32_16x16x32_bf16 v[36:39], a[72:75], a[12:15], v[36:39]
  ds_read_b64_tr_b16 a[98:99], v20 offset:6144
  v_mfma_f32_16x16x32_bf16 v[40:43], a[72:75], a[16:19], v[40:43]
  buffer_load_dwordx4 v224, s[8:11], s46 offen offset:0 lds
  v_mfma_f32_16x16x32_bf16 v[44:47], a[72:75], a[20:23], v[44:47]
  ds_read_b128 a[40:43], v17 offset:2048
  v_mfma_f32_16x16x32_bf16 v[48:51], a[72:75], a[24:27], v[48:51]
  v_mfma_f32_16x16x32_bf16 v[52:55], a[72:75], a[28:31], v[52:55]
  ds_read_b128 a[44:47], v17 offset:4096
  v_mfma_f32_16x16x32_bf16 v[56:59], a[76:79], a[0:3], v[56:59]
  v_mfma_f32_16x16x32_bf16 v[60:63], a[76:79], a[4:7], v[60:63]
  buffer_load_dwordx4 v225, s[8:11], s46 offen offset:1024 lds
  ds_read_b128 a[48:51], v17 offset:6144
  v_mfma_f32_16x16x32_bf16 v[64:67], a[76:79], a[8:11], v[64:67]
  v_mfma_f32_16x16x32_bf16 v[68:71], a[76:79], a[12:15], v[68:71]
  ds_read_b128 a[52:55], v17 offset:8192
  v_mfma_f32_16x16x32_bf16 v[72:75], a[76:79], a[16:19], v[72:75]
  v_mfma_f32_16x16x32_bf16 v[76:79], a[76:79], a[20:23], v[76:79]
  ds_read_b128 a[56:59], v17 offset:10240
  v_mfma_f32_16x16x32_bf16 v[80:83], a[76:79], a[24:27], v[80:83]
  buffer_load_dwordx4 v226, s[8:11], s46 offen offset:2048 lds
  v_mfma_f32_16x16x32_bf16 v[84:87], a[76:79], a[28:31], v[84:87]
  ds_read_b128 a[60:63], v17 offset:12288
  v_mfma_f32_16x16x32_bf16 v[88:91], a[80:83], a[0:3], v[88:91]
  v_mfma_f32_16x16x32_bf16 v[92:95], a[80:83], a[4:7], v[92:95]
  ds_read_b128 a[64:67], v17 offset:14336
  v_mfma_f32_16x16x32_bf16 v[96:99], a[80:83], a[8:11], v[96:99]
  v_mfma_f32_16x16x32_bf16 v[100:103], a[80:83], a[12:15], v[100:103]
  buffer_load_dwordx4 v227, s[8:11], s46 offen offset:3072 lds
  ds_read_b64_tr_b16 a[100:101], v21 offset:4096
  v_mfma_f32_16x16x32_bf16 v[104:107], a[80:83], a[16:19], v[104:107]
  s_add_u32 m0, s36, 4096
  ds_read_b64_tr_b16 a[102:103], v21 offset:6144
  v_mfma_f32_16x16x32_bf16 v[108:111], a[80:83], a[20:23], v[108:111]
  v_mfma_f32_16x16x32_bf16 v[112:115], a[80:83], a[24:27], v[112:115]
  ds_read_b64_tr_b16 a[104:105], v20 offset:12288
  v_mfma_f32_16x16x32_bf16 v[116:119], a[80:83], a[28:31], v[116:119]
  buffer_load_dwordx4 v228, s[8:11], s46 offen offset:0 lds
  v_mfma_f32_16x16x32_bf16 v[216:219], a[80:83], a[32:35], v[216:219]
  ds_read_b64_tr_b16 a[106:107], v20 offset:14336
  v_mfma_f32_16x16x32_bf16 v[120:123], a[84:87], a[0:3], v[120:123]
  v_mfma_f32_16x16x32_bf16 v[124:127], a[84:87], a[4:7], v[124:127]
  ds_read_b128 a[68:71], v19 offset:0
  v_mfma_f32_16x16x32_bf16 v[128:131], a[84:87], a[8:11], v[128:131]
  v_mfma_f32_16x16x32_bf16 v[132:135], a[84:87], a[12:15], v[132:135]
  buffer_load_dwordx4 v229, s[8:11], s46 offen offset:1024 lds
  ds_read_b64_tr_b16 a[108:109], v21 offset:12288
  v_mfma_f32_16x16x32_bf16 v[136:139], a[84:87], a[16:19], v[136:139]
  v_mfma_f32_16x16x32_bf16 v[140:143], a[84:87], a[20:23], v[140:143]
  ds_read_b64_tr_b16 a[110:111], v21 offset:14336
  v_mfma_f32_16x16x32_bf16 v[144:147], a[84:87], a[24:27], v[144:147]
  v_mfma_f32_16x16x32_bf16 v[148:151], a[84:87], a[28:31], v[148:151]
  ds_read_b64_tr_b16 a[112:113], v20 offset:20480
  v_mfma_f32_16x16x32_bf16 v[220:223], a[84:87], a[32:35], v[220:223]
  buffer_load_dwordx4 v230, s[8:11], s46 offen offset:2048 lds
  v_mfma_f32_16x16x32_bf16 v[152:155], a[0:3], a[88:91], v[152:155]
  ds_read_b64_tr_b16 a[114:115], v20 offset:22528
  v_mfma_f32_16x16x32_bf16 v[156:159], a[4:7], a[88:91], v[156:159]
  v_mfma_f32_16x16x32_bf16 v[160:163], a[8:11], a[88:91], v[160:163]
  ds_read_b64_tr_b16 a[116:117], v21 offset:20480
  v_mfma_f32_16x16x32_bf16 v[164:167], a[12:15], a[88:91], v[164:167]
  v_mfma_f32_16x16x32_bf16 v[168:171], a[16:19], a[88:91], v[168:171]
  buffer_load_dwordx4 v231, s[8:11], s46 offen offset:3072 lds
  ds_read_b64_tr_b16 a[118:119], v21 offset:22528
  v_mfma_f32_16x16x32_bf16 v[172:175], a[20:23], a[88:91], v[172:175]
  s_mul_i32 s47, s48, 393216
  s_bfe_u32 s34, 0x302010e, s49
  s_add_u32 s48, s48, s34
  v_mfma_f32_16x16x32_bf16 v[176:179], a[24:27], a[88:91], v[176:179]
  s_add_u32 s49, s49, 8
  s_and_b32 s49, s49, 0x8001f
  s_and_b32 s48, s48, 15
  v_mfma_f32_16x16x32_bf16 v[180:183], a[28:31], a[88:91], v[180:183]
  s_lshl_b32 s46, s48, 7
  v_mfma_f32_16x16x32_bf16 v[184:187], a[0:3], a[92:95], v[184:187]
  s_add_u32 s36, s36, s38
  s_add_u32 s37, s37, 1
  s_cmp_eq_u32 s37, 3
  s_cselect_b32 s37, 0, s37
  s_cselect_b32 s38, s39, s40
  v_mfma_f32_16x16x32_bf16 v[188:191], a[4:7], a[92:95], v[188:191]
  s_add_u32 s41, s41, s43
  s_sub_u32 s43, 0, s43
  v_mfma_f32_16x16x32_bf16 v[192:195], a[8:11], a[92:95], v[192:195]
  v_add_u32 v16, s38, v16
  v_add_u32 v17, s38, v17
  v_mfma_f32_16x16x32_bf16 v[196:199], a[12:15], a[92:95], v[196:199]
  v_add_u32 v18, s38, v18
  v_add_u32 v19, s38, v19
  v_mfma_f32_16x16x32_bf16 v[200:203], a[16:19], a[92:95], v[200:203]
  v_add_u32 v20, s43, v20
  v_add_u32 v21, s43, v21
  v_mfma_f32_16x16x32_bf16 v[204:207], a[20:23], a[92:95], v[204:207]
  s_waitcnt vmcnt(9) lgkmcnt(0)
  s_barrier
  v_mfma_f32_16x16x32_bf16 v[208:211], a[24:27], a[92:95], v[208:211]
  s_sub_u32 s35, s35, 1
  v_mfma_f32_16x16x32_bf16 v[212:215], a[28:31], a[92:95], v[212:215]
  s_cmp_lg_u32 s35, 0
  s_cbranch_scc1 Lp2r0_loop
  v_accvgpr_read_b32 v4, a222
  v_accvgpr_read_b32 v5, a223
  v_accvgpr_read_b32 v6, a224
  v_accvgpr_read_b32 v7, a225
  v_accvgpr_read_b32 v8, a226
  v_accvgpr_read_b32 v9, a227
  v_accvgpr_read_b32 v10, a228
  v_accvgpr_read_b32 v11, a229
  s_mov_b32 s8, s64
  s_mov_b32 s9, s65
  s_mov_b32 s10, 4194304
  s_mov_b32 s11, 0x00020000
  s_mov_b32 s20, s68
  s_mov_b32 s21, s69
  s_mov_b32 s22, 8388608
  s_mov_b32 s23, 0x00020000
  s_and_b32 s4, s2, 7
  s_lshl_b32 s4, s4, 1
  s_lshr_b32 s5, s2, 6
  s_lshr_b32 s30, s2, 4
  s_add_u32 s5, s5, s30
  s_and_b32 s53, s5, 3
  s_lshl_b32 s53, s53, 3
  s_or_b32 s53, s53, 0x80000
  s_bfe_u32 s52, 0xf0f02, s53
  s_add_u32 s52, s52, s4
  s_and_b32 s52, s52, 15
  s_mov_b32 s54, s52
  s_mov_b32 s55, s53
  s_lshl_b32 s29, s52, 7
  s_lshl_b32 s28, s54, 19
  s_lshl_b32 s30, s25, 18
  s_and_b32 s31, s25, 1
  s_lshl_b32 s31, s31, 1
  s_add_u32 s31, s31, 14
  s_sub_u32 s31, s31, s25
  s_lshl_b32 s31, s31, 18
  s_or_b32 s26, s30, s29
  s_or_b32 s27, s31, s29
  s_lshl_b32 s68, s3, 12
  s_lshl_b32 s88, s3, 13
  s_add_u32 s88, s88, 98304
  v_mfma_f32_16x16x32_bf16 v[24:27], a[96:99], a[36:39], v[24:27]
  s_mov_b32 m0, s41
  ds_read_b128 a[0:3], v16 offset:0
  v_mfma_f32_16x16x32_bf16 v[28:31], a[96:99], a[40:43], v[28:31]
  buffer_load_dwordx4 v233, s[12:15], s47 offen offset:0 lds
  ds_read_b64_tr_b16 a[72:73], v20 offset:0
  v_mfma_f32_16x16x32_bf16 v[32:35], a[96:99], a[44:47], v[32:35]
  v_mfma_f32_16x16x32_bf16 v[36:39], a[96:99], a[48:51], v[36:39]
  ds_read_b64_tr_b16 a[74:75], v20 offset:2048
  v_mfma_f32_16x16x32_bf16 v[40:43], a[96:99], a[52:55], v[40:43]
  v_mfma_f32_16x16x32_bf16 v[44:47], a[96:99], a[56:59], v[44:47]
  ds_read_b128 a[4:7], v16 offset:2048
  v_mfma_f32_16x16x32_bf16 v[48:51], a[96:99], a[60:63], v[48:51]
  v_mfma_f32_16x16x32_bf16 v[52:55], a[96:99], a[64:67], v[52:55]
  ds_read_b128 a[8:11], v16 offset:4096
  v_mfma_f32_16x16x32_bf16 v[56:59], a[100:103], a[36:39], v[56:59]
  v_mfma_f32_16x16x32_bf16 v[60:63], a[100:103], a[40:43], v[60:63]
  ds_read_b128 a[12:15], v16 offset:6144
  v_mfma_f32_16x16x32_bf16 v[64:67], a[100:103], a[44:47], v[64:67]
  v_mfma_f32_16x16x32_bf16 v[68:71], a[100:103], a[48:51], v[68:71]
  ds_read_b128 a[16:19], v16 offset:8192
  v_mfma_f32_16x16x32_bf16 v[72:75], a[100:103], a[52:55], v[72:75]
  v_mfma_f32_16x16x32_bf16 v[76:79], a[100:103], a[56:59], v[76:79]
  ds_read_b128 a[20:23], v16 offset:10240
  v_mfma_f32_16x16x32_bf16 v[80:83], a[100:103], a[60:63], v[80:83]
  v_mfma_f32_16x16x32_bf16 v[84:87], a[100:103], a[64:67], v[84:87]
  ds_read_b128 a[24:27], v16 offset:12288
  v_mfma_f32_16x16x32_bf16 v[88:91], a[104:107], a[36:39], v[88:91]
  buffer_load_dwordx4 v234, s[12:15], s47 offen offset:1024 lds
  v_mfma_f32_16x16x32_bf16 v[92:95], a[104:107], a[40:43], v[92:95]
  ds_read_b128 a[28:31], v16 offset:14336
  v_mfma_f32_16x16x32_bf16 v[96:99], a[104:107], a[44:47], v[96:99]
  v_mfma_f32_16x16x32_bf16 v[100:103], a[104:107], a[48:51], v[100:103]
  ds_read_b64_tr_b16 a[76:77], v21 offset:0
  v_mfma_f32_16x16x32_bf16 v[104:107], a[104:107], a[52:55], v[104:107]
  ds_read_b64_tr_b16 a[78:79], v21 offset:2048
  v_mfma_f32_16x16x32_bf16 v[108:111], a[104:107], a[56:59], v[108:111]
  v_mfma_f32_16x16x32_bf16 v[112:115], a[104:107], a[60:63], v[112:115]
  ds_read_b64_tr_b16 a[80:81], v20 offset:8192
  v_mfma_f32_16x16x32_bf16 v[116:119], a[104:107], a[64:67], v[116:119]
  v_mfma_f32_16x16x32_bf16 v[216:219], a[104:107], a[68:71], v[216:219]
  ds_read_b64_tr_b16 a[82:83], v20 offset:10240
  v_mfma_f32_16x16x32_bf16 v[120:123], a[108:111], a[36:39], v[120:123]
  v_mfma_f32_16x16x32_bf16 v[124:127], a[108:111], a[40:43], v[124:127]
  ds_read_b128 a[32:35], v18 offset:0
  v_mfma_f32_16x16x32_bf16 v[128:131], a[108:111], a[44:47], v[128:131]
  v_mfma_f32_16x16x32_bf16 v[132:135], a[108:111], a[48:51], v[132:135]
  ds_read_b64_tr_b16 a[84:85], v21 offset:8192
  v_mfma_f32_16x16x32_bf16 v[136:139], a[108:111], a[52:55], v[136:139]
  v_mfma_f32_16x16x32_bf16 v[140:143], a[108:111], a[56:59], v[140:143]
  ds_read_b64_tr_b16 a[86:87], v21 offset:10240
  v_mfma_f32_16x16x32_bf16 v[144:147], a[108:111], a[60:63], v[144:147]
  v_mfma_f32_16x16x32_bf16 v[148:151], a[108:111], a[64:67], v[148:151]
  buffer_load_dwordx4 v235, s[12:15], s47 offen offset:2048 lds
  ds_read_b64_tr_b16 a[88:89], v20 offset:16384
  v_mfma_f32_16x16x32_bf16 v[220:223], a[108:111], a[68:71], v[220:223]
  v_mfma_f32_16x16x32_bf16 v[152:155], a[36:39], a[112:115], v[152:155]
  ds_read_b64_tr_b16 a[90:91], v20 offset:18432
  v_mfma_f32_16x16x32_bf16 v[156:159], a[40:43], a[112:115], v[156:159]
  v_mfma_f32_16x16x32_bf16 v[160:163], a[44:47], a[112:115], v[160:163]
  ds_read_b64_tr_b16 a[92:93], v21 offset:16384
  v_mfma_f32_16x16x32_bf16 v[164:167], a[48:51], a[112:115], v[164:167]
  v_mfma_f32_16x16x32_bf16 v[168:171], a[52:55], a[112:115], v[168:171]
  ds_read_b64_tr_b16 a[94:95], v21 offset:18432
  v_mfma_f32_16x16x32_bf16 v[172:175], a[56:59], a[112:115], v[172:175]
  v_mfma_f32_16x16x32_bf16 v[176:179], a[60:63], a[112:115], v[176:179]
  v_mfma_f32_16x16x32_bf16 v[180:183], a[64:67], a[112:115], v[180:183]
  v_mfma_f32_16x16x32_bf16 v[184:187], a[36:39], a[116:119], v[184:187]
  v_mfma_f32_16x16x32_bf16 v[188:191], a[40:43], a[116:119], v[188:191]
  v_mfma_f32_16x16x32_bf16 v[192:195], a[44:47], a[116:119], v[192:195]
  v_mfma_f32_16x16x32_bf16 v[196:199], a[48:51], a[116:119], v[196:199]
  v_mfma_f32_16x16x32_bf16 v[200:203], a[52:55], a[116:119], v[200:203]
  v_mfma_f32_16x16x32_bf16 v[204:207], a[56:59], a[116:119], v[204:207]
  v_mfma_f32_16x16x32_bf16 v[208:211], a[60:63], a[116:119], v[208:211]
  v_mfma_f32_16x16x32_bf16 v[212:215], a[64:67], a[116:119], v[212:215]
  s_waitcnt lgkmcnt(0)
  v_mfma_f32_16x16x32_bf16 v[24:27], a[72:75], a[0:3], v[24:27]
  s_add_u32 m0, s41, 3072
  ds_read_b128 a[36:39], v17 offset:0
  v_mfma_f32_16x16x32_bf16 v[28:31], a[72:75], a[4:7], v[28:31]
  buffer_load_dwordx4 v236, s[12:15], s47 offen offset:0 lds
  ds_read_b64_tr_b16 a[96:97], v20 offset:4096
  v_mfma_f32_16x16x32_bf16 v[32:35], a[72:75], a[8:11], v[32:35]
  v_mfma_f32_16x16x32_bf16 v[36:39], a[72:75], a[12:15], v[36:39]
  ds_read_b64_tr_b16 a[98:99], v20 offset:6144
  v_mfma_f32_16x16x32_bf16 v[40:43], a[72:75], a[16:19], v[40:43]
  v_mfma_f32_16x16x32_bf16 v[44:47], a[72:75], a[20:23], v[44:47]
  ds_read_b128 a[40:43], v17 offset:2048
  v_mfma_f32_16x16x32_bf16 v[48:51], a[72:75], a[24:27], v[48:51]
  v_mfma_f32_16x16x32_bf16 v[52:55], a[72:75], a[28:31], v[52:55]
  ds_read_b128 a[44:47], v17 offset:4096
  v_mfma_f32_16x16x32_bf16 v[56:59], a[76:79], a[0:3], v[56:59]
  v_mfma_f32_16x16x32_bf16 v[60:63], a[76:79], a[4:7], v[60:63]
  ds_read_b128 a[48:51], v17 offset:6144
  v_mfma_f32_16x16x32_bf16 v[64:67], a[76:79], a[8:11], v[64:67]
  v_mfma_f32_16x16x32_bf16 v[68:71], a[76:79], a[12:15], v[68:71]
  ds_read_b128 a[52:55], v17 offset:8192
  v_mfma_f32_16x16x32_bf16 v[72:75], a[76:79], a[16:19], v[72:75]
  v_mfma_f32_16x16x32_bf16 v[76:79], a[76:79], a[20:23], v[76:79]
  ds_read_b128 a[56:59], v17 offset:10240
  v_mfma_f32_16x16x32_bf16 v[80:83], a[76:79], a[24:27], v[80:83]
  buffer_load_dwordx4 v237, s[12:15], s47 offen offset:1024 lds
  v_mfma_f32_16x16x32_bf16 v[84:87], a[76:79], a[28:31], v[84:87]
  ds_read_b128 a[60:63], v17 offset:12288
  v_mfma_f32_16x16x32_bf16 v[88:91], a[80:83], a[0:3], v[88:91]
  v_mfma_f32_16x16x32_bf16 v[92:95], a[80:83], a[4:7], v[92:95]
  ds_read_b128 a[64:67], v17 offset:14336
  v_mfma_f32_16x16x32_bf16 v[96:99], a[80:83], a[8:11], v[96:99]
  v_mfma_f32_16x16x32_bf16 v[100:103], a[80:83], a[12:15], v[100:103]
  ds_read_b64_tr_b16 a[100:101], v21 offset:4096
  v_mfma_f32_16x16x32_bf16 v[104:107], a[80:83], a[16:19], v[104:107]
  ds_read_b64_tr_b16 a[102:103], v21 offset:6144
  v_mfma_f32_16x16x32_bf16 v[108:111], a[80:83], a[20:23], v[108:111]
  v_mfma_f32_16x16x32_bf16 v[112:115], a[80:83], a[24:27], v[112:115]
  ds_read_b64_tr_b16 a[104:105], v20 offset:12288
  v_mfma_f32_16x16x32_bf16 v[116:119], a[80:83], a[28:31], v[116:119]
  v_mfma_f32_16x16x32_bf16 v[216:219], a[80:83], a[32:35], v[216:219]
  ds_read_b64_tr_b16 a[106:107], v20 offset:14336
  v_mfma_f32_16x16x32_bf16 v[120:123], a[84:87], a[0:3], v[120:123]
  v_mfma_f32_16x16x32_bf16 v[124:127], a[84:87], a[4:7], v[124:127]
  ds_read_b128 a[68:71], v19 offset:0
  v_mfma_f32_16x16x32_bf16 v[128:131], a[84:87], a[8:11], v[128:131]
  v_mfma_f32_16x16x32_bf16 v[132:135], a[84:87], a[12:15], v[132:135]
  buffer_load_dwordx4 v238, s[12:15], s47 offen offset:2048 lds
  ds_read_b64_tr_b16 a[108:109], v21 offset:12288
  v_mfma_f32_16x16x32_bf16 v[136:139], a[84:87], a[16:19], v[136:139]
  s_add_u32 s36, s36, s38
  s_add_u32 s37, s37, 1
  s_cmp_eq_u32 s37, 3
  s_cselect_b32 s37, 0, s37
  s_cselect_b32 s38, s39, s40
  v_mfma_f32_16x16x32_bf16 v[140:143], a[84:87], a[20:23], v[140:143]
  s_add_u32 s41, s41, s43
  s_sub_u32 s43, 0, s43
  ds_read_b64_tr_b16 a[110:111], v21 offset:14336
  v_mfma_f32_16x16x32_bf16 v[144:147], a[84:87], a[24:27], v[144:147]
  v_mfma_f32_16x16x32_bf16 v[148:151], a[84:87], a[28:31], v[148:151]
  ds_read_b64_tr_b16 a[112:113], v20 offset:20480
  v_mfma_f32_16x16x32_bf16 v[220:223], a[84:87], a[32:35], v[220:223]
  v_mfma_f32_16x16x32_bf16 v[152:155], a[0:3], a[88:91], v[152:155]
  ds_read_b64_tr_b16 a[114:115], v20 offset:22528
  v_mfma_f32_16x16x32_bf16 v[156:159], a[4:7], a[88:91], v[156:159]
  v_mfma_f32_16x16x32_bf16 v[160:163], a[8:11], a[88:91], v[160:163]
  ds_read_b64_tr_b16 a[116:117], v21 offset:20480
  v_mfma_f32_16x16x32_bf16 v[164:167], a[12:15], a[88:91], v[164:167]
  v_mfma_f32_16x16x32_bf16 v[168:171], a[16:19], a[88:91], v[168:171]
  ds_read_b64_tr_b16 a[118:119], v21 offset:22528
  v_mfma_f32_16x16x32_bf16 v[172:175], a[20:23], a[88:91], v[172:175]
  v_add_u32 v16, s38, v16
  v_add_u32 v17, s38, v17
  v_mfma_f32_16x16x32_bf16 v[176:179], a[24:27], a[88:91], v[176:179]
  v_add_u32 v18, s38, v18
  v_add_u32 v19, s38, v19
  v_mfma_f32_16x16x32_bf16 v[180:183], a[28:31], a[88:91], v[180:183]
  v_add_u32 v20, s43, v20
  v_add_u32 v21, s43, v21
  v_mfma_f32_16x16x32_bf16 v[184:187], a[0:3], a[92:95], v[184:187]
  v_mfma_f32_16x16x32_bf16 v[188:191], a[4:7], a[92:95], v[188:191]
  v_mfma_f32_16x16x32_bf16 v[192:195], a[8:11], a[92:95], v[192:195]
  v_mfma_f32_16x16x32_bf16 v[196:199], a[12:15], a[92:95], v[196:199]
  v_mfma_f32_16x16x32_bf16 v[200:203], a[16:19], a[92:95], v[200:203]
  v_mfma_f32_16x16x32_bf16 v[204:207], a[20:23], a[92:95], v[204:207]
  v_mfma_f32_16x16x32_bf16 v[208:211], a[24:27], a[92:95], v[208:211]
  v_mfma_f32_16x16x32_bf16 v[212:215], a[28:31], a[92:95], v[212:215]
  s_waitcnt vmcnt(0) lgkmcnt(0)
  s_barrier
  s_mov_b32 s6, 0x3e8293ee
  s_mov_b32 s7, s6
  v_mfma_f32_16x16x32_bf16 v[24:27], a[96:99], a[36:39], v[24:27]
  ds_read_b128 a[0:3], v16 offset:0
  v_mfma_f32_16x16x32_bf16 v[28:31], a[96:99], a[40:43], v[28:31]
  ds_read_b64_tr_b16 a[72:73], v20 offset:0
  v_mfma_f32_16x16x32_bf16 v[32:35], a[96:99], a[44:47], v[32:35]
  v_mfma_f32_16x16x32_bf16 v[36:39], a[96:99], a[48:51], v[36:39]
  ds_read_b64_tr_b16 a[74:75], v20 offset:2048
  v_mfma_f32_16x16x32_bf16 v[40:43], a[96:99], a[52:55], v[40:43]
  v_mfma_f32_16x16x32_bf16 v[44:47], a[96:99], a[56:59], v[44:47]
  ds_read_b128 a[4:7], v16 offset:2048
  v_mfma_f32_16x16x32_bf16 v[48:51], a[96:99], a[60:63], v[48:51]
  v_mfma_f32_16x16x32_bf16 v[52:55], a[96:99], a[64:67], v[52:55]
  ds_read_b128 a[8:11], v16 offset:4096
  v_mfma_f32_16x16x32_bf16 v[56:59], a[100:103], a[36:39], v[56:59]
  v_mfma_f32_16x16x32_bf16 v[60:63], a[100:103], a[40:43], v[60:63]
  ds_read_b128 a[12:15], v16 offset:6144
  v_mfma_f32_16x16x32_bf16 v[64:67], a[100:103], a[44:47], v[64:67]
  v_mfma_f32_16x16x32_bf16 v[68:71], a[100:103], a[48:51], v[68:71]
  ds_read_b128 a[16:19], v16 offset:8192
  v_mfma_f32_16x16x32_bf16 v[72:75], a[100:103], a[52:55], v[72:75]
  v_mfma_f32_16x16x32_bf16 v[76:79], a[100:103], a[56:59], v[76:79]
  ds_read_b128 a[20:23], v16 offset:10240
  v_mfma_f32_16x16x32_bf16 v[80:83], a[100:103], a[60:63], v[80:83]
  v_mfma_f32_16x16x32_bf16 v[84:87], a[100:103], a[64:67], v[84:87]
  ds_read_b128 a[24:27], v16 offset:12288
  v_mfma_f32_16x16x32_bf16 v[88:91], a[104:107], a[36:39], v[88:91]
  v_mfma_f32_16x16x32_bf16 v[92:95], a[104:107], a[40:43], v[92:95]
  ds_read_b128 a[28:31], v16 offset:14336
  v_mfma_f32_16x16x32_bf16 v[96:99], a[104:107], a[44:47], v[96:99]
  v_mfma_f32_16x16x32_bf16 v[100:103], a[104:107], a[48:51], v[100:103]
  ds_read_b64_tr_b16 a[76:77], v21 offset:0
  v_mfma_f32_16x16x32_bf16 v[104:107], a[104:107], a[52:55], v[104:107]
  ds_read_b64_tr_b16 a[78:79], v21 offset:2048
  v_mfma_f32_16x16x32_bf16 v[108:111], a[104:107], a[56:59], v[108:111]
  v_mfma_f32_16x16x32_bf16 v[112:115], a[104:107], a[60:63], v[112:115]
  ds_read_b64_tr_b16 a[80:81], v20 offset:8192
  v_mfma_f32_16x16x32_bf16 v[116:119], a[104:107], a[64:67], v[116:119]
  v_mfma_f32_16x16x32_bf16 v[216:219], a[104:107], a[68:71], v[216:219]
  ds_read_b64_tr_b16 a[82:83], v20 offset:10240
  v_mfma_f32_16x16x32_bf16 v[120:123], a[108:111], a[36:39], v[120:123]
  v_mfma_f32_16x16x32_bf16 v[124:127], a[108:111], a[40:43], v[124:127]
  ds_read_b128 a[32:35], v18 offset:0
  v_mfma_f32_16x16x32_bf16 v[128:131], a[108:111], a[44:47], v[128:131]
  v_mfma_f32_16x16x32_bf16 v[132:135], a[108:111], a[48:51], v[132:135]
  ds_read_b64_tr_b16 a[84:85], v21 offset:8192
  v_mfma_f32_16x16x32_bf16 v[136:139], a[108:111], a[52:55], v[136:139]
  v_mfma_f32_16x16x32_bf16 v[140:143], a[108:111], a[56:59], v[140:143]
  ds_read_b64_tr_b16 a[86:87], v21 offset:10240
  v_mfma_f32_16x16x32_bf16 v[144:147], a[108:111], a[60:63], v[144:147]
  v_mfma_f32_16x16x32_bf16 v[148:151], a[108:111], a[64:67], v[148:151]
  ds_read_b64_tr_b16 a[88:89], v20 offset:16384
  v_mfma_f32_16x16x32_bf16 v[220:223], a[108:111], a[68:71], v[220:223]
  v_mfma_f32_16x16x32_bf16 v[152:155], a[36:39], a[112:115], v[152:155]
  ds_read_b64_tr_b16 a[90:91], v20 offset:18432
  v_mfma_f32_16x16x32_bf16 v[156:159], a[40:43], a[112:115], v[156:159]
  v_mfma_f32_16x16x32_bf16 v[160:163], a[44:47], a[112:115], v[160:163]
  ds_read_b64_tr_b16 a[92:93], v21 offset:16384
  v_mfma_f32_16x16x32_bf16 v[164:167], a[48:51], a[112:115], v[164:167]
  v_mfma_f32_16x16x32_bf16 v[168:171], a[52:55], a[112:115], v[168:171]
  ds_read_b64_tr_b16 a[94:95], v21 offset:18432
  v_mfma_f32_16x16x32_bf16 v[172:175], a[56:59], a[112:115], v[172:175]
  v_mfma_f32_16x16x32_bf16 v[176:179], a[60:63], a[112:115], v[176:179]
  v_mfma_f32_16x16x32_bf16 v[180:183], a[64:67], a[112:115], v[180:183]
  v_mfma_f32_16x16x32_bf16 v[184:187], a[36:39], a[116:119], v[184:187]
  v_mfma_f32_16x16x32_bf16 v[188:191], a[40:43], a[116:119], v[188:191]
  v_mfma_f32_16x16x32_bf16 v[192:195], a[44:47], a[116:119], v[192:195]
  v_mfma_f32_16x16x32_bf16 v[196:199], a[48:51], a[116:119], v[196:199]
  v_mfma_f32_16x16x32_bf16 v[200:203], a[52:55], a[116:119], v[200:203]
  v_mfma_f32_16x16x32_bf16 v[204:207], a[56:59], a[116:119], v[204:207]
  v_mfma_f32_16x16x32_bf16 v[208:211], a[60:63], a[116:119], v[208:211]
  v_mfma_f32_16x16x32_bf16 v[212:215], a[64:67], a[116:119], v[212:215]
  s_waitcnt lgkmcnt(0)
  v_mfma_f32_16x16x32_bf16 v[24:27], a[72:75], a[0:3], v[24:27]
  ds_read_b128 a[36:39], v17 offset:0
  ds_read_b64_tr_b16 a[96:97], v20 offset:4096
  v_mfma_f32_16x16x32_bf16 v[56:59], a[76:79], a[0:3], v[56:59]
  ds_read_b64_tr_b16 a[98:99], v20 offset:6144
  ds_read_b128 a[40:43], v17 offset:2048
  v_mfma_f32_16x16x32_bf16 v[28:31], a[72:75], a[4:7], v[28:31]
  ds_read_b128 a[44:47], v17 offset:4096
  ds_read_b128 a[48:51], v17 offset:6144
  v_mfma_f32_16x16x32_bf16 v[60:63], a[76:79], a[4:7], v[60:63]
  ds_read_b128 a[52:55], v17 offset:8192
  ds_read_b128 a[56:59], v17 offset:10240
  v_mfma_f32_16x16x32_bf16 v[32:35], a[72:75], a[8:11], v[32:35]
  ds_read_b128 a[60:63], v17 offset:12288
  ds_read_b128 a[64:67], v17 offset:14336
  v_mfma_f32_16x16x32_bf16 v[64:67], a[76:79], a[8:11], v[64:67]
  ds_read_b64_tr_b16 a[100:101], v21 offset:4096
  ds_read_b64_tr_b16 a[102:103], v21 offset:6144
  v_mfma_f32_16x16x32_bf16 v[36:39], a[72:75], a[12:15], v[36:39]
  ds_read_b64_tr_b16 a[104:105], v20 offset:12288
  ds_read_b64_tr_b16 a[106:107], v20 offset:14336
  v_mfma_f32_16x16x32_bf16 v[68:71], a[76:79], a[12:15], v[68:71]
  ds_read_b128 a[68:71], v19 offset:0
  ds_read_b64_tr_b16 a[108:109], v21 offset:12288
  v_mfma_f32_16x16x32_bf16 v[40:43], a[72:75], a[16:19], v[40:43]
  ds_read_b64_tr_b16 a[110:111], v21 offset:14336
  ds_read_b64_tr_b16 a[112:113], v20 offset:20480
  v_mfma_f32_16x16x32_bf16 v[72:75], a[76:79], a[16:19], v[72:75]
  ds_read_b64_tr_b16 a[114:115], v20 offset:22528
  ds_read_b64_tr_b16 a[116:117], v21 offset:20480
  v_mfma_f32_16x16x32_bf16 v[44:47], a[72:75], a[20:23], v[44:47]
  ds_read_b64_tr_b16 a[118:119], v21 offset:22528
  v_mfma_f32_16x16x32_bf16 v[76:79], a[76:79], a[20:23], v[76:79]
  v_mfma_f32_16x16x32_bf16 v[48:51], a[72:75], a[24:27], v[48:51]
  v_mfma_f32_16x16x32_bf16 v[80:83], a[76:79], a[24:27], v[80:83]
  v_mfma_f32_16x16x32_bf16 v[52:55], a[72:75], a[28:31], v[52:55]
  v_mfma_f32_16x16x32_bf16 v[84:87], a[76:79], a[28:31], v[84:87]
  s_waitcnt lgkmcnt(0)
  s_barrier
  s_mov_b32 s12, s84
  s_mov_b32 s13, s85
  s_mov_b32 s14, 256
  s_mov_b32 s15, 0x00020000
  buffer_load_dwordx2 v[22:23], off, s[12:15], 0 sc1
  v_mfma_f32_16x16x32_bf16 v[24:27], a[96:99], a[36:39], v[24:27]
  s_mov_b32 m0, s68
  v_mfma_f32_16x16x32_bf16 v[56:59], a[100:103], a[36:39], v[56:59]
  buffer_load_dwordx4 v8, s[20:23], s28 offen offset:0 lds
  v_mfma_f32_16x16x32_bf16 v[28:31], a[96:99], a[40:43], v[28:31]
  v_mfma_f32_16x16x32_bf16 v[60:63], a[100:103], a[40:43], v[60:63]
  v_mfma_f32_16x16x32_bf16 v[32:35], a[96:99], a[44:47], v[32:35]
  v_mfma_f32_16x16x32_bf16 v[64:67], a[100:103], a[44:47], v[64:67]
  buffer_load_dwordx4 v9, s[20:23], s28 offen offset:1024 lds
  v_pk_mul_f32 v[24:25], v[24:25], s[6:7]
  v_mfma_f32_16x16x32_bf16 v[36:39], a[96:99], a[48:51], v[36:39]
  v_pk_mul_f32 v[26:27], v[26:27], s[6:7]
  v_pk_mul_f32 v[56:57], v[56:57], s[6:7]
  v_mfma_f32_16x16x32_bf16 v[68:71], a[100:103], a[48:51], v[68:71]
  v_pk_mul_f32 v[58:59], v[58:59], s[6:7]
  v_cvt_pk_bf16_f32 v24, v24, v25
  v_mfma_f32_16x16x32_bf16 v[40:43], a[96:99], a[52:55], v[40:43]
  v_cvt_pk_bf16_f32 v25, v26, v27
  v_cvt_pk_bf16_f32 v26, v56, v57
  v_mfma_f32_16x16x32_bf16 v[72:75], a[100:103], a[52:55], v[72:75]
  v_cvt_pk_bf16_f32 v27, v58, v59
  v_pk_mul_f32 v[28:29], v[28:29], s[6:7]
  v_mfma_f32_16x16x32_bf16 v[44:47], a[96:99], a[56:59], v[44:47]
  buffer_load_dwordx4 v10, s[20:23], s28 offen offset:2048 lds
  v_pk_mul_f32 v[30:31], v[30:31], s[6:7]
  v_mfma_f32_16x16x32_bf16 v[76:79], a[100:103], a[56:59], v[76:79]
  v_pk_mul_f32 v[60:61], v[60:61], s[6:7]
  v_pk_mul_f32 v[62:63], v[62:63], s[6:7]
  v_mfma_f32_16x16x32_bf16 v[48:51], a[96:99], a[60:63], v[48:51]
  v_cvt_pk_bf16_f32 v28, v28, v29
  v_cvt_pk_bf16_f32 v29, v30, v31
  v_mfma_f32_16x16x32_bf16 v[80:83], a[100:103], a[60:63], v[80:83]
  v_cvt_pk_bf16_f32 v30, v60, v61
  v_cvt_pk_bf16_f32 v31, v62, v63
  v_mfma_f32_16x16x32_bf16 v[52:55], a[96:99], a[64:67], v[52:55]
  v_pk_mul_f32 v[32:33], v[32:33], s[6:7]
  v_pk_mul_f32 v[34:35], v[34:35], s[6:7]
  v_mfma_f32_16x16x32_bf16 v[84:87], a[100:103], a[64:67], v[84:87]
  buffer_load_dwordx4 v11, s[20:23], s28 offen offset:3072 lds
  v_pk_mul_f32 v[64:65], v[64:65], s[6:7]
  v_mfma_f32_16x16x32_bf16 v[216:219], a[80:83], a[32:35], v[216:219]
  s_bfe_u32 s56, 0x302010e, s55
  s_add_u32 s54, s54, s56
  s_add_u32 s55, s55, 8
  v_mfma_f32_16x16x32_bf16 v[220:223], a[84:87], a[32:35], v[220:223]
  s_and_b32 s55, s55, 0x8001f
  s_and_b32 s54, s54, 15
  s_lshl_b32 s28, s54, 19
  v_mfma_f32_16x16x32_bf16 v[216:219], a[104:107], a[68:71], v[216:219]
  s_add_u32 m0, s68, 16384
  v_pk_mul_f32 v[66:67], v[66:67], s[6:7]
  v_cvt_pk_bf16_f32 v32, v32, v33
  v_mfma_f32_16x16x32_bf16 v[220:223], a[108:111], a[68:71], v[220:223]
  v_cvt_pk_bf16_f32 v33, v34, v35
  v_cvt_pk_bf16_f32 v34, v64, v65
  v_mfma_f32_16x16x32_bf16 v[88:91], a[80:83], a[0:3], v[88:91]
  buffer_load_dwordx4 v8, s[20:23], s28 offen offset:0 lds
  v_cvt_pk_bf16_f32 v35, v66, v67
  v_mfma_f32_16x16x32_bf16 v[120:123], a[84:87], a[0:3], v[120:123]
  v_pk_mul_f32 v[36:37], v[36:37], s[6:7]
  v_pk_mul_f32 v[38:39], v[38:39], s[6:7]
  v_mfma_f32_16x16x32_bf16 v[88:91], a[104:107], a[36:39], v[88:91]
  v_pk_mul_f32 v[68:69], v[68:69], s[6:7]
  v_pk_mul_f32 v[70:71], v[70:71], s[6:7]
  v_mfma_f32_16x16x32_bf16 v[120:123], a[108:111], a[36:39], v[120:123]
  v_cvt_pk_bf16_f32 v36, v36, v37
  v_cvt_pk_bf16_f32 v37, v38, v39
  v_mfma_f32_16x16x32_bf16 v[92:95], a[80:83], a[4:7], v[92:95]
  v_cvt_pk_bf16_f32 v38, v68, v69
  v_cvt_pk_bf16_f32 v39, v70, v71
  v_mfma_f32_16x16x32_bf16 v[124:127], a[84:87], a[4:7], v[124:127]
  buffer_load_dwordx4 v9, s[20:23], s28 offen offset:1024 lds
  v_pk_mul_f32 v[40:41], v[40:41], s[6:7]
  v_mfma_f32_16x16x32_bf16 v[92:95], a[104:107], a[40:43], v[92:95]
  v_pk_mul_f32 v[42:43], v[42:43], s[6:7]
  v_pk_mul_f32 v[72:73], v[72:73], s[6:7]
  v_mfma_f32_16x16x32_bf16 v[124:127], a[108:111], a[40:43], v[124:127]
  v_pk_mul_f32 v[74:75], v[74:75], s[6:7]
  v_cvt_pk_bf16_f32 v40, v40, v41
  v_mfma_f32_16x16x32_bf16 v[96:99], a[80:83], a[8:11], v[96:99]
  v_cvt_pk_bf16_f32 v41, v42, v43
  v_cvt_pk_bf16_f32 v42, v72, v73
  v_mfma_f32_16x16x32_bf16 v[128:131], a[84:87], a[8:11], v[128:131]
  v_cvt_pk_bf16_f32 v43, v74, v75
  v_pk_mul_f32 v[44:45], v[44:45], s[6:7]
  v_mfma_f32_16x16x32_bf16 v[96:99], a[104:107], a[44:47], v[96:99]
  v_pk_mul_f32 v[46:47], v[46:47], s[6:7]
  v_pk_mul_f32 v[76:77], v[76:77], s[6:7]
  v_mfma_f32_16x16x32_bf16 v[128:131], a[108:111], a[44:47], v[128:131]
  buffer_load_dwordx4 v10, s[20:23], s28 offen offset:2048 lds
  v_pk_mul_f32 v[78:79], v[78:79], s[6:7]
  v_mfma_f32_16x16x32_bf16 v[100:103], a[80:83], a[12:15], v[100:103]
  v_cvt_pk_bf16_f32 v44, v44, v45
  v_cvt_pk_bf16_f32 v45, v46, v47
  v_mfma_f32_16x16x32_bf16 v[132:135], a[84:87], a[12:15], v[132:135]
  v_cvt_pk_bf16_f32 v46, v76, v77
  v_cvt_pk_bf16_f32 v47, v78, v79
  v_mfma_f32_16x16x32_bf16 v[100:103], a[104:107], a[48:51], v[100:103]
  v_pk_mul_f32 v[48:49], v[48:49], s[6:7]
  v_pk_mul_f32 v[50:51], v[50:51], s[6:7]
  v_mfma_f32_16x16x32_bf16 v[132:135], a[108:111], a[48:51], v[132:135]
  v_pk_mul_f32 v[80:81], v[80:81], s[6:7]
  v_pk_mul_f32 v[82:83], v[82:83], s[6:7]
  v_mfma_f32_16x16x32_bf16 v[104:107], a[80:83], a[16:19], v[104:107]
  buffer_load_dwordx4 v11, s[20:23], s28 offen offset:3072 lds
  v_cvt_pk_bf16_f32 v48, v48, v49
  v_mfma_f32_16x16x32_bf16 v[136:139], a[84:87], a[16:19], v[136:139]
  s_bfe_u32 s56, 0x302010e, s55
  s_add_u32 s54, s54, s56
  s_add_u32 s55, s55, 8
  v_mfma_f32_16x16x32_bf16 v[104:107], a[104:107], a[52:55], v[104:107]
  s_and_b32 s55, s55, 0x8001f
  s_and_b32 s54, s54, 15
  s_lshl_b32 s28, s54, 19
  v_mfma_f32_16x16x32_bf16 v[136:139], a[108:111], a[52:55], v[136:139]
  s_mov_b32 m0, s88
  v_cvt_pk_bf16_f32 v49, v50, v51
  v_cvt_pk_bf16_f32 v50, v80, v81
  v_mfma_f32_16x16x32_bf16 v[108:111], a[80:83], a[20:23], v[108:111]
  v_cvt_pk_bf16_f32 v51, v82, v83
  v_pk_mul_f32 v[52:53], v[52:53], s[6:7]
  v_mfma_f32_16x16x32_bf16 v[140:143], a[84:87], a[20:23], v[140:143]
  buffer_load_dwordx4 v4, s[8:11], s26 offen offset:0 lds
  v_pk_mul_f32 v[54:55], v[54:55], s[6:7]
  v_mfma_f32_16x16x32_bf16 v[108:111], a[104:107], a[56:59], v[108:111]
  v_pk_mul_f32 v[84:85], v[84:85], s[6:7]
  v_pk_mul_f32 v[86:87], v[86:87], s[6:7]
  v_mfma_f32_16x16x32_bf16 v[140:143], a[108:111], a[56:59], v[140:143]
  v_cvt_pk_bf16_f32 v52, v52, v53
  v_cvt_pk_bf16_f32 v53, v54, v55
  v_mfma_f32_16x16x32_bf16 v[112:115], a[80:83], a[24:27], v[112:115]
  v_cvt_pk_bf16_f32 v54, v84, v85
  v_cvt_pk_bf16_f32 v55, v86, v87
  v_mfma_f32_16x16x32_bf16 v[144:147], a[84:87], a[24:27], v[144:147]
  v_cvt_pk_bf16_f32 v216, v216, v217
  v_cvt_pk_bf16_f32 v217, v218, v219
  v_mfma_f32_16x16x32_bf16 v[112:115], a[104:107], a[60:63], v[112:115]
  buffer_load_dwordx4 v5, s[8:11], s26 offen offset:1024 lds
  v_cvt_pk_bf16_f32 v218, v220, v221
  v_mfma_f32_16x16x32_bf16 v[144:147], a[108:111], a[60:63], v[144:147]
  v_cvt_pk_bf16_f32 v219, v222, v223
  v_mfma_f32_16x16x32_bf16 v[116:119], a[80:83], a[28:31], v[116:119]
  ds_write_b128 v252, v[216:219]
  v_cvt_pk_bf16_f32 v88, v88, v89
  v_mfma_f32_16x16x32_bf16 v[148:151], a[84:87], a[28:31], v[148:151]
  v_cvt_pk_bf16_f32 v89, v90, v91
  v_cvt_pk_bf16_f32 v90, v120, v121
  v_mfma_f32_16x16x32_bf16 v[116:119], a[104:107], a[64:67], v[116:119]
  v_cvt_pk_bf16_f32 v91, v122, v123
  v_cvt_pk_bf16_f32 v92, v92, v93
  v_mfma_f32_16x16x32_bf16 v[148:151], a[108:111], a[64:67], v[148:151]
  buffer_load_dwordx4 v6, s[8:11], s26 offen offset:2048 lds
  v_cvt_pk_bf16_f32 v93, v94, v95
  v_mfma_f32_16x16x32_bf16 v[180:183], a[28:31], a[88:91], v[180:183]
  v_cvt_pk_bf16_f32 v94, v124, v125
  v_cvt_pk_bf16_f32 v95, v126, v127
  v_mfma_f32_16x16x32_bf16 v[212:215], a[28:31], a[92:95], v[212:215]
  v_cvt_pk_bf16_f32 v96, v96, v97
  v_cvt_pk_bf16_f32 v97, v98, v99
  v_mfma_f32_16x16x32_bf16 v[180:183], a[64:67], a[112:115], v[180:183]
  v_cvt_pk_bf16_f32 v98, v128, v129
  v_cvt_pk_bf16_f32 v99, v130, v131
  v_mfma_f32_16x16x32_bf16 v[212:215], a[64:67], a[116:119], v[212:215]
  v_cvt_pk_bf16_f32 v100, v100, v101
  v_cvt_pk_bf16_f32 v101, v102, v103
  v_mfma_f32_16x16x32_bf16 v[176:179], a[24:27], a[88:91], v[176:179]
  v_cvt_pk_bf16_f32 v102, v132, v133
  v_cvt_pk_bf16_f32 v103, v134, v135
  v_mfma_f32_16x16x32_bf16 v[208:211], a[24:27], a[92:95], v[208:211]
  buffer_load_dwordx4 v7, s[8:11], s26 offen offset:3072 lds
  v_cvt_pk_bf16_f32 v104, v104, v105
  v_mfma_f32_16x16x32_bf16 v[176:179], a[60:63], a[112:115], v[176:179]
  s_add_u32 m0, s88, 4096
  v_cvt_pk_bf16_f32 v105, v106, v107
  v_cvt_pk_bf16_f32 v106, v136, v137
  v_mfma_f32_16x16x32_bf16 v[208:211], a[60:63], a[116:119], v[208:211]
  v_cvt_pk_bf16_f32 v107, v138, v139
  v_cvt_pk_bf16_f32 v108, v108, v109
  v_mfma_f32_16x16x32_bf16 v[172:175], a[20:23], a[88:91], v[172:175]
  v_cvt_pk_bf16_f32 v109, v110, v111
  v_cvt_pk_bf16_f32 v110, v140, v141
  v_mfma_f32_16x16x32_bf16 v[204:207], a[20:23], a[92:95], v[204:207]
  v_cvt_pk_bf16_f32 v111, v142, v143
  v_cvt_pk_bf16_f32 v112, v112, v113
  v_mfma_f32_16x16x32_bf16 v[172:175], a[56:59], a[112:115], v[172:175]
  buffer_load_dwordx4 v4, s[8:11], s27 offen offset:0 lds
  v_cvt_pk_bf16_f32 v113, v114, v115
  v_mfma_f32_16x16x32_bf16 v[204:207], a[56:59], a[116:119], v[204:207]
  v_cvt_pk_bf16_f32 v114, v144, v145
  v_cvt_pk_bf16_f32 v115, v146, v147
  v_mfma_f32_16x16x32_bf16 v[168:171], a[16:19], a[88:91], v[168:171]
  v_cvt_pk_bf16_f32 v116, v116, v117
  v_cvt_pk_bf16_f32 v117, v118, v119
  v_mfma_f32_16x16x32_bf16 v[200:203], a[16:19], a[92:95], v[200:203]
  v_cvt_pk_bf16_f32 v118, v148, v149
  v_cvt_pk_bf16_f32 v119, v150, v151
  v_mfma_f32_16x16x32_bf16 v[168:171], a[52:55], a[112:115], v[168:171]
  ds_write_b128 v252, v[116:119] offset:2048
  v_cvt_pk_bf16_f32 v72, v180, v181
  v_mfma_f32_16x16x32_bf16 v[200:203], a[52:55], a[116:119], v[200:203]
  buffer_load_dwordx4 v5, s[8:11], s27 offen offset:1024 lds
  v_cvt_pk_bf16_f32 v73, v182, v183
  v_mfma_f32_16x16x32_bf16 v[164:167], a[12:15], a[88:91], v[164:167]
  v_cvt_pk_bf16_f32 v136, v212, v213
  v_cvt_pk_bf16_f32 v137, v214, v215
  v_mfma_f32_16x16x32_bf16 v[196:199], a[12:15], a[92:95], v[196:199]
  ds_write_b64 v252, v[72:73] offset:3072
  ds_write_b64 v252, v[136:137] offset:3080
  v_mfma_f32_16x16x32_bf16 v[164:167], a[48:51], a[112:115], v[164:167]
  v_cvt_pk_bf16_f32 v70, v176, v177
  v_cvt_pk_bf16_f32 v71, v178, v179
  v_mfma_f32_16x16x32_bf16 v[196:199], a[48:51], a[116:119], v[196:199]
  v_cvt_pk_bf16_f32 v134, v208, v209
  v_cvt_pk_bf16_f32 v135, v210, v211
  v_mfma_f32_16x16x32_bf16 v[160:163], a[8:11], a[88:91], v[160:163]
  buffer_load_dwordx4 v6, s[8:11], s27 offen offset:2048 lds
  v_cvt_pk_bf16_f32 v68, v172, v173
  v_mfma_f32_16x16x32_bf16 v[192:195], a[8:11], a[92:95], v[192:195]
  v_cvt_pk_bf16_f32 v69, v174, v175
  v_cvt_pk_bf16_f32 v132, v204, v205
  v_mfma_f32_16x16x32_bf16 v[160:163], a[44:47], a[112:115], v[160:163]
  v_cvt_pk_bf16_f32 v133, v206, v207
  v_cvt_pk_bf16_f32 v66, v168, v169
  v_mfma_f32_16x16x32_bf16 v[192:195], a[44:47], a[116:119], v[192:195]
  v_cvt_pk_bf16_f32 v67, v170, v171
  v_cvt_pk_bf16_f32 v130, v200, v201
  v_mfma_f32_16x16x32_bf16 v[156:159], a[4:7], a[88:91], v[156:159]
  v_cvt_pk_bf16_f32 v131, v202, v203
  v_cvt_pk_bf16_f32 v64, v164, v165
  v_mfma_f32_16x16x32_bf16 v[188:191], a[4:7], a[92:95], v[188:191]
  buffer_load_dwordx4 v7, s[8:11], s27 offen offset:3072 lds
  v_cvt_pk_bf16_f32 v65, v166, v167
  v_mfma_f32_16x16x32_bf16 v[156:159], a[40:43], a[112:115], v[156:159]
  s_bfe_u32 s29, 0x302010e, s53
  s_add_u32 s52, s52, s29
  s_add_u32 s53, s53, 8
  v_mfma_f32_16x16x32_bf16 v[188:191], a[40:43], a[116:119], v[188:191]
  s_and_b32 s53, s53, 0x8001f
  s_and_b32 s52, s52, 15
  s_lshl_b32 s29, s52, 7
  v_mfma_f32_16x16x32_bf16 v[152:155], a[0:3], a[88:91], v[152:155]
  s_or_b32 s26, s30, s29
  s_or_b32 s27, s31, s29
  v_cvt_pk_bf16_f32 v128, v196, v197
  v_mfma_f32_16x16x32_bf16 v[184:187], a[0:3], a[92:95], v[184:187]
  v_cvt_pk_bf16_f32 v129, v198, v199
  v_cvt_pk_bf16_f32 v62, v160, v161
  v_mfma_f32_16x16x32_bf16 v[152:155], a[36:39], a[112:115], v[152:155]
  v_cvt_pk_bf16_f32 v63, v162, v163
  v_cvt_pk_bf16_f32 v126, v192, v193
  v_mfma_f32_16x16x32_bf16 v[184:187], a[36:39], a[116:119], v[184:187]
  v_cvt_pk_bf16_f32 v127, v194, v195
  v_cvt_pk_bf16_f32 v60, v156, v157
  v_cvt_pk_bf16_f32 v61, v158, v159
  v_cvt_pk_bf16_f32 v124, v188, v189
  v_cvt_pk_bf16_f32 v125, v190, v191
  v_cvt_pk_bf16_f32 v58, v152, v153
  v_cvt_pk_bf16_f32 v59, v154, v155
  s_nop 0
  v_cvt_pk_bf16_f32 v122, v184, v185
  v_cvt_pk_bf16_f32 v123, v186, v187
  s_waitcnt lgkmcnt(0)
  s_barrier
  s_branch Lp2_at
Lp2_r1:
  s_and_b32 s4, s2, 7
  s_lshl_b32 s4, s4, 4
  s_add_u32 s4, s4, s59
  s_lshl_b32 s4, s4, 2
  s_add_u32 s4, s4, s3
  s_lshl_b32 s51, s4, 13
  s_mov_b32 m0, s36
  s_nop 0
  buffer_load_dwordx4 v224, s[8:11], s46 offen offset:0 lds
  buffer_load_dwordx4 v225, s[8:11], s46 offen offset:1024 lds
  buffer_load_dwordx4 v226, s[8:11], s46 offen offset:2048 lds
  buffer_load_dwordx4 v227, s[8:11], s46 offen offset:3072 lds
  s_add_u32 m0, s36, 4096
  s_nop 0
  buffer_load_dwordx4 v228, s[8:11], s46 offen offset:0 lds
  buffer_load_dwordx4 v229, s[8:11], s46 offen offset:1024 lds
  buffer_load_dwordx4 v230, s[8:11], s46 offen offset:2048 lds
  buffer_load_dwordx4 v231, s[8:11], s46 offen offset:3072 lds
  s_mul_i32 s47, s48, 393216
  s_bfe_u32 s34, 0x302010e, s49
  s_add_u32 s48, s48, s34
  s_add_u32 s49, s49, 8
  s_and_b32 s49, s49, 0x8001f
  s_and_b32 s48, s48, 15
  s_lshl_b32 s46, s48, 7
  s_mov_b32 m0, s41
  s_nop 0
  buffer_load_dwordx4 v233, s[12:15], s47 offen offset:0 lds
  buffer_load_dwordx4 v234, s[12:15], s47 offen offset:1024 lds
  buffer_load_dwordx4 v235, s[12:15], s47 offen offset:2048 lds
  s_add_u32 m0, s41, 3072
  s_nop 0
  buffer_load_dwordx4 v236, s[12:15], s47 offen offset:0 lds
  buffer_load_dwordx4 v237, s[12:15], s47 offen offset:1024 lds
  buffer_load_dwordx4 v238, s[12:15], s47 offen offset:2048 lds
  s_lshr_b32 s4, s3, 1
  s_lshl_b32 s4, s4, 14
  v_and_b32 v240, 15, v1
  v_lshlrev_b32 v240, 7, v240
  v_lshrrev_b32 v241, 4, v1
  v_and_b32 v242, 6, v1
  v_xor_b32 v241, v241, v242
  v_lshl_add_u32 v240, v241, 4, v240
  v_add_u32 v16, s4, v240
  v_xor_b32 v17, 64, v16
  v_and_b32 v240, 15, v1
  v_lshlrev_b32 v240, 7, v240
  v_lshrrev_b32 v241, 4, v1
  v_and_b32 v242, 6, v1
  v_xor_b32 v241, v241, v242
  v_lshl_add_u32 v240, v241, 4, v240
  v_add_u32 v18, 32768, v240
  v_xor_b32 v19, 64, v18
  v_lshrrev_b32 v240, 2, v1
  v_and_b32 v241, 6, v240
  v_lshlrev_b32 v240, 7, v240
  v_and_b32 v242, 1, v1
  v_lshl_add_u32 v240, v242, 3, v240
  v_add_u32 v240, 104448, v240
  v_bfe_u32 v242, v1, 1, 1
  v_xor_b32 v241, v241, v242
  v_xor_b32 v242, 0, v241
  v_lshl_add_u32 v20, v242, 4, v240
  v_xor_b32 v242, 2, v241
  v_lshl_add_u32 v21, v242, 4, v240
  s_and_b32 s4, s3, 1
  s_lshl_b32 s4, s4, 6
  v_xor_b32 v20, s4, v20
  s_add_u32 m0, s36, 34816
  s_nop 0
  buffer_load_dwordx4 v224, s[8:11], s46 offen offset:0 lds
  v_xor_b32 v21, s4, v21
  s_and_b32 s24, s2, 7
  s_lshr_b32 s4, s2, 6
  s_lshl_b32 s4, s4, 3
  s_add_u32 s24, s24, s4
  s_lshr_b32 s4, s2, 3
  s_and_b32 s25, s4, 6
  s_xor_b32 s4, s4, s2
  s_bfe_u32 s4, s4, 0x10003
  s_add_u32 s25, s25, s4
  v_accvgpr_write_b32 a244, -1
  v_accvgpr_write_b32 a245, -1
  v_accvgpr_write_b32 a246, -1
  v_accvgpr_write_b32 a247, -1
  v_lshrrev_b32 v24, 3, v1
  v_and_b32 v25, 6, v24
  v_and_b32 v26, 7, v1
  buffer_load_dwordx4 v225, s[8:11], s46 offen offset:1024 lds
  v_xor_b32 v25, v25, v26
  v_lshlrev_b32 v25, 4, v25
  s_and_b32 s4, s3, 1
  s_lshl_b32 s4, s4, 16
  s_lshr_b32 s5, s3, 1
  s_lshl_b32 s5, s5, 7
  s_add_u32 s4, s4, s5
  v_lshl_add_u32 v24, v24, 11, v25
  v_add_u32 v24, s4, v24
  v_add_u32 v25, 0, v24
  v_accvgpr_write_b32 a212, v25
  v_add_u32 v25, 15360, v24
  v_accvgpr_write_b32 a213, v25
  v_add_u32 v25, 30720, v24
  buffer_load_dwordx4 v226, s[8:11], s46 offen offset:2048 lds
  v_accvgpr_write_b32 a214, v25
  v_add_u32 v25, 46080, v24
  v_accvgpr_write_b32 a215, v25
  v_accvgpr_write_b32 a236, 0
  v_mov_b32 v27, 0x3f803f80
  v_accvgpr_write_b32 a208, v27
  v_accvgpr_write_b32 a237, 0
  v_accvgpr_write_b32 a209, v27
  buffer_load_dwordx4 v227, s[8:11], s46 offen offset:3072 lds
  v_accvgpr_write_b32 a238, 0
  v_accvgpr_write_b32 a210, v27
  v_accvgpr_write_b32 a239, 0
  v_accvgpr_write_b32 a211, v27
  v_lshrrev_b32 v24, 3, v1
  v_and_b32 v25, 6, v24
  v_and_b32 v26, 7, v1
  s_add_u32 m0, s36, 38912
  s_nop 0
  buffer_load_dwordx4 v228, s[8:11], s46 offen offset:0 lds
  v_xor_b32 v25, v25, v26
  v_lshlrev_b32 v25, 4, v25
  v_lshlrev_b32 v26, 2, v24
  v_add_u32 v26, s3, v26
  v_lshl_add_u32 v26, v26, 11, v25
  v_add_u32 v27, 0, v26
  v_accvgpr_write_b32 a222, v27
  v_add_u32 v27, 64512, v26
  buffer_load_dwordx4 v229, s[8:11], s46 offen offset:1024 lds
  v_accvgpr_write_b32 a223, v27
  v_add_u32 v27, 129024, v26
  v_accvgpr_write_b32 a224, v27
  v_add_u32 v27, 193536, v26
  v_accvgpr_write_b32 a225, v27
  v_lshrrev_b32 v26, 2, v24
  v_and_b32 v27, 3, v24
  v_lshl_add_u32 v26, v26, 3, v27
  s_and_b32 s4, s3, 1
  s_lshl_b32 s4, s4, 18
  s_lshr_b32 s5, s3, 1
  s_lshl_b32 s5, s5, 7
  s_add_u32 s4, s4, s5
  s_lshl_b32 s5, s24, 8
  s_add_u32 s4, s4, s5
  v_lshl_add_u32 v26, v26, 13, v25
  buffer_load_dwordx4 v230, s[8:11], s46 offen offset:2048 lds
  v_add_u32 v26, s4, v26
  v_add_u32 v27, 0, v26
  v_accvgpr_write_b32 a226, v27
  v_add_u32 v27, 130048, v26
  v_accvgpr_write_b32 a227, v27
  v_add_u32 v27, 30720, v26
  v_accvgpr_write_b32 a228, v27
  v_add_u32 v27, 160768, v26
  buffer_load_dwordx4 v231, s[8:11], s46 offen offset:3072 lds
  v_accvgpr_write_b32 a229, v27
  s_lshl_b32 s4, s3, 13
  s_add_u32 s4, s4, 98304
  v_and_b32 v24, 15, v1
  v_lshlrev_b32 v24, 7, v24
  v_lshrrev_b32 v25, 4, v1
  v_and_b32 v26, 6, v1
  v_xor_b32 v25, v25, v26
  v_lshl_add_u32 v24, v25, 4, v24
  v_add_u32 v28, s4, v24
  s_mul_i32 s47, s48, 393216
  s_bfe_u32 s34, 0x302010e, s49
  s_add_u32 s48, s48, s34
  s_add_u32 s49, s49, 8
  s_and_b32 s49, s49, 0x8001f
  s_and_b32 s48, s48, 15
  s_lshl_b32 s46, s48, 7
  s_add_u32 m0, s41, 24576
  s_nop 0
  buffer_load_dwordx4 v233, s[12:15], s47 offen offset:0 lds
  v_xor_b32 v29, 64, v28
  v_lshrrev_b32 v24, 2, v1
  v_and_b32 v25, 6, v24
  v_lshlrev_b32 v24, 7, v24
  v_and_b32 v26, 1, v1
  v_lshl_add_u32 v24, v26, 3, v24
  v_add_u32 v24, 0, v24
  v_bfe_u32 v26, v1, 1, 1
  buffer_load_dwordx4 v234, s[12:15], s47 offen offset:1024 lds
  v_xor_b32 v25, v25, v26
  v_xor_b32 v26, 0, v25
  v_lshl_add_u32 v30, v26, 4, v24
  v_xor_b32 v26, 2, v25
  v_lshl_add_u32 v31, v26, 4, v24
  v_xor_b32 v26, 4, v25
  v_lshl_add_u32 v32, v26, 4, v24
  v_xor_b32 v26, 6, v25
  buffer_load_dwordx4 v235, s[12:15], s47 offen offset:2048 lds
  v_lshl_add_u32 v33, v26, 4, v24
  v_accvgpr_write_b32 a230, v28
  v_accvgpr_write_b32 a231, v29
  v_accvgpr_write_b32 a232, v30
  v_accvgpr_write_b32 a233, v31
  v_accvgpr_write_b32 a234, v32
  v_accvgpr_write_b32 a235, v33
  s_add_u32 m0, s41, 27648
  s_nop 0
  buffer_load_dwordx4 v236, s[12:15], s47 offen offset:0 lds
  v_and_b32 v253, 15, v1
  v_lshrrev_b32 v254, 4, v1
  v_lshlrev_b32 v254, 2, v254
  v_sub_u32 v253, v253, v254
  v_mov_b32 v254, 0xf149f2ca
  s_lshr_b32 s4, s3, 1
  s_or_b32 s4, s4, s32
  s_cselect_b64 s[6:7], 0, -1
  v_subrev_u32 v255, 0, v253
  v_and_b32 v252, 0x80000001, v255
  v_cmp_ne_u32 vcc, 0, v252
  s_nop 1
  v_cndmask_b32 v244, 0, v254, vcc
  v_add_u32 v255, 1, v255
  v_and_b32 v252, 0x80000001, v255
  v_cmp_ne_u32 vcc, 0x80000001, v252
  s_nop 1
  v_cndmask_b32 v240, 0, v254, vcc
  buffer_load_dwordx4 v237, s[12:15], s47 offen offset:1024 lds
  v_cndmask_b32 v248, v240, v254, s[6:7]
  v_subrev_u32 v255, 1, v253
  v_and_b32 v252, 0x80000001, v255
  v_cmp_ne_u32 vcc, 0, v252
  s_nop 1
  v_cndmask_b32 v245, 0, v254, vcc
  v_add_u32 v255, 1, v255
  v_and_b32 v252, 0x80000001, v255
  v_cmp_ne_u32 vcc, 0x80000001, v252
  s_nop 1
  v_cndmask_b32 v241, 0, v254, vcc
  v_cndmask_b32 v249, v241, v254, s[6:7]
  v_subrev_u32 v255, 2, v253
  v_and_b32 v252, 0x80000001, v255
  v_cmp_ne_u32 vcc, 0, v252
  s_nop 1
  v_cndmask_b32 v246, 0, v254, vcc
  buffer_load_dwordx4 v238, s[12:15], s47 offen offset:2048 lds
  v_add_u32 v255, 1, v255
  v_and_b32 v252, 0x80000001, v255
  v_cmp_ne_u32 vcc, 0x80000001, v252
  s_nop 1
  v_cndmask_b32 v242, 0, v254, vcc
  v_cndmask_b32 v250, v242, v254, s[6:7]
  v_subrev_u32 v255, 3, v253
  v_and_b32 v252, 0x80000001, v255
  v_cmp_ne_u32 vcc, 0, v252
  s_nop 1
  v_cndmask_b32 v247, 0, v254, vcc
  v_add_u32 v255, 1, v255
  v_and_b32 v252, 0x80000001, v255
  v_cmp_ne_u32 vcc, 0x80000001, v252
  s_nop 1
  v_cndmask_b32 v243, 0, v254, vcc
  v_cndmask_b32 v251, v243, v254, s[6:7]
  s_and_b32 s4, s3, 1
  s_lshl_b32 s4, s4, 12
  s_add_u32 s4, s4, 49152
  v_add_u32 v252, s4, v2
  s_lshr_b32 s5, s3, 1
  s_lshl_b32 s5, s5, 11
  v_add_u32 v253, s5, v252
  s_add_u32 s16, s86, 83886080
  s_addc_u32 s17, s87, 0
  s_mov_b32 s18, 4194304
  s_mov_b32 s19, 0x00020000
  s_lshl_b32 s57, s32, 19
  s_lshl_b32 s5, s5, 7
  s_add_u32 s57, s57, s5
  s_lshl_b32 s4, s33, 14
  s_add_u32 s57, s57, s4
  s_and_b32 s4, s3, 1
  s_lshl_b32 s4, s4, 13
  s_add_u32 s57, s57, s4
  s_add_u32 s58, s57, 4096
  s_mov_b32 s37, 0
  s_mov_b32 s39, 4294897664
  s_mov_b32 s40, 34816
  s_mov_b32 s42, 0
  s_mov_b32 s44, 4294942720
  s_mov_b32 s45, 24576
  s_mov_b32 s43, s44
  s_mov_b32 s52, s72
  s_mov_b32 s53, s73
  s_mov_b32 s54, 4194304
  s_mov_b32 s55, 0x00020000
  s_lshl_b32 s1, s51, 1
  s_mov_b32 s56, s51
  s_mov_b32 s0, 0
  s_waitcnt vmcnt(14)
  s_barrier
  ds_read_b128 a[0:3], v16 offset:0
  ds_read_b64_tr_b16 a[72:73], v20 offset:0
  ds_read_b64_tr_b16 a[74:75], v20 offset:2048
  ds_read_b128 a[4:7], v16 offset:2048
  ds_read_b128 a[8:11], v16 offset:4096
  ds_read_b128 a[12:15], v16 offset:6144
  ds_read_b128 a[16:19], v16 offset:8192
  ds_read_b128 a[20:23], v16 offset:10240
  ds_read_b128 a[24:27], v16 offset:12288
  ds_read_b128 a[28:31], v16 offset:14336
  ds_read_b64_tr_b16 a[76:77], v21 offset:0
  ds_read_b64_tr_b16 a[78:79], v21 offset:2048
  ds_read_b64_tr_b16 a[80:81], v20 offset:8192
  ds_read_b64_tr_b16 a[82:83], v20 offset:10240
  ds_read_b64_tr_b16 a[84:85], v21 offset:8192
  ds_read_b64_tr_b16 a[86:87], v21 offset:10240
  ds_read_b64_tr_b16 a[88:89], v20 offset:16384
  ds_read_b64_tr_b16 a[90:91], v20 offset:18432
  ds_read_b128 a[32:35], v18 offset:0
  ds_read_b64_tr_b16 a[92:93], v21 offset:16384
  ds_read_b64_tr_b16 a[94:95], v21 offset:18432
  s_waitcnt lgkmcnt(0)
  v_mfma_f32_16x16x32_bf16 v[24:27], a[72:75], a[0:3], 0
  s_add_u32 m0, s36, 69632
  ds_read_b128 a[36:39], v17 offset:0
  v_mfma_f32_16x16x32_bf16 v[28:31], a[72:75], a[4:7], 0
  buffer_load_dwordx4 v224, s[8:11], s46 offen offset:0 lds
  ds_read_b64_tr_b16 a[96:97], v20 offset:4096
  v_mfma_f32_16x16x32_bf16 v[32:35], a[72:75], a[8:11], 0
  v_mfma_f32_16x16x32_bf16 v[36:39], a[72:75], a[12:15], 0
  ds_read_b64_tr_b16 a[98:99], v20 offset:6144
  v_mfma_f32_16x16x32_bf16 v[40:43], a[72:75], a[16:19], 0
  v_mfma_f32_16x16x32_bf16 v[44:47], a[72:75], a[20:23], 0
  buffer_load_dwordx4 v225, s[8:11], s46 offen offset:1024 lds
  ds_read_b128 a[40:43], v17 offset:2048
  v_mfma_f32_16x16x32_bf16 v[48:51], a[72:75], a[24:27], 0
  v_mfma_f32_16x16x32_bf16 v[52:55], a[72:75], a[28:31], 0
  ds_read_b128 a[44:47], v17 offset:4096
  v_mfma_f32_16x16x32_bf16 v[56:59], a[76:79], a[0:3], 0
  v_mfma_f32_16x16x32_bf16 v[60:63], a[76:79], a[4:7], 0
  ds_read_b128 a[48:51], v17 offset:6144
  v_mfma_f32_16x16x32_bf16 v[64:67], a[76:79], a[8:11], 0
  buffer_load_dwordx4 v226, s[8:11], s46 offen offset:2048 lds
  v_mfma_f32_16x16x32_bf16 v[68:71], a[76:79], a[12:15], 0
  ds_read_b128 a[52:55], v17 offset:8192
  v_mfma_f32_16x16x32_bf16 v[72:75], a[76:79], a[16:19], 0
  v_mfma_f32_16x16x32_bf16 v[76:79], a[76:79], a[20:23], 0
  ds_read_b128 a[56:59], v17 offset:10240
  v_mfma_f32_16x16x32_bf16 v[80:83], a[76:79], a[24:27], 0
  v_mfma_f32_16x16x32_bf16 v[84:87], a[76:79], a[28:31], 0
  ds_read_b128 a[60:63], v17 offset:12288
  v_mfma_f32_16x16x32_bf16 v[88:91], a[80:83], a[0:3], 0
  buffer_load_dwordx4 v227, s[8:11], s46 offen offset:3072 lds
  v_mfma_f32_16x16x32_bf16 v[92:95], a[80:83], a[4:7], 0
  s_add_u32 m0, s36, 73728
  ds_read_b128 a[64:67], v17 offset:14336
  v_mfma_f32_16x16x32_bf16 v[96:99], a[80:83], a[8:11], 0
  v_mfma_f32_16x16x32_bf16 v[100:103], a[80:83], a[12:15], 0
  ds_read_b64_tr_b16 a[100:101], v21 offset:4096
  v_mfma_f32_16x16x32_bf16 v[104:107], a[80:83], a[16:19], 0
  ds_read_b64_tr_b16 a[102:103], v21 offset:6144
  v_mfma_f32_16x16x32_bf16 v[108:111], a[80:83], a[20:23], 0
  buffer_load_dwordx4 v228, s[8:11], s46 offen offset:0 lds
  v_mfma_f32_16x16x32_bf16 v[112:115], a[80:83], a[24:27], 0
  ds_read_b64_tr_b16 a[104:105], v20 offset:12288
  v_mfma_f32_16x16x32_bf16 v[116:119], a[80:83], a[28:31], 0
  v_mfma_f32_16x16x32_bf16 v[120:123], a[84:87], a[0:3], 0
  ds_read_b64_tr_b16 a[106:107], v20 offset:14336
  v_mfma_f32_16x16x32_bf16 v[124:127], a[84:87], a[4:7], 0
  v_mfma_f32_16x16x32_bf16 v[128:131], a[84:87], a[8:11], 0
  buffer_load_dwordx4 v229, s[8:11], s46 offen offset:1024 lds
  ds_read_b64_tr_b16 a[108:109], v21 offset:12288
  v_mfma_f32_16x16x32_bf16 v[132:135], a[84:87], a[12:15], 0
  v_mfma_f32_16x16x32_bf16 v[136:139], a[84:87], a[16:19], 0
  ds_read_b64_tr_b16 a[110:111], v21 offset:14336
  v_mfma_f32_16x16x32_bf16 v[140:143], a[84:87], a[20:23], 0
  v_mfma_f32_16x16x32_bf16 v[144:147], a[84:87], a[24:27], 0
  ds_read_b64_tr_b16 a[112:113], v20 offset:20480
  v_mfma_f32_16x16x32_bf16 v[148:151], a[84:87], a[28:31], 0
  v_mfma_f32_16x16x32_bf16 v[152:155], a[0:3], a[88:91], 0
  buffer_load_dwordx4 v230, s[8:11], s46 offen offset:2048 lds
  ds_read_b64_tr_b16 a[114:115], v20 offset:22528
  v_mfma_f32_16x16x32_bf16 v[156:159], a[4:7], a[88:91], 0
  v_mfma_f32_16x16x32_bf16 v[160:163], a[8:11], a[88:91], 0
  ds_read_b128 a[68:71], v19 offset:0
  v_mfma_f32_16x16x32_bf16 v[164:167], a[12:15], a[88:91], 0
  v_mfma_f32_16x16x32_bf16 v[168:171], a[16:19], a[88:91], 0
  ds_read_b64_tr_b16 a[116:117], v21 offset:20480
  v_mfma_f32_16x16x32_bf16 v[172:175], a[20:23], a[88:91], 0
  buffer_load_dwordx4 v231, s[8:11], s46 offen offset:3072 lds
  v_mfma_f32_16x16x32_bf16 v[176:179], a[24:27], a[88:91], 0
  s_mul_i32 s47, s48, 393216
  s_bfe_u32 s34, 0x302010e, s49
  s_add_u32 s48, s48, s34
  v_mfma_f32_16x16x32_bf16 v[180:183], a[28:31], a[88:91], 0
  s_add_u32 s49, s49, 8
  s_and_b32 s49, s49, 0x8001f
  s_and_b32 s48, s48, 15
  v_mfma_f32_16x16x32_bf16 v[216:219], a[32:35], a[88:91], 0
  s_lshl_b32 s46, s48, 7
  ds_read_b64_tr_b16 a[118:119], v21 offset:22528
  v_mfma_f32_16x16x32_bf16 v[184:187], a[0:3], a[92:95], 0
  s_add_u32 s37, s37, 1
  s_cmp_eq_u32 s37, 3
  s_cselect_b32 s37, 0, s37
  s_cselect_b32 s38, s39, s40
  v_mfma_f32_16x16x32_bf16 v[188:191], a[4:7], a[92:95], 0
  s_sub_u32 s43, 0, s43
  v_mfma_f32_16x16x32_bf16 v[192:195], a[8:11], a[92:95], 0
  v_add_u32 v16, s38, v16
  v_add_u32 v17, s38, v17
  v_mfma_f32_16x16x32_bf16 v[196:199], a[12:15], a[92:95], 0
  v_add_u32 v18, s38, v18
  v_add_u32 v19, s38, v19
  v_mfma_f32_16x16x32_bf16 v[200:203], a[16:19], a[92:95], 0
  v_add_u32 v20, s43, v20
  v_add_u32 v21, s43, v21
  v_mfma_f32_16x16x32_bf16 v[204:207], a[20:23], a[92:95], 0
  v_mfma_f32_16x16x32_bf16 v[208:211], a[24:27], a[92:95], 0
  v_mfma_f32_16x16x32_bf16 v[212:215], a[28:31], a[92:95], 0
  v_mfma_f32_16x16x32_bf16 v[220:223], a[32:35], a[92:95], 0
  s_mov_b32 s35, 13
  s_waitcnt vmcnt(8) lgkmcnt(0)
  s_barrier
  .p2align 6
Lp2r1_loop:
  v_mfma_f32_16x16x32_bf16 v[24:27], a[96:99], a[36:39], v[24:27]
  buffer_load_dwordx4 a[192:195], v2, s[52:55], s51 offen offset:0
  ds_read_b128 a[0:3], v16 offset:0
  v_mfma_f32_16x16x32_bf16 v[28:31], a[96:99], a[40:43], v[28:31]
  ds_read_b64_tr_b16 a[72:73], v20 offset:0
  v_mfma_f32_16x16x32_bf16 v[32:35], a[96:99], a[44:47], v[32:35]
  v_mfma_f32_16x16x32_bf16 v[36:39], a[96:99], a[48:51], v[36:39]
  ds_read_b64_tr_b16 a[74:75], v20 offset:2048
  v_mfma_f32_16x16x32_bf16 v[40:43], a[96:99], a[52:55], v[40:43]
  v_mfma_f32_16x16x32_bf16 v[44:47], a[96:99], a[56:59], v[44:47]
  buffer_load_dwordx4 a[192:195], v2, s[52:55], s51 offen offset:1024
  ds_read_b128 a[4:7], v16 offset:2048
  v_mfma_f32_16x16x32_bf16 v[48:51], a[96:99], a[60:63], v[48:51]
  v_mfma_f32_16x16x32_bf16 v[52:55], a[96:99], a[64:67], v[52:55]
  ds_read_b128 a[8:11], v16 offset:4096
  v_mfma_f32_16x16x32_bf16 v[56:59], a[100:103], a[36:39], v[56:59]
  v_mfma_f32_16x16x32_bf16 v[60:63], a[100:103], a[40:43], v[60:63]
  ds_read_b128 a[12:15], v16 offset:6144
  v_mfma_f32_16x16x32_bf16 v[64:67], a[100:103], a[44:47], v[64:67]
  buffer_load_dwordx4 a[192:195], v2, s[52:55], s51 offen offset:2048
  v_mfma_f32_16x16x32_bf16 v[68:71], a[100:103], a[48:51], v[68:71]
  ds_read_b128 a[16:19], v16 offset:8192
  v_mfma_f32_16x16x32_bf16 v[72:75], a[100:103], a[52:55], v[72:75]
  v_mfma_f32_16x16x32_bf16 v[76:79], a[100:103], a[56:59], v[76:79]
  ds_read_b128 a[20:23], v16 offset:10240
  v_mfma_f32_16x16x32_bf16 v[80:83], a[100:103], a[60:63], v[80:83]
  v_mfma_f32_16x16x32_bf16 v[84:87], a[100:103], a[64:67], v[84:87]
  ds_read_b128 a[24:27], v16 offset:12288
  v_mfma_f32_16x16x32_bf16 v[88:91], a[104:107], a[36:39], v[88:91]
  buffer_load_dwordx4 a[192:195], v2, s[52:55], s51 offen offset:3072
  v_mfma_f32_16x16x32_bf16 v[92:95], a[104:107], a[40:43], v[92:95]
  s_add_u32 s51, s51, 4096
  s_add_u32 s0, s0, 1
  s_cmp_eq_u32 s0, 2
  s_cselect_b32 s52, s68, s52
  s_cselect_b32 s53, s69, s53
  s_cselect_b32 s51, s1, s51
  s_cselect_b32 s54, 0, s54
  v_mfma_f32_16x16x32_bf16 v[96:99], a[104:107], a[44:47], v[96:99]
  s_cmp_eq_u32 s0, 6
  s_cselect_b32 s52, s64, s52
  s_cselect_b32 s53, s65, s53
  s_cselect_b32 s51, s56, s51
  s_cselect_b32 s54, 0, s54
  v_mfma_f32_16x16x32_bf16 v[100:103], a[104:107], a[48:51], v[100:103]
  s_cmp_eq_u32 s0, 8
  s_cselect_b32 s54, 0, s54
  s_mov_b32 m0, s41
  v_mfma_f32_16x16x32_bf16 v[104:107], a[104:107], a[52:55], v[104:107]
  ds_read_b128 a[28:31], v16 offset:14336
  ds_read_b64_tr_b16 a[76:77], v21 offset:0
  v_mfma_f32_16x16x32_bf16 v[108:111], a[104:107], a[56:59], v[108:111]
  buffer_load_dwordx4 v233, s[12:15], s47 offen offset:0 lds
  ds_read_b64_tr_b16 a[78:79], v21 offset:2048
  v_mfma_f32_16x16x32_bf16 v[112:115], a[104:107], a[60:63], v[112:115]
  ds_read_b64_tr_b16 a[80:81], v20 offset:8192
  v_mfma_f32_16x16x32_bf16 v[116:119], a[104:107], a[64:67], v[116:119]
  v_mfma_f32_16x16x32_bf16 v[120:123], a[108:111], a[36:39], v[120:123]
  ds_read_b64_tr_b16 a[82:83], v20 offset:10240
  v_mfma_f32_16x16x32_bf16 v[124:127], a[108:111], a[40:43], v[124:127]
  v_mfma_f32_16x16x32_bf16 v[128:131], a[108:111], a[44:47], v[128:131]
  ds_read_b64_tr_b16 a[84:85], v21 offset:8192
  v_mfma_f32_16x16x32_bf16 v[132:135], a[108:111], a[48:51], v[132:135]
  buffer_load_dwordx4 v234, s[12:15], s47 offen offset:1024 lds
  v_mfma_f32_16x16x32_bf16 v[136:139], a[108:111], a[52:55], v[136:139]
  ds_read_b64_tr_b16 a[86:87], v21 offset:10240
  v_mfma_f32_16x16x32_bf16 v[140:143], a[108:111], a[56:59], v[140:143]
  v_mfma_f32_16x16x32_bf16 v[144:147], a[108:111], a[60:63], v[144:147]
  ds_read_b64_tr_b16 a[88:89], v20 offset:16384
  v_mfma_f32_16x16x32_bf16 v[148:151], a[108:111], a[64:67], v[148:151]
  v_mfma_f32_16x16x32_bf16 v[152:155], a[36:39], a[112:115], v[152:155]
  buffer_load_dwordx4 v235, s[12:15], s47 offen offset:2048 lds
  ds_read_b64_tr_b16 a[90:91], v20 offset:18432
  v_mfma_f32_16x16x32_bf16 v[156:159], a[40:43], a[112:115], v[156:159]
  s_add_u32 m0, s41, 3072
  v_mfma_f32_16x16x32_bf16 v[160:163], a[44:47], a[112:115], v[160:163]
  ds_read_b128 a[32:35], v18 offset:0
  v_mfma_f32_16x16x32_bf16 v[164:167], a[48:51], a[112:115], v[164:167]
  v_mfma_f32_16x16x32_bf16 v[168:171], a[52:55], a[112:115], v[168:171]
  ds_read_b64_tr_b16 a[92:93], v21 offset:16384
  v_mfma_f32_16x16x32_bf16 v[172:175], a[56:59], a[112:115], v[172:175]
  v_mfma_f32_16x16x32_bf16 v[176:179], a[60:63], a[112:115], v[176:179]
  buffer_load_dwordx4 v236, s[12:15], s47 offen offset:0 lds
  ds_read_b64_tr_b16 a[94:95], v21 offset:18432
  v_mfma_f32_16x16x32_bf16 v[180:183], a[64:67], a[112:115], v[180:183]
  v_mfma_f32_16x16x32_bf16 v[216:219], a[68:71], a[112:115], v[216:219]
  v_mfma_f32_16x16x32_bf16 v[184:187], a[36:39], a[116:119], v[184:187]
  v_mfma_f32_16x16x32_bf16 v[188:191], a[40:43], a[116:119], v[188:191]
  v_mfma_f32_16x16x32_bf16 v[192:195], a[44:47], a[116:119], v[192:195]
  buffer_load_dwordx4 v237, s[12:15], s47 offen offset:1024 lds
  v_mfma_f32_16x16x32_bf16 v[196:199], a[48:51], a[116:119], v[196:199]
  v_mfma_f32_16x16x32_bf16 v[200:203], a[52:55], a[116:119], v[200:203]
  v_mfma_f32_16x16x32_bf16 v[204:207], a[56:59], a[116:119], v[204:207]
  v_mfma_f32_16x16x32_bf16 v[208:211], a[60:63], a[116:119], v[208:211]
  v_mfma_f32_16x16x32_bf16 v[212:215], a[64:67], a[116:119], v[212:215]
  v_mfma_f32_16x16x32_bf16 v[220:223], a[68:71], a[116:119], v[220:223]
  s_waitcnt lgkmcnt(0)
  v_mfma_f32_16x16x32_bf16 v[24:27], a[72:75], a[0:3], v[24:27]
  buffer_load_dwordx4 v238, s[12:15], s47 offen offset:2048 lds
  ds_read_b128 a[36:39], v17 offset:0
  v_mfma_f32_16x16x32_bf16 v[28:31], a[72:75], a[4:7], v[28:31]
  s_mov_b32 m0, s36
  ds_read_b64_tr_b16 a[96:97], v20 offset:4096
  v_mfma_f32_16x16x32_bf16 v[32:35], a[72:75], a[8:11], v[32:35]
  v_mfma_f32_16x16x32_bf16 v[36:39], a[72:75], a[12:15], v[36:39]
  ds_read_b64_tr_b16 a[98:99], v20 offset:6144
  v_mfma_f32_16x16x32_bf16 v[40:43], a[72:75], a[16:19], v[40:43]
  buffer_load_dwordx4 v224, s[8:11], s46 offen offset:0 lds
  v_mfma_f32_16x16x32_bf16 v[44:47], a[72:75], a[20:23], v[44:47]
  ds_read_b128 a[40:43], v17 offset:2048
  v_mfma_f32_16x16x32_bf16 v[48:51], a[72:75], a[24:27], v[48:51]
  v_mfma_f32_16x16x32_bf16 v[52:55], a[72:75], a[28:31], v[52:55]
  ds_read_b128 a[44:47], v17 offset:4096
  v_mfma_f32_16x16x32_bf16 v[56:59], a[76:79], a[0:3], v[56:59]
  v_mfma_f32_16x16x32_bf16 v[60:63], a[76:79], a[4:7], v[60:63]
  buffer_load_dwordx4 v225, s[8:11], s46 offen offset:1024 lds
  ds_read_b128 a[48:51], v17 offset:6144
  v_mfma_f32_16x16x32_bf16 v[64:67], a[76:79], a[8:11], v[64:67]
  v_mfma_f32_16x16x32_bf16 v[68:71], a[76:79], a[12:15], v[68:71]
  ds_read_b128 a[52:55], v17 offset:8192
  v_mfma_f32_16x16x32_bf16 v[72:75], a[76:79], a[16:19], v[72:75]
  v_mfma_f32_16x16x32_bf16 v[76:79], a[76:79], a[20:23], v[76:79]
  ds_read_b128 a[56:59], v17 offset:10240
  v_mfma_f32_16x16x32_bf16 v[80:83], a[76:79], a[24:27], v[80:83]
  buffer_load_dwordx4 v226, s[8:11], s46 offen offset:2048 lds
  v_mfma_f32_16x16x32_bf16 v[84:87], a[76:79], a[28:31], v[84:87]
  ds_read_b128 a[60:63], v17 offset:12288
  v_mfma_f32_16x16x32_bf16 v[88:91], a[80:83], a[0:3], v[88:91]
  v_mfma_f32_16x16x32_bf16 v[92:95], a[80:83], a[4:7], v[92:95]
  ds_read_b128 a[64:67], v17 offset:14336
  v_mfma_f32_16x16x32_bf16 v[96:99], a[80:83], a[8:11], v[96:99]
  v_mfma_f32_16x16x32_bf16 v[100:103], a[80:83], a[12:15], v[100:103]
  buffer_load_dwordx4 v227, s[8:11], s46 offen offset:3072 lds
  ds_read_b64_tr_b16 a[100:101], v21 offset:4096
  v_mfma_f32_16x16x32_bf16 v[104:107], a[80:83], a[16:19], v[104:107]
  s_add_u32 m0, s36, 4096
  ds_read_b64_tr_b16 a[102:103], v21 offset:6144
  v_mfma_f32_16x16x32_bf16 v[108:111], a[80:83], a[20:23], v[108:111]
  v_mfma_f32_16x16x32_bf16 v[112:115], a[80:83], a[24:27], v[112:115]
  ds_read_b64_tr_b16 a[104:105], v20 offset:12288
  v_mfma_f32_16x16x32_bf16 v[116:119], a[80:83], a[28:31], v[116:119]
  buffer_load_dwordx4 v228, s[8:11], s46 offen offset:0 lds
  v_mfma_f32_16x16x32_bf16 v[120:123], a[84:87], a[0:3], v[120:123]
  ds_read_b64_tr_b16 a[106:107], v20 offset:14336
  v_mfma_f32_16x16x32_bf16 v[124:127], a[84:87], a[4:7], v[124:127]
  v_mfma_f32_16x16x32_bf16 v[128:131], a[84:87], a[8:11], v[128:131]
  ds_read_b64_tr_b16 a[108:109], v21 offset:12288
  v_mfma_f32_16x16x32_bf16 v[132:135], a[84:87], a[12:15], v[132:135]
  v_mfma_f32_16x16x32_bf16 v[136:139], a[84:87], a[16:19], v[136:139]
  buffer_load_dwordx4 v229, s[8:11], s46 offen offset:1024 lds
  ds_read_b64_tr_b16 a[110:111], v21 offset:14336
  v_mfma_f32_16x16x32_bf16 v[140:143], a[84:87], a[20:23], v[140:143]
  v_mfma_f32_16x16x32_bf16 v[144:147], a[84:87], a[24:27], v[144:147]
  ds_read_b64_tr_b16 a[112:113], v20 offset:20480
  v_mfma_f32_16x16x32_bf16 v[148:151], a[84:87], a[28:31], v[148:151]
  v_mfma_f32_16x16x32_bf16 v[152:155], a[0:3], a[88:91], v[152:155]
  ds_read_b64_tr_b16 a[114:115], v20 offset:22528
  v_mfma_f32_16x16x32_bf16 v[156:159], a[4:7], a[88:91], v[156:159]
  buffer_load_dwordx4 v230, s[8:11], s46 offen offset:2048 lds
  v_mfma_f32_16x16x32_bf16 v[160:163], a[8:11], a[88:91], v[160:163]
  ds_read_b128 a[68:71], v19 offset:0
  v_mfma_f32_16x16x32_bf16 v[164:167], a[12:15], a[88:91], v[164:167]
  v_mfma_f32_16x16x32_bf16 v[168:171], a[16:19], a[88:91], v[168:171]
  ds_read_b64_tr_b16 a[116:117], v21 offset:20480
  v_mfma_f32_16x16x32_bf16 v[172:175], a[20:23], a[88:91], v[172:175]
  v_mfma_f32_16x16x32_bf16 v[176:179], a[24:27], a[88:91], v[176:179]
  buffer_load_dwordx4 v231, s[8:11], s46 offen offset:3072 lds
  ds_read_b64_tr_b16 a[118:119], v21 offset:22528
  v_mfma_f32_16x16x32_bf16 v[180:183], a[28:31], a[88:91], v[180:183]
  s_mul_i32 s47, s48, 393216
  s_bfe_u32 s34, 0x302010e, s49
  s_add_u32 s48, s48, s34
  v_mfma_f32_16x16x32_bf16 v[216:219], a[32:35], a[88:91], v[216:219]
  s_add_u32 s49, s49, 8
  s_and_b32 s49, s49, 0x8001f
  s_and_b32 s48, s48, 15
  v_mfma_f32_16x16x32_bf16 v[184:187], a[0:3], a[92:95], v[184:187]
  s_lshl_b32 s46, s48, 7
  v_mfma_f32_16x16x32_bf16 v[188:191], a[4:7], a[92:95], v[188:191]
  s_add_u32 s36, s36, s38
  s_add_u32 s37, s37, 1
  s_cmp_eq_u32 s37, 3
  s_cselect_b32 s37, 0, s37
  s_cselect_b32 s38, s39, s40
  v_mfma_f32_16x16x32_bf16 v[192:195], a[8:11], a[92:95], v[192:195]
  s_add_u32 s41, s41, s43
  s_sub_u32 s43, 0, s43
  v_mfma_f32_16x16x32_bf16 v[196:199], a[12:15], a[92:95], v[196:199]
  v_add_u32 v16, s38, v16
  v_add_u32 v17, s38, v17
  v_mfma_f32_16x16x32_bf16 v[200:203], a[16:19], a[92:95], v[200:203]
  v_add_u32 v18, s38, v18
  v_add_u32 v19, s38, v19
  v_mfma_f32_16x16x32_bf16 v[204:207], a[20:23], a[92:95], v[204:207]
  v_add_u32 v20, s43, v20
  v_add_u32 v21, s43, v21
  v_mfma_f32_16x16x32_bf16 v[208:211], a[24:27], a[92:95], v[208:211]
  s_waitcnt vmcnt(8) lgkmcnt(0)
  s_barrier
  v_mfma_f32_16x16x32_bf16 v[212:215], a[28:31], a[92:95], v[212:215]
  s_sub_u32 s35, s35, 1
  v_mfma_f32_16x16x32_bf16 v[220:223], a[32:35], a[92:95], v[220:223]
  s_cmp_lg_u32 s35, 0
  s_cbranch_scc1 Lp2r1_loop
  v_accvgpr_read_b32 v4, a222
  v_accvgpr_read_b32 v5, a223
  v_accvgpr_read_b32 v6, a224
  v_accvgpr_read_b32 v7, a225
  v_accvgpr_read_b32 v8, a226
  v_accvgpr_read_b32 v9, a227
  v_accvgpr_read_b32 v10, a228
  v_accvgpr_read_b32 v11, a229
  s_mov_b32 s8, s64
  s_mov_b32 s9, s65
  s_mov_b32 s10, 4194304
  s_mov_b32 s11, 0x00020000
  s_mov_b32 s20, s68
  s_mov_b32 s21, s69
  s_mov_b32 s22, 8388608
  s_mov_b32 s23, 0x00020000
  s_and_b32 s4, s2, 7
  s_lshl_b32 s4, s4, 1
  s_lshr_b32 s5, s2, 6
  s_lshr_b32 s30, s2, 4
  s_add_u32 s5, s5, s30
  s_and_b32 s53, s5, 3
  s_lshl_b32 s53, s53, 3
  s_or_b32 s53, s53, 0x80000
  s_bfe_u32 s52, 0xf0f02, s53
  s_add_u32 s52, s52, s4
  s_and_b32 s52, s52, 15
  s_mov_b32 s54, s52
  s_mov_b32 s55, s53
  s_lshl_b32 s29, s52, 7
  s_lshl_b32 s28, s54, 19
  s_lshl_b32 s30, s25, 18
  s_and_b32 s31, s25, 1
  s_lshl_b32 s31, s31, 1
  s_add_u32 s31, s31, 14
  s_sub_u32 s31, s31, s25
  s_lshl_b32 s31, s31, 18
  s_or_b32 s26, s30, s29
  s_or_b32 s27, s31, s29
  s_lshl_b32 s68, s3, 12
  s_lshl_b32 s88, s3, 13
  s_add_u32 s88, s88, 98304
  v_mfma_f32_16x16x32_bf16 v[24:27], a[96:99], a[36:39], v[24:27]
  s_mov_b32 m0, s41
  ds_read_b128 a[0:3], v16 offset:0
  v_mfma_f32_16x16x32_bf16 v[28:31], a[96:99], a[40:43], v[28:31]
  buffer_load_dwordx4 v233, s[12:15], s47 offen offset:0 lds
  ds_read_b64_tr_b16 a[72:73], v20 offset:0
  v_mfma_f32_16x16x32_bf16 v[32:35], a[96:99], a[44:47], v[32:35]
  v_mfma_f32_16x16x32_bf16 v[36:39], a[96:99], a[48:51], v[36:39]
  ds_read_b64_tr_b16 a[74:75], v20 offset:2048
  v_mfma_f32_16x16x32_bf16 v[40:43], a[96:99], a[52:55], v[40:43]
  v_mfma_f32_16x16x32_bf16 v[44:47], a[96:99], a[56:59], v[44:47]
  ds_read_b128 a[4:7], v16 offset:2048
  v_mfma_f32_16x16x32_bf16 v[48:51], a[96:99], a[60:63], v[48:51]
  v_mfma_f32_16x16x32_bf16 v[52:55], a[96:99], a[64:67], v[52:55]
  ds_read_b128 a[8:11], v16 offset:4096
  v_mfma_f32_16x16x32_bf16 v[56:59], a[100:103], a[36:39], v[56:59]
  v_mfma_f32_16x16x32_bf16 v[60:63], a[100:103], a[40:43], v[60:63]
  ds_read_b128 a[12:15], v16 offset:6144
  v_mfma_f32_16x16x32_bf16 v[64:67], a[100:103], a[44:47], v[64:67]
  v_mfma_f32_16x16x32_bf16 v[68:71], a[100:103], a[48:51], v[68:71]
  ds_read_b128 a[16:19], v16 offset:8192
  v_mfma_f32_16x16x32_bf16 v[72:75], a[100:103], a[52:55], v[72:75]
  v_mfma_f32_16x16x32_bf16 v[76:79], a[100:103], a[56:59], v[76:79]
  ds_read_b128 a[20:23], v16 offset:10240
  v_mfma_f32_16x16x32_bf16 v[80:83], a[100:103], a[60:63], v[80:83]
  v_mfma_f32_16x16x32_bf16 v[84:87], a[100:103], a[64:67], v[84:87]
  ds_read_b128 a[24:27], v16 offset:12288
  v_mfma_f32_16x16x32_bf16 v[88:91], a[104:107], a[36:39], v[88:91]
  buffer_load_dwordx4 v234, s[12:15], s47 offen offset:1024 lds
  v_mfma_f32_16x16x32_bf16 v[92:95], a[104:107], a[40:43], v[92:95]
  ds_read_b128 a[28:31], v16 offset:14336
  v_mfma_f32_16x16x32_bf16 v[96:99], a[104:107], a[44:47], v[96:99]
  v_mfma_f32_16x16x32_bf16 v[100:103], a[104:107], a[48:51], v[100:103]
  ds_read_b64_tr_b16 a[76:77], v21 offset:0
  v_mfma_f32_16x16x32_bf16 v[104:107], a[104:107], a[52:55], v[104:107]
  ds_read_b64_tr_b16 a[78:79], v21 offset:2048
  v_mfma_f32_16x16x32_bf16 v[108:111], a[104:107], a[56:59], v[108:111]
  v_mfma_f32_16x16x32_bf16 v[112:115], a[104:107], a[60:63], v[112:115]
  ds_read_b64_tr_b16 a[80:81], v20 offset:8192
  v_mfma_f32_16x16x32_bf16 v[116:119], a[104:107], a[64:67], v[116:119]
  v_mfma_f32_16x16x32_bf16 v[120:123], a[108:111], a[36:39], v[120:123]
  ds_read_b64_tr_b16 a[82:83], v20 offset:10240
  v_mfma_f32_16x16x32_bf16 v[124:127], a[108:111], a[40:43], v[124:127]
  v_mfma_f32_16x16x32_bf16 v[128:131], a[108:111], a[44:47], v[128:131]
  ds_read_b64_tr_b16 a[84:85], v21 offset:8192
  v_mfma_f32_16x16x32_bf16 v[132:135], a[108:111], a[48:51], v[132:135]
  v_mfma_f32_16x16x32_bf16 v[136:139], a[108:111], a[52:55], v[136:139]
  ds_read_b64_tr_b16 a[86:87], v21 offset:10240
  v_mfma_f32_16x16x32_bf16 v[140:143], a[108:111], a[56:59], v[140:143]
  v_mfma_f32_16x16x32_bf16 v[144:147], a[108:111], a[60:63], v[144:147]
  ds_read_b64_tr_b16 a[88:89], v20 offset:16384
  v_mfma_f32_16x16x32_bf16 v[148:151], a[108:111], a[64:67], v[148:151]
  v_mfma_f32_16x16x32_bf16 v[152:155], a[36:39], a[112:115], v[152:155]
  buffer_load_dwordx4 v235, s[12:15], s47 offen offset:2048 lds
  ds_read_b64_tr_b16 a[90:91], v20 offset:18432
  v_mfma_f32_16x16x32_bf16 v[156:159], a[40:43], a[112:115], v[156:159]
  v_mfma_f32_16x16x32_bf16 v[160:163], a[44:47], a[112:115], v[160:163]
  ds_read_b128 a[32:35], v18 offset:0
  v_mfma_f32_16x16x32_bf16 v[164:167], a[48:51], a[112:115], v[164:167]
  v_mfma_f32_16x16x32_bf16 v[168:171], a[52:55], a[112:115], v[168:171]
  ds_read_b64_tr_b16 a[92:93], v21 offset:16384
  v_mfma_f32_16x16x32_bf16 v[172:175], a[56:59], a[112:115], v[172:175]
  v_mfma_f32_16x16x32_bf16 v[176:179], a[60:63], a[112:115], v[176:179]
  ds_read_b64_tr_b16 a[94:95], v21 offset:18432
  v_mfma_f32_16x16x32_bf16 v[180:183], a[64:67], a[112:115], v[180:183]
  v_mfma_f32_16x16x32_bf16 v[216:219], a[68:71], a[112:115], v[216:219]
  v_mfma_f32_16x16x32_bf16 v[184:187], a[36:39], a[116:119], v[184:187]
  v_mfma_f32_16x16x32_bf16 v[188:191], a[40:43], a[116:119], v[188:191]
  v_mfma_f32_16x16x32_bf16 v[192:195], a[44:47], a[116:119], v[192:195]
  v_mfma_f32_16x16x32_bf16 v[196:199], a[48:51], a[116:119], v[196:199]
  v_mfma_f32_16x16x32_bf16 v[200:203], a[52:55], a[116:119], v[200:203]
  v_mfma_f32_16x16x32_bf16 v[204:207], a[56:59], a[116:119], v[204:207]
  v_mfma_f32_16x16x32_bf16 v[208:211], a[60:63], a[116:119], v[208:211]
  v_mfma_f32_16x16x32_bf16 v[212:215], a[64:67], a[116:119], v[212:215]
  v_mfma_f32_16x16x32_bf16 v[220:223], a[68:71], a[116:119], v[220:223]
  s_waitcnt lgkmcnt(0)
  v_mfma_f32_16x16x32_bf16 v[24:27], a[72:75], a[0:3], v[24:27]
  s_add_u32 m0, s41, 3072
  ds_read_b128 a[36:39], v17 offset:0
  v_mfma_f32_16x16x32_bf16 v[28:31], a[72:75], a[4:7], v[28:31]
  buffer_load_dwordx4 v236, s[12:15], s47 offen offset:0 lds
  ds_read_b64_tr_b16 a[96:97], v20 offset:4096
  v_mfma_f32_16x16x32_bf16 v[32:35], a[72:75], a[8:11], v[32:35]
  v_mfma_f32_16x16x32_bf16 v[36:39], a[72:75], a[12:15], v[36:39]
  ds_read_b64_tr_b16 a[98:99], v20 offset:6144
  v_mfma_f32_16x16x32_bf16 v[40:43], a[72:75], a[16:19], v[40:43]
  v_mfma_f32_16x16x32_bf16 v[44:47], a[72:75], a[20:23], v[44:47]
  ds_read_b128 a[40:43], v17 offset:2048
  v_mfma_f32_16x16x32_bf16 v[48:51], a[72:75], a[24:27], v[48:51]
  v_mfma_f32_16x16x32_bf16 v[52:55], a[72:75], a[28:31], v[52:55]
  ds_read_b128 a[44:47], v17 offset:4096
  v_mfma_f32_16x16x32_bf16 v[56:59], a[76:79], a[0:3], v[56:59]
  v_mfma_f32_16x16x32_bf16 v[60:63], a[76:79], a[4:7], v[60:63]
  ds_read_b128 a[48:51], v17 offset:6144
  v_mfma_f32_16x16x32_bf16 v[64:67], a[76:79], a[8:11], v[64:67]
  v_mfma_f32_16x16x32_bf16 v[68:71], a[76:79], a[12:15], v[68:71]
  ds_read_b128 a[52:55], v17 offset:8192
  v_mfma_f32_16x16x32_bf16 v[72:75], a[76:79], a[16:19], v[72:75]
  v_mfma_f32_16x16x32_bf16 v[76:79], a[76:79], a[20:23], v[76:79]
  ds_read_b128 a[56:59], v17 offset:10240
  v_mfma_f32_16x16x32_bf16 v[80:83], a[76:79], a[24:27], v[80:83]
  buffer_load_dwordx4 v237, s[12:15], s47 offen offset:1024 lds
  v_mfma_f32_16x16x32_bf16 v[84:87], a[76:79], a[28:31], v[84:87]
  ds_read_b128 a[60:63], v17 offset:12288
  v_mfma_f32_16x16x32_bf16 v[88:91], a[80:83], a[0:3], v[88:91]
  v_mfma_f32_16x16x32_bf16 v[92:95], a[80:83], a[4:7], v[92:95]
  ds_read_b128 a[64:67], v17 offset:14336
  v_mfma_f32_16x16x32_bf16 v[96:99], a[80:83], a[8:11], v[96:99]
  v_mfma_f32_16x16x32_bf16 v[100:103], a[80:83], a[12:15], v[100:103]
  ds_read_b64_tr_b16 a[100:101], v21 offset:4096
  v_mfma_f32_16x16x32_bf16 v[104:107], a[80:83], a[16:19], v[104:107]
  ds_read_b64_tr_b16 a[102:103], v21 offset:6144
  v_mfma_f32_16x16x32_bf16 v[108:111], a[80:83], a[20:23], v[108:111]
  v_mfma_f32_16x16x32_bf16 v[112:115], a[80:83], a[24:27], v[112:115]
  ds_read_b64_tr_b16 a[104:105], v20 offset:12288
  v_mfma_f32_16x16x32_bf16 v[116:119], a[80:83], a[28:31], v[116:119]
  v_mfma_f32_16x16x32_bf16 v[120:123], a[84:87], a[0:3], v[120:123]
  ds_read_b64_tr_b16 a[106:107], v20 offset:14336
  v_mfma_f32_16x16x32_bf16 v[124:127], a[84:87], a[4:7], v[124:127]
  v_mfma_f32_16x16x32_bf16 v[128:131], a[84:87], a[8:11], v[128:131]
  ds_read_b64_tr_b16 a[108:109], v21 offset:12288
  v_mfma_f32_16x16x32_bf16 v[132:135], a[84:87], a[12:15], v[132:135]
  v_mfma_f32_16x16x32_bf16 v[136:139], a[84:87], a[16:19], v[136:139]
  buffer_load_dwordx4 v238, s[12:15], s47 offen offset:2048 lds
  ds_read_b64_tr_b16 a[110:111], v21 offset:14336
  v_mfma_f32_16x16x32_bf16 v[140:143], a[84:87], a[20:23], v[140:143]
  s_add_u32 s36, s36, s38
  s_add_u32 s37, s37, 1
  s_cmp_eq_u32 s37, 3
  s_cselect_b32 s37, 0, s37
  s_cselect_b32 s38, s39, s40
  v_mfma_f32_16x16x32_bf16 v[144:147], a[84:87], a[24:27], v[144:147]
  s_add_u32 s41, s41, s43
  s_sub_u32 s43, 0, s43
  ds_read_b64_tr_b16 a[112:113], v20 offset:20480
  v_mfma_f32_16x16x32_bf16 v[148:151], a[84:87], a[28:31], v[148:151]
  v_mfma_f32_16x16x32_bf16 v[152:155], a[0:3], a[88:91], v[152:155]
  ds_read_b64_tr_b16 a[114:115], v20 offset:22528
  v_mfma_f32_16x16x32_bf16 v[156:159], a[4:7], a[88:91], v[156:159]
  v_mfma_f32_16x16x32_bf16 v[160:163], a[8:11], a[88:91], v[160:163]
  ds_read_b128 a[68:71], v19 offset:0
  v_mfma_f32_16x16x32_bf16 v[164:167], a[12:15], a[88:91], v[164:167]
  v_mfma_f32_16x16x32_bf16 v[168:171], a[16:19], a[88:91], v[168:171]
  ds_read_b64_tr_b16 a[116:117], v21 offset:20480
  v_mfma_f32_16x16x32_bf16 v[172:175], a[20:23], a[88:91], v[172:175]
  v_mfma_f32_16x16x32_bf16 v[176:179], a[24:27], a[88:91], v[176:179]
  ds_read_b64_tr_b16 a[118:119], v21 offset:22528
  v_mfma_f32_16x16x32_bf16 v[180:183], a[28:31], a[88:91], v[180:183]
  v_add_u32 v16, s38, v16
  v_add_u32 v17, s38, v17
  v_mfma_f32_16x16x32_bf16 v[216:219], a[32:35], a[88:91], v[216:219]
  v_add_u32 v18, s38, v18
  v_add_u32 v19, s38, v19
  v_mfma_f32_16x16x32_bf16 v[184:187], a[0:3], a[92:95], v[184:187]
  v_add_u32 v20, s43, v20
  v_add_u32 v21, s43, v21
  v_mfma_f32_16x16x32_bf16 v[188:191], a[4:7], a[92:95], v[188:191]
  v_mfma_f32_16x16x32_bf16 v[192:195], a[8:11], a[92:95], v[192:195]
  v_mfma_f32_16x16x32_bf16 v[196:199], a[12:15], a[92:95], v[196:199]
  v_mfma_f32_16x16x32_bf16 v[200:203], a[16:19], a[92:95], v[200:203]
  v_mfma_f32_16x16x32_bf16 v[204:207], a[20:23], a[92:95], v[204:207]
  v_mfma_f32_16x16x32_bf16 v[208:211], a[24:27], a[92:95], v[208:211]
  v_mfma_f32_16x16x32_bf16 v[212:215], a[28:31], a[92:95], v[212:215]
  v_mfma_f32_16x16x32_bf16 v[220:223], a[32:35], a[92:95], v[220:223]
  s_waitcnt vmcnt(0) lgkmcnt(0)
  s_barrier
  s_mov_b32 s6, 0x3e8293ee
  s_mov_b32 s7, s6
  v_mfma_f32_16x16x32_bf16 v[24:27], a[96:99], a[36:39], v[24:27]
  ds_read_b128 a[0:3], v16 offset:0
  v_mfma_f32_16x16x32_bf16 v[28:31], a[96:99], a[40:43], v[28:31]
  ds_read_b64_tr_b16 a[72:73], v20 offset:0
  v_mfma_f32_16x16x32_bf16 v[32:35], a[96:99], a[44:47], v[32:35]
  v_mfma_f32_16x16x32_bf16 v[36:39], a[96:99], a[48:51], v[36:39]
  ds_read_b64_tr_b16 a[74:75], v20 offset:2048
  v_mfma_f32_16x16x32_bf16 v[40:43], a[96:99], a[52:55], v[40:43]
  v_mfma_f32_16x16x32_bf16 v[44:47], a[96:99], a[56:59], v[44:47]
  ds_read_b128 a[4:7], v16 offset:2048
  v_mfma_f32_16x16x32_bf16 v[48:51], a[96:99], a[60:63], v[48:51]
  v_mfma_f32_16x16x32_bf16 v[52:55], a[96:99], a[64:67], v[52:55]
  ds_read_b128 a[8:11], v16 offset:4096
  v_mfma_f32_16x16x32_bf16 v[56:59], a[100:103], a[36:39], v[56:59]
  v_mfma_f32_16x16x32_bf16 v[60:63], a[100:103], a[40:43], v[60:63]
  ds_read_b128 a[12:15], v16 offset:6144
  v_mfma_f32_16x16x32_bf16 v[64:67], a[100:103], a[44:47], v[64:67]
  v_mfma_f32_16x16x32_bf16 v[68:71], a[100:103], a[48:51], v[68:71]
  ds_read_b128 a[16:19], v16 offset:8192
  v_mfma_f32_16x16x32_bf16 v[72:75], a[100:103], a[52:55], v[72:75]
  v_mfma_f32_16x16x32_bf16 v[76:79], a[100:103], a[56:59], v[76:79]
  ds_read_b128 a[20:23], v16 offset:10240
  v_mfma_f32_16x16x32_bf16 v[80:83], a[100:103], a[60:63], v[80:83]
  v_mfma_f32_16x16x32_bf16 v[84:87], a[100:103], a[64:67], v[84:87]
  ds_read_b128 a[24:27], v16 offset:12288
  v_mfma_f32_16x16x32_bf16 v[88:91], a[104:107], a[36:39], v[88:91]
  v_mfma_f32_16x16x32_bf16 v[92:95], a[104:107], a[40:43], v[92:95]
  ds_read_b128 a[28:31], v16 offset:14336
  v_mfma_f32_16x16x32_bf16 v[96:99], a[104:107], a[44:47], v[96:99]
  v_mfma_f32_16x16x32_bf16 v[100:103], a[104:107], a[48:51], v[100:103]
  ds_read_b64_tr_b16 a[76:77], v21 offset:0
  v_mfma_f32_16x16x32_bf16 v[104:107], a[104:107], a[52:55], v[104:107]
  ds_read_b64_tr_b16 a[78:79], v21 offset:2048
  v_mfma_f32_16x16x32_bf16 v[108:111], a[104:107], a[56:59], v[108:111]
  v_mfma_f32_16x16x32_bf16 v[112:115], a[104:107], a[60:63], v[112:115]
  ds_read_b64_tr_b16 a[80:81], v20 offset:8192
  v_mfma_f32_16x16x32_bf16 v[116:119], a[104:107], a[64:67], v[116:119]
  v_mfma_f32_16x16x32_bf16 v[120:123], a[108:111], a[36:39], v[120:123]
  ds_read_b64_tr_b16 a[82:83], v20 offset:10240
  v_mfma_f32_16x16x32_bf16 v[124:127], a[108:111], a[40:43], v[124:127]
  v_mfma_f32_16x16x32_bf16 v[128:131], a[108:111], a[44:47], v[128:131]
  ds_read_b64_tr_b16 a[84:85], v21 offset:8192
  v_mfma_f32_16x16x32_bf16 v[132:135], a[108:111], a[48:51], v[132:135]
  v_mfma_f32_16x16x32_bf16 v[136:139], a[108:111], a[52:55], v[136:139]
  ds_read_b64_tr_b16 a[86:87], v21 offset:10240
  v_mfma_f32_16x16x32_bf16 v[140:143], a[108:111], a[56:59], v[140:143]
  v_mfma_f32_16x16x32_bf16 v[144:147], a[108:111], a[60:63], v[144:147]
  ds_read_b64_tr_b16 a[88:89], v20 offset:16384
  v_mfma_f32_16x16x32_bf16 v[148:151], a[108:111], a[64:67], v[148:151]
  v_mfma_f32_16x16x32_bf16 v[152:155], a[36:39], a[112:115], v[152:155]
  ds_read_b64_tr_b16 a[90:91], v20 offset:18432
  v_mfma_f32_16x16x32_bf16 v[156:159], a[40:43], a[112:115], v[156:159]
  v_mfma_f32_16x16x32_bf16 v[160:163], a[44:47], a[112:115], v[160:163]
  ds_read_b128 a[32:35], v18 offset:0
  v_mfma_f32_16x16x32_bf16 v[164:167], a[48:51], a[112:115], v[164:167]
  v_mfma_f32_16x16x32_bf16 v[168:171], a[52:55], a[112:115], v[168:171]
  ds_read_b64_tr_b16 a[92:93], v21 offset:16384
  v_mfma_f32_16x16x32_bf16 v[172:175], a[56:59], a[112:115], v[172:175]
  v_mfma_f32_16x16x32_bf16 v[176:179], a[60:63], a[112:115], v[176:179]
  ds_read_b64_tr_b16 a[94:95], v21 offset:18432
  v_mfma_f32_16x16x32_bf16 v[180:183], a[64:67], a[112:115], v[180:183]
  v_mfma_f32_16x16x32_bf16 v[216:219], a[68:71], a[112:115], v[216:219]
  v_mfma_f32_16x16x32_bf16 v[184:187], a[36:39], a[116:119], v[184:187]
  v_mfma_f32_16x16x32_bf16 v[188:191], a[40:43], a[116:119], v[188:191]
  v_mfma_f32_16x16x32_bf16 v[192:195], a[44:47], a[116:119], v[192:195]
  v_mfma_f32_16x16x32_bf16 v[196:199], a[48:51], a[116:119], v[196:199]
  v_mfma_f32_16x16x32_bf16 v[200:203], a[52:55], a[116:119], v[200:203]
  v_mfma_f32_16x16x32_bf16 v[204:207], a[56:59], a[116:119], v[204:207]
  v_mfma_f32_16x16x32_bf16 v[208:211], a[60:63], a[116:119], v[208:211]
  v_mfma_f32_16x16x32_bf16 v[212:215], a[64:67], a[116:119], v[212:215]
  v_mfma_f32_16x16x32_bf16 v[220:223], a[68:71], a[116:119], v[220:223]
  s_waitcnt lgkmcnt(0)
  v_mfma_f32_16x16x32_bf16 v[24:27], a[72:75], a[0:3], v[24:27]
  ds_read_b128 a[36:39], v17 offset:0
  ds_read_b64_tr_b16 a[96:97], v20 offset:4096
  v_mfma_f32_16x16x32_bf16 v[56:59], a[76:79], a[0:3], v[56:59]
  ds_read_b64_tr_b16 a[98:99], v20 offset:6144
  ds_read_b128 a[40:43], v17 offset:2048
  v_mfma_f32_16x16x32_bf16 v[28:31], a[72:75], a[4:7], v[28:31]
  ds_read_b128 a[44:47], v17 offset:4096
  ds_read_b128 a[48:51], v17 offset:6144
  v_mfma_f32_16x16x32_bf16 v[60:63], a[76:79], a[4:7], v[60:63]
  ds_read_b128 a[52:55], v17 offset:8192
  ds_read_b128 a[56:59], v17 offset:10240
  v_mfma_f32_16x16x32_bf16 v[32:35], a[72:75], a[8:11], v[32:35]
  ds_read_b128 a[60:63], v17 offset:12288
  ds_read_b128 a[64:67], v17 offset:14336
  v_mfma_f32_16x16x32_bf16 v[64:67], a[76:79], a[8:11], v[64:67]
  ds_read_b64_tr_b16 a[100:101], v21 offset:4096
  ds_read_b64_tr_b16 a[102:103], v21 offset:6144
  v_mfma_f32_16x16x32_bf16 v[36:39], a[72:75], a[12:15], v[36:39]
  ds_read_b64_tr_b16 a[104:105], v20 offset:12288
  ds_read_b64_tr_b16 a[106:107], v20 offset:14336
  v_mfma_f32_16x16x32_bf16 v[68:71], a[76:79], a[12:15], v[68:71]
  ds_read_b64_tr_b16 a[108:109], v21 offset:12288
  ds_read_b64_tr_b16 a[110:111], v21 offset:14336
  v_mfma_f32_16x16x32_bf16 v[40:43], a[72:75], a[16:19], v[40:43]
  ds_read_b64_tr_b16 a[112:113], v20 offset:20480
  ds_read_b64_tr_b16 a[114:115], v20 offset:22528
  v_mfma_f32_16x16x32_bf16 v[72:75], a[76:79], a[16:19], v[72:75]
  ds_read_b128 a[68:71], v19 offset:0
  ds_read_b64_tr_b16 a[116:117], v21 offset:20480
  v_mfma_f32_16x16x32_bf16 v[44:47], a[72:75], a[20:23], v[44:47]
  ds_read_b64_tr_b16 a[118:119], v21 offset:22528
  v_mfma_f32_16x16x32_bf16 v[76:79], a[76:79], a[20:23], v[76:79]
  v_mfma_f32_16x16x32_bf16 v[48:51], a[72:75], a[24:27], v[48:51]
  v_mfma_f32_16x16x32_bf16 v[80:83], a[76:79], a[24:27], v[80:83]
  v_mfma_f32_16x16x32_bf16 v[52:55], a[72:75], a[28:31], v[52:55]
  v_mfma_f32_16x16x32_bf16 v[84:87], a[76:79], a[28:31], v[84:87]
  s_waitcnt lgkmcnt(0)
  s_barrier
  s_mov_b32 s12, s84
  s_mov_b32 s13, s85
  s_mov_b32 s14, 256
  s_mov_b32 s15, 0x00020000
  buffer_load_dwordx2 v[22:23], off, s[12:15], 0 sc1
  v_mfma_f32_16x16x32_bf16 v[24:27], a[96:99], a[36:39], v[24:27]
  s_mov_b32 m0, s68
  v_mfma_f32_16x16x32_bf16 v[56:59], a[100:103], a[36:39], v[56:59]
  buffer_load_dwordx4 v8, s[20:23], s28 offen offset:0 lds
  v_mfma_f32_16x16x32_bf16 v[28:31], a[96:99], a[40:43], v[28:31]
  v_mfma_f32_16x16x32_bf16 v[60:63], a[100:103], a[40:43], v[60:63]
  v_mfma_f32_16x16x32_bf16 v[32:35], a[96:99], a[44:47], v[32:35]
  v_mfma_f32_16x16x32_bf16 v[64:67], a[100:103], a[44:47], v[64:67]
  buffer_load_dwordx4 v9, s[20:23], s28 offen offset:1024 lds
  v_pk_mul_f32 v[24:25], v[24:25], s[6:7]
  v_mfma_f32_16x16x32_bf16 v[36:39], a[96:99], a[48:51], v[36:39]
  v_pk_mul_f32 v[26:27], v[26:27], s[6:7]
  v_pk_mul_f32 v[56:57], v[56:57], s[6:7]
  v_mfma_f32_16x16x32_bf16 v[68:71], a[100:103], a[48:51], v[68:71]
  v_pk_mul_f32 v[58:59], v[58:59], s[6:7]
  v_cvt_pk_bf16_f32 v24, v24, v25
  v_mfma_f32_16x16x32_bf16 v[40:43], a[96:99], a[52:55], v[40:43]
  v_cvt_pk_bf16_f32 v25, v26, v27
  v_cvt_pk_bf16_f32 v26, v56, v57
  v_mfma_f32_16x16x32_bf16 v[72:75], a[100:103], a[52:55], v[72:75]
  v_cvt_pk_bf16_f32 v27, v58, v59
  v_pk_mul_f32 v[28:29], v[28:29], s[6:7]
  v_mfma_f32_16x16x32_bf16 v[44:47], a[96:99], a[56:59], v[44:47]
  buffer_load_dwordx4 v10, s[20:23], s28 offen offset:2048 lds
  v_pk_mul_f32 v[30:31], v[30:31], s[6:7]
  v_mfma_f32_16x16x32_bf16 v[76:79], a[100:103], a[56:59], v[76:79]
  v_pk_mul_f32 v[60:61], v[60:61], s[6:7]
  v_pk_mul_f32 v[62:63], v[62:63], s[6:7]
  v_mfma_f32_16x16x32_bf16 v[48:51], a[96:99], a[60:63], v[48:51]
  v_cvt_pk_bf16_f32 v28, v28, v29
  v_cvt_pk_bf16_f32 v29, v30, v31
  v_mfma_f32_16x16x32_bf16 v[80:83], a[100:103], a[60:63], v[80:83]
  v_cvt_pk_bf16_f32 v30, v60, v61
  v_cvt_pk_bf16_f32 v31, v62, v63
  v_mfma_f32_16x16x32_bf16 v[52:55], a[96:99], a[64:67], v[52:55]
  v_pk_mul_f32 v[32:33], v[32:33], s[6:7]
  v_pk_mul_f32 v[34:35], v[34:35], s[6:7]
  v_mfma_f32_16x16x32_bf16 v[84:87], a[100:103], a[64:67], v[84:87]
  buffer_load_dwordx4 v11, s[20:23], s28 offen offset:3072 lds
  v_pk_mul_f32 v[64:65], v[64:65], s[6:7]
  v_mfma_f32_16x16x32_bf16 v[88:91], a[80:83], a[0:3], v[88:91]
  s_bfe_u32 s56, 0x302010e, s55
  s_add_u32 s54, s54, s56
  s_add_u32 s55, s55, 8
  v_mfma_f32_16x16x32_bf16 v[120:123], a[84:87], a[0:3], v[120:123]
  s_and_b32 s55, s55, 0x8001f
  s_and_b32 s54, s54, 15
  s_lshl_b32 s28, s54, 19
  v_mfma_f32_16x16x32_bf16 v[88:91], a[104:107], a[36:39], v[88:91]
  s_add_u32 m0, s68, 16384
  v_pk_mul_f32 v[66:67], v[66:67], s[6:7]
  v_cvt_pk_bf16_f32 v32, v32, v33
  v_mfma_f32_16x16x32_bf16 v[120:123], a[108:111], a[36:39], v[120:123]
  v_cvt_pk_bf16_f32 v33, v34, v35
  v_cvt_pk_bf16_f32 v34, v64, v65
  v_mfma_f32_16x16x32_bf16 v[92:95], a[80:83], a[4:7], v[92:95]
  buffer_load_dwordx4 v8, s[20:23], s28 offen offset:0 lds
  v_cvt_pk_bf16_f32 v35, v66, v67
  v_mfma_f32_16x16x32_bf16 v[124:127], a[84:87], a[4:7], v[124:127]
  v_pk_mul_f32 v[36:37], v[36:37], s[6:7]
  v_pk_mul_f32 v[38:39], v[38:39], s[6:7]
  v_mfma_f32_16x16x32_bf16 v[92:95], a[104:107], a[40:43], v[92:95]
  v_pk_mul_f32 v[68:69], v[68:69], s[6:7]
  v_pk_mul_f32 v[70:71], v[70:71], s[6:7]
  v_mfma_f32_16x16x32_bf16 v[124:127], a[108:111], a[40:43], v[124:127]
  v_cvt_pk_bf16_f32 v36, v36, v37
  v_cvt_pk_bf16_f32 v37, v38, v39
  v_mfma_f32_16x16x32_bf16 v[96:99], a[80:83], a[8:11], v[96:99]
  v_cvt_pk_bf16_f32 v38, v68, v69
  v_cvt_pk_bf16_f32 v39, v70, v71
  v_mfma_f32_16x16x32_bf16 v[128:131], a[84:87], a[8:11], v[128:131]
  buffer_load_dwordx4 v9, s[20:23], s28 offen offset:1024 lds
  v_pk_mul_f32 v[40:41], v[40:41], s[6:7]
  v_mfma_f32_16x16x32_bf16 v[96:99], a[104:107], a[44:47], v[96:99]
  v_pk_mul_f32 v[42:43], v[42:43], s[6:7]
  v_pk_mul_f32 v[72:73], v[72:73], s[6:7]
  v_mfma_f32_16x16x32_bf16 v[128:131], a[108:111], a[44:47], v[128:131]
  v_pk_mul_f32 v[74:75], v[74:75], s[6:7]
  v_cvt_pk_bf16_f32 v40, v40, v41
  v_mfma_f32_16x16x32_bf16 v[100:103], a[80:83], a[12:15], v[100:103]
  v_cvt_pk_bf16_f32 v41, v42, v43
  v_cvt_pk_bf16_f32 v42, v72, v73
  v_mfma_f32_16x16x32_bf16 v[132:135], a[84:87], a[12:15], v[132:135]
  v_cvt_pk_bf16_f32 v43, v74, v75
  v_pk_mul_f32 v[44:45], v[44:45], s[6:7]
  v_mfma_f32_16x16x32_bf16 v[100:103], a[104:107], a[48:51], v[100:103]
  v_pk_mul_f32 v[46:47], v[46:47], s[6:7]
  v_pk_mul_f32 v[76:77], v[76:77], s[6:7]
  v_mfma_f32_16x16x32_bf16 v[132:135], a[108:111], a[48:51], v[132:135]
  buffer_load_dwordx4 v10, s[20:23], s28 offen offset:2048 lds
  v_pk_mul_f32 v[78:79], v[78:79], s[6:7]
  v_mfma_f32_16x16x32_bf16 v[104:107], a[80:83], a[16:19], v[104:107]
  v_cvt_pk_bf16_f32 v44, v44, v45
  v_cvt_pk_bf16_f32 v45, v46, v47
  v_mfma_f32_16x16x32_bf16 v[136:139], a[84:87], a[16:19], v[136:139]
  v_cvt_pk_bf16_f32 v46, v76, v77
  v_cvt_pk_bf16_f32 v47, v78, v79
  v_mfma_f32_16x16x32_bf16 v[104:107], a[104:107], a[52:55], v[104:107]
  v_pk_mul_f32 v[48:49], v[48:49], s[6:7]
  v_pk_mul_f32 v[50:51], v[50:51], s[6:7]
  v_mfma_f32_16x16x32_bf16 v[136:139], a[108:111], a[52:55], v[136:139]
  v_pk_mul_f32 v[80:81], v[80:81], s[6:7]
  v_pk_mul_f32 v[82:83], v[82:83], s[6:7]
  v_mfma_f32_16x16x32_bf16 v[108:111], a[80:83], a[20:23], v[108:111]
  buffer_load_dwordx4 v11, s[20:23], s28 offen offset:3072 lds
  v_cvt_pk_bf16_f32 v48, v48, v49
  v_mfma_f32_16x16x32_bf16 v[140:143], a[84:87], a[20:23], v[140:143]
  s_bfe_u32 s56, 0x302010e, s55
  s_add_u32 s54, s54, s56
  s_add_u32 s55, s55, 8
  v_mfma_f32_16x16x32_bf16 v[108:111], a[104:107], a[56:59], v[108:111]
  s_and_b32 s55, s55, 0x8001f
  s_and_b32 s54, s54, 15
  s_lshl_b32 s28, s54, 19
  v_mfma_f32_16x16x32_bf16 v[140:143], a[108:111], a[56:59], v[140:143]
  s_mov_b32 m0, s88
  v_cvt_pk_bf16_f32 v49, v50, v51
  v_cvt_pk_bf16_f32 v50, v80, v81
  v_mfma_f32_16x16x32_bf16 v[112:115], a[80:83], a[24:27], v[112:115]
  v_cvt_pk_bf16_f32 v51, v82, v83
  v_pk_mul_f32 v[52:53], v[52:53], s[6:7]
  v_mfma_f32_16x16x32_bf16 v[144:147], a[84:87], a[24:27], v[144:147]
  buffer_load_dwordx4 v4, s[8:11], s26 offen offset:0 lds
  v_pk_mul_f32 v[54:55], v[54:55], s[6:7]
  v_mfma_f32_16x16x32_bf16 v[112:115], a[104:107], a[60:63], v[112:115]
  v_pk_mul_f32 v[84:85], v[84:85], s[6:7]
  v_pk_mul_f32 v[86:87], v[86:87], s[6:7]
  v_mfma_f32_16x16x32_bf16 v[144:147], a[108:111], a[60:63], v[144:147]
  v_cvt_pk_bf16_f32 v52, v52, v53
  v_cvt_pk_bf16_f32 v53, v54, v55
  v_mfma_f32_16x16x32_bf16 v[116:119], a[80:83], a[28:31], v[116:119]
  v_cvt_pk_bf16_f32 v54, v84, v85
  v_cvt_pk_bf16_f32 v55, v86, v87
  v_mfma_f32_16x16x32_bf16 v[148:151], a[84:87], a[28:31], v[148:151]
  v_cvt_pk_bf16_f32 v88, v88, v89
  v_cvt_pk_bf16_f32 v89, v90, v91
  v_mfma_f32_16x16x32_bf16 v[116:119], a[104:107], a[64:67], v[116:119]
  buffer_load_dwordx4 v5, s[8:11], s26 offen offset:1024 lds
  v_cvt_pk_bf16_f32 v90, v120, v121
  v_mfma_f32_16x16x32_bf16 v[148:151], a[108:111], a[64:67], v[148:151]
  v_cvt_pk_bf16_f32 v91, v122, v123
  v_cvt_pk_bf16_f32 v92, v92, v93
  v_mfma_f32_16x16x32_bf16 v[216:219], a[32:35], a[88:91], v[216:219]
  v_cvt_pk_bf16_f32 v93, v94, v95
  v_cvt_pk_bf16_f32 v94, v124, v125
  v_mfma_f32_16x16x32_bf16 v[220:223], a[32:35], a[92:95], v[220:223]
  v_cvt_pk_bf16_f32 v95, v126, v127
  v_cvt_pk_bf16_f32 v96, v96, v97
  v_mfma_f32_16x16x32_bf16 v[216:219], a[68:71], a[112:115], v[216:219]
  v_cvt_pk_bf16_f32 v97, v98, v99
  v_cvt_pk_bf16_f32 v98, v128, v129
  v_mfma_f32_16x16x32_bf16 v[220:223], a[68:71], a[116:119], v[220:223]
  buffer_load_dwordx4 v6, s[8:11], s26 offen offset:2048 lds
  v_cvt_pk_bf16_f32 v99, v130, v131
  v_mfma_f32_16x16x32_bf16 v[180:183], a[28:31], a[88:91], v[180:183]
  v_cvt_pk_bf16_f32 v100, v100, v101
  v_cvt_pk_bf16_f32 v101, v102, v103
  v_mfma_f32_16x16x32_bf16 v[212:215], a[28:31], a[92:95], v[212:215]
  v_cvt_pk_bf16_f32 v102, v132, v133
  v_cvt_pk_bf16_f32 v103, v134, v135
  v_mfma_f32_16x16x32_bf16 v[180:183], a[64:67], a[112:115], v[180:183]
  v_cvt_pk_bf16_f32 v104, v104, v105
  v_cvt_pk_bf16_f32 v105, v106, v107
  v_mfma_f32_16x16x32_bf16 v[212:215], a[64:67], a[116:119], v[212:215]
  v_cvt_pk_bf16_f32 v106, v136, v137
  v_cvt_pk_bf16_f32 v107, v138, v139
  v_mfma_f32_16x16x32_bf16 v[176:179], a[24:27], a[88:91], v[176:179]
  v_cvt_pk_bf16_f32 v108, v108, v109
  v_cvt_pk_bf16_f32 v109, v110, v111
  v_mfma_f32_16x16x32_bf16 v[208:211], a[24:27], a[92:95], v[208:211]
  buffer_load_dwordx4 v7, s[8:11], s26 offen offset:3072 lds
  v_cvt_pk_bf16_f32 v110, v140, v141
  v_mfma_f32_16x16x32_bf16 v[176:179], a[60:63], a[112:115], v[176:179]
  s_add_u32 m0, s88, 4096
  v_cvt_pk_bf16_f32 v111, v142, v143
  v_cvt_pk_bf16_f32 v112, v112, v113
  v_mfma_f32_16x16x32_bf16 v[208:211], a[60:63], a[116:119], v[208:211]
  v_cvt_pk_bf16_f32 v113, v114, v115
  v_cvt_pk_bf16_f32 v114, v144, v145
  v_mfma_f32_16x16x32_bf16 v[172:175], a[20:23], a[88:91], v[172:175]
  v_cvt_pk_bf16_f32 v115, v146, v147
  v_cvt_pk_bf16_f32 v116, v116, v117
  v_mfma_f32_16x16x32_bf16 v[204:207], a[20:23], a[92:95], v[204:207]
  v_cvt_pk_bf16_f32 v117, v118, v119
  v_cvt_pk_bf16_f32 v118, v148, v149
  v_mfma_f32_16x16x32_bf16 v[172:175], a[56:59], a[112:115], v[172:175]
  buffer_load_dwordx4 v4, s[8:11], s27 offen offset:0 lds
  v_cvt_pk_bf16_f32 v119, v150, v151
  v_mfma_f32_16x16x32_bf16 v[204:207], a[56:59], a[116:119], v[204:207]
  v_cvt_pk_bf16_f32 v216, v216, v217
  v_cvt_pk_bf16_f32 v217, v218, v219
  v_mfma_f32_16x16x32_bf16 v[168:171], a[16:19], a[88:91], v[168:171]
  v_cvt_pk_bf16_f32 v218, v220, v221
  v_cvt_pk_bf16_f32 v219, v222, v223
  v_mfma_f32_16x16x32_bf16 v[200:203], a[16:19], a[92:95], v[200:203]
  ds_write_b128 v252, v[216:219] offset:1024
  v_cvt_pk_bf16_f32 v72, v180, v181
  v_mfma_f32_16x16x32_bf16 v[168:171], a[52:55], a[112:115], v[168:171]
  v_cvt_pk_bf16_f32 v73, v182, v183
  v_cvt_pk_bf16_f32 v136, v212, v213
  v_mfma_f32_16x16x32_bf16 v[200:203], a[52:55], a[116:119], v[200:203]
  buffer_load_dwordx4 v5, s[8:11], s27 offen offset:1024 lds
  v_cvt_pk_bf16_f32 v137, v214, v215
  v_mfma_f32_16x16x32_bf16 v[164:167], a[12:15], a[88:91], v[164:167]
  v_cvt_pk_bf16_f32 v70, v176, v177
  v_cvt_pk_bf16_f32 v71, v178, v179
  v_mfma_f32_16x16x32_bf16 v[196:199], a[12:15], a[92:95], v[196:199]
  v_cvt_pk_bf16_f32 v134, v208, v209
  v_cvt_pk_bf16_f32 v135, v210, v211
  v_mfma_f32_16x16x32_bf16 v[164:167], a[48:51], a[112:115], v[164:167]
  v_cvt_pk_bf16_f32 v68, v172, v173
  v_cvt_pk_bf16_f32 v69, v174, v175
  v_mfma_f32_16x16x32_bf16 v[196:199], a[48:51], a[116:119], v[196:199]
  v_cvt_pk_bf16_f32 v132, v204, v205
  v_cvt_pk_bf16_f32 v133, v206, v207
  v_mfma_f32_16x16x32_bf16 v[160:163], a[8:11], a[88:91], v[160:163]
  buffer_load_dwordx4 v6, s[8:11], s27 offen offset:2048 lds
  v_cvt_pk_bf16_f32 v66, v168, v169
  v_mfma_f32_16x16x32_bf16 v[192:195], a[8:11], a[92:95], v[192:195]
  v_cvt_pk_bf16_f32 v67, v170, v171
  v_cvt_pk_bf16_f32 v130, v200, v201
  v_mfma_f32_16x16x32_bf16 v[160:163], a[44:47], a[112:115], v[160:163]
  v_cvt_pk_bf16_f32 v131, v202, v203
  v_mfma_f32_16x16x32_bf16 v[192:195], a[44:47], a[116:119], v[192:195]
  v_cvt_pk_bf16_f32 v64, v164, v165
  v_cvt_pk_bf16_f32 v65, v166, v167
  v_mfma_f32_16x16x32_bf16 v[156:159], a[4:7], a[88:91], v[156:159]
  v_cvt_pk_bf16_f32 v128, v196, v197
  v_cvt_pk_bf16_f32 v129, v198, v199
  v_mfma_f32_16x16x32_bf16 v[188:191], a[4:7], a[92:95], v[188:191]
  buffer_load_dwordx4 v7, s[8:11], s27 offen offset:3072 lds
  v_mfma_f32_16x16x32_bf16 v[156:159], a[40:43], a[112:115], v[156:159]
  s_bfe_u32 s29, 0x302010e, s53
  s_add_u32 s52, s52, s29
  s_add_u32 s53, s53, 8
  v_mfma_f32_16x16x32_bf16 v[188:191], a[40:43], a[116:119], v[188:191]
  s_and_b32 s53, s53, 0x8001f
  s_and_b32 s52, s52, 15
  s_lshl_b32 s29, s52, 7
  v_mfma_f32_16x16x32_bf16 v[152:155], a[0:3], a[88:91], v[152:155]
  s_or_b32 s26, s30, s29
  s_or_b32 s27, s31, s29
  v_cvt_pk_bf16_f32 v62, v160, v161
  v_mfma_f32_16x16x32_bf16 v[184:187], a[0:3], a[92:95], v[184:187]
  v_cvt_pk_bf16_f32 v63, v162, v163
  v_cvt_pk_bf16_f32 v126, v192, v193
  v_mfma_f32_16x16x32_bf16 v[152:155], a[36:39], a[112:115], v[152:155]
  v_cvt_pk_bf16_f32 v127, v194, v195
  v_mfma_f32_16x16x32_bf16 v[184:187], a[36:39], a[116:119], v[184:187]
  v_cvt_pk_bf16_f32 v60, v156, v157
  v_cvt_pk_bf16_f32 v61, v158, v159
  v_cvt_pk_bf16_f32 v124, v188, v189
  v_cvt_pk_bf16_f32 v125, v190, v191
  s_nop 1
  v_cvt_pk_bf16_f32 v58, v152, v153
  v_cvt_pk_bf16_f32 v59, v154, v155
  v_cvt_pk_bf16_f32 v122, v184, v185
  v_cvt_pk_bf16_f32 v123, v186, v187
  s_waitcnt lgkmcnt(0)
  s_barrier
Lp2_at:
  ds_read_b128 v[76:79], v253
  ds_read_b64 v[56:57], v253 offset:1024
  ds_read_b64 v[120:121], v253 offset:1032
  v_mfma_f32_16x16x32_bf16 v[208:211], v[112:115], v[52:55], v[240:243]
  s_add_u32 m0, s88, 32768
  s_nop 0
  buffer_load_dwordx4 v4, s[8:11], s26 offen offset:0 lds
  v_mfma_f32_16x16x32_bf16 v[212:215], v[116:119], v[52:55], v[244:247]
  v_mfma_f32_16x16x32_bf16 v[200:203], v[108:111], v[48:51], v[240:243]
  v_mfma_f32_16x16x32_bf16 v[204:207], v[112:115], v[48:51], v[244:247]
  v_mfma_f32_16x16x32_bf16 v[192:195], v[104:107], v[44:47], v[240:243]
  v_mfma_f32_16x16x32_bf16 v[196:199], v[108:111], v[44:47], v[244:247]
  v_mfma_f32_16x16x32_bf16 v[184:187], v[100:103], v[40:43], v[240:243]
  v_mfma_f32_16x16x32_bf16 v[188:191], v[104:107], v[40:43], v[244:247]
  v_mfma_f32_16x16x32_bf16 v[176:179], v[96:99], v[36:39], v[240:243]
  v_mfma_f32_16x16x32_bf16 v[180:183], v[100:103], v[36:39], v[244:247]
  v_mfma_f32_16x16x32_bf16 v[168:171], v[92:95], v[32:35], v[240:243]
  v_mfma_f32_16x16x32_bf16 v[172:175], v[96:99], v[32:35], v[244:247]
  v_mfma_f32_16x16x32_bf16 v[160:163], v[88:91], v[28:31], v[240:243]
  buffer_load_dwordx4 v5, s[8:11], s26 offen offset:1024 lds
  v_mfma_f32_16x16x32_bf16 v[164:167], v[92:95], v[28:31], v[244:247]
  s_waitcnt lgkmcnt(0)
  v_mfma_f32_16x16x32_bf16 v[152:155], v[76:79], v[24:27], v[248:251]
  v_mfma_f32_16x16x32_bf16 v[156:159], v[88:91], v[24:27], v[244:247]
  v_max3_f32 v238, v208, v209, v210
  v_max3_f32 v239, v211, v212, v213
  v_max3_f32 v238, v238, v214, v215
  v_max_f32 v238, v238, v239
  v_max3_f32 v236, v200, v201, v202
  v_max3_f32 v237, v203, v204, v205
  v_max3_f32 v236, v236, v206, v207
  v_max_f32 v236, v236, v237
  v_max3_f32 v234, v192, v193, v194
  v_max3_f32 v235, v195, v196, v197
  buffer_load_dwordx4 v6, s[8:11], s26 offen offset:2048 lds
  v_max3_f32 v234, v234, v198, v199
  v_max_f32 v234, v234, v235
  v_max3_f32 v232, v184, v185, v186
  v_max3_f32 v233, v187, v188, v189
  v_max3_f32 v232, v232, v190, v191
  v_max_f32 v232, v232, v233
  v_max3_f32 v230, v176, v177, v178
  v_max3_f32 v231, v179, v180, v181
  v_max3_f32 v230, v230, v182, v183
  v_max_f32 v230, v230, v231
  v_max3_f32 v228, v168, v169, v170
  v_max3_f32 v229, v171, v172, v173
  buffer_load_dwordx4 v7, s[8:11], s26 offen offset:3072 lds
  v_max3_f32 v228, v228, v174, v175
  v_max_f32 v228, v228, v229
  v_max3_f32 v226, v160, v161, v162
  v_max3_f32 v227, v163, v164, v165
  v_max3_f32 v226, v226, v166, v167
  v_max_f32 v226, v226, v227
  v_max3_f32 v224, v152, v153, v154
  v_max3_f32 v225, v155, v156, v157
  v_max3_f32 v224, v224, v158, v159
  v_max_f32 v224, v224, v225
  v_mov_b32 v239, v238
  v_mov_b32 v237, v236
  v_mov_b32 v235, v234
  s_add_u32 m0, s88, 36864
  s_nop 0
  buffer_load_dwordx4 v4, s[8:11], s27 offen offset:0 lds
  v_mov_b32 v233, v232
  v_mov_b32 v231, v230
  v_mov_b32 v229, v228
  v_mov_b32 v227, v226
  v_mov_b32 v225, v224
  v_permlane32_swap_b32 v238, v239
  v_permlane32_swap_b32 v236, v237
  v_permlane32_swap_b32 v234, v235
  v_permlane32_swap_b32 v232, v233
  v_permlane32_swap_b32 v230, v231
  v_permlane32_swap_b32 v228, v229
  v_permlane32_swap_b32 v226, v227
  buffer_load_dwordx4 v5, s[8:11], s27 offen offset:1024 lds
  v_permlane32_swap_b32 v224, v225
  v_max_f32 v238, v238, v239
  v_max_f32 v236, v236, v237
  v_max_f32 v234, v234, v235
  v_max_f32 v232, v232, v233
  v_max_f32 v230, v230, v231
  v_max_f32 v228, v228, v229
  v_max_f32 v226, v226, v227
  v_max_f32 v224, v224, v225
  v_mov_b32 v239, v238
  v_mov_b32 v237, v236
  v_mov_b32 v235, v234
  buffer_load_dwordx4 v6, s[8:11], s27 offen offset:2048 lds
  v_mov_b32 v233, v232
  v_mov_b32 v231, v230
  v_mov_b32 v229, v228
  v_mov_b32 v227, v226
  v_mov_b32 v225, v224
  v_permlane16_swap_b32 v238, v239
  v_permlane16_swap_b32 v236, v237
  v_permlane16_swap_b32 v234, v235
  v_permlane16_swap_b32 v232, v233
  v_permlane16_swap_b32 v230, v231
  v_permlane16_swap_b32 v228, v229
  v_permlane16_swap_b32 v226, v227
  buffer_load_dwordx4 v7, s[8:11], s27 offen offset:3072 lds
  v_permlane16_swap_b32 v224, v225
  v_max_f32 v238, v238, v239
  v_max_f32 v236, v236, v237
  v_max_f32 v234, v234, v235
  v_max_f32 v232, v232, v233
  v_max_f32 v230, v230, v231
  v_max_f32 v228, v228, v229
  v_max_f32 v226, v226, v227
  v_max_f32 v224, v224, v225
  v_sub_f32 v208, v208, v238
  v_sub_f32 v209, v209, v238
  v_sub_f32 v210, v210, v238
  v_sub_f32 v211, v211, v238
  s_bfe_u32 s29, 0x302010e, s53
  s_add_u32 s52, s52, s29
  s_add_u32 s53, s53, 8
  s_and_b32 s53, s53, 0x8001f
  s_and_b32 s52, s52, 15
  s_lshl_b32 s29, s52, 7
  s_or_b32 s26, s30, s29
  s_or_b32 s27, s31, s29
  s_add_u32 m0, s68, 32768
  s_nop 0
  buffer_load_dwordx4 v8, s[20:23], s28 offen offset:0 lds
  v_sub_f32 v212, v212, v238
  v_sub_f32 v213, v213, v238
  v_sub_f32 v214, v214, v238
  v_sub_f32 v215, v215, v238
  v_exp_f32 v208, v208
  v_exp_f32 v209, v209
  v_exp_f32 v210, v210
  v_exp_f32 v211, v211
  v_exp_f32 v212, v212
  v_exp_f32 v213, v213
  v_exp_f32 v214, v214
  v_exp_f32 v215, v215
  buffer_load_dwordx4 v9, s[20:23], s28 offen offset:1024 lds
  v_sub_f32 v200, v200, v236
  v_sub_f32 v201, v201, v236
  v_sub_f32 v202, v202, v236
  v_sub_f32 v203, v203, v236
  v_sub_f32 v204, v204, v236
  v_sub_f32 v205, v205, v236
  v_sub_f32 v206, v206, v236
  v_sub_f32 v207, v207, v236
  v_exp_f32 v200, v200
  v_exp_f32 v201, v201
  v_exp_f32 v202, v202
  v_exp_f32 v203, v203
  buffer_load_dwordx4 v10, s[20:23], s28 offen offset:2048 lds
  v_exp_f32 v204, v204
  v_exp_f32 v205, v205
  v_exp_f32 v206, v206
  v_exp_f32 v207, v207
  v_cvt_pk_bf16_f32 v116, v208, v209
  v_cvt_pk_bf16_f32 v117, v210, v211
  v_cvt_pk_bf16_f32 v118, v212, v213
  v_cvt_pk_bf16_f32 v119, v214, v215
  s_nop 1
  v_mfma_f32_16x16x32_bf16 v[52:55], a[208:211], v[116:119], 0
  v_mfma_f32_16x16x32_bf16 v[208:211], v[70:73], v[116:119], 0
  v_mfma_f32_16x16x32_bf16 v[212:215], v[134:137], v[116:119], 0
  v_sub_f32 v192, v192, v234
  buffer_load_dwordx4 v11, s[20:23], s28 offen offset:3072 lds
  v_sub_f32 v193, v193, v234
  v_sub_f32 v194, v194, v234
  v_sub_f32 v195, v195, v234
  v_sub_f32 v196, v196, v234
  v_sub_f32 v197, v197, v234
  v_sub_f32 v198, v198, v234
  v_sub_f32 v199, v199, v234
  v_exp_f32 v192, v192
  v_exp_f32 v193, v193
  v_exp_f32 v194, v194
  v_exp_f32 v195, v195
  v_exp_f32 v196, v196
  v_exp_f32 v197, v197
  s_bfe_u32 s56, 0x302010e, s55
  s_add_u32 s54, s54, s56
  s_add_u32 s55, s55, 8
  s_and_b32 s55, s55, 0x8001f
  s_and_b32 s54, s54, 15
  s_lshl_b32 s28, s54, 19
  s_add_u32 m0, s88, -32768
  s_nop 0
  buffer_load_dwordx4 v4, s[8:11], s26 offen offset:0 lds
  v_exp_f32 v198, v198
  v_exp_f32 v199, v199
  v_cvt_pk_bf16_f32 v112, v200, v201
  v_cvt_pk_bf16_f32 v113, v202, v203
  v_cvt_pk_bf16_f32 v114, v204, v205
  v_cvt_pk_bf16_f32 v115, v206, v207
  s_nop 1
  v_mfma_f32_16x16x32_bf16 v[48:51], a[208:211], v[112:115], 0
  v_mfma_f32_16x16x32_bf16 v[200:203], v[68:71], v[112:115], 0
  v_mfma_f32_16x16x32_bf16 v[204:207], v[132:135], v[112:115], 0
  v_sub_f32 v184, v184, v232
  v_sub_f32 v185, v185, v232
  v_sub_f32 v186, v186, v232
  buffer_load_dwordx4 v5, s[8:11], s26 offen offset:1024 lds
  v_sub_f32 v187, v187, v232
  v_sub_f32 v188, v188, v232
  v_sub_f32 v189, v189, v232
  v_sub_f32 v190, v190, v232
  v_sub_f32 v191, v191, v232
  v_exp_f32 v184, v184
  v_exp_f32 v185, v185
  v_exp_f32 v186, v186
  v_exp_f32 v187, v187
  v_exp_f32 v188, v188
  v_exp_f32 v189, v189
  v_exp_f32 v190, v190
  buffer_load_dwordx4 v6, s[8:11], s26 offen offset:2048 lds
  v_exp_f32 v191, v191
  v_cvt_pk_bf16_f32 v108, v192, v193
  v_cvt_pk_bf16_f32 v109, v194, v195
  v_cvt_pk_bf16_f32 v110, v196, v197
  v_cvt_pk_bf16_f32 v111, v198, v199
  s_nop 1
  v_mfma_f32_16x16x32_bf16 v[44:47], a[208:211], v[108:111], 0
  v_mfma_f32_16x16x32_bf16 v[192:195], v[66:69], v[108:111], 0
  v_mfma_f32_16x16x32_bf16 v[196:199], v[130:133], v[108:111], 0
  v_sub_f32 v176, v176, v230
  v_sub_f32 v177, v177, v230
  v_sub_f32 v178, v178, v230
  v_sub_f32 v179, v179, v230
  buffer_load_dwordx4 v7, s[8:11], s26 offen offset:3072 lds
  v_sub_f32 v180, v180, v230
  v_sub_f32 v181, v181, v230
  v_sub_f32 v182, v182, v230
  v_sub_f32 v183, v183, v230
  v_exp_f32 v176, v176
  v_exp_f32 v177, v177
  v_exp_f32 v178, v178
  v_exp_f32 v179, v179
  v_exp_f32 v180, v180
  v_exp_f32 v181, v181
  v_exp_f32 v182, v182
  v_exp_f32 v183, v183
  v_cvt_pk_bf16_f32 v104, v184, v185
  s_add_u32 m0, s88, -28672
  s_nop 0
  buffer_load_dwordx4 v4, s[8:11], s27 offen offset:0 lds
  v_cvt_pk_bf16_f32 v105, v186, v187
  v_cvt_pk_bf16_f32 v106, v188, v189
  v_cvt_pk_bf16_f32 v107, v190, v191
  s_nop 1
  v_mfma_f32_16x16x32_bf16 v[40:43], a[208:211], v[104:107], 0
  v_mfma_f32_16x16x32_bf16 v[184:187], v[64:67], v[104:107], 0
  v_mfma_f32_16x16x32_bf16 v[188:191], v[128:131], v[104:107], 0
  v_sub_f32 v168, v168, v228
  v_sub_f32 v169, v169, v228
  v_sub_f32 v170, v170, v228
  v_sub_f32 v171, v171, v228
  v_sub_f32 v172, v172, v228
  v_sub_f32 v173, v173, v228
  buffer_load_dwordx4 v5, s[8:11], s27 offen offset:1024 lds
  v_sub_f32 v174, v174, v228
  v_sub_f32 v175, v175, v228
  v_exp_f32 v168, v168
  v_exp_f32 v169, v169
  v_exp_f32 v170, v170
  v_exp_f32 v171, v171
  v_exp_f32 v172, v172
  v_exp_f32 v173, v173
  v_exp_f32 v174, v174
  v_exp_f32 v175, v175
  v_cvt_pk_bf16_f32 v100, v176, v177
  v_cvt_pk_bf16_f32 v101, v178, v179
  buffer_load_dwordx4 v6, s[8:11], s27 offen offset:2048 lds
  v_cvt_pk_bf16_f32 v102, v180, v181
  v_cvt_pk_bf16_f32 v103, v182, v183
  s_nop 1
  v_mfma_f32_16x16x32_bf16 v[36:39], a[208:211], v[100:103], 0
  v_mfma_f32_16x16x32_bf16 v[176:179], v[62:65], v[100:103], 0
  v_mfma_f32_16x16x32_bf16 v[180:183], v[126:129], v[100:103], 0
  v_sub_f32 v160, v160, v226
  v_sub_f32 v161, v161, v226
  v_sub_f32 v162, v162, v226
  v_sub_f32 v163, v163, v226
  v_sub_f32 v164, v164, v226
  v_sub_f32 v165, v165, v226
  v_sub_f32 v166, v166, v226
  buffer_load_dwordx4 v7, s[8:11], s27 offen offset:3072 lds
  s_bfe_u32 s29, 0x302010e, s53
  s_add_u32 s52, s52, s29
  s_add_u32 s53, s53, 8
  s_and_b32 s53, s53, 0x8001f
  s_and_b32 s52, s52, 15
  s_lshl_b32 s29, s52, 7
  s_or_b32 s26, s30, s29
  s_or_b32 s27, s31, s29
  v_sub_f32 v167, v167, v226
  v_exp_f32 v160, v160
  v_exp_f32 v161, v161
  v_exp_f32 v162, v162
  v_exp_f32 v163, v163
  v_exp_f32 v164, v164
  v_exp_f32 v165, v165
  v_exp_f32 v166, v166
  v_exp_f32 v167, v167
  v_cvt_pk_bf16_f32 v96, v168, v169
  v_cvt_pk_bf16_f32 v97, v170, v171
  v_cvt_pk_bf16_f32 v98, v172, v173
  v_cvt_pk_bf16_f32 v99, v174, v175
  s_nop 1
  v_mfma_f32_16x16x32_bf16 v[32:35], a[208:211], v[96:99], 0
  v_mfma_f32_16x16x32_bf16 v[168:171], v[60:63], v[96:99], 0
  v_mfma_f32_16x16x32_bf16 v[172:175], v[124:127], v[96:99], 0
  v_sub_f32 v152, v152, v224
  v_sub_f32 v153, v153, v224
  v_sub_f32 v154, v154, v224
  v_sub_f32 v155, v155, v224
  v_sub_f32 v156, v156, v224
  v_sub_f32 v157, v157, v224
  v_sub_f32 v158, v158, v224
  v_sub_f32 v159, v159, v224
  v_exp_f32 v152, v152
  v_exp_f32 v153, v153
  v_exp_f32 v154, v154
  v_exp_f32 v155, v155
  v_exp_f32 v156, v156
  v_exp_f32 v157, v157
  v_exp_f32 v158, v158
  v_exp_f32 v159, v159
  v_cvt_pk_bf16_f32 v92, v160, v161
  v_cvt_pk_bf16_f32 v93, v162, v163
  v_cvt_pk_bf16_f32 v94, v164, v165
  v_cvt_pk_bf16_f32 v95, v166, v167
  s_nop 1
  v_mfma_f32_16x16x32_bf16 v[28:31], a[208:211], v[92:95], 0
  v_mfma_f32_16x16x32_bf16 v[160:163], v[58:61], v[92:95], 0
  v_mfma_f32_16x16x32_bf16 v[164:167], v[122:125], v[92:95], 0
  v_cvt_pk_bf16_f32 v88, v152, v153
  v_cvt_pk_bf16_f32 v89, v154, v155
  v_cvt_pk_bf16_f32 v90, v156, v157
  v_cvt_pk_bf16_f32 v91, v158, v159
  s_nop 1
  v_mfma_f32_16x16x32_bf16 v[24:27], a[208:211], v[88:91], 0
  v_mfma_f32_16x16x32_bf16 v[152:155], v[56:59], v[88:91], 0
  v_mfma_f32_16x16x32_bf16 v[156:159], v[120:123], v[88:91], 0
  v_rcp_f32 v52, v52
  v_rcp_f32 v48, v48
  v_rcp_f32 v44, v44
  v_rcp_f32 v40, v40
  v_rcp_f32 v36, v36
  v_rcp_f32 v32, v32
  v_rcp_f32 v28, v28
  v_rcp_f32 v24, v24
  v_mov_b32 v53, v52
  v_mov_b32 v49, v48
  v_mov_b32 v45, v44
  v_mov_b32 v41, v40
  v_mov_b32 v37, v36
  v_mov_b32 v33, v32
  v_mov_b32 v29, v28
  v_mov_b32 v25, v24
  v_pk_mul_f32 v[208:209], v[208:209], v[52:53]
  v_pk_mul_f32 v[210:211], v[210:211], v[52:53]
  v_pk_mul_f32 v[212:213], v[212:213], v[52:53]
  v_pk_mul_f32 v[214:215], v[214:215], v[52:53]
  v_cvt_pk_bf16_f32 v208, v208, v209
  v_cvt_pk_bf16_f32 v209, v210, v211
  v_cvt_pk_bf16_f32 v210, v212, v213
  v_cvt_pk_bf16_f32 v211, v214, v215
  buffer_store_dwordx4 v[208:211], v2, s[16:19], s58 offen offset:3072 sc1
  v_pk_mul_f32 v[200:201], v[200:201], v[48:49]
  v_pk_mul_f32 v[202:203], v[202:203], v[48:49]
  v_pk_mul_f32 v[204:205], v[204:205], v[48:49]
  v_pk_mul_f32 v[206:207], v[206:207], v[48:49]
  v_cvt_pk_bf16_f32 v200, v200, v201
  v_cvt_pk_bf16_f32 v201, v202, v203
  v_cvt_pk_bf16_f32 v202, v204, v205
  v_cvt_pk_bf16_f32 v203, v206, v207
  buffer_store_dwordx4 v[200:203], v2, s[16:19], s58 offen offset:2048 sc1
  v_pk_mul_f32 v[192:193], v[192:193], v[44:45]
  v_pk_mul_f32 v[194:195], v[194:195], v[44:45]
  v_pk_mul_f32 v[196:197], v[196:197], v[44:45]
  v_pk_mul_f32 v[198:199], v[198:199], v[44:45]
  v_cvt_pk_bf16_f32 v192, v192, v193
  v_cvt_pk_bf16_f32 v193, v194, v195
  v_cvt_pk_bf16_f32 v194, v196, v197
  v_cvt_pk_bf16_f32 v195, v198, v199
  buffer_store_dwordx4 v[192:195], v2, s[16:19], s58 offen offset:1024 sc1
  v_pk_mul_f32 v[184:185], v[184:185], v[40:41]
  v_pk_mul_f32 v[186:187], v[186:187], v[40:41]
  v_pk_mul_f32 v[188:189], v[188:189], v[40:41]
  v_pk_mul_f32 v[190:191], v[190:191], v[40:41]
  v_cvt_pk_bf16_f32 v184, v184, v185
  v_cvt_pk_bf16_f32 v185, v186, v187
  v_cvt_pk_bf16_f32 v186, v188, v189
  v_cvt_pk_bf16_f32 v187, v190, v191
  buffer_store_dwordx4 v[184:187], v2, s[16:19], s58 offen offset:0 sc1
  v_pk_mul_f32 v[176:177], v[176:177], v[36:37]
  v_pk_mul_f32 v[178:179], v[178:179], v[36:37]
  v_pk_mul_f32 v[180:181], v[180:181], v[36:37]
  v_pk_mul_f32 v[182:183], v[182:183], v[36:37]
  v_cvt_pk_bf16_f32 v176, v176, v177
  v_cvt_pk_bf16_f32 v177, v178, v179
  v_cvt_pk_bf16_f32 v178, v180, v181
  v_cvt_pk_bf16_f32 v179, v182, v183
  buffer_store_dwordx4 v[176:179], v2, s[16:19], s57 offen offset:3072 sc1
  v_pk_mul_f32 v[168:169], v[168:169], v[32:33]
  v_pk_mul_f32 v[170:171], v[170:171], v[32:33]
  v_pk_mul_f32 v[172:173], v[172:173], v[32:33]
  v_pk_mul_f32 v[174:175], v[174:175], v[32:33]
  v_cvt_pk_bf16_f32 v168, v168, v169
  v_cvt_pk_bf16_f32 v169, v170, v171
  v_cvt_pk_bf16_f32 v170, v172, v173
  v_cvt_pk_bf16_f32 v171, v174, v175
  buffer_store_dwordx4 v[168:171], v2, s[16:19], s57 offen offset:2048 sc1
  v_pk_mul_f32 v[160:161], v[160:161], v[28:29]
  v_pk_mul_f32 v[162:163], v[162:163], v[28:29]
  v_pk_mul_f32 v[164:165], v[164:165], v[28:29]
  v_pk_mul_f32 v[166:167], v[166:167], v[28:29]
  v_cvt_pk_bf16_f32 v160, v160, v161
  v_cvt_pk_bf16_f32 v161, v162, v163
  v_cvt_pk_bf16_f32 v162, v164, v165
  v_cvt_pk_bf16_f32 v163, v166, v167
  buffer_store_dwordx4 v[160:163], v2, s[16:19], s57 offen offset:1024 sc1
  v_pk_mul_f32 v[152:153], v[152:153], v[24:25]
  v_pk_mul_f32 v[154:155], v[154:155], v[24:25]
  v_pk_mul_f32 v[156:157], v[156:157], v[24:25]
  v_pk_mul_f32 v[158:159], v[158:159], v[24:25]
  v_cvt_pk_bf16_f32 v152, v152, v153
  v_cvt_pk_bf16_f32 v153, v154, v155
  v_cvt_pk_bf16_f32 v154, v156, v157
  v_cvt_pk_bf16_f32 v155, v158, v159
  buffer_store_dwordx4 v[152:155], v2, s[16:19], s57 offen offset:0 sc1
  s_lshl_b32 s34, s32, 4
  s_add_u32 s34, s34, s33
  s_lshl_b32 s34, s34, 7
  s_add_u32 s34, s34, 32768
  s_mov_b32 s63, 0x70000000
Lp3:
  v_accvgpr_read_b32 v16, a230
  v_accvgpr_read_b32 v17, a231
  v_accvgpr_read_b32 v18, a232
  v_accvgpr_read_b32 v19, a233
  v_accvgpr_read_b32 v20, a234
  v_accvgpr_read_b32 v21, a235
  s_mov_b32 s89, 0
  s_mov_b32 s91, 4294901760
  s_mov_b32 s92, 32768
  s_mov_b32 s89, 1
  s_mov_b32 s69, 0
  s_mov_b32 s71, 4294934528
  s_mov_b32 s72, 16384
  s_waitcnt vmcnt(28)
  s_barrier
  ds_read_b128 a[0:3], v16 offset:0
  ds_read_b64_tr_b16 a[32:33], v18 offset:0
  ds_read_b64_tr_b16 a[34:35], v18 offset:2048
  ds_read_b128 a[4:7], v16 offset:2048
  ds_read_b128 a[8:11], v16 offset:4096
  ds_read_b128 a[12:15], v16 offset:6144
  ds_read_b64_tr_b16 a[36:37], v19 offset:0
  ds_read_b64_tr_b16 a[38:39], v19 offset:2048
  ds_read_b64_tr_b16 a[40:41], v20 offset:0
  ds_read_b64_tr_b16 a[42:43], v20 offset:2048
  ds_read_b64_tr_b16 a[44:45], v21 offset:0
  ds_read_b64_tr_b16 a[46:47], v21 offset:2048
  ds_read_b64_tr_b16 a[48:49], v18 offset:8192
  ds_read_b64_tr_b16 a[50:51], v18 offset:10240
  ds_read_b64_tr_b16 a[52:53], v19 offset:8192
  ds_read_b64_tr_b16 a[54:55], v19 offset:10240
  ds_read_b64_tr_b16 a[56:57], v20 offset:8192
  ds_read_b64_tr_b16 a[58:59], v20 offset:10240
  ds_read_b64_tr_b16 a[60:61], v21 offset:8192
  ds_read_b64_tr_b16 a[62:63], v21 offset:10240
  s_waitcnt lgkmcnt(0)
  v_mfma_f32_16x16x32_bf16 v[32:35], a[32:35], a[0:3], 0
  s_add_u32 s60, s63, 32768
  buffer_store_dwordx4 v[192:195], v2, s[16:19], s60 offen offset:0 sc1
  ds_read_b128 a[16:19], v17 offset:0
  v_mfma_f32_16x16x32_bf16 v[64:67], a[32:35], a[4:7], 0
  s_add_u32 s60, s63, 40960
  ds_read_b64_tr_b16 a[64:65], v18 offset:4096
  v_mfma_f32_16x16x32_bf16 v[96:99], a[32:35], a[8:11], 0
  ds_read_b64_tr_b16 a[66:67], v18 offset:6144
  v_mfma_f32_16x16x32_bf16 v[128:131], a[32:35], a[12:15], 0
  buffer_store_dwordx4 v[224:227], v2, s[16:19], s60 offen offset:0 sc1
  ds_read_b128 a[20:23], v17 offset:2048
  v_mfma_f32_16x16x32_bf16 v[36:39], a[36:39], a[0:3], 0
  s_add_u32 s60, s63, 32768
  ds_read_b128 a[24:27], v17 offset:4096
  v_mfma_f32_16x16x32_bf16 v[68:71], a[36:39], a[4:7], 0
  ds_read_b128 a[28:31], v17 offset:6144
  v_mfma_f32_16x16x32_bf16 v[100:103], a[36:39], a[8:11], 0
  buffer_store_dwordx4 v[196:199], v2, s[16:19], s60 offen offset:1024 sc1
  ds_read_b64_tr_b16 a[68:69], v19 offset:4096
  v_mfma_f32_16x16x32_bf16 v[132:135], a[36:39], a[12:15], 0
  s_add_u32 s60, s63, 40960
  ds_read_b64_tr_b16 a[70:71], v19 offset:6144
  v_mfma_f32_16x16x32_bf16 v[40:43], a[40:43], a[0:3], 0
  ds_read_b64_tr_b16 a[72:73], v20 offset:4096
  v_mfma_f32_16x16x32_bf16 v[72:75], a[40:43], a[4:7], 0
  buffer_store_dwordx4 v[228:231], v2, s[16:19], s60 offen offset:1024 sc1
  ds_read_b64_tr_b16 a[74:75], v20 offset:6144
  v_mfma_f32_16x16x32_bf16 v[104:107], a[40:43], a[8:11], 0
  s_add_u32 s60, s63, 32768
  v_mfma_f32_16x16x32_bf16 v[136:139], a[40:43], a[12:15], 0
  ds_read_b64_tr_b16 a[76:77], v21 offset:4096
  v_mfma_f32_16x16x32_bf16 v[44:47], a[44:47], a[0:3], 0
  buffer_store_dwordx4 v[200:203], v2, s[16:19], s60 offen offset:2048 sc1
  ds_read_b64_tr_b16 a[78:79], v21 offset:6144
  v_mfma_f32_16x16x32_bf16 v[76:79], a[44:47], a[4:7], 0
  s_add_u32 s60, s63, 40960
  ds_read_b64_tr_b16 a[80:81], v18 offset:12288
  v_mfma_f32_16x16x32_bf16 v[108:111], a[44:47], a[8:11], 0
  ds_read_b64_tr_b16 a[82:83], v18 offset:14336
  v_mfma_f32_16x16x32_bf16 v[140:143], a[44:47], a[12:15], 0
  buffer_store_dwordx4 v[232:235], v2, s[16:19], s60 offen offset:2048 sc1
  ds_read_b64_tr_b16 a[84:85], v19 offset:12288
  v_mfma_f32_16x16x32_bf16 v[48:51], a[48:51], a[0:3], 0
  s_add_u32 s60, s63, 32768
  ds_read_b64_tr_b16 a[86:87], v19 offset:14336
  v_mfma_f32_16x16x32_bf16 v[80:83], a[48:51], a[4:7], 0
  ds_read_b64_tr_b16 a[88:89], v20 offset:12288
  v_mfma_f32_16x16x32_bf16 v[112:115], a[48:51], a[8:11], 0
  buffer_store_dwordx4 v[204:207], v2, s[16:19], s60 offen offset:3072 sc1
  ds_read_b64_tr_b16 a[90:91], v20 offset:14336
  v_mfma_f32_16x16x32_bf16 v[144:147], a[48:51], a[12:15], 0
  s_add_u32 s60, s63, 40960
  ds_read_b64_tr_b16 a[92:93], v21 offset:12288
  v_mfma_f32_16x16x32_bf16 v[52:55], a[52:55], a[0:3], 0
  ds_read_b64_tr_b16 a[94:95], v21 offset:14336
  v_mfma_f32_16x16x32_bf16 v[84:87], a[52:55], a[4:7], 0
  buffer_store_dwordx4 v[236:239], v2, s[16:19], s60 offen offset:3072 sc1
  v_mfma_f32_16x16x32_bf16 v[116:119], a[52:55], a[8:11], 0
  s_add_u32 s89, s89, 1
  s_cmp_eq_u32 s89, 3
  s_cselect_b32 s89, 0, s89
  s_cselect_b32 s90, s91, s92
  v_mfma_f32_16x16x32_bf16 v[148:151], a[52:55], a[12:15], 0
  s_add_u32 s69, s69, 1
  s_cmp_eq_u32 s69, 3
  s_cselect_b32 s69, 0, s69
  s_cselect_b32 s70, s71, s72
  v_mfma_f32_16x16x32_bf16 v[56:59], a[56:59], a[0:3], 0
  v_add_u32 v16, s90, v16
  v_add_u32 v17, s90, v17
  v_mfma_f32_16x16x32_bf16 v[88:91], a[56:59], a[4:7], 0
  v_add_u32 v18, s70, v18
  v_add_u32 v19, s70, v19
  v_mfma_f32_16x16x32_bf16 v[120:123], a[56:59], a[8:11], 0
  v_add_u32 v20, s70, v20
  v_add_u32 v21, s70, v21
  v_mfma_f32_16x16x32_bf16 v[152:155], a[56:59], a[12:15], 0
  v_mfma_f32_16x16x32_bf16 v[60:63], a[60:63], a[0:3], 0
  v_mfma_f32_16x16x32_bf16 v[92:95], a[60:63], a[4:7], 0
  v_mfma_f32_16x16x32_bf16 v[124:127], a[60:63], a[8:11], 0
  v_mfma_f32_16x16x32_bf16 v[156:159], a[60:63], a[12:15], 0
  s_waitcnt vmcnt(20) lgkmcnt(0)
  s_barrier
  v_mfma_f32_16x16x32_bf16 v[32:35], a[64:67], a[16:19], v[32:35]
  s_mov_b32 m0, s68
  ds_read_b128 a[0:3], v16 offset:0
  v_mfma_f32_16x16x32_bf16 v[64:67], a[64:67], a[20:23], v[64:67]
  buffer_load_dwordx4 v8, s[20:23], s28 offen offset:0 lds
  ds_read_b64_tr_b16 a[32:33], v18 offset:0
  v_mfma_f32_16x16x32_bf16 v[96:99], a[64:67], a[24:27], v[96:99]
  ds_read_b64_tr_b16 a[34:35], v18 offset:2048
  v_mfma_f32_16x16x32_bf16 v[128:131], a[64:67], a[28:31], v[128:131]
  ds_read_b128 a[4:7], v16 offset:2048
  v_mfma_f32_16x16x32_bf16 v[36:39], a[68:71], a[16:19], v[36:39]
  ds_read_b128 a[8:11], v16 offset:4096
  v_mfma_f32_16x16x32_bf16 v[68:71], a[68:71], a[20:23], v[68:71]
  buffer_load_dwordx4 v9, s[20:23], s28 offen offset:1024 lds
  ds_read_b128 a[12:15], v16 offset:6144
  v_mfma_f32_16x16x32_bf16 v[100:103], a[68:71], a[24:27], v[100:103]
  ds_read_b64_tr_b16 a[36:37], v19 offset:0
  v_mfma_f32_16x16x32_bf16 v[132:135], a[68:71], a[28:31], v[132:135]
  ds_read_b64_tr_b16 a[38:39], v19 offset:2048
  v_mfma_f32_16x16x32_bf16 v[40:43], a[72:75], a[16:19], v[40:43]
  ds_read_b64_tr_b16 a[40:41], v20 offset:0
  v_mfma_f32_16x16x32_bf16 v[72:75], a[72:75], a[20:23], v[72:75]
  ds_read_b64_tr_b16 a[42:43], v20 offset:2048
  v_mfma_f32_16x16x32_bf16 v[104:107], a[72:75], a[24:27], v[104:107]
  buffer_load_dwordx4 v10, s[20:23], s28 offen offset:2048 lds
  v_mfma_f32_16x16x32_bf16 v[136:139], a[72:75], a[28:31], v[136:139]
  ds_read_b64_tr_b16 a[44:45], v21 offset:0
  v_mfma_f32_16x16x32_bf16 v[44:47], a[76:79], a[16:19], v[44:47]
  ds_read_b64_tr_b16 a[46:47], v21 offset:2048
  v_mfma_f32_16x16x32_bf16 v[76:79], a[76:79], a[20:23], v[76:79]
  ds_read_b64_tr_b16 a[48:49], v18 offset:8192
  v_mfma_f32_16x16x32_bf16 v[108:111], a[76:79], a[24:27], v[108:111]
  ds_read_b64_tr_b16 a[50:51], v18 offset:10240
  v_mfma_f32_16x16x32_bf16 v[140:143], a[76:79], a[28:31], v[140:143]
  buffer_load_dwordx4 v11, s[20:23], s28 offen offset:3072 lds
  ds_read_b64_tr_b16 a[52:53], v19 offset:8192
  v_mfma_f32_16x16x32_bf16 v[48:51], a[80:83], a[16:19], v[48:51]
  s_bfe_u32 s56, 0x302010e, s55
  s_add_u32 s54, s54, s56
  s_add_u32 s55, s55, 8
  v_mfma_f32_16x16x32_bf16 v[80:83], a[80:83], a[20:23], v[80:83]
  s_and_b32 s55, s55, 0x8001f
  s_and_b32 s54, s54, 15
  s_lshl_b32 s28, s54, 19
  v_mfma_f32_16x16x32_bf16 v[112:115], a[80:83], a[24:27], v[112:115]
  s_mov_b32 m0, s88
  ds_read_b64_tr_b16 a[54:55], v19 offset:10240
  ds_read_b64_tr_b16 a[56:57], v20 offset:8192
  v_mfma_f32_16x16x32_bf16 v[144:147], a[80:83], a[28:31], v[144:147]
  ds_read_b64_tr_b16 a[58:59], v20 offset:10240
  ds_read_b64_tr_b16 a[60:61], v21 offset:8192
  v_mfma_f32_16x16x32_bf16 v[52:55], a[84:87], a[16:19], v[52:55]
  buffer_load_dwordx4 v4, s[8:11], s26 offen offset:0 lds
  ds_read_b64_tr_b16 a[62:63], v21 offset:10240
  v_mfma_f32_16x16x32_bf16 v[84:87], a[84:87], a[20:23], v[84:87]
  v_mfma_f32_16x16x32_bf16 v[116:119], a[84:87], a[24:27], v[116:119]
  v_mfma_f32_16x16x32_bf16 v[148:151], a[84:87], a[28:31], v[148:151]
  v_mfma_f32_16x16x32_bf16 v[56:59], a[88:91], a[16:19], v[56:59]
  v_mfma_f32_16x16x32_bf16 v[88:91], a[88:91], a[20:23], v[88:91]
  buffer_load_dwordx4 v5, s[8:11], s26 offen offset:1024 lds
  v_mfma_f32_16x16x32_bf16 v[120:123], a[88:91], a[24:27], v[120:123]
  v_mfma_f32_16x16x32_bf16 v[152:155], a[88:91], a[28:31], v[152:155]
  v_mfma_f32_16x16x32_bf16 v[60:63], a[92:95], a[16:19], v[60:63]
  v_mfma_f32_16x16x32_bf16 v[92:95], a[92:95], a[20:23], v[92:95]
  v_mfma_f32_16x16x32_bf16 v[124:127], a[92:95], a[24:27], v[124:127]
  v_mfma_f32_16x16x32_bf16 v[156:159], a[92:95], a[28:31], v[156:159]
  s_waitcnt lgkmcnt(0)
  v_mfma_f32_16x16x32_bf16 v[32:35], a[32:35], a[0:3], v[32:35]
  buffer_load_dwordx4 v6, s[8:11], s26 offen offset:2048 lds
  ds_read_b128 a[16:19], v17 offset:0
  v_mfma_f32_16x16x32_bf16 v[64:67], a[32:35], a[4:7], v[64:67]
  ds_read_b64_tr_b16 a[64:65], v18 offset:4096
  v_mfma_f32_16x16x32_bf16 v[96:99], a[32:35], a[8:11], v[96:99]
  ds_read_b64_tr_b16 a[66:67], v18 offset:6144
  v_mfma_f32_16x16x32_bf16 v[128:131], a[32:35], a[12:15], v[128:131]
  ds_read_b128 a[20:23], v17 offset:2048
  v_mfma_f32_16x16x32_bf16 v[36:39], a[36:39], a[0:3], v[36:39]
  buffer_load_dwordx4 v7, s[8:11], s26 offen offset:3072 lds
  ds_read_b128 a[24:27], v17 offset:4096
  v_mfma_f32_16x16x32_bf16 v[68:71], a[36:39], a[4:7], v[68:71]
  s_add_u32 m0, s88, 4096
  ds_read_b128 a[28:31], v17 offset:6144
  v_mfma_f32_16x16x32_bf16 v[100:103], a[36:39], a[8:11], v[100:103]
  ds_read_b64_tr_b16 a[68:69], v19 offset:4096
  v_mfma_f32_16x16x32_bf16 v[132:135], a[36:39], a[12:15], v[132:135]
  ds_read_b64_tr_b16 a[70:71], v19 offset:6144
  v_mfma_f32_16x16x32_bf16 v[40:43], a[40:43], a[0:3], v[40:43]
  buffer_load_dwordx4 v4, s[8:11], s27 offen offset:0 lds
  ds_read_b64_tr_b16 a[72:73], v20 offset:4096
  v_mfma_f32_16x16x32_bf16 v[72:75], a[40:43], a[4:7], v[72:75]
  ds_read_b64_tr_b16 a[74:75], v20 offset:6144
  v_mfma_f32_16x16x32_bf16 v[104:107], a[40:43], a[8:11], v[104:107]
  v_mfma_f32_16x16x32_bf16 v[136:139], a[40:43], a[12:15], v[136:139]
  ds_read_b64_tr_b16 a[76:77], v21 offset:4096
  v_mfma_f32_16x16x32_bf16 v[44:47], a[44:47], a[0:3], v[44:47]
  buffer_load_dwordx4 v5, s[8:11], s27 offen offset:1024 lds
  ds_read_b64_tr_b16 a[78:79], v21 offset:6144
  v_mfma_f32_16x16x32_bf16 v[76:79], a[44:47], a[4:7], v[76:79]
  ds_read_b64_tr_b16 a[80:81], v18 offset:12288
  v_mfma_f32_16x16x32_bf16 v[108:111], a[44:47], a[8:11], v[108:111]
  ds_read_b64_tr_b16 a[82:83], v18 offset:14336
  v_mfma_f32_16x16x32_bf16 v[140:143], a[44:47], a[12:15], v[140:143]
  ds_read_b64_tr_b16 a[84:85], v19 offset:12288
  v_mfma_f32_16x16x32_bf16 v[48:51], a[48:51], a[0:3], v[48:51]
  buffer_load_dwordx4 v6, s[8:11], s27 offen offset:2048 lds
  ds_read_b64_tr_b16 a[86:87], v19 offset:14336
  v_mfma_f32_16x16x32_bf16 v[80:83], a[48:51], a[4:7], v[80:83]
  ds_read_b64_tr_b16 a[88:89], v20 offset:12288
  v_mfma_f32_16x16x32_bf16 v[112:115], a[48:51], a[8:11], v[112:115]
  ds_read_b64_tr_b16 a[90:91], v20 offset:14336
  v_mfma_f32_16x16x32_bf16 v[144:147], a[48:51], a[12:15], v[144:147]
  ds_read_b64_tr_b16 a[92:93], v21 offset:12288
  v_mfma_f32_16x16x32_bf16 v[52:55], a[52:55], a[0:3], v[52:55]
  buffer_load_dwordx4 v7, s[8:11], s27 offen offset:3072 lds
  ds_read_b64_tr_b16 a[94:95], v21 offset:14336
  v_mfma_f32_16x16x32_bf16 v[84:87], a[52:55], a[4:7], v[84:87]
  s_bfe_u32 s29, 0x302010e, s53
  s_add_u32 s52, s52, s29
  s_add_u32 s53, s53, 8
  v_mfma_f32_16x16x32_bf16 v[116:119], a[52:55], a[8:11], v[116:119]
  s_and_b32 s53, s53, 0x8001f
  s_and_b32 s52, s52, 15
  s_lshl_b32 s29, s52, 7
  v_mfma_f32_16x16x32_bf16 v[148:151], a[52:55], a[12:15], v[148:151]
  s_or_b32 s26, s30, s29
  s_or_b32 s27, s31, s29
  v_mfma_f32_16x16x32_bf16 v[56:59], a[56:59], a[0:3], v[56:59]
  s_add_u32 s88, s88, s90
  s_add_u32 s89, s89, 1
  s_cmp_eq_u32 s89, 3
  s_cselect_b32 s89, 0, s89
  s_cselect_b32 s90, s91, s92
  v_mfma_f32_16x16x32_bf16 v[88:91], a[56:59], a[4:7], v[88:91]
  s_add_u32 s68, s68, s70
  s_add_u32 s69, s69, 1
  s_cmp_eq_u32 s69, 3
  s_cselect_b32 s69, 0, s69
  s_cselect_b32 s70, s71, s72
  v_mfma_f32_16x16x32_bf16 v[120:123], a[56:59], a[8:11], v[120:123]
  v_add_u32 v16, s90, v16
  v_add_u32 v17, s90, v17
  v_mfma_f32_16x16x32_bf16 v[152:155], a[56:59], a[12:15], v[152:155]
  v_add_u32 v18, s70, v18
  v_add_u32 v19, s70, v19
  v_mfma_f32_16x16x32_bf16 v[60:63], a[60:63], a[0:3], v[60:63]
  v_add_u32 v20, s70, v20
  v_add_u32 v21, s70, v21
  v_mfma_f32_16x16x32_bf16 v[92:95], a[60:63], a[4:7], v[92:95]
  v_mfma_f32_16x16x32_bf16 v[124:127], a[60:63], a[8:11], v[124:127]
  v_mfma_f32_16x16x32_bf16 v[156:159], a[60:63], a[12:15], v[156:159]
  s_waitcnt vmcnt(20) lgkmcnt(0)
  s_barrier
  v_mfma_f32_16x16x32_bf16 v[32:35], a[64:67], a[16:19], v[32:35]
  s_mov_b32 m0, s68
  ds_read_b128 a[0:3], v16 offset:0
  v_mfma_f32_16x16x32_bf16 v[64:67], a[64:67], a[20:23], v[64:67]
  buffer_load_dwordx4 v8, s[20:23], s28 offen offset:0 lds
  ds_read_b64_tr_b16 a[32:33], v18 offset:0
  v_mfma_f32_16x16x32_bf16 v[96:99], a[64:67], a[24:27], v[96:99]
  ds_read_b64_tr_b16 a[34:35], v18 offset:2048
  v_mfma_f32_16x16x32_bf16 v[128:131], a[64:67], a[28:31], v[128:131]
  buffer_load_dwordx4 v9, s[20:23], s28 offen offset:1024 lds
  ds_read_b128 a[4:7], v16 offset:2048
  v_mfma_f32_16x16x32_bf16 v[36:39], a[68:71], a[16:19], v[36:39]
  ds_read_b128 a[8:11], v16 offset:4096
  v_mfma_f32_16x16x32_bf16 v[68:71], a[68:71], a[20:23], v[68:71]
  ds_read_b128 a[12:15], v16 offset:6144
  v_mfma_f32_16x16x32_bf16 v[100:103], a[68:71], a[24:27], v[100:103]
  buffer_load_dwordx4 v10, s[20:23], s28 offen offset:2048 lds
  ds_read_b64_tr_b16 a[36:37], v19 offset:0
  v_mfma_f32_16x16x32_bf16 v[132:135], a[68:71], a[28:31], v[132:135]
  ds_read_b64_tr_b16 a[38:39], v19 offset:2048
  v_mfma_f32_16x16x32_bf16 v[40:43], a[72:75], a[16:19], v[40:43]
  ds_read_b64_tr_b16 a[40:41], v20 offset:0
  v_mfma_f32_16x16x32_bf16 v[72:75], a[72:75], a[20:23], v[72:75]
  buffer_load_dwordx4 v11, s[20:23], s28 offen offset:3072 lds
  ds_read_b64_tr_b16 a[42:43], v20 offset:2048
  v_mfma_f32_16x16x32_bf16 v[104:107], a[72:75], a[24:27], v[104:107]
  s_bfe_u32 s56, 0x302010e, s55
  s_add_u32 s54, s54, s56
  s_add_u32 s55, s55, 8
  v_mfma_f32_16x16x32_bf16 v[136:139], a[72:75], a[28:31], v[136:139]
  s_and_b32 s55, s55, 0x8001f
  s_and_b32 s54, s54, 15
  s_lshl_b32 s28, s54, 19
  v_mfma_f32_16x16x32_bf16 v[44:47], a[76:79], a[16:19], v[44:47]
  s_mov_b32 m0, s88
  ds_read_b64_tr_b16 a[44:45], v21 offset:0
  ds_read_b64_tr_b16 a[46:47], v21 offset:2048
  v_mfma_f32_16x16x32_bf16 v[76:79], a[76:79], a[20:23], v[76:79]
  buffer_load_dwordx4 v4, s[8:11], s26 offen offset:0 lds
  ds_read_b64_tr_b16 a[48:49], v18 offset:8192
  v_mfma_f32_16x16x32_bf16 v[108:111], a[76:79], a[24:27], v[108:111]
  ds_read_b64_tr_b16 a[50:51], v18 offset:10240
  v_mfma_f32_16x16x32_bf16 v[140:143], a[76:79], a[28:31], v[140:143]
  buffer_load_dwordx4 v5, s[8:11], s26 offen offset:1024 lds
  ds_read_b64_tr_b16 a[52:53], v19 offset:8192
  v_mfma_f32_16x16x32_bf16 v[48:51], a[80:83], a[16:19], v[48:51]
  ds_read_b64_tr_b16 a[54:55], v19 offset:10240
  v_mfma_f32_16x16x32_bf16 v[80:83], a[80:83], a[20:23], v[80:83]
  ds_read_b64_tr_b16 a[56:57], v20 offset:8192
  v_mfma_f32_16x16x32_bf16 v[112:115], a[80:83], a[24:27], v[112:115]
  buffer_load_dwordx4 v6, s[8:11], s26 offen offset:2048 lds
  ds_read_b64_tr_b16 a[58:59], v20 offset:10240
  v_mfma_f32_16x16x32_bf16 v[144:147], a[80:83], a[28:31], v[144:147]
  ds_read_b64_tr_b16 a[60:61], v21 offset:8192
  v_mfma_f32_16x16x32_bf16 v[52:55], a[84:87], a[16:19], v[52:55]
  ds_read_b64_tr_b16 a[62:63], v21 offset:10240
  v_mfma_f32_16x16x32_bf16 v[84:87], a[84:87], a[20:23], v[84:87]
  buffer_load_dwordx4 v7, s[8:11], s26 offen offset:3072 lds
  v_mfma_f32_16x16x32_bf16 v[116:119], a[84:87], a[24:27], v[116:119]
  s_add_u32 m0, s88, 4096
  v_mfma_f32_16x16x32_bf16 v[148:151], a[84:87], a[28:31], v[148:151]
  v_mfma_f32_16x16x32_bf16 v[56:59], a[88:91], a[16:19], v[56:59]
  buffer_load_dwordx4 v4, s[8:11], s27 offen offset:0 lds
  v_mfma_f32_16x16x32_bf16 v[88:91], a[88:91], a[20:23], v[88:91]
  v_mfma_f32_16x16x32_bf16 v[120:123], a[88:91], a[24:27], v[120:123]
  v_mfma_f32_16x16x32_bf16 v[152:155], a[88:91], a[28:31], v[152:155]
  buffer_load_dwordx4 v5, s[8:11], s27 offen offset:1024 lds
  v_mfma_f32_16x16x32_bf16 v[60:63], a[92:95], a[16:19], v[60:63]
  v_mfma_f32_16x16x32_bf16 v[92:95], a[92:95], a[20:23], v[92:95]
  v_mfma_f32_16x16x32_bf16 v[124:127], a[92:95], a[24:27], v[124:127]
  v_mfma_f32_16x16x32_bf16 v[156:159], a[92:95], a[28:31], v[156:159]
  s_waitcnt lgkmcnt(0)
  v_mfma_f32_16x16x32_bf16 v[32:35], a[32:35], a[0:3], v[32:35]
  buffer_load_dwordx4 v6, s[8:11], s27 offen offset:2048 lds
  ds_read_b128 a[16:19], v17 offset:0
  v_mfma_f32_16x16x32_bf16 v[64:67], a[32:35], a[4:7], v[64:67]
  ds_read_b64_tr_b16 a[64:65], v18 offset:4096
  v_mfma_f32_16x16x32_bf16 v[96:99], a[32:35], a[8:11], v[96:99]
  buffer_load_dwordx4 v7, s[8:11], s27 offen offset:3072 lds
  ds_read_b64_tr_b16 a[66:67], v18 offset:6144
  v_mfma_f32_16x16x32_bf16 v[128:131], a[32:35], a[12:15], v[128:131]
  s_bfe_u32 s29, 0x302010e, s53
  s_add_u32 s52, s52, s29
  s_add_u32 s53, s53, 8
  v_mfma_f32_16x16x32_bf16 v[36:39], a[36:39], a[0:3], v[36:39]
  s_and_b32 s53, s53, 0x8001f
  s_and_b32 s52, s52, 15
  s_lshl_b32 s29, s52, 7
  v_mfma_f32_16x16x32_bf16 v[68:71], a[36:39], a[4:7], v[68:71]
  s_or_b32 s26, s30, s29
  s_or_b32 s27, s31, s29
  s_add_u32 s60, s63, 36864
  v_mfma_f32_16x16x32_bf16 v[100:103], a[36:39], a[8:11], v[100:103]
  buffer_store_dwordx4 v[208:211], v2, s[16:19], s60 offen offset:0 sc1
  ds_read_b128 a[20:23], v17 offset:2048
  v_mfma_f32_16x16x32_bf16 v[132:135], a[36:39], a[12:15], v[132:135]
  s_add_u32 s60, s63, 45056
  buffer_store_dwordx4 v[240:243], v2, s[16:19], s60 offen offset:0 sc1
  ds_read_b128 a[24:27], v17 offset:4096
  v_mfma_f32_16x16x32_bf16 v[40:43], a[40:43], a[0:3], v[40:43]
  s_add_u32 s60, s63, 36864
  ds_read_b128 a[28:31], v17 offset:6144
  ds_read_b64_tr_b16 a[68:69], v19 offset:4096
  v_mfma_f32_16x16x32_bf16 v[72:75], a[40:43], a[4:7], v[72:75]
  ds_read_b64_tr_b16 a[70:71], v19 offset:6144
  ds_read_b64_tr_b16 a[72:73], v20 offset:4096
  v_mfma_f32_16x16x32_bf16 v[104:107], a[40:43], a[8:11], v[104:107]
  buffer_store_dwordx4 v[212:215], v2, s[16:19], s60 offen offset:1024 sc1
  ds_read_b64_tr_b16 a[74:75], v20 offset:6144
  v_mfma_f32_16x16x32_bf16 v[136:139], a[40:43], a[12:15], v[136:139]
  s_add_u32 s60, s63, 45056
  ds_read_b64_tr_b16 a[76:77], v21 offset:4096
  v_mfma_f32_16x16x32_bf16 v[44:47], a[44:47], a[0:3], v[44:47]
  buffer_store_dwordx4 v[244:247], v2, s[16:19], s60 offen offset:1024 sc1
  ds_read_b64_tr_b16 a[78:79], v21 offset:6144
  v_mfma_f32_16x16x32_bf16 v[76:79], a[44:47], a[4:7], v[76:79]
  s_add_u32 s60, s63, 36864
  ds_read_b64_tr_b16 a[80:81], v18 offset:12288
  v_mfma_f32_16x16x32_bf16 v[108:111], a[44:47], a[8:11], v[108:111]
  ds_read_b64_tr_b16 a[82:83], v18 offset:14336
  v_mfma_f32_16x16x32_bf16 v[140:143], a[44:47], a[12:15], v[140:143]
  buffer_store_dwordx4 v[216:219], v2, s[16:19], s60 offen offset:2048 sc1
  ds_read_b64_tr_b16 a[84:85], v19 offset:12288
  v_mfma_f32_16x16x32_bf16 v[48:51], a[48:51], a[0:3], v[48:51]
  s_add_u32 s60, s63, 45056
  ds_read_b64_tr_b16 a[86:87], v19 offset:14336
  v_mfma_f32_16x16x32_bf16 v[80:83], a[48:51], a[4:7], v[80:83]
  buffer_store_dwordx4 v[248:251], v2, s[16:19], s60 offen offset:2048 sc1
  ds_read_b64_tr_b16 a[88:89], v20 offset:12288
  v_mfma_f32_16x16x32_bf16 v[112:115], a[48:51], a[8:11], v[112:115]
  s_add_u32 s60, s63, 36864
  ds_read_b64_tr_b16 a[90:91], v20 offset:14336
  v_mfma_f32_16x16x32_bf16 v[144:147], a[48:51], a[12:15], v[144:147]
  ds_read_b64_tr_b16 a[92:93], v21 offset:12288
  v_mfma_f32_16x16x32_bf16 v[52:55], a[52:55], a[0:3], v[52:55]
  buffer_store_dwordx4 v[220:223], v2, s[16:19], s60 offen offset:3072 sc1
  ds_read_b64_tr_b16 a[94:95], v21 offset:14336
  v_mfma_f32_16x16x32_bf16 v[84:87], a[52:55], a[4:7], v[84:87]
  s_add_u32 s60, s63, 45056
  v_mfma_f32_16x16x32_bf16 v[116:119], a[52:55], a[8:11], v[116:119]
  buffer_store_dwordx4 v[252:255], v2, s[16:19], s60 offen offset:3072 sc1
  v_mfma_f32_16x16x32_bf16 v[148:151], a[52:55], a[12:15], v[148:151]
  s_add_u32 s88, s88, s90
  s_add_u32 s89, s89, 1
  s_cmp_eq_u32 s89, 3
  s_cselect_b32 s89, 0, s89
  s_cselect_b32 s90, s91, s92
  v_mfma_f32_16x16x32_bf16 v[56:59], a[56:59], a[0:3], v[56:59]
  s_add_u32 s68, s68, s70
  s_add_u32 s69, s69, 1
  s_cmp_eq_u32 s69, 3
  s_cselect_b32 s69, 0, s69
  s_cselect_b32 s70, s71, s72
  v_mfma_f32_16x16x32_bf16 v[88:91], a[56:59], a[4:7], v[88:91]
  v_add_u32 v16, s90, v16
  v_add_u32 v17, s90, v17
  v_mfma_f32_16x16x32_bf16 v[120:123], a[56:59], a[8:11], v[120:123]
  v_add_u32 v18, s70, v18
  v_add_u32 v19, s70, v19
  v_mfma_f32_16x16x32_bf16 v[152:155], a[56:59], a[12:15], v[152:155]
  v_add_u32 v20, s70, v20
  v_add_u32 v21, s70, v21
  v_mfma_f32_16x16x32_bf16 v[60:63], a[60:63], a[0:3], v[60:63]
  v_mfma_f32_16x16x32_bf16 v[92:95], a[60:63], a[4:7], v[92:95]
  v_mfma_f32_16x16x32_bf16 v[124:127], a[60:63], a[8:11], v[124:127]
  v_mfma_f32_16x16x32_bf16 v[156:159], a[60:63], a[12:15], v[156:159]
  s_waitcnt vmcnt(20) lgkmcnt(0)
  s_barrier
  v_mfma_f32_16x16x32_bf16 v[32:35], a[64:67], a[16:19], v[32:35]
  s_mov_b32 m0, s68
  ds_read_b128 a[0:3], v16 offset:0
  v_mfma_f32_16x16x32_bf16 v[64:67], a[64:67], a[20:23], v[64:67]
  buffer_load_dwordx4 v8, s[20:23], s28 offen offset:0 lds
  ds_read_b64_tr_b16 a[32:33], v18 offset:0
  v_mfma_f32_16x16x32_bf16 v[96:99], a[64:67], a[24:27], v[96:99]
  ds_read_b64_tr_b16 a[34:35], v18 offset:2048
  v_mfma_f32_16x16x32_bf16 v[128:131], a[64:67], a[28:31], v[128:131]
  ds_read_b128 a[4:7], v16 offset:2048
  v_mfma_f32_16x16x32_bf16 v[36:39], a[68:71], a[16:19], v[36:39]
  ds_read_b128 a[8:11], v16 offset:4096
  v_mfma_f32_16x16x32_bf16 v[68:71], a[68:71], a[20:23], v[68:71]
  buffer_load_dwordx4 v9, s[20:23], s28 offen offset:1024 lds
  ds_read_b128 a[12:15], v16 offset:6144
  v_mfma_f32_16x16x32_bf16 v[100:103], a[68:71], a[24:27], v[100:103]
  ds_read_b64_tr_b16 a[36:37], v19 offset:0
  v_mfma_f32_16x16x32_bf16 v[132:135], a[68:71], a[28:31], v[132:135]
  ds_read_b64_tr_b16 a[38:39], v19 offset:2048
  v_mfma_f32_16x16x32_bf16 v[40:43], a[72:75], a[16:19], v[40:43]
  ds_read_b64_tr_b16 a[40:41], v20 offset:0
  v_mfma_f32_16x16x32_bf16 v[72:75], a[72:75], a[20:23], v[72:75]
  ds_read_b64_tr_b16 a[42:43], v20 offset:2048
  v_mfma_f32_16x16x32_bf16 v[104:107], a[72:75], a[24:27], v[104:107]
  buffer_load_dwordx4 v10, s[20:23], s28 offen offset:2048 lds
  v_mfma_f32_16x16x32_bf16 v[136:139], a[72:75], a[28:31], v[136:139]
  ds_read_b64_tr_b16 a[44:45], v21 offset:0
  v_mfma_f32_16x16x32_bf16 v[44:47], a[76:79], a[16:19], v[44:47]
  ds_read_b64_tr_b16 a[46:47], v21 offset:2048
  v_mfma_f32_16x16x32_bf16 v[76:79], a[76:79], a[20:23], v[76:79]
  ds_read_b64_tr_b16 a[48:49], v18 offset:8192
  v_mfma_f32_16x16x32_bf16 v[108:111], a[76:79], a[24:27], v[108:111]
  ds_read_b64_tr_b16 a[50:51], v18 offset:10240
  v_mfma_f32_16x16x32_bf16 v[140:143], a[76:79], a[28:31], v[140:143]
  buffer_load_dwordx4 v11, s[20:23], s28 offen offset:3072 lds
  ds_read_b64_tr_b16 a[52:53], v19 offset:8192
  v_mfma_f32_16x16x32_bf16 v[48:51], a[80:83], a[16:19], v[48:51]
  s_bfe_u32 s56, 0x302010e, s55
  s_add_u32 s54, s54, s56
  s_add_u32 s55, s55, 8
  v_mfma_f32_16x16x32_bf16 v[80:83], a[80:83], a[20:23], v[80:83]
  s_and_b32 s55, s55, 0x8001f
  s_and_b32 s54, s54, 15
  s_lshl_b32 s28, s54, 19
  v_mfma_f32_16x16x32_bf16 v[112:115], a[80:83], a[24:27], v[112:115]
  s_mov_b32 m0, s88
  ds_read_b64_tr_b16 a[54:55], v19 offset:10240
  ds_read_b64_tr_b16 a[56:57], v20 offset:8192
  v_mfma_f32_16x16x32_bf16 v[144:147], a[80:83], a[28:31], v[144:147]
  ds_read_b64_tr_b16 a[58:59], v20 offset:10240
  ds_read_b64_tr_b16 a[60:61], v21 offset:8192
  v_mfma_f32_16x16x32_bf16 v[52:55], a[84:87], a[16:19], v[52:55]
  buffer_load_dwordx4 v4, s[8:11], s26 offen offset:0 lds
  ds_read_b64_tr_b16 a[62:63], v21 offset:10240
  v_mfma_f32_16x16x32_bf16 v[84:87], a[84:87], a[20:23], v[84:87]
  v_mfma_f32_16x16x32_bf16 v[116:119], a[84:87], a[24:27], v[116:119]
  v_mfma_f32_16x16x32_bf16 v[148:151], a[84:87], a[28:31], v[148:151]
  v_mfma_f32_16x16x32_bf16 v[56:59], a[88:91], a[16:19], v[56:59]
  v_mfma_f32_16x16x32_bf16 v[88:91], a[88:91], a[20:23], v[88:91]
  buffer_load_dwordx4 v5, s[8:11], s26 offen offset:1024 lds
  v_mfma_f32_16x16x32_bf16 v[120:123], a[88:91], a[24:27], v[120:123]
  v_mfma_f32_16x16x32_bf16 v[152:155], a[88:91], a[28:31], v[152:155]
  v_mfma_f32_16x16x32_bf16 v[60:63], a[92:95], a[16:19], v[60:63]
  v_mfma_f32_16x16x32_bf16 v[92:95], a[92:95], a[20:23], v[92:95]
  v_mfma_f32_16x16x32_bf16 v[124:127], a[92:95], a[24:27], v[124:127]
  v_mfma_f32_16x16x32_bf16 v[156:159], a[92:95], a[28:31], v[156:159]
  s_waitcnt lgkmcnt(0)
  v_mfma_f32_16x16x32_bf16 v[32:35], a[32:35], a[0:3], v[32:35]
  buffer_load_dwordx4 v6, s[8:11], s26 offen offset:2048 lds
  ds_read_b128 a[16:19], v17 offset:0
  v_mfma_f32_16x16x32_bf16 v[64:67], a[32:35], a[4:7], v[64:67]
  ds_read_b64_tr_b16 a[64:65], v18 offset:4096
  v_mfma_f32_16x16x32_bf16 v[96:99], a[32:35], a[8:11], v[96:99]
  ds_read_b64_tr_b16 a[66:67], v18 offset:6144
  v_mfma_f32_16x16x32_bf16 v[128:131], a[32:35], a[12:15], v[128:131]
  ds_read_b128 a[20:23], v17 offset:2048
  v_mfma_f32_16x16x32_bf16 v[36:39], a[36:39], a[0:3], v[36:39]
  buffer_load_dwordx4 v7, s[8:11], s26 offen offset:3072 lds
  ds_read_b128 a[24:27], v17 offset:4096
  v_mfma_f32_16x16x32_bf16 v[68:71], a[36:39], a[4:7], v[68:71]
  s_add_u32 m0, s88, 4096
  ds_read_b128 a[28:31], v17 offset:6144
  v_mfma_f32_16x16x32_bf16 v[100:103], a[36:39], a[8:11], v[100:103]
  ds_read_b64_tr_b16 a[68:69], v19 offset:4096
  v_mfma_f32_16x16x32_bf16 v[132:135], a[36:39], a[12:15], v[132:135]
  ds_read_b64_tr_b16 a[70:71], v19 offset:6144
  v_mfma_f32_16x16x32_bf16 v[40:43], a[40:43], a[0:3], v[40:43]
  buffer_load_dwordx4 v4, s[8:11], s27 offen offset:0 lds
  ds_read_b64_tr_b16 a[72:73], v20 offset:4096
  v_mfma_f32_16x16x32_bf16 v[72:75], a[40:43], a[4:7], v[72:75]
  ds_read_b64_tr_b16 a[74:75], v20 offset:6144
  v_mfma_f32_16x16x32_bf16 v[104:107], a[40:43], a[8:11], v[104:107]
  v_mfma_f32_16x16x32_bf16 v[136:139], a[40:43], a[12:15], v[136:139]
  ds_read_b64_tr_b16 a[76:77], v21 offset:4096
  v_mfma_f32_16x16x32_bf16 v[44:47], a[44:47], a[0:3], v[44:47]
  buffer_load_dwordx4 v5, s[8:11], s27 offen offset:1024 lds
  ds_read_b64_tr_b16 a[78:79], v21 offset:6144
  v_mfma_f32_16x16x32_bf16 v[76:79], a[44:47], a[4:7], v[76:79]
  ds_read_b64_tr_b16 a[80:81], v18 offset:12288
  v_mfma_f32_16x16x32_bf16 v[108:111], a[44:47], a[8:11], v[108:111]
  ds_read_b64_tr_b16 a[82:83], v18 offset:14336
  v_mfma_f32_16x16x32_bf16 v[140:143], a[44:47], a[12:15], v[140:143]
  ds_read_b64_tr_b16 a[84:85], v19 offset:12288
  v_mfma_f32_16x16x32_bf16 v[48:51], a[48:51], a[0:3], v[48:51]
  buffer_load_dwordx4 v6, s[8:11], s27 offen offset:2048 lds
  ds_read_b64_tr_b16 a[86:87], v19 offset:14336
  v_mfma_f32_16x16x32_bf16 v[80:83], a[48:51], a[4:7], v[80:83]
  ds_read_b64_tr_b16 a[88:89], v20 offset:12288
  v_mfma_f32_16x16x32_bf16 v[112:115], a[48:51], a[8:11], v[112:115]
  ds_read_b64_tr_b16 a[90:91], v20 offset:14336
  v_mfma_f32_16x16x32_bf16 v[144:147], a[48:51], a[12:15], v[144:147]
  ds_read_b64_tr_b16 a[92:93], v21 offset:12288
  v_mfma_f32_16x16x32_bf16 v[52:55], a[52:55], a[0:3], v[52:55]
  buffer_load_dwordx4 v7, s[8:11], s27 offen offset:3072 lds
  ds_read_b64_tr_b16 a[94:95], v21 offset:14336
  v_mfma_f32_16x16x32_bf16 v[84:87], a[52:55], a[4:7], v[84:87]
  s_bfe_u32 s29, 0x302010e, s53
  s_add_u32 s52, s52, s29
  s_add_u32 s53, s53, 8
  v_mfma_f32_16x16x32_bf16 v[116:119], a[52:55], a[8:11], v[116:119]
  s_and_b32 s53, s53, 0x8001f
  s_and_b32 s52, s52, 15
  s_lshl_b32 s29, s52, 7
  v_mfma_f32_16x16x32_bf16 v[148:151], a[52:55], a[12:15], v[148:151]
  s_or_b32 s26, s30, s29
  s_or_b32 s27, s31, s29
  v_mfma_f32_16x16x32_bf16 v[56:59], a[56:59], a[0:3], v[56:59]
  s_add_u32 s88, s88, s90
  s_add_u32 s89, s89, 1
  s_cmp_eq_u32 s89, 3
  s_cselect_b32 s89, 0, s89
  s_cselect_b32 s90, s91, s92
  v_mfma_f32_16x16x32_bf16 v[88:91], a[56:59], a[4:7], v[88:91]
  s_add_u32 s68, s68, s70
  s_add_u32 s69, s69, 1
  s_cmp_eq_u32 s69, 3
  s_cselect_b32 s69, 0, s69
  s_cselect_b32 s70, s71, s72
  v_mfma_f32_16x16x32_bf16 v[120:123], a[56:59], a[8:11], v[120:123]
  v_add_u32 v16, s90, v16
  v_add_u32 v17, s90, v17
  v_mfma_f32_16x16x32_bf16 v[152:155], a[56:59], a[12:15], v[152:155]
  v_add_u32 v18, s70, v18
  v_add_u32 v19, s70, v19
  v_mfma_f32_16x16x32_bf16 v[60:63], a[60:63], a[0:3], v[60:63]
  v_add_u32 v20, s70, v20
  v_add_u32 v21, s70, v21
  v_mfma_f32_16x16x32_bf16 v[92:95], a[60:63], a[4:7], v[92:95]
  v_mfma_f32_16x16x32_bf16 v[124:127], a[60:63], a[8:11], v[124:127]
  v_mfma_f32_16x16x32_bf16 v[156:159], a[60:63], a[12:15], v[156:159]
  s_waitcnt vmcnt(20) lgkmcnt(0)
  s_barrier
  v_mfma_f32_16x16x32_bf16 v[32:35], a[64:67], a[16:19], v[32:35]
  s_mov_b32 m0, s68
  ds_read_b128 a[0:3], v16 offset:0
  v_mfma_f32_16x16x32_bf16 v[64:67], a[64:67], a[20:23], v[64:67]
  buffer_load_dwordx4 v8, s[20:23], s28 offen offset:0 lds
  ds_read_b64_tr_b16 a[32:33], v18 offset:0
  v_mfma_f32_16x16x32_bf16 v[96:99], a[64:67], a[24:27], v[96:99]
  ds_read_b64_tr_b16 a[34:35], v18 offset:2048
  v_mfma_f32_16x16x32_bf16 v[128:131], a[64:67], a[28:31], v[128:131]
  buffer_load_dwordx4 v9, s[20:23], s28 offen offset:1024 lds
  ds_read_b128 a[4:7], v16 offset:2048
  v_mfma_f32_16x16x32_bf16 v[36:39], a[68:71], a[16:19], v[36:39]
  ds_read_b128 a[8:11], v16 offset:4096
  v_mfma_f32_16x16x32_bf16 v[68:71], a[68:71], a[20:23], v[68:71]
  ds_read_b128 a[12:15], v16 offset:6144
  v_mfma_f32_16x16x32_bf16 v[100:103], a[68:71], a[24:27], v[100:103]
  buffer_load_dwordx4 v10, s[20:23], s28 offen offset:2048 lds
  ds_read_b64_tr_b16 a[36:37], v19 offset:0
  v_mfma_f32_16x16x32_bf16 v[132:135], a[68:71], a[28:31], v[132:135]
  ds_read_b64_tr_b16 a[38:39], v19 offset:2048
  v_mfma_f32_16x16x32_bf16 v[40:43], a[72:75], a[16:19], v[40:43]
  ds_read_b64_tr_b16 a[40:41], v20 offset:0
  v_mfma_f32_16x16x32_bf16 v[72:75], a[72:75], a[20:23], v[72:75]
  buffer_load_dwordx4 v11, s[20:23], s28 offen offset:3072 lds
  ds_read_b64_tr_b16 a[42:43], v20 offset:2048
  v_mfma_f32_16x16x32_bf16 v[104:107], a[72:75], a[24:27], v[104:107]
  s_bfe_u32 s56, 0x302010e, s55
  s_add_u32 s54, s54, s56
  s_add_u32 s55, s55, 8
  v_mfma_f32_16x16x32_bf16 v[136:139], a[72:75], a[28:31], v[136:139]
  s_and_b32 s55, s55, 0x8001f
  s_and_b32 s54, s54, 15
  s_lshl_b32 s28, s54, 19
  v_mfma_f32_16x16x32_bf16 v[44:47], a[76:79], a[16:19], v[44:47]
  s_mov_b32 m0, s88
  ds_read_b64_tr_b16 a[44:45], v21 offset:0
  ds_read_b64_tr_b16 a[46:47], v21 offset:2048
  v_mfma_f32_16x16x32_bf16 v[76:79], a[76:79], a[20:23], v[76:79]
  buffer_load_dwordx4 v4, s[8:11], s26 offen offset:0 lds
  ds_read_b64_tr_b16 a[48:49], v18 offset:8192
  v_mfma_f32_16x16x32_bf16 v[108:111], a[76:79], a[24:27], v[108:111]
  ds_read_b64_tr_b16 a[50:51], v18 offset:10240
  v_mfma_f32_16x16x32_bf16 v[140:143], a[76:79], a[28:31], v[140:143]
  buffer_load_dwordx4 v5, s[8:11], s26 offen offset:1024 lds
  ds_read_b64_tr_b16 a[52:53], v19 offset:8192
  v_mfma_f32_16x16x32_bf16 v[48:51], a[80:83], a[16:19], v[48:51]
  ds_read_b64_tr_b16 a[54:55], v19 offset:10240
  v_mfma_f32_16x16x32_bf16 v[80:83], a[80:83], a[20:23], v[80:83]
  ds_read_b64_tr_b16 a[56:57], v20 offset:8192
  v_mfma_f32_16x16x32_bf16 v[112:115], a[80:83], a[24:27], v[112:115]
  buffer_load_dwordx4 v6, s[8:11], s26 offen offset:2048 lds
  ds_read_b64_tr_b16 a[58:59], v20 offset:10240
  v_mfma_f32_16x16x32_bf16 v[144:147], a[80:83], a[28:31], v[144:147]
  ds_read_b64_tr_b16 a[60:61], v21 offset:8192
  v_mfma_f32_16x16x32_bf16 v[52:55], a[84:87], a[16:19], v[52:55]
  ds_read_b64_tr_b16 a[62:63], v21 offset:10240
  v_mfma_f32_16x16x32_bf16 v[84:87], a[84:87], a[20:23], v[84:87]
  buffer_load_dwordx4 v7, s[8:11], s26 offen offset:3072 lds
  v_mfma_f32_16x16x32_bf16 v[116:119], a[84:87], a[24:27], v[116:119]
  s_add_u32 m0, s88, 4096
  v_mfma_f32_16x16x32_bf16 v[148:151], a[84:87], a[28:31], v[148:151]
  v_mfma_f32_16x16x32_bf16 v[56:59], a[88:91], a[16:19], v[56:59]
  buffer_load_dwordx4 v4, s[8:11], s27 offen offset:0 lds
  v_mfma_f32_16x16x32_bf16 v[88:91], a[88:91], a[20:23], v[88:91]
  v_mfma_f32_16x16x32_bf16 v[120:123], a[88:91], a[24:27], v[120:123]
  v_mfma_f32_16x16x32_bf16 v[152:155], a[88:91], a[28:31], v[152:155]
  buffer_load_dwordx4 v5, s[8:11], s27 offen offset:1024 lds
  v_mfma_f32_16x16x32_bf16 v[60:63], a[92:95], a[16:19], v[60:63]
  v_mfma_f32_16x16x32_bf16 v[92:95], a[92:95], a[20:23], v[92:95]
  v_mfma_f32_16x16x32_bf16 v[124:127], a[92:95], a[24:27], v[124:127]
  v_mfma_f32_16x16x32_bf16 v[156:159], a[92:95], a[28:31], v[156:159]
  s_waitcnt lgkmcnt(0)
  v_mfma_f32_16x16x32_bf16 v[32:35], a[32:35], a[0:3], v[32:35]
  buffer_load_dwordx4 v6, s[8:11], s27 offen offset:2048 lds
  ds_read_b128 a[16:19], v17 offset:0
  v_mfma_f32_16x16x32_bf16 v[64:67], a[32:35], a[4:7], v[64:67]
  ds_read_b64_tr_b16 a[64:65], v18 offset:4096
  v_mfma_f32_16x16x32_bf16 v[96:99], a[32:35], a[8:11], v[96:99]
  buffer_load_dwordx4 v7, s[8:11], s27 offen offset:3072 lds
  ds_read_b64_tr_b16 a[66:67], v18 offset:6144
  v_mfma_f32_16x16x32_bf16 v[128:131], a[32:35], a[12:15], v[128:131]
  s_bfe_u32 s29, 0x302010e, s53
  s_add_u32 s52, s52, s29
  s_add_u32 s53, s53, 8
  v_mfma_f32_16x16x32_bf16 v[36:39], a[36:39], a[0:3], v[36:39]
  s_and_b32 s53, s53, 0x8001f
  s_and_b32 s52, s52, 15
  s_lshl_b32 s29, s52, 7
  v_mfma_f32_16x16x32_bf16 v[68:71], a[36:39], a[4:7], v[68:71]
  s_or_b32 s26, s30, s29
  s_or_b32 s27, s31, s29
  s_add_u32 s60, s63, 0
  v_mfma_f32_16x16x32_bf16 v[100:103], a[36:39], a[8:11], v[100:103]
  buffer_store_dwordx4 v[160:163], v2, s[16:19], s60 offen offset:0 sc1
  ds_read_b128 a[20:23], v17 offset:2048
  v_mfma_f32_16x16x32_bf16 v[132:135], a[36:39], a[12:15], v[132:135]
  buffer_store_dwordx4 v[164:167], v2, s[16:19], s60 offen offset:1024 sc1
  ds_read_b128 a[24:27], v17 offset:4096
  v_mfma_f32_16x16x32_bf16 v[40:43], a[40:43], a[0:3], v[40:43]
  ds_read_b128 a[28:31], v17 offset:6144
  ds_read_b64_tr_b16 a[68:69], v19 offset:4096
  v_mfma_f32_16x16x32_bf16 v[72:75], a[40:43], a[4:7], v[72:75]
  ds_read_b64_tr_b16 a[70:71], v19 offset:6144
  ds_read_b64_tr_b16 a[72:73], v20 offset:4096
  v_mfma_f32_16x16x32_bf16 v[104:107], a[40:43], a[8:11], v[104:107]
  buffer_store_dwordx4 v[168:171], v2, s[16:19], s60 offen offset:2048 sc1
  ds_read_b64_tr_b16 a[74:75], v20 offset:6144
  v_mfma_f32_16x16x32_bf16 v[136:139], a[40:43], a[12:15], v[136:139]
  ds_read_b64_tr_b16 a[76:77], v21 offset:4096
  v_mfma_f32_16x16x32_bf16 v[44:47], a[44:47], a[0:3], v[44:47]
  buffer_store_dwordx4 v[172:175], v2, s[16:19], s60 offen offset:3072 sc1
  ds_read_b64_tr_b16 a[78:79], v21 offset:6144
  v_mfma_f32_16x16x32_bf16 v[76:79], a[44:47], a[4:7], v[76:79]
  s_add_u32 s60, s63, 4096
  ds_read_b64_tr_b16 a[80:81], v18 offset:12288
  v_mfma_f32_16x16x32_bf16 v[108:111], a[44:47], a[8:11], v[108:111]
  ds_read_b64_tr_b16 a[82:83], v18 offset:14336
  v_mfma_f32_16x16x32_bf16 v[140:143], a[44:47], a[12:15], v[140:143]
  buffer_store_dwordx4 v[176:179], v2, s[16:19], s60 offen offset:0 sc1
  ds_read_b64_tr_b16 a[84:85], v19 offset:12288
  v_mfma_f32_16x16x32_bf16 v[48:51], a[48:51], a[0:3], v[48:51]
  ds_read_b64_tr_b16 a[86:87], v19 offset:14336
  v_mfma_f32_16x16x32_bf16 v[80:83], a[48:51], a[4:7], v[80:83]
  buffer_store_dwordx4 v[180:183], v2, s[16:19], s60 offen offset:1024 sc1
  ds_read_b64_tr_b16 a[88:89], v20 offset:12288
  v_mfma_f32_16x16x32_bf16 v[112:115], a[48:51], a[8:11], v[112:115]
  ds_read_b64_tr_b16 a[90:91], v20 offset:14336
  v_mfma_f32_16x16x32_bf16 v[144:147], a[48:51], a[12:15], v[144:147]
  ds_read_b64_tr_b16 a[92:93], v21 offset:12288
  v_mfma_f32_16x16x32_bf16 v[52:55], a[52:55], a[0:3], v[52:55]
  buffer_store_dwordx4 v[184:187], v2, s[16:19], s60 offen offset:2048 sc1
  ds_read_b64_tr_b16 a[94:95], v21 offset:14336
  v_mfma_f32_16x16x32_bf16 v[84:87], a[52:55], a[4:7], v[84:87]
  v_mfma_f32_16x16x32_bf16 v[116:119], a[52:55], a[8:11], v[116:119]
  buffer_store_dwordx4 v[188:191], v2, s[16:19], s60 offen offset:3072 sc1
  v_mfma_f32_16x16x32_bf16 v[148:151], a[52:55], a[12:15], v[148:151]
  s_add_u32 s88, s88, s90
  s_add_u32 s89, s89, 1
  s_cmp_eq_u32 s89, 3
  s_cselect_b32 s89, 0, s89
  s_cselect_b32 s90, s91, s92
  v_mfma_f32_16x16x32_bf16 v[56:59], a[56:59], a[0:3], v[56:59]
  s_add_u32 s68, s68, s70
  s_add_u32 s69, s69, 1
  s_cmp_eq_u32 s69, 3
  s_cselect_b32 s69, 0, s69
  s_cselect_b32 s70, s71, s72
  v_mfma_f32_16x16x32_bf16 v[88:91], a[56:59], a[4:7], v[88:91]
  v_add_u32 v16, s90, v16
  v_add_u32 v17, s90, v17
  v_mfma_f32_16x16x32_bf16 v[120:123], a[56:59], a[8:11], v[120:123]
  v_add_u32 v18, s70, v18
  v_add_u32 v19, s70, v19
  v_mfma_f32_16x16x32_bf16 v[152:155], a[56:59], a[12:15], v[152:155]
  v_add_u32 v20, s70, v20
  v_add_u32 v21, s70, v21
  v_mfma_f32_16x16x32_bf16 v[60:63], a[60:63], a[0:3], v[60:63]
  v_mfma_f32_16x16x32_bf16 v[92:95], a[60:63], a[4:7], v[92:95]
  v_mfma_f32_16x16x32_bf16 v[124:127], a[60:63], a[8:11], v[124:127]
  v_mfma_f32_16x16x32_bf16 v[156:159], a[60:63], a[12:15], v[156:159]
  s_waitcnt vmcnt(20) lgkmcnt(0)
  s_barrier
  v_mfma_f32_16x16x32_bf16 v[32:35], a[64:67], a[16:19], v[32:35]
  s_mov_b32 m0, s68
  ds_read_b128 a[0:3], v16 offset:0
  v_mfma_f32_16x16x32_bf16 v[64:67], a[64:67], a[20:23], v[64:67]
  buffer_load_dwordx4 v8, s[20:23], s28 offen offset:0 lds
  ds_read_b64_tr_b16 a[32:33], v18 offset:0
  v_mfma_f32_16x16x32_bf16 v[96:99], a[64:67], a[24:27], v[96:99]
  ds_read_b64_tr_b16 a[34:35], v18 offset:2048
  v_mfma_f32_16x16x32_bf16 v[128:131], a[64:67], a[28:31], v[128:131]
  ds_read_b128 a[4:7], v16 offset:2048
  v_mfma_f32_16x16x32_bf16 v[36:39], a[68:71], a[16:19], v[36:39]
  ds_read_b128 a[8:11], v16 offset:4096
  v_mfma_f32_16x16x32_bf16 v[68:71], a[68:71], a[20:23], v[68:71]
  buffer_load_dwordx4 v9, s[20:23], s28 offen offset:1024 lds
  ds_read_b128 a[12:15], v16 offset:6144
  v_mfma_f32_16x16x32_bf16 v[100:103], a[68:71], a[24:27], v[100:103]
  ds_read_b64_tr_b16 a[36:37], v19 offset:0
  v_mfma_f32_16x16x32_bf16 v[132:135], a[68:71], a[28:31], v[132:135]
  ds_read_b64_tr_b16 a[38:39], v19 offset:2048
  v_mfma_f32_16x16x32_bf16 v[40:43], a[72:75], a[16:19], v[40:43]
  ds_read_b64_tr_b16 a[40:41], v20 offset:0
  v_mfma_f32_16x16x32_bf16 v[72:75], a[72:75], a[20:23], v[72:75]
  ds_read_b64_tr_b16 a[42:43], v20 offset:2048
  v_mfma_f32_16x16x32_bf16 v[104:107], a[72:75], a[24:27], v[104:107]
  buffer_load_dwordx4 v10, s[20:23], s28 offen offset:2048 lds
  v_mfma_f32_16x16x32_bf16 v[136:139], a[72:75], a[28:31], v[136:139]
  ds_read_b64_tr_b16 a[44:45], v21 offset:0
  v_mfma_f32_16x16x32_bf16 v[44:47], a[76:79], a[16:19], v[44:47]
  ds_read_b64_tr_b16 a[46:47], v21 offset:2048
  v_mfma_f32_16x16x32_bf16 v[76:79], a[76:79], a[20:23], v[76:79]
  ds_read_b64_tr_b16 a[48:49], v18 offset:8192
  v_mfma_f32_16x16x32_bf16 v[108:111], a[76:79], a[24:27], v[108:111]
  ds_read_b64_tr_b16 a[50:51], v18 offset:10240
  v_mfma_f32_16x16x32_bf16 v[140:143], a[76:79], a[28:31], v[140:143]
  buffer_load_dwordx4 v11, s[20:23], s28 offen offset:3072 lds
  ds_read_b64_tr_b16 a[52:53], v19 offset:8192
  v_mfma_f32_16x16x32_bf16 v[48:51], a[80:83], a[16:19], v[48:51]
  s_bfe_u32 s56, 0x302010e, s55
  s_add_u32 s54, s54, s56
  s_add_u32 s55, s55, 8
  v_mfma_f32_16x16x32_bf16 v[80:83], a[80:83], a[20:23], v[80:83]
  s_and_b32 s55, s55, 0x8001f
  s_and_b32 s54, s54, 15
  s_lshl_b32 s28, s54, 19
  v_mfma_f32_16x16x32_bf16 v[112:115], a[80:83], a[24:27], v[112:115]
  s_mov_b32 m0, s88
  ds_read_b64_tr_b16 a[54:55], v19 offset:10240
  ds_read_b64_tr_b16 a[56:57], v20 offset:8192
  v_mfma_f32_16x16x32_bf16 v[144:147], a[80:83], a[28:31], v[144:147]
  ds_read_b64_tr_b16 a[58:59], v20 offset:10240
  ds_read_b64_tr_b16 a[60:61], v21 offset:8192
  v_mfma_f32_16x16x32_bf16 v[52:55], a[84:87], a[16:19], v[52:55]
  buffer_load_dwordx4 v4, s[8:11], s26 offen offset:0 lds
  ds_read_b64_tr_b16 a[62:63], v21 offset:10240
  v_mfma_f32_16x16x32_bf16 v[84:87], a[84:87], a[20:23], v[84:87]
  v_mfma_f32_16x16x32_bf16 v[116:119], a[84:87], a[24:27], v[116:119]
  v_mfma_f32_16x16x32_bf16 v[148:151], a[84:87], a[28:31], v[148:151]
  v_mfma_f32_16x16x32_bf16 v[56:59], a[88:91], a[16:19], v[56:59]
  v_mfma_f32_16x16x32_bf16 v[88:91], a[88:91], a[20:23], v[88:91]
  buffer_load_dwordx4 v5, s[8:11], s26 offen offset:1024 lds
  v_mfma_f32_16x16x32_bf16 v[120:123], a[88:91], a[24:27], v[120:123]
  v_mfma_f32_16x16x32_bf16 v[152:155], a[88:91], a[28:31], v[152:155]
  v_mfma_f32_16x16x32_bf16 v[60:63], a[92:95], a[16:19], v[60:63]
  v_mfma_f32_16x16x32_bf16 v[92:95], a[92:95], a[20:23], v[92:95]
  v_mfma_f32_16x16x32_bf16 v[124:127], a[92:95], a[24:27], v[124:127]
  v_mfma_f32_16x16x32_bf16 v[156:159], a[92:95], a[28:31], v[156:159]
  s_waitcnt lgkmcnt(0)
  v_mfma_f32_16x16x32_bf16 v[32:35], a[32:35], a[0:3], v[32:35]
  buffer_load_dwordx4 v6, s[8:11], s26 offen offset:2048 lds
  ds_read_b128 a[16:19], v17 offset:0
  v_mfma_f32_16x16x32_bf16 v[64:67], a[32:35], a[4:7], v[64:67]
  ds_read_b64_tr_b16 a[64:65], v18 offset:4096
  v_mfma_f32_16x16x32_bf16 v[96:99], a[32:35], a[8:11], v[96:99]
  ds_read_b64_tr_b16 a[66:67], v18 offset:6144
  v_mfma_f32_16x16x32_bf16 v[128:131], a[32:35], a[12:15], v[128:131]
  ds_read_b128 a[20:23], v17 offset:2048
  v_mfma_f32_16x16x32_bf16 v[36:39], a[36:39], a[0:3], v[36:39]
  buffer_load_dwordx4 v7, s[8:11], s26 offen offset:3072 lds
  ds_read_b128 a[24:27], v17 offset:4096
  v_mfma_f32_16x16x32_bf16 v[68:71], a[36:39], a[4:7], v[68:71]
  s_add_u32 m0, s88, 4096
  ds_read_b128 a[28:31], v17 offset:6144
  v_mfma_f32_16x16x32_bf16 v[100:103], a[36:39], a[8:11], v[100:103]
  ds_read_b64_tr_b16 a[68:69], v19 offset:4096
  v_mfma_f32_16x16x32_bf16 v[132:135], a[36:39], a[12:15], v[132:135]
  ds_read_b64_tr_b16 a[70:71], v19 offset:6144
  v_mfma_f32_16x16x32_bf16 v[40:43], a[40:43], a[0:3], v[40:43]
  buffer_load_dwordx4 v4, s[8:11], s27 offen offset:0 lds
  ds_read_b64_tr_b16 a[72:73], v20 offset:4096
  v_mfma_f32_16x16x32_bf16 v[72:75], a[40:43], a[4:7], v[72:75]
  ds_read_b64_tr_b16 a[74:75], v20 offset:6144
  v_mfma_f32_16x16x32_bf16 v[104:107], a[40:43], a[8:11], v[104:107]
  v_mfma_f32_16x16x32_bf16 v[136:139], a[40:43], a[12:15], v[136:139]
  ds_read_b64_tr_b16 a[76:77], v21 offset:4096
  v_mfma_f32_16x16x32_bf16 v[44:47], a[44:47], a[0:3], v[44:47]
  buffer_load_dwordx4 v5, s[8:11], s27 offen offset:1024 lds
  ds_read_b64_tr_b16 a[78:79], v21 offset:6144
  v_mfma_f32_16x16x32_bf16 v[76:79], a[44:47], a[4:7], v[76:79]
  ds_read_b64_tr_b16 a[80:81], v18 offset:12288
  v_mfma_f32_16x16x32_bf16 v[108:111], a[44:47], a[8:11], v[108:111]
  ds_read_b64_tr_b16 a[82:83], v18 offset:14336
  v_mfma_f32_16x16x32_bf16 v[140:143], a[44:47], a[12:15], v[140:143]
  ds_read_b64_tr_b16 a[84:85], v19 offset:12288
  v_mfma_f32_16x16x32_bf16 v[48:51], a[48:51], a[0:3], v[48:51]
  buffer_load_dwordx4 v6, s[8:11], s27 offen offset:2048 lds
  ds_read_b64_tr_b16 a[86:87], v19 offset:14336
  v_mfma_f32_16x16x32_bf16 v[80:83], a[48:51], a[4:7], v[80:83]
  ds_read_b64_tr_b16 a[88:89], v20 offset:12288
  v_mfma_f32_16x16x32_bf16 v[112:115], a[48:51], a[8:11], v[112:115]
  ds_read_b64_tr_b16 a[90:91], v20 offset:14336
  v_mfma_f32_16x16x32_bf16 v[144:147], a[48:51], a[12:15], v[144:147]
  ds_read_b64_tr_b16 a[92:93], v21 offset:12288
  v_mfma_f32_16x16x32_bf16 v[52:55], a[52:55], a[0:3], v[52:55]
  buffer_load_dwordx4 v7, s[8:11], s27 offen offset:3072 lds
  ds_read_b64_tr_b16 a[94:95], v21 offset:14336
  v_mfma_f32_16x16x32_bf16 v[84:87], a[52:55], a[4:7], v[84:87]
  s_bfe_u32 s29, 0x302010e, s53
  s_add_u32 s52, s52, s29
  s_add_u32 s53, s53, 8
  v_mfma_f32_16x16x32_bf16 v[116:119], a[52:55], a[8:11], v[116:119]
  s_and_b32 s53, s53, 0x8001f
  s_and_b32 s52, s52, 15
  s_lshl_b32 s29, s52, 7
  v_mfma_f32_16x16x32_bf16 v[148:151], a[52:55], a[12:15], v[148:151]
  s_or_b32 s26, s30, s29
  s_or_b32 s27, s31, s29
  v_mfma_f32_16x16x32_bf16 v[56:59], a[56:59], a[0:3], v[56:59]
  s_add_u32 s88, s88, s90
  s_add_u32 s89, s89, 1
  s_cmp_eq_u32 s89, 3
  s_cselect_b32 s89, 0, s89
  s_cselect_b32 s90, s91, s92
  v_mfma_f32_16x16x32_bf16 v[88:91], a[56:59], a[4:7], v[88:91]
  s_add_u32 s68, s68, s70
  s_add_u32 s69, s69, 1
  s_cmp_eq_u32 s69, 3
  s_cselect_b32 s69, 0, s69
  s_cselect_b32 s70, s71, s72
  v_mfma_f32_16x16x32_bf16 v[120:123], a[56:59], a[8:11], v[120:123]
  v_add_u32 v16, s90, v16
  v_add_u32 v17, s90, v17
  v_mfma_f32_16x16x32_bf16 v[152:155], a[56:59], a[12:15], v[152:155]
  v_add_u32 v18, s70, v18
  v_add_u32 v19, s70, v19
  v_mfma_f32_16x16x32_bf16 v[60:63], a[60:63], a[0:3], v[60:63]
  v_add_u32 v20, s70, v20
  v_add_u32 v21, s70, v21
  v_mfma_f32_16x16x32_bf16 v[92:95], a[60:63], a[4:7], v[92:95]
  v_mfma_f32_16x16x32_bf16 v[124:127], a[60:63], a[8:11], v[124:127]
  v_mfma_f32_16x16x32_bf16 v[156:159], a[60:63], a[12:15], v[156:159]
  s_waitcnt vmcnt(12) lgkmcnt(0)
  s_barrier
  s_mov_b32 s5, 0x40000
Ltg_3:
  v_readfirstlane_b32 s94, v22
  v_readfirstlane_b32 s95, v23
  s_nop 0
  s_cmp_lg_u32 s95, 0
  s_cbranch_scc1 Lpolld_4
  s_sleep 4
  s_mov_b32 s12, s84
  s_mov_b32 s13, s85
  s_mov_b32 s14, 256
  s_mov_b32 s15, 0x00020000
  buffer_load_dwordx2 v[22:23], off, s[12:15], 0 sc1
  s_sub_u32 s5, s5, 1
  s_waitcnt vmcnt(0)
  s_cbranch_scc0 Ltg_3
Lpolld_4:
  v_mov_b32 v3, 0x40000000
  v_mov_b32 v22, s94
  v_cmp_eq_u32 vcc, 0, v0
  v_mov_b32 v23, s95
  s_nop 0
  v_cndmask_b32_e64 v3, v3, 0, vcc
  buffer_store_dwordx2 v[22:23], v3, s[96:99], s34 offen sc1
  v_mfma_f32_16x16x32_bf16 v[32:35], a[64:67], a[16:19], v[32:35]
  s_mov_b32 m0, s68
  ds_read_b128 a[0:3], v16 offset:0
  v_mfma_f32_16x16x32_bf16 v[64:67], a[64:67], a[20:23], v[64:67]
  buffer_load_dwordx4 v8, s[20:23], s28 offen offset:0 lds
  ds_read_b64_tr_b16 a[32:33], v18 offset:0
  v_mfma_f32_16x16x32_bf16 v[96:99], a[64:67], a[24:27], v[96:99]
  ds_read_b64_tr_b16 a[34:35], v18 offset:2048
  v_mfma_f32_16x16x32_bf16 v[128:131], a[64:67], a[28:31], v[128:131]
  ds_read_b128 a[4:7], v16 offset:2048
  v_mfma_f32_16x16x32_bf16 v[36:39], a[68:71], a[16:19], v[36:39]
  ds_read_b128 a[8:11], v16 offset:4096
  v_mfma_f32_16x16x32_bf16 v[68:71], a[68:71], a[20:23], v[68:71]
  buffer_load_dwordx4 v9, s[20:23], s28 offen offset:1024 lds
  ds_read_b128 a[12:15], v16 offset:6144
  v_mfma_f32_16x16x32_bf16 v[100:103], a[68:71], a[24:27], v[100:103]
  ds_read_b64_tr_b16 a[36:37], v19 offset:0
  v_mfma_f32_16x16x32_bf16 v[132:135], a[68:71], a[28:31], v[132:135]
  ds_read_b64_tr_b16 a[38:39], v19 offset:2048
  v_mfma_f32_16x16x32_bf16 v[40:43], a[72:75], a[16:19], v[40:43]
  ds_read_b64_tr_b16 a[40:41], v20 offset:0
  v_mfma_f32_16x16x32_bf16 v[72:75], a[72:75], a[20:23], v[72:75]
  ds_read_b64_tr_b16 a[42:43], v20 offset:2048
  v_mfma_f32_16x16x32_bf16 v[104:107], a[72:75], a[24:27], v[104:107]
  buffer_load_dwordx4 v10, s[20:23], s28 offen offset:2048 lds
  v_mfma_f32_16x16x32_bf16 v[136:139], a[72:75], a[28:31], v[136:139]
  ds_read_b64_tr_b16 a[44:45], v21 offset:0
  v_mfma_f32_16x16x32_bf16 v[44:47], a[76:79], a[16:19], v[44:47]
  ds_read_b64_tr_b16 a[46:47], v21 offset:2048
  v_mfma_f32_16x16x32_bf16 v[76:79], a[76:79], a[20:23], v[76:79]
  ds_read_b64_tr_b16 a[48:49], v18 offset:8192
  v_mfma_f32_16x16x32_bf16 v[108:111], a[76:79], a[24:27], v[108:111]
  ds_read_b64_tr_b16 a[50:51], v18 offset:10240
  v_mfma_f32_16x16x32_bf16 v[140:143], a[76:79], a[28:31], v[140:143]
  buffer_load_dwordx4 v11, s[20:23], s28 offen offset:3072 lds
  ds_read_b64_tr_b16 a[52:53], v19 offset:8192
  v_mfma_f32_16x16x32_bf16 v[48:51], a[80:83], a[16:19], v[48:51]
  s_bfe_u32 s56, 0x302010e, s55
  s_add_u32 s54, s54, s56
  s_add_u32 s55, s55, 8
  v_mfma_f32_16x16x32_bf16 v[80:83], a[80:83], a[20:23], v[80:83]
  s_and_b32 s55, s55, 0x8001f
  s_and_b32 s54, s54, 15
  s_lshl_b32 s28, s54, 19
  v_mfma_f32_16x16x32_bf16 v[112:115], a[80:83], a[24:27], v[112:115]
  s_mov_b32 m0, s88
  ds_read_b64_tr_b16 a[54:55], v19 offset:10240
  ds_read_b64_tr_b16 a[56:57], v20 offset:8192
  v_mfma_f32_16x16x32_bf16 v[144:147], a[80:83], a[28:31], v[144:147]
  ds_read_b64_tr_b16 a[58:59], v20 offset:10240
  ds_read_b64_tr_b16 a[60:61], v21 offset:8192
  v_mfma_f32_16x16x32_bf16 v[52:55], a[84:87], a[16:19], v[52:55]
  buffer_load_dwordx4 v4, s[8:11], s26 offen offset:0 lds
  ds_read_b64_tr_b16 a[62:63], v21 offset:10240
  v_mfma_f32_16x16x32_bf16 v[84:87], a[84:87], a[20:23], v[84:87]
  v_mfma_f32_16x16x32_bf16 v[116:119], a[84:87], a[24:27], v[116:119]
  v_mfma_f32_16x16x32_bf16 v[148:151], a[84:87], a[28:31], v[148:151]
  v_mfma_f32_16x16x32_bf16 v[56:59], a[88:91], a[16:19], v[56:59]
  v_mfma_f32_16x16x32_bf16 v[88:91], a[88:91], a[20:23], v[88:91]
  buffer_load_dwordx4 v5, s[8:11], s26 offen offset:1024 lds
  v_mfma_f32_16x16x32_bf16 v[120:123], a[88:91], a[24:27], v[120:123]
  v_mfma_f32_16x16x32_bf16 v[152:155], a[88:91], a[28:31], v[152:155]
  v_mfma_f32_16x16x32_bf16 v[60:63], a[92:95], a[16:19], v[60:63]
  v_mfma_f32_16x16x32_bf16 v[92:95], a[92:95], a[20:23], v[92:95]
  v_mfma_f32_16x16x32_bf16 v[124:127], a[92:95], a[24:27], v[124:127]
  v_mfma_f32_16x16x32_bf16 v[156:159], a[92:95], a[28:31], v[156:159]
  s_waitcnt lgkmcnt(0)
  v_mfma_f32_16x16x32_bf16 v[32:35], a[32:35], a[0:3], v[32:35]
  buffer_load_dwordx4 v6, s[8:11], s26 offen offset:2048 lds
  ds_read_b128 a[16:19], v17 offset:0
  v_mfma_f32_16x16x32_bf16 v[64:67], a[32:35], a[4:7], v[64:67]
  ds_read_b64_tr_b16 a[64:65], v18 offset:4096
  v_mfma_f32_16x16x32_bf16 v[96:99], a[32:35], a[8:11], v[96:99]
  ds_read_b64_tr_b16 a[66:67], v18 offset:6144
  v_mfma_f32_16x16x32_bf16 v[128:131], a[32:35], a[12:15], v[128:131]
  ds_read_b128 a[20:23], v17 offset:2048
  v_mfma_f32_16x16x32_bf16 v[36:39], a[36:39], a[0:3], v[36:39]
  buffer_load_dwordx4 v7, s[8:11], s26 offen offset:3072 lds
  ds_read_b128 a[24:27], v17 offset:4096
  v_mfma_f32_16x16x32_bf16 v[68:71], a[36:39], a[4:7], v[68:71]
  s_add_u32 m0, s88, 4096
  ds_read_b128 a[28:31], v17 offset:6144
  v_mfma_f32_16x16x32_bf16 v[100:103], a[36:39], a[8:11], v[100:103]
  ds_read_b64_tr_b16 a[68:69], v19 offset:4096
  v_mfma_f32_16x16x32_bf16 v[132:135], a[36:39], a[12:15], v[132:135]
  ds_read_b64_tr_b16 a[70:71], v19 offset:6144
  v_mfma_f32_16x16x32_bf16 v[40:43], a[40:43], a[0:3], v[40:43]
  buffer_load_dwordx4 v4, s[8:11], s27 offen offset:0 lds
  ds_read_b64_tr_b16 a[72:73], v20 offset:4096
  v_mfma_f32_16x16x32_bf16 v[72:75], a[40:43], a[4:7], v[72:75]
  ds_read_b64_tr_b16 a[74:75], v20 offset:6144
  v_mfma_f32_16x16x32_bf16 v[104:107], a[40:43], a[8:11], v[104:107]
  v_mfma_f32_16x16x32_bf16 v[136:139], a[40:43], a[12:15], v[136:139]
  ds_read_b64_tr_b16 a[76:77], v21 offset:4096
  v_mfma_f32_16x16x32_bf16 v[44:47], a[44:47], a[0:3], v[44:47]
  buffer_load_dwordx4 v5, s[8:11], s27 offen offset:1024 lds
  ds_read_b64_tr_b16 a[78:79], v21 offset:6144
  v_mfma_f32_16x16x32_bf16 v[76:79], a[44:47], a[4:7], v[76:79]
  ds_read_b64_tr_b16 a[80:81], v18 offset:12288
  v_mfma_f32_16x16x32_bf16 v[108:111], a[44:47], a[8:11], v[108:111]
  ds_read_b64_tr_b16 a[82:83], v18 offset:14336
  v_mfma_f32_16x16x32_bf16 v[140:143], a[44:47], a[12:15], v[140:143]
  ds_read_b64_tr_b16 a[84:85], v19 offset:12288
  v_mfma_f32_16x16x32_bf16 v[48:51], a[48:51], a[0:3], v[48:51]
  buffer_load_dwordx4 v6, s[8:11], s27 offen offset:2048 lds
  ds_read_b64_tr_b16 a[86:87], v19 offset:14336
  v_mfma_f32_16x16x32_bf16 v[80:83], a[48:51], a[4:7], v[80:83]
  ds_read_b64_tr_b16 a[88:89], v20 offset:12288
  v_mfma_f32_16x16x32_bf16 v[112:115], a[48:51], a[8:11], v[112:115]
  ds_read_b64_tr_b16 a[90:91], v20 offset:14336
  v_mfma_f32_16x16x32_bf16 v[144:147], a[48:51], a[12:15], v[144:147]
  ds_read_b64_tr_b16 a[92:93], v21 offset:12288
  v_mfma_f32_16x16x32_bf16 v[52:55], a[52:55], a[0:3], v[52:55]
  buffer_load_dwordx4 v7, s[8:11], s27 offen offset:3072 lds
  ds_read_b64_tr_b16 a[94:95], v21 offset:14336
  v_mfma_f32_16x16x32_bf16 v[84:87], a[52:55], a[4:7], v[84:87]
  s_bfe_u32 s29, 0x302010e, s53
  s_add_u32 s52, s52, s29
  s_add_u32 s53, s53, 8
  v_mfma_f32_16x16x32_bf16 v[116:119], a[52:55], a[8:11], v[116:119]
  s_and_b32 s53, s53, 0x8001f
  s_and_b32 s52, s52, 15
  s_lshl_b32 s29, s52, 7
  v_mfma_f32_16x16x32_bf16 v[148:151], a[52:55], a[12:15], v[148:151]
  s_or_b32 s26, s30, s29
  s_or_b32 s27, s31, s29
  v_mfma_f32_16x16x32_bf16 v[56:59], a[56:59], a[0:3], v[56:59]
  s_add_u32 s88, s88, s90
  s_add_u32 s89, s89, 1
  s_cmp_eq_u32 s89, 3
  s_cselect_b32 s89, 0, s89
  s_cselect_b32 s90, s91, s92
  v_mfma_f32_16x16x32_bf16 v[88:91], a[56:59], a[4:7], v[88:91]
  s_add_u32 s68, s68, s70
  s_add_u32 s69, s69, 1
  s_cmp_eq_u32 s69, 3
  s_cselect_b32 s69, 0, s69
  s_cselect_b32 s70, s71, s72
  v_mfma_f32_16x16x32_bf16 v[120:123], a[56:59], a[8:11], v[120:123]
  v_add_u32 v16, s90, v16
  v_add_u32 v17, s90, v17
  v_mfma_f32_16x16x32_bf16 v[152:155], a[56:59], a[12:15], v[152:155]
  v_add_u32 v18, s70, v18
  v_add_u32 v19, s70, v19
  v_mfma_f32_16x16x32_bf16 v[60:63], a[60:63], a[0:3], v[60:63]
  v_add_u32 v20, s70, v20
  v_add_u32 v21, s70, v21
  v_mfma_f32_16x16x32_bf16 v[92:95], a[60:63], a[4:7], v[92:95]
  v_mfma_f32_16x16x32_bf16 v[124:127], a[60:63], a[8:11], v[124:127]
  v_mfma_f32_16x16x32_bf16 v[156:159], a[60:63], a[12:15], v[156:159]
  s_mov_b32 s35, 6
  s_waitcnt vmcnt(12) lgkmcnt(0)
  s_barrier
  .p2align 6
Lp3_loop:
  v_mfma_f32_16x16x32_bf16 v[32:35], a[64:67], a[16:19], v[32:35]
  s_mov_b32 m0, s68
  ds_read_b128 a[0:3], v16 offset:0
  v_mfma_f32_16x16x32_bf16 v[64:67], a[64:67], a[20:23], v[64:67]
  buffer_load_dwordx4 v8, s[20:23], s28 offen offset:0 lds
  ds_read_b64_tr_b16 a[32:33], v18 offset:0
  v_mfma_f32_16x16x32_bf16 v[96:99], a[64:67], a[24:27], v[96:99]
  ds_read_b64_tr_b16 a[34:35], v18 offset:2048
  v_mfma_f32_16x16x32_bf16 v[128:131], a[64:67], a[28:31], v[128:131]
  ds_read_b128 a[4:7], v16 offset:2048
  v_mfma_f32_16x16x32_bf16 v[36:39], a[68:71], a[16:19], v[36:39]
  ds_read_b128 a[8:11], v16 offset:4096
  v_mfma_f32_16x16x32_bf16 v[68:71], a[68:71], a[20:23], v[68:71]
  buffer_load_dwordx4 v9, s[20:23], s28 offen offset:1024 lds
  ds_read_b128 a[12:15], v16 offset:6144
  v_mfma_f32_16x16x32_bf16 v[100:103], a[68:71], a[24:27], v[100:103]
  ds_read_b64_tr_b16 a[36:37], v19 offset:0
  v_mfma_f32_16x16x32_bf16 v[132:135], a[68:71], a[28:31], v[132:135]
  ds_read_b64_tr_b16 a[38:39], v19 offset:2048
  v_mfma_f32_16x16x32_bf16 v[40:43], a[72:75], a[16:19], v[40:43]
  ds_read_b64_tr_b16 a[40:41], v20 offset:0
  v_mfma_f32_16x16x32_bf16 v[72:75], a[72:75], a[20:23], v[72:75]
  ds_read_b64_tr_b16 a[42:43], v20 offset:2048
  v_mfma_f32_16x16x32_bf16 v[104:107], a[72:75], a[24:27], v[104:107]
  buffer_load_dwordx4 v10, s[20:23], s28 offen offset:2048 lds
  v_mfma_f32_16x16x32_bf16 v[136:139], a[72:75], a[28:31], v[136:139]
  ds_read_b64_tr_b16 a[44:45], v21 offset:0
  v_mfma_f32_16x16x32_bf16 v[44:47], a[76:79], a[16:19], v[44:47]
  ds_read_b64_tr_b16 a[46:47], v21 offset:2048
  v_mfma_f32_16x16x32_bf16 v[76:79], a[76:79], a[20:23], v[76:79]
  ds_read_b64_tr_b16 a[48:49], v18 offset:8192
  v_mfma_f32_16x16x32_bf16 v[108:111], a[76:79], a[24:27], v[108:111]
  ds_read_b64_tr_b16 a[50:51], v18 offset:10240
  v_mfma_f32_16x16x32_bf16 v[140:143], a[76:79], a[28:31], v[140:143]
  buffer_load_dwordx4 v11, s[20:23], s28 offen offset:3072 lds
  ds_read_b64_tr_b16 a[52:53], v19 offset:8192
  v_mfma_f32_16x16x32_bf16 v[48:51], a[80:83], a[16:19], v[48:51]
  s_bfe_u32 s56, 0x302010e, s55
  s_add_u32 s54, s54, s56
  s_add_u32 s55, s55, 8
  v_mfma_f32_16x16x32_bf16 v[80:83], a[80:83], a[20:23], v[80:83]
  s_and_b32 s55, s55, 0x8001f
  s_and_b32 s54, s54, 15
  s_lshl_b32 s28, s54, 19
  v_mfma_f32_16x16x32_bf16 v[112:115], a[80:83], a[24:27], v[112:115]
  s_mov_b32 m0, s88
  ds_read_b64_tr_b16 a[54:55], v19 offset:10240
  ds_read_b64_tr_b16 a[56:57], v20 offset:8192
  v_mfma_f32_16x16x32_bf16 v[144:147], a[80:83], a[28:31], v[144:147]
  ds_read_b64_tr_b16 a[58:59], v20 offset:10240
  ds_read_b64_tr_b16 a[60:61], v21 offset:8192
  v_mfma_f32_16x16x32_bf16 v[52:55], a[84:87], a[16:19], v[52:55]
  buffer_load_dwordx4 v4, s[8:11], s26 offen offset:0 lds
  ds_read_b64_tr_b16 a[62:63], v21 offset:10240
  v_mfma_f32_16x16x32_bf16 v[84:87], a[84:87], a[20:23], v[84:87]
  v_mfma_f32_16x16x32_bf16 v[116:119], a[84:87], a[24:27], v[116:119]
  v_mfma_f32_16x16x32_bf16 v[148:151], a[84:87], a[28:31], v[148:151]
  v_mfma_f32_16x16x32_bf16 v[56:59], a[88:91], a[16:19], v[56:59]
  v_mfma_f32_16x16x32_bf16 v[88:91], a[88:91], a[20:23], v[88:91]
  buffer_load_dwordx4 v5, s[8:11], s26 offen offset:1024 lds
  v_mfma_f32_16x16x32_bf16 v[120:123], a[88:91], a[24:27], v[120:123]
  v_mfma_f32_16x16x32_bf16 v[152:155], a[88:91], a[28:31], v[152:155]
  v_mfma_f32_16x16x32_bf16 v[60:63], a[92:95], a[16:19], v[60:63]
  v_mfma_f32_16x16x32_bf16 v[92:95], a[92:95], a[20:23], v[92:95]
  v_mfma_f32_16x16x32_bf16 v[124:127], a[92:95], a[24:27], v[124:127]
  v_mfma_f32_16x16x32_bf16 v[156:159], a[92:95], a[28:31], v[156:159]
  s_waitcnt lgkmcnt(0)
  v_mfma_f32_16x16x32_bf16 v[32:35], a[32:35], a[0:3], v[32:35]
  buffer_load_dwordx4 v6, s[8:11], s26 offen offset:2048 lds
  ds_read_b128 a[16:19], v17 offset:0
  v_mfma_f32_16x16x32_bf16 v[64:67], a[32:35], a[4:7], v[64:67]
  ds_read_b64_tr_b16 a[64:65], v18 offset:4096
  v_mfma_f32_16x16x32_bf16 v[96:99], a[32:35], a[8:11], v[96:99]
  ds_read_b64_tr_b16 a[66:67], v18 offset:6144
  v_mfma_f32_16x16x32_bf16 v[128:131], a[32:35], a[12:15], v[128:131]
  ds_read_b128 a[20:23], v17 offset:2048
  v_mfma_f32_16x16x32_bf16 v[36:39], a[36:39], a[0:3], v[36:39]
  buffer_load_dwordx4 v7, s[8:11], s26 offen offset:3072 lds
  ds_read_b128 a[24:27], v17 offset:4096
  v_mfma_f32_16x16x32_bf16 v[68:71], a[36:39], a[4:7], v[68:71]
  s_add_u32 m0, s88, 4096
  ds_read_b128 a[28:31], v17 offset:6144
  v_mfma_f32_16x16x32_bf16 v[100:103], a[36:39], a[8:11], v[100:103]
  ds_read_b64_tr_b16 a[68:69], v19 offset:4096
  v_mfma_f32_16x16x32_bf16 v[132:135], a[36:39], a[12:15], v[132:135]
  ds_read_b64_tr_b16 a[70:71], v19 offset:6144
  v_mfma_f32_16x16x32_bf16 v[40:43], a[40:43], a[0:3], v[40:43]
  buffer_load_dwordx4 v4, s[8:11], s27 offen offset:0 lds
  ds_read_b64_tr_b16 a[72:73], v20 offset:4096
  v_mfma_f32_16x16x32_bf16 v[72:75], a[40:43], a[4:7], v[72:75]
  ds_read_b64_tr_b16 a[74:75], v20 offset:6144
  v_mfma_f32_16x16x32_bf16 v[104:107], a[40:43], a[8:11], v[104:107]
  v_mfma_f32_16x16x32_bf16 v[136:139], a[40:43], a[12:15], v[136:139]
  ds_read_b64_tr_b16 a[76:77], v21 offset:4096
  v_mfma_f32_16x16x32_bf16 v[44:47], a[44:47], a[0:3], v[44:47]
  buffer_load_dwordx4 v5, s[8:11], s27 offen offset:1024 lds
  ds_read_b64_tr_b16 a[78:79], v21 offset:6144
  v_mfma_f32_16x16x32_bf16 v[76:79], a[44:47], a[4:7], v[76:79]
  ds_read_b64_tr_b16 a[80:81], v18 offset:12288
  v_mfma_f32_16x16x32_bf16 v[108:111], a[44:47], a[8:11], v[108:111]
  ds_read_b64_tr_b16 a[82:83], v18 offset:14336
  v_mfma_f32_16x16x32_bf16 v[140:143], a[44:47], a[12:15], v[140:143]
  ds_read_b64_tr_b16 a[84:85], v19 offset:12288
  v_mfma_f32_16x16x32_bf16 v[48:51], a[48:51], a[0:3], v[48:51]
  buffer_load_dwordx4 v6, s[8:11], s27 offen offset:2048 lds
  ds_read_b64_tr_b16 a[86:87], v19 offset:14336
  v_mfma_f32_16x16x32_bf16 v[80:83], a[48:51], a[4:7], v[80:83]
  ds_read_b64_tr_b16 a[88:89], v20 offset:12288
  v_mfma_f32_16x16x32_bf16 v[112:115], a[48:51], a[8:11], v[112:115]
  ds_read_b64_tr_b16 a[90:91], v20 offset:14336
  v_mfma_f32_16x16x32_bf16 v[144:147], a[48:51], a[12:15], v[144:147]
  ds_read_b64_tr_b16 a[92:93], v21 offset:12288
  v_mfma_f32_16x16x32_bf16 v[52:55], a[52:55], a[0:3], v[52:55]
  buffer_load_dwordx4 v7, s[8:11], s27 offen offset:3072 lds
  ds_read_b64_tr_b16 a[94:95], v21 offset:14336
  v_mfma_f32_16x16x32_bf16 v[84:87], a[52:55], a[4:7], v[84:87]
  s_bfe_u32 s29, 0x302010e, s53
  s_add_u32 s52, s52, s29
  s_add_u32 s53, s53, 8
  v_mfma_f32_16x16x32_bf16 v[116:119], a[52:55], a[8:11], v[116:119]
  s_and_b32 s53, s53, 0x8001f
  s_and_b32 s52, s52, 15
  s_lshl_b32 s29, s52, 7
  v_mfma_f32_16x16x32_bf16 v[148:151], a[52:55], a[12:15], v[148:151]
  s_or_b32 s26, s30, s29
  s_or_b32 s27, s31, s29
  v_mfma_f32_16x16x32_bf16 v[56:59], a[56:59], a[0:3], v[56:59]
  s_add_u32 s88, s88, s90
  s_add_u32 s89, s89, 1
  s_cmp_eq_u32 s89, 3
  s_cselect_b32 s89, 0, s89
  s_cselect_b32 s90, s91, s92
  v_mfma_f32_16x16x32_bf16 v[88:91], a[56:59], a[4:7], v[88:91]
  s_add_u32 s68, s68, s70
  s_add_u32 s69, s69, 1
  s_cmp_eq_u32 s69, 3
  s_cselect_b32 s69, 0, s69
  s_cselect_b32 s70, s71, s72
  v_mfma_f32_16x16x32_bf16 v[120:123], a[56:59], a[8:11], v[120:123]
  v_add_u32 v16, s90, v16
  v_add_u32 v17, s90, v17
  v_mfma_f32_16x16x32_bf16 v[152:155], a[56:59], a[12:15], v[152:155]
  v_add_u32 v18, s70, v18
  v_add_u32 v19, s70, v19
  v_mfma_f32_16x16x32_bf16 v[60:63], a[60:63], a[0:3], v[60:63]
  v_add_u32 v20, s70, v20
  v_add_u32 v21, s70, v21
  v_mfma_f32_16x16x32_bf16 v[92:95], a[60:63], a[4:7], v[92:95]
  s_waitcnt vmcnt(12) lgkmcnt(0)
  s_barrier
  v_mfma_f32_16x16x32_bf16 v[124:127], a[60:63], a[8:11], v[124:127]
  s_sub_u32 s35, s35, 1
  v_mfma_f32_16x16x32_bf16 v[156:159], a[60:63], a[12:15], v[156:159]
  s_cmp_lg_u32 s35, 0
  s_cbranch_scc1 Lp3_loop
  s_lshr_b32 s34, s24, 1
  s_lshl_b32 s34, s34, 11
  v_and_b32 v3, 7, v1
  v_lshlrev_b32 v3, 7, v3
  v_mfma_f32_16x16x32_bf16 v[32:35], a[64:67], a[16:19], v[32:35]
  buffer_load_dwordx2 v[22:23], v3, s[96:99], s34 offen sc1
  ds_read_b128 a[0:3], v16 offset:0
  v_mfma_f32_16x16x32_bf16 v[64:67], a[64:67], a[20:23], v[64:67]
  s_mov_b32 m0, s68
  ds_read_b64_tr_b16 a[32:33], v18 offset:0
  v_mfma_f32_16x16x32_bf16 v[96:99], a[64:67], a[24:27], v[96:99]
  ds_read_b64_tr_b16 a[34:35], v18 offset:2048
  v_mfma_f32_16x16x32_bf16 v[128:131], a[64:67], a[28:31], v[128:131]
  ds_read_b128 a[4:7], v16 offset:2048
  v_mfma_f32_16x16x32_bf16 v[36:39], a[68:71], a[16:19], v[36:39]
  buffer_load_dwordx4 v8, s[20:23], s28 offen offset:0 lds
  ds_read_b128 a[8:11], v16 offset:4096
  v_mfma_f32_16x16x32_bf16 v[68:71], a[68:71], a[20:23], v[68:71]
  ds_read_b128 a[12:15], v16 offset:6144
  v_mfma_f32_16x16x32_bf16 v[100:103], a[68:71], a[24:27], v[100:103]
  ds_read_b64_tr_b16 a[36:37], v19 offset:0
  v_mfma_f32_16x16x32_bf16 v[132:135], a[68:71], a[28:31], v[132:135]
  ds_read_b64_tr_b16 a[38:39], v19 offset:2048
  v_mfma_f32_16x16x32_bf16 v[40:43], a[72:75], a[16:19], v[40:43]
  buffer_load_dwordx4 v9, s[20:23], s28 offen offset:1024 lds
  ds_read_b64_tr_b16 a[40:41], v20 offset:0
  v_mfma_f32_16x16x32_bf16 v[72:75], a[72:75], a[20:23], v[72:75]
  ds_read_b64_tr_b16 a[42:43], v20 offset:2048
  v_mfma_f32_16x16x32_bf16 v[104:107], a[72:75], a[24:27], v[104:107]
  v_mfma_f32_16x16x32_bf16 v[136:139], a[72:75], a[28:31], v[136:139]
  ds_read_b64_tr_b16 a[44:45], v21 offset:0
  v_mfma_f32_16x16x32_bf16 v[44:47], a[76:79], a[16:19], v[44:47]
  ds_read_b64_tr_b16 a[46:47], v21 offset:2048
  v_mfma_f32_16x16x32_bf16 v[76:79], a[76:79], a[20:23], v[76:79]
  buffer_load_dwordx4 v10, s[20:23], s28 offen offset:2048 lds
  ds_read_b64_tr_b16 a[48:49], v18 offset:8192
  v_mfma_f32_16x16x32_bf16 v[108:111], a[76:79], a[24:27], v[108:111]
  ds_read_b64_tr_b16 a[50:51], v18 offset:10240
  v_mfma_f32_16x16x32_bf16 v[140:143], a[76:79], a[28:31], v[140:143]
  ds_read_b64_tr_b16 a[52:53], v19 offset:8192
  v_mfma_f32_16x16x32_bf16 v[48:51], a[80:83], a[16:19], v[48:51]
  ds_read_b64_tr_b16 a[54:55], v19 offset:10240
  v_mfma_f32_16x16x32_bf16 v[80:83], a[80:83], a[20:23], v[80:83]
  buffer_load_dwordx4 v11, s[20:23], s28 offen offset:3072 lds
  ds_read_b64_tr_b16 a[56:57], v20 offset:8192
  v_mfma_f32_16x16x32_bf16 v[112:115], a[80:83], a[24:27], v[112:115]
  s_bfe_u32 s56, 0x302010e, s55
  s_add_u32 s54, s54, s56
  s_add_u32 s55, s55, 8
  v_mfma_f32_16x16x32_bf16 v[144:147], a[80:83], a[28:31], v[144:147]
  s_and_b32 s55, s55, 0x8001f
  s_and_b32 s54, s54, 15
  s_lshl_b32 s28, s54, 19
  v_mfma_f32_16x16x32_bf16 v[52:55], a[84:87], a[16:19], v[52:55]
  s_mov_b32 m0, s88
  ds_read_b64_tr_b16 a[58:59], v20 offset:10240
  ds_read_b64_tr_b16 a[60:61], v21 offset:8192
  v_mfma_f32_16x16x32_bf16 v[84:87], a[84:87], a[20:23], v[84:87]
  ds_read_b64_tr_b16 a[62:63], v21 offset:10240
  v_mfma_f32_16x16x32_bf16 v[116:119], a[84:87], a[24:27], v[116:119]
  buffer_load_dwordx4 v4, s[8:11], s26 offen offset:0 lds
  v_mfma_f32_16x16x32_bf16 v[148:151], a[84:87], a[28:31], v[148:151]
  v_mfma_f32_16x16x32_bf16 v[56:59], a[88:91], a[16:19], v[56:59]
  v_mfma_f32_16x16x32_bf16 v[88:91], a[88:91], a[20:23], v[88:91]
  v_mfma_f32_16x16x32_bf16 v[120:123], a[88:91], a[24:27], v[120:123]
  buffer_load_dwordx4 v5, s[8:11], s26 offen offset:1024 lds
  v_mfma_f32_16x16x32_bf16 v[152:155], a[88:91], a[28:31], v[152:155]
  v_mfma_f32_16x16x32_bf16 v[60:63], a[92:95], a[16:19], v[60:63]
  v_mfma_f32_16x16x32_bf16 v[92:95], a[92:95], a[20:23], v[92:95]
  v_mfma_f32_16x16x32_bf16 v[124:127], a[92:95], a[24:27], v[124:127]
  v_mfma_f32_16x16x32_bf16 v[156:159], a[92:95], a[28:31], v[156:159]
  s_waitcnt lgkmcnt(0)
  v_mfma_f32_16x16x32_bf16 v[32:35], a[32:35], a[0:3], v[32:35]
  buffer_load_dwordx4 v6, s[8:11], s26 offen offset:2048 lds
  ds_read_b128 a[16:19], v17 offset:0
  v_mfma_f32_16x16x32_bf16 v[64:67], a[32:35], a[4:7], v[64:67]
  ds_read_b64_tr_b16 a[64:65], v18 offset:4096
  v_mfma_f32_16x16x32_bf16 v[96:99], a[32:35], a[8:11], v[96:99]
  ds_read_b64_tr_b16 a[66:67], v18 offset:6144
  v_mfma_f32_16x16x32_bf16 v[128:131], a[32:35], a[12:15], v[128:131]
  ds_read_b128 a[20:23], v17 offset:2048
  v_mfma_f32_16x16x32_bf16 v[36:39], a[36:39], a[0:3], v[36:39]
  buffer_load_dwordx4 v7, s[8:11], s26 offen offset:3072 lds
  ds_read_b128 a[24:27], v17 offset:4096
  v_mfma_f32_16x16x32_bf16 v[68:71], a[36:39], a[4:7], v[68:71]
  s_add_u32 m0, s88, 4096
  ds_read_b128 a[28:31], v17 offset:6144
  v_mfma_f32_16x16x32_bf16 v[100:103], a[36:39], a[8:11], v[100:103]
  ds_read_b64_tr_b16 a[68:69], v19 offset:4096
  v_mfma_f32_16x16x32_bf16 v[132:135], a[36:39], a[12:15], v[132:135]
  ds_read_b64_tr_b16 a[70:71], v19 offset:6144
  v_mfma_f32_16x16x32_bf16 v[40:43], a[40:43], a[0:3], v[40:43]
  buffer_load_dwordx4 v4, s[8:11], s27 offen offset:0 lds
  ds_read_b64_tr_b16 a[72:73], v20 offset:4096
  v_mfma_f32_16x16x32_bf16 v[72:75], a[40:43], a[4:7], v[72:75]
  ds_read_b64_tr_b16 a[74:75], v20 offset:6144
  v_mfma_f32_16x16x32_bf16 v[104:107], a[40:43], a[8:11], v[104:107]
  v_mfma_f32_16x16x32_bf16 v[136:139], a[40:43], a[12:15], v[136:139]
  ds_read_b64_tr_b16 a[76:77], v21 offset:4096
  v_mfma_f32_16x16x32_bf16 v[44:47], a[44:47], a[0:3], v[44:47]
  buffer_load_dwordx4 v5, s[8:11], s27 offen offset:1024 lds
  ds_read_b64_tr_b16 a[78:79], v21 offset:6144
  v_mfma_f32_16x16x32_bf16 v[76:79], a[44:47], a[4:7], v[76:79]
  ds_read_b64_tr_b16 a[80:81], v18 offset:12288
  v_mfma_f32_16x16x32_bf16 v[108:111], a[44:47], a[8:11], v[108:111]
  ds_read_b64_tr_b16 a[82:83], v18 offset:14336
  v_mfma_f32_16x16x32_bf16 v[140:143], a[44:47], a[12:15], v[140:143]
  ds_read_b64_tr_b16 a[84:85], v19 offset:12288
  v_mfma_f32_16x16x32_bf16 v[48:51], a[48:51], a[0:3], v[48:51]
  buffer_load_dwordx4 v6, s[8:11], s27 offen offset:2048 lds
  ds_read_b64_tr_b16 a[86:87], v19 offset:14336
  v_mfma_f32_16x16x32_bf16 v[80:83], a[48:51], a[4:7], v[80:83]
  ds_read_b64_tr_b16 a[88:89], v20 offset:12288
  v_mfma_f32_16x16x32_bf16 v[112:115], a[48:51], a[8:11], v[112:115]
  ds_read_b64_tr_b16 a[90:91], v20 offset:14336
  v_mfma_f32_16x16x32_bf16 v[144:147], a[48:51], a[12:15], v[144:147]
  ds_read_b64_tr_b16 a[92:93], v21 offset:12288
  v_mfma_f32_16x16x32_bf16 v[52:55], a[52:55], a[0:3], v[52:55]
  buffer_load_dwordx4 v7, s[8:11], s27 offen offset:3072 lds
  ds_read_b64_tr_b16 a[94:95], v21 offset:14336
  v_mfma_f32_16x16x32_bf16 v[84:87], a[52:55], a[4:7], v[84:87]
  s_bfe_u32 s29, 0x302010e, s53
  s_add_u32 s52, s52, s29
  s_add_u32 s53, s53, 8
  v_mfma_f32_16x16x32_bf16 v[116:119], a[52:55], a[8:11], v[116:119]
  s_and_b32 s53, s53, 0x8001f
  s_and_b32 s52, s52, 15
  s_lshl_b32 s29, s52, 7
  v_mfma_f32_16x16x32_bf16 v[148:151], a[52:55], a[12:15], v[148:151]
  s_or_b32 s26, s30, s29
  s_or_b32 s27, s31, s29
  v_mfma_f32_16x16x32_bf16 v[56:59], a[56:59], a[0:3], v[56:59]
  s_add_u32 s88, s88, s90
  s_add_u32 s89, s89, 1
  s_cmp_eq_u32 s89, 3
  s_cselect_b32 s89, 0, s89
  s_cselect_b32 s90, s91, s92
  v_mfma_f32_16x16x32_bf16 v[88:91], a[56:59], a[4:7], v[88:91]
  s_add_u32 s68, s68, s70
  s_add_u32 s69, s69, 1
  s_cmp_eq_u32 s69, 3
  s_cselect_b32 s69, 0, s69
  s_cselect_b32 s70, s71, s72
  v_mfma_f32_16x16x32_bf16 v[120:123], a[56:59], a[8:11], v[120:123]
  v_add_u32 v16, s90, v16
  v_add_u32 v17, s90, v17
  v_mfma_f32_16x16x32_bf16 v[152:155], a[56:59], a[12:15], v[152:155]
  v_add_u32 v18, s70, v18
  v_add_u32 v19, s70, v19
  v_mfma_f32_16x16x32_bf16 v[60:63], a[60:63], a[0:3], v[60:63]
  v_add_u32 v20, s70, v20
  v_add_u32 v21, s70, v21
  v_mfma_f32_16x16x32_bf16 v[92:95], a[60:63], a[4:7], v[92:95]
  v_mfma_f32_16x16x32_bf16 v[124:127], a[60:63], a[8:11], v[124:127]
  v_mfma_f32_16x16x32_bf16 v[156:159], a[60:63], a[12:15], v[156:159]
  s_waitcnt vmcnt(12) lgkmcnt(0)
  s_barrier
  s_mov_b32 s5, 0x40000
Lpoll_5:
  v_cmp_ne_u64 vcc, s[94:95], v[22:23]
  s_nop 0
  s_cbranch_vccz Lpolld_6
  s_sleep 4
  buffer_load_dwordx2 v[22:23], v3, s[96:99], s34 offen sc1
  s_sub_u32 s5, s5, 1
  s_waitcnt vmcnt(0)
  s_cbranch_scc0 Lpoll_5
Lpolld_6:
  s_lshl_b32 s4, s24, 20
  s_and_b32 s5, s25, 1
  s_lshl_b32 s5, s5, 1
  s_add_u32 s5, s5, 14
  s_sub_u32 s5, s5, s25
  s_add_u32 s5, s5, 1
  s_lshl_b32 s5, s5, 16
  s_add_u32 s20, s86, 16777216
  s_addc_u32 s21, s87, 0
  s_add_u32 s20, s20, s4
  s_addc_u32 s21, s21, 0
  s_mov_b32 s22, s5
  s_mov_b32 s23, 0x00020000
  s_lshl_b32 s28, s3, 12
  s_add_u32 s26, s28, 0xc000
  s_add_u32 s27, s28, 0x10000
  s_add_u32 s29, s28, 0x4000
  s_and_b32 s4, s2, 1
  s_lshl_b32 s4, s4, 3
  s_bfe_u32 s5, s2, 0x30003
  s_add_u32 s73, s4, s5
  s_bfe_u32 s4, s2, 0x10001
  s_lshl_b32 s4, s4, 2
  s_lshr_b32 s5, s2, 6
  s_add_u32 s76, s4, s5
  s_bfe_u32 s77, s2, 0x10002
  s_lshl_b32 s78, s73, 3
  s_add_u32 s78, s78, s76
  s_lshl_b32 s79, s3, 12
  v_mfma_f32_16x16x32_bf16 v[32:35], a[64:67], a[16:19], v[32:35]
  s_mov_b32 m0, s26
  ds_read_b128 a[0:3], v16 offset:0
  v_mfma_f32_16x16x32_bf16 v[64:67], a[64:67], a[20:23], v[64:67]
  buffer_load_dwordx4 v2, s[20:23], s28 offen offset:0 sc1 lds
  ds_read_b64_tr_b16 a[32:33], v18 offset:0
  v_mfma_f32_16x16x32_bf16 v[96:99], a[64:67], a[24:27], v[96:99]
  ds_read_b64_tr_b16 a[34:35], v18 offset:2048
  v_mfma_f32_16x16x32_bf16 v[128:131], a[64:67], a[28:31], v[128:131]
  ds_read_b128 a[4:7], v16 offset:2048
  v_mfma_f32_16x16x32_bf16 v[36:39], a[68:71], a[16:19], v[36:39]
  ds_read_b128 a[8:11], v16 offset:4096
  v_mfma_f32_16x16x32_bf16 v[68:71], a[68:71], a[20:23], v[68:71]
  ds_read_b128 a[12:15], v16 offset:6144
  v_mfma_f32_16x16x32_bf16 v[100:103], a[68:71], a[24:27], v[100:103]
  ds_read_b64_tr_b16 a[36:37], v19 offset:0
  v_mfma_f32_16x16x32_bf16 v[132:135], a[68:71], a[28:31], v[132:135]
  ds_read_b64_tr_b16 a[38:39], v19 offset:2048
  v_mfma_f32_16x16x32_bf16 v[40:43], a[72:75], a[16:19], v[40:43]
  ds_read_b64_tr_b16 a[40:41], v20 offset:0
  v_mfma_f32_16x16x32_bf16 v[72:75], a[72:75], a[20:23], v[72:75]
  ds_read_b64_tr_b16 a[42:43], v20 offset:2048
  v_mfma_f32_16x16x32_bf16 v[104:107], a[72:75], a[24:27], v[104:107]
  v_mfma_f32_16x16x32_bf16 v[136:139], a[72:75], a[28:31], v[136:139]
  ds_read_b64_tr_b16 a[44:45], v21 offset:0
  v_mfma_f32_16x16x32_bf16 v[44:47], a[76:79], a[16:19], v[44:47]
  ds_read_b64_tr_b16 a[46:47], v21 offset:2048
  v_mfma_f32_16x16x32_bf16 v[76:79], a[76:79], a[20:23], v[76:79]
  ds_read_b64_tr_b16 a[48:49], v18 offset:8192
  v_mfma_f32_16x16x32_bf16 v[108:111], a[76:79], a[24:27], v[108:111]
  ds_read_b64_tr_b16 a[50:51], v18 offset:10240
  v_mfma_f32_16x16x32_bf16 v[140:143], a[76:79], a[28:31], v[140:143]
  buffer_load_dwordx4 v2, s[20:23], s28 offen offset:1024 sc1 lds
  ds_read_b64_tr_b16 a[52:53], v19 offset:8192
  v_mfma_f32_16x16x32_bf16 v[48:51], a[80:83], a[16:19], v[48:51]
  ds_read_b64_tr_b16 a[54:55], v19 offset:10240
  v_mfma_f32_16x16x32_bf16 v[80:83], a[80:83], a[20:23], v[80:83]
  ds_read_b64_tr_b16 a[56:57], v20 offset:8192
  v_mfma_f32_16x16x32_bf16 v[112:115], a[80:83], a[24:27], v[112:115]
  ds_read_b64_tr_b16 a[58:59], v20 offset:10240
  v_mfma_f32_16x16x32_bf16 v[144:147], a[80:83], a[28:31], v[144:147]
  ds_read_b64_tr_b16 a[60:61], v21 offset:8192
  v_mfma_f32_16x16x32_bf16 v[52:55], a[84:87], a[16:19], v[52:55]
  ds_read_b64_tr_b16 a[62:63], v21 offset:10240
  v_mfma_f32_16x16x32_bf16 v[84:87], a[84:87], a[20:23], v[84:87]
  v_mfma_f32_16x16x32_bf16 v[116:119], a[84:87], a[24:27], v[116:119]
  v_mfma_f32_16x16x32_bf16 v[148:151], a[84:87], a[28:31], v[148:151]
  v_mfma_f32_16x16x32_bf16 v[56:59], a[88:91], a[16:19], v[56:59]
  v_mfma_f32_16x16x32_bf16 v[88:91], a[88:91], a[20:23], v[88:91]
  v_mfma_f32_16x16x32_bf16 v[120:123], a[88:91], a[24:27], v[120:123]
  v_mfma_f32_16x16x32_bf16 v[152:155], a[88:91], a[28:31], v[152:155]
  v_mfma_f32_16x16x32_bf16 v[60:63], a[92:95], a[16:19], v[60:63]
  v_mfma_f32_16x16x32_bf16 v[92:95], a[92:95], a[20:23], v[92:95]
  v_mfma_f32_16x16x32_bf16 v[124:127], a[92:95], a[24:27], v[124:127]
  v_mfma_f32_16x16x32_bf16 v[156:159], a[92:95], a[28:31], v[156:159]
  s_waitcnt lgkmcnt(0)
  v_mfma_f32_16x16x32_bf16 v[32:35], a[32:35], a[0:3], v[32:35]
  buffer_load_dwordx4 v2, s[20:23], s28 offen offset:2048 sc1 lds
  ds_read_b128 a[16:19], v17 offset:0
  v_mfma_f32_16x16x32_bf16 v[64:67], a[32:35], a[4:7], v[64:67]
  ds_read_b64_tr_b16 a[64:65], v18 offset:4096
  v_mfma_f32_16x16x32_bf16 v[96:99], a[32:35], a[8:11], v[96:99]
  ds_read_b64_tr_b16 a[66:67], v18 offset:6144
  v_mfma_f32_16x16x32_bf16 v[128:131], a[32:35], a[12:15], v[128:131]
  ds_read_b128 a[20:23], v17 offset:2048
  v_mfma_f32_16x16x32_bf16 v[36:39], a[36:39], a[0:3], v[36:39]
  ds_read_b128 a[24:27], v17 offset:4096
  v_mfma_f32_16x16x32_bf16 v[68:71], a[36:39], a[4:7], v[68:71]
  ds_read_b128 a[28:31], v17 offset:6144
  v_mfma_f32_16x16x32_bf16 v[100:103], a[36:39], a[8:11], v[100:103]
  ds_read_b64_tr_b16 a[68:69], v19 offset:4096
  v_mfma_f32_16x16x32_bf16 v[132:135], a[36:39], a[12:15], v[132:135]
  ds_read_b64_tr_b16 a[70:71], v19 offset:6144
  v_mfma_f32_16x16x32_bf16 v[40:43], a[40:43], a[0:3], v[40:43]
  ds_read_b64_tr_b16 a[72:73], v20 offset:4096
  v_mfma_f32_16x16x32_bf16 v[72:75], a[40:43], a[4:7], v[72:75]
  ds_read_b64_tr_b16 a[74:75], v20 offset:6144
  v_mfma_f32_16x16x32_bf16 v[104:107], a[40:43], a[8:11], v[104:107]
  v_mfma_f32_16x16x32_bf16 v[136:139], a[40:43], a[12:15], v[136:139]
  ds_read_b64_tr_b16 a[76:77], v21 offset:4096
  v_mfma_f32_16x16x32_bf16 v[44:47], a[44:47], a[0:3], v[44:47]
  buffer_load_dwordx4 v2, s[20:23], s28 offen offset:3072 sc1 lds
  ds_read_b64_tr_b16 a[78:79], v21 offset:6144
  v_mfma_f32_16x16x32_bf16 v[76:79], a[44:47], a[4:7], v[76:79]
  s_xor_b32 s26, s26, 0x4000
  s_add_u32 s28, s28, 0x8000
  ds_read_b64_tr_b16 a[80:81], v18 offset:12288
  v_mfma_f32_16x16x32_bf16 v[108:111], a[44:47], a[8:11], v[108:111]
  s_add_u32 s88, s88, s90
  s_add_u32 s89, s89, 1
  ds_read_b64_tr_b16 a[82:83], v18 offset:14336
  v_mfma_f32_16x16x32_bf16 v[140:143], a[44:47], a[12:15], v[140:143]
  s_cmp_eq_u32 s89, 3
  s_cselect_b32 s89, 0, s89
  s_cselect_b32 s90, s91, s92
  ds_read_b64_tr_b16 a[84:85], v19 offset:12288
  v_mfma_f32_16x16x32_bf16 v[48:51], a[48:51], a[0:3], v[48:51]
  s_add_u32 s68, s68, s70
  s_add_u32 s69, s69, 1
  ds_read_b64_tr_b16 a[86:87], v19 offset:14336
  v_mfma_f32_16x16x32_bf16 v[80:83], a[48:51], a[4:7], v[80:83]
  s_cmp_eq_u32 s69, 3
  s_cselect_b32 s69, 0, s69
  s_cselect_b32 s70, s71, s72
  ds_read_b64_tr_b16 a[88:89], v20 offset:12288
  v_mfma_f32_16x16x32_bf16 v[112:115], a[48:51], a[8:11], v[112:115]
  ds_read_b64_tr_b16 a[90:91], v20 offset:14336
  v_mfma_f32_16x16x32_bf16 v[144:147], a[48:51], a[12:15], v[144:147]
  ds_read_b64_tr_b16 a[92:93], v21 offset:12288
  v_mfma_f32_16x16x32_bf16 v[52:55], a[52:55], a[0:3], v[52:55]
  ds_read_b64_tr_b16 a[94:95], v21 offset:14336
  v_mfma_f32_16x16x32_bf16 v[84:87], a[52:55], a[4:7], v[84:87]
  v_add_u32 v16, s90, v16
  v_add_u32 v17, s90, v17
  v_mfma_f32_16x16x32_bf16 v[116:119], a[52:55], a[8:11], v[116:119]
  v_add_u32 v18, s70, v18
  v_add_u32 v19, s70, v19
  v_mfma_f32_16x16x32_bf16 v[148:151], a[52:55], a[12:15], v[148:151]
  v_add_u32 v20, s70, v20
  v_add_u32 v21, s70, v21
  v_mfma_f32_16x16x32_bf16 v[56:59], a[56:59], a[0:3], v[56:59]
  v_mfma_f32_16x16x32_bf16 v[88:91], a[56:59], a[4:7], v[88:91]
  v_mfma_f32_16x16x32_bf16 v[120:123], a[56:59], a[8:11], v[120:123]
  v_mfma_f32_16x16x32_bf16 v[152:155], a[56:59], a[12:15], v[152:155]
  v_mfma_f32_16x16x32_bf16 v[60:63], a[60:63], a[0:3], v[60:63]
  v_mfma_f32_16x16x32_bf16 v[92:95], a[60:63], a[4:7], v[92:95]
  v_mfma_f32_16x16x32_bf16 v[124:127], a[60:63], a[8:11], v[124:127]
  v_mfma_f32_16x16x32_bf16 v[156:159], a[60:63], a[12:15], v[156:159]
  s_waitcnt vmcnt(4) lgkmcnt(0)
  s_barrier
  s_mov_b32 s6, 0x3e0293ee
  s_mov_b32 s7, s6
  v_mfma_f32_16x16x32_bf16 v[32:35], a[64:67], a[16:19], v[32:35]
  s_mov_b32 m0, s26
  ds_read_b128 a[0:3], v16 offset:0
  v_mfma_f32_16x16x32_bf16 v[64:67], a[64:67], a[20:23], v[64:67]
  buffer_load_dwordx4 v2, s[20:23], s28 offen offset:0 sc1 lds
  ds_read_b64_tr_b16 a[32:33], v18 offset:0
  v_mfma_f32_16x16x32_bf16 v[96:99], a[64:67], a[24:27], v[96:99]
  ds_read_b64_tr_b16 a[34:35], v18 offset:2048
  v_mfma_f32_16x16x32_bf16 v[128:131], a[64:67], a[28:31], v[128:131]
  buffer_load_dwordx4 v2, s[20:23], s28 offen offset:1024 sc1 lds
  ds_read_b128 a[4:7], v16 offset:2048
  v_mfma_f32_16x16x32_bf16 v[36:39], a[68:71], a[16:19], v[36:39]
  ds_read_b128 a[8:11], v16 offset:4096
  v_mfma_f32_16x16x32_bf16 v[68:71], a[68:71], a[20:23], v[68:71]
  ds_read_b128 a[12:15], v16 offset:6144
  v_mfma_f32_16x16x32_bf16 v[100:103], a[68:71], a[24:27], v[100:103]
  ds_read_b64_tr_b16 a[36:37], v19 offset:0
  v_mfma_f32_16x16x32_bf16 v[132:135], a[68:71], a[28:31], v[132:135]
  buffer_load_dwordx4 v2, s[20:23], s28 offen offset:2048 sc1 lds
  ds_read_b64_tr_b16 a[38:39], v19 offset:2048
  v_mfma_f32_16x16x32_bf16 v[40:43], a[72:75], a[16:19], v[40:43]
  ds_read_b64_tr_b16 a[40:41], v20 offset:0
  v_mfma_f32_16x16x32_bf16 v[72:75], a[72:75], a[20:23], v[72:75]
  ds_read_b64_tr_b16 a[42:43], v20 offset:2048
  v_mfma_f32_16x16x32_bf16 v[104:107], a[72:75], a[24:27], v[104:107]
  v_mfma_f32_16x16x32_bf16 v[136:139], a[72:75], a[28:31], v[136:139]
  buffer_load_dwordx4 v2, s[20:23], s28 offen offset:3072 sc1 lds
  ds_read_b64_tr_b16 a[44:45], v21 offset:0
  v_mfma_f32_16x16x32_bf16 v[44:47], a[76:79], a[16:19], v[44:47]
  s_xor_b32 s26, s26, 0x8000
  s_add_u32 s28, s28, 0x8000
  s_mov_b32 m0, s27
  v_mfma_f32_16x16x32_bf16 v[76:79], a[76:79], a[20:23], v[76:79]
  ds_read_b64_tr_b16 a[46:47], v21 offset:2048
  ds_read_b64_tr_b16 a[48:49], v18 offset:8192
  v_mfma_f32_16x16x32_bf16 v[108:111], a[76:79], a[24:27], v[108:111]
  ds_read_b64_tr_b16 a[50:51], v18 offset:10240
  v_mfma_f32_16x16x32_bf16 v[140:143], a[76:79], a[28:31], v[140:143]
  buffer_load_dwordx4 v2, s[20:23], s29 offen offset:0 sc1 lds
  ds_read_b64_tr_b16 a[52:53], v19 offset:8192
  v_mfma_f32_16x16x32_bf16 v[48:51], a[80:83], a[16:19], v[48:51]
  ds_read_b64_tr_b16 a[54:55], v19 offset:10240
  v_mfma_f32_16x16x32_bf16 v[80:83], a[80:83], a[20:23], v[80:83]
  ds_read_b64_tr_b16 a[56:57], v20 offset:8192
  v_mfma_f32_16x16x32_bf16 v[112:115], a[80:83], a[24:27], v[112:115]
  ds_read_b64_tr_b16 a[58:59], v20 offset:10240
  v_mfma_f32_16x16x32_bf16 v[144:147], a[80:83], a[28:31], v[144:147]
  buffer_load_dwordx4 v2, s[20:23], s29 offen offset:1024 sc1 lds
  ds_read_b64_tr_b16 a[60:61], v21 offset:8192
  v_mfma_f32_16x16x32_bf16 v[52:55], a[84:87], a[16:19], v[52:55]
  ds_read_b64_tr_b16 a[62:63], v21 offset:10240
  v_mfma_f32_16x16x32_bf16 v[84:87], a[84:87], a[20:23], v[84:87]
  v_mfma_f32_16x16x32_bf16 v[116:119], a[84:87], a[24:27], v[116:119]
  v_mfma_f32_16x16x32_bf16 v[148:151], a[84:87], a[28:31], v[148:151]
  buffer_load_dwordx4 v2, s[20:23], s29 offen offset:2048 sc1 lds
  v_mfma_f32_16x16x32_bf16 v[56:59], a[88:91], a[16:19], v[56:59]
  v_mfma_f32_16x16x32_bf16 v[88:91], a[88:91], a[20:23], v[88:91]
  v_mfma_f32_16x16x32_bf16 v[120:123], a[88:91], a[24:27], v[120:123]
  v_mfma_f32_16x16x32_bf16 v[152:155], a[88:91], a[28:31], v[152:155]
  buffer_load_dwordx4 v2, s[20:23], s29 offen offset:3072 sc1 lds
  v_mfma_f32_16x16x32_bf16 v[60:63], a[92:95], a[16:19], v[60:63]
  s_xor_b32 s27, s27, 0x4000
  s_add_u32 s29, s29, 0x8000
  v_mfma_f32_16x16x32_bf16 v[92:95], a[92:95], a[20:23], v[92:95]
  v_mfma_f32_16x16x32_bf16 v[124:127], a[92:95], a[24:27], v[124:127]
  v_mfma_f32_16x16x32_bf16 v[156:159], a[92:95], a[28:31], v[156:159]
  s_waitcnt lgkmcnt(0)
  v_mfma_f32_16x16x32_bf16 v[32:35], a[32:35], a[0:3], v[32:35]
  ds_read_b128 a[16:19], v17 offset:0
  ds_read_b64_tr_b16 a[64:65], v18 offset:4096
  v_mfma_f32_16x16x32_bf16 v[36:39], a[36:39], a[0:3], v[36:39]
  ds_read_b64_tr_b16 a[66:67], v18 offset:6144
  ds_read_b128 a[20:23], v17 offset:2048
  v_mfma_f32_16x16x32_bf16 v[40:43], a[40:43], a[0:3], v[40:43]
  ds_read_b128 a[24:27], v17 offset:4096
  ds_read_b128 a[28:31], v17 offset:6144
  v_mfma_f32_16x16x32_bf16 v[44:47], a[44:47], a[0:3], v[44:47]
  ds_read_b64_tr_b16 a[68:69], v19 offset:4096
  ds_read_b64_tr_b16 a[70:71], v19 offset:6144
  v_mfma_f32_16x16x32_bf16 v[48:51], a[48:51], a[0:3], v[48:51]
  ds_read_b64_tr_b16 a[72:73], v20 offset:4096
  ds_read_b64_tr_b16 a[74:75], v20 offset:6144
  v_mfma_f32_16x16x32_bf16 v[52:55], a[52:55], a[0:3], v[52:55]
  ds_read_b64_tr_b16 a[76:77], v21 offset:4096
  v_mfma_f32_16x16x32_bf16 v[56:59], a[56:59], a[0:3], v[56:59]
  ds_read_b64_tr_b16 a[78:79], v21 offset:6144
  ds_read_b64_tr_b16 a[80:81], v18 offset:12288
  v_mfma_f32_16x16x32_bf16 v[60:63], a[60:63], a[0:3], v[60:63]
  ds_read_b64_tr_b16 a[82:83], v18 offset:14336
  ds_read_b64_tr_b16 a[84:85], v19 offset:12288
  v_mfma_f32_16x16x32_bf16 v[64:67], a[32:35], a[4:7], v[64:67]
  ds_read_b64_tr_b16 a[86:87], v19 offset:14336
  ds_read_b64_tr_b16 a[88:89], v20 offset:12288
  v_mfma_f32_16x16x32_bf16 v[68:71], a[36:39], a[4:7], v[68:71]
  ds_read_b64_tr_b16 a[90:91], v20 offset:14336
  ds_read_b64_tr_b16 a[92:93], v21 offset:12288
  v_mfma_f32_16x16x32_bf16 v[72:75], a[40:43], a[4:7], v[72:75]
  ds_read_b64_tr_b16 a[94:95], v21 offset:14336
  v_mfma_f32_16x16x32_bf16 v[76:79], a[44:47], a[4:7], v[76:79]
  v_mfma_f32_16x16x32_bf16 v[80:83], a[48:51], a[4:7], v[80:83]
  v_mfma_f32_16x16x32_bf16 v[84:87], a[52:55], a[4:7], v[84:87]
  v_mfma_f32_16x16x32_bf16 v[88:91], a[56:59], a[4:7], v[88:91]
  v_mfma_f32_16x16x32_bf16 v[92:95], a[60:63], a[4:7], v[92:95]
  s_waitcnt lgkmcnt(0)
  v_mfma_f32_16x16x32_bf16 v[32:35], a[64:67], a[16:19], v[32:35]
  v_mfma_f32_16x16x32_bf16 v[36:39], a[68:71], a[16:19], v[36:39]
  v_mfma_f32_16x16x32_bf16 v[40:43], a[72:75], a[16:19], v[40:43]
  v_mfma_f32_16x16x32_bf16 v[44:47], a[76:79], a[16:19], v[44:47]
  v_mfma_f32_16x16x32_bf16 v[48:51], a[80:83], a[16:19], v[48:51]
  v_mfma_f32_16x16x32_bf16 v[52:55], a[84:87], a[16:19], v[52:55]
  s_nop 2
  v_pk_mul_f32 v[32:33], v[32:33], s[6:7]
  v_pk_mul_f32 v[34:35], v[34:35], s[6:7]
  v_mfma_f32_16x16x32_bf16 v[56:59], a[88:91], a[16:19], v[56:59]
  v_pk_mul_f32 v[36:37], v[36:37], s[6:7]
  v_pk_mul_f32 v[38:39], v[38:39], s[6:7]
  v_mfma_f32_16x16x32_bf16 v[60:63], a[92:95], a[16:19], v[60:63]
  v_cvt_pk_bf16_f32 v32, v32, v33
  v_cvt_pk_bf16_f32 v33, v34, v35
  v_mfma_f32_16x16x32_bf16 v[64:67], a[64:67], a[20:23], v[64:67]
  v_cvt_pk_bf16_f32 v34, v36, v37
  v_cvt_pk_bf16_f32 v35, v38, v39
  v_mfma_f32_16x16x32_bf16 v[68:71], a[68:71], a[20:23], v[68:71]
  v_accvgpr_write_b32 a128, v32
  v_accvgpr_write_b32 a129, v33
  v_mfma_f32_16x16x32_bf16 v[72:75], a[72:75], a[20:23], v[72:75]
  v_accvgpr_write_b32 a130, v34
  v_accvgpr_write_b32 a131, v35
  v_mfma_f32_16x16x32_bf16 v[76:79], a[76:79], a[20:23], v[76:79]
  v_pk_mul_f32 v[40:41], v[40:41], s[6:7]
  v_pk_mul_f32 v[42:43], v[42:43], s[6:7]
  v_mfma_f32_16x16x32_bf16 v[80:83], a[80:83], a[20:23], v[80:83]
  v_pk_mul_f32 v[44:45], v[44:45], s[6:7]
  v_pk_mul_f32 v[46:47], v[46:47], s[6:7]
  v_mfma_f32_16x16x32_bf16 v[84:87], a[84:87], a[20:23], v[84:87]
  v_cvt_pk_bf16_f32 v40, v40, v41
  v_cvt_pk_bf16_f32 v41, v42, v43
  v_mfma_f32_16x16x32_bf16 v[88:91], a[88:91], a[20:23], v[88:91]
  v_cvt_pk_bf16_f32 v42, v44, v45
  v_cvt_pk_bf16_f32 v43, v46, v47
  v_mfma_f32_16x16x32_bf16 v[92:95], a[92:95], a[20:23], v[92:95]
  v_accvgpr_write_b32 a132, v40
  v_accvgpr_write_b32 a133, v41
  v_mfma_f32_16x16x32_bf16 v[96:99], a[32:35], a[8:11], v[96:99]
  v_accvgpr_write_b32 a134, v42
  v_accvgpr_write_b32 a135, v43
  v_mfma_f32_16x16x32_bf16 v[100:103], a[36:39], a[8:11], v[100:103]
  v_mfma_f32_32x32x16_bf16 v[160:175], a[236:239], a[236:239], 0
  v_pk_mul_f32 v[48:49], v[48:49], s[6:7]
  v_mfma_f32_16x16x32_bf16 v[96:99], a[64:67], a[24:27], v[96:99]
  v_pk_mul_f32 v[50:51], v[50:51], s[6:7]
  v_pk_mul_f32 v[52:53], v[52:53], s[6:7]
  v_mfma_f32_16x16x32_bf16 v[100:103], a[68:71], a[24:27], v[100:103]
  v_pk_mul_f32 v[54:55], v[54:55], s[6:7]
  v_cvt_pk_bf16_f32 v48, v48, v49
  v_mfma_f32_16x16x32_bf16 v[104:107], a[40:43], a[8:11], v[104:107]
  v_cvt_pk_bf16_f32 v49, v50, v51
  v_cvt_pk_bf16_f32 v50, v52, v53
  v_mfma_f32_16x16x32_bf16 v[108:111], a[44:47], a[8:11], v[108:111]
  v_cvt_pk_bf16_f32 v51, v54, v55
  v_accvgpr_write_b32 a136, v48
  v_mfma_f32_16x16x32_bf16 v[104:107], a[72:75], a[24:27], v[104:107]
  v_accvgpr_write_b32 a137, v49
  v_accvgpr_write_b32 a138, v50
  v_mfma_f32_16x16x32_bf16 v[108:111], a[76:79], a[24:27], v[108:111]
  v_accvgpr_write_b32 a139, v51
  v_pk_mul_f32 v[56:57], v[56:57], s[6:7]
  v_mfma_f32_16x16x32_bf16 v[112:115], a[48:51], a[8:11], v[112:115]
  v_pk_mul_f32 v[58:59], v[58:59], s[6:7]
  v_pk_mul_f32 v[60:61], v[60:61], s[6:7]
  v_mfma_f32_16x16x32_bf16 v[116:119], a[52:55], a[8:11], v[116:119]
  v_pk_mul_f32 v[62:63], v[62:63], s[6:7]
  v_cvt_pk_bf16_f32 v56, v56, v57
  v_mfma_f32_16x16x32_bf16 v[112:115], a[80:83], a[24:27], v[112:115]
  v_cvt_pk_bf16_f32 v57, v58, v59
  v_cvt_pk_bf16_f32 v58, v60, v61
  v_mfma_f32_16x16x32_bf16 v[116:119], a[84:87], a[24:27], v[116:119]
  v_cvt_pk_bf16_f32 v59, v62, v63
  v_accvgpr_write_b32 a140, v56
  v_mfma_f32_16x16x32_bf16 v[120:123], a[56:59], a[8:11], v[120:123]
  v_accvgpr_write_b32 a141, v57
  v_accvgpr_write_b32 a142, v58
  v_mfma_f32_16x16x32_bf16 v[124:127], a[60:63], a[8:11], v[124:127]
  v_accvgpr_write_b32 a143, v59
  v_mfma_f32_32x32x16_bf16 v[176:191], a[236:239], a[236:239], 0
  v_mfma_f32_16x16x32_bf16 v[120:123], a[88:91], a[24:27], v[120:123]
  v_pk_mul_f32 v[64:65], v[64:65], s[6:7]
  v_pk_mul_f32 v[66:67], v[66:67], s[6:7]
  v_mfma_f32_16x16x32_bf16 v[124:127], a[92:95], a[24:27], v[124:127]
  v_pk_mul_f32 v[68:69], v[68:69], s[6:7]
  v_pk_mul_f32 v[70:71], v[70:71], s[6:7]
  v_mfma_f32_16x16x32_bf16 v[128:131], a[32:35], a[12:15], v[128:131]
  v_cvt_pk_bf16_f32 v64, v64, v65
  v_cvt_pk_bf16_f32 v65, v66, v67
  v_mfma_f32_16x16x32_bf16 v[132:135], a[36:39], a[12:15], v[132:135]
  v_cvt_pk_bf16_f32 v66, v68, v69
  v_cvt_pk_bf16_f32 v67, v70, v71
  v_mfma_f32_16x16x32_bf16 v[128:131], a[64:67], a[28:31], v[128:131]
  v_accvgpr_write_b32 a144, v64
  v_accvgpr_write_b32 a145, v65
  v_mfma_f32_16x16x32_bf16 v[132:135], a[68:71], a[28:31], v[132:135]
  v_accvgpr_write_b32 a146, v66
  v_accvgpr_write_b32 a147, v67
  v_mfma_f32_16x16x32_bf16 v[136:139], a[40:43], a[12:15], v[136:139]
  v_pk_mul_f32 v[72:73], v[72:73], s[6:7]
  v_pk_mul_f32 v[74:75], v[74:75], s[6:7]
  v_mfma_f32_16x16x32_bf16 v[140:143], a[44:47], a[12:15], v[140:143]
  v_pk_mul_f32 v[76:77], v[76:77], s[6:7]
  v_pk_mul_f32 v[78:79], v[78:79], s[6:7]
  v_mfma_f32_16x16x32_bf16 v[136:139], a[72:75], a[28:31], v[136:139]
  v_cvt_pk_bf16_f32 v72, v72, v73
  v_cvt_pk_bf16_f32 v73, v74, v75
  v_mfma_f32_16x16x32_bf16 v[140:143], a[76:79], a[28:31], v[140:143]
  v_cvt_pk_bf16_f32 v74, v76, v77
  v_cvt_pk_bf16_f32 v75, v78, v79
  v_mfma_f32_16x16x32_bf16 v[144:147], a[48:51], a[12:15], v[144:147]
  v_accvgpr_write_b32 a148, v72
  v_accvgpr_write_b32 a149, v73
  v_mfma_f32_16x16x32_bf16 v[148:151], a[52:55], a[12:15], v[148:151]
  v_accvgpr_write_b32 a150, v74
  v_accvgpr_write_b32 a151, v75
  v_mfma_f32_16x16x32_bf16 v[144:147], a[80:83], a[28:31], v[144:147]
  v_mfma_f32_32x32x16_bf16 v[192:207], a[236:239], a[236:239], 0
  v_pk_mul_f32 v[80:81], v[80:81], s[6:7]
  v_mfma_f32_16x16x32_bf16 v[148:151], a[84:87], a[28:31], v[148:151]
  v_pk_mul_f32 v[82:83], v[82:83], s[6:7]
  v_pk_mul_f32 v[84:85], v[84:85], s[6:7]
  v_mfma_f32_16x16x32_bf16 v[152:155], a[56:59], a[12:15], v[152:155]
  v_pk_mul_f32 v[86:87], v[86:87], s[6:7]
  v_cvt_pk_bf16_f32 v80, v80, v81
  v_mfma_f32_16x16x32_bf16 v[156:159], a[60:63], a[12:15], v[156:159]
  v_cvt_pk_bf16_f32 v81, v82, v83
  v_cvt_pk_bf16_f32 v82, v84, v85
  v_mfma_f32_16x16x32_bf16 v[152:155], a[88:91], a[28:31], v[152:155]
  v_cvt_pk_bf16_f32 v83, v86, v87
  v_accvgpr_write_b32 a152, v80
  v_mfma_f32_16x16x32_bf16 v[156:159], a[92:95], a[28:31], v[156:159]
  v_accvgpr_write_b32 a153, v81
  v_accvgpr_write_b32 a154, v82
  v_accvgpr_write_b32 a155, v83
  v_pk_mul_f32 v[88:89], v[88:89], s[6:7]
  v_pk_mul_f32 v[90:91], v[90:91], s[6:7]
  v_pk_mul_f32 v[92:93], v[92:93], s[6:7]
  v_pk_mul_f32 v[94:95], v[94:95], s[6:7]
  v_cvt_pk_bf16_f32 v88, v88, v89
  v_cvt_pk_bf16_f32 v89, v90, v91
  v_cvt_pk_bf16_f32 v90, v92, v93
  v_cvt_pk_bf16_f32 v91, v94, v95
  v_accvgpr_write_b32 a156, v88
  v_accvgpr_write_b32 a157, v89
  v_accvgpr_write_b32 a158, v90
  v_accvgpr_write_b32 a159, v91
  v_mfma_f32_32x32x16_bf16 v[208:223], a[236:239], a[236:239], 0
  v_pk_mul_f32 v[96:97], v[96:97], s[6:7]
  v_pk_mul_f32 v[98:99], v[98:99], s[6:7]
  v_pk_mul_f32 v[100:101], v[100:101], s[6:7]
  v_pk_mul_f32 v[102:103], v[102:103], s[6:7]
  v_cvt_pk_bf16_f32 v96, v96, v97
  v_cvt_pk_bf16_f32 v97, v98, v99
  v_cvt_pk_bf16_f32 v98, v100, v101
  v_cvt_pk_bf16_f32 v99, v102, v103
  v_accvgpr_write_b32 a160, v96
  v_accvgpr_write_b32 a161, v97
  v_accvgpr_write_b32 a162, v98
  v_accvgpr_write_b32 a163, v99
  v_pk_mul_f32 v[104:105], v[104:105], s[6:7]
  v_pk_mul_f32 v[106:107], v[106:107], s[6:7]
  v_pk_mul_f32 v[108:109], v[108:109], s[6:7]
  v_pk_mul_f32 v[110:111], v[110:111], s[6:7]
  v_cvt_pk_bf16_f32 v104, v104, v105
  v_cvt_pk_bf16_f32 v105, v106, v107
  v_cvt_pk_bf16_f32 v106, v108, v109
  v_cvt_pk_bf16_f32 v107, v110, v111
  v_accvgpr_write_b32 a164, v104
  v_accvgpr_write_b32 a165, v105
  v_accvgpr_write_b32 a166, v106
  v_accvgpr_write_b32 a167, v107
  v_mfma_f32_32x32x16_bf16 v[224:239], a[236:239], a[236:239], 0
  v_pk_mul_f32 v[112:113], v[112:113], s[6:7]
  v_pk_mul_f32 v[114:115], v[114:115], s[6:7]
  v_pk_mul_f32 v[116:117], v[116:117], s[6:7]
  v_pk_mul_f32 v[118:119], v[118:119], s[6:7]
  v_cvt_pk_bf16_f32 v112, v112, v113
  v_cvt_pk_bf16_f32 v113, v114, v115
  v_cvt_pk_bf16_f32 v114, v116, v117
  v_cvt_pk_bf16_f32 v115, v118, v119
  v_accvgpr_write_b32 a168, v112
  v_accvgpr_write_b32 a169, v113
  v_accvgpr_write_b32 a170, v114
  v_accvgpr_write_b32 a171, v115
  v_pk_mul_f32 v[120:121], v[120:121], s[6:7]
  v_pk_mul_f32 v[122:123], v[122:123], s[6:7]
  v_pk_mul_f32 v[124:125], v[124:125], s[6:7]
  v_pk_mul_f32 v[126:127], v[126:127], s[6:7]
  v_cvt_pk_bf16_f32 v120, v120, v121
  v_cvt_pk_bf16_f32 v121, v122, v123
  v_cvt_pk_bf16_f32 v122, v124, v125
  v_cvt_pk_bf16_f32 v123, v126, v127
  v_accvgpr_write_b32 a172, v120
  v_accvgpr_write_b32 a173, v121
  v_accvgpr_write_b32 a174, v122
  v_accvgpr_write_b32 a175, v123
  v_mfma_f32_32x32x16_bf16 v[240:255], a[236:239], a[236:239], 0
  v_pk_mul_f32 v[128:129], v[128:129], s[6:7]
  v_pk_mul_f32 v[130:131], v[130:131], s[6:7]
  v_pk_mul_f32 v[132:133], v[132:133], s[6:7]
  v_pk_mul_f32 v[134:135], v[134:135], s[6:7]
  v_cvt_pk_bf16_f32 v128, v128, v129
  v_cvt_pk_bf16_f32 v129, v130, v131
  v_cvt_pk_bf16_f32 v130, v132, v133
  v_cvt_pk_bf16_f32 v131, v134, v135
  v_accvgpr_write_b32 a176, v128
  v_accvgpr_write_b32 a177, v129
  v_accvgpr_write_b32 a178, v130
  v_accvgpr_write_b32 a179, v131
  v_pk_mul_f32 v[136:137], v[136:137], s[6:7]
  v_pk_mul_f32 v[138:139], v[138:139], s[6:7]
  v_pk_mul_f32 v[140:141], v[140:141], s[6:7]
  v_pk_mul_f32 v[142:143], v[142:143], s[6:7]
  v_cvt_pk_bf16_f32 v136, v136, v137
  v_cvt_pk_bf16_f32 v137, v138, v139
  v_cvt_pk_bf16_f32 v138, v140, v141
  v_cvt_pk_bf16_f32 v139, v142, v143
  v_accvgpr_write_b32 a180, v136
  v_accvgpr_write_b32 a181, v137
  v_accvgpr_write_b32 a182, v138
  v_accvgpr_write_b32 a183, v139
  v_mfma_f32_32x32x16_bf16 v[128:143], a[236:239], a[236:239], 0
  v_pk_mul_f32 v[144:145], v[144:145], s[6:7]
  v_pk_mul_f32 v[146:147], v[146:147], s[6:7]
  v_pk_mul_f32 v[148:149], v[148:149], s[6:7]
  v_pk_mul_f32 v[150:151], v[150:151], s[6:7]
  v_cvt_pk_bf16_f32 v144, v144, v145
  v_cvt_pk_bf16_f32 v145, v146, v147
  v_cvt_pk_bf16_f32 v146, v148, v149
  v_cvt_pk_bf16_f32 v147, v150, v151
  v_accvgpr_write_b32 a184, v144
  v_accvgpr_write_b32 a185, v145
  v_accvgpr_write_b32 a186, v146
  v_accvgpr_write_b32 a187, v147
  v_pk_mul_f32 v[152:153], v[152:153], s[6:7]
  v_pk_mul_f32 v[154:155], v[154:155], s[6:7]
  v_pk_mul_f32 v[156:157], v[156:157], s[6:7]
  v_pk_mul_f32 v[158:159], v[158:159], s[6:7]
  v_cvt_pk_bf16_f32 v152, v152, v153
  v_cvt_pk_bf16_f32 v153, v154, v155
  v_cvt_pk_bf16_f32 v154, v156, v157
  v_cvt_pk_bf16_f32 v155, v158, v159
  v_accvgpr_write_b32 a188, v152
  v_accvgpr_write_b32 a189, v153
  v_accvgpr_write_b32 a190, v154
  v_accvgpr_write_b32 a191, v155
  v_mfma_f32_32x32x16_bf16 v[144:159], a[236:239], a[236:239], 0
  v_add_u32 v3, 0xc000, v2
  v_add_u32 v4, 0x10000, v2
  v_mov_b32 v5, 0xf149f2ca
  s_mov_b32 s89, 0
  v_mfma_f32_32x32x16_bf16 a[192:207], a[236:239], a[236:239], 0
  s_lshl_b32 s90, s78, 1
  s_add_u32 s90, s90, s77
  s_lshl_b32 s90, s90, 2
  s_add_u32 s90, s90, s3
  s_lshl_b32 s90, s90, 14
  s_add_u32 s64, s86, 100663296
  s_addc_u32 s65, s87, 0
  s_add_u32 s64, s64, s90
  s_addc_u32 s65, s65, 0
  s_mov_b32 s66, 16384
  s_mov_b32 s67, 0x00020000
  s_mov_b32 s90, 0
  s_waitcnt vmcnt(8)
  s_barrier
  ds_read_b128 a[32:35], v3 offset:0
  ds_read_b128 a[36:39], v3 offset:1024
  ds_read_b128 a[40:43], v3 offset:2048
  ds_read_b128 a[44:47], v3 offset:3072
  ds_read_b128 a[48:51], v3 offset:4096
  ds_read_b128 a[52:55], v3 offset:5120
  ds_read_b128 a[56:59], v3 offset:6144
  ds_read_b128 a[60:63], v3 offset:7168
  s_waitcnt lgkmcnt(6)
  v_mfma_f32_16x16x32_bf16 v[64:67], a[32:35], a[128:131], 0
  s_lshl_b32 s4, s2, 2
  s_add_u32 s4, s4, s3
  s_lshl_b32 s6, s4, 13
  v_mfma_f32_16x16x32_bf16 v[72:75], a[32:35], a[144:147], 0
  s_lshl_b32 s7, s4, 11
  s_mov_b32 s8, s74
  s_mov_b32 s9, s75
  v_mfma_f32_16x16x32_bf16 v[80:83], a[32:35], a[160:163], 0
  s_mov_b32 s10, 8388608
  s_mov_b32 s11, 0x00020000
  s_mov_b32 s12, s80
  v_mfma_f32_16x16x32_bf16 v[88:91], a[32:35], a[176:179], 0
  s_mov_b32 s13, s81
  s_mov_b32 s14, 2097152
  ds_read_b128 a[0:3], v3 offset:8192
  v_mfma_f32_16x16x32_bf16 v[64:67], a[36:39], a[132:135], v[64:67]
  s_mov_b32 s15, 0x00020000
  s_add_u32 s16, s86, 67108864
  s_addc_u32 s17, s87, 0
  v_mfma_f32_16x16x32_bf16 v[72:75], a[36:39], a[148:151], v[72:75]
  s_mov_b32 s18, 16777216
  s_mov_b32 s19, 0x00020000
  v_mfma_f32_16x16x32_bf16 v[80:83], a[36:39], a[164:167], v[80:83]
  v_and_b32 v6, 15, v1
  v_lshrrev_b32 v7, 4, v1
  v_mfma_f32_16x16x32_bf16 v[88:91], a[36:39], a[180:183], v[88:91]
  s_waitcnt lgkmcnt(5)
  ds_read_b128 a[4:7], v3 offset:9216
  v_sub_u32 v6, v6, v7
  v_mfma_f32_16x16x32_bf16 v[64:67], a[40:43], a[136:139], v[64:67]
  v_lshlrev_b32 v6, 2, v6
  v_add_u32 v6, s3, v6
  v_mfma_f32_16x16x32_bf16 v[72:75], a[40:43], a[152:155], v[72:75]
  v_cmp_gt_i32 s[32:33], 0, v6
  v_cmp_gt_i32 s[34:35], 1, v6
  v_mfma_f32_16x16x32_bf16 v[80:83], a[40:43], a[168:171], v[80:83]
  v_cmp_gt_i32 s[36:37], 2, v6
  v_cmp_gt_i32 s[38:39], 3, v6
  v_mfma_f32_16x16x32_bf16 v[88:91], a[40:43], a[184:187], v[88:91]
  ds_read_b128 a[8:11], v3 offset:10240
  v_cmp_gt_i32 s[40:41], 16, v6
  v_mfma_f32_16x16x32_bf16 v[64:67], a[44:47], a[140:143], v[64:67]
  v_cmp_gt_i32 s[42:43], 17, v6
  v_cmp_gt_i32 s[44:45], 18, v6
  v_mfma_f32_16x16x32_bf16 v[72:75], a[44:47], a[156:159], v[72:75]
  v_cmp_gt_i32 s[46:47], 19, v6
  v_cmp_gt_i32 s[48:49], 32, v6
  v_mfma_f32_16x16x32_bf16 v[80:83], a[44:47], a[172:175], v[80:83]
  v_cmp_gt_i32 s[50:51], 33, v6
  v_cmp_gt_i32 s[52:53], 34, v6
  v_mfma_f32_16x16x32_bf16 v[88:91], a[44:47], a[188:191], v[88:91]
  s_waitcnt lgkmcnt(5)
  ds_read_b128 a[12:15], v3 offset:11264
  v_cmp_gt_i32 s[54:55], 35, v6
  v_mfma_f32_16x16x32_bf16 v[68:71], a[48:51], a[128:131], 0
  v_cmp_gt_i32 s[56:57], 48, v6
  v_cmp_gt_i32 s[58:59], 49, v6
  v_mfma_f32_16x16x32_bf16 v[76:79], a[48:51], a[144:147], 0
  s_mov_b32 s30, 0x8000
  v_cmp_gt_i32 s[60:61], 50, v6
  v_cmp_gt_i32 s[62:63], 51, v6
  v_mfma_f32_16x16x32_bf16 v[84:87], a[48:51], a[160:163], 0
  s_mov_b32 s31, 0x4000
  v_mfma_f32_16x16x32_bf16 v[92:95], a[48:51], a[176:179], 0
  ds_read_b128 a[16:19], v3 offset:12288
  v_mfma_f32_16x16x32_bf16 v[68:71], a[52:55], a[132:135], v[68:71]
  v_mfma_f32_16x16x32_bf16 v[76:79], a[52:55], a[148:151], v[76:79]
  v_mfma_f32_16x16x32_bf16 v[84:87], a[52:55], a[164:167], v[84:87]
  v_mfma_f32_16x16x32_bf16 v[92:95], a[52:55], a[180:183], v[92:95]
  s_waitcnt lgkmcnt(5)
  ds_read_b128 a[20:23], v3 offset:13312
  v_mfma_f32_16x16x32_bf16 v[68:71], a[56:59], a[136:139], v[68:71]
  v_mfma_f32_16x16x32_bf16 v[76:79], a[56:59], a[152:155], v[76:79]
  v_mfma_f32_16x16x32_bf16 v[84:87], a[56:59], a[168:171], v[84:87]
  v_mfma_f32_16x16x32_bf16 v[92:95], a[56:59], a[184:187], v[92:95]
  ds_read_b128 a[24:27], v3 offset:14336
  v_mfma_f32_16x16x32_bf16 v[68:71], a[60:63], a[140:143], v[68:71]
  v_mfma_f32_16x16x32_bf16 v[76:79], a[60:63], a[156:159], v[76:79]
  v_mfma_f32_16x16x32_bf16 v[84:87], a[60:63], a[172:175], v[84:87]
  v_mfma_f32_16x16x32_bf16 v[92:95], a[60:63], a[188:191], v[92:95]
  ds_read_b128 a[28:31], v3 offset:15360
  s_cmp_lg_u32 s25, 0
  s_nop 0
  s_cbranch_scc1 La_nomask0
  v_cndmask_b32 v64, v64, v5, s[32:33]
  v_cndmask_b32 v65, v65, v5, s[34:35]
  v_cndmask_b32 v66, v66, v5, s[36:37]
  v_cndmask_b32 v67, v67, v5, s[38:39]
  v_cndmask_b32 v68, v68, v5, s[40:41]
  v_cndmask_b32 v69, v69, v5, s[42:43]
  v_cndmask_b32 v70, v70, v5, s[44:45]
  v_cndmask_b32 v71, v71, v5, s[46:47]
La_nomask0:
  v_max3_f32 v6, v64, v65, v66
  v_max3_f32 v7, v67, v68, v69
  v_max3_f32 v6, v6, v70, v71
  v_max_f32 v6, v6, v7
  v_max3_f32 v8, v72, v73, v74
  v_max3_f32 v9, v75, v76, v77
  v_max3_f32 v8, v8, v78, v79
  v_max_f32 v8, v8, v9
  v_max3_f32 v10, v80, v81, v82
  v_max3_f32 v11, v83, v84, v85
  v_max3_f32 v10, v10, v86, v87
  v_max_f32 v10, v10, v11
  v_max3_f32 v12, v88, v89, v90
  v_max3_f32 v13, v91, v92, v93
  v_max3_f32 v12, v12, v94, v95
  v_max_f32 v12, v12, v13
  v_mov_b32 v7, v6
  v_mov_b32 v9, v8
  v_mov_b32 v11, v10
  v_mov_b32 v13, v12
  v_permlane32_swap_b32 v6, v7
  v_permlane32_swap_b32 v8, v9
  v_permlane32_swap_b32 v10, v11
  v_permlane32_swap_b32 v12, v13
  v_max_f32 v6, v6, v7
  v_max_f32 v8, v8, v9
  v_max_f32 v10, v10, v11
  v_max_f32 v12, v12, v13
  v_mov_b32 v7, v6
  v_mov_b32 v9, v8
  v_mov_b32 v11, v10
  v_mov_b32 v13, v12
  v_permlane16_swap_b32 v6, v7
  v_permlane16_swap_b32 v8, v9
  v_permlane16_swap_b32 v10, v11
  v_permlane16_swap_b32 v12, v13
  v_max_f32 v6, v6, v7
  v_max_f32 v8, v8, v9
  v_max_f32 v10, v10, v11
  v_max_f32 v12, v12, v13
  v_sub_f32 v16, 0, v6
  v_sub_f32 v17, 0, v6
  v_sub_f32 v18, 0, v6
  v_sub_f32 v19, 0, v6
  v_sub_f32 v20, 0, v8
  v_sub_f32 v21, 0, v8
  v_sub_f32 v22, 0, v8
  v_sub_f32 v23, 0, v8
  v_sub_f32 v24, 0, v10
  v_sub_f32 v25, 0, v10
  v_sub_f32 v26, 0, v10
  v_sub_f32 v27, 0, v10
  v_sub_f32 v28, 0, v12
  v_sub_f32 v29, 0, v12
  v_sub_f32 v30, 0, v12
  v_sub_f32 v31, 0, v12
  v_pk_add_f32 v[64:65], v[64:65], v[16:17]
  v_pk_add_f32 v[66:67], v[66:67], v[16:17]
  v_pk_add_f32 v[68:69], v[68:69], v[16:17]
  v_pk_add_f32 v[70:71], v[70:71], v[16:17]
  v_pk_add_f32 v[72:73], v[72:73], v[20:21]
  v_pk_add_f32 v[74:75], v[74:75], v[20:21]
  v_pk_add_f32 v[76:77], v[76:77], v[20:21]
  v_pk_add_f32 v[78:79], v[78:79], v[20:21]
  v_pk_add_f32 v[80:81], v[80:81], v[24:25]
  v_pk_add_f32 v[82:83], v[82:83], v[24:25]
  v_pk_add_f32 v[84:85], v[84:85], v[24:25]
  v_pk_add_f32 v[86:87], v[86:87], v[24:25]
  v_pk_add_f32 v[88:89], v[88:89], v[28:29]
  v_pk_add_f32 v[90:91], v[90:91], v[28:29]
  v_pk_add_f32 v[92:93], v[92:93], v[28:29]
  v_pk_add_f32 v[94:95], v[94:95], v[28:29]
  s_lshl_b32 s88, s25, 1
  s_waitcnt vmcnt(0)
  s_barrier
  s_waitcnt lgkmcnt(4)
  v_mfma_f32_16x16x32_bf16 v[96:99], a[0:3], a[128:131], v[16:19]
  s_mov_b32 m0, s26
  v_exp_f32 v64, v64
  v_mfma_f32_16x16x32_bf16 v[96:99], a[4:7], a[132:135], v[96:99]
  buffer_load_dwordx4 v2, s[20:23], s28 offen offset:0 sc1 lds
  v_exp_f32 v65, v65
  v_mfma_f32_16x16x32_bf16 v[96:99], a[8:11], a[136:139], v[96:99]
  buffer_load_dwordx4 v2, s[20:23], s28 offen offset:1024 sc1 lds
  v_exp_f32 v66, v66
  v_mfma_f32_16x16x32_bf16 v[96:99], a[12:15], a[140:143], v[96:99]
  buffer_load_dwordx4 v2, s[20:23], s28 offen offset:2048 sc1 lds
  v_exp_f32 v67, v67
  v_mfma_f32_16x16x32_bf16 v[104:107], a[0:3], a[144:147], v[20:23]
  v_exp_f32 v68, v68
  v_cvt_pk_bf16_f32 v32, v64, v65
  v_mfma_f32_16x16x32_bf16 v[104:107], a[4:7], a[148:151], v[104:107]
  buffer_load_dwordx4 v2, s[20:23], s28 offen offset:3072 sc1 lds
  v_exp_f32 v69, v69
  v_mfma_f32_16x16x32_bf16 v[104:107], a[8:11], a[152:155], v[104:107]
  s_xor_b32 s26, s26, 0x4000
  v_exp_f32 v70, v70
  v_cvt_pk_bf16_f32 v33, v66, v67
  v_mfma_f32_16x16x32_bf16 v[104:107], a[12:15], a[156:159], v[104:107]
  s_add_u32 s28, s28, 0x8000
  v_exp_f32 v71, v71
  v_cvt_pk_bf16_f32 v34, v68, v69
  v_mfma_f32_16x16x32_bf16 v[112:115], a[0:3], a[160:163], v[24:27]
  s_mov_b32 m0, s27
  v_exp_f32 v72, v72
  v_cvt_pk_bf16_f32 v35, v70, v71
  v_mfma_f32_16x16x32_bf16 v[112:115], a[4:7], a[164:167], v[112:115]
  buffer_load_dwordx4 v2, s[20:23], s29 offen offset:0 sc1 lds
  v_exp_f32 v73, v73
  v_mfma_f32_16x16x32_bf16 v[112:115], a[8:11], a[168:171], v[112:115]
  buffer_load_dwordx4 v2, s[20:23], s29 offen offset:1024 sc1 lds
  v_exp_f32 v74, v74
  v_mfma_f32_16x16x32_bf16 v[112:115], a[12:15], a[172:175], v[112:115]
  buffer_load_dwordx4 v2, s[20:23], s29 offen offset:2048 sc1 lds
  v_exp_f32 v75, v75
  v_mfma_f32_16x16x32_bf16 v[120:123], a[0:3], a[176:179], v[28:31]
  buffer_load_dwordx4 v2, s[20:23], s29 offen offset:3072 sc1 lds
  v_exp_f32 v76, v76
  v_mfma_f32_16x16x32_bf16 v[120:123], a[4:7], a[180:183], v[120:123]
  s_xor_b32 s27, s27, 0x8000
  v_exp_f32 v77, v77
  v_cvt_pk_bf16_f32 v36, v72, v73
  v_mfma_f32_16x16x32_bf16 v[120:123], a[8:11], a[184:187], v[120:123]
  s_add_u32 s29, s29, 0x8000
  v_exp_f32 v78, v78
  v_cvt_pk_bf16_f32 v37, v74, v75
  v_mfma_f32_16x16x32_bf16 v[120:123], a[12:15], a[188:191], v[120:123]
  s_waitcnt lgkmcnt(0)
  v_exp_f32 v79, v79
  v_cvt_pk_bf16_f32 v38, v76, v77
  v_mfma_f32_16x16x32_bf16 v[100:103], a[16:19], a[128:131], v[16:19]
  s_mov_b32 m0, s26
  v_exp_f32 v80, v80
  v_cvt_pk_bf16_f32 v39, v78, v79
  v_mfma_f32_16x16x32_bf16 v[100:103], a[20:23], a[132:135], v[100:103]
  buffer_load_dwordx4 v2, s[20:23], s28 offen offset:0 sc1 lds
  v_exp_f32 v81, v81
  v_mfma_f32_16x16x32_bf16 v[100:103], a[24:27], a[136:139], v[100:103]
  buffer_load_dwordx4 v2, s[20:23], s28 offen offset:1024 sc1 lds
  v_exp_f32 v82, v82
  v_cvt_pk_bf16_f32 v40, v80, v81
  v_mfma_f32_16x16x32_bf16 v[100:103], a[28:31], a[140:143], v[100:103]
  buffer_load_dwordx4 v2, s[20:23], s28 offen offset:2048 sc1 lds
  v_exp_f32 v83, v83
  v_mfma_f32_16x16x32_bf16 v[108:111], a[16:19], a[144:147], v[20:23]
  buffer_load_dwordx4 v2, s[20:23], s28 offen offset:3072 sc1 lds
  v_exp_f32 v84, v84
  v_cvt_pk_bf16_f32 v41, v82, v83
  v_mfma_f32_16x16x32_bf16 v[108:111], a[20:23], a[148:151], v[108:111]
  s_xor_b32 s26, s26, 0x8000
  v_exp_f32 v85, v85
  v_xor_b32 v3, 0x4000, v3
  v_mfma_f32_16x16x32_bf16 v[108:111], a[24:27], a[152:155], v[108:111]
  s_add_u32 s28, s28, 0x8000
  ds_read_b128 a[32:35], v3 offset:0
  v_exp_f32 v86, v86
  v_cvt_pk_bf16_f32 v42, v84, v85
  v_mfma_f32_16x16x32_bf16 v[108:111], a[28:31], a[156:159], v[108:111]
  s_mov_b32 m0, s27
  ds_read_b128 a[36:39], v3 offset:1024
  v_exp_f32 v87, v87
  v_mfma_f32_16x16x32_bf16 v[116:119], a[16:19], a[160:163], v[24:27]
  buffer_load_dwordx4 v2, s[20:23], s29 offen offset:0 sc1 lds
  v_exp_f32 v88, v88
  v_cvt_pk_bf16_f32 v43, v86, v87
  v_mfma_f32_16x16x32_bf16 v[116:119], a[20:23], a[164:167], v[116:119]
  buffer_load_dwordx4 v2, s[20:23], s29 offen offset:1024 sc1 lds
  v_exp_f32 v89, v89
  v_mfma_f32_16x16x32_bf16 v[116:119], a[24:27], a[168:171], v[116:119]
  buffer_load_dwordx4 v2, s[20:23], s29 offen offset:2048 sc1 lds
  v_exp_f32 v90, v90
  v_cvt_pk_bf16_f32 v44, v88, v89
  v_mfma_f32_16x16x32_bf16 v[116:119], a[28:31], a[172:175], v[116:119]
  buffer_load_dwordx4 v2, s[20:23], s29 offen offset:3072 sc1 lds
  v_exp_f32 v91, v91
  v_mfma_f32_16x16x32_bf16 v[124:127], a[16:19], a[176:179], v[28:31]
  s_xor_b32 s27, s27, 0x4000
  ds_read_b128 a[40:43], v3 offset:2048
  v_exp_f32 v92, v92
  v_cvt_pk_bf16_f32 v45, v90, v91
  v_mfma_f32_16x16x32_bf16 v[124:127], a[20:23], a[180:183], v[124:127]
  s_add_u32 s29, s29, 0x8000
  ds_read_b128 a[44:47], v3 offset:3072
  v_exp_f32 v93, v93
  v_mfma_f32_16x16x32_bf16 v[124:127], a[24:27], a[184:187], v[124:127]
  ds_read_b128 a[48:51], v3 offset:4096
  v_exp_f32 v94, v94
  v_cvt_pk_bf16_f32 v46, v92, v93
  v_mfma_f32_16x16x32_bf16 v[124:127], a[28:31], a[188:191], v[124:127]
  ds_read_b128 a[52:55], v3 offset:5120
  ds_read_b128 a[56:59], v3 offset:6144
  ds_read_b128 a[60:63], v3 offset:7168
  ds_read_b128 a[0:3], v4 offset:0
  ds_read_b128 a[4:7], v4 offset:1024
  ds_read_b128 a[8:11], v4 offset:2048
  v_exp_f32 v95, v95
  s_nop 0
  v_cvt_pk_bf16_f32 v47, v94, v95
  s_cmp_eq_u32 s25, 0
  s_cbranch_scc1 La_d1
  .p2align 6
La_lo:
  s_waitcnt lgkmcnt(7)
  v_mfma_f32_16x16x32_bf16 v[64:67], a[32:35], a[128:131], v[16:19]
  v_exp_f32 v96, v96
  v_mfma_f32_16x16x32_bf16 v[64:67], a[36:39], a[132:135], v[64:67]
  buffer_store_dwordx4 a[244:247], v2, s[64:67], s90 offen offset:0 sc1
  ds_read_b128 a[12:15], v4 offset:3072
  v_mfma_f32_16x16x32_bf16 v[64:67], a[40:43], a[136:139], v[64:67]
  v_exp_f32 v97, v97
  v_mfma_f32_16x16x32_bf16 v[64:67], a[44:47], a[140:143], v[64:67]
  v_cvt_pk_bf16_f32 v48, v96, v97
  v_mfma_f32_16x16x32_bf16 v[72:75], a[32:35], a[144:147], v[20:23]
  v_exp_f32 v98, v98
  v_mfma_f32_16x16x32_bf16 v[72:75], a[36:39], a[148:151], v[72:75]
  ds_read_b128 a[16:19], v4 offset:4096
  v_mfma_f32_16x16x32_bf16 v[72:75], a[40:43], a[152:155], v[72:75]
  v_exp_f32 v99, v99
  v_mfma_f32_16x16x32_bf16 v[72:75], a[44:47], a[156:159], v[72:75]
  v_cvt_pk_bf16_f32 v49, v98, v99
  v_mfma_f32_16x16x32_bf16 v[80:83], a[32:35], a[160:163], v[24:27]
  v_exp_f32 v100, v100
  v_mfma_f32_16x16x32_bf16 v[80:83], a[36:39], a[164:167], v[80:83]
  ds_read_b128 a[20:23], v4 offset:5120
  v_mfma_f32_16x16x32_bf16 v[80:83], a[40:43], a[168:171], v[80:83]
  v_exp_f32 v101, v101
  v_mfma_f32_16x16x32_bf16 v[80:83], a[44:47], a[172:175], v[80:83]
  v_cvt_pk_bf16_f32 v50, v100, v101
  v_mfma_f32_16x16x32_bf16 v[88:91], a[32:35], a[176:179], v[28:31]
  v_exp_f32 v102, v102
  v_mfma_f32_16x16x32_bf16 v[88:91], a[36:39], a[180:183], v[88:91]
  ds_read_b128 a[24:27], v4 offset:6144
  v_mfma_f32_16x16x32_bf16 v[88:91], a[40:43], a[184:187], v[88:91]
  v_exp_f32 v103, v103
  v_mfma_f32_16x16x32_bf16 v[88:91], a[44:47], a[188:191], v[88:91]
  s_waitcnt lgkmcnt(7)
  v_cvt_pk_bf16_f32 v51, v102, v103
  v_mfma_f32_16x16x32_bf16 v[68:71], a[48:51], a[128:131], v[16:19]
  v_exp_f32 v104, v104
  v_mfma_f32_16x16x32_bf16 v[68:71], a[52:55], a[132:135], v[68:71]
  ds_read_b128 a[28:31], v4 offset:7168
  v_mfma_f32_16x16x32_bf16 v[68:71], a[56:59], a[136:139], v[68:71]
  v_exp_f32 v105, v105
  v_mfma_f32_16x16x32_bf16 v[68:71], a[60:63], a[140:143], v[68:71]
  v_cvt_pk_bf16_f32 v52, v104, v105
  v_mfma_f32_16x16x32_bf16 v[76:79], a[48:51], a[144:147], v[20:23]
  v_exp_f32 v106, v106
  v_mfma_f32_16x16x32_bf16 v[76:79], a[52:55], a[148:151], v[76:79]
  ds_read_b128 a[32:35], v3 offset:8192
  v_mfma_f32_16x16x32_bf16 v[76:79], a[56:59], a[152:155], v[76:79]
  v_exp_f32 v107, v107
  v_mfma_f32_16x16x32_bf16 v[76:79], a[60:63], a[156:159], v[76:79]
  v_cvt_pk_bf16_f32 v53, v106, v107
  v_mfma_f32_16x16x32_bf16 v[84:87], a[48:51], a[160:163], v[24:27]
  v_exp_f32 v108, v108
  v_mfma_f32_16x16x32_bf16 v[84:87], a[52:55], a[164:167], v[84:87]
  ds_read_b128 a[36:39], v3 offset:9216
  v_mfma_f32_16x16x32_bf16 v[84:87], a[56:59], a[168:171], v[84:87]
  v_exp_f32 v109, v109
  v_mfma_f32_16x16x32_bf16 v[84:87], a[60:63], a[172:175], v[84:87]
  v_cvt_pk_bf16_f32 v54, v108, v109
  v_mfma_f32_16x16x32_bf16 v[92:95], a[48:51], a[176:179], v[28:31]
  v_exp_f32 v110, v110
  v_mfma_f32_16x16x32_bf16 v[92:95], a[52:55], a[180:183], v[92:95]
  ds_read_b128 a[40:43], v3 offset:10240
  v_mfma_f32_16x16x32_bf16 v[92:95], a[56:59], a[184:187], v[92:95]
  v_exp_f32 v111, v111
  v_mfma_f32_16x16x32_bf16 v[92:95], a[60:63], a[188:191], v[92:95]
  s_waitcnt lgkmcnt(7)
  v_cvt_pk_bf16_f32 v55, v110, v111
  v_mfma_f32_16x16x32_bf16 v[128:131], a[0:3], v[32:35], v[128:131]
  buffer_store_dwordx4 a[244:247], v2, s[64:67], s90 offen offset:1024 sc1
  ds_read_b128 a[44:47], v3 offset:11264
  v_mfma_f32_16x16x32_bf16 v[160:163], a[0:3], v[36:39], v[160:163]
  s_add_u32 s90, s90, 2048
  v_exp_f32 v112, v112
  v_mfma_f32_16x16x32_bf16 v[192:195], a[0:3], v[40:43], v[192:195]
  s_sub_u32 s88, s88, 1
  v_mfma_f32_16x16x32_bf16 v[224:227], a[0:3], v[44:47], v[224:227]
  v_exp_f32 v113, v113
  v_mfma_f32_16x16x32_bf16 a[192:195], a[208:211], v[32:35], a[192:195]
  v_cvt_pk_bf16_f32 v56, v112, v113
  v_mfma_f32_16x16x32_bf16 v[132:135], a[4:7], v[32:35], v[132:135]
  v_exp_f32 v114, v114
  v_mfma_f32_16x16x32_bf16 v[164:167], a[4:7], v[36:39], v[164:167]
  ds_read_b128 a[48:51], v3 offset:12288
  v_mfma_f32_16x16x32_bf16 v[196:199], a[4:7], v[40:43], v[196:199]
  v_exp_f32 v115, v115
  v_mfma_f32_16x16x32_bf16 v[228:231], a[4:7], v[44:47], v[228:231]
  v_cvt_pk_bf16_f32 v57, v114, v115
  v_mfma_f32_16x16x32_bf16 a[196:199], a[208:211], v[36:39], a[196:199]
  v_exp_f32 v116, v116
  v_mfma_f32_16x16x32_bf16 v[136:139], a[8:11], v[32:35], v[136:139]
  ds_read_b128 a[52:55], v3 offset:13312
  v_mfma_f32_16x16x32_bf16 v[168:171], a[8:11], v[36:39], v[168:171]
  v_exp_f32 v117, v117
  v_mfma_f32_16x16x32_bf16 v[200:203], a[8:11], v[40:43], v[200:203]
  v_cvt_pk_bf16_f32 v58, v116, v117
  v_mfma_f32_16x16x32_bf16 v[232:235], a[8:11], v[44:47], v[232:235]
  v_exp_f32 v118, v118
  v_mfma_f32_16x16x32_bf16 a[200:203], a[208:211], v[40:43], a[200:203]
  v_mfma_f32_16x16x32_bf16 v[140:143], a[12:15], v[32:35], v[140:143]
  v_exp_f32 v119, v119
  v_mfma_f32_16x16x32_bf16 v[172:175], a[12:15], v[36:39], v[172:175]
  ds_read_b128 a[56:59], v3 offset:14336
  v_cvt_pk_bf16_f32 v59, v118, v119
  v_mfma_f32_16x16x32_bf16 v[204:207], a[12:15], v[40:43], v[204:207]
  v_exp_f32 v120, v120
  v_mfma_f32_16x16x32_bf16 v[236:239], a[12:15], v[44:47], v[236:239]
  v_mfma_f32_16x16x32_bf16 a[204:207], a[208:211], v[44:47], a[204:207]
  s_waitcnt lgkmcnt(7)
  v_exp_f32 v121, v121
  v_mfma_f32_16x16x32_bf16 v[144:147], a[16:19], v[32:35], v[144:147]
  ds_read_b128 a[60:63], v3 offset:15360
  v_cvt_pk_bf16_f32 v60, v120, v121
  v_mfma_f32_16x16x32_bf16 v[176:179], a[16:19], v[36:39], v[176:179]
  v_exp_f32 v122, v122
  v_mfma_f32_16x16x32_bf16 v[208:211], a[16:19], v[40:43], v[208:211]
  v_mfma_f32_16x16x32_bf16 v[240:243], a[16:19], v[44:47], v[240:243]
  v_exp_f32 v123, v123
  v_mfma_f32_16x16x32_bf16 v[148:151], a[20:23], v[32:35], v[148:151]
  ds_read_b128 a[0:3], v4 offset:8192
  v_cvt_pk_bf16_f32 v61, v122, v123
  v_mfma_f32_16x16x32_bf16 v[180:183], a[20:23], v[36:39], v[180:183]
  v_exp_f32 v124, v124
  v_mfma_f32_16x16x32_bf16 v[212:215], a[20:23], v[40:43], v[212:215]
  v_mfma_f32_16x16x32_bf16 v[244:247], a[20:23], v[44:47], v[244:247]
  v_exp_f32 v125, v125
  v_mfma_f32_16x16x32_bf16 v[152:155], a[24:27], v[32:35], v[152:155]
  ds_read_b128 a[4:7], v4 offset:9216
  v_cvt_pk_bf16_f32 v62, v124, v125
  v_mfma_f32_16x16x32_bf16 v[184:187], a[24:27], v[36:39], v[184:187]
  v_exp_f32 v126, v126
  v_mfma_f32_16x16x32_bf16 v[216:219], a[24:27], v[40:43], v[216:219]
  v_mfma_f32_16x16x32_bf16 v[248:251], a[24:27], v[44:47], v[248:251]
  v_exp_f32 v127, v127
  v_mfma_f32_16x16x32_bf16 v[156:159], a[28:31], v[32:35], v[156:159]
  ds_read_b128 a[8:11], v4 offset:10240
  v_cvt_pk_bf16_f32 v63, v126, v127
  v_mfma_f32_16x16x32_bf16 v[188:191], a[28:31], v[36:39], v[188:191]
  v_mfma_f32_16x16x32_bf16 v[220:223], a[28:31], v[40:43], v[220:223]
  s_waitcnt vmcnt(10)
  s_barrier
  v_mfma_f32_16x16x32_bf16 v[252:255], a[28:31], v[44:47], v[252:255]
  s_cmp_eq_u32 s88, 0
  s_cbranch_scc1 La_d0
  s_waitcnt lgkmcnt(7)
  v_mfma_f32_16x16x32_bf16 v[96:99], a[32:35], a[128:131], v[16:19]
  s_mov_b32 m0, s26
  v_exp_f32 v64, v64
  v_mfma_f32_16x16x32_bf16 v[96:99], a[36:39], a[132:135], v[96:99]
  buffer_load_dwordx4 v2, s[20:23], s28 offen offset:0 sc1 lds
  ds_read_b128 a[12:15], v4 offset:11264
  v_mfma_f32_16x16x32_bf16 v[96:99], a[40:43], a[136:139], v[96:99]
  v_exp_f32 v65, v65
  v_mfma_f32_16x16x32_bf16 v[96:99], a[44:47], a[140:143], v[96:99]
  v_cvt_pk_bf16_f32 v32, v64, v65
  v_mfma_f32_16x16x32_bf16 v[104:107], a[32:35], a[144:147], v[20:23]
  v_exp_f32 v66, v66
  v_mfma_f32_16x16x32_bf16 v[104:107], a[36:39], a[148:151], v[104:107]
  ds_read_b128 a[16:19], v4 offset:12288
  v_mfma_f32_16x16x32_bf16 v[104:107], a[40:43], a[152:155], v[104:107]
  v_exp_f32 v67, v67
  v_mfma_f32_16x16x32_bf16 v[104:107], a[44:47], a[156:159], v[104:107]
  v_cvt_pk_bf16_f32 v33, v66, v67
  v_mfma_f32_16x16x32_bf16 v[112:115], a[32:35], a[160:163], v[24:27]
  v_exp_f32 v68, v68
  v_mfma_f32_16x16x32_bf16 v[112:115], a[36:39], a[164:167], v[112:115]
  buffer_load_dwordx4 v2, s[20:23], s28 offen offset:1024 sc1 lds
  ds_read_b128 a[20:23], v4 offset:13312
  v_mfma_f32_16x16x32_bf16 v[112:115], a[40:43], a[168:171], v[112:115]
  v_exp_f32 v69, v69
  v_mfma_f32_16x16x32_bf16 v[112:115], a[44:47], a[172:175], v[112:115]
  v_cvt_pk_bf16_f32 v34, v68, v69
  v_mfma_f32_16x16x32_bf16 v[120:123], a[32:35], a[176:179], v[28:31]
  v_exp_f32 v70, v70
  v_mfma_f32_16x16x32_bf16 v[120:123], a[36:39], a[180:183], v[120:123]
  ds_read_b128 a[24:27], v4 offset:14336
  v_mfma_f32_16x16x32_bf16 v[120:123], a[40:43], a[184:187], v[120:123]
  v_exp_f32 v71, v71
  v_mfma_f32_16x16x32_bf16 v[120:123], a[44:47], a[188:191], v[120:123]
  s_waitcnt lgkmcnt(7)
  v_cvt_pk_bf16_f32 v35, v70, v71
  v_mfma_f32_16x16x32_bf16 v[100:103], a[48:51], a[128:131], v[16:19]
  v_exp_f32 v72, v72
  v_mfma_f32_16x16x32_bf16 v[100:103], a[52:55], a[132:135], v[100:103]
  buffer_load_dwordx4 v2, s[20:23], s28 offen offset:2048 sc1 lds
  ds_read_b128 a[28:31], v4 offset:15360
  v_mfma_f32_16x16x32_bf16 v[100:103], a[56:59], a[136:139], v[100:103]
  v_exp_f32 v73, v73
  v_mfma_f32_16x16x32_bf16 v[100:103], a[60:63], a[140:143], v[100:103]
  v_xor_b32 v3, s30, v3
  v_cvt_pk_bf16_f32 v36, v72, v73
  v_mfma_f32_16x16x32_bf16 v[108:111], a[48:51], a[144:147], v[20:23]
  v_exp_f32 v74, v74
  v_mfma_f32_16x16x32_bf16 v[108:111], a[52:55], a[148:151], v[108:111]
  ds_read_b128 a[32:35], v3 offset:0
  v_mfma_f32_16x16x32_bf16 v[108:111], a[56:59], a[152:155], v[108:111]
  v_exp_f32 v75, v75
  v_mfma_f32_16x16x32_bf16 v[108:111], a[60:63], a[156:159], v[108:111]
  v_cvt_pk_bf16_f32 v37, v74, v75
  v_mfma_f32_16x16x32_bf16 v[116:119], a[48:51], a[160:163], v[24:27]
  v_exp_f32 v76, v76
  v_mfma_f32_16x16x32_bf16 v[116:119], a[52:55], a[164:167], v[116:119]
  buffer_load_dwordx4 v2, s[20:23], s28 offen offset:3072 sc1 lds
  ds_read_b128 a[36:39], v3 offset:1024
  v_mfma_f32_16x16x32_bf16 v[116:119], a[56:59], a[168:171], v[116:119]
  s_xor_b32 s26, s26, s31
  v_exp_f32 v77, v77
  v_mfma_f32_16x16x32_bf16 v[116:119], a[60:63], a[172:175], v[116:119]
  s_add_u32 s28, s28, 0x8000
  s_mov_b32 m0, s27
  v_cvt_pk_bf16_f32 v38, v76, v77
  v_mfma_f32_16x16x32_bf16 v[124:127], a[48:51], a[176:179], v[28:31]
  v_exp_f32 v78, v78
  v_mfma_f32_16x16x32_bf16 v[124:127], a[52:55], a[180:183], v[124:127]
  ds_read_b128 a[40:43], v3 offset:2048
  v_mfma_f32_16x16x32_bf16 v[124:127], a[56:59], a[184:187], v[124:127]
  v_exp_f32 v79, v79
  v_mfma_f32_16x16x32_bf16 v[124:127], a[60:63], a[188:191], v[124:127]
  s_waitcnt lgkmcnt(7)
  v_cvt_pk_bf16_f32 v39, v78, v79
  v_mfma_f32_16x16x32_bf16 v[128:131], a[0:3], v[48:51], v[128:131]
  buffer_load_dwordx4 v2, s[20:23], s29 offen offset:0 sc1 lds
  ds_read_b128 a[44:47], v3 offset:3072
  v_mfma_f32_16x16x32_bf16 v[160:163], a[0:3], v[52:55], v[160:163]
  v_exp_f32 v80, v80
  v_mfma_f32_16x16x32_bf16 v[192:195], a[0:3], v[56:59], v[192:195]
  v_mfma_f32_16x16x32_bf16 v[224:227], a[0:3], v[60:63], v[224:227]
  v_exp_f32 v81, v81
  v_mfma_f32_16x16x32_bf16 a[192:195], a[208:211], v[48:51], a[192:195]
  v_cvt_pk_bf16_f32 v40, v80, v81
  v_mfma_f32_16x16x32_bf16 v[132:135], a[4:7], v[48:51], v[132:135]
  v_exp_f32 v82, v82
  v_mfma_f32_16x16x32_bf16 v[164:167], a[4:7], v[52:55], v[164:167]
  ds_read_b128 a[48:51], v3 offset:4096
  v_mfma_f32_16x16x32_bf16 v[196:199], a[4:7], v[56:59], v[196:199]
  v_exp_f32 v83, v83
  v_mfma_f32_16x16x32_bf16 v[228:231], a[4:7], v[60:63], v[228:231]
  buffer_load_dwordx4 v2, s[20:23], s29 offen offset:1024 sc1 lds
  v_cvt_pk_bf16_f32 v41, v82, v83
  v_mfma_f32_16x16x32_bf16 a[196:199], a[208:211], v[52:55], a[196:199]
  v_exp_f32 v84, v84
  v_mfma_f32_16x16x32_bf16 v[136:139], a[8:11], v[48:51], v[136:139]
  ds_read_b128 a[52:55], v3 offset:5120
  v_mfma_f32_16x16x32_bf16 v[168:171], a[8:11], v[52:55], v[168:171]
  v_exp_f32 v85, v85
  v_mfma_f32_16x16x32_bf16 v[200:203], a[8:11], v[56:59], v[200:203]
  v_cvt_pk_bf16_f32 v42, v84, v85
  v_mfma_f32_16x16x32_bf16 v[232:235], a[8:11], v[60:63], v[232:235]
  v_exp_f32 v86, v86
  v_mfma_f32_16x16x32_bf16 a[200:203], a[208:211], v[56:59], a[200:203]
  v_mfma_f32_16x16x32_bf16 v[140:143], a[12:15], v[48:51], v[140:143]
  v_exp_f32 v87, v87
  v_mfma_f32_16x16x32_bf16 v[172:175], a[12:15], v[52:55], v[172:175]
  buffer_load_dwordx4 v2, s[20:23], s29 offen offset:2048 sc1 lds
  ds_read_b128 a[56:59], v3 offset:6144
  v_mfma_f32_16x16x32_bf16 v[204:207], a[12:15], v[56:59], v[204:207]
  v_exp_f32 v88, v88
  v_mfma_f32_16x16x32_bf16 v[236:239], a[12:15], v[60:63], v[236:239]
  v_cvt_pk_bf16_f32 v43, v86, v87
  v_mfma_f32_16x16x32_bf16 a[204:207], a[208:211], v[60:63], a[204:207]
  s_waitcnt lgkmcnt(7)
  v_exp_f32 v89, v89
  v_mfma_f32_16x16x32_bf16 v[144:147], a[16:19], v[48:51], v[144:147]
  ds_read_b128 a[60:63], v3 offset:7168
  v_cvt_pk_bf16_f32 v44, v88, v89
  v_mfma_f32_16x16x32_bf16 v[176:179], a[16:19], v[52:55], v[176:179]
  v_exp_f32 v90, v90
  v_mfma_f32_16x16x32_bf16 v[208:211], a[16:19], v[56:59], v[208:211]
  v_mfma_f32_16x16x32_bf16 v[240:243], a[16:19], v[60:63], v[240:243]
  v_exp_f32 v91, v91
  v_mfma_f32_16x16x32_bf16 v[148:151], a[20:23], v[48:51], v[148:151]
  buffer_load_dwordx4 v2, s[20:23], s29 offen offset:3072 sc1 lds
  v_xor_b32 v4, s31, v4
  v_mfma_f32_16x16x32_bf16 v[180:183], a[20:23], v[52:55], v[180:183]
  s_xor_b32 s27, s27, s30
  v_exp_f32 v92, v92
  v_mfma_f32_16x16x32_bf16 v[212:215], a[20:23], v[56:59], v[212:215]
  s_add_u32 s29, s29, 0x8000
  ds_read_b128 a[0:3], v4 offset:0
  v_cvt_pk_bf16_f32 v45, v90, v91
  v_mfma_f32_16x16x32_bf16 v[244:247], a[20:23], v[60:63], v[244:247]
  v_exp_f32 v93, v93
  v_mfma_f32_16x16x32_bf16 v[152:155], a[24:27], v[48:51], v[152:155]
  ds_read_b128 a[4:7], v4 offset:1024
  v_cvt_pk_bf16_f32 v46, v92, v93
  v_mfma_f32_16x16x32_bf16 v[184:187], a[24:27], v[52:55], v[184:187]
  v_exp_f32 v94, v94
  v_mfma_f32_16x16x32_bf16 v[216:219], a[24:27], v[56:59], v[216:219]
  v_mfma_f32_16x16x32_bf16 v[248:251], a[24:27], v[60:63], v[248:251]
  v_exp_f32 v95, v95
  v_mfma_f32_16x16x32_bf16 v[156:159], a[28:31], v[48:51], v[156:159]
  ds_read_b128 a[8:11], v4 offset:2048
  v_cvt_pk_bf16_f32 v47, v94, v95
  v_mfma_f32_16x16x32_bf16 v[188:191], a[28:31], v[52:55], v[188:191]
  v_mfma_f32_16x16x32_bf16 v[220:223], a[28:31], v[56:59], v[220:223]
  v_mfma_f32_16x16x32_bf16 v[252:255], a[28:31], v[60:63], v[252:255]
  s_xor_b32 s30, s30, 0xc000
  s_xor_b32 s31, s31, 0xc000
  s_branch La_lo
La_d0:
  s_waitcnt lgkmcnt(7)
  v_mfma_f32_16x16x32_bf16 v[96:99], a[32:35], a[128:131], v[16:19]
  s_mov_b32 m0, s26
  ds_read_b128 a[12:15], v4 offset:11264
  v_cndmask_b32 v64, v64, v5, s[32:33]
  v_mfma_f32_16x16x32_bf16 v[96:99], a[36:39], a[132:135], v[96:99]
  v_exp_f32 v64, v64
  v_mfma_f32_16x16x32_bf16 v[96:99], a[40:43], a[136:139], v[96:99]
  v_cndmask_b32 v65, v65, v5, s[34:35]
  v_exp_f32 v65, v65
  v_mfma_f32_16x16x32_bf16 v[96:99], a[44:47], a[140:143], v[96:99]
  buffer_load_dwordx4 v2, s[20:23], s28 offen offset:0 sc1 lds
  v_cndmask_b32 v66, v66, v5, s[36:37]
  v_mfma_f32_16x16x32_bf16 v[104:107], a[32:35], a[144:147], v[20:23]
  v_exp_f32 v66, v66
  v_mfma_f32_16x16x32_bf16 v[104:107], a[36:39], a[148:151], v[104:107]
  ds_read_b128 a[16:19], v4 offset:12288
  v_cndmask_b32 v67, v67, v5, s[38:39]
  v_mfma_f32_16x16x32_bf16 v[104:107], a[40:43], a[152:155], v[104:107]
  v_exp_f32 v67, v67
  v_mfma_f32_16x16x32_bf16 v[104:107], a[44:47], a[156:159], v[104:107]
  v_cndmask_b32 v68, v68, v5, s[40:41]
  v_cndmask_b32 v69, v69, v5, s[42:43]
  v_mfma_f32_16x16x32_bf16 v[112:115], a[32:35], a[160:163], v[24:27]
  v_exp_f32 v68, v68
  v_mfma_f32_16x16x32_bf16 v[112:115], a[36:39], a[164:167], v[112:115]
  buffer_load_dwordx4 v2, s[20:23], s28 offen offset:1024 sc1 lds
  ds_read_b128 a[20:23], v4 offset:13312
  v_mfma_f32_16x16x32_bf16 v[112:115], a[40:43], a[168:171], v[112:115]
  v_exp_f32 v69, v69
  v_mfma_f32_16x16x32_bf16 v[112:115], a[44:47], a[172:175], v[112:115]
  v_cndmask_b32 v70, v70, v5, s[44:45]
  v_cvt_pk_bf16_f32 v32, v64, v65
  v_mfma_f32_16x16x32_bf16 v[120:123], a[32:35], a[176:179], v[28:31]
  v_exp_f32 v70, v70
  v_mfma_f32_16x16x32_bf16 v[120:123], a[36:39], a[180:183], v[120:123]
  ds_read_b128 a[24:27], v4 offset:14336
  v_cndmask_b32 v71, v71, v5, s[46:47]
  v_mfma_f32_16x16x32_bf16 v[120:123], a[40:43], a[184:187], v[120:123]
  v_exp_f32 v71, v71
  v_mfma_f32_16x16x32_bf16 v[120:123], a[44:47], a[188:191], v[120:123]
  s_waitcnt lgkmcnt(7)
  v_cvt_pk_bf16_f32 v33, v66, v67
  v_cvt_pk_bf16_f32 v34, v68, v69
  v_mfma_f32_16x16x32_bf16 v[100:103], a[48:51], a[128:131], v[16:19]
  v_exp_f32 v72, v72
  v_mfma_f32_16x16x32_bf16 v[100:103], a[52:55], a[132:135], v[100:103]
  buffer_load_dwordx4 v2, s[20:23], s28 offen offset:2048 sc1 lds
  ds_read_b128 a[28:31], v4 offset:15360
  v_mfma_f32_16x16x32_bf16 v[100:103], a[56:59], a[136:139], v[100:103]
  v_exp_f32 v73, v73
  v_mfma_f32_16x16x32_bf16 v[100:103], a[60:63], a[140:143], v[100:103]
  v_xor_b32 v3, 0x4000, v3
  v_cvt_pk_bf16_f32 v35, v70, v71
  v_mfma_f32_16x16x32_bf16 v[108:111], a[48:51], a[144:147], v[20:23]
  v_exp_f32 v74, v74
  v_mfma_f32_16x16x32_bf16 v[108:111], a[52:55], a[148:151], v[108:111]
  ds_read_b128 a[32:35], v3 offset:0
  v_cvt_pk_bf16_f32 v36, v72, v73
  v_mfma_f32_16x16x32_bf16 v[108:111], a[56:59], a[152:155], v[108:111]
  v_exp_f32 v75, v75
  v_mfma_f32_16x16x32_bf16 v[108:111], a[60:63], a[156:159], v[108:111]
  v_cvt_pk_bf16_f32 v37, v74, v75
  v_mfma_f32_16x16x32_bf16 v[116:119], a[48:51], a[160:163], v[24:27]
  v_exp_f32 v76, v76
  v_mfma_f32_16x16x32_bf16 v[116:119], a[52:55], a[164:167], v[116:119]
  buffer_load_dwordx4 v2, s[20:23], s28 offen offset:3072 sc1 lds
  ds_read_b128 a[36:39], v3 offset:1024
  v_mfma_f32_16x16x32_bf16 v[116:119], a[56:59], a[168:171], v[116:119]
  s_xor_b32 s26, s26, 0x8000
  v_exp_f32 v77, v77
  v_mfma_f32_16x16x32_bf16 v[116:119], a[60:63], a[172:175], v[116:119]
  s_add_u32 s28, s28, 0x8000
  s_mov_b32 m0, s27
  v_cvt_pk_bf16_f32 v38, v76, v77
  v_mfma_f32_16x16x32_bf16 v[124:127], a[48:51], a[176:179], v[28:31]
  v_exp_f32 v78, v78
  v_mfma_f32_16x16x32_bf16 v[124:127], a[52:55], a[180:183], v[124:127]
  ds_read_b128 a[40:43], v3 offset:2048
  v_mfma_f32_16x16x32_bf16 v[124:127], a[56:59], a[184:187], v[124:127]
  v_exp_f32 v79, v79
  v_mfma_f32_16x16x32_bf16 v[124:127], a[60:63], a[188:191], v[124:127]
  s_waitcnt lgkmcnt(7)
  v_cvt_pk_bf16_f32 v39, v78, v79
  v_mfma_f32_16x16x32_bf16 v[128:131], a[0:3], v[48:51], v[128:131]
  buffer_load_dwordx4 v2, s[20:23], s29 offen offset:0 sc1 lds
  ds_read_b128 a[44:47], v3 offset:3072
  v_mfma_f32_16x16x32_bf16 v[160:163], a[0:3], v[52:55], v[160:163]
  v_exp_f32 v80, v80
  v_mfma_f32_16x16x32_bf16 v[192:195], a[0:3], v[56:59], v[192:195]
  v_mfma_f32_16x16x32_bf16 v[224:227], a[0:3], v[60:63], v[224:227]
  v_exp_f32 v81, v81
  v_mfma_f32_16x16x32_bf16 a[192:195], a[208:211], v[48:51], a[192:195]
  v_cvt_pk_bf16_f32 v40, v80, v81
  v_mfma_f32_16x16x32_bf16 v[132:135], a[4:7], v[48:51], v[132:135]
  v_exp_f32 v82, v82
  v_mfma_f32_16x16x32_bf16 v[164:167], a[4:7], v[52:55], v[164:167]
  ds_read_b128 a[48:51], v3 offset:4096
  v_mfma_f32_16x16x32_bf16 v[196:199], a[4:7], v[56:59], v[196:199]
  v_exp_f32 v83, v83
  v_mfma_f32_16x16x32_bf16 v[228:231], a[4:7], v[60:63], v[228:231]
  buffer_load_dwordx4 v2, s[20:23], s29 offen offset:1024 sc1 lds
  v_cvt_pk_bf16_f32 v41, v82, v83
  v_mfma_f32_16x16x32_bf16 a[196:199], a[208:211], v[52:55], a[196:199]
  v_exp_f32 v84, v84
  v_mfma_f32_16x16x32_bf16 v[136:139], a[8:11], v[48:51], v[136:139]
  ds_read_b128 a[52:55], v3 offset:5120
  v_mfma_f32_16x16x32_bf16 v[168:171], a[8:11], v[52:55], v[168:171]
  v_exp_f32 v85, v85
  v_mfma_f32_16x16x32_bf16 v[200:203], a[8:11], v[56:59], v[200:203]
  v_cvt_pk_bf16_f32 v42, v84, v85
  v_mfma_f32_16x16x32_bf16 v[232:235], a[8:11], v[60:63], v[232:235]
  v_exp_f32 v86, v86
  v_mfma_f32_16x16x32_bf16 a[200:203], a[208:211], v[56:59], a[200:203]
  v_mfma_f32_16x16x32_bf16 v[140:143], a[12:15], v[48:51], v[140:143]
  v_exp_f32 v87, v87
  v_mfma_f32_16x16x32_bf16 v[172:175], a[12:15], v[52:55], v[172:175]
  buffer_load_dwordx4 v2, s[20:23], s29 offen offset:2048 sc1 lds
  ds_read_b128 a[56:59], v3 offset:6144
  v_mfma_f32_16x16x32_bf16 v[204:207], a[12:15], v[56:59], v[204:207]
  v_exp_f32 v88, v88
  v_mfma_f32_16x16x32_bf16 v[236:239], a[12:15], v[60:63], v[236:239]
  v_cvt_pk_bf16_f32 v43, v86, v87
  v_mfma_f32_16x16x32_bf16 a[204:207], a[208:211], v[60:63], a[204:207]
  s_waitcnt lgkmcnt(7)
  v_exp_f32 v89, v89
  v_mfma_f32_16x16x32_bf16 v[144:147], a[16:19], v[48:51], v[144:147]
  ds_read_b128 a[60:63], v3 offset:7168
  v_cvt_pk_bf16_f32 v44, v88, v89
  v_mfma_f32_16x16x32_bf16 v[176:179], a[16:19], v[52:55], v[176:179]
  v_exp_f32 v90, v90
  v_mfma_f32_16x16x32_bf16 v[208:211], a[16:19], v[56:59], v[208:211]
  v_mfma_f32_16x16x32_bf16 v[240:243], a[16:19], v[60:63], v[240:243]
  v_exp_f32 v91, v91
  v_mfma_f32_16x16x32_bf16 v[148:151], a[20:23], v[48:51], v[148:151]
  buffer_load_dwordx4 v2, s[20:23], s29 offen offset:3072 sc1 lds
  v_xor_b32 v4, 0x8000, v4
  v_mfma_f32_16x16x32_bf16 v[180:183], a[20:23], v[52:55], v[180:183]
  s_xor_b32 s27, s27, 0x4000
  v_exp_f32 v92, v92
  v_mfma_f32_16x16x32_bf16 v[212:215], a[20:23], v[56:59], v[212:215]
  s_add_u32 s29, s29, 0x8000
  ds_read_b128 a[0:3], v4 offset:0
  v_cvt_pk_bf16_f32 v45, v90, v91
  v_mfma_f32_16x16x32_bf16 v[244:247], a[20:23], v[60:63], v[244:247]
  v_exp_f32 v93, v93
  v_mfma_f32_16x16x32_bf16 v[152:155], a[24:27], v[48:51], v[152:155]
  ds_read_b128 a[4:7], v4 offset:1024
  v_cvt_pk_bf16_f32 v46, v92, v93
  v_mfma_f32_16x16x32_bf16 v[184:187], a[24:27], v[52:55], v[184:187]
  v_exp_f32 v94, v94
  v_mfma_f32_16x16x32_bf16 v[216:219], a[24:27], v[56:59], v[216:219]
  v_mfma_f32_16x16x32_bf16 v[248:251], a[24:27], v[60:63], v[248:251]
  v_exp_f32 v95, v95
  v_mfma_f32_16x16x32_bf16 v[156:159], a[28:31], v[48:51], v[156:159]
  ds_read_b128 a[8:11], v4 offset:2048
  v_cvt_pk_bf16_f32 v47, v94, v95
  v_mfma_f32_16x16x32_bf16 v[188:191], a[28:31], v[52:55], v[188:191]
  v_mfma_f32_16x16x32_bf16 v[220:223], a[28:31], v[56:59], v[220:223]
  v_mfma_f32_16x16x32_bf16 v[252:255], a[28:31], v[60:63], v[252:255]
La_d1:
  s_waitcnt lgkmcnt(7)
  v_mfma_f32_16x16x32_bf16 v[72:75], a[32:35], a[144:147], v[20:23]
  buffer_load_dwordx4 a[64:67], v2, s[8:11], s6 offen offset:0
  ds_read_b128 a[12:15], v4 offset:3072
  v_mfma_f32_16x16x32_bf16 v[72:75], a[36:39], a[148:151], v[72:75]
  v_cndmask_b32 v96, v96, v5, s[48:49]
  v_exp_f32 v96, v96
  v_mfma_f32_16x16x32_bf16 v[72:75], a[40:43], a[152:155], v[72:75]
  v_cndmask_b32 v97, v97, v5, s[50:51]
  v_exp_f32 v97, v97
  v_mfma_f32_16x16x32_bf16 v[72:75], a[44:47], a[156:159], v[72:75]
  v_cndmask_b32 v98, v98, v5, s[52:53]
  v_exp_f32 v98, v98
  v_mfma_f32_16x16x32_bf16 v[80:83], a[32:35], a[160:163], v[24:27]
  ds_read_b128 a[16:19], v4 offset:4096
  v_cndmask_b32 v99, v99, v5, s[54:55]
  v_mfma_f32_16x16x32_bf16 v[80:83], a[36:39], a[164:167], v[80:83]
  v_exp_f32 v99, v99
  v_mfma_f32_16x16x32_bf16 v[80:83], a[40:43], a[168:171], v[80:83]
  buffer_load_dwordx4 a[64:67], v2, s[8:11], s6 offen offset:1024
  ds_read_b128 a[20:23], v4 offset:5120
  v_mfma_f32_16x16x32_bf16 v[80:83], a[44:47], a[172:175], v[80:83]
  v_cndmask_b32 v100, v100, v5, s[56:57]
  v_exp_f32 v100, v100
  v_mfma_f32_16x16x32_bf16 v[88:91], a[32:35], a[176:179], v[28:31]
  v_cndmask_b32 v101, v101, v5, s[58:59]
  v_cndmask_b32 v102, v102, v5, s[60:61]
  v_mfma_f32_16x16x32_bf16 v[88:91], a[36:39], a[180:183], v[88:91]
  v_exp_f32 v101, v101
  v_mfma_f32_16x16x32_bf16 v[88:91], a[40:43], a[184:187], v[88:91]
  v_exp_f32 v102, v102
  v_mfma_f32_16x16x32_bf16 v[88:91], a[44:47], a[188:191], v[88:91]
  s_waitcnt lgkmcnt(6)
  buffer_load_dwordx4 a[64:67], v2, s[8:11], s6 offen offset:2048
  ds_read_b128 a[24:27], v4 offset:6144
  v_mfma_f32_16x16x32_bf16 v[76:79], a[48:51], a[144:147], v[20:23]
  v_cndmask_b32 v103, v103, v5, s[62:63]
  v_exp_f32 v103, v103
  v_mfma_f32_16x16x32_bf16 v[76:79], a[52:55], a[148:151], v[76:79]
  ds_read_b128 a[28:31], v4 offset:7168
  v_cvt_pk_bf16_f32 v48, v96, v97
  v_mfma_f32_16x16x32_bf16 v[76:79], a[56:59], a[152:155], v[76:79]
  v_exp_f32 v104, v104
  v_mfma_f32_16x16x32_bf16 v[76:79], a[60:63], a[156:159], v[76:79]
  ds_read_b128 a[32:35], v3 offset:8192
  v_cvt_pk_bf16_f32 v49, v98, v99
  v_mfma_f32_16x16x32_bf16 v[84:87], a[48:51], a[160:163], v[24:27]
  v_exp_f32 v105, v105
  v_mfma_f32_16x16x32_bf16 v[84:87], a[52:55], a[164:167], v[84:87]
  buffer_load_dwordx4 a[64:67], v2, s[8:11], s6 offen offset:3072
  v_cvt_pk_bf16_f32 v50, v100, v101
  v_mfma_f32_16x16x32_bf16 v[84:87], a[56:59], a[168:171], v[84:87]
  s_add_u32 s6, s6, 4096
  v_exp_f32 v106, v106
  v_mfma_f32_16x16x32_bf16 v[84:87], a[60:63], a[172:175], v[84:87]
  v_exp_f32 v107, v107
  v_mfma_f32_16x16x32_bf16 v[92:95], a[48:51], a[176:179], v[28:31]
  ds_read_b128 a[36:39], v3 offset:9216
  v_cvt_pk_bf16_f32 v51, v102, v103
  v_mfma_f32_16x16x32_bf16 v[92:95], a[52:55], a[180:183], v[92:95]
  v_exp_f32 v108, v108
  v_mfma_f32_16x16x32_bf16 v[92:95], a[56:59], a[184:187], v[92:95]
  buffer_load_dwordx4 a[64:67], v2, s[8:11], s6 offen offset:0
  ds_read_b128 a[40:43], v3 offset:10240
  v_mfma_f32_16x16x32_bf16 v[92:95], a[60:63], a[188:191], v[92:95]
  s_waitcnt lgkmcnt(7)
  v_exp_f32 v109, v109
  v_mfma_f32_16x16x32_bf16 v[128:131], a[0:3], v[32:35], v[128:131]
  ds_read_b128 a[44:47], v3 offset:11264
  v_cvt_pk_bf16_f32 v52, v104, v105
  v_mfma_f32_16x16x32_bf16 v[160:163], a[0:3], v[36:39], v[160:163]
  v_exp_f32 v110, v110
  v_mfma_f32_16x16x32_bf16 v[192:195], a[0:3], v[40:43], v[192:195]
  v_cvt_pk_bf16_f32 v53, v106, v107
  v_cvt_pk_bf16_f32 v54, v108, v109
  v_mfma_f32_16x16x32_bf16 v[224:227], a[0:3], v[44:47], v[224:227]
  v_exp_f32 v111, v111
  v_mfma_f32_16x16x32_bf16 a[192:195], a[208:211], v[32:35], a[192:195]
  buffer_load_dwordx4 a[64:67], v2, s[8:11], s6 offen offset:1024
  v_cvt_pk_bf16_f32 v55, v110, v111
  v_mfma_f32_16x16x32_bf16 v[132:135], a[4:7], v[32:35], v[132:135]
  v_exp_f32 v112, v112
  v_mfma_f32_16x16x32_bf16 v[164:167], a[4:7], v[36:39], v[164:167]
  v_exp_f32 v113, v113
  v_mfma_f32_16x16x32_bf16 v[196:199], a[4:7], v[40:43], v[196:199]
  ds_read_b128 a[48:51], v3 offset:12288
  v_cvt_pk_bf16_f32 v56, v112, v113
  v_mfma_f32_16x16x32_bf16 v[228:231], a[4:7], v[44:47], v[228:231]
  v_exp_f32 v114, v114
  v_mfma_f32_16x16x32_bf16 a[196:199], a[208:211], v[36:39], a[196:199]
  buffer_load_dwordx4 a[64:67], v2, s[8:11], s6 offen offset:2048
  v_mfma_f32_16x16x32_bf16 v[136:139], a[8:11], v[32:35], v[136:139]
  v_exp_f32 v115, v115
  v_mfma_f32_16x16x32_bf16 v[168:171], a[8:11], v[36:39], v[168:171]
  ds_read_b128 a[52:55], v3 offset:13312
  v_cvt_pk_bf16_f32 v57, v114, v115
  v_mfma_f32_16x16x32_bf16 v[200:203], a[8:11], v[40:43], v[200:203]
  v_exp_f32 v116, v116
  v_mfma_f32_16x16x32_bf16 v[232:235], a[8:11], v[44:47], v[232:235]
  v_mfma_f32_16x16x32_bf16 a[200:203], a[208:211], v[40:43], a[200:203]
  v_exp_f32 v117, v117
  v_mfma_f32_16x16x32_bf16 v[140:143], a[12:15], v[32:35], v[140:143]
  v_exp_f32 v118, v118
  v_mfma_f32_16x16x32_bf16 v[172:175], a[12:15], v[36:39], v[172:175]
  buffer_load_dwordx4 a[64:67], v2, s[8:11], s6 offen offset:3072
  ds_read_b128 a[56:59], v3 offset:14336
  v_mfma_f32_16x16x32_bf16 v[204:207], a[12:15], v[40:43], v[204:207]
  v_exp_f32 v119, v119
  v_mfma_f32_16x16x32_bf16 v[236:239], a[12:15], v[44:47], v[236:239]
  v_cvt_pk_bf16_f32 v58, v116, v117
  v_cvt_pk_bf16_f32 v59, v118, v119
  v_mfma_f32_16x16x32_bf16 a[204:207], a[208:211], v[44:47], a[204:207]
  s_waitcnt lgkmcnt(7)
  v_exp_f32 v120, v120
  v_mfma_f32_16x16x32_bf16 v[144:147], a[16:19], v[32:35], v[144:147]
  buffer_load_dwordx4 a[64:67], v2, s[12:15], s7 offen offset:0
  ds_read_b128 a[60:63], v3 offset:15360
  v_mfma_f32_16x16x32_bf16 v[176:179], a[16:19], v[36:39], v[176:179]
  v_exp_f32 v121, v121
  v_mfma_f32_16x16x32_bf16 v[208:211], a[16:19], v[40:43], v[208:211]
  v_cvt_pk_bf16_f32 v60, v120, v121
  v_mfma_f32_16x16x32_bf16 v[240:243], a[16:19], v[44:47], v[240:243]
  v_exp_f32 v122, v122
  v_mfma_f32_16x16x32_bf16 v[148:151], a[20:23], v[32:35], v[148:151]
  v_exp_f32 v123, v123
  v_mfma_f32_16x16x32_bf16 v[180:183], a[20:23], v[36:39], v[180:183]
  ds_read_b128 a[0:3], v4 offset:8192
  v_cvt_pk_bf16_f32 v61, v122, v123
  v_mfma_f32_16x16x32_bf16 v[212:215], a[20:23], v[40:43], v[212:215]
  v_exp_f32 v124, v124
  v_mfma_f32_16x16x32_bf16 v[244:247], a[20:23], v[44:47], v[244:247]
  buffer_load_dwordx4 a[64:67], v2, s[12:15], s7 offen offset:1024
  v_mfma_f32_16x16x32_bf16 v[152:155], a[24:27], v[32:35], v[152:155]
  v_exp_f32 v125, v125
  v_mfma_f32_16x16x32_bf16 v[184:187], a[24:27], v[36:39], v[184:187]
  ds_read_b128 a[4:7], v4 offset:9216
  v_cvt_pk_bf16_f32 v62, v124, v125
  v_mfma_f32_16x16x32_bf16 v[216:219], a[24:27], v[40:43], v[216:219]
  v_exp_f32 v126, v126
  v_mfma_f32_16x16x32_bf16 v[248:251], a[24:27], v[44:47], v[248:251]
  v_mfma_f32_16x16x32_bf16 v[156:159], a[28:31], v[32:35], v[156:159]
  v_exp_f32 v127, v127
  v_mfma_f32_16x16x32_bf16 v[188:191], a[28:31], v[36:39], v[188:191]
  ds_read_b128 a[8:11], v4 offset:10240
  v_cvt_pk_bf16_f32 v63, v126, v127
  v_mfma_f32_16x16x32_bf16 v[220:223], a[28:31], v[40:43], v[220:223]
  s_waitcnt vmcnt(22)
  s_barrier
  v_mfma_f32_16x16x32_bf16 v[252:255], a[28:31], v[44:47], v[252:255]
  s_waitcnt lgkmcnt(7)
  v_mfma_f32_16x16x32_bf16 v[104:107], a[32:35], a[144:147], v[20:23]
  s_mov_b32 m0, s26
  ds_read_b128 a[12:15], v4 offset:11264
  v_cndmask_b32 v72, v72, v5, s[32:33]
  v_mfma_f32_16x16x32_bf16 v[104:107], a[36:39], a[148:151], v[104:107]
  v_exp_f32 v72, v72
  v_mfma_f32_16x16x32_bf16 v[104:107], a[40:43], a[152:155], v[104:107]
  v_cndmask_b32 v73, v73, v5, s[34:35]
  v_exp_f32 v73, v73
  v_mfma_f32_16x16x32_bf16 v[104:107], a[44:47], a[156:159], v[104:107]
  buffer_load_dwordx4 v2, s[20:23], s28 offen offset:0 sc1 lds
  ds_read_b128 a[16:19], v4 offset:12288
  v_mfma_f32_16x16x32_bf16 v[112:115], a[32:35], a[160:163], v[24:27]
  v_cndmask_b32 v74, v74, v5, s[36:37]
  v_exp_f32 v74, v74
  v_mfma_f32_16x16x32_bf16 v[112:115], a[36:39], a[164:167], v[112:115]
  v_cvt_pk_bf16_f32 v36, v72, v73
  v_mfma_f32_16x16x32_bf16 v[112:115], a[40:43], a[168:171], v[112:115]
  ds_read_b128 a[20:23], v4 offset:13312
  v_cndmask_b32 v75, v75, v5, s[38:39]
  v_mfma_f32_16x16x32_bf16 v[112:115], a[44:47], a[172:175], v[112:115]
  v_exp_f32 v75, v75
  v_mfma_f32_16x16x32_bf16 v[120:123], a[32:35], a[176:179], v[28:31]
  buffer_load_dwordx4 v2, s[20:23], s28 offen offset:1024 sc1 lds
  v_cndmask_b32 v76, v76, v5, s[40:41]
  v_mfma_f32_16x16x32_bf16 v[120:123], a[36:39], a[180:183], v[120:123]
  v_exp_f32 v76, v76
  v_mfma_f32_16x16x32_bf16 v[120:123], a[40:43], a[184:187], v[120:123]
  ds_read_b128 a[24:27], v4 offset:14336
  v_cndmask_b32 v79, v79, v5, s[46:47]
  v_mfma_f32_16x16x32_bf16 v[120:123], a[44:47], a[188:191], v[120:123]
  s_waitcnt lgkmcnt(7)
  v_cndmask_b32 v77, v77, v5, s[42:43]
  v_cndmask_b32 v78, v78, v5, s[44:45]
  v_mfma_f32_16x16x32_bf16 v[108:111], a[48:51], a[144:147], v[20:23]
  v_exp_f32 v77, v77
  v_mfma_f32_16x16x32_bf16 v[108:111], a[52:55], a[148:151], v[108:111]
  ds_read_b128 a[28:31], v4 offset:15360
  v_xor_b32 v4, 0x4000, v4
  v_mfma_f32_16x16x32_bf16 v[108:111], a[56:59], a[152:155], v[108:111]
  v_exp_f32 v78, v78
  v_mfma_f32_16x16x32_bf16 v[108:111], a[60:63], a[156:159], v[108:111]
  buffer_load_dwordx4 v2, s[20:23], s28 offen offset:2048 sc1 lds
  v_xor_b32 v3, 0x8000, v3
  v_mfma_f32_16x16x32_bf16 v[116:119], a[48:51], a[160:163], v[24:27]
  v_exp_f32 v79, v79
  v_mfma_f32_16x16x32_bf16 v[116:119], a[52:55], a[164:167], v[116:119]
  ds_read_b128 a[32:35], v3 offset:0
  v_cvt_pk_bf16_f32 v37, v74, v75
  v_mfma_f32_16x16x32_bf16 v[116:119], a[56:59], a[168:171], v[116:119]
  ds_read_b128 a[36:39], v3 offset:1024
  v_cvt_pk_bf16_f32 v38, v76, v77
  v_mfma_f32_16x16x32_bf16 v[116:119], a[60:63], a[172:175], v[116:119]
  v_exp_f32 v80, v80
  v_mfma_f32_16x16x32_bf16 v[124:127], a[48:51], a[176:179], v[28:31]
  v_cvt_pk_bf16_f32 v39, v78, v79
  v_mfma_f32_16x16x32_bf16 v[124:127], a[52:55], a[180:183], v[124:127]
  v_exp_f32 v81, v81
  v_mfma_f32_16x16x32_bf16 v[124:127], a[56:59], a[184:187], v[124:127]
  buffer_load_dwordx4 v2, s[20:23], s28 offen offset:3072 sc1 lds
  ds_read_b128 a[40:43], v3 offset:2048
  v_mfma_f32_16x16x32_bf16 v[124:127], a[60:63], a[188:191], v[124:127]
  s_waitcnt lgkmcnt(7)
  s_xor_b32 s26, s26, 0x4000
  s_add_u32 s28, s28, 0x8000
  v_mfma_f32_16x16x32_bf16 v[128:131], a[0:3], v[48:51], v[128:131]
  s_mov_b32 m0, s27
  v_exp_f32 v82, v82
  v_mfma_f32_16x16x32_bf16 v[160:163], a[0:3], v[52:55], v[160:163]
  ds_read_b128 a[44:47], v3 offset:3072
  v_cvt_pk_bf16_f32 v40, v80, v81
  v_mfma_f32_16x16x32_bf16 v[192:195], a[0:3], v[56:59], v[192:195]
  v_exp_f32 v83, v83
  v_mfma_f32_16x16x32_bf16 v[224:227], a[0:3], v[60:63], v[224:227]
  v_cvt_pk_bf16_f32 v41, v82, v83
  v_mfma_f32_16x16x32_bf16 a[192:195], a[208:211], v[48:51], a[192:195]
  buffer_load_dwordx4 v2, s[20:23], s29 offen offset:0 sc1 lds
  v_mfma_f32_16x16x32_bf16 v[132:135], a[4:7], v[48:51], v[132:135]
  v_exp_f32 v84, v84
  v_mfma_f32_16x16x32_bf16 v[164:167], a[4:7], v[52:55], v[164:167]
  ds_read_b128 a[48:51], v3 offset:4096
  v_mfma_f32_16x16x32_bf16 v[196:199], a[4:7], v[56:59], v[196:199]
  v_exp_f32 v85, v85
  v_mfma_f32_16x16x32_bf16 v[228:231], a[4:7], v[60:63], v[228:231]
  v_cvt_pk_bf16_f32 v42, v84, v85
  v_mfma_f32_16x16x32_bf16 a[196:199], a[208:211], v[52:55], a[196:199]
  v_exp_f32 v86, v86
  v_mfma_f32_16x16x32_bf16 v[136:139], a[8:11], v[48:51], v[136:139]
  ds_read_b128 a[52:55], v3 offset:5120
  v_mfma_f32_16x16x32_bf16 v[168:171], a[8:11], v[52:55], v[168:171]
  buffer_load_dwordx4 v2, s[20:23], s29 offen offset:1024 sc1 lds
  v_mfma_f32_16x16x32_bf16 v[200:203], a[8:11], v[56:59], v[200:203]
  v_exp_f32 v87, v87
  v_mfma_f32_16x16x32_bf16 v[232:235], a[8:11], v[60:63], v[232:235]
  v_cvt_pk_bf16_f32 v43, v86, v87
  v_mfma_f32_16x16x32_bf16 a[200:203], a[208:211], v[56:59], a[200:203]
  v_exp_f32 v88, v88
  v_mfma_f32_16x16x32_bf16 v[140:143], a[12:15], v[48:51], v[140:143]
  ds_read_b128 a[56:59], v3 offset:6144
  v_mfma_f32_16x16x32_bf16 v[172:175], a[12:15], v[52:55], v[172:175]
  v_mfma_f32_16x16x32_bf16 v[204:207], a[12:15], v[56:59], v[204:207]
  v_exp_f32 v89, v89
  v_mfma_f32_16x16x32_bf16 v[236:239], a[12:15], v[60:63], v[236:239]
  buffer_load_dwordx4 v2, s[20:23], s29 offen offset:2048 sc1 lds
  v_cvt_pk_bf16_f32 v44, v88, v89
  v_mfma_f32_16x16x32_bf16 a[204:207], a[208:211], v[60:63], a[204:207]
  s_waitcnt lgkmcnt(7)
  v_exp_f32 v90, v90
  v_mfma_f32_16x16x32_bf16 v[144:147], a[16:19], v[48:51], v[144:147]
  ds_read_b128 a[60:63], v3 offset:7168
  v_mfma_f32_16x16x32_bf16 v[176:179], a[16:19], v[52:55], v[176:179]
  v_exp_f32 v91, v91
  v_mfma_f32_16x16x32_bf16 v[208:211], a[16:19], v[56:59], v[208:211]
  v_cvt_pk_bf16_f32 v45, v90, v91
  v_mfma_f32_16x16x32_bf16 v[240:243], a[16:19], v[60:63], v[240:243]
  v_mfma_f32_16x16x32_bf16 v[148:151], a[20:23], v[48:51], v[148:151]
  v_exp_f32 v92, v92
  v_mfma_f32_16x16x32_bf16 v[180:183], a[20:23], v[52:55], v[180:183]
  buffer_load_dwordx4 v2, s[20:23], s29 offen offset:3072 sc1 lds
  ds_read_b128 a[0:3], v3 offset:8192
  v_mfma_f32_16x16x32_bf16 v[212:215], a[20:23], v[56:59], v[212:215]
  s_xor_b32 s27, s27, 0x8000
  v_exp_f32 v93, v93
  v_mfma_f32_16x16x32_bf16 v[244:247], a[20:23], v[60:63], v[244:247]
  s_add_u32 s29, s29, 0x8000
  v_cvt_pk_bf16_f32 v46, v92, v93
  v_mfma_f32_16x16x32_bf16 v[152:155], a[24:27], v[48:51], v[152:155]
  ds_read_b128 a[4:7], v3 offset:9216
  v_mfma_f32_16x16x32_bf16 v[184:187], a[24:27], v[52:55], v[184:187]
  v_exp_f32 v94, v94
  v_mfma_f32_16x16x32_bf16 v[216:219], a[24:27], v[56:59], v[216:219]
  v_mfma_f32_16x16x32_bf16 v[248:251], a[24:27], v[60:63], v[248:251]
  v_exp_f32 v95, v95
  v_mfma_f32_16x16x32_bf16 v[156:159], a[28:31], v[48:51], v[156:159]
  ds_read_b128 a[8:11], v3 offset:10240
  v_cvt_pk_bf16_f32 v47, v94, v95
  v_mfma_f32_16x16x32_bf16 v[188:191], a[28:31], v[52:55], v[188:191]
  v_mfma_f32_16x16x32_bf16 v[220:223], a[28:31], v[56:59], v[220:223]
  s_waitcnt vmcnt(22)
  s_barrier
  v_mfma_f32_16x16x32_bf16 v[252:255], a[28:31], v[60:63], v[252:255]
  s_lshr_b32 s91, s73, 1
  s_lshl_b32 s91, s91, 11
  s_add_u32 s91, s91, 32768
  v_and_b32 v14, 15, v1
  v_lshlrev_b32 v14, 7, v14
  s_waitcnt lgkmcnt(3)
  v_mfma_f32_16x16x32_bf16 v[64:67], a[32:35], a[160:163], v[24:27]
  s_mov_b32 m0, s26
  ds_read_b128 a[12:15], v3 offset:11264
  v_cndmask_b32 v104, v104, v5, s[48:49]
  v_mfma_f32_16x16x32_bf16 v[64:67], a[36:39], a[164:167], v[64:67]
  v_exp_f32 v104, v104
  v_mfma_f32_16x16x32_bf16 v[64:67], a[40:43], a[168:171], v[64:67]
  v_cndmask_b32 v105, v105, v5, s[50:51]
  v_exp_f32 v105, v105
  v_mfma_f32_16x16x32_bf16 v[64:67], a[44:47], a[172:175], v[64:67]
  buffer_load_dwordx4 v2, s[20:23], s28 offen offset:0 sc1 lds
  ds_read_b128 a[16:19], v3 offset:12288
  v_mfma_f32_16x16x32_bf16 v[72:75], a[32:35], a[176:179], v[28:31]
  v_cndmask_b32 v106, v106, v5, s[52:53]
  v_exp_f32 v106, v106
  v_mfma_f32_16x16x32_bf16 v[72:75], a[36:39], a[180:183], v[72:75]
  ds_read_b128 a[20:23], v3 offset:13312
  v_cndmask_b32 v107, v107, v5, s[54:55]
  v_mfma_f32_16x16x32_bf16 v[72:75], a[40:43], a[184:187], v[72:75]
  buffer_load_dwordx4 v2, s[20:23], s28 offen offset:1024 sc1 lds
  ds_read_b128 a[24:27], v3 offset:14336
  v_mfma_f32_16x16x32_bf16 v[72:75], a[44:47], a[188:191], v[72:75]
  v_exp_f32 v107, v107
  v_mfma_f32_16x16x32_bf16 v[68:71], a[48:51], a[160:163], v[24:27]
  ds_read_b128 a[28:31], v3 offset:15360
  v_cndmask_b32 v108, v108, v5, s[56:57]
  v_mfma_f32_16x16x32_bf16 v[68:71], a[52:55], a[164:167], v[68:71]
  v_exp_f32 v108, v108
  v_mfma_f32_16x16x32_bf16 v[68:71], a[56:59], a[168:171], v[68:71]
  ds_read_b128 a[32:35], v4 offset:0
  v_cndmask_b32 v109, v109, v5, s[58:59]
  v_mfma_f32_16x16x32_bf16 v[68:71], a[60:63], a[172:175], v[68:71]
  v_exp_f32 v109, v109
  v_mfma_f32_16x16x32_bf16 v[76:79], a[48:51], a[176:179], v[28:31]
  ds_read_b128 a[36:39], v4 offset:1024
  v_cvt_pk_bf16_f32 v52, v104, v105
  v_mfma_f32_16x16x32_bf16 v[76:79], a[52:55], a[180:183], v[76:79]
  buffer_load_dwordx4 v2, s[20:23], s28 offen offset:2048 sc1 lds
  v_cndmask_b32 v110, v110, v5, s[60:61]
  v_mfma_f32_16x16x32_bf16 v[76:79], a[56:59], a[184:187], v[76:79]
  v_exp_f32 v110, v110
  v_mfma_f32_16x16x32_bf16 v[76:79], a[60:63], a[188:191], v[76:79]
  s_waitcnt lgkmcnt(2)
  ds_read_b128 a[40:43], v4 offset:2048
  v_cndmask_b32 v111, v111, v5, s[62:63]
  v_mfma_f32_16x16x32_bf16 v[80:83], a[0:3], a[160:163], v[24:27]
  v_exp_f32 v111, v111
  v_mfma_f32_16x16x32_bf16 v[80:83], a[4:7], a[164:167], v[80:83]
  ds_read_b128 a[44:47], v4 offset:3072
  v_cvt_pk_bf16_f32 v53, v106, v107
  v_mfma_f32_16x16x32_bf16 v[80:83], a[8:11], a[168:171], v[80:83]
  ds_read_b128 a[48:51], v4 offset:4096
  v_cvt_pk_bf16_f32 v54, v108, v109
  v_mfma_f32_16x16x32_bf16 v[80:83], a[12:15], a[172:175], v[80:83]
  v_exp_f32 v112, v112
  v_mfma_f32_16x16x32_bf16 v[88:91], a[0:3], a[176:179], v[28:31]
  buffer_load_dwordx4 v2, s[20:23], s28 offen offset:3072 sc1 lds
  ds_read_b128 a[52:55], v4 offset:5120
  v_mfma_f32_16x16x32_bf16 v[88:91], a[4:7], a[180:183], v[88:91]
  s_xor_b32 s26, s26, 0x8000
  v_exp_f32 v113, v113
  v_mfma_f32_16x16x32_bf16 v[88:91], a[8:11], a[184:187], v[88:91]
  s_add_u32 s28, s28, 0x8000
  s_mov_b32 m0, s27
  ds_read_b128 a[56:59], v4 offset:6144
  v_mfma_f32_16x16x32_bf16 v[88:91], a[12:15], a[188:191], v[88:91]
  v_exp_f32 v114, v114
  v_mfma_f32_16x16x32_bf16 v[84:87], a[16:19], a[160:163], v[24:27]
  ds_read_b128 a[60:63], v4 offset:7168
  v_cvt_pk_bf16_f32 v55, v110, v111
  v_mfma_f32_16x16x32_bf16 v[84:87], a[20:23], a[164:167], v[84:87]
  v_xor_b32 v3, 0x4000, v3
  v_cvt_pk_bf16_f32 v56, v112, v113
  v_mfma_f32_16x16x32_bf16 v[84:87], a[24:27], a[168:171], v[84:87]
  v_exp_f32 v115, v115
  v_mfma_f32_16x16x32_bf16 v[84:87], a[28:31], a[172:175], v[84:87]
  buffer_load_dwordx4 v2, s[20:23], s29 offen offset:0 sc1 lds
  ds_read_b128 a[0:3], v3 offset:0
  v_mfma_f32_16x16x32_bf16 v[92:95], a[16:19], a[176:179], v[28:31]
  v_exp_f32 v116, v116
  v_mfma_f32_16x16x32_bf16 v[92:95], a[20:23], a[180:183], v[92:95]
  ds_read_b128 a[4:7], v3 offset:1024
  v_cvt_pk_bf16_f32 v57, v114, v115
  v_mfma_f32_16x16x32_bf16 v[92:95], a[24:27], a[184:187], v[92:95]
  v_exp_f32 v117, v117
  v_mfma_f32_16x16x32_bf16 v[92:95], a[28:31], a[188:191], v[92:95]
  s_waitcnt lgkmcnt(6)
  ds_read_b128 a[8:11], v3 offset:2048
  v_cvt_pk_bf16_f32 v58, v116, v117
  v_mfma_f32_16x16x32_bf16 v[160:163], a[32:35], v[36:39], v[160:163]
  ds_read_b128 a[12:15], v3 offset:3072
  v_mfma_f32_16x16x32_bf16 v[192:195], a[32:35], v[40:43], v[192:195]
  v_exp_f32 v118, v118
  v_mfma_f32_16x16x32_bf16 v[224:227], a[32:35], v[44:47], v[224:227]
  buffer_load_dwordx4 v2, s[20:23], s29 offen offset:1024 sc1 lds
  v_mfma_f32_16x16x32_bf16 a[196:199], a[208:211], v[36:39], a[196:199]
  v_exp_f32 v119, v119
  v_mfma_f32_16x16x32_bf16 v[164:167], a[36:39], v[36:39], v[164:167]
  ds_read_b128 a[16:19], v3 offset:4096
  v_cvt_pk_bf16_f32 v59, v118, v119
  v_mfma_f32_16x16x32_bf16 v[196:199], a[36:39], v[40:43], v[196:199]
  v_mfma_f32_16x16x32_bf16 v[228:231], a[36:39], v[44:47], v[228:231]
  v_exp_f32 v120, v120
  v_mfma_f32_16x16x32_bf16 a[200:203], a[208:211], v[40:43], a[200:203]
  v_mfma_f32_16x16x32_bf16 v[168:171], a[40:43], v[36:39], v[168:171]
  v_exp_f32 v121, v121
  v_mfma_f32_16x16x32_bf16 v[200:203], a[40:43], v[40:43], v[200:203]
  buffer_load_dwordx4 v2, s[20:23], s29 offen offset:2048 sc1 lds
  ds_read_b128 a[20:23], v3 offset:5120
  v_mfma_f32_16x16x32_bf16 v[232:235], a[40:43], v[44:47], v[232:235]
  v_exp_f32 v122, v122
  v_mfma_f32_16x16x32_bf16 a[204:207], a[208:211], v[44:47], a[204:207]
  v_cvt_pk_bf16_f32 v60, v120, v121
  v_mfma_f32_16x16x32_bf16 v[172:175], a[44:47], v[36:39], v[172:175]
  ds_read_b128 a[24:27], v3 offset:6144
  v_mfma_f32_16x16x32_bf16 v[204:207], a[44:47], v[40:43], v[204:207]
  v_exp_f32 v123, v123
  v_mfma_f32_16x16x32_bf16 v[236:239], a[44:47], v[44:47], v[236:239]
  s_waitcnt lgkmcnt(7)
  v_cvt_pk_bf16_f32 v61, v122, v123
  v_mfma_f32_16x16x32_bf16 v[176:179], a[48:51], v[36:39], v[176:179]
  v_exp_f32 v124, v124
  v_mfma_f32_16x16x32_bf16 v[208:211], a[48:51], v[40:43], v[208:211]
  buffer_load_dwordx4 v2, s[20:23], s29 offen offset:3072 sc1 lds
  ds_read_b128 a[28:31], v3 offset:7168
  v_mfma_f32_16x16x32_bf16 v[240:243], a[48:51], v[44:47], v[240:243]
  s_xor_b32 s27, s27, 0x4000
  v_exp_f32 v125, v125
  v_mfma_f32_16x16x32_bf16 v[180:183], a[52:55], v[36:39], v[180:183]
  s_add_u32 s29, s29, 0x8000
  ds_read_b128 a[32:35], v3 offset:8192
  v_cvt_pk_bf16_f32 v62, v124, v125
  v_mfma_f32_16x16x32_bf16 v[212:215], a[52:55], v[40:43], v[212:215]
  v_mfma_f32_16x16x32_bf16 v[244:247], a[52:55], v[44:47], v[244:247]
  v_exp_f32 v126, v126
  v_mfma_f32_16x16x32_bf16 v[184:187], a[56:59], v[36:39], v[184:187]
  ds_read_b128 a[36:39], v3 offset:9216
  v_mfma_f32_16x16x32_bf16 v[216:219], a[56:59], v[40:43], v[216:219]
  v_exp_f32 v127, v127
  v_mfma_f32_16x16x32_bf16 v[248:251], a[56:59], v[44:47], v[248:251]
  v_cvt_pk_bf16_f32 v63, v126, v127
  v_mfma_f32_16x16x32_bf16 v[188:191], a[60:63], v[36:39], v[188:191]
  ds_read_b128 a[40:43], v3 offset:10240
  v_mfma_f32_16x16x32_bf16 v[220:223], a[60:63], v[40:43], v[220:223]
  s_waitcnt vmcnt(12)
  s_barrier
  v_mfma_f32_16x16x32_bf16 v[252:255], a[60:63], v[44:47], v[252:255]
  s_waitcnt lgkmcnt(3)
  v_mfma_f32_16x16x32_bf16 v[96:99], a[0:3], a[160:163], v[24:27]
  s_mov_b32 m0, s26
  v_exp_f32 v64, v64
  v_mfma_f32_16x16x32_bf16 v[96:99], a[4:7], a[164:167], v[96:99]
  v_exp_f32 v65, v65
  v_mfma_f32_16x16x32_bf16 v[96:99], a[8:11], a[168:171], v[96:99]
  buffer_load_dwordx4 v2, s[20:23], s28 offen offset:0 sc1 lds
  ds_read_b128 a[44:47], v3 offset:11264
  v_mfma_f32_16x16x32_bf16 v[96:99], a[12:15], a[172:175], v[96:99]
  v_exp_f32 v66, v66
  v_mfma_f32_16x16x32_bf16 v[104:107], a[0:3], a[176:179], v[28:31]
  ds_read_b128 a[48:51], v3 offset:12288
  ds_read_b128 a[52:55], v3 offset:13312
  v_mfma_f32_16x16x32_bf16 v[104:107], a[4:7], a[180:183], v[104:107]
  v_exp_f32 v67, v67
  v_mfma_f32_16x16x32_bf16 v[104:107], a[8:11], a[184:187], v[104:107]
  ds_read_b128 a[56:59], v3 offset:14336
  v_cvt_pk_bf16_f32 v32, v64, v65
  v_mfma_f32_16x16x32_bf16 v[104:107], a[12:15], a[188:191], v[104:107]
  v_exp_f32 v68, v68
  v_mfma_f32_16x16x32_bf16 v[100:103], a[16:19], a[160:163], v[24:27]
  v_exp_f32 v69, v69
  v_mfma_f32_16x16x32_bf16 v[100:103], a[20:23], a[164:167], v[100:103]
  ds_read_b128 a[60:63], v3 offset:15360
  v_cvt_pk_bf16_f32 v33, v66, v67
  v_mfma_f32_16x16x32_bf16 v[100:103], a[24:27], a[168:171], v[100:103]
  v_exp_f32 v70, v70
  v_mfma_f32_16x16x32_bf16 v[100:103], a[28:31], a[172:175], v[100:103]
  ds_read_b128 a[0:3], v4 offset:8192
  v_cvt_pk_bf16_f32 v34, v68, v69
  v_mfma_f32_16x16x32_bf16 v[108:111], a[16:19], a[176:179], v[28:31]
  v_exp_f32 v71, v71
  v_mfma_f32_16x16x32_bf16 v[108:111], a[20:23], a[180:183], v[108:111]
  buffer_load_dwordx4 v2, s[20:23], s28 offen offset:1024 sc1 lds
  ds_read_b128 a[4:7], v4 offset:9216
  v_mfma_f32_16x16x32_bf16 v[108:111], a[24:27], a[184:187], v[108:111]
  v_exp_f32 v72, v72
  v_mfma_f32_16x16x32_bf16 v[108:111], a[28:31], a[188:191], v[108:111]
  s_waitcnt lgkmcnt(2)
  ds_read_b128 a[8:11], v4 offset:10240
  v_cvt_pk_bf16_f32 v35, v70, v71
  v_mfma_f32_16x16x32_bf16 v[112:115], a[32:35], a[160:163], v[24:27]
  v_exp_f32 v73, v73
  v_mfma_f32_16x16x32_bf16 v[112:115], a[36:39], a[164:167], v[112:115]
  v_exp_f32 v74, v74
  v_mfma_f32_16x16x32_bf16 v[112:115], a[40:43], a[168:171], v[112:115]
  ds_read_b128 a[12:15], v4 offset:11264
  ds_read_b128 a[16:19], v4 offset:12288
  v_mfma_f32_16x16x32_bf16 v[112:115], a[44:47], a[172:175], v[112:115]
  v_exp_f32 v75, v75
  v_mfma_f32_16x16x32_bf16 v[120:123], a[32:35], a[176:179], v[28:31]
  ds_read_b128 a[20:23], v4 offset:13312
  v_cvt_pk_bf16_f32 v36, v72, v73
  v_mfma_f32_16x16x32_bf16 v[120:123], a[36:39], a[180:183], v[120:123]
  v_exp_f32 v76, v76
  v_mfma_f32_16x16x32_bf16 v[120:123], a[40:43], a[184:187], v[120:123]
  ds_read_b128 a[24:27], v4 offset:14336
  v_cvt_pk_bf16_f32 v37, v74, v75
  v_mfma_f32_16x16x32_bf16 v[120:123], a[44:47], a[188:191], v[120:123]
  v_exp_f32 v77, v77
  v_mfma_f32_16x16x32_bf16 v[116:119], a[48:51], a[160:163], v[24:27]
  v_exp_f32 v78, v78
  v_mfma_f32_16x16x32_bf16 v[116:119], a[52:55], a[164:167], v[116:119]
  ds_read_b128 a[28:31], v4 offset:15360
  v_xor_b32 v4, 0x8000, v4
  v_mfma_f32_16x16x32_bf16 v[116:119], a[56:59], a[168:171], v[116:119]
  v_exp_f32 v79, v79
  v_mfma_f32_16x16x32_bf16 v[116:119], a[60:63], a[172:175], v[116:119]
  buffer_load_dwordx4 v2, s[20:23], s28 offen offset:2048 sc1 lds
  v_xor_b32 v3, 0x8000, v3
  v_mfma_f32_16x16x32_bf16 v[124:127], a[48:51], a[176:179], v[28:31]
  v_exp_f32 v80, v80
  v_mfma_f32_16x16x32_bf16 v[124:127], a[52:55], a[180:183], v[124:127]
  ds_read_b128 a[32:35], v3 offset:0
  ds_read_b128 a[36:39], v3 offset:1024
  v_mfma_f32_16x16x32_bf16 v[124:127], a[56:59], a[184:187], v[124:127]
  v_exp_f32 v81, v81
  v_mfma_f32_16x16x32_bf16 v[124:127], a[60:63], a[188:191], v[124:127]
  s_waitcnt lgkmcnt(6)
  ds_read_b128 a[40:43], v3 offset:2048
  v_cvt_pk_bf16_f32 v38, v76, v77
  v_mfma_f32_16x16x32_bf16 v[160:163], a[0:3], v[52:55], v[160:163]
  v_exp_f32 v82, v82
  v_mfma_f32_16x16x32_bf16 v[192:195], a[0:3], v[56:59], v[192:195]
  v_exp_f32 v83, v83
  v_mfma_f32_16x16x32_bf16 v[224:227], a[0:3], v[60:63], v[224:227]
  ds_read_b128 a[44:47], v3 offset:3072
  v_cvt_pk_bf16_f32 v39, v78, v79
  v_mfma_f32_16x16x32_bf16 a[196:199], a[208:211], v[52:55], a[196:199]
  v_exp_f32 v84, v84
  v_mfma_f32_16x16x32_bf16 v[164:167], a[4:7], v[52:55], v[164:167]
  ds_read_b128 a[48:51], v3 offset:4096
  v_cvt_pk_bf16_f32 v40, v80, v81
  v_mfma_f32_16x16x32_bf16 v[196:199], a[4:7], v[56:59], v[196:199]
  v_exp_f32 v85, v85
  v_mfma_f32_16x16x32_bf16 v[228:231], a[4:7], v[60:63], v[228:231]
  v_cvt_pk_bf16_f32 v41, v82, v83
  v_cvt_pk_bf16_f32 v42, v84, v85
  v_mfma_f32_16x16x32_bf16 a[200:203], a[208:211], v[56:59], a[200:203]
  v_exp_f32 v86, v86
  v_mfma_f32_16x16x32_bf16 v[168:171], a[8:11], v[52:55], v[168:171]
  v_exp_f32 v87, v87
  v_mfma_f32_16x16x32_bf16 v[200:203], a[8:11], v[56:59], v[200:203]
  buffer_load_dwordx4 v2, s[20:23], s28 offen offset:3072 sc1 lds
  ds_read_b128 a[52:55], v3 offset:5120
  v_mfma_f32_16x16x32_bf16 v[232:235], a[8:11], v[60:63], v[232:235]
  s_xor_b32 s26, s26, 0x4000
  v_exp_f32 v88, v88
  v_mfma_f32_16x16x32_bf16 a[204:207], a[208:211], v[60:63], a[204:207]
  s_add_u32 s28, s28, 0x8000
  v_cvt_pk_bf16_f32 v43, v86, v87
  v_mfma_f32_16x16x32_bf16 v[172:175], a[12:15], v[52:55], v[172:175]
  v_exp_f32 v89, v89
  v_mfma_f32_16x16x32_bf16 v[204:207], a[12:15], v[56:59], v[204:207]
  ds_read_b128 a[56:59], v3 offset:6144
  v_cvt_pk_bf16_f32 v44, v88, v89
  v_mfma_f32_16x16x32_bf16 v[236:239], a[12:15], v[60:63], v[236:239]
  s_waitcnt lgkmcnt(7)
  v_exp_f32 v90, v90
  v_mfma_f32_16x16x32_bf16 v[176:179], a[16:19], v[52:55], v[176:179]
  ds_read_b128 a[60:63], v3 offset:7168
  v_mfma_f32_16x16x32_bf16 v[208:211], a[16:19], v[56:59], v[208:211]
  v_exp_f32 v91, v91
  v_mfma_f32_16x16x32_bf16 v[240:243], a[16:19], v[60:63], v[240:243]
  v_exp_f32 v92, v92
  v_mfma_f32_16x16x32_bf16 v[180:183], a[20:23], v[52:55], v[180:183]
  ds_read_b128 a[0:3], v3 offset:8192
  v_cvt_pk_bf16_f32 v45, v90, v91
  v_mfma_f32_16x16x32_bf16 v[212:215], a[20:23], v[56:59], v[212:215]
  v_exp_f32 v93, v93
  v_mfma_f32_16x16x32_bf16 v[244:247], a[20:23], v[60:63], v[244:247]
  v_cvt_pk_bf16_f32 v46, v92, v93
  v_mfma_f32_16x16x32_bf16 v[184:187], a[24:27], v[52:55], v[184:187]
  v_exp_f32 v94, v94
  v_mfma_f32_16x16x32_bf16 v[216:219], a[24:27], v[56:59], v[216:219]
  ds_read_b128 a[4:7], v3 offset:9216
  v_mfma_f32_16x16x32_bf16 v[248:251], a[24:27], v[60:63], v[248:251]
  v_exp_f32 v95, v95
  v_mfma_f32_16x16x32_bf16 v[188:191], a[28:31], v[52:55], v[188:191]
  ds_read_b128 a[8:11], v3 offset:10240
  v_cvt_pk_bf16_f32 v47, v94, v95
  v_mfma_f32_16x16x32_bf16 v[220:223], a[28:31], v[56:59], v[220:223]
  s_waitcnt vmcnt(8)
  s_barrier
  v_mfma_f32_16x16x32_bf16 v[252:255], a[28:31], v[60:63], v[252:255]
  s_lshl_b32 s4, s25, 20
  s_lshl_b32 s5, s24, 15
  s_add_u32 s4, s4, s5
  s_lshl_b32 s5, s3, 11
  s_add_u32 s4, s4, s5
  v_accvgpr_read_b32 v6, a192
  v_accvgpr_read_b32 v8, a196
  s_mov_b32 s5, 0x5f800000
  v_cmp_ngt_f32 vcc, s5, v6
  v_rcp_f32 v6, v6
  s_or_b32 s89, s89, vcc_lo
  s_or_b32 s89, s89, vcc_hi
  v_mov_b32 v7, v6
  v_cmp_ngt_f32 vcc, s5, v8
  v_rcp_f32 v8, v8
  s_or_b32 s89, s89, vcc_lo
  s_or_b32 s89, s89, vcc_hi
  v_mov_b32 v9, v8
  v_pk_mul_f32 v[128:129], v[128:129], v[6:7]
  v_pk_mul_f32 v[130:131], v[130:131], v[6:7]
  v_pk_mul_f32 v[132:133], v[132:133], v[6:7]
  v_pk_mul_f32 v[134:135], v[134:135], v[6:7]
  v_cvt_pk_bf16_f32 v128, v128, v129
  v_cvt_pk_bf16_f32 v129, v130, v131
  v_cvt_pk_bf16_f32 v130, v132, v133
  v_cvt_pk_bf16_f32 v131, v134, v135
  buffer_store_dwordx4 v[128:131], v2, s[16:19], s4 offen offset:0 sc1
  v_pk_mul_f32 v[160:161], v[160:161], v[8:9]
  v_pk_mul_f32 v[162:163], v[162:163], v[8:9]
  v_pk_mul_f32 v[164:165], v[164:165], v[8:9]
  v_pk_mul_f32 v[166:167], v[166:167], v[8:9]
  v_cvt_pk_bf16_f32 v160, v160, v161
  v_cvt_pk_bf16_f32 v161, v162, v163
  v_cvt_pk_bf16_f32 v162, v164, v165
  v_cvt_pk_bf16_f32 v163, v166, v167
  buffer_store_dwordx4 v[160:163], v2, s[16:19], s4 offen offset:1024 sc1
  s_add_u32 s4, s4, 8192
  v_pk_mul_f32 v[136:137], v[136:137], v[6:7]
  v_pk_mul_f32 v[138:139], v[138:139], v[6:7]
  v_pk_mul_f32 v[140:141], v[140:141], v[6:7]
  v_pk_mul_f32 v[142:143], v[142:143], v[6:7]
  v_cvt_pk_bf16_f32 v136, v136, v137
  v_cvt_pk_bf16_f32 v137, v138, v139
  v_cvt_pk_bf16_f32 v138, v140, v141
  v_cvt_pk_bf16_f32 v139, v142, v143
  buffer_store_dwordx4 v[136:139], v2, s[16:19], s4 offen offset:0 sc1
  v_pk_mul_f32 v[168:169], v[168:169], v[8:9]
  v_pk_mul_f32 v[170:171], v[170:171], v[8:9]
  v_pk_mul_f32 v[172:173], v[172:173], v[8:9]
  v_pk_mul_f32 v[174:175], v[174:175], v[8:9]
  v_cvt_pk_bf16_f32 v168, v168, v169
  v_cvt_pk_bf16_f32 v169, v170, v171
  v_cvt_pk_bf16_f32 v170, v172, v173
  v_cvt_pk_bf16_f32 v171, v174, v175
  buffer_store_dwordx4 v[168:171], v2, s[16:19], s4 offen offset:1024 sc1
  s_add_u32 s4, s4, 8192
  v_pk_mul_f32 v[144:145], v[144:145], v[6:7]
  v_pk_mul_f32 v[146:147], v[146:147], v[6:7]
  v_pk_mul_f32 v[148:149], v[148:149], v[6:7]
  v_pk_mul_f32 v[150:151], v[150:151], v[6:7]
  v_cvt_pk_bf16_f32 v144, v144, v145
  v_cvt_pk_bf16_f32 v145, v146, v147
  v_cvt_pk_bf16_f32 v146, v148, v149
  v_cvt_pk_bf16_f32 v147, v150, v151
  buffer_store_dwordx4 v[144:147], v2, s[16:19], s4 offen offset:0 sc1
  v_pk_mul_f32 v[176:177], v[176:177], v[8:9]
  v_pk_mul_f32 v[178:179], v[178:179], v[8:9]
  v_pk_mul_f32 v[180:181], v[180:181], v[8:9]
  v_pk_mul_f32 v[182:183], v[182:183], v[8:9]
  v_cvt_pk_bf16_f32 v176, v176, v177
  v_cvt_pk_bf16_f32 v177, v178, v179
  v_cvt_pk_bf16_f32 v178, v180, v181
  v_cvt_pk_bf16_f32 v179, v182, v183
  buffer_store_dwordx4 v[176:179], v2, s[16:19], s4 offen offset:1024 sc1
  s_add_u32 s4, s4, 8192
  v_pk_mul_f32 v[152:153], v[152:153], v[6:7]
  v_pk_mul_f32 v[154:155], v[154:155], v[6:7]
  v_pk_mul_f32 v[156:157], v[156:157], v[6:7]
  v_pk_mul_f32 v[158:159], v[158:159], v[6:7]
  v_cvt_pk_bf16_f32 v152, v152, v153
  v_cvt_pk_bf16_f32 v153, v154, v155
  v_cvt_pk_bf16_f32 v154, v156, v157
  v_cvt_pk_bf16_f32 v155, v158, v159
  buffer_store_dwordx4 v[152:155], v2, s[16:19], s4 offen offset:0 sc1
  v_pk_mul_f32 v[184:185], v[184:185], v[8:9]
  v_pk_mul_f32 v[186:187], v[186:187], v[8:9]
  v_pk_mul_f32 v[188:189], v[188:189], v[8:9]
  v_pk_mul_f32 v[190:191], v[190:191], v[8:9]
  v_cvt_pk_bf16_f32 v184, v184, v185
  v_cvt_pk_bf16_f32 v185, v186, v187
  v_cvt_pk_bf16_f32 v186, v188, v189
  v_cvt_pk_bf16_f32 v187, v190, v191
  buffer_store_dwordx4 v[184:187], v2, s[16:19], s4 offen offset:1024 sc1
  s_and_b32 s88, s25, 1
  s_lshl_b32 s88, s88, 1
  s_add_u32 s88, s88, 14
  s_sub_u32 s88, s88, s25
  s_sub_u32 s88, s88, s25
  s_sub_u32 s88, s88, 1
  .p2align 6
La_so:
  s_waitcnt lgkmcnt(3)
  v_mfma_f32_16x16x32_bf16 v[64:67], a[32:35], a[160:163], v[24:27]
  v_exp_f32 v96, v96
  v_mfma_f32_16x16x32_bf16 v[64:67], a[36:39], a[164:167], v[64:67]
  buffer_store_dwordx4 a[244:247], v2, s[64:67], s90 offen offset:0 sc1
  ds_read_b128 a[12:15], v3 offset:11264
  v_mfma_f32_16x16x32_bf16 v[64:67], a[40:43], a[168:171], v[64:67]
  v_exp_f32 v97, v97
  v_mfma_f32_16x16x32_bf16 v[64:67], a[44:47], a[172:175], v[64:67]
  ds_read_b128 a[16:19], v3 offset:12288
  v_cvt_pk_bf16_f32 v48, v96, v97
  v_mfma_f32_16x16x32_bf16 v[72:75], a[32:35], a[176:179], v[28:31]
  v_exp_f32 v98, v98
  v_mfma_f32_16x16x32_bf16 v[72:75], a[36:39], a[180:183], v[72:75]
  ds_read_b128 a[20:23], v3 offset:13312
  v_mfma_f32_16x16x32_bf16 v[72:75], a[40:43], a[184:187], v[72:75]
  v_exp_f32 v99, v99
  v_mfma_f32_16x16x32_bf16 v[72:75], a[44:47], a[188:191], v[72:75]
  buffer_store_dwordx4 a[244:247], v2, s[64:67], s90 offen offset:1024 sc1
  ds_read_b128 a[24:27], v3 offset:14336
  v_mfma_f32_16x16x32_bf16 v[68:71], a[48:51], a[160:163], v[24:27]
  s_add_u32 s90, s90, 2048
  v_exp_f32 v100, v100
  v_mfma_f32_16x16x32_bf16 v[68:71], a[52:55], a[164:167], v[68:71]
  s_mov_b32 m0, s26
  ds_read_b128 a[28:31], v3 offset:15360
  v_cvt_pk_bf16_f32 v49, v98, v99
  v_mfma_f32_16x16x32_bf16 v[68:71], a[56:59], a[168:171], v[68:71]
  v_exp_f32 v101, v101
  v_mfma_f32_16x16x32_bf16 v[68:71], a[60:63], a[172:175], v[68:71]
  ds_read_b128 a[32:35], v4 offset:0
  v_cvt_pk_bf16_f32 v50, v100, v101
  v_mfma_f32_16x16x32_bf16 v[76:79], a[48:51], a[176:179], v[28:31]
  v_exp_f32 v102, v102
  v_mfma_f32_16x16x32_bf16 v[76:79], a[52:55], a[180:183], v[76:79]
  buffer_load_dwordx4 v2, s[20:23], s28 offen offset:0 sc1 lds
  ds_read_b128 a[36:39], v4 offset:1024
  v_mfma_f32_16x16x32_bf16 v[76:79], a[56:59], a[184:187], v[76:79]
  v_exp_f32 v103, v103
  v_mfma_f32_16x16x32_bf16 v[76:79], a[60:63], a[188:191], v[76:79]
  s_waitcnt lgkmcnt(2)
  ds_read_b128 a[40:43], v4 offset:2048
  v_cvt_pk_bf16_f32 v51, v102, v103
  v_mfma_f32_16x16x32_bf16 v[80:83], a[0:3], a[160:163], v[24:27]
  v_exp_f32 v104, v104
  v_mfma_f32_16x16x32_bf16 v[80:83], a[4:7], a[164:167], v[80:83]
  ds_read_b128 a[44:47], v4 offset:3072
  v_mfma_f32_16x16x32_bf16 v[80:83], a[8:11], a[168:171], v[80:83]
  v_exp_f32 v105, v105
  v_mfma_f32_16x16x32_bf16 v[80:83], a[12:15], a[172:175], v[80:83]
  buffer_load_dwordx4 v2, s[20:23], s28 offen offset:1024 sc1 lds
  ds_read_b128 a[48:51], v4 offset:4096
  v_mfma_f32_16x16x32_bf16 v[88:91], a[0:3], a[176:179], v[28:31]
  v_exp_f32 v106, v106
  v_mfma_f32_16x16x32_bf16 v[88:91], a[4:7], a[180:183], v[88:91]
  ds_read_b128 a[52:55], v4 offset:5120
  v_cvt_pk_bf16_f32 v52, v104, v105
  v_mfma_f32_16x16x32_bf16 v[88:91], a[8:11], a[184:187], v[88:91]
  v_exp_f32 v107, v107
  v_mfma_f32_16x16x32_bf16 v[88:91], a[12:15], a[188:191], v[88:91]
  ds_read_b128 a[56:59], v4 offset:6144
  v_cvt_pk_bf16_f32 v53, v106, v107
  v_mfma_f32_16x16x32_bf16 v[84:87], a[16:19], a[160:163], v[24:27]
  v_exp_f32 v108, v108
  v_mfma_f32_16x16x32_bf16 v[84:87], a[20:23], a[164:167], v[84:87]
  buffer_load_dwordx4 v2, s[20:23], s28 offen offset:2048 sc1 lds
  ds_read_b128 a[60:63], v4 offset:7168
  v_mfma_f32_16x16x32_bf16 v[84:87], a[24:27], a[168:171], v[84:87]
  v_exp_f32 v109, v109
  v_mfma_f32_16x16x32_bf16 v[84:87], a[28:31], a[172:175], v[84:87]
  ds_read_b128 a[0:3], v4 offset:8192
  v_cvt_pk_bf16_f32 v54, v108, v109
  v_mfma_f32_16x16x32_bf16 v[92:95], a[16:19], a[176:179], v[28:31]
  v_exp_f32 v110, v110
  v_mfma_f32_16x16x32_bf16 v[92:95], a[20:23], a[180:183], v[92:95]
  ds_read_b128 a[4:7], v4 offset:9216
  v_mfma_f32_16x16x32_bf16 v[92:95], a[24:27], a[184:187], v[92:95]
  v_exp_f32 v111, v111
  v_mfma_f32_16x16x32_bf16 v[92:95], a[28:31], a[188:191], v[92:95]
  s_waitcnt lgkmcnt(2)
  ds_read_b128 a[8:11], v4 offset:10240
  v_cvt_pk_bf16_f32 v55, v110, v111
  v_mfma_f32_16x16x32_bf16 v[192:195], a[32:35], v[32:35], v[192:195]
  buffer_load_dwordx4 v2, s[20:23], s28 offen offset:3072 sc1 lds
  ds_read_b128 a[12:15], v4 offset:11264
  v_mfma_f32_16x16x32_bf16 v[224:227], a[32:35], v[36:39], v[224:227]
  s_xor_b32 s26, s26, 0x8000
  v_exp_f32 v112, v112
  v_mfma_f32_16x16x32_bf16 a[200:203], a[208:211], v[32:35], a[200:203]
  s_add_u32 s28, s28, 0x8000
  s_mov_b32 m0, s27
  s_sub_u32 s88, s88, 1
  v_mfma_f32_16x16x32_bf16 v[196:199], a[36:39], v[32:35], v[196:199]
  v_exp_f32 v113, v113
  v_mfma_f32_16x16x32_bf16 v[228:231], a[36:39], v[36:39], v[228:231]
  ds_read_b128 a[16:19], v4 offset:12288
  v_cvt_pk_bf16_f32 v56, v112, v113
  v_mfma_f32_16x16x32_bf16 a[204:207], a[208:211], v[36:39], a[204:207]
  v_exp_f32 v114, v114
  v_mfma_f32_16x16x32_bf16 v[200:203], a[40:43], v[32:35], v[200:203]
  buffer_load_dwordx4 v2, s[20:23], s29 offen offset:0 sc1 lds
  ds_read_b128 a[20:23], v4 offset:13312
  v_mfma_f32_16x16x32_bf16 v[232:235], a[40:43], v[36:39], v[232:235]
  v_exp_f32 v115, v115
  v_mfma_f32_16x16x32_bf16 v[204:207], a[44:47], v[32:35], v[204:207]
  ds_read_b128 a[24:27], v4 offset:14336
  v_cvt_pk_bf16_f32 v57, v114, v115
  v_mfma_f32_16x16x32_bf16 v[236:239], a[44:47], v[36:39], v[236:239]
  v_exp_f32 v116, v116
  v_mfma_f32_16x16x32_bf16 v[208:211], a[48:51], v[32:35], v[208:211]
  ds_read_b128 a[28:31], v4 offset:15360
  v_xor_b32 v4, 0x4000, v4
  v_mfma_f32_16x16x32_bf16 v[240:243], a[48:51], v[36:39], v[240:243]
  v_exp_f32 v117, v117
  v_mfma_f32_16x16x32_bf16 v[212:215], a[52:55], v[32:35], v[212:215]
  buffer_load_dwordx4 v2, s[20:23], s29 offen offset:1024 sc1 lds
  v_xor_b32 v3, 0x4000, v3
  v_mfma_f32_16x16x32_bf16 v[244:247], a[52:55], v[36:39], v[244:247]
  v_exp_f32 v118, v118
  v_mfma_f32_16x16x32_bf16 v[216:219], a[56:59], v[32:35], v[216:219]
  ds_read_b128 a[32:35], v3 offset:0
  ds_read_b128 a[36:39], v3 offset:1024
  v_mfma_f32_16x16x32_bf16 v[248:251], a[56:59], v[36:39], v[248:251]
  v_exp_f32 v119, v119
  v_mfma_f32_16x16x32_bf16 v[220:223], a[60:63], v[32:35], v[220:223]
  ds_read_b128 a[40:43], v3 offset:2048
  v_cvt_pk_bf16_f32 v58, v116, v117
  v_mfma_f32_16x16x32_bf16 v[252:255], a[60:63], v[36:39], v[252:255]
  s_waitcnt lgkmcnt(3)
  v_exp_f32 v120, v120
  v_mfma_f32_16x16x32_bf16 v[192:195], a[0:3], v[40:43], v[192:195]
  ds_read_b128 a[44:47], v3 offset:3072
  v_cvt_pk_bf16_f32 v59, v118, v119
  v_mfma_f32_16x16x32_bf16 v[224:227], a[0:3], v[44:47], v[224:227]
  v_exp_f32 v121, v121
  v_mfma_f32_16x16x32_bf16 a[200:203], a[208:211], v[40:43], a[200:203]
  buffer_load_dwordx4 v2, s[20:23], s29 offen offset:2048 sc1 lds
  v_cvt_pk_bf16_f32 v60, v120, v121
  v_mfma_f32_16x16x32_bf16 v[196:199], a[4:7], v[40:43], v[196:199]
  v_exp_f32 v122, v122
  v_mfma_f32_16x16x32_bf16 v[228:231], a[4:7], v[44:47], v[228:231]
  ds_read_b128 a[48:51], v3 offset:4096
  v_mfma_f32_16x16x32_bf16 a[204:207], a[208:211], v[44:47], a[204:207]
  v_exp_f32 v123, v123
  v_mfma_f32_16x16x32_bf16 v[200:203], a[8:11], v[40:43], v[200:203]
  ds_read_b128 a[52:55], v3 offset:5120
  v_cvt_pk_bf16_f32 v61, v122, v123
  v_mfma_f32_16x16x32_bf16 v[232:235], a[8:11], v[44:47], v[232:235]
  v_exp_f32 v124, v124
  v_mfma_f32_16x16x32_bf16 v[204:207], a[12:15], v[40:43], v[204:207]
  buffer_load_dwordx4 v2, s[20:23], s29 offen offset:3072 sc1 lds
  ds_read_b128 a[56:59], v3 offset:6144
  v_mfma_f32_16x16x32_bf16 v[236:239], a[12:15], v[44:47], v[236:239]
  s_xor_b32 s27, s27, 0x8000
  v_exp_f32 v125, v125
  v_mfma_f32_16x16x32_bf16 v[208:211], a[16:19], v[40:43], v[208:211]
  s_add_u32 s29, s29, 0x8000
  ds_read_b128 a[60:63], v3 offset:7168
  v_cvt_pk_bf16_f32 v62, v124, v125
  v_mfma_f32_16x16x32_bf16 v[240:243], a[16:19], v[44:47], v[240:243]
  v_exp_f32 v126, v126
  v_mfma_f32_16x16x32_bf16 v[212:215], a[20:23], v[40:43], v[212:215]
  ds_read_b128 a[0:3], v3 offset:8192
  v_mfma_f32_16x16x32_bf16 v[244:247], a[20:23], v[44:47], v[244:247]
  v_exp_f32 v127, v127
  v_mfma_f32_16x16x32_bf16 v[216:219], a[24:27], v[40:43], v[216:219]
  ds_read_b128 a[4:7], v3 offset:9216
  v_cvt_pk_bf16_f32 v63, v126, v127
  v_mfma_f32_16x16x32_bf16 v[248:251], a[24:27], v[44:47], v[248:251]
  v_mfma_f32_16x16x32_bf16 v[220:223], a[28:31], v[40:43], v[220:223]
  s_waitcnt vmcnt(10)
  s_barrier
  v_mfma_f32_16x16x32_bf16 v[252:255], a[28:31], v[44:47], v[252:255]
  ds_read_b128 a[8:11], v3 offset:10240
  s_cmp_eq_u32 s88, 0
  s_cbranch_scc1 La_e0
  s_waitcnt lgkmcnt(3)
  v_mfma_f32_16x16x32_bf16 v[96:99], a[32:35], a[160:163], v[24:27]
  s_mov_b32 m0, s26
  v_exp_f32 v64, v64
  v_mfma_f32_16x16x32_bf16 v[96:99], a[36:39], a[164:167], v[96:99]
  buffer_load_dwordx4 v2, s[20:23], s28 offen offset:0 sc1 lds
  ds_read_b128 a[12:15], v3 offset:11264
  v_mfma_f32_16x16x32_bf16 v[96:99], a[40:43], a[168:171], v[96:99]
  v_exp_f32 v65, v65
  v_mfma_f32_16x16x32_bf16 v[96:99], a[44:47], a[172:175], v[96:99]
  ds_read_b128 a[16:19], v3 offset:12288
  v_cvt_pk_bf16_f32 v32, v64, v65
  v_mfma_f32_16x16x32_bf16 v[104:107], a[32:35], a[176:179], v[28:31]
  v_exp_f32 v66, v66
  v_mfma_f32_16x16x32_bf16 v[104:107], a[36:39], a[180:183], v[104:107]
  ds_read_b128 a[20:23], v3 offset:13312
  v_mfma_f32_16x16x32_bf16 v[104:107], a[40:43], a[184:187], v[104:107]
  v_exp_f32 v67, v67
  v_mfma_f32_16x16x32_bf16 v[104:107], a[44:47], a[188:191], v[104:107]
  ds_read_b128 a[24:27], v3 offset:14336
  v_cvt_pk_bf16_f32 v33, v66, v67
  v_mfma_f32_16x16x32_bf16 v[100:103], a[48:51], a[160:163], v[24:27]
  v_exp_f32 v68, v68
  v_mfma_f32_16x16x32_bf16 v[100:103], a[52:55], a[164:167], v[100:103]
  buffer_load_dwordx4 v2, s[20:23], s28 offen offset:1024 sc1 lds
  ds_read_b128 a[28:31], v3 offset:15360
  v_mfma_f32_16x16x32_bf16 v[100:103], a[56:59], a[168:171], v[100:103]
  v_exp_f32 v69, v69
  v_mfma_f32_16x16x32_bf16 v[100:103], a[60:63], a[172:175], v[100:103]
  ds_read_b128 a[32:35], v4 offset:0
  v_cvt_pk_bf16_f32 v34, v68, v69
  v_mfma_f32_16x16x32_bf16 v[108:111], a[48:51], a[176:179], v[28:31]
  v_exp_f32 v70, v70
  v_mfma_f32_16x16x32_bf16 v[108:111], a[52:55], a[180:183], v[108:111]
  ds_read_b128 a[36:39], v4 offset:1024
  v_mfma_f32_16x16x32_bf16 v[108:111], a[56:59], a[184:187], v[108:111]
  v_exp_f32 v71, v71
  v_mfma_f32_16x16x32_bf16 v[108:111], a[60:63], a[188:191], v[108:111]
  s_waitcnt lgkmcnt(2)
  ds_read_b128 a[40:43], v4 offset:2048
  v_cvt_pk_bf16_f32 v35, v70, v71
  v_mfma_f32_16x16x32_bf16 v[112:115], a[0:3], a[160:163], v[24:27]
  v_exp_f32 v72, v72
  v_mfma_f32_16x16x32_bf16 v[112:115], a[4:7], a[164:167], v[112:115]
  buffer_load_dwordx4 v2, s[20:23], s28 offen offset:2048 sc1 lds
  ds_read_b128 a[44:47], v4 offset:3072
  v_mfma_f32_16x16x32_bf16 v[112:115], a[8:11], a[168:171], v[112:115]
  v_exp_f32 v73, v73
  v_mfma_f32_16x16x32_bf16 v[112:115], a[12:15], a[172:175], v[112:115]
  ds_read_b128 a[48:51], v4 offset:4096
  v_cvt_pk_bf16_f32 v36, v72, v73
  v_mfma_f32_16x16x32_bf16 v[120:123], a[0:3], a[176:179], v[28:31]
  v_exp_f32 v74, v74
  v_mfma_f32_16x16x32_bf16 v[120:123], a[4:7], a[180:183], v[120:123]
  ds_read_b128 a[52:55], v4 offset:5120
  v_mfma_f32_16x16x32_bf16 v[120:123], a[8:11], a[184:187], v[120:123]
  v_exp_f32 v75, v75
  v_mfma_f32_16x16x32_bf16 v[120:123], a[12:15], a[188:191], v[120:123]
  ds_read_b128 a[56:59], v4 offset:6144
  v_cvt_pk_bf16_f32 v37, v74, v75
  v_mfma_f32_16x16x32_bf16 v[116:119], a[16:19], a[160:163], v[24:27]
  v_exp_f32 v76, v76
  v_mfma_f32_16x16x32_bf16 v[116:119], a[20:23], a[164:167], v[116:119]
  buffer_load_dwordx4 v2, s[20:23], s28 offen offset:3072 sc1 lds
  ds_read_b128 a[60:63], v4 offset:7168
  v_mfma_f32_16x16x32_bf16 v[116:119], a[24:27], a[168:171], v[116:119]
  s_xor_b32 s26, s26, 0x4000
  v_exp_f32 v77, v77
  v_mfma_f32_16x16x32_bf16 v[116:119], a[28:31], a[172:175], v[116:119]
  s_add_u32 s28, s28, 0x8000
  s_mov_b32 m0, s27
  ds_read_b128 a[0:3], v4 offset:8192
  v_mfma_f32_16x16x32_bf16 v[124:127], a[16:19], a[176:179], v[28:31]
  v_exp_f32 v78, v78
  v_mfma_f32_16x16x32_bf16 v[124:127], a[20:23], a[180:183], v[124:127]
  ds_read_b128 a[4:7], v4 offset:9216
  v_cvt_pk_bf16_f32 v38, v76, v77
  v_mfma_f32_16x16x32_bf16 v[124:127], a[24:27], a[184:187], v[124:127]
  v_exp_f32 v79, v79
  v_mfma_f32_16x16x32_bf16 v[124:127], a[28:31], a[188:191], v[124:127]
  s_waitcnt lgkmcnt(2)
  ds_read_b128 a[8:11], v4 offset:10240
  v_cvt_pk_bf16_f32 v39, v78, v79
  v_mfma_f32_16x16x32_bf16 v[192:195], a[32:35], v[48:51], v[192:195]
  buffer_load_dwordx4 v2, s[20:23], s29 offen offset:0 sc1 lds
  ds_read_b128 a[12:15], v4 offset:11264
  v_mfma_f32_16x16x32_bf16 v[224:227], a[32:35], v[52:55], v[224:227]
  v_exp_f32 v80, v80
  v_mfma_f32_16x16x32_bf16 a[200:203], a[208:211], v[48:51], a[200:203]
  v_mfma_f32_16x16x32_bf16 v[196:199], a[36:39], v[48:51], v[196:199]
  v_exp_f32 v81, v81
  v_mfma_f32_16x16x32_bf16 v[228:231], a[36:39], v[52:55], v[228:231]
  ds_read_b128 a[16:19], v4 offset:12288
  v_cvt_pk_bf16_f32 v40, v80, v81
  v_mfma_f32_16x16x32_bf16 a[204:207], a[208:211], v[52:55], a[204:207]
  v_exp_f32 v82, v82
  v_mfma_f32_16x16x32_bf16 v[200:203], a[40:43], v[48:51], v[200:203]
  ds_read_b128 a[20:23], v4 offset:13312
  v_mfma_f32_16x16x32_bf16 v[232:235], a[40:43], v[52:55], v[232:235]
  v_exp_f32 v83, v83
  v_mfma_f32_16x16x32_bf16 v[204:207], a[44:47], v[48:51], v[204:207]
  buffer_load_dwordx4 v2, s[20:23], s29 offen offset:1024 sc1 lds
  ds_read_b128 a[24:27], v4 offset:14336
  v_mfma_f32_16x16x32_bf16 v[236:239], a[44:47], v[52:55], v[236:239]
  v_exp_f32 v84, v84
  v_mfma_f32_16x16x32_bf16 v[208:211], a[48:51], v[48:51], v[208:211]
  ds_read_b128 a[28:31], v4 offset:15360
  v_xor_b32 v4, 0x8000, v4
  v_mfma_f32_16x16x32_bf16 v[240:243], a[48:51], v[52:55], v[240:243]
  v_exp_f32 v85, v85
  v_mfma_f32_16x16x32_bf16 v[212:215], a[52:55], v[48:51], v[212:215]
  v_xor_b32 v3, 0x8000, v3
  v_cvt_pk_bf16_f32 v41, v82, v83
  v_mfma_f32_16x16x32_bf16 v[244:247], a[52:55], v[52:55], v[244:247]
  v_exp_f32 v86, v86
  v_mfma_f32_16x16x32_bf16 v[216:219], a[56:59], v[48:51], v[216:219]
  ds_read_b128 a[32:35], v3 offset:0
  ds_read_b128 a[36:39], v3 offset:1024
  v_mfma_f32_16x16x32_bf16 v[248:251], a[56:59], v[52:55], v[248:251]
  v_exp_f32 v87, v87
  v_mfma_f32_16x16x32_bf16 v[220:223], a[60:63], v[48:51], v[220:223]
  buffer_load_dwordx4 v2, s[20:23], s29 offen offset:2048 sc1 lds
  ds_read_b128 a[40:43], v3 offset:2048
  v_mfma_f32_16x16x32_bf16 v[252:255], a[60:63], v[52:55], v[252:255]
  s_waitcnt lgkmcnt(3)
  v_exp_f32 v88, v88
  v_mfma_f32_16x16x32_bf16 v[192:195], a[0:3], v[56:59], v[192:195]
  ds_read_b128 a[44:47], v3 offset:3072
  v_cvt_pk_bf16_f32 v42, v84, v85
  v_mfma_f32_16x16x32_bf16 v[224:227], a[0:3], v[60:63], v[224:227]
  v_exp_f32 v89, v89
  v_mfma_f32_16x16x32_bf16 a[200:203], a[208:211], v[56:59], a[200:203]
  v_cvt_pk_bf16_f32 v43, v86, v87
  v_cvt_pk_bf16_f32 v44, v88, v89
  v_mfma_f32_16x16x32_bf16 v[196:199], a[4:7], v[56:59], v[196:199]
  v_exp_f32 v90, v90
  v_mfma_f32_16x16x32_bf16 v[228:231], a[4:7], v[60:63], v[228:231]
  ds_read_b128 a[48:51], v3 offset:4096
  v_mfma_f32_16x16x32_bf16 a[204:207], a[208:211], v[60:63], a[204:207]
  v_exp_f32 v91, v91
  v_mfma_f32_16x16x32_bf16 v[200:203], a[8:11], v[56:59], v[200:203]
  buffer_load_dwordx4 v2, s[20:23], s29 offen offset:3072 sc1 lds
  ds_read_b128 a[52:55], v3 offset:5120
  v_mfma_f32_16x16x32_bf16 v[232:235], a[8:11], v[60:63], v[232:235]
  s_xor_b32 s27, s27, 0x4000
  v_exp_f32 v92, v92
  v_mfma_f32_16x16x32_bf16 v[204:207], a[12:15], v[56:59], v[204:207]
  s_add_u32 s29, s29, 0x8000
  ds_read_b128 a[56:59], v3 offset:6144
  v_cvt_pk_bf16_f32 v45, v90, v91
  v_mfma_f32_16x16x32_bf16 v[236:239], a[12:15], v[60:63], v[236:239]
  v_exp_f32 v93, v93
  v_mfma_f32_16x16x32_bf16 v[208:211], a[16:19], v[56:59], v[208:211]
  ds_read_b128 a[60:63], v3 offset:7168
  v_cvt_pk_bf16_f32 v46, v92, v93
  v_mfma_f32_16x16x32_bf16 v[240:243], a[16:19], v[60:63], v[240:243]
  v_exp_f32 v94, v94
  v_mfma_f32_16x16x32_bf16 v[212:215], a[20:23], v[56:59], v[212:215]
  ds_read_b128 a[0:3], v3 offset:8192
  v_mfma_f32_16x16x32_bf16 v[244:247], a[20:23], v[60:63], v[244:247]
  v_exp_f32 v95, v95
  v_mfma_f32_16x16x32_bf16 v[216:219], a[24:27], v[56:59], v[216:219]
  ds_read_b128 a[4:7], v3 offset:9216
  v_cvt_pk_bf16_f32 v47, v94, v95
  v_mfma_f32_16x16x32_bf16 v[248:251], a[24:27], v[60:63], v[248:251]
  v_mfma_f32_16x16x32_bf16 v[220:223], a[28:31], v[56:59], v[220:223]
  s_waitcnt vmcnt(12)
  s_barrier
  v_mfma_f32_16x16x32_bf16 v[252:255], a[28:31], v[60:63], v[252:255]
  ds_read_b128 a[8:11], v3 offset:10240
  s_branch La_so
La_e0:
  s_waitcnt lgkmcnt(7)
  v_mfma_f32_16x16x32_bf16 v[104:107], a[32:35], a[176:179], v[28:31]
  buffer_load_dwordx2 v[12:13], v14, s[96:99], s91 offen sc1
  ds_read_b128 a[12:15], v3 offset:11264
  v_mfma_f32_16x16x32_bf16 v[104:107], a[36:39], a[180:183], v[104:107]
  v_cndmask_b32 v64, v64, v5, s[32:33]
  v_exp_f32 v64, v64
  v_mfma_f32_16x16x32_bf16 v[104:107], a[40:43], a[184:187], v[104:107]
  v_cndmask_b32 v65, v65, v5, s[34:35]
  v_exp_f32 v65, v65
  v_mfma_f32_16x16x32_bf16 v[104:107], a[44:47], a[188:191], v[104:107]
  s_waitcnt lgkmcnt(4)
  v_cndmask_b32 v66, v66, v5, s[36:37]
  v_exp_f32 v66, v66
  v_mfma_f32_16x16x32_bf16 v[108:111], a[48:51], a[176:179], v[28:31]
  v_cndmask_b32 v67, v67, v5, s[38:39]
  v_exp_f32 v67, v67
  v_mfma_f32_16x16x32_bf16 v[108:111], a[52:55], a[180:183], v[108:111]
  ds_read_b128 a[16:19], v3 offset:12288
  ds_read_b128 a[20:23], v3 offset:13312
  v_mfma_f32_16x16x32_bf16 v[108:111], a[56:59], a[184:187], v[108:111]
  v_cndmask_b32 v68, v68, v5, s[40:41]
  v_exp_f32 v68, v68
  v_mfma_f32_16x16x32_bf16 v[108:111], a[60:63], a[188:191], v[108:111]
  s_waitcnt lgkmcnt(2)
  v_cndmask_b32 v69, v69, v5, s[42:43]
  v_exp_f32 v69, v69
  v_mfma_f32_16x16x32_bf16 v[120:123], a[0:3], a[176:179], v[28:31]
  ds_read_b128 a[24:27], v3 offset:14336
  ds_read_b128 a[28:31], v3 offset:15360
  v_mfma_f32_16x16x32_bf16 v[120:123], a[4:7], a[180:183], v[120:123]
  v_cndmask_b32 v70, v70, v5, s[44:45]
  v_exp_f32 v70, v70
  v_mfma_f32_16x16x32_bf16 v[120:123], a[8:11], a[184:187], v[120:123]
  v_cndmask_b32 v71, v71, v5, s[46:47]
  v_exp_f32 v71, v71
  v_mfma_f32_16x16x32_bf16 v[120:123], a[12:15], a[188:191], v[120:123]
  s_waitcnt lgkmcnt(0)
  ds_read_b128 a[32:35], v4 offset:0
  ds_read_b128 a[36:39], v4 offset:1024
  v_mfma_f32_16x16x32_bf16 v[124:127], a[16:19], a[176:179], v[28:31]
  v_exp_f32 v72, v72
  v_mfma_f32_16x16x32_bf16 v[124:127], a[20:23], a[180:183], v[124:127]
  ds_read_b128 a[40:43], v4 offset:2048
  ds_read_b128 a[44:47], v4 offset:3072
  ds_read_b128 a[48:51], v4 offset:4096
  v_mfma_f32_16x16x32_bf16 v[124:127], a[24:27], a[184:187], v[124:127]
  ds_read_b128 a[52:55], v4 offset:5120
  ds_read_b128 a[56:59], v4 offset:6144
  ds_read_b128 a[60:63], v4 offset:7168
  v_exp_f32 v73, v73
  v_mfma_f32_16x16x32_bf16 v[124:127], a[28:31], a[188:191], v[124:127]
  s_waitcnt lgkmcnt(0)
  v_exp_f32 v74, v74
  v_mfma_f32_16x16x32_bf16 v[192:195], a[32:35], v[48:51], v[192:195]
  ds_read_b128 a[0:3], v4 offset:8192
  ds_read_b128 a[4:7], v4 offset:9216
  v_mfma_f32_16x16x32_bf16 v[224:227], a[32:35], v[52:55], v[224:227]
  v_exp_f32 v75, v75
  v_mfma_f32_16x16x32_bf16 a[200:203], a[208:211], v[48:51], a[200:203]
  v_exp_f32 v76, v76
  v_mfma_f32_16x16x32_bf16 v[196:199], a[36:39], v[48:51], v[196:199]
  ds_read_b128 a[8:11], v4 offset:10240
  ds_read_b128 a[12:15], v4 offset:11264
  v_mfma_f32_16x16x32_bf16 v[228:231], a[36:39], v[52:55], v[228:231]
  v_exp_f32 v77, v77
  v_mfma_f32_16x16x32_bf16 a[204:207], a[208:211], v[52:55], a[204:207]
  v_exp_f32 v78, v78
  v_mfma_f32_16x16x32_bf16 v[200:203], a[40:43], v[48:51], v[200:203]
  ds_read_b128 a[16:19], v4 offset:12288
  ds_read_b128 a[20:23], v4 offset:13312
  v_mfma_f32_16x16x32_bf16 v[232:235], a[40:43], v[52:55], v[232:235]
  v_exp_f32 v79, v79
  v_mfma_f32_16x16x32_bf16 v[204:207], a[44:47], v[48:51], v[204:207]
  ds_read_b128 a[24:27], v4 offset:14336
  v_cvt_pk_bf16_f32 v32, v64, v65
  v_mfma_f32_16x16x32_bf16 v[236:239], a[44:47], v[52:55], v[236:239]
  v_cndmask_b32 v80, v80, v5, s[48:49]
  v_exp_f32 v80, v80
  v_mfma_f32_16x16x32_bf16 v[208:211], a[48:51], v[48:51], v[208:211]
  v_cndmask_b32 v81, v81, v5, s[50:51]
  v_exp_f32 v81, v81
  v_mfma_f32_16x16x32_bf16 v[240:243], a[48:51], v[52:55], v[240:243]
  ds_read_b128 a[28:31], v4 offset:15360
  v_xor_b32 v4, 0x8000, v4
  v_cvt_pk_bf16_f32 v40, v80, v81
  v_mfma_f32_16x16x32_bf16 v[212:215], a[52:55], v[48:51], v[212:215]
  v_cndmask_b32 v82, v82, v5, s[52:53]
  v_exp_f32 v82, v82
  v_mfma_f32_16x16x32_bf16 v[244:247], a[52:55], v[52:55], v[244:247]
  v_cndmask_b32 v83, v83, v5, s[54:55]
  v_exp_f32 v83, v83
  v_mfma_f32_16x16x32_bf16 v[216:219], a[56:59], v[48:51], v[216:219]
  ds_read_b128 a[32:35], v4 offset:0
  ds_read_b128 a[36:39], v4 offset:1024
  v_cvt_pk_bf16_f32 v41, v82, v83
  v_mfma_f32_16x16x32_bf16 v[248:251], a[56:59], v[52:55], v[248:251]
  v_cndmask_b32 v84, v84, v5, s[56:57]
  v_exp_f32 v84, v84
  v_mfma_f32_16x16x32_bf16 v[220:223], a[60:63], v[48:51], v[220:223]
  v_cndmask_b32 v85, v85, v5, s[58:59]
  v_exp_f32 v85, v85
  v_mfma_f32_16x16x32_bf16 v[252:255], a[60:63], v[52:55], v[252:255]
  s_waitcnt lgkmcnt(2)
  ds_read_b128 a[40:43], v4 offset:2048
  v_cvt_pk_bf16_f32 v33, v66, v67
  v_cvt_pk_bf16_f32 v42, v84, v85
  v_mfma_f32_16x16x32_bf16 v[192:195], a[0:3], v[56:59], v[192:195]
  v_cndmask_b32 v86, v86, v5, s[60:61]
  v_exp_f32 v86, v86
  v_mfma_f32_16x16x32_bf16 v[224:227], a[0:3], v[60:63], v[224:227]
  v_cndmask_b32 v87, v87, v5, s[62:63]
  v_exp_f32 v87, v87
  v_mfma_f32_16x16x32_bf16 a[200:203], a[208:211], v[56:59], a[200:203]
  ds_read_b128 a[44:47], v4 offset:3072
  v_cvt_pk_bf16_f32 v34, v68, v69
  v_cvt_pk_bf16_f32 v43, v86, v87
  v_mfma_f32_16x16x32_bf16 v[196:199], a[4:7], v[56:59], v[196:199]
  v_exp_f32 v88, v88
  v_mfma_f32_16x16x32_bf16 v[228:231], a[4:7], v[60:63], v[228:231]
  ds_read_b128 a[48:51], v4 offset:4096
  v_cvt_pk_bf16_f32 v35, v70, v71
  v_mfma_f32_16x16x32_bf16 a[204:207], a[208:211], v[60:63], a[204:207]
  v_exp_f32 v89, v89
  v_mfma_f32_16x16x32_bf16 v[200:203], a[8:11], v[56:59], v[200:203]
  v_exp_f32 v90, v90
  v_cvt_pk_bf16_f32 v44, v88, v89
  v_mfma_f32_16x16x32_bf16 v[232:235], a[8:11], v[60:63], v[232:235]
  ds_read_b128 a[52:55], v4 offset:5120
  v_cvt_pk_bf16_f32 v36, v72, v73
  v_mfma_f32_16x16x32_bf16 v[204:207], a[12:15], v[56:59], v[204:207]
  v_exp_f32 v91, v91
  v_mfma_f32_16x16x32_bf16 v[236:239], a[12:15], v[60:63], v[236:239]
  v_exp_f32 v92, v92
  v_cvt_pk_bf16_f32 v45, v90, v91
  v_mfma_f32_16x16x32_bf16 v[208:211], a[16:19], v[56:59], v[208:211]
  ds_read_b128 a[56:59], v4 offset:6144
  ds_read_b128 a[60:63], v4 offset:7168
  v_mfma_f32_16x16x32_bf16 v[240:243], a[16:19], v[60:63], v[240:243]
  v_exp_f32 v93, v93
  v_mfma_f32_16x16x32_bf16 v[212:215], a[20:23], v[56:59], v[212:215]
  v_exp_f32 v94, v94
  v_cvt_pk_bf16_f32 v46, v92, v93
  v_mfma_f32_16x16x32_bf16 v[244:247], a[20:23], v[60:63], v[244:247]
  ds_read_b128 a[0:3], v4 offset:8192
  v_cvt_pk_bf16_f32 v37, v74, v75
  v_mfma_f32_16x16x32_bf16 v[216:219], a[24:27], v[56:59], v[216:219]
  v_exp_f32 v95, v95
  v_mfma_f32_16x16x32_bf16 v[248:251], a[24:27], v[60:63], v[248:251]
  ds_read_b128 a[4:7], v4 offset:9216
  v_cvt_pk_bf16_f32 v38, v76, v77
  v_cvt_pk_bf16_f32 v47, v94, v95
  v_mfma_f32_16x16x32_bf16 v[220:223], a[28:31], v[56:59], v[220:223]
  s_waitcnt vmcnt(0)
  s_barrier
  v_mfma_f32_16x16x32_bf16 v[252:255], a[28:31], v[60:63], v[252:255]
  ds_read_b128 a[8:11], v4 offset:10240
  v_cvt_pk_bf16_f32 v39, v78, v79
La_e1:
  s_mov_b32 s5, 0x40000
Lpoll_7:
  v_cmp_ne_u64 vcc, s[94:95], v[12:13]
  s_nop 0
  s_cbranch_vccz Lpolld_8
  s_sleep 4
  buffer_load_dwordx2 v[12:13], v14, s[96:99], s91 offen sc1
  s_sub_u32 s5, s5, 1
  s_waitcnt vmcnt(0)
  s_cbranch_scc0 Lpoll_7
Lpolld_8:
  s_add_u32 s64, s79, 131072
  v_accvgpr_read_b32 v10, a212
  v_accvgpr_read_b32 v11, a213
  v_accvgpr_read_b32 v12, a214
  v_accvgpr_read_b32 v13, a215
  s_mov_b32 s12, s80
  s_mov_b32 s13, s81
  s_mov_b32 s14, 2097152
  s_mov_b32 s15, 0x00020000
  s_lshl_b32 s93, s77, 20
  s_lshl_b32 s72, s76, 8
  s_add_u32 s93, s93, s72
  s_add_u32 s72, s73, s76
  s_and_b32 s31, s72, 3
  s_lshl_b32 s31, s31, 3
  s_or_b32 s31, s31, 0x80000
  s_bfe_u32 s30, 0x70702, s31
  s_add_u32 s30, s30, 0
  s_and_b32 s30, s30, 7
  s_lshl_b32 s72, s30, 17
  s_add_u32 s71, s93, s72
  s_add_u32 s8, s86, 83886080
  s_addc_u32 s9, s87, 0
  s_mov_b32 s10, 4194304
  s_mov_b32 s11, 0x00020000
  s_lshl_b32 s92, s73, 1
  s_add_u32 s92, s92, s77
  s_lshl_b32 s92, s92, 17
  s_add_u32 s92, s92, s79
  s_add_u32 s72, s73, s76
  s_and_b32 s1, s72, 3
  s_lshl_b32 s1, s1, 3
  s_or_b32 s1, s1, 0x80000
  s_bfe_u32 s0, 0x70702, s1
  s_add_u32 s0, s0, 0
  s_and_b32 s0, s0, 7
  s_lshl_b32 s72, s0, 14
  s_add_u32 s70, s92, s72
  s_waitcnt lgkmcnt(3)
  v_mfma_f32_16x16x32_bf16 v[192:195], a[32:35], v[32:35], v[192:195]
  s_add_u32 m0, s79, 147456
  ds_read_b128 a[12:15], v4 offset:11264
  v_cndmask_b32 v104, v104, v5, s[32:33]
  v_mfma_f32_16x16x32_bf16 v[224:227], a[32:35], v[36:39], v[224:227]
  v_exp_f32 v104, v104
  v_mfma_f32_16x16x32_bf16 a[200:203], a[208:211], v[32:35], a[200:203]
  v_cndmask_b32 v105, v105, v5, s[34:35]
  v_exp_f32 v105, v105
  v_mfma_f32_16x16x32_bf16 v[196:199], a[36:39], v[32:35], v[196:199]
  buffer_load_dwordx4 v10, s[12:15], s71 offen offset:0 lds
  ds_read_b128 a[16:19], v4 offset:12288
  v_mfma_f32_16x16x32_bf16 v[228:231], a[36:39], v[36:39], v[228:231]
  v_cndmask_b32 v106, v106, v5, s[36:37]
  v_exp_f32 v106, v106
  v_mfma_f32_16x16x32_bf16 a[204:207], a[208:211], v[36:39], a[204:207]
  buffer_load_dwordx4 v11, s[12:15], s71 offen offset:1024 lds
  v_cndmask_b32 v107, v107, v5, s[38:39]
  v_mfma_f32_16x16x32_bf16 v[200:203], a[40:43], v[32:35], v[200:203]
  v_exp_f32 v107, v107
  v_mfma_f32_16x16x32_bf16 v[232:235], a[40:43], v[36:39], v[232:235]
  ds_read_b128 a[20:23], v4 offset:13312
  v_cndmask_b32 v108, v108, v5, s[40:41]
  v_mfma_f32_16x16x32_bf16 v[204:207], a[44:47], v[32:35], v[204:207]
  v_exp_f32 v108, v108
  v_mfma_f32_16x16x32_bf16 v[236:239], a[44:47], v[36:39], v[236:239]
  buffer_load_dwordx4 v12, s[12:15], s71 offen offset:2048 lds
  ds_read_b128 a[24:27], v4 offset:14336
  v_mfma_f32_16x16x32_bf16 v[208:211], a[48:51], v[32:35], v[208:211]
  v_cndmask_b32 v109, v109, v5, s[42:43]
  v_exp_f32 v109, v109
  v_mfma_f32_16x16x32_bf16 v[240:243], a[48:51], v[36:39], v[240:243]
  ds_read_b128 a[28:31], v4 offset:15360
  v_xor_b32 v4, 0x4000, v4
  v_mfma_f32_16x16x32_bf16 v[212:215], a[52:55], v[32:35], v[212:215]
  v_cndmask_b32 v110, v110, v5, s[44:45]
  v_exp_f32 v110, v110
  v_mfma_f32_16x16x32_bf16 v[244:247], a[52:55], v[36:39], v[244:247]
  buffer_load_dwordx4 v13, s[12:15], s71 offen offset:3072 lds
  ds_read_b128 a[32:35], v4 offset:0
  v_mfma_f32_16x16x32_bf16 v[216:219], a[56:59], v[32:35], v[216:219]
  s_bfe_u32 s72, 0x3020106, s31
  v_cndmask_b32 v111, v111, v5, s[46:47]
  v_exp_f32 v111, v111
  v_mfma_f32_16x16x32_bf16 v[248:251], a[56:59], v[36:39], v[248:251]
  s_add_u32 s30, s30, s72
  s_add_u32 s31, s31, 8
  s_and_b32 s31, s31, 0x8001f
  v_mfma_f32_16x16x32_bf16 v[220:223], a[60:63], v[32:35], v[220:223]
  s_and_b32 s30, s30, 7
  s_lshl_b32 s72, s30, 17
  s_add_u32 s71, s93, s72
  v_mfma_f32_16x16x32_bf16 v[252:255], a[60:63], v[36:39], v[252:255]
  s_waitcnt lgkmcnt(1)
  v_cndmask_b32 v120, v120, v5, s[48:49]
  v_exp_f32 v120, v120
  v_mfma_f32_16x16x32_bf16 v[192:195], a[0:3], v[40:43], v[192:195]
  s_add_u32 m0, s79, 131072
  ds_read_b128 a[36:39], v4 offset:1024
  ds_read_b128 a[40:43], v4 offset:2048
  v_mfma_f32_16x16x32_bf16 v[224:227], a[0:3], v[44:47], v[224:227]
  v_cndmask_b32 v121, v121, v5, s[50:51]
  v_exp_f32 v121, v121
  v_mfma_f32_16x16x32_bf16 a[200:203], a[208:211], v[40:43], a[200:203]
  buffer_load_dwordx4 v2, s[8:11], s70 offen offset:0 sc1 lds
  ds_read_b128 a[44:47], v4 offset:3072
  v_mfma_f32_16x16x32_bf16 v[196:199], a[4:7], v[40:43], v[196:199]
  v_cndmask_b32 v122, v122, v5, s[52:53]
  v_exp_f32 v122, v122
  v_mfma_f32_16x16x32_bf16 v[228:231], a[4:7], v[44:47], v[228:231]
  buffer_load_dwordx4 v2, s[8:11], s70 offen offset:1024 sc1 lds
  ds_read_b128 a[48:51], v4 offset:4096
  v_mfma_f32_16x16x32_bf16 a[204:207], a[208:211], v[44:47], a[204:207]
  v_cndmask_b32 v123, v123, v5, s[54:55]
  v_exp_f32 v123, v123
  v_mfma_f32_16x16x32_bf16 v[200:203], a[8:11], v[40:43], v[200:203]
  buffer_load_dwordx4 v2, s[8:11], s70 offen offset:2048 sc1 lds
  ds_read_b128 a[52:55], v4 offset:5120
  v_cvt_pk_bf16_f32 v61, v122, v123
  v_mfma_f32_16x16x32_bf16 v[232:235], a[8:11], v[44:47], v[232:235]
  v_cndmask_b32 v124, v124, v5, s[56:57]
  v_exp_f32 v124, v124
  v_mfma_f32_16x16x32_bf16 v[204:207], a[12:15], v[40:43], v[204:207]
  ds_read_b128 a[56:59], v4 offset:6144
  v_cvt_pk_bf16_f32 v52, v104, v105
  v_mfma_f32_16x16x32_bf16 v[236:239], a[12:15], v[44:47], v[236:239]
  v_cndmask_b32 v125, v125, v5, s[58:59]
  v_exp_f32 v125, v125
  v_mfma_f32_16x16x32_bf16 v[208:211], a[16:19], v[40:43], v[208:211]
  buffer_load_dwordx4 v2, s[8:11], s70 offen offset:3072 sc1 lds
  ds_read_b128 a[60:63], v4 offset:7168
  v_cvt_pk_bf16_f32 v62, v124, v125
  v_mfma_f32_16x16x32_bf16 v[240:243], a[16:19], v[44:47], v[240:243]
  s_bfe_u32 s72, 0x3020106, s1
  v_cndmask_b32 v126, v126, v5, s[60:61]
  v_exp_f32 v126, v126
  v_mfma_f32_16x16x32_bf16 v[212:215], a[20:23], v[40:43], v[212:215]
  s_add_u32 s0, s0, s72
  s_add_u32 s1, s1, 8
  s_and_b32 s1, s1, 0x8001f
  v_mfma_f32_16x16x32_bf16 v[244:247], a[20:23], v[44:47], v[244:247]
  s_and_b32 s0, s0, 7
  v_cndmask_b32 v127, v127, v5, s[62:63]
  v_exp_f32 v127, v127
  v_mfma_f32_16x16x32_bf16 v[216:219], a[24:27], v[40:43], v[216:219]
  s_lshl_b32 s72, s0, 14
  s_add_u32 s70, s92, s72
  ds_read_b128 a[0:3], v4 offset:8192
  v_cvt_pk_bf16_f32 v63, v126, v127
  v_mfma_f32_16x16x32_bf16 v[248:251], a[24:27], v[44:47], v[248:251]
  ds_read_b128 a[4:7], v4 offset:9216
  v_cvt_pk_bf16_f32 v53, v106, v107
  v_mfma_f32_16x16x32_bf16 v[220:223], a[28:31], v[40:43], v[220:223]
  ds_read_b128 a[8:11], v4 offset:10240
  v_cvt_pk_bf16_f32 v54, v108, v109
  v_mfma_f32_16x16x32_bf16 v[252:255], a[28:31], v[44:47], v[252:255]
  v_cvt_pk_bf16_f32 v55, v110, v111
  v_cvt_pk_bf16_f32 v60, v120, v121
  s_waitcnt lgkmcnt(7)
  v_mfma_f32_16x16x32_bf16 v[224:227], a[32:35], v[52:55], v[224:227]
  s_add_u32 m0, s79, 49152
  ds_read_b128 a[12:15], v4 offset:11264
  v_mfma_f32_16x16x32_bf16 a[204:207], a[208:211], v[52:55], a[204:207]
  buffer_load_dwordx4 v10, s[12:15], s71 offen offset:0 lds
  v_mfma_f32_16x16x32_bf16 v[228:231], a[36:39], v[52:55], v[228:231]
  buffer_load_dwordx4 v11, s[12:15], s71 offen offset:1024 lds
  ds_read_b128 a[16:19], v4 offset:12288
  v_mfma_f32_16x16x32_bf16 v[232:235], a[40:43], v[52:55], v[232:235]
  buffer_load_dwordx4 v12, s[12:15], s71 offen offset:2048 lds
  ds_read_b128 a[20:23], v4 offset:13312
  v_mfma_f32_16x16x32_bf16 v[236:239], a[44:47], v[52:55], v[236:239]
  s_waitcnt lgkmcnt(6)
  ds_read_b128 a[24:27], v4 offset:14336
  v_mfma_f32_16x16x32_bf16 v[240:243], a[48:51], v[52:55], v[240:243]
  buffer_load_dwordx4 v13, s[12:15], s71 offen offset:3072 lds
  ds_read_b128 a[28:31], v4 offset:15360
  v_mfma_f32_16x16x32_bf16 v[244:247], a[52:55], v[52:55], v[244:247]
  s_bfe_u32 s72, 0x3020106, s31
  s_add_u32 s30, s30, s72
  s_add_u32 s31, s31, 8
  v_mfma_f32_16x16x32_bf16 v[248:251], a[56:59], v[52:55], v[248:251]
  s_and_b32 s31, s31, 0x8001f
  s_and_b32 s30, s30, 7
  s_lshl_b32 s72, s30, 17
  v_mfma_f32_16x16x32_bf16 v[252:255], a[60:63], v[52:55], v[252:255]
  s_waitcnt lgkmcnt(4)
  s_add_u32 s71, s93, s72
  s_add_u32 m0, s79, 32768
  v_mfma_f32_16x16x32_bf16 v[224:227], a[0:3], v[60:63], v[224:227]
  buffer_load_dwordx4 v2, s[8:11], s70 offen offset:0 sc1 lds
  v_mfma_f32_16x16x32_bf16 a[204:207], a[208:211], v[60:63], a[204:207]
  buffer_load_dwordx4 v2, s[8:11], s70 offen offset:1024 sc1 lds
  v_mfma_f32_16x16x32_bf16 v[228:231], a[4:7], v[60:63], v[228:231]
  buffer_load_dwordx4 v2, s[8:11], s70 offen offset:2048 sc1 lds
  v_mfma_f32_16x16x32_bf16 v[232:235], a[8:11], v[60:63], v[232:235]
  buffer_load_dwordx4 v2, s[8:11], s70 offen offset:3072 sc1 lds
  v_mfma_f32_16x16x32_bf16 v[236:239], a[12:15], v[60:63], v[236:239]
  s_waitcnt lgkmcnt(0)
  s_bfe_u32 s72, 0x3020106, s1
  s_add_u32 s0, s0, s72
  v_mfma_f32_16x16x32_bf16 v[240:243], a[16:19], v[60:63], v[240:243]
  s_add_u32 s1, s1, 8
  s_and_b32 s1, s1, 0x8001f
  s_and_b32 s0, s0, 7
  v_mfma_f32_16x16x32_bf16 v[244:247], a[20:23], v[60:63], v[244:247]
  s_lshl_b32 s72, s0, 14
  s_add_u32 s70, s92, s72
  v_mfma_f32_16x16x32_bf16 v[248:251], a[24:27], v[60:63], v[248:251]
  v_mfma_f32_16x16x32_bf16 v[252:255], a[28:31], v[60:63], v[252:255]
  s_and_b32 s88, s25, 1
  s_lshl_b32 s88, s88, 1
  s_add_u32 s88, s88, 14
  s_sub_u32 s88, s88, s25
  s_lshl_b32 s4, s88, 20
  s_lshl_b32 s5, s24, 15
  s_add_u32 s4, s4, s5
  s_lshl_b32 s5, s3, 11
  s_add_u32 s4, s4, s5
  v_accvgpr_read_b32 v6, a200
  v_accvgpr_read_b32 v8, a204
  s_mov_b32 s5, 0x5f800000
  v_cmp_ngt_f32 vcc, s5, v6
  v_rcp_f32 v6, v6
  s_or_b32 s89, s89, vcc_lo
  s_or_b32 s89, s89, vcc_hi
  v_mov_b32 v7, v6
  v_cmp_ngt_f32 vcc, s5, v8
  v_rcp_f32 v8, v8
  s_or_b32 s89, s89, vcc_lo
  s_or_b32 s89, s89, vcc_hi
  v_mov_b32 v9, v8
  v_pk_mul_f32 v[192:193], v[192:193], v[6:7]
  v_pk_mul_f32 v[194:195], v[194:195], v[6:7]
  v_pk_mul_f32 v[196:197], v[196:197], v[6:7]
  v_pk_mul_f32 v[198:199], v[198:199], v[6:7]
  v_cvt_pk_bf16_f32 v192, v192, v193
  v_cvt_pk_bf16_f32 v193, v194, v195
  v_cvt_pk_bf16_f32 v194, v196, v197
  v_cvt_pk_bf16_f32 v195, v198, v199
  buffer_store_dwordx4 v[192:195], v2, s[16:19], s4 offen offset:0 sc1
  v_pk_mul_f32 v[224:225], v[224:225], v[8:9]
  v_pk_mul_f32 v[226:227], v[226:227], v[8:9]
  v_pk_mul_f32 v[228:229], v[228:229], v[8:9]
  v_pk_mul_f32 v[230:231], v[230:231], v[8:9]
  v_cvt_pk_bf16_f32 v224, v224, v225
  v_cvt_pk_bf16_f32 v225, v226, v227
  v_cvt_pk_bf16_f32 v226, v228, v229
  v_cvt_pk_bf16_f32 v227, v230, v231
  buffer_store_dwordx4 v[224:227], v2, s[16:19], s4 offen offset:1024 sc1
  s_add_u32 s4, s4, 8192
  v_pk_mul_f32 v[200:201], v[200:201], v[6:7]
  v_pk_mul_f32 v[202:203], v[202:203], v[6:7]
  v_pk_mul_f32 v[204:205], v[204:205], v[6:7]
  v_pk_mul_f32 v[206:207], v[206:207], v[6:7]
  v_cvt_pk_bf16_f32 v200, v200, v201
  v_cvt_pk_bf16_f32 v201, v202, v203
  v_cvt_pk_bf16_f32 v202, v204, v205
  v_cvt_pk_bf16_f32 v203, v206, v207
  buffer_store_dwordx4 v[200:203], v2, s[16:19], s4 offen offset:0 sc1
  v_pk_mul_f32 v[232:233], v[232:233], v[8:9]
  v_pk_mul_f32 v[234:235], v[234:235], v[8:9]
  v_pk_mul_f32 v[236:237], v[236:237], v[8:9]
  v_pk_mul_f32 v[238:239], v[238:239], v[8:9]
  v_cvt_pk_bf16_f32 v232, v232, v233
  v_cvt_pk_bf16_f32 v233, v234, v235
  v_cvt_pk_bf16_f32 v234, v236, v237
  v_cvt_pk_bf16_f32 v235, v238, v239
  buffer_store_dwordx4 v[232:235], v2, s[16:19], s4 offen offset:1024 sc1
  s_add_u32 s4, s4, 8192
  v_pk_mul_f32 v[208:209], v[208:209], v[6:7]
  v_pk_mul_f32 v[210:211], v[210:211], v[6:7]
  v_pk_mul_f32 v[212:213], v[212:213], v[6:7]
  v_pk_mul_f32 v[214:215], v[214:215], v[6:7]
  v_cvt_pk_bf16_f32 v208, v208, v209
  v_cvt_pk_bf16_f32 v209, v210, v211
  v_cvt_pk_bf16_f32 v210, v212, v213
  v_cvt_pk_bf16_f32 v211, v214, v215
  buffer_store_dwordx4 v[208:211], v2, s[16:19], s4 offen offset:0 sc1
  v_pk_mul_f32 v[240:241], v[240:241], v[8:9]
  v_pk_mul_f32 v[242:243], v[242:243], v[8:9]
  v_pk_mul_f32 v[244:245], v[244:245], v[8:9]
  v_pk_mul_f32 v[246:247], v[246:247], v[8:9]
  v_cvt_pk_bf16_f32 v240, v240, v241
  v_cvt_pk_bf16_f32 v241, v242, v243
  v_cvt_pk_bf16_f32 v242, v244, v245
  v_cvt_pk_bf16_f32 v243, v246, v247
  buffer_store_dwordx4 v[240:243], v2, s[16:19], s4 offen offset:1024 sc1
  s_add_u32 s4, s4, 8192
  v_pk_mul_f32 v[216:217], v[216:217], v[6:7]
  v_pk_mul_f32 v[218:219], v[218:219], v[6:7]
  v_pk_mul_f32 v[220:221], v[220:221], v[6:7]
  v_pk_mul_f32 v[222:223], v[222:223], v[6:7]
  v_cvt_pk_bf16_f32 v216, v216, v217
  v_cvt_pk_bf16_f32 v217, v218, v219
  v_cvt_pk_bf16_f32 v218, v220, v221
  v_cvt_pk_bf16_f32 v219, v222, v223
  buffer_store_dwordx4 v[216:219], v2, s[16:19], s4 offen offset:0 sc1
  v_pk_mul_f32 v[248:249], v[248:249], v[8:9]
  v_pk_mul_f32 v[250:251], v[250:251], v[8:9]
  v_pk_mul_f32 v[252:253], v[252:253], v[8:9]
  v_pk_mul_f32 v[254:255], v[254:255], v[8:9]
  v_cvt_pk_bf16_f32 v248, v248, v249
  v_cvt_pk_bf16_f32 v249, v250, v251
  v_cvt_pk_bf16_f32 v250, v252, v253
  v_cvt_pk_bf16_f32 v251, v254, v255
  buffer_store_dwordx4 v[248:251], v2, s[16:19], s4 offen offset:1024 sc1
  s_cmp_eq_u32 s89, 0
  s_cbranch_scc1 La_done
  s_waitcnt vmcnt(0)
  s_and_b32 s6, s25, 1
  s_lshl_b32 s6, s6, 1
  s_add_u32 s6, s6, 14
  s_sub_u32 s6, s6, s25
La_sl_blk:
  v_mov_b32 v192, 0
  v_mov_b32 v193, 0
  v_mov_b32 v194, 0
  v_mov_b32 v195, 0
  v_mov_b32 v196, 0
  v_mov_b32 v197, 0
  v_mov_b32 v198, 0
  v_mov_b32 v199, 0
  v_mov_b32 v200, 0
  v_mov_b32 v201, 0
  v_mov_b32 v202, 0
  v_mov_b32 v203, 0
  v_mov_b32 v204, 0
  v_mov_b32 v205, 0
  v_mov_b32 v206, 0
  v_mov_b32 v207, 0
  v_mov_b32 v208, 0
  v_mov_b32 v209, 0
  v_mov_b32 v210, 0
  v_mov_b32 v211, 0
  v_mov_b32 v212, 0
  v_mov_b32 v213, 0
  v_mov_b32 v214, 0
  v_mov_b32 v215, 0
  v_mov_b32 v216, 0
  v_mov_b32 v217, 0
  v_mov_b32 v218, 0
  v_mov_b32 v219, 0
  v_mov_b32 v220, 0
  v_mov_b32 v221, 0
  v_mov_b32 v222, 0
  v_mov_b32 v223, 0
  v_mov_b32 v224, 0
  v_mov_b32 v225, 0
  v_mov_b32 v226, 0
  v_mov_b32 v227, 0
  v_mov_b32 v228, 0
  v_mov_b32 v229, 0
  v_mov_b32 v230, 0
  v_mov_b32 v231, 0
  v_mov_b32 v232, 0
  v_mov_b32 v233, 0
  v_mov_b32 v234, 0
  v_mov_b32 v235, 0
  v_mov_b32 v236, 0
  v_mov_b32 v237, 0
  v_mov_b32 v238, 0
  v_mov_b32 v239, 0
  v_mov_b32 v240, 0
  v_mov_b32 v241, 0
  v_mov_b32 v242, 0
  v_mov_b32 v243, 0
  v_mov_b32 v244, 0
  v_mov_b32 v245, 0
  v_mov_b32 v246, 0
  v_mov_b32 v247, 0
  v_mov_b32 v248, 0
  v_mov_b32 v249, 0
  v_mov_b32 v250, 0
  v_mov_b32 v251, 0
  v_mov_b32 v252, 0
  v_mov_b32 v253, 0
  v_mov_b32 v254, 0
  v_mov_b32 v255, 0
  v_mov_b32 v24, 0
  v_mov_b32 v25, 0
  v_mov_b32 v26, 0
  v_mov_b32 v27, 0
  v_mov_b32 v28, 0
  v_mov_b32 v29, 0
  v_mov_b32 v30, 0
  v_mov_b32 v31, 0
  v_mov_b32 v16, v5
  v_mov_b32 v17, v5
  v_and_b32 v20, 15, v1
  v_lshrrev_b32 v21, 4, v1
  v_sub_u32 v20, v20, v21
  v_lshlrev_b32 v20, 2, v20
  s_lshl_b32 s4, s6, 7
  s_add_u32 s4, s4, s3
  v_add_u32 v20, s4, v20
  v_add_u32 v21, 64, v20
  s_add_u32 s7, s6, 1
  s_lshl_b32 s7, s7, 2
  s_mov_b32 s90, 0
La_sl_loop:
  s_add_u32 s4, s90, 0
  buffer_load_dwordx4 a[0:3], v2, s[20:23], s4 offen offset:0 sc1
  buffer_load_dwordx4 a[4:7], v2, s[20:23], s4 offen offset:1024 sc1
  buffer_load_dwordx4 a[8:11], v2, s[20:23], s4 offen offset:2048 sc1
  buffer_load_dwordx4 a[12:15], v2, s[20:23], s4 offen offset:3072 sc1
  s_add_u32 s4, s90, 4096
  buffer_load_dwordx4 a[16:19], v2, s[20:23], s4 offen offset:0 sc1
  buffer_load_dwordx4 a[20:23], v2, s[20:23], s4 offen offset:1024 sc1
  buffer_load_dwordx4 a[24:27], v2, s[20:23], s4 offen offset:2048 sc1
  buffer_load_dwordx4 a[28:31], v2, s[20:23], s4 offen offset:3072 sc1
  s_add_u32 s4, s90, 16384
  buffer_load_dwordx4 a[32:35], v2, s[20:23], s4 offen offset:0 sc1
  buffer_load_dwordx4 a[36:39], v2, s[20:23], s4 offen offset:1024 sc1
  buffer_load_dwordx4 a[40:43], v2, s[20:23], s4 offen offset:2048 sc1
  buffer_load_dwordx4 a[44:47], v2, s[20:23], s4 offen offset:3072 sc1
  s_add_u32 s4, s90, 20480
  buffer_load_dwordx4 a[48:51], v2, s[20:23], s4 offen offset:0 sc1
  buffer_load_dwordx4 a[52:55], v2, s[20:23], s4 offen offset:1024 sc1
  buffer_load_dwordx4 a[56:59], v2, s[20:23], s4 offen offset:2048 sc1
  buffer_load_dwordx4 a[60:63], v2, s[20:23], s4 offen offset:3072 sc1
  s_waitcnt vmcnt(0)
  v_mfma_f32_16x16x32_bf16 v[64:67], a[0:3], a[160:163], 0
  v_mfma_f32_16x16x32_bf16 v[72:75], a[0:3], a[176:179], 0
  v_mfma_f32_16x16x32_bf16 v[64:67], a[4:7], a[164:167], v[64:67]
  v_mfma_f32_16x16x32_bf16 v[72:75], a[4:7], a[180:183], v[72:75]
  v_mfma_f32_16x16x32_bf16 v[64:67], a[8:11], a[168:171], v[64:67]
  v_mfma_f32_16x16x32_bf16 v[72:75], a[8:11], a[184:187], v[72:75]
  v_mfma_f32_16x16x32_bf16 v[64:67], a[12:15], a[172:175], v[64:67]
  v_mfma_f32_16x16x32_bf16 v[72:75], a[12:15], a[188:191], v[72:75]
  v_mfma_f32_16x16x32_bf16 v[68:71], a[16:19], a[160:163], 0
  v_mfma_f32_16x16x32_bf16 v[76:79], a[16:19], a[176:179], 0
  v_mfma_f32_16x16x32_bf16 v[68:71], a[20:23], a[164:167], v[68:71]
  v_mfma_f32_16x16x32_bf16 v[76:79], a[20:23], a[180:183], v[76:79]
  v_mfma_f32_16x16x32_bf16 v[68:71], a[24:27], a[168:171], v[68:71]
  v_mfma_f32_16x16x32_bf16 v[76:79], a[24:27], a[184:187], v[76:79]
  v_mfma_f32_16x16x32_bf16 v[68:71], a[28:31], a[172:175], v[68:71]
  v_mfma_f32_16x16x32_bf16 v[76:79], a[28:31], a[188:191], v[76:79]
  v_cmp_gt_i32 vcc, 0, v20
  s_nop 1
  v_cndmask_b32 v64, v64, v5, vcc
  v_cmp_gt_i32 vcc, 1, v20
  s_nop 1
  v_cndmask_b32 v65, v65, v5, vcc
  v_cmp_gt_i32 vcc, 2, v20
  s_nop 1
  v_cndmask_b32 v66, v66, v5, vcc
  v_cmp_gt_i32 vcc, 3, v20
  s_nop 1
  v_cndmask_b32 v67, v67, v5, vcc
  v_cmp_gt_i32 vcc, 16, v20
  s_nop 1
  v_cndmask_b32 v68, v68, v5, vcc
  v_cmp_gt_i32 vcc, 17, v20
  s_nop 1
  v_cndmask_b32 v69, v69, v5, vcc
  v_cmp_gt_i32 vcc, 18, v20
  s_nop 1
  v_cndmask_b32 v70, v70, v5, vcc
  v_cmp_gt_i32 vcc, 19, v20
  s_nop 1
  v_cndmask_b32 v71, v71, v5, vcc
  v_subrev_u32 v20, 32, v20
  v_max3_f32 v6, v64, v65, v66
  v_max3_f32 v7, v67, v68, v69
  v_max3_f32 v6, v6, v70, v71
  v_max_f32 v6, v6, v7
  v_cmp_gt_i32 vcc, 0, v21
  s_nop 1
  v_cndmask_b32 v72, v72, v5, vcc
  v_cmp_gt_i32 vcc, 1, v21
  s_nop 1
  v_cndmask_b32 v73, v73, v5, vcc
  v_cmp_gt_i32 vcc, 2, v21
  s_nop 1
  v_cndmask_b32 v74, v74, v5, vcc
  v_cmp_gt_i32 vcc, 3, v21
  s_nop 1
  v_cndmask_b32 v75, v75, v5, vcc
  v_cmp_gt_i32 vcc, 16, v21
  s_nop 1
  v_cndmask_b32 v76, v76, v5, vcc
  v_cmp_gt_i32 vcc, 17, v21
  s_nop 1
  v_cndmask_b32 v77, v77, v5, vcc
  v_cmp_gt_i32 vcc, 18, v21
  s_nop 1
  v_cndmask_b32 v78, v78, v5, vcc
  v_cmp_gt_i32 vcc, 19, v21
  s_nop 1
  v_cndmask_b32 v79, v79, v5, vcc
  v_subrev_u32 v21, 32, v21
  v_max3_f32 v8, v72, v73, v74
  v_max3_f32 v9, v75, v76, v77
  v_max3_f32 v8, v8, v78, v79
  v_max_f32 v8, v8, v9
  v_mov_b32 v7, v6
  v_mov_b32 v9, v8
  s_nop 0
  v_permlane32_swap_b32 v6, v7
  v_permlane32_swap_b32 v8, v9
  v_max_f32 v6, v6, v7
  v_max_f32 v8, v8, v9
  v_mov_b32 v7, v6
  v_mov_b32 v9, v8
  s_nop 0
  v_permlane16_swap_b32 v6, v7
  v_permlane16_swap_b32 v8, v9
  v_max_f32 v6, v6, v7
  v_max_f32 v8, v8, v9
  v_max_f32 v6, v6, v16
  v_sub_f32 v7, v16, v6
  v_exp_f32 v7, v7
  v_mov_b32 v16, v6
  v_sub_f32 v64, v64, v16
  v_sub_f32 v65, v65, v16
  v_sub_f32 v66, v66, v16
  v_sub_f32 v67, v67, v16
  v_sub_f32 v68, v68, v16
  v_sub_f32 v69, v69, v16
  v_sub_f32 v70, v70, v16
  v_sub_f32 v71, v71, v16
  v_exp_f32 v64, v64
  v_exp_f32 v65, v65
  v_exp_f32 v66, v66
  v_exp_f32 v67, v67
  v_exp_f32 v68, v68
  v_exp_f32 v69, v69
  v_exp_f32 v70, v70
  v_exp_f32 v71, v71
  v_mul_f32 v24, v24, v7
  v_mul_f32 v25, v25, v7
  v_mul_f32 v26, v26, v7
  v_mul_f32 v27, v27, v7
  v_mul_f32 v192, v192, v7
  v_mul_f32 v193, v193, v7
  v_mul_f32 v194, v194, v7
  v_mul_f32 v195, v195, v7
  v_mul_f32 v196, v196, v7
  v_mul_f32 v197, v197, v7
  v_mul_f32 v198, v198, v7
  v_mul_f32 v199, v199, v7
  v_mul_f32 v200, v200, v7
  v_mul_f32 v201, v201, v7
  v_mul_f32 v202, v202, v7
  v_mul_f32 v203, v203, v7
  v_mul_f32 v204, v204, v7
  v_mul_f32 v205, v205, v7
  v_mul_f32 v206, v206, v7
  v_mul_f32 v207, v207, v7
  v_mul_f32 v208, v208, v7
  v_mul_f32 v209, v209, v7
  v_mul_f32 v210, v210, v7
  v_mul_f32 v211, v211, v7
  v_mul_f32 v212, v212, v7
  v_mul_f32 v213, v213, v7
  v_mul_f32 v214, v214, v7
  v_mul_f32 v215, v215, v7
  v_mul_f32 v216, v216, v7
  v_mul_f32 v217, v217, v7
  v_mul_f32 v218, v218, v7
  v_mul_f32 v219, v219, v7
  v_mul_f32 v220, v220, v7
  v_mul_f32 v221, v221, v7
  v_mul_f32 v222, v222, v7
  v_mul_f32 v223, v223, v7
  v_cvt_pk_bf16_f32 v32, v64, v65
  v_cvt_pk_bf16_f32 v33, v66, v67
  v_cvt_pk_bf16_f32 v34, v68, v69
  v_cvt_pk_bf16_f32 v35, v70, v71
  v_max_f32 v8, v8, v17
  v_sub_f32 v9, v17, v8
  v_exp_f32 v9, v9
  v_mov_b32 v17, v8
  v_sub_f32 v72, v72, v17
  v_sub_f32 v73, v73, v17
  v_sub_f32 v74, v74, v17
  v_sub_f32 v75, v75, v17
  v_sub_f32 v76, v76, v17
  v_sub_f32 v77, v77, v17
  v_sub_f32 v78, v78, v17
  v_sub_f32 v79, v79, v17
  v_exp_f32 v72, v72
  v_exp_f32 v73, v73
  v_exp_f32 v74, v74
  v_exp_f32 v75, v75
  v_exp_f32 v76, v76
  v_exp_f32 v77, v77
  v_exp_f32 v78, v78
  v_exp_f32 v79, v79
  v_mul_f32 v28, v28, v9
  v_mul_f32 v29, v29, v9
  v_mul_f32 v30, v30, v9
  v_mul_f32 v31, v31, v9
  v_mul_f32 v224, v224, v9
  v_mul_f32 v225, v225, v9
  v_mul_f32 v226, v226, v9
  v_mul_f32 v227, v227, v9
  v_mul_f32 v228, v228, v9
  v_mul_f32 v229, v229, v9
  v_mul_f32 v230, v230, v9
  v_mul_f32 v231, v231, v9
  v_mul_f32 v232, v232, v9
  v_mul_f32 v233, v233, v9
  v_mul_f32 v234, v234, v9
  v_mul_f32 v235, v235, v9
  v_mul_f32 v236, v236, v9
  v_mul_f32 v237, v237, v9
  v_mul_f32 v238, v238, v9
  v_mul_f32 v239, v239, v9
  v_mul_f32 v240, v240, v9
  v_mul_f32 v241, v241, v9
  v_mul_f32 v242, v242, v9
  v_mul_f32 v243, v243, v9
  v_mul_f32 v244, v244, v9
  v_mul_f32 v245, v245, v9
  v_mul_f32 v246, v246, v9
  v_mul_f32 v247, v247, v9
  v_mul_f32 v248, v248, v9
  v_mul_f32 v249, v249, v9
  v_mul_f32 v250, v250, v9
  v_mul_f32 v251, v251, v9
  v_mul_f32 v252, v252, v9
  v_mul_f32 v253, v253, v9
  v_mul_f32 v254, v254, v9
  v_mul_f32 v255, v255, v9
  v_cvt_pk_bf16_f32 v36, v72, v73
  v_cvt_pk_bf16_f32 v37, v74, v75
  v_cvt_pk_bf16_f32 v38, v76, v77
  v_cvt_pk_bf16_f32 v39, v78, v79
  v_mfma_f32_16x16x32_bf16 v[24:27], a[208:211], v[32:35], v[24:27]
  v_mfma_f32_16x16x32_bf16 v[192:195], a[32:35], v[32:35], v[192:195]
  v_mfma_f32_16x16x32_bf16 v[196:199], a[36:39], v[32:35], v[196:199]
  v_mfma_f32_16x16x32_bf16 v[200:203], a[40:43], v[32:35], v[200:203]
  v_mfma_f32_16x16x32_bf16 v[204:207], a[44:47], v[32:35], v[204:207]
  v_mfma_f32_16x16x32_bf16 v[208:211], a[48:51], v[32:35], v[208:211]
  v_mfma_f32_16x16x32_bf16 v[212:215], a[52:55], v[32:35], v[212:215]
  v_mfma_f32_16x16x32_bf16 v[216:219], a[56:59], v[32:35], v[216:219]
  v_mfma_f32_16x16x32_bf16 v[220:223], a[60:63], v[32:35], v[220:223]
  v_mfma_f32_16x16x32_bf16 v[28:31], a[208:211], v[36:39], v[28:31]
  v_mfma_f32_16x16x32_bf16 v[224:227], a[32:35], v[36:39], v[224:227]
  v_mfma_f32_16x16x32_bf16 v[228:231], a[36:39], v[36:39], v[228:231]
  v_mfma_f32_16x16x32_bf16 v[232:235], a[40:43], v[36:39], v[232:235]
  v_mfma_f32_16x16x32_bf16 v[236:239], a[44:47], v[36:39], v[236:239]
  v_mfma_f32_16x16x32_bf16 v[240:243], a[48:51], v[36:39], v[240:243]
  v_mfma_f32_16x16x32_bf16 v[244:247], a[52:55], v[36:39], v[244:247]
  v_mfma_f32_16x16x32_bf16 v[248:251], a[56:59], v[36:39], v[248:251]
  v_mfma_f32_16x16x32_bf16 v[252:255], a[60:63], v[36:39], v[252:255]
  s_add_u32 s90, s90, 8192
  s_and_b32 s4, s90, 0x4000
  s_add_u32 s90, s90, s4
  s_sub_u32 s7, s7, 1
  s_cmp_lg_u32 s7, 0
  s_cbranch_scc1 La_sl_loop
  s_lshl_b32 s4, s6, 20
  s_lshl_b32 s5, s24, 15
  s_add_u32 s4, s4, s5
  s_lshl_b32 s5, s3, 11
  s_add_u32 s4, s4, s5
  v_rcp_f32 v6, v24
  s_nop 0
  v_mov_b32 v7, v6
  v_rcp_f32 v8, v28
  s_nop 0
  v_mov_b32 v9, v8
  v_pk_mul_f32 v[192:193], v[192:193], v[6:7]
  v_pk_mul_f32 v[194:195], v[194:195], v[6:7]
  v_pk_mul_f32 v[196:197], v[196:197], v[6:7]
  v_pk_mul_f32 v[198:199], v[198:199], v[6:7]
  v_cvt_pk_bf16_f32 v192, v192, v193
  v_cvt_pk_bf16_f32 v193, v194, v195
  v_cvt_pk_bf16_f32 v194, v196, v197
  v_cvt_pk_bf16_f32 v195, v198, v199
  buffer_store_dwordx4 v[192:195], v2, s[16:19], s4 offen offset:0 sc1
  v_pk_mul_f32 v[224:225], v[224:225], v[8:9]
  v_pk_mul_f32 v[226:227], v[226:227], v[8:9]
  v_pk_mul_f32 v[228:229], v[228:229], v[8:9]
  v_pk_mul_f32 v[230:231], v[230:231], v[8:9]
  v_cvt_pk_bf16_f32 v224, v224, v225
  v_cvt_pk_bf16_f32 v225, v226, v227
  v_cvt_pk_bf16_f32 v226, v228, v229
  v_cvt_pk_bf16_f32 v227, v230, v231
  buffer_store_dwordx4 v[224:227], v2, s[16:19], s4 offen offset:1024 sc1
  s_add_u32 s4, s4, 8192
  v_pk_mul_f32 v[200:201], v[200:201], v[6:7]
  v_pk_mul_f32 v[202:203], v[202:203], v[6:7]
  v_pk_mul_f32 v[204:205], v[204:205], v[6:7]
  v_pk_mul_f32 v[206:207], v[206:207], v[6:7]
  v_cvt_pk_bf16_f32 v200, v200, v201
  v_cvt_pk_bf16_f32 v201, v202, v203
  v_cvt_pk_bf16_f32 v202, v204, v205
  v_cvt_pk_bf16_f32 v203, v206, v207
  buffer_store_dwordx4 v[200:203], v2, s[16:19], s4 offen offset:0 sc1
  v_pk_mul_f32 v[232:233], v[232:233], v[8:9]
  v_pk_mul_f32 v[234:235], v[234:235], v[8:9]
  v_pk_mul_f32 v[236:237], v[236:237], v[8:9]
  v_pk_mul_f32 v[238:239], v[238:239], v[8:9]
  v_cvt_pk_bf16_f32 v232, v232, v233
  v_cvt_pk_bf16_f32 v233, v234, v235
  v_cvt_pk_bf16_f32 v234, v236, v237
  v_cvt_pk_bf16_f32 v235, v238, v239
  buffer_store_dwordx4 v[232:235], v2, s[16:19], s4 offen offset:1024 sc1
  s_add_u32 s4, s4, 8192
  v_pk_mul_f32 v[208:209], v[208:209], v[6:7]
  v_pk_mul_f32 v[210:211], v[210:211], v[6:7]
  v_pk_mul_f32 v[212:213], v[212:213], v[6:7]
  v_pk_mul_f32 v[214:215], v[214:215], v[6:7]
  v_cvt_pk_bf16_f32 v208, v208, v209
  v_cvt_pk_bf16_f32 v209, v210, v211
  v_cvt_pk_bf16_f32 v210, v212, v213
  v_cvt_pk_bf16_f32 v211, v214, v215
  buffer_store_dwordx4 v[208:211], v2, s[16:19], s4 offen offset:0 sc1
  v_pk_mul_f32 v[240:241], v[240:241], v[8:9]
  v_pk_mul_f32 v[242:243], v[242:243], v[8:9]
  v_pk_mul_f32 v[244:245], v[244:245], v[8:9]
  v_pk_mul_f32 v[246:247], v[246:247], v[8:9]
  v_cvt_pk_bf16_f32 v240, v240, v241
  v_cvt_pk_bf16_f32 v241, v242, v243
  v_cvt_pk_bf16_f32 v242, v244, v245
  v_cvt_pk_bf16_f32 v243, v246, v247
  buffer_store_dwordx4 v[240:243], v2, s[16:19], s4 offen offset:1024 sc1
  s_add_u32 s4, s4, 8192
  v_pk_mul_f32 v[216:217], v[216:217], v[6:7]
  v_pk_mul_f32 v[218:219], v[218:219], v[6:7]
  v_pk_mul_f32 v[220:221], v[220:221], v[6:7]
  v_pk_mul_f32 v[222:223], v[222:223], v[6:7]
  v_cvt_pk_bf16_f32 v216, v216, v217
  v_cvt_pk_bf16_f32 v217, v218, v219
  v_cvt_pk_bf16_f32 v218, v220, v221
  v_cvt_pk_bf16_f32 v219, v222, v223
  buffer_store_dwordx4 v[216:219], v2, s[16:19], s4 offen offset:0 sc1
  v_pk_mul_f32 v[248:249], v[248:249], v[8:9]
  v_pk_mul_f32 v[250:251], v[250:251], v[8:9]
  v_pk_mul_f32 v[252:253], v[252:253], v[8:9]
  v_pk_mul_f32 v[254:255], v[254:255], v[8:9]
  v_cvt_pk_bf16_f32 v248, v248, v249
  v_cvt_pk_bf16_f32 v249, v250, v251
  v_cvt_pk_bf16_f32 v250, v252, v253
  v_cvt_pk_bf16_f32 v251, v254, v255
  buffer_store_dwordx4 v[248:251], v2, s[16:19], s4 offen offset:1024 sc1
  s_cmp_eq_u32 s6, s25
  s_cbranch_scc1 La_done
  v_accvgpr_read_b32 v64, a128
  v_accvgpr_read_b32 v65, a129
  v_accvgpr_read_b32 v66, a130
  v_accvgpr_read_b32 v67, a131
  v_accvgpr_read_b32 v68, a132
  v_accvgpr_read_b32 v69, a133
  v_accvgpr_read_b32 v70, a134
  v_accvgpr_read_b32 v71, a135
  v_accvgpr_read_b32 v72, a136
  v_accvgpr_read_b32 v73, a137
  v_accvgpr_read_b32 v74, a138
  v_accvgpr_read_b32 v75, a139
  v_accvgpr_read_b32 v76, a140
  v_accvgpr_read_b32 v77, a141
  v_accvgpr_read_b32 v78, a142
  v_accvgpr_read_b32 v79, a143
  v_accvgpr_read_b32 v80, a144
  v_accvgpr_read_b32 v81, a145
  v_accvgpr_read_b32 v82, a146
  v_accvgpr_read_b32 v83, a147
  v_accvgpr_read_b32 v84, a148
  v_accvgpr_read_b32 v85, a149
  v_accvgpr_read_b32 v86, a150
  v_accvgpr_read_b32 v87, a151
  v_accvgpr_read_b32 v88, a152
  v_accvgpr_read_b32 v89, a153
  v_accvgpr_read_b32 v90, a154
  v_accvgpr_read_b32 v91, a155
  v_accvgpr_read_b32 v92, a156
  v_accvgpr_read_b32 v93, a157
  v_accvgpr_read_b32 v94, a158
  v_accvgpr_read_b32 v95, a159
  v_accvgpr_write_b32 a160, v64
  v_accvgpr_write_b32 a161, v65
  v_accvgpr_write_b32 a162, v66
  v_accvgpr_write_b32 a163, v67
  v_accvgpr_write_b32 a164, v68
  v_accvgpr_write_b32 a165, v69
  v_accvgpr_write_b32 a166, v70
  v_accvgpr_write_b32 a167, v71
  v_accvgpr_write_b32 a168, v72
  v_accvgpr_write_b32 a169, v73
  v_accvgpr_write_b32 a170, v74
  v_accvgpr_write_b32 a171, v75
  v_accvgpr_write_b32 a172, v76
  v_accvgpr_write_b32 a173, v77
  v_accvgpr_write_b32 a174, v78
  v_accvgpr_write_b32 a175, v79
  v_accvgpr_write_b32 a176, v80
  v_accvgpr_write_b32 a177, v81
  v_accvgpr_write_b32 a178, v82
  v_accvgpr_write_b32 a179, v83
  v_accvgpr_write_b32 a180, v84
  v_accvgpr_write_b32 a181, v85
  v_accvgpr_write_b32 a182, v86
  v_accvgpr_write_b32 a183, v87
  v_accvgpr_write_b32 a184, v88
  v_accvgpr_write_b32 a185, v89
  v_accvgpr_write_b32 a186, v90
  v_accvgpr_write_b32 a187, v91
  v_accvgpr_write_b32 a188, v92
  v_accvgpr_write_b32 a189, v93
  v_accvgpr_write_b32 a190, v94
  v_accvgpr_write_b32 a191, v95
  s_mov_b32 s6, s25
  s_branch La_sl_blk
La_done:
  s_lshr_b32 s4, s3, 1
  s_lshl_b32 s4, s4, 12
  s_add_u32 s4, s4, 131072
  s_lshl_b32 s5, s77, 11
  s_add_u32 s4, s4, s5
  v_add_u32 v16, s4, v2
  v_xor_b32 v17, 0x800, v16
  s_and_b32 s4, s3, 1
  s_lshl_b32 s4, s4, 13
  s_add_u32 s4, s4, 131072
  v_lshrrev_b32 v24, 2, v1
  v_and_b32 v25, 6, v24
  v_lshlrev_b32 v24, 7, v24
  v_and_b32 v26, 1, v1
  v_lshl_add_u32 v24, v26, 3, v24
  v_add_u32 v24, s4, v24
  v_bfe_u32 v26, v1, 1, 1
  v_xor_b32 v25, v25, v26
  v_xor_b32 v26, 0, v25
  v_lshl_add_u32 v18, v26, 4, v24
  v_xor_b32 v26, 2, v25
  v_lshl_add_u32 v19, v26, 4, v24
  v_xor_b32 v26, 4, v25
  v_lshl_add_u32 v20, v26, 4, v24
  v_xor_b32 v26, 6, v25
  v_lshl_add_u32 v21, v26, 4, v24
  s_mov_b32 s65, 0
  s_mov_b32 s67, 4294868992
  s_mov_b32 s68, 32768
  s_mov_b32 s65, 3
  s_lshl_b32 s36, s24, 7
  s_add_u32 s36, s36, 65536
  s_and_b32 s37, s25, 1
  s_lshl_b32 s37, s37, 1
  s_add_u32 s37, s37, 14
  s_sub_u32 s37, s37, s25
  s_lshl_b32 s37, s37, 12
  s_add_u32 s37, s37, s36
  s_lshl_b32 s38, s25, 12
  s_add_u32 s36, s36, s38
  s_lshl_b32 s38, s78, 1
  s_add_u32 s38, s38, s77
  s_lshl_b32 s38, s38, 7
  s_add_u32 s38, s38, 163840
  s_lshl_b32 s91, s73, 12
  s_add_u32 s91, s91, 65536
  s_lshl_b32 s39, s78, 1
  s_add_u32 s39, s39, s77
  s_xor_b32 s39, s39, 1
  s_lshl_b32 s39, s39, 7
  s_add_u32 s39, s39, 163840
  s_sub_u32 s39, s39, s91
  v_mov_b32 v8, 0x40000000
  v_mov_b32 v6, s94
  v_cmp_eq_u32 vcc, 0, v0
  v_mov_b32 v7, s95
  s_nop 0
  v_cndmask_b32_e64 v8, v8, 0, vcc
  v_lshlrev_b32 v14, 7, v1
  v_mov_b32 v9, s39
  v_cmp_gt_u32 vcc, 32, v1
  s_nop 1
  v_cndmask_b32 v14, v9, v14, vcc
  s_waitcnt vmcnt(16)
  s_barrier
  ds_read_b128 a[64:67], v16 offset:0
  ds_read_b64_tr_b16 a[96:97], v18 offset:16384
  ds_read_b64_tr_b16 a[98:99], v18 offset:18432
  ds_read_b128 a[68:71], v16 offset:1024
  ds_read_b128 a[72:75], v17 offset:0
  ds_read_b128 a[76:79], v17 offset:1024
  ds_read_b64_tr_b16 a[100:101], v19 offset:16384
  ds_read_b64_tr_b16 a[102:103], v19 offset:18432
  ds_read_b64_tr_b16 a[104:105], v20 offset:16384
  ds_read_b64_tr_b16 a[106:107], v20 offset:18432
  ds_read_b64_tr_b16 a[108:109], v21 offset:16384
  ds_read_b64_tr_b16 a[110:111], v21 offset:18432
  s_waitcnt lgkmcnt(0)
  v_mfma_f32_16x16x32_bf16 v[32:35], a[96:99], a[64:67], 0
  s_add_u32 m0, s79, 81920
  ds_read_b128 a[80:83], v16 offset:8192
  ds_read_b64_tr_b16 a[112:113], v18 offset:20480
  v_mfma_f32_16x16x32_bf16 v[48:51], a[96:99], a[68:71], 0
  buffer_load_dwordx4 v10, s[12:15], s71 offen offset:0 lds
  ds_read_b64_tr_b16 a[114:115], v18 offset:22528
  v_mfma_f32_16x16x32_bf16 v[64:67], a[96:99], a[72:75], 0
  buffer_load_dwordx4 v11, s[12:15], s71 offen offset:1024 lds
  ds_read_b128 a[84:87], v16 offset:9216
  v_mfma_f32_16x16x32_bf16 v[80:83], a[96:99], a[76:79], 0
  buffer_load_dwordx4 v12, s[12:15], s71 offen offset:2048 lds
  ds_read_b128 a[88:91], v17 offset:8192
  v_mfma_f32_16x16x32_bf16 v[36:39], a[100:103], a[64:67], 0
  buffer_load_dwordx4 v13, s[12:15], s71 offen offset:3072 lds
  ds_read_b128 a[92:95], v17 offset:9216
  v_mfma_f32_16x16x32_bf16 v[52:55], a[100:103], a[68:71], 0
  s_bfe_u32 s72, 0x3020106, s31
  s_add_u32 s30, s30, s72
  s_add_u32 s31, s31, 8
  v_mfma_f32_16x16x32_bf16 v[68:71], a[100:103], a[72:75], 0
  s_and_b32 s31, s31, 0x8001f
  s_and_b32 s30, s30, 7
  s_lshl_b32 s72, s30, 17
  v_mfma_f32_16x16x32_bf16 v[84:87], a[100:103], a[76:79], 0
  s_add_u32 s71, s93, s72
  s_add_u32 m0, s79, 65536
  ds_read_b64_tr_b16 a[116:117], v19 offset:20480
  v_mfma_f32_16x16x32_bf16 v[40:43], a[104:107], a[64:67], 0
  buffer_load_dwordx4 v2, s[8:11], s70 offen offset:0 sc1 lds
  ds_read_b64_tr_b16 a[118:119], v19 offset:22528
  v_mfma_f32_16x16x32_bf16 v[56:59], a[104:107], a[68:71], 0
  buffer_load_dwordx4 v2, s[8:11], s70 offen offset:1024 sc1 lds
  ds_read_b64_tr_b16 a[120:121], v20 offset:20480
  v_mfma_f32_16x16x32_bf16 v[72:75], a[104:107], a[72:75], 0
  buffer_load_dwordx4 v2, s[8:11], s70 offen offset:2048 sc1 lds
  ds_read_b64_tr_b16 a[122:123], v20 offset:22528
  v_mfma_f32_16x16x32_bf16 v[88:91], a[104:107], a[76:79], 0
  buffer_load_dwordx4 v2, s[8:11], s70 offen offset:3072 sc1 lds
  ds_read_b64_tr_b16 a[124:125], v21 offset:20480
  v_mfma_f32_16x16x32_bf16 v[44:47], a[108:111], a[64:67], 0
  s_bfe_u32 s72, 0x3020106, s1
  s_add_u32 s0, s0, s72
  s_add_u32 s1, s1, 8
  v_mfma_f32_16x16x32_bf16 v[60:63], a[108:111], a[68:71], 0
  s_and_b32 s1, s1, 0x8001f
  s_and_b32 s0, s0, 7
  s_lshl_b32 s72, s0, 14
  v_mfma_f32_16x16x32_bf16 v[76:79], a[108:111], a[72:75], 0
  s_add_u32 s70, s92, s72
  ds_read_b64_tr_b16 a[126:127], v21 offset:22528
  v_mfma_f32_16x16x32_bf16 v[92:95], a[108:111], a[76:79], 0
  s_add_u32 s65, s65, 1
  s_cmp_eq_u32 s65, 4
  s_cselect_b32 s65, 0, s65
  s_cselect_b32 s66, s67, s68
  v_add_u32 v16, s66, v16
  v_add_u32 v17, s66, v17
  v_add_u32 v18, s66, v18
  v_add_u32 v19, s66, v19
  v_add_u32 v20, s66, v20
  v_add_u32 v21, s66, v21
  s_waitcnt vmcnt(8) lgkmcnt(0)
  s_barrier
  v_mfma_f32_16x16x32_bf16 v[32:35], a[112:115], a[80:83], v[32:35]
  buffer_store_dwordx2 v[6:7], v8, s[96:99], s36 offen sc1
  ds_read_b128 a[64:67], v16 offset:0
  v_mfma_f32_16x16x32_bf16 v[48:51], a[112:115], a[84:87], v[48:51]
  buffer_store_dwordx2 v[6:7], v8, s[96:99], s37 offen sc1
  ds_read_b64_tr_b16 a[96:97], v18 offset:16384
  v_mfma_f32_16x16x32_bf16 v[64:67], a[112:115], a[88:91], v[64:67]
  ds_read_b64_tr_b16 a[98:99], v18 offset:18432
  ds_read_b128 a[68:71], v16 offset:1024
  v_mfma_f32_16x16x32_bf16 v[80:83], a[112:115], a[92:95], v[80:83]
  buffer_store_dwordx2 v[6:7], v8, s[96:99], s38 offen sc1
  ds_read_b128 a[72:75], v17 offset:0
  v_mfma_f32_16x16x32_bf16 v[36:39], a[116:119], a[80:83], v[36:39]
  s_add_u32 m0, s79, 114688
  ds_read_b128 a[76:79], v17 offset:1024
  ds_read_b64_tr_b16 a[100:101], v19 offset:16384
  v_mfma_f32_16x16x32_bf16 v[52:55], a[116:119], a[84:87], v[52:55]
  buffer_load_dwordx4 v10, s[12:15], s71 offen offset:0 lds
  ds_read_b64_tr_b16 a[102:103], v19 offset:18432
  v_mfma_f32_16x16x32_bf16 v[68:71], a[116:119], a[88:91], v[68:71]
  buffer_load_dwordx4 v11, s[12:15], s71 offen offset:1024 lds
  ds_read_b64_tr_b16 a[104:105], v20 offset:16384
  v_mfma_f32_16x16x32_bf16 v[84:87], a[116:119], a[92:95], v[84:87]
  buffer_load_dwordx4 v12, s[12:15], s71 offen offset:2048 lds
  ds_read_b64_tr_b16 a[106:107], v20 offset:18432
  v_mfma_f32_16x16x32_bf16 v[40:43], a[120:123], a[80:83], v[40:43]
  ds_read_b64_tr_b16 a[108:109], v21 offset:16384
  ds_read_b64_tr_b16 a[110:111], v21 offset:18432
  v_mfma_f32_16x16x32_bf16 v[56:59], a[120:123], a[84:87], v[56:59]
  buffer_load_dwordx4 v13, s[12:15], s71 offen offset:3072 lds
  v_mfma_f32_16x16x32_bf16 v[72:75], a[120:123], a[88:91], v[72:75]
  s_bfe_u32 s72, 0x3020106, s31
  s_add_u32 s30, s30, s72
  s_add_u32 s31, s31, 8
  v_mfma_f32_16x16x32_bf16 v[88:91], a[120:123], a[92:95], v[88:91]
  s_and_b32 s31, s31, 0x8001f
  s_and_b32 s30, s30, 7
  s_lshl_b32 s72, s30, 17
  v_mfma_f32_16x16x32_bf16 v[44:47], a[124:127], a[80:83], v[44:47]
  s_add_u32 s71, s93, s72
  s_add_u32 m0, s79, 98304
  v_mfma_f32_16x16x32_bf16 v[60:63], a[124:127], a[84:87], v[60:63]
  buffer_load_dwordx4 v2, s[8:11], s70 offen offset:0 sc1 lds
  v_mfma_f32_16x16x32_bf16 v[76:79], a[124:127], a[88:91], v[76:79]
  buffer_load_dwordx4 v2, s[8:11], s70 offen offset:1024 sc1 lds
  v_mfma_f32_16x16x32_bf16 v[92:95], a[124:127], a[92:95], v[92:95]
  buffer_load_dwordx4 v2, s[8:11], s70 offen offset:2048 sc1 lds
  s_waitcnt lgkmcnt(0)
  v_mfma_f32_16x16x32_bf16 v[32:35], a[96:99], a[64:67], v[32:35]
  buffer_load_dwordx4 v2, s[8:11], s70 offen offset:3072 sc1 lds
  ds_read_b128 a[80:83], v16 offset:8192
  v_mfma_f32_16x16x32_bf16 v[48:51], a[96:99], a[68:71], v[48:51]
  s_bfe_u32 s72, 0x3020106, s1
  s_add_u32 s0, s0, s72
  s_add_u32 s1, s1, 8
  v_mfma_f32_16x16x32_bf16 v[64:67], a[96:99], a[72:75], v[64:67]
  s_and_b32 s1, s1, 0x8001f
  s_and_b32 s0, s0, 7
  s_lshl_b32 s72, s0, 14
  v_mfma_f32_16x16x32_bf16 v[80:83], a[96:99], a[76:79], v[80:83]
  s_add_u32 s70, s92, s72
  s_add_u32 m0, s64, 16384
  ds_read_b64_tr_b16 a[112:113], v18 offset:20480
  v_mfma_f32_16x16x32_bf16 v[36:39], a[100:103], a[64:67], v[36:39]
  buffer_load_dwordx4 v10, s[12:15], s71 offen offset:0 lds
  ds_read_b64_tr_b16 a[114:115], v18 offset:22528
  v_mfma_f32_16x16x32_bf16 v[52:55], a[100:103], a[68:71], v[52:55]
  buffer_load_dwordx4 v11, s[12:15], s71 offen offset:1024 lds
  ds_read_b128 a[84:87], v16 offset:9216
  v_mfma_f32_16x16x32_bf16 v[68:71], a[100:103], a[72:75], v[68:71]
  buffer_load_dwordx4 v12, s[12:15], s71 offen offset:2048 lds
  ds_read_b128 a[88:91], v17 offset:8192
  v_mfma_f32_16x16x32_bf16 v[84:87], a[100:103], a[76:79], v[84:87]
  buffer_load_dwordx4 v13, s[12:15], s71 offen offset:3072 lds
  ds_read_b128 a[92:95], v17 offset:9216
  v_mfma_f32_16x16x32_bf16 v[40:43], a[104:107], a[64:67], v[40:43]
  s_bfe_u32 s72, 0x3020106, s31
  s_add_u32 s30, s30, s72
  s_add_u32 s31, s31, 8
  v_mfma_f32_16x16x32_bf16 v[56:59], a[104:107], a[68:71], v[56:59]
  s_and_b32 s31, s31, 0x8001f
  s_and_b32 s30, s30, 7
  s_lshl_b32 s72, s30, 17
  v_mfma_f32_16x16x32_bf16 v[72:75], a[104:107], a[72:75], v[72:75]
  s_add_u32 s71, s93, s72
  s_mov_b32 m0, s64
  ds_read_b64_tr_b16 a[116:117], v19 offset:20480
  v_mfma_f32_16x16x32_bf16 v[88:91], a[104:107], a[76:79], v[88:91]
  buffer_load_dwordx4 v2, s[8:11], s70 offen offset:0 sc1 lds
  ds_read_b64_tr_b16 a[118:119], v19 offset:22528
  v_mfma_f32_16x16x32_bf16 v[44:47], a[108:111], a[64:67], v[44:47]
  buffer_load_dwordx4 v2, s[8:11], s70 offen offset:1024 sc1 lds
  ds_read_b64_tr_b16 a[120:121], v20 offset:20480
  v_mfma_f32_16x16x32_bf16 v[60:63], a[108:111], a[68:71], v[60:63]
  buffer_load_dwordx4 v2, s[8:11], s70 offen offset:2048 sc1 lds
  ds_read_b64_tr_b16 a[122:123], v20 offset:22528
  v_mfma_f32_16x16x32_bf16 v[76:79], a[108:111], a[72:75], v[76:79]
  buffer_load_dwordx4 v2, s[8:11], s70 offen offset:3072 sc1 lds
  ds_read_b64_tr_b16 a[124:125], v21 offset:20480
  ds_read_b64_tr_b16 a[126:127], v21 offset:22528
  v_mfma_f32_16x16x32_bf16 v[92:95], a[108:111], a[76:79], v[92:95]
  s_bfe_u32 s72, 0x3020106, s1
  s_add_u32 s0, s0, s72
  s_add_u32 s1, s1, 8
  s_and_b32 s1, s1, 0x8001f
  s_and_b32 s0, s0, 7
  s_lshl_b32 s72, s0, 14
  s_add_u32 s70, s92, s72
  s_add_u32 s64, s64, s66
  s_add_u32 s65, s65, 1
  s_cmp_eq_u32 s65, 4
  s_cselect_b32 s65, 0, s65
  s_cselect_b32 s66, s67, s68
  v_add_u32 v16, s66, v16
  v_add_u32 v17, s66, v17
  v_add_u32 v18, s66, v18
  v_add_u32 v19, s66, v19
  v_add_u32 v20, s66, v20
  v_add_u32 v21, s66, v21
  s_waitcnt vmcnt(19) lgkmcnt(0)
  s_barrier
  v_mfma_f32_16x16x32_bf16 v[32:35], a[112:115], a[80:83], v[32:35]
  s_add_u32 s16, s86, 100663296
  s_addc_u32 s17, s87, 0
  s_mov_b32 s18, 16777216
  v_mfma_f32_16x16x32_bf16 v[48:51], a[112:115], a[84:87], v[48:51]
  s_mov_b32 s19, 0x00020000
  s_add_u32 m0, s64, 16384
  ds_read_b128 a[64:67], v16 offset:0
  v_mfma_f32_16x16x32_bf16 v[64:67], a[112:115], a[88:91], v[64:67]
  buffer_load_dwordx4 v10, s[12:15], s71 offen offset:0 lds
  ds_read_b64_tr_b16 a[96:97], v18 offset:16384
  v_mfma_f32_16x16x32_bf16 v[80:83], a[112:115], a[92:95], v[80:83]
  buffer_load_dwordx4 v11, s[12:15], s71 offen offset:1024 lds
  ds_read_b64_tr_b16 a[98:99], v18 offset:18432
  v_mfma_f32_16x16x32_bf16 v[36:39], a[116:119], a[80:83], v[36:39]
  ds_read_b128 a[68:71], v16 offset:1024
  ds_read_b128 a[72:75], v17 offset:0
  v_mfma_f32_16x16x32_bf16 v[52:55], a[116:119], a[84:87], v[52:55]
  ds_read_b128 a[76:79], v17 offset:1024
  ds_read_b64_tr_b16 a[100:101], v19 offset:16384
  v_mfma_f32_16x16x32_bf16 v[68:71], a[116:119], a[88:91], v[68:71]
  ds_read_b64_tr_b16 a[102:103], v19 offset:18432
  ds_read_b64_tr_b16 a[104:105], v20 offset:16384
  v_mfma_f32_16x16x32_bf16 v[84:87], a[116:119], a[92:95], v[84:87]
  buffer_load_dwordx4 v12, s[12:15], s71 offen offset:2048 lds
  ds_read_b64_tr_b16 a[106:107], v20 offset:18432
  v_mfma_f32_16x16x32_bf16 v[40:43], a[120:123], a[80:83], v[40:43]
  ds_read_b64_tr_b16 a[108:109], v21 offset:16384
  ds_read_b64_tr_b16 a[110:111], v21 offset:18432
  v_mfma_f32_16x16x32_bf16 v[56:59], a[120:123], a[84:87], v[56:59]
  v_mfma_f32_16x16x32_bf16 v[72:75], a[120:123], a[88:91], v[72:75]
  v_mfma_f32_16x16x32_bf16 v[88:91], a[120:123], a[92:95], v[88:91]
  buffer_load_dwordx4 v13, s[12:15], s71 offen offset:3072 lds
  v_mfma_f32_16x16x32_bf16 v[44:47], a[124:127], a[80:83], v[44:47]
  s_bfe_u32 s72, 0x3020106, s31
  s_add_u32 s30, s30, s72
  s_add_u32 s31, s31, 8
  v_mfma_f32_16x16x32_bf16 v[60:63], a[124:127], a[84:87], v[60:63]
  s_and_b32 s31, s31, 0x8001f
  s_and_b32 s30, s30, 7
  s_lshl_b32 s72, s30, 17
  v_mfma_f32_16x16x32_bf16 v[76:79], a[124:127], a[88:91], v[76:79]
  s_add_u32 s71, s93, s72
  v_mfma_f32_16x16x32_bf16 v[92:95], a[124:127], a[92:95], v[92:95]
  s_waitcnt lgkmcnt(0)
  v_mfma_f32_16x16x32_bf16 v[32:35], a[96:99], a[64:67], v[32:35]
  s_mov_b32 m0, s64
  ds_read_b128 a[80:83], v16 offset:8192
  ds_read_b64_tr_b16 a[112:113], v18 offset:20480
  v_mfma_f32_16x16x32_bf16 v[48:51], a[96:99], a[68:71], v[48:51]
  buffer_load_dwordx4 v2, s[8:11], s70 offen offset:0 sc1 lds
  ds_read_b64_tr_b16 a[114:115], v18 offset:22528
  v_mfma_f32_16x16x32_bf16 v[64:67], a[96:99], a[72:75], v[64:67]
  buffer_load_dwordx4 v2, s[8:11], s70 offen offset:1024 sc1 lds
  ds_read_b128 a[84:87], v16 offset:9216
  v_mfma_f32_16x16x32_bf16 v[80:83], a[96:99], a[76:79], v[80:83]
  ds_read_b128 a[88:91], v17 offset:8192
  ds_read_b128 a[92:95], v17 offset:9216
  v_mfma_f32_16x16x32_bf16 v[36:39], a[100:103], a[64:67], v[36:39]
  buffer_load_dwordx4 v2, s[8:11], s70 offen offset:2048 sc1 lds
  ds_read_b64_tr_b16 a[116:117], v19 offset:20480
  v_mfma_f32_16x16x32_bf16 v[52:55], a[100:103], a[68:71], v[52:55]
  ds_read_b64_tr_b16 a[118:119], v19 offset:22528
  ds_read_b64_tr_b16 a[120:121], v20 offset:20480
  v_mfma_f32_16x16x32_bf16 v[68:71], a[100:103], a[72:75], v[68:71]
  buffer_load_dwordx4 v2, s[8:11], s70 offen offset:3072 sc1 lds
  ds_read_b64_tr_b16 a[122:123], v20 offset:22528
  v_mfma_f32_16x16x32_bf16 v[84:87], a[100:103], a[76:79], v[84:87]
  s_bfe_u32 s72, 0x3020106, s1
  s_add_u32 s0, s0, s72
  s_add_u32 s1, s1, 8
  v_mfma_f32_16x16x32_bf16 v[40:43], a[104:107], a[64:67], v[40:43]
  s_and_b32 s1, s1, 0x8001f
  s_and_b32 s0, s0, 7
  s_lshl_b32 s72, s0, 14
  v_mfma_f32_16x16x32_bf16 v[56:59], a[104:107], a[68:71], v[56:59]
  s_add_u32 s70, s92, s72
  ds_read_b64_tr_b16 a[124:125], v21 offset:20480
  ds_read_b64_tr_b16 a[126:127], v21 offset:22528
  v_mfma_f32_16x16x32_bf16 v[72:75], a[104:107], a[72:75], v[72:75]
  s_add_u32 s64, s64, s66
  s_add_u32 s65, s65, 1
  s_cmp_eq_u32 s65, 4
  s_cselect_b32 s65, 0, s65
  s_cselect_b32 s66, s67, s68
  v_mfma_f32_16x16x32_bf16 v[88:91], a[104:107], a[76:79], v[88:91]
  v_add_u32 v16, s66, v16
  v_add_u32 v17, s66, v17
  v_mfma_f32_16x16x32_bf16 v[44:47], a[108:111], a[64:67], v[44:47]
  v_add_u32 v18, s66, v18
  v_add_u32 v19, s66, v19
  v_mfma_f32_16x16x32_bf16 v[60:63], a[108:111], a[68:71], v[60:63]
  v_add_u32 v20, s66, v20
  v_add_u32 v21, s66, v21
  v_mfma_f32_16x16x32_bf16 v[76:79], a[108:111], a[72:75], v[76:79]
  v_mfma_f32_16x16x32_bf16 v[92:95], a[108:111], a[76:79], v[92:95]
  s_waitcnt vmcnt(16) lgkmcnt(0)
  s_barrier
  v_mfma_f32_16x16x32_bf16 v[32:35], a[112:115], a[80:83], v[32:35]
  s_add_u32 m0, s64, 16384
  ds_read_b128 a[64:67], v16 offset:0
  ds_read_b64_tr_b16 a[96:97], v18 offset:16384
  v_mfma_f32_16x16x32_bf16 v[48:51], a[112:115], a[84:87], v[48:51]
  buffer_load_dwordx4 v10, s[12:15], s71 offen offset:0 lds
  ds_read_b64_tr_b16 a[98:99], v18 offset:18432
  v_mfma_f32_16x16x32_bf16 v[64:67], a[112:115], a[88:91], v[64:67]
  ds_read_b128 a[68:71], v16 offset:1024
  ds_read_b128 a[72:75], v17 offset:0
  v_mfma_f32_16x16x32_bf16 v[80:83], a[112:115], a[92:95], v[80:83]
  buffer_load_dwordx4 v11, s[12:15], s71 offen offset:1024 lds
  ds_read_b128 a[76:79], v17 offset:1024
  v_mfma_f32_16x16x32_bf16 v[36:39], a[116:119], a[80:83], v[36:39]
  ds_read_b64_tr_b16 a[100:101], v19 offset:16384
  ds_read_b64_tr_b16 a[102:103], v19 offset:18432
  v_mfma_f32_16x16x32_bf16 v[52:55], a[116:119], a[84:87], v[52:55]
  ds_read_b64_tr_b16 a[104:105], v20 offset:16384
  ds_read_b64_tr_b16 a[106:107], v20 offset:18432
  v_mfma_f32_16x16x32_bf16 v[68:71], a[116:119], a[88:91], v[68:71]
  ds_read_b64_tr_b16 a[108:109], v21 offset:16384
  ds_read_b64_tr_b16 a[110:111], v21 offset:18432
  v_mfma_f32_16x16x32_bf16 v[84:87], a[116:119], a[92:95], v[84:87]
  buffer_load_dwordx4 v12, s[12:15], s71 offen offset:2048 lds
  v_mfma_f32_16x16x32_bf16 v[40:43], a[120:123], a[80:83], v[40:43]
  v_mfma_f32_16x16x32_bf16 v[56:59], a[120:123], a[84:87], v[56:59]
  v_mfma_f32_16x16x32_bf16 v[72:75], a[120:123], a[88:91], v[72:75]
  v_mfma_f32_16x16x32_bf16 v[88:91], a[120:123], a[92:95], v[88:91]
  buffer_load_dwordx4 v13, s[12:15], s71 offen offset:3072 lds
  v_mfma_f32_16x16x32_bf16 v[44:47], a[124:127], a[80:83], v[44:47]
  s_bfe_u32 s72, 0x3020106, s31
  s_add_u32 s30, s30, s72
  s_add_u32 s31, s31, 8
  v_mfma_f32_16x16x32_bf16 v[60:63], a[124:127], a[84:87], v[60:63]
  s_and_b32 s31, s31, 0x8001f
  s_and_b32 s30, s30, 7
  s_lshl_b32 s72, s30, 17
  v_mfma_f32_16x16x32_bf16 v[76:79], a[124:127], a[88:91], v[76:79]
  s_add_u32 s71, s93, s72
  v_mfma_f32_16x16x32_bf16 v[92:95], a[124:127], a[92:95], v[92:95]
  s_waitcnt lgkmcnt(0)
  v_mfma_f32_16x16x32_bf16 v[32:35], a[96:99], a[64:67], v[32:35]
  s_mov_b32 m0, s64
  ds_read_b128 a[80:83], v16 offset:8192
  ds_read_b64_tr_b16 a[112:113], v18 offset:20480
  v_mfma_f32_16x16x32_bf16 v[48:51], a[96:99], a[68:71], v[48:51]
  buffer_load_dwordx4 v2, s[8:11], s70 offen offset:0 sc1 lds
  ds_read_b64_tr_b16 a[114:115], v18 offset:22528
  v_mfma_f32_16x16x32_bf16 v[64:67], a[96:99], a[72:75], v[64:67]
  buffer_load_dwordx4 v2, s[8:11], s70 offen offset:1024 sc1 lds
  ds_read_b128 a[84:87], v16 offset:9216
  v_mfma_f32_16x16x32_bf16 v[80:83], a[96:99], a[76:79], v[80:83]
  ds_read_b128 a[88:91], v17 offset:8192
  ds_read_b128 a[92:95], v17 offset:9216
  v_mfma_f32_16x16x32_bf16 v[36:39], a[100:103], a[64:67], v[36:39]
  buffer_load_dwordx4 v2, s[8:11], s70 offen offset:2048 sc1 lds
  ds_read_b64_tr_b16 a[116:117], v19 offset:20480
  v_mfma_f32_16x16x32_bf16 v[52:55], a[100:103], a[68:71], v[52:55]
  ds_read_b64_tr_b16 a[118:119], v19 offset:22528
  ds_read_b64_tr_b16 a[120:121], v20 offset:20480
  v_mfma_f32_16x16x32_bf16 v[68:71], a[100:103], a[72:75], v[68:71]
  buffer_load_dwordx4 v2, s[8:11], s70 offen offset:3072 sc1 lds
  ds_read_b64_tr_b16 a[122:123], v20 offset:22528
  v_mfma_f32_16x16x32_bf16 v[84:87], a[100:103], a[76:79], v[84:87]
  s_bfe_u32 s72, 0x3020106, s1
  s_add_u32 s0, s0, s72
  s_add_u32 s1, s1, 8
  v_mfma_f32_16x16x32_bf16 v[40:43], a[104:107], a[64:67], v[40:43]
  s_and_b32 s1, s1, 0x8001f
  s_and_b32 s0, s0, 7
  s_lshl_b32 s72, s0, 14
  v_mfma_f32_16x16x32_bf16 v[56:59], a[104:107], a[68:71], v[56:59]
  s_add_u32 s70, s92, s72
  ds_read_b64_tr_b16 a[124:125], v21 offset:20480
  ds_read_b64_tr_b16 a[126:127], v21 offset:22528
  v_mfma_f32_16x16x32_bf16 v[72:75], a[104:107], a[72:75], v[72:75]
  s_add_u32 s64, s64, s66
  s_add_u32 s65, s65, 1
  s_cmp_eq_u32 s65, 4
  s_cselect_b32 s65, 0, s65
  s_cselect_b32 s66, s67, s68
  v_mfma_f32_16x16x32_bf16 v[88:91], a[104:107], a[76:79], v[88:91]
  v_add_u32 v16, s66, v16
  v_add_u32 v17, s66, v17
  v_mfma_f32_16x16x32_bf16 v[44:47], a[108:111], a[64:67], v[44:47]
  v_add_u32 v18, s66, v18
  v_add_u32 v19, s66, v19
  v_mfma_f32_16x16x32_bf16 v[60:63], a[108:111], a[68:71], v[60:63]
  v_add_u32 v20, s66, v20
  v_add_u32 v21, s66, v21
  v_mfma_f32_16x16x32_bf16 v[76:79], a[108:111], a[72:75], v[76:79]
  v_mfma_f32_16x16x32_bf16 v[92:95], a[108:111], a[76:79], v[92:95]
  s_waitcnt vmcnt(16) lgkmcnt(0)
  s_barrier
  v_mfma_f32_16x16x32_bf16 v[32:35], a[112:115], a[80:83], v[32:35]
  s_add_u32 m0, s64, 16384
  ds_read_b128 a[64:67], v16 offset:0
  ds_read_b64_tr_b16 a[96:97], v18 offset:16384
  v_mfma_f32_16x16x32_bf16 v[48:51], a[112:115], a[84:87], v[48:51]
  buffer_load_dwordx4 v10, s[12:15], s71 offen offset:0 lds
  ds_read_b64_tr_b16 a[98:99], v18 offset:18432
  v_mfma_f32_16x16x32_bf16 v[64:67], a[112:115], a[88:91], v[64:67]
  ds_read_b128 a[68:71], v16 offset:1024
  ds_read_b128 a[72:75], v17 offset:0
  v_mfma_f32_16x16x32_bf16 v[80:83], a[112:115], a[92:95], v[80:83]
  buffer_load_dwordx4 v11, s[12:15], s71 offen offset:1024 lds
  ds_read_b128 a[76:79], v17 offset:1024
  v_mfma_f32_16x16x32_bf16 v[36:39], a[116:119], a[80:83], v[36:39]
  ds_read_b64_tr_b16 a[100:101], v19 offset:16384
  ds_read_b64_tr_b16 a[102:103], v19 offset:18432
  v_mfma_f32_16x16x32_bf16 v[52:55], a[116:119], a[84:87], v[52:55]
  ds_read_b64_tr_b16 a[104:105], v20 offset:16384
  ds_read_b64_tr_b16 a[106:107], v20 offset:18432
  v_mfma_f32_16x16x32_bf16 v[68:71], a[116:119], a[88:91], v[68:71]
  ds_read_b64_tr_b16 a[108:109], v21 offset:16384
  ds_read_b64_tr_b16 a[110:111], v21 offset:18432
  v_mfma_f32_16x16x32_bf16 v[84:87], a[116:119], a[92:95], v[84:87]
  buffer_load_dwordx4 v12, s[12:15], s71 offen offset:2048 lds
  v_mfma_f32_16x16x32_bf16 v[40:43], a[120:123], a[80:83], v[40:43]
  v_mfma_f32_16x16x32_bf16 v[56:59], a[120:123], a[84:87], v[56:59]
  v_mfma_f32_16x16x32_bf16 v[72:75], a[120:123], a[88:91], v[72:75]
  v_mfma_f32_16x16x32_bf16 v[88:91], a[120:123], a[92:95], v[88:91]
  buffer_load_dwordx4 v13, s[12:15], s71 offen offset:3072 lds
  v_mfma_f32_16x16x32_bf16 v[44:47], a[124:127], a[80:83], v[44:47]
  s_bfe_u32 s72, 0x3020106, s31
  s_add_u32 s30, s30, s72
  s_add_u32 s31, s31, 8
  v_mfma_f32_16x16x32_bf16 v[60:63], a[124:127], a[84:87], v[60:63]
  s_and_b32 s31, s31, 0x8001f
  s_and_b32 s30, s30, 7
  s_lshl_b32 s72, s30, 17
  v_mfma_f32_16x16x32_bf16 v[76:79], a[124:127], a[88:91], v[76:79]
  s_add_u32 s71, s93, s72
  v_mfma_f32_16x16x32_bf16 v[92:95], a[124:127], a[92:95], v[92:95]
  s_waitcnt lgkmcnt(0)
  v_mfma_f32_16x16x32_bf16 v[32:35], a[96:99], a[64:67], v[32:35]
  s_mov_b32 m0, s64
  ds_read_b128 a[80:83], v16 offset:8192
  ds_read_b64_tr_b16 a[112:113], v18 offset:20480
  v_mfma_f32_16x16x32_bf16 v[48:51], a[96:99], a[68:71], v[48:51]
  buffer_load_dwordx4 v2, s[8:11], s70 offen offset:0 sc1 lds
  ds_read_b64_tr_b16 a[114:115], v18 offset:22528
  v_mfma_f32_16x16x32_bf16 v[64:67], a[96:99], a[72:75], v[64:67]
  buffer_load_dwordx4 v2, s[8:11], s70 offen offset:1024 sc1 lds
  ds_read_b128 a[84:87], v16 offset:9216
  v_mfma_f32_16x16x32_bf16 v[80:83], a[96:99], a[76:79], v[80:83]
  ds_read_b128 a[88:91], v17 offset:8192
  ds_read_b128 a[92:95], v17 offset:9216
  v_mfma_f32_16x16x32_bf16 v[36:39], a[100:103], a[64:67], v[36:39]
  buffer_load_dwordx4 v2, s[8:11], s70 offen offset:2048 sc1 lds
  ds_read_b64_tr_b16 a[116:117], v19 offset:20480
  v_mfma_f32_16x16x32_bf16 v[52:55], a[100:103], a[68:71], v[52:55]
  ds_read_b64_tr_b16 a[118:119], v19 offset:22528
  ds_read_b64_tr_b16 a[120:121], v20 offset:20480
  v_mfma_f32_16x16x32_bf16 v[68:71], a[100:103], a[72:75], v[68:71]
  buffer_load_dwordx4 v2, s[8:11], s70 offen offset:3072 sc1 lds
  ds_read_b64_tr_b16 a[122:123], v20 offset:22528
  v_mfma_f32_16x16x32_bf16 v[84:87], a[100:103], a[76:79], v[84:87]
  s_bfe_u32 s72, 0x3020106, s1
  s_add_u32 s0, s0, s72
  s_add_u32 s1, s1, 8
  v_mfma_f32_16x16x32_bf16 v[40:43], a[104:107], a[64:67], v[40:43]
  s_and_b32 s1, s1, 0x8001f
  s_and_b32 s0, s0, 7
  s_lshl_b32 s72, s0, 14
  v_mfma_f32_16x16x32_bf16 v[56:59], a[104:107], a[68:71], v[56:59]
  s_add_u32 s70, s92, s72
  ds_read_b64_tr_b16 a[124:125], v21 offset:20480
  ds_read_b64_tr_b16 a[126:127], v21 offset:22528
  v_mfma_f32_16x16x32_bf16 v[72:75], a[104:107], a[72:75], v[72:75]
  s_add_u32 s64, s64, s66
  s_add_u32 s65, s65, 1
  s_cmp_eq_u32 s65, 4
  s_cselect_b32 s65, 0, s65
  s_cselect_b32 s66, s67, s68
  v_mfma_f32_16x16x32_bf16 v[88:91], a[104:107], a[76:79], v[88:91]
  v_add_u32 v16, s66, v16
  v_add_u32 v17, s66, v17
  v_mfma_f32_16x16x32_bf16 v[44:47], a[108:111], a[64:67], v[44:47]
  v_add_u32 v18, s66, v18
  v_add_u32 v19, s66, v19
  v_mfma_f32_16x16x32_bf16 v[60:63], a[108:111], a[68:71], v[60:63]
  v_add_u32 v20, s66, v20
  v_add_u32 v21, s66, v21
  v_mfma_f32_16x16x32_bf16 v[76:79], a[108:111], a[72:75], v[76:79]
  v_mfma_f32_16x16x32_bf16 v[92:95], a[108:111], a[76:79], v[92:95]
  s_waitcnt vmcnt(16) lgkmcnt(0)
  s_barrier
  v_mfma_f32_16x16x32_bf16 v[32:35], a[112:115], a[80:83], v[32:35]
  buffer_load_dwordx2 v[6:7], v14, s[96:99], s91 offen sc1
  ds_read_b128 a[64:67], v16 offset:0
  v_mfma_f32_16x16x32_bf16 v[48:51], a[112:115], a[84:87], v[48:51]
  s_mov_b32 s12, s74
  s_mov_b32 s13, s75
  s_mov_b32 s14, 8388608
  v_mfma_f32_16x16x32_bf16 v[64:67], a[112:115], a[88:91], v[64:67]
  s_mov_b32 s15, 0x00020000
  s_lshl_b32 s93, s77, 22
  s_lshl_b32 s72, s76, 8
  v_mfma_f32_16x16x32_bf16 v[80:83], a[112:115], a[92:95], v[80:83]
  s_add_u32 s93, s93, s72
  s_add_u32 s72, s73, s76
  s_and_b32 s31, s72, 3
  v_mfma_f32_16x16x32_bf16 v[36:39], a[116:119], a[80:83], v[36:39]
  s_lshl_b32 s31, s31, 3
  s_or_b32 s31, s31, 0x80000
  s_bfe_u32 s30, 0x1b1b02, s31
  v_mfma_f32_16x16x32_bf16 v[52:55], a[116:119], a[84:87], v[52:55]
  s_add_u32 s30, s30, 0
  s_cmp_ge_u32 s30, 28
  s_cselect_b32 s72, 28, 0
  v_mfma_f32_16x16x32_bf16 v[68:71], a[116:119], a[88:91], v[68:71]
  s_sub_u32 s30, s30, s72
  s_lshl_b32 s72, s30, 17
  s_add_u32 s71, s93, s72
  v_mfma_f32_16x16x32_bf16 v[84:87], a[116:119], a[92:95], v[84:87]
  s_add_u32 m0, s64, 16384
  ds_read_b64_tr_b16 a[96:97], v18 offset:16384
  ds_read_b64_tr_b16 a[98:99], v18 offset:18432
  v_mfma_f32_16x16x32_bf16 v[40:43], a[120:123], a[80:83], v[40:43]
  buffer_load_dwordx4 v10, s[12:15], s71 offen offset:0 lds
  ds_read_b128 a[68:71], v16 offset:1024
  v_mfma_f32_16x16x32_bf16 v[56:59], a[120:123], a[84:87], v[56:59]
  ds_read_b128 a[72:75], v17 offset:0
  ds_read_b128 a[76:79], v17 offset:1024
  v_mfma_f32_16x16x32_bf16 v[72:75], a[120:123], a[88:91], v[72:75]
  buffer_load_dwordx4 v11, s[12:15], s71 offen offset:1024 lds
  ds_read_b64_tr_b16 a[100:101], v19 offset:16384
  v_mfma_f32_16x16x32_bf16 v[88:91], a[120:123], a[92:95], v[88:91]
  ds_read_b64_tr_b16 a[102:103], v19 offset:18432
  ds_read_b64_tr_b16 a[104:105], v20 offset:16384
  v_mfma_f32_16x16x32_bf16 v[44:47], a[124:127], a[80:83], v[44:47]
  ds_read_b64_tr_b16 a[106:107], v20 offset:18432
  ds_read_b64_tr_b16 a[108:109], v21 offset:16384
  v_mfma_f32_16x16x32_bf16 v[60:63], a[124:127], a[84:87], v[60:63]
  ds_read_b64_tr_b16 a[110:111], v21 offset:18432
  v_mfma_f32_16x16x32_bf16 v[76:79], a[124:127], a[88:91], v[76:79]
  v_mfma_f32_16x16x32_bf16 v[92:95], a[124:127], a[92:95], v[92:95]
  s_waitcnt lgkmcnt(0)
  v_mfma_f32_16x16x32_bf16 v[32:35], a[96:99], a[64:67], v[32:35]
  buffer_load_dwordx4 v12, s[12:15], s71 offen offset:2048 lds
  ds_read_b128 a[80:83], v16 offset:8192
  v_mfma_f32_16x16x32_bf16 v[48:51], a[96:99], a[68:71], v[48:51]
  ds_read_b64_tr_b16 a[112:113], v18 offset:20480
  ds_read_b64_tr_b16 a[114:115], v18 offset:22528
  v_mfma_f32_16x16x32_bf16 v[64:67], a[96:99], a[72:75], v[64:67]
  ds_read_b128 a[84:87], v16 offset:9216
  ds_read_b128 a[88:91], v17 offset:8192
  v_mfma_f32_16x16x32_bf16 v[80:83], a[96:99], a[76:79], v[80:83]
  ds_read_b128 a[92:95], v17 offset:9216
  ds_read_b64_tr_b16 a[116:117], v19 offset:20480
  v_mfma_f32_16x16x32_bf16 v[36:39], a[100:103], a[64:67], v[36:39]
  buffer_load_dwordx4 v13, s[12:15], s71 offen offset:3072 lds
  ds_read_b64_tr_b16 a[118:119], v19 offset:22528
  v_mfma_f32_16x16x32_bf16 v[52:55], a[100:103], a[68:71], v[52:55]
  s_bfe_u32 s72, 0x302011a, s31
  s_add_u32 s30, s30, s72
  s_add_u32 s31, s31, 8
  v_mfma_f32_16x16x32_bf16 v[68:71], a[100:103], a[72:75], v[68:71]
  s_and_b32 s31, s31, 0x8001f
  s_cmp_ge_u32 s30, 28
  s_cselect_b32 s72, 28, 0
  v_mfma_f32_16x16x32_bf16 v[84:87], a[100:103], a[76:79], v[84:87]
  s_sub_u32 s30, s30, s72
  s_lshl_b32 s72, s30, 17
  s_add_u32 s71, s93, s72
  v_mfma_f32_16x16x32_bf16 v[40:43], a[104:107], a[64:67], v[40:43]
  s_add_u32 s64, s64, s66
  ds_read_b64_tr_b16 a[120:121], v20 offset:20480
  ds_read_b64_tr_b16 a[122:123], v20 offset:22528
  v_mfma_f32_16x16x32_bf16 v[56:59], a[104:107], a[68:71], v[56:59]
  s_add_u32 s65, s65, 1
  ds_read_b64_tr_b16 a[124:125], v21 offset:20480
  ds_read_b64_tr_b16 a[126:127], v21 offset:22528
  v_mfma_f32_16x16x32_bf16 v[72:75], a[104:107], a[72:75], v[72:75]
  s_cmp_eq_u32 s65, 4
  s_cselect_b32 s65, 0, s65
  s_cselect_b32 s66, s67, s68
  v_mfma_f32_16x16x32_bf16 v[88:91], a[104:107], a[76:79], v[88:91]
  v_add_u32 v16, s66, v16
  v_add_u32 v17, s66, v17
  v_mfma_f32_16x16x32_bf16 v[44:47], a[108:111], a[64:67], v[44:47]
  v_add_u32 v18, s66, v18
  v_add_u32 v19, s66, v19
  v_mfma_f32_16x16x32_bf16 v[60:63], a[108:111], a[68:71], v[60:63]
  v_add_u32 v20, s66, v20
  v_add_u32 v21, s66, v21
  v_mfma_f32_16x16x32_bf16 v[76:79], a[108:111], a[72:75], v[76:79]
  v_mfma_f32_16x16x32_bf16 v[92:95], a[108:111], a[76:79], v[92:95]
  s_waitcnt vmcnt(4)
  v_cmp_ne_u64 vcc, s[94:95], v[6:7]
  s_nop 1
  v_cndmask_b32_e64 v8, 0, 1, vcc
  v_lshlrev_b32 v9, 2, v0
  ds_write_b32 v9, v8
  v_lshlrev_b32 v9, 4, v1
  s_waitcnt lgkmcnt(0)
  s_barrier
  ds_read_b128 v[160:163], v9
  s_waitcnt lgkmcnt(0)
  v_or3_b32 v160, v160, v161, v162
  v_or_b32 v160, v160, v163
  v_cmp_ne_u32 vcc, 0, v160
  s_nop 0
  s_cbranch_vccnz Lp6_late
  s_add_u32 s8, s86, 67108864
  s_addc_u32 s9, s87, 0
  s_mov_b32 s10, 16777216
  s_mov_b32 s11, 0x00020000
  s_lshl_b32 s92, s73, 1
  s_add_u32 s92, s92, s77
  s_lshl_b32 s92, s92, 19
  s_add_u32 s92, s92, s79
  s_add_u32 s72, s73, s76
  s_and_b32 s1, s72, 3
  s_lshl_b32 s1, s1, 3
  s_or_b32 s1, s1, 0x80000
  s_bfe_u32 s0, 0x1b1b02, s1
  s_add_u32 s0, s0, 0
  s_cmp_ge_u32 s0, 28
  s_cselect_b32 s72, 28, 0
  s_sub_u32 s0, s0, s72
  s_lshl_b32 s72, s0, 14
  s_add_u32 s70, s92, s72
  v_mfma_f32_16x16x32_bf16 v[32:35], a[112:115], a[80:83], v[32:35]
  s_add_u32 m0, s79, 131072
  ds_read_b128 a[64:67], v16 offset:0
  ds_read_b64_tr_b16 a[96:97], v18 offset:16384
  v_mfma_f32_16x16x32_bf16 v[48:51], a[112:115], a[84:87], v[48:51]
  buffer_load_dwordx4 v2, s[8:11], s70 offen offset:0 sc1 lds
  ds_read_b64_tr_b16 a[98:99], v18 offset:18432
  v_mfma_f32_16x16x32_bf16 v[64:67], a[112:115], a[88:91], v[64:67]
  buffer_load_dwordx4 v2, s[8:11], s70 offen offset:1024 sc1 lds
  ds_read_b128 a[68:71], v16 offset:1024
  v_mfma_f32_16x16x32_bf16 v[80:83], a[112:115], a[92:95], v[80:83]
  ds_read_b128 a[72:75], v17 offset:0
  ds_read_b128 a[76:79], v17 offset:1024
  v_mfma_f32_16x16x32_bf16 v[36:39], a[116:119], a[80:83], v[36:39]
  ds_read_b64_tr_b16 a[100:101], v19 offset:16384
  ds_read_b64_tr_b16 a[102:103], v19 offset:18432
  v_mfma_f32_16x16x32_bf16 v[52:55], a[116:119], a[84:87], v[52:55]
  buffer_load_dwordx4 v2, s[8:11], s70 offen offset:2048 sc1 lds
  ds_read_b64_tr_b16 a[104:105], v20 offset:16384
  v_mfma_f32_16x16x32_bf16 v[68:71], a[116:119], a[88:91], v[68:71]
  ds_read_b64_tr_b16 a[106:107], v20 offset:18432
  ds_read_b64_tr_b16 a[108:109], v21 offset:16384
  v_mfma_f32_16x16x32_bf16 v[84:87], a[116:119], a[92:95], v[84:87]
  buffer_load_dwordx4 v2, s[8:11], s70 offen offset:3072 sc1 lds
  ds_read_b64_tr_b16 a[110:111], v21 offset:18432
  v_mfma_f32_16x16x32_bf16 v[40:43], a[120:123], a[80:83], v[40:43]
  s_bfe_u32 s72, 0x302011a, s1
  s_add_u32 s0, s0, s72
  s_add_u32 s1, s1, 8
  v_mfma_f32_16x16x32_bf16 v[56:59], a[120:123], a[84:87], v[56:59]
  s_and_b32 s1, s1, 0x8001f
  s_cmp_ge_u32 s0, 28
  s_cselect_b32 s72, 28, 0
  v_mfma_f32_16x16x32_bf16 v[72:75], a[120:123], a[88:91], v[72:75]
  s_sub_u32 s0, s0, s72
  s_lshl_b32 s72, s0, 14
  s_add_u32 s70, s92, s72
  v_mfma_f32_16x16x32_bf16 v[88:91], a[120:123], a[92:95], v[88:91]
  s_add_u32 m0, s64, 16384
  v_mfma_f32_16x16x32_bf16 v[44:47], a[124:127], a[80:83], v[44:47]
  buffer_load_dwordx4 v10, s[12:15], s71 offen offset:0 lds
  v_mfma_f32_16x16x32_bf16 v[60:63], a[124:127], a[84:87], v[60:63]
  buffer_load_dwordx4 v11, s[12:15], s71 offen offset:1024 lds
  v_mfma_f32_16x16x32_bf16 v[76:79], a[124:127], a[88:91], v[76:79]
  v_mfma_f32_16x16x32_bf16 v[92:95], a[124:127], a[92:95], v[92:95]
  s_waitcnt lgkmcnt(0)
  v_mfma_f32_16x16x32_bf16 v[32:35], a[96:99], a[64:67], v[32:35]
  buffer_load_dwordx4 v12, s[12:15], s71 offen offset:2048 lds
  ds_read_b128 a[80:83], v16 offset:8192
  v_mfma_f32_16x16x32_bf16 v[48:51], a[96:99], a[68:71], v[48:51]
  buffer_load_dwordx4 v13, s[12:15], s71 offen offset:3072 lds
  ds_read_b64_tr_b16 a[112:113], v18 offset:20480
  v_mfma_f32_16x16x32_bf16 v[64:67], a[96:99], a[72:75], v[64:67]
  s_bfe_u32 s72, 0x302011a, s31
  s_add_u32 s30, s30, s72
  s_add_u32 s31, s31, 8
  v_mfma_f32_16x16x32_bf16 v[80:83], a[96:99], a[76:79], v[80:83]
  s_and_b32 s31, s31, 0x8001f
  s_cmp_ge_u32 s30, 28
  s_cselect_b32 s72, 28, 0
  v_mfma_f32_16x16x32_bf16 v[36:39], a[100:103], a[64:67], v[36:39]
  s_sub_u32 s30, s30, s72
  s_lshl_b32 s72, s30, 17
  s_add_u32 s71, s93, s72
  v_mfma_f32_16x16x32_bf16 v[52:55], a[100:103], a[68:71], v[52:55]
  s_mov_b32 m0, s64
  ds_read_b64_tr_b16 a[114:115], v18 offset:22528
  ds_read_b128 a[84:87], v16 offset:9216
  v_mfma_f32_16x16x32_bf16 v[68:71], a[100:103], a[72:75], v[68:71]
  buffer_load_dwordx4 v2, s[8:11], s70 offen offset:0 sc1 lds
  ds_read_b128 a[88:91], v17 offset:8192
  v_mfma_f32_16x16x32_bf16 v[84:87], a[100:103], a[76:79], v[84:87]
  buffer_load_dwordx4 v2, s[8:11], s70 offen offset:1024 sc1 lds
  ds_read_b128 a[92:95], v17 offset:9216
  v_mfma_f32_16x16x32_bf16 v[40:43], a[104:107], a[64:67], v[40:43]
  buffer_load_dwordx4 v2, s[8:11], s70 offen offset:2048 sc1 lds
  ds_read_b64_tr_b16 a[116:117], v19 offset:20480
  v_mfma_f32_16x16x32_bf16 v[56:59], a[104:107], a[68:71], v[56:59]
  buffer_load_dwordx4 v2, s[8:11], s70 offen offset:3072 sc1 lds
  ds_read_b64_tr_b16 a[118:119], v19 offset:22528
  v_mfma_f32_16x16x32_bf16 v[72:75], a[104:107], a[72:75], v[72:75]
  s_bfe_u32 s72, 0x302011a, s1
  s_add_u32 s0, s0, s72
  s_add_u32 s1, s1, 8
  v_mfma_f32_16x16x32_bf16 v[88:91], a[104:107], a[76:79], v[88:91]
  s_and_b32 s1, s1, 0x8001f
  s_cmp_ge_u32 s0, 28
  s_cselect_b32 s72, 28, 0
  v_mfma_f32_16x16x32_bf16 v[44:47], a[108:111], a[64:67], v[44:47]
  s_sub_u32 s0, s0, s72
  s_lshl_b32 s72, s0, 14
  s_add_u32 s70, s92, s72
  v_mfma_f32_16x16x32_bf16 v[60:63], a[108:111], a[68:71], v[60:63]
  s_add_u32 s64, s64, s66
  ds_read_b64_tr_b16 a[120:121], v20 offset:20480
  ds_read_b64_tr_b16 a[122:123], v20 offset:22528
  v_mfma_f32_16x16x32_bf16 v[76:79], a[108:111], a[72:75], v[76:79]
  s_add_u32 s65, s65, 1
  ds_read_b64_tr_b16 a[124:125], v21 offset:20480
  ds_read_b64_tr_b16 a[126:127], v21 offset:22528
  v_mfma_f32_16x16x32_bf16 v[92:95], a[108:111], a[76:79], v[92:95]
  s_cmp_eq_u32 s65, 4
  s_cselect_b32 s65, 0, s65
  s_cselect_b32 s66, s67, s68
  v_add_u32 v16, s66, v16
  v_add_u32 v17, s66, v17
  v_add_u32 v18, s66, v18
  v_add_u32 v19, s66, v19
  v_add_u32 v20, s66, v20
  v_add_u32 v21, s66, v21
  s_waitcnt vmcnt(16) lgkmcnt(0)
  s_barrier
  v_mfma_f32_16x16x32_bf16 v[32:35], a[112:115], a[80:83], v[32:35]
  s_add_u32 m0, s64, 16384
  ds_read_b128 a[64:67], v16 offset:0
  ds_read_b64_tr_b16 a[96:97], v18 offset:16384
  v_mfma_f32_16x16x32_bf16 v[48:51], a[112:115], a[84:87], v[48:51]
  buffer_load_dwordx4 v10, s[12:15], s71 offen offset:0 lds
  ds_read_b64_tr_b16 a[98:99], v18 offset:18432
  v_mfma_f32_16x16x32_bf16 v[64:67], a[112:115], a[88:91], v[64:67]
  ds_read_b128 a[68:71], v16 offset:1024
  ds_read_b128 a[72:75], v17 offset:0
  v_mfma_f32_16x16x32_bf16 v[80:83], a[112:115], a[92:95], v[80:83]
  buffer_load_dwordx4 v11, s[12:15], s71 offen offset:1024 lds
  ds_read_b128 a[76:79], v17 offset:1024
  v_mfma_f32_16x16x32_bf16 v[36:39], a[116:119], a[80:83], v[36:39]
  ds_read_b64_tr_b16 a[100:101], v19 offset:16384
  ds_read_b64_tr_b16 a[102:103], v19 offset:18432
  v_mfma_f32_16x16x32_bf16 v[52:55], a[116:119], a[84:87], v[52:55]
  ds_read_b64_tr_b16 a[104:105], v20 offset:16384
  ds_read_b64_tr_b16 a[106:107], v20 offset:18432
  v_mfma_f32_16x16x32_bf16 v[68:71], a[116:119], a[88:91], v[68:71]
  ds_read_b64_tr_b16 a[108:109], v21 offset:16384
  ds_read_b64_tr_b16 a[110:111], v21 offset:18432
  v_mfma_f32_16x16x32_bf16 v[84:87], a[116:119], a[92:95], v[84:87]
  buffer_load_dwordx4 v12, s[12:15], s71 offen offset:2048 lds
  v_mfma_f32_16x16x32_bf16 v[40:43], a[120:123], a[80:83], v[40:43]
  v_mfma_f32_16x16x32_bf16 v[56:59], a[120:123], a[84:87], v[56:59]
  v_mfma_f32_16x16x32_bf16 v[72:75], a[120:123], a[88:91], v[72:75]
  v_mfma_f32_16x16x32_bf16 v[88:91], a[120:123], a[92:95], v[88:91]
  buffer_load_dwordx4 v13, s[12:15], s71 offen offset:3072 lds
  v_mfma_f32_16x16x32_bf16 v[44:47], a[124:127], a[80:83], v[44:47]
  s_bfe_u32 s72, 0x302011a, s31
  s_add_u32 s30, s30, s72
  s_add_u32 s31, s31, 8
  v_mfma_f32_16x16x32_bf16 v[60:63], a[124:127], a[84:87], v[60:63]
  s_and_b32 s31, s31, 0x8001f
  s_cmp_ge_u32 s30, 28
  s_cselect_b32 s72, 28, 0
  v_mfma_f32_16x16x32_bf16 v[76:79], a[124:127], a[88:91], v[76:79]
  s_sub_u32 s30, s30, s72
  s_lshl_b32 s72, s30, 17
  s_add_u32 s71, s93, s72
  v_mfma_f32_16x16x32_bf16 v[92:95], a[124:127], a[92:95], v[92:95]
  s_waitcnt lgkmcnt(0)
  v_mfma_f32_16x16x32_bf16 v[32:35], a[96:99], a[64:67], v[32:35]
  s_mov_b32 m0, s64
  ds_read_b128 a[80:83], v16 offset:8192
  ds_read_b64_tr_b16 a[112:113], v18 offset:20480
  v_mfma_f32_16x16x32_bf16 v[48:51], a[96:99], a[68:71], v[48:51]
  buffer_load_dwordx4 v2, s[8:11], s70 offen offset:0 sc1 lds
  ds_read_b64_tr_b16 a[114:115], v18 offset:22528
  v_mfma_f32_16x16x32_bf16 v[64:67], a[96:99], a[72:75], v[64:67]
  buffer_load_dwordx4 v2, s[8:11], s70 offen offset:1024 sc1 lds
  ds_read_b128 a[84:87], v16 offset:9216
  v_mfma_f32_16x16x32_bf16 v[80:83], a[96:99], a[76:79], v[80:83]
  ds_read_b128 a[88:91], v17 offset:8192
  ds_read_b128 a[92:95], v17 offset:9216
  v_mfma_f32_16x16x32_bf16 v[36:39], a[100:103], a[64:67], v[36:39]
  buffer_load_dwordx4 v2, s[8:11], s70 offen offset:2048 sc1 lds
  ds_read_b64_tr_b16 a[116:117], v19 offset:20480
  v_mfma_f32_16x16x32_bf16 v[52:55], a[100:103], a[68:71], v[52:55]
  ds_read_b64_tr_b16 a[118:119], v19 offset:22528
  ds_read_b64_tr_b16 a[120:121], v20 offset:20480
  v_mfma_f32_16x16x32_bf16 v[68:71], a[100:103], a[72:75], v[68:71]
  buffer_load_dwordx4 v2, s[8:11], s70 offen offset:3072 sc1 lds
  ds_read_b64_tr_b16 a[122:123], v20 offset:22528
  v_mfma_f32_16x16x32_bf16 v[84:87], a[100:103], a[76:79], v[84:87]
  s_bfe_u32 s72, 0x302011a, s1
  s_add_u32 s0, s0, s72
  s_add_u32 s1, s1, 8
  v_mfma_f32_16x16x32_bf16 v[40:43], a[104:107], a[64:67], v[40:43]
  s_and_b32 s1, s1, 0x8001f
  s_cmp_ge_u32 s0, 28
  s_cselect_b32 s72, 28, 0
  v_mfma_f32_16x16x32_bf16 v[56:59], a[104:107], a[68:71], v[56:59]
  s_sub_u32 s0, s0, s72
  s_lshl_b32 s72, s0, 14
  s_add_u32 s70, s92, s72
  v_mfma_f32_16x16x32_bf16 v[72:75], a[104:107], a[72:75], v[72:75]
  s_add_u32 s64, s64, s66
  ds_read_b64_tr_b16 a[124:125], v21 offset:20480
  ds_read_b64_tr_b16 a[126:127], v21 offset:22528
  v_mfma_f32_16x16x32_bf16 v[88:91], a[104:107], a[76:79], v[88:91]
  s_add_u32 s65, s65, 1
  s_cmp_eq_u32 s65, 4
  s_cselect_b32 s65, 0, s65
  s_cselect_b32 s66, s67, s68
  v_mfma_f32_16x16x32_bf16 v[44:47], a[108:111], a[64:67], v[44:47]
  v_add_u32 v16, s66, v16
  v_add_u32 v17, s66, v17
  v_mfma_f32_16x16x32_bf16 v[60:63], a[108:111], a[68:71], v[60:63]
  v_add_u32 v18, s66, v18
  v_add_u32 v19, s66, v19
  v_mfma_f32_16x16x32_bf16 v[76:79], a[108:111], a[72:75], v[76:79]
  v_add_u32 v20, s66, v20
  v_add_u32 v21, s66, v21
  v_mfma_f32_16x16x32_bf16 v[92:95], a[108:111], a[76:79], v[92:95]
  s_waitcnt vmcnt(16) lgkmcnt(0)
  s_barrier
  v_mfma_f32_16x16x32_bf16 v[32:35], a[112:115], a[80:83], v[32:35]
  s_add_u32 m0, s64, 16384
  ds_read_b128 a[64:67], v16 offset:0
  ds_read_b64_tr_b16 a[96:97], v18 offset:16384
  v_mfma_f32_16x16x32_bf16 v[48:51], a[112:115], a[84:87], v[48:51]
  buffer_load_dwordx4 v10, s[12:15], s71 offen offset:0 lds
  ds_read_b64_tr_b16 a[98:99], v18 offset:18432
  v_mfma_f32_16x16x32_bf16 v[64:67], a[112:115], a[88:91], v[64:67]
  buffer_load_dwordx4 v11, s[12:15], s71 offen offset:1024 lds
  ds_read_b128 a[68:71], v16 offset:1024
  v_mfma_f32_16x16x32_bf16 v[80:83], a[112:115], a[92:95], v[80:83]
  buffer_load_dwordx4 v12, s[12:15], s71 offen offset:2048 lds
  ds_read_b128 a[72:75], v17 offset:0
  v_mfma_f32_16x16x32_bf16 v[36:39], a[116:119], a[80:83], v[36:39]
  ds_read_b128 a[76:79], v17 offset:1024
  ds_read_b64_tr_b16 a[100:101], v19 offset:16384
  v_mfma_f32_16x16x32_bf16 v[52:55], a[116:119], a[84:87], v[52:55]
  buffer_load_dwordx4 v13, s[12:15], s71 offen offset:3072 lds
  ds_read_b64_tr_b16 a[102:103], v19 offset:18432
  v_mfma_f32_16x16x32_bf16 v[68:71], a[116:119], a[88:91], v[68:71]
  s_bfe_u32 s72, 0x302011a, s31
  s_add_u32 s30, s30, s72
  s_add_u32 s31, s31, 8
  v_mfma_f32_16x16x32_bf16 v[84:87], a[116:119], a[92:95], v[84:87]
  s_and_b32 s31, s31, 0x8001f
  s_cmp_ge_u32 s30, 28
  s_cselect_b32 s72, 28, 0
  v_mfma_f32_16x16x32_bf16 v[40:43], a[120:123], a[80:83], v[40:43]
  s_sub_u32 s30, s30, s72
  s_lshl_b32 s72, s30, 17
  s_add_u32 s71, s93, s72
  v_mfma_f32_16x16x32_bf16 v[56:59], a[120:123], a[84:87], v[56:59]
  s_mov_b32 m0, s64
  ds_read_b64_tr_b16 a[104:105], v20 offset:16384
  ds_read_b64_tr_b16 a[106:107], v20 offset:18432
  v_mfma_f32_16x16x32_bf16 v[72:75], a[120:123], a[88:91], v[72:75]
  buffer_load_dwordx4 v2, s[8:11], s70 offen offset:0 sc1 lds
  ds_read_b64_tr_b16 a[108:109], v21 offset:16384
  v_mfma_f32_16x16x32_bf16 v[88:91], a[120:123], a[92:95], v[88:91]
  buffer_load_dwordx4 v2, s[8:11], s70 offen offset:1024 sc1 lds
  ds_read_b64_tr_b16 a[110:111], v21 offset:18432
  v_mfma_f32_16x16x32_bf16 v[44:47], a[124:127], a[80:83], v[44:47]
  buffer_load_dwordx4 v2, s[8:11], s70 offen offset:2048 sc1 lds
  v_mfma_f32_16x16x32_bf16 v[60:63], a[124:127], a[84:87], v[60:63]
  buffer_load_dwordx4 v2, s[8:11], s70 offen offset:3072 sc1 lds
  v_mfma_f32_16x16x32_bf16 v[76:79], a[124:127], a[88:91], v[76:79]
  s_bfe_u32 s72, 0x302011a, s1
  s_add_u32 s0, s0, s72
  s_add_u32 s1, s1, 8
  v_mfma_f32_16x16x32_bf16 v[92:95], a[124:127], a[92:95], v[92:95]
  s_and_b32 s1, s1, 0x8001f
  s_cmp_ge_u32 s0, 28
  s_cselect_b32 s72, 28, 0
  s_sub_u32 s0, s0, s72
  s_lshl_b32 s72, s0, 14
  s_add_u32 s70, s92, s72
  s_waitcnt lgkmcnt(0)
  s_lshl_b32 s6, s78, 1
  s_add_u32 s6, s6, s77
  s_xor_b32 s6, s6, 1
  s_lshl_b32 s6, s6, 2
  s_add_u32 s6, s6, s3
  s_lshl_b32 s6, s6, 14
  s_add_u32 s6, s6, 8192
  s_add_u32 s7, s6, 4096
  v_mfma_f32_16x16x32_bf16 v[96:99], a[96:99], a[64:67], 0
  s_add_u32 s64, s64, s66
  ds_read_b128 a[80:83], v16 offset:8192
  ds_read_b64_tr_b16 a[112:113], v18 offset:20480
  v_mfma_f32_16x16x32_bf16 v[112:115], a[96:99], a[68:71], 0
  s_add_u32 s65, s65, 1
  ds_read_b64_tr_b16 a[114:115], v18 offset:22528
  ds_read_b128 a[84:87], v16 offset:9216
  v_mfma_f32_16x16x32_bf16 v[128:131], a[96:99], a[72:75], 0
  s_cmp_eq_u32 s65, 4
  s_cselect_b32 s65, 0, s65
  s_cselect_b32 s66, s67, s68
  ds_read_b128 a[88:91], v17 offset:8192
  ds_read_b128 a[92:95], v17 offset:9216
  v_mfma_f32_16x16x32_bf16 v[144:147], a[96:99], a[76:79], 0
  ds_read_b64_tr_b16 a[116:117], v19 offset:20480
  v_mfma_f32_16x16x32_bf16 v[100:103], a[100:103], a[64:67], 0
  ds_read_b64_tr_b16 a[118:119], v19 offset:22528
  ds_read_b64_tr_b16 a[120:121], v20 offset:20480
  v_mfma_f32_16x16x32_bf16 v[116:119], a[100:103], a[68:71], 0
  ds_read_b64_tr_b16 a[122:123], v20 offset:22528
  ds_read_b64_tr_b16 a[124:125], v21 offset:20480
  v_mfma_f32_16x16x32_bf16 v[132:135], a[100:103], a[72:75], 0
  buffer_store_dwordx4 v[64:67], v2, s[16:19], s6 offen offset:0 sc1
  ds_read_b64_tr_b16 a[126:127], v21 offset:22528
  v_mfma_f32_16x16x32_bf16 v[148:151], a[100:103], a[76:79], 0
  v_add_u32 v16, s66, v16
  v_add_u32 v17, s66, v17
  v_mfma_f32_16x16x32_bf16 v[104:107], a[104:107], a[64:67], 0
  v_add_u32 v18, s66, v18
  v_add_u32 v19, s66, v19
  v_mfma_f32_16x16x32_bf16 v[120:123], a[104:107], a[68:71], 0
  v_add_u32 v20, s66, v20
  v_add_u32 v21, s66, v21
  v_mfma_f32_16x16x32_bf16 v[136:139], a[104:107], a[72:75], 0
  buffer_store_dwordx4 v[68:71], v2, s[16:19], s6 offen offset:1024 sc1
  v_mfma_f32_16x16x32_bf16 v[152:155], a[104:107], a[76:79], 0
  buffer_store_dwordx4 v[72:75], v2, s[16:19], s6 offen offset:2048 sc1
  v_mfma_f32_16x16x32_bf16 v[108:111], a[108:111], a[64:67], 0
  buffer_store_dwordx4 v[76:79], v2, s[16:19], s6 offen offset:3072 sc1
  v_mfma_f32_16x16x32_bf16 v[124:127], a[108:111], a[68:71], 0
  buffer_store_dwordx4 v[80:83], v2, s[16:19], s7 offen offset:0 sc1
  v_mfma_f32_16x16x32_bf16 v[140:143], a[108:111], a[72:75], 0
  buffer_store_dwordx4 v[84:87], v2, s[16:19], s7 offen offset:1024 sc1
  v_mfma_f32_16x16x32_bf16 v[156:159], a[108:111], a[76:79], 0
  buffer_store_dwordx4 v[88:91], v2, s[16:19], s7 offen offset:2048 sc1
  buffer_store_dwordx4 v[92:95], v2, s[16:19], s7 offen offset:3072 sc1
  s_branch Lp7
Lp6_late:
  v_mfma_f32_16x16x32_bf16 v[32:35], a[112:115], a[80:83], v[32:35]
  s_add_u32 m0, s64, 16384
  ds_read_b128 a[64:67], v16 offset:0
  ds_read_b64_tr_b16 a[96:97], v18 offset:16384
  v_mfma_f32_16x16x32_bf16 v[48:51], a[112:115], a[84:87], v[48:51]
  buffer_load_dwordx4 v10, s[12:15], s71 offen offset:0 lds
  ds_read_b64_tr_b16 a[98:99], v18 offset:18432
  v_mfma_f32_16x16x32_bf16 v[64:67], a[112:115], a[88:91], v[64:67]
  ds_read_b128 a[68:71], v16 offset:1024
  ds_read_b128 a[72:75], v17 offset:0
  v_mfma_f32_16x16x32_bf16 v[80:83], a[112:115], a[92:95], v[80:83]
  ds_read_b128 a[76:79], v17 offset:1024
  ds_read_b64_tr_b16 a[100:101], v19 offset:16384
  v_mfma_f32_16x16x32_bf16 v[36:39], a[116:119], a[80:83], v[36:39]
  ds_read_b64_tr_b16 a[102:103], v19 offset:18432
  ds_read_b64_tr_b16 a[104:105], v20 offset:16384
  v_mfma_f32_16x16x32_bf16 v[52:55], a[116:119], a[84:87], v[52:55]
  ds_read_b64_tr_b16 a[106:107], v20 offset:18432
  ds_read_b64_tr_b16 a[108:109], v21 offset:16384
  v_mfma_f32_16x16x32_bf16 v[68:71], a[116:119], a[88:91], v[68:71]
  ds_read_b64_tr_b16 a[110:111], v21 offset:18432
  v_mfma_f32_16x16x32_bf16 v[84:87], a[116:119], a[92:95], v[84:87]
  buffer_load_dwordx4 v11, s[12:15], s71 offen offset:1024 lds
  v_mfma_f32_16x16x32_bf16 v[40:43], a[120:123], a[80:83], v[40:43]
  v_mfma_f32_16x16x32_bf16 v[56:59], a[120:123], a[84:87], v[56:59]
  v_mfma_f32_16x16x32_bf16 v[72:75], a[120:123], a[88:91], v[72:75]
  v_mfma_f32_16x16x32_bf16 v[88:91], a[120:123], a[92:95], v[88:91]
  v_mfma_f32_16x16x32_bf16 v[44:47], a[124:127], a[80:83], v[44:47]
  v_mfma_f32_16x16x32_bf16 v[60:63], a[124:127], a[84:87], v[60:63]
  v_mfma_f32_16x16x32_bf16 v[76:79], a[124:127], a[88:91], v[76:79]
  v_mfma_f32_16x16x32_bf16 v[92:95], a[124:127], a[92:95], v[92:95]
  s_waitcnt lgkmcnt(0)
  v_mfma_f32_16x16x32_bf16 v[32:35], a[96:99], a[64:67], v[32:35]
  buffer_load_dwordx4 v12, s[12:15], s71 offen offset:2048 lds
  ds_read_b128 a[80:83], v16 offset:8192
  v_mfma_f32_16x16x32_bf16 v[48:51], a[96:99], a[68:71], v[48:51]
  ds_read_b64_tr_b16 a[112:113], v18 offset:20480
  ds_read_b64_tr_b16 a[114:115], v18 offset:22528
  v_mfma_f32_16x16x32_bf16 v[64:67], a[96:99], a[72:75], v[64:67]
  ds_read_b128 a[84:87], v16 offset:9216
  ds_read_b128 a[88:91], v17 offset:8192
  v_mfma_f32_16x16x32_bf16 v[80:83], a[96:99], a[76:79], v[80:83]
  ds_read_b128 a[92:95], v17 offset:9216
  ds_read_b64_tr_b16 a[116:117], v19 offset:20480
  v_mfma_f32_16x16x32_bf16 v[36:39], a[100:103], a[64:67], v[36:39]
  buffer_load_dwordx4 v13, s[12:15], s71 offen offset:3072 lds
  ds_read_b64_tr_b16 a[118:119], v19 offset:22528
  v_mfma_f32_16x16x32_bf16 v[52:55], a[100:103], a[68:71], v[52:55]
  s_bfe_u32 s72, 0x302011a, s31
  s_add_u32 s30, s30, s72
  s_add_u32 s31, s31, 8
  v_mfma_f32_16x16x32_bf16 v[68:71], a[100:103], a[72:75], v[68:71]
  s_and_b32 s31, s31, 0x8001f
  s_cmp_ge_u32 s30, 28
  s_cselect_b32 s72, 28, 0
  v_mfma_f32_16x16x32_bf16 v[84:87], a[100:103], a[76:79], v[84:87]
  s_sub_u32 s30, s30, s72
  s_lshl_b32 s72, s30, 17
  s_add_u32 s71, s93, s72
  v_mfma_f32_16x16x32_bf16 v[40:43], a[104:107], a[64:67], v[40:43]
  s_add_u32 s64, s64, s66
  ds_read_b64_tr_b16 a[120:121], v20 offset:20480
  ds_read_b64_tr_b16 a[122:123], v20 offset:22528
  v_mfma_f32_16x16x32_bf16 v[56:59], a[104:107], a[68:71], v[56:59]
  s_add_u32 s65, s65, 1
  ds_read_b64_tr_b16 a[124:125], v21 offset:20480
  ds_read_b64_tr_b16 a[126:127], v21 offset:22528
  v_mfma_f32_16x16x32_bf16 v[72:75], a[104:107], a[72:75], v[72:75]
  s_cmp_eq_u32 s65, 4
  s_cselect_b32 s65, 0, s65
  s_cselect_b32 s66, s67, s68
  v_mfma_f32_16x16x32_bf16 v[88:91], a[104:107], a[76:79], v[88:91]
  v_add_u32 v16, s66, v16
  v_add_u32 v17, s66, v17
  v_mfma_f32_16x16x32_bf16 v[44:47], a[108:111], a[64:67], v[44:47]
  v_add_u32 v18, s66, v18
  v_add_u32 v19, s66, v19
  v_mfma_f32_16x16x32_bf16 v[60:63], a[108:111], a[68:71], v[60:63]
  v_add_u32 v20, s66, v20
  v_add_u32 v21, s66, v21
  v_mfma_f32_16x16x32_bf16 v[76:79], a[108:111], a[72:75], v[76:79]
  v_mfma_f32_16x16x32_bf16 v[92:95], a[108:111], a[76:79], v[92:95]
  s_waitcnt vmcnt(8) lgkmcnt(0)
  s_barrier
  v_mfma_f32_16x16x32_bf16 v[32:35], a[112:115], a[80:83], v[32:35]
  s_add_u32 m0, s64, 16384
  ds_read_b128 a[64:67], v16 offset:0
  ds_read_b64_tr_b16 a[96:97], v18 offset:16384
  v_mfma_f32_16x16x32_bf16 v[48:51], a[112:115], a[84:87], v[48:51]
  buffer_load_dwordx4 v10, s[12:15], s71 offen offset:0 lds
  ds_read_b64_tr_b16 a[98:99], v18 offset:18432
  v_mfma_f32_16x16x32_bf16 v[64:67], a[112:115], a[88:91], v[64:67]
  ds_read_b128 a[68:71], v16 offset:1024
  ds_read_b128 a[72:75], v17 offset:0
  v_mfma_f32_16x16x32_bf16 v[80:83], a[112:115], a[92:95], v[80:83]
  ds_read_b128 a[76:79], v17 offset:1024
  ds_read_b64_tr_b16 a[100:101], v19 offset:16384
  v_mfma_f32_16x16x32_bf16 v[36:39], a[116:119], a[80:83], v[36:39]
  ds_read_b64_tr_b16 a[102:103], v19 offset:18432
  ds_read_b64_tr_b16 a[104:105], v20 offset:16384
  v_mfma_f32_16x16x32_bf16 v[52:55], a[116:119], a[84:87], v[52:55]
  buffer_load_dwordx4 v11, s[12:15], s71 offen offset:1024 lds
  ds_read_b64_tr_b16 a[106:107], v20 offset:18432
  v_mfma_f32_16x16x32_bf16 v[68:71], a[116:119], a[88:91], v[68:71]
  ds_read_b64_tr_b16 a[108:109], v21 offset:16384
  ds_read_b64_tr_b16 a[110:111], v21 offset:18432
  v_mfma_f32_16x16x32_bf16 v[84:87], a[116:119], a[92:95], v[84:87]
  v_mfma_f32_16x16x32_bf16 v[40:43], a[120:123], a[80:83], v[40:43]
  v_mfma_f32_16x16x32_bf16 v[56:59], a[120:123], a[84:87], v[56:59]
  v_mfma_f32_16x16x32_bf16 v[72:75], a[120:123], a[88:91], v[72:75]
  buffer_load_dwordx4 v12, s[12:15], s71 offen offset:2048 lds
  v_mfma_f32_16x16x32_bf16 v[88:91], a[120:123], a[92:95], v[88:91]
  v_mfma_f32_16x16x32_bf16 v[44:47], a[124:127], a[80:83], v[44:47]
  v_mfma_f32_16x16x32_bf16 v[60:63], a[124:127], a[84:87], v[60:63]
  v_mfma_f32_16x16x32_bf16 v[76:79], a[124:127], a[88:91], v[76:79]
  v_mfma_f32_16x16x32_bf16 v[92:95], a[124:127], a[92:95], v[92:95]
  s_waitcnt lgkmcnt(0)
  v_mfma_f32_16x16x32_bf16 v[32:35], a[96:99], a[64:67], v[32:35]
  buffer_load_dwordx4 v13, s[12:15], s71 offen offset:3072 lds
  ds_read_b128 a[80:83], v16 offset:8192
  v_mfma_f32_16x16x32_bf16 v[48:51], a[96:99], a[68:71], v[48:51]
  s_bfe_u32 s72, 0x302011a, s31
  s_add_u32 s30, s30, s72
  s_add_u32 s31, s31, 8
  v_mfma_f32_16x16x32_bf16 v[64:67], a[96:99], a[72:75], v[64:67]
  s_and_b32 s31, s31, 0x8001f
  s_cmp_ge_u32 s30, 28
  s_cselect_b32 s72, 28, 0
  v_mfma_f32_16x16x32_bf16 v[80:83], a[96:99], a[76:79], v[80:83]
  s_sub_u32 s30, s30, s72
  s_lshl_b32 s72, s30, 17
  s_add_u32 s71, s93, s72
  v_mfma_f32_16x16x32_bf16 v[36:39], a[100:103], a[64:67], v[36:39]
  buffer_load_dwordx2 v[6:7], v14, s[96:99], s91 offen sc1
  ds_read_b64_tr_b16 a[112:113], v18 offset:20480
  v_mfma_f32_16x16x32_bf16 v[52:55], a[100:103], a[68:71], v[52:55]
  s_add_u32 s64, s64, s66
  ds_read_b64_tr_b16 a[114:115], v18 offset:22528
  ds_read_b128 a[84:87], v16 offset:9216
  v_mfma_f32_16x16x32_bf16 v[68:71], a[100:103], a[72:75], v[68:71]
  s_add_u32 s65, s65, 1
  ds_read_b128 a[88:91], v17 offset:8192
  ds_read_b128 a[92:95], v17 offset:9216
  v_mfma_f32_16x16x32_bf16 v[84:87], a[100:103], a[76:79], v[84:87]
  s_cmp_eq_u32 s65, 4
  s_cselect_b32 s65, 0, s65
  s_cselect_b32 s66, s67, s68
  ds_read_b64_tr_b16 a[116:117], v19 offset:20480
  ds_read_b64_tr_b16 a[118:119], v19 offset:22528
  v_mfma_f32_16x16x32_bf16 v[40:43], a[104:107], a[64:67], v[40:43]
  ds_read_b64_tr_b16 a[120:121], v20 offset:20480
  ds_read_b64_tr_b16 a[122:123], v20 offset:22528
  v_mfma_f32_16x16x32_bf16 v[56:59], a[104:107], a[68:71], v[56:59]
  ds_read_b64_tr_b16 a[124:125], v21 offset:20480
  ds_read_b64_tr_b16 a[126:127], v21 offset:22528
  v_mfma_f32_16x16x32_bf16 v[72:75], a[104:107], a[72:75], v[72:75]
  v_add_u32 v16, s66, v16
  v_add_u32 v17, s66, v17
  v_mfma_f32_16x16x32_bf16 v[88:91], a[104:107], a[76:79], v[88:91]
  v_add_u32 v18, s66, v18
  v_add_u32 v19, s66, v19
  v_mfma_f32_16x16x32_bf16 v[44:47], a[108:111], a[64:67], v[44:47]
  v_add_u32 v20, s66, v20
  v_add_u32 v21, s66, v21
  v_mfma_f32_16x16x32_bf16 v[60:63], a[108:111], a[68:71], v[60:63]
  v_mfma_f32_16x16x32_bf16 v[76:79], a[108:111], a[72:75], v[76:79]
  v_mfma_f32_16x16x32_bf16 v[92:95], a[108:111], a[76:79], v[92:95]
  s_waitcnt vmcnt(0) lgkmcnt(0)
  s_barrier
  s_mov_b32 s5, 0x40000
Lpoll_9:
  v_cmp_ne_u64 vcc, s[94:95], v[6:7]
  s_nop 0
  s_cbranch_vccz Lpolld_10
  s_sleep 4
  buffer_load_dwordx2 v[6:7], v14, s[96:99], s91 offen sc1
  s_sub_u32 s5, s5, 1
  s_waitcnt vmcnt(0)
  s_cbranch_scc0 Lpoll_9
Lpolld_10:
  s_add_u32 s8, s86, 67108864
  s_addc_u32 s9, s87, 0
  s_mov_b32 s10, 16777216
  s_mov_b32 s11, 0x00020000
  s_lshl_b32 s92, s73, 1
  s_add_u32 s92, s92, s77
  s_lshl_b32 s92, s92, 19
  s_add_u32 s92, s92, s79
  s_add_u32 s72, s73, s76
  s_and_b32 s1, s72, 3
  s_lshl_b32 s1, s1, 3
  s_or_b32 s1, s1, 0x80000
  s_bfe_u32 s0, 0x1b1b02, s1
  s_add_u32 s0, s0, 0
  s_cmp_ge_u32 s0, 28
  s_cselect_b32 s72, 28, 0
  s_sub_u32 s0, s0, s72
  s_lshl_b32 s72, s0, 14
  s_add_u32 s70, s92, s72
  v_mfma_f32_16x16x32_bf16 v[32:35], a[112:115], a[80:83], v[32:35]
  s_add_u32 m0, s79, 131072
  v_mfma_f32_16x16x32_bf16 v[48:51], a[112:115], a[84:87], v[48:51]
  buffer_load_dwordx4 v2, s[8:11], s70 offen offset:0 sc1 lds
  v_mfma_f32_16x16x32_bf16 v[64:67], a[112:115], a[88:91], v[64:67]
  buffer_load_dwordx4 v2, s[8:11], s70 offen offset:1024 sc1 lds
  v_mfma_f32_16x16x32_bf16 v[80:83], a[112:115], a[92:95], v[80:83]
  buffer_load_dwordx4 v2, s[8:11], s70 offen offset:2048 sc1 lds
  v_mfma_f32_16x16x32_bf16 v[36:39], a[116:119], a[80:83], v[36:39]
  buffer_load_dwordx4 v2, s[8:11], s70 offen offset:3072 sc1 lds
  v_mfma_f32_16x16x32_bf16 v[52:55], a[116:119], a[84:87], v[52:55]
  s_bfe_u32 s72, 0x302011a, s1
  s_add_u32 s0, s0, s72
  s_add_u32 s1, s1, 8
  v_mfma_f32_16x16x32_bf16 v[68:71], a[116:119], a[88:91], v[68:71]
  s_and_b32 s1, s1, 0x8001f
  s_cmp_ge_u32 s0, 28
  s_cselect_b32 s72, 28, 0
  v_mfma_f32_16x16x32_bf16 v[84:87], a[116:119], a[92:95], v[84:87]
  s_sub_u32 s0, s0, s72
  s_lshl_b32 s72, s0, 14
  s_add_u32 s70, s92, s72
  v_mfma_f32_16x16x32_bf16 v[40:43], a[120:123], a[80:83], v[40:43]
  s_add_u32 m0, s79, 32768
  v_mfma_f32_16x16x32_bf16 v[56:59], a[120:123], a[84:87], v[56:59]
  buffer_load_dwordx4 v2, s[8:11], s70 offen offset:0 sc1 lds
  v_mfma_f32_16x16x32_bf16 v[72:75], a[120:123], a[88:91], v[72:75]
  buffer_load_dwordx4 v2, s[8:11], s70 offen offset:1024 sc1 lds
  v_mfma_f32_16x16x32_bf16 v[88:91], a[120:123], a[92:95], v[88:91]
  buffer_load_dwordx4 v2, s[8:11], s70 offen offset:2048 sc1 lds
  v_mfma_f32_16x16x32_bf16 v[44:47], a[124:127], a[80:83], v[44:47]
  buffer_load_dwordx4 v2, s[8:11], s70 offen offset:3072 sc1 lds
  v_mfma_f32_16x16x32_bf16 v[60:63], a[124:127], a[84:87], v[60:63]
  s_bfe_u32 s72, 0x302011a, s1
  s_add_u32 s0, s0, s72
  s_add_u32 s1, s1, 8
  v_mfma_f32_16x16x32_bf16 v[76:79], a[124:127], a[88:91], v[76:79]
  s_and_b32 s1, s1, 0x8001f
  s_cmp_ge_u32 s0, 28
  s_cselect_b32 s72, 28, 0
  v_mfma_f32_16x16x32_bf16 v[92:95], a[124:127], a[92:95], v[92:95]
  s_sub_u32 s0, s0, s72
  s_lshl_b32 s72, s0, 14
  s_add_u32 s70, s92, s72
  s_add_u32 m0, s79, 65536
  s_nop 0
  buffer_load_dwordx4 v2, s[8:11], s70 offen offset:0 sc1 lds
  buffer_load_dwordx4 v2, s[8:11], s70 offen offset:1024 sc1 lds
  buffer_load_dwordx4 v2, s[8:11], s70 offen offset:2048 sc1 lds
  buffer_load_dwordx4 v2, s[8:11], s70 offen offset:3072 sc1 lds
  s_bfe_u32 s72, 0x302011a, s1
  s_add_u32 s0, s0, s72
  s_add_u32 s1, s1, 8
  s_and_b32 s1, s1, 0x8001f
  s_cmp_ge_u32 s0, 28
  s_cselect_b32 s72, 28, 0
  s_sub_u32 s0, s0, s72
  s_lshl_b32 s72, s0, 14
  s_add_u32 s70, s92, s72
  s_add_u32 m0, s79, 114688
  s_nop 0
  buffer_load_dwordx4 v10, s[12:15], s71 offen offset:0 lds
  buffer_load_dwordx4 v11, s[12:15], s71 offen offset:1024 lds
  buffer_load_dwordx4 v12, s[12:15], s71 offen offset:2048 lds
  buffer_load_dwordx4 v13, s[12:15], s71 offen offset:3072 lds
  s_bfe_u32 s72, 0x302011a, s31
  s_add_u32 s30, s30, s72
  s_add_u32 s31, s31, 8
  s_and_b32 s31, s31, 0x8001f
  s_cmp_ge_u32 s30, 28
  s_cselect_b32 s72, 28, 0
  s_sub_u32 s30, s30, s72
  s_lshl_b32 s72, s30, 17
  s_add_u32 s71, s93, s72
  s_add_u32 m0, s79, 98304
  s_nop 0
  buffer_load_dwordx4 v2, s[8:11], s70 offen offset:0 sc1 lds
  buffer_load_dwordx4 v2, s[8:11], s70 offen offset:1024 sc1 lds
  buffer_load_dwordx4 v2, s[8:11], s70 offen offset:2048 sc1 lds
  buffer_load_dwordx4 v2, s[8:11], s70 offen offset:3072 sc1 lds
  s_bfe_u32 s72, 0x302011a, s1
  s_add_u32 s0, s0, s72
  s_add_u32 s1, s1, 8
  s_and_b32 s1, s1, 0x8001f
  s_cmp_ge_u32 s0, 28
  s_cselect_b32 s72, 28, 0
  s_sub_u32 s0, s0, s72
  s_lshl_b32 s72, s0, 14
  s_add_u32 s70, s92, s72
  s_lshl_b32 s6, s78, 1
  s_add_u32 s6, s6, s77
  s_xor_b32 s6, s6, 1
  s_lshl_b32 s6, s6, 2
  s_add_u32 s6, s6, s3
  s_lshl_b32 s6, s6, 14
  s_add_u32 s6, s6, 8192
  s_add_u32 s7, s6, 4096
  buffer_store_dwordx4 v[64:67], v2, s[16:19], s6 offen offset:0 sc1
  buffer_store_dwordx4 v[68:71], v2, s[16:19], s6 offen offset:1024 sc1
  buffer_store_dwordx4 v[72:75], v2, s[16:19], s6 offen offset:2048 sc1
  buffer_store_dwordx4 v[76:79], v2, s[16:19], s6 offen offset:3072 sc1
  buffer_store_dwordx4 v[80:83], v2, s[16:19], s7 offen offset:0 sc1
  buffer_store_dwordx4 v[84:87], v2, s[16:19], s7 offen offset:1024 sc1
  buffer_store_dwordx4 v[88:91], v2, s[16:19], s7 offen offset:2048 sc1
  buffer_store_dwordx4 v[92:95], v2, s[16:19], s7 offen offset:3072 sc1
  s_waitcnt vmcnt(24)
  s_barrier
  ds_read_b128 a[64:67], v16 offset:0
  ds_read_b64_tr_b16 a[96:97], v18 offset:16384
  ds_read_b64_tr_b16 a[98:99], v18 offset:18432
  ds_read_b128 a[68:71], v16 offset:1024
  ds_read_b128 a[72:75], v17 offset:0
  ds_read_b128 a[76:79], v17 offset:1024
  ds_read_b64_tr_b16 a[100:101], v19 offset:16384
  ds_read_b64_tr_b16 a[102:103], v19 offset:18432
  ds_read_b64_tr_b16 a[104:105], v20 offset:16384
  ds_read_b64_tr_b16 a[106:107], v20 offset:18432
  ds_read_b64_tr_b16 a[108:109], v21 offset:16384
  ds_read_b64_tr_b16 a[110:111], v21 offset:18432
  s_waitcnt lgkmcnt(0)
  v_mfma_f32_16x16x32_bf16 v[96:99], a[96:99], a[64:67], 0
  s_add_u32 s64, s64, s66
  ds_read_b128 a[80:83], v16 offset:8192
  ds_read_b64_tr_b16 a[112:113], v18 offset:20480
  v_mfma_f32_16x16x32_bf16 v[112:115], a[96:99], a[68:71], 0
  s_add_u32 s65, s65, 1
  ds_read_b64_tr_b16 a[114:115], v18 offset:22528
  ds_read_b128 a[84:87], v16 offset:9216
  v_mfma_f32_16x16x32_bf16 v[128:131], a[96:99], a[72:75], 0
  s_cmp_eq_u32 s65, 4
  s_cselect_b32 s65, 0, s65
  s_cselect_b32 s66, s67, s68
  ds_read_b128 a[88:91], v17 offset:8192
  ds_read_b128 a[92:95], v17 offset:9216
  v_mfma_f32_16x16x32_bf16 v[144:147], a[96:99], a[76:79], 0
  ds_read_b64_tr_b16 a[116:117], v19 offset:20480
  v_mfma_f32_16x16x32_bf16 v[100:103], a[100:103], a[64:67], 0
  ds_read_b64_tr_b16 a[118:119], v19 offset:22528
  ds_read_b64_tr_b16 a[120:121], v20 offset:20480
  v_mfma_f32_16x16x32_bf16 v[116:119], a[100:103], a[68:71], 0
  ds_read_b64_tr_b16 a[122:123], v20 offset:22528
  ds_read_b64_tr_b16 a[124:125], v21 offset:20480
  v_mfma_f32_16x16x32_bf16 v[132:135], a[100:103], a[72:75], 0
  ds_read_b64_tr_b16 a[126:127], v21 offset:22528
  v_mfma_f32_16x16x32_bf16 v[148:151], a[100:103], a[76:79], 0
  v_add_u32 v16, s66, v16
  v_add_u32 v17, s66, v17
  v_mfma_f32_16x16x32_bf16 v[104:107], a[104:107], a[64:67], 0
  v_add_u32 v18, s66, v18
  v_add_u32 v19, s66, v19
  v_mfma_f32_16x16x32_bf16 v[120:123], a[104:107], a[68:71], 0
  v_add_u32 v20, s66, v20
  v_add_u32 v21, s66, v21
  v_mfma_f32_16x16x32_bf16 v[136:139], a[104:107], a[72:75], 0
  v_mfma_f32_16x16x32_bf16 v[152:155], a[104:107], a[76:79], 0
  v_mfma_f32_16x16x32_bf16 v[108:111], a[108:111], a[64:67], 0
  v_mfma_f32_16x16x32_bf16 v[124:127], a[108:111], a[68:71], 0
  v_mfma_f32_16x16x32_bf16 v[140:143], a[108:111], a[72:75], 0
  v_mfma_f32_16x16x32_bf16 v[156:159], a[108:111], a[76:79], 0
Lp7:
  s_mov_b32 s69, 24
  s_waitcnt vmcnt(16) lgkmcnt(0)
  s_barrier
  .p2align 6
Lp7_loop:
  v_mfma_f32_16x16x32_bf16 v[96:99], a[112:115], a[80:83], v[96:99]
  s_add_u32 m0, s64, 16384
  ds_read_b128 a[64:67], v16 offset:0
  ds_read_b64_tr_b16 a[96:97], v18 offset:16384
  v_mfma_f32_16x16x32_bf16 v[112:115], a[112:115], a[84:87], v[112:115]
  buffer_load_dwordx4 v10, s[12:15], s71 offen offset:0 lds
  ds_read_b64_tr_b16 a[98:99], v18 offset:18432
  v_mfma_f32_16x16x32_bf16 v[128:131], a[112:115], a[88:91], v[128:131]
  ds_read_b128 a[68:71], v16 offset:1024
  ds_read_b128 a[72:75], v17 offset:0
  v_mfma_f32_16x16x32_bf16 v[144:147], a[112:115], a[92:95], v[144:147]
  buffer_load_dwordx4 v11, s[12:15], s71 offen offset:1024 lds
  ds_read_b128 a[76:79], v17 offset:1024
  v_mfma_f32_16x16x32_bf16 v[100:103], a[116:119], a[80:83], v[100:103]
  ds_read_b64_tr_b16 a[100:101], v19 offset:16384
  ds_read_b64_tr_b16 a[102:103], v19 offset:18432
  v_mfma_f32_16x16x32_bf16 v[116:119], a[116:119], a[84:87], v[116:119]
  ds_read_b64_tr_b16 a[104:105], v20 offset:16384
  ds_read_b64_tr_b16 a[106:107], v20 offset:18432
  v_mfma_f32_16x16x32_bf16 v[132:135], a[116:119], a[88:91], v[132:135]
  ds_read_b64_tr_b16 a[108:109], v21 offset:16384
  ds_read_b64_tr_b16 a[110:111], v21 offset:18432
  v_mfma_f32_16x16x32_bf16 v[148:151], a[116:119], a[92:95], v[148:151]
  buffer_load_dwordx4 v12, s[12:15], s71 offen offset:2048 lds
  v_mfma_f32_16x16x32_bf16 v[104:107], a[120:123], a[80:83], v[104:107]
  v_mfma_f32_16x16x32_bf16 v[120:123], a[120:123], a[84:87], v[120:123]
  v_mfma_f32_16x16x32_bf16 v[136:139], a[120:123], a[88:91], v[136:139]
  v_mfma_f32_16x16x32_bf16 v[152:155], a[120:123], a[92:95], v[152:155]
  buffer_load_dwordx4 v13, s[12:15], s71 offen offset:3072 lds
  v_mfma_f32_16x16x32_bf16 v[108:111], a[124:127], a[80:83], v[108:111]
  s_bfe_u32 s72, 0x302011a, s31
  s_add_u32 s30, s30, s72
  s_add_u32 s31, s31, 8
  v_mfma_f32_16x16x32_bf16 v[124:127], a[124:127], a[84:87], v[124:127]
  s_and_b32 s31, s31, 0x8001f
  s_cmp_ge_u32 s30, 28
  s_cselect_b32 s72, 28, 0
  v_mfma_f32_16x16x32_bf16 v[140:143], a[124:127], a[88:91], v[140:143]
  s_sub_u32 s30, s30, s72
  s_lshl_b32 s72, s30, 17
  s_add_u32 s71, s93, s72
  v_mfma_f32_16x16x32_bf16 v[156:159], a[124:127], a[92:95], v[156:159]
  s_waitcnt lgkmcnt(0)
  v_mfma_f32_16x16x32_bf16 v[96:99], a[96:99], a[64:67], v[96:99]
  s_mov_b32 m0, s64
  ds_read_b128 a[80:83], v16 offset:8192
  ds_read_b64_tr_b16 a[112:113], v18 offset:20480
  v_mfma_f32_16x16x32_bf16 v[112:115], a[96:99], a[68:71], v[112:115]
  buffer_load_dwordx4 v2, s[8:11], s70 offen offset:0 sc1 lds
  ds_read_b64_tr_b16 a[114:115], v18 offset:22528
  v_mfma_f32_16x16x32_bf16 v[128:131], a[96:99], a[72:75], v[128:131]
  buffer_load_dwordx4 v2, s[8:11], s70 offen offset:1024 sc1 lds
  ds_read_b128 a[84:87], v16 offset:9216
  v_mfma_f32_16x16x32_bf16 v[144:147], a[96:99], a[76:79], v[144:147]
  ds_read_b128 a[88:91], v17 offset:8192
  ds_read_b128 a[92:95], v17 offset:9216
  v_mfma_f32_16x16x32_bf16 v[100:103], a[100:103], a[64:67], v[100:103]
  buffer_load_dwordx4 v2, s[8:11], s70 offen offset:2048 sc1 lds
  ds_read_b64_tr_b16 a[116:117], v19 offset:20480
  v_mfma_f32_16x16x32_bf16 v[116:119], a[100:103], a[68:71], v[116:119]
  ds_read_b64_tr_b16 a[118:119], v19 offset:22528
  ds_read_b64_tr_b16 a[120:121], v20 offset:20480
  v_mfma_f32_16x16x32_bf16 v[132:135], a[100:103], a[72:75], v[132:135]
  buffer_load_dwordx4 v2, s[8:11], s70 offen offset:3072 sc1 lds
  ds_read_b64_tr_b16 a[122:123], v20 offset:22528
  v_mfma_f32_16x16x32_bf16 v[148:151], a[100:103], a[76:79], v[148:151]
  s_bfe_u32 s72, 0x302011a, s1
  s_add_u32 s0, s0, s72
  s_add_u32 s1, s1, 8
  v_mfma_f32_16x16x32_bf16 v[104:107], a[104:107], a[64:67], v[104:107]
  s_and_b32 s1, s1, 0x8001f
  s_cmp_ge_u32 s0, 28
  s_cselect_b32 s72, 28, 0
  v_mfma_f32_16x16x32_bf16 v[120:123], a[104:107], a[68:71], v[120:123]
  s_sub_u32 s0, s0, s72
  s_lshl_b32 s72, s0, 14
  s_add_u32 s70, s92, s72
  v_mfma_f32_16x16x32_bf16 v[136:139], a[104:107], a[72:75], v[136:139]
  s_add_u32 s64, s64, s66
  ds_read_b64_tr_b16 a[124:125], v21 offset:20480
  ds_read_b64_tr_b16 a[126:127], v21 offset:22528
  v_mfma_f32_16x16x32_bf16 v[152:155], a[104:107], a[76:79], v[152:155]
  s_add_u32 s65, s65, 1
  s_cmp_eq_u32 s65, 4
  s_cselect_b32 s65, 0, s65
  s_cselect_b32 s66, s67, s68
  v_mfma_f32_16x16x32_bf16 v[108:111], a[108:111], a[64:67], v[108:111]
  v_add_u32 v16, s66, v16
  v_add_u32 v17, s66, v17
  v_mfma_f32_16x16x32_bf16 v[124:127], a[108:111], a[68:71], v[124:127]
  s_waitcnt vmcnt(16) lgkmcnt(0)
  s_barrier
  v_add_u32 v18, s66, v18
  v_add_u32 v19, s66, v19
  v_mfma_f32_16x16x32_bf16 v[140:143], a[108:111], a[72:75], v[140:143]
  s_sub_u32 s69, s69, 1
  v_add_u32 v20, s66, v20
  v_add_u32 v21, s66, v21
  v_mfma_f32_16x16x32_bf16 v[156:159], a[108:111], a[76:79], v[156:159]
  s_cmp_lg_u32 s69, 0
  s_cbranch_scc1 Lp7_loop
  s_mov_b32 s20, s82
  s_mov_b32 s21, s83
  s_mov_b32 s22, 8388608
  s_mov_b32 s23, 0x00020000
  v_bfe_u32 v25, v1, 4, 1
  v_lshrrev_b32 v26, 5, v1
  v_lshl_or_b32 v25, v25, 1, v26
  v_lshlrev_b32 v25, 4, v25
  v_and_b32 v24, 15, v1
  v_lshl_add_u32 v26, v24, 14, v25
  v_lshl_add_u32 v27, v24, 12, v25
  v_mfma_f32_16x16x32_bf16 v[96:99], a[112:115], a[80:83], v[96:99]
  s_lshl_b32 s6, s78, 1
  s_add_u32 s6, s6, s77
  s_lshl_b32 s6, s6, 2
  v_mfma_f32_16x16x32_bf16 v[112:115], a[112:115], a[84:87], v[112:115]
  s_add_u32 s6, s6, s3
  s_lshl_b32 s6, s6, 14
  s_add_u32 s6, s6, 8192
  v_mfma_f32_16x16x32_bf16 v[128:131], a[112:115], a[88:91], v[128:131]
  s_add_u32 s7, s6, 4096
  buffer_load_dwordx4 v[160:163], v2, s[16:19], s6 offen offset:0 sc1
  ds_read_b128 a[64:67], v16 offset:0
  v_mfma_f32_16x16x32_bf16 v[144:147], a[112:115], a[92:95], v[144:147]
  buffer_load_dwordx4 v[164:167], v2, s[16:19], s6 offen offset:1024 sc1
  ds_read_b64_tr_b16 a[96:97], v18 offset:16384
  v_mfma_f32_16x16x32_bf16 v[100:103], a[116:119], a[80:83], v[100:103]
  buffer_load_dwordx4 v[168:171], v2, s[16:19], s6 offen offset:2048 sc1
  ds_read_b64_tr_b16 a[98:99], v18 offset:18432
  v_mfma_f32_16x16x32_bf16 v[116:119], a[116:119], a[84:87], v[116:119]
  buffer_load_dwordx4 v[172:175], v2, s[16:19], s6 offen offset:3072 sc1
  ds_read_b128 a[68:71], v16 offset:1024
  v_mfma_f32_16x16x32_bf16 v[132:135], a[116:119], a[88:91], v[132:135]
  ds_read_b128 a[72:75], v17 offset:0
  ds_read_b128 a[76:79], v17 offset:1024
  v_mfma_f32_16x16x32_bf16 v[148:151], a[116:119], a[92:95], v[148:151]
  buffer_load_dwordx4 v[176:179], v2, s[16:19], s7 offen offset:0 sc1
  ds_read_b64_tr_b16 a[100:101], v19 offset:16384
  v_mfma_f32_16x16x32_bf16 v[104:107], a[120:123], a[80:83], v[104:107]
  ds_read_b64_tr_b16 a[102:103], v19 offset:18432
  ds_read_b64_tr_b16 a[104:105], v20 offset:16384
  v_mfma_f32_16x16x32_bf16 v[120:123], a[120:123], a[84:87], v[120:123]
  buffer_load_dwordx4 v[180:183], v2, s[16:19], s7 offen offset:1024 sc1
  ds_read_b64_tr_b16 a[106:107], v20 offset:18432
  v_mfma_f32_16x16x32_bf16 v[136:139], a[120:123], a[88:91], v[136:139]
  ds_read_b64_tr_b16 a[108:109], v21 offset:16384
  ds_read_b64_tr_b16 a[110:111], v21 offset:18432
  v_mfma_f32_16x16x32_bf16 v[152:155], a[120:123], a[92:95], v[152:155]
  buffer_load_dwordx4 v[184:187], v2, s[16:19], s7 offen offset:2048 sc1
  v_mfma_f32_16x16x32_bf16 v[108:111], a[124:127], a[80:83], v[108:111]
  v_mfma_f32_16x16x32_bf16 v[124:127], a[124:127], a[84:87], v[124:127]
  buffer_load_dwordx4 v[188:191], v2, s[16:19], s7 offen offset:3072 sc1
  v_mfma_f32_16x16x32_bf16 v[140:143], a[124:127], a[88:91], v[140:143]
  s_lshl_b32 s32, s73, 19
  s_lshl_b32 s72, s76, 8
  s_add_u32 s32, s32, s72
  v_mfma_f32_16x16x32_bf16 v[156:159], a[124:127], a[92:95], v[156:159]
  s_and_b32 s72, s3, 1
  s_lshl_b32 s72, s72, 7
  s_add_u32 s32, s32, s72
  s_lshr_b32 s72, s3, 1
  s_lshl_b32 s72, s72, 1
  s_add_u32 s72, s72, s77
  s_lshl_b32 s72, s72, 17
  s_add_u32 s32, s32, s72
  s_add_u32 s32, s32, 2048
  s_add_u32 s33, s32, 65536
  s_lshl_b32 s34, s73, 19
  s_lshl_b32 s72, s76, 8
  s_add_u32 s34, s34, s72
  s_and_b32 s72, s3, 1
  s_lshl_b32 s72, s72, 7
  s_add_u32 s34, s34, s72
  s_lshr_b32 s72, s3, 1
  s_lshl_b32 s72, s72, 1
  s_add_u32 s72, s72, s77
  s_lshl_b32 s72, s72, 12
  s_add_u32 s34, s34, s72
  s_add_u32 s35, s34, 262144
  s_add_u32 s70, s92, 458752
  s_add_u32 s71, s93, 3670016
  s_waitcnt lgkmcnt(0)
  v_mfma_f32_16x16x32_bf16 v[96:99], a[96:99], a[64:67], v[96:99]
  s_add_u32 m0, s64, 16384
  ds_read_b128 a[80:83], v16 offset:8192
  ds_read_b64_tr_b16 a[112:113], v18 offset:20480
  v_mfma_f32_16x16x32_bf16 v[112:115], a[96:99], a[68:71], v[112:115]
  buffer_load_dwordx4 v10, s[12:15], s71 offen offset:0 lds
  ds_read_b64_tr_b16 a[114:115], v18 offset:22528
  v_mfma_f32_16x16x32_bf16 v[128:131], a[96:99], a[72:75], v[128:131]
  buffer_load_dwordx4 v11, s[12:15], s71 offen offset:1024 lds
  ds_read_b128 a[84:87], v16 offset:9216
  v_mfma_f32_16x16x32_bf16 v[144:147], a[96:99], a[76:79], v[144:147]
  buffer_load_dwordx4 v12, s[12:15], s71 offen offset:2048 lds
  ds_read_b128 a[88:91], v17 offset:8192
  v_mfma_f32_16x16x32_bf16 v[100:103], a[100:103], a[64:67], v[100:103]
  buffer_load_dwordx4 v13, s[12:15], s71 offen offset:3072 lds
  ds_read_b128 a[92:95], v17 offset:9216
  v_mfma_f32_16x16x32_bf16 v[116:119], a[100:103], a[68:71], v[116:119]
  s_add_u32 s71, s71, 131072
  s_mov_b32 m0, s64
  ds_read_b64_tr_b16 a[116:117], v19 offset:20480
  v_mfma_f32_16x16x32_bf16 v[132:135], a[100:103], a[72:75], v[132:135]
  buffer_load_dwordx4 v2, s[8:11], s70 offen offset:0 sc1 lds
  ds_read_b64_tr_b16 a[118:119], v19 offset:22528
  v_mfma_f32_16x16x32_bf16 v[148:151], a[100:103], a[76:79], v[148:151]
  buffer_load_dwordx4 v2, s[8:11], s70 offen offset:1024 sc1 lds
  ds_read_b64_tr_b16 a[120:121], v20 offset:20480
  v_mfma_f32_16x16x32_bf16 v[104:107], a[104:107], a[64:67], v[104:107]
  buffer_load_dwordx4 v2, s[8:11], s70 offen offset:2048 sc1 lds
  ds_read_b64_tr_b16 a[122:123], v20 offset:22528
  v_mfma_f32_16x16x32_bf16 v[120:123], a[104:107], a[68:71], v[120:123]
  buffer_load_dwordx4 v2, s[8:11], s70 offen offset:3072 sc1 lds
  ds_read_b64_tr_b16 a[124:125], v21 offset:20480
  v_mfma_f32_16x16x32_bf16 v[136:139], a[104:107], a[72:75], v[136:139]
  s_add_u32 s70, s70, 16384
  ds_read_b64_tr_b16 a[126:127], v21 offset:22528
  v_mfma_f32_16x16x32_bf16 v[152:155], a[104:107], a[76:79], v[152:155]
  s_add_u32 s64, s64, s66
  s_add_u32 s65, s65, 1
  s_cmp_eq_u32 s65, 4
  s_cselect_b32 s65, 0, s65
  s_cselect_b32 s66, s67, s68
  v_mfma_f32_16x16x32_bf16 v[108:111], a[108:111], a[64:67], v[108:111]
  v_add_u32 v16, s66, v16
  v_add_u32 v17, s66, v17
  v_mfma_f32_16x16x32_bf16 v[124:127], a[108:111], a[68:71], v[124:127]
  v_add_u32 v18, s66, v18
  v_add_u32 v19, s66, v19
  v_mfma_f32_16x16x32_bf16 v[140:143], a[108:111], a[72:75], v[140:143]
  v_add_u32 v20, s66, v20
  v_add_u32 v21, s66, v21
  v_mfma_f32_16x16x32_bf16 v[156:159], a[108:111], a[76:79], v[156:159]
  s_waitcnt vmcnt(24) lgkmcnt(0)
  s_barrier
  v_mfma_f32_16x16x32_bf16 v[96:99], a[112:115], a[80:83], v[96:99]
  s_add_u32 m0, s64, 16384
  ds_read_b128 a[64:67], v16 offset:0
  ds_read_b64_tr_b16 a[96:97], v18 offset:16384
  v_mfma_f32_16x16x32_bf16 v[112:115], a[112:115], a[84:87], v[112:115]
  buffer_load_dwordx4 v10, s[12:15], s71 offen offset:0 lds
  ds_read_b64_tr_b16 a[98:99], v18 offset:18432
  v_mfma_f32_16x16x32_bf16 v[128:131], a[112:115], a[88:91], v[128:131]
  ds_read_b128 a[68:71], v16 offset:1024
  ds_read_b128 a[72:75], v17 offset:0
  v_mfma_f32_16x16x32_bf16 v[144:147], a[112:115], a[92:95], v[144:147]
  buffer_load_dwordx4 v11, s[12:15], s71 offen offset:1024 lds
  ds_read_b128 a[76:79], v17 offset:1024
  v_mfma_f32_16x16x32_bf16 v[100:103], a[116:119], a[80:83], v[100:103]
  ds_read_b64_tr_b16 a[100:101], v19 offset:16384
  ds_read_b64_tr_b16 a[102:103], v19 offset:18432
  v_mfma_f32_16x16x32_bf16 v[116:119], a[116:119], a[84:87], v[116:119]
  ds_read_b64_tr_b16 a[104:105], v20 offset:16384
  ds_read_b64_tr_b16 a[106:107], v20 offset:18432
  v_mfma_f32_16x16x32_bf16 v[132:135], a[116:119], a[88:91], v[132:135]
  ds_read_b64_tr_b16 a[108:109], v21 offset:16384
  ds_read_b64_tr_b16 a[110:111], v21 offset:18432
  v_mfma_f32_16x16x32_bf16 v[148:151], a[116:119], a[92:95], v[148:151]
  buffer_load_dwordx4 v12, s[12:15], s71 offen offset:2048 lds
  v_mfma_f32_16x16x32_bf16 v[104:107], a[120:123], a[80:83], v[104:107]
  v_mfma_f32_16x16x32_bf16 v[120:123], a[120:123], a[84:87], v[120:123]
  v_mfma_f32_16x16x32_bf16 v[136:139], a[120:123], a[88:91], v[136:139]
  v_mfma_f32_16x16x32_bf16 v[152:155], a[120:123], a[92:95], v[152:155]
  buffer_load_dwordx4 v13, s[12:15], s71 offen offset:3072 lds
  v_mfma_f32_16x16x32_bf16 v[108:111], a[124:127], a[80:83], v[108:111]
  s_add_u32 s71, s71, 131072
  v_mfma_f32_16x16x32_bf16 v[124:127], a[124:127], a[84:87], v[124:127]
  v_mfma_f32_16x16x32_bf16 v[140:143], a[124:127], a[88:91], v[140:143]
  v_mfma_f32_16x16x32_bf16 v[156:159], a[124:127], a[92:95], v[156:159]
  s_waitcnt lgkmcnt(0)
  v_mfma_f32_16x16x32_bf16 v[96:99], a[96:99], a[64:67], v[96:99]
  s_mov_b32 m0, s64
  ds_read_b128 a[80:83], v16 offset:8192
  ds_read_b64_tr_b16 a[112:113], v18 offset:20480
  v_mfma_f32_16x16x32_bf16 v[112:115], a[96:99], a[68:71], v[112:115]
  buffer_load_dwordx4 v2, s[8:11], s70 offen offset:0 sc1 lds
  ds_read_b64_tr_b16 a[114:115], v18 offset:22528
  v_mfma_f32_16x16x32_bf16 v[128:131], a[96:99], a[72:75], v[128:131]
  buffer_load_dwordx4 v2, s[8:11], s70 offen offset:1024 sc1 lds
  ds_read_b128 a[84:87], v16 offset:9216
  v_mfma_f32_16x16x32_bf16 v[144:147], a[96:99], a[76:79], v[144:147]
  ds_read_b128 a[88:91], v17 offset:8192
  ds_read_b128 a[92:95], v17 offset:9216
  v_mfma_f32_16x16x32_bf16 v[100:103], a[100:103], a[64:67], v[100:103]
  buffer_load_dwordx4 v2, s[8:11], s70 offen offset:2048 sc1 lds
  ds_read_b64_tr_b16 a[116:117], v19 offset:20480
  v_mfma_f32_16x16x32_bf16 v[116:119], a[100:103], a[68:71], v[116:119]
  ds_read_b64_tr_b16 a[118:119], v19 offset:22528
  ds_read_b64_tr_b16 a[120:121], v20 offset:20480
  v_mfma_f32_16x16x32_bf16 v[132:135], a[100:103], a[72:75], v[132:135]
  buffer_load_dwordx4 v2, s[8:11], s70 offen offset:3072 sc1 lds
  ds_read_b64_tr_b16 a[122:123], v20 offset:22528
  v_mfma_f32_16x16x32_bf16 v[148:151], a[100:103], a[76:79], v[148:151]
  s_add_u32 s70, s70, 16384
  ds_read_b64_tr_b16 a[124:125], v21 offset:20480
  ds_read_b64_tr_b16 a[126:127], v21 offset:22528
  v_mfma_f32_16x16x32_bf16 v[104:107], a[104:107], a[64:67], v[104:107]
  s_add_u32 s64, s64, s66
  s_add_u32 s65, s65, 1
  s_cmp_eq_u32 s65, 4
  s_cselect_b32 s65, 0, s65
  s_cselect_b32 s66, s67, s68
  v_mfma_f32_16x16x32_bf16 v[120:123], a[104:107], a[68:71], v[120:123]
  v_add_u32 v16, s66, v16
  v_add_u32 v17, s66, v17
  v_mfma_f32_16x16x32_bf16 v[136:139], a[104:107], a[72:75], v[136:139]
  v_add_u32 v18, s66, v18
  v_add_u32 v19, s66, v19
  v_mfma_f32_16x16x32_bf16 v[152:155], a[104:107], a[76:79], v[152:155]
  v_add_u32 v20, s66, v20
  v_add_u32 v21, s66, v21
  v_mfma_f32_16x16x32_bf16 v[108:111], a[108:111], a[64:67], v[108:111]
  v_mfma_f32_16x16x32_bf16 v[124:127], a[108:111], a[68:71], v[124:127]
  v_mfma_f32_16x16x32_bf16 v[140:143], a[108:111], a[72:75], v[140:143]
  v_mfma_f32_16x16x32_bf16 v[156:159], a[108:111], a[76:79], v[156:159]
  s_waitcnt vmcnt(16) lgkmcnt(0)
  s_barrier
  s_mov_b32 s72, 0x40000
Lrc_11:
  v_max3_u32 v4, v160, v161, v162
  v_max3_u32 v5, v168, v169, v170
  v_max3_u32 v6, v176, v177, v178
  v_max3_u32 v7, v184, v185, v186
  v_max3_u32 v4, v4, v163, v164
  v_max3_u32 v5, v5, v171, v172
  v_max3_u32 v6, v6, v179, v180
  v_max3_u32 v7, v7, v187, v188
  v_max3_u32 v4, v4, v165, v166
  v_max3_u32 v5, v5, v173, v174
  v_max3_u32 v6, v6, v181, v182
  v_max3_u32 v7, v7, v189, v190
  v_max_u32 v4, v4, v167
  v_max_u32 v5, v5, v175
  v_max_u32 v6, v6, v183
  v_max_u32 v7, v7, v191
  v_max3_u32 v4, v4, v5, v6
  v_max_u32 v4, v4, v7
  v_cmp_eq_u32 vcc, -1, v4
  s_nop 0
  s_cbranch_vccz Lpolld_12
  buffer_load_dwordx4 v[160:163], v2, s[16:19], s6 offen offset:0 sc1
  buffer_load_dwordx4 v[164:167], v2, s[16:19], s6 offen offset:1024 sc1
  buffer_load_dwordx4 v[168:171], v2, s[16:19], s6 offen offset:2048 sc1
  buffer_load_dwordx4 v[172:175], v2, s[16:19], s6 offen offset:3072 sc1
  buffer_load_dwordx4 v[176:179], v2, s[16:19], s7 offen offset:0 sc1
  buffer_load_dwordx4 v[180:183], v2, s[16:19], s7 offen offset:1024 sc1
  buffer_load_dwordx4 v[184:187], v2, s[16:19], s7 offen offset:2048 sc1
  buffer_load_dwordx4 v[188:191], v2, s[16:19], s7 offen offset:3072 sc1
  s_sub_u32 s72, s72, 1
  s_waitcnt vmcnt(0)
  s_cbranch_scc0 Lrc_11
Lpolld_12:
  v_mfma_f32_16x16x32_bf16 v[96:99], a[112:115], a[80:83], v[96:99]
  s_and_b32 s88, s3, 1
  s_lshl_b32 s88, s88, 12
  s_lshr_b32 s72, s3, 1
  v_mfma_f32_16x16x32_bf16 v[112:115], a[112:115], a[84:87], v[112:115]
  s_lshl_b32 s72, s72, 13
  s_add_u32 s88, s88, s72
  s_lshl_b32 s72, s77, 11
  v_mfma_f32_16x16x32_bf16 v[128:131], a[112:115], a[88:91], v[128:131]
  s_add_u32 s88, s88, s72
  s_sub_u32 s88, s88, s79
  s_add_u32 s70, s92, s88
  v_mfma_f32_16x16x32_bf16 v[144:147], a[112:115], a[92:95], v[144:147]
  s_add_u32 s70, s70, 491520
  s_add_u32 s71, s93, 3932160
  s_add_u32 m0, s64, 16384
  v_mfma_f32_16x16x32_bf16 v[100:103], a[116:119], a[80:83], v[100:103]
  buffer_load_dwordx4 v10, s[12:15], s71 offen offset:0 lds
  ds_read_b128 a[64:67], v16 offset:0
  v_mfma_f32_16x16x32_bf16 v[116:119], a[116:119], a[84:87], v[116:119]
  buffer_load_dwordx4 v11, s[12:15], s71 offen offset:1024 lds
  ds_read_b64_tr_b16 a[96:97], v18 offset:16384
  v_mfma_f32_16x16x32_bf16 v[132:135], a[116:119], a[88:91], v[132:135]
  ds_read_b64_tr_b16 a[98:99], v18 offset:18432
  ds_read_b128 a[68:71], v16 offset:1024
  v_mfma_f32_16x16x32_bf16 v[148:151], a[116:119], a[92:95], v[148:151]
  ds_read_b128 a[72:75], v17 offset:0
  ds_read_b128 a[76:79], v17 offset:1024
  v_mfma_f32_16x16x32_bf16 v[104:107], a[120:123], a[80:83], v[104:107]
  ds_read_b64_tr_b16 a[100:101], v19 offset:16384
  ds_read_b64_tr_b16 a[102:103], v19 offset:18432
  v_mfma_f32_16x16x32_bf16 v[120:123], a[120:123], a[84:87], v[120:123]
  ds_read_b64_tr_b16 a[104:105], v20 offset:16384
  ds_read_b64_tr_b16 a[106:107], v20 offset:18432
  v_mfma_f32_16x16x32_bf16 v[136:139], a[120:123], a[88:91], v[136:139]
  buffer_load_dwordx4 v12, s[12:15], s71 offen offset:2048 lds
  ds_read_b64_tr_b16 a[108:109], v21 offset:16384
  v_mfma_f32_16x16x32_bf16 v[152:155], a[120:123], a[92:95], v[152:155]
  ds_read_b64_tr_b16 a[110:111], v21 offset:18432
  v_pk_add_f32 v[160:161], v[160:161], v[32:33]
  v_mfma_f32_16x16x32_bf16 v[108:111], a[124:127], a[80:83], v[108:111]
  v_pk_add_f32 v[162:163], v[162:163], v[34:35]
  v_pk_add_f32 v[164:165], v[164:165], v[36:37]
  v_mfma_f32_16x16x32_bf16 v[124:127], a[124:127], a[84:87], v[124:127]
  v_pk_add_f32 v[166:167], v[166:167], v[38:39]
  v_cvt_pk_bf16_f32 v160, v160, v161
  v_mfma_f32_16x16x32_bf16 v[140:143], a[124:127], a[88:91], v[140:143]
  v_cvt_pk_bf16_f32 v161, v162, v163
  v_cvt_pk_bf16_f32 v162, v164, v165
  v_mfma_f32_16x16x32_bf16 v[156:159], a[124:127], a[92:95], v[156:159]
  v_cvt_pk_bf16_f32 v163, v166, v167
  v_permlane16_swap_b32 v160, v162
  s_nop 0
  v_permlane16_swap_b32 v161, v163
  s_waitcnt lgkmcnt(0)
  v_mfma_f32_16x16x32_bf16 v[96:99], a[96:99], a[64:67], v[96:99]
  buffer_load_dwordx4 v13, s[12:15], s71 offen offset:3072 lds
  ds_read_b128 a[80:83], v16 offset:8192
  v_mfma_f32_16x16x32_bf16 v[112:115], a[96:99], a[68:71], v[112:115]
  s_add_u32 s71, s71, 131072
  s_add_u32 m0, s64, s88
  ds_read_b64_tr_b16 a[112:113], v18 offset:20480
  v_mfma_f32_16x16x32_bf16 v[128:131], a[96:99], a[72:75], v[128:131]
  ds_read_b64_tr_b16 a[114:115], v18 offset:22528
  ds_read_b128 a[84:87], v16 offset:9216
  v_mfma_f32_16x16x32_bf16 v[144:147], a[96:99], a[76:79], v[144:147]
  buffer_load_dwordx4 v2, s[8:11], s70 offen offset:0 sc1 lds
  ds_read_b128 a[88:91], v17 offset:8192
  v_mfma_f32_16x16x32_bf16 v[100:103], a[100:103], a[64:67], v[100:103]
  ds_read_b128 a[92:95], v17 offset:9216
  ds_read_b64_tr_b16 a[116:117], v19 offset:20480
  v_mfma_f32_16x16x32_bf16 v[116:119], a[100:103], a[68:71], v[116:119]
  ds_read_b64_tr_b16 a[118:119], v19 offset:22528
  ds_read_b64_tr_b16 a[120:121], v20 offset:20480
  v_mfma_f32_16x16x32_bf16 v[132:135], a[100:103], a[72:75], v[132:135]
  buffer_load_dwordx4 v2, s[8:11], s70 offen offset:1024 sc1 lds
  ds_read_b64_tr_b16 a[122:123], v20 offset:22528
  v_mfma_f32_16x16x32_bf16 v[148:151], a[100:103], a[76:79], v[148:151]
  s_add_u32 s70, s70, 16384
  ds_read_b64_tr_b16 a[124:125], v21 offset:20480
  ds_read_b64_tr_b16 a[126:127], v21 offset:22528
  v_mfma_f32_16x16x32_bf16 v[104:107], a[104:107], a[64:67], v[104:107]
  s_add_u32 s64, s64, s66
  s_add_u32 s65, s65, 1
  s_cmp_eq_u32 s65, 4
  s_cselect_b32 s65, 0, s65
  s_cselect_b32 s66, s67, s68
  v_mfma_f32_16x16x32_bf16 v[120:123], a[104:107], a[68:71], v[120:123]
  v_add_u32 v16, s66, v16
  v_add_u32 v17, s66, v17
  v_mfma_f32_16x16x32_bf16 v[136:139], a[104:107], a[72:75], v[136:139]
  v_add_u32 v18, s66, v18
  v_add_u32 v19, s66, v19
  v_mfma_f32_16x16x32_bf16 v[152:155], a[104:107], a[76:79], v[152:155]
  v_add_u32 v20, s66, v20
  v_add_u32 v21, s66, v21
  v_mfma_f32_16x16x32_bf16 v[108:111], a[108:111], a[64:67], v[108:111]
  v_mfma_f32_16x16x32_bf16 v[124:127], a[108:111], a[68:71], v[124:127]
  v_mfma_f32_16x16x32_bf16 v[140:143], a[108:111], a[72:75], v[140:143]
  v_mfma_f32_16x16x32_bf16 v[156:159], a[108:111], a[76:79], v[156:159]
  buffer_store_dwordx4 v[160:163], v27, s[20:23], s32 offen offset:0
  s_waitcnt vmcnt(15) lgkmcnt(0)
  s_barrier
  v_mfma_f32_16x16x32_bf16 v[96:99], a[112:115], a[80:83], v[96:99]
  s_add_u32 m0, s64, 16384
  ds_read_b128 a[64:67], v16 offset:0
  ds_read_b64_tr_b16 a[96:97], v18 offset:16384
  v_mfma_f32_16x16x32_bf16 v[112:115], a[112:115], a[84:87], v[112:115]
  buffer_load_dwordx4 v10, s[12:15], s71 offen offset:0 lds
  ds_read_b64_tr_b16 a[98:99], v18 offset:18432
  v_mfma_f32_16x16x32_bf16 v[128:131], a[112:115], a[88:91], v[128:131]
  ds_read_b128 a[68:71], v16 offset:1024
  ds_read_b128 a[72:75], v17 offset:0
  v_mfma_f32_16x16x32_bf16 v[144:147], a[112:115], a[92:95], v[144:147]
  ds_read_b128 a[76:79], v17 offset:1024
  ds_read_b64_tr_b16 a[100:101], v19 offset:16384
  v_mfma_f32_16x16x32_bf16 v[100:103], a[116:119], a[80:83], v[100:103]
  ds_read_b64_tr_b16 a[102:103], v19 offset:18432
  ds_read_b64_tr_b16 a[104:105], v20 offset:16384
  v_mfma_f32_16x16x32_bf16 v[116:119], a[116:119], a[84:87], v[116:119]
  buffer_load_dwordx4 v11, s[12:15], s71 offen offset:1024 lds
  ds_read_b64_tr_b16 a[106:107], v20 offset:18432
  v_mfma_f32_16x16x32_bf16 v[132:135], a[116:119], a[88:91], v[132:135]
  ds_read_b64_tr_b16 a[108:109], v21 offset:16384
  ds_read_b64_tr_b16 a[110:111], v21 offset:18432
  v_mfma_f32_16x16x32_bf16 v[148:151], a[116:119], a[92:95], v[148:151]
  v_pk_add_f32 v[168:169], v[168:169], v[40:41]
  v_pk_add_f32 v[170:171], v[170:171], v[42:43]
  v_mfma_f32_16x16x32_bf16 v[104:107], a[120:123], a[80:83], v[104:107]
  v_pk_add_f32 v[172:173], v[172:173], v[44:45]
  v_pk_add_f32 v[174:175], v[174:175], v[46:47]
  v_mfma_f32_16x16x32_bf16 v[120:123], a[120:123], a[84:87], v[120:123]
  v_cvt_pk_bf16_f32 v168, v168, v169
  v_cvt_pk_bf16_f32 v169, v170, v171
  v_mfma_f32_16x16x32_bf16 v[136:139], a[120:123], a[88:91], v[136:139]
  buffer_load_dwordx4 v12, s[12:15], s71 offen offset:2048 lds
  v_cvt_pk_bf16_f32 v170, v172, v173
  v_mfma_f32_16x16x32_bf16 v[152:155], a[120:123], a[92:95], v[152:155]
  v_cvt_pk_bf16_f32 v171, v174, v175
  v_permlane16_swap_b32 v168, v170
  v_mfma_f32_16x16x32_bf16 v[108:111], a[124:127], a[80:83], v[108:111]
  v_permlane16_swap_b32 v169, v171
  v_mfma_f32_16x16x32_bf16 v[124:127], a[124:127], a[84:87], v[124:127]
  v_mfma_f32_16x16x32_bf16 v[140:143], a[124:127], a[88:91], v[140:143]
  v_mfma_f32_16x16x32_bf16 v[156:159], a[124:127], a[92:95], v[156:159]
  s_waitcnt lgkmcnt(0)
  v_mfma_f32_16x16x32_bf16 v[96:99], a[96:99], a[64:67], v[96:99]
  buffer_load_dwordx4 v13, s[12:15], s71 offen offset:3072 lds
  ds_read_b128 a[80:83], v16 offset:8192
  v_mfma_f32_16x16x32_bf16 v[112:115], a[96:99], a[68:71], v[112:115]
  s_add_u32 s71, s71, 131072
  s_add_u32 m0, s64, s88
  ds_read_b64_tr_b16 a[112:113], v18 offset:20480
  v_mfma_f32_16x16x32_bf16 v[128:131], a[96:99], a[72:75], v[128:131]
  ds_read_b64_tr_b16 a[114:115], v18 offset:22528
  ds_read_b128 a[84:87], v16 offset:9216
  v_mfma_f32_16x16x32_bf16 v[144:147], a[96:99], a[76:79], v[144:147]
  buffer_load_dwordx4 v2, s[8:11], s70 offen offset:0 sc1 lds
  ds_read_b128 a[88:91], v17 offset:8192
  v_mfma_f32_16x16x32_bf16 v[100:103], a[100:103], a[64:67], v[100:103]
  ds_read_b128 a[92:95], v17 offset:9216
  ds_read_b64_tr_b16 a[116:117], v19 offset:20480
  v_mfma_f32_16x16x32_bf16 v[116:119], a[100:103], a[68:71], v[116:119]
  ds_read_b64_tr_b16 a[118:119], v19 offset:22528
  ds_read_b64_tr_b16 a[120:121], v20 offset:20480
  v_mfma_f32_16x16x32_bf16 v[132:135], a[100:103], a[72:75], v[132:135]
  buffer_load_dwordx4 v2, s[8:11], s70 offen offset:1024 sc1 lds
  ds_read_b64_tr_b16 a[122:123], v20 offset:22528
  v_mfma_f32_16x16x32_bf16 v[148:151], a[100:103], a[76:79], v[148:151]
  s_add_u32 s70, s70, 16384
  ds_read_b64_tr_b16 a[124:125], v21 offset:20480
  ds_read_b64_tr_b16 a[126:127], v21 offset:22528
  v_mfma_f32_16x16x32_bf16 v[104:107], a[104:107], a[64:67], v[104:107]
  s_add_u32 s64, s64, s66
  s_add_u32 s65, s65, 1
  s_cmp_eq_u32 s65, 4
  s_cselect_b32 s65, 0, s65
  s_cselect_b32 s66, s67, s68
  v_mfma_f32_16x16x32_bf16 v[120:123], a[104:107], a[68:71], v[120:123]
  v_add_u32 v16, s66, v16
  v_add_u32 v17, s66, v17
  v_mfma_f32_16x16x32_bf16 v[136:139], a[104:107], a[72:75], v[136:139]
  v_add_u32 v18, s66, v18
  v_add_u32 v19, s66, v19
  v_mfma_f32_16x16x32_bf16 v[152:155], a[104:107], a[76:79], v[152:155]
  v_add_u32 v20, s66, v20
  v_add_u32 v21, s66, v21
  v_mfma_f32_16x16x32_bf16 v[108:111], a[108:111], a[64:67], v[108:111]
  v_mfma_f32_16x16x32_bf16 v[124:127], a[108:111], a[68:71], v[124:127]
  v_mfma_f32_16x16x32_bf16 v[140:143], a[108:111], a[72:75], v[140:143]
  v_mfma_f32_16x16x32_bf16 v[156:159], a[108:111], a[76:79], v[156:159]
  buffer_store_dwordx4 v[168:171], v27, s[20:23], s32 offen offset:64
  s_waitcnt vmcnt(14) lgkmcnt(0)
  s_barrier
  v_mfma_f32_16x16x32_bf16 v[96:99], a[112:115], a[80:83], v[96:99]
  s_sub_u32 s70, s70, 32768
  s_xor_b32 s70, s70, 524288
  s_sub_u32 s71, s71, 262144
  v_mfma_f32_16x16x32_bf16 v[112:115], a[112:115], a[84:87], v[112:115]
  s_xor_b32 s71, s71, 4194304
  s_add_u32 m0, s64, 16384
  ds_read_b128 a[64:67], v16 offset:0
  v_mfma_f32_16x16x32_bf16 v[128:131], a[112:115], a[88:91], v[128:131]
  buffer_load_dwordx4 v10, s[12:15], s71 offen offset:0 lds
  ds_read_b64_tr_b16 a[96:97], v18 offset:16384
  v_mfma_f32_16x16x32_bf16 v[144:147], a[112:115], a[92:95], v[144:147]
  ds_read_b64_tr_b16 a[98:99], v18 offset:18432
  ds_read_b128 a[68:71], v16 offset:1024
  v_mfma_f32_16x16x32_bf16 v[100:103], a[116:119], a[80:83], v[100:103]
  ds_read_b128 a[72:75], v17 offset:0
  ds_read_b128 a[76:79], v17 offset:1024
  v_mfma_f32_16x16x32_bf16 v[116:119], a[116:119], a[84:87], v[116:119]
  buffer_load_dwordx4 v11, s[12:15], s71 offen offset:1024 lds
  ds_read_b64_tr_b16 a[100:101], v19 offset:16384
  v_mfma_f32_16x16x32_bf16 v[132:135], a[116:119], a[88:91], v[132:135]
  ds_read_b64_tr_b16 a[102:103], v19 offset:18432
  ds_read_b64_tr_b16 a[104:105], v20 offset:16384
  v_mfma_f32_16x16x32_bf16 v[148:151], a[116:119], a[92:95], v[148:151]
  ds_read_b64_tr_b16 a[106:107], v20 offset:18432
  ds_read_b64_tr_b16 a[108:109], v21 offset:16384
  v_mfma_f32_16x16x32_bf16 v[104:107], a[120:123], a[80:83], v[104:107]
  ds_read_b64_tr_b16 a[110:111], v21 offset:18432
  v_pk_add_f32 v[176:177], v[176:177], v[48:49]
  v_mfma_f32_16x16x32_bf16 v[120:123], a[120:123], a[84:87], v[120:123]
  v_pk_add_f32 v[178:179], v[178:179], v[50:51]
  v_pk_add_f32 v[180:181], v[180:181], v[52:53]
  v_mfma_f32_16x16x32_bf16 v[136:139], a[120:123], a[88:91], v[136:139]
  buffer_load_dwordx4 v12, s[12:15], s71 offen offset:2048 lds
  v_pk_add_f32 v[182:183], v[182:183], v[54:55]
  v_mfma_f32_16x16x32_bf16 v[152:155], a[120:123], a[92:95], v[152:155]
  v_cvt_pk_bf16_f32 v176, v176, v177
  v_cvt_pk_bf16_f32 v177, v178, v179
  v_mfma_f32_16x16x32_bf16 v[108:111], a[124:127], a[80:83], v[108:111]
  v_cvt_pk_bf16_f32 v178, v180, v181
  v_cvt_pk_bf16_f32 v179, v182, v183
  v_mfma_f32_16x16x32_bf16 v[124:127], a[124:127], a[84:87], v[124:127]
  v_permlane16_swap_b32 v176, v178
  v_permlane16_swap_b32 v177, v179
  v_mfma_f32_16x16x32_bf16 v[140:143], a[124:127], a[88:91], v[140:143]
  v_mfma_f32_16x16x32_bf16 v[156:159], a[124:127], a[92:95], v[156:159]
  s_waitcnt lgkmcnt(0)
  v_mfma_f32_16x16x32_bf16 v[96:99], a[96:99], a[64:67], v[96:99]
  buffer_load_dwordx4 v13, s[12:15], s71 offen offset:3072 lds
  ds_read_b128 a[80:83], v16 offset:8192
  v_mfma_f32_16x16x32_bf16 v[112:115], a[96:99], a[68:71], v[112:115]
  s_add_u32 s71, s71, 131072
  s_add_u32 m0, s64, s88
  ds_read_b64_tr_b16 a[112:113], v18 offset:20480
  v_mfma_f32_16x16x32_bf16 v[128:131], a[96:99], a[72:75], v[128:131]
  ds_read_b64_tr_b16 a[114:115], v18 offset:22528
  ds_read_b128 a[84:87], v16 offset:9216
  v_mfma_f32_16x16x32_bf16 v[144:147], a[96:99], a[76:79], v[144:147]
  buffer_load_dwordx4 v2, s[8:11], s70 offen offset:0 sc1 lds
  ds_read_b128 a[88:91], v17 offset:8192
  v_mfma_f32_16x16x32_bf16 v[100:103], a[100:103], a[64:67], v[100:103]
  ds_read_b128 a[92:95], v17 offset:9216
  ds_read_b64_tr_b16 a[116:117], v19 offset:20480
  v_mfma_f32_16x16x32_bf16 v[116:119], a[100:103], a[68:71], v[116:119]
  ds_read_b64_tr_b16 a[118:119], v19 offset:22528
  ds_read_b64_tr_b16 a[120:121], v20 offset:20480
  v_mfma_f32_16x16x32_bf16 v[132:135], a[100:103], a[72:75], v[132:135]
  buffer_load_dwordx4 v2, s[8:11], s70 offen offset:1024 sc1 lds
  ds_read_b64_tr_b16 a[122:123], v20 offset:22528
  v_mfma_f32_16x16x32_bf16 v[148:151], a[100:103], a[76:79], v[148:151]
  s_add_u32 s70, s70, 16384
  ds_read_b64_tr_b16 a[124:125], v21 offset:20480
  ds_read_b64_tr_b16 a[126:127], v21 offset:22528
  v_mfma_f32_16x16x32_bf16 v[104:107], a[104:107], a[64:67], v[104:107]
  s_add_u32 s64, s64, s66
  s_add_u32 s65, s65, 1
  s_cmp_eq_u32 s65, 4
  s_cselect_b32 s65, 0, s65
  s_cselect_b32 s66, s67, s68
  v_mfma_f32_16x16x32_bf16 v[120:123], a[104:107], a[68:71], v[120:123]
  v_add_u32 v16, s66, v16
  v_add_u32 v17, s66, v17
  v_mfma_f32_16x16x32_bf16 v[136:139], a[104:107], a[72:75], v[136:139]
  v_add_u32 v18, s66, v18
  v_add_u32 v19, s66, v19
  v_mfma_f32_16x16x32_bf16 v[152:155], a[104:107], a[76:79], v[152:155]
  v_add_u32 v20, s66, v20
  v_add_u32 v21, s66, v21
  v_mfma_f32_16x16x32_bf16 v[108:111], a[108:111], a[64:67], v[108:111]
  v_mfma_f32_16x16x32_bf16 v[124:127], a[108:111], a[68:71], v[124:127]
  v_mfma_f32_16x16x32_bf16 v[140:143], a[108:111], a[72:75], v[140:143]
  v_mfma_f32_16x16x32_bf16 v[156:159], a[108:111], a[76:79], v[156:159]
  buffer_store_dwordx4 v[176:179], v27, s[20:23], s33 offen offset:0
  s_waitcnt vmcnt(15) lgkmcnt(0)
  s_barrier
  v_mfma_f32_16x16x32_bf16 v[96:99], a[112:115], a[80:83], v[96:99]
  s_add_u32 m0, s64, 16384
  ds_read_b128 a[64:67], v16 offset:0
  ds_read_b64_tr_b16 a[96:97], v18 offset:16384
  v_mfma_f32_16x16x32_bf16 v[112:115], a[112:115], a[84:87], v[112:115]
  buffer_load_dwordx4 v10, s[12:15], s71 offen offset:0 lds
  ds_read_b64_tr_b16 a[98:99], v18 offset:18432
  v_mfma_f32_16x16x32_bf16 v[128:131], a[112:115], a[88:91], v[128:131]
  buffer_load_dwordx4 v11, s[12:15], s71 offen offset:1024 lds
  ds_read_b128 a[68:71], v16 offset:1024
  v_mfma_f32_16x16x32_bf16 v[144:147], a[112:115], a[92:95], v[144:147]
  ds_read_b64_tr_b16 a[100:101], v19 offset:16384
  ds_read_b64_tr_b16 a[102:103], v19 offset:18432
  v_mfma_f32_16x16x32_bf16 v[100:103], a[116:119], a[80:83], v[100:103]
  ds_read_b64_tr_b16 a[104:105], v20 offset:16384
  ds_read_b64_tr_b16 a[106:107], v20 offset:18432
  v_mfma_f32_16x16x32_bf16 v[116:119], a[116:119], a[84:87], v[116:119]
  buffer_load_dwordx4 v12, s[12:15], s71 offen offset:2048 lds
  ds_read_b64_tr_b16 a[108:109], v21 offset:16384
  v_mfma_f32_16x16x32_bf16 v[132:135], a[116:119], a[88:91], v[132:135]
  ds_read_b64_tr_b16 a[110:111], v21 offset:18432
  v_pk_add_f32 v[184:185], v[184:185], v[56:57]
  v_mfma_f32_16x16x32_bf16 v[148:151], a[116:119], a[92:95], v[148:151]
  buffer_load_dwordx4 v13, s[12:15], s71 offen offset:3072 lds
  v_pk_add_f32 v[186:187], v[186:187], v[58:59]
  v_mfma_f32_16x16x32_bf16 v[104:107], a[120:123], a[80:83], v[104:107]
  s_add_u32 s71, s71, 131072
  s_add_u32 m0, s64, s88
  v_pk_add_f32 v[188:189], v[188:189], v[60:61]
  v_mfma_f32_16x16x32_bf16 v[120:123], a[120:123], a[84:87], v[120:123]
  v_pk_add_f32 v[190:191], v[190:191], v[62:63]
  v_cvt_pk_bf16_f32 v184, v184, v185
  v_mfma_f32_16x16x32_bf16 v[136:139], a[120:123], a[88:91], v[136:139]
  buffer_load_dwordx4 v2, s[8:11], s70 offen offset:0 sc1 lds
  v_cvt_pk_bf16_f32 v185, v186, v187
  v_mfma_f32_16x16x32_bf16 v[152:155], a[120:123], a[92:95], v[152:155]
  v_cvt_pk_bf16_f32 v186, v188, v189
  v_cvt_pk_bf16_f32 v187, v190, v191
  v_mfma_f32_16x16x32_bf16 v[108:111], a[124:127], a[80:83], v[108:111]
  buffer_load_dwordx4 v2, s[8:11], s70 offen offset:1024 sc1 lds
  v_permlane16_swap_b32 v184, v186
  v_mfma_f32_16x16x32_bf16 v[124:127], a[124:127], a[84:87], v[124:127]
  s_add_u32 s70, s70, 16384
  s_lshl_b32 s36, s78, 1
  s_add_u32 s36, s36, s77
  v_mfma_f32_16x16x32_bf16 v[140:143], a[124:127], a[88:91], v[140:143]
  s_xor_b32 s36, s36, 1
  s_lshl_b32 s36, s36, 2
  s_add_u32 s36, s36, s3
  v_mfma_f32_16x16x32_bf16 v[156:159], a[124:127], a[92:95], v[156:159]
  s_lshl_b32 s36, s36, 14
  s_add_u32 s37, s36, 4096
  v_permlane16_swap_b32 v185, v187
  s_waitcnt lgkmcnt(0)
  v_mfma_f32_16x16x32_bf16 v[96:99], a[96:99], a[64:67], v[96:99]
  buffer_store_dwordx4 v[128:131], v2, s[16:19], s36 offen offset:0 sc1
  ds_read_b128 a[80:83], v16 offset:8192
  v_mfma_f32_16x16x32_bf16 v[112:115], a[96:99], a[68:71], v[112:115]
  buffer_store_dwordx4 v[132:135], v2, s[16:19], s36 offen offset:1024 sc1
  ds_read_b64_tr_b16 a[112:113], v18 offset:20480
  v_mfma_f32_16x16x32_bf16 v[100:103], a[100:103], a[64:67], v[100:103]
  buffer_store_dwordx4 v[136:139], v2, s[16:19], s36 offen offset:2048 sc1
  ds_read_b64_tr_b16 a[114:115], v18 offset:22528
  v_mfma_f32_16x16x32_bf16 v[116:119], a[100:103], a[68:71], v[116:119]
  buffer_store_dwordx4 v[140:143], v2, s[16:19], s36 offen offset:3072 sc1
  ds_read_b128 a[84:87], v16 offset:9216
  v_mfma_f32_16x16x32_bf16 v[104:107], a[104:107], a[64:67], v[104:107]
  buffer_store_dwordx4 v[144:147], v2, s[16:19], s37 offen offset:0 sc1
  ds_read_b64_tr_b16 a[116:117], v19 offset:20480
  v_mfma_f32_16x16x32_bf16 v[120:123], a[104:107], a[68:71], v[120:123]
  buffer_store_dwordx4 v[148:151], v2, s[16:19], s37 offen offset:1024 sc1
  ds_read_b64_tr_b16 a[118:119], v19 offset:22528
  v_mfma_f32_16x16x32_bf16 v[108:111], a[108:111], a[64:67], v[108:111]
  buffer_store_dwordx4 v[152:155], v2, s[16:19], s37 offen offset:2048 sc1
  ds_read_b64_tr_b16 a[120:121], v20 offset:20480
  v_mfma_f32_16x16x32_bf16 v[124:127], a[108:111], a[68:71], v[124:127]
  buffer_store_dwordx4 v[156:159], v2, s[16:19], s37 offen offset:3072 sc1
  ds_read_b64_tr_b16 a[122:123], v20 offset:22528
  ds_read_b64_tr_b16 a[124:125], v21 offset:20480
  ds_read_b64_tr_b16 a[126:127], v21 offset:22528
  s_add_u32 s64, s64, s66
  s_add_u32 s65, s65, 1
  s_cmp_eq_u32 s65, 4
  s_cselect_b32 s65, 0, s65
  s_cselect_b32 s66, s67, s68
  v_add_u32 v16, s66, v16
  v_add_u32 v17, s66, v17
  v_add_u32 v18, s66, v18
  v_add_u32 v19, s66, v19
  v_add_u32 v20, s66, v20
  v_add_u32 v21, s66, v21
  buffer_store_dwordx4 v[184:187], v27, s[20:23], s33 offen offset:64
  s_waitcnt vmcnt(23) lgkmcnt(0)
  s_barrier
  v_mfma_f32_16x16x32_bf16 v[96:99], a[112:115], a[80:83], v[96:99]
  ds_read_b128 a[64:67], v16 offset:0
  ds_read_b64_tr_b16 a[96:97], v18 offset:16384
  v_mfma_f32_16x16x32_bf16 v[112:115], a[112:115], a[84:87], v[112:115]
  ds_read_b64_tr_b16 a[98:99], v18 offset:18432
  ds_read_b128 a[68:71], v16 offset:1024
  v_mfma_f32_16x16x32_bf16 v[100:103], a[116:119], a[80:83], v[100:103]
  ds_read_b64_tr_b16 a[100:101], v19 offset:16384
  v_mfma_f32_16x16x32_bf16 v[116:119], a[116:119], a[84:87], v[116:119]
  ds_read_b64_tr_b16 a[102:103], v19 offset:18432
  ds_read_b64_tr_b16 a[104:105], v20 offset:16384
  v_mfma_f32_16x16x32_bf16 v[104:107], a[120:123], a[80:83], v[104:107]
  ds_read_b64_tr_b16 a[106:107], v20 offset:18432
  ds_read_b64_tr_b16 a[108:109], v21 offset:16384
  v_mfma_f32_16x16x32_bf16 v[120:123], a[120:123], a[84:87], v[120:123]
  ds_read_b64_tr_b16 a[110:111], v21 offset:18432
  v_mfma_f32_16x16x32_bf16 v[108:111], a[124:127], a[80:83], v[108:111]
  v_mfma_f32_16x16x32_bf16 v[124:127], a[124:127], a[84:87], v[124:127]
  s_waitcnt lgkmcnt(0)
  v_mfma_f32_16x16x32_bf16 v[96:99], a[96:99], a[64:67], v[96:99]
  s_add_u32 s64, s64, s66
  ds_read_b128 a[80:83], v16 offset:8192
  ds_read_b64_tr_b16 a[112:113], v18 offset:20480
  v_mfma_f32_16x16x32_bf16 v[112:115], a[96:99], a[68:71], v[112:115]
  s_add_u32 s65, s65, 1
  ds_read_b64_tr_b16 a[114:115], v18 offset:22528
  ds_read_b128 a[84:87], v16 offset:9216
  v_mfma_f32_16x16x32_bf16 v[100:103], a[100:103], a[64:67], v[100:103]
  s_cmp_eq_u32 s65, 4
  s_cselect_b32 s65, 0, s65
  s_cselect_b32 s66, s67, s68
  ds_read_b64_tr_b16 a[116:117], v19 offset:20480
  v_mfma_f32_16x16x32_bf16 v[116:119], a[100:103], a[68:71], v[116:119]
  ds_read_b64_tr_b16 a[118:119], v19 offset:22528
  ds_read_b64_tr_b16 a[120:121], v20 offset:20480
  v_mfma_f32_16x16x32_bf16 v[104:107], a[104:107], a[64:67], v[104:107]
  ds_read_b64_tr_b16 a[122:123], v20 offset:22528
  ds_read_b64_tr_b16 a[124:125], v21 offset:20480
  v_mfma_f32_16x16x32_bf16 v[120:123], a[104:107], a[68:71], v[120:123]
  ds_read_b64_tr_b16 a[126:127], v21 offset:22528
  v_mfma_f32_16x16x32_bf16 v[108:111], a[108:111], a[64:67], v[108:111]
  v_add_u32 v16, s66, v16
  v_add_u32 v17, s66, v17
  v_add_u32 v20, s66, v20
  v_mfma_f32_16x16x32_bf16 v[124:127], a[108:111], a[68:71], v[124:127]
  v_add_u32 v18, s66, v18
  v_add_u32 v19, s66, v19
  v_add_u32 v21, s66, v21
  s_waitcnt vmcnt(16) lgkmcnt(0)
  s_barrier
  v_mfma_f32_16x16x32_bf16 v[96:99], a[112:115], a[80:83], v[96:99]
  ds_read_b128 a[64:67], v16 offset:0
  ds_read_b64_tr_b16 a[96:97], v18 offset:16384
  v_mfma_f32_16x16x32_bf16 v[112:115], a[112:115], a[84:87], v[112:115]
  ds_read_b64_tr_b16 a[98:99], v18 offset:18432
  ds_read_b128 a[68:71], v16 offset:1024
  v_mfma_f32_16x16x32_bf16 v[100:103], a[116:119], a[80:83], v[100:103]
  ds_read_b64_tr_b16 a[100:101], v19 offset:16384
  v_mfma_f32_16x16x32_bf16 v[116:119], a[116:119], a[84:87], v[116:119]
  ds_read_b64_tr_b16 a[102:103], v19 offset:18432
  ds_read_b64_tr_b16 a[104:105], v20 offset:16384
  v_mfma_f32_16x16x32_bf16 v[104:107], a[120:123], a[80:83], v[104:107]
  ds_read_b64_tr_b16 a[106:107], v20 offset:18432
  ds_read_b64_tr_b16 a[108:109], v21 offset:16384
  v_mfma_f32_16x16x32_bf16 v[120:123], a[120:123], a[84:87], v[120:123]
  ds_read_b64_tr_b16 a[110:111], v21 offset:18432
  v_mfma_f32_16x16x32_bf16 v[108:111], a[124:127], a[80:83], v[108:111]
  v_mfma_f32_16x16x32_bf16 v[124:127], a[124:127], a[84:87], v[124:127]
  s_waitcnt lgkmcnt(0)
  v_mfma_f32_16x16x32_bf16 v[96:99], a[96:99], a[64:67], v[96:99]
  s_add_u32 s64, s64, s66
  ds_read_b128 a[80:83], v16 offset:8192
  ds_read_b64_tr_b16 a[112:113], v18 offset:20480
  v_mfma_f32_16x16x32_bf16 v[112:115], a[96:99], a[68:71], v[112:115]
  s_add_u32 s65, s65, 1
  ds_read_b64_tr_b16 a[114:115], v18 offset:22528
  ds_read_b128 a[84:87], v16 offset:9216
  v_mfma_f32_16x16x32_bf16 v[100:103], a[100:103], a[64:67], v[100:103]
  s_cmp_eq_u32 s65, 4
  s_cselect_b32 s65, 0, s65
  s_cselect_b32 s66, s67, s68
  ds_read_b64_tr_b16 a[116:117], v19 offset:20480
  v_mfma_f32_16x16x32_bf16 v[116:119], a[100:103], a[68:71], v[116:119]
  ds_read_b64_tr_b16 a[118:119], v19 offset:22528
  ds_read_b64_tr_b16 a[120:121], v20 offset:20480
  v_mfma_f32_16x16x32_bf16 v[104:107], a[104:107], a[64:67], v[104:107]
  ds_read_b64_tr_b16 a[122:123], v20 offset:22528
  ds_read_b64_tr_b16 a[124:125], v21 offset:20480
  v_mfma_f32_16x16x32_bf16 v[120:123], a[104:107], a[68:71], v[120:123]
  ds_read_b64_tr_b16 a[126:127], v21 offset:22528
  v_mfma_f32_16x16x32_bf16 v[108:111], a[108:111], a[64:67], v[108:111]
  v_add_u32 v16, s66, v16
  v_add_u32 v17, s66, v17
  v_add_u32 v20, s66, v20
  v_mfma_f32_16x16x32_bf16 v[124:127], a[108:111], a[68:71], v[124:127]
  v_add_u32 v18, s66, v18
  v_add_u32 v19, s66, v19
  v_add_u32 v21, s66, v21
  s_waitcnt vmcnt(9) lgkmcnt(0)
  s_barrier
  v_mfma_f32_16x16x32_bf16 v[96:99], a[112:115], a[80:83], v[96:99]
  s_lshl_b32 s6, s78, 1
  s_add_u32 s6, s6, s77
  s_lshl_b32 s6, s6, 2
  v_mfma_f32_16x16x32_bf16 v[112:115], a[112:115], a[84:87], v[112:115]
  s_add_u32 s6, s6, s3
  s_lshl_b32 s6, s6, 14
  s_add_u32 s7, s6, 4096
  v_mfma_f32_16x16x32_bf16 v[100:103], a[116:119], a[80:83], v[100:103]
  buffer_load_dwordx4 v[192:195], v2, s[16:19], s6 offen offset:0 sc1
  ds_read_b128 a[64:67], v16 offset:0
  v_mfma_f32_16x16x32_bf16 v[116:119], a[116:119], a[84:87], v[116:119]
  buffer_load_dwordx4 v[196:199], v2, s[16:19], s6 offen offset:1024 sc1
  ds_read_b64_tr_b16 a[96:97], v18 offset:16384
  v_mfma_f32_16x16x32_bf16 v[104:107], a[120:123], a[80:83], v[104:107]
  buffer_load_dwordx4 v[200:203], v2, s[16:19], s6 offen offset:2048 sc1
  ds_read_b64_tr_b16 a[98:99], v18 offset:18432
  v_mfma_f32_16x16x32_bf16 v[120:123], a[120:123], a[84:87], v[120:123]
  buffer_load_dwordx4 v[204:207], v2, s[16:19], s6 offen offset:3072 sc1
  ds_read_b128 a[68:71], v16 offset:1024
  v_mfma_f32_16x16x32_bf16 v[108:111], a[124:127], a[80:83], v[108:111]
  ds_read_b64_tr_b16 a[100:101], v19 offset:16384
  ds_read_b64_tr_b16 a[102:103], v19 offset:18432
  v_mfma_f32_16x16x32_bf16 v[124:127], a[124:127], a[84:87], v[124:127]
  ds_read_b64_tr_b16 a[104:105], v20 offset:16384
  ds_read_b64_tr_b16 a[106:107], v20 offset:18432
  ds_read_b64_tr_b16 a[108:109], v21 offset:16384
  ds_read_b64_tr_b16 a[110:111], v21 offset:18432
  s_waitcnt lgkmcnt(0)
  v_mfma_f32_16x16x32_bf16 v[96:99], a[96:99], a[64:67], v[96:99]
  buffer_load_dwordx4 v[208:211], v2, s[16:19], s7 offen offset:0 sc1
  ds_read_b128 a[80:83], v16 offset:8192
  v_mfma_f32_16x16x32_bf16 v[112:115], a[96:99], a[68:71], v[112:115]
  buffer_load_dwordx4 v[212:215], v2, s[16:19], s7 offen offset:1024 sc1
  ds_read_b64_tr_b16 a[112:113], v18 offset:20480
  v_mfma_f32_16x16x32_bf16 v[100:103], a[100:103], a[64:67], v[100:103]
  ds_read_b64_tr_b16 a[114:115], v18 offset:22528
  ds_read_b128 a[84:87], v16 offset:9216
  v_mfma_f32_16x16x32_bf16 v[116:119], a[100:103], a[68:71], v[116:119]
  buffer_load_dwordx4 v[216:219], v2, s[16:19], s7 offen offset:2048 sc1
  ds_read_b64_tr_b16 a[116:117], v19 offset:20480
  v_mfma_f32_16x16x32_bf16 v[104:107], a[104:107], a[64:67], v[104:107]
  ds_read_b64_tr_b16 a[118:119], v19 offset:22528
  ds_read_b64_tr_b16 a[120:121], v20 offset:20480
  v_mfma_f32_16x16x32_bf16 v[120:123], a[104:107], a[68:71], v[120:123]
  buffer_load_dwordx4 v[220:223], v2, s[16:19], s7 offen offset:3072 sc1
  ds_read_b64_tr_b16 a[122:123], v20 offset:22528
  v_mfma_f32_16x16x32_bf16 v[108:111], a[108:111], a[64:67], v[108:111]
  ds_read_b64_tr_b16 a[124:125], v21 offset:20480
  ds_read_b64_tr_b16 a[126:127], v21 offset:22528
  v_mfma_f32_16x16x32_bf16 v[124:127], a[108:111], a[68:71], v[124:127]
  s_waitcnt lgkmcnt(0)
  v_mfma_f32_16x16x32_bf16 v[96:99], a[112:115], a[80:83], v[96:99]
  v_mfma_f32_16x16x32_bf16 v[112:115], a[112:115], a[84:87], v[112:115]
  v_mfma_f32_16x16x32_bf16 v[100:103], a[116:119], a[80:83], v[100:103]
  v_mfma_f32_16x16x32_bf16 v[116:119], a[116:119], a[84:87], v[116:119]
  v_mfma_f32_16x16x32_bf16 v[104:107], a[120:123], a[80:83], v[104:107]
  v_mfma_f32_16x16x32_bf16 v[120:123], a[120:123], a[84:87], v[120:123]
  v_mfma_f32_16x16x32_bf16 v[108:111], a[124:127], a[80:83], v[108:111]
  v_mfma_f32_16x16x32_bf16 v[124:127], a[124:127], a[84:87], v[124:127]
  s_waitcnt vmcnt(0)
  s_mov_b32 s72, 0x40000
Lrc_13:
  v_max3_u32 v4, v192, v193, v194
  v_max3_u32 v5, v200, v201, v202
  v_max3_u32 v6, v208, v209, v210
  v_max3_u32 v7, v216, v217, v218
  v_max3_u32 v4, v4, v195, v196
  v_max3_u32 v5, v5, v203, v204
  v_max3_u32 v6, v6, v211, v212
  v_max3_u32 v7, v7, v219, v220
  v_max3_u32 v4, v4, v197, v198
  v_max3_u32 v5, v5, v205, v206
  v_max3_u32 v6, v6, v213, v214
  v_max3_u32 v7, v7, v221, v222
  v_max_u32 v4, v4, v199
  v_max_u32 v5, v5, v207
  v_max_u32 v6, v6, v215
  v_max_u32 v7, v7, v223
  v_max3_u32 v4, v4, v5, v6
  v_max_u32 v4, v4, v7
  v_cmp_eq_u32 vcc, -1, v4
  s_nop 0
  s_cbranch_vccz Lpolld_14
  buffer_load_dwordx4 v[192:195], v2, s[16:19], s6 offen offset:0 sc1
  buffer_load_dwordx4 v[196:199], v2, s[16:19], s6 offen offset:1024 sc1
  buffer_load_dwordx4 v[200:203], v2, s[16:19], s6 offen offset:2048 sc1
  buffer_load_dwordx4 v[204:207], v2, s[16:19], s6 offen offset:3072 sc1
  buffer_load_dwordx4 v[208:211], v2, s[16:19], s7 offen offset:0 sc1
  buffer_load_dwordx4 v[212:215], v2, s[16:19], s7 offen offset:1024 sc1
  buffer_load_dwordx4 v[216:219], v2, s[16:19], s7 offen offset:2048 sc1
  buffer_load_dwordx4 v[220:223], v2, s[16:19], s7 offen offset:3072 sc1
  s_sub_u32 s72, s72, 1
  s_waitcnt vmcnt(0)
  s_cbranch_scc0 Lrc_13
Lpolld_14:
  v_pk_add_f32 v[192:193], v[192:193], v[96:97]
  v_pk_add_f32 v[200:201], v[200:201], v[104:105]
  v_pk_add_f32 v[208:209], v[208:209], v[112:113]
  v_pk_add_f32 v[216:217], v[216:217], v[120:121]
  v_pk_add_f32 v[194:195], v[194:195], v[98:99]
  v_pk_add_f32 v[202:203], v[202:203], v[106:107]
  v_pk_add_f32 v[210:211], v[210:211], v[114:115]
  v_pk_add_f32 v[218:219], v[218:219], v[122:123]
  v_pk_add_f32 v[196:197], v[196:197], v[100:101]
  v_pk_add_f32 v[204:205], v[204:205], v[108:109]
  v_pk_add_f32 v[212:213], v[212:213], v[116:117]
  v_pk_add_f32 v[220:221], v[220:221], v[124:125]
  v_pk_add_f32 v[198:199], v[198:199], v[102:103]
  v_pk_add_f32 v[206:207], v[206:207], v[110:111]
  v_pk_add_f32 v[214:215], v[214:215], v[118:119]
  v_pk_add_f32 v[222:223], v[222:223], v[126:127]
  v_cvt_pk_bf16_f32 v192, v192, v193
  v_cvt_pk_bf16_f32 v200, v200, v201
  v_cvt_pk_bf16_f32 v208, v208, v209
  v_cvt_pk_bf16_f32 v216, v216, v217
  v_cvt_pk_bf16_f32 v193, v194, v195
  v_cvt_pk_bf16_f32 v201, v202, v203
  v_cvt_pk_bf16_f32 v209, v210, v211
  v_cvt_pk_bf16_f32 v217, v218, v219
  v_cvt_pk_bf16_f32 v194, v196, v197
  v_cvt_pk_bf16_f32 v202, v204, v205
  v_cvt_pk_bf16_f32 v210, v212, v213
  v_cvt_pk_bf16_f32 v218, v220, v221
  v_cvt_pk_bf16_f32 v195, v198, v199
  v_cvt_pk_bf16_f32 v203, v206, v207
  v_cvt_pk_bf16_f32 v211, v214, v215
  v_cvt_pk_bf16_f32 v219, v222, v223
  v_permlane16_swap_b32 v192, v194
  v_permlane16_swap_b32 v200, v202
  v_permlane16_swap_b32 v208, v210
  v_permlane16_swap_b32 v216, v218
  v_permlane16_swap_b32 v193, v195
  v_permlane16_swap_b32 v201, v203
  v_permlane16_swap_b32 v209, v211
  v_permlane16_swap_b32 v217, v219
  buffer_store_dwordx4 v[192:195], v26, s[20:23], s34 offen offset:0
  buffer_store_dwordx4 v[200:203], v26, s[20:23], s34 offen offset:64
  buffer_store_dwordx4 v[208:211], v26, s[20:23], s35 offen offset:0
  buffer_store_dwordx4 v[216:219], v26, s[20:23], s35 offen offset:64
Lend:
  s_endpgm
.section .rodata,"a"
.p2align 6
.amdhsa_kernel concat_heads__compressed_kv_cla__sliding_local_dilated__prompt_kernel
  .amdhsa_next_free_vgpr 512
  .amdhsa_next_free_sgpr 102
  .amdhsa_accum_offset 256
  .amdhsa_group_segment_fixed_size 0
  .amdhsa_kernarg_size 96
  .amdhsa_user_sgpr_count 2
  .amdhsa_user_sgpr_kernarg_segment_ptr 1
  .amdhsa_system_sgpr_workgroup_id_x 1
.end_amdhsa_kernel
```

```asm
; @launch grid=(256,1,1) block=(256,1,1) lds=163840
.amdgcn_target "amdgcn-amd-amdhsa--gfx950"
.text
.globl concat_heads__compressed_kv_cla__sliding_local_dilated__prompt_kernel
.p2align 8
.type concat_heads__compressed_kv_cla__sliding_local_dilated__prompt_kernel,@function
concat_heads__compressed_kv_cla__sliding_local_dilated__prompt_kernel:
  s_cmp_ge_u32 s2, 256
  s_cbranch_scc1 Lend
  s_load_dwordx16 s[64:79], s[0:1], 0
  s_load_dwordx8 s[80:87], s[0:1], 64
  v_lshrrev_b32 v2, 6, v0
  v_and_b32 v1, 63, v0
  v_readfirstlane_b32 s3, v2
  v_lshlrev_b32 v2, 4, v1
  s_bfe_u32 s59, s2, 0x30003
  s_lshr_b32 s4, s2, 7
  s_lshl_b32 s4, s4, 3
  s_add_u32 s59, s59, s4
  s_lshr_b32 s4, s2, 3
  s_xor_b32 s4, s4, s2
  s_bitcmp1_b32 s4, 3
  s_cbranch_scc1 Lp2
  s_and_b32 s4, s2, 1
  s_lshl_b32 s4, s4, 2
  s_and_b32 s5, s59, 3
  s_add_u32 s61, s4, s5
  s_bfe_u32 s4, s2, 0x20001
  s_lshl_b32 s4, s4, 2
  s_lshr_b32 s5, s59, 2
  s_add_u32 s62, s4, s5
  s_lshl_b32 s4, s3, 13
  s_add_u32 s36, s4, 65536
  s_add_u32 s41, s4, 98304
  v_lshrrev_b32 v32, 3, v1
  v_and_b32 v33, 6, v32
  v_and_b32 v34, 7, v1
  v_xor_b32 v33, v33, v34
  v_lshlrev_b32 v33, 4, v33
  s_lshl_b32 s4, s61, 2
  s_add_u32 s4, s4, s3
  s_lshl_b32 s4, s4, 6
  v_add_u32 v34, s4, v32
  v_lshl_add_u32 v34, v34, 10, v33
  v_add_u32 v48, 0, v34
  v_add_u32 v49, 7168, v34
  v_add_u32 v50, 14336, v34
  v_add_u32 v51, 21504, v34
  v_add_u32 v52, 32768, v34
  v_add_u32 v53, 39936, v34
  v_add_u32 v54, 47104, v34
  v_add_u32 v55, 54272, v34
  v_lshrrev_b32 v34, 2, v32
  v_and_b32 v35, 3, v32
  v_lshl_add_u32 v34, v34, 3, v35
  s_lshl_b32 s4, s62, 2
  s_add_u32 s4, s4, s3
  s_lshl_b32 s4, s4, 7
  v_lshl_add_u32 v34, v34, 13, v33
  v_add_u32 v34, s4, v34
  v_add_u32 v56, 0, v34
  v_add_u32 v57, 130048, v34
  v_add_u32 v58, 30720, v34
  v_add_u32 v59, 160768, v34
  v_add_u32 v60, 262144, v34
  v_add_u32 v61, 392192, v34
  v_add_u32 v62, 292864, v34
  v_add_u32 v63, 422912, v34
  s_and_b32 s6, s2, 7
  s_add_u32 s4, s61, s62
  s_and_b32 s49, s4, 3
  s_lshl_b32 s49, s49, 3
  s_or_b32 s49, s49, 0x80000
  s_bfe_u32 s48, 0x70702, s49
  s_add_u32 s48, s48, s6
  s_and_b32 s48, s48, 7
  s_lshl_b32 s46, s48, 7
  s_waitcnt lgkmcnt(0)
  s_mov_b32 s8, s66
  s_mov_b32 s9, s67
  s_mov_b32 s10, 2097152
  s_mov_b32 s11, 0x00020000
  s_mov_b32 s12, s70
  s_mov_b32 s13, s71
  s_mov_b32 s14, 4194304
  s_mov_b32 s15, 0x00020000
  s_mov_b32 s50, 9
  s_add_u32 s96, s86, 125829120
  s_addc_u32 s97, s87, 0
  s_mov_b32 s98, 262144
  s_mov_b32 s99, 0x00020000
  s_or_b32 s4, s2, s3
  s_cbranch_scc1 Ltag_1
  s_mov_b32 s4, 196608
  buffer_load_dwordx2 v[22:23], off, s[96:99], s4 sc1
Ltag_1:
  s_mov_b32 m0, s36
  s_nop 0
  buffer_load_dwordx4 v48, s[8:11], s46 offen offset:0 lds
  buffer_load_dwordx4 v49, s[8:11], s46 offen offset:1024 lds
  buffer_load_dwordx4 v50, s[8:11], s46 offen offset:2048 lds
  buffer_load_dwordx4 v51, s[8:11], s46 offen offset:3072 lds
  s_add_u32 m0, s36, 4096
  s_nop 0
  buffer_load_dwordx4 v52, s[8:11], s46 offen offset:0 lds
  buffer_load_dwordx4 v53, s[8:11], s46 offen offset:1024 lds
  buffer_load_dwordx4 v54, s[8:11], s46 offen offset:2048 lds
  buffer_load_dwordx4 v55, s[8:11], s46 offen offset:3072 lds
  s_sub_u32 s50, s50, 1
  s_cmp_eq_u32 s50, 0
  s_cselect_b32 s12, s72, s12
  s_cselect_b32 s13, s73, s13
  s_lshl_b32 s47, s48, 19
  s_bfe_u32 s34, 0x3020106, s49
  s_add_u32 s48, s48, s34
  s_add_u32 s49, s49, 8
  s_and_b32 s49, s49, 0x8001f
  s_and_b32 s48, s48, 7
  s_lshl_b32 s46, s48, 7
  s_mov_b32 m0, s41
  s_nop 0
  buffer_load_dwordx4 v56, s[12:15], s47 offen offset:0 lds
  buffer_load_dwordx4 v57, s[12:15], s47 offen offset:1024 lds
  buffer_load_dwordx4 v58, s[12:15], s47 offen offset:2048 lds
  buffer_load_dwordx4 v59, s[12:15], s47 offen offset:3072 lds
  s_add_u32 m0, s41, 4096
  s_nop 0
  buffer_load_dwordx4 v60, s[12:15], s47 offen offset:0 lds
  buffer_load_dwordx4 v61, s[12:15], s47 offen offset:1024 lds
  buffer_load_dwordx4 v62, s[12:15], s47 offen offset:2048 lds
  buffer_load_dwordx4 v63, s[12:15], s47 offen offset:3072 lds
  s_lshr_b32 s4, s3, 1
  s_lshl_b32 s4, s4, 14
  s_add_u32 s4, s4, 65536
  v_and_b32 v32, 15, v1
  v_lshlrev_b32 v32, 7, v32
  v_lshrrev_b32 v33, 4, v1
  v_and_b32 v34, 6, v1
  v_xor_b32 v33, v33, v34
  v_lshl_add_u32 v32, v33, 4, v32
  v_add_u32 v16, s4, v32
  v_xor_b32 v17, 64, v16
  s_and_b32 s4, s3, 1
  s_lshl_b32 s4, s4, 14
  s_add_u32 s4, s4, 98304
  v_lshrrev_b32 v32, 2, v1
  v_and_b32 v33, 6, v32
  v_lshlrev_b32 v32, 7, v32
  v_and_b32 v34, 1, v1
  v_lshl_add_u32 v32, v34, 3, v32
  v_add_u32 v32, s4, v32
  v_bfe_u32 v34, v1, 1, 1
  v_xor_b32 v33, v33, v34
  v_xor_b32 v34, 0, v33
  v_lshl_add_u32 v18, v34, 4, v32
  v_xor_b32 v34, 2, v33
  v_lshl_add_u32 v19, v34, 4, v32
  v_xor_b32 v34, 4, v33
  v_lshl_add_u32 v20, v34, 4, v32
  v_xor_b32 v34, 6, v33
  v_lshl_add_u32 v21, v34, 4, v32
  s_and_b32 s24, s2, 7
  s_lshr_b32 s4, s2, 6
  s_lshl_b32 s4, s4, 3
  s_add_u32 s24, s24, s4
  s_lshr_b32 s4, s2, 3
  s_and_b32 s25, s4, 6
  s_xor_b32 s4, s4, s2
  s_bfe_u32 s4, s4, 0x10003
  s_add_u32 s25, s25, s4
  v_accvgpr_write_b32 a244, -1
  v_accvgpr_write_b32 a245, -1
  v_accvgpr_write_b32 a246, -1
  v_accvgpr_write_b32 a247, -1
  v_lshrrev_b32 v24, 3, v1
  v_and_b32 v25, 6, v24
  v_and_b32 v26, 7, v1
  v_xor_b32 v25, v25, v26
  v_lshlrev_b32 v25, 4, v25
  s_and_b32 s4, s3, 1
  s_lshl_b32 s4, s4, 16
  s_lshr_b32 s5, s3, 1
  s_lshl_b32 s5, s5, 7
  s_add_u32 s4, s4, s5
  v_lshl_add_u32 v24, v24, 11, v25
  v_add_u32 v24, s4, v24
  v_add_u32 v25, 0, v24
  v_accvgpr_write_b32 a212, v25
  v_add_u32 v25, 15360, v24
  v_accvgpr_write_b32 a213, v25
  v_add_u32 v25, 30720, v24
  v_accvgpr_write_b32 a214, v25
  v_add_u32 v25, 46080, v24
  v_accvgpr_write_b32 a215, v25
  v_accvgpr_write_b32 a236, 0
  v_mov_b32 v27, 0x3f803f80
  v_accvgpr_write_b32 a208, v27
  v_accvgpr_write_b32 a237, 0
  v_accvgpr_write_b32 a209, v27
  v_accvgpr_write_b32 a238, 0
  v_accvgpr_write_b32 a210, v27
  v_accvgpr_write_b32 a239, 0
  v_accvgpr_write_b32 a211, v27
  v_lshrrev_b32 v24, 3, v1
  v_and_b32 v25, 6, v24
  v_and_b32 v26, 7, v1
  v_xor_b32 v25, v25, v26
  v_lshlrev_b32 v25, 4, v25
  v_lshlrev_b32 v26, 2, v24
  v_add_u32 v26, s3, v26
  v_lshl_add_u32 v26, v26, 11, v25
  v_add_u32 v27, 0, v26
  v_accvgpr_write_b32 a222, v27
  v_add_u32 v27, 64512, v26
  v_accvgpr_write_b32 a223, v27
  v_add_u32 v27, 129024, v26
  v_accvgpr_write_b32 a224, v27
  v_add_u32 v27, 193536, v26
  v_accvgpr_write_b32 a225, v27
  v_lshrrev_b32 v26, 2, v24
  v_and_b32 v27, 3, v24
  v_lshl_add_u32 v26, v26, 3, v27
  s_and_b32 s4, s3, 1
  s_lshl_b32 s4, s4, 18
  s_lshr_b32 s5, s3, 1
  s_lshl_b32 s5, s5, 7
  s_add_u32 s4, s4, s5
  s_lshl_b32 s5, s24, 8
  s_add_u32 s4, s4, s5
  v_lshl_add_u32 v26, v26, 13, v25
  v_add_u32 v26, s4, v26
  v_add_u32 v27, 0, v26
  v_accvgpr_write_b32 a226, v27
  v_add_u32 v27, 130048, v26
  v_accvgpr_write_b32 a227, v27
  v_add_u32 v27, 30720, v26
  v_accvgpr_write_b32 a228, v27
  v_add_u32 v27, 160768, v26
  v_accvgpr_write_b32 a229, v27
  s_lshl_b32 s4, s3, 13
  s_add_u32 s4, s4, 98304
  v_and_b32 v24, 15, v1
  v_lshlrev_b32 v24, 7, v24
  v_lshrrev_b32 v25, 4, v1
  v_and_b32 v26, 6, v1
  v_xor_b32 v25, v25, v26
  v_lshl_add_u32 v24, v25, 4, v24
  v_add_u32 v28, s4, v24
  v_xor_b32 v29, 64, v28
  v_lshrrev_b32 v24, 2, v1
  v_and_b32 v25, 6, v24
  v_lshlrev_b32 v24, 7, v24
  v_and_b32 v26, 1, v1
  v_lshl_add_u32 v24, v26, 3, v24
  v_add_u32 v24, 0, v24
  v_bfe_u32 v26, v1, 1, 1
  v_xor_b32 v25, v25, v26
  v_xor_b32 v26, 0, v25
  v_lshl_add_u32 v30, v26, 4, v24
  v_xor_b32 v26, 2, v25
  v_lshl_add_u32 v31, v26, 4, v24
  v_xor_b32 v26, 4, v25
  v_lshl_add_u32 v32, v26, 4, v24
  v_xor_b32 v26, 6, v25
  v_lshl_add_u32 v33, v26, 4, v24
  v_accvgpr_write_b32 a230, v28
  v_accvgpr_write_b32 a231, v29
  v_accvgpr_write_b32 a232, v30
  v_accvgpr_write_b32 a233, v31
  v_accvgpr_write_b32 a234, v32
  v_accvgpr_write_b32 a235, v33
  s_and_b32 s4, s3, 1
  s_lshl_b32 s5, s62, 1
  s_add_u32 s4, s4, s5
  s_lshr_b32 s5, s3, 1
  s_lshl_b32 s6, s61, 1
  s_add_u32 s5, s5, s6
  s_add_u32 s16, s86, 16777216
  s_addc_u32 s17, s87, 0
  s_mov_b32 s18, 33554432
  s_mov_b32 s19, 0x00020000
  s_lshl_b32 s4, s4, 20
  s_lshl_b32 s5, s5, 16
  s_add_u32 s63, s4, s5
  s_mov_b32 s37, 0
  s_mov_b32 s39, 4294901760
  s_mov_b32 s40, 32768
  s_mov_b32 s37, 2
  s_mov_b32 s42, 0
  s_mov_b32 s44, 4294934528
  s_mov_b32 s45, 32768
  s_mov_b32 s43, s44
  s_or_b32 s4, s2, s3
  s_cbranch_scc1 Ltag_2
  s_mov_b32 s4, 196608
  s_mov_b32 s92, s84
  s_mov_b32 s93, s85
  s_mov_b32 s94, 256
  s_mov_b32 s95, 0x00020000
  s_waitcnt vmcnt(16)
  v_add_u32 v22, 1, v22
  v_or_b32 v23, 0x80000000, v23
  buffer_store_dwordx2 v[22:23], off, s[96:99], s4 sc1
  buffer_store_dwordx2 v[22:23], off, s[92:95], 0 sc1
Ltag_2:
  s_waitcnt vmcnt(0)
  s_barrier
  ds_read_b128 a[0:3], v16 offset:0
  ds_read_b64_tr_b16 a[64:65], v18 offset:0
  ds_read_b64_tr_b16 a[66:67], v18 offset:2048
  ds_read_b128 a[4:7], v16 offset:2048
  ds_read_b128 a[8:11], v16 offset:4096
  ds_read_b128 a[12:15], v16 offset:6144
  ds_read_b128 a[16:19], v16 offset:8192
  ds_read_b128 a[20:23], v16 offset:10240
  ds_read_b128 a[24:27], v16 offset:12288
  ds_read_b128 a[28:31], v16 offset:14336
  ds_read_b64_tr_b16 a[68:69], v19 offset:0
  ds_read_b64_tr_b16 a[70:71], v19 offset:2048
  ds_read_b64_tr_b16 a[72:73], v20 offset:0
  ds_read_b64_tr_b16 a[74:75], v20 offset:2048
  ds_read_b64_tr_b16 a[76:77], v21 offset:0
  ds_read_b64_tr_b16 a[78:79], v21 offset:2048
  ds_read_b64_tr_b16 a[80:81], v18 offset:8192
  ds_read_b64_tr_b16 a[82:83], v18 offset:10240
  ds_read_b64_tr_b16 a[84:85], v19 offset:8192
  ds_read_b64_tr_b16 a[86:87], v19 offset:10240
  ds_read_b64_tr_b16 a[88:89], v20 offset:8192
  ds_read_b64_tr_b16 a[90:91], v20 offset:10240
  ds_read_b64_tr_b16 a[92:93], v21 offset:8192
  ds_read_b64_tr_b16 a[94:95], v21 offset:10240
  s_waitcnt lgkmcnt(0)
  v_mfma_f32_16x16x32_bf16 v[64:67], a[64:67], a[0:3], 0
  s_add_u32 m0, s36, -65536
  ds_read_b128 a[32:35], v17 offset:0
  v_mfma_f32_16x16x32_bf16 v[96:99], a[64:67], a[4:7], 0
  buffer_load_dwordx4 v48, s[8:11], s46 offen offset:0 lds
  v_mfma_f32_16x16x32_bf16 v[128:131], a[64:67], a[8:11], 0
  buffer_load_dwordx4 v49, s[8:11], s46 offen offset:1024 lds
  ds_read_b64_tr_b16 a[96:97], v18 offset:4096
  v_mfma_f32_16x16x32_bf16 v[160:163], a[64:67], a[12:15], 0
  v_mfma_f32_16x16x32_bf16 v[192:195], a[64:67], a[16:19], 0
  buffer_load_dwordx4 v50, s[8:11], s46 offen offset:2048 lds
  ds_read_b64_tr_b16 a[98:99], v18 offset:6144
  v_mfma_f32_16x16x32_bf16 v[224:227], a[64:67], a[20:23], 0
  v_mfma_f32_16x16x32_bf16 a[128:131], a[64:67], a[24:27], 0
  ds_read_b128 a[36:39], v17 offset:2048
  v_mfma_f32_16x16x32_bf16 a[160:163], a[64:67], a[28:31], 0
  buffer_load_dwordx4 v51, s[8:11], s46 offen offset:3072 lds
  v_mfma_f32_16x16x32_bf16 v[68:71], a[68:71], a[0:3], 0
  s_add_u32 m0, s36, -61440
  v_mfma_f32_16x16x32_bf16 v[100:103], a[68:71], a[4:7], 0
  buffer_load_dwordx4 v52, s[8:11], s46 offen offset:0 lds
  ds_read_b128 a[40:43], v17 offset:4096
  v_mfma_f32_16x16x32_bf16 v[132:135], a[68:71], a[8:11], 0
  v_mfma_f32_16x16x32_bf16 v[164:167], a[68:71], a[12:15], 0
  buffer_load_dwordx4 v53, s[8:11], s46 offen offset:1024 lds
  ds_read_b128 a[44:47], v17 offset:6144
  v_mfma_f32_16x16x32_bf16 v[196:199], a[68:71], a[16:19], 0
  v_mfma_f32_16x16x32_bf16 v[228:231], a[68:71], a[20:23], 0
  ds_read_b128 a[48:51], v17 offset:8192
  v_mfma_f32_16x16x32_bf16 a[132:135], a[68:71], a[24:27], 0
  buffer_load_dwordx4 v54, s[8:11], s46 offen offset:2048 lds
  v_mfma_f32_16x16x32_bf16 a[164:167], a[68:71], a[28:31], 0
  ds_read_b128 a[52:55], v17 offset:10240
  v_mfma_f32_16x16x32_bf16 v[72:75], a[72:75], a[0:3], 0
  buffer_load_dwordx4 v55, s[8:11], s46 offen offset:3072 lds
  v_mfma_f32_16x16x32_bf16 v[104:107], a[72:75], a[4:7], 0
  s_sub_u32 s50, s50, 1
  s_cmp_eq_u32 s50, 0
  s_cselect_b32 s12, s72, s12
  s_cselect_b32 s13, s73, s13
  v_mfma_f32_16x16x32_bf16 v[136:139], a[72:75], a[8:11], 0
  s_lshl_b32 s47, s48, 19
  s_bfe_u32 s34, 0x3020106, s49
  s_add_u32 s48, s48, s34
  v_mfma_f32_16x16x32_bf16 v[168:171], a[72:75], a[12:15], 0
  s_add_u32 s49, s49, 8
  s_and_b32 s49, s49, 0x8001f
  s_and_b32 s48, s48, 7
  v_mfma_f32_16x16x32_bf16 v[200:203], a[72:75], a[16:19], 0
  s_lshl_b32 s46, s48, 7
  s_add_u32 m0, s41, 32768
  ds_read_b128 a[56:59], v17 offset:12288
  v_mfma_f32_16x16x32_bf16 v[232:235], a[72:75], a[20:23], 0
  buffer_load_dwordx4 v56, s[12:15], s47 offen offset:0 lds
  ds_read_b128 a[60:63], v17 offset:14336
  v_mfma_f32_16x16x32_bf16 a[136:139], a[72:75], a[24:27], 0
  buffer_load_dwordx4 v57, s[12:15], s47 offen offset:1024 lds
  ds_read_b64_tr_b16 a[100:101], v19 offset:4096
  v_mfma_f32_16x16x32_bf16 a[168:171], a[72:75], a[28:31], 0
  buffer_load_dwordx4 v58, s[12:15], s47 offen offset:2048 lds
  v_mfma_f32_16x16x32_bf16 v[76:79], a[76:79], a[0:3], 0
  ds_read_b64_tr_b16 a[102:103], v19 offset:6144
  v_mfma_f32_16x16x32_bf16 v[108:111], a[76:79], a[4:7], 0
  v_mfma_f32_16x16x32_bf16 v[140:143], a[76:79], a[8:11], 0
  buffer_load_dwordx4 v59, s[12:15], s47 offen offset:3072 lds
  v_mfma_f32_16x16x32_bf16 v[172:175], a[76:79], a[12:15], 0
  s_add_u32 m0, s41, 36864
  ds_read_b64_tr_b16 a[104:105], v20 offset:4096
  v_mfma_f32_16x16x32_bf16 v[204:207], a[76:79], a[16:19], 0
  buffer_load_dwordx4 v60, s[12:15], s47 offen offset:0 lds
  v_mfma_f32_16x16x32_bf16 v[236:239], a[76:79], a[20:23], 0
  ds_read_b64_tr_b16 a[106:107], v20 offset:6144
  v_mfma_f32_16x16x32_bf16 a[140:143], a[76:79], a[24:27], 0
  buffer_load_dwordx4 v61, s[12:15], s47 offen offset:1024 lds
  v_mfma_f32_16x16x32_bf16 a[172:175], a[76:79], a[28:31], 0
  ds_read_b64_tr_b16 a[108:109], v21 offset:4096
  v_mfma_f32_16x16x32_bf16 v[80:83], a[80:83], a[0:3], 0
  v_mfma_f32_16x16x32_bf16 v[112:115], a[80:83], a[4:7], 0
  buffer_load_dwordx4 v62, s[12:15], s47 offen offset:2048 lds
  ds_read_b64_tr_b16 a[110:111], v21 offset:6144
  v_mfma_f32_16x16x32_bf16 v[144:147], a[80:83], a[8:11], 0
  v_mfma_f32_16x16x32_bf16 v[176:179], a[80:83], a[12:15], 0
  buffer_load_dwordx4 v63, s[12:15], s47 offen offset:3072 lds
  v_mfma_f32_16x16x32_bf16 v[208:211], a[80:83], a[16:19], 0
  s_add_u32 m0, s36, -32768
  ds_read_b64_tr_b16 a[112:113], v18 offset:12288
  v_mfma_f32_16x16x32_bf16 v[240:243], a[80:83], a[20:23], 0
  v_mfma_f32_16x16x32_bf16 a[144:147], a[80:83], a[24:27], 0
  buffer_load_dwordx4 v48, s[8:11], s46 offen offset:0 lds
  ds_read_b64_tr_b16 a[114:115], v18 offset:14336
  v_mfma_f32_16x16x32_bf16 a[176:179], a[80:83], a[28:31], 0
  v_mfma_f32_16x16x32_bf16 v[84:87], a[84:87], a[0:3], 0
  buffer_load_dwordx4 v49, s[8:11], s46 offen offset:1024 lds
  ds_read_b64_tr_b16 a[116:117], v19 offset:12288
  v_mfma_f32_16x16x32_bf16 v[116:119], a[84:87], a[4:7], 0
  v_mfma_f32_16x16x32_bf16 v[148:151], a[84:87], a[8:11], 0
  buffer_load_dwordx4 v50, s[8:11], s46 offen offset:2048 lds
  ds_read_b64_tr_b16 a[118:119], v19 offset:14336
  v_mfma_f32_16x16x32_bf16 v[180:183], a[84:87], a[12:15], 0
  v_mfma_f32_16x16x32_bf16 v[212:215], a[84:87], a[16:19], 0
  v_mfma_f32_16x16x32_bf16 v[244:247], a[84:87], a[20:23], 0
  buffer_load_dwordx4 v51, s[8:11], s46 offen offset:3072 lds
  ds_read_b64_tr_b16 a[120:121], v20 offset:12288
  v_mfma_f32_16x16x32_bf16 a[148:151], a[84:87], a[24:27], 0
  s_add_u32 m0, s36, -28672
  v_mfma_f32_16x16x32_bf16 a[180:183], a[84:87], a[28:31], 0
  buffer_load_dwordx4 v52, s[8:11], s46 offen offset:0 lds
  ds_read_b64_tr_b16 a[122:123], v20 offset:14336
  v_mfma_f32_16x16x32_bf16 v[88:91], a[88:91], a[0:3], 0
  v_mfma_f32_16x16x32_bf16 v[120:123], a[88:91], a[4:7], 0
  buffer_load_dwordx4 v53, s[8:11], s46 offen offset:1024 lds
  ds_read_b64_tr_b16 a[124:125], v21 offset:12288
  v_mfma_f32_16x16x32_bf16 v[152:155], a[88:91], a[8:11], 0
  v_mfma_f32_16x16x32_bf16 v[184:187], a[88:91], a[12:15], 0
  ds_read_b64_tr_b16 a[126:127], v21 offset:14336
  v_mfma_f32_16x16x32_bf16 v[216:219], a[88:91], a[16:19], 0
  buffer_load_dwordx4 v54, s[8:11], s46 offen offset:2048 lds
  v_mfma_f32_16x16x32_bf16 v[248:251], a[88:91], a[20:23], 0
  v_mfma_f32_16x16x32_bf16 a[152:155], a[88:91], a[24:27], 0
  buffer_load_dwordx4 v55, s[8:11], s46 offen offset:3072 lds
  v_mfma_f32_16x16x32_bf16 a[184:187], a[88:91], a[28:31], 0
  s_sub_u32 s50, s50, 1
  s_cmp_eq_u32 s50, 0
  s_cselect_b32 s12, s72, s12
  s_cselect_b32 s13, s73, s13
  v_mfma_f32_16x16x32_bf16 v[92:95], a[92:95], a[0:3], 0
  s_lshl_b32 s47, s48, 19
  s_bfe_u32 s34, 0x3020106, s49
  s_add_u32 s48, s48, s34
  v_mfma_f32_16x16x32_bf16 v[124:127], a[92:95], a[4:7], 0
  s_add_u32 s49, s49, 8
  s_and_b32 s49, s49, 0x8001f
  s_and_b32 s48, s48, 7
  v_mfma_f32_16x16x32_bf16 v[156:159], a[92:95], a[8:11], 0
  s_lshl_b32 s46, s48, 7
  v_mfma_f32_16x16x32_bf16 v[188:191], a[92:95], a[12:15], 0
  s_add_u32 s37, s37, 1
  s_cmp_eq_u32 s37, 3
  s_cselect_b32 s37, 0, s37
  s_cselect_b32 s38, s39, s40
  v_mfma_f32_16x16x32_bf16 v[220:223], a[92:95], a[16:19], 0
  s_sub_u32 s43, 0, s43
  v_mfma_f32_16x16x32_bf16 v[252:255], a[92:95], a[20:23], 0
  v_add_u32 v16, s38, v16
  v_add_u32 v17, s38, v17
  v_mfma_f32_16x16x32_bf16 a[156:159], a[92:95], a[24:27], 0
  v_add_u32 v18, s43, v18
  v_add_u32 v19, s43, v19
  v_mfma_f32_16x16x32_bf16 a[188:191], a[92:95], a[28:31], 0
  v_add_u32 v20, s43, v20
  v_add_u32 v21, s43, v21
  s_mov_b32 s35, 6
  s_waitcnt vmcnt(8) lgkmcnt(0)
  s_barrier
  .p2align 6
Lp1wx_loop:
  v_mfma_f32_16x16x32_bf16 v[64:67], a[96:99], a[32:35], v[64:67]
  s_mov_b32 m0, s41
  ds_read_b128 a[0:3], v16 offset:0
  v_mfma_f32_16x16x32_bf16 v[96:99], a[96:99], a[36:39], v[96:99]
  buffer_load_dwordx4 v56, s[12:15], s47 offen offset:0 lds
  v_mfma_f32_16x16x32_bf16 v[128:131], a[96:99], a[40:43], v[128:131]
  ds_read_b64_tr_b16 a[64:65], v18 offset:0
  v_mfma_f32_16x16x32_bf16 v[160:163], a[96:99], a[44:47], v[160:163]
  v_mfma_f32_16x16x32_bf16 v[192:195], a[96:99], a[48:51], v[192:195]
  ds_read_b64_tr_b16 a[66:67], v18 offset:2048
  v_mfma_f32_16x16x32_bf16 v[224:227], a[96:99], a[52:55], v[224:227]
  v_mfma_f32_16x16x32_bf16 a[128:131], a[96:99], a[56:59], a[128:131]
  ds_read_b128 a[4:7], v16 offset:2048
  v_mfma_f32_16x16x32_bf16 a[160:163], a[96:99], a[60:63], a[160:163]
  buffer_load_dwordx4 v57, s[12:15], s47 offen offset:1024 lds
  v_mfma_f32_16x16x32_bf16 v[68:71], a[100:103], a[32:35], v[68:71]
  v_mfma_f32_16x16x32_bf16 v[100:103], a[100:103], a[36:39], v[100:103]
  ds_read_b128 a[8:11], v16 offset:4096
  v_mfma_f32_16x16x32_bf16 v[132:135], a[100:103], a[40:43], v[132:135]
  v_mfma_f32_16x16x32_bf16 v[164:167], a[100:103], a[44:47], v[164:167]
  ds_read_b128 a[12:15], v16 offset:6144
  v_mfma_f32_16x16x32_bf16 v[196:199], a[100:103], a[48:51], v[196:199]
  v_mfma_f32_16x16x32_bf16 v[228:231], a[100:103], a[52:55], v[228:231]
  ds_read_b128 a[16:19], v16 offset:8192
  v_mfma_f32_16x16x32_bf16 a[132:135], a[100:103], a[56:59], a[132:135]
  v_mfma_f32_16x16x32_bf16 a[164:167], a[100:103], a[60:63], a[164:167]
  buffer_load_dwordx4 v58, s[12:15], s47 offen offset:2048 lds
  ds_read_b128 a[20:23], v16 offset:10240
  v_mfma_f32_16x16x32_bf16 v[72:75], a[104:107], a[32:35], v[72:75]
  v_mfma_f32_16x16x32_bf16 v[104:107], a[104:107], a[36:39], v[104:107]
  v_mfma_f32_16x16x32_bf16 v[136:139], a[104:107], a[40:43], v[136:139]
  ds_read_b128 a[24:27], v16 offset:12288
  v_mfma_f32_16x16x32_bf16 v[168:171], a[104:107], a[44:47], v[168:171]
  v_mfma_f32_16x16x32_bf16 v[200:203], a[104:107], a[48:51], v[200:203]
  ds_read_b128 a[28:31], v16 offset:14336
  v_mfma_f32_16x16x32_bf16 v[232:235], a[104:107], a[52:55], v[232:235]
  v_mfma_f32_16x16x32_bf16 a[136:139], a[104:107], a[56:59], a[136:139]
  ds_read_b64_tr_b16 a[68:69], v19 offset:0
  v_mfma_f32_16x16x32_bf16 a[168:171], a[104:107], a[60:63], a[168:171]
  buffer_load_dwordx4 v59, s[12:15], s47 offen offset:3072 lds
  v_mfma_f32_16x16x32_bf16 v[76:79], a[108:111], a[32:35], v[76:79]
  s_add_u32 m0, s41, 4096
  ds_read_b64_tr_b16 a[70:71], v19 offset:2048
  v_mfma_f32_16x16x32_bf16 v[108:111], a[108:111], a[36:39], v[108:111]
  v_mfma_f32_16x16x32_bf16 v[140:143], a[108:111], a[40:43], v[140:143]
  v_mfma_f32_16x16x32_bf16 v[172:175], a[108:111], a[44:47], v[172:175]
  ds_read_b64_tr_b16 a[72:73], v20 offset:0
  v_mfma_f32_16x16x32_bf16 v[204:207], a[108:111], a[48:51], v[204:207]
  v_mfma_f32_16x16x32_bf16 v[236:239], a[108:111], a[52:55], v[236:239]
  ds_read_b64_tr_b16 a[74:75], v20 offset:2048
  v_mfma_f32_16x16x32_bf16 a[140:143], a[108:111], a[56:59], a[140:143]
  v_mfma_f32_16x16x32_bf16 a[172:175], a[108:111], a[60:63], a[172:175]
  buffer_load_dwordx4 v60, s[12:15], s47 offen offset:0 lds
  ds_read_b64_tr_b16 a[76:77], v21 offset:0
  v_mfma_f32_16x16x32_bf16 v[80:83], a[112:115], a[32:35], v[80:83]
  v_mfma_f32_16x16x32_bf16 v[112:115], a[112:115], a[36:39], v[112:115]
  ds_read_b64_tr_b16 a[78:79], v21 offset:2048
  v_mfma_f32_16x16x32_bf16 v[144:147], a[112:115], a[40:43], v[144:147]
  v_mfma_f32_16x16x32_bf16 v[176:179], a[112:115], a[44:47], v[176:179]
  v_mfma_f32_16x16x32_bf16 v[208:211], a[112:115], a[48:51], v[208:211]
  ds_read_b64_tr_b16 a[80:81], v18 offset:8192
  v_mfma_f32_16x16x32_bf16 v[240:243], a[112:115], a[52:55], v[240:243]
  v_mfma_f32_16x16x32_bf16 a[144:147], a[112:115], a[56:59], a[144:147]
  ds_read_b64_tr_b16 a[82:83], v18 offset:10240
  v_mfma_f32_16x16x32_bf16 a[176:179], a[112:115], a[60:63], a[176:179]
  buffer_load_dwordx4 v61, s[12:15], s47 offen offset:1024 lds
  v_mfma_f32_16x16x32_bf16 v[84:87], a[116:119], a[32:35], v[84:87]
  ds_read_b64_tr_b16 a[84:85], v19 offset:8192
  v_mfma_f32_16x16x32_bf16 v[116:119], a[116:119], a[36:39], v[116:119]
  v_mfma_f32_16x16x32_bf16 v[148:151], a[116:119], a[40:43], v[148:151]
  ds_read_b64_tr_b16 a[86:87], v19 offset:10240
  v_mfma_f32_16x16x32_bf16 v[180:183], a[116:119], a[44:47], v[180:183]
  v_mfma_f32_16x16x32_bf16 v[212:215], a[116:119], a[48:51], v[212:215]
  v_mfma_f32_16x16x32_bf16 v[244:247], a[116:119], a[52:55], v[244:247]
  ds_read_b64_tr_b16 a[88:89], v20 offset:8192
  v_mfma_f32_16x16x32_bf16 a[148:151], a[116:119], a[56:59], a[148:151]
  v_mfma_f32_16x16x32_bf16 a[180:183], a[116:119], a[60:63], a[180:183]
  buffer_load_dwordx4 v62, s[12:15], s47 offen offset:2048 lds
  ds_read_b64_tr_b16 a[90:91], v20 offset:10240
  v_mfma_f32_16x16x32_bf16 v[88:91], a[120:123], a[32:35], v[88:91]
  v_mfma_f32_16x16x32_bf16 v[120:123], a[120:123], a[36:39], v[120:123]
  ds_read_b64_tr_b16 a[92:93], v21 offset:8192
  v_mfma_f32_16x16x32_bf16 v[152:155], a[120:123], a[40:43], v[152:155]
  v_mfma_f32_16x16x32_bf16 v[184:187], a[120:123], a[44:47], v[184:187]
  ds_read_b64_tr_b16 a[94:95], v21 offset:10240
  v_mfma_f32_16x16x32_bf16 v[216:219], a[120:123], a[48:51], v[216:219]
  v_mfma_f32_16x16x32_bf16 v[248:251], a[120:123], a[52:55], v[248:251]
  v_mfma_f32_16x16x32_bf16 a[152:155], a[120:123], a[56:59], a[152:155]
  v_mfma_f32_16x16x32_bf16 a[184:187], a[120:123], a[60:63], a[184:187]
  buffer_load_dwordx4 v63, s[12:15], s47 offen offset:3072 lds
  v_mfma_f32_16x16x32_bf16 v[92:95], a[124:127], a[32:35], v[92:95]
  v_mfma_f32_16x16x32_bf16 v[124:127], a[124:127], a[36:39], v[124:127]
  v_mfma_f32_16x16x32_bf16 v[156:159], a[124:127], a[40:43], v[156:159]
  v_mfma_f32_16x16x32_bf16 v[188:191], a[124:127], a[44:47], v[188:191]
  v_mfma_f32_16x16x32_bf16 v[220:223], a[124:127], a[48:51], v[220:223]
  v_mfma_f32_16x16x32_bf16 v[252:255], a[124:127], a[52:55], v[252:255]
  v_mfma_f32_16x16x32_bf16 a[156:159], a[124:127], a[56:59], a[156:159]
  v_mfma_f32_16x16x32_bf16 a[188:191], a[124:127], a[60:63], a[188:191]
  s_waitcnt lgkmcnt(0)
  v_mfma_f32_16x16x32_bf16 v[64:67], a[64:67], a[0:3], v[64:67]
  s_mov_b32 m0, s36
  ds_read_b128 a[32:35], v17 offset:0
  v_mfma_f32_16x16x32_bf16 v[96:99], a[64:67], a[4:7], v[96:99]
  buffer_load_dwordx4 v48, s[8:11], s46 offen offset:0 lds
  v_mfma_f32_16x16x32_bf16 v[128:131], a[64:67], a[8:11], v[128:131]
  ds_read_b64_tr_b16 a[96:97], v18 offset:4096
  v_mfma_f32_16x16x32_bf16 v[160:163], a[64:67], a[12:15], v[160:163]
  v_mfma_f32_16x16x32_bf16 v[192:195], a[64:67], a[16:19], v[192:195]
  ds_read_b64_tr_b16 a[98:99], v18 offset:6144
  v_mfma_f32_16x16x32_bf16 v[224:227], a[64:67], a[20:23], v[224:227]
  v_mfma_f32_16x16x32_bf16 a[128:131], a[64:67], a[24:27], a[128:131]
  ds_read_b128 a[36:39], v17 offset:2048
  v_mfma_f32_16x16x32_bf16 a[160:163], a[64:67], a[28:31], a[160:163]
  buffer_load_dwordx4 v49, s[8:11], s46 offen offset:1024 lds
  v_mfma_f32_16x16x32_bf16 v[68:71], a[68:71], a[0:3], v[68:71]
  v_mfma_f32_16x16x32_bf16 v[100:103], a[68:71], a[4:7], v[100:103]
  ds_read_b128 a[40:43], v17 offset:4096
  v_mfma_f32_16x16x32_bf16 v[132:135], a[68:71], a[8:11], v[132:135]
  v_mfma_f32_16x16x32_bf16 v[164:167], a[68:71], a[12:15], v[164:167]
  ds_read_b128 a[44:47], v17 offset:6144
  v_mfma_f32_16x16x32_bf16 v[196:199], a[68:71], a[16:19], v[196:199]
  v_mfma_f32_16x16x32_bf16 v[228:231], a[68:71], a[20:23], v[228:231]
  ds_read_b128 a[48:51], v17 offset:8192
  v_mfma_f32_16x16x32_bf16 a[132:135], a[68:71], a[24:27], a[132:135]
  buffer_load_dwordx4 v50, s[8:11], s46 offen offset:2048 lds
  v_mfma_f32_16x16x32_bf16 a[164:167], a[68:71], a[28:31], a[164:167]
  ds_read_b128 a[52:55], v17 offset:10240
  v_mfma_f32_16x16x32_bf16 v[72:75], a[72:75], a[0:3], v[72:75]
  v_mfma_f32_16x16x32_bf16 v[104:107], a[72:75], a[4:7], v[104:107]
  v_mfma_f32_16x16x32_bf16 v[136:139], a[72:75], a[8:11], v[136:139]
  ds_read_b128 a[56:59], v17 offset:12288
  v_mfma_f32_16x16x32_bf16 v[168:171], a[72:75], a[12:15], v[168:171]
  v_mfma_f32_16x16x32_bf16 v[200:203], a[72:75], a[16:19], v[200:203]
  ds_read_b128 a[60:63], v17 offset:14336
  v_mfma_f32_16x16x32_bf16 v[232:235], a[72:75], a[20:23], v[232:235]
  buffer_load_dwordx4 v51, s[8:11], s46 offen offset:3072 lds
  v_mfma_f32_16x16x32_bf16 a[136:139], a[72:75], a[24:27], a[136:139]
  s_add_u32 m0, s36, 4096
  ds_read_b64_tr_b16 a[100:101], v19 offset:4096
  v_mfma_f32_16x16x32_bf16 a[168:171], a[72:75], a[28:31], a[168:171]
  v_mfma_f32_16x16x32_bf16 v[76:79], a[76:79], a[0:3], v[76:79]
  ds_read_b64_tr_b16 a[102:103], v19 offset:6144
  v_mfma_f32_16x16x32_bf16 v[108:111], a[76:79], a[4:7], v[108:111]
  v_mfma_f32_16x16x32_bf16 v[140:143], a[76:79], a[8:11], v[140:143]
  v_mfma_f32_16x16x32_bf16 v[172:175], a[76:79], a[12:15], v[172:175]
  ds_read_b64_tr_b16 a[104:105], v20 offset:4096
  v_mfma_f32_16x16x32_bf16 v[204:207], a[76:79], a[16:19], v[204:207]
  buffer_load_dwordx4 v52, s[8:11], s46 offen offset:0 lds
  v_mfma_f32_16x16x32_bf16 v[236:239], a[76:79], a[20:23], v[236:239]
  ds_read_b64_tr_b16 a[106:107], v20 offset:6144
  v_mfma_f32_16x16x32_bf16 a[140:143], a[76:79], a[24:27], a[140:143]
  v_mfma_f32_16x16x32_bf16 a[172:175], a[76:79], a[28:31], a[172:175]
  ds_read_b64_tr_b16 a[108:109], v21 offset:4096
  v_mfma_f32_16x16x32_bf16 v[80:83], a[80:83], a[0:3], v[80:83]
  v_mfma_f32_16x16x32_bf16 v[112:115], a[80:83], a[4:7], v[112:115]
  ds_read_b64_tr_b16 a[110:111], v21 offset:6144
  v_mfma_f32_16x16x32_bf16 v[144:147], a[80:83], a[8:11], v[144:147]
  v_mfma_f32_16x16x32_bf16 v[176:179], a[80:83], a[12:15], v[176:179]
  buffer_load_dwordx4 v53, s[8:11], s46 offen offset:1024 lds
  v_mfma_f32_16x16x32_bf16 v[208:211], a[80:83], a[16:19], v[208:211]
  ds_read_b64_tr_b16 a[112:113], v18 offset:12288
  v_mfma_f32_16x16x32_bf16 v[240:243], a[80:83], a[20:23], v[240:243]
  v_mfma_f32_16x16x32_bf16 a[144:147], a[80:83], a[24:27], a[144:147]
  ds_read_b64_tr_b16 a[114:115], v18 offset:14336
  v_mfma_f32_16x16x32_bf16 a[176:179], a[80:83], a[28:31], a[176:179]
  v_mfma_f32_16x16x32_bf16 v[84:87], a[84:87], a[0:3], v[84:87]
  ds_read_b64_tr_b16 a[116:117], v19 offset:12288
  v_mfma_f32_16x16x32_bf16 v[116:119], a[84:87], a[4:7], v[116:119]
  v_mfma_f32_16x16x32_bf16 v[148:151], a[84:87], a[8:11], v[148:151]
  buffer_load_dwordx4 v54, s[8:11], s46 offen offset:2048 lds
  ds_read_b64_tr_b16 a[118:119], v19 offset:14336
  v_mfma_f32_16x16x32_bf16 v[180:183], a[84:87], a[12:15], v[180:183]
  v_mfma_f32_16x16x32_bf16 v[212:215], a[84:87], a[16:19], v[212:215]
  v_mfma_f32_16x16x32_bf16 v[244:247], a[84:87], a[20:23], v[244:247]
  ds_read_b64_tr_b16 a[120:121], v20 offset:12288
  v_mfma_f32_16x16x32_bf16 a[148:151], a[84:87], a[24:27], a[148:151]
  v_mfma_f32_16x16x32_bf16 a[180:183], a[84:87], a[28:31], a[180:183]
  ds_read_b64_tr_b16 a[122:123], v20 offset:14336
  v_mfma_f32_16x16x32_bf16 v[88:91], a[88:91], a[0:3], v[88:91]
  v_mfma_f32_16x16x32_bf16 v[120:123], a[88:91], a[4:7], v[120:123]
  buffer_load_dwordx4 v55, s[8:11], s46 offen offset:3072 lds
  ds_read_b64_tr_b16 a[124:125], v21 offset:12288
  v_mfma_f32_16x16x32_bf16 v[152:155], a[88:91], a[8:11], v[152:155]
  s_sub_u32 s50, s50, 1
  s_cmp_eq_u32 s50, 0
  s_cselect_b32 s12, s72, s12
  s_cselect_b32 s13, s73, s13
  v_mfma_f32_16x16x32_bf16 v[184:187], a[88:91], a[12:15], v[184:187]
  s_lshl_b32 s47, s48, 19
  s_bfe_u32 s34, 0x3020106, s49
  s_add_u32 s48, s48, s34
  v_mfma_f32_16x16x32_bf16 v[216:219], a[88:91], a[16:19], v[216:219]
  s_add_u32 s49, s49, 8
  s_and_b32 s49, s49, 0x8001f
  s_and_b32 s48, s48, 7
  v_mfma_f32_16x16x32_bf16 v[248:251], a[88:91], a[20:23], v[248:251]
  s_lshl_b32 s46, s48, 7
  ds_read_b64_tr_b16 a[126:127], v21 offset:14336
  v_mfma_f32_16x16x32_bf16 a[152:155], a[88:91], a[24:27], a[152:155]
  s_add_u32 s36, s36, s38
  s_add_u32 s37, s37, 1
  s_cmp_eq_u32 s37, 3
  s_cselect_b32 s37, 0, s37
  s_cselect_b32 s38, s39, s40
  v_mfma_f32_16x16x32_bf16 a[184:187], a[88:91], a[28:31], a[184:187]
  s_add_u32 s41, s41, s43
  s_sub_u32 s43, 0, s43
  v_mfma_f32_16x16x32_bf16 v[92:95], a[92:95], a[0:3], v[92:95]
  v_add_u32 v16, s38, v16
  v_add_u32 v17, s38, v17
  v_mfma_f32_16x16x32_bf16 v[124:127], a[92:95], a[4:7], v[124:127]
  v_add_u32 v18, s43, v18
  v_add_u32 v19, s43, v19
  v_mfma_f32_16x16x32_bf16 v[156:159], a[92:95], a[8:11], v[156:159]
  v_add_u32 v20, s43, v20
  v_add_u32 v21, s43, v21
  v_mfma_f32_16x16x32_bf16 v[188:191], a[92:95], a[12:15], v[188:191]
  v_mfma_f32_16x16x32_bf16 v[220:223], a[92:95], a[16:19], v[220:223]
  v_mfma_f32_16x16x32_bf16 v[252:255], a[92:95], a[20:23], v[252:255]
  s_waitcnt vmcnt(8) lgkmcnt(0)
  s_barrier
  v_mfma_f32_16x16x32_bf16 a[156:159], a[92:95], a[24:27], a[156:159]
  s_sub_u32 s35, s35, 1
  v_mfma_f32_16x16x32_bf16 a[188:191], a[92:95], a[28:31], a[188:191]
  s_cmp_lg_u32 s35, 0
  s_cbranch_scc1 Lp1wx_loop
  v_mfma_f32_16x16x32_bf16 v[64:67], a[96:99], a[32:35], v[64:67]
  s_mov_b32 m0, s41
  ds_read_b128 a[0:3], v16 offset:0
  v_mfma_f32_16x16x32_bf16 v[96:99], a[96:99], a[36:39], v[96:99]
  buffer_load_dwordx4 v56, s[12:15], s47 offen offset:0 lds
  v_mfma_f32_16x16x32_bf16 v[128:131], a[96:99], a[40:43], v[128:131]
  ds_read_b64_tr_b16 a[64:65], v18 offset:0
  v_mfma_f32_16x16x32_bf16 v[160:163], a[96:99], a[44:47], v[160:163]
  buffer_load_dwordx4 v57, s[12:15], s47 offen offset:1024 lds
  v_mfma_f32_16x16x32_bf16 v[192:195], a[96:99], a[48:51], v[192:195]
  ds_read_b64_tr_b16 a[66:67], v18 offset:2048
  v_mfma_f32_16x16x32_bf16 v[224:227], a[96:99], a[52:55], v[224:227]
  v_mfma_f32_16x16x32_bf16 a[128:131], a[96:99], a[56:59], a[128:131]
  ds_read_b128 a[4:7], v16 offset:2048
  v_mfma_f32_16x16x32_bf16 a[160:163], a[96:99], a[60:63], a[160:163]
  buffer_load_dwordx4 v58, s[12:15], s47 offen offset:2048 lds
  v_mfma_f32_16x16x32_bf16 v[68:71], a[100:103], a[32:35], v[68:71]
  v_mfma_f32_16x16x32_bf16 v[100:103], a[100:103], a[36:39], v[100:103]
  ds_read_b128 a[8:11], v16 offset:4096
  v_mfma_f32_16x16x32_bf16 v[132:135], a[100:103], a[40:43], v[132:135]
  v_mfma_f32_16x16x32_bf16 v[164:167], a[100:103], a[44:47], v[164:167]
  buffer_load_dwordx4 v59, s[12:15], s47 offen offset:3072 lds
  ds_read_b128 a[12:15], v16 offset:6144
  v_mfma_f32_16x16x32_bf16 v[196:199], a[100:103], a[48:51], v[196:199]
  s_add_u32 m0, s41, 4096
  v_mfma_f32_16x16x32_bf16 v[228:231], a[100:103], a[52:55], v[228:231]
  ds_read_b128 a[16:19], v16 offset:8192
  v_mfma_f32_16x16x32_bf16 a[132:135], a[100:103], a[56:59], a[132:135]
  v_mfma_f32_16x16x32_bf16 a[164:167], a[100:103], a[60:63], a[164:167]
  buffer_load_dwordx4 v60, s[12:15], s47 offen offset:0 lds
  ds_read_b128 a[20:23], v16 offset:10240
  v_mfma_f32_16x16x32_bf16 v[72:75], a[104:107], a[32:35], v[72:75]
  v_mfma_f32_16x16x32_bf16 v[104:107], a[104:107], a[36:39], v[104:107]
  v_mfma_f32_16x16x32_bf16 v[136:139], a[104:107], a[40:43], v[136:139]
  ds_read_b128 a[24:27], v16 offset:12288
  v_mfma_f32_16x16x32_bf16 v[168:171], a[104:107], a[44:47], v[168:171]
  buffer_load_dwordx4 v61, s[12:15], s47 offen offset:1024 lds
  v_mfma_f32_16x16x32_bf16 v[200:203], a[104:107], a[48:51], v[200:203]
  ds_read_b128 a[28:31], v16 offset:14336
  v_mfma_f32_16x16x32_bf16 v[232:235], a[104:107], a[52:55], v[232:235]
  v_mfma_f32_16x16x32_bf16 a[136:139], a[104:107], a[56:59], a[136:139]
  ds_read_b64_tr_b16 a[68:69], v19 offset:0
  v_mfma_f32_16x16x32_bf16 a[168:171], a[104:107], a[60:63], a[168:171]
  buffer_load_dwordx4 v62, s[12:15], s47 offen offset:2048 lds
  v_mfma_f32_16x16x32_bf16 v[76:79], a[108:111], a[32:35], v[76:79]
  ds_read_b64_tr_b16 a[70:71], v19 offset:2048
  v_mfma_f32_16x16x32_bf16 v[108:111], a[108:111], a[36:39], v[108:111]
  v_mfma_f32_16x16x32_bf16 v[140:143], a[108:111], a[40:43], v[140:143]
  v_mfma_f32_16x16x32_bf16 v[172:175], a[108:111], a[44:47], v[172:175]
  buffer_load_dwordx4 v63, s[12:15], s47 offen offset:3072 lds
  ds_read_b64_tr_b16 a[72:73], v20 offset:0
  v_mfma_f32_16x16x32_bf16 v[204:207], a[108:111], a[48:51], v[204:207]
  s_mov_b32 m0, s36
  v_mfma_f32_16x16x32_bf16 v[236:239], a[108:111], a[52:55], v[236:239]
  ds_read_b64_tr_b16 a[74:75], v20 offset:2048
  v_mfma_f32_16x16x32_bf16 a[140:143], a[108:111], a[56:59], a[140:143]
  v_mfma_f32_16x16x32_bf16 a[172:175], a[108:111], a[60:63], a[172:175]
  buffer_load_dwordx4 v48, s[8:11], s46 offen offset:0 lds
  ds_read_b64_tr_b16 a[76:77], v21 offset:0
  v_mfma_f32_16x16x32_bf16 v[80:83], a[112:115], a[32:35], v[80:83]
  v_mfma_f32_16x16x32_bf16 v[112:115], a[112:115], a[36:39], v[112:115]
  ds_read_b64_tr_b16 a[78:79], v21 offset:2048
  v_mfma_f32_16x16x32_bf16 v[144:147], a[112:115], a[40:43], v[144:147]
  v_mfma_f32_16x16x32_bf16 v[176:179], a[112:115], a[44:47], v[176:179]
  buffer_load_dwordx4 v49, s[8:11], s46 offen offset:1024 lds
  v_mfma_f32_16x16x32_bf16 v[208:211], a[112:115], a[48:51], v[208:211]
  ds_read_b64_tr_b16 a[80:81], v18 offset:8192
  v_mfma_f32_16x16x32_bf16 v[240:243], a[112:115], a[52:55], v[240:243]
  v_mfma_f32_16x16x32_bf16 a[144:147], a[112:115], a[56:59], a[144:147]
  ds_read_b64_tr_b16 a[82:83], v18 offset:10240
  v_mfma_f32_16x16x32_bf16 a[176:179], a[112:115], a[60:63], a[176:179]
  buffer_load_dwordx4 v50, s[8:11], s46 offen offset:2048 lds
  v_mfma_f32_16x16x32_bf16 v[84:87], a[116:119], a[32:35], v[84:87]
  ds_read_b64_tr_b16 a[84:85], v19 offset:8192
  v_mfma_f32_16x16x32_bf16 v[116:119], a[116:119], a[36:39], v[116:119]
  v_mfma_f32_16x16x32_bf16 v[148:151], a[116:119], a[40:43], v[148:151]
  ds_read_b64_tr_b16 a[86:87], v19 offset:10240
  v_mfma_f32_16x16x32_bf16 v[180:183], a[116:119], a[44:47], v[180:183]
  buffer_load_dwordx4 v51, s[8:11], s46 offen offset:3072 lds
  v_mfma_f32_16x16x32_bf16 v[212:215], a[116:119], a[48:51], v[212:215]
  s_add_u32 m0, s36, 4096
  v_mfma_f32_16x16x32_bf16 v[244:247], a[116:119], a[52:55], v[244:247]
  ds_read_b64_tr_b16 a[88:89], v20 offset:8192
  v_mfma_f32_16x16x32_bf16 a[148:151], a[116:119], a[56:59], a[148:151]
  v_mfma_f32_16x16x32_bf16 a[180:183], a[116:119], a[60:63], a[180:183]
  buffer_load_dwordx4 v52, s[8:11], s46 offen offset:0 lds
  ds_read_b64_tr_b16 a[90:91], v20 offset:10240
  v_mfma_f32_16x16x32_bf16 v[88:91], a[120:123], a[32:35], v[88:91]
  v_mfma_f32_16x16x32_bf16 v[120:123], a[120:123], a[36:39], v[120:123]
  ds_read_b64_tr_b16 a[92:93], v21 offset:8192
  v_mfma_f32_16x16x32_bf16 v[152:155], a[120:123], a[40:43], v[152:155]
  v_mfma_f32_16x16x32_bf16 v[184:187], a[120:123], a[44:47], v[184:187]
  buffer_load_dwordx4 v53, s[8:11], s46 offen offset:1024 lds
  ds_read_b64_tr_b16 a[94:95], v21 offset:10240
  v_mfma_f32_16x16x32_bf16 v[216:219], a[120:123], a[48:51], v[216:219]
  v_mfma_f32_16x16x32_bf16 v[248:251], a[120:123], a[52:55], v[248:251]
  v_mfma_f32_16x16x32_bf16 a[152:155], a[120:123], a[56:59], a[152:155]
  v_mfma_f32_16x16x32_bf16 a[184:187], a[120:123], a[60:63], a[184:187]
  buffer_load_dwordx4 v54, s[8:11], s46 offen offset:2048 lds
  v_mfma_f32_16x16x32_bf16 v[92:95], a[124:127], a[32:35], v[92:95]
  v_mfma_f32_16x16x32_bf16 v[124:127], a[124:127], a[36:39], v[124:127]
  v_mfma_f32_16x16x32_bf16 v[156:159], a[124:127], a[40:43], v[156:159]
  v_mfma_f32_16x16x32_bf16 v[188:191], a[124:127], a[44:47], v[188:191]
  buffer_load_dwordx4 v55, s[8:11], s46 offen offset:3072 lds
  v_mfma_f32_16x16x32_bf16 v[220:223], a[124:127], a[48:51], v[220:223]
  s_sub_u32 s50, s50, 1
  s_cmp_eq_u32 s50, 0
  s_cselect_b32 s12, s72, s12
  s_cselect_b32 s13, s73, s13
  v_mfma_f32_16x16x32_bf16 v[252:255], a[124:127], a[52:55], v[252:255]
  s_lshl_b32 s47, s48, 19
  s_bfe_u32 s34, 0x3020106, s49
  s_add_u32 s48, s48, s34
  v_mfma_f32_16x16x32_bf16 a[156:159], a[124:127], a[56:59], a[156:159]
  s_add_u32 s49, s49, 8
  s_and_b32 s49, s49, 0x8001f
  s_and_b32 s48, s48, 7
  v_mfma_f32_16x16x32_bf16 a[188:191], a[124:127], a[60:63], a[188:191]
  s_lshl_b32 s46, s48, 7
  s_waitcnt lgkmcnt(0)
  v_mfma_f32_16x16x32_bf16 v[128:131], a[64:67], a[8:11], v[128:131]
  ds_read_b128 a[32:35], v17 offset:0
  ds_read_b64_tr_b16 a[96:97], v18 offset:4096
  v_mfma_f32_16x16x32_bf16 v[132:135], a[68:71], a[8:11], v[132:135]
  ds_read_b64_tr_b16 a[98:99], v18 offset:6144
  ds_read_b128 a[36:39], v17 offset:2048
  v_mfma_f32_16x16x32_bf16 a[128:131], a[64:67], a[24:27], a[128:131]
  ds_read_b128 a[40:43], v17 offset:4096
  ds_read_b128 a[44:47], v17 offset:6144
  v_mfma_f32_16x16x32_bf16 a[132:135], a[68:71], a[24:27], a[132:135]
  ds_read_b128 a[48:51], v17 offset:8192
  ds_read_b128 a[52:55], v17 offset:10240
  v_mfma_f32_16x16x32_bf16 v[136:139], a[72:75], a[8:11], v[136:139]
  ds_read_b128 a[56:59], v17 offset:12288
  ds_read_b128 a[60:63], v17 offset:14336
  v_mfma_f32_16x16x32_bf16 v[140:143], a[76:79], a[8:11], v[140:143]
  ds_read_b64_tr_b16 a[100:101], v19 offset:4096
  ds_read_b64_tr_b16 a[102:103], v19 offset:6144
  v_mfma_f32_16x16x32_bf16 a[136:139], a[72:75], a[24:27], a[136:139]
  ds_read_b64_tr_b16 a[104:105], v20 offset:4096
  v_mfma_f32_16x16x32_bf16 a[140:143], a[76:79], a[24:27], a[140:143]
  ds_read_b64_tr_b16 a[106:107], v20 offset:6144
  ds_read_b64_tr_b16 a[108:109], v21 offset:4096
  v_mfma_f32_16x16x32_bf16 v[144:147], a[80:83], a[8:11], v[144:147]
  ds_read_b64_tr_b16 a[110:111], v21 offset:6144
  ds_read_b64_tr_b16 a[112:113], v18 offset:12288
  v_mfma_f32_16x16x32_bf16 v[148:151], a[84:87], a[8:11], v[148:151]
  ds_read_b64_tr_b16 a[114:115], v18 offset:14336
  ds_read_b64_tr_b16 a[116:117], v19 offset:12288
  v_mfma_f32_16x16x32_bf16 a[144:147], a[80:83], a[24:27], a[144:147]
  ds_read_b64_tr_b16 a[118:119], v19 offset:14336
  ds_read_b64_tr_b16 a[120:121], v20 offset:12288
  v_mfma_f32_16x16x32_bf16 a[148:151], a[84:87], a[24:27], a[148:151]
  ds_read_b64_tr_b16 a[122:123], v20 offset:14336
  ds_read_b64_tr_b16 a[124:125], v21 offset:12288
  v_mfma_f32_16x16x32_bf16 v[152:155], a[88:91], a[8:11], v[152:155]
  ds_read_b64_tr_b16 a[126:127], v21 offset:14336
  v_mfma_f32_16x16x32_bf16 v[156:159], a[92:95], a[8:11], v[156:159]
  v_mfma_f32_16x16x32_bf16 a[152:155], a[88:91], a[24:27], a[152:155]
  v_mfma_f32_16x16x32_bf16 a[156:159], a[92:95], a[24:27], a[156:159]
  v_mfma_f32_16x16x32_bf16 v[160:163], a[64:67], a[12:15], v[160:163]
  v_mfma_f32_16x16x32_bf16 v[164:167], a[68:71], a[12:15], v[164:167]
  s_add_u32 s36, s36, s38
  s_add_u32 s37, s37, 1
  s_cmp_eq_u32 s37, 3
  s_cselect_b32 s37, 0, s37
  s_cselect_b32 s38, s39, s40
  v_add_u32 v16, s38, v16
  v_add_u32 v17, s38, v17
  s_add_u32 s41, s41, s43
  s_sub_u32 s43, 0, s43
  v_add_u32 v18, s43, v18
  v_add_u32 v19, s43, v19
  v_add_u32 v20, s43, v20
  v_add_u32 v21, s43, v21
  s_waitcnt vmcnt(8) lgkmcnt(0)
  s_barrier
  v_mfma_f32_16x16x32_bf16 v[128:131], a[96:99], a[40:43], v[128:131]
  s_mov_b32 m0, s41
  v_mfma_f32_16x16x32_bf16 v[132:135], a[100:103], a[40:43], v[132:135]
  buffer_load_dwordx4 v56, s[12:15], s47 offen offset:0 lds
  v_mfma_f32_16x16x32_bf16 a[128:131], a[96:99], a[56:59], a[128:131]
  v_mfma_f32_16x16x32_bf16 a[132:135], a[100:103], a[56:59], a[132:135]
  v_mfma_f32_16x16x32_bf16 v[136:139], a[104:107], a[40:43], v[136:139]
  v_mfma_f32_16x16x32_bf16 v[140:143], a[108:111], a[40:43], v[140:143]
  buffer_load_dwordx4 v57, s[12:15], s47 offen offset:1024 lds
  v_cvt_pk_bf16_f32 v128, v128, v129
  v_mfma_f32_16x16x32_bf16 a[136:139], a[104:107], a[56:59], a[136:139]
  v_cvt_pk_bf16_f32 v129, v130, v131
  v_cvt_pk_bf16_f32 v130, v132, v133
  v_mfma_f32_16x16x32_bf16 a[140:143], a[108:111], a[56:59], a[140:143]
  v_cvt_pk_bf16_f32 v131, v134, v135
  v_accvgpr_read_b32 v24, a128
  v_mfma_f32_16x16x32_bf16 v[144:147], a[112:115], a[40:43], v[144:147]
  v_accvgpr_read_b32 v25, a129
  v_accvgpr_read_b32 v26, a130
  v_mfma_f32_16x16x32_bf16 v[148:151], a[116:119], a[40:43], v[148:151]
  v_accvgpr_read_b32 v27, a131
  v_accvgpr_read_b32 v28, a132
  v_mfma_f32_16x16x32_bf16 a[144:147], a[112:115], a[56:59], a[144:147]
  v_accvgpr_read_b32 v29, a133
  v_accvgpr_read_b32 v30, a134
  v_mfma_f32_16x16x32_bf16 a[148:151], a[116:119], a[56:59], a[148:151]
  buffer_load_dwordx4 v58, s[12:15], s47 offen offset:2048 lds
  v_accvgpr_read_b32 v31, a135
  v_mfma_f32_16x16x32_bf16 v[152:155], a[120:123], a[40:43], v[152:155]
  v_cvt_pk_bf16_f32 v132, v24, v25
  v_cvt_pk_bf16_f32 v133, v26, v27
  v_mfma_f32_16x16x32_bf16 v[156:159], a[124:127], a[40:43], v[156:159]
  v_cvt_pk_bf16_f32 v134, v28, v29
  v_cvt_pk_bf16_f32 v135, v30, v31
  v_mfma_f32_16x16x32_bf16 a[152:155], a[120:123], a[56:59], a[152:155]
  s_add_u32 s60, s63, 8192
  buffer_store_dwordx4 v[128:131], v2, s[16:19], s60 offen offset:0 sc1
  v_cvt_pk_bf16_f32 v136, v136, v137
  v_mfma_f32_16x16x32_bf16 a[156:159], a[124:127], a[56:59], a[156:159]
  v_cvt_pk_bf16_f32 v137, v138, v139
  v_cvt_pk_bf16_f32 v138, v140, v141
  v_mfma_f32_16x16x32_bf16 v[160:163], a[96:99], a[44:47], v[160:163]
  v_cvt_pk_bf16_f32 v139, v142, v143
  v_mfma_f32_16x16x32_bf16 v[164:167], a[100:103], a[44:47], v[164:167]
  buffer_load_dwordx4 v59, s[12:15], s47 offen offset:3072 lds
  v_mfma_f32_16x16x32_bf16 a[160:163], a[64:67], a[28:31], a[160:163]
  s_add_u32 m0, s41, 4096
  v_mfma_f32_16x16x32_bf16 a[164:167], a[68:71], a[28:31], a[164:167]
  s_add_u32 s60, s63, 40960
  buffer_store_dwordx4 v[132:135], v2, s[16:19], s60 offen offset:0 sc1
  v_accvgpr_read_b32 v32, a136
  v_mfma_f32_16x16x32_bf16 a[160:163], a[96:99], a[60:63], a[160:163]
  v_accvgpr_read_b32 v33, a137
  v_accvgpr_read_b32 v34, a138
  v_mfma_f32_16x16x32_bf16 a[164:167], a[100:103], a[60:63], a[164:167]
  v_accvgpr_read_b32 v35, a139
  v_accvgpr_read_b32 v36, a140
  v_mfma_f32_16x16x32_bf16 v[168:171], a[72:75], a[12:15], v[168:171]
  buffer_load_dwordx4 v60, s[12:15], s47 offen offset:0 lds
  v_accvgpr_read_b32 v37, a141
  v_mfma_f32_16x16x32_bf16 v[172:175], a[76:79], a[12:15], v[172:175]
  v_accvgpr_read_b32 v38, a142
  v_accvgpr_read_b32 v39, a143
  v_mfma_f32_16x16x32_bf16 v[168:171], a[104:107], a[44:47], v[168:171]
  v_cvt_pk_bf16_f32 v140, v32, v33
  v_cvt_pk_bf16_f32 v141, v34, v35
  v_mfma_f32_16x16x32_bf16 v[172:175], a[108:111], a[44:47], v[172:175]
  v_cvt_pk_bf16_f32 v142, v36, v37
  v_cvt_pk_bf16_f32 v143, v38, v39
  v_mfma_f32_16x16x32_bf16 a[168:171], a[72:75], a[28:31], a[168:171]
  s_add_u32 s60, s63, 8192
  buffer_store_dwordx4 v[136:139], v2, s[16:19], s60 offen offset:1024 sc1
  v_cvt_pk_bf16_f32 v144, v144, v145
  v_mfma_f32_16x16x32_bf16 a[172:175], a[76:79], a[28:31], a[172:175]
  v_cvt_pk_bf16_f32 v145, v146, v147
  v_cvt_pk_bf16_f32 v146, v148, v149
  v_mfma_f32_16x16x32_bf16 a[168:171], a[104:107], a[60:63], a[168:171]
  buffer_load_dwordx4 v61, s[12:15], s47 offen offset:1024 lds
  v_cvt_pk_bf16_f32 v147, v150, v151
  v_mfma_f32_16x16x32_bf16 a[172:175], a[108:111], a[60:63], a[172:175]
  s_add_u32 s60, s63, 40960
  buffer_store_dwordx4 v[140:143], v2, s[16:19], s60 offen offset:1024 sc1
  v_accvgpr_read_b32 v40, a144
  v_mfma_f32_16x16x32_bf16 v[176:179], a[80:83], a[12:15], v[176:179]
  v_accvgpr_read_b32 v41, a145
  v_accvgpr_read_b32 v42, a146
  v_mfma_f32_16x16x32_bf16 v[180:183], a[84:87], a[12:15], v[180:183]
  v_accvgpr_read_b32 v43, a147
  v_accvgpr_read_b32 v44, a148
  v_mfma_f32_16x16x32_bf16 v[176:179], a[112:115], a[44:47], v[176:179]
  v_accvgpr_read_b32 v45, a149
  v_accvgpr_read_b32 v46, a150
  v_mfma_f32_16x16x32_bf16 v[180:183], a[116:119], a[44:47], v[180:183]
  v_accvgpr_read_b32 v47, a151
  v_cvt_pk_bf16_f32 v148, v40, v41
  v_mfma_f32_16x16x32_bf16 a[176:179], a[80:83], a[28:31], a[176:179]
  buffer_load_dwordx4 v62, s[12:15], s47 offen offset:2048 lds
  v_cvt_pk_bf16_f32 v149, v42, v43
  v_mfma_f32_16x16x32_bf16 a[180:183], a[84:87], a[28:31], a[180:183]
  v_cvt_pk_bf16_f32 v150, v44, v45
  v_cvt_pk_bf16_f32 v151, v46, v47
  v_mfma_f32_16x16x32_bf16 a[176:179], a[112:115], a[60:63], a[176:179]
  s_add_u32 s60, s63, 8192
  buffer_store_dwordx4 v[144:147], v2, s[16:19], s60 offen offset:2048 sc1
  v_cvt_pk_bf16_f32 v152, v152, v153
  v_mfma_f32_16x16x32_bf16 a[180:183], a[116:119], a[60:63], a[180:183]
  v_cvt_pk_bf16_f32 v153, v154, v155
  v_cvt_pk_bf16_f32 v154, v156, v157
  v_mfma_f32_16x16x32_bf16 v[184:187], a[88:91], a[12:15], v[184:187]
  v_cvt_pk_bf16_f32 v155, v158, v159
  v_mfma_f32_16x16x32_bf16 v[188:191], a[92:95], a[12:15], v[188:191]
  buffer_load_dwordx4 v63, s[12:15], s47 offen offset:3072 lds
  v_mfma_f32_16x16x32_bf16 v[184:187], a[120:123], a[44:47], v[184:187]
  s_mov_b32 m0, s36
  v_mfma_f32_16x16x32_bf16 v[188:191], a[124:127], a[44:47], v[188:191]
  s_add_u32 s60, s63, 40960
  buffer_store_dwordx4 v[148:151], v2, s[16:19], s60 offen offset:2048 sc1
  v_accvgpr_read_b32 v24, a152
  v_mfma_f32_16x16x32_bf16 a[184:187], a[88:91], a[28:31], a[184:187]
  v_accvgpr_read_b32 v25, a153
  v_accvgpr_read_b32 v26, a154
  v_mfma_f32_16x16x32_bf16 a[188:191], a[92:95], a[28:31], a[188:191]
  v_accvgpr_read_b32 v27, a155
  v_accvgpr_read_b32 v28, a156
  v_mfma_f32_16x16x32_bf16 a[184:187], a[120:123], a[60:63], a[184:187]
  v_accvgpr_read_b32 v29, a157
  v_accvgpr_read_b32 v30, a158
  v_mfma_f32_16x16x32_bf16 a[188:191], a[124:127], a[60:63], a[188:191]
  buffer_load_dwordx4 v48, s[8:11], s46 offen offset:0 lds
  v_accvgpr_read_b32 v31, a159
  v_mfma_f32_16x16x32_bf16 v[192:195], a[64:67], a[16:19], v[192:195]
  v_cvt_pk_bf16_f32 v156, v24, v25
  v_cvt_pk_bf16_f32 v157, v26, v27
  v_mfma_f32_16x16x32_bf16 v[196:199], a[68:71], a[16:19], v[196:199]
  v_cvt_pk_bf16_f32 v158, v28, v29
  v_cvt_pk_bf16_f32 v159, v30, v31
  v_mfma_f32_16x16x32_bf16 v[192:195], a[96:99], a[48:51], v[192:195]
  v_cvt_pk_bf16_f32 v160, v160, v161
  v_cvt_pk_bf16_f32 v161, v162, v163
  v_mfma_f32_16x16x32_bf16 v[196:199], a[100:103], a[48:51], v[196:199]
  v_cvt_pk_bf16_f32 v162, v164, v165
  v_cvt_pk_bf16_f32 v163, v166, v167
  v_mfma_f32_16x16x32_bf16 v[64:67], a[64:67], a[0:3], v[64:67]
  s_add_u32 s60, s63, 8192
  buffer_store_dwordx4 v[152:155], v2, s[16:19], s60 offen offset:3072 sc1
  v_accvgpr_read_b32 v32, a160
  v_mfma_f32_16x16x32_bf16 v[68:71], a[68:71], a[0:3], v[68:71]
  buffer_load_dwordx4 v49, s[8:11], s46 offen offset:1024 lds
  v_accvgpr_read_b32 v33, a161
  v_mfma_f32_16x16x32_bf16 v[64:67], a[96:99], a[32:35], v[64:67]
  v_accvgpr_read_b32 v34, a162
  v_accvgpr_read_b32 v35, a163
  v_mfma_f32_16x16x32_bf16 v[68:71], a[100:103], a[32:35], v[68:71]
  v_accvgpr_read_b32 v36, a164
  v_accvgpr_read_b32 v37, a165
  v_mfma_f32_16x16x32_bf16 v[200:203], a[72:75], a[16:19], v[200:203]
  v_accvgpr_read_b32 v38, a166
  v_accvgpr_read_b32 v39, a167
  v_mfma_f32_16x16x32_bf16 v[204:207], a[76:79], a[16:19], v[204:207]
  v_cvt_pk_bf16_f32 v164, v32, v33
  v_cvt_pk_bf16_f32 v165, v34, v35
  v_mfma_f32_16x16x32_bf16 v[200:203], a[104:107], a[48:51], v[200:203]
  buffer_load_dwordx4 v50, s[8:11], s46 offen offset:2048 lds
  v_cvt_pk_bf16_f32 v166, v36, v37
  v_mfma_f32_16x16x32_bf16 v[204:207], a[108:111], a[48:51], v[204:207]
  v_cvt_pk_bf16_f32 v167, v38, v39
  v_mfma_f32_16x16x32_bf16 v[72:75], a[72:75], a[0:3], v[72:75]
  s_add_u32 s60, s63, 40960
  buffer_store_dwordx4 v[156:159], v2, s[16:19], s60 offen offset:3072 sc1
  v_cvt_pk_bf16_f32 v168, v168, v169
  v_mfma_f32_16x16x32_bf16 v[76:79], a[76:79], a[0:3], v[76:79]
  v_cvt_pk_bf16_f32 v169, v170, v171
  v_cvt_pk_bf16_f32 v170, v172, v173
  v_mfma_f32_16x16x32_bf16 v[72:75], a[104:107], a[32:35], v[72:75]
  v_cvt_pk_bf16_f32 v171, v174, v175
  v_mfma_f32_16x16x32_bf16 v[76:79], a[108:111], a[32:35], v[76:79]
  s_add_u32 s60, s63, 12288
  buffer_store_dwordx4 v[160:163], v2, s[16:19], s60 offen offset:0 sc1
  v_accvgpr_read_b32 v40, a168
  v_mfma_f32_16x16x32_bf16 v[208:211], a[80:83], a[16:19], v[208:211]
  buffer_load_dwordx4 v51, s[8:11], s46 offen offset:3072 lds
  v_accvgpr_read_b32 v41, a169
  v_mfma_f32_16x16x32_bf16 v[212:215], a[84:87], a[16:19], v[212:215]
  s_add_u32 m0, s36, 4096
  v_accvgpr_read_b32 v42, a170
  v_accvgpr_read_b32 v43, a171
  v_mfma_f32_16x16x32_bf16 v[208:211], a[112:115], a[48:51], v[208:211]
  v_accvgpr_read_b32 v44, a172
  v_accvgpr_read_b32 v45, a173
  v_mfma_f32_16x16x32_bf16 v[212:215], a[116:119], a[48:51], v[212:215]
  v_accvgpr_read_b32 v46, a174
  v_accvgpr_read_b32 v47, a175
  v_mfma_f32_16x16x32_bf16 v[80:83], a[80:83], a[0:3], v[80:83]
  v_cvt_pk_bf16_f32 v172, v40, v41
  v_cvt_pk_bf16_f32 v173, v42, v43
  v_mfma_f32_16x16x32_bf16 v[84:87], a[84:87], a[0:3], v[84:87]
  v_cvt_pk_bf16_f32 v174, v44, v45
  v_cvt_pk_bf16_f32 v175, v46, v47
  v_mfma_f32_16x16x32_bf16 v[80:83], a[112:115], a[32:35], v[80:83]
  buffer_load_dwordx4 v52, s[8:11], s46 offen offset:0 lds
  v_mfma_f32_16x16x32_bf16 v[84:87], a[116:119], a[32:35], v[84:87]
  s_add_u32 s60, s63, 45056
  buffer_store_dwordx4 v[164:167], v2, s[16:19], s60 offen offset:0 sc1
  v_cvt_pk_bf16_f32 v176, v176, v177
  v_mfma_f32_16x16x32_bf16 v[216:219], a[88:91], a[16:19], v[216:219]
  v_cvt_pk_bf16_f32 v177, v178, v179
  v_cvt_pk_bf16_f32 v178, v180, v181
  v_mfma_f32_16x16x32_bf16 v[220:223], a[92:95], a[16:19], v[220:223]
  v_cvt_pk_bf16_f32 v179, v182, v183
  v_mfma_f32_16x16x32_bf16 v[216:219], a[120:123], a[48:51], v[216:219]
  s_add_u32 s60, s63, 12288
  buffer_store_dwordx4 v[168:171], v2, s[16:19], s60 offen offset:1024 sc1
  v_accvgpr_read_b32 v24, a176
  v_mfma_f32_16x16x32_bf16 v[220:223], a[124:127], a[48:51], v[220:223]
  buffer_load_dwordx4 v53, s[8:11], s46 offen offset:1024 lds
  v_accvgpr_read_b32 v25, a177
  v_mfma_f32_16x16x32_bf16 v[88:91], a[88:91], a[0:3], v[88:91]
  v_accvgpr_read_b32 v26, a178
  v_accvgpr_read_b32 v27, a179
  v_mfma_f32_16x16x32_bf16 v[92:95], a[92:95], a[0:3], v[92:95]
  v_accvgpr_read_b32 v28, a180
  v_accvgpr_read_b32 v29, a181
  v_mfma_f32_16x16x32_bf16 v[224:227], a[64:67], a[20:23], v[224:227]
  v_accvgpr_read_b32 v30, a182
  v_accvgpr_read_b32 v31, a183
  v_mfma_f32_16x16x32_bf16 v[228:231], a[68:71], a[20:23], v[228:231]
  v_cvt_pk_bf16_f32 v180, v24, v25
  v_cvt_pk_bf16_f32 v181, v26, v27
  v_mfma_f32_16x16x32_bf16 v[96:99], a[64:67], a[4:7], v[96:99]
  v_cvt_pk_bf16_f32 v182, v28, v29
  v_cvt_pk_bf16_f32 v183, v30, v31
  v_mfma_f32_16x16x32_bf16 v[100:103], a[68:71], a[4:7], v[100:103]
  buffer_load_dwordx4 v54, s[8:11], s46 offen offset:2048 lds
  v_mfma_f32_16x16x32_bf16 v[232:235], a[72:75], a[20:23], v[232:235]
  s_add_u32 s60, s63, 45056
  buffer_store_dwordx4 v[172:175], v2, s[16:19], s60 offen offset:1024 sc1
  v_cvt_pk_bf16_f32 v184, v184, v185
  v_mfma_f32_16x16x32_bf16 v[236:239], a[76:79], a[20:23], v[236:239]
  v_cvt_pk_bf16_f32 v185, v186, v187
  v_cvt_pk_bf16_f32 v186, v188, v189
  v_mfma_f32_16x16x32_bf16 v[104:107], a[72:75], a[4:7], v[104:107]
  v_cvt_pk_bf16_f32 v187, v190, v191
  v_accvgpr_read_b32 v32, a184
  v_mfma_f32_16x16x32_bf16 v[108:111], a[76:79], a[4:7], v[108:111]
  v_accvgpr_read_b32 v33, a185
  v_accvgpr_read_b32 v34, a186
  v_mfma_f32_16x16x32_bf16 v[240:243], a[80:83], a[20:23], v[240:243]
  v_accvgpr_read_b32 v35, a187
  v_accvgpr_read_b32 v36, a188
  v_mfma_f32_16x16x32_bf16 v[244:247], a[84:87], a[20:23], v[244:247]
  buffer_load_dwordx4 v55, s[8:11], s46 offen offset:3072 lds
  v_accvgpr_read_b32 v37, a189
  v_mfma_f32_16x16x32_bf16 v[112:115], a[80:83], a[4:7], v[112:115]
  s_sub_u32 s50, s50, 1
  s_cmp_eq_u32 s50, 0
  s_cselect_b32 s12, s72, s12
  s_cselect_b32 s13, s73, s13
  v_mfma_f32_16x16x32_bf16 v[116:119], a[84:87], a[4:7], v[116:119]
  s_lshl_b32 s47, s48, 19
  s_bfe_u32 s34, 0x3020106, s49
  s_add_u32 s48, s48, s34
  v_mfma_f32_16x16x32_bf16 v[248:251], a[88:91], a[20:23], v[248:251]
  s_add_u32 s49, s49, 8
  s_and_b32 s49, s49, 0x8001f
  s_and_b32 s48, s48, 7
  v_mfma_f32_16x16x32_bf16 v[252:255], a[92:95], a[20:23], v[252:255]
  s_lshl_b32 s46, s48, 7
  v_accvgpr_read_b32 v38, a190
  v_accvgpr_read_b32 v39, a191
  v_mfma_f32_16x16x32_bf16 v[120:123], a[88:91], a[4:7], v[120:123]
  v_cvt_pk_bf16_f32 v188, v32, v33
  v_cvt_pk_bf16_f32 v189, v34, v35
  v_mfma_f32_16x16x32_bf16 v[124:127], a[92:95], a[4:7], v[124:127]
  v_cvt_pk_bf16_f32 v190, v36, v37
  v_cvt_pk_bf16_f32 v191, v38, v39
  v_mfma_f32_16x16x32_bf16 v[88:91], a[120:123], a[32:35], v[88:91]
  ds_read_b128 a[0:3], v16 offset:0
  ds_read_b64_tr_b16 a[64:65], v18 offset:0
  v_mfma_f32_16x16x32_bf16 v[92:95], a[124:127], a[32:35], v[92:95]
  ds_read_b64_tr_b16 a[66:67], v18 offset:2048
  ds_read_b128 a[4:7], v16 offset:2048
  v_mfma_f32_16x16x32_bf16 v[224:227], a[96:99], a[52:55], v[224:227]
  ds_read_b128 a[8:11], v16 offset:4096
  ds_read_b128 a[12:15], v16 offset:6144
  v_mfma_f32_16x16x32_bf16 v[228:231], a[100:103], a[52:55], v[228:231]
  ds_read_b128 a[16:19], v16 offset:8192
  ds_read_b128 a[20:23], v16 offset:10240
  v_mfma_f32_16x16x32_bf16 v[96:99], a[96:99], a[36:39], v[96:99]
  ds_read_b128 a[24:27], v16 offset:12288
  ds_read_b128 a[28:31], v16 offset:14336
  v_mfma_f32_16x16x32_bf16 v[100:103], a[100:103], a[36:39], v[100:103]
  ds_read_b64_tr_b16 a[68:69], v19 offset:0
  ds_read_b64_tr_b16 a[70:71], v19 offset:2048
  v_mfma_f32_16x16x32_bf16 v[232:235], a[104:107], a[52:55], v[232:235]
  ds_read_b64_tr_b16 a[72:73], v20 offset:0
  ds_read_b64_tr_b16 a[74:75], v20 offset:2048
  v_mfma_f32_16x16x32_bf16 v[236:239], a[108:111], a[52:55], v[236:239]
  ds_read_b64_tr_b16 a[76:77], v21 offset:0
  ds_read_b64_tr_b16 a[78:79], v21 offset:2048
  v_mfma_f32_16x16x32_bf16 v[104:107], a[104:107], a[36:39], v[104:107]
  ds_read_b64_tr_b16 a[80:81], v18 offset:8192
  ds_read_b64_tr_b16 a[82:83], v18 offset:10240
  v_mfma_f32_16x16x32_bf16 v[108:111], a[108:111], a[36:39], v[108:111]
  ds_read_b64_tr_b16 a[84:85], v19 offset:8192
  ds_read_b64_tr_b16 a[86:87], v19 offset:10240
  v_mfma_f32_16x16x32_bf16 v[240:243], a[112:115], a[52:55], v[240:243]
  ds_read_b64_tr_b16 a[88:89], v20 offset:8192
  ds_read_b64_tr_b16 a[90:91], v20 offset:10240
  v_mfma_f32_16x16x32_bf16 v[244:247], a[116:119], a[52:55], v[244:247]
  ds_read_b64_tr_b16 a[92:93], v21 offset:8192
  ds_read_b64_tr_b16 a[94:95], v21 offset:10240
  v_mfma_f32_16x16x32_bf16 v[112:115], a[112:115], a[36:39], v[112:115]
  v_cvt_pk_bf16_f32 v192, v192, v193
  v_cvt_pk_bf16_f32 v193, v194, v195
  v_mfma_f32_16x16x32_bf16 v[116:119], a[116:119], a[36:39], v[116:119]
  v_cvt_pk_bf16_f32 v194, v196, v197
  v_cvt_pk_bf16_f32 v195, v198, v199
  v_mfma_f32_16x16x32_bf16 v[248:251], a[120:123], a[52:55], v[248:251]
  v_cvt_pk_bf16_f32 v196, v64, v65
  v_cvt_pk_bf16_f32 v197, v66, v67
  v_mfma_f32_16x16x32_bf16 v[252:255], a[124:127], a[52:55], v[252:255]
  v_cvt_pk_bf16_f32 v198, v68, v69
  v_cvt_pk_bf16_f32 v199, v70, v71
  v_mfma_f32_16x16x32_bf16 v[120:123], a[120:123], a[36:39], v[120:123]
  v_cvt_pk_bf16_f32 v200, v200, v201
  v_cvt_pk_bf16_f32 v201, v202, v203
  v_mfma_f32_16x16x32_bf16 v[124:127], a[124:127], a[36:39], v[124:127]
  v_cvt_pk_bf16_f32 v202, v204, v205
  v_cvt_pk_bf16_f32 v203, v206, v207
  s_waitcnt lgkmcnt(0)
  v_mfma_f32_16x16x32_bf16 a[128:131], a[24:27], a[64:67], 0
  ds_read_b128 a[32:35], v17 offset:0
  ds_read_b64_tr_b16 a[96:97], v18 offset:4096
  v_mfma_f32_16x16x32_bf16 a[132:135], a[24:27], a[68:71], 0
  ds_read_b64_tr_b16 a[98:99], v18 offset:6144
  ds_read_b128 a[36:39], v17 offset:2048
  v_mfma_f32_16x16x32_bf16 a[136:139], a[24:27], a[72:75], 0
  ds_read_b128 a[40:43], v17 offset:4096
  ds_read_b128 a[44:47], v17 offset:6144
  v_mfma_f32_16x16x32_bf16 a[140:143], a[24:27], a[76:79], 0
  ds_read_b128 a[48:51], v17 offset:8192
  ds_read_b128 a[52:55], v17 offset:10240
  v_mfma_f32_16x16x32_bf16 a[144:147], a[24:27], a[80:83], 0
  ds_read_b128 a[56:59], v17 offset:12288
  ds_read_b128 a[60:63], v17 offset:14336
  v_mfma_f32_16x16x32_bf16 a[148:151], a[24:27], a[84:87], 0
  ds_read_b64_tr_b16 a[100:101], v19 offset:4096
  ds_read_b64_tr_b16 a[102:103], v19 offset:6144
  v_mfma_f32_16x16x32_bf16 a[152:155], a[24:27], a[88:91], 0
  ds_read_b64_tr_b16 a[104:105], v20 offset:4096
  v_cvt_pk_bf16_f32 v204, v72, v73
  v_mfma_f32_16x16x32_bf16 a[156:159], a[24:27], a[92:95], 0
  ds_read_b64_tr_b16 a[106:107], v20 offset:6144
  ds_read_b64_tr_b16 a[108:109], v21 offset:4096
  v_mfma_f32_16x16x32_bf16 a[160:163], a[28:31], a[64:67], 0
  ds_read_b64_tr_b16 a[110:111], v21 offset:6144
  ds_read_b64_tr_b16 a[112:113], v18 offset:12288
  v_mfma_f32_16x16x32_bf16 a[164:167], a[28:31], a[68:71], 0
  ds_read_b64_tr_b16 a[114:115], v18 offset:14336
  ds_read_b64_tr_b16 a[116:117], v19 offset:12288
  v_mfma_f32_16x16x32_bf16 a[168:171], a[28:31], a[72:75], 0
  ds_read_b64_tr_b16 a[118:119], v19 offset:14336
  ds_read_b64_tr_b16 a[120:121], v20 offset:12288
  v_mfma_f32_16x16x32_bf16 a[172:175], a[28:31], a[76:79], 0
  ds_read_b64_tr_b16 a[122:123], v20 offset:14336
  ds_read_b64_tr_b16 a[124:125], v21 offset:12288
  v_mfma_f32_16x16x32_bf16 a[176:179], a[28:31], a[80:83], 0
  ds_read_b64_tr_b16 a[126:127], v21 offset:14336
  v_cvt_pk_bf16_f32 v205, v74, v75
  v_mfma_f32_16x16x32_bf16 a[180:183], a[28:31], a[84:87], 0
  v_cvt_pk_bf16_f32 v206, v76, v77
  v_cvt_pk_bf16_f32 v207, v78, v79
  v_mfma_f32_16x16x32_bf16 a[184:187], a[28:31], a[88:91], 0
  v_cvt_pk_bf16_f32 v208, v208, v209
  v_cvt_pk_bf16_f32 v209, v210, v211
  v_mfma_f32_16x16x32_bf16 a[188:191], a[28:31], a[92:95], 0
  v_cvt_pk_bf16_f32 v210, v212, v213
  v_cvt_pk_bf16_f32 v211, v214, v215
  v_mfma_f32_16x16x32_bf16 v[128:131], a[8:11], a[64:67], 0
  v_cvt_pk_bf16_f32 v212, v80, v81
  v_cvt_pk_bf16_f32 v213, v82, v83
  v_mfma_f32_16x16x32_bf16 v[132:135], a[8:11], a[68:71], 0
  v_cvt_pk_bf16_f32 v214, v84, v85
  v_cvt_pk_bf16_f32 v215, v86, v87
  v_mfma_f32_16x16x32_bf16 v[136:139], a[8:11], a[72:75], 0
  v_cvt_pk_bf16_f32 v216, v216, v217
  v_cvt_pk_bf16_f32 v217, v218, v219
  v_mfma_f32_16x16x32_bf16 v[140:143], a[8:11], a[76:79], 0
  s_add_u32 s36, s36, s38
  s_add_u32 s37, s37, 1
  s_cmp_eq_u32 s37, 3
  s_cselect_b32 s37, 0, s37
  s_cselect_b32 s38, s39, s40
  v_add_u32 v16, s38, v16
  v_add_u32 v17, s38, v17
  s_add_u32 s41, s41, s43
  s_sub_u32 s43, 0, s43
  v_add_u32 v18, s43, v18
  v_add_u32 v19, s43, v19
  v_add_u32 v20, s43, v20
  v_add_u32 v21, s43, v21
  s_waitcnt vmcnt(8) lgkmcnt(0)
  s_barrier
  v_mfma_f32_16x16x32_bf16 a[128:131], a[56:59], a[96:99], a[128:131]
  s_mov_b32 m0, s41
  v_cvt_pk_bf16_f32 v218, v220, v221
  v_cvt_pk_bf16_f32 v219, v222, v223
  v_mfma_f32_16x16x32_bf16 a[132:135], a[56:59], a[100:103], a[132:135]
  v_cvt_pk_bf16_f32 v220, v88, v89
  v_cvt_pk_bf16_f32 v221, v90, v91
  v_mfma_f32_16x16x32_bf16 a[136:139], a[56:59], a[104:107], a[136:139]
  v_cvt_pk_bf16_f32 v222, v92, v93
  v_cvt_pk_bf16_f32 v223, v94, v95
  v_mfma_f32_16x16x32_bf16 a[140:143], a[56:59], a[108:111], a[140:143]
  v_cvt_pk_bf16_f32 v224, v224, v225
  v_cvt_pk_bf16_f32 v225, v226, v227
  v_mfma_f32_16x16x32_bf16 a[144:147], a[56:59], a[112:115], a[144:147]
  v_cvt_pk_bf16_f32 v226, v228, v229
  v_cvt_pk_bf16_f32 v227, v230, v231
  v_mfma_f32_16x16x32_bf16 a[148:151], a[56:59], a[116:119], a[148:151]
  v_cvt_pk_bf16_f32 v228, v96, v97
  v_cvt_pk_bf16_f32 v229, v98, v99
  v_mfma_f32_16x16x32_bf16 a[152:155], a[56:59], a[120:123], a[152:155]
  v_cvt_pk_bf16_f32 v230, v100, v101
  v_cvt_pk_bf16_f32 v231, v102, v103
  v_mfma_f32_16x16x32_bf16 a[156:159], a[56:59], a[124:127], a[156:159]
  v_cvt_pk_bf16_f32 v232, v232, v233
  v_cvt_pk_bf16_f32 v233, v234, v235
  v_mfma_f32_16x16x32_bf16 a[160:163], a[60:63], a[96:99], a[160:163]
  v_cvt_pk_bf16_f32 v234, v236, v237
  v_cvt_pk_bf16_f32 v235, v238, v239
  v_mfma_f32_16x16x32_bf16 a[164:167], a[60:63], a[100:103], a[164:167]
  v_cvt_pk_bf16_f32 v236, v104, v105
  v_cvt_pk_bf16_f32 v237, v106, v107
  v_mfma_f32_16x16x32_bf16 a[168:171], a[60:63], a[104:107], a[168:171]
  v_cvt_pk_bf16_f32 v238, v108, v109
  v_cvt_pk_bf16_f32 v239, v110, v111
  v_mfma_f32_16x16x32_bf16 a[172:175], a[60:63], a[108:111], a[172:175]
  v_cvt_pk_bf16_f32 v240, v240, v241
  v_cvt_pk_bf16_f32 v241, v242, v243
  v_mfma_f32_16x16x32_bf16 a[176:179], a[60:63], a[112:115], a[176:179]
  v_cvt_pk_bf16_f32 v242, v244, v245
  v_cvt_pk_bf16_f32 v243, v246, v247
  v_mfma_f32_16x16x32_bf16 a[180:183], a[60:63], a[116:119], a[180:183]
  v_cvt_pk_bf16_f32 v244, v112, v113
  v_cvt_pk_bf16_f32 v245, v114, v115
  v_mfma_f32_16x16x32_bf16 a[184:187], a[60:63], a[120:123], a[184:187]
  v_cvt_pk_bf16_f32 v246, v116, v117
  v_cvt_pk_bf16_f32 v247, v118, v119
  v_mfma_f32_16x16x32_bf16 a[188:191], a[60:63], a[124:127], a[188:191]
  v_cvt_pk_bf16_f32 v248, v248, v249
  v_cvt_pk_bf16_f32 v249, v250, v251
  v_mfma_f32_16x16x32_bf16 v[128:131], a[40:43], a[96:99], v[128:131]
  v_cvt_pk_bf16_f32 v250, v252, v253
  v_cvt_pk_bf16_f32 v251, v254, v255
  v_mfma_f32_16x16x32_bf16 v[132:135], a[40:43], a[100:103], v[132:135]
  v_cvt_pk_bf16_f32 v252, v120, v121
  v_cvt_pk_bf16_f32 v253, v122, v123
  v_mfma_f32_16x16x32_bf16 v[136:139], a[40:43], a[104:107], v[136:139]
  v_cvt_pk_bf16_f32 v254, v124, v125
  v_cvt_pk_bf16_f32 v255, v126, v127
  v_mfma_f32_16x16x32_bf16 v[140:143], a[40:43], a[108:111], v[140:143]
  s_add_u32 s60, s63, 12288
  buffer_store_dwordx4 v[176:179], v2, s[16:19], s60 offen offset:2048 sc1
  v_mfma_f32_16x16x32_bf16 v[144:147], a[8:11], a[80:83], 0
  s_add_u32 s60, s63, 45056
  buffer_store_dwordx4 v[180:183], v2, s[16:19], s60 offen offset:2048 sc1
  v_mfma_f32_16x16x32_bf16 v[148:151], a[8:11], a[84:87], 0
  s_add_u32 s60, s63, 12288
  buffer_store_dwordx4 v[184:187], v2, s[16:19], s60 offen offset:3072 sc1
  v_mfma_f32_16x16x32_bf16 v[144:147], a[40:43], a[112:115], v[144:147]
  s_add_u32 s60, s63, 45056
  buffer_store_dwordx4 v[188:191], v2, s[16:19], s60 offen offset:3072 sc1
  v_mfma_f32_16x16x32_bf16 v[148:151], a[40:43], a[116:119], v[148:151]
  s_add_u32 s60, s63, 32768
  buffer_store_dwordx4 v[192:195], v2, s[16:19], s60 offen offset:0 sc1
  v_mfma_f32_16x16x32_bf16 v[152:155], a[8:11], a[88:91], 0
  s_add_u32 s60, s63, 0
  buffer_store_dwordx4 v[196:199], v2, s[16:19], s60 offen offset:0 sc1
  v_mfma_f32_16x16x32_bf16 v[156:159], a[8:11], a[92:95], 0
  buffer_load_dwordx4 v56, s[12:15], s47 offen offset:0 lds
  v_mfma_f32_16x16x32_bf16 v[152:155], a[40:43], a[120:123], v[152:155]
  s_add_u32 s60, s63, 32768
  buffer_store_dwordx4 v[200:203], v2, s[16:19], s60 offen offset:1024 sc1
  v_mfma_f32_16x16x32_bf16 v[156:159], a[40:43], a[124:127], v[156:159]
  buffer_load_dwordx4 v57, s[12:15], s47 offen offset:1024 lds
  v_mfma_f32_16x16x32_bf16 v[160:163], a[12:15], a[64:67], 0
  buffer_load_dwordx4 v58, s[12:15], s47 offen offset:2048 lds
  v_mfma_f32_16x16x32_bf16 v[164:167], a[12:15], a[68:71], 0
  buffer_load_dwordx4 v59, s[12:15], s47 offen offset:3072 lds
  v_mfma_f32_16x16x32_bf16 v[160:163], a[44:47], a[96:99], v[160:163]
  s_add_u32 m0, s41, 4096
  v_mfma_f32_16x16x32_bf16 v[164:167], a[44:47], a[100:103], v[164:167]
  s_add_u32 s60, s63, 0
  buffer_store_dwordx4 v[204:207], v2, s[16:19], s60 offen offset:1024 sc1
  v_mfma_f32_16x16x32_bf16 v[168:171], a[12:15], a[72:75], 0
  buffer_load_dwordx4 v60, s[12:15], s47 offen offset:0 lds
  v_mfma_f32_16x16x32_bf16 v[172:175], a[12:15], a[76:79], 0
  buffer_load_dwordx4 v61, s[12:15], s47 offen offset:1024 lds
  v_mfma_f32_16x16x32_bf16 v[168:171], a[44:47], a[104:107], v[168:171]
  buffer_load_dwordx4 v62, s[12:15], s47 offen offset:2048 lds
  v_mfma_f32_16x16x32_bf16 v[172:175], a[44:47], a[108:111], v[172:175]
  s_add_u32 s60, s63, 32768
  buffer_store_dwordx4 v[208:211], v2, s[16:19], s60 offen offset:2048 sc1
  v_mfma_f32_16x16x32_bf16 v[64:67], a[0:3], a[64:67], 0
  v_mfma_f32_16x16x32_bf16 v[68:71], a[0:3], a[68:71], 0
  v_mfma_f32_16x16x32_bf16 v[64:67], a[32:35], a[96:99], v[64:67]
  buffer_load_dwordx4 v63, s[12:15], s47 offen offset:3072 lds
  v_mfma_f32_16x16x32_bf16 v[68:71], a[32:35], a[100:103], v[68:71]
  s_add_u32 s60, s63, 0
  buffer_store_dwordx4 v[212:215], v2, s[16:19], s60 offen offset:2048 sc1
  s_mov_b32 m0, s36
  s_nop 0
  buffer_load_dwordx4 v48, s[8:11], s46 offen offset:0 lds
  buffer_load_dwordx4 v49, s[8:11], s46 offen offset:1024 lds
  buffer_load_dwordx4 v50, s[8:11], s46 offen offset:2048 lds
  buffer_load_dwordx4 v51, s[8:11], s46 offen offset:3072 lds
  v_mfma_f32_16x16x32_bf16 v[72:75], a[0:3], a[72:75], 0
  s_add_u32 m0, s36, 4096
  v_mfma_f32_16x16x32_bf16 v[76:79], a[0:3], a[76:79], 0
  v_mfma_f32_16x16x32_bf16 v[72:75], a[32:35], a[104:107], v[72:75]
  v_mfma_f32_16x16x32_bf16 v[76:79], a[32:35], a[108:111], v[76:79]
  v_mfma_f32_16x16x32_bf16 v[80:83], a[0:3], a[80:83], 0
  s_add_u32 s60, s63, 32768
  buffer_store_dwordx4 v[216:219], v2, s[16:19], s60 offen offset:3072 sc1
  v_mfma_f32_16x16x32_bf16 v[84:87], a[0:3], a[84:87], 0
  v_mfma_f32_16x16x32_bf16 v[80:83], a[32:35], a[112:115], v[80:83]
  v_mfma_f32_16x16x32_bf16 v[84:87], a[32:35], a[116:119], v[84:87]
  v_mfma_f32_16x16x32_bf16 v[88:91], a[0:3], a[88:91], 0
  s_add_u32 s60, s63, 0
  buffer_store_dwordx4 v[220:223], v2, s[16:19], s60 offen offset:3072 sc1
  v_mfma_f32_16x16x32_bf16 v[92:95], a[0:3], a[92:95], 0
  v_mfma_f32_16x16x32_bf16 v[88:91], a[32:35], a[120:123], v[88:91]
  v_mfma_f32_16x16x32_bf16 v[92:95], a[32:35], a[124:127], v[92:95]
  v_mfma_f32_16x16x32_bf16 v[96:99], a[4:7], a[64:67], 0
  s_add_u32 s60, s63, 36864
  buffer_store_dwordx4 v[224:227], v2, s[16:19], s60 offen offset:0 sc1
  v_mfma_f32_16x16x32_bf16 v[100:103], a[4:7], a[68:71], 0
  v_mfma_f32_16x16x32_bf16 v[96:99], a[36:39], a[96:99], v[96:99]
  v_mfma_f32_16x16x32_bf16 v[100:103], a[36:39], a[100:103], v[100:103]
  v_mfma_f32_16x16x32_bf16 v[104:107], a[4:7], a[72:75], 0
  s_add_u32 s60, s63, 4096
  buffer_store_dwordx4 v[228:231], v2, s[16:19], s60 offen offset:0 sc1
  v_mfma_f32_16x16x32_bf16 v[108:111], a[4:7], a[76:79], 0
  v_mfma_f32_16x16x32_bf16 v[104:107], a[36:39], a[104:107], v[104:107]
  v_mfma_f32_16x16x32_bf16 v[108:111], a[36:39], a[108:111], v[108:111]
  v_mfma_f32_16x16x32_bf16 v[112:115], a[4:7], a[80:83], 0
  v_mfma_f32_16x16x32_bf16 v[116:119], a[4:7], a[84:87], 0
  s_add_u32 s60, s63, 36864
  buffer_store_dwordx4 v[232:235], v2, s[16:19], s60 offen offset:1024 sc1
  v_mfma_f32_16x16x32_bf16 v[112:115], a[36:39], a[112:115], v[112:115]
  v_mfma_f32_16x16x32_bf16 v[116:119], a[36:39], a[116:119], v[116:119]
  v_mfma_f32_16x16x32_bf16 v[120:123], a[4:7], a[88:91], 0
  v_mfma_f32_16x16x32_bf16 v[124:127], a[4:7], a[92:95], 0
  s_add_u32 s60, s63, 4096
  buffer_store_dwordx4 v[236:239], v2, s[16:19], s60 offen offset:1024 sc1
  v_mfma_f32_16x16x32_bf16 v[120:123], a[36:39], a[120:123], v[120:123]
  buffer_load_dwordx4 v52, s[8:11], s46 offen offset:0 lds
  v_mfma_f32_16x16x32_bf16 v[124:127], a[36:39], a[124:127], v[124:127]
  v_mfma_f32_16x16x32_bf16 v[176:179], a[12:15], a[80:83], 0
  v_mfma_f32_16x16x32_bf16 v[180:183], a[12:15], a[84:87], 0
  s_add_u32 s60, s63, 36864
  buffer_store_dwordx4 v[240:243], v2, s[16:19], s60 offen offset:2048 sc1
  v_mfma_f32_16x16x32_bf16 v[176:179], a[44:47], a[112:115], v[176:179]
  v_mfma_f32_16x16x32_bf16 v[180:183], a[44:47], a[116:119], v[180:183]
  v_mfma_f32_16x16x32_bf16 v[184:187], a[12:15], a[88:91], 0
  buffer_load_dwordx4 v53, s[8:11], s46 offen offset:1024 lds
  v_mfma_f32_16x16x32_bf16 v[188:191], a[12:15], a[92:95], 0
  v_mfma_f32_16x16x32_bf16 v[192:195], a[16:19], a[64:67], 0
  s_add_u32 s60, s63, 4096
  buffer_store_dwordx4 v[244:247], v2, s[16:19], s60 offen offset:2048 sc1
  v_mfma_f32_16x16x32_bf16 v[196:199], a[16:19], a[68:71], 0
  v_mfma_f32_16x16x32_bf16 v[200:203], a[16:19], a[72:75], 0
  v_mfma_f32_16x16x32_bf16 v[204:207], a[16:19], a[76:79], 0
  buffer_load_dwordx4 v54, s[8:11], s46 offen offset:2048 lds
  v_mfma_f32_16x16x32_bf16 v[208:211], a[16:19], a[80:83], 0
  s_add_u32 s60, s63, 36864
  buffer_store_dwordx4 v[248:251], v2, s[16:19], s60 offen offset:3072 sc1
  v_mfma_f32_16x16x32_bf16 v[212:215], a[16:19], a[84:87], 0
  v_mfma_f32_16x16x32_bf16 v[216:219], a[16:19], a[88:91], 0
  v_mfma_f32_16x16x32_bf16 v[220:223], a[16:19], a[92:95], 0
  v_mfma_f32_16x16x32_bf16 v[224:227], a[20:23], a[64:67], 0
  s_add_u32 s60, s63, 4096
  buffer_store_dwordx4 v[252:255], v2, s[16:19], s60 offen offset:3072 sc1
  v_mfma_f32_16x16x32_bf16 v[228:231], a[20:23], a[68:71], 0
  buffer_load_dwordx4 v55, s[8:11], s46 offen offset:3072 lds
  v_mfma_f32_16x16x32_bf16 v[232:235], a[20:23], a[72:75], 0
  s_sub_u32 s50, s50, 1
  s_cmp_eq_u32 s50, 0
  s_cselect_b32 s12, s72, s12
  s_cselect_b32 s13, s73, s13
  v_mfma_f32_16x16x32_bf16 v[236:239], a[20:23], a[76:79], 0
  s_lshl_b32 s47, s48, 19
  s_bfe_u32 s34, 0x3020106, s49
  s_add_u32 s48, s48, s34
  v_mfma_f32_16x16x32_bf16 v[240:243], a[20:23], a[80:83], 0
  s_add_u32 s49, s49, 8
  s_and_b32 s49, s49, 0x8001f
  s_and_b32 s48, s48, 7
  v_mfma_f32_16x16x32_bf16 v[244:247], a[20:23], a[84:87], 0
  s_lshl_b32 s46, s48, 7
  v_mfma_f32_16x16x32_bf16 v[248:251], a[20:23], a[88:91], 0
  v_mfma_f32_16x16x32_bf16 v[252:255], a[20:23], a[92:95], 0
  v_mfma_f32_16x16x32_bf16 v[184:187], a[44:47], a[120:123], v[184:187]
  ds_read_b128 a[0:3], v16 offset:0
  ds_read_b64_tr_b16 a[64:65], v18 offset:0
  v_mfma_f32_16x16x32_bf16 v[188:191], a[44:47], a[124:127], v[188:191]
  ds_read_b64_tr_b16 a[66:67], v18 offset:2048
  ds_read_b128 a[4:7], v16 offset:2048
  v_mfma_f32_16x16x32_bf16 v[192:195], a[48:51], a[96:99], v[192:195]
  ds_read_b128 a[8:11], v16 offset:4096
  ds_read_b128 a[12:15], v16 offset:6144
  v_mfma_f32_16x16x32_bf16 v[196:199], a[48:51], a[100:103], v[196:199]
  ds_read_b128 a[16:19], v16 offset:8192
  ds_read_b128 a[20:23], v16 offset:10240
  v_mfma_f32_16x16x32_bf16 v[200:203], a[48:51], a[104:107], v[200:203]
  ds_read_b128 a[24:27], v16 offset:12288
  ds_read_b128 a[28:31], v16 offset:14336
  v_mfma_f32_16x16x32_bf16 v[204:207], a[48:51], a[108:111], v[204:207]
  ds_read_b64_tr_b16 a[68:69], v19 offset:0
  ds_read_b64_tr_b16 a[70:71], v19 offset:2048
  v_mfma_f32_16x16x32_bf16 v[208:211], a[48:51], a[112:115], v[208:211]
  ds_read_b64_tr_b16 a[72:73], v20 offset:0
  ds_read_b64_tr_b16 a[74:75], v20 offset:2048
  v_mfma_f32_16x16x32_bf16 v[212:215], a[48:51], a[116:119], v[212:215]
  ds_read_b64_tr_b16 a[76:77], v21 offset:0
  ds_read_b64_tr_b16 a[78:79], v21 offset:2048
  v_mfma_f32_16x16x32_bf16 v[216:219], a[48:51], a[120:123], v[216:219]
  ds_read_b64_tr_b16 a[80:81], v18 offset:8192
  ds_read_b64_tr_b16 a[82:83], v18 offset:10240
  v_mfma_f32_16x16x32_bf16 v[220:223], a[48:51], a[124:127], v[220:223]
  ds_read_b64_tr_b16 a[84:85], v19 offset:8192
  ds_read_b64_tr_b16 a[86:87], v19 offset:10240
  v_mfma_f32_16x16x32_bf16 v[224:227], a[52:55], a[96:99], v[224:227]
  ds_read_b64_tr_b16 a[88:89], v20 offset:8192
  ds_read_b64_tr_b16 a[90:91], v20 offset:10240
  v_mfma_f32_16x16x32_bf16 v[228:231], a[52:55], a[100:103], v[228:231]
  ds_read_b64_tr_b16 a[92:93], v21 offset:8192
  ds_read_b64_tr_b16 a[94:95], v21 offset:10240
  v_mfma_f32_16x16x32_bf16 v[232:235], a[52:55], a[104:107], v[232:235]
  v_mfma_f32_16x16x32_bf16 v[236:239], a[52:55], a[108:111], v[236:239]
  v_mfma_f32_16x16x32_bf16 v[240:243], a[52:55], a[112:115], v[240:243]
  v_mfma_f32_16x16x32_bf16 v[244:247], a[52:55], a[116:119], v[244:247]
  v_mfma_f32_16x16x32_bf16 v[248:251], a[52:55], a[120:123], v[248:251]
  v_mfma_f32_16x16x32_bf16 v[252:255], a[52:55], a[124:127], v[252:255]
  s_add_u32 s63, s63, 0x4000
  s_waitcnt lgkmcnt(0)
  v_mfma_f32_16x16x32_bf16 v[64:67], a[0:3], a[64:67], v[64:67]
  s_add_u32 s36, s36, s38
  s_add_u32 s37, s37, 1
  ds_read_b128 a[32:35], v17 offset:0
  v_mfma_f32_16x16x32_bf16 v[96:99], a[4:7], a[64:67], v[96:99]
  s_cmp_eq_u32 s37, 3
  s_cselect_b32 s37, 0, s37
  s_cselect_b32 s38, s39, s40
  v_mfma_f32_16x16x32_bf16 v[128:131], a[8:11], a[64:67], v[128:131]
  s_add_u32 s41, s41, s43
  s_sub_u32 s43, 0, s43
  ds_read_b64_tr_b16 a[96:97], v18 offset:4096
  v_mfma_f32_16x16x32_bf16 v[160:163], a[12:15], a[64:67], v[160:163]
  v_mfma_f32_16x16x32_bf16 v[192:195], a[16:19], a[64:67], v[192:195]
  ds_read_b64_tr_b16 a[98:99], v18 offset:6144
  v_mfma_f32_16x16x32_bf16 v[224:227], a[20:23], a[64:67], v[224:227]
  v_mfma_f32_16x16x32_bf16 a[128:131], a[24:27], a[64:67], a[128:131]
  ds_read_b128 a[36:39], v17 offset:2048
  v_mfma_f32_16x16x32_bf16 a[160:163], a[28:31], a[64:67], a[160:163]
  v_mfma_f32_16x16x32_bf16 v[68:71], a[0:3], a[68:71], v[68:71]
  v_mfma_f32_16x16x32_bf16 v[100:103], a[4:7], a[68:71], v[100:103]
  ds_read_b128 a[40:43], v17 offset:4096
  v_mfma_f32_16x16x32_bf16 v[132:135], a[8:11], a[68:71], v[132:135]
  v_mfma_f32_16x16x32_bf16 v[164:167], a[12:15], a[68:71], v[164:167]
  ds_read_b128 a[44:47], v17 offset:6144
  v_mfma_f32_16x16x32_bf16 v[196:199], a[16:19], a[68:71], v[196:199]
  v_mfma_f32_16x16x32_bf16 v[228:231], a[20:23], a[68:71], v[228:231]
  ds_read_b128 a[48:51], v17 offset:8192
  v_mfma_f32_16x16x32_bf16 a[132:135], a[24:27], a[68:71], a[132:135]
  v_mfma_f32_16x16x32_bf16 a[164:167], a[28:31], a[68:71], a[164:167]
  ds_read_b128 a[52:55], v17 offset:10240
  v_mfma_f32_16x16x32_bf16 v[72:75], a[0:3], a[72:75], v[72:75]
  v_mfma_f32_16x16x32_bf16 v[104:107], a[4:7], a[72:75], v[104:107]
  v_mfma_f32_16x16x32_bf16 v[136:139], a[8:11], a[72:75], v[136:139]
  ds_read_b128 a[56:59], v17 offset:12288
  v_mfma_f32_16x16x32_bf16 v[168:171], a[12:15], a[72:75], v[168:171]
  v_mfma_f32_16x16x32_bf16 v[200:203], a[16:19], a[72:75], v[200:203]
  ds_read_b128 a[60:63], v17 offset:14336
  v_mfma_f32_16x16x32_bf16 v[232:235], a[20:23], a[72:75], v[232:235]
  v_mfma_f32_16x16x32_bf16 a[136:139], a[24:27], a[72:75], a[136:139]
  ds_read_b64_tr_b16 a[100:101], v19 offset:4096
  v_mfma_f32_16x16x32_bf16 a[168:171], a[28:31], a[72:75], a[168:171]
  v_mfma_f32_16x16x32_bf16 v[76:79], a[0:3], a[76:79], v[76:79]
  ds_read_b64_tr_b16 a[102:103], v19 offset:6144
  v_mfma_f32_16x16x32_bf16 v[108:111], a[4:7], a[76:79], v[108:111]
  v_mfma_f32_16x16x32_bf16 v[140:143], a[8:11], a[76:79], v[140:143]
  v_mfma_f32_16x16x32_bf16 v[172:175], a[12:15], a[76:79], v[172:175]
  ds_read_b64_tr_b16 a[104:105], v20 offset:4096
  v_mfma_f32_16x16x32_bf16 v[204:207], a[16:19], a[76:79], v[204:207]
  v_mfma_f32_16x16x32_bf16 v[236:239], a[20:23], a[76:79], v[236:239]
  ds_read_b64_tr_b16 a[106:107], v20 offset:6144
  v_mfma_f32_16x16x32_bf16 a[140:143], a[24:27], a[76:79], a[140:143]
  v_mfma_f32_16x16x32_bf16 a[172:175], a[28:31], a[76:79], a[172:175]
  ds_read_b64_tr_b16 a[108:109], v21 offset:4096
  v_mfma_f32_16x16x32_bf16 v[80:83], a[0:3], a[80:83], v[80:83]
  v_mfma_f32_16x16x32_bf16 v[112:115], a[4:7], a[80:83], v[112:115]
  ds_read_b64_tr_b16 a[110:111], v21 offset:6144
  v_mfma_f32_16x16x32_bf16 v[144:147], a[8:11], a[80:83], v[144:147]
  v_mfma_f32_16x16x32_bf16 v[176:179], a[12:15], a[80:83], v[176:179]
  v_mfma_f32_16x16x32_bf16 v[208:211], a[16:19], a[80:83], v[208:211]
  ds_read_b64_tr_b16 a[112:113], v18 offset:12288
  v_mfma_f32_16x16x32_bf16 v[240:243], a[20:23], a[80:83], v[240:243]
  v_mfma_f32_16x16x32_bf16 a[144:147], a[24:27], a[80:83], a[144:147]
  ds_read_b64_tr_b16 a[114:115], v18 offset:14336
  v_mfma_f32_16x16x32_bf16 a[176:179], a[28:31], a[80:83], a[176:179]
  v_mfma_f32_16x16x32_bf16 v[84:87], a[0:3], a[84:87], v[84:87]
  ds_read_b64_tr_b16 a[116:117], v19 offset:12288
  v_mfma_f32_16x16x32_bf16 v[116:119], a[4:7], a[84:87], v[116:119]
  v_mfma_f32_16x16x32_bf16 v[148:151], a[8:11], a[84:87], v[148:151]
  ds_read_b64_tr_b16 a[118:119], v19 offset:14336
  v_mfma_f32_16x16x32_bf16 v[180:183], a[12:15], a[84:87], v[180:183]
  v_mfma_f32_16x16x32_bf16 v[212:215], a[16:19], a[84:87], v[212:215]
  v_mfma_f32_16x16x32_bf16 v[244:247], a[20:23], a[84:87], v[244:247]
  ds_read_b64_tr_b16 a[120:121], v20 offset:12288
  v_mfma_f32_16x16x32_bf16 a[148:151], a[24:27], a[84:87], a[148:151]
  v_mfma_f32_16x16x32_bf16 a[180:183], a[28:31], a[84:87], a[180:183]
  ds_read_b64_tr_b16 a[122:123], v20 offset:14336
  v_mfma_f32_16x16x32_bf16 v[88:91], a[0:3], a[88:91], v[88:91]
  v_mfma_f32_16x16x32_bf16 v[120:123], a[4:7], a[88:91], v[120:123]
  ds_read_b64_tr_b16 a[124:125], v21 offset:12288
  v_mfma_f32_16x16x32_bf16 v[152:155], a[8:11], a[88:91], v[152:155]
  v_mfma_f32_16x16x32_bf16 v[184:187], a[12:15], a[88:91], v[184:187]
  ds_read_b64_tr_b16 a[126:127], v21 offset:14336
  v_mfma_f32_16x16x32_bf16 v[216:219], a[16:19], a[88:91], v[216:219]
  v_add_u32 v16, s38, v16
  v_add_u32 v17, s38, v17
  v_mfma_f32_16x16x32_bf16 v[248:251], a[20:23], a[88:91], v[248:251]
  v_add_u32 v18, s43, v18
  v_add_u32 v19, s43, v19
  v_mfma_f32_16x16x32_bf16 a[152:155], a[24:27], a[88:91], a[152:155]
  v_add_u32 v20, s43, v20
  v_add_u32 v21, s43, v21
  v_mfma_f32_16x16x32_bf16 a[184:187], a[28:31], a[88:91], a[184:187]
  v_mfma_f32_16x16x32_bf16 v[92:95], a[0:3], a[92:95], v[92:95]
  v_mfma_f32_16x16x32_bf16 v[124:127], a[4:7], a[92:95], v[124:127]
  v_mfma_f32_16x16x32_bf16 v[156:159], a[8:11], a[92:95], v[156:159]
  v_mfma_f32_16x16x32_bf16 v[188:191], a[12:15], a[92:95], v[188:191]
  v_mfma_f32_16x16x32_bf16 v[220:223], a[16:19], a[92:95], v[220:223]
  v_mfma_f32_16x16x32_bf16 v[252:255], a[20:23], a[92:95], v[252:255]
  v_mfma_f32_16x16x32_bf16 a[156:159], a[24:27], a[92:95], a[156:159]
  v_mfma_f32_16x16x32_bf16 a[188:191], a[28:31], a[92:95], a[188:191]
  s_mov_b32 s35, 4
  s_waitcnt vmcnt(8) lgkmcnt(0)
  s_barrier
  .p2align 6
Lp1xw_loop:
  v_mfma_f32_16x16x32_bf16 v[64:67], a[32:35], a[96:99], v[64:67]
  s_mov_b32 m0, s41
  ds_read_b128 a[0:3], v16 offset:0
  v_mfma_f32_16x16x32_bf16 v[96:99], a[36:39], a[96:99], v[96:99]
  buffer_load_dwordx4 v56, s[12:15], s47 offen offset:0 lds
  v_mfma_f32_16x16x32_bf16 v[128:131], a[40:43], a[96:99], v[128:131]
  ds_read_b64_tr_b16 a[64:65], v18 offset:0
  v_mfma_f32_16x16x32_bf16 v[160:163], a[44:47], a[96:99], v[160:163]
  v_mfma_f32_16x16x32_bf16 v[192:195], a[48:51], a[96:99], v[192:195]
  ds_read_b64_tr_b16 a[66:67], v18 offset:2048
  v_mfma_f32_16x16x32_bf16 v[224:227], a[52:55], a[96:99], v[224:227]
  v_mfma_f32_16x16x32_bf16 a[128:131], a[56:59], a[96:99], a[128:131]
  ds_read_b128 a[4:7], v16 offset:2048
  v_mfma_f32_16x16x32_bf16 a[160:163], a[60:63], a[96:99], a[160:163]
  buffer_load_dwordx4 v57, s[12:15], s47 offen offset:1024 lds
  v_mfma_f32_16x16x32_bf16 v[68:71], a[32:35], a[100:103], v[68:71]
  v_mfma_f32_16x16x32_bf16 v[100:103], a[36:39], a[100:103], v[100:103]
  ds_read_b128 a[8:11], v16 offset:4096
  v_mfma_f32_16x16x32_bf16 v[132:135], a[40:43], a[100:103], v[132:135]
  v_mfma_f32_16x16x32_bf16 v[164:167], a[44:47], a[100:103], v[164:167]
  ds_read_b128 a[12:15], v16 offset:6144
  v_mfma_f32_16x16x32_bf16 v[196:199], a[48:51], a[100:103], v[196:199]
  v_mfma_f32_16x16x32_bf16 v[228:231], a[52:55], a[100:103], v[228:231]
  ds_read_b128 a[16:19], v16 offset:8192
  v_mfma_f32_16x16x32_bf16 a[132:135], a[56:59], a[100:103], a[132:135]
  v_mfma_f32_16x16x32_bf16 a[164:167], a[60:63], a[100:103], a[164:167]
  buffer_load_dwordx4 v58, s[12:15], s47 offen offset:2048 lds
  ds_read_b128 a[20:23], v16 offset:10240
  v_mfma_f32_16x16x32_bf16 v[72:75], a[32:35], a[104:107], v[72:75]
  v_mfma_f32_16x16x32_bf16 v[104:107], a[36:39], a[104:107], v[104:107]
  v_mfma_f32_16x16x32_bf16 v[136:139], a[40:43], a[104:107], v[136:139]
  ds_read_b128 a[24:27], v16 offset:12288
  v_mfma_f32_16x16x32_bf16 v[168:171], a[44:47], a[104:107], v[168:171]
  v_mfma_f32_16x16x32_bf16 v[200:203], a[48:51], a[104:107], v[200:203]
  ds_read_b128 a[28:31], v16 offset:14336
  v_mfma_f32_16x16x32_bf16 v[232:235], a[52:55], a[104:107], v[232:235]
  v_mfma_f32_16x16x32_bf16 a[136:139], a[56:59], a[104:107], a[136:139]
  ds_read_b64_tr_b16 a[68:69], v19 offset:0
  v_mfma_f32_16x16x32_bf16 a[168:171], a[60:63], a[104:107], a[168:171]
  buffer_load_dwordx4 v59, s[12:15], s47 offen offset:3072 lds
  v_mfma_f32_16x16x32_bf16 v[76:79], a[32:35], a[108:111], v[76:79]
  s_add_u32 m0, s41, 4096
  ds_read_b64_tr_b16 a[70:71], v19 offset:2048
  v_mfma_f32_16x16x32_bf16 v[108:111], a[36:39], a[108:111], v[108:111]
  v_mfma_f32_16x16x32_bf16 v[140:143], a[40:43], a[108:111], v[140:143]
  v_mfma_f32_16x16x32_bf16 v[172:175], a[44:47], a[108:111], v[172:175]
  ds_read_b64_tr_b16 a[72:73], v20 offset:0
  v_mfma_f32_16x16x32_bf16 v[204:207], a[48:51], a[108:111], v[204:207]
  v_mfma_f32_16x16x32_bf16 v[236:239], a[52:55], a[108:111], v[236:239]
  ds_read_b64_tr_b16 a[74:75], v20 offset:2048
  v_mfma_f32_16x16x32_bf16 a[140:143], a[56:59], a[108:111], a[140:143]
  v_mfma_f32_16x16x32_bf16 a[172:175], a[60:63], a[108:111], a[172:175]
  buffer_load_dwordx4 v60, s[12:15], s47 offen offset:0 lds
  ds_read_b64_tr_b16 a[76:77], v21 offset:0
  v_mfma_f32_16x16x32_bf16 v[80:83], a[32:35], a[112:115], v[80:83]
  v_mfma_f32_16x16x32_bf16 v[112:115], a[36:39], a[112:115], v[112:115]
  ds_read_b64_tr_b16 a[78:79], v21 offset:2048
  v_mfma_f32_16x16x32_bf16 v[144:147], a[40:43], a[112:115], v[144:147]
  v_mfma_f32_16x16x32_bf16 v[176:179], a[44:47], a[112:115], v[176:179]
  v_mfma_f32_16x16x32_bf16 v[208:211], a[48:51], a[112:115], v[208:211]
  ds_read_b64_tr_b16 a[80:81], v18 offset:8192
  v_mfma_f32_16x16x32_bf16 v[240:243], a[52:55], a[112:115], v[240:243]
  v_mfma_f32_16x16x32_bf16 a[144:147], a[56:59], a[112:115], a[144:147]
  ds_read_b64_tr_b16 a[82:83], v18 offset:10240
  v_mfma_f32_16x16x32_bf16 a[176:179], a[60:63], a[112:115], a[176:179]
  buffer_load_dwordx4 v61, s[12:15], s47 offen offset:1024 lds
  v_mfma_f32_16x16x32_bf16 v[84:87], a[32:35], a[116:119], v[84:87]
  ds_read_b64_tr_b16 a[84:85], v19 offset:8192
  v_mfma_f32_16x16x32_bf16 v[116:119], a[36:39], a[116:119], v[116:119]
  v_mfma_f32_16x16x32_bf16 v[148:151], a[40:43], a[116:119], v[148:151]
  ds_read_b64_tr_b16 a[86:87], v19 offset:10240
  v_mfma_f32_16x16x32_bf16 v[180:183], a[44:47], a[116:119], v[180:183]
  v_mfma_f32_16x16x32_bf16 v[212:215], a[48:51], a[116:119], v[212:215]
  v_mfma_f32_16x16x32_bf16 v[244:247], a[52:55], a[116:119], v[244:247]
  ds_read_b64_tr_b16 a[88:89], v20 offset:8192
  v_mfma_f32_16x16x32_bf16 a[148:151], a[56:59], a[116:119], a[148:151]
  v_mfma_f32_16x16x32_bf16 a[180:183], a[60:63], a[116:119], a[180:183]
  buffer_load_dwordx4 v62, s[12:15], s47 offen offset:2048 lds
  ds_read_b64_tr_b16 a[90:91], v20 offset:10240
  v_mfma_f32_16x16x32_bf16 v[88:91], a[32:35], a[120:123], v[88:91]
  v_mfma_f32_16x16x32_bf16 v[120:123], a[36:39], a[120:123], v[120:123]
  ds_read_b64_tr_b16 a[92:93], v21 offset:8192
  v_mfma_f32_16x16x32_bf16 v[152:155], a[40:43], a[120:123], v[152:155]
  v_mfma_f32_16x16x32_bf16 v[184:187], a[44:47], a[120:123], v[184:187]
  ds_read_b64_tr_b16 a[94:95], v21 offset:10240
  v_mfma_f32_16x16x32_bf16 v[216:219], a[48:51], a[120:123], v[216:219]
  v_mfma_f32_16x16x32_bf16 v[248:251], a[52:55], a[120:123], v[248:251]
  v_mfma_f32_16x16x32_bf16 a[152:155], a[56:59], a[120:123], a[152:155]
  v_mfma_f32_16x16x32_bf16 a[184:187], a[60:63], a[120:123], a[184:187]
  buffer_load_dwordx4 v63, s[12:15], s47 offen offset:3072 lds
  v_mfma_f32_16x16x32_bf16 v[92:95], a[32:35], a[124:127], v[92:95]
  v_mfma_f32_16x16x32_bf16 v[124:127], a[36:39], a[124:127], v[124:127]
  v_mfma_f32_16x16x32_bf16 v[156:159], a[40:43], a[124:127], v[156:159]
  v_mfma_f32_16x16x32_bf16 v[188:191], a[44:47], a[124:127], v[188:191]
  v_mfma_f32_16x16x32_bf16 v[220:223], a[48:51], a[124:127], v[220:223]
  v_mfma_f32_16x16x32_bf16 v[252:255], a[52:55], a[124:127], v[252:255]
  v_mfma_f32_16x16x32_bf16 a[156:159], a[56:59], a[124:127], a[156:159]
  v_mfma_f32_16x16x32_bf16 a[188:191], a[60:63], a[124:127], a[188:191]
  s_waitcnt lgkmcnt(0)
  v_mfma_f32_16x16x32_bf16 v[64:67], a[0:3], a[64:67], v[64:67]
  s_mov_b32 m0, s36
  ds_read_b128 a[32:35], v17 offset:0
  v_mfma_f32_16x16x32_bf16 v[96:99], a[4:7], a[64:67], v[96:99]
  buffer_load_dwordx4 v48, s[8:11], s46 offen offset:0 lds
  v_mfma_f32_16x16x32_bf16 v[128:131], a[8:11], a[64:67], v[128:131]
  ds_read_b64_tr_b16 a[96:97], v18 offset:4096
  v_mfma_f32_16x16x32_bf16 v[160:163], a[12:15], a[64:67], v[160:163]
  v_mfma_f32_16x16x32_bf16 v[192:195], a[16:19], a[64:67], v[192:195]
  ds_read_b64_tr_b16 a[98:99], v18 offset:6144
  v_mfma_f32_16x16x32_bf16 v[224:227], a[20:23], a[64:67], v[224:227]
  v_mfma_f32_16x16x32_bf16 a[128:131], a[24:27], a[64:67], a[128:131]
  ds_read_b128 a[36:39], v17 offset:2048
  v_mfma_f32_16x16x32_bf16 a[160:163], a[28:31], a[64:67], a[160:163]
  buffer_load_dwordx4 v49, s[8:11], s46 offen offset:1024 lds
  v_mfma_f32_16x16x32_bf16 v[68:71], a[0:3], a[68:71], v[68:71]
  v_mfma_f32_16x16x32_bf16 v[100:103], a[4:7], a[68:71], v[100:103]
  ds_read_b128 a[40:43], v17 offset:4096
  v_mfma_f32_16x16x32_bf16 v[132:135], a[8:11], a[68:71], v[132:135]
  v_mfma_f32_16x16x32_bf16 v[164:167], a[12:15], a[68:71], v[164:167]
  ds_read_b128 a[44:47], v17 offset:6144
  v_mfma_f32_16x16x32_bf16 v[196:199], a[16:19], a[68:71], v[196:199]
  v_mfma_f32_16x16x32_bf16 v[228:231], a[20:23], a[68:71], v[228:231]
  ds_read_b128 a[48:51], v17 offset:8192
  v_mfma_f32_16x16x32_bf16 a[132:135], a[24:27], a[68:71], a[132:135]
  buffer_load_dwordx4 v50, s[8:11], s46 offen offset:2048 lds
  v_mfma_f32_16x16x32_bf16 a[164:167], a[28:31], a[68:71], a[164:167]
  ds_read_b128 a[52:55], v17 offset:10240
  v_mfma_f32_16x16x32_bf16 v[72:75], a[0:3], a[72:75], v[72:75]
  v_mfma_f32_16x16x32_bf16 v[104:107], a[4:7], a[72:75], v[104:107]
  v_mfma_f32_16x16x32_bf16 v[136:139], a[8:11], a[72:75], v[136:139]
  ds_read_b128 a[56:59], v17 offset:12288
  v_mfma_f32_16x16x32_bf16 v[168:171], a[12:15], a[72:75], v[168:171]
  v_mfma_f32_16x16x32_bf16 v[200:203], a[16:19], a[72:75], v[200:203]
  ds_read_b128 a[60:63], v17 offset:14336
  v_mfma_f32_16x16x32_bf16 v[232:235], a[20:23], a[72:75], v[232:235]
  buffer_load_dwordx4 v51, s[8:11], s46 offen offset:3072 lds
  v_mfma_f32_16x16x32_bf16 a[136:139], a[24:27], a[72:75], a[136:139]
  s_add_u32 m0, s36, 4096
  ds_read_b64_tr_b16 a[100:101], v19 offset:4096
  v_mfma_f32_16x16x32_bf16 a[168:171], a[28:31], a[72:75], a[168:171]
  v_mfma_f32_16x16x32_bf16 v[76:79], a[0:3], a[76:79], v[76:79]
  ds_read_b64_tr_b16 a[102:103], v19 offset:6144
  v_mfma_f32_16x16x32_bf16 v[108:111], a[4:7], a[76:79], v[108:111]
  v_mfma_f32_16x16x32_bf16 v[140:143], a[8:11], a[76:79], v[140:143]
  v_mfma_f32_16x16x32_bf16 v[172:175], a[12:15], a[76:79], v[172:175]
  ds_read_b64_tr_b16 a[104:105], v20 offset:4096
  v_mfma_f32_16x16x32_bf16 v[204:207], a[16:19], a[76:79], v[204:207]
  buffer_load_dwordx4 v52, s[8:11], s46 offen offset:0 lds
  v_mfma_f32_16x16x32_bf16 v[236:239], a[20:23], a[76:79], v[236:239]
  ds_read_b64_tr_b16 a[106:107], v20 offset:6144
  v_mfma_f32_16x16x32_bf16 a[140:143], a[24:27], a[76:79], a[140:143]
  v_mfma_f32_16x16x32_bf16 a[172:175], a[28:31], a[76:79], a[172:175]
  ds_read_b64_tr_b16 a[108:109], v21 offset:4096
  v_mfma_f32_16x16x32_bf16 v[80:83], a[0:3], a[80:83], v[80:83]
  v_mfma_f32_16x16x32_bf16 v[112:115], a[4:7], a[80:83], v[112:115]
  ds_read_b64_tr_b16 a[110:111], v21 offset:6144
  v_mfma_f32_16x16x32_bf16 v[144:147], a[8:11], a[80:83], v[144:147]
  v_mfma_f32_16x16x32_bf16 v[176:179], a[12:15], a[80:83], v[176:179]
  buffer_load_dwordx4 v53, s[8:11], s46 offen offset:1024 lds
  v_mfma_f32_16x16x32_bf16 v[208:211], a[16:19], a[80:83], v[208:211]
  ds_read_b64_tr_b16 a[112:113], v18 offset:12288
  v_mfma_f32_16x16x32_bf16 v[240:243], a[20:23], a[80:83], v[240:243]
  v_mfma_f32_16x16x32_bf16 a[144:147], a[24:27], a[80:83], a[144:147]
  ds_read_b64_tr_b16 a[114:115], v18 offset:14336
  v_mfma_f32_16x16x32_bf16 a[176:179], a[28:31], a[80:83], a[176:179]
  v_mfma_f32_16x16x32_bf16 v[84:87], a[0:3], a[84:87], v[84:87]
  ds_read_b64_tr_b16 a[116:117], v19 offset:12288
  v_mfma_f32_16x16x32_bf16 v[116:119], a[4:7], a[84:87], v[116:119]
  v_mfma_f32_16x16x32_bf16 v[148:151], a[8:11], a[84:87], v[148:151]
  buffer_load_dwordx4 v54, s[8:11], s46 offen offset:2048 lds
  ds_read_b64_tr_b16 a[118:119], v19 offset:14336
  v_mfma_f32_16x16x32_bf16 v[180:183], a[12:15], a[84:87], v[180:183]
  v_mfma_f32_16x16x32_bf16 v[212:215], a[16:19], a[84:87], v[212:215]
  v_mfma_f32_16x16x32_bf16 v[244:247], a[20:23], a[84:87], v[244:247]
  ds_read_b64_tr_b16 a[120:121], v20 offset:12288
  v_mfma_f32_16x16x32_bf16 a[148:151], a[24:27], a[84:87], a[148:151]
  v_mfma_f32_16x16x32_bf16 a[180:183], a[28:31], a[84:87], a[180:183]
  ds_read_b64_tr_b16 a[122:123], v20 offset:14336
  v_mfma_f32_16x16x32_bf16 v[88:91], a[0:3], a[88:91], v[88:91]
  v_mfma_f32_16x16x32_bf16 v[120:123], a[4:7], a[88:91], v[120:123]
  buffer_load_dwordx4 v55, s[8:11], s46 offen offset:3072 lds
  ds_read_b64_tr_b16 a[124:125], v21 offset:12288
  v_mfma_f32_16x16x32_bf16 v[152:155], a[8:11], a[88:91], v[152:155]
  s_sub_u32 s50, s50, 1
  s_cmp_eq_u32 s50, 0
  s_cselect_b32 s12, s72, s12
  s_cselect_b32 s13, s73, s13
  v_mfma_f32_16x16x32_bf16 v[184:187], a[12:15], a[88:91], v[184:187]
  s_lshl_b32 s47, s48, 19
  s_bfe_u32 s34, 0x3020106, s49
  s_add_u32 s48, s48, s34
  v_mfma_f32_16x16x32_bf16 v[216:219], a[16:19], a[88:91], v[216:219]
  s_add_u32 s49, s49, 8
  s_and_b32 s49, s49, 0x8001f
  s_and_b32 s48, s48, 7
  v_mfma_f32_16x16x32_bf16 v[248:251], a[20:23], a[88:91], v[248:251]
  s_lshl_b32 s46, s48, 7
  ds_read_b64_tr_b16 a[126:127], v21 offset:14336
  v_mfma_f32_16x16x32_bf16 a[152:155], a[24:27], a[88:91], a[152:155]
  s_add_u32 s36, s36, s38
  s_add_u32 s37, s37, 1
  s_cmp_eq_u32 s37, 3
  s_cselect_b32 s37, 0, s37
  s_cselect_b32 s38, s39, s40
  v_mfma_f32_16x16x32_bf16 a[184:187], a[28:31], a[88:91], a[184:187]
  s_add_u32 s41, s41, s43
  s_sub_u32 s43, 0, s43
  v_mfma_f32_16x16x32_bf16 v[92:95], a[0:3], a[92:95], v[92:95]
  v_add_u32 v16, s38, v16
  v_add_u32 v17, s38, v17
  v_mfma_f32_16x16x32_bf16 v[124:127], a[4:7], a[92:95], v[124:127]
  v_add_u32 v18, s43, v18
  v_add_u32 v19, s43, v19
  v_mfma_f32_16x16x32_bf16 v[156:159], a[8:11], a[92:95], v[156:159]
  v_add_u32 v20, s43, v20
  v_add_u32 v21, s43, v21
  v_mfma_f32_16x16x32_bf16 v[188:191], a[12:15], a[92:95], v[188:191]
  v_mfma_f32_16x16x32_bf16 v[220:223], a[16:19], a[92:95], v[220:223]
  v_mfma_f32_16x16x32_bf16 v[252:255], a[20:23], a[92:95], v[252:255]
  s_waitcnt vmcnt(8) lgkmcnt(0)
  s_barrier
  v_mfma_f32_16x16x32_bf16 a[156:159], a[24:27], a[92:95], a[156:159]
  s_sub_u32 s35, s35, 1
  v_mfma_f32_16x16x32_bf16 a[188:191], a[28:31], a[92:95], a[188:191]
  s_cmp_lg_u32 s35, 0
  s_cbranch_scc1 Lp1xw_loop
  v_accvgpr_read_b32 v4, a222
  v_accvgpr_read_b32 v5, a223
  v_accvgpr_read_b32 v6, a224
  v_accvgpr_read_b32 v7, a225
  v_accvgpr_read_b32 v8, a226
  v_accvgpr_read_b32 v9, a227
  v_accvgpr_read_b32 v10, a228
  v_accvgpr_read_b32 v11, a229
  s_mov_b32 s8, s64
  s_mov_b32 s9, s65
  s_mov_b32 s10, 4194304
  s_mov_b32 s11, 0x00020000
  s_mov_b32 s20, s68
  s_mov_b32 s21, s69
  s_mov_b32 s22, 8388608
  s_mov_b32 s23, 0x00020000
  s_and_b32 s4, s2, 7
  s_lshl_b32 s4, s4, 1
  s_lshr_b32 s5, s2, 6
  s_lshr_b32 s30, s2, 4
  s_add_u32 s5, s5, s30
  s_and_b32 s53, s5, 3
  s_lshl_b32 s53, s53, 3
  s_or_b32 s53, s53, 0x80000
  s_bfe_u32 s52, 0xf0f02, s53
  s_add_u32 s52, s52, s4
  s_and_b32 s52, s52, 15
  s_mov_b32 s54, s52
  s_mov_b32 s55, s53
  s_lshl_b32 s29, s52, 7
  s_lshl_b32 s28, s54, 19
  s_lshl_b32 s30, s25, 18
  s_and_b32 s31, s25, 1
  s_lshl_b32 s31, s31, 1
  s_add_u32 s31, s31, 14
  s_sub_u32 s31, s31, s25
  s_lshl_b32 s31, s31, 18
  s_or_b32 s26, s30, s29
  s_or_b32 s27, s31, s29
  s_lshl_b32 s68, s3, 12
  s_lshl_b32 s88, s3, 13
  s_add_u32 s88, s88, 98304
  v_mfma_f32_16x16x32_bf16 v[64:67], a[32:35], a[96:99], v[64:67]
  s_mov_b32 m0, s41
  ds_read_b128 a[0:3], v16 offset:0
  v_mfma_f32_16x16x32_bf16 v[96:99], a[36:39], a[96:99], v[96:99]
  buffer_load_dwordx4 v56, s[12:15], s47 offen offset:0 lds
  v_mfma_f32_16x16x32_bf16 v[128:131], a[40:43], a[96:99], v[128:131]
  ds_read_b64_tr_b16 a[64:65], v18 offset:0
  v_mfma_f32_16x16x32_bf16 v[160:163], a[44:47], a[96:99], v[160:163]
  v_mfma_f32_16x16x32_bf16 v[192:195], a[48:51], a[96:99], v[192:195]
  ds_read_b64_tr_b16 a[66:67], v18 offset:2048
  v_mfma_f32_16x16x32_bf16 v[224:227], a[52:55], a[96:99], v[224:227]
  v_mfma_f32_16x16x32_bf16 a[128:131], a[56:59], a[96:99], a[128:131]
  ds_read_b128 a[4:7], v16 offset:2048
  v_mfma_f32_16x16x32_bf16 a[160:163], a[60:63], a[96:99], a[160:163]
  buffer_load_dwordx4 v57, s[12:15], s47 offen offset:1024 lds
  v_mfma_f32_16x16x32_bf16 v[68:71], a[32:35], a[100:103], v[68:71]
  v_mfma_f32_16x16x32_bf16 v[100:103], a[36:39], a[100:103], v[100:103]
  ds_read_b128 a[8:11], v16 offset:4096
  v_mfma_f32_16x16x32_bf16 v[132:135], a[40:43], a[100:103], v[132:135]
  v_mfma_f32_16x16x32_bf16 v[164:167], a[44:47], a[100:103], v[164:167]
  ds_read_b128 a[12:15], v16 offset:6144
  v_mfma_f32_16x16x32_bf16 v[196:199], a[48:51], a[100:103], v[196:199]
  v_mfma_f32_16x16x32_bf16 v[228:231], a[52:55], a[100:103], v[228:231]
  ds_read_b128 a[16:19], v16 offset:8192
  v_mfma_f32_16x16x32_bf16 a[132:135], a[56:59], a[100:103], a[132:135]
  v_mfma_f32_16x16x32_bf16 a[164:167], a[60:63], a[100:103], a[164:167]
  buffer_load_dwordx4 v58, s[12:15], s47 offen offset:2048 lds
  ds_read_b128 a[20:23], v16 offset:10240
  v_mfma_f32_16x16x32_bf16 v[72:75], a[32:35], a[104:107], v[72:75]
  v_mfma_f32_16x16x32_bf16 v[104:107], a[36:39], a[104:107], v[104:107]
  v_mfma_f32_16x16x32_bf16 v[136:139], a[40:43], a[104:107], v[136:139]
  ds_read_b128 a[24:27], v16 offset:12288
  v_mfma_f32_16x16x32_bf16 v[168:171], a[44:47], a[104:107], v[168:171]
  v_mfma_f32_16x16x32_bf16 v[200:203], a[48:51], a[104:107], v[200:203]
  ds_read_b128 a[28:31], v16 offset:14336
  v_mfma_f32_16x16x32_bf16 v[232:235], a[52:55], a[104:107], v[232:235]
  v_mfma_f32_16x16x32_bf16 a[136:139], a[56:59], a[104:107], a[136:139]
  ds_read_b64_tr_b16 a[68:69], v19 offset:0
  v_mfma_f32_16x16x32_bf16 a[168:171], a[60:63], a[104:107], a[168:171]
  buffer_load_dwordx4 v59, s[12:15], s47 offen offset:3072 lds
  v_mfma_f32_16x16x32_bf16 v[76:79], a[32:35], a[108:111], v[76:79]
  s_add_u32 m0, s41, 4096
  ds_read_b64_tr_b16 a[70:71], v19 offset:2048
  v_mfma_f32_16x16x32_bf16 v[108:111], a[36:39], a[108:111], v[108:111]
  v_mfma_f32_16x16x32_bf16 v[140:143], a[40:43], a[108:111], v[140:143]
  v_mfma_f32_16x16x32_bf16 v[172:175], a[44:47], a[108:111], v[172:175]
  ds_read_b64_tr_b16 a[72:73], v20 offset:0
  v_mfma_f32_16x16x32_bf16 v[204:207], a[48:51], a[108:111], v[204:207]
  v_mfma_f32_16x16x32_bf16 v[236:239], a[52:55], a[108:111], v[236:239]
  ds_read_b64_tr_b16 a[74:75], v20 offset:2048
  v_mfma_f32_16x16x32_bf16 a[140:143], a[56:59], a[108:111], a[140:143]
  v_mfma_f32_16x16x32_bf16 a[172:175], a[60:63], a[108:111], a[172:175]
  buffer_load_dwordx4 v60, s[12:15], s47 offen offset:0 lds
  ds_read_b64_tr_b16 a[76:77], v21 offset:0
  v_mfma_f32_16x16x32_bf16 v[80:83], a[32:35], a[112:115], v[80:83]
  v_mfma_f32_16x16x32_bf16 v[112:115], a[36:39], a[112:115], v[112:115]
  ds_read_b64_tr_b16 a[78:79], v21 offset:2048
  v_mfma_f32_16x16x32_bf16 v[144:147], a[40:43], a[112:115], v[144:147]
  v_mfma_f32_16x16x32_bf16 v[176:179], a[44:47], a[112:115], v[176:179]
  v_mfma_f32_16x16x32_bf16 v[208:211], a[48:51], a[112:115], v[208:211]
  ds_read_b64_tr_b16 a[80:81], v18 offset:8192
  v_mfma_f32_16x16x32_bf16 v[240:243], a[52:55], a[112:115], v[240:243]
  v_mfma_f32_16x16x32_bf16 a[144:147], a[56:59], a[112:115], a[144:147]
  ds_read_b64_tr_b16 a[82:83], v18 offset:10240
  v_mfma_f32_16x16x32_bf16 a[176:179], a[60:63], a[112:115], a[176:179]
  buffer_load_dwordx4 v61, s[12:15], s47 offen offset:1024 lds
  v_mfma_f32_16x16x32_bf16 v[84:87], a[32:35], a[116:119], v[84:87]
  ds_read_b64_tr_b16 a[84:85], v19 offset:8192
  v_mfma_f32_16x16x32_bf16 v[116:119], a[36:39], a[116:119], v[116:119]
  v_mfma_f32_16x16x32_bf16 v[148:151], a[40:43], a[116:119], v[148:151]
  ds_read_b64_tr_b16 a[86:87], v19 offset:10240
  v_mfma_f32_16x16x32_bf16 v[180:183], a[44:47], a[116:119], v[180:183]
  v_mfma_f32_16x16x32_bf16 v[212:215], a[48:51], a[116:119], v[212:215]
  v_mfma_f32_16x16x32_bf16 v[244:247], a[52:55], a[116:119], v[244:247]
  ds_read_b64_tr_b16 a[88:89], v20 offset:8192
  v_mfma_f32_16x16x32_bf16 a[148:151], a[56:59], a[116:119], a[148:151]
  v_mfma_f32_16x16x32_bf16 a[180:183], a[60:63], a[116:119], a[180:183]
  buffer_load_dwordx4 v62, s[12:15], s47 offen offset:2048 lds
  ds_read_b64_tr_b16 a[90:91], v20 offset:10240
  v_mfma_f32_16x16x32_bf16 v[88:91], a[32:35], a[120:123], v[88:91]
  v_mfma_f32_16x16x32_bf16 v[120:123], a[36:39], a[120:123], v[120:123]
  ds_read_b64_tr_b16 a[92:93], v21 offset:8192
  v_mfma_f32_16x16x32_bf16 v[152:155], a[40:43], a[120:123], v[152:155]
  v_mfma_f32_16x16x32_bf16 v[184:187], a[44:47], a[120:123], v[184:187]
  ds_read_b64_tr_b16 a[94:95], v21 offset:10240
  v_mfma_f32_16x16x32_bf16 v[216:219], a[48:51], a[120:123], v[216:219]
  v_mfma_f32_16x16x32_bf16 v[248:251], a[52:55], a[120:123], v[248:251]
  v_mfma_f32_16x16x32_bf16 a[152:155], a[56:59], a[120:123], a[152:155]
  v_mfma_f32_16x16x32_bf16 a[184:187], a[60:63], a[120:123], a[184:187]
  buffer_load_dwordx4 v63, s[12:15], s47 offen offset:3072 lds
  v_mfma_f32_16x16x32_bf16 v[92:95], a[32:35], a[124:127], v[92:95]
  v_mfma_f32_16x16x32_bf16 v[124:127], a[36:39], a[124:127], v[124:127]
  v_mfma_f32_16x16x32_bf16 v[156:159], a[40:43], a[124:127], v[156:159]
  v_mfma_f32_16x16x32_bf16 v[188:191], a[44:47], a[124:127], v[188:191]
  v_mfma_f32_16x16x32_bf16 v[220:223], a[48:51], a[124:127], v[220:223]
  v_mfma_f32_16x16x32_bf16 v[252:255], a[52:55], a[124:127], v[252:255]
  v_mfma_f32_16x16x32_bf16 a[156:159], a[56:59], a[124:127], a[156:159]
  v_mfma_f32_16x16x32_bf16 a[188:191], a[60:63], a[124:127], a[188:191]
  s_waitcnt lgkmcnt(0)
  v_mfma_f32_16x16x32_bf16 v[64:67], a[0:3], a[64:67], v[64:67]
  s_mov_b32 m0, s68
  ds_read_b128 a[32:35], v17 offset:0
  v_mfma_f32_16x16x32_bf16 v[96:99], a[4:7], a[64:67], v[96:99]
  buffer_load_dwordx4 v8, s[20:23], s28 offen offset:0 lds
  v_mfma_f32_16x16x32_bf16 v[128:131], a[8:11], a[64:67], v[128:131]
  ds_read_b64_tr_b16 a[96:97], v18 offset:4096
  v_mfma_f32_16x16x32_bf16 v[160:163], a[12:15], a[64:67], v[160:163]
  v_mfma_f32_16x16x32_bf16 v[192:195], a[16:19], a[64:67], v[192:195]
  ds_read_b64_tr_b16 a[98:99], v18 offset:6144
  v_mfma_f32_16x16x32_bf16 v[224:227], a[20:23], a[64:67], v[224:227]
  v_mfma_f32_16x16x32_bf16 a[128:131], a[24:27], a[64:67], a[128:131]
  ds_read_b128 a[36:39], v17 offset:2048
  v_mfma_f32_16x16x32_bf16 a[160:163], a[28:31], a[64:67], a[160:163]
  buffer_load_dwordx4 v9, s[20:23], s28 offen offset:1024 lds
  v_mfma_f32_16x16x32_bf16 v[68:71], a[0:3], a[68:71], v[68:71]
  v_mfma_f32_16x16x32_bf16 v[100:103], a[4:7], a[68:71], v[100:103]
  ds_read_b128 a[40:43], v17 offset:4096
  v_mfma_f32_16x16x32_bf16 v[132:135], a[8:11], a[68:71], v[132:135]
  v_mfma_f32_16x16x32_bf16 v[164:167], a[12:15], a[68:71], v[164:167]
  ds_read_b128 a[44:47], v17 offset:6144
  v_mfma_f32_16x16x32_bf16 v[196:199], a[16:19], a[68:71], v[196:199]
  v_mfma_f32_16x16x32_bf16 v[228:231], a[20:23], a[68:71], v[228:231]
  ds_read_b128 a[48:51], v17 offset:8192
  v_mfma_f32_16x16x32_bf16 a[132:135], a[24:27], a[68:71], a[132:135]
  buffer_load_dwordx4 v10, s[20:23], s28 offen offset:2048 lds
  v_mfma_f32_16x16x32_bf16 a[164:167], a[28:31], a[68:71], a[164:167]
  ds_read_b128 a[52:55], v17 offset:10240
  v_mfma_f32_16x16x32_bf16 v[72:75], a[0:3], a[72:75], v[72:75]
  v_mfma_f32_16x16x32_bf16 v[104:107], a[4:7], a[72:75], v[104:107]
  v_mfma_f32_16x16x32_bf16 v[136:139], a[8:11], a[72:75], v[136:139]
  ds_read_b128 a[56:59], v17 offset:12288
  v_mfma_f32_16x16x32_bf16 v[168:171], a[12:15], a[72:75], v[168:171]
  v_mfma_f32_16x16x32_bf16 v[200:203], a[16:19], a[72:75], v[200:203]
  ds_read_b128 a[60:63], v17 offset:14336
  v_mfma_f32_16x16x32_bf16 v[232:235], a[20:23], a[72:75], v[232:235]
  buffer_load_dwordx4 v11, s[20:23], s28 offen offset:3072 lds
  v_mfma_f32_16x16x32_bf16 a[136:139], a[24:27], a[72:75], a[136:139]
  s_bfe_u32 s56, 0x302010e, s55
  s_add_u32 s54, s54, s56
  s_add_u32 s55, s55, 8
  v_mfma_f32_16x16x32_bf16 a[168:171], a[28:31], a[72:75], a[168:171]
  s_and_b32 s55, s55, 0x8001f
  s_and_b32 s54, s54, 15
  s_lshl_b32 s28, s54, 19
  v_mfma_f32_16x16x32_bf16 v[76:79], a[0:3], a[76:79], v[76:79]
  s_add_u32 m0, s68, 16384
  ds_read_b64_tr_b16 a[100:101], v19 offset:4096
  ds_read_b64_tr_b16 a[102:103], v19 offset:6144
  v_mfma_f32_16x16x32_bf16 v[108:111], a[4:7], a[76:79], v[108:111]
  v_mfma_f32_16x16x32_bf16 v[140:143], a[8:11], a[76:79], v[140:143]
  v_mfma_f32_16x16x32_bf16 v[172:175], a[12:15], a[76:79], v[172:175]
  ds_read_b64_tr_b16 a[104:105], v20 offset:4096
  v_mfma_f32_16x16x32_bf16 v[204:207], a[16:19], a[76:79], v[204:207]
  buffer_load_dwordx4 v8, s[20:23], s28 offen offset:0 lds
  v_mfma_f32_16x16x32_bf16 v[236:239], a[20:23], a[76:79], v[236:239]
  ds_read_b64_tr_b16 a[106:107], v20 offset:6144
  v_mfma_f32_16x16x32_bf16 a[140:143], a[24:27], a[76:79], a[140:143]
  v_mfma_f32_16x16x32_bf16 a[172:175], a[28:31], a[76:79], a[172:175]
  ds_read_b64_tr_b16 a[108:109], v21 offset:4096
  v_mfma_f32_16x16x32_bf16 v[80:83], a[0:3], a[80:83], v[80:83]
  v_mfma_f32_16x16x32_bf16 v[112:115], a[4:7], a[80:83], v[112:115]
  ds_read_b64_tr_b16 a[110:111], v21 offset:6144
  v_mfma_f32_16x16x32_bf16 v[144:147], a[8:11], a[80:83], v[144:147]
  v_mfma_f32_16x16x32_bf16 v[176:179], a[12:15], a[80:83], v[176:179]
  buffer_load_dwordx4 v9, s[20:23], s28 offen offset:1024 lds
  v_mfma_f32_16x16x32_bf16 v[208:211], a[16:19], a[80:83], v[208:211]
  ds_read_b64_tr_b16 a[112:113], v18 offset:12288
  v_mfma_f32_16x16x32_bf16 v[240:243], a[20:23], a[80:83], v[240:243]
  v_mfma_f32_16x16x32_bf16 a[144:147], a[24:27], a[80:83], a[144:147]
  ds_read_b64_tr_b16 a[114:115], v18 offset:14336
  v_mfma_f32_16x16x32_bf16 a[176:179], a[28:31], a[80:83], a[176:179]
  v_mfma_f32_16x16x32_bf16 v[84:87], a[0:3], a[84:87], v[84:87]
  ds_read_b64_tr_b16 a[116:117], v19 offset:12288
  v_mfma_f32_16x16x32_bf16 v[116:119], a[4:7], a[84:87], v[116:119]
  v_mfma_f32_16x16x32_bf16 v[148:151], a[8:11], a[84:87], v[148:151]
  buffer_load_dwordx4 v10, s[20:23], s28 offen offset:2048 lds
  ds_read_b64_tr_b16 a[118:119], v19 offset:14336
  v_mfma_f32_16x16x32_bf16 v[180:183], a[12:15], a[84:87], v[180:183]
  v_mfma_f32_16x16x32_bf16 v[212:215], a[16:19], a[84:87], v[212:215]
  v_mfma_f32_16x16x32_bf16 v[244:247], a[20:23], a[84:87], v[244:247]
  ds_read_b64_tr_b16 a[120:121], v20 offset:12288
  v_mfma_f32_16x16x32_bf16 a[148:151], a[24:27], a[84:87], a[148:151]
  v_mfma_f32_16x16x32_bf16 a[180:183], a[28:31], a[84:87], a[180:183]
  ds_read_b64_tr_b16 a[122:123], v20 offset:14336
  v_mfma_f32_16x16x32_bf16 v[88:91], a[0:3], a[88:91], v[88:91]
  v_mfma_f32_16x16x32_bf16 v[120:123], a[4:7], a[88:91], v[120:123]
  buffer_load_dwordx4 v11, s[20:23], s28 offen offset:3072 lds
  ds_read_b64_tr_b16 a[124:125], v21 offset:12288
  v_mfma_f32_16x16x32_bf16 v[152:155], a[8:11], a[88:91], v[152:155]
  s_bfe_u32 s56, 0x302010e, s55
  s_add_u32 s54, s54, s56
  s_add_u32 s55, s55, 8
  v_mfma_f32_16x16x32_bf16 v[184:187], a[12:15], a[88:91], v[184:187]
  s_and_b32 s55, s55, 0x8001f
  s_and_b32 s54, s54, 15
  s_lshl_b32 s28, s54, 19
  v_mfma_f32_16x16x32_bf16 v[216:219], a[16:19], a[88:91], v[216:219]
  s_add_u32 s36, s36, s38
  s_add_u32 s37, s37, 1
  ds_read_b64_tr_b16 a[126:127], v21 offset:14336
  v_mfma_f32_16x16x32_bf16 v[248:251], a[20:23], a[88:91], v[248:251]
  s_cmp_eq_u32 s37, 3
  s_cselect_b32 s37, 0, s37
  s_cselect_b32 s38, s39, s40
  v_mfma_f32_16x16x32_bf16 a[152:155], a[24:27], a[88:91], a[152:155]
  s_add_u32 s41, s41, s43
  s_sub_u32 s43, 0, s43
  v_mfma_f32_16x16x32_bf16 a[184:187], a[28:31], a[88:91], a[184:187]
  v_add_u32 v16, s38, v16
  v_add_u32 v17, s38, v17
  v_mfma_f32_16x16x32_bf16 v[92:95], a[0:3], a[92:95], v[92:95]
  v_add_u32 v18, s43, v18
  v_add_u32 v19, s43, v19
  v_mfma_f32_16x16x32_bf16 v[124:127], a[4:7], a[92:95], v[124:127]
  v_add_u32 v20, s43, v20
  v_add_u32 v21, s43, v21
  v_mfma_f32_16x16x32_bf16 v[156:159], a[8:11], a[92:95], v[156:159]
  v_mfma_f32_16x16x32_bf16 v[188:191], a[12:15], a[92:95], v[188:191]
  v_mfma_f32_16x16x32_bf16 v[220:223], a[16:19], a[92:95], v[220:223]
  v_mfma_f32_16x16x32_bf16 v[252:255], a[20:23], a[92:95], v[252:255]
  v_mfma_f32_16x16x32_bf16 a[156:159], a[24:27], a[92:95], a[156:159]
  v_mfma_f32_16x16x32_bf16 a[188:191], a[28:31], a[92:95], a[188:191]
  s_waitcnt vmcnt(8) lgkmcnt(0)
  s_barrier
  v_mfma_f32_16x16x32_bf16 v[64:67], a[32:35], a[96:99], v[64:67]
  s_mov_b32 m0, s88
  ds_read_b128 a[0:3], v16 offset:0
  v_mfma_f32_16x16x32_bf16 v[96:99], a[36:39], a[96:99], v[96:99]
  buffer_load_dwordx4 v4, s[8:11], s26 offen offset:0 lds
  v_mfma_f32_16x16x32_bf16 v[128:131], a[40:43], a[96:99], v[128:131]
  ds_read_b64_tr_b16 a[64:65], v18 offset:0
  v_mfma_f32_16x16x32_bf16 v[160:163], a[44:47], a[96:99], v[160:163]
  v_mfma_f32_16x16x32_bf16 v[192:195], a[48:51], a[96:99], v[192:195]
  ds_read_b64_tr_b16 a[66:67], v18 offset:2048
  v_mfma_f32_16x16x32_bf16 v[224:227], a[52:55], a[96:99], v[224:227]
  v_mfma_f32_16x16x32_bf16 a[128:131], a[56:59], a[96:99], a[128:131]
  ds_read_b128 a[4:7], v16 offset:2048
  v_mfma_f32_16x16x32_bf16 a[160:163], a[60:63], a[96:99], a[160:163]
  buffer_load_dwordx4 v5, s[8:11], s26 offen offset:1024 lds
  v_mfma_f32_16x16x32_bf16 v[68:71], a[32:35], a[100:103], v[68:71]
  v_mfma_f32_16x16x32_bf16 v[100:103], a[36:39], a[100:103], v[100:103]
  ds_read_b128 a[8:11], v16 offset:4096
  v_mfma_f32_16x16x32_bf16 v[132:135], a[40:43], a[100:103], v[132:135]
  v_mfma_f32_16x16x32_bf16 v[164:167], a[44:47], a[100:103], v[164:167]
  ds_read_b128 a[12:15], v16 offset:6144
  v_mfma_f32_16x16x32_bf16 v[196:199], a[48:51], a[100:103], v[196:199]
  v_mfma_f32_16x16x32_bf16 v[228:231], a[52:55], a[100:103], v[228:231]
  ds_read_b128 a[16:19], v16 offset:8192
  v_mfma_f32_16x16x32_bf16 a[132:135], a[56:59], a[100:103], a[132:135]
  v_mfma_f32_16x16x32_bf16 a[164:167], a[60:63], a[100:103], a[164:167]
  buffer_load_dwordx4 v6, s[8:11], s26 offen offset:2048 lds
  ds_read_b128 a[20:23], v16 offset:10240
  v_mfma_f32_16x16x32_bf16 v[72:75], a[32:35], a[104:107], v[72:75]
  v_mfma_f32_16x16x32_bf16 v[104:107], a[36:39], a[104:107], v[104:107]
  v_mfma_f32_16x16x32_bf16 v[136:139], a[40:43], a[104:107], v[136:139]
  ds_read_b128 a[24:27], v16 offset:12288
  v_mfma_f32_16x16x32_bf16 v[168:171], a[44:47], a[104:107], v[168:171]
  v_mfma_f32_16x16x32_bf16 v[200:203], a[48:51], a[104:107], v[200:203]
  ds_read_b128 a[28:31], v16 offset:14336
  v_mfma_f32_16x16x32_bf16 v[232:235], a[52:55], a[104:107], v[232:235]
  v_mfma_f32_16x16x32_bf16 a[136:139], a[56:59], a[104:107], a[136:139]
  ds_read_b64_tr_b16 a[68:69], v19 offset:0
  v_mfma_f32_16x16x32_bf16 a[168:171], a[60:63], a[104:107], a[168:171]
  buffer_load_dwordx4 v7, s[8:11], s26 offen offset:3072 lds
  v_mfma_f32_16x16x32_bf16 v[76:79], a[32:35], a[108:111], v[76:79]
  s_add_u32 m0, s88, 4096
  ds_read_b64_tr_b16 a[70:71], v19 offset:2048
  v_mfma_f32_16x16x32_bf16 v[108:111], a[36:39], a[108:111], v[108:111]
  v_mfma_f32_16x16x32_bf16 v[140:143], a[40:43], a[108:111], v[140:143]
  v_mfma_f32_16x16x32_bf16 v[172:175], a[44:47], a[108:111], v[172:175]
  ds_read_b64_tr_b16 a[72:73], v20 offset:0
  v_mfma_f32_16x16x32_bf16 v[204:207], a[48:51], a[108:111], v[204:207]
  v_mfma_f32_16x16x32_bf16 v[236:239], a[52:55], a[108:111], v[236:239]
  ds_read_b64_tr_b16 a[74:75], v20 offset:2048
  v_mfma_f32_16x16x32_bf16 a[140:143], a[56:59], a[108:111], a[140:143]
  v_mfma_f32_16x16x32_bf16 a[172:175], a[60:63], a[108:111], a[172:175]
  buffer_load_dwordx4 v4, s[8:11], s27 offen offset:0 lds
  ds_read_b64_tr_b16 a[76:77], v21 offset:0
  v_mfma_f32_16x16x32_bf16 v[80:83], a[32:35], a[112:115], v[80:83]
  v_mfma_f32_16x16x32_bf16 v[112:115], a[36:39], a[112:115], v[112:115]
  ds_read_b64_tr_b16 a[78:79], v21 offset:2048
  v_mfma_f32_16x16x32_bf16 v[144:147], a[40:43], a[112:115], v[144:147]
  v_mfma_f32_16x16x32_bf16 v[176:179], a[44:47], a[112:115], v[176:179]
  v_mfma_f32_16x16x32_bf16 v[208:211], a[48:51], a[112:115], v[208:211]
  ds_read_b64_tr_b16 a[80:81], v18 offset:8192
  v_mfma_f32_16x16x32_bf16 v[240:243], a[52:55], a[112:115], v[240:243]
  v_mfma_f32_16x16x32_bf16 a[144:147], a[56:59], a[112:115], a[144:147]
  ds_read_b64_tr_b16 a[82:83], v18 offset:10240
  v_mfma_f32_16x16x32_bf16 a[176:179], a[60:63], a[112:115], a[176:179]
  buffer_load_dwordx4 v5, s[8:11], s27 offen offset:1024 lds
  v_mfma_f32_16x16x32_bf16 v[84:87], a[32:35], a[116:119], v[84:87]
  ds_read_b64_tr_b16 a[84:85], v19 offset:8192
  v_mfma_f32_16x16x32_bf16 v[116:119], a[36:39], a[116:119], v[116:119]
  v_mfma_f32_16x16x32_bf16 v[148:151], a[40:43], a[116:119], v[148:151]
  ds_read_b64_tr_b16 a[86:87], v19 offset:10240
  v_mfma_f32_16x16x32_bf16 v[180:183], a[44:47], a[116:119], v[180:183]
  v_mfma_f32_16x16x32_bf16 v[212:215], a[48:51], a[116:119], v[212:215]
  v_mfma_f32_16x16x32_bf16 v[244:247], a[52:55], a[116:119], v[244:247]
  ds_read_b64_tr_b16 a[88:89], v20 offset:8192
  v_mfma_f32_16x16x32_bf16 a[148:151], a[56:59], a[116:119], a[148:151]
  v_mfma_f32_16x16x32_bf16 a[180:183], a[60:63], a[116:119], a[180:183]
  buffer_load_dwordx4 v6, s[8:11], s27 offen offset:2048 lds
  ds_read_b64_tr_b16 a[90:91], v20 offset:10240
  v_mfma_f32_16x16x32_bf16 v[88:91], a[32:35], a[120:123], v[88:91]
  v_mfma_f32_16x16x32_bf16 v[120:123], a[36:39], a[120:123], v[120:123]
  ds_read_b64_tr_b16 a[92:93], v21 offset:8192
  v_mfma_f32_16x16x32_bf16 v[152:155], a[40:43], a[120:123], v[152:155]
  v_mfma_f32_16x16x32_bf16 v[184:187], a[44:47], a[120:123], v[184:187]
  ds_read_b64_tr_b16 a[94:95], v21 offset:10240
  v_mfma_f32_16x16x32_bf16 v[216:219], a[48:51], a[120:123], v[216:219]
  v_mfma_f32_16x16x32_bf16 v[248:251], a[52:55], a[120:123], v[248:251]
  v_mfma_f32_16x16x32_bf16 a[152:155], a[56:59], a[120:123], a[152:155]
  v_mfma_f32_16x16x32_bf16 a[184:187], a[60:63], a[120:123], a[184:187]
  buffer_load_dwordx4 v7, s[8:11], s27 offen offset:3072 lds
  v_mfma_f32_16x16x32_bf16 v[92:95], a[32:35], a[124:127], v[92:95]
  s_bfe_u32 s29, 0x302010e, s53
  s_add_u32 s52, s52, s29
  s_add_u32 s53, s53, 8
  v_mfma_f32_16x16x32_bf16 v[124:127], a[36:39], a[124:127], v[124:127]
  s_and_b32 s53, s53, 0x8001f
  s_and_b32 s52, s52, 15
  s_lshl_b32 s29, s52, 7
  v_mfma_f32_16x16x32_bf16 v[156:159], a[40:43], a[124:127], v[156:159]
  s_or_b32 s26, s30, s29
  s_or_b32 s27, s31, s29
  v_mfma_f32_16x16x32_bf16 v[188:191], a[44:47], a[124:127], v[188:191]
  v_mfma_f32_16x16x32_bf16 v[220:223], a[48:51], a[124:127], v[220:223]
  v_mfma_f32_16x16x32_bf16 v[252:255], a[52:55], a[124:127], v[252:255]
  v_mfma_f32_16x16x32_bf16 a[156:159], a[56:59], a[124:127], a[156:159]
  v_mfma_f32_16x16x32_bf16 a[188:191], a[60:63], a[124:127], a[188:191]
  s_waitcnt lgkmcnt(0)
  v_mfma_f32_16x16x32_bf16 v[128:131], a[8:11], a[64:67], v[128:131]
  ds_read_b128 a[32:35], v17 offset:0
  ds_read_b64_tr_b16 a[96:97], v18 offset:4096
  v_mfma_f32_16x16x32_bf16 v[160:163], a[12:15], a[64:67], v[160:163]
  ds_read_b64_tr_b16 a[98:99], v18 offset:6144
  ds_read_b128 a[36:39], v17 offset:2048
  v_mfma_f32_16x16x32_bf16 v[132:135], a[8:11], a[68:71], v[132:135]
  ds_read_b128 a[40:43], v17 offset:4096
  ds_read_b128 a[44:47], v17 offset:6144
  v_mfma_f32_16x16x32_bf16 v[164:167], a[12:15], a[68:71], v[164:167]
  ds_read_b128 a[48:51], v17 offset:8192
  ds_read_b128 a[52:55], v17 offset:10240
  v_mfma_f32_16x16x32_bf16 v[136:139], a[8:11], a[72:75], v[136:139]
  ds_read_b128 a[56:59], v17 offset:12288
  ds_read_b128 a[60:63], v17 offset:14336
  v_mfma_f32_16x16x32_bf16 v[168:171], a[12:15], a[72:75], v[168:171]
  ds_read_b64_tr_b16 a[100:101], v19 offset:4096
  ds_read_b64_tr_b16 a[102:103], v19 offset:6144
  v_mfma_f32_16x16x32_bf16 v[140:143], a[8:11], a[76:79], v[140:143]
  ds_read_b64_tr_b16 a[104:105], v20 offset:4096
  v_mfma_f32_16x16x32_bf16 v[172:175], a[12:15], a[76:79], v[172:175]
  ds_read_b64_tr_b16 a[106:107], v20 offset:6144
  ds_read_b64_tr_b16 a[108:109], v21 offset:4096
  v_mfma_f32_16x16x32_bf16 v[144:147], a[8:11], a[80:83], v[144:147]
  ds_read_b64_tr_b16 a[110:111], v21 offset:6144
  ds_read_b64_tr_b16 a[112:113], v18 offset:12288
  v_mfma_f32_16x16x32_bf16 v[176:179], a[12:15], a[80:83], v[176:179]
  ds_read_b64_tr_b16 a[114:115], v18 offset:14336
  ds_read_b64_tr_b16 a[116:117], v19 offset:12288
  v_mfma_f32_16x16x32_bf16 v[148:151], a[8:11], a[84:87], v[148:151]
  ds_read_b64_tr_b16 a[118:119], v19 offset:14336
  ds_read_b64_tr_b16 a[120:121], v20 offset:12288
  v_mfma_f32_16x16x32_bf16 v[180:183], a[12:15], a[84:87], v[180:183]
  ds_read_b64_tr_b16 a[122:123], v20 offset:14336
  ds_read_b64_tr_b16 a[124:125], v21 offset:12288
  v_mfma_f32_16x16x32_bf16 v[152:155], a[8:11], a[88:91], v[152:155]
  ds_read_b64_tr_b16 a[126:127], v21 offset:14336
  v_mfma_f32_16x16x32_bf16 v[184:187], a[12:15], a[88:91], v[184:187]
  v_mfma_f32_16x16x32_bf16 v[156:159], a[8:11], a[92:95], v[156:159]
  v_mfma_f32_16x16x32_bf16 v[188:191], a[12:15], a[92:95], v[188:191]
  v_mfma_f32_16x16x32_bf16 v[192:195], a[16:19], a[64:67], v[192:195]
  v_mfma_f32_16x16x32_bf16 v[224:227], a[20:23], a[64:67], v[224:227]
  s_waitcnt lgkmcnt(0)
  s_barrier
  s_mov_b32 s12, s84
  s_mov_b32 s13, s85
  s_mov_b32 s14, 256
  s_mov_b32 s15, 0x00020000
  buffer_load_dwordx2 v[22:23], off, s[12:15], 0 sc1
  v_mfma_f32_16x16x32_bf16 v[128:131], a[40:43], a[96:99], v[128:131]
  s_add_u32 m0, s88, 32768
  v_mfma_f32_16x16x32_bf16 v[160:163], a[44:47], a[96:99], v[160:163]
  buffer_load_dwordx4 v4, s[8:11], s26 offen offset:0 lds
  v_mfma_f32_16x16x32_bf16 v[132:135], a[40:43], a[100:103], v[132:135]
  v_mfma_f32_16x16x32_bf16 v[164:167], a[44:47], a[100:103], v[164:167]
  v_mfma_f32_16x16x32_bf16 v[136:139], a[40:43], a[104:107], v[136:139]
  v_mfma_f32_16x16x32_bf16 v[168:171], a[44:47], a[104:107], v[168:171]
  buffer_load_dwordx4 v5, s[8:11], s26 offen offset:1024 lds
  v_cvt_pk_bf16_f32 v128, v128, v129
  v_mfma_f32_16x16x32_bf16 v[140:143], a[40:43], a[108:111], v[140:143]
  v_cvt_pk_bf16_f32 v129, v130, v131
  v_cvt_pk_bf16_f32 v130, v160, v161
  v_mfma_f32_16x16x32_bf16 v[172:175], a[44:47], a[108:111], v[172:175]
  v_cvt_pk_bf16_f32 v131, v162, v163
  v_cvt_pk_bf16_f32 v132, v132, v133
  v_mfma_f32_16x16x32_bf16 v[144:147], a[40:43], a[112:115], v[144:147]
  v_cvt_pk_bf16_f32 v133, v134, v135
  v_cvt_pk_bf16_f32 v134, v164, v165
  v_mfma_f32_16x16x32_bf16 v[176:179], a[44:47], a[112:115], v[176:179]
  v_cvt_pk_bf16_f32 v135, v166, v167
  v_mfma_f32_16x16x32_bf16 v[148:151], a[40:43], a[116:119], v[148:151]
  buffer_load_dwordx4 v6, s[8:11], s26 offen offset:2048 lds
  v_mfma_f32_16x16x32_bf16 v[180:183], a[44:47], a[116:119], v[180:183]
  s_add_u32 s60, s63, 8192
  buffer_store_dwordx4 v[128:131], v2, s[16:19], s60 offen offset:0 sc1
  v_cvt_pk_bf16_f32 v136, v136, v137
  v_mfma_f32_16x16x32_bf16 v[152:155], a[40:43], a[120:123], v[152:155]
  v_cvt_pk_bf16_f32 v137, v138, v139
  v_cvt_pk_bf16_f32 v138, v168, v169
  v_mfma_f32_16x16x32_bf16 v[184:187], a[44:47], a[120:123], v[184:187]
  v_cvt_pk_bf16_f32 v139, v170, v171
  v_cvt_pk_bf16_f32 v140, v140, v141
  v_mfma_f32_16x16x32_bf16 v[156:159], a[40:43], a[124:127], v[156:159]
  v_cvt_pk_bf16_f32 v141, v142, v143
  v_cvt_pk_bf16_f32 v142, v172, v173
  v_mfma_f32_16x16x32_bf16 v[188:191], a[44:47], a[124:127], v[188:191]
  v_cvt_pk_bf16_f32 v143, v174, v175
  v_cvt_pk_bf16_f32 v144, v144, v145
  v_mfma_f32_16x16x32_bf16 v[192:195], a[48:51], a[96:99], v[192:195]
  buffer_load_dwordx4 v7, s[8:11], s26 offen offset:3072 lds
  v_cvt_pk_bf16_f32 v145, v146, v147
  v_mfma_f32_16x16x32_bf16 v[224:227], a[52:55], a[96:99], v[224:227]
  s_add_u32 m0, s88, 36864
  v_cvt_pk_bf16_f32 v146, v176, v177
  v_cvt_pk_bf16_f32 v147, v178, v179
  v_mfma_f32_16x16x32_bf16 a[128:131], a[24:27], a[64:67], a[128:131]
  s_add_u32 s60, s63, 8192
  buffer_store_dwordx4 v[132:135], v2, s[16:19], s60 offen offset:1024 sc1
  v_cvt_pk_bf16_f32 v148, v148, v149
  v_mfma_f32_16x16x32_bf16 a[160:163], a[28:31], a[64:67], a[160:163]
  v_cvt_pk_bf16_f32 v149, v150, v151
  v_cvt_pk_bf16_f32 v150, v180, v181
  v_mfma_f32_16x16x32_bf16 a[128:131], a[56:59], a[96:99], a[128:131]
  v_cvt_pk_bf16_f32 v151, v182, v183
  v_cvt_pk_bf16_f32 v152, v152, v153
  v_mfma_f32_16x16x32_bf16 a[160:163], a[60:63], a[96:99], a[160:163]
  buffer_load_dwordx4 v4, s[8:11], s27 offen offset:0 lds
  v_cvt_pk_bf16_f32 v153, v154, v155
  v_mfma_f32_16x16x32_bf16 v[196:199], a[16:19], a[68:71], v[196:199]
  v_cvt_pk_bf16_f32 v154, v184, v185
  v_cvt_pk_bf16_f32 v155, v186, v187
  v_mfma_f32_16x16x32_bf16 v[228:231], a[20:23], a[68:71], v[228:231]
  v_cvt_pk_bf16_f32 v156, v156, v157
  v_cvt_pk_bf16_f32 v157, v158, v159
  v_mfma_f32_16x16x32_bf16 v[196:199], a[48:51], a[100:103], v[196:199]
  v_cvt_pk_bf16_f32 v158, v188, v189
  v_cvt_pk_bf16_f32 v159, v190, v191
  v_mfma_f32_16x16x32_bf16 v[228:231], a[52:55], a[100:103], v[228:231]
  v_cvt_pk_bf16_f32 v192, v192, v193
  v_cvt_pk_bf16_f32 v193, v194, v195
  v_mfma_f32_16x16x32_bf16 a[132:135], a[24:27], a[68:71], a[132:135]
  v_cvt_pk_bf16_f32 v194, v224, v225
  v_cvt_pk_bf16_f32 v195, v226, v227
  v_mfma_f32_16x16x32_bf16 a[164:167], a[28:31], a[68:71], a[164:167]
  buffer_load_dwordx4 v5, s[8:11], s27 offen offset:1024 lds
  v_mfma_f32_16x16x32_bf16 a[132:135], a[56:59], a[100:103], a[132:135]
  s_add_u32 s60, s63, 8192
  buffer_store_dwordx4 v[136:139], v2, s[16:19], s60 offen offset:2048 sc1
  v_accvgpr_read_b32 v24, a128
  v_mfma_f32_16x16x32_bf16 a[164:167], a[60:63], a[100:103], a[164:167]
  v_accvgpr_read_b32 v25, a129
  v_accvgpr_read_b32 v26, a130
  v_mfma_f32_16x16x32_bf16 v[200:203], a[16:19], a[72:75], v[200:203]
  v_accvgpr_read_b32 v27, a131
  v_accvgpr_read_b32 v28, a160
  v_mfma_f32_16x16x32_bf16 v[232:235], a[20:23], a[72:75], v[232:235]
  v_accvgpr_read_b32 v29, a161
  v_accvgpr_read_b32 v30, a162
  v_mfma_f32_16x16x32_bf16 v[200:203], a[48:51], a[104:107], v[200:203]
  buffer_load_dwordx4 v6, s[8:11], s27 offen offset:2048 lds
  v_accvgpr_read_b32 v31, a163
  v_mfma_f32_16x16x32_bf16 v[232:235], a[52:55], a[104:107], v[232:235]
  v_cvt_pk_bf16_f32 v224, v24, v25
  v_cvt_pk_bf16_f32 v225, v26, v27
  v_mfma_f32_16x16x32_bf16 a[136:139], a[24:27], a[72:75], a[136:139]
  v_cvt_pk_bf16_f32 v226, v28, v29
  v_cvt_pk_bf16_f32 v227, v30, v31
  v_mfma_f32_16x16x32_bf16 a[168:171], a[28:31], a[72:75], a[168:171]
  v_cvt_pk_bf16_f32 v196, v196, v197
  v_cvt_pk_bf16_f32 v197, v198, v199
  v_mfma_f32_16x16x32_bf16 a[136:139], a[56:59], a[104:107], a[136:139]
  v_cvt_pk_bf16_f32 v198, v228, v229
  v_cvt_pk_bf16_f32 v199, v230, v231
  v_mfma_f32_16x16x32_bf16 a[168:171], a[60:63], a[104:107], a[168:171]
  v_accvgpr_read_b32 v32, a132
  v_accvgpr_read_b32 v33, a133
  v_mfma_f32_16x16x32_bf16 v[204:207], a[16:19], a[76:79], v[204:207]
  buffer_load_dwordx4 v7, s[8:11], s27 offen offset:3072 lds
  v_accvgpr_read_b32 v34, a134
  v_mfma_f32_16x16x32_bf16 v[236:239], a[20:23], a[76:79], v[236:239]
  s_bfe_u32 s29, 0x302010e, s53
  s_add_u32 s52, s52, s29
  s_add_u32 s53, s53, 8
  v_mfma_f32_16x16x32_bf16 v[204:207], a[48:51], a[108:111], v[204:207]
  s_and_b32 s53, s53, 0x8001f
  s_and_b32 s52, s52, 15
  s_lshl_b32 s29, s52, 7
  v_mfma_f32_16x16x32_bf16 v[236:239], a[52:55], a[108:111], v[236:239]
  s_or_b32 s26, s30, s29
  s_or_b32 s27, s31, s29
  s_add_u32 m0, s68, 32768
  v_mfma_f32_16x16x32_bf16 a[140:143], a[24:27], a[76:79], a[140:143]
  v_accvgpr_read_b32 v35, a135
  v_accvgpr_read_b32 v36, a164
  v_mfma_f32_16x16x32_bf16 a[172:175], a[28:31], a[76:79], a[172:175]
  buffer_load_dwordx4 v8, s[20:23], s28 offen offset:0 lds
  v_accvgpr_read_b32 v37, a165
  v_mfma_f32_16x16x32_bf16 a[140:143], a[56:59], a[108:111], a[140:143]
  v_accvgpr_read_b32 v38, a166
  v_accvgpr_read_b32 v39, a167
  v_mfma_f32_16x16x32_bf16 a[172:175], a[60:63], a[108:111], a[172:175]
  v_cvt_pk_bf16_f32 v228, v32, v33
  v_cvt_pk_bf16_f32 v229, v34, v35
  v_mfma_f32_16x16x32_bf16 v[208:211], a[16:19], a[80:83], v[208:211]
  v_cvt_pk_bf16_f32 v230, v36, v37
  v_cvt_pk_bf16_f32 v231, v38, v39
  v_mfma_f32_16x16x32_bf16 v[240:243], a[20:23], a[80:83], v[240:243]
  s_add_u32 s60, s63, 8192
  buffer_store_dwordx4 v[140:143], v2, s[16:19], s60 offen offset:3072 sc1
  v_cvt_pk_bf16_f32 v200, v200, v201
  v_mfma_f32_16x16x32_bf16 v[208:211], a[48:51], a[112:115], v[208:211]
  v_cvt_pk_bf16_f32 v201, v202, v203
  v_cvt_pk_bf16_f32 v202, v232, v233
  v_mfma_f32_16x16x32_bf16 v[240:243], a[52:55], a[112:115], v[240:243]
  buffer_load_dwordx4 v9, s[20:23], s28 offen offset:1024 lds
  v_cvt_pk_bf16_f32 v203, v234, v235
  v_mfma_f32_16x16x32_bf16 a[144:147], a[24:27], a[80:83], a[144:147]
  v_accvgpr_read_b32 v40, a136
  v_accvgpr_read_b32 v41, a137
  v_mfma_f32_16x16x32_bf16 a[176:179], a[28:31], a[80:83], a[176:179]
  v_accvgpr_read_b32 v42, a138
  v_accvgpr_read_b32 v43, a139
  v_mfma_f32_16x16x32_bf16 a[144:147], a[56:59], a[112:115], a[144:147]
  v_accvgpr_read_b32 v44, a168
  v_accvgpr_read_b32 v45, a169
  v_mfma_f32_16x16x32_bf16 a[176:179], a[60:63], a[112:115], a[176:179]
  v_accvgpr_read_b32 v46, a170
  v_accvgpr_read_b32 v47, a171
  v_mfma_f32_16x16x32_bf16 v[212:215], a[16:19], a[84:87], v[212:215]
  buffer_load_dwordx4 v10, s[20:23], s28 offen offset:2048 lds
  v_cvt_pk_bf16_f32 v232, v40, v41
  v_mfma_f32_16x16x32_bf16 v[244:247], a[20:23], a[84:87], v[244:247]
  v_cvt_pk_bf16_f32 v233, v42, v43
  v_cvt_pk_bf16_f32 v234, v44, v45
  v_mfma_f32_16x16x32_bf16 v[212:215], a[48:51], a[116:119], v[212:215]
  v_cvt_pk_bf16_f32 v235, v46, v47
  v_cvt_pk_bf16_f32 v204, v204, v205
  v_mfma_f32_16x16x32_bf16 v[244:247], a[52:55], a[116:119], v[244:247]
  v_cvt_pk_bf16_f32 v205, v206, v207
  v_cvt_pk_bf16_f32 v206, v236, v237
  v_mfma_f32_16x16x32_bf16 a[148:151], a[24:27], a[84:87], a[148:151]
  v_cvt_pk_bf16_f32 v207, v238, v239
  v_accvgpr_read_b32 v24, a140
  v_mfma_f32_16x16x32_bf16 a[180:183], a[28:31], a[84:87], a[180:183]
  buffer_load_dwordx4 v11, s[20:23], s28 offen offset:3072 lds
  v_accvgpr_read_b32 v25, a141
  v_mfma_f32_16x16x32_bf16 a[148:151], a[56:59], a[116:119], a[148:151]
  s_bfe_u32 s56, 0x302010e, s55
  s_add_u32 s54, s54, s56
  s_add_u32 s55, s55, 8
  v_mfma_f32_16x16x32_bf16 a[180:183], a[60:63], a[116:119], a[180:183]
  s_and_b32 s55, s55, 0x8001f
  s_and_b32 s54, s54, 15
  s_lshl_b32 s28, s54, 19
  v_mfma_f32_16x16x32_bf16 v[216:219], a[16:19], a[88:91], v[216:219]
  s_add_u32 m0, s88, -32768
  v_accvgpr_read_b32 v26, a142
  v_accvgpr_read_b32 v27, a143
  v_mfma_f32_16x16x32_bf16 v[248:251], a[20:23], a[88:91], v[248:251]
  v_accvgpr_read_b32 v28, a172
  v_accvgpr_read_b32 v29, a173
  v_mfma_f32_16x16x32_bf16 v[216:219], a[48:51], a[120:123], v[216:219]
  v_accvgpr_read_b32 v30, a174
  v_accvgpr_read_b32 v31, a175
  v_mfma_f32_16x16x32_bf16 v[248:251], a[52:55], a[120:123], v[248:251]
  buffer_load_dwordx4 v4, s[8:11], s26 offen offset:0 lds
  v_cvt_pk_bf16_f32 v236, v24, v25
  v_mfma_f32_16x16x32_bf16 a[152:155], a[24:27], a[88:91], a[152:155]
  v_cvt_pk_bf16_f32 v237, v26, v27
  v_cvt_pk_bf16_f32 v238, v28, v29
  v_mfma_f32_16x16x32_bf16 a[184:187], a[28:31], a[88:91], a[184:187]
  v_cvt_pk_bf16_f32 v239, v30, v31
  v_mfma_f32_16x16x32_bf16 a[152:155], a[56:59], a[120:123], a[152:155]
  s_add_u32 s60, s63, 12288
  buffer_store_dwordx4 v[144:147], v2, s[16:19], s60 offen offset:0 sc1
  v_cvt_pk_bf16_f32 v208, v208, v209
  v_mfma_f32_16x16x32_bf16 a[184:187], a[60:63], a[120:123], a[184:187]
  v_cvt_pk_bf16_f32 v209, v210, v211
  v_cvt_pk_bf16_f32 v210, v240, v241
  v_mfma_f32_16x16x32_bf16 v[220:223], a[16:19], a[92:95], v[220:223]
  buffer_load_dwordx4 v5, s[8:11], s26 offen offset:1024 lds
  v_cvt_pk_bf16_f32 v211, v242, v243
  v_mfma_f32_16x16x32_bf16 v[252:255], a[20:23], a[92:95], v[252:255]
  v_accvgpr_read_b32 v32, a144
  v_accvgpr_read_b32 v33, a145
  v_mfma_f32_16x16x32_bf16 v[220:223], a[48:51], a[124:127], v[220:223]
  v_accvgpr_read_b32 v34, a146
  v_accvgpr_read_b32 v35, a147
  v_mfma_f32_16x16x32_bf16 v[252:255], a[52:55], a[124:127], v[252:255]
  v_accvgpr_read_b32 v36, a176
  v_accvgpr_read_b32 v37, a177
  v_mfma_f32_16x16x32_bf16 a[156:159], a[24:27], a[92:95], a[156:159]
  v_accvgpr_read_b32 v38, a178
  v_accvgpr_read_b32 v39, a179
  v_mfma_f32_16x16x32_bf16 a[188:191], a[28:31], a[92:95], a[188:191]
  v_cvt_pk_bf16_f32 v240, v32, v33
  v_cvt_pk_bf16_f32 v241, v34, v35
  v_mfma_f32_16x16x32_bf16 a[156:159], a[56:59], a[124:127], a[156:159]
  buffer_load_dwordx4 v6, s[8:11], s26 offen offset:2048 lds
  v_cvt_pk_bf16_f32 v242, v36, v37
  v_mfma_f32_16x16x32_bf16 a[188:191], a[60:63], a[124:127], a[188:191]
  v_cvt_pk_bf16_f32 v243, v38, v39
  v_cvt_pk_bf16_f32 v212, v212, v213
  v_mfma_f32_16x16x32_bf16 v[64:67], a[0:3], a[64:67], v[64:67]
  v_cvt_pk_bf16_f32 v213, v214, v215
  v_cvt_pk_bf16_f32 v214, v244, v245
  v_mfma_f32_16x16x32_bf16 v[96:99], a[4:7], a[64:67], v[96:99]
  v_cvt_pk_bf16_f32 v215, v246, v247
  v_mfma_f32_16x16x32_bf16 v[64:67], a[32:35], a[96:99], v[64:67]
  s_add_u32 s60, s63, 12288
  buffer_store_dwordx4 v[148:151], v2, s[16:19], s60 offen offset:1024 sc1
  v_accvgpr_read_b32 v40, a148
  v_mfma_f32_16x16x32_bf16 v[96:99], a[36:39], a[96:99], v[96:99]
  buffer_load_dwordx4 v7, s[8:11], s26 offen offset:3072 lds
  v_accvgpr_read_b32 v41, a149
  v_mfma_f32_16x16x32_bf16 v[68:71], a[0:3], a[68:71], v[68:71]
  s_add_u32 m0, s88, -28672
  v_accvgpr_read_b32 v42, a150
  v_accvgpr_read_b32 v43, a151
  v_mfma_f32_16x16x32_bf16 v[100:103], a[4:7], a[68:71], v[100:103]
  v_accvgpr_read_b32 v44, a180
  v_accvgpr_read_b32 v45, a181
  v_mfma_f32_16x16x32_bf16 v[68:71], a[32:35], a[100:103], v[68:71]
  v_accvgpr_read_b32 v46, a182
  v_accvgpr_read_b32 v47, a183
  v_mfma_f32_16x16x32_bf16 v[100:103], a[36:39], a[100:103], v[100:103]
  v_cvt_pk_bf16_f32 v244, v40, v41
  v_cvt_pk_bf16_f32 v245, v42, v43
  v_mfma_f32_16x16x32_bf16 v[72:75], a[0:3], a[72:75], v[72:75]
  v_cvt_pk_bf16_f32 v246, v44, v45
  v_cvt_pk_bf16_f32 v247, v46, v47
  v_mfma_f32_16x16x32_bf16 v[104:107], a[4:7], a[72:75], v[104:107]
  buffer_load_dwordx4 v4, s[8:11], s27 offen offset:0 lds
  v_cvt_pk_bf16_f32 v216, v216, v217
  v_mfma_f32_16x16x32_bf16 v[72:75], a[32:35], a[104:107], v[72:75]
  v_cvt_pk_bf16_f32 v217, v218, v219
  v_cvt_pk_bf16_f32 v218, v248, v249
  v_mfma_f32_16x16x32_bf16 v[104:107], a[36:39], a[104:107], v[104:107]
  v_cvt_pk_bf16_f32 v219, v250, v251
  v_accvgpr_read_b32 v24, a152
  v_mfma_f32_16x16x32_bf16 v[76:79], a[0:3], a[76:79], v[76:79]
  v_accvgpr_read_b32 v25, a153
  v_accvgpr_read_b32 v26, a154
  v_mfma_f32_16x16x32_bf16 v[108:111], a[4:7], a[76:79], v[108:111]
  v_accvgpr_read_b32 v27, a155
  v_accvgpr_read_b32 v28, a184
  v_mfma_f32_16x16x32_bf16 v[76:79], a[32:35], a[108:111], v[76:79]
  buffer_load_dwordx4 v5, s[8:11], s27 offen offset:1024 lds
  v_accvgpr_read_b32 v29, a185
  v_mfma_f32_16x16x32_bf16 v[108:111], a[36:39], a[108:111], v[108:111]
  v_accvgpr_read_b32 v30, a186
  v_accvgpr_read_b32 v31, a187
  v_mfma_f32_16x16x32_bf16 v[80:83], a[0:3], a[80:83], v[80:83]
  v_cvt_pk_bf16_f32 v248, v24, v25
  v_cvt_pk_bf16_f32 v249, v26, v27
  v_mfma_f32_16x16x32_bf16 v[112:115], a[4:7], a[80:83], v[112:115]
  v_cvt_pk_bf16_f32 v250, v28, v29
  v_cvt_pk_bf16_f32 v251, v30, v31
  v_mfma_f32_16x16x32_bf16 v[80:83], a[32:35], a[112:115], v[80:83]
  v_cvt_pk_bf16_f32 v220, v220, v221
  v_cvt_pk_bf16_f32 v221, v222, v223
  v_mfma_f32_16x16x32_bf16 v[112:115], a[36:39], a[112:115], v[112:115]
  v_cvt_pk_bf16_f32 v222, v252, v253
  v_cvt_pk_bf16_f32 v223, v254, v255
  v_mfma_f32_16x16x32_bf16 v[84:87], a[0:3], a[84:87], v[84:87]
  buffer_load_dwordx4 v6, s[8:11], s27 offen offset:2048 lds
  v_mfma_f32_16x16x32_bf16 v[116:119], a[4:7], a[84:87], v[116:119]
  s_add_u32 s60, s63, 12288
  buffer_store_dwordx4 v[152:155], v2, s[16:19], s60 offen offset:2048 sc1
  v_accvgpr_read_b32 v32, a156
  v_mfma_f32_16x16x32_bf16 v[84:87], a[32:35], a[116:119], v[84:87]
  v_accvgpr_read_b32 v33, a157
  v_accvgpr_read_b32 v34, a158
  v_mfma_f32_16x16x32_bf16 v[116:119], a[36:39], a[116:119], v[116:119]
  v_accvgpr_read_b32 v35, a159
  v_accvgpr_read_b32 v36, a188
  v_mfma_f32_16x16x32_bf16 v[88:91], a[0:3], a[88:91], v[88:91]
  v_accvgpr_read_b32 v37, a189
  v_accvgpr_read_b32 v38, a190
  v_mfma_f32_16x16x32_bf16 v[120:123], a[4:7], a[88:91], v[120:123]
  buffer_load_dwordx4 v7, s[8:11], s27 offen offset:3072 lds
  v_accvgpr_read_b32 v39, a191
  v_mfma_f32_16x16x32_bf16 v[88:91], a[32:35], a[120:123], v[88:91]
  s_bfe_u32 s29, 0x302010e, s53
  s_add_u32 s52, s52, s29
  s_add_u32 s53, s53, 8
  v_mfma_f32_16x16x32_bf16 v[120:123], a[36:39], a[120:123], v[120:123]
  s_and_b32 s53, s53, 0x8001f
  s_and_b32 s52, s52, 15
  s_lshl_b32 s29, s52, 7
  v_mfma_f32_16x16x32_bf16 v[92:95], a[0:3], a[92:95], v[92:95]
  s_or_b32 s26, s30, s29
  s_or_b32 s27, s31, s29
  v_cvt_pk_bf16_f32 v252, v32, v33
  v_mfma_f32_16x16x32_bf16 v[124:127], a[4:7], a[92:95], v[124:127]
  v_cvt_pk_bf16_f32 v253, v34, v35
  v_cvt_pk_bf16_f32 v254, v36, v37
  v_mfma_f32_16x16x32_bf16 v[92:95], a[32:35], a[124:127], v[92:95]
  v_cvt_pk_bf16_f32 v255, v38, v39
  v_cvt_pk_bf16_f32 v160, v64, v65
  v_mfma_f32_16x16x32_bf16 v[124:127], a[36:39], a[124:127], v[124:127]
  v_cvt_pk_bf16_f32 v161, v66, v67
  v_cvt_pk_bf16_f32 v162, v96, v97
  v_cvt_pk_bf16_f32 v163, v98, v99
  v_cvt_pk_bf16_f32 v164, v68, v69
  v_cvt_pk_bf16_f32 v165, v70, v71
  v_cvt_pk_bf16_f32 v166, v100, v101
  v_cvt_pk_bf16_f32 v167, v102, v103
  s_add_u32 s60, s63, 12288
  buffer_store_dwordx4 v[156:159], v2, s[16:19], s60 offen offset:3072 sc1
  v_cvt_pk_bf16_f32 v168, v72, v73
  v_cvt_pk_bf16_f32 v169, v74, v75
  v_cvt_pk_bf16_f32 v170, v104, v105
  v_cvt_pk_bf16_f32 v171, v106, v107
  v_cvt_pk_bf16_f32 v172, v76, v77
  v_cvt_pk_bf16_f32 v173, v78, v79
  v_cvt_pk_bf16_f32 v174, v108, v109
  v_cvt_pk_bf16_f32 v175, v110, v111
  v_cvt_pk_bf16_f32 v176, v80, v81
  v_cvt_pk_bf16_f32 v177, v82, v83
  v_cvt_pk_bf16_f32 v178, v112, v113
  v_cvt_pk_bf16_f32 v179, v114, v115
  v_cvt_pk_bf16_f32 v180, v84, v85
  v_cvt_pk_bf16_f32 v181, v86, v87
  v_cvt_pk_bf16_f32 v182, v116, v117
  v_cvt_pk_bf16_f32 v183, v118, v119
  v_cvt_pk_bf16_f32 v184, v88, v89
  v_cvt_pk_bf16_f32 v185, v90, v91
  v_cvt_pk_bf16_f32 v186, v120, v121
  v_cvt_pk_bf16_f32 v187, v122, v123
  v_cvt_pk_bf16_f32 v188, v92, v93
  v_cvt_pk_bf16_f32 v189, v94, v95
  v_cvt_pk_bf16_f32 v190, v124, v125
  v_cvt_pk_bf16_f32 v191, v126, v127
  s_lshl_b32 s34, s62, 4
  s_add_u32 s34, s34, s61
  s_lshl_b32 s34, s34, 7
  s_branch Lp3
Lp2:
  s_and_b32 s4, s2, 1
  s_lshl_b32 s4, s4, 2
  s_and_b32 s5, s59, 3
  s_add_u32 s32, s4, s5
  s_bfe_u32 s4, s2, 0x20001
  s_lshl_b32 s4, s4, 2
  s_lshr_b32 s5, s59, 2
  s_add_u32 s33, s4, s5
  s_and_b32 s4, s2, 7
  s_lshl_b32 s4, s4, 1
  s_add_u32 s5, s32, s33
  s_and_b32 s49, s5, 3
  s_lshl_b32 s49, s49, 3
  s_or_b32 s49, s49, 0x80000
  s_bfe_u32 s48, 0xf0f02, s49
  s_add_u32 s48, s48, s4
  s_and_b32 s48, s48, 15
  s_lshl_b32 s46, s48, 7
  s_lshl_b32 s36, s3, 13
  s_mul_i32 s41, s3, 6144
  s_add_u32 s41, s41, 104448
  s_mul_i32 s4, s3, 7168
  s_sub_u32 s50, 32768, s4
  v_lshrrev_b32 v240, 3, v1
  v_and_b32 v241, 6, v240
  v_and_b32 v242, 7, v1
  v_xor_b32 v241, v241, v242
  v_lshlrev_b32 v241, 4, v241
  s_lshl_b32 s4, s3, 6
  s_add_u32 s4, s4, 16
  v_add_u32 v242, s4, v240
  v_lshl_add_u32 v242, v242, 11, v241
  v_add_u32 v224, 0, v242
  v_add_u32 v225, 15360, v242
  v_add_u32 v226, 30720, v242
  v_add_u32 v227, 46080, v242
  v_add_u32 v228, 65536, v242
  v_add_u32 v229, 80896, v242
  v_add_u32 v230, 96256, v242
  v_add_u32 v231, 111616, v242
  s_lshl_b32 s4, s3, 14
  s_cmp_eq_u32 s32, 0
  s_cselect_b32 s4, 0x40000000, s4
  v_lshl_add_u32 v242, v240, 11, v241
  v_add_u32 v232, s4, v242
  v_lshrrev_b32 v242, 2, v240
  v_and_b32 v243, 3, v240
  v_lshl_add_u32 v242, v242, 3, v243
  v_mul_u32_u24 v242, 6144, v242
  v_add_u32 v242, v242, v241
  s_lshl_b32 s4, s33, 7
  v_add_u32 v242, s4, v242
  s_mul_i32 s6, s3, 6
  s_add_u32 s7, s6, 0
  s_bfe_u32 s4, s7, 0x10002
  s_lshl_b32 s4, s4, 5
  s_and_b32 s5, s7, 1
  s_lshl_b32 s5, s5, 4
  s_add_u32 s4, s4, s5
  s_bfe_u32 s5, s7, 0x10001
  s_lshl_b32 s5, s5, 2
  s_add_u32 s4, s4, s5
  s_mul_i32 s4, s4, 6144
  s_lshr_b32 s5, s7, 3
  s_lshl_b32 s5, s5, 11
  s_add_u32 s4, s4, s5
  s_add_u32 s4, s4, 2048
  v_add_u32 v233, s4, v242
  s_add_u32 s7, s6, 1
  s_bfe_u32 s4, s7, 0x10002
  s_lshl_b32 s4, s4, 5
  s_and_b32 s5, s7, 1
  s_lshl_b32 s5, s5, 4
  s_add_u32 s4, s4, s5
  s_bfe_u32 s5, s7, 0x10001
  s_lshl_b32 s5, s5, 2
  s_add_u32 s4, s4, s5
  s_mul_i32 s4, s4, 6144
  s_lshr_b32 s5, s7, 3
  s_lshl_b32 s5, s5, 11
  s_add_u32 s4, s4, s5
  s_add_u32 s4, s4, 1024
  v_add_u32 v234, s4, v242
  s_add_u32 s7, s6, 2
  s_bfe_u32 s4, s7, 0x10002
  s_lshl_b32 s4, s4, 5
  s_and_b32 s5, s7, 1
  s_lshl_b32 s5, s5, 4
  s_add_u32 s4, s4, s5
  s_bfe_u32 s5, s7, 0x10001
  s_lshl_b32 s5, s5, 2
  s_add_u32 s4, s4, s5
  s_mul_i32 s4, s4, 6144
  s_lshr_b32 s5, s7, 3
  s_lshl_b32 s5, s5, 11
  s_add_u32 s4, s4, s5
  s_add_u32 s4, s4, 0
  v_add_u32 v235, s4, v242
  s_add_u32 s7, s6, 3
  s_bfe_u32 s4, s7, 0x10002
  s_lshl_b32 s4, s4, 5
  s_and_b32 s5, s7, 1
  s_lshl_b32 s5, s5, 4
  s_add_u32 s4, s4, s5
  s_bfe_u32 s5, s7, 0x10001
  s_lshl_b32 s5, s5, 2
  s_add_u32 s4, s4, s5
  s_mul_i32 s4, s4, 6144
  s_lshr_b32 s5, s7, 3
  s_lshl_b32 s5, s5, 11
  s_add_u32 s4, s4, s5
  s_add_u32 s4, s4, 2048
  v_add_u32 v236, s4, v242
  s_add_u32 s7, s6, 4
  s_bfe_u32 s4, s7, 0x10002
  s_lshl_b32 s4, s4, 5
  s_and_b32 s5, s7, 1
  s_lshl_b32 s5, s5, 4
  s_add_u32 s4, s4, s5
  s_bfe_u32 s5, s7, 0x10001
  s_lshl_b32 s5, s5, 2
  s_add_u32 s4, s4, s5
  s_mul_i32 s4, s4, 6144
  s_lshr_b32 s5, s7, 3
  s_lshl_b32 s5, s5, 11
  s_add_u32 s4, s4, s5
  s_add_u32 s4, s4, 1024
  v_add_u32 v237, s4, v242
  s_add_u32 s7, s6, 5
  s_bfe_u32 s4, s7, 0x10002
  s_lshl_b32 s4, s4, 5
  s_and_b32 s5, s7, 1
  s_lshl_b32 s5, s5, 4
  s_add_u32 s4, s4, s5
  s_bfe_u32 s5, s7, 0x10001
  s_lshl_b32 s5, s5, 2
  s_add_u32 s4, s4, s5
  s_mul_i32 s4, s4, 6144
  s_lshr_b32 s5, s7, 3
  s_lshl_b32 s5, s5, 11
  s_add_u32 s4, s4, s5
  s_add_u32 s4, s4, 0
  v_add_u32 v238, s4, v242
  s_waitcnt lgkmcnt(0)
  s_lshl_b32 s10, s32, 19
  s_add_u32 s8, s76, s10
  s_addc_u32 s9, s77, 0
  s_sub_u32 s8, s8, 32768
  s_subb_u32 s9, s9, 0
  s_mov_b32 s10, 557056
  s_mov_b32 s11, 0x00020000
  s_sub_u32 s12, s78, 2048
  s_subb_u32 s13, s79, 0
  s_mov_b32 s14, 6293504
  s_mov_b32 s15, 0x00020000
  s_add_u32 s96, s86, 125829120
  s_addc_u32 s97, s87, 0
  s_mov_b32 s98, 262144
  s_mov_b32 s99, 0x00020000
  s_cmp_ge_u32 s3, 2
  s_cbranch_scc1 Lp2_r1
  s_and_b32 s4, s2, 7
  s_lshl_b32 s4, s4, 4
  s_add_u32 s4, s4, s59
  s_lshl_b32 s4, s4, 2
  s_add_u32 s4, s4, s3
  s_lshl_b32 s51, s4, 13
  s_add_u32 m0, s36, s50
  s_nop 0
  buffer_load_dwordx4 v232, s[8:11], s46 offen offset:0 lds
  s_mov_b32 m0, s36
  s_nop 0
  buffer_load_dwordx4 v224, s[8:11], s46 offen offset:0 lds
  buffer_load_dwordx4 v225, s[8:11], s46 offen offset:1024 lds
  buffer_load_dwordx4 v226, s[8:11], s46 offen offset:2048 lds
  buffer_load_dwordx4 v227, s[8:11], s46 offen offset:3072 lds
  s_add_u32 m0, s36, 4096
  s_nop 0
  buffer_load_dwordx4 v228, s[8:11], s46 offen offset:0 lds
  buffer_load_dwordx4 v229, s[8:11], s46 offen offset:1024 lds
  buffer_load_dwordx4 v230, s[8:11], s46 offen offset:2048 lds
  buffer_load_dwordx4 v231, s[8:11], s46 offen offset:3072 lds
  s_mul_i32 s47, s48, 393216
  s_bfe_u32 s34, 0x302010e, s49
  s_add_u32 s48, s48, s34
  s_add_u32 s49, s49, 8
  s_and_b32 s49, s49, 0x8001f
  s_and_b32 s48, s48, 15
  s_lshl_b32 s46, s48, 7
  s_mov_b32 m0, s41
  s_nop 0
  buffer_load_dwordx4 v233, s[12:15], s47 offen offset:0 lds
  buffer_load_dwordx4 v234, s[12:15], s47 offen offset:1024 lds
  buffer_load_dwordx4 v235, s[12:15], s47 offen offset:2048 lds
  s_add_u32 m0, s41, 3072
  s_nop 0
  buffer_load_dwordx4 v236, s[12:15], s47 offen offset:0 lds
  buffer_load_dwordx4 v237, s[12:15], s47 offen offset:1024 lds
  buffer_load_dwordx4 v238, s[12:15], s47 offen offset:2048 lds
  s_lshr_b32 s4, s3, 1
  s_lshl_b32 s4, s4, 14
  v_and_b32 v240, 15, v1
  v_lshlrev_b32 v240, 7, v240
  v_lshrrev_b32 v241, 4, v1
  v_and_b32 v242, 6, v1
  v_xor_b32 v241, v241, v242
  v_lshl_add_u32 v240, v241, 4, v240
  v_add_u32 v16, s4, v240
  v_xor_b32 v17, 64, v16
  v_and_b32 v240, 15, v1
  v_lshlrev_b32 v240, 7, v240
  v_lshrrev_b32 v241, 4, v1
  v_and_b32 v242, 6, v1
  v_xor_b32 v241, v241, v242
  v_lshl_add_u32 v240, v241, 4, v240
  v_add_u32 v18, 32768, v240
  v_xor_b32 v19, 64, v18
  v_lshrrev_b32 v240, 2, v1
  v_and_b32 v241, 6, v240
  v_lshlrev_b32 v240, 7, v240
  v_and_b32 v242, 1, v1
  v_lshl_add_u32 v240, v242, 3, v240
  v_add_u32 v240, 104448, v240
  v_bfe_u32 v242, v1, 1, 1
  v_xor_b32 v241, v241, v242
  v_xor_b32 v242, 0, v241
  v_lshl_add_u32 v20, v242, 4, v240
  v_xor_b32 v242, 2, v241
  v_lshl_add_u32 v21, v242, 4, v240
  s_and_b32 s4, s3, 1
  s_lshl_b32 s4, s4, 6
  v_xor_b32 v20, s4, v20
  v_xor_b32 v21, s4, v21
  s_and_b32 s24, s2, 7
  s_lshr_b32 s4, s2, 6
  s_lshl_b32 s4, s4, 3
  s_add_u32 s24, s24, s4
  s_lshr_b32 s4, s2, 3
  s_and_b32 s25, s4, 6
  s_xor_b32 s4, s4, s2
  s_bfe_u32 s4, s4, 0x10003
  s_add_u32 s25, s25, s4
  v_accvgpr_write_b32 a244, -1
  v_accvgpr_write_b32 a245, -1
  v_accvgpr_write_b32 a246, -1
  v_accvgpr_write_b32 a247, -1
  v_lshrrev_b32 v24, 3, v1
  v_and_b32 v25, 6, v24
  v_and_b32 v26, 7, v1
  v_xor_b32 v25, v25, v26
  v_lshlrev_b32 v25, 4, v25
  s_and_b32 s4, s3, 1
  s_lshl_b32 s4, s4, 16
  s_lshr_b32 s5, s3, 1
  s_lshl_b32 s5, s5, 7
  s_add_u32 s4, s4, s5
  v_lshl_add_u32 v24, v24, 11, v25
  v_add_u32 v24, s4, v24
  v_add_u32 v25, 0, v24
  v_accvgpr_write_b32 a212, v25
  v_add_u32 v25, 15360, v24
  v_accvgpr_write_b32 a213, v25
  v_add_u32 v25, 30720, v24
  v_accvgpr_write_b32 a214, v25
  v_add_u32 v25, 46080, v24
  v_accvgpr_write_b32 a215, v25
  v_accvgpr_write_b32 a236, 0
  v_mov_b32 v27, 0x3f803f80
  v_accvgpr_write_b32 a208, v27
  v_accvgpr_write_b32 a237, 0
  v_accvgpr_write_b32 a209, v27
  v_accvgpr_write_b32 a238, 0
  v_accvgpr_write_b32 a210, v27
  v_accvgpr_write_b32 a239, 0
  v_accvgpr_write_b32 a211, v27
  v_lshrrev_b32 v24, 3, v1
  v_and_b32 v25, 6, v24
  v_and_b32 v26, 7, v1
  v_xor_b32 v25, v25, v26
  v_lshlrev_b32 v25, 4, v25
  v_lshlrev_b32 v26, 2, v24
  v_add_u32 v26, s3, v26
  v_lshl_add_u32 v26, v26, 11, v25
  v_add_u32 v27, 0, v26
  v_accvgpr_write_b32 a222, v27
  v_add_u32 v27, 64512, v26
  v_accvgpr_write_b32 a223, v27
  v_add_u32 v27, 129024, v26
  v_accvgpr_write_b32 a224, v27
  v_add_u32 v27, 193536, v26
  v_accvgpr_write_b32 a225, v27
  v_lshrrev_b32 v26, 2, v24
  v_and_b32 v27, 3, v24
  v_lshl_add_u32 v26, v26, 3, v27
  s_and_b32 s4, s3, 1
  s_lshl_b32 s4, s4, 18
  s_lshr_b32 s5, s3, 1
  s_lshl_b32 s5, s5, 7
  s_add_u32 s4, s4, s5
  s_lshl_b32 s5, s24, 8
  s_add_u32 s4, s4, s5
  v_lshl_add_u32 v26, v26, 13, v25
  v_add_u32 v26, s4, v26
  v_add_u32 v27, 0, v26
  v_accvgpr_write_b32 a226, v27
  v_add_u32 v27, 130048, v26
  v_accvgpr_write_b32 a227, v27
  v_add_u32 v27, 30720, v26
  v_accvgpr_write_b32 a228, v27
  v_add_u32 v27, 160768, v26
  v_accvgpr_write_b32 a229, v27
  s_lshl_b32 s4, s3, 13
  s_add_u32 s4, s4, 98304
  v_and_b32 v24, 15, v1
  v_lshlrev_b32 v24, 7, v24
  v_lshrrev_b32 v25, 4, v1
  v_and_b32 v26, 6, v1
  v_xor_b32 v25, v25, v26
  v_lshl_add_u32 v24, v25, 4, v24
  v_add_u32 v28, s4, v24
  v_xor_b32 v29, 64, v28
  v_lshrrev_b32 v24, 2, v1
  v_and_b32 v25, 6, v24
  v_lshlrev_b32 v24, 7, v24
  v_and_b32 v26, 1, v1
  v_lshl_add_u32 v24, v26, 3, v24
  v_add_u32 v24, 0, v24
  v_bfe_u32 v26, v1, 1, 1
  v_xor_b32 v25, v25, v26
  v_xor_b32 v26, 0, v25
  v_lshl_add_u32 v30, v26, 4, v24
  v_xor_b32 v26, 2, v25
  v_lshl_add_u32 v31, v26, 4, v24
  v_xor_b32 v26, 4, v25
  v_lshl_add_u32 v32, v26, 4, v24
  v_xor_b32 v26, 6, v25
  v_lshl_add_u32 v33, v26, 4, v24
  v_accvgpr_write_b32 a230, v28
  v_accvgpr_write_b32 a231, v29
  v_accvgpr_write_b32 a232, v30
  v_accvgpr_write_b32 a233, v31
  v_accvgpr_write_b32 a234, v32
  v_accvgpr_write_b32 a235, v33
  v_and_b32 v253, 15, v1
  v_lshrrev_b32 v254, 4, v1
  v_lshlrev_b32 v254, 2, v254
  v_sub_u32 v253, v253, v254
  v_mov_b32 v254, 0xf149f2ca
  s_lshr_b32 s4, s3, 1
  s_or_b32 s4, s4, s32
  s_cselect_b64 s[6:7], 0, -1
  v_subrev_u32 v255, 0, v253
  v_and_b32 v252, 0x80000001, v255
  v_cmp_ne_u32 vcc, 0, v252
  s_nop 1
  v_cndmask_b32 v244, 0, v254, vcc
  v_add_u32 v255, 1, v255
  v_and_b32 v252, 0x80000001, v255
  v_cmp_ne_u32 vcc, 0x80000001, v252
  s_nop 1
  v_cndmask_b32 v240, 0, v254, vcc
  v_cndmask_b32 v248, v240, v254, s[6:7]
  v_subrev_u32 v255, 1, v253
  v_and_b32 v252, 0x80000001, v255
  v_cmp_ne_u32 vcc, 0, v252
  s_nop 1
  v_cndmask_b32 v245, 0, v254, vcc
  v_add_u32 v255, 1, v255
  v_and_b32 v252, 0x80000001, v255
  v_cmp_ne_u32 vcc, 0x80000001, v252
  s_nop 1
  v_cndmask_b32 v241, 0, v254, vcc
  v_cndmask_b32 v249, v241, v254, s[6:7]
  v_subrev_u32 v255, 2, v253
  v_and_b32 v252, 0x80000001, v255
  v_cmp_ne_u32 vcc, 0, v252
  s_nop 1
  v_cndmask_b32 v246, 0, v254, vcc
  v_add_u32 v255, 1, v255
  v_and_b32 v252, 0x80000001, v255
  v_cmp_ne_u32 vcc, 0x80000001, v252
  s_nop 1
  v_cndmask_b32 v242, 0, v254, vcc
  v_cndmask_b32 v250, v242, v254, s[6:7]
  v_subrev_u32 v255, 3, v253
  v_and_b32 v252, 0x80000001, v255
  v_cmp_ne_u32 vcc, 0, v252
  s_nop 1
  v_cndmask_b32 v247, 0, v254, vcc
  v_add_u32 v255, 1, v255
  v_and_b32 v252, 0x80000001, v255
  v_cmp_ne_u32 vcc, 0x80000001, v252
  s_nop 1
  v_cndmask_b32 v243, 0, v254, vcc
  v_cndmask_b32 v251, v243, v254, s[6:7]
  s_and_b32 s4, s3, 1
  s_lshl_b32 s4, s4, 12
  s_add_u32 s4, s4, 49152
  v_add_u32 v252, s4, v2
  s_lshr_b32 s5, s3, 1
  s_lshl_b32 s5, s5, 11
  v_add_u32 v253, s5, v252
  s_add_u32 s16, s86, 83886080
  s_addc_u32 s17, s87, 0
  s_mov_b32 s18, 4194304
  s_mov_b32 s19, 0x00020000
  s_lshl_b32 s57, s32, 19
  s_lshl_b32 s5, s5, 7
  s_add_u32 s57, s57, s5
  s_lshl_b32 s4, s33, 14
  s_add_u32 s57, s57, s4
  s_and_b32 s4, s3, 1
  s_lshl_b32 s4, s4, 13
  s_add_u32 s57, s57, s4
  s_add_u32 s58, s57, 4096
  s_mov_b32 s37, 0
  s_mov_b32 s39, 4294897664
  s_mov_b32 s40, 34816
  s_mov_b32 s42, 0
  s_mov_b32 s44, 4294942720
  s_mov_b32 s45, 24576
  s_mov_b32 s43, s44
  s_mov_b32 s52, s72
  s_mov_b32 s53, s73
  s_mov_b32 s54, 4194304
  s_mov_b32 s55, 0x00020000
  s_lshl_b32 s1, s51, 1
  s_mov_b32 s56, s51
  s_mov_b32 s0, 0
  s_waitcnt vmcnt(0)
  s_barrier
  ds_read_b128 a[0:3], v16 offset:0
  ds_read_b64_tr_b16 a[72:73], v20 offset:0
  ds_read_b64_tr_b16 a[74:75], v20 offset:2048
  ds_read_b128 a[4:7], v16 offset:2048
  ds_read_b128 a[8:11], v16 offset:4096
  ds_read_b128 a[12:15], v16 offset:6144
  ds_read_b128 a[16:19], v16 offset:8192
  ds_read_b128 a[20:23], v16 offset:10240
  ds_read_b128 a[24:27], v16 offset:12288
  ds_read_b128 a[28:31], v16 offset:14336
  ds_read_b64_tr_b16 a[76:77], v21 offset:0
  ds_read_b64_tr_b16 a[78:79], v21 offset:2048
  ds_read_b64_tr_b16 a[80:81], v20 offset:8192
  ds_read_b64_tr_b16 a[82:83], v20 offset:10240
  ds_read_b128 a[32:35], v18 offset:0
  ds_read_b64_tr_b16 a[84:85], v21 offset:8192
  ds_read_b64_tr_b16 a[86:87], v21 offset:10240
  ds_read_b64_tr_b16 a[88:89], v20 offset:16384
  ds_read_b64_tr_b16 a[90:91], v20 offset:18432
  ds_read_b64_tr_b16 a[92:93], v21 offset:16384
  ds_read_b64_tr_b16 a[94:95], v21 offset:18432
  s_waitcnt lgkmcnt(0)
  v_mfma_f32_16x16x32_bf16 v[24:27], a[72:75], a[0:3], 0
  s_add_u32 m0, s36, s50
  s_add_u32 m0, m0, 34816
  ds_read_b128 a[36:39], v17 offset:0
  v_mfma_f32_16x16x32_bf16 v[28:31], a[72:75], a[4:7], 0
  buffer_load_dwordx4 v232, s[8:11], s46 offen offset:0 lds
  ds_read_b64_tr_b16 a[96:97], v20 offset:4096
  v_mfma_f32_16x16x32_bf16 v[32:35], a[72:75], a[8:11], 0
  s_add_u32 m0, s36, 34816
  v_mfma_f32_16x16x32_bf16 v[36:39], a[72:75], a[12:15], 0
  buffer_load_dwordx4 v224, s[8:11], s46 offen offset:0 lds
  ds_read_b64_tr_b16 a[98:99], v20 offset:6144
  v_mfma_f32_16x16x32_bf16 v[40:43], a[72:75], a[16:19], 0
  buffer_load_dwordx4 v225, s[8:11], s46 offen offset:1024 lds
  v_mfma_f32_16x16x32_bf16 v[44:47], a[72:75], a[20:23], 0
  buffer_load_dwordx4 v226, s[8:11], s46 offen offset:2048 lds
  ds_read_b128 a[40:43], v17 offset:2048
  v_mfma_f32_16x16x32_bf16 v[48:51], a[72:75], a[24:27], 0
  v_mfma_f32_16x16x32_bf16 v[52:55], a[72:75], a[28:31], 0
  buffer_load_dwordx4 v227, s[8:11], s46 offen offset:3072 lds
  ds_read_b128 a[44:47], v17 offset:4096
  v_mfma_f32_16x16x32_bf16 v[56:59], a[76:79], a[0:3], 0
  s_add_u32 m0, s36, 38912
  v_mfma_f32_16x16x32_bf16 v[60:63], a[76:79], a[4:7], 0
  buffer_load_dwordx4 v228, s[8:11], s46 offen offset:0 lds
  ds_read_b128 a[48:51], v17 offset:6144
  v_mfma_f32_16x16x32_bf16 v[64:67], a[76:79], a[8:11], 0
  buffer_load_dwordx4 v229, s[8:11], s46 offen offset:1024 lds
  v_mfma_f32_16x16x32_bf16 v[68:71], a[76:79], a[12:15], 0
  ds_read_b128 a[52:55], v17 offset:8192
  v_mfma_f32_16x16x32_bf16 v[72:75], a[76:79], a[16:19], 0
  buffer_load_dwordx4 v230, s[8:11], s46 offen offset:2048 lds
  v_mfma_f32_16x16x32_bf16 v[76:79], a[76:79], a[20:23], 0
  ds_read_b128 a[56:59], v17 offset:10240
  v_mfma_f32_16x16x32_bf16 v[80:83], a[76:79], a[24:27], 0
  buffer_load_dwordx4 v231, s[8:11], s46 offen offset:3072 lds
  v_mfma_f32_16x16x32_bf16 v[84:87], a[76:79], a[28:31], 0
  s_mul_i32 s47, s48, 393216
  s_bfe_u32 s34, 0x302010e, s49
  s_add_u32 s48, s48, s34
  v_mfma_f32_16x16x32_bf16 v[88:91], a[80:83], a[0:3], 0
  s_add_u32 s49, s49, 8
  s_and_b32 s49, s49, 0x8001f
  s_and_b32 s48, s48, 15
  v_mfma_f32_16x16x32_bf16 v[92:95], a[80:83], a[4:7], 0
  s_lshl_b32 s46, s48, 7
  s_add_u32 m0, s41, 24576
  ds_read_b128 a[60:63], v17 offset:12288
  v_mfma_f32_16x16x32_bf16 v[96:99], a[80:83], a[8:11], 0
  buffer_load_dwordx4 v233, s[12:15], s47 offen offset:0 lds
  ds_read_b128 a[64:67], v17 offset:14336
  v_mfma_f32_16x16x32_bf16 v[100:103], a[80:83], a[12:15], 0
  buffer_load_dwordx4 v234, s[12:15], s47 offen offset:1024 lds
  ds_read_b64_tr_b16 a[100:101], v21 offset:4096
  v_mfma_f32_16x16x32_bf16 v[104:107], a[80:83], a[16:19], 0
  buffer_load_dwordx4 v235, s[12:15], s47 offen offset:2048 lds
  ds_read_b64_tr_b16 a[102:103], v21 offset:6144
  v_mfma_f32_16x16x32_bf16 v[108:111], a[80:83], a[20:23], 0
  s_add_u32 m0, s41, 27648
  v_mfma_f32_16x16x32_bf16 v[112:115], a[80:83], a[24:27], 0
  buffer_load_dwordx4 v236, s[12:15], s47 offen offset:0 lds
  ds_read_b64_tr_b16 a[104:105], v20 offset:12288
  v_mfma_f32_16x16x32_bf16 v[116:119], a[80:83], a[28:31], 0
  buffer_load_dwordx4 v237, s[12:15], s47 offen offset:1024 lds
  v_mfma_f32_16x16x32_bf16 v[216:219], a[80:83], a[32:35], 0
  ds_read_b64_tr_b16 a[106:107], v20 offset:14336
  v_mfma_f32_16x16x32_bf16 v[120:123], a[84:87], a[0:3], 0
  buffer_load_dwordx4 v238, s[12:15], s47 offen offset:2048 lds
  v_mfma_f32_16x16x32_bf16 v[124:127], a[84:87], a[4:7], 0
  s_add_u32 m0, s36, s50
  s_add_u32 m0, m0, 69632
  ds_read_b128 a[68:71], v19 offset:0
  v_mfma_f32_16x16x32_bf16 v[128:131], a[84:87], a[8:11], 0
  buffer_load_dwordx4 v232, s[8:11], s46 offen offset:0 lds
  v_mfma_f32_16x16x32_bf16 v[132:135], a[84:87], a[12:15], 0
  s_add_u32 m0, s36, 69632
  ds_read_b64_tr_b16 a[108:109], v21 offset:12288
  v_mfma_f32_16x16x32_bf16 v[136:139], a[84:87], a[16:19], 0
  buffer_load_dwordx4 v224, s[8:11], s46 offen offset:0 lds
  v_mfma_f32_16x16x32_bf16 v[140:143], a[84:87], a[20:23], 0
  buffer_load_dwordx4 v225, s[8:11], s46 offen offset:1024 lds
  ds_read_b64_tr_b16 a[110:111], v21 offset:14336
  v_mfma_f32_16x16x32_bf16 v[144:147], a[84:87], a[24:27], 0
  v_mfma_f32_16x16x32_bf16 v[148:151], a[84:87], a[28:31], 0
  buffer_load_dwordx4 v226, s[8:11], s46 offen offset:2048 lds
  ds_read_b64_tr_b16 a[112:113], v20 offset:20480
  v_mfma_f32_16x16x32_bf16 v[220:223], a[84:87], a[32:35], 0
  v_mfma_f32_16x16x32_bf16 v[152:155], a[0:3], a[88:91], 0
  buffer_load_dwordx4 v227, s[8:11], s46 offen offset:3072 lds
  ds_read_b64_tr_b16 a[114:115], v20 offset:22528
  v_mfma_f32_16x16x32_bf16 v[156:159], a[4:7], a[88:91], 0
  s_add_u32 m0, s36, 73728
  v_mfma_f32_16x16x32_bf16 v[160:163], a[8:11], a[88:91], 0
  buffer_load_dwordx4 v228, s[8:11], s46 offen offset:0 lds
  ds_read_b64_tr_b16 a[116:117], v21 offset:20480
  v_mfma_f32_16x16x32_bf16 v[164:167], a[12:15], a[88:91], 0
  buffer_load_dwordx4 v229, s[8:11], s46 offen offset:1024 lds
  v_mfma_f32_16x16x32_bf16 v[168:171], a[16:19], a[88:91], 0
  ds_read_b64_tr_b16 a[118:119], v21 offset:22528
  v_mfma_f32_16x16x32_bf16 v[172:175], a[20:23], a[88:91], 0
  buffer_load_dwordx4 v230, s[8:11], s46 offen offset:2048 lds
  v_mfma_f32_16x16x32_bf16 v[176:179], a[24:27], a[88:91], 0
  v_mfma_f32_16x16x32_bf16 v[180:183], a[28:31], a[88:91], 0
  buffer_load_dwordx4 v231, s[8:11], s46 offen offset:3072 lds
  v_mfma_f32_16x16x32_bf16 v[184:187], a[0:3], a[92:95], 0
  s_mul_i32 s47, s48, 393216
  s_bfe_u32 s34, 0x302010e, s49
  s_add_u32 s48, s48, s34
  v_mfma_f32_16x16x32_bf16 v[188:191], a[4:7], a[92:95], 0
  s_add_u32 s49, s49, 8
  s_and_b32 s49, s49, 0x8001f
  s_and_b32 s48, s48, 15
  v_mfma_f32_16x16x32_bf16 v[192:195], a[8:11], a[92:95], 0
  s_lshl_b32 s46, s48, 7
  v_mfma_f32_16x16x32_bf16 v[196:199], a[12:15], a[92:95], 0
  s_add_u32 s37, s37, 1
  s_cmp_eq_u32 s37, 3
  s_cselect_b32 s37, 0, s37
  s_cselect_b32 s38, s39, s40
  v_mfma_f32_16x16x32_bf16 v[200:203], a[16:19], a[92:95], 0
  s_sub_u32 s43, 0, s43
  v_mfma_f32_16x16x32_bf16 v[204:207], a[20:23], a[92:95], 0
  v_add_u32 v16, s38, v16
  v_add_u32 v17, s38, v17
  v_mfma_f32_16x16x32_bf16 v[208:211], a[24:27], a[92:95], 0
  v_add_u32 v18, s38, v18
  v_add_u32 v19, s38, v19
  v_mfma_f32_16x16x32_bf16 v[212:215], a[28:31], a[92:95], 0
  v_add_u32 v20, s43, v20
  v_add_u32 v21, s43, v21
  s_mov_b32 s35, 13
  s_waitcnt vmcnt(9) lgkmcnt(0)
  s_barrier
  .p2align 6
Lp2r0_loop:
  v_mfma_f32_16x16x32_bf16 v[24:27], a[96:99], a[36:39], v[24:27]
  buffer_load_dwordx4 a[192:195], v2, s[52:55], s51 offen offset:0
  ds_read_b128 a[0:3], v16 offset:0
  v_mfma_f32_16x16x32_bf16 v[28:31], a[96:99], a[40:43], v[28:31]
  ds_read_b64_tr_b16 a[72:73], v20 offset:0
  v_mfma_f32_16x16x32_bf16 v[32:35], a[96:99], a[44:47], v[32:35]
  v_mfma_f32_16x16x32_bf16 v[36:39], a[96:99], a[48:51], v[36:39]
  ds_read_b64_tr_b16 a[74:75], v20 offset:2048
  v_mfma_f32_16x16x32_bf16 v[40:43], a[96:99], a[52:55], v[40:43]
  buffer_load_dwordx4 a[192:195], v2, s[52:55], s51 offen offset:1024
  v_mfma_f32_16x16x32_bf16 v[44:47], a[96:99], a[56:59], v[44:47]
  ds_read_b128 a[4:7], v16 offset:2048
  v_mfma_f32_16x16x32_bf16 v[48:51], a[96:99], a[60:63], v[48:51]
  v_mfma_f32_16x16x32_bf16 v[52:55], a[96:99], a[64:67], v[52:55]
  ds_read_b128 a[8:11], v16 offset:4096
  v_mfma_f32_16x16x32_bf16 v[56:59], a[100:103], a[36:39], v[56:59]
  v_mfma_f32_16x16x32_bf16 v[60:63], a[100:103], a[40:43], v[60:63]
  buffer_load_dwordx4 a[192:195], v2, s[52:55], s51 offen offset:2048
  ds_read_b128 a[12:15], v16 offset:6144
  v_mfma_f32_16x16x32_bf16 v[64:67], a[100:103], a[44:47], v[64:67]
  v_mfma_f32_16x16x32_bf16 v[68:71], a[100:103], a[48:51], v[68:71]
  ds_read_b128 a[16:19], v16 offset:8192
  v_mfma_f32_16x16x32_bf16 v[72:75], a[100:103], a[52:55], v[72:75]
  v_mfma_f32_16x16x32_bf16 v[76:79], a[100:103], a[56:59], v[76:79]
  ds_read_b128 a[20:23], v16 offset:10240
  v_mfma_f32_16x16x32_bf16 v[80:83], a[100:103], a[60:63], v[80:83]
  buffer_load_dwordx4 a[192:195], v2, s[52:55], s51 offen offset:3072
  v_mfma_f32_16x16x32_bf16 v[84:87], a[100:103], a[64:67], v[84:87]
  s_add_u32 s51, s51, 4096
  s_add_u32 s0, s0, 1
  s_cmp_eq_u32 s0, 2
  s_cselect_b32 s52, s68, s52
  s_cselect_b32 s53, s69, s53
  s_cselect_b32 s51, s1, s51
  s_cselect_b32 s54, 0, s54
  v_mfma_f32_16x16x32_bf16 v[88:91], a[104:107], a[36:39], v[88:91]
  s_cmp_eq_u32 s0, 6
  s_cselect_b32 s52, s64, s52
  s_cselect_b32 s53, s65, s53
  s_cselect_b32 s51, s56, s51
  s_cselect_b32 s54, 0, s54
  v_mfma_f32_16x16x32_bf16 v[92:95], a[104:107], a[40:43], v[92:95]
  s_cmp_eq_u32 s0, 8
  s_cselect_b32 s54, 0, s54
  s_mov_b32 m0, s41
  v_mfma_f32_16x16x32_bf16 v[96:99], a[104:107], a[44:47], v[96:99]
  ds_read_b128 a[24:27], v16 offset:12288
  ds_read_b128 a[28:31], v16 offset:14336
  v_mfma_f32_16x16x32_bf16 v[100:103], a[104:107], a[48:51], v[100:103]
  buffer_load_dwordx4 v233, s[12:15], s47 offen offset:0 lds
  ds_read_b64_tr_b16 a[76:77], v21 offset:0
  v_mfma_f32_16x16x32_bf16 v[104:107], a[104:107], a[52:55], v[104:107]
  ds_read_b64_tr_b16 a[78:79], v21 offset:2048
  v_mfma_f32_16x16x32_bf16 v[108:111], a[104:107], a[56:59], v[108:111]
  v_mfma_f32_16x16x32_bf16 v[112:115], a[104:107], a[60:63], v[112:115]
  ds_read_b64_tr_b16 a[80:81], v20 offset:8192
  v_mfma_f32_16x16x32_bf16 v[116:119], a[104:107], a[64:67], v[116:119]
  v_mfma_f32_16x16x32_bf16 v[216:219], a[104:107], a[68:71], v[216:219]
  buffer_load_dwordx4 v234, s[12:15], s47 offen offset:1024 lds
  ds_read_b64_tr_b16 a[82:83], v20 offset:10240
  v_mfma_f32_16x16x32_bf16 v[120:123], a[108:111], a[36:39], v[120:123]
  v_mfma_f32_16x16x32_bf16 v[124:127], a[108:111], a[40:43], v[124:127]
  ds_read_b128 a[32:35], v18 offset:0
  v_mfma_f32_16x16x32_bf16 v[128:131], a[108:111], a[44:47], v[128:131]
  v_mfma_f32_16x16x32_bf16 v[132:135], a[108:111], a[48:51], v[132:135]
  ds_read_b64_tr_b16 a[84:85], v21 offset:8192
  v_mfma_f32_16x16x32_bf16 v[136:139], a[108:111], a[52:55], v[136:139]
  buffer_load_dwordx4 v235, s[12:15], s47 offen offset:2048 lds
  v_mfma_f32_16x16x32_bf16 v[140:143], a[108:111], a[56:59], v[140:143]
  s_add_u32 m0, s41, 3072
  ds_read_b64_tr_b16 a[86:87], v21 offset:10240
  v_mfma_f32_16x16x32_bf16 v[144:147], a[108:111], a[60:63], v[144:147]
  v_mfma_f32_16x16x32_bf16 v[148:151], a[108:111], a[64:67], v[148:151]
  ds_read_b64_tr_b16 a[88:89], v20 offset:16384
  v_mfma_f32_16x16x32_bf16 v[220:223], a[108:111], a[68:71], v[220:223]
  v_mfma_f32_16x16x32_bf16 v[152:155], a[36:39], a[112:115], v[152:155]
  buffer_load_dwordx4 v236, s[12:15], s47 offen offset:0 lds
  ds_read_b64_tr_b16 a[90:91], v20 offset:18432
  v_mfma_f32_16x16x32_bf16 v[156:159], a[40:43], a[112:115], v[156:159]
  v_mfma_f32_16x16x32_bf16 v[160:163], a[44:47], a[112:115], v[160:163]
  ds_read_b64_tr_b16 a[92:93], v21 offset:16384
  v_mfma_f32_16x16x32_bf16 v[164:167], a[48:51], a[112:115], v[164:167]
  v_mfma_f32_16x16x32_bf16 v[168:171], a[52:55], a[112:115], v[168:171]
  ds_read_b64_tr_b16 a[94:95], v21 offset:18432
  v_mfma_f32_16x16x32_bf16 v[172:175], a[56:59], a[112:115], v[172:175]
  buffer_load_dwordx4 v237, s[12:15], s47 offen offset:1024 lds
  v_mfma_f32_16x16x32_bf16 v[176:179], a[60:63], a[112:115], v[176:179]
  v_mfma_f32_16x16x32_bf16 v[180:183], a[64:67], a[112:115], v[180:183]
  v_mfma_f32_16x16x32_bf16 v[184:187], a[36:39], a[116:119], v[184:187]
  v_mfma_f32_16x16x32_bf16 v[188:191], a[40:43], a[116:119], v[188:191]
  v_mfma_f32_16x16x32_bf16 v[192:195], a[44:47], a[116:119], v[192:195]
  buffer_load_dwordx4 v238, s[12:15], s47 offen offset:2048 lds
  v_mfma_f32_16x16x32_bf16 v[196:199], a[48:51], a[116:119], v[196:199]
  v_mfma_f32_16x16x32_bf16 v[200:203], a[52:55], a[116:119], v[200:203]
  v_mfma_f32_16x16x32_bf16 v[204:207], a[56:59], a[116:119], v[204:207]
  v_mfma_f32_16x16x32_bf16 v[208:211], a[60:63], a[116:119], v[208:211]
  v_mfma_f32_16x16x32_bf16 v[212:215], a[64:67], a[116:119], v[212:215]
  s_waitcnt lgkmcnt(0)
  v_mfma_f32_16x16x32_bf16 v[24:27], a[72:75], a[0:3], v[24:27]
  s_add_u32 m0, s36, s50
  ds_read_b128 a[36:39], v17 offset:0
  v_mfma_f32_16x16x32_bf16 v[28:31], a[72:75], a[4:7], v[28:31]
  buffer_load_dwordx4 v232, s[8:11], s46 offen offset:0 lds
  ds_read_b64_tr_b16 a[96:97], v20 offset:4096
  v_mfma_f32_16x16x32_bf16 v[32:35], a[72:75], a[8:11], v[32:35]
  s_mov_b32 m0, s36
  v_mfma_f32_16x16x32_bf16 v[36:39], a[72:75], a[12:15], v[36:39]
  ds_read_b64_tr_b16 a[98:99], v20 offset:6144
  v_mfma_f32_16x16x32_bf16 v[40:43], a[72:75], a[16:19], v[40:43]
  buffer_load_dwordx4 v224, s[8:11], s46 offen offset:0 lds
  v_mfma_f32_16x16x32_bf16 v[44:47], a[72:75], a[20:23], v[44:47]
  ds_read_b128 a[40:43], v17 offset:2048
  v_mfma_f32_16x16x32_bf16 v[48:51], a[72:75], a[24:27], v[48:51]
  v_mfma_f32_16x16x32_bf16 v[52:55], a[72:75], a[28:31], v[52:55]
  ds_read_b128 a[44:47], v17 offset:4096
  v_mfma_f32_16x16x32_bf16 v[56:59], a[76:79], a[0:3], v[56:59]
  v_mfma_f32_16x16x32_bf16 v[60:63], a[76:79], a[4:7], v[60:63]
  buffer_load_dwordx4 v225, s[8:11], s46 offen offset:1024 lds
  ds_read_b128 a[48:51], v17 offset:6144
  v_mfma_f32_16x16x32_bf16 v[64:67], a[76:79], a[8:11], v[64:67]
  v_mfma_f32_16x16x32_bf16 v[68:71], a[76:79], a[12:15], v[68:71]
  ds_read_b128 a[52:55], v17 offset:8192
  v_mfma_f32_16x16x32_bf16 v[72:75], a[76:79], a[16:19], v[72:75]
  v_mfma_f32_16x16x32_bf16 v[76:79], a[76:79], a[20:23], v[76:79]
  ds_read_b128 a[56:59], v17 offset:10240
  v_mfma_f32_16x16x32_bf16 v[80:83], a[76:79], a[24:27], v[80:83]
  buffer_load_dwordx4 v226, s[8:11], s46 offen offset:2048 lds
  v_mfma_f32_16x16x32_bf16 v[84:87], a[76:79], a[28:31], v[84:87]
  ds_read_b128 a[60:63], v17 offset:12288
  v_mfma_f32_16x16x32_bf16 v[88:91], a[80:83], a[0:3], v[88:91]
  v_mfma_f32_16x16x32_bf16 v[92:95], a[80:83], a[4:7], v[92:95]
  ds_read_b128 a[64:67], v17 offset:14336
  v_mfma_f32_16x16x32_bf16 v[96:99], a[80:83], a[8:11], v[96:99]
  v_mfma_f32_16x16x32_bf16 v[100:103], a[80:83], a[12:15], v[100:103]
  buffer_load_dwordx4 v227, s[8:11], s46 offen offset:3072 lds
  ds_read_b64_tr_b16 a[100:101], v21 offset:4096
  v_mfma_f32_16x16x32_bf16 v[104:107], a[80:83], a[16:19], v[104:107]
  s_add_u32 m0, s36, 4096
  ds_read_b64_tr_b16 a[102:103], v21 offset:6144
  v_mfma_f32_16x16x32_bf16 v[108:111], a[80:83], a[20:23], v[108:111]
  v_mfma_f32_16x16x32_bf16 v[112:115], a[80:83], a[24:27], v[112:115]
  ds_read_b64_tr_b16 a[104:105], v20 offset:12288
  v_mfma_f32_16x16x32_bf16 v[116:119], a[80:83], a[28:31], v[116:119]
  buffer_load_dwordx4 v228, s[8:11], s46 offen offset:0 lds
  v_mfma_f32_16x16x32_bf16 v[216:219], a[80:83], a[32:35], v[216:219]
  ds_read_b64_tr_b16 a[106:107], v20 offset:14336
  v_mfma_f32_16x16x32_bf16 v[120:123], a[84:87], a[0:3], v[120:123]
  v_mfma_f32_16x16x32_bf16 v[124:127], a[84:87], a[4:7], v[124:127]
  ds_read_b128 a[68:71], v19 offset:0
  v_mfma_f32_16x16x32_bf16 v[128:131], a[84:87], a[8:11], v[128:131]
  v_mfma_f32_16x16x32_bf16 v[132:135], a[84:87], a[12:15], v[132:135]
  buffer_load_dwordx4 v229, s[8:11], s46 offen offset:1024 lds
  ds_read_b64_tr_b16 a[108:109], v21 offset:12288
  v_mfma_f32_16x16x32_bf16 v[136:139], a[84:87], a[16:19], v[136:139]
  v_mfma_f32_16x16x32_bf16 v[140:143], a[84:87], a[20:23], v[140:143]
  ds_read_b64_tr_b16 a[110:111], v21 offset:14336
  v_mfma_f32_16x16x32_bf16 v[144:147], a[84:87], a[24:27], v[144:147]
  v_mfma_f32_16x16x32_bf16 v[148:151], a[84:87], a[28:31], v[148:151]
  ds_read_b64_tr_b16 a[112:113], v20 offset:20480
  v_mfma_f32_16x16x32_bf16 v[220:223], a[84:87], a[32:35], v[220:223]
  buffer_load_dwordx4 v230, s[8:11], s46 offen offset:2048 lds
  v_mfma_f32_16x16x32_bf16 v[152:155], a[0:3], a[88:91], v[152:155]
  ds_read_b64_tr_b16 a[114:115], v20 offset:22528
  v_mfma_f32_16x16x32_bf16 v[156:159], a[4:7], a[88:91], v[156:159]
  v_mfma_f32_16x16x32_bf16 v[160:163], a[8:11], a[88:91], v[160:163]
  ds_read_b64_tr_b16 a[116:117], v21 offset:20480
  v_mfma_f32_16x16x32_bf16 v[164:167], a[12:15], a[88:91], v[164:167]
  v_mfma_f32_16x16x32_bf16 v[168:171], a[16:19], a[88:91], v[168:171]
  buffer_load_dwordx4 v231, s[8:11], s46 offen offset:3072 lds
  ds_read_b64_tr_b16 a[118:119], v21 offset:22528
  v_mfma_f32_16x16x32_bf16 v[172:175], a[20:23], a[88:91], v[172:175]
  s_mul_i32 s47, s48, 393216
  s_bfe_u32 s34, 0x302010e, s49
  s_add_u32 s48, s48, s34
  v_mfma_f32_16x16x32_bf16 v[176:179], a[24:27], a[88:91], v[176:179]
  s_add_u32 s49, s49, 8
  s_and_b32 s49, s49, 0x8001f
  s_and_b32 s48, s48, 15
  v_mfma_f32_16x16x32_bf16 v[180:183], a[28:31], a[88:91], v[180:183]
  s_lshl_b32 s46, s48, 7
  v_mfma_f32_16x16x32_bf16 v[184:187], a[0:3], a[92:95], v[184:187]
  s_add_u32 s36, s36, s38
  s_add_u32 s37, s37, 1
  s_cmp_eq_u32 s37, 3
  s_cselect_b32 s37, 0, s37
  s_cselect_b32 s38, s39, s40
  v_mfma_f32_16x16x32_bf16 v[188:191], a[4:7], a[92:95], v[188:191]
  s_add_u32 s41, s41, s43
  s_sub_u32 s43, 0, s43
  v_mfma_f32_16x16x32_bf16 v[192:195], a[8:11], a[92:95], v[192:195]
  v_add_u32 v16, s38, v16
  v_add_u32 v17, s38, v17
  v_mfma_f32_16x16x32_bf16 v[196:199], a[12:15], a[92:95], v[196:199]
  v_add_u32 v18, s38, v18
  v_add_u32 v19, s38, v19
  v_mfma_f32_16x16x32_bf16 v[200:203], a[16:19], a[92:95], v[200:203]
  v_add_u32 v20, s43, v20
  v_add_u32 v21, s43, v21
  v_mfma_f32_16x16x32_bf16 v[204:207], a[20:23], a[92:95], v[204:207]
  s_waitcnt vmcnt(9) lgkmcnt(0)
  s_barrier
  v_mfma_f32_16x16x32_bf16 v[208:211], a[24:27], a[92:95], v[208:211]
  s_sub_u32 s35, s35, 1
  v_mfma_f32_16x16x32_bf16 v[212:215], a[28:31], a[92:95], v[212:215]
  s_cmp_lg_u32 s35, 0
  s_cbranch_scc1 Lp2r0_loop
  v_accvgpr_read_b32 v4, a222
  v_accvgpr_read_b32 v5, a223
  v_accvgpr_read_b32 v6, a224
  v_accvgpr_read_b32 v7, a225
  v_accvgpr_read_b32 v8, a226
  v_accvgpr_read_b32 v9, a227
  v_accvgpr_read_b32 v10, a228
  v_accvgpr_read_b32 v11, a229
  s_mov_b32 s8, s64
  s_mov_b32 s9, s65
  s_mov_b32 s10, 4194304
  s_mov_b32 s11, 0x00020000
  s_mov_b32 s20, s68
  s_mov_b32 s21, s69
  s_mov_b32 s22, 8388608
  s_mov_b32 s23, 0x00020000
  s_and_b32 s4, s2, 7
  s_lshl_b32 s4, s4, 1
  s_lshr_b32 s5, s2, 6
  s_lshr_b32 s30, s2, 4
  s_add_u32 s5, s5, s30
  s_and_b32 s53, s5, 3
  s_lshl_b32 s53, s53, 3
  s_or_b32 s53, s53, 0x80000
  s_bfe_u32 s52, 0xf0f02, s53
  s_add_u32 s52, s52, s4
  s_and_b32 s52, s52, 15
  s_mov_b32 s54, s52
  s_mov_b32 s55, s53
  s_lshl_b32 s29, s52, 7
  s_lshl_b32 s28, s54, 19
  s_lshl_b32 s30, s25, 18
  s_and_b32 s31, s25, 1
  s_lshl_b32 s31, s31, 1
  s_add_u32 s31, s31, 14
  s_sub_u32 s31, s31, s25
  s_lshl_b32 s31, s31, 18
  s_or_b32 s26, s30, s29
  s_or_b32 s27, s31, s29
  s_lshl_b32 s68, s3, 12
  s_lshl_b32 s88, s3, 13
  s_add_u32 s88, s88, 98304
  v_mfma_f32_16x16x32_bf16 v[24:27], a[96:99], a[36:39], v[24:27]
  s_mov_b32 m0, s41
  ds_read_b128 a[0:3], v16 offset:0
  v_mfma_f32_16x16x32_bf16 v[28:31], a[96:99], a[40:43], v[28:31]
  buffer_load_dwordx4 v233, s[12:15], s47 offen offset:0 lds
  ds_read_b64_tr_b16 a[72:73], v20 offset:0
  v_mfma_f32_16x16x32_bf16 v[32:35], a[96:99], a[44:47], v[32:35]
  v_mfma_f32_16x16x32_bf16 v[36:39], a[96:99], a[48:51], v[36:39]
  ds_read_b64_tr_b16 a[74:75], v20 offset:2048
  v_mfma_f32_16x16x32_bf16 v[40:43], a[96:99], a[52:55], v[40:43]
  v_mfma_f32_16x16x32_bf16 v[44:47], a[96:99], a[56:59], v[44:47]
  ds_read_b128 a[4:7], v16 offset:2048
  v_mfma_f32_16x16x32_bf16 v[48:51], a[96:99], a[60:63], v[48:51]
  v_mfma_f32_16x16x32_bf16 v[52:55], a[96:99], a[64:67], v[52:55]
  ds_read_b128 a[8:11], v16 offset:4096
  v_mfma_f32_16x16x32_bf16 v[56:59], a[100:103], a[36:39], v[56:59]
  v_mfma_f32_16x16x32_bf16 v[60:63], a[100:103], a[40:43], v[60:63]
  ds_read_b128 a[12:15], v16 offset:6144
  v_mfma_f32_16x16x32_bf16 v[64:67], a[100:103], a[44:47], v[64:67]
  v_mfma_f32_16x16x32_bf16 v[68:71], a[100:103], a[48:51], v[68:71]
  ds_read_b128 a[16:19], v16 offset:8192
  v_mfma_f32_16x16x32_bf16 v[72:75], a[100:103], a[52:55], v[72:75]
  v_mfma_f32_16x16x32_bf16 v[76:79], a[100:103], a[56:59], v[76:79]
  ds_read_b128 a[20:23], v16 offset:10240
  v_mfma_f32_16x16x32_bf16 v[80:83], a[100:103], a[60:63], v[80:83]
  v_mfma_f32_16x16x32_bf16 v[84:87], a[100:103], a[64:67], v[84:87]
  ds_read_b128 a[24:27], v16 offset:12288
  v_mfma_f32_16x16x32_bf16 v[88:91], a[104:107], a[36:39], v[88:91]
  buffer_load_dwordx4 v234, s[12:15], s47 offen offset:1024 lds
  v_mfma_f32_16x16x32_bf16 v[92:95], a[104:107], a[40:43], v[92:95]
  ds_read_b128 a[28:31], v16 offset:14336
  v_mfma_f32_16x16x32_bf16 v[96:99], a[104:107], a[44:47], v[96:99]
  v_mfma_f32_16x16x32_bf16 v[100:103], a[104:107], a[48:51], v[100:103]
  ds_read_b64_tr_b16 a[76:77], v21 offset:0
  v_mfma_f32_16x16x32_bf16 v[104:107], a[104:107], a[52:55], v[104:107]
  ds_read_b64_tr_b16 a[78:79], v21 offset:2048
  v_mfma_f32_16x16x32_bf16 v[108:111], a[104:107], a[56:59], v[108:111]
  v_mfma_f32_16x16x32_bf16 v[112:115], a[104:107], a[60:63], v[112:115]
  ds_read_b64_tr_b16 a[80:81], v20 offset:8192
  v_mfma_f32_16x16x32_bf16 v[116:119], a[104:107], a[64:67], v[116:119]
  v_mfma_f32_16x16x32_bf16 v[216:219], a[104:107], a[68:71], v[216:219]
  ds_read_b64_tr_b16 a[82:83], v20 offset:10240
  v_mfma_f32_16x16x32_bf16 v[120:123], a[108:111], a[36:39], v[120:123]
  v_mfma_f32_16x16x32_bf16 v[124:127], a[108:111], a[40:43], v[124:127]
  ds_read_b128 a[32:35], v18 offset:0
  v_mfma_f32_16x16x32_bf16 v[128:131], a[108:111], a[44:47], v[128:131]
  v_mfma_f32_16x16x32_bf16 v[132:135], a[108:111], a[48:51], v[132:135]
  ds_read_b64_tr_b16 a[84:85], v21 offset:8192
  v_mfma_f32_16x16x32_bf16 v[136:139], a[108:111], a[52:55], v[136:139]
  v_mfma_f32_16x16x32_bf16 v[140:143], a[108:111], a[56:59], v[140:143]
  ds_read_b64_tr_b16 a[86:87], v21 offset:10240
  v_mfma_f32_16x16x32_bf16 v[144:147], a[108:111], a[60:63], v[144:147]
  v_mfma_f32_16x16x32_bf16 v[148:151], a[108:111], a[64:67], v[148:151]
  buffer_load_dwordx4 v235, s[12:15], s47 offen offset:2048 lds
  ds_read_b64_tr_b16 a[88:89], v20 offset:16384
  v_mfma_f32_16x16x32_bf16 v[220:223], a[108:111], a[68:71], v[220:223]
  v_mfma_f32_16x16x32_bf16 v[152:155], a[36:39], a[112:115], v[152:155]
  ds_read_b64_tr_b16 a[90:91], v20 offset:18432
  v_mfma_f32_16x16x32_bf16 v[156:159], a[40:43], a[112:115], v[156:159]
  v_mfma_f32_16x16x32_bf16 v[160:163], a[44:47], a[112:115], v[160:163]
  ds_read_b64_tr_b16 a[92:93], v21 offset:16384
  v_mfma_f32_16x16x32_bf16 v[164:167], a[48:51], a[112:115], v[164:167]
  v_mfma_f32_16x16x32_bf16 v[168:171], a[52:55], a[112:115], v[168:171]
  ds_read_b64_tr_b16 a[94:95], v21 offset:18432
  v_mfma_f32_16x16x32_bf16 v[172:175], a[56:59], a[112:115], v[172:175]
  v_mfma_f32_16x16x32_bf16 v[176:179], a[60:63], a[112:115], v[176:179]
  v_mfma_f32_16x16x32_bf16 v[180:183], a[64:67], a[112:115], v[180:183]
  v_mfma_f32_16x16x32_bf16 v[184:187], a[36:39], a[116:119], v[184:187]
  v_mfma_f32_16x16x32_bf16 v[188:191], a[40:43], a[116:119], v[188:191]
  v_mfma_f32_16x16x32_bf16 v[192:195], a[44:47], a[116:119], v[192:195]
  v_mfma_f32_16x16x32_bf16 v[196:199], a[48:51], a[116:119], v[196:199]
  v_mfma_f32_16x16x32_bf16 v[200:203], a[52:55], a[116:119], v[200:203]
  v_mfma_f32_16x16x32_bf16 v[204:207], a[56:59], a[116:119], v[204:207]
  v_mfma_f32_16x16x32_bf16 v[208:211], a[60:63], a[116:119], v[208:211]
  v_mfma_f32_16x16x32_bf16 v[212:215], a[64:67], a[116:119], v[212:215]
  s_waitcnt lgkmcnt(0)
  v_mfma_f32_16x16x32_bf16 v[24:27], a[72:75], a[0:3], v[24:27]
  s_add_u32 m0, s41, 3072
  ds_read_b128 a[36:39], v17 offset:0
  v_mfma_f32_16x16x32_bf16 v[28:31], a[72:75], a[4:7], v[28:31]
  buffer_load_dwordx4 v236, s[12:15], s47 offen offset:0 lds
  ds_read_b64_tr_b16 a[96:97], v20 offset:4096
  v_mfma_f32_16x16x32_bf16 v[32:35], a[72:75], a[8:11], v[32:35]
  v_mfma_f32_16x16x32_bf16 v[36:39], a[72:75], a[12:15], v[36:39]
  ds_read_b64_tr_b16 a[98:99], v20 offset:6144
  v_mfma_f32_16x16x32_bf16 v[40:43], a[72:75], a[16:19], v[40:43]
  v_mfma_f32_16x16x32_bf16 v[44:47], a[72:75], a[20:23], v[44:47]
  ds_read_b128 a[40:43], v17 offset:2048
  v_mfma_f32_16x16x32_bf16 v[48:51], a[72:75], a[24:27], v[48:51]
  v_mfma_f32_16x16x32_bf16 v[52:55], a[72:75], a[28:31], v[52:55]
  ds_read_b128 a[44:47], v17 offset:4096
  v_mfma_f32_16x16x32_bf16 v[56:59], a[76:79], a[0:3], v[56:59]
  v_mfma_f32_16x16x32_bf16 v[60:63], a[76:79], a[4:7], v[60:63]
  ds_read_b128 a[48:51], v17 offset:6144
  v_mfma_f32_16x16x32_bf16 v[64:67], a[76:79], a[8:11], v[64:67]
  v_mfma_f32_16x16x32_bf16 v[68:71], a[76:79], a[12:15], v[68:71]
  ds_read_b128 a[52:55], v17 offset:8192
  v_mfma_f32_16x16x32_bf16 v[72:75], a[76:79], a[16:19], v[72:75]
  v_mfma_f32_16x16x32_bf16 v[76:79], a[76:79], a[20:23], v[76:79]
  ds_read_b128 a[56:59], v17 offset:10240
  v_mfma_f32_16x16x32_bf16 v[80:83], a[76:79], a[24:27], v[80:83]
  buffer_load_dwordx4 v237, s[12:15], s47 offen offset:1024 lds
  v_mfma_f32_16x16x32_bf16 v[84:87], a[76:79], a[28:31], v[84:87]
  ds_read_b128 a[60:63], v17 offset:12288
  v_mfma_f32_16x16x32_bf16 v[88:91], a[80:83], a[0:3], v[88:91]
  v_mfma_f32_16x16x32_bf16 v[92:95], a[80:83], a[4:7], v[92:95]
  ds_read_b128 a[64:67], v17 offset:14336
  v_mfma_f32_16x16x32_bf16 v[96:99], a[80:83], a[8:11], v[96:99]
  v_mfma_f32_16x16x32_bf16 v[100:103], a[80:83], a[12:15], v[100:103]
  ds_read_b64_tr_b16 a[100:101], v21 offset:4096
  v_mfma_f32_16x16x32_bf16 v[104:107], a[80:83], a[16:19], v[104:107]
  ds_read_b64_tr_b16 a[102:103], v21 offset:6144
  v_mfma_f32_16x16x32_bf16 v[108:111], a[80:83], a[20:23], v[108:111]
  v_mfma_f32_16x16x32_bf16 v[112:115], a[80:83], a[24:27], v[112:115]
  ds_read_b64_tr_b16 a[104:105], v20 offset:12288
  v_mfma_f32_16x16x32_bf16 v[116:119], a[80:83], a[28:31], v[116:119]
  v_mfma_f32_16x16x32_bf16 v[216:219], a[80:83], a[32:35], v[216:219]
  ds_read_b64_tr_b16 a[106:107], v20 offset:14336
  v_mfma_f32_16x16x32_bf16 v[120:123], a[84:87], a[0:3], v[120:123]
  v_mfma_f32_16x16x32_bf16 v[124:127], a[84:87], a[4:7], v[124:127]
  ds_read_b128 a[68:71], v19 offset:0
  v_mfma_f32_16x16x32_bf16 v[128:131], a[84:87], a[8:11], v[128:131]
  v_mfma_f32_16x16x32_bf16 v[132:135], a[84:87], a[12:15], v[132:135]
  buffer_load_dwordx4 v238, s[12:15], s47 offen offset:2048 lds
  ds_read_b64_tr_b16 a[108:109], v21 offset:12288
  v_mfma_f32_16x16x32_bf16 v[136:139], a[84:87], a[16:19], v[136:139]
  s_add_u32 s36, s36, s38
  s_add_u32 s37, s37, 1
  s_cmp_eq_u32 s37, 3
  s_cselect_b32 s37, 0, s37
  s_cselect_b32 s38, s39, s40
  v_mfma_f32_16x16x32_bf16 v[140:143], a[84:87], a[20:23], v[140:143]
  s_add_u32 s41, s41, s43
  s_sub_u32 s43, 0, s43
  ds_read_b64_tr_b16 a[110:111], v21 offset:14336
  v_mfma_f32_16x16x32_bf16 v[144:147], a[84:87], a[24:27], v[144:147]
  v_mfma_f32_16x16x32_bf16 v[148:151], a[84:87], a[28:31], v[148:151]
  ds_read_b64_tr_b16 a[112:113], v20 offset:20480
  v_mfma_f32_16x16x32_bf16 v[220:223], a[84:87], a[32:35], v[220:223]
  v_mfma_f32_16x16x32_bf16 v[152:155], a[0:3], a[88:91], v[152:155]
  ds_read_b64_tr_b16 a[114:115], v20 offset:22528
  v_mfma_f32_16x16x32_bf16 v[156:159], a[4:7], a[88:91], v[156:159]
  v_mfma_f32_16x16x32_bf16 v[160:163], a[8:11], a[88:91], v[160:163]
  ds_read_b64_tr_b16 a[116:117], v21 offset:20480
  v_mfma_f32_16x16x32_bf16 v[164:167], a[12:15], a[88:91], v[164:167]
  v_mfma_f32_16x16x32_bf16 v[168:171], a[16:19], a[88:91], v[168:171]
  ds_read_b64_tr_b16 a[118:119], v21 offset:22528
  v_mfma_f32_16x16x32_bf16 v[172:175], a[20:23], a[88:91], v[172:175]
  v_add_u32 v16, s38, v16
  v_add_u32 v17, s38, v17
  v_mfma_f32_16x16x32_bf16 v[176:179], a[24:27], a[88:91], v[176:179]
  v_add_u32 v18, s38, v18
  v_add_u32 v19, s38, v19
  v_mfma_f32_16x16x32_bf16 v[180:183], a[28:31], a[88:91], v[180:183]
  v_add_u32 v20, s43, v20
  v_add_u32 v21, s43, v21
  v_mfma_f32_16x16x32_bf16 v[184:187], a[0:3], a[92:95], v[184:187]
  v_mfma_f32_16x16x32_bf16 v[188:191], a[4:7], a[92:95], v[188:191]
  v_mfma_f32_16x16x32_bf16 v[192:195], a[8:11], a[92:95], v[192:195]
  v_mfma_f32_16x16x32_bf16 v[196:199], a[12:15], a[92:95], v[196:199]
  v_mfma_f32_16x16x32_bf16 v[200:203], a[16:19], a[92:95], v[200:203]
  v_mfma_f32_16x16x32_bf16 v[204:207], a[20:23], a[92:95], v[204:207]
  v_mfma_f32_16x16x32_bf16 v[208:211], a[24:27], a[92:95], v[208:211]
  v_mfma_f32_16x16x32_bf16 v[212:215], a[28:31], a[92:95], v[212:215]
  s_waitcnt vmcnt(0) lgkmcnt(0)
  s_barrier
  s_mov_b32 s6, 0x3e8293ee
  s_mov_b32 s7, s6
  v_mfma_f32_16x16x32_bf16 v[24:27], a[96:99], a[36:39], v[24:27]
  ds_read_b128 a[0:3], v16 offset:0
  v_mfma_f32_16x16x32_bf16 v[28:31], a[96:99], a[40:43], v[28:31]
  ds_read_b64_tr_b16 a[72:73], v20 offset:0
  v_mfma_f32_16x16x32_bf16 v[32:35], a[96:99], a[44:47], v[32:35]
  v_mfma_f32_16x16x32_bf16 v[36:39], a[96:99], a[48:51], v[36:39]
  ds_read_b64_tr_b16 a[74:75], v20 offset:2048
  v_mfma_f32_16x16x32_bf16 v[40:43], a[96:99], a[52:55], v[40:43]
  v_mfma_f32_16x16x32_bf16 v[44:47], a[96:99], a[56:59], v[44:47]
  ds_read_b128 a[4:7], v16 offset:2048
  v_mfma_f32_16x16x32_bf16 v[48:51], a[96:99], a[60:63], v[48:51]
  v_mfma_f32_16x16x32_bf16 v[52:55], a[96:99], a[64:67], v[52:55]
  ds_read_b128 a[8:11], v16 offset:4096
  v_mfma_f32_16x16x32_bf16 v[56:59], a[100:103], a[36:39], v[56:59]
  v_mfma_f32_16x16x32_bf16 v[60:63], a[100:103], a[40:43], v[60:63]
  ds_read_b128 a[12:15], v16 offset:6144
  v_mfma_f32_16x16x32_bf16 v[64:67], a[100:103], a[44:47], v[64:67]
  v_mfma_f32_16x16x32_bf16 v[68:71], a[100:103], a[48:51], v[68:71]
  ds_read_b128 a[16:19], v16 offset:8192
  v_mfma_f32_16x16x32_bf16 v[72:75], a[100:103], a[52:55], v[72:75]
  v_mfma_f32_16x16x32_bf16 v[76:79], a[100:103], a[56:59], v[76:79]
  ds_read_b128 a[20:23], v16 offset:10240
  v_mfma_f32_16x16x32_bf16 v[80:83], a[100:103], a[60:63], v[80:83]
  v_mfma_f32_16x16x32_bf16 v[84:87], a[100:103], a[64:67], v[84:87]
  ds_read_b128 a[24:27], v16 offset:12288
  v_mfma_f32_16x16x32_bf16 v[88:91], a[104:107], a[36:39], v[88:91]
  v_mfma_f32_16x16x32_bf16 v[92:95], a[104:107], a[40:43], v[92:95]
  ds_read_b128 a[28:31], v16 offset:14336
  v_mfma_f32_16x16x32_bf16 v[96:99], a[104:107], a[44:47], v[96:99]
  v_mfma_f32_16x16x32_bf16 v[100:103], a[104:107], a[48:51], v[100:103]
  ds_read_b64_tr_b16 a[76:77], v21 offset:0
  v_mfma_f32_16x16x32_bf16 v[104:107], a[104:107], a[52:55], v[104:107]
  ds_read_b64_tr_b16 a[78:79], v21 offset:2048
  v_mfma_f32_16x16x32_bf16 v[108:111], a[104:107], a[56:59], v[108:111]
  v_mfma_f32_16x16x32_bf16 v[112:115], a[104:107], a[60:63], v[112:115]
  ds_read_b64_tr_b16 a[80:81], v20 offset:8192
  v_mfma_f32_16x16x32_bf16 v[116:119], a[104:107], a[64:67], v[116:119]
  v_mfma_f32_16x16x32_bf16 v[216:219], a[104:107], a[68:71], v[216:219]
  ds_read_b64_tr_b16 a[82:83], v20 offset:10240
  v_mfma_f32_16x16x32_bf16 v[120:123], a[108:111], a[36:39], v[120:123]
  v_mfma_f32_16x16x32_bf16 v[124:127], a[108:111], a[40:43], v[124:127]
  ds_read_b128 a[32:35], v18 offset:0
  v_mfma_f32_16x16x32_bf16 v[128:131], a[108:111], a[44:47], v[128:131]
  v_mfma_f32_16x16x32_bf16 v[132:135], a[108:111], a[48:51], v[132:135]
  ds_read_b64_tr_b16 a[84:85], v21 offset:8192
  v_mfma_f32_16x16x32_bf16 v[136:139], a[108:111], a[52:55], v[136:139]
  v_mfma_f32_16x16x32_bf16 v[140:143], a[108:111], a[56:59], v[140:143]
  ds_read_b64_tr_b16 a[86:87], v21 offset:10240
  v_mfma_f32_16x16x32_bf16 v[144:147], a[108:111], a[60:63], v[144:147]
  v_mfma_f32_16x16x32_bf16 v[148:151], a[108:111], a[64:67], v[148:151]
  ds_read_b64_tr_b16 a[88:89], v20 offset:16384
  v_mfma_f32_16x16x32_bf16 v[220:223], a[108:111], a[68:71], v[220:223]
  v_mfma_f32_16x16x32_bf16 v[152:155], a[36:39], a[112:115], v[152:155]
  ds_read_b64_tr_b16 a[90:91], v20 offset:18432
  v_mfma_f32_16x16x32_bf16 v[156:159], a[40:43], a[112:115], v[156:159]
  v_mfma_f32_16x16x32_bf16 v[160:163], a[44:47], a[112:115], v[160:163]
  ds_read_b64_tr_b16 a[92:93], v21 offset:16384
  v_mfma_f32_16x16x32_bf16 v[164:167], a[48:51], a[112:115], v[164:167]
  v_mfma_f32_16x16x32_bf16 v[168:171], a[52:55], a[112:115], v[168:171]
  ds_read_b64_tr_b16 a[94:95], v21 offset:18432
  v_mfma_f32_16x16x32_bf16 v[172:175], a[56:59], a[112:115], v[172:175]
  v_mfma_f32_16x16x32_bf16 v[176:179], a[60:63], a[112:115], v[176:179]
  v_mfma_f32_16x16x32_bf16 v[180:183], a[64:67], a[112:115], v[180:183]
  v_mfma_f32_16x16x32_bf16 v[184:187], a[36:39], a[116:119], v[184:187]
  v_mfma_f32_16x16x32_bf16 v[188:191], a[40:43], a[116:119], v[188:191]
  v_mfma_f32_16x16x32_bf16 v[192:195], a[44:47], a[116:119], v[192:195]
  v_mfma_f32_16x16x32_bf16 v[196:199], a[48:51], a[116:119], v[196:199]
  v_mfma_f32_16x16x32_bf16 v[200:203], a[52:55], a[116:119], v[200:203]
  v_mfma_f32_16x16x32_bf16 v[204:207], a[56:59], a[116:119], v[204:207]
  v_mfma_f32_16x16x32_bf16 v[208:211], a[60:63], a[116:119], v[208:211]
  v_mfma_f32_16x16x32_bf16 v[212:215], a[64:67], a[116:119], v[212:215]
  s_waitcnt lgkmcnt(0)
  v_mfma_f32_16x16x32_bf16 v[24:27], a[72:75], a[0:3], v[24:27]
  ds_read_b128 a[36:39], v17 offset:0
  ds_read_b64_tr_b16 a[96:97], v20 offset:4096
  v_mfma_f32_16x16x32_bf16 v[56:59], a[76:79], a[0:3], v[56:59]
  ds_read_b64_tr_b16 a[98:99], v20 offset:6144
  ds_read_b128 a[40:43], v17 offset:2048
  v_mfma_f32_16x16x32_bf16 v[28:31], a[72:75], a[4:7], v[28:31]
  ds_read_b128 a[44:47], v17 offset:4096
  ds_read_b128 a[48:51], v17 offset:6144
  v_mfma_f32_16x16x32_bf16 v[60:63], a[76:79], a[4:7], v[60:63]
  ds_read_b128 a[52:55], v17 offset:8192
  ds_read_b128 a[56:59], v17 offset:10240
  v_mfma_f32_16x16x32_bf16 v[32:35], a[72:75], a[8:11], v[32:35]
  ds_read_b128 a[60:63], v17 offset:12288
  ds_read_b128 a[64:67], v17 offset:14336
  v_mfma_f32_16x16x32_bf16 v[64:67], a[76:79], a[8:11], v[64:67]
  ds_read_b64_tr_b16 a[100:101], v21 offset:4096
  ds_read_b64_tr_b16 a[102:103], v21 offset:6144
  v_mfma_f32_16x16x32_bf16 v[36:39], a[72:75], a[12:15], v[36:39]
  ds_read_b64_tr_b16 a[104:105], v20 offset:12288
  ds_read_b64_tr_b16 a[106:107], v20 offset:14336
  v_mfma_f32_16x16x32_bf16 v[68:71], a[76:79], a[12:15], v[68:71]
  ds_read_b128 a[68:71], v19 offset:0
  ds_read_b64_tr_b16 a[108:109], v21 offset:12288
  v_mfma_f32_16x16x32_bf16 v[40:43], a[72:75], a[16:19], v[40:43]
  ds_read_b64_tr_b16 a[110:111], v21 offset:14336
  ds_read_b64_tr_b16 a[112:113], v20 offset:20480
  v_mfma_f32_16x16x32_bf16 v[72:75], a[76:79], a[16:19], v[72:75]
  ds_read_b64_tr_b16 a[114:115], v20 offset:22528
  ds_read_b64_tr_b16 a[116:117], v21 offset:20480
  v_mfma_f32_16x16x32_bf16 v[44:47], a[72:75], a[20:23], v[44:47]
  ds_read_b64_tr_b16 a[118:119], v21 offset:22528
  v_mfma_f32_16x16x32_bf16 v[76:79], a[76:79], a[20:23], v[76:79]
  v_mfma_f32_16x16x32_bf16 v[48:51], a[72:75], a[24:27], v[48:51]
  v_mfma_f32_16x16x32_bf16 v[80:83], a[76:79], a[24:27], v[80:83]
  v_mfma_f32_16x16x32_bf16 v[52:55], a[72:75], a[28:31], v[52:55]
  v_mfma_f32_16x16x32_bf16 v[84:87], a[76:79], a[28:31], v[84:87]
  s_waitcnt lgkmcnt(0)
  s_barrier
  s_mov_b32 s12, s84
  s_mov_b32 s13, s85
  s_mov_b32 s14, 256
  s_mov_b32 s15, 0x00020000
  buffer_load_dwordx2 v[22:23], off, s[12:15], 0 sc1
  v_mfma_f32_16x16x32_bf16 v[24:27], a[96:99], a[36:39], v[24:27]
  s_mov_b32 m0, s68
  v_mfma_f32_16x16x32_bf16 v[56:59], a[100:103], a[36:39], v[56:59]
  buffer_load_dwordx4 v8, s[20:23], s28 offen offset:0 lds
  v_mfma_f32_16x16x32_bf16 v[28:31], a[96:99], a[40:43], v[28:31]
  v_mfma_f32_16x16x32_bf16 v[60:63], a[100:103], a[40:43], v[60:63]
  v_mfma_f32_16x16x32_bf16 v[32:35], a[96:99], a[44:47], v[32:35]
  v_mfma_f32_16x16x32_bf16 v[64:67], a[100:103], a[44:47], v[64:67]
  buffer_load_dwordx4 v9, s[20:23], s28 offen offset:1024 lds
  v_pk_mul_f32 v[24:25], v[24:25], s[6:7]
  v_mfma_f32_16x16x32_bf16 v[36:39], a[96:99], a[48:51], v[36:39]
  v_pk_mul_f32 v[26:27], v[26:27], s[6:7]
  v_pk_mul_f32 v[56:57], v[56:57], s[6:7]
  v_mfma_f32_16x16x32_bf16 v[68:71], a[100:103], a[48:51], v[68:71]
  v_pk_mul_f32 v[58:59], v[58:59], s[6:7]
  v_cvt_pk_bf16_f32 v24, v24, v25
  v_mfma_f32_16x16x32_bf16 v[40:43], a[96:99], a[52:55], v[40:43]
  v_cvt_pk_bf16_f32 v25, v26, v27
  v_cvt_pk_bf16_f32 v26, v56, v57
  v_mfma_f32_16x16x32_bf16 v[72:75], a[100:103], a[52:55], v[72:75]
  v_cvt_pk_bf16_f32 v27, v58, v59
  v_pk_mul_f32 v[28:29], v[28:29], s[6:7]
  v_mfma_f32_16x16x32_bf16 v[44:47], a[96:99], a[56:59], v[44:47]
  buffer_load_dwordx4 v10, s[20:23], s28 offen offset:2048 lds
  v_pk_mul_f32 v[30:31], v[30:31], s[6:7]
  v_mfma_f32_16x16x32_bf16 v[76:79], a[100:103], a[56:59], v[76:79]
  v_pk_mul_f32 v[60:61], v[60:61], s[6:7]
  v_pk_mul_f32 v[62:63], v[62:63], s[6:7]
  v_mfma_f32_16x16x32_bf16 v[48:51], a[96:99], a[60:63], v[48:51]
  v_cvt_pk_bf16_f32 v28, v28, v29
  v_cvt_pk_bf16_f32 v29, v30, v31
  v_mfma_f32_16x16x32_bf16 v[80:83], a[100:103], a[60:63], v[80:83]
  v_cvt_pk_bf16_f32 v30, v60, v61
  v_cvt_pk_bf16_f32 v31, v62, v63
  v_mfma_f32_16x16x32_bf16 v[52:55], a[96:99], a[64:67], v[52:55]
  v_pk_mul_f32 v[32:33], v[32:33], s[6:7]
  v_pk_mul_f32 v[34:35], v[34:35], s[6:7]
  v_mfma_f32_16x16x32_bf16 v[84:87], a[100:103], a[64:67], v[84:87]
  buffer_load_dwordx4 v11, s[20:23], s28 offen offset:3072 lds
  v_pk_mul_f32 v[64:65], v[64:65], s[6:7]
  v_mfma_f32_16x16x32_bf16 v[216:219], a[80:83], a[32:35], v[216:219]
  s_bfe_u32 s56, 0x302010e, s55
  s_add_u32 s54, s54, s56
  s_add_u32 s55, s55, 8
  v_mfma_f32_16x16x32_bf16 v[220:223], a[84:87], a[32:35], v[220:223]
  s_and_b32 s55, s55, 0x8001f
  s_and_b32 s54, s54, 15
  s_lshl_b32 s28, s54, 19
  v_mfma_f32_16x16x32_bf16 v[216:219], a[104:107], a[68:71], v[216:219]
  s_add_u32 m0, s68, 16384
  v_pk_mul_f32 v[66:67], v[66:67], s[6:7]
  v_cvt_pk_bf16_f32 v32, v32, v33
  v_mfma_f32_16x16x32_bf16 v[220:223], a[108:111], a[68:71], v[220:223]
  v_cvt_pk_bf16_f32 v33, v34, v35
  v_cvt_pk_bf16_f32 v34, v64, v65
  v_mfma_f32_16x16x32_bf16 v[88:91], a[80:83], a[0:3], v[88:91]
  buffer_load_dwordx4 v8, s[20:23], s28 offen offset:0 lds
  v_cvt_pk_bf16_f32 v35, v66, v67
  v_mfma_f32_16x16x32_bf16 v[120:123], a[84:87], a[0:3], v[120:123]
  v_pk_mul_f32 v[36:37], v[36:37], s[6:7]
  v_pk_mul_f32 v[38:39], v[38:39], s[6:7]
  v_mfma_f32_16x16x32_bf16 v[88:91], a[104:107], a[36:39], v[88:91]
  v_pk_mul_f32 v[68:69], v[68:69], s[6:7]
  v_pk_mul_f32 v[70:71], v[70:71], s[6:7]
  v_mfma_f32_16x16x32_bf16 v[120:123], a[108:111], a[36:39], v[120:123]
  v_cvt_pk_bf16_f32 v36, v36, v37
  v_cvt_pk_bf16_f32 v37, v38, v39
  v_mfma_f32_16x16x32_bf16 v[92:95], a[80:83], a[4:7], v[92:95]
  v_cvt_pk_bf16_f32 v38, v68, v69
  v_cvt_pk_bf16_f32 v39, v70, v71
  v_mfma_f32_16x16x32_bf16 v[124:127], a[84:87], a[4:7], v[124:127]
  buffer_load_dwordx4 v9, s[20:23], s28 offen offset:1024 lds
  v_pk_mul_f32 v[40:41], v[40:41], s[6:7]
  v_mfma_f32_16x16x32_bf16 v[92:95], a[104:107], a[40:43], v[92:95]
  v_pk_mul_f32 v[42:43], v[42:43], s[6:7]
  v_pk_mul_f32 v[72:73], v[72:73], s[6:7]
  v_mfma_f32_16x16x32_bf16 v[124:127], a[108:111], a[40:43], v[124:127]
  v_pk_mul_f32 v[74:75], v[74:75], s[6:7]
  v_cvt_pk_bf16_f32 v40, v40, v41
  v_mfma_f32_16x16x32_bf16 v[96:99], a[80:83], a[8:11], v[96:99]
  v_cvt_pk_bf16_f32 v41, v42, v43
  v_cvt_pk_bf16_f32 v42, v72, v73
  v_mfma_f32_16x16x32_bf16 v[128:131], a[84:87], a[8:11], v[128:131]
  v_cvt_pk_bf16_f32 v43, v74, v75
  v_pk_mul_f32 v[44:45], v[44:45], s[6:7]
  v_mfma_f32_16x16x32_bf16 v[96:99], a[104:107], a[44:47], v[96:99]
  v_pk_mul_f32 v[46:47], v[46:47], s[6:7]
  v_pk_mul_f32 v[76:77], v[76:77], s[6:7]
  v_mfma_f32_16x16x32_bf16 v[128:131], a[108:111], a[44:47], v[128:131]
  buffer_load_dwordx4 v10, s[20:23], s28 offen offset:2048 lds
  v_pk_mul_f32 v[78:79], v[78:79], s[6:7]
  v_mfma_f32_16x16x32_bf16 v[100:103], a[80:83], a[12:15], v[100:103]
  v_cvt_pk_bf16_f32 v44, v44, v45
  v_cvt_pk_bf16_f32 v45, v46, v47
  v_mfma_f32_16x16x32_bf16 v[132:135], a[84:87], a[12:15], v[132:135]
  v_cvt_pk_bf16_f32 v46, v76, v77
  v_cvt_pk_bf16_f32 v47, v78, v79
  v_mfma_f32_16x16x32_bf16 v[100:103], a[104:107], a[48:51], v[100:103]
  v_pk_mul_f32 v[48:49], v[48:49], s[6:7]
  v_pk_mul_f32 v[50:51], v[50:51], s[6:7]
  v_mfma_f32_16x16x32_bf16 v[132:135], a[108:111], a[48:51], v[132:135]
  v_pk_mul_f32 v[80:81], v[80:81], s[6:7]
  v_pk_mul_f32 v[82:83], v[82:83], s[6:7]
  v_mfma_f32_16x16x32_bf16 v[104:107], a[80:83], a[16:19], v[104:107]
  buffer_load_dwordx4 v11, s[20:23], s28 offen offset:3072 lds
  v_cvt_pk_bf16_f32 v48, v48, v49
  v_mfma_f32_16x16x32_bf16 v[136:139], a[84:87], a[16:19], v[136:139]
  s_bfe_u32 s56, 0x302010e, s55
  s_add_u32 s54, s54, s56
  s_add_u32 s55, s55, 8
  v_mfma_f32_16x16x32_bf16 v[104:107], a[104:107], a[52:55], v[104:107]
  s_and_b32 s55, s55, 0x8001f
  s_and_b32 s54, s54, 15
  s_lshl_b32 s28, s54, 19
  v_mfma_f32_16x16x32_bf16 v[136:139], a[108:111], a[52:55], v[136:139]
  s_mov_b32 m0, s88
  v_cvt_pk_bf16_f32 v49, v50, v51
  v_cvt_pk_bf16_f32 v50, v80, v81
  v_mfma_f32_16x16x32_bf16 v[108:111], a[80:83], a[20:23], v[108:111]
  v_cvt_pk_bf16_f32 v51, v82, v83
  v_pk_mul_f32 v[52:53], v[52:53], s[6:7]
  v_mfma_f32_16x16x32_bf16 v[140:143], a[84:87], a[20:23], v[140:143]
  buffer_load_dwordx4 v4, s[8:11], s26 offen offset:0 lds
  v_pk_mul_f32 v[54:55], v[54:55], s[6:7]
  v_mfma_f32_16x16x32_bf16 v[108:111], a[104:107], a[56:59], v[108:111]
  v_pk_mul_f32 v[84:85], v[84:85], s[6:7]
  v_pk_mul_f32 v[86:87], v[86:87], s[6:7]
  v_mfma_f32_16x16x32_bf16 v[140:143], a[108:111], a[56:59], v[140:143]
  v_cvt_pk_bf16_f32 v52, v52, v53
  v_cvt_pk_bf16_f32 v53, v54, v55
  v_mfma_f32_16x16x32_bf16 v[112:115], a[80:83], a[24:27], v[112:115]
  v_cvt_pk_bf16_f32 v54, v84, v85
  v_cvt_pk_bf16_f32 v55, v86, v87
  v_mfma_f32_16x16x32_bf16 v[144:147], a[84:87], a[24:27], v[144:147]
  v_cvt_pk_bf16_f32 v216, v216, v217
  v_cvt_pk_bf16_f32 v217, v218, v219
  v_mfma_f32_16x16x32_bf16 v[112:115], a[104:107], a[60:63], v[112:115]
  buffer_load_dwordx4 v5, s[8:11], s26 offen offset:1024 lds
  v_cvt_pk_bf16_f32 v218, v220, v221
  v_mfma_f32_16x16x32_bf16 v[144:147], a[108:111], a[60:63], v[144:147]
  v_cvt_pk_bf16_f32 v219, v222, v223
  v_mfma_f32_16x16x32_bf16 v[116:119], a[80:83], a[28:31], v[116:119]
  ds_write_b128 v252, v[216:219]
  v_cvt_pk_bf16_f32 v88, v88, v89
  v_mfma_f32_16x16x32_bf16 v[148:151], a[84:87], a[28:31], v[148:151]
  v_cvt_pk_bf16_f32 v89, v90, v91
  v_cvt_pk_bf16_f32 v90, v120, v121
  v_mfma_f32_16x16x32_bf16 v[116:119], a[104:107], a[64:67], v[116:119]
  v_cvt_pk_bf16_f32 v91, v122, v123
  v_cvt_pk_bf16_f32 v92, v92, v93
  v_mfma_f32_16x16x32_bf16 v[148:151], a[108:111], a[64:67], v[148:151]
  buffer_load_dwordx4 v6, s[8:11], s26 offen offset:2048 lds
  v_cvt_pk_bf16_f32 v93, v94, v95
  v_mfma_f32_16x16x32_bf16 v[180:183], a[28:31], a[88:91], v[180:183]
  v_cvt_pk_bf16_f32 v94, v124, v125
  v_cvt_pk_bf16_f32 v95, v126, v127
  v_mfma_f32_16x16x32_bf16 v[212:215], a[28:31], a[92:95], v[212:215]
  v_cvt_pk_bf16_f32 v96, v96, v97
  v_cvt_pk_bf16_f32 v97, v98, v99
  v_mfma_f32_16x16x32_bf16 v[180:183], a[64:67], a[112:115], v[180:183]
  v_cvt_pk_bf16_f32 v98, v128, v129
  v_cvt_pk_bf16_f32 v99, v130, v131
  v_mfma_f32_16x16x32_bf16 v[212:215], a[64:67], a[116:119], v[212:215]
  v_cvt_pk_bf16_f32 v100, v100, v101
  v_cvt_pk_bf16_f32 v101, v102, v103
  v_mfma_f32_16x16x32_bf16 v[176:179], a[24:27], a[88:91], v[176:179]
  v_cvt_pk_bf16_f32 v102, v132, v133
  v_cvt_pk_bf16_f32 v103, v134, v135
  v_mfma_f32_16x16x32_bf16 v[208:211], a[24:27], a[92:95], v[208:211]
  buffer_load_dwordx4 v7, s[8:11], s26 offen offset:3072 lds
  v_cvt_pk_bf16_f32 v104, v104, v105
  v_mfma_f32_16x16x32_bf16 v[176:179], a[60:63], a[112:115], v[176:179]
  s_add_u32 m0, s88, 4096
  v_cvt_pk_bf16_f32 v105, v106, v107
  v_cvt_pk_bf16_f32 v106, v136, v137
  v_mfma_f32_16x16x32_bf16 v[208:211], a[60:63], a[116:119], v[208:211]
  v_cvt_pk_bf16_f32 v107, v138, v139
  v_cvt_pk_bf16_f32 v108, v108, v109
  v_mfma_f32_16x16x32_bf16 v[172:175], a[20:23], a[88:91], v[172:175]
  v_cvt_pk_bf16_f32 v109, v110, v111
  v_cvt_pk_bf16_f32 v110, v140, v141
  v_mfma_f32_16x16x32_bf16 v[204:207], a[20:23], a[92:95], v[204:207]
  v_cvt_pk_bf16_f32 v111, v142, v143
  v_cvt_pk_bf16_f32 v112, v112, v113
  v_mfma_f32_16x16x32_bf16 v[172:175], a[56:59], a[112:115], v[172:175]
  buffer_load_dwordx4 v4, s[8:11], s27 offen offset:0 lds
  v_cvt_pk_bf16_f32 v113, v114, v115
  v_mfma_f32_16x16x32_bf16 v[204:207], a[56:59], a[116:119], v[204:207]
  v_cvt_pk_bf16_f32 v114, v144, v145
  v_cvt_pk_bf16_f32 v115, v146, v147
  v_mfma_f32_16x16x32_bf16 v[168:171], a[16:19], a[88:91], v[168:171]
  v_cvt_pk_bf16_f32 v116, v116, v117
  v_cvt_pk_bf16_f32 v117, v118, v119
  v_mfma_f32_16x16x32_bf16 v[200:203], a[16:19], a[92:95], v[200:203]
  v_cvt_pk_bf16_f32 v118, v148, v149
  v_cvt_pk_bf16_f32 v119, v150, v151
  v_mfma_f32_16x16x32_bf16 v[168:171], a[52:55], a[112:115], v[168:171]
  ds_write_b128 v252, v[116:119] offset:2048
  v_cvt_pk_bf16_f32 v72, v180, v181
  v_mfma_f32_16x16x32_bf16 v[200:203], a[52:55], a[116:119], v[200:203]
  buffer_load_dwordx4 v5, s[8:11], s27 offen offset:1024 lds
  v_cvt_pk_bf16_f32 v73, v182, v183
  v_mfma_f32_16x16x32_bf16 v[164:167], a[12:15], a[88:91], v[164:167]
  v_cvt_pk_bf16_f32 v136, v212, v213
  v_cvt_pk_bf16_f32 v137, v214, v215
  v_mfma_f32_16x16x32_bf16 v[196:199], a[12:15], a[92:95], v[196:199]
  ds_write_b64 v252, v[72:73] offset:3072
  ds_write_b64 v252, v[136:137] offset:3080
  v_mfma_f32_16x16x32_bf16 v[164:167], a[48:51], a[112:115], v[164:167]
  v_cvt_pk_bf16_f32 v70, v176, v177
  v_cvt_pk_bf16_f32 v71, v178, v179
  v_mfma_f32_16x16x32_bf16 v[196:199], a[48:51], a[116:119], v[196:199]
  v_cvt_pk_bf16_f32 v134, v208, v209
  v_cvt_pk_bf16_f32 v135, v210, v211
  v_mfma_f32_16x16x32_bf16 v[160:163], a[8:11], a[88:91], v[160:163]
  buffer_load_dwordx4 v6, s[8:11], s27 offen offset:2048 lds
  v_cvt_pk_bf16_f32 v68, v172, v173
  v_mfma_f32_16x16x32_bf16 v[192:195], a[8:11], a[92:95], v[192:195]
  v_cvt_pk_bf16_f32 v69, v174, v175
  v_cvt_pk_bf16_f32 v132, v204, v205
  v_mfma_f32_16x16x32_bf16 v[160:163], a[44:47], a[112:115], v[160:163]
  v_cvt_pk_bf16_f32 v133, v206, v207
  v_cvt_pk_bf16_f32 v66, v168, v169
  v_mfma_f32_16x16x32_bf16 v[192:195], a[44:47], a[116:119], v[192:195]
  v_cvt_pk_bf16_f32 v67, v170, v171
  v_cvt_pk_bf16_f32 v130, v200, v201
  v_mfma_f32_16x16x32_bf16 v[156:159], a[4:7], a[88:91], v[156:159]
  v_cvt_pk_bf16_f32 v131, v202, v203
  v_cvt_pk_bf16_f32 v64, v164, v165
  v_mfma_f32_16x16x32_bf16 v[188:191], a[4:7], a[92:95], v[188:191]
  buffer_load_dwordx4 v7, s[8:11], s27 offen offset:3072 lds
  v_cvt_pk_bf16_f32 v65, v166, v167
  v_mfma_f32_16x16x32_bf16 v[156:159], a[40:43], a[112:115], v[156:159]
  s_bfe_u32 s29, 0x302010e, s53
  s_add_u32 s52, s52, s29
  s_add_u32 s53, s53, 8
  v_mfma_f32_16x16x32_bf16 v[188:191], a[40:43], a[116:119], v[188:191]
  s_and_b32 s53, s53, 0x8001f
  s_and_b32 s52, s52, 15
  s_lshl_b32 s29, s52, 7
  v_mfma_f32_16x16x32_bf16 v[152:155], a[0:3], a[88:91], v[152:155]
  s_or_b32 s26, s30, s29
  s_or_b32 s27, s31, s29
  v_cvt_pk_bf16_f32 v128, v196, v197
  v_mfma_f32_16x16x32_bf16 v[184:187], a[0:3], a[92:95], v[184:187]
  v_cvt_pk_bf16_f32 v129, v198, v199
  v_cvt_pk_bf16_f32 v62, v160, v161
  v_mfma_f32_16x16x32_bf16 v[152:155], a[36:39], a[112:115], v[152:155]
  v_cvt_pk_bf16_f32 v63, v162, v163
  v_cvt_pk_bf16_f32 v126, v192, v193
  v_mfma_f32_16x16x32_bf16 v[184:187], a[36:39], a[116:119], v[184:187]
  v_cvt_pk_bf16_f32 v127, v194, v195
  v_cvt_pk_bf16_f32 v60, v156, v157
  v_cvt_pk_bf16_f32 v61, v158, v159
  v_cvt_pk_bf16_f32 v124, v188, v189
  v_cvt_pk_bf16_f32 v125, v190, v191
  v_cvt_pk_bf16_f32 v58, v152, v153
  v_cvt_pk_bf16_f32 v59, v154, v155
  s_nop 0
  v_cvt_pk_bf16_f32 v122, v184, v185
  v_cvt_pk_bf16_f32 v123, v186, v187
  s_waitcnt lgkmcnt(0)
  s_barrier
  s_branch Lp2_at
Lp2_r1:
  s_and_b32 s4, s2, 7
  s_lshl_b32 s4, s4, 4
  s_add_u32 s4, s4, s59
  s_lshl_b32 s4, s4, 2
  s_add_u32 s4, s4, s3
  s_lshl_b32 s51, s4, 13
  s_mov_b32 m0, s36
  s_nop 0
  buffer_load_dwordx4 v224, s[8:11], s46 offen offset:0 lds
  buffer_load_dwordx4 v225, s[8:11], s46 offen offset:1024 lds
  buffer_load_dwordx4 v226, s[8:11], s46 offen offset:2048 lds
  buffer_load_dwordx4 v227, s[8:11], s46 offen offset:3072 lds
  s_add_u32 m0, s36, 4096
  s_nop 0
  buffer_load_dwordx4 v228, s[8:11], s46 offen offset:0 lds
  buffer_load_dwordx4 v229, s[8:11], s46 offen offset:1024 lds
  buffer_load_dwordx4 v230, s[8:11], s46 offen offset:2048 lds
  buffer_load_dwordx4 v231, s[8:11], s46 offen offset:3072 lds
  s_mul_i32 s47, s48, 393216
  s_bfe_u32 s34, 0x302010e, s49
  s_add_u32 s48, s48, s34
  s_add_u32 s49, s49, 8
  s_and_b32 s49, s49, 0x8001f
  s_and_b32 s48, s48, 15
  s_lshl_b32 s46, s48, 7
  s_mov_b32 m0, s41
  s_nop 0
  buffer_load_dwordx4 v233, s[12:15], s47 offen offset:0 lds
  buffer_load_dwordx4 v234, s[12:15], s47 offen offset:1024 lds
  buffer_load_dwordx4 v235, s[12:15], s47 offen offset:2048 lds
  s_add_u32 m0, s41, 3072
  s_nop 0
  buffer_load_dwordx4 v236, s[12:15], s47 offen offset:0 lds
  buffer_load_dwordx4 v237, s[12:15], s47 offen offset:1024 lds
  buffer_load_dwordx4 v238, s[12:15], s47 offen offset:2048 lds
  s_lshr_b32 s4, s3, 1
  s_lshl_b32 s4, s4, 14
  v_and_b32 v240, 15, v1
  v_lshlrev_b32 v240, 7, v240
  v_lshrrev_b32 v241, 4, v1
  v_and_b32 v242, 6, v1
  v_xor_b32 v241, v241, v242
  v_lshl_add_u32 v240, v241, 4, v240
  v_add_u32 v16, s4, v240
  v_xor_b32 v17, 64, v16
  v_and_b32 v240, 15, v1
  v_lshlrev_b32 v240, 7, v240
  v_lshrrev_b32 v241, 4, v1
  v_and_b32 v242, 6, v1
  v_xor_b32 v241, v241, v242
  v_lshl_add_u32 v240, v241, 4, v240
  v_add_u32 v18, 32768, v240
  v_xor_b32 v19, 64, v18
  v_lshrrev_b32 v240, 2, v1
  v_and_b32 v241, 6, v240
  v_lshlrev_b32 v240, 7, v240
  v_and_b32 v242, 1, v1
  v_lshl_add_u32 v240, v242, 3, v240
  v_add_u32 v240, 104448, v240
  v_bfe_u32 v242, v1, 1, 1
  v_xor_b32 v241, v241, v242
  v_xor_b32 v242, 0, v241
  v_lshl_add_u32 v20, v242, 4, v240
  v_xor_b32 v242, 2, v241
  v_lshl_add_u32 v21, v242, 4, v240
  s_and_b32 s4, s3, 1
  s_lshl_b32 s4, s4, 6
  v_xor_b32 v20, s4, v20
  v_xor_b32 v21, s4, v21
  s_and_b32 s24, s2, 7
  s_lshr_b32 s4, s2, 6
  s_lshl_b32 s4, s4, 3
  s_add_u32 s24, s24, s4
  s_lshr_b32 s4, s2, 3
  s_and_b32 s25, s4, 6
  s_xor_b32 s4, s4, s2
  s_bfe_u32 s4, s4, 0x10003
  s_add_u32 s25, s25, s4
  v_accvgpr_write_b32 a244, -1
  v_accvgpr_write_b32 a245, -1
  v_accvgpr_write_b32 a246, -1
  v_accvgpr_write_b32 a247, -1
  v_lshrrev_b32 v24, 3, v1
  v_and_b32 v25, 6, v24
  v_and_b32 v26, 7, v1
  v_xor_b32 v25, v25, v26
  v_lshlrev_b32 v25, 4, v25
  s_and_b32 s4, s3, 1
  s_lshl_b32 s4, s4, 16
  s_lshr_b32 s5, s3, 1
  s_lshl_b32 s5, s5, 7
  s_add_u32 s4, s4, s5
  v_lshl_add_u32 v24, v24, 11, v25
  v_add_u32 v24, s4, v24
  v_add_u32 v25, 0, v24
  v_accvgpr_write_b32 a212, v25
  v_add_u32 v25, 15360, v24
  v_accvgpr_write_b32 a213, v25
  v_add_u32 v25, 30720, v24
  v_accvgpr_write_b32 a214, v25
  v_add_u32 v25, 46080, v24
  v_accvgpr_write_b32 a215, v25
  v_accvgpr_write_b32 a236, 0
  v_mov_b32 v27, 0x3f803f80
  v_accvgpr_write_b32 a208, v27
  v_accvgpr_write_b32 a237, 0
  v_accvgpr_write_b32 a209, v27
  v_accvgpr_write_b32 a238, 0
  v_accvgpr_write_b32 a210, v27
  v_accvgpr_write_b32 a239, 0
  v_accvgpr_write_b32 a211, v27
  v_lshrrev_b32 v24, 3, v1
  v_and_b32 v25, 6, v24
  v_and_b32 v26, 7, v1
  v_xor_b32 v25, v25, v26
  v_lshlrev_b32 v25, 4, v25
  v_lshlrev_b32 v26, 2, v24
  v_add_u32 v26, s3, v26
  v_lshl_add_u32 v26, v26, 11, v25
  v_add_u32 v27, 0, v26
  v_accvgpr_write_b32 a222, v27
  v_add_u32 v27, 64512, v26
  v_accvgpr_write_b32 a223, v27
  v_add_u32 v27, 129024, v26
  v_accvgpr_write_b32 a224, v27
  v_add_u32 v27, 193536, v26
  v_accvgpr_write_b32 a225, v27
  v_lshrrev_b32 v26, 2, v24
  v_and_b32 v27, 3, v24
  v_lshl_add_u32 v26, v26, 3, v27
  s_and_b32 s4, s3, 1
  s_lshl_b32 s4, s4, 18
  s_lshr_b32 s5, s3, 1
  s_lshl_b32 s5, s5, 7
  s_add_u32 s4, s4, s5
  s_lshl_b32 s5, s24, 8
  s_add_u32 s4, s4, s5
  v_lshl_add_u32 v26, v26, 13, v25
  v_add_u32 v26, s4, v26
  v_add_u32 v27, 0, v26
  v_accvgpr_write_b32 a226, v27
  v_add_u32 v27, 130048, v26
  v_accvgpr_write_b32 a227, v27
  v_add_u32 v27, 30720, v26
  v_accvgpr_write_b32 a228, v27
  v_add_u32 v27, 160768, v26
  v_accvgpr_write_b32 a229, v27
  s_lshl_b32 s4, s3, 13
  s_add_u32 s4, s4, 98304
  v_and_b32 v24, 15, v1
  v_lshlrev_b32 v24, 7, v24
  v_lshrrev_b32 v25, 4, v1
  v_and_b32 v26, 6, v1
  v_xor_b32 v25, v25, v26
  v_lshl_add_u32 v24, v25, 4, v24
  v_add_u32 v28, s4, v24
  v_xor_b32 v29, 64, v28
  v_lshrrev_b32 v24, 2, v1
  v_and_b32 v25, 6, v24
  v_lshlrev_b32 v24, 7, v24
  v_and_b32 v26, 1, v1
  v_lshl_add_u32 v24, v26, 3, v24
  v_add_u32 v24, 0, v24
  v_bfe_u32 v26, v1, 1, 1
  v_xor_b32 v25, v25, v26
  v_xor_b32 v26, 0, v25
  v_lshl_add_u32 v30, v26, 4, v24
  v_xor_b32 v26, 2, v25
  v_lshl_add_u32 v31, v26, 4, v24
  v_xor_b32 v26, 4, v25
  v_lshl_add_u32 v32, v26, 4, v24
  v_xor_b32 v26, 6, v25
  v_lshl_add_u32 v33, v26, 4, v24
  v_accvgpr_write_b32 a230, v28
  v_accvgpr_write_b32 a231, v29
  v_accvgpr_write_b32 a232, v30
  v_accvgpr_write_b32 a233, v31
  v_accvgpr_write_b32 a234, v32
  v_accvgpr_write_b32 a235, v33
  v_and_b32 v253, 15, v1
  v_lshrrev_b32 v254, 4, v1
  v_lshlrev_b32 v254, 2, v254
  v_sub_u32 v253, v253, v254
  v_mov_b32 v254, 0xf149f2ca
  s_lshr_b32 s4, s3, 1
  s_or_b32 s4, s4, s32
  s_cselect_b64 s[6:7], 0, -1
  v_subrev_u32 v255, 0, v253
  v_and_b32 v252, 0x80000001, v255
  v_cmp_ne_u32 vcc, 0, v252
  s_nop 1
  v_cndmask_b32 v244, 0, v254, vcc
  v_add_u32 v255, 1, v255
  v_and_b32 v252, 0x80000001, v255
  v_cmp_ne_u32 vcc, 0x80000001, v252
  s_nop 1
  v_cndmask_b32 v240, 0, v254, vcc
  v_cndmask_b32 v248, v240, v254, s[6:7]
  v_subrev_u32 v255, 1, v253
  v_and_b32 v252, 0x80000001, v255
  v_cmp_ne_u32 vcc, 0, v252
  s_nop 1
  v_cndmask_b32 v245, 0, v254, vcc
  v_add_u32 v255, 1, v255
  v_and_b32 v252, 0x80000001, v255
  v_cmp_ne_u32 vcc, 0x80000001, v252
  s_nop 1
  v_cndmask_b32 v241, 0, v254, vcc
  v_cndmask_b32 v249, v241, v254, s[6:7]
  v_subrev_u32 v255, 2, v253
  v_and_b32 v252, 0x80000001, v255
  v_cmp_ne_u32 vcc, 0, v252
  s_nop 1
  v_cndmask_b32 v246, 0, v254, vcc
  v_add_u32 v255, 1, v255
  v_and_b32 v252, 0x80000001, v255
  v_cmp_ne_u32 vcc, 0x80000001, v252
  s_nop 1
  v_cndmask_b32 v242, 0, v254, vcc
  v_cndmask_b32 v250, v242, v254, s[6:7]
  v_subrev_u32 v255, 3, v253
  v_and_b32 v252, 0x80000001, v255
  v_cmp_ne_u32 vcc, 0, v252
  s_nop 1
  v_cndmask_b32 v247, 0, v254, vcc
  v_add_u32 v255, 1, v255
  v_and_b32 v252, 0x80000001, v255
  v_cmp_ne_u32 vcc, 0x80000001, v252
  s_nop 1
  v_cndmask_b32 v243, 0, v254, vcc
  v_cndmask_b32 v251, v243, v254, s[6:7]
  s_and_b32 s4, s3, 1
  s_lshl_b32 s4, s4, 12
  s_add_u32 s4, s4, 49152
  v_add_u32 v252, s4, v2
  s_lshr_b32 s5, s3, 1
  s_lshl_b32 s5, s5, 11
  v_add_u32 v253, s5, v252
  s_add_u32 s16, s86, 83886080
  s_addc_u32 s17, s87, 0
  s_mov_b32 s18, 4194304
  s_mov_b32 s19, 0x00020000
  s_lshl_b32 s57, s32, 19
  s_lshl_b32 s5, s5, 7
  s_add_u32 s57, s57, s5
  s_lshl_b32 s4, s33, 14
  s_add_u32 s57, s57, s4
  s_and_b32 s4, s3, 1
  s_lshl_b32 s4, s4, 13
  s_add_u32 s57, s57, s4
  s_add_u32 s58, s57, 4096
  s_mov_b32 s37, 0
  s_mov_b32 s39, 4294897664
  s_mov_b32 s40, 34816
  s_mov_b32 s42, 0
  s_mov_b32 s44, 4294942720
  s_mov_b32 s45, 24576
  s_mov_b32 s43, s44
  s_mov_b32 s52, s72
  s_mov_b32 s53, s73
  s_mov_b32 s54, 4194304
  s_mov_b32 s55, 0x00020000
  s_lshl_b32 s1, s51, 1
  s_mov_b32 s56, s51
  s_mov_b32 s0, 0
  s_waitcnt vmcnt(0)
  s_barrier
  ds_read_b128 a[0:3], v16 offset:0
  ds_read_b64_tr_b16 a[72:73], v20 offset:0
  ds_read_b64_tr_b16 a[74:75], v20 offset:2048
  ds_read_b128 a[4:7], v16 offset:2048
  ds_read_b128 a[8:11], v16 offset:4096
  ds_read_b128 a[12:15], v16 offset:6144
  ds_read_b128 a[16:19], v16 offset:8192
  ds_read_b128 a[20:23], v16 offset:10240
  ds_read_b128 a[24:27], v16 offset:12288
  ds_read_b128 a[28:31], v16 offset:14336
  ds_read_b64_tr_b16 a[76:77], v21 offset:0
  ds_read_b64_tr_b16 a[78:79], v21 offset:2048
  ds_read_b64_tr_b16 a[80:81], v20 offset:8192
  ds_read_b64_tr_b16 a[82:83], v20 offset:10240
  ds_read_b64_tr_b16 a[84:85], v21 offset:8192
  ds_read_b64_tr_b16 a[86:87], v21 offset:10240
  ds_read_b64_tr_b16 a[88:89], v20 offset:16384
  ds_read_b64_tr_b16 a[90:91], v20 offset:18432
  ds_read_b128 a[32:35], v18 offset:0
  ds_read_b64_tr_b16 a[92:93], v21 offset:16384
  ds_read_b64_tr_b16 a[94:95], v21 offset:18432
  s_waitcnt lgkmcnt(0)
  v_mfma_f32_16x16x32_bf16 v[24:27], a[72:75], a[0:3], 0
  s_add_u32 m0, s36, 34816
  ds_read_b128 a[36:39], v17 offset:0
  v_mfma_f32_16x16x32_bf16 v[28:31], a[72:75], a[4:7], 0
  buffer_load_dwordx4 v224, s[8:11], s46 offen offset:0 lds
  ds_read_b64_tr_b16 a[96:97], v20 offset:4096
  v_mfma_f32_16x16x32_bf16 v[32:35], a[72:75], a[8:11], 0
  buffer_load_dwordx4 v225, s[8:11], s46 offen offset:1024 lds
  v_mfma_f32_16x16x32_bf16 v[36:39], a[72:75], a[12:15], 0
  buffer_load_dwordx4 v226, s[8:11], s46 offen offset:2048 lds
  ds_read_b64_tr_b16 a[98:99], v20 offset:6144
  v_mfma_f32_16x16x32_bf16 v[40:43], a[72:75], a[16:19], 0
  v_mfma_f32_16x16x32_bf16 v[44:47], a[72:75], a[20:23], 0
  buffer_load_dwordx4 v227, s[8:11], s46 offen offset:3072 lds
  ds_read_b128 a[40:43], v17 offset:2048
  v_mfma_f32_16x16x32_bf16 v[48:51], a[72:75], a[24:27], 0
  s_add_u32 m0, s36, 38912
  v_mfma_f32_16x16x32_bf16 v[52:55], a[72:75], a[28:31], 0
  buffer_load_dwordx4 v228, s[8:11], s46 offen offset:0 lds
  ds_read_b128 a[44:47], v17 offset:4096
  v_mfma_f32_16x16x32_bf16 v[56:59], a[76:79], a[0:3], 0
  v_mfma_f32_16x16x32_bf16 v[60:63], a[76:79], a[4:7], 0
  buffer_load_dwordx4 v229, s[8:11], s46 offen offset:1024 lds
  ds_read_b128 a[48:51], v17 offset:6144
  v_mfma_f32_16x16x32_bf16 v[64:67], a[76:79], a[8:11], 0
  v_mfma_f32_16x16x32_bf16 v[68:71], a[76:79], a[12:15], 0
  buffer_load_dwordx4 v230, s[8:11], s46 offen offset:2048 lds
  ds_read_b128 a[52:55], v17 offset:8192
  v_mfma_f32_16x16x32_bf16 v[72:75], a[76:79], a[16:19], 0
  v_mfma_f32_16x16x32_bf16 v[76:79], a[76:79], a[20:23], 0
  buffer_load_dwordx4 v231, s[8:11], s46 offen offset:3072 lds
  ds_read_b128 a[56:59], v17 offset:10240
  v_mfma_f32_16x16x32_bf16 v[80:83], a[76:79], a[24:27], 0
  s_mul_i32 s47, s48, 393216
  s_bfe_u32 s34, 0x302010e, s49
  s_add_u32 s48, s48, s34
  v_mfma_f32_16x16x32_bf16 v[84:87], a[76:79], a[28:31], 0
  s_add_u32 s49, s49, 8
  s_and_b32 s49, s49, 0x8001f
  s_and_b32 s48, s48, 15
  v_mfma_f32_16x16x32_bf16 v[88:91], a[80:83], a[0:3], 0
  s_lshl_b32 s46, s48, 7
  s_add_u32 m0, s41, 24576
  ds_read_b128 a[60:63], v17 offset:12288
  v_mfma_f32_16x16x32_bf16 v[92:95], a[80:83], a[4:7], 0
  buffer_load_dwordx4 v233, s[12:15], s47 offen offset:0 lds
  ds_read_b128 a[64:67], v17 offset:14336
  v_mfma_f32_16x16x32_bf16 v[96:99], a[80:83], a[8:11], 0
  buffer_load_dwordx4 v234, s[12:15], s47 offen offset:1024 lds
  v_mfma_f32_16x16x32_bf16 v[100:103], a[80:83], a[12:15], 0
  buffer_load_dwordx4 v235, s[12:15], s47 offen offset:2048 lds
  ds_read_b64_tr_b16 a[100:101], v21 offset:4096
  v_mfma_f32_16x16x32_bf16 v[104:107], a[80:83], a[16:19], 0
  s_add_u32 m0, s41, 27648
  ds_read_b64_tr_b16 a[102:103], v21 offset:6144
  v_mfma_f32_16x16x32_bf16 v[108:111], a[80:83], a[20:23], 0
  buffer_load_dwordx4 v236, s[12:15], s47 offen offset:0 lds
  v_mfma_f32_16x16x32_bf16 v[112:115], a[80:83], a[24:27], 0
  ds_read_b64_tr_b16 a[104:105], v20 offset:12288
  v_mfma_f32_16x16x32_bf16 v[116:119], a[80:83], a[28:31], 0
  buffer_load_dwordx4 v237, s[12:15], s47 offen offset:1024 lds
  v_mfma_f32_16x16x32_bf16 v[120:123], a[84:87], a[0:3], 0
  ds_read_b64_tr_b16 a[106:107], v20 offset:14336
  v_mfma_f32_16x16x32_bf16 v[124:127], a[84:87], a[4:7], 0
  buffer_load_dwordx4 v238, s[12:15], s47 offen offset:2048 lds
  v_mfma_f32_16x16x32_bf16 v[128:131], a[84:87], a[8:11], 0
  s_add_u32 m0, s36, 69632
  ds_read_b64_tr_b16 a[108:109], v21 offset:12288
  v_mfma_f32_16x16x32_bf16 v[132:135], a[84:87], a[12:15], 0
  buffer_load_dwordx4 v224, s[8:11], s46 offen offset:0 lds
  v_mfma_f32_16x16x32_bf16 v[136:139], a[84:87], a[16:19], 0
  ds_read_b64_tr_b16 a[110:111], v21 offset:14336
  v_mfma_f32_16x16x32_bf16 v[140:143], a[84:87], a[20:23], 0
  buffer_load_dwordx4 v225, s[8:11], s46 offen offset:1024 lds
  v_mfma_f32_16x16x32_bf16 v[144:147], a[84:87], a[24:27], 0
  ds_read_b64_tr_b16 a[112:113], v20 offset:20480
  v_mfma_f32_16x16x32_bf16 v[148:151], a[84:87], a[28:31], 0
  buffer_load_dwordx4 v226, s[8:11], s46 offen offset:2048 lds
  v_mfma_f32_16x16x32_bf16 v[152:155], a[0:3], a[88:91], 0
  ds_read_b64_tr_b16 a[114:115], v20 offset:22528
  v_mfma_f32_16x16x32_bf16 v[156:159], a[4:7], a[88:91], 0
  buffer_load_dwordx4 v227, s[8:11], s46 offen offset:3072 lds
  v_mfma_f32_16x16x32_bf16 v[160:163], a[8:11], a[88:91], 0
  s_add_u32 m0, s36, 73728
  ds_read_b128 a[68:71], v19 offset:0
  v_mfma_f32_16x16x32_bf16 v[164:167], a[12:15], a[88:91], 0
  buffer_load_dwordx4 v228, s[8:11], s46 offen offset:0 lds
  v_mfma_f32_16x16x32_bf16 v[168:171], a[16:19], a[88:91], 0
  ds_read_b64_tr_b16 a[116:117], v21 offset:20480
  v_mfma_f32_16x16x32_bf16 v[172:175], a[20:23], a[88:91], 0
  buffer_load_dwordx4 v229, s[8:11], s46 offen offset:1024 lds
  v_mfma_f32_16x16x32_bf16 v[176:179], a[24:27], a[88:91], 0
  ds_read_b64_tr_b16 a[118:119], v21 offset:22528
  v_mfma_f32_16x16x32_bf16 v[180:183], a[28:31], a[88:91], 0
  buffer_load_dwordx4 v230, s[8:11], s46 offen offset:2048 lds
  v_mfma_f32_16x16x32_bf16 v[216:219], a[32:35], a[88:91], 0
  v_mfma_f32_16x16x32_bf16 v[184:187], a[0:3], a[92:95], 0
  buffer_load_dwordx4 v231, s[8:11], s46 offen offset:3072 lds
  v_mfma_f32_16x16x32_bf16 v[188:191], a[4:7], a[92:95], 0
  s_mul_i32 s47, s48, 393216
  s_bfe_u32 s34, 0x302010e, s49
  s_add_u32 s48, s48, s34
  v_mfma_f32_16x16x32_bf16 v[192:195], a[8:11], a[92:95], 0
  s_add_u32 s49, s49, 8
  s_and_b32 s49, s49, 0x8001f
  s_and_b32 s48, s48, 15
  v_mfma_f32_16x16x32_bf16 v[196:199], a[12:15], a[92:95], 0
  s_lshl_b32 s46, s48, 7
  v_mfma_f32_16x16x32_bf16 v[200:203], a[16:19], a[92:95], 0
  s_add_u32 s37, s37, 1
  s_cmp_eq_u32 s37, 3
  s_cselect_b32 s37, 0, s37
  s_cselect_b32 s38, s39, s40
  v_mfma_f32_16x16x32_bf16 v[204:207], a[20:23], a[92:95], 0
  s_sub_u32 s43, 0, s43
  v_mfma_f32_16x16x32_bf16 v[208:211], a[24:27], a[92:95], 0
  v_add_u32 v16, s38, v16
  v_add_u32 v17, s38, v17
  v_mfma_f32_16x16x32_bf16 v[212:215], a[28:31], a[92:95], 0
  v_add_u32 v18, s38, v18
  v_add_u32 v19, s38, v19
  v_mfma_f32_16x16x32_bf16 v[220:223], a[32:35], a[92:95], 0
  v_add_u32 v20, s43, v20
  v_add_u32 v21, s43, v21
  s_mov_b32 s35, 13
  s_waitcnt vmcnt(8) lgkmcnt(0)
  s_barrier
  .p2align 6
Lp2r1_loop:
  v_mfma_f32_16x16x32_bf16 v[24:27], a[96:99], a[36:39], v[24:27]
  buffer_load_dwordx4 a[192:195], v2, s[52:55], s51 offen offset:0
  ds_read_b128 a[0:3], v16 offset:0
  v_mfma_f32_16x16x32_bf16 v[28:31], a[96:99], a[40:43], v[28:31]
  ds_read_b64_tr_b16 a[72:73], v20 offset:0
  v_mfma_f32_16x16x32_bf16 v[32:35], a[96:99], a[44:47], v[32:35]
  v_mfma_f32_16x16x32_bf16 v[36:39], a[96:99], a[48:51], v[36:39]
  ds_read_b64_tr_b16 a[74:75], v20 offset:2048
  v_mfma_f32_16x16x32_bf16 v[40:43], a[96:99], a[52:55], v[40:43]
  v_mfma_f32_16x16x32_bf16 v[44:47], a[96:99], a[56:59], v[44:47]
  buffer_load_dwordx4 a[192:195], v2, s[52:55], s51 offen offset:1024
  ds_read_b128 a[4:7], v16 offset:2048
  v_mfma_f32_16x16x32_bf16 v[48:51], a[96:99], a[60:63], v[48:51]
  v_mfma_f32_16x16x32_bf16 v[52:55], a[96:99], a[64:67], v[52:55]
  ds_read_b128 a[8:11], v16 offset:4096
  v_mfma_f32_16x16x32_bf16 v[56:59], a[100:103], a[36:39], v[56:59]
  v_mfma_f32_16x16x32_bf16 v[60:63], a[100:103], a[40:43], v[60:63]
  ds_read_b128 a[12:15], v16 offset:6144
  v_mfma_f32_16x16x32_bf16 v[64:67], a[100:103], a[44:47], v[64:67]
  buffer_load_dwordx4 a[192:195], v2, s[52:55], s51 offen offset:2048
  v_mfma_f32_16x16x32_bf16 v[68:71], a[100:103], a[48:51], v[68:71]
  ds_read_b128 a[16:19], v16 offset:8192
  v_mfma_f32_16x16x32_bf16 v[72:75], a[100:103], a[52:55], v[72:75]
  v_mfma_f32_16x16x32_bf16 v[76:79], a[100:103], a[56:59], v[76:79]
  ds_read_b128 a[20:23], v16 offset:10240
  v_mfma_f32_16x16x32_bf16 v[80:83], a[100:103], a[60:63], v[80:83]
  v_mfma_f32_16x16x32_bf16 v[84:87], a[100:103], a[64:67], v[84:87]
  ds_read_b128 a[24:27], v16 offset:12288
  v_mfma_f32_16x16x32_bf16 v[88:91], a[104:107], a[36:39], v[88:91]
  buffer_load_dwordx4 a[192:195], v2, s[52:55], s51 offen offset:3072
  v_mfma_f32_16x16x32_bf16 v[92:95], a[104:107], a[40:43], v[92:95]
  s_add_u32 s51, s51, 4096
  s_add_u32 s0, s0, 1
  s_cmp_eq_u32 s0, 2
  s_cselect_b32 s52, s68, s52
  s_cselect_b32 s53, s69, s53
  s_cselect_b32 s51, s1, s51
  s_cselect_b32 s54, 0, s54
  v_mfma_f32_16x16x32_bf16 v[96:99], a[104:107], a[44:47], v[96:99]
  s_cmp_eq_u32 s0, 6
  s_cselect_b32 s52, s64, s52
  s_cselect_b32 s53, s65, s53
  s_cselect_b32 s51, s56, s51
  s_cselect_b32 s54, 0, s54
  v_mfma_f32_16x16x32_bf16 v[100:103], a[104:107], a[48:51], v[100:103]
  s_cmp_eq_u32 s0, 8
  s_cselect_b32 s54, 0, s54
  s_mov_b32 m0, s41
  v_mfma_f32_16x16x32_bf16 v[104:107], a[104:107], a[52:55], v[104:107]
  ds_read_b128 a[28:31], v16 offset:14336
  ds_read_b64_tr_b16 a[76:77], v21 offset:0
  v_mfma_f32_16x16x32_bf16 v[108:111], a[104:107], a[56:59], v[108:111]
  buffer_load_dwordx4 v233, s[12:15], s47 offen offset:0 lds
  ds_read_b64_tr_b16 a[78:79], v21 offset:2048
  v_mfma_f32_16x16x32_bf16 v[112:115], a[104:107], a[60:63], v[112:115]
  ds_read_b64_tr_b16 a[80:81], v20 offset:8192
  v_mfma_f32_16x16x32_bf16 v[116:119], a[104:107], a[64:67], v[116:119]
  v_mfma_f32_16x16x32_bf16 v[120:123], a[108:111], a[36:39], v[120:123]
  ds_read_b64_tr_b16 a[82:83], v20 offset:10240
  v_mfma_f32_16x16x32_bf16 v[124:127], a[108:111], a[40:43], v[124:127]
  v_mfma_f32_16x16x32_bf16 v[128:131], a[108:111], a[44:47], v[128:131]
  ds_read_b64_tr_b16 a[84:85], v21 offset:8192
  v_mfma_f32_16x16x32_bf16 v[132:135], a[108:111], a[48:51], v[132:135]
  buffer_load_dwordx4 v234, s[12:15], s47 offen offset:1024 lds
  v_mfma_f32_16x16x32_bf16 v[136:139], a[108:111], a[52:55], v[136:139]
  ds_read_b64_tr_b16 a[86:87], v21 offset:10240
  v_mfma_f32_16x16x32_bf16 v[140:143], a[108:111], a[56:59], v[140:143]
  v_mfma_f32_16x16x32_bf16 v[144:147], a[108:111], a[60:63], v[144:147]
  ds_read_b64_tr_b16 a[88:89], v20 offset:16384
  v_mfma_f32_16x16x32_bf16 v[148:151], a[108:111], a[64:67], v[148:151]
  v_mfma_f32_16x16x32_bf16 v[152:155], a[36:39], a[112:115], v[152:155]
  buffer_load_dwordx4 v235, s[12:15], s47 offen offset:2048 lds
  ds_read_b64_tr_b16 a[90:91], v20 offset:18432
  v_mfma_f32_16x16x32_bf16 v[156:159], a[40:43], a[112:115], v[156:159]
  s_add_u32 m0, s41, 3072
  v_mfma_f32_16x16x32_bf16 v[160:163], a[44:47], a[112:115], v[160:163]
  ds_read_b128 a[32:35], v18 offset:0
  v_mfma_f32_16x16x32_bf16 v[164:167], a[48:51], a[112:115], v[164:167]
  v_mfma_f32_16x16x32_bf16 v[168:171], a[52:55], a[112:115], v[168:171]
  ds_read_b64_tr_b16 a[92:93], v21 offset:16384
  v_mfma_f32_16x16x32_bf16 v[172:175], a[56:59], a[112:115], v[172:175]
  v_mfma_f32_16x16x32_bf16 v[176:179], a[60:63], a[112:115], v[176:179]
  buffer_load_dwordx4 v236, s[12:15], s47 offen offset:0 lds
  ds_read_b64_tr_b16 a[94:95], v21 offset:18432
  v_mfma_f32_16x16x32_bf16 v[180:183], a[64:67], a[112:115], v[180:183]
  v_mfma_f32_16x16x32_bf16 v[216:219], a[68:71], a[112:115], v[216:219]
  v_mfma_f32_16x16x32_bf16 v[184:187], a[36:39], a[116:119], v[184:187]
  v_mfma_f32_16x16x32_bf16 v[188:191], a[40:43], a[116:119], v[188:191]
  v_mfma_f32_16x16x32_bf16 v[192:195], a[44:47], a[116:119], v[192:195]
  buffer_load_dwordx4 v237, s[12:15], s47 offen offset:1024 lds
  v_mfma_f32_16x16x32_bf16 v[196:199], a[48:51], a[116:119], v[196:199]
  v_mfma_f32_16x16x32_bf16 v[200:203], a[52:55], a[116:119], v[200:203]
  v_mfma_f32_16x16x32_bf16 v[204:207], a[56:59], a[116:119], v[204:207]
  v_mfma_f32_16x16x32_bf16 v[208:211], a[60:63], a[116:119], v[208:211]
  v_mfma_f32_16x16x32_bf16 v[212:215], a[64:67], a[116:119], v[212:215]
  v_mfma_f32_16x16x32_bf16 v[220:223], a[68:71], a[116:119], v[220:223]
  s_waitcnt lgkmcnt(0)
  v_mfma_f32_16x16x32_bf16 v[24:27], a[72:75], a[0:3], v[24:27]
  buffer_load_dwordx4 v238, s[12:15], s47 offen offset:2048 lds
  ds_read_b128 a[36:39], v17 offset:0
  v_mfma_f32_16x16x32_bf16 v[28:31], a[72:75], a[4:7], v[28:31]
  s_mov_b32 m0, s36
  ds_read_b64_tr_b16 a[96:97], v20 offset:4096
  v_mfma_f32_16x16x32_bf16 v[32:35], a[72:75], a[8:11], v[32:35]
  v_mfma_f32_16x16x32_bf16 v[36:39], a[72:75], a[12:15], v[36:39]
  ds_read_b64_tr_b16 a[98:99], v20 offset:6144
  v_mfma_f32_16x16x32_bf16 v[40:43], a[72:75], a[16:19], v[40:43]
  buffer_load_dwordx4 v224, s[8:11], s46 offen offset:0 lds
  v_mfma_f32_16x16x32_bf16 v[44:47], a[72:75], a[20:23], v[44:47]
  ds_read_b128 a[40:43], v17 offset:2048
  v_mfma_f32_16x16x32_bf16 v[48:51], a[72:75], a[24:27], v[48:51]
  v_mfma_f32_16x16x32_bf16 v[52:55], a[72:75], a[28:31], v[52:55]
  ds_read_b128 a[44:47], v17 offset:4096
  v_mfma_f32_16x16x32_bf16 v[56:59], a[76:79], a[0:3], v[56:59]
  v_mfma_f32_16x16x32_bf16 v[60:63], a[76:79], a[4:7], v[60:63]
  buffer_load_dwordx4 v225, s[8:11], s46 offen offset:1024 lds
  ds_read_b128 a[48:51], v17 offset:6144
  v_mfma_f32_16x16x32_bf16 v[64:67], a[76:79], a[8:11], v[64:67]
  v_mfma_f32_16x16x32_bf16 v[68:71], a[76:79], a[12:15], v[68:71]
  ds_read_b128 a[52:55], v17 offset:8192
  v_mfma_f32_16x16x32_bf16 v[72:75], a[76:79], a[16:19], v[72:75]
  v_mfma_f32_16x16x32_bf16 v[76:79], a[76:79], a[20:23], v[76:79]
  ds_read_b128 a[56:59], v17 offset:10240
  v_mfma_f32_16x16x32_bf16 v[80:83], a[76:79], a[24:27], v[80:83]
  buffer_load_dwordx4 v226, s[8:11], s46 offen offset:2048 lds
  v_mfma_f32_16x16x32_bf16 v[84:87], a[76:79], a[28:31], v[84:87]
  ds_read_b128 a[60:63], v17 offset:12288
  v_mfma_f32_16x16x32_bf16 v[88:91], a[80:83], a[0:3], v[88:91]
  v_mfma_f32_16x16x32_bf16 v[92:95], a[80:83], a[4:7], v[92:95]
  ds_read_b128 a[64:67], v17 offset:14336
  v_mfma_f32_16x16x32_bf16 v[96:99], a[80:83], a[8:11], v[96:99]
  v_mfma_f32_16x16x32_bf16 v[100:103], a[80:83], a[12:15], v[100:103]
  buffer_load_dwordx4 v227, s[8:11], s46 offen offset:3072 lds
  ds_read_b64_tr_b16 a[100:101], v21 offset:4096
  v_mfma_f32_16x16x32_bf16 v[104:107], a[80:83], a[16:19], v[104:107]
  s_add_u32 m0, s36, 4096
  ds_read_b64_tr_b16 a[102:103], v21 offset:6144
  v_mfma_f32_16x16x32_bf16 v[108:111], a[80:83], a[20:23], v[108:111]
  v_mfma_f32_16x16x32_bf16 v[112:115], a[80:83], a[24:27], v[112:115]
  ds_read_b64_tr_b16 a[104:105], v20 offset:12288
  v_mfma_f32_16x16x32_bf16 v[116:119], a[80:83], a[28:31], v[116:119]
  buffer_load_dwordx4 v228, s[8:11], s46 offen offset:0 lds
  v_mfma_f32_16x16x32_bf16 v[120:123], a[84:87], a[0:3], v[120:123]
  ds_read_b64_tr_b16 a[106:107], v20 offset:14336
  v_mfma_f32_16x16x32_bf16 v[124:127], a[84:87], a[4:7], v[124:127]
  v_mfma_f32_16x16x32_bf16 v[128:131], a[84:87], a[8:11], v[128:131]
  ds_read_b64_tr_b16 a[108:109], v21 offset:12288
  v_mfma_f32_16x16x32_bf16 v[132:135], a[84:87], a[12:15], v[132:135]
  v_mfma_f32_16x16x32_bf16 v[136:139], a[84:87], a[16:19], v[136:139]
  buffer_load_dwordx4 v229, s[8:11], s46 offen offset:1024 lds
  ds_read_b64_tr_b16 a[110:111], v21 offset:14336
  v_mfma_f32_16x16x32_bf16 v[140:143], a[84:87], a[20:23], v[140:143]
  v_mfma_f32_16x16x32_bf16 v[144:147], a[84:87], a[24:27], v[144:147]
  ds_read_b64_tr_b16 a[112:113], v20 offset:20480
  v_mfma_f32_16x16x32_bf16 v[148:151], a[84:87], a[28:31], v[148:151]
  v_mfma_f32_16x16x32_bf16 v[152:155], a[0:3], a[88:91], v[152:155]
  ds_read_b64_tr_b16 a[114:115], v20 offset:22528
  v_mfma_f32_16x16x32_bf16 v[156:159], a[4:7], a[88:91], v[156:159]
  buffer_load_dwordx4 v230, s[8:11], s46 offen offset:2048 lds
  v_mfma_f32_16x16x32_bf16 v[160:163], a[8:11], a[88:91], v[160:163]
  ds_read_b128 a[68:71], v19 offset:0
  v_mfma_f32_16x16x32_bf16 v[164:167], a[12:15], a[88:91], v[164:167]
  v_mfma_f32_16x16x32_bf16 v[168:171], a[16:19], a[88:91], v[168:171]
  ds_read_b64_tr_b16 a[116:117], v21 offset:20480
  v_mfma_f32_16x16x32_bf16 v[172:175], a[20:23], a[88:91], v[172:175]
  v_mfma_f32_16x16x32_bf16 v[176:179], a[24:27], a[88:91], v[176:179]
  buffer_load_dwordx4 v231, s[8:11], s46 offen offset:3072 lds
  ds_read_b64_tr_b16 a[118:119], v21 offset:22528
  v_mfma_f32_16x16x32_bf16 v[180:183], a[28:31], a[88:91], v[180:183]
  s_mul_i32 s47, s48, 393216
  s_bfe_u32 s34, 0x302010e, s49
  s_add_u32 s48, s48, s34
  v_mfma_f32_16x16x32_bf16 v[216:219], a[32:35], a[88:91], v[216:219]
  s_add_u32 s49, s49, 8
  s_and_b32 s49, s49, 0x8001f
  s_and_b32 s48, s48, 15
  v_mfma_f32_16x16x32_bf16 v[184:187], a[0:3], a[92:95], v[184:187]
  s_lshl_b32 s46, s48, 7
  v_mfma_f32_16x16x32_bf16 v[188:191], a[4:7], a[92:95], v[188:191]
  s_add_u32 s36, s36, s38
  s_add_u32 s37, s37, 1
  s_cmp_eq_u32 s37, 3
  s_cselect_b32 s37, 0, s37
  s_cselect_b32 s38, s39, s40
  v_mfma_f32_16x16x32_bf16 v[192:195], a[8:11], a[92:95], v[192:195]
  s_add_u32 s41, s41, s43
  s_sub_u32 s43, 0, s43
  v_mfma_f32_16x16x32_bf16 v[196:199], a[12:15], a[92:95], v[196:199]
  v_add_u32 v16, s38, v16
  v_add_u32 v17, s38, v17
  v_mfma_f32_16x16x32_bf16 v[200:203], a[16:19], a[92:95], v[200:203]
  v_add_u32 v18, s38, v18
  v_add_u32 v19, s38, v19
  v_mfma_f32_16x16x32_bf16 v[204:207], a[20:23], a[92:95], v[204:207]
  v_add_u32 v20, s43, v20
  v_add_u32 v21, s43, v21
  v_mfma_f32_16x16x32_bf16 v[208:211], a[24:27], a[92:95], v[208:211]
  s_waitcnt vmcnt(8) lgkmcnt(0)
  s_barrier
  v_mfma_f32_16x16x32_bf16 v[212:215], a[28:31], a[92:95], v[212:215]
  s_sub_u32 s35, s35, 1
  v_mfma_f32_16x16x32_bf16 v[220:223], a[32:35], a[92:95], v[220:223]
  s_cmp_lg_u32 s35, 0
  s_cbranch_scc1 Lp2r1_loop
  v_accvgpr_read_b32 v4, a222
  v_accvgpr_read_b32 v5, a223
  v_accvgpr_read_b32 v6, a224
  v_accvgpr_read_b32 v7, a225
  v_accvgpr_read_b32 v8, a226
  v_accvgpr_read_b32 v9, a227
  v_accvgpr_read_b32 v10, a228
  v_accvgpr_read_b32 v11, a229
  s_mov_b32 s8, s64
  s_mov_b32 s9, s65
  s_mov_b32 s10, 4194304
  s_mov_b32 s11, 0x00020000
  s_mov_b32 s20, s68
  s_mov_b32 s21, s69
  s_mov_b32 s22, 8388608
  s_mov_b32 s23, 0x00020000
  s_and_b32 s4, s2, 7
  s_lshl_b32 s4, s4, 1
  s_lshr_b32 s5, s2, 6
  s_lshr_b32 s30, s2, 4
  s_add_u32 s5, s5, s30
  s_and_b32 s53, s5, 3
  s_lshl_b32 s53, s53, 3
  s_or_b32 s53, s53, 0x80000
  s_bfe_u32 s52, 0xf0f02, s53
  s_add_u32 s52, s52, s4
  s_and_b32 s52, s52, 15
  s_mov_b32 s54, s52
  s_mov_b32 s55, s53
  s_lshl_b32 s29, s52, 7
  s_lshl_b32 s28, s54, 19
  s_lshl_b32 s30, s25, 18
  s_and_b32 s31, s25, 1
  s_lshl_b32 s31, s31, 1
  s_add_u32 s31, s31, 14
  s_sub_u32 s31, s31, s25
  s_lshl_b32 s31, s31, 18
  s_or_b32 s26, s30, s29
  s_or_b32 s27, s31, s29
  s_lshl_b32 s68, s3, 12
  s_lshl_b32 s88, s3, 13
  s_add_u32 s88, s88, 98304
  v_mfma_f32_16x16x32_bf16 v[24:27], a[96:99], a[36:39], v[24:27]
  s_mov_b32 m0, s41
  ds_read_b128 a[0:3], v16 offset:0
  v_mfma_f32_16x16x32_bf16 v[28:31], a[96:99], a[40:43], v[28:31]
  buffer_load_dwordx4 v233, s[12:15], s47 offen offset:0 lds
  ds_read_b64_tr_b16 a[72:73], v20 offset:0
  v_mfma_f32_16x16x32_bf16 v[32:35], a[96:99], a[44:47], v[32:35]
  v_mfma_f32_16x16x32_bf16 v[36:39], a[96:99], a[48:51], v[36:39]
  ds_read_b64_tr_b16 a[74:75], v20 offset:2048
  v_mfma_f32_16x16x32_bf16 v[40:43], a[96:99], a[52:55], v[40:43]
  v_mfma_f32_16x16x32_bf16 v[44:47], a[96:99], a[56:59], v[44:47]
  ds_read_b128 a[4:7], v16 offset:2048
  v_mfma_f32_16x16x32_bf16 v[48:51], a[96:99], a[60:63], v[48:51]
  v_mfma_f32_16x16x32_bf16 v[52:55], a[96:99], a[64:67], v[52:55]
  ds_read_b128 a[8:11], v16 offset:4096
  v_mfma_f32_16x16x32_bf16 v[56:59], a[100:103], a[36:39], v[56:59]
  v_mfma_f32_16x16x32_bf16 v[60:63], a[100:103], a[40:43], v[60:63]
  ds_read_b128 a[12:15], v16 offset:6144
  v_mfma_f32_16x16x32_bf16 v[64:67], a[100:103], a[44:47], v[64:67]
  v_mfma_f32_16x16x32_bf16 v[68:71], a[100:103], a[48:51], v[68:71]
  ds_read_b128 a[16:19], v16 offset:8192
  v_mfma_f32_16x16x32_bf16 v[72:75], a[100:103], a[52:55], v[72:75]
  v_mfma_f32_16x16x32_bf16 v[76:79], a[100:103], a[56:59], v[76:79]
  ds_read_b128 a[20:23], v16 offset:10240
  v_mfma_f32_16x16x32_bf16 v[80:83], a[100:103], a[60:63], v[80:83]
  v_mfma_f32_16x16x32_bf16 v[84:87], a[100:103], a[64:67], v[84:87]
  ds_read_b128 a[24:27], v16 offset:12288
  v_mfma_f32_16x16x32_bf16 v[88:91], a[104:107], a[36:39], v[88:91]
  buffer_load_dwordx4 v234, s[12:15], s47 offen offset:1024 lds
  v_mfma_f32_16x16x32_bf16 v[92:95], a[104:107], a[40:43], v[92:95]
  ds_read_b128 a[28:31], v16 offset:14336
  v_mfma_f32_16x16x32_bf16 v[96:99], a[104:107], a[44:47], v[96:99]
  v_mfma_f32_16x16x32_bf16 v[100:103], a[104:107], a[48:51], v[100:103]
  ds_read_b64_tr_b16 a[76:77], v21 offset:0
  v_mfma_f32_16x16x32_bf16 v[104:107], a[104:107], a[52:55], v[104:107]
  ds_read_b64_tr_b16 a[78:79], v21 offset:2048
  v_mfma_f32_16x16x32_bf16 v[108:111], a[104:107], a[56:59], v[108:111]
  v_mfma_f32_16x16x32_bf16 v[112:115], a[104:107], a[60:63], v[112:115]
  ds_read_b64_tr_b16 a[80:81], v20 offset:8192
  v_mfma_f32_16x16x32_bf16 v[116:119], a[104:107], a[64:67], v[116:119]
  v_mfma_f32_16x16x32_bf16 v[120:123], a[108:111], a[36:39], v[120:123]
  ds_read_b64_tr_b16 a[82:83], v20 offset:10240
  v_mfma_f32_16x16x32_bf16 v[124:127], a[108:111], a[40:43], v[124:127]
  v_mfma_f32_16x16x32_bf16 v[128:131], a[108:111], a[44:47], v[128:131]
  ds_read_b64_tr_b16 a[84:85], v21 offset:8192
  v_mfma_f32_16x16x32_bf16 v[132:135], a[108:111], a[48:51], v[132:135]
  v_mfma_f32_16x16x32_bf16 v[136:139], a[108:111], a[52:55], v[136:139]
  ds_read_b64_tr_b16 a[86:87], v21 offset:10240
  v_mfma_f32_16x16x32_bf16 v[140:143], a[108:111], a[56:59], v[140:143]
  v_mfma_f32_16x16x32_bf16 v[144:147], a[108:111], a[60:63], v[144:147]
  ds_read_b64_tr_b16 a[88:89], v20 offset:16384
  v_mfma_f32_16x16x32_bf16 v[148:151], a[108:111], a[64:67], v[148:151]
  v_mfma_f32_16x16x32_bf16 v[152:155], a[36:39], a[112:115], v[152:155]
  buffer_load_dwordx4 v235, s[12:15], s47 offen offset:2048 lds
  ds_read_b64_tr_b16 a[90:91], v20 offset:18432
  v_mfma_f32_16x16x32_bf16 v[156:159], a[40:43], a[112:115], v[156:159]
  v_mfma_f32_16x16x32_bf16 v[160:163], a[44:47], a[112:115], v[160:163]
  ds_read_b128 a[32:35], v18 offset:0
  v_mfma_f32_16x16x32_bf16 v[164:167], a[48:51], a[112:115], v[164:167]
  v_mfma_f32_16x16x32_bf16 v[168:171], a[52:55], a[112:115], v[168:171]
  ds_read_b64_tr_b16 a[92:93], v21 offset:16384
  v_mfma_f32_16x16x32_bf16 v[172:175], a[56:59], a[112:115], v[172:175]
  v_mfma_f32_16x16x32_bf16 v[176:179], a[60:63], a[112:115], v[176:179]
  ds_read_b64_tr_b16 a[94:95], v21 offset:18432
  v_mfma_f32_16x16x32_bf16 v[180:183], a[64:67], a[112:115], v[180:183]
  v_mfma_f32_16x16x32_bf16 v[216:219], a[68:71], a[112:115], v[216:219]
  v_mfma_f32_16x16x32_bf16 v[184:187], a[36:39], a[116:119], v[184:187]
  v_mfma_f32_16x16x32_bf16 v[188:191], a[40:43], a[116:119], v[188:191]
  v_mfma_f32_16x16x32_bf16 v[192:195], a[44:47], a[116:119], v[192:195]
  v_mfma_f32_16x16x32_bf16 v[196:199], a[48:51], a[116:119], v[196:199]
  v_mfma_f32_16x16x32_bf16 v[200:203], a[52:55], a[116:119], v[200:203]
  v_mfma_f32_16x16x32_bf16 v[204:207], a[56:59], a[116:119], v[204:207]
  v_mfma_f32_16x16x32_bf16 v[208:211], a[60:63], a[116:119], v[208:211]
  v_mfma_f32_16x16x32_bf16 v[212:215], a[64:67], a[116:119], v[212:215]
  v_mfma_f32_16x16x32_bf16 v[220:223], a[68:71], a[116:119], v[220:223]
  s_waitcnt lgkmcnt(0)
  v_mfma_f32_16x16x32_bf16 v[24:27], a[72:75], a[0:3], v[24:27]
  s_add_u32 m0, s41, 3072
  ds_read_b128 a[36:39], v17 offset:0
  v_mfma_f32_16x16x32_bf16 v[28:31], a[72:75], a[4:7], v[28:31]
  buffer_load_dwordx4 v236, s[12:15], s47 offen offset:0 lds
  ds_read_b64_tr_b16 a[96:97], v20 offset:4096
  v_mfma_f32_16x16x32_bf16 v[32:35], a[72:75], a[8:11], v[32:35]
  v_mfma_f32_16x16x32_bf16 v[36:39], a[72:75], a[12:15], v[36:39]
  ds_read_b64_tr_b16 a[98:99], v20 offset:6144
  v_mfma_f32_16x16x32_bf16 v[40:43], a[72:75], a[16:19], v[40:43]
  v_mfma_f32_16x16x32_bf16 v[44:47], a[72:75], a[20:23], v[44:47]
  ds_read_b128 a[40:43], v17 offset:2048
  v_mfma_f32_16x16x32_bf16 v[48:51], a[72:75], a[24:27], v[48:51]
  v_mfma_f32_16x16x32_bf16 v[52:55], a[72:75], a[28:31], v[52:55]
  ds_read_b128 a[44:47], v17 offset:4096
  v_mfma_f32_16x16x32_bf16 v[56:59], a[76:79], a[0:3], v[56:59]
  v_mfma_f32_16x16x32_bf16 v[60:63], a[76:79], a[4:7], v[60:63]
  ds_read_b128 a[48:51], v17 offset:6144
  v_mfma_f32_16x16x32_bf16 v[64:67], a[76:79], a[8:11], v[64:67]
  v_mfma_f32_16x16x32_bf16 v[68:71], a[76:79], a[12:15], v[68:71]
  ds_read_b128 a[52:55], v17 offset:8192
  v_mfma_f32_16x16x32_bf16 v[72:75], a[76:79], a[16:19], v[72:75]
  v_mfma_f32_16x16x32_bf16 v[76:79], a[76:79], a[20:23], v[76:79]
  ds_read_b128 a[56:59], v17 offset:10240
  v_mfma_f32_16x16x32_bf16 v[80:83], a[76:79], a[24:27], v[80:83]
  buffer_load_dwordx4 v237, s[12:15], s47 offen offset:1024 lds
  v_mfma_f32_16x16x32_bf16 v[84:87], a[76:79], a[28:31], v[84:87]
  ds_read_b128 a[60:63], v17 offset:12288
  v_mfma_f32_16x16x32_bf16 v[88:91], a[80:83], a[0:3], v[88:91]
  v_mfma_f32_16x16x32_bf16 v[92:95], a[80:83], a[4:7], v[92:95]
  ds_read_b128 a[64:67], v17 offset:14336
  v_mfma_f32_16x16x32_bf16 v[96:99], a[80:83], a[8:11], v[96:99]
  v_mfma_f32_16x16x32_bf16 v[100:103], a[80:83], a[12:15], v[100:103]
  ds_read_b64_tr_b16 a[100:101], v21 offset:4096
  v_mfma_f32_16x16x32_bf16 v[104:107], a[80:83], a[16:19], v[104:107]
  ds_read_b64_tr_b16 a[102:103], v21 offset:6144
  v_mfma_f32_16x16x32_bf16 v[108:111], a[80:83], a[20:23], v[108:111]
  v_mfma_f32_16x16x32_bf16 v[112:115], a[80:83], a[24:27], v[112:115]
  ds_read_b64_tr_b16 a[104:105], v20 offset:12288
  v_mfma_f32_16x16x32_bf16 v[116:119], a[80:83], a[28:31], v[116:119]
  v_mfma_f32_16x16x32_bf16 v[120:123], a[84:87], a[0:3], v[120:123]
  ds_read_b64_tr_b16 a[106:107], v20 offset:14336
  v_mfma_f32_16x16x32_bf16 v[124:127], a[84:87], a[4:7], v[124:127]
  v_mfma_f32_16x16x32_bf16 v[128:131], a[84:87], a[8:11], v[128:131]
  ds_read_b64_tr_b16 a[108:109], v21 offset:12288
  v_mfma_f32_16x16x32_bf16 v[132:135], a[84:87], a[12:15], v[132:135]
  v_mfma_f32_16x16x32_bf16 v[136:139], a[84:87], a[16:19], v[136:139]
  buffer_load_dwordx4 v238, s[12:15], s47 offen offset:2048 lds
  ds_read_b64_tr_b16 a[110:111], v21 offset:14336
  v_mfma_f32_16x16x32_bf16 v[140:143], a[84:87], a[20:23], v[140:143]
  s_add_u32 s36, s36, s38
  s_add_u32 s37, s37, 1
  s_cmp_eq_u32 s37, 3
  s_cselect_b32 s37, 0, s37
  s_cselect_b32 s38, s39, s40
  v_mfma_f32_16x16x32_bf16 v[144:147], a[84:87], a[24:27], v[144:147]
  s_add_u32 s41, s41, s43
  s_sub_u32 s43, 0, s43
  ds_read_b64_tr_b16 a[112:113], v20 offset:20480
  v_mfma_f32_16x16x32_bf16 v[148:151], a[84:87], a[28:31], v[148:151]
  v_mfma_f32_16x16x32_bf16 v[152:155], a[0:3], a[88:91], v[152:155]
  ds_read_b64_tr_b16 a[114:115], v20 offset:22528
  v_mfma_f32_16x16x32_bf16 v[156:159], a[4:7], a[88:91], v[156:159]
  v_mfma_f32_16x16x32_bf16 v[160:163], a[8:11], a[88:91], v[160:163]
  ds_read_b128 a[68:71], v19 offset:0
  v_mfma_f32_16x16x32_bf16 v[164:167], a[12:15], a[88:91], v[164:167]
  v_mfma_f32_16x16x32_bf16 v[168:171], a[16:19], a[88:91], v[168:171]
  ds_read_b64_tr_b16 a[116:117], v21 offset:20480
  v_mfma_f32_16x16x32_bf16 v[172:175], a[20:23], a[88:91], v[172:175]
  v_mfma_f32_16x16x32_bf16 v[176:179], a[24:27], a[88:91], v[176:179]
  ds_read_b64_tr_b16 a[118:119], v21 offset:22528
  v_mfma_f32_16x16x32_bf16 v[180:183], a[28:31], a[88:91], v[180:183]
  v_add_u32 v16, s38, v16
  v_add_u32 v17, s38, v17
  v_mfma_f32_16x16x32_bf16 v[216:219], a[32:35], a[88:91], v[216:219]
  v_add_u32 v18, s38, v18
  v_add_u32 v19, s38, v19
  v_mfma_f32_16x16x32_bf16 v[184:187], a[0:3], a[92:95], v[184:187]
  v_add_u32 v20, s43, v20
  v_add_u32 v21, s43, v21
  v_mfma_f32_16x16x32_bf16 v[188:191], a[4:7], a[92:95], v[188:191]
  v_mfma_f32_16x16x32_bf16 v[192:195], a[8:11], a[92:95], v[192:195]
  v_mfma_f32_16x16x32_bf16 v[196:199], a[12:15], a[92:95], v[196:199]
  v_mfma_f32_16x16x32_bf16 v[200:203], a[16:19], a[92:95], v[200:203]
  v_mfma_f32_16x16x32_bf16 v[204:207], a[20:23], a[92:95], v[204:207]
  v_mfma_f32_16x16x32_bf16 v[208:211], a[24:27], a[92:95], v[208:211]
  v_mfma_f32_16x16x32_bf16 v[212:215], a[28:31], a[92:95], v[212:215]
  v_mfma_f32_16x16x32_bf16 v[220:223], a[32:35], a[92:95], v[220:223]
  s_waitcnt vmcnt(0) lgkmcnt(0)
  s_barrier
  s_mov_b32 s6, 0x3e8293ee
  s_mov_b32 s7, s6
  v_mfma_f32_16x16x32_bf16 v[24:27], a[96:99], a[36:39], v[24:27]
  ds_read_b128 a[0:3], v16 offset:0
  v_mfma_f32_16x16x32_bf16 v[28:31], a[96:99], a[40:43], v[28:31]
  ds_read_b64_tr_b16 a[72:73], v20 offset:0
  v_mfma_f32_16x16x32_bf16 v[32:35], a[96:99], a[44:47], v[32:35]
  v_mfma_f32_16x16x32_bf16 v[36:39], a[96:99], a[48:51], v[36:39]
  ds_read_b64_tr_b16 a[74:75], v20 offset:2048
  v_mfma_f32_16x16x32_bf16 v[40:43], a[96:99], a[52:55], v[40:43]
  v_mfma_f32_16x16x32_bf16 v[44:47], a[96:99], a[56:59], v[44:47]
  ds_read_b128 a[4:7], v16 offset:2048
  v_mfma_f32_16x16x32_bf16 v[48:51], a[96:99], a[60:63], v[48:51]
  v_mfma_f32_16x16x32_bf16 v[52:55], a[96:99], a[64:67], v[52:55]
  ds_read_b128 a[8:11], v16 offset:4096
  v_mfma_f32_16x16x32_bf16 v[56:59], a[100:103], a[36:39], v[56:59]
  v_mfma_f32_16x16x32_bf16 v[60:63], a[100:103], a[40:43], v[60:63]
  ds_read_b128 a[12:15], v16 offset:6144
  v_mfma_f32_16x16x32_bf16 v[64:67], a[100:103], a[44:47], v[64:67]
  v_mfma_f32_16x16x32_bf16 v[68:71], a[100:103], a[48:51], v[68:71]
  ds_read_b128 a[16:19], v16 offset:8192
  v_mfma_f32_16x16x32_bf16 v[72:75], a[100:103], a[52:55], v[72:75]
  v_mfma_f32_16x16x32_bf16 v[76:79], a[100:103], a[56:59], v[76:79]
  ds_read_b128 a[20:23], v16 offset:10240
  v_mfma_f32_16x16x32_bf16 v[80:83], a[100:103], a[60:63], v[80:83]
  v_mfma_f32_16x16x32_bf16 v[84:87], a[100:103], a[64:67], v[84:87]
  ds_read_b128 a[24:27], v16 offset:12288
  v_mfma_f32_16x16x32_bf16 v[88:91], a[104:107], a[36:39], v[88:91]
  v_mfma_f32_16x16x32_bf16 v[92:95], a[104:107], a[40:43], v[92:95]
  ds_read_b128 a[28:31], v16 offset:14336
  v_mfma_f32_16x16x32_bf16 v[96:99], a[104:107], a[44:47], v[96:99]
  v_mfma_f32_16x16x32_bf16 v[100:103], a[104:107], a[48:51], v[100:103]
  ds_read_b64_tr_b16 a[76:77], v21 offset:0
  v_mfma_f32_16x16x32_bf16 v[104:107], a[104:107], a[52:55], v[104:107]
  ds_read_b64_tr_b16 a[78:79], v21 offset:2048
  v_mfma_f32_16x16x32_bf16 v[108:111], a[104:107], a[56:59], v[108:111]
  v_mfma_f32_16x16x32_bf16 v[112:115], a[104:107], a[60:63], v[112:115]
  ds_read_b64_tr_b16 a[80:81], v20 offset:8192
  v_mfma_f32_16x16x32_bf16 v[116:119], a[104:107], a[64:67], v[116:119]
  v_mfma_f32_16x16x32_bf16 v[120:123], a[108:111], a[36:39], v[120:123]
  ds_read_b64_tr_b16 a[82:83], v20 offset:10240
  v_mfma_f32_16x16x32_bf16 v[124:127], a[108:111], a[40:43], v[124:127]
  v_mfma_f32_16x16x32_bf16 v[128:131], a[108:111], a[44:47], v[128:131]
  ds_read_b64_tr_b16 a[84:85], v21 offset:8192
  v_mfma_f32_16x16x32_bf16 v[132:135], a[108:111], a[48:51], v[132:135]
  v_mfma_f32_16x16x32_bf16 v[136:139], a[108:111], a[52:55], v[136:139]
  ds_read_b64_tr_b16 a[86:87], v21 offset:10240
  v_mfma_f32_16x16x32_bf16 v[140:143], a[108:111], a[56:59], v[140:143]
  v_mfma_f32_16x16x32_bf16 v[144:147], a[108:111], a[60:63], v[144:147]
  ds_read_b64_tr_b16 a[88:89], v20 offset:16384
  v_mfma_f32_16x16x32_bf16 v[148:151], a[108:111], a[64:67], v[148:151]
  v_mfma_f32_16x16x32_bf16 v[152:155], a[36:39], a[112:115], v[152:155]
  ds_read_b64_tr_b16 a[90:91], v20 offset:18432
  v_mfma_f32_16x16x32_bf16 v[156:159], a[40:43], a[112:115], v[156:159]
  v_mfma_f32_16x16x32_bf16 v[160:163], a[44:47], a[112:115], v[160:163]
  ds_read_b128 a[32:35], v18 offset:0
  v_mfma_f32_16x16x32_bf16 v[164:167], a[48:51], a[112:115], v[164:167]
  v_mfma_f32_16x16x32_bf16 v[168:171], a[52:55], a[112:115], v[168:171]
  ds_read_b64_tr_b16 a[92:93], v21 offset:16384
  v_mfma_f32_16x16x32_bf16 v[172:175], a[56:59], a[112:115], v[172:175]
  v_mfma_f32_16x16x32_bf16 v[176:179], a[60:63], a[112:115], v[176:179]
  ds_read_b64_tr_b16 a[94:95], v21 offset:18432
  v_mfma_f32_16x16x32_bf16 v[180:183], a[64:67], a[112:115], v[180:183]
  v_mfma_f32_16x16x32_bf16 v[216:219], a[68:71], a[112:115], v[216:219]
  v_mfma_f32_16x16x32_bf16 v[184:187], a[36:39], a[116:119], v[184:187]
  v_mfma_f32_16x16x32_bf16 v[188:191], a[40:43], a[116:119], v[188:191]
  v_mfma_f32_16x16x32_bf16 v[192:195], a[44:47], a[116:119], v[192:195]
  v_mfma_f32_16x16x32_bf16 v[196:199], a[48:51], a[116:119], v[196:199]
  v_mfma_f32_16x16x32_bf16 v[200:203], a[52:55], a[116:119], v[200:203]
  v_mfma_f32_16x16x32_bf16 v[204:207], a[56:59], a[116:119], v[204:207]
  v_mfma_f32_16x16x32_bf16 v[208:211], a[60:63], a[116:119], v[208:211]
  v_mfma_f32_16x16x32_bf16 v[212:215], a[64:67], a[116:119], v[212:215]
  v_mfma_f32_16x16x32_bf16 v[220:223], a[68:71], a[116:119], v[220:223]
  s_waitcnt lgkmcnt(0)
  v_mfma_f32_16x16x32_bf16 v[24:27], a[72:75], a[0:3], v[24:27]
  ds_read_b128 a[36:39], v17 offset:0
  ds_read_b64_tr_b16 a[96:97], v20 offset:4096
  v_mfma_f32_16x16x32_bf16 v[56:59], a[76:79], a[0:3], v[56:59]
  ds_read_b64_tr_b16 a[98:99], v20 offset:6144
  ds_read_b128 a[40:43], v17 offset:2048
  v_mfma_f32_16x16x32_bf16 v[28:31], a[72:75], a[4:7], v[28:31]
  ds_read_b128 a[44:47], v17 offset:4096
  ds_read_b128 a[48:51], v17 offset:6144
  v_mfma_f32_16x16x32_bf16 v[60:63], a[76:79], a[4:7], v[60:63]
  ds_read_b128 a[52:55], v17 offset:8192
  ds_read_b128 a[56:59], v17 offset:10240
  v_mfma_f32_16x16x32_bf16 v[32:35], a[72:75], a[8:11], v[32:35]
  ds_read_b128 a[60:63], v17 offset:12288
  ds_read_b128 a[64:67], v17 offset:14336
  v_mfma_f32_16x16x32_bf16 v[64:67], a[76:79], a[8:11], v[64:67]
  ds_read_b64_tr_b16 a[100:101], v21 offset:4096
  ds_read_b64_tr_b16 a[102:103], v21 offset:6144
  v_mfma_f32_16x16x32_bf16 v[36:39], a[72:75], a[12:15], v[36:39]
  ds_read_b64_tr_b16 a[104:105], v20 offset:12288
  ds_read_b64_tr_b16 a[106:107], v20 offset:14336
  v_mfma_f32_16x16x32_bf16 v[68:71], a[76:79], a[12:15], v[68:71]
  ds_read_b64_tr_b16 a[108:109], v21 offset:12288
  ds_read_b64_tr_b16 a[110:111], v21 offset:14336
  v_mfma_f32_16x16x32_bf16 v[40:43], a[72:75], a[16:19], v[40:43]
  ds_read_b64_tr_b16 a[112:113], v20 offset:20480
  ds_read_b64_tr_b16 a[114:115], v20 offset:22528
  v_mfma_f32_16x16x32_bf16 v[72:75], a[76:79], a[16:19], v[72:75]
  ds_read_b128 a[68:71], v19 offset:0
  ds_read_b64_tr_b16 a[116:117], v21 offset:20480
  v_mfma_f32_16x16x32_bf16 v[44:47], a[72:75], a[20:23], v[44:47]
  ds_read_b64_tr_b16 a[118:119], v21 offset:22528
  v_mfma_f32_16x16x32_bf16 v[76:79], a[76:79], a[20:23], v[76:79]
  v_mfma_f32_16x16x32_bf16 v[48:51], a[72:75], a[24:27], v[48:51]
  v_mfma_f32_16x16x32_bf16 v[80:83], a[76:79], a[24:27], v[80:83]
  v_mfma_f32_16x16x32_bf16 v[52:55], a[72:75], a[28:31], v[52:55]
  v_mfma_f32_16x16x32_bf16 v[84:87], a[76:79], a[28:31], v[84:87]
  s_waitcnt lgkmcnt(0)
  s_barrier
  s_mov_b32 s12, s84
  s_mov_b32 s13, s85
  s_mov_b32 s14, 256
  s_mov_b32 s15, 0x00020000
  buffer_load_dwordx2 v[22:23], off, s[12:15], 0 sc1
  v_mfma_f32_16x16x32_bf16 v[24:27], a[96:99], a[36:39], v[24:27]
  s_mov_b32 m0, s68
  v_mfma_f32_16x16x32_bf16 v[56:59], a[100:103], a[36:39], v[56:59]
  buffer_load_dwordx4 v8, s[20:23], s28 offen offset:0 lds
  v_mfma_f32_16x16x32_bf16 v[28:31], a[96:99], a[40:43], v[28:31]
  v_mfma_f32_16x16x32_bf16 v[60:63], a[100:103], a[40:43], v[60:63]
  v_mfma_f32_16x16x32_bf16 v[32:35], a[96:99], a[44:47], v[32:35]
  v_mfma_f32_16x16x32_bf16 v[64:67], a[100:103], a[44:47], v[64:67]
  buffer_load_dwordx4 v9, s[20:23], s28 offen offset:1024 lds
  v_pk_mul_f32 v[24:25], v[24:25], s[6:7]
  v_mfma_f32_16x16x32_bf16 v[36:39], a[96:99], a[48:51], v[36:39]
  v_pk_mul_f32 v[26:27], v[26:27], s[6:7]
  v_pk_mul_f32 v[56:57], v[56:57], s[6:7]
  v_mfma_f32_16x16x32_bf16 v[68:71], a[100:103], a[48:51], v[68:71]
  v_pk_mul_f32 v[58:59], v[58:59], s[6:7]
  v_cvt_pk_bf16_f32 v24, v24, v25
  v_mfma_f32_16x16x32_bf16 v[40:43], a[96:99], a[52:55], v[40:43]
  v_cvt_pk_bf16_f32 v25, v26, v27
  v_cvt_pk_bf16_f32 v26, v56, v57
  v_mfma_f32_16x16x32_bf16 v[72:75], a[100:103], a[52:55], v[72:75]
  v_cvt_pk_bf16_f32 v27, v58, v59
  v_pk_mul_f32 v[28:29], v[28:29], s[6:7]
  v_mfma_f32_16x16x32_bf16 v[44:47], a[96:99], a[56:59], v[44:47]
  buffer_load_dwordx4 v10, s[20:23], s28 offen offset:2048 lds
  v_pk_mul_f32 v[30:31], v[30:31], s[6:7]
  v_mfma_f32_16x16x32_bf16 v[76:79], a[100:103], a[56:59], v[76:79]
  v_pk_mul_f32 v[60:61], v[60:61], s[6:7]
  v_pk_mul_f32 v[62:63], v[62:63], s[6:7]
  v_mfma_f32_16x16x32_bf16 v[48:51], a[96:99], a[60:63], v[48:51]
  v_cvt_pk_bf16_f32 v28, v28, v29
  v_cvt_pk_bf16_f32 v29, v30, v31
  v_mfma_f32_16x16x32_bf16 v[80:83], a[100:103], a[60:63], v[80:83]
  v_cvt_pk_bf16_f32 v30, v60, v61
  v_cvt_pk_bf16_f32 v31, v62, v63
  v_mfma_f32_16x16x32_bf16 v[52:55], a[96:99], a[64:67], v[52:55]
  v_pk_mul_f32 v[32:33], v[32:33], s[6:7]
  v_pk_mul_f32 v[34:35], v[34:35], s[6:7]
  v_mfma_f32_16x16x32_bf16 v[84:87], a[100:103], a[64:67], v[84:87]
  buffer_load_dwordx4 v11, s[20:23], s28 offen offset:3072 lds
  v_pk_mul_f32 v[64:65], v[64:65], s[6:7]
  v_mfma_f32_16x16x32_bf16 v[88:91], a[80:83], a[0:3], v[88:91]
  s_bfe_u32 s56, 0x302010e, s55
  s_add_u32 s54, s54, s56
  s_add_u32 s55, s55, 8
  v_mfma_f32_16x16x32_bf16 v[120:123], a[84:87], a[0:3], v[120:123]
  s_and_b32 s55, s55, 0x8001f
  s_and_b32 s54, s54, 15
  s_lshl_b32 s28, s54, 19
  v_mfma_f32_16x16x32_bf16 v[88:91], a[104:107], a[36:39], v[88:91]
  s_add_u32 m0, s68, 16384
  v_pk_mul_f32 v[66:67], v[66:67], s[6:7]
  v_cvt_pk_bf16_f32 v32, v32, v33
  v_mfma_f32_16x16x32_bf16 v[120:123], a[108:111], a[36:39], v[120:123]
  v_cvt_pk_bf16_f32 v33, v34, v35
  v_cvt_pk_bf16_f32 v34, v64, v65
  v_mfma_f32_16x16x32_bf16 v[92:95], a[80:83], a[4:7], v[92:95]
  buffer_load_dwordx4 v8, s[20:23], s28 offen offset:0 lds
  v_cvt_pk_bf16_f32 v35, v66, v67
  v_mfma_f32_16x16x32_bf16 v[124:127], a[84:87], a[4:7], v[124:127]
  v_pk_mul_f32 v[36:37], v[36:37], s[6:7]
  v_pk_mul_f32 v[38:39], v[38:39], s[6:7]
  v_mfma_f32_16x16x32_bf16 v[92:95], a[104:107], a[40:43], v[92:95]
  v_pk_mul_f32 v[68:69], v[68:69], s[6:7]
  v_pk_mul_f32 v[70:71], v[70:71], s[6:7]
  v_mfma_f32_16x16x32_bf16 v[124:127], a[108:111], a[40:43], v[124:127]
  v_cvt_pk_bf16_f32 v36, v36, v37
  v_cvt_pk_bf16_f32 v37, v38, v39
  v_mfma_f32_16x16x32_bf16 v[96:99], a[80:83], a[8:11], v[96:99]
  v_cvt_pk_bf16_f32 v38, v68, v69
  v_cvt_pk_bf16_f32 v39, v70, v71
  v_mfma_f32_16x16x32_bf16 v[128:131], a[84:87], a[8:11], v[128:131]
  buffer_load_dwordx4 v9, s[20:23], s28 offen offset:1024 lds
  v_pk_mul_f32 v[40:41], v[40:41], s[6:7]
  v_mfma_f32_16x16x32_bf16 v[96:99], a[104:107], a[44:47], v[96:99]
  v_pk_mul_f32 v[42:43], v[42:43], s[6:7]
  v_pk_mul_f32 v[72:73], v[72:73], s[6:7]
  v_mfma_f32_16x16x32_bf16 v[128:131], a[108:111], a[44:47], v[128:131]
  v_pk_mul_f32 v[74:75], v[74:75], s[6:7]
  v_cvt_pk_bf16_f32 v40, v40, v41
  v_mfma_f32_16x16x32_bf16 v[100:103], a[80:83], a[12:15], v[100:103]
  v_cvt_pk_bf16_f32 v41, v42, v43
  v_cvt_pk_bf16_f32 v42, v72, v73
  v_mfma_f32_16x16x32_bf16 v[132:135], a[84:87], a[12:15], v[132:135]
  v_cvt_pk_bf16_f32 v43, v74, v75
  v_pk_mul_f32 v[44:45], v[44:45], s[6:7]
  v_mfma_f32_16x16x32_bf16 v[100:103], a[104:107], a[48:51], v[100:103]
  v_pk_mul_f32 v[46:47], v[46:47], s[6:7]
  v_pk_mul_f32 v[76:77], v[76:77], s[6:7]
  v_mfma_f32_16x16x32_bf16 v[132:135], a[108:111], a[48:51], v[132:135]
  buffer_load_dwordx4 v10, s[20:23], s28 offen offset:2048 lds
  v_pk_mul_f32 v[78:79], v[78:79], s[6:7]
  v_mfma_f32_16x16x32_bf16 v[104:107], a[80:83], a[16:19], v[104:107]
  v_cvt_pk_bf16_f32 v44, v44, v45
  v_cvt_pk_bf16_f32 v45, v46, v47
  v_mfma_f32_16x16x32_bf16 v[136:139], a[84:87], a[16:19], v[136:139]
  v_cvt_pk_bf16_f32 v46, v76, v77
  v_cvt_pk_bf16_f32 v47, v78, v79
  v_mfma_f32_16x16x32_bf16 v[104:107], a[104:107], a[52:55], v[104:107]
  v_pk_mul_f32 v[48:49], v[48:49], s[6:7]
  v_pk_mul_f32 v[50:51], v[50:51], s[6:7]
  v_mfma_f32_16x16x32_bf16 v[136:139], a[108:111], a[52:55], v[136:139]
  v_pk_mul_f32 v[80:81], v[80:81], s[6:7]
  v_pk_mul_f32 v[82:83], v[82:83], s[6:7]
  v_mfma_f32_16x16x32_bf16 v[108:111], a[80:83], a[20:23], v[108:111]
  buffer_load_dwordx4 v11, s[20:23], s28 offen offset:3072 lds
  v_cvt_pk_bf16_f32 v48, v48, v49
  v_mfma_f32_16x16x32_bf16 v[140:143], a[84:87], a[20:23], v[140:143]
  s_bfe_u32 s56, 0x302010e, s55
  s_add_u32 s54, s54, s56
  s_add_u32 s55, s55, 8
  v_mfma_f32_16x16x32_bf16 v[108:111], a[104:107], a[56:59], v[108:111]
  s_and_b32 s55, s55, 0x8001f
  s_and_b32 s54, s54, 15
  s_lshl_b32 s28, s54, 19
  v_mfma_f32_16x16x32_bf16 v[140:143], a[108:111], a[56:59], v[140:143]
  s_mov_b32 m0, s88
  v_cvt_pk_bf16_f32 v49, v50, v51
  v_cvt_pk_bf16_f32 v50, v80, v81
  v_mfma_f32_16x16x32_bf16 v[112:115], a[80:83], a[24:27], v[112:115]
  v_cvt_pk_bf16_f32 v51, v82, v83
  v_pk_mul_f32 v[52:53], v[52:53], s[6:7]
  v_mfma_f32_16x16x32_bf16 v[144:147], a[84:87], a[24:27], v[144:147]
  buffer_load_dwordx4 v4, s[8:11], s26 offen offset:0 lds
  v_pk_mul_f32 v[54:55], v[54:55], s[6:7]
  v_mfma_f32_16x16x32_bf16 v[112:115], a[104:107], a[60:63], v[112:115]
  v_pk_mul_f32 v[84:85], v[84:85], s[6:7]
  v_pk_mul_f32 v[86:87], v[86:87], s[6:7]
  v_mfma_f32_16x16x32_bf16 v[144:147], a[108:111], a[60:63], v[144:147]
  v_cvt_pk_bf16_f32 v52, v52, v53
  v_cvt_pk_bf16_f32 v53, v54, v55
  v_mfma_f32_16x16x32_bf16 v[116:119], a[80:83], a[28:31], v[116:119]
  v_cvt_pk_bf16_f32 v54, v84, v85
  v_cvt_pk_bf16_f32 v55, v86, v87
  v_mfma_f32_16x16x32_bf16 v[148:151], a[84:87], a[28:31], v[148:151]
  v_cvt_pk_bf16_f32 v88, v88, v89
  v_cvt_pk_bf16_f32 v89, v90, v91
  v_mfma_f32_16x16x32_bf16 v[116:119], a[104:107], a[64:67], v[116:119]
  buffer_load_dwordx4 v5, s[8:11], s26 offen offset:1024 lds
  v_cvt_pk_bf16_f32 v90, v120, v121
  v_mfma_f32_16x16x32_bf16 v[148:151], a[108:111], a[64:67], v[148:151]
  v_cvt_pk_bf16_f32 v91, v122, v123
  v_cvt_pk_bf16_f32 v92, v92, v93
  v_mfma_f32_16x16x32_bf16 v[216:219], a[32:35], a[88:91], v[216:219]
  v_cvt_pk_bf16_f32 v93, v94, v95
  v_cvt_pk_bf16_f32 v94, v124, v125
  v_mfma_f32_16x16x32_bf16 v[220:223], a[32:35], a[92:95], v[220:223]
  v_cvt_pk_bf16_f32 v95, v126, v127
  v_cvt_pk_bf16_f32 v96, v96, v97
  v_mfma_f32_16x16x32_bf16 v[216:219], a[68:71], a[112:115], v[216:219]
  v_cvt_pk_bf16_f32 v97, v98, v99
  v_cvt_pk_bf16_f32 v98, v128, v129
  v_mfma_f32_16x16x32_bf16 v[220:223], a[68:71], a[116:119], v[220:223]
  buffer_load_dwordx4 v6, s[8:11], s26 offen offset:2048 lds
  v_cvt_pk_bf16_f32 v99, v130, v131
  v_mfma_f32_16x16x32_bf16 v[180:183], a[28:31], a[88:91], v[180:183]
  v_cvt_pk_bf16_f32 v100, v100, v101
  v_cvt_pk_bf16_f32 v101, v102, v103
  v_mfma_f32_16x16x32_bf16 v[212:215], a[28:31], a[92:95], v[212:215]
  v_cvt_pk_bf16_f32 v102, v132, v133
  v_cvt_pk_bf16_f32 v103, v134, v135
  v_mfma_f32_16x16x32_bf16 v[180:183], a[64:67], a[112:115], v[180:183]
  v_cvt_pk_bf16_f32 v104, v104, v105
  v_cvt_pk_bf16_f32 v105, v106, v107
  v_mfma_f32_16x16x32_bf16 v[212:215], a[64:67], a[116:119], v[212:215]
  v_cvt_pk_bf16_f32 v106, v136, v137
  v_cvt_pk_bf16_f32 v107, v138, v139
  v_mfma_f32_16x16x32_bf16 v[176:179], a[24:27], a[88:91], v[176:179]
  v_cvt_pk_bf16_f32 v108, v108, v109
  v_cvt_pk_bf16_f32 v109, v110, v111
  v_mfma_f32_16x16x32_bf16 v[208:211], a[24:27], a[92:95], v[208:211]
  buffer_load_dwordx4 v7, s[8:11], s26 offen offset:3072 lds
  v_cvt_pk_bf16_f32 v110, v140, v141
  v_mfma_f32_16x16x32_bf16 v[176:179], a[60:63], a[112:115], v[176:179]
  s_add_u32 m0, s88, 4096
  v_cvt_pk_bf16_f32 v111, v142, v143
  v_cvt_pk_bf16_f32 v112, v112, v113
  v_mfma_f32_16x16x32_bf16 v[208:211], a[60:63], a[116:119], v[208:211]
  v_cvt_pk_bf16_f32 v113, v114, v115
  v_cvt_pk_bf16_f32 v114, v144, v145
  v_mfma_f32_16x16x32_bf16 v[172:175], a[20:23], a[88:91], v[172:175]
  v_cvt_pk_bf16_f32 v115, v146, v147
  v_cvt_pk_bf16_f32 v116, v116, v117
  v_mfma_f32_16x16x32_bf16 v[204:207], a[20:23], a[92:95], v[204:207]
  v_cvt_pk_bf16_f32 v117, v118, v119
  v_cvt_pk_bf16_f32 v118, v148, v149
  v_mfma_f32_16x16x32_bf16 v[172:175], a[56:59], a[112:115], v[172:175]
  buffer_load_dwordx4 v4, s[8:11], s27 offen offset:0 lds
  v_cvt_pk_bf16_f32 v119, v150, v151
  v_mfma_f32_16x16x32_bf16 v[204:207], a[56:59], a[116:119], v[204:207]
  v_cvt_pk_bf16_f32 v216, v216, v217
  v_cvt_pk_bf16_f32 v217, v218, v219
  v_mfma_f32_16x16x32_bf16 v[168:171], a[16:19], a[88:91], v[168:171]
  v_cvt_pk_bf16_f32 v218, v220, v221
  v_cvt_pk_bf16_f32 v219, v222, v223
  v_mfma_f32_16x16x32_bf16 v[200:203], a[16:19], a[92:95], v[200:203]
  ds_write_b128 v252, v[216:219] offset:1024
  v_cvt_pk_bf16_f32 v72, v180, v181
  v_mfma_f32_16x16x32_bf16 v[168:171], a[52:55], a[112:115], v[168:171]
  v_cvt_pk_bf16_f32 v73, v182, v183
  v_cvt_pk_bf16_f32 v136, v212, v213
  v_mfma_f32_16x16x32_bf16 v[200:203], a[52:55], a[116:119], v[200:203]
  buffer_load_dwordx4 v5, s[8:11], s27 offen offset:1024 lds
  v_cvt_pk_bf16_f32 v137, v214, v215
  v_mfma_f32_16x16x32_bf16 v[164:167], a[12:15], a[88:91], v[164:167]
  v_cvt_pk_bf16_f32 v70, v176, v177
  v_cvt_pk_bf16_f32 v71, v178, v179
  v_mfma_f32_16x16x32_bf16 v[196:199], a[12:15], a[92:95], v[196:199]
  v_cvt_pk_bf16_f32 v134, v208, v209
  v_cvt_pk_bf16_f32 v135, v210, v211
  v_mfma_f32_16x16x32_bf16 v[164:167], a[48:51], a[112:115], v[164:167]
  v_cvt_pk_bf16_f32 v68, v172, v173
  v_cvt_pk_bf16_f32 v69, v174, v175
  v_mfma_f32_16x16x32_bf16 v[196:199], a[48:51], a[116:119], v[196:199]
  v_cvt_pk_bf16_f32 v132, v204, v205
  v_cvt_pk_bf16_f32 v133, v206, v207
  v_mfma_f32_16x16x32_bf16 v[160:163], a[8:11], a[88:91], v[160:163]
  buffer_load_dwordx4 v6, s[8:11], s27 offen offset:2048 lds
  v_cvt_pk_bf16_f32 v66, v168, v169
  v_mfma_f32_16x16x32_bf16 v[192:195], a[8:11], a[92:95], v[192:195]
  v_cvt_pk_bf16_f32 v67, v170, v171
  v_cvt_pk_bf16_f32 v130, v200, v201
  v_mfma_f32_16x16x32_bf16 v[160:163], a[44:47], a[112:115], v[160:163]
  v_cvt_pk_bf16_f32 v131, v202, v203
  v_mfma_f32_16x16x32_bf16 v[192:195], a[44:47], a[116:119], v[192:195]
  v_cvt_pk_bf16_f32 v64, v164, v165
  v_cvt_pk_bf16_f32 v65, v166, v167
  v_mfma_f32_16x16x32_bf16 v[156:159], a[4:7], a[88:91], v[156:159]
  v_cvt_pk_bf16_f32 v128, v196, v197
  v_cvt_pk_bf16_f32 v129, v198, v199
  v_mfma_f32_16x16x32_bf16 v[188:191], a[4:7], a[92:95], v[188:191]
  buffer_load_dwordx4 v7, s[8:11], s27 offen offset:3072 lds
  v_mfma_f32_16x16x32_bf16 v[156:159], a[40:43], a[112:115], v[156:159]
  s_bfe_u32 s29, 0x302010e, s53
  s_add_u32 s52, s52, s29
  s_add_u32 s53, s53, 8
  v_mfma_f32_16x16x32_bf16 v[188:191], a[40:43], a[116:119], v[188:191]
  s_and_b32 s53, s53, 0x8001f
  s_and_b32 s52, s52, 15
  s_lshl_b32 s29, s52, 7
  v_mfma_f32_16x16x32_bf16 v[152:155], a[0:3], a[88:91], v[152:155]
  s_or_b32 s26, s30, s29
  s_or_b32 s27, s31, s29
  v_cvt_pk_bf16_f32 v62, v160, v161
  v_mfma_f32_16x16x32_bf16 v[184:187], a[0:3], a[92:95], v[184:187]
  v_cvt_pk_bf16_f32 v63, v162, v163
  v_cvt_pk_bf16_f32 v126, v192, v193
  v_mfma_f32_16x16x32_bf16 v[152:155], a[36:39], a[112:115], v[152:155]
  v_cvt_pk_bf16_f32 v127, v194, v195
  v_mfma_f32_16x16x32_bf16 v[184:187], a[36:39], a[116:119], v[184:187]
  v_cvt_pk_bf16_f32 v60, v156, v157
  v_cvt_pk_bf16_f32 v61, v158, v159
  v_cvt_pk_bf16_f32 v124, v188, v189
  v_cvt_pk_bf16_f32 v125, v190, v191
  s_nop 1
  v_cvt_pk_bf16_f32 v58, v152, v153
  v_cvt_pk_bf16_f32 v59, v154, v155
  v_cvt_pk_bf16_f32 v122, v184, v185
  v_cvt_pk_bf16_f32 v123, v186, v187
  s_waitcnt lgkmcnt(0)
  s_barrier
Lp2_at:
  ds_read_b128 v[76:79], v253
  ds_read_b64 v[56:57], v253 offset:1024
  ds_read_b64 v[120:121], v253 offset:1032
  v_mfma_f32_16x16x32_bf16 v[208:211], v[112:115], v[52:55], v[240:243]
  s_add_u32 m0, s88, 32768
  s_nop 0
  buffer_load_dwordx4 v4, s[8:11], s26 offen offset:0 lds
  v_mfma_f32_16x16x32_bf16 v[212:215], v[116:119], v[52:55], v[244:247]
  v_mfma_f32_16x16x32_bf16 v[200:203], v[108:111], v[48:51], v[240:243]
  v_mfma_f32_16x16x32_bf16 v[204:207], v[112:115], v[48:51], v[244:247]
  v_mfma_f32_16x16x32_bf16 v[192:195], v[104:107], v[44:47], v[240:243]
  v_mfma_f32_16x16x32_bf16 v[196:199], v[108:111], v[44:47], v[244:247]
  v_mfma_f32_16x16x32_bf16 v[184:187], v[100:103], v[40:43], v[240:243]
  v_mfma_f32_16x16x32_bf16 v[188:191], v[104:107], v[40:43], v[244:247]
  v_mfma_f32_16x16x32_bf16 v[176:179], v[96:99], v[36:39], v[240:243]
  v_mfma_f32_16x16x32_bf16 v[180:183], v[100:103], v[36:39], v[244:247]
  v_mfma_f32_16x16x32_bf16 v[168:171], v[92:95], v[32:35], v[240:243]
  v_mfma_f32_16x16x32_bf16 v[172:175], v[96:99], v[32:35], v[244:247]
  v_mfma_f32_16x16x32_bf16 v[160:163], v[88:91], v[28:31], v[240:243]
  buffer_load_dwordx4 v5, s[8:11], s26 offen offset:1024 lds
  v_mfma_f32_16x16x32_bf16 v[164:167], v[92:95], v[28:31], v[244:247]
  s_waitcnt lgkmcnt(0)
  v_mfma_f32_16x16x32_bf16 v[152:155], v[76:79], v[24:27], v[248:251]
  v_mfma_f32_16x16x32_bf16 v[156:159], v[88:91], v[24:27], v[244:247]
  v_max3_f32 v238, v208, v209, v210
  v_max3_f32 v239, v211, v212, v213
  v_max3_f32 v238, v238, v214, v215
  v_max_f32 v238, v238, v239
  v_max3_f32 v236, v200, v201, v202
  v_max3_f32 v237, v203, v204, v205
  v_max3_f32 v236, v236, v206, v207
  v_max_f32 v236, v236, v237
  v_max3_f32 v234, v192, v193, v194
  v_max3_f32 v235, v195, v196, v197
  buffer_load_dwordx4 v6, s[8:11], s26 offen offset:2048 lds
  v_max3_f32 v234, v234, v198, v199
  v_max_f32 v234, v234, v235
  v_max3_f32 v232, v184, v185, v186
  v_max3_f32 v233, v187, v188, v189
  v_max3_f32 v232, v232, v190, v191
  v_max_f32 v232, v232, v233
  v_max3_f32 v230, v176, v177, v178
  v_max3_f32 v231, v179, v180, v181
  v_max3_f32 v230, v230, v182, v183
  v_max_f32 v230, v230, v231
  v_max3_f32 v228, v168, v169, v170
  v_max3_f32 v229, v171, v172, v173
  buffer_load_dwordx4 v7, s[8:11], s26 offen offset:3072 lds
  v_max3_f32 v228, v228, v174, v175
  v_max_f32 v228, v228, v229
  v_max3_f32 v226, v160, v161, v162
  v_max3_f32 v227, v163, v164, v165
  v_max3_f32 v226, v226, v166, v167
  v_max_f32 v226, v226, v227
  v_max3_f32 v224, v152, v153, v154
  v_max3_f32 v225, v155, v156, v157
  v_max3_f32 v224, v224, v158, v159
  v_max_f32 v224, v224, v225
  v_mov_b32 v239, v238
  v_mov_b32 v237, v236
  v_mov_b32 v235, v234
  s_add_u32 m0, s88, 36864
  s_nop 0
  buffer_load_dwordx4 v4, s[8:11], s27 offen offset:0 lds
  v_mov_b32 v233, v232
  v_mov_b32 v231, v230
  v_mov_b32 v229, v228
  v_mov_b32 v227, v226
  v_mov_b32 v225, v224
  v_permlane32_swap_b32 v238, v239
  v_permlane32_swap_b32 v236, v237
  v_permlane32_swap_b32 v234, v235
  v_permlane32_swap_b32 v232, v233
  v_permlane32_swap_b32 v230, v231
  v_permlane32_swap_b32 v228, v229
  v_permlane32_swap_b32 v226, v227
  buffer_load_dwordx4 v5, s[8:11], s27 offen offset:1024 lds
  v_permlane32_swap_b32 v224, v225
  v_max_f32 v238, v238, v239
  v_max_f32 v236, v236, v237
  v_max_f32 v234, v234, v235
  v_max_f32 v232, v232, v233
  v_max_f32 v230, v230, v231
  v_max_f32 v228, v228, v229
  v_max_f32 v226, v226, v227
  v_max_f32 v224, v224, v225
  v_mov_b32 v239, v238
  v_mov_b32 v237, v236
  v_mov_b32 v235, v234
  buffer_load_dwordx4 v6, s[8:11], s27 offen offset:2048 lds
  v_mov_b32 v233, v232
  v_mov_b32 v231, v230
  v_mov_b32 v229, v228
  v_mov_b32 v227, v226
  v_mov_b32 v225, v224
  v_permlane16_swap_b32 v238, v239
  v_permlane16_swap_b32 v236, v237
  v_permlane16_swap_b32 v234, v235
  v_permlane16_swap_b32 v232, v233
  v_permlane16_swap_b32 v230, v231
  v_permlane16_swap_b32 v228, v229
  v_permlane16_swap_b32 v226, v227
  buffer_load_dwordx4 v7, s[8:11], s27 offen offset:3072 lds
  v_permlane16_swap_b32 v224, v225
  v_max_f32 v238, v238, v239
  v_max_f32 v236, v236, v237
  v_max_f32 v234, v234, v235
  v_max_f32 v232, v232, v233
  v_max_f32 v230, v230, v231
  v_max_f32 v228, v228, v229
  v_max_f32 v226, v226, v227
  v_max_f32 v224, v224, v225
  v_sub_f32 v208, v208, v238
  v_sub_f32 v209, v209, v238
  v_sub_f32 v210, v210, v238
  v_sub_f32 v211, v211, v238
  s_bfe_u32 s29, 0x302010e, s53
  s_add_u32 s52, s52, s29
  s_add_u32 s53, s53, 8
  s_and_b32 s53, s53, 0x8001f
  s_and_b32 s52, s52, 15
  s_lshl_b32 s29, s52, 7
  s_or_b32 s26, s30, s29
  s_or_b32 s27, s31, s29
  s_add_u32 m0, s68, 32768
  s_nop 0
  buffer_load_dwordx4 v8, s[20:23], s28 offen offset:0 lds
  v_sub_f32 v212, v212, v238
  v_sub_f32 v213, v213, v238
  v_sub_f32 v214, v214, v238
  v_sub_f32 v215, v215, v238
  v_exp_f32 v208, v208
  v_exp_f32 v209, v209
  v_exp_f32 v210, v210
  v_exp_f32 v211, v211
  v_exp_f32 v212, v212
  v_exp_f32 v213, v213
  v_exp_f32 v214, v214
  v_exp_f32 v215, v215
  buffer_load_dwordx4 v9, s[20:23], s28 offen offset:1024 lds
  v_sub_f32 v200, v200, v236
  v_sub_f32 v201, v201, v236
  v_sub_f32 v202, v202, v236
  v_sub_f32 v203, v203, v236
  v_sub_f32 v204, v204, v236
  v_sub_f32 v205, v205, v236
  v_sub_f32 v206, v206, v236
  v_sub_f32 v207, v207, v236
  v_exp_f32 v200, v200
  v_exp_f32 v201, v201
  v_exp_f32 v202, v202
  v_exp_f32 v203, v203
  buffer_load_dwordx4 v10, s[20:23], s28 offen offset:2048 lds
  v_exp_f32 v204, v204
  v_exp_f32 v205, v205
  v_exp_f32 v206, v206
  v_exp_f32 v207, v207
  v_cvt_pk_bf16_f32 v116, v208, v209
  v_cvt_pk_bf16_f32 v117, v210, v211
  v_cvt_pk_bf16_f32 v118, v212, v213
  v_cvt_pk_bf16_f32 v119, v214, v215
  s_nop 1
  v_mfma_f32_16x16x32_bf16 v[52:55], a[208:211], v[116:119], 0
  v_mfma_f32_16x16x32_bf16 v[208:211], v[70:73], v[116:119], 0
  v_mfma_f32_16x16x32_bf16 v[212:215], v[134:137], v[116:119], 0
  v_sub_f32 v192, v192, v234
  buffer_load_dwordx4 v11, s[20:23], s28 offen offset:3072 lds
  v_sub_f32 v193, v193, v234
  v_sub_f32 v194, v194, v234
  v_sub_f32 v195, v195, v234
  v_sub_f32 v196, v196, v234
  v_sub_f32 v197, v197, v234
  v_sub_f32 v198, v198, v234
  v_sub_f32 v199, v199, v234
  v_exp_f32 v192, v192
  v_exp_f32 v193, v193
  v_exp_f32 v194, v194
  v_exp_f32 v195, v195
  v_exp_f32 v196, v196
  v_exp_f32 v197, v197
  s_bfe_u32 s56, 0x302010e, s55
  s_add_u32 s54, s54, s56
  s_add_u32 s55, s55, 8
  s_and_b32 s55, s55, 0x8001f
  s_and_b32 s54, s54, 15
  s_lshl_b32 s28, s54, 19
  s_add_u32 m0, s88, -32768
  s_nop 0
  buffer_load_dwordx4 v4, s[8:11], s26 offen offset:0 lds
  v_exp_f32 v198, v198
  v_exp_f32 v199, v199
  v_cvt_pk_bf16_f32 v112, v200, v201
  v_cvt_pk_bf16_f32 v113, v202, v203
  v_cvt_pk_bf16_f32 v114, v204, v205
  v_cvt_pk_bf16_f32 v115, v206, v207
  s_nop 1
  v_mfma_f32_16x16x32_bf16 v[48:51], a[208:211], v[112:115], 0
  v_mfma_f32_16x16x32_bf16 v[200:203], v[68:71], v[112:115], 0
  v_mfma_f32_16x16x32_bf16 v[204:207], v[132:135], v[112:115], 0
  v_sub_f32 v184, v184, v232
  v_sub_f32 v185, v185, v232
  v_sub_f32 v186, v186, v232
  buffer_load_dwordx4 v5, s[8:11], s26 offen offset:1024 lds
  v_sub_f32 v187, v187, v232
  v_sub_f32 v188, v188, v232
  v_sub_f32 v189, v189, v232
  v_sub_f32 v190, v190, v232
  v_sub_f32 v191, v191, v232
  v_exp_f32 v184, v184
  v_exp_f32 v185, v185
  v_exp_f32 v186, v186
  v_exp_f32 v187, v187
  v_exp_f32 v188, v188
  v_exp_f32 v189, v189
  v_exp_f32 v190, v190
  buffer_load_dwordx4 v6, s[8:11], s26 offen offset:2048 lds
  v_exp_f32 v191, v191
  v_cvt_pk_bf16_f32 v108, v192, v193
  v_cvt_pk_bf16_f32 v109, v194, v195
  v_cvt_pk_bf16_f32 v110, v196, v197
  v_cvt_pk_bf16_f32 v111, v198, v199
  s_nop 1
  v_mfma_f32_16x16x32_bf16 v[44:47], a[208:211], v[108:111], 0
  v_mfma_f32_16x16x32_bf16 v[192:195], v[66:69], v[108:111], 0
  v_mfma_f32_16x16x32_bf16 v[196:199], v[130:133], v[108:111], 0
  v_sub_f32 v176, v176, v230
  v_sub_f32 v177, v177, v230
  v_sub_f32 v178, v178, v230
  v_sub_f32 v179, v179, v230
  buffer_load_dwordx4 v7, s[8:11], s26 offen offset:3072 lds
  v_sub_f32 v180, v180, v230
  v_sub_f32 v181, v181, v230
  v_sub_f32 v182, v182, v230
  v_sub_f32 v183, v183, v230
  v_exp_f32 v176, v176
  v_exp_f32 v177, v177
  v_exp_f32 v178, v178
  v_exp_f32 v179, v179
  v_exp_f32 v180, v180
  v_exp_f32 v181, v181
  v_exp_f32 v182, v182
  v_exp_f32 v183, v183
  v_cvt_pk_bf16_f32 v104, v184, v185
  s_add_u32 m0, s88, -28672
  s_nop 0
  buffer_load_dwordx4 v4, s[8:11], s27 offen offset:0 lds
  v_cvt_pk_bf16_f32 v105, v186, v187
  v_cvt_pk_bf16_f32 v106, v188, v189
  v_cvt_pk_bf16_f32 v107, v190, v191
  s_nop 1
  v_mfma_f32_16x16x32_bf16 v[40:43], a[208:211], v[104:107], 0
  v_mfma_f32_16x16x32_bf16 v[184:187], v[64:67], v[104:107], 0
  v_mfma_f32_16x16x32_bf16 v[188:191], v[128:131], v[104:107], 0
  v_sub_f32 v168, v168, v228
  v_sub_f32 v169, v169, v228
  v_sub_f32 v170, v170, v228
  v_sub_f32 v171, v171, v228
  v_sub_f32 v172, v172, v228
  v_sub_f32 v173, v173, v228
  buffer_load_dwordx4 v5, s[8:11], s27 offen offset:1024 lds
  v_sub_f32 v174, v174, v228
  v_sub_f32 v175, v175, v228
  v_exp_f32 v168, v168
  v_exp_f32 v169, v169
  v_exp_f32 v170, v170
  v_exp_f32 v171, v171
  v_exp_f32 v172, v172
  v_exp_f32 v173, v173
  v_exp_f32 v174, v174
  v_exp_f32 v175, v175
  v_cvt_pk_bf16_f32 v100, v176, v177
  v_cvt_pk_bf16_f32 v101, v178, v179
  buffer_load_dwordx4 v6, s[8:11], s27 offen offset:2048 lds
  v_cvt_pk_bf16_f32 v102, v180, v181
  v_cvt_pk_bf16_f32 v103, v182, v183
  s_nop 1
  v_mfma_f32_16x16x32_bf16 v[36:39], a[208:211], v[100:103], 0
  v_mfma_f32_16x16x32_bf16 v[176:179], v[62:65], v[100:103], 0
  v_mfma_f32_16x16x32_bf16 v[180:183], v[126:129], v[100:103], 0
  v_sub_f32 v160, v160, v226
  v_sub_f32 v161, v161, v226
  v_sub_f32 v162, v162, v226
  v_sub_f32 v163, v163, v226
  v_sub_f32 v164, v164, v226
  v_sub_f32 v165, v165, v226
  v_sub_f32 v166, v166, v226
  buffer_load_dwordx4 v7, s[8:11], s27 offen offset:3072 lds
  s_bfe_u32 s29, 0x302010e, s53
  s_add_u32 s52, s52, s29
  s_add_u32 s53, s53, 8
  s_and_b32 s53, s53, 0x8001f
  s_and_b32 s52, s52, 15
  s_lshl_b32 s29, s52, 7
  s_or_b32 s26, s30, s29
  s_or_b32 s27, s31, s29
  v_sub_f32 v167, v167, v226
  v_exp_f32 v160, v160
  v_exp_f32 v161, v161
  v_exp_f32 v162, v162
  v_exp_f32 v163, v163
  v_exp_f32 v164, v164
  v_exp_f32 v165, v165
  v_exp_f32 v166, v166
  v_exp_f32 v167, v167
  v_cvt_pk_bf16_f32 v96, v168, v169
  v_cvt_pk_bf16_f32 v97, v170, v171
  v_cvt_pk_bf16_f32 v98, v172, v173
  v_cvt_pk_bf16_f32 v99, v174, v175
  s_nop 1
  v_mfma_f32_16x16x32_bf16 v[32:35], a[208:211], v[96:99], 0
  v_mfma_f32_16x16x32_bf16 v[168:171], v[60:63], v[96:99], 0
  v_mfma_f32_16x16x32_bf16 v[172:175], v[124:127], v[96:99], 0
  v_sub_f32 v152, v152, v224
  v_sub_f32 v153, v153, v224
  v_sub_f32 v154, v154, v224
  v_sub_f32 v155, v155, v224
  v_sub_f32 v156, v156, v224
  v_sub_f32 v157, v157, v224
  v_sub_f32 v158, v158, v224
  v_sub_f32 v159, v159, v224
  v_exp_f32 v152, v152
  v_exp_f32 v153, v153
  v_exp_f32 v154, v154
  v_exp_f32 v155, v155
  v_exp_f32 v156, v156
  v_exp_f32 v157, v157
  v_exp_f32 v158, v158
  v_exp_f32 v159, v159
  v_cvt_pk_bf16_f32 v92, v160, v161
  v_cvt_pk_bf16_f32 v93, v162, v163
  v_cvt_pk_bf16_f32 v94, v164, v165
  v_cvt_pk_bf16_f32 v95, v166, v167
  s_nop 1
  v_mfma_f32_16x16x32_bf16 v[28:31], a[208:211], v[92:95], 0
  v_mfma_f32_16x16x32_bf16 v[160:163], v[58:61], v[92:95], 0
  v_mfma_f32_16x16x32_bf16 v[164:167], v[122:125], v[92:95], 0
  v_cvt_pk_bf16_f32 v88, v152, v153
  v_cvt_pk_bf16_f32 v89, v154, v155
  v_cvt_pk_bf16_f32 v90, v156, v157
  v_cvt_pk_bf16_f32 v91, v158, v159
  s_nop 1
  v_mfma_f32_16x16x32_bf16 v[24:27], a[208:211], v[88:91], 0
  v_mfma_f32_16x16x32_bf16 v[152:155], v[56:59], v[88:91], 0
  v_mfma_f32_16x16x32_bf16 v[156:159], v[120:123], v[88:91], 0
  v_rcp_f32 v52, v52
  v_rcp_f32 v48, v48
  v_rcp_f32 v44, v44
  v_rcp_f32 v40, v40
  v_rcp_f32 v36, v36
  v_rcp_f32 v32, v32
  v_rcp_f32 v28, v28
  v_rcp_f32 v24, v24
  v_mov_b32 v53, v52
  v_mov_b32 v49, v48
  v_mov_b32 v45, v44
  v_mov_b32 v41, v40
  v_mov_b32 v37, v36
  v_mov_b32 v33, v32
  v_mov_b32 v29, v28
  v_mov_b32 v25, v24
  v_pk_mul_f32 v[208:209], v[208:209], v[52:53]
  v_pk_mul_f32 v[210:211], v[210:211], v[52:53]
  v_pk_mul_f32 v[212:213], v[212:213], v[52:53]
  v_pk_mul_f32 v[214:215], v[214:215], v[52:53]
  v_cvt_pk_bf16_f32 v208, v208, v209
  v_cvt_pk_bf16_f32 v209, v210, v211
  v_cvt_pk_bf16_f32 v210, v212, v213
  v_cvt_pk_bf16_f32 v211, v214, v215
  buffer_store_dwordx4 v[208:211], v2, s[16:19], s58 offen offset:3072 sc1
  v_pk_mul_f32 v[200:201], v[200:201], v[48:49]
  v_pk_mul_f32 v[202:203], v[202:203], v[48:49]
  v_pk_mul_f32 v[204:205], v[204:205], v[48:49]
  v_pk_mul_f32 v[206:207], v[206:207], v[48:49]
  v_cvt_pk_bf16_f32 v200, v200, v201
  v_cvt_pk_bf16_f32 v201, v202, v203
  v_cvt_pk_bf16_f32 v202, v204, v205
  v_cvt_pk_bf16_f32 v203, v206, v207
  buffer_store_dwordx4 v[200:203], v2, s[16:19], s58 offen offset:2048 sc1
  v_pk_mul_f32 v[192:193], v[192:193], v[44:45]
  v_pk_mul_f32 v[194:195], v[194:195], v[44:45]
  v_pk_mul_f32 v[196:197], v[196:197], v[44:45]
  v_pk_mul_f32 v[198:199], v[198:199], v[44:45]
  v_cvt_pk_bf16_f32 v192, v192, v193
  v_cvt_pk_bf16_f32 v193, v194, v195
  v_cvt_pk_bf16_f32 v194, v196, v197
  v_cvt_pk_bf16_f32 v195, v198, v199
  buffer_store_dwordx4 v[192:195], v2, s[16:19], s58 offen offset:1024 sc1
  v_pk_mul_f32 v[184:185], v[184:185], v[40:41]
  v_pk_mul_f32 v[186:187], v[186:187], v[40:41]
  v_pk_mul_f32 v[188:189], v[188:189], v[40:41]
  v_pk_mul_f32 v[190:191], v[190:191], v[40:41]
  v_cvt_pk_bf16_f32 v184, v184, v185
  v_cvt_pk_bf16_f32 v185, v186, v187
  v_cvt_pk_bf16_f32 v186, v188, v189
  v_cvt_pk_bf16_f32 v187, v190, v191
  buffer_store_dwordx4 v[184:187], v2, s[16:19], s58 offen offset:0 sc1
  v_pk_mul_f32 v[176:177], v[176:177], v[36:37]
  v_pk_mul_f32 v[178:179], v[178:179], v[36:37]
  v_pk_mul_f32 v[180:181], v[180:181], v[36:37]
  v_pk_mul_f32 v[182:183], v[182:183], v[36:37]
  v_cvt_pk_bf16_f32 v176, v176, v177
  v_cvt_pk_bf16_f32 v177, v178, v179
  v_cvt_pk_bf16_f32 v178, v180, v181
  v_cvt_pk_bf16_f32 v179, v182, v183
  buffer_store_dwordx4 v[176:179], v2, s[16:19], s57 offen offset:3072 sc1
  v_pk_mul_f32 v[168:169], v[168:169], v[32:33]
  v_pk_mul_f32 v[170:171], v[170:171], v[32:33]
  v_pk_mul_f32 v[172:173], v[172:173], v[32:33]
  v_pk_mul_f32 v[174:175], v[174:175], v[32:33]
  v_cvt_pk_bf16_f32 v168, v168, v169
  v_cvt_pk_bf16_f32 v169, v170, v171
  v_cvt_pk_bf16_f32 v170, v172, v173
  v_cvt_pk_bf16_f32 v171, v174, v175
  buffer_store_dwordx4 v[168:171], v2, s[16:19], s57 offen offset:2048 sc1
  v_pk_mul_f32 v[160:161], v[160:161], v[28:29]
  v_pk_mul_f32 v[162:163], v[162:163], v[28:29]
  v_pk_mul_f32 v[164:165], v[164:165], v[28:29]
  v_pk_mul_f32 v[166:167], v[166:167], v[28:29]
  v_cvt_pk_bf16_f32 v160, v160, v161
  v_cvt_pk_bf16_f32 v161, v162, v163
  v_cvt_pk_bf16_f32 v162, v164, v165
  v_cvt_pk_bf16_f32 v163, v166, v167
  buffer_store_dwordx4 v[160:163], v2, s[16:19], s57 offen offset:1024 sc1
  v_pk_mul_f32 v[152:153], v[152:153], v[24:25]
  v_pk_mul_f32 v[154:155], v[154:155], v[24:25]
  v_pk_mul_f32 v[156:157], v[156:157], v[24:25]
  v_pk_mul_f32 v[158:159], v[158:159], v[24:25]
  v_cvt_pk_bf16_f32 v152, v152, v153
  v_cvt_pk_bf16_f32 v153, v154, v155
  v_cvt_pk_bf16_f32 v154, v156, v157
  v_cvt_pk_bf16_f32 v155, v158, v159
  buffer_store_dwordx4 v[152:155], v2, s[16:19], s57 offen offset:0 sc1
  s_lshl_b32 s34, s32, 4
  s_add_u32 s34, s34, s33
  s_lshl_b32 s34, s34, 7
  s_add_u32 s34, s34, 32768
  s_mov_b32 s63, 0x70000000
Lp3:
  v_accvgpr_read_b32 v16, a230
  v_accvgpr_read_b32 v17, a231
  v_accvgpr_read_b32 v18, a232
  v_accvgpr_read_b32 v19, a233
  v_accvgpr_read_b32 v20, a234
  v_accvgpr_read_b32 v21, a235
  s_mov_b32 s89, 0
  s_mov_b32 s91, 4294901760
  s_mov_b32 s92, 32768
  s_mov_b32 s89, 1
  s_mov_b32 s69, 0
  s_mov_b32 s71, 4294934528
  s_mov_b32 s72, 16384
  s_waitcnt vmcnt(28)
  s_barrier
  ds_read_b128 a[0:3], v16 offset:0
  ds_read_b64_tr_b16 a[32:33], v18 offset:0
  ds_read_b64_tr_b16 a[34:35], v18 offset:2048
  ds_read_b128 a[4:7], v16 offset:2048
  ds_read_b128 a[8:11], v16 offset:4096
  ds_read_b128 a[12:15], v16 offset:6144
  ds_read_b64_tr_b16 a[36:37], v19 offset:0
  ds_read_b64_tr_b16 a[38:39], v19 offset:2048
  ds_read_b64_tr_b16 a[40:41], v20 offset:0
  ds_read_b64_tr_b16 a[42:43], v20 offset:2048
  ds_read_b64_tr_b16 a[44:45], v21 offset:0
  ds_read_b64_tr_b16 a[46:47], v21 offset:2048
  ds_read_b64_tr_b16 a[48:49], v18 offset:8192
  ds_read_b64_tr_b16 a[50:51], v18 offset:10240
  ds_read_b64_tr_b16 a[52:53], v19 offset:8192
  ds_read_b64_tr_b16 a[54:55], v19 offset:10240
  ds_read_b64_tr_b16 a[56:57], v20 offset:8192
  ds_read_b64_tr_b16 a[58:59], v20 offset:10240
  ds_read_b64_tr_b16 a[60:61], v21 offset:8192
  ds_read_b64_tr_b16 a[62:63], v21 offset:10240
  s_waitcnt lgkmcnt(0)
  v_mfma_f32_16x16x32_bf16 v[32:35], a[32:35], a[0:3], 0
  s_add_u32 s60, s63, 32768
  buffer_store_dwordx4 v[192:195], v2, s[16:19], s60 offen offset:0 sc1
  ds_read_b128 a[16:19], v17 offset:0
  v_mfma_f32_16x16x32_bf16 v[64:67], a[32:35], a[4:7], 0
  s_add_u32 s60, s63, 40960
  ds_read_b64_tr_b16 a[64:65], v18 offset:4096
  v_mfma_f32_16x16x32_bf16 v[96:99], a[32:35], a[8:11], 0
  ds_read_b64_tr_b16 a[66:67], v18 offset:6144
  v_mfma_f32_16x16x32_bf16 v[128:131], a[32:35], a[12:15], 0
  buffer_store_dwordx4 v[224:227], v2, s[16:19], s60 offen offset:0 sc1
  ds_read_b128 a[20:23], v17 offset:2048
  v_mfma_f32_16x16x32_bf16 v[36:39], a[36:39], a[0:3], 0
  s_add_u32 s60, s63, 32768
  ds_read_b128 a[24:27], v17 offset:4096
  v_mfma_f32_16x16x32_bf16 v[68:71], a[36:39], a[4:7], 0
  ds_read_b128 a[28:31], v17 offset:6144
  v_mfma_f32_16x16x32_bf16 v[100:103], a[36:39], a[8:11], 0
  buffer_store_dwordx4 v[196:199], v2, s[16:19], s60 offen offset:1024 sc1
  ds_read_b64_tr_b16 a[68:69], v19 offset:4096
  v_mfma_f32_16x16x32_bf16 v[132:135], a[36:39], a[12:15], 0
  s_add_u32 s60, s63, 40960
  ds_read_b64_tr_b16 a[70:71], v19 offset:6144
  v_mfma_f32_16x16x32_bf16 v[40:43], a[40:43], a[0:3], 0
  ds_read_b64_tr_b16 a[72:73], v20 offset:4096
  v_mfma_f32_16x16x32_bf16 v[72:75], a[40:43], a[4:7], 0
  buffer_store_dwordx4 v[228:231], v2, s[16:19], s60 offen offset:1024 sc1
  ds_read_b64_tr_b16 a[74:75], v20 offset:6144
  v_mfma_f32_16x16x32_bf16 v[104:107], a[40:43], a[8:11], 0
  s_add_u32 s60, s63, 32768
  v_mfma_f32_16x16x32_bf16 v[136:139], a[40:43], a[12:15], 0
  ds_read_b64_tr_b16 a[76:77], v21 offset:4096
  v_mfma_f32_16x16x32_bf16 v[44:47], a[44:47], a[0:3], 0
  buffer_store_dwordx4 v[200:203], v2, s[16:19], s60 offen offset:2048 sc1
  ds_read_b64_tr_b16 a[78:79], v21 offset:6144
  v_mfma_f32_16x16x32_bf16 v[76:79], a[44:47], a[4:7], 0
  s_add_u32 s60, s63, 40960
  ds_read_b64_tr_b16 a[80:81], v18 offset:12288
  v_mfma_f32_16x16x32_bf16 v[108:111], a[44:47], a[8:11], 0
  ds_read_b64_tr_b16 a[82:83], v18 offset:14336
  v_mfma_f32_16x16x32_bf16 v[140:143], a[44:47], a[12:15], 0
  buffer_store_dwordx4 v[232:235], v2, s[16:19], s60 offen offset:2048 sc1
  ds_read_b64_tr_b16 a[84:85], v19 offset:12288
  v_mfma_f32_16x16x32_bf16 v[48:51], a[48:51], a[0:3], 0
  s_add_u32 s60, s63, 32768
  ds_read_b64_tr_b16 a[86:87], v19 offset:14336
  v_mfma_f32_16x16x32_bf16 v[80:83], a[48:51], a[4:7], 0
  ds_read_b64_tr_b16 a[88:89], v20 offset:12288
  v_mfma_f32_16x16x32_bf16 v[112:115], a[48:51], a[8:11], 0
  buffer_store_dwordx4 v[204:207], v2, s[16:19], s60 offen offset:3072 sc1
  ds_read_b64_tr_b16 a[90:91], v20 offset:14336
  v_mfma_f32_16x16x32_bf16 v[144:147], a[48:51], a[12:15], 0
  s_add_u32 s60, s63, 40960
  ds_read_b64_tr_b16 a[92:93], v21 offset:12288
  v_mfma_f32_16x16x32_bf16 v[52:55], a[52:55], a[0:3], 0
  ds_read_b64_tr_b16 a[94:95], v21 offset:14336
  v_mfma_f32_16x16x32_bf16 v[84:87], a[52:55], a[4:7], 0
  buffer_store_dwordx4 v[236:239], v2, s[16:19], s60 offen offset:3072 sc1
  v_mfma_f32_16x16x32_bf16 v[116:119], a[52:55], a[8:11], 0
  s_add_u32 s89, s89, 1
  s_cmp_eq_u32 s89, 3
  s_cselect_b32 s89, 0, s89
  s_cselect_b32 s90, s91, s92
  v_mfma_f32_16x16x32_bf16 v[148:151], a[52:55], a[12:15], 0
  s_add_u32 s69, s69, 1
  s_cmp_eq_u32 s69, 3
  s_cselect_b32 s69, 0, s69
  s_cselect_b32 s70, s71, s72
  v_mfma_f32_16x16x32_bf16 v[56:59], a[56:59], a[0:3], 0
  v_add_u32 v16, s90, v16
  v_add_u32 v17, s90, v17
  v_mfma_f32_16x16x32_bf16 v[88:91], a[56:59], a[4:7], 0
  v_add_u32 v18, s70, v18
  v_add_u32 v19, s70, v19
  v_mfma_f32_16x16x32_bf16 v[120:123], a[56:59], a[8:11], 0
  v_add_u32 v20, s70, v20
  v_add_u32 v21, s70, v21
  v_mfma_f32_16x16x32_bf16 v[152:155], a[56:59], a[12:15], 0
  v_mfma_f32_16x16x32_bf16 v[60:63], a[60:63], a[0:3], 0
  v_mfma_f32_16x16x32_bf16 v[92:95], a[60:63], a[4:7], 0
  v_mfma_f32_16x16x32_bf16 v[124:127], a[60:63], a[8:11], 0
  v_mfma_f32_16x16x32_bf16 v[156:159], a[60:63], a[12:15], 0
  s_waitcnt vmcnt(20) lgkmcnt(0)
  s_barrier
  v_mfma_f32_16x16x32_bf16 v[32:35], a[64:67], a[16:19], v[32:35]
  s_mov_b32 m0, s68
  ds_read_b128 a[0:3], v16 offset:0
  v_mfma_f32_16x16x32_bf16 v[64:67], a[64:67], a[20:23], v[64:67]
  buffer_load_dwordx4 v8, s[20:23], s28 offen offset:0 lds
  ds_read_b64_tr_b16 a[32:33], v18 offset:0
  v_mfma_f32_16x16x32_bf16 v[96:99], a[64:67], a[24:27], v[96:99]
  ds_read_b64_tr_b16 a[34:35], v18 offset:2048
  v_mfma_f32_16x16x32_bf16 v[128:131], a[64:67], a[28:31], v[128:131]
  ds_read_b128 a[4:7], v16 offset:2048
  v_mfma_f32_16x16x32_bf16 v[36:39], a[68:71], a[16:19], v[36:39]
  ds_read_b128 a[8:11], v16 offset:4096
  v_mfma_f32_16x16x32_bf16 v[68:71], a[68:71], a[20:23], v[68:71]
  buffer_load_dwordx4 v9, s[20:23], s28 offen offset:1024 lds
  ds_read_b128 a[12:15], v16 offset:6144
  v_mfma_f32_16x16x32_bf16 v[100:103], a[68:71], a[24:27], v[100:103]
  ds_read_b64_tr_b16 a[36:37], v19 offset:0
  v_mfma_f32_16x16x32_bf16 v[132:135], a[68:71], a[28:31], v[132:135]
  ds_read_b64_tr_b16 a[38:39], v19 offset:2048
  v_mfma_f32_16x16x32_bf16 v[40:43], a[72:75], a[16:19], v[40:43]
  ds_read_b64_tr_b16 a[40:41], v20 offset:0
  v_mfma_f32_16x16x32_bf16 v[72:75], a[72:75], a[20:23], v[72:75]
  ds_read_b64_tr_b16 a[42:43], v20 offset:2048
  v_mfma_f32_16x16x32_bf16 v[104:107], a[72:75], a[24:27], v[104:107]
  buffer_load_dwordx4 v10, s[20:23], s28 offen offset:2048 lds
  v_mfma_f32_16x16x32_bf16 v[136:139], a[72:75], a[28:31], v[136:139]
  ds_read_b64_tr_b16 a[44:45], v21 offset:0
  v_mfma_f32_16x16x32_bf16 v[44:47], a[76:79], a[16:19], v[44:47]
  ds_read_b64_tr_b16 a[46:47], v21 offset:2048
  v_mfma_f32_16x16x32_bf16 v[76:79], a[76:79], a[20:23], v[76:79]
  ds_read_b64_tr_b16 a[48:49], v18 offset:8192
  v_mfma_f32_16x16x32_bf16 v[108:111], a[76:79], a[24:27], v[108:111]
  ds_read_b64_tr_b16 a[50:51], v18 offset:10240
  v_mfma_f32_16x16x32_bf16 v[140:143], a[76:79], a[28:31], v[140:143]
  buffer_load_dwordx4 v11, s[20:23], s28 offen offset:3072 lds
  ds_read_b64_tr_b16 a[52:53], v19 offset:8192
  v_mfma_f32_16x16x32_bf16 v[48:51], a[80:83], a[16:19], v[48:51]
  s_bfe_u32 s56, 0x302010e, s55
  s_add_u32 s54, s54, s56
  s_add_u32 s55, s55, 8
  v_mfma_f32_16x16x32_bf16 v[80:83], a[80:83], a[20:23], v[80:83]
  s_and_b32 s55, s55, 0x8001f
  s_and_b32 s54, s54, 15
  s_lshl_b32 s28, s54, 19
  v_mfma_f32_16x16x32_bf16 v[112:115], a[80:83], a[24:27], v[112:115]
  s_mov_b32 m0, s88
  ds_read_b64_tr_b16 a[54:55], v19 offset:10240
  ds_read_b64_tr_b16 a[56:57], v20 offset:8192
  v_mfma_f32_16x16x32_bf16 v[144:147], a[80:83], a[28:31], v[144:147]
  ds_read_b64_tr_b16 a[58:59], v20 offset:10240
  ds_read_b64_tr_b16 a[60:61], v21 offset:8192
  v_mfma_f32_16x16x32_bf16 v[52:55], a[84:87], a[16:19], v[52:55]
  buffer_load_dwordx4 v4, s[8:11], s26 offen offset:0 lds
  ds_read_b64_tr_b16 a[62:63], v21 offset:10240
  v_mfma_f32_16x16x32_bf16 v[84:87], a[84:87], a[20:23], v[84:87]
  v_mfma_f32_16x16x32_bf16 v[116:119], a[84:87], a[24:27], v[116:119]
  v_mfma_f32_16x16x32_bf16 v[148:151], a[84:87], a[28:31], v[148:151]
  v_mfma_f32_16x16x32_bf16 v[56:59], a[88:91], a[16:19], v[56:59]
  v_mfma_f32_16x16x32_bf16 v[88:91], a[88:91], a[20:23], v[88:91]
  buffer_load_dwordx4 v5, s[8:11], s26 offen offset:1024 lds
  v_mfma_f32_16x16x32_bf16 v[120:123], a[88:91], a[24:27], v[120:123]
  v_mfma_f32_16x16x32_bf16 v[152:155], a[88:91], a[28:31], v[152:155]
  v_mfma_f32_16x16x32_bf16 v[60:63], a[92:95], a[16:19], v[60:63]
  v_mfma_f32_16x16x32_bf16 v[92:95], a[92:95], a[20:23], v[92:95]
  v_mfma_f32_16x16x32_bf16 v[124:127], a[92:95], a[24:27], v[124:127]
  v_mfma_f32_16x16x32_bf16 v[156:159], a[92:95], a[28:31], v[156:159]
  s_waitcnt lgkmcnt(0)
  v_mfma_f32_16x16x32_bf16 v[32:35], a[32:35], a[0:3], v[32:35]
  buffer_load_dwordx4 v6, s[8:11], s26 offen offset:2048 lds
  ds_read_b128 a[16:19], v17 offset:0
  v_mfma_f32_16x16x32_bf16 v[64:67], a[32:35], a[4:7], v[64:67]
  ds_read_b64_tr_b16 a[64:65], v18 offset:4096
  v_mfma_f32_16x16x32_bf16 v[96:99], a[32:35], a[8:11], v[96:99]
  ds_read_b64_tr_b16 a[66:67], v18 offset:6144
  v_mfma_f32_16x16x32_bf16 v[128:131], a[32:35], a[12:15], v[128:131]
  ds_read_b128 a[20:23], v17 offset:2048
  v_mfma_f32_16x16x32_bf16 v[36:39], a[36:39], a[0:3], v[36:39]
  buffer_load_dwordx4 v7, s[8:11], s26 offen offset:3072 lds
  ds_read_b128 a[24:27], v17 offset:4096
  v_mfma_f32_16x16x32_bf16 v[68:71], a[36:39], a[4:7], v[68:71]
  s_add_u32 m0, s88, 4096
  ds_read_b128 a[28:31], v17 offset:6144
  v_mfma_f32_16x16x32_bf16 v[100:103], a[36:39], a[8:11], v[100:103]
  ds_read_b64_tr_b16 a[68:69], v19 offset:4096
  v_mfma_f32_16x16x32_bf16 v[132:135], a[36:39], a[12:15], v[132:135]
  ds_read_b64_tr_b16 a[70:71], v19 offset:6144
  v_mfma_f32_16x16x32_bf16 v[40:43], a[40:43], a[0:3], v[40:43]
  buffer_load_dwordx4 v4, s[8:11], s27 offen offset:0 lds
  ds_read_b64_tr_b16 a[72:73], v20 offset:4096
  v_mfma_f32_16x16x32_bf16 v[72:75], a[40:43], a[4:7], v[72:75]
  ds_read_b64_tr_b16 a[74:75], v20 offset:6144
  v_mfma_f32_16x16x32_bf16 v[104:107], a[40:43], a[8:11], v[104:107]
  v_mfma_f32_16x16x32_bf16 v[136:139], a[40:43], a[12:15], v[136:139]
  ds_read_b64_tr_b16 a[76:77], v21 offset:4096
  v_mfma_f32_16x16x32_bf16 v[44:47], a[44:47], a[0:3], v[44:47]
  buffer_load_dwordx4 v5, s[8:11], s27 offen offset:1024 lds
  ds_read_b64_tr_b16 a[78:79], v21 offset:6144
  v_mfma_f32_16x16x32_bf16 v[76:79], a[44:47], a[4:7], v[76:79]
  ds_read_b64_tr_b16 a[80:81], v18 offset:12288
  v_mfma_f32_16x16x32_bf16 v[108:111], a[44:47], a[8:11], v[108:111]
  ds_read_b64_tr_b16 a[82:83], v18 offset:14336
  v_mfma_f32_16x16x32_bf16 v[140:143], a[44:47], a[12:15], v[140:143]
  ds_read_b64_tr_b16 a[84:85], v19 offset:12288
  v_mfma_f32_16x16x32_bf16 v[48:51], a[48:51], a[0:3], v[48:51]
  buffer_load_dwordx4 v6, s[8:11], s27 offen offset:2048 lds
  ds_read_b64_tr_b16 a[86:87], v19 offset:14336
  v_mfma_f32_16x16x32_bf16 v[80:83], a[48:51], a[4:7], v[80:83]
  ds_read_b64_tr_b16 a[88:89], v20 offset:12288
  v_mfma_f32_16x16x32_bf16 v[112:115], a[48:51], a[8:11], v[112:115]
  ds_read_b64_tr_b16 a[90:91], v20 offset:14336
  v_mfma_f32_16x16x32_bf16 v[144:147], a[48:51], a[12:15], v[144:147]
  ds_read_b64_tr_b16 a[92:93], v21 offset:12288
  v_mfma_f32_16x16x32_bf16 v[52:55], a[52:55], a[0:3], v[52:55]
  buffer_load_dwordx4 v7, s[8:11], s27 offen offset:3072 lds
  ds_read_b64_tr_b16 a[94:95], v21 offset:14336
  v_mfma_f32_16x16x32_bf16 v[84:87], a[52:55], a[4:7], v[84:87]
  s_bfe_u32 s29, 0x302010e, s53
  s_add_u32 s52, s52, s29
  s_add_u32 s53, s53, 8
  v_mfma_f32_16x16x32_bf16 v[116:119], a[52:55], a[8:11], v[116:119]
  s_and_b32 s53, s53, 0x8001f
  s_and_b32 s52, s52, 15
  s_lshl_b32 s29, s52, 7
  v_mfma_f32_16x16x32_bf16 v[148:151], a[52:55], a[12:15], v[148:151]
  s_or_b32 s26, s30, s29
  s_or_b32 s27, s31, s29
  v_mfma_f32_16x16x32_bf16 v[56:59], a[56:59], a[0:3], v[56:59]
  s_add_u32 s88, s88, s90
  s_add_u32 s89, s89, 1
  s_cmp_eq_u32 s89, 3
  s_cselect_b32 s89, 0, s89
  s_cselect_b32 s90, s91, s92
  v_mfma_f32_16x16x32_bf16 v[88:91], a[56:59], a[4:7], v[88:91]
  s_add_u32 s68, s68, s70
  s_add_u32 s69, s69, 1
  s_cmp_eq_u32 s69, 3
  s_cselect_b32 s69, 0, s69
  s_cselect_b32 s70, s71, s72
  v_mfma_f32_16x16x32_bf16 v[120:123], a[56:59], a[8:11], v[120:123]
  v_add_u32 v16, s90, v16
  v_add_u32 v17, s90, v17
  v_mfma_f32_16x16x32_bf16 v[152:155], a[56:59], a[12:15], v[152:155]
  v_add_u32 v18, s70, v18
  v_add_u32 v19, s70, v19
  v_mfma_f32_16x16x32_bf16 v[60:63], a[60:63], a[0:3], v[60:63]
  v_add_u32 v20, s70, v20
  v_add_u32 v21, s70, v21
  v_mfma_f32_16x16x32_bf16 v[92:95], a[60:63], a[4:7], v[92:95]
  v_mfma_f32_16x16x32_bf16 v[124:127], a[60:63], a[8:11], v[124:127]
  v_mfma_f32_16x16x32_bf16 v[156:159], a[60:63], a[12:15], v[156:159]
  s_waitcnt vmcnt(20) lgkmcnt(0)
  s_barrier
  v_mfma_f32_16x16x32_bf16 v[32:35], a[64:67], a[16:19], v[32:35]
  s_mov_b32 m0, s68
  ds_read_b128 a[0:3], v16 offset:0
  v_mfma_f32_16x16x32_bf16 v[64:67], a[64:67], a[20:23], v[64:67]
  buffer_load_dwordx4 v8, s[20:23], s28 offen offset:0 lds
  ds_read_b64_tr_b16 a[32:33], v18 offset:0
  v_mfma_f32_16x16x32_bf16 v[96:99], a[64:67], a[24:27], v[96:99]
  ds_read_b64_tr_b16 a[34:35], v18 offset:2048
  v_mfma_f32_16x16x32_bf16 v[128:131], a[64:67], a[28:31], v[128:131]
  buffer_load_dwordx4 v9, s[20:23], s28 offen offset:1024 lds
  ds_read_b128 a[4:7], v16 offset:2048
  v_mfma_f32_16x16x32_bf16 v[36:39], a[68:71], a[16:19], v[36:39]
  ds_read_b128 a[8:11], v16 offset:4096
  v_mfma_f32_16x16x32_bf16 v[68:71], a[68:71], a[20:23], v[68:71]
  ds_read_b128 a[12:15], v16 offset:6144
  v_mfma_f32_16x16x32_bf16 v[100:103], a[68:71], a[24:27], v[100:103]
  buffer_load_dwordx4 v10, s[20:23], s28 offen offset:2048 lds
  ds_read_b64_tr_b16 a[36:37], v19 offset:0
  v_mfma_f32_16x16x32_bf16 v[132:135], a[68:71], a[28:31], v[132:135]
  ds_read_b64_tr_b16 a[38:39], v19 offset:2048
  v_mfma_f32_16x16x32_bf16 v[40:43], a[72:75], a[16:19], v[40:43]
  ds_read_b64_tr_b16 a[40:41], v20 offset:0
  v_mfma_f32_16x16x32_bf16 v[72:75], a[72:75], a[20:23], v[72:75]
  buffer_load_dwordx4 v11, s[20:23], s28 offen offset:3072 lds
  ds_read_b64_tr_b16 a[42:43], v20 offset:2048
  v_mfma_f32_16x16x32_bf16 v[104:107], a[72:75], a[24:27], v[104:107]
  s_bfe_u32 s56, 0x302010e, s55
  s_add_u32 s54, s54, s56
  s_add_u32 s55, s55, 8
  v_mfma_f32_16x16x32_bf16 v[136:139], a[72:75], a[28:31], v[136:139]
  s_and_b32 s55, s55, 0x8001f
  s_and_b32 s54, s54, 15
  s_lshl_b32 s28, s54, 19
  v_mfma_f32_16x16x32_bf16 v[44:47], a[76:79], a[16:19], v[44:47]
  s_mov_b32 m0, s88
  ds_read_b64_tr_b16 a[44:45], v21 offset:0
  ds_read_b64_tr_b16 a[46:47], v21 offset:2048
  v_mfma_f32_16x16x32_bf16 v[76:79], a[76:79], a[20:23], v[76:79]
  buffer_load_dwordx4 v4, s[8:11], s26 offen offset:0 lds
  ds_read_b64_tr_b16 a[48:49], v18 offset:8192
  v_mfma_f32_16x16x32_bf16 v[108:111], a[76:79], a[24:27], v[108:111]
  ds_read_b64_tr_b16 a[50:51], v18 offset:10240
  v_mfma_f32_16x16x32_bf16 v[140:143], a[76:79], a[28:31], v[140:143]
  buffer_load_dwordx4 v5, s[8:11], s26 offen offset:1024 lds
  ds_read_b64_tr_b16 a[52:53], v19 offset:8192
  v_mfma_f32_16x16x32_bf16 v[48:51], a[80:83], a[16:19], v[48:51]
  ds_read_b64_tr_b16 a[54:55], v19 offset:10240
  v_mfma_f32_16x16x32_bf16 v[80:83], a[80:83], a[20:23], v[80:83]
  ds_read_b64_tr_b16 a[56:57], v20 offset:8192
  v_mfma_f32_16x16x32_bf16 v[112:115], a[80:83], a[24:27], v[112:115]
  buffer_load_dwordx4 v6, s[8:11], s26 offen offset:2048 lds
  ds_read_b64_tr_b16 a[58:59], v20 offset:10240
  v_mfma_f32_16x16x32_bf16 v[144:147], a[80:83], a[28:31], v[144:147]
  ds_read_b64_tr_b16 a[60:61], v21 offset:8192
  v_mfma_f32_16x16x32_bf16 v[52:55], a[84:87], a[16:19], v[52:55]
  ds_read_b64_tr_b16 a[62:63], v21 offset:10240
  v_mfma_f32_16x16x32_bf16 v[84:87], a[84:87], a[20:23], v[84:87]
  buffer_load_dwordx4 v7, s[8:11], s26 offen offset:3072 lds
  v_mfma_f32_16x16x32_bf16 v[116:119], a[84:87], a[24:27], v[116:119]
  s_add_u32 m0, s88, 4096
  v_mfma_f32_16x16x32_bf16 v[148:151], a[84:87], a[28:31], v[148:151]
  v_mfma_f32_16x16x32_bf16 v[56:59], a[88:91], a[16:19], v[56:59]
  buffer_load_dwordx4 v4, s[8:11], s27 offen offset:0 lds
  v_mfma_f32_16x16x32_bf16 v[88:91], a[88:91], a[20:23], v[88:91]
  v_mfma_f32_16x16x32_bf16 v[120:123], a[88:91], a[24:27], v[120:123]
  v_mfma_f32_16x16x32_bf16 v[152:155], a[88:91], a[28:31], v[152:155]
  buffer_load_dwordx4 v5, s[8:11], s27 offen offset:1024 lds
  v_mfma_f32_16x16x32_bf16 v[60:63], a[92:95], a[16:19], v[60:63]
  v_mfma_f32_16x16x32_bf16 v[92:95], a[92:95], a[20:23], v[92:95]
  v_mfma_f32_16x16x32_bf16 v[124:127], a[92:95], a[24:27], v[124:127]
  v_mfma_f32_16x16x32_bf16 v[156:159], a[92:95], a[28:31], v[156:159]
  s_waitcnt lgkmcnt(0)
  v_mfma_f32_16x16x32_bf16 v[32:35], a[32:35], a[0:3], v[32:35]
  buffer_load_dwordx4 v6, s[8:11], s27 offen offset:2048 lds
  ds_read_b128 a[16:19], v17 offset:0
  v_mfma_f32_16x16x32_bf16 v[64:67], a[32:35], a[4:7], v[64:67]
  ds_read_b64_tr_b16 a[64:65], v18 offset:4096
  v_mfma_f32_16x16x32_bf16 v[96:99], a[32:35], a[8:11], v[96:99]
  buffer_load_dwordx4 v7, s[8:11], s27 offen offset:3072 lds
  ds_read_b64_tr_b16 a[66:67], v18 offset:6144
  v_mfma_f32_16x16x32_bf16 v[128:131], a[32:35], a[12:15], v[128:131]
  s_bfe_u32 s29, 0x302010e, s53
  s_add_u32 s52, s52, s29
  s_add_u32 s53, s53, 8
  v_mfma_f32_16x16x32_bf16 v[36:39], a[36:39], a[0:3], v[36:39]
  s_and_b32 s53, s53, 0x8001f
  s_and_b32 s52, s52, 15
  s_lshl_b32 s29, s52, 7
  v_mfma_f32_16x16x32_bf16 v[68:71], a[36:39], a[4:7], v[68:71]
  s_or_b32 s26, s30, s29
  s_or_b32 s27, s31, s29
  s_add_u32 s60, s63, 36864
  v_mfma_f32_16x16x32_bf16 v[100:103], a[36:39], a[8:11], v[100:103]
  buffer_store_dwordx4 v[208:211], v2, s[16:19], s60 offen offset:0 sc1
  ds_read_b128 a[20:23], v17 offset:2048
  v_mfma_f32_16x16x32_bf16 v[132:135], a[36:39], a[12:15], v[132:135]
  s_add_u32 s60, s63, 45056
  buffer_store_dwordx4 v[240:243], v2, s[16:19], s60 offen offset:0 sc1
  ds_read_b128 a[24:27], v17 offset:4096
  v_mfma_f32_16x16x32_bf16 v[40:43], a[40:43], a[0:3], v[40:43]
  s_add_u32 s60, s63, 36864
  ds_read_b128 a[28:31], v17 offset:6144
  ds_read_b64_tr_b16 a[68:69], v19 offset:4096
  v_mfma_f32_16x16x32_bf16 v[72:75], a[40:43], a[4:7], v[72:75]
  ds_read_b64_tr_b16 a[70:71], v19 offset:6144
  ds_read_b64_tr_b16 a[72:73], v20 offset:4096
  v_mfma_f32_16x16x32_bf16 v[104:107], a[40:43], a[8:11], v[104:107]
  buffer_store_dwordx4 v[212:215], v2, s[16:19], s60 offen offset:1024 sc1
  ds_read_b64_tr_b16 a[74:75], v20 offset:6144
  v_mfma_f32_16x16x32_bf16 v[136:139], a[40:43], a[12:15], v[136:139]
  s_add_u32 s60, s63, 45056
  ds_read_b64_tr_b16 a[76:77], v21 offset:4096
  v_mfma_f32_16x16x32_bf16 v[44:47], a[44:47], a[0:3], v[44:47]
  buffer_store_dwordx4 v[244:247], v2, s[16:19], s60 offen offset:1024 sc1
  ds_read_b64_tr_b16 a[78:79], v21 offset:6144
  v_mfma_f32_16x16x32_bf16 v[76:79], a[44:47], a[4:7], v[76:79]
  s_add_u32 s60, s63, 36864
  ds_read_b64_tr_b16 a[80:81], v18 offset:12288
  v_mfma_f32_16x16x32_bf16 v[108:111], a[44:47], a[8:11], v[108:111]
  ds_read_b64_tr_b16 a[82:83], v18 offset:14336
  v_mfma_f32_16x16x32_bf16 v[140:143], a[44:47], a[12:15], v[140:143]
  buffer_store_dwordx4 v[216:219], v2, s[16:19], s60 offen offset:2048 sc1
  ds_read_b64_tr_b16 a[84:85], v19 offset:12288
  v_mfma_f32_16x16x32_bf16 v[48:51], a[48:51], a[0:3], v[48:51]
  s_add_u32 s60, s63, 45056
  ds_read_b64_tr_b16 a[86:87], v19 offset:14336
  v_mfma_f32_16x16x32_bf16 v[80:83], a[48:51], a[4:7], v[80:83]
  buffer_store_dwordx4 v[248:251], v2, s[16:19], s60 offen offset:2048 sc1
  ds_read_b64_tr_b16 a[88:89], v20 offset:12288
  v_mfma_f32_16x16x32_bf16 v[112:115], a[48:51], a[8:11], v[112:115]
  s_add_u32 s60, s63, 36864
  ds_read_b64_tr_b16 a[90:91], v20 offset:14336
  v_mfma_f32_16x16x32_bf16 v[144:147], a[48:51], a[12:15], v[144:147]
  ds_read_b64_tr_b16 a[92:93], v21 offset:12288
  v_mfma_f32_16x16x32_bf16 v[52:55], a[52:55], a[0:3], v[52:55]
  buffer_store_dwordx4 v[220:223], v2, s[16:19], s60 offen offset:3072 sc1
  ds_read_b64_tr_b16 a[94:95], v21 offset:14336
  v_mfma_f32_16x16x32_bf16 v[84:87], a[52:55], a[4:7], v[84:87]
  s_add_u32 s60, s63, 45056
  v_mfma_f32_16x16x32_bf16 v[116:119], a[52:55], a[8:11], v[116:119]
  buffer_store_dwordx4 v[252:255], v2, s[16:19], s60 offen offset:3072 sc1
  v_mfma_f32_16x16x32_bf16 v[148:151], a[52:55], a[12:15], v[148:151]
  s_add_u32 s88, s88, s90
  s_add_u32 s89, s89, 1
  s_cmp_eq_u32 s89, 3
  s_cselect_b32 s89, 0, s89
  s_cselect_b32 s90, s91, s92
  v_mfma_f32_16x16x32_bf16 v[56:59], a[56:59], a[0:3], v[56:59]
  s_add_u32 s68, s68, s70
  s_add_u32 s69, s69, 1
  s_cmp_eq_u32 s69, 3
  s_cselect_b32 s69, 0, s69
  s_cselect_b32 s70, s71, s72
  v_mfma_f32_16x16x32_bf16 v[88:91], a[56:59], a[4:7], v[88:91]
  v_add_u32 v16, s90, v16
  v_add_u32 v17, s90, v17
  v_mfma_f32_16x16x32_bf16 v[120:123], a[56:59], a[8:11], v[120:123]
  v_add_u32 v18, s70, v18
  v_add_u32 v19, s70, v19
  v_mfma_f32_16x16x32_bf16 v[152:155], a[56:59], a[12:15], v[152:155]
  v_add_u32 v20, s70, v20
  v_add_u32 v21, s70, v21
  v_mfma_f32_16x16x32_bf16 v[60:63], a[60:63], a[0:3], v[60:63]
  v_mfma_f32_16x16x32_bf16 v[92:95], a[60:63], a[4:7], v[92:95]
  v_mfma_f32_16x16x32_bf16 v[124:127], a[60:63], a[8:11], v[124:127]
  v_mfma_f32_16x16x32_bf16 v[156:159], a[60:63], a[12:15], v[156:159]
  s_waitcnt vmcnt(20) lgkmcnt(0)
  s_barrier
  v_mfma_f32_16x16x32_bf16 v[32:35], a[64:67], a[16:19], v[32:35]
  s_mov_b32 m0, s68
  ds_read_b128 a[0:3], v16 offset:0
  v_mfma_f32_16x16x32_bf16 v[64:67], a[64:67], a[20:23], v[64:67]
  buffer_load_dwordx4 v8, s[20:23], s28 offen offset:0 lds
  ds_read_b64_tr_b16 a[32:33], v18 offset:0
  v_mfma_f32_16x16x32_bf16 v[96:99], a[64:67], a[24:27], v[96:99]
  ds_read_b64_tr_b16 a[34:35], v18 offset:2048
  v_mfma_f32_16x16x32_bf16 v[128:131], a[64:67], a[28:31], v[128:131]
  ds_read_b128 a[4:7], v16 offset:2048
  v_mfma_f32_16x16x32_bf16 v[36:39], a[68:71], a[16:19], v[36:39]
  ds_read_b128 a[8:11], v16 offset:4096
  v_mfma_f32_16x16x32_bf16 v[68:71], a[68:71], a[20:23], v[68:71]
  buffer_load_dwordx4 v9, s[20:23], s28 offen offset:1024 lds
  ds_read_b128 a[12:15], v16 offset:6144
  v_mfma_f32_16x16x32_bf16 v[100:103], a[68:71], a[24:27], v[100:103]
  ds_read_b64_tr_b16 a[36:37], v19 offset:0
  v_mfma_f32_16x16x32_bf16 v[132:135], a[68:71], a[28:31], v[132:135]
  ds_read_b64_tr_b16 a[38:39], v19 offset:2048
  v_mfma_f32_16x16x32_bf16 v[40:43], a[72:75], a[16:19], v[40:43]
  ds_read_b64_tr_b16 a[40:41], v20 offset:0
  v_mfma_f32_16x16x32_bf16 v[72:75], a[72:75], a[20:23], v[72:75]
  ds_read_b64_tr_b16 a[42:43], v20 offset:2048
  v_mfma_f32_16x16x32_bf16 v[104:107], a[72:75], a[24:27], v[104:107]
  buffer_load_dwordx4 v10, s[20:23], s28 offen offset:2048 lds
  v_mfma_f32_16x16x32_bf16 v[136:139], a[72:75], a[28:31], v[136:139]
  ds_read_b64_tr_b16 a[44:45], v21 offset:0
  v_mfma_f32_16x16x32_bf16 v[44:47], a[76:79], a[16:19], v[44:47]
  ds_read_b64_tr_b16 a[46:47], v21 offset:2048
  v_mfma_f32_16x16x32_bf16 v[76:79], a[76:79], a[20:23], v[76:79]
  ds_read_b64_tr_b16 a[48:49], v18 offset:8192
  v_mfma_f32_16x16x32_bf16 v[108:111], a[76:79], a[24:27], v[108:111]
  ds_read_b64_tr_b16 a[50:51], v18 offset:10240
  v_mfma_f32_16x16x32_bf16 v[140:143], a[76:79], a[28:31], v[140:143]
  buffer_load_dwordx4 v11, s[20:23], s28 offen offset:3072 lds
  ds_read_b64_tr_b16 a[52:53], v19 offset:8192
  v_mfma_f32_16x16x32_bf16 v[48:51], a[80:83], a[16:19], v[48:51]
  s_bfe_u32 s56, 0x302010e, s55
  s_add_u32 s54, s54, s56
  s_add_u32 s55, s55, 8
  v_mfma_f32_16x16x32_bf16 v[80:83], a[80:83], a[20:23], v[80:83]
  s_and_b32 s55, s55, 0x8001f
  s_and_b32 s54, s54, 15
  s_lshl_b32 s28, s54, 19
  v_mfma_f32_16x16x32_bf16 v[112:115], a[80:83], a[24:27], v[112:115]
  s_mov_b32 m0, s88
  ds_read_b64_tr_b16 a[54:55], v19 offset:10240
  ds_read_b64_tr_b16 a[56:57], v20 offset:8192
  v_mfma_f32_16x16x32_bf16 v[144:147], a[80:83], a[28:31], v[144:147]
  ds_read_b64_tr_b16 a[58:59], v20 offset:10240
  ds_read_b64_tr_b16 a[60:61], v21 offset:8192
  v_mfma_f32_16x16x32_bf16 v[52:55], a[84:87], a[16:19], v[52:55]
  buffer_load_dwordx4 v4, s[8:11], s26 offen offset:0 lds
  ds_read_b64_tr_b16 a[62:63], v21 offset:10240
  v_mfma_f32_16x16x32_bf16 v[84:87], a[84:87], a[20:23], v[84:87]
  v_mfma_f32_16x16x32_bf16 v[116:119], a[84:87], a[24:27], v[116:119]
  v_mfma_f32_16x16x32_bf16 v[148:151], a[84:87], a[28:31], v[148:151]
  v_mfma_f32_16x16x32_bf16 v[56:59], a[88:91], a[16:19], v[56:59]
  v_mfma_f32_16x16x32_bf16 v[88:91], a[88:91], a[20:23], v[88:91]
  buffer_load_dwordx4 v5, s[8:11], s26 offen offset:1024 lds
  v_mfma_f32_16x16x32_bf16 v[120:123], a[88:91], a[24:27], v[120:123]
  v_mfma_f32_16x16x32_bf16 v[152:155], a[88:91], a[28:31], v[152:155]
  v_mfma_f32_16x16x32_bf16 v[60:63], a[92:95], a[16:19], v[60:63]
  v_mfma_f32_16x16x32_bf16 v[92:95], a[92:95], a[20:23], v[92:95]
  v_mfma_f32_16x16x32_bf16 v[124:127], a[92:95], a[24:27], v[124:127]
  v_mfma_f32_16x16x32_bf16 v[156:159], a[92:95], a[28:31], v[156:159]
  s_waitcnt lgkmcnt(0)
  v_mfma_f32_16x16x32_bf16 v[32:35], a[32:35], a[0:3], v[32:35]
  buffer_load_dwordx4 v6, s[8:11], s26 offen offset:2048 lds
  ds_read_b128 a[16:19], v17 offset:0
  v_mfma_f32_16x16x32_bf16 v[64:67], a[32:35], a[4:7], v[64:67]
  ds_read_b64_tr_b16 a[64:65], v18 offset:4096
  v_mfma_f32_16x16x32_bf16 v[96:99], a[32:35], a[8:11], v[96:99]
  ds_read_b64_tr_b16 a[66:67], v18 offset:6144
  v_mfma_f32_16x16x32_bf16 v[128:131], a[32:35], a[12:15], v[128:131]
  ds_read_b128 a[20:23], v17 offset:2048
  v_mfma_f32_16x16x32_bf16 v[36:39], a[36:39], a[0:3], v[36:39]
  buffer_load_dwordx4 v7, s[8:11], s26 offen offset:3072 lds
  ds_read_b128 a[24:27], v17 offset:4096
  v_mfma_f32_16x16x32_bf16 v[68:71], a[36:39], a[4:7], v[68:71]
  s_add_u32 m0, s88, 4096
  ds_read_b128 a[28:31], v17 offset:6144
  v_mfma_f32_16x16x32_bf16 v[100:103], a[36:39], a[8:11], v[100:103]
  ds_read_b64_tr_b16 a[68:69], v19 offset:4096
  v_mfma_f32_16x16x32_bf16 v[132:135], a[36:39], a[12:15], v[132:135]
  ds_read_b64_tr_b16 a[70:71], v19 offset:6144
  v_mfma_f32_16x16x32_bf16 v[40:43], a[40:43], a[0:3], v[40:43]
  buffer_load_dwordx4 v4, s[8:11], s27 offen offset:0 lds
  ds_read_b64_tr_b16 a[72:73], v20 offset:4096
  v_mfma_f32_16x16x32_bf16 v[72:75], a[40:43], a[4:7], v[72:75]
  ds_read_b64_tr_b16 a[74:75], v20 offset:6144
  v_mfma_f32_16x16x32_bf16 v[104:107], a[40:43], a[8:11], v[104:107]
  v_mfma_f32_16x16x32_bf16 v[136:139], a[40:43], a[12:15], v[136:139]
  ds_read_b64_tr_b16 a[76:77], v21 offset:4096
  v_mfma_f32_16x16x32_bf16 v[44:47], a[44:47], a[0:3], v[44:47]
  buffer_load_dwordx4 v5, s[8:11], s27 offen offset:1024 lds
  ds_read_b64_tr_b16 a[78:79], v21 offset:6144
  v_mfma_f32_16x16x32_bf16 v[76:79], a[44:47], a[4:7], v[76:79]
  ds_read_b64_tr_b16 a[80:81], v18 offset:12288
  v_mfma_f32_16x16x32_bf16 v[108:111], a[44:47], a[8:11], v[108:111]
  ds_read_b64_tr_b16 a[82:83], v18 offset:14336
  v_mfma_f32_16x16x32_bf16 v[140:143], a[44:47], a[12:15], v[140:143]
  ds_read_b64_tr_b16 a[84:85], v19 offset:12288
  v_mfma_f32_16x16x32_bf16 v[48:51], a[48:51], a[0:3], v[48:51]
  buffer_load_dwordx4 v6, s[8:11], s27 offen offset:2048 lds
  ds_read_b64_tr_b16 a[86:87], v19 offset:14336
  v_mfma_f32_16x16x32_bf16 v[80:83], a[48:51], a[4:7], v[80:83]
  ds_read_b64_tr_b16 a[88:89], v20 offset:12288
  v_mfma_f32_16x16x32_bf16 v[112:115], a[48:51], a[8:11], v[112:115]
  ds_read_b64_tr_b16 a[90:91], v20 offset:14336
  v_mfma_f32_16x16x32_bf16 v[144:147], a[48:51], a[12:15], v[144:147]
  ds_read_b64_tr_b16 a[92:93], v21 offset:12288
  v_mfma_f32_16x16x32_bf16 v[52:55], a[52:55], a[0:3], v[52:55]
  buffer_load_dwordx4 v7, s[8:11], s27 offen offset:3072 lds
  ds_read_b64_tr_b16 a[94:95], v21 offset:14336
  v_mfma_f32_16x16x32_bf16 v[84:87], a[52:55], a[4:7], v[84:87]
  s_bfe_u32 s29, 0x302010e, s53
  s_add_u32 s52, s52, s29
  s_add_u32 s53, s53, 8
  v_mfma_f32_16x16x32_bf16 v[116:119], a[52:55], a[8:11], v[116:119]
  s_and_b32 s53, s53, 0x8001f
  s_and_b32 s52, s52, 15
  s_lshl_b32 s29, s52, 7
  v_mfma_f32_16x16x32_bf16 v[148:151], a[52:55], a[12:15], v[148:151]
  s_or_b32 s26, s30, s29
  s_or_b32 s27, s31, s29
  v_mfma_f32_16x16x32_bf16 v[56:59], a[56:59], a[0:3], v[56:59]
  s_add_u32 s88, s88, s90
  s_add_u32 s89, s89, 1
  s_cmp_eq_u32 s89, 3
  s_cselect_b32 s89, 0, s89
  s_cselect_b32 s90, s91, s92
  v_mfma_f32_16x16x32_bf16 v[88:91], a[56:59], a[4:7], v[88:91]
  s_add_u32 s68, s68, s70
  s_add_u32 s69, s69, 1
  s_cmp_eq_u32 s69, 3
  s_cselect_b32 s69, 0, s69
  s_cselect_b32 s70, s71, s72
  v_mfma_f32_16x16x32_bf16 v[120:123], a[56:59], a[8:11], v[120:123]
  v_add_u32 v16, s90, v16
  v_add_u32 v17, s90, v17
  v_mfma_f32_16x16x32_bf16 v[152:155], a[56:59], a[12:15], v[152:155]
  v_add_u32 v18, s70, v18
  v_add_u32 v19, s70, v19
  v_mfma_f32_16x16x32_bf16 v[60:63], a[60:63], a[0:3], v[60:63]
  v_add_u32 v20, s70, v20
  v_add_u32 v21, s70, v21
  v_mfma_f32_16x16x32_bf16 v[92:95], a[60:63], a[4:7], v[92:95]
  v_mfma_f32_16x16x32_bf16 v[124:127], a[60:63], a[8:11], v[124:127]
  v_mfma_f32_16x16x32_bf16 v[156:159], a[60:63], a[12:15], v[156:159]
  s_waitcnt vmcnt(20) lgkmcnt(0)
  s_barrier
  v_mfma_f32_16x16x32_bf16 v[32:35], a[64:67], a[16:19], v[32:35]
  s_mov_b32 m0, s68
  ds_read_b128 a[0:3], v16 offset:0
  v_mfma_f32_16x16x32_bf16 v[64:67], a[64:67], a[20:23], v[64:67]
  buffer_load_dwordx4 v8, s[20:23], s28 offen offset:0 lds
  ds_read_b64_tr_b16 a[32:33], v18 offset:0
  v_mfma_f32_16x16x32_bf16 v[96:99], a[64:67], a[24:27], v[96:99]
  ds_read_b64_tr_b16 a[34:35], v18 offset:2048
  v_mfma_f32_16x16x32_bf16 v[128:131], a[64:67], a[28:31], v[128:131]
  buffer_load_dwordx4 v9, s[20:23], s28 offen offset:1024 lds
  ds_read_b128 a[4:7], v16 offset:2048
  v_mfma_f32_16x16x32_bf16 v[36:39], a[68:71], a[16:19], v[36:39]
  ds_read_b128 a[8:11], v16 offset:4096
  v_mfma_f32_16x16x32_bf16 v[68:71], a[68:71], a[20:23], v[68:71]
  ds_read_b128 a[12:15], v16 offset:6144
  v_mfma_f32_16x16x32_bf16 v[100:103], a[68:71], a[24:27], v[100:103]
  buffer_load_dwordx4 v10, s[20:23], s28 offen offset:2048 lds
  ds_read_b64_tr_b16 a[36:37], v19 offset:0
  v_mfma_f32_16x16x32_bf16 v[132:135], a[68:71], a[28:31], v[132:135]
  ds_read_b64_tr_b16 a[38:39], v19 offset:2048
  v_mfma_f32_16x16x32_bf16 v[40:43], a[72:75], a[16:19], v[40:43]
  ds_read_b64_tr_b16 a[40:41], v20 offset:0
  v_mfma_f32_16x16x32_bf16 v[72:75], a[72:75], a[20:23], v[72:75]
  buffer_load_dwordx4 v11, s[20:23], s28 offen offset:3072 lds
  ds_read_b64_tr_b16 a[42:43], v20 offset:2048
  v_mfma_f32_16x16x32_bf16 v[104:107], a[72:75], a[24:27], v[104:107]
  s_bfe_u32 s56, 0x302010e, s55
  s_add_u32 s54, s54, s56
  s_add_u32 s55, s55, 8
  v_mfma_f32_16x16x32_bf16 v[136:139], a[72:75], a[28:31], v[136:139]
  s_and_b32 s55, s55, 0x8001f
  s_and_b32 s54, s54, 15
  s_lshl_b32 s28, s54, 19
  v_mfma_f32_16x16x32_bf16 v[44:47], a[76:79], a[16:19], v[44:47]
  s_mov_b32 m0, s88
  ds_read_b64_tr_b16 a[44:45], v21 offset:0
  ds_read_b64_tr_b16 a[46:47], v21 offset:2048
  v_mfma_f32_16x16x32_bf16 v[76:79], a[76:79], a[20:23], v[76:79]
  buffer_load_dwordx4 v4, s[8:11], s26 offen offset:0 lds
  ds_read_b64_tr_b16 a[48:49], v18 offset:8192
  v_mfma_f32_16x16x32_bf16 v[108:111], a[76:79], a[24:27], v[108:111]
  ds_read_b64_tr_b16 a[50:51], v18 offset:10240
  v_mfma_f32_16x16x32_bf16 v[140:143], a[76:79], a[28:31], v[140:143]
  buffer_load_dwordx4 v5, s[8:11], s26 offen offset:1024 lds
  ds_read_b64_tr_b16 a[52:53], v19 offset:8192
  v_mfma_f32_16x16x32_bf16 v[48:51], a[80:83], a[16:19], v[48:51]
  ds_read_b64_tr_b16 a[54:55], v19 offset:10240
  v_mfma_f32_16x16x32_bf16 v[80:83], a[80:83], a[20:23], v[80:83]
  ds_read_b64_tr_b16 a[56:57], v20 offset:8192
  v_mfma_f32_16x16x32_bf16 v[112:115], a[80:83], a[24:27], v[112:115]
  buffer_load_dwordx4 v6, s[8:11], s26 offen offset:2048 lds
  ds_read_b64_tr_b16 a[58:59], v20 offset:10240
  v_mfma_f32_16x16x32_bf16 v[144:147], a[80:83], a[28:31], v[144:147]
  ds_read_b64_tr_b16 a[60:61], v21 offset:8192
  v_mfma_f32_16x16x32_bf16 v[52:55], a[84:87], a[16:19], v[52:55]
  ds_read_b64_tr_b16 a[62:63], v21 offset:10240
  v_mfma_f32_16x16x32_bf16 v[84:87], a[84:87], a[20:23], v[84:87]
  buffer_load_dwordx4 v7, s[8:11], s26 offen offset:3072 lds
  v_mfma_f32_16x16x32_bf16 v[116:119], a[84:87], a[24:27], v[116:119]
  s_add_u32 m0, s88, 4096
  v_mfma_f32_16x16x32_bf16 v[148:151], a[84:87], a[28:31], v[148:151]
  v_mfma_f32_16x16x32_bf16 v[56:59], a[88:91], a[16:19], v[56:59]
  buffer_load_dwordx4 v4, s[8:11], s27 offen offset:0 lds
  v_mfma_f32_16x16x32_bf16 v[88:91], a[88:91], a[20:23], v[88:91]
  v_mfma_f32_16x16x32_bf16 v[120:123], a[88:91], a[24:27], v[120:123]
  v_mfma_f32_16x16x32_bf16 v[152:155], a[88:91], a[28:31], v[152:155]
  buffer_load_dwordx4 v5, s[8:11], s27 offen offset:1024 lds
  v_mfma_f32_16x16x32_bf16 v[60:63], a[92:95], a[16:19], v[60:63]
  v_mfma_f32_16x16x32_bf16 v[92:95], a[92:95], a[20:23], v[92:95]
  v_mfma_f32_16x16x32_bf16 v[124:127], a[92:95], a[24:27], v[124:127]
  v_mfma_f32_16x16x32_bf16 v[156:159], a[92:95], a[28:31], v[156:159]
  s_waitcnt lgkmcnt(0)
  v_mfma_f32_16x16x32_bf16 v[32:35], a[32:35], a[0:3], v[32:35]
  buffer_load_dwordx4 v6, s[8:11], s27 offen offset:2048 lds
  ds_read_b128 a[16:19], v17 offset:0
  v_mfma_f32_16x16x32_bf16 v[64:67], a[32:35], a[4:7], v[64:67]
  ds_read_b64_tr_b16 a[64:65], v18 offset:4096
  v_mfma_f32_16x16x32_bf16 v[96:99], a[32:35], a[8:11], v[96:99]
  buffer_load_dwordx4 v7, s[8:11], s27 offen offset:3072 lds
  ds_read_b64_tr_b16 a[66:67], v18 offset:6144
  v_mfma_f32_16x16x32_bf16 v[128:131], a[32:35], a[12:15], v[128:131]
  s_bfe_u32 s29, 0x302010e, s53
  s_add_u32 s52, s52, s29
  s_add_u32 s53, s53, 8
  v_mfma_f32_16x16x32_bf16 v[36:39], a[36:39], a[0:3], v[36:39]
  s_and_b32 s53, s53, 0x8001f
  s_and_b32 s52, s52, 15
  s_lshl_b32 s29, s52, 7
  v_mfma_f32_16x16x32_bf16 v[68:71], a[36:39], a[4:7], v[68:71]
  s_or_b32 s26, s30, s29
  s_or_b32 s27, s31, s29
  s_add_u32 s60, s63, 0
  v_mfma_f32_16x16x32_bf16 v[100:103], a[36:39], a[8:11], v[100:103]
  buffer_store_dwordx4 v[160:163], v2, s[16:19], s60 offen offset:0 sc1
  ds_read_b128 a[20:23], v17 offset:2048
  v_mfma_f32_16x16x32_bf16 v[132:135], a[36:39], a[12:15], v[132:135]
  buffer_store_dwordx4 v[164:167], v2, s[16:19], s60 offen offset:1024 sc1
  ds_read_b128 a[24:27], v17 offset:4096
  v_mfma_f32_16x16x32_bf16 v[40:43], a[40:43], a[0:3], v[40:43]
  ds_read_b128 a[28:31], v17 offset:6144
  ds_read_b64_tr_b16 a[68:69], v19 offset:4096
  v_mfma_f32_16x16x32_bf16 v[72:75], a[40:43], a[4:7], v[72:75]
  ds_read_b64_tr_b16 a[70:71], v19 offset:6144
  ds_read_b64_tr_b16 a[72:73], v20 offset:4096
  v_mfma_f32_16x16x32_bf16 v[104:107], a[40:43], a[8:11], v[104:107]
  buffer_store_dwordx4 v[168:171], v2, s[16:19], s60 offen offset:2048 sc1
  ds_read_b64_tr_b16 a[74:75], v20 offset:6144
  v_mfma_f32_16x16x32_bf16 v[136:139], a[40:43], a[12:15], v[136:139]
  ds_read_b64_tr_b16 a[76:77], v21 offset:4096
  v_mfma_f32_16x16x32_bf16 v[44:47], a[44:47], a[0:3], v[44:47]
  buffer_store_dwordx4 v[172:175], v2, s[16:19], s60 offen offset:3072 sc1
  ds_read_b64_tr_b16 a[78:79], v21 offset:6144
  v_mfma_f32_16x16x32_bf16 v[76:79], a[44:47], a[4:7], v[76:79]
  s_add_u32 s60, s63, 4096
  ds_read_b64_tr_b16 a[80:81], v18 offset:12288
  v_mfma_f32_16x16x32_bf16 v[108:111], a[44:47], a[8:11], v[108:111]
  ds_read_b64_tr_b16 a[82:83], v18 offset:14336
  v_mfma_f32_16x16x32_bf16 v[140:143], a[44:47], a[12:15], v[140:143]
  buffer_store_dwordx4 v[176:179], v2, s[16:19], s60 offen offset:0 sc1
  ds_read_b64_tr_b16 a[84:85], v19 offset:12288
  v_mfma_f32_16x16x32_bf16 v[48:51], a[48:51], a[0:3], v[48:51]
  ds_read_b64_tr_b16 a[86:87], v19 offset:14336
  v_mfma_f32_16x16x32_bf16 v[80:83], a[48:51], a[4:7], v[80:83]
  buffer_store_dwordx4 v[180:183], v2, s[16:19], s60 offen offset:1024 sc1
  ds_read_b64_tr_b16 a[88:89], v20 offset:12288
  v_mfma_f32_16x16x32_bf16 v[112:115], a[48:51], a[8:11], v[112:115]
  ds_read_b64_tr_b16 a[90:91], v20 offset:14336
  v_mfma_f32_16x16x32_bf16 v[144:147], a[48:51], a[12:15], v[144:147]
  ds_read_b64_tr_b16 a[92:93], v21 offset:12288
  v_mfma_f32_16x16x32_bf16 v[52:55], a[52:55], a[0:3], v[52:55]
  buffer_store_dwordx4 v[184:187], v2, s[16:19], s60 offen offset:2048 sc1
  ds_read_b64_tr_b16 a[94:95], v21 offset:14336
  v_mfma_f32_16x16x32_bf16 v[84:87], a[52:55], a[4:7], v[84:87]
  v_mfma_f32_16x16x32_bf16 v[116:119], a[52:55], a[8:11], v[116:119]
  buffer_store_dwordx4 v[188:191], v2, s[16:19], s60 offen offset:3072 sc1
  v_mfma_f32_16x16x32_bf16 v[148:151], a[52:55], a[12:15], v[148:151]
  s_add_u32 s88, s88, s90
  s_add_u32 s89, s89, 1
  s_cmp_eq_u32 s89, 3
  s_cselect_b32 s89, 0, s89
  s_cselect_b32 s90, s91, s92
  v_mfma_f32_16x16x32_bf16 v[56:59], a[56:59], a[0:3], v[56:59]
  s_add_u32 s68, s68, s70
  s_add_u32 s69, s69, 1
  s_cmp_eq_u32 s69, 3
  s_cselect_b32 s69, 0, s69
  s_cselect_b32 s70, s71, s72
  v_mfma_f32_16x16x32_bf16 v[88:91], a[56:59], a[4:7], v[88:91]
  v_add_u32 v16, s90, v16
  v_add_u32 v17, s90, v17
  v_mfma_f32_16x16x32_bf16 v[120:123], a[56:59], a[8:11], v[120:123]
  v_add_u32 v18, s70, v18
  v_add_u32 v19, s70, v19
  v_mfma_f32_16x16x32_bf16 v[152:155], a[56:59], a[12:15], v[152:155]
  v_add_u32 v20, s70, v20
  v_add_u32 v21, s70, v21
  v_mfma_f32_16x16x32_bf16 v[60:63], a[60:63], a[0:3], v[60:63]
  v_mfma_f32_16x16x32_bf16 v[92:95], a[60:63], a[4:7], v[92:95]
  v_mfma_f32_16x16x32_bf16 v[124:127], a[60:63], a[8:11], v[124:127]
  v_mfma_f32_16x16x32_bf16 v[156:159], a[60:63], a[12:15], v[156:159]
  s_waitcnt vmcnt(20) lgkmcnt(0)
  s_barrier
  v_mfma_f32_16x16x32_bf16 v[32:35], a[64:67], a[16:19], v[32:35]
  s_mov_b32 m0, s68
  ds_read_b128 a[0:3], v16 offset:0
  v_mfma_f32_16x16x32_bf16 v[64:67], a[64:67], a[20:23], v[64:67]
  buffer_load_dwordx4 v8, s[20:23], s28 offen offset:0 lds
  ds_read_b64_tr_b16 a[32:33], v18 offset:0
  v_mfma_f32_16x16x32_bf16 v[96:99], a[64:67], a[24:27], v[96:99]
  ds_read_b64_tr_b16 a[34:35], v18 offset:2048
  v_mfma_f32_16x16x32_bf16 v[128:131], a[64:67], a[28:31], v[128:131]
  ds_read_b128 a[4:7], v16 offset:2048
  v_mfma_f32_16x16x32_bf16 v[36:39], a[68:71], a[16:19], v[36:39]
  ds_read_b128 a[8:11], v16 offset:4096
  v_mfma_f32_16x16x32_bf16 v[68:71], a[68:71], a[20:23], v[68:71]
  buffer_load_dwordx4 v9, s[20:23], s28 offen offset:1024 lds
  ds_read_b128 a[12:15], v16 offset:6144
  v_mfma_f32_16x16x32_bf16 v[100:103], a[68:71], a[24:27], v[100:103]
  ds_read_b64_tr_b16 a[36:37], v19 offset:0
  v_mfma_f32_16x16x32_bf16 v[132:135], a[68:71], a[28:31], v[132:135]
  ds_read_b64_tr_b16 a[38:39], v19 offset:2048
  v_mfma_f32_16x16x32_bf16 v[40:43], a[72:75], a[16:19], v[40:43]
  ds_read_b64_tr_b16 a[40:41], v20 offset:0
  v_mfma_f32_16x16x32_bf16 v[72:75], a[72:75], a[20:23], v[72:75]
  ds_read_b64_tr_b16 a[42:43], v20 offset:2048
  v_mfma_f32_16x16x32_bf16 v[104:107], a[72:75], a[24:27], v[104:107]
  buffer_load_dwordx4 v10, s[20:23], s28 offen offset:2048 lds
  v_mfma_f32_16x16x32_bf16 v[136:139], a[72:75], a[28:31], v[136:139]
  ds_read_b64_tr_b16 a[44:45], v21 offset:0
  v_mfma_f32_16x16x32_bf16 v[44:47], a[76:79], a[16:19], v[44:47]
  ds_read_b64_tr_b16 a[46:47], v21 offset:2048
  v_mfma_f32_16x16x32_bf16 v[76:79], a[76:79], a[20:23], v[76:79]
  ds_read_b64_tr_b16 a[48:49], v18 offset:8192
  v_mfma_f32_16x16x32_bf16 v[108:111], a[76:79], a[24:27], v[108:111]
  ds_read_b64_tr_b16 a[50:51], v18 offset:10240
  v_mfma_f32_16x16x32_bf16 v[140:143], a[76:79], a[28:31], v[140:143]
  buffer_load_dwordx4 v11, s[20:23], s28 offen offset:3072 lds
  ds_read_b64_tr_b16 a[52:53], v19 offset:8192
  v_mfma_f32_16x16x32_bf16 v[48:51], a[80:83], a[16:19], v[48:51]
  s_bfe_u32 s56, 0x302010e, s55
  s_add_u32 s54, s54, s56
  s_add_u32 s55, s55, 8
  v_mfma_f32_16x16x32_bf16 v[80:83], a[80:83], a[20:23], v[80:83]
  s_and_b32 s55, s55, 0x8001f
  s_and_b32 s54, s54, 15
  s_lshl_b32 s28, s54, 19
  v_mfma_f32_16x16x32_bf16 v[112:115], a[80:83], a[24:27], v[112:115]
  s_mov_b32 m0, s88
  ds_read_b64_tr_b16 a[54:55], v19 offset:10240
  ds_read_b64_tr_b16 a[56:57], v20 offset:8192
  v_mfma_f32_16x16x32_bf16 v[144:147], a[80:83], a[28:31], v[144:147]
  ds_read_b64_tr_b16 a[58:59], v20 offset:10240
  ds_read_b64_tr_b16 a[60:61], v21 offset:8192
  v_mfma_f32_16x16x32_bf16 v[52:55], a[84:87], a[16:19], v[52:55]
  buffer_load_dwordx4 v4, s[8:11], s26 offen offset:0 lds
  ds_read_b64_tr_b16 a[62:63], v21 offset:10240
  v_mfma_f32_16x16x32_bf16 v[84:87], a[84:87], a[20:23], v[84:87]
  v_mfma_f32_16x16x32_bf16 v[116:119], a[84:87], a[24:27], v[116:119]
  v_mfma_f32_16x16x32_bf16 v[148:151], a[84:87], a[28:31], v[148:151]
  v_mfma_f32_16x16x32_bf16 v[56:59], a[88:91], a[16:19], v[56:59]
  v_mfma_f32_16x16x32_bf16 v[88:91], a[88:91], a[20:23], v[88:91]
  buffer_load_dwordx4 v5, s[8:11], s26 offen offset:1024 lds
  v_mfma_f32_16x16x32_bf16 v[120:123], a[88:91], a[24:27], v[120:123]
  v_mfma_f32_16x16x32_bf16 v[152:155], a[88:91], a[28:31], v[152:155]
  v_mfma_f32_16x16x32_bf16 v[60:63], a[92:95], a[16:19], v[60:63]
  v_mfma_f32_16x16x32_bf16 v[92:95], a[92:95], a[20:23], v[92:95]
  v_mfma_f32_16x16x32_bf16 v[124:127], a[92:95], a[24:27], v[124:127]
  v_mfma_f32_16x16x32_bf16 v[156:159], a[92:95], a[28:31], v[156:159]
  s_waitcnt lgkmcnt(0)
  v_mfma_f32_16x16x32_bf16 v[32:35], a[32:35], a[0:3], v[32:35]
  buffer_load_dwordx4 v6, s[8:11], s26 offen offset:2048 lds
  ds_read_b128 a[16:19], v17 offset:0
  v_mfma_f32_16x16x32_bf16 v[64:67], a[32:35], a[4:7], v[64:67]
  ds_read_b64_tr_b16 a[64:65], v18 offset:4096
  v_mfma_f32_16x16x32_bf16 v[96:99], a[32:35], a[8:11], v[96:99]
  ds_read_b64_tr_b16 a[66:67], v18 offset:6144
  v_mfma_f32_16x16x32_bf16 v[128:131], a[32:35], a[12:15], v[128:131]
  ds_read_b128 a[20:23], v17 offset:2048
  v_mfma_f32_16x16x32_bf16 v[36:39], a[36:39], a[0:3], v[36:39]
  buffer_load_dwordx4 v7, s[8:11], s26 offen offset:3072 lds
  ds_read_b128 a[24:27], v17 offset:4096
  v_mfma_f32_16x16x32_bf16 v[68:71], a[36:39], a[4:7], v[68:71]
  s_add_u32 m0, s88, 4096
  ds_read_b128 a[28:31], v17 offset:6144
  v_mfma_f32_16x16x32_bf16 v[100:103], a[36:39], a[8:11], v[100:103]
  ds_read_b64_tr_b16 a[68:69], v19 offset:4096
  v_mfma_f32_16x16x32_bf16 v[132:135], a[36:39], a[12:15], v[132:135]
  ds_read_b64_tr_b16 a[70:71], v19 offset:6144
  v_mfma_f32_16x16x32_bf16 v[40:43], a[40:43], a[0:3], v[40:43]
  buffer_load_dwordx4 v4, s[8:11], s27 offen offset:0 lds
  ds_read_b64_tr_b16 a[72:73], v20 offset:4096
  v_mfma_f32_16x16x32_bf16 v[72:75], a[40:43], a[4:7], v[72:75]
  ds_read_b64_tr_b16 a[74:75], v20 offset:6144
  v_mfma_f32_16x16x32_bf16 v[104:107], a[40:43], a[8:11], v[104:107]
  v_mfma_f32_16x16x32_bf16 v[136:139], a[40:43], a[12:15], v[136:139]
  ds_read_b64_tr_b16 a[76:77], v21 offset:4096
  v_mfma_f32_16x16x32_bf16 v[44:47], a[44:47], a[0:3], v[44:47]
  buffer_load_dwordx4 v5, s[8:11], s27 offen offset:1024 lds
  ds_read_b64_tr_b16 a[78:79], v21 offset:6144
  v_mfma_f32_16x16x32_bf16 v[76:79], a[44:47], a[4:7], v[76:79]
  ds_read_b64_tr_b16 a[80:81], v18 offset:12288
  v_mfma_f32_16x16x32_bf16 v[108:111], a[44:47], a[8:11], v[108:111]
  ds_read_b64_tr_b16 a[82:83], v18 offset:14336
  v_mfma_f32_16x16x32_bf16 v[140:143], a[44:47], a[12:15], v[140:143]
  ds_read_b64_tr_b16 a[84:85], v19 offset:12288
  v_mfma_f32_16x16x32_bf16 v[48:51], a[48:51], a[0:3], v[48:51]
  buffer_load_dwordx4 v6, s[8:11], s27 offen offset:2048 lds
  ds_read_b64_tr_b16 a[86:87], v19 offset:14336
  v_mfma_f32_16x16x32_bf16 v[80:83], a[48:51], a[4:7], v[80:83]
  ds_read_b64_tr_b16 a[88:89], v20 offset:12288
  v_mfma_f32_16x16x32_bf16 v[112:115], a[48:51], a[8:11], v[112:115]
  ds_read_b64_tr_b16 a[90:91], v20 offset:14336
  v_mfma_f32_16x16x32_bf16 v[144:147], a[48:51], a[12:15], v[144:147]
  ds_read_b64_tr_b16 a[92:93], v21 offset:12288
  v_mfma_f32_16x16x32_bf16 v[52:55], a[52:55], a[0:3], v[52:55]
  buffer_load_dwordx4 v7, s[8:11], s27 offen offset:3072 lds
  ds_read_b64_tr_b16 a[94:95], v21 offset:14336
  v_mfma_f32_16x16x32_bf16 v[84:87], a[52:55], a[4:7], v[84:87]
  s_bfe_u32 s29, 0x302010e, s53
  s_add_u32 s52, s52, s29
  s_add_u32 s53, s53, 8
  v_mfma_f32_16x16x32_bf16 v[116:119], a[52:55], a[8:11], v[116:119]
  s_and_b32 s53, s53, 0x8001f
  s_and_b32 s52, s52, 15
  s_lshl_b32 s29, s52, 7
  v_mfma_f32_16x16x32_bf16 v[148:151], a[52:55], a[12:15], v[148:151]
  s_or_b32 s26, s30, s29
  s_or_b32 s27, s31, s29
  v_mfma_f32_16x16x32_bf16 v[56:59], a[56:59], a[0:3], v[56:59]
  s_add_u32 s88, s88, s90
  s_add_u32 s89, s89, 1
  s_cmp_eq_u32 s89, 3
  s_cselect_b32 s89, 0, s89
  s_cselect_b32 s90, s91, s92
  v_mfma_f32_16x16x32_bf16 v[88:91], a[56:59], a[4:7], v[88:91]
  s_add_u32 s68, s68, s70
  s_add_u32 s69, s69, 1
  s_cmp_eq_u32 s69, 3
  s_cselect_b32 s69, 0, s69
  s_cselect_b32 s70, s71, s72
  v_mfma_f32_16x16x32_bf16 v[120:123], a[56:59], a[8:11], v[120:123]
  v_add_u32 v16, s90, v16
  v_add_u32 v17, s90, v17
  v_mfma_f32_16x16x32_bf16 v[152:155], a[56:59], a[12:15], v[152:155]
  v_add_u32 v18, s70, v18
  v_add_u32 v19, s70, v19
  v_mfma_f32_16x16x32_bf16 v[60:63], a[60:63], a[0:3], v[60:63]
  v_add_u32 v20, s70, v20
  v_add_u32 v21, s70, v21
  v_mfma_f32_16x16x32_bf16 v[92:95], a[60:63], a[4:7], v[92:95]
  v_mfma_f32_16x16x32_bf16 v[124:127], a[60:63], a[8:11], v[124:127]
  v_mfma_f32_16x16x32_bf16 v[156:159], a[60:63], a[12:15], v[156:159]
  s_waitcnt vmcnt(12) lgkmcnt(0)
  s_barrier
  s_mov_b32 s5, 0x40000
Ltg_3:
  v_readfirstlane_b32 s94, v22
  v_readfirstlane_b32 s95, v23
  s_nop 0
  s_cmp_lg_u32 s95, 0
  s_cbranch_scc1 Lpolld_4
  s_sleep 4
  s_mov_b32 s12, s84
  s_mov_b32 s13, s85
  s_mov_b32 s14, 256
  s_mov_b32 s15, 0x00020000
  buffer_load_dwordx2 v[22:23], off, s[12:15], 0 sc1
  s_sub_u32 s5, s5, 1
  s_waitcnt vmcnt(0)
  s_cbranch_scc0 Ltg_3
Lpolld_4:
  v_mov_b32 v3, 0x40000000
  v_mov_b32 v22, s94
  v_cmp_eq_u32 vcc, 0, v0
  v_mov_b32 v23, s95
  s_nop 0
  v_cndmask_b32_e64 v3, v3, 0, vcc
  buffer_store_dwordx2 v[22:23], v3, s[96:99], s34 offen sc1
  v_mfma_f32_16x16x32_bf16 v[32:35], a[64:67], a[16:19], v[32:35]
  s_mov_b32 m0, s68
  ds_read_b128 a[0:3], v16 offset:0
  v_mfma_f32_16x16x32_bf16 v[64:67], a[64:67], a[20:23], v[64:67]
  buffer_load_dwordx4 v8, s[20:23], s28 offen offset:0 lds
  ds_read_b64_tr_b16 a[32:33], v18 offset:0
  v_mfma_f32_16x16x32_bf16 v[96:99], a[64:67], a[24:27], v[96:99]
  ds_read_b64_tr_b16 a[34:35], v18 offset:2048
  v_mfma_f32_16x16x32_bf16 v[128:131], a[64:67], a[28:31], v[128:131]
  ds_read_b128 a[4:7], v16 offset:2048
  v_mfma_f32_16x16x32_bf16 v[36:39], a[68:71], a[16:19], v[36:39]
  ds_read_b128 a[8:11], v16 offset:4096
  v_mfma_f32_16x16x32_bf16 v[68:71], a[68:71], a[20:23], v[68:71]
  buffer_load_dwordx4 v9, s[20:23], s28 offen offset:1024 lds
  ds_read_b128 a[12:15], v16 offset:6144
  v_mfma_f32_16x16x32_bf16 v[100:103], a[68:71], a[24:27], v[100:103]
  ds_read_b64_tr_b16 a[36:37], v19 offset:0
  v_mfma_f32_16x16x32_bf16 v[132:135], a[68:71], a[28:31], v[132:135]
  ds_read_b64_tr_b16 a[38:39], v19 offset:2048
  v_mfma_f32_16x16x32_bf16 v[40:43], a[72:75], a[16:19], v[40:43]
  ds_read_b64_tr_b16 a[40:41], v20 offset:0
  v_mfma_f32_16x16x32_bf16 v[72:75], a[72:75], a[20:23], v[72:75]
  ds_read_b64_tr_b16 a[42:43], v20 offset:2048
  v_mfma_f32_16x16x32_bf16 v[104:107], a[72:75], a[24:27], v[104:107]
  buffer_load_dwordx4 v10, s[20:23], s28 offen offset:2048 lds
  v_mfma_f32_16x16x32_bf16 v[136:139], a[72:75], a[28:31], v[136:139]
  ds_read_b64_tr_b16 a[44:45], v21 offset:0
  v_mfma_f32_16x16x32_bf16 v[44:47], a[76:79], a[16:19], v[44:47]
  ds_read_b64_tr_b16 a[46:47], v21 offset:2048
  v_mfma_f32_16x16x32_bf16 v[76:79], a[76:79], a[20:23], v[76:79]
  ds_read_b64_tr_b16 a[48:49], v18 offset:8192
  v_mfma_f32_16x16x32_bf16 v[108:111], a[76:79], a[24:27], v[108:111]
  ds_read_b64_tr_b16 a[50:51], v18 offset:10240
  v_mfma_f32_16x16x32_bf16 v[140:143], a[76:79], a[28:31], v[140:143]
  buffer_load_dwordx4 v11, s[20:23], s28 offen offset:3072 lds
  ds_read_b64_tr_b16 a[52:53], v19 offset:8192
  v_mfma_f32_16x16x32_bf16 v[48:51], a[80:83], a[16:19], v[48:51]
  s_bfe_u32 s56, 0x302010e, s55
  s_add_u32 s54, s54, s56
  s_add_u32 s55, s55, 8
  v_mfma_f32_16x16x32_bf16 v[80:83], a[80:83], a[20:23], v[80:83]
  s_and_b32 s55, s55, 0x8001f
  s_and_b32 s54, s54, 15
  s_lshl_b32 s28, s54, 19
  v_mfma_f32_16x16x32_bf16 v[112:115], a[80:83], a[24:27], v[112:115]
  s_mov_b32 m0, s88
  ds_read_b64_tr_b16 a[54:55], v19 offset:10240
  ds_read_b64_tr_b16 a[56:57], v20 offset:8192
  v_mfma_f32_16x16x32_bf16 v[144:147], a[80:83], a[28:31], v[144:147]
  ds_read_b64_tr_b16 a[58:59], v20 offset:10240
  ds_read_b64_tr_b16 a[60:61], v21 offset:8192
  v_mfma_f32_16x16x32_bf16 v[52:55], a[84:87], a[16:19], v[52:55]
  buffer_load_dwordx4 v4, s[8:11], s26 offen offset:0 lds
  ds_read_b64_tr_b16 a[62:63], v21 offset:10240
  v_mfma_f32_16x16x32_bf16 v[84:87], a[84:87], a[20:23], v[84:87]
  v_mfma_f32_16x16x32_bf16 v[116:119], a[84:87], a[24:27], v[116:119]
  v_mfma_f32_16x16x32_bf16 v[148:151], a[84:87], a[28:31], v[148:151]
  v_mfma_f32_16x16x32_bf16 v[56:59], a[88:91], a[16:19], v[56:59]
  v_mfma_f32_16x16x32_bf16 v[88:91], a[88:91], a[20:23], v[88:91]
  buffer_load_dwordx4 v5, s[8:11], s26 offen offset:1024 lds
  v_mfma_f32_16x16x32_bf16 v[120:123], a[88:91], a[24:27], v[120:123]
  v_mfma_f32_16x16x32_bf16 v[152:155], a[88:91], a[28:31], v[152:155]
  v_mfma_f32_16x16x32_bf16 v[60:63], a[92:95], a[16:19], v[60:63]
  v_mfma_f32_16x16x32_bf16 v[92:95], a[92:95], a[20:23], v[92:95]
  v_mfma_f32_16x16x32_bf16 v[124:127], a[92:95], a[24:27], v[124:127]
  v_mfma_f32_16x16x32_bf16 v[156:159], a[92:95], a[28:31], v[156:159]
  s_waitcnt lgkmcnt(0)
  v_mfma_f32_16x16x32_bf16 v[32:35], a[32:35], a[0:3], v[32:35]
  buffer_load_dwordx4 v6, s[8:11], s26 offen offset:2048 lds
  ds_read_b128 a[16:19], v17 offset:0
  v_mfma_f32_16x16x32_bf16 v[64:67], a[32:35], a[4:7], v[64:67]
  ds_read_b64_tr_b16 a[64:65], v18 offset:4096
  v_mfma_f32_16x16x32_bf16 v[96:99], a[32:35], a[8:11], v[96:99]
  ds_read_b64_tr_b16 a[66:67], v18 offset:6144
  v_mfma_f32_16x16x32_bf16 v[128:131], a[32:35], a[12:15], v[128:131]
  ds_read_b128 a[20:23], v17 offset:2048
  v_mfma_f32_16x16x32_bf16 v[36:39], a[36:39], a[0:3], v[36:39]
  buffer_load_dwordx4 v7, s[8:11], s26 offen offset:3072 lds
  ds_read_b128 a[24:27], v17 offset:4096
  v_mfma_f32_16x16x32_bf16 v[68:71], a[36:39], a[4:7], v[68:71]
  s_add_u32 m0, s88, 4096
  ds_read_b128 a[28:31], v17 offset:6144
  v_mfma_f32_16x16x32_bf16 v[100:103], a[36:39], a[8:11], v[100:103]
  ds_read_b64_tr_b16 a[68:69], v19 offset:4096
  v_mfma_f32_16x16x32_bf16 v[132:135], a[36:39], a[12:15], v[132:135]
  ds_read_b64_tr_b16 a[70:71], v19 offset:6144
  v_mfma_f32_16x16x32_bf16 v[40:43], a[40:43], a[0:3], v[40:43]
  buffer_load_dwordx4 v4, s[8:11], s27 offen offset:0 lds
  ds_read_b64_tr_b16 a[72:73], v20 offset:4096
  v_mfma_f32_16x16x32_bf16 v[72:75], a[40:43], a[4:7], v[72:75]
  ds_read_b64_tr_b16 a[74:75], v20 offset:6144
  v_mfma_f32_16x16x32_bf16 v[104:107], a[40:43], a[8:11], v[104:107]
  v_mfma_f32_16x16x32_bf16 v[136:139], a[40:43], a[12:15], v[136:139]
  ds_read_b64_tr_b16 a[76:77], v21 offset:4096
  v_mfma_f32_16x16x32_bf16 v[44:47], a[44:47], a[0:3], v[44:47]
  buffer_load_dwordx4 v5, s[8:11], s27 offen offset:1024 lds
  ds_read_b64_tr_b16 a[78:79], v21 offset:6144
  v_mfma_f32_16x16x32_bf16 v[76:79], a[44:47], a[4:7], v[76:79]
  ds_read_b64_tr_b16 a[80:81], v18 offset:12288
  v_mfma_f32_16x16x32_bf16 v[108:111], a[44:47], a[8:11], v[108:111]
  ds_read_b64_tr_b16 a[82:83], v18 offset:14336
  v_mfma_f32_16x16x32_bf16 v[140:143], a[44:47], a[12:15], v[140:143]
  ds_read_b64_tr_b16 a[84:85], v19 offset:12288
  v_mfma_f32_16x16x32_bf16 v[48:51], a[48:51], a[0:3], v[48:51]
  buffer_load_dwordx4 v6, s[8:11], s27 offen offset:2048 lds
  ds_read_b64_tr_b16 a[86:87], v19 offset:14336
  v_mfma_f32_16x16x32_bf16 v[80:83], a[48:51], a[4:7], v[80:83]
  ds_read_b64_tr_b16 a[88:89], v20 offset:12288
  v_mfma_f32_16x16x32_bf16 v[112:115], a[48:51], a[8:11], v[112:115]
  ds_read_b64_tr_b16 a[90:91], v20 offset:14336
  v_mfma_f32_16x16x32_bf16 v[144:147], a[48:51], a[12:15], v[144:147]
  ds_read_b64_tr_b16 a[92:93], v21 offset:12288
  v_mfma_f32_16x16x32_bf16 v[52:55], a[52:55], a[0:3], v[52:55]
  buffer_load_dwordx4 v7, s[8:11], s27 offen offset:3072 lds
  ds_read_b64_tr_b16 a[94:95], v21 offset:14336
  v_mfma_f32_16x16x32_bf16 v[84:87], a[52:55], a[4:7], v[84:87]
  s_bfe_u32 s29, 0x302010e, s53
  s_add_u32 s52, s52, s29
  s_add_u32 s53, s53, 8
  v_mfma_f32_16x16x32_bf16 v[116:119], a[52:55], a[8:11], v[116:119]
  s_and_b32 s53, s53, 0x8001f
  s_and_b32 s52, s52, 15
  s_lshl_b32 s29, s52, 7
  v_mfma_f32_16x16x32_bf16 v[148:151], a[52:55], a[12:15], v[148:151]
  s_or_b32 s26, s30, s29
  s_or_b32 s27, s31, s29
  v_mfma_f32_16x16x32_bf16 v[56:59], a[56:59], a[0:3], v[56:59]
  s_add_u32 s88, s88, s90
  s_add_u32 s89, s89, 1
  s_cmp_eq_u32 s89, 3
  s_cselect_b32 s89, 0, s89
  s_cselect_b32 s90, s91, s92
  v_mfma_f32_16x16x32_bf16 v[88:91], a[56:59], a[4:7], v[88:91]
  s_add_u32 s68, s68, s70
  s_add_u32 s69, s69, 1
  s_cmp_eq_u32 s69, 3
  s_cselect_b32 s69, 0, s69
  s_cselect_b32 s70, s71, s72
  v_mfma_f32_16x16x32_bf16 v[120:123], a[56:59], a[8:11], v[120:123]
  v_add_u32 v16, s90, v16
  v_add_u32 v17, s90, v17
  v_mfma_f32_16x16x32_bf16 v[152:155], a[56:59], a[12:15], v[152:155]
  v_add_u32 v18, s70, v18
  v_add_u32 v19, s70, v19
  v_mfma_f32_16x16x32_bf16 v[60:63], a[60:63], a[0:3], v[60:63]
  v_add_u32 v20, s70, v20
  v_add_u32 v21, s70, v21
  v_mfma_f32_16x16x32_bf16 v[92:95], a[60:63], a[4:7], v[92:95]
  v_mfma_f32_16x16x32_bf16 v[124:127], a[60:63], a[8:11], v[124:127]
  v_mfma_f32_16x16x32_bf16 v[156:159], a[60:63], a[12:15], v[156:159]
  s_mov_b32 s35, 6
  s_waitcnt vmcnt(12) lgkmcnt(0)
  s_barrier
  .p2align 6
Lp3_loop:
  v_mfma_f32_16x16x32_bf16 v[32:35], a[64:67], a[16:19], v[32:35]
  s_mov_b32 m0, s68
  ds_read_b128 a[0:3], v16 offset:0
  v_mfma_f32_16x16x32_bf16 v[64:67], a[64:67], a[20:23], v[64:67]
  buffer_load_dwordx4 v8, s[20:23], s28 offen offset:0 lds
  ds_read_b64_tr_b16 a[32:33], v18 offset:0
  v_mfma_f32_16x16x32_bf16 v[96:99], a[64:67], a[24:27], v[96:99]
  ds_read_b64_tr_b16 a[34:35], v18 offset:2048
  v_mfma_f32_16x16x32_bf16 v[128:131], a[64:67], a[28:31], v[128:131]
  ds_read_b128 a[4:7], v16 offset:2048
  v_mfma_f32_16x16x32_bf16 v[36:39], a[68:71], a[16:19], v[36:39]
  ds_read_b128 a[8:11], v16 offset:4096
  v_mfma_f32_16x16x32_bf16 v[68:71], a[68:71], a[20:23], v[68:71]
  buffer_load_dwordx4 v9, s[20:23], s28 offen offset:1024 lds
  ds_read_b128 a[12:15], v16 offset:6144
  v_mfma_f32_16x16x32_bf16 v[100:103], a[68:71], a[24:27], v[100:103]
  ds_read_b64_tr_b16 a[36:37], v19 offset:0
  v_mfma_f32_16x16x32_bf16 v[132:135], a[68:71], a[28:31], v[132:135]
  ds_read_b64_tr_b16 a[38:39], v19 offset:2048
  v_mfma_f32_16x16x32_bf16 v[40:43], a[72:75], a[16:19], v[40:43]
  ds_read_b64_tr_b16 a[40:41], v20 offset:0
  v_mfma_f32_16x16x32_bf16 v[72:75], a[72:75], a[20:23], v[72:75]
  ds_read_b64_tr_b16 a[42:43], v20 offset:2048
  v_mfma_f32_16x16x32_bf16 v[104:107], a[72:75], a[24:27], v[104:107]
  buffer_load_dwordx4 v10, s[20:23], s28 offen offset:2048 lds
  v_mfma_f32_16x16x32_bf16 v[136:139], a[72:75], a[28:31], v[136:139]
  ds_read_b64_tr_b16 a[44:45], v21 offset:0
  v_mfma_f32_16x16x32_bf16 v[44:47], a[76:79], a[16:19], v[44:47]
  ds_read_b64_tr_b16 a[46:47], v21 offset:2048
  v_mfma_f32_16x16x32_bf16 v[76:79], a[76:79], a[20:23], v[76:79]
  ds_read_b64_tr_b16 a[48:49], v18 offset:8192
  v_mfma_f32_16x16x32_bf16 v[108:111], a[76:79], a[24:27], v[108:111]
  ds_read_b64_tr_b16 a[50:51], v18 offset:10240
  v_mfma_f32_16x16x32_bf16 v[140:143], a[76:79], a[28:31], v[140:143]
  buffer_load_dwordx4 v11, s[20:23], s28 offen offset:3072 lds
  ds_read_b64_tr_b16 a[52:53], v19 offset:8192
  v_mfma_f32_16x16x32_bf16 v[48:51], a[80:83], a[16:19], v[48:51]
  s_bfe_u32 s56, 0x302010e, s55
  s_add_u32 s54, s54, s56
  s_add_u32 s55, s55, 8
  v_mfma_f32_16x16x32_bf16 v[80:83], a[80:83], a[20:23], v[80:83]
  s_and_b32 s55, s55, 0x8001f
  s_and_b32 s54, s54, 15
  s_lshl_b32 s28, s54, 19
  v_mfma_f32_16x16x32_bf16 v[112:115], a[80:83], a[24:27], v[112:115]
  s_mov_b32 m0, s88
  ds_read_b64_tr_b16 a[54:55], v19 offset:10240
  ds_read_b64_tr_b16 a[56:57], v20 offset:8192
  v_mfma_f32_16x16x32_bf16 v[144:147], a[80:83], a[28:31], v[144:147]
  ds_read_b64_tr_b16 a[58:59], v20 offset:10240
  ds_read_b64_tr_b16 a[60:61], v21 offset:8192
  v_mfma_f32_16x16x32_bf16 v[52:55], a[84:87], a[16:19], v[52:55]
  buffer_load_dwordx4 v4, s[8:11], s26 offen offset:0 lds
  ds_read_b64_tr_b16 a[62:63], v21 offset:10240
  v_mfma_f32_16x16x32_bf16 v[84:87], a[84:87], a[20:23], v[84:87]
  v_mfma_f32_16x16x32_bf16 v[116:119], a[84:87], a[24:27], v[116:119]
  v_mfma_f32_16x16x32_bf16 v[148:151], a[84:87], a[28:31], v[148:151]
  v_mfma_f32_16x16x32_bf16 v[56:59], a[88:91], a[16:19], v[56:59]
  v_mfma_f32_16x16x32_bf16 v[88:91], a[88:91], a[20:23], v[88:91]
  buffer_load_dwordx4 v5, s[8:11], s26 offen offset:1024 lds
  v_mfma_f32_16x16x32_bf16 v[120:123], a[88:91], a[24:27], v[120:123]
  v_mfma_f32_16x16x32_bf16 v[152:155], a[88:91], a[28:31], v[152:155]
  v_mfma_f32_16x16x32_bf16 v[60:63], a[92:95], a[16:19], v[60:63]
  v_mfma_f32_16x16x32_bf16 v[92:95], a[92:95], a[20:23], v[92:95]
  v_mfma_f32_16x16x32_bf16 v[124:127], a[92:95], a[24:27], v[124:127]
  v_mfma_f32_16x16x32_bf16 v[156:159], a[92:95], a[28:31], v[156:159]
  s_waitcnt lgkmcnt(0)
  v_mfma_f32_16x16x32_bf16 v[32:35], a[32:35], a[0:3], v[32:35]
  buffer_load_dwordx4 v6, s[8:11], s26 offen offset:2048 lds
  ds_read_b128 a[16:19], v17 offset:0
  v_mfma_f32_16x16x32_bf16 v[64:67], a[32:35], a[4:7], v[64:67]
  ds_read_b64_tr_b16 a[64:65], v18 offset:4096
  v_mfma_f32_16x16x32_bf16 v[96:99], a[32:35], a[8:11], v[96:99]
  ds_read_b64_tr_b16 a[66:67], v18 offset:6144
  v_mfma_f32_16x16x32_bf16 v[128:131], a[32:35], a[12:15], v[128:131]
  ds_read_b128 a[20:23], v17 offset:2048
  v_mfma_f32_16x16x32_bf16 v[36:39], a[36:39], a[0:3], v[36:39]
  buffer_load_dwordx4 v7, s[8:11], s26 offen offset:3072 lds
  ds_read_b128 a[24:27], v17 offset:4096
  v_mfma_f32_16x16x32_bf16 v[68:71], a[36:39], a[4:7], v[68:71]
  s_add_u32 m0, s88, 4096
  ds_read_b128 a[28:31], v17 offset:6144
  v_mfma_f32_16x16x32_bf16 v[100:103], a[36:39], a[8:11], v[100:103]
  ds_read_b64_tr_b16 a[68:69], v19 offset:4096
  v_mfma_f32_16x16x32_bf16 v[132:135], a[36:39], a[12:15], v[132:135]
  ds_read_b64_tr_b16 a[70:71], v19 offset:6144
  v_mfma_f32_16x16x32_bf16 v[40:43], a[40:43], a[0:3], v[40:43]
  buffer_load_dwordx4 v4, s[8:11], s27 offen offset:0 lds
  ds_read_b64_tr_b16 a[72:73], v20 offset:4096
  v_mfma_f32_16x16x32_bf16 v[72:75], a[40:43], a[4:7], v[72:75]
  ds_read_b64_tr_b16 a[74:75], v20 offset:6144
  v_mfma_f32_16x16x32_bf16 v[104:107], a[40:43], a[8:11], v[104:107]
  v_mfma_f32_16x16x32_bf16 v[136:139], a[40:43], a[12:15], v[136:139]
  ds_read_b64_tr_b16 a[76:77], v21 offset:4096
  v_mfma_f32_16x16x32_bf16 v[44:47], a[44:47], a[0:3], v[44:47]
  buffer_load_dwordx4 v5, s[8:11], s27 offen offset:1024 lds
  ds_read_b64_tr_b16 a[78:79], v21 offset:6144
  v_mfma_f32_16x16x32_bf16 v[76:79], a[44:47], a[4:7], v[76:79]
  ds_read_b64_tr_b16 a[80:81], v18 offset:12288
  v_mfma_f32_16x16x32_bf16 v[108:111], a[44:47], a[8:11], v[108:111]
  ds_read_b64_tr_b16 a[82:83], v18 offset:14336
  v_mfma_f32_16x16x32_bf16 v[140:143], a[44:47], a[12:15], v[140:143]
  ds_read_b64_tr_b16 a[84:85], v19 offset:12288
  v_mfma_f32_16x16x32_bf16 v[48:51], a[48:51], a[0:3], v[48:51]
  buffer_load_dwordx4 v6, s[8:11], s27 offen offset:2048 lds
  ds_read_b64_tr_b16 a[86:87], v19 offset:14336
  v_mfma_f32_16x16x32_bf16 v[80:83], a[48:51], a[4:7], v[80:83]
  ds_read_b64_tr_b16 a[88:89], v20 offset:12288
  v_mfma_f32_16x16x32_bf16 v[112:115], a[48:51], a[8:11], v[112:115]
  ds_read_b64_tr_b16 a[90:91], v20 offset:14336
  v_mfma_f32_16x16x32_bf16 v[144:147], a[48:51], a[12:15], v[144:147]
  ds_read_b64_tr_b16 a[92:93], v21 offset:12288
  v_mfma_f32_16x16x32_bf16 v[52:55], a[52:55], a[0:3], v[52:55]
  buffer_load_dwordx4 v7, s[8:11], s27 offen offset:3072 lds
  ds_read_b64_tr_b16 a[94:95], v21 offset:14336
  v_mfma_f32_16x16x32_bf16 v[84:87], a[52:55], a[4:7], v[84:87]
  s_bfe_u32 s29, 0x302010e, s53
  s_add_u32 s52, s52, s29
  s_add_u32 s53, s53, 8
  v_mfma_f32_16x16x32_bf16 v[116:119], a[52:55], a[8:11], v[116:119]
  s_and_b32 s53, s53, 0x8001f
  s_and_b32 s52, s52, 15
  s_lshl_b32 s29, s52, 7
  v_mfma_f32_16x16x32_bf16 v[148:151], a[52:55], a[12:15], v[148:151]
  s_or_b32 s26, s30, s29
  s_or_b32 s27, s31, s29
  v_mfma_f32_16x16x32_bf16 v[56:59], a[56:59], a[0:3], v[56:59]
  s_add_u32 s88, s88, s90
  s_add_u32 s89, s89, 1
  s_cmp_eq_u32 s89, 3
  s_cselect_b32 s89, 0, s89
  s_cselect_b32 s90, s91, s92
  v_mfma_f32_16x16x32_bf16 v[88:91], a[56:59], a[4:7], v[88:91]
  s_add_u32 s68, s68, s70
  s_add_u32 s69, s69, 1
  s_cmp_eq_u32 s69, 3
  s_cselect_b32 s69, 0, s69
  s_cselect_b32 s70, s71, s72
  v_mfma_f32_16x16x32_bf16 v[120:123], a[56:59], a[8:11], v[120:123]
  v_add_u32 v16, s90, v16
  v_add_u32 v17, s90, v17
  v_mfma_f32_16x16x32_bf16 v[152:155], a[56:59], a[12:15], v[152:155]
  v_add_u32 v18, s70, v18
  v_add_u32 v19, s70, v19
  v_mfma_f32_16x16x32_bf16 v[60:63], a[60:63], a[0:3], v[60:63]
  v_add_u32 v20, s70, v20
  v_add_u32 v21, s70, v21
  v_mfma_f32_16x16x32_bf16 v[92:95], a[60:63], a[4:7], v[92:95]
  s_waitcnt vmcnt(12) lgkmcnt(0)
  s_barrier
  v_mfma_f32_16x16x32_bf16 v[124:127], a[60:63], a[8:11], v[124:127]
  s_sub_u32 s35, s35, 1
  v_mfma_f32_16x16x32_bf16 v[156:159], a[60:63], a[12:15], v[156:159]
  s_cmp_lg_u32 s35, 0
  s_cbranch_scc1 Lp3_loop
  s_lshr_b32 s34, s24, 1
  s_lshl_b32 s34, s34, 11
  v_and_b32 v3, 7, v1
  v_lshlrev_b32 v3, 7, v3
  v_mfma_f32_16x16x32_bf16 v[32:35], a[64:67], a[16:19], v[32:35]
  buffer_load_dwordx2 v[22:23], v3, s[96:99], s34 offen sc1
  ds_read_b128 a[0:3], v16 offset:0
  v_mfma_f32_16x16x32_bf16 v[64:67], a[64:67], a[20:23], v[64:67]
  s_mov_b32 m0, s68
  ds_read_b64_tr_b16 a[32:33], v18 offset:0
  v_mfma_f32_16x16x32_bf16 v[96:99], a[64:67], a[24:27], v[96:99]
  ds_read_b64_tr_b16 a[34:35], v18 offset:2048
  v_mfma_f32_16x16x32_bf16 v[128:131], a[64:67], a[28:31], v[128:131]
  ds_read_b128 a[4:7], v16 offset:2048
  v_mfma_f32_16x16x32_bf16 v[36:39], a[68:71], a[16:19], v[36:39]
  buffer_load_dwordx4 v8, s[20:23], s28 offen offset:0 lds
  ds_read_b128 a[8:11], v16 offset:4096
  v_mfma_f32_16x16x32_bf16 v[68:71], a[68:71], a[20:23], v[68:71]
  ds_read_b128 a[12:15], v16 offset:6144
  v_mfma_f32_16x16x32_bf16 v[100:103], a[68:71], a[24:27], v[100:103]
  ds_read_b64_tr_b16 a[36:37], v19 offset:0
  v_mfma_f32_16x16x32_bf16 v[132:135], a[68:71], a[28:31], v[132:135]
  ds_read_b64_tr_b16 a[38:39], v19 offset:2048
  v_mfma_f32_16x16x32_bf16 v[40:43], a[72:75], a[16:19], v[40:43]
  buffer_load_dwordx4 v9, s[20:23], s28 offen offset:1024 lds
  ds_read_b64_tr_b16 a[40:41], v20 offset:0
  v_mfma_f32_16x16x32_bf16 v[72:75], a[72:75], a[20:23], v[72:75]
  ds_read_b64_tr_b16 a[42:43], v20 offset:2048
  v_mfma_f32_16x16x32_bf16 v[104:107], a[72:75], a[24:27], v[104:107]
  v_mfma_f32_16x16x32_bf16 v[136:139], a[72:75], a[28:31], v[136:139]
  ds_read_b64_tr_b16 a[44:45], v21 offset:0
  v_mfma_f32_16x16x32_bf16 v[44:47], a[76:79], a[16:19], v[44:47]
  ds_read_b64_tr_b16 a[46:47], v21 offset:2048
  v_mfma_f32_16x16x32_bf16 v[76:79], a[76:79], a[20:23], v[76:79]
  buffer_load_dwordx4 v10, s[20:23], s28 offen offset:2048 lds
  ds_read_b64_tr_b16 a[48:49], v18 offset:8192
  v_mfma_f32_16x16x32_bf16 v[108:111], a[76:79], a[24:27], v[108:111]
  ds_read_b64_tr_b16 a[50:51], v18 offset:10240
  v_mfma_f32_16x16x32_bf16 v[140:143], a[76:79], a[28:31], v[140:143]
  ds_read_b64_tr_b16 a[52:53], v19 offset:8192
  v_mfma_f32_16x16x32_bf16 v[48:51], a[80:83], a[16:19], v[48:51]
  ds_read_b64_tr_b16 a[54:55], v19 offset:10240
  v_mfma_f32_16x16x32_bf16 v[80:83], a[80:83], a[20:23], v[80:83]
  buffer_load_dwordx4 v11, s[20:23], s28 offen offset:3072 lds
  ds_read_b64_tr_b16 a[56:57], v20 offset:8192
  v_mfma_f32_16x16x32_bf16 v[112:115], a[80:83], a[24:27], v[112:115]
  s_bfe_u32 s56, 0x302010e, s55
  s_add_u32 s54, s54, s56
  s_add_u32 s55, s55, 8
  v_mfma_f32_16x16x32_bf16 v[144:147], a[80:83], a[28:31], v[144:147]
  s_and_b32 s55, s55, 0x8001f
  s_and_b32 s54, s54, 15
  s_lshl_b32 s28, s54, 19
  v_mfma_f32_16x16x32_bf16 v[52:55], a[84:87], a[16:19], v[52:55]
  s_mov_b32 m0, s88
  ds_read_b64_tr_b16 a[58:59], v20 offset:10240
  ds_read_b64_tr_b16 a[60:61], v21 offset:8192
  v_mfma_f32_16x16x32_bf16 v[84:87], a[84:87], a[20:23], v[84:87]
  ds_read_b64_tr_b16 a[62:63], v21 offset:10240
  v_mfma_f32_16x16x32_bf16 v[116:119], a[84:87], a[24:27], v[116:119]
  buffer_load_dwordx4 v4, s[8:11], s26 offen offset:0 lds
  v_mfma_f32_16x16x32_bf16 v[148:151], a[84:87], a[28:31], v[148:151]
  v_mfma_f32_16x16x32_bf16 v[56:59], a[88:91], a[16:19], v[56:59]
  v_mfma_f32_16x16x32_bf16 v[88:91], a[88:91], a[20:23], v[88:91]
  v_mfma_f32_16x16x32_bf16 v[120:123], a[88:91], a[24:27], v[120:123]
  buffer_load_dwordx4 v5, s[8:11], s26 offen offset:1024 lds
  v_mfma_f32_16x16x32_bf16 v[152:155], a[88:91], a[28:31], v[152:155]
  v_mfma_f32_16x16x32_bf16 v[60:63], a[92:95], a[16:19], v[60:63]
  v_mfma_f32_16x16x32_bf16 v[92:95], a[92:95], a[20:23], v[92:95]
  v_mfma_f32_16x16x32_bf16 v[124:127], a[92:95], a[24:27], v[124:127]
  v_mfma_f32_16x16x32_bf16 v[156:159], a[92:95], a[28:31], v[156:159]
  s_waitcnt lgkmcnt(0)
  v_mfma_f32_16x16x32_bf16 v[32:35], a[32:35], a[0:3], v[32:35]
  buffer_load_dwordx4 v6, s[8:11], s26 offen offset:2048 lds
  ds_read_b128 a[16:19], v17 offset:0
  v_mfma_f32_16x16x32_bf16 v[64:67], a[32:35], a[4:7], v[64:67]
  ds_read_b64_tr_b16 a[64:65], v18 offset:4096
  v_mfma_f32_16x16x32_bf16 v[96:99], a[32:35], a[8:11], v[96:99]
  ds_read_b64_tr_b16 a[66:67], v18 offset:6144
  v_mfma_f32_16x16x32_bf16 v[128:131], a[32:35], a[12:15], v[128:131]
  ds_read_b128 a[20:23], v17 offset:2048
  v_mfma_f32_16x16x32_bf16 v[36:39], a[36:39], a[0:3], v[36:39]
  buffer_load_dwordx4 v7, s[8:11], s26 offen offset:3072 lds
  ds_read_b128 a[24:27], v17 offset:4096
  v_mfma_f32_16x16x32_bf16 v[68:71], a[36:39], a[4:7], v[68:71]
  s_add_u32 m0, s88, 4096
  ds_read_b128 a[28:31], v17 offset:6144
  v_mfma_f32_16x16x32_bf16 v[100:103], a[36:39], a[8:11], v[100:103]
  ds_read_b64_tr_b16 a[68:69], v19 offset:4096
  v_mfma_f32_16x16x32_bf16 v[132:135], a[36:39], a[12:15], v[132:135]
  ds_read_b64_tr_b16 a[70:71], v19 offset:6144
  v_mfma_f32_16x16x32_bf16 v[40:43], a[40:43], a[0:3], v[40:43]
  buffer_load_dwordx4 v4, s[8:11], s27 offen offset:0 lds
  ds_read_b64_tr_b16 a[72:73], v20 offset:4096
  v_mfma_f32_16x16x32_bf16 v[72:75], a[40:43], a[4:7], v[72:75]
  ds_read_b64_tr_b16 a[74:75], v20 offset:6144
  v_mfma_f32_16x16x32_bf16 v[104:107], a[40:43], a[8:11], v[104:107]
  v_mfma_f32_16x16x32_bf16 v[136:139], a[40:43], a[12:15], v[136:139]
  ds_read_b64_tr_b16 a[76:77], v21 offset:4096
  v_mfma_f32_16x16x32_bf16 v[44:47], a[44:47], a[0:3], v[44:47]
  buffer_load_dwordx4 v5, s[8:11], s27 offen offset:1024 lds
  ds_read_b64_tr_b16 a[78:79], v21 offset:6144
  v_mfma_f32_16x16x32_bf16 v[76:79], a[44:47], a[4:7], v[76:79]
  ds_read_b64_tr_b16 a[80:81], v18 offset:12288
  v_mfma_f32_16x16x32_bf16 v[108:111], a[44:47], a[8:11], v[108:111]
  ds_read_b64_tr_b16 a[82:83], v18 offset:14336
  v_mfma_f32_16x16x32_bf16 v[140:143], a[44:47], a[12:15], v[140:143]
  ds_read_b64_tr_b16 a[84:85], v19 offset:12288
  v_mfma_f32_16x16x32_bf16 v[48:51], a[48:51], a[0:3], v[48:51]
  buffer_load_dwordx4 v6, s[8:11], s27 offen offset:2048 lds
  ds_read_b64_tr_b16 a[86:87], v19 offset:14336
  v_mfma_f32_16x16x32_bf16 v[80:83], a[48:51], a[4:7], v[80:83]
  ds_read_b64_tr_b16 a[88:89], v20 offset:12288
  v_mfma_f32_16x16x32_bf16 v[112:115], a[48:51], a[8:11], v[112:115]
  ds_read_b64_tr_b16 a[90:91], v20 offset:14336
  v_mfma_f32_16x16x32_bf16 v[144:147], a[48:51], a[12:15], v[144:147]
  ds_read_b64_tr_b16 a[92:93], v21 offset:12288
  v_mfma_f32_16x16x32_bf16 v[52:55], a[52:55], a[0:3], v[52:55]
  buffer_load_dwordx4 v7, s[8:11], s27 offen offset:3072 lds
  ds_read_b64_tr_b16 a[94:95], v21 offset:14336
  v_mfma_f32_16x16x32_bf16 v[84:87], a[52:55], a[4:7], v[84:87]
  s_bfe_u32 s29, 0x302010e, s53
  s_add_u32 s52, s52, s29
  s_add_u32 s53, s53, 8
  v_mfma_f32_16x16x32_bf16 v[116:119], a[52:55], a[8:11], v[116:119]
  s_and_b32 s53, s53, 0x8001f
  s_and_b32 s52, s52, 15
  s_lshl_b32 s29, s52, 7
  v_mfma_f32_16x16x32_bf16 v[148:151], a[52:55], a[12:15], v[148:151]
  s_or_b32 s26, s30, s29
  s_or_b32 s27, s31, s29
  v_mfma_f32_16x16x32_bf16 v[56:59], a[56:59], a[0:3], v[56:59]
  s_add_u32 s88, s88, s90
  s_add_u32 s89, s89, 1
  s_cmp_eq_u32 s89, 3
  s_cselect_b32 s89, 0, s89
  s_cselect_b32 s90, s91, s92
  v_mfma_f32_16x16x32_bf16 v[88:91], a[56:59], a[4:7], v[88:91]
  s_add_u32 s68, s68, s70
  s_add_u32 s69, s69, 1
  s_cmp_eq_u32 s69, 3
  s_cselect_b32 s69, 0, s69
  s_cselect_b32 s70, s71, s72
  v_mfma_f32_16x16x32_bf16 v[120:123], a[56:59], a[8:11], v[120:123]
  v_add_u32 v16, s90, v16
  v_add_u32 v17, s90, v17
  v_mfma_f32_16x16x32_bf16 v[152:155], a[56:59], a[12:15], v[152:155]
  v_add_u32 v18, s70, v18
  v_add_u32 v19, s70, v19
  v_mfma_f32_16x16x32_bf16 v[60:63], a[60:63], a[0:3], v[60:63]
  v_add_u32 v20, s70, v20
  v_add_u32 v21, s70, v21
  v_mfma_f32_16x16x32_bf16 v[92:95], a[60:63], a[4:7], v[92:95]
  v_mfma_f32_16x16x32_bf16 v[124:127], a[60:63], a[8:11], v[124:127]
  v_mfma_f32_16x16x32_bf16 v[156:159], a[60:63], a[12:15], v[156:159]
  s_waitcnt vmcnt(12) lgkmcnt(0)
  s_barrier
  s_mov_b32 s5, 0x40000
Lpoll_5:
  v_cmp_ne_u64 vcc, s[94:95], v[22:23]
  s_nop 0
  s_cbranch_vccz Lpolld_6
  s_sleep 4
  buffer_load_dwordx2 v[22:23], v3, s[96:99], s34 offen sc1
  s_sub_u32 s5, s5, 1
  s_waitcnt vmcnt(0)
  s_cbranch_scc0 Lpoll_5
Lpolld_6:
  s_lshl_b32 s4, s24, 20
  s_and_b32 s5, s25, 1
  s_lshl_b32 s5, s5, 1
  s_add_u32 s5, s5, 14
  s_sub_u32 s5, s5, s25
  s_add_u32 s5, s5, 1
  s_lshl_b32 s5, s5, 16
  s_add_u32 s20, s86, 16777216
  s_addc_u32 s21, s87, 0
  s_add_u32 s20, s20, s4
  s_addc_u32 s21, s21, 0
  s_mov_b32 s22, s5
  s_mov_b32 s23, 0x00020000
  s_lshl_b32 s28, s3, 12
  s_add_u32 s26, s28, 0xc000
  s_add_u32 s27, s28, 0x10000
  s_add_u32 s29, s28, 0x4000
  s_and_b32 s4, s2, 1
  s_lshl_b32 s4, s4, 3
  s_bfe_u32 s5, s2, 0x30003
  s_add_u32 s73, s4, s5
  s_bfe_u32 s4, s2, 0x10001
  s_lshl_b32 s4, s4, 2
  s_lshr_b32 s5, s2, 6
  s_add_u32 s76, s4, s5
  s_bfe_u32 s77, s2, 0x10002
  s_lshl_b32 s78, s73, 3
  s_add_u32 s78, s78, s76
  s_lshl_b32 s79, s3, 12
  v_mfma_f32_16x16x32_bf16 v[32:35], a[64:67], a[16:19], v[32:35]
  s_mov_b32 m0, s26
  ds_read_b128 a[0:3], v16 offset:0
  v_mfma_f32_16x16x32_bf16 v[64:67], a[64:67], a[20:23], v[64:67]
  buffer_load_dwordx4 v2, s[20:23], s28 offen offset:0 sc1 lds
  ds_read_b64_tr_b16 a[32:33], v18 offset:0
  v_mfma_f32_16x16x32_bf16 v[96:99], a[64:67], a[24:27], v[96:99]
  ds_read_b64_tr_b16 a[34:35], v18 offset:2048
  v_mfma_f32_16x16x32_bf16 v[128:131], a[64:67], a[28:31], v[128:131]
  ds_read_b128 a[4:7], v16 offset:2048
  v_mfma_f32_16x16x32_bf16 v[36:39], a[68:71], a[16:19], v[36:39]
  ds_read_b128 a[8:11], v16 offset:4096
  v_mfma_f32_16x16x32_bf16 v[68:71], a[68:71], a[20:23], v[68:71]
  ds_read_b128 a[12:15], v16 offset:6144
  v_mfma_f32_16x16x32_bf16 v[100:103], a[68:71], a[24:27], v[100:103]
  ds_read_b64_tr_b16 a[36:37], v19 offset:0
  v_mfma_f32_16x16x32_bf16 v[132:135], a[68:71], a[28:31], v[132:135]
  ds_read_b64_tr_b16 a[38:39], v19 offset:2048
  v_mfma_f32_16x16x32_bf16 v[40:43], a[72:75], a[16:19], v[40:43]
  ds_read_b64_tr_b16 a[40:41], v20 offset:0
  v_mfma_f32_16x16x32_bf16 v[72:75], a[72:75], a[20:23], v[72:75]
  ds_read_b64_tr_b16 a[42:43], v20 offset:2048
  v_mfma_f32_16x16x32_bf16 v[104:107], a[72:75], a[24:27], v[104:107]
  v_mfma_f32_16x16x32_bf16 v[136:139], a[72:75], a[28:31], v[136:139]
  ds_read_b64_tr_b16 a[44:45], v21 offset:0
  v_mfma_f32_16x16x32_bf16 v[44:47], a[76:79], a[16:19], v[44:47]
  ds_read_b64_tr_b16 a[46:47], v21 offset:2048
  v_mfma_f32_16x16x32_bf16 v[76:79], a[76:79], a[20:23], v[76:79]
  ds_read_b64_tr_b16 a[48:49], v18 offset:8192
  v_mfma_f32_16x16x32_bf16 v[108:111], a[76:79], a[24:27], v[108:111]
  ds_read_b64_tr_b16 a[50:51], v18 offset:10240
  v_mfma_f32_16x16x32_bf16 v[140:143], a[76:79], a[28:31], v[140:143]
  buffer_load_dwordx4 v2, s[20:23], s28 offen offset:1024 sc1 lds
  ds_read_b64_tr_b16 a[52:53], v19 offset:8192
  v_mfma_f32_16x16x32_bf16 v[48:51], a[80:83], a[16:19], v[48:51]
  ds_read_b64_tr_b16 a[54:55], v19 offset:10240
  v_mfma_f32_16x16x32_bf16 v[80:83], a[80:83], a[20:23], v[80:83]
  ds_read_b64_tr_b16 a[56:57], v20 offset:8192
  v_mfma_f32_16x16x32_bf16 v[112:115], a[80:83], a[24:27], v[112:115]
  ds_read_b64_tr_b16 a[58:59], v20 offset:10240
  v_mfma_f32_16x16x32_bf16 v[144:147], a[80:83], a[28:31], v[144:147]
  ds_read_b64_tr_b16 a[60:61], v21 offset:8192
  v_mfma_f32_16x16x32_bf16 v[52:55], a[84:87], a[16:19], v[52:55]
  ds_read_b64_tr_b16 a[62:63], v21 offset:10240
  v_mfma_f32_16x16x32_bf16 v[84:87], a[84:87], a[20:23], v[84:87]
  v_mfma_f32_16x16x32_bf16 v[116:119], a[84:87], a[24:27], v[116:119]
  v_mfma_f32_16x16x32_bf16 v[148:151], a[84:87], a[28:31], v[148:151]
  v_mfma_f32_16x16x32_bf16 v[56:59], a[88:91], a[16:19], v[56:59]
  v_mfma_f32_16x16x32_bf16 v[88:91], a[88:91], a[20:23], v[88:91]
  v_mfma_f32_16x16x32_bf16 v[120:123], a[88:91], a[24:27], v[120:123]
  v_mfma_f32_16x16x32_bf16 v[152:155], a[88:91], a[28:31], v[152:155]
  v_mfma_f32_16x16x32_bf16 v[60:63], a[92:95], a[16:19], v[60:63]
  v_mfma_f32_16x16x32_bf16 v[92:95], a[92:95], a[20:23], v[92:95]
  v_mfma_f32_16x16x32_bf16 v[124:127], a[92:95], a[24:27], v[124:127]
  v_mfma_f32_16x16x32_bf16 v[156:159], a[92:95], a[28:31], v[156:159]
  s_waitcnt lgkmcnt(0)
  v_mfma_f32_16x16x32_bf16 v[32:35], a[32:35], a[0:3], v[32:35]
  buffer_load_dwordx4 v2, s[20:23], s28 offen offset:2048 sc1 lds
  ds_read_b128 a[16:19], v17 offset:0
  v_mfma_f32_16x16x32_bf16 v[64:67], a[32:35], a[4:7], v[64:67]
  ds_read_b64_tr_b16 a[64:65], v18 offset:4096
  v_mfma_f32_16x16x32_bf16 v[96:99], a[32:35], a[8:11], v[96:99]
  ds_read_b64_tr_b16 a[66:67], v18 offset:6144
  v_mfma_f32_16x16x32_bf16 v[128:131], a[32:35], a[12:15], v[128:131]
  ds_read_b128 a[20:23], v17 offset:2048
  v_mfma_f32_16x16x32_bf16 v[36:39], a[36:39], a[0:3], v[36:39]
  ds_read_b128 a[24:27], v17 offset:4096
  v_mfma_f32_16x16x32_bf16 v[68:71], a[36:39], a[4:7], v[68:71]
  ds_read_b128 a[28:31], v17 offset:6144
  v_mfma_f32_16x16x32_bf16 v[100:103], a[36:39], a[8:11], v[100:103]
  ds_read_b64_tr_b16 a[68:69], v19 offset:4096
  v_mfma_f32_16x16x32_bf16 v[132:135], a[36:39], a[12:15], v[132:135]
  ds_read_b64_tr_b16 a[70:71], v19 offset:6144
  v_mfma_f32_16x16x32_bf16 v[40:43], a[40:43], a[0:3], v[40:43]
  ds_read_b64_tr_b16 a[72:73], v20 offset:4096
  v_mfma_f32_16x16x32_bf16 v[72:75], a[40:43], a[4:7], v[72:75]
  ds_read_b64_tr_b16 a[74:75], v20 offset:6144
  v_mfma_f32_16x16x32_bf16 v[104:107], a[40:43], a[8:11], v[104:107]
  v_mfma_f32_16x16x32_bf16 v[136:139], a[40:43], a[12:15], v[136:139]
  ds_read_b64_tr_b16 a[76:77], v21 offset:4096
  v_mfma_f32_16x16x32_bf16 v[44:47], a[44:47], a[0:3], v[44:47]
  buffer_load_dwordx4 v2, s[20:23], s28 offen offset:3072 sc1 lds
  ds_read_b64_tr_b16 a[78:79], v21 offset:6144
  v_mfma_f32_16x16x32_bf16 v[76:79], a[44:47], a[4:7], v[76:79]
  s_xor_b32 s26, s26, 0x4000
  s_add_u32 s28, s28, 0x8000
  ds_read_b64_tr_b16 a[80:81], v18 offset:12288
  v_mfma_f32_16x16x32_bf16 v[108:111], a[44:47], a[8:11], v[108:111]
  s_add_u32 s88, s88, s90
  s_add_u32 s89, s89, 1
  ds_read_b64_tr_b16 a[82:83], v18 offset:14336
  v_mfma_f32_16x16x32_bf16 v[140:143], a[44:47], a[12:15], v[140:143]
  s_cmp_eq_u32 s89, 3
  s_cselect_b32 s89, 0, s89
  s_cselect_b32 s90, s91, s92
  ds_read_b64_tr_b16 a[84:85], v19 offset:12288
  v_mfma_f32_16x16x32_bf16 v[48:51], a[48:51], a[0:3], v[48:51]
  s_add_u32 s68, s68, s70
  s_add_u32 s69, s69, 1
  ds_read_b64_tr_b16 a[86:87], v19 offset:14336
  v_mfma_f32_16x16x32_bf16 v[80:83], a[48:51], a[4:7], v[80:83]
  s_cmp_eq_u32 s69, 3
  s_cselect_b32 s69, 0, s69
  s_cselect_b32 s70, s71, s72
  ds_read_b64_tr_b16 a[88:89], v20 offset:12288
  v_mfma_f32_16x16x32_bf16 v[112:115], a[48:51], a[8:11], v[112:115]
  ds_read_b64_tr_b16 a[90:91], v20 offset:14336
  v_mfma_f32_16x16x32_bf16 v[144:147], a[48:51], a[12:15], v[144:147]
  ds_read_b64_tr_b16 a[92:93], v21 offset:12288
  v_mfma_f32_16x16x32_bf16 v[52:55], a[52:55], a[0:3], v[52:55]
  ds_read_b64_tr_b16 a[94:95], v21 offset:14336
  v_mfma_f32_16x16x32_bf16 v[84:87], a[52:55], a[4:7], v[84:87]
  v_add_u32 v16, s90, v16
  v_add_u32 v17, s90, v17
  v_mfma_f32_16x16x32_bf16 v[116:119], a[52:55], a[8:11], v[116:119]
  v_add_u32 v18, s70, v18
  v_add_u32 v19, s70, v19
  v_mfma_f32_16x16x32_bf16 v[148:151], a[52:55], a[12:15], v[148:151]
  v_add_u32 v20, s70, v20
  v_add_u32 v21, s70, v21
  v_mfma_f32_16x16x32_bf16 v[56:59], a[56:59], a[0:3], v[56:59]
  v_mfma_f32_16x16x32_bf16 v[88:91], a[56:59], a[4:7], v[88:91]
  v_mfma_f32_16x16x32_bf16 v[120:123], a[56:59], a[8:11], v[120:123]
  v_mfma_f32_16x16x32_bf16 v[152:155], a[56:59], a[12:15], v[152:155]
  v_mfma_f32_16x16x32_bf16 v[60:63], a[60:63], a[0:3], v[60:63]
  v_mfma_f32_16x16x32_bf16 v[92:95], a[60:63], a[4:7], v[92:95]
  v_mfma_f32_16x16x32_bf16 v[124:127], a[60:63], a[8:11], v[124:127]
  v_mfma_f32_16x16x32_bf16 v[156:159], a[60:63], a[12:15], v[156:159]
  s_waitcnt vmcnt(4) lgkmcnt(0)
  s_barrier
  s_mov_b32 s6, 0x3e0293ee
  s_mov_b32 s7, s6
  v_mfma_f32_16x16x32_bf16 v[32:35], a[64:67], a[16:19], v[32:35]
  s_mov_b32 m0, s26
  ds_read_b128 a[0:3], v16 offset:0
  v_mfma_f32_16x16x32_bf16 v[64:67], a[64:67], a[20:23], v[64:67]
  buffer_load_dwordx4 v2, s[20:23], s28 offen offset:0 sc1 lds
  ds_read_b64_tr_b16 a[32:33], v18 offset:0
  v_mfma_f32_16x16x32_bf16 v[96:99], a[64:67], a[24:27], v[96:99]
  ds_read_b64_tr_b16 a[34:35], v18 offset:2048
  v_mfma_f32_16x16x32_bf16 v[128:131], a[64:67], a[28:31], v[128:131]
  buffer_load_dwordx4 v2, s[20:23], s28 offen offset:1024 sc1 lds
  ds_read_b128 a[4:7], v16 offset:2048
  v_mfma_f32_16x16x32_bf16 v[36:39], a[68:71], a[16:19], v[36:39]
  ds_read_b128 a[8:11], v16 offset:4096
  v_mfma_f32_16x16x32_bf16 v[68:71], a[68:71], a[20:23], v[68:71]
  ds_read_b128 a[12:15], v16 offset:6144
  v_mfma_f32_16x16x32_bf16 v[100:103], a[68:71], a[24:27], v[100:103]
  ds_read_b64_tr_b16 a[36:37], v19 offset:0
  v_mfma_f32_16x16x32_bf16 v[132:135], a[68:71], a[28:31], v[132:135]
  buffer_load_dwordx4 v2, s[20:23], s28 offen offset:2048 sc1 lds
  ds_read_b64_tr_b16 a[38:39], v19 offset:2048
  v_mfma_f32_16x16x32_bf16 v[40:43], a[72:75], a[16:19], v[40:43]
  ds_read_b64_tr_b16 a[40:41], v20 offset:0
  v_mfma_f32_16x16x32_bf16 v[72:75], a[72:75], a[20:23], v[72:75]
  ds_read_b64_tr_b16 a[42:43], v20 offset:2048
  v_mfma_f32_16x16x32_bf16 v[104:107], a[72:75], a[24:27], v[104:107]
  v_mfma_f32_16x16x32_bf16 v[136:139], a[72:75], a[28:31], v[136:139]
  buffer_load_dwordx4 v2, s[20:23], s28 offen offset:3072 sc1 lds
  ds_read_b64_tr_b16 a[44:45], v21 offset:0
  v_mfma_f32_16x16x32_bf16 v[44:47], a[76:79], a[16:19], v[44:47]
  s_xor_b32 s26, s26, 0x8000
  s_add_u32 s28, s28, 0x8000
  s_mov_b32 m0, s27
  v_mfma_f32_16x16x32_bf16 v[76:79], a[76:79], a[20:23], v[76:79]
  ds_read_b64_tr_b16 a[46:47], v21 offset:2048
  ds_read_b64_tr_b16 a[48:49], v18 offset:8192
  v_mfma_f32_16x16x32_bf16 v[108:111], a[76:79], a[24:27], v[108:111]
  ds_read_b64_tr_b16 a[50:51], v18 offset:10240
  v_mfma_f32_16x16x32_bf16 v[140:143], a[76:79], a[28:31], v[140:143]
  buffer_load_dwordx4 v2, s[20:23], s29 offen offset:0 sc1 lds
  ds_read_b64_tr_b16 a[52:53], v19 offset:8192
  v_mfma_f32_16x16x32_bf16 v[48:51], a[80:83], a[16:19], v[48:51]
  ds_read_b64_tr_b16 a[54:55], v19 offset:10240
  v_mfma_f32_16x16x32_bf16 v[80:83], a[80:83], a[20:23], v[80:83]
  ds_read_b64_tr_b16 a[56:57], v20 offset:8192
  v_mfma_f32_16x16x32_bf16 v[112:115], a[80:83], a[24:27], v[112:115]
  ds_read_b64_tr_b16 a[58:59], v20 offset:10240
  v_mfma_f32_16x16x32_bf16 v[144:147], a[80:83], a[28:31], v[144:147]
  buffer_load_dwordx4 v2, s[20:23], s29 offen offset:1024 sc1 lds
  ds_read_b64_tr_b16 a[60:61], v21 offset:8192
  v_mfma_f32_16x16x32_bf16 v[52:55], a[84:87], a[16:19], v[52:55]
  ds_read_b64_tr_b16 a[62:63], v21 offset:10240
  v_mfma_f32_16x16x32_bf16 v[84:87], a[84:87], a[20:23], v[84:87]
  v_mfma_f32_16x16x32_bf16 v[116:119], a[84:87], a[24:27], v[116:119]
  v_mfma_f32_16x16x32_bf16 v[148:151], a[84:87], a[28:31], v[148:151]
  buffer_load_dwordx4 v2, s[20:23], s29 offen offset:2048 sc1 lds
  v_mfma_f32_16x16x32_bf16 v[56:59], a[88:91], a[16:19], v[56:59]
  v_mfma_f32_16x16x32_bf16 v[88:91], a[88:91], a[20:23], v[88:91]
  v_mfma_f32_16x16x32_bf16 v[120:123], a[88:91], a[24:27], v[120:123]
  v_mfma_f32_16x16x32_bf16 v[152:155], a[88:91], a[28:31], v[152:155]
  buffer_load_dwordx4 v2, s[20:23], s29 offen offset:3072 sc1 lds
  v_mfma_f32_16x16x32_bf16 v[60:63], a[92:95], a[16:19], v[60:63]
  s_xor_b32 s27, s27, 0x4000
  s_add_u32 s29, s29, 0x8000
  v_mfma_f32_16x16x32_bf16 v[92:95], a[92:95], a[20:23], v[92:95]
  v_mfma_f32_16x16x32_bf16 v[124:127], a[92:95], a[24:27], v[124:127]
  v_mfma_f32_16x16x32_bf16 v[156:159], a[92:95], a[28:31], v[156:159]
  s_waitcnt lgkmcnt(0)
  v_mfma_f32_16x16x32_bf16 v[32:35], a[32:35], a[0:3], v[32:35]
  ds_read_b128 a[16:19], v17 offset:0
  ds_read_b64_tr_b16 a[64:65], v18 offset:4096
  v_mfma_f32_16x16x32_bf16 v[36:39], a[36:39], a[0:3], v[36:39]
  ds_read_b64_tr_b16 a[66:67], v18 offset:6144
  ds_read_b128 a[20:23], v17 offset:2048
  v_mfma_f32_16x16x32_bf16 v[40:43], a[40:43], a[0:3], v[40:43]
  ds_read_b128 a[24:27], v17 offset:4096
  ds_read_b128 a[28:31], v17 offset:6144
  v_mfma_f32_16x16x32_bf16 v[44:47], a[44:47], a[0:3], v[44:47]
  ds_read_b64_tr_b16 a[68:69], v19 offset:4096
  ds_read_b64_tr_b16 a[70:71], v19 offset:6144
  v_mfma_f32_16x16x32_bf16 v[48:51], a[48:51], a[0:3], v[48:51]
  ds_read_b64_tr_b16 a[72:73], v20 offset:4096
  ds_read_b64_tr_b16 a[74:75], v20 offset:6144
  v_mfma_f32_16x16x32_bf16 v[52:55], a[52:55], a[0:3], v[52:55]
  ds_read_b64_tr_b16 a[76:77], v21 offset:4096
  v_mfma_f32_16x16x32_bf16 v[56:59], a[56:59], a[0:3], v[56:59]
  ds_read_b64_tr_b16 a[78:79], v21 offset:6144
  ds_read_b64_tr_b16 a[80:81], v18 offset:12288
  v_mfma_f32_16x16x32_bf16 v[60:63], a[60:63], a[0:3], v[60:63]
  ds_read_b64_tr_b16 a[82:83], v18 offset:14336
  ds_read_b64_tr_b16 a[84:85], v19 offset:12288
  v_mfma_f32_16x16x32_bf16 v[64:67], a[32:35], a[4:7], v[64:67]
  ds_read_b64_tr_b16 a[86:87], v19 offset:14336
  ds_read_b64_tr_b16 a[88:89], v20 offset:12288
  v_mfma_f32_16x16x32_bf16 v[68:71], a[36:39], a[4:7], v[68:71]
  ds_read_b64_tr_b16 a[90:91], v20 offset:14336
  ds_read_b64_tr_b16 a[92:93], v21 offset:12288
  v_mfma_f32_16x16x32_bf16 v[72:75], a[40:43], a[4:7], v[72:75]
  ds_read_b64_tr_b16 a[94:95], v21 offset:14336
  v_mfma_f32_16x16x32_bf16 v[76:79], a[44:47], a[4:7], v[76:79]
  v_mfma_f32_16x16x32_bf16 v[80:83], a[48:51], a[4:7], v[80:83]
  v_mfma_f32_16x16x32_bf16 v[84:87], a[52:55], a[4:7], v[84:87]
  v_mfma_f32_16x16x32_bf16 v[88:91], a[56:59], a[4:7], v[88:91]
  v_mfma_f32_16x16x32_bf16 v[92:95], a[60:63], a[4:7], v[92:95]
  s_waitcnt lgkmcnt(0)
  v_mfma_f32_16x16x32_bf16 v[32:35], a[64:67], a[16:19], v[32:35]
  v_mfma_f32_16x16x32_bf16 v[36:39], a[68:71], a[16:19], v[36:39]
  v_mfma_f32_16x16x32_bf16 v[40:43], a[72:75], a[16:19], v[40:43]
  v_mfma_f32_16x16x32_bf16 v[44:47], a[76:79], a[16:19], v[44:47]
  v_mfma_f32_16x16x32_bf16 v[48:51], a[80:83], a[16:19], v[48:51]
  v_mfma_f32_16x16x32_bf16 v[52:55], a[84:87], a[16:19], v[52:55]
  s_nop 2
  v_pk_mul_f32 v[32:33], v[32:33], s[6:7]
  v_pk_mul_f32 v[34:35], v[34:35], s[6:7]
  v_mfma_f32_16x16x32_bf16 v[56:59], a[88:91], a[16:19], v[56:59]
  v_pk_mul_f32 v[36:37], v[36:37], s[6:7]
  v_pk_mul_f32 v[38:39], v[38:39], s[6:7]
  v_mfma_f32_16x16x32_bf16 v[60:63], a[92:95], a[16:19], v[60:63]
  v_cvt_pk_bf16_f32 v32, v32, v33
  v_cvt_pk_bf16_f32 v33, v34, v35
  v_mfma_f32_16x16x32_bf16 v[64:67], a[64:67], a[20:23], v[64:67]
  v_cvt_pk_bf16_f32 v34, v36, v37
  v_cvt_pk_bf16_f32 v35, v38, v39
  v_mfma_f32_16x16x32_bf16 v[68:71], a[68:71], a[20:23], v[68:71]
  v_accvgpr_write_b32 a128, v32
  v_accvgpr_write_b32 a129, v33
  v_mfma_f32_16x16x32_bf16 v[72:75], a[72:75], a[20:23], v[72:75]
  v_accvgpr_write_b32 a130, v34
  v_accvgpr_write_b32 a131, v35
  v_mfma_f32_16x16x32_bf16 v[76:79], a[76:79], a[20:23], v[76:79]
  v_pk_mul_f32 v[40:41], v[40:41], s[6:7]
  v_pk_mul_f32 v[42:43], v[42:43], s[6:7]
  v_mfma_f32_16x16x32_bf16 v[80:83], a[80:83], a[20:23], v[80:83]
  v_pk_mul_f32 v[44:45], v[44:45], s[6:7]
  v_pk_mul_f32 v[46:47], v[46:47], s[6:7]
  v_mfma_f32_16x16x32_bf16 v[84:87], a[84:87], a[20:23], v[84:87]
  v_cvt_pk_bf16_f32 v40, v40, v41
  v_cvt_pk_bf16_f32 v41, v42, v43
  v_mfma_f32_16x16x32_bf16 v[88:91], a[88:91], a[20:23], v[88:91]
  v_cvt_pk_bf16_f32 v42, v44, v45
  v_cvt_pk_bf16_f32 v43, v46, v47
  v_mfma_f32_16x16x32_bf16 v[92:95], a[92:95], a[20:23], v[92:95]
  v_accvgpr_write_b32 a132, v40
  v_accvgpr_write_b32 a133, v41
  v_mfma_f32_16x16x32_bf16 v[96:99], a[32:35], a[8:11], v[96:99]
  v_accvgpr_write_b32 a134, v42
  v_accvgpr_write_b32 a135, v43
  v_mfma_f32_16x16x32_bf16 v[100:103], a[36:39], a[8:11], v[100:103]
  v_mfma_f32_32x32x16_bf16 v[160:175], a[236:239], a[236:239], 0
  v_pk_mul_f32 v[48:49], v[48:49], s[6:7]
  v_mfma_f32_16x16x32_bf16 v[96:99], a[64:67], a[24:27], v[96:99]
  v_pk_mul_f32 v[50:51], v[50:51], s[6:7]
  v_pk_mul_f32 v[52:53], v[52:53], s[6:7]
  v_mfma_f32_16x16x32_bf16 v[100:103], a[68:71], a[24:27], v[100:103]
  v_pk_mul_f32 v[54:55], v[54:55], s[6:7]
  v_cvt_pk_bf16_f32 v48, v48, v49
  v_mfma_f32_16x16x32_bf16 v[104:107], a[40:43], a[8:11], v[104:107]
  v_cvt_pk_bf16_f32 v49, v50, v51
  v_cvt_pk_bf16_f32 v50, v52, v53
  v_mfma_f32_16x16x32_bf16 v[108:111], a[44:47], a[8:11], v[108:111]
  v_cvt_pk_bf16_f32 v51, v54, v55
  v_accvgpr_write_b32 a136, v48
  v_mfma_f32_16x16x32_bf16 v[104:107], a[72:75], a[24:27], v[104:107]
  v_accvgpr_write_b32 a137, v49
  v_accvgpr_write_b32 a138, v50
  v_mfma_f32_16x16x32_bf16 v[108:111], a[76:79], a[24:27], v[108:111]
  v_accvgpr_write_b32 a139, v51
  v_pk_mul_f32 v[56:57], v[56:57], s[6:7]
  v_mfma_f32_16x16x32_bf16 v[112:115], a[48:51], a[8:11], v[112:115]
  v_pk_mul_f32 v[58:59], v[58:59], s[6:7]
  v_pk_mul_f32 v[60:61], v[60:61], s[6:7]
  v_mfma_f32_16x16x32_bf16 v[116:119], a[52:55], a[8:11], v[116:119]
  v_pk_mul_f32 v[62:63], v[62:63], s[6:7]
  v_cvt_pk_bf16_f32 v56, v56, v57
  v_mfma_f32_16x16x32_bf16 v[112:115], a[80:83], a[24:27], v[112:115]
  v_cvt_pk_bf16_f32 v57, v58, v59
  v_cvt_pk_bf16_f32 v58, v60, v61
  v_mfma_f32_16x16x32_bf16 v[116:119], a[84:87], a[24:27], v[116:119]
  v_cvt_pk_bf16_f32 v59, v62, v63
  v_accvgpr_write_b32 a140, v56
  v_mfma_f32_16x16x32_bf16 v[120:123], a[56:59], a[8:11], v[120:123]
  v_accvgpr_write_b32 a141, v57
  v_accvgpr_write_b32 a142, v58
  v_mfma_f32_16x16x32_bf16 v[124:127], a[60:63], a[8:11], v[124:127]
  v_accvgpr_write_b32 a143, v59
  v_mfma_f32_32x32x16_bf16 v[176:191], a[236:239], a[236:239], 0
  v_mfma_f32_16x16x32_bf16 v[120:123], a[88:91], a[24:27], v[120:123]
  v_pk_mul_f32 v[64:65], v[64:65], s[6:7]
  v_pk_mul_f32 v[66:67], v[66:67], s[6:7]
  v_mfma_f32_16x16x32_bf16 v[124:127], a[92:95], a[24:27], v[124:127]
  v_pk_mul_f32 v[68:69], v[68:69], s[6:7]
  v_pk_mul_f32 v[70:71], v[70:71], s[6:7]
  v_mfma_f32_16x16x32_bf16 v[128:131], a[32:35], a[12:15], v[128:131]
  v_cvt_pk_bf16_f32 v64, v64, v65
  v_cvt_pk_bf16_f32 v65, v66, v67
  v_mfma_f32_16x16x32_bf16 v[132:135], a[36:39], a[12:15], v[132:135]
  v_cvt_pk_bf16_f32 v66, v68, v69
  v_cvt_pk_bf16_f32 v67, v70, v71
  v_mfma_f32_16x16x32_bf16 v[128:131], a[64:67], a[28:31], v[128:131]
  v_accvgpr_write_b32 a144, v64
  v_accvgpr_write_b32 a145, v65
  v_mfma_f32_16x16x32_bf16 v[132:135], a[68:71], a[28:31], v[132:135]
  v_accvgpr_write_b32 a146, v66
  v_accvgpr_write_b32 a147, v67
  v_mfma_f32_16x16x32_bf16 v[136:139], a[40:43], a[12:15], v[136:139]
  v_pk_mul_f32 v[72:73], v[72:73], s[6:7]
  v_pk_mul_f32 v[74:75], v[74:75], s[6:7]
  v_mfma_f32_16x16x32_bf16 v[140:143], a[44:47], a[12:15], v[140:143]
  v_pk_mul_f32 v[76:77], v[76:77], s[6:7]
  v_pk_mul_f32 v[78:79], v[78:79], s[6:7]
  v_mfma_f32_16x16x32_bf16 v[136:139], a[72:75], a[28:31], v[136:139]
  v_cvt_pk_bf16_f32 v72, v72, v73
  v_cvt_pk_bf16_f32 v73, v74, v75
  v_mfma_f32_16x16x32_bf16 v[140:143], a[76:79], a[28:31], v[140:143]
  v_cvt_pk_bf16_f32 v74, v76, v77
  v_cvt_pk_bf16_f32 v75, v78, v79
  v_mfma_f32_16x16x32_bf16 v[144:147], a[48:51], a[12:15], v[144:147]
  v_accvgpr_write_b32 a148, v72
  v_accvgpr_write_b32 a149, v73
  v_mfma_f32_16x16x32_bf16 v[148:151], a[52:55], a[12:15], v[148:151]
  v_accvgpr_write_b32 a150, v74
  v_accvgpr_write_b32 a151, v75
  v_mfma_f32_16x16x32_bf16 v[144:147], a[80:83], a[28:31], v[144:147]
  v_mfma_f32_32x32x16_bf16 v[192:207], a[236:239], a[236:239], 0
  v_pk_mul_f32 v[80:81], v[80:81], s[6:7]
  v_mfma_f32_16x16x32_bf16 v[148:151], a[84:87], a[28:31], v[148:151]
  v_pk_mul_f32 v[82:83], v[82:83], s[6:7]
  v_pk_mul_f32 v[84:85], v[84:85], s[6:7]
  v_mfma_f32_16x16x32_bf16 v[152:155], a[56:59], a[12:15], v[152:155]
  v_pk_mul_f32 v[86:87], v[86:87], s[6:7]
  v_cvt_pk_bf16_f32 v80, v80, v81
  v_mfma_f32_16x16x32_bf16 v[156:159], a[60:63], a[12:15], v[156:159]
  v_cvt_pk_bf16_f32 v81, v82, v83
  v_cvt_pk_bf16_f32 v82, v84, v85
  v_mfma_f32_16x16x32_bf16 v[152:155], a[88:91], a[28:31], v[152:155]
  v_cvt_pk_bf16_f32 v83, v86, v87
  v_accvgpr_write_b32 a152, v80
  v_mfma_f32_16x16x32_bf16 v[156:159], a[92:95], a[28:31], v[156:159]
  v_accvgpr_write_b32 a153, v81
  v_accvgpr_write_b32 a154, v82
  v_accvgpr_write_b32 a155, v83
  v_pk_mul_f32 v[88:89], v[88:89], s[6:7]
  v_pk_mul_f32 v[90:91], v[90:91], s[6:7]
  v_pk_mul_f32 v[92:93], v[92:93], s[6:7]
  v_pk_mul_f32 v[94:95], v[94:95], s[6:7]
  v_cvt_pk_bf16_f32 v88, v88, v89
  v_cvt_pk_bf16_f32 v89, v90, v91
  v_cvt_pk_bf16_f32 v90, v92, v93
  v_cvt_pk_bf16_f32 v91, v94, v95
  v_accvgpr_write_b32 a156, v88
  v_accvgpr_write_b32 a157, v89
  v_accvgpr_write_b32 a158, v90
  v_accvgpr_write_b32 a159, v91
  v_mfma_f32_32x32x16_bf16 v[208:223], a[236:239], a[236:239], 0
  v_pk_mul_f32 v[96:97], v[96:97], s[6:7]
  v_pk_mul_f32 v[98:99], v[98:99], s[6:7]
  v_pk_mul_f32 v[100:101], v[100:101], s[6:7]
  v_pk_mul_f32 v[102:103], v[102:103], s[6:7]
  v_cvt_pk_bf16_f32 v96, v96, v97
  v_cvt_pk_bf16_f32 v97, v98, v99
  v_cvt_pk_bf16_f32 v98, v100, v101
  v_cvt_pk_bf16_f32 v99, v102, v103
  v_accvgpr_write_b32 a160, v96
  v_accvgpr_write_b32 a161, v97
  v_accvgpr_write_b32 a162, v98
  v_accvgpr_write_b32 a163, v99
  v_pk_mul_f32 v[104:105], v[104:105], s[6:7]
  v_pk_mul_f32 v[106:107], v[106:107], s[6:7]
  v_pk_mul_f32 v[108:109], v[108:109], s[6:7]
  v_pk_mul_f32 v[110:111], v[110:111], s[6:7]
  v_cvt_pk_bf16_f32 v104, v104, v105
  v_cvt_pk_bf16_f32 v105, v106, v107
  v_cvt_pk_bf16_f32 v106, v108, v109
  v_cvt_pk_bf16_f32 v107, v110, v111
  v_accvgpr_write_b32 a164, v104
  v_accvgpr_write_b32 a165, v105
  v_accvgpr_write_b32 a166, v106
  v_accvgpr_write_b32 a167, v107
  v_mfma_f32_32x32x16_bf16 v[224:239], a[236:239], a[236:239], 0
  v_pk_mul_f32 v[112:113], v[112:113], s[6:7]
  v_pk_mul_f32 v[114:115], v[114:115], s[6:7]
  v_pk_mul_f32 v[116:117], v[116:117], s[6:7]
  v_pk_mul_f32 v[118:119], v[118:119], s[6:7]
  v_cvt_pk_bf16_f32 v112, v112, v113
  v_cvt_pk_bf16_f32 v113, v114, v115
  v_cvt_pk_bf16_f32 v114, v116, v117
  v_cvt_pk_bf16_f32 v115, v118, v119
  v_accvgpr_write_b32 a168, v112
  v_accvgpr_write_b32 a169, v113
  v_accvgpr_write_b32 a170, v114
  v_accvgpr_write_b32 a171, v115
  v_pk_mul_f32 v[120:121], v[120:121], s[6:7]
  v_pk_mul_f32 v[122:123], v[122:123], s[6:7]
  v_pk_mul_f32 v[124:125], v[124:125], s[6:7]
  v_pk_mul_f32 v[126:127], v[126:127], s[6:7]
  v_cvt_pk_bf16_f32 v120, v120, v121
  v_cvt_pk_bf16_f32 v121, v122, v123
  v_cvt_pk_bf16_f32 v122, v124, v125
  v_cvt_pk_bf16_f32 v123, v126, v127
  v_accvgpr_write_b32 a172, v120
  v_accvgpr_write_b32 a173, v121
  v_accvgpr_write_b32 a174, v122
  v_accvgpr_write_b32 a175, v123
  v_mfma_f32_32x32x16_bf16 v[240:255], a[236:239], a[236:239], 0
  v_pk_mul_f32 v[128:129], v[128:129], s[6:7]
  v_pk_mul_f32 v[130:131], v[130:131], s[6:7]
  v_pk_mul_f32 v[132:133], v[132:133], s[6:7]
  v_pk_mul_f32 v[134:135], v[134:135], s[6:7]
  v_cvt_pk_bf16_f32 v128, v128, v129
  v_cvt_pk_bf16_f32 v129, v130, v131
  v_cvt_pk_bf16_f32 v130, v132, v133
  v_cvt_pk_bf16_f32 v131, v134, v135
  v_accvgpr_write_b32 a176, v128
  v_accvgpr_write_b32 a177, v129
  v_accvgpr_write_b32 a178, v130
  v_accvgpr_write_b32 a179, v131
  v_pk_mul_f32 v[136:137], v[136:137], s[6:7]
  v_pk_mul_f32 v[138:139], v[138:139], s[6:7]
  v_pk_mul_f32 v[140:141], v[140:141], s[6:7]
  v_pk_mul_f32 v[142:143], v[142:143], s[6:7]
  v_cvt_pk_bf16_f32 v136, v136, v137
  v_cvt_pk_bf16_f32 v137, v138, v139
  v_cvt_pk_bf16_f32 v138, v140, v141
  v_cvt_pk_bf16_f32 v139, v142, v143
  v_accvgpr_write_b32 a180, v136
  v_accvgpr_write_b32 a181, v137
  v_accvgpr_write_b32 a182, v138
  v_accvgpr_write_b32 a183, v139
  v_mfma_f32_32x32x16_bf16 v[128:143], a[236:239], a[236:239], 0
  v_pk_mul_f32 v[144:145], v[144:145], s[6:7]
  v_pk_mul_f32 v[146:147], v[146:147], s[6:7]
  v_pk_mul_f32 v[148:149], v[148:149], s[6:7]
  v_pk_mul_f32 v[150:151], v[150:151], s[6:7]
  v_cvt_pk_bf16_f32 v144, v144, v145
  v_cvt_pk_bf16_f32 v145, v146, v147
  v_cvt_pk_bf16_f32 v146, v148, v149
  v_cvt_pk_bf16_f32 v147, v150, v151
  v_accvgpr_write_b32 a184, v144
  v_accvgpr_write_b32 a185, v145
  v_accvgpr_write_b32 a186, v146
  v_accvgpr_write_b32 a187, v147
  v_pk_mul_f32 v[152:153], v[152:153], s[6:7]
  v_pk_mul_f32 v[154:155], v[154:155], s[6:7]
  v_pk_mul_f32 v[156:157], v[156:157], s[6:7]
  v_pk_mul_f32 v[158:159], v[158:159], s[6:7]
  v_cvt_pk_bf16_f32 v152, v152, v153
  v_cvt_pk_bf16_f32 v153, v154, v155
  v_cvt_pk_bf16_f32 v154, v156, v157
  v_cvt_pk_bf16_f32 v155, v158, v159
  v_accvgpr_write_b32 a188, v152
  v_accvgpr_write_b32 a189, v153
  v_accvgpr_write_b32 a190, v154
  v_accvgpr_write_b32 a191, v155
  v_mfma_f32_32x32x16_bf16 v[144:159], a[236:239], a[236:239], 0
  v_add_u32 v3, 0xc000, v2
  v_add_u32 v4, 0x10000, v2
  v_mov_b32 v5, 0xf149f2ca
  s_mov_b32 s89, 0
  v_mfma_f32_32x32x16_bf16 a[192:207], a[236:239], a[236:239], 0
  s_lshl_b32 s90, s78, 1
  s_add_u32 s90, s90, s77
  s_lshl_b32 s90, s90, 2
  s_add_u32 s90, s90, s3
  s_lshl_b32 s90, s90, 14
  s_add_u32 s64, s86, 100663296
  s_addc_u32 s65, s87, 0
  s_add_u32 s64, s64, s90
  s_addc_u32 s65, s65, 0
  s_mov_b32 s66, 16384
  s_mov_b32 s67, 0x00020000
  s_mov_b32 s90, 0
  s_waitcnt vmcnt(8)
  s_barrier
  ds_read_b128 a[32:35], v3 offset:0
  ds_read_b128 a[36:39], v3 offset:1024
  ds_read_b128 a[40:43], v3 offset:2048
  ds_read_b128 a[44:47], v3 offset:3072
  ds_read_b128 a[48:51], v3 offset:4096
  ds_read_b128 a[52:55], v3 offset:5120
  ds_read_b128 a[56:59], v3 offset:6144
  ds_read_b128 a[60:63], v3 offset:7168
  s_waitcnt lgkmcnt(6)
  v_mfma_f32_16x16x32_bf16 v[64:67], a[32:35], a[128:131], 0
  s_lshl_b32 s4, s2, 2
  s_add_u32 s4, s4, s3
  s_lshl_b32 s6, s4, 13
  v_mfma_f32_16x16x32_bf16 v[72:75], a[32:35], a[144:147], 0
  s_lshl_b32 s7, s4, 11
  s_mov_b32 s8, s74
  s_mov_b32 s9, s75
  v_mfma_f32_16x16x32_bf16 v[80:83], a[32:35], a[160:163], 0
  s_mov_b32 s10, 8388608
  s_mov_b32 s11, 0x00020000
  s_mov_b32 s12, s80
  v_mfma_f32_16x16x32_bf16 v[88:91], a[32:35], a[176:179], 0
  s_mov_b32 s13, s81
  s_mov_b32 s14, 2097152
  ds_read_b128 a[0:3], v3 offset:8192
  v_mfma_f32_16x16x32_bf16 v[64:67], a[36:39], a[132:135], v[64:67]
  s_mov_b32 s15, 0x00020000
  s_add_u32 s16, s86, 67108864
  s_addc_u32 s17, s87, 0
  v_mfma_f32_16x16x32_bf16 v[72:75], a[36:39], a[148:151], v[72:75]
  s_mov_b32 s18, 16777216
  s_mov_b32 s19, 0x00020000
  v_mfma_f32_16x16x32_bf16 v[80:83], a[36:39], a[164:167], v[80:83]
  v_and_b32 v6, 15, v1
  v_lshrrev_b32 v7, 4, v1
  v_mfma_f32_16x16x32_bf16 v[88:91], a[36:39], a[180:183], v[88:91]
  s_waitcnt lgkmcnt(5)
  ds_read_b128 a[4:7], v3 offset:9216
  v_sub_u32 v6, v6, v7
  v_mfma_f32_16x16x32_bf16 v[64:67], a[40:43], a[136:139], v[64:67]
  v_lshlrev_b32 v6, 2, v6
  v_add_u32 v6, s3, v6
  v_mfma_f32_16x16x32_bf16 v[72:75], a[40:43], a[152:155], v[72:75]
  v_cmp_gt_i32 s[32:33], 0, v6
  v_cmp_gt_i32 s[34:35], 1, v6
  v_mfma_f32_16x16x32_bf16 v[80:83], a[40:43], a[168:171], v[80:83]
  v_cmp_gt_i32 s[36:37], 2, v6
  v_cmp_gt_i32 s[38:39], 3, v6
  v_mfma_f32_16x16x32_bf16 v[88:91], a[40:43], a[184:187], v[88:91]
  ds_read_b128 a[8:11], v3 offset:10240
  v_cmp_gt_i32 s[40:41], 16, v6
  v_mfma_f32_16x16x32_bf16 v[64:67], a[44:47], a[140:143], v[64:67]
  v_cmp_gt_i32 s[42:43], 17, v6
  v_cmp_gt_i32 s[44:45], 18, v6
  v_mfma_f32_16x16x32_bf16 v[72:75], a[44:47], a[156:159], v[72:75]
  v_cmp_gt_i32 s[46:47], 19, v6
  v_cmp_gt_i32 s[48:49], 32, v6
  v_mfma_f32_16x16x32_bf16 v[80:83], a[44:47], a[172:175], v[80:83]
  v_cmp_gt_i32 s[50:51], 33, v6
  v_cmp_gt_i32 s[52:53], 34, v6
  v_mfma_f32_16x16x32_bf16 v[88:91], a[44:47], a[188:191], v[88:91]
  s_waitcnt lgkmcnt(5)
  ds_read_b128 a[12:15], v3 offset:11264
  v_cmp_gt_i32 s[54:55], 35, v6
  v_mfma_f32_16x16x32_bf16 v[68:71], a[48:51], a[128:131], 0
  v_cmp_gt_i32 s[56:57], 48, v6
  v_cmp_gt_i32 s[58:59], 49, v6
  v_mfma_f32_16x16x32_bf16 v[76:79], a[48:51], a[144:147], 0
  s_mov_b32 s30, 0x8000
  v_cmp_gt_i32 s[60:61], 50, v6
  v_cmp_gt_i32 s[62:63], 51, v6
  v_mfma_f32_16x16x32_bf16 v[84:87], a[48:51], a[160:163], 0
  s_mov_b32 s31, 0x4000
  v_mfma_f32_16x16x32_bf16 v[92:95], a[48:51], a[176:179], 0
  ds_read_b128 a[16:19], v3 offset:12288
  v_mfma_f32_16x16x32_bf16 v[68:71], a[52:55], a[132:135], v[68:71]
  v_mfma_f32_16x16x32_bf16 v[76:79], a[52:55], a[148:151], v[76:79]
  v_mfma_f32_16x16x32_bf16 v[84:87], a[52:55], a[164:167], v[84:87]
  v_mfma_f32_16x16x32_bf16 v[92:95], a[52:55], a[180:183], v[92:95]
  s_waitcnt lgkmcnt(5)
  ds_read_b128 a[20:23], v3 offset:13312
  v_mfma_f32_16x16x32_bf16 v[68:71], a[56:59], a[136:139], v[68:71]
  v_mfma_f32_16x16x32_bf16 v[76:79], a[56:59], a[152:155], v[76:79]
  v_mfma_f32_16x16x32_bf16 v[84:87], a[56:59], a[168:171], v[84:87]
  v_mfma_f32_16x16x32_bf16 v[92:95], a[56:59], a[184:187], v[92:95]
  ds_read_b128 a[24:27], v3 offset:14336
  v_mfma_f32_16x16x32_bf16 v[68:71], a[60:63], a[140:143], v[68:71]
  v_mfma_f32_16x16x32_bf16 v[76:79], a[60:63], a[156:159], v[76:79]
  v_mfma_f32_16x16x32_bf16 v[84:87], a[60:63], a[172:175], v[84:87]
  v_mfma_f32_16x16x32_bf16 v[92:95], a[60:63], a[188:191], v[92:95]
  ds_read_b128 a[28:31], v3 offset:15360
  s_cmp_lg_u32 s25, 0
  s_nop 0
  s_cbranch_scc1 La_nomask0
  v_cndmask_b32 v64, v64, v5, s[32:33]
  v_cndmask_b32 v65, v65, v5, s[34:35]
  v_cndmask_b32 v66, v66, v5, s[36:37]
  v_cndmask_b32 v67, v67, v5, s[38:39]
  v_cndmask_b32 v68, v68, v5, s[40:41]
  v_cndmask_b32 v69, v69, v5, s[42:43]
  v_cndmask_b32 v70, v70, v5, s[44:45]
  v_cndmask_b32 v71, v71, v5, s[46:47]
La_nomask0:
  v_max3_f32 v6, v64, v65, v66
  v_max3_f32 v7, v67, v68, v69
  v_max3_f32 v6, v6, v70, v71
  v_max_f32 v6, v6, v7
  v_max3_f32 v8, v72, v73, v74
  v_max3_f32 v9, v75, v76, v77
  v_max3_f32 v8, v8, v78, v79
  v_max_f32 v8, v8, v9
  v_max3_f32 v10, v80, v81, v82
  v_max3_f32 v11, v83, v84, v85
  v_max3_f32 v10, v10, v86, v87
  v_max_f32 v10, v10, v11
  v_max3_f32 v12, v88, v89, v90
  v_max3_f32 v13, v91, v92, v93
  v_max3_f32 v12, v12, v94, v95
  v_max_f32 v12, v12, v13
  v_mov_b32 v7, v6
  v_mov_b32 v9, v8
  v_mov_b32 v11, v10
  v_mov_b32 v13, v12
  v_permlane32_swap_b32 v6, v7
  v_permlane32_swap_b32 v8, v9
  v_permlane32_swap_b32 v10, v11
  v_permlane32_swap_b32 v12, v13
  v_max_f32 v6, v6, v7
  v_max_f32 v8, v8, v9
  v_max_f32 v10, v10, v11
  v_max_f32 v12, v12, v13
  v_mov_b32 v7, v6
  v_mov_b32 v9, v8
  v_mov_b32 v11, v10
  v_mov_b32 v13, v12
  v_permlane16_swap_b32 v6, v7
  v_permlane16_swap_b32 v8, v9
  v_permlane16_swap_b32 v10, v11
  v_permlane16_swap_b32 v12, v13
  v_max_f32 v6, v6, v7
  v_max_f32 v8, v8, v9
  v_max_f32 v10, v10, v11
  v_max_f32 v12, v12, v13
  v_sub_f32 v16, 0, v6
  v_sub_f32 v17, 0, v6
  v_sub_f32 v18, 0, v6
  v_sub_f32 v19, 0, v6
  v_sub_f32 v20, 0, v8
  v_sub_f32 v21, 0, v8
  v_sub_f32 v22, 0, v8
  v_sub_f32 v23, 0, v8
  v_sub_f32 v24, 0, v10
  v_sub_f32 v25, 0, v10
  v_sub_f32 v26, 0, v10
  v_sub_f32 v27, 0, v10
  v_sub_f32 v28, 0, v12
  v_sub_f32 v29, 0, v12
  v_sub_f32 v30, 0, v12
  v_sub_f32 v31, 0, v12
  v_pk_add_f32 v[64:65], v[64:65], v[16:17]
  v_pk_add_f32 v[66:67], v[66:67], v[16:17]
  v_pk_add_f32 v[68:69], v[68:69], v[16:17]
  v_pk_add_f32 v[70:71], v[70:71], v[16:17]
  v_pk_add_f32 v[72:73], v[72:73], v[20:21]
  v_pk_add_f32 v[74:75], v[74:75], v[20:21]
  v_pk_add_f32 v[76:77], v[76:77], v[20:21]
  v_pk_add_f32 v[78:79], v[78:79], v[20:21]
  v_pk_add_f32 v[80:81], v[80:81], v[24:25]
  v_pk_add_f32 v[82:83], v[82:83], v[24:25]
  v_pk_add_f32 v[84:85], v[84:85], v[24:25]
  v_pk_add_f32 v[86:87], v[86:87], v[24:25]
  v_pk_add_f32 v[88:89], v[88:89], v[28:29]
  v_pk_add_f32 v[90:91], v[90:91], v[28:29]
  v_pk_add_f32 v[92:93], v[92:93], v[28:29]
  v_pk_add_f32 v[94:95], v[94:95], v[28:29]
  s_lshl_b32 s88, s25, 1
  s_waitcnt vmcnt(0)
  s_barrier
  s_waitcnt lgkmcnt(4)
  v_mfma_f32_16x16x32_bf16 v[96:99], a[0:3], a[128:131], v[16:19]
  s_mov_b32 m0, s26
  v_exp_f32 v64, v64
  v_mfma_f32_16x16x32_bf16 v[96:99], a[4:7], a[132:135], v[96:99]
  buffer_load_dwordx4 v2, s[20:23], s28 offen offset:0 sc1 lds
  v_exp_f32 v65, v65
  v_mfma_f32_16x16x32_bf16 v[96:99], a[8:11], a[136:139], v[96:99]
  buffer_load_dwordx4 v2, s[20:23], s28 offen offset:1024 sc1 lds
  v_exp_f32 v66, v66
  v_mfma_f32_16x16x32_bf16 v[96:99], a[12:15], a[140:143], v[96:99]
  buffer_load_dwordx4 v2, s[20:23], s28 offen offset:2048 sc1 lds
  v_exp_f32 v67, v67
  v_mfma_f32_16x16x32_bf16 v[104:107], a[0:3], a[144:147], v[20:23]
  v_exp_f32 v68, v68
  v_cvt_pk_bf16_f32 v32, v64, v65
  v_mfma_f32_16x16x32_bf16 v[104:107], a[4:7], a[148:151], v[104:107]
  buffer_load_dwordx4 v2, s[20:23], s28 offen offset:3072 sc1 lds
  v_exp_f32 v69, v69
  v_mfma_f32_16x16x32_bf16 v[104:107], a[8:11], a[152:155], v[104:107]
  s_xor_b32 s26, s26, 0x4000
  v_exp_f32 v70, v70
  v_cvt_pk_bf16_f32 v33, v66, v67
  v_mfma_f32_16x16x32_bf16 v[104:107], a[12:15], a[156:159], v[104:107]
  s_add_u32 s28, s28, 0x8000
  v_exp_f32 v71, v71
  v_cvt_pk_bf16_f32 v34, v68, v69
  v_mfma_f32_16x16x32_bf16 v[112:115], a[0:3], a[160:163], v[24:27]
  s_mov_b32 m0, s27
  v_exp_f32 v72, v72
  v_cvt_pk_bf16_f32 v35, v70, v71
  v_mfma_f32_16x16x32_bf16 v[112:115], a[4:7], a[164:167], v[112:115]
  buffer_load_dwordx4 v2, s[20:23], s29 offen offset:0 sc1 lds
  v_exp_f32 v73, v73
  v_mfma_f32_16x16x32_bf16 v[112:115], a[8:11], a[168:171], v[112:115]
  buffer_load_dwordx4 v2, s[20:23], s29 offen offset:1024 sc1 lds
  v_exp_f32 v74, v74
  v_mfma_f32_16x16x32_bf16 v[112:115], a[12:15], a[172:175], v[112:115]
  buffer_load_dwordx4 v2, s[20:23], s29 offen offset:2048 sc1 lds
  v_exp_f32 v75, v75
  v_mfma_f32_16x16x32_bf16 v[120:123], a[0:3], a[176:179], v[28:31]
  buffer_load_dwordx4 v2, s[20:23], s29 offen offset:3072 sc1 lds
  v_exp_f32 v76, v76
  v_mfma_f32_16x16x32_bf16 v[120:123], a[4:7], a[180:183], v[120:123]
  s_xor_b32 s27, s27, 0x8000
  v_exp_f32 v77, v77
  v_cvt_pk_bf16_f32 v36, v72, v73
  v_mfma_f32_16x16x32_bf16 v[120:123], a[8:11], a[184:187], v[120:123]
  s_add_u32 s29, s29, 0x8000
  v_exp_f32 v78, v78
  v_cvt_pk_bf16_f32 v37, v74, v75
  v_mfma_f32_16x16x32_bf16 v[120:123], a[12:15], a[188:191], v[120:123]
  s_waitcnt lgkmcnt(0)
  v_exp_f32 v79, v79
  v_cvt_pk_bf16_f32 v38, v76, v77
  v_mfma_f32_16x16x32_bf16 v[100:103], a[16:19], a[128:131], v[16:19]
  s_mov_b32 m0, s26
  v_exp_f32 v80, v80
  v_cvt_pk_bf16_f32 v39, v78, v79
  v_mfma_f32_16x16x32_bf16 v[100:103], a[20:23], a[132:135], v[100:103]
  buffer_load_dwordx4 v2, s[20:23], s28 offen offset:0 sc1 lds
  v_exp_f32 v81, v81
  v_mfma_f32_16x16x32_bf16 v[100:103], a[24:27], a[136:139], v[100:103]
  buffer_load_dwordx4 v2, s[20:23], s28 offen offset:1024 sc1 lds
  v_exp_f32 v82, v82
  v_cvt_pk_bf16_f32 v40, v80, v81
  v_mfma_f32_16x16x32_bf16 v[100:103], a[28:31], a[140:143], v[100:103]
  buffer_load_dwordx4 v2, s[20:23], s28 offen offset:2048 sc1 lds
  v_exp_f32 v83, v83
  v_mfma_f32_16x16x32_bf16 v[108:111], a[16:19], a[144:147], v[20:23]
  buffer_load_dwordx4 v2, s[20:23], s28 offen offset:3072 sc1 lds
  v_exp_f32 v84, v84
  v_cvt_pk_bf16_f32 v41, v82, v83
  v_mfma_f32_16x16x32_bf16 v[108:111], a[20:23], a[148:151], v[108:111]
  s_xor_b32 s26, s26, 0x8000
  v_exp_f32 v85, v85
  v_xor_b32 v3, 0x4000, v3
  v_mfma_f32_16x16x32_bf16 v[108:111], a[24:27], a[152:155], v[108:111]
  s_add_u32 s28, s28, 0x8000
  ds_read_b128 a[32:35], v3 offset:0
  v_exp_f32 v86, v86
  v_cvt_pk_bf16_f32 v42, v84, v85
  v_mfma_f32_16x16x32_bf16 v[108:111], a[28:31], a[156:159], v[108:111]
  s_mov_b32 m0, s27
  ds_read_b128 a[36:39], v3 offset:1024
  v_exp_f32 v87, v87
  v_mfma_f32_16x16x32_bf16 v[116:119], a[16:19], a[160:163], v[24:27]
  buffer_load_dwordx4 v2, s[20:23], s29 offen offset:0 sc1 lds
  v_exp_f32 v88, v88
  v_cvt_pk_bf16_f32 v43, v86, v87
  v_mfma_f32_16x16x32_bf16 v[116:119], a[20:23], a[164:167], v[116:119]
  buffer_load_dwordx4 v2, s[20:23], s29 offen offset:1024 sc1 lds
  v_exp_f32 v89, v89
  v_mfma_f32_16x16x32_bf16 v[116:119], a[24:27], a[168:171], v[116:119]
  buffer_load_dwordx4 v2, s[20:23], s29 offen offset:2048 sc1 lds
  v_exp_f32 v90, v90
  v_cvt_pk_bf16_f32 v44, v88, v89
  v_mfma_f32_16x16x32_bf16 v[116:119], a[28:31], a[172:175], v[116:119]
  buffer_load_dwordx4 v2, s[20:23], s29 offen offset:3072 sc1 lds
  v_exp_f32 v91, v91
  v_mfma_f32_16x16x32_bf16 v[124:127], a[16:19], a[176:179], v[28:31]
  s_xor_b32 s27, s27, 0x4000
  ds_read_b128 a[40:43], v3 offset:2048
  v_exp_f32 v92, v92
  v_cvt_pk_bf16_f32 v45, v90, v91
  v_mfma_f32_16x16x32_bf16 v[124:127], a[20:23], a[180:183], v[124:127]
  s_add_u32 s29, s29, 0x8000
  ds_read_b128 a[44:47], v3 offset:3072
  v_exp_f32 v93, v93
  v_mfma_f32_16x16x32_bf16 v[124:127], a[24:27], a[184:187], v[124:127]
  ds_read_b128 a[48:51], v3 offset:4096
  v_exp_f32 v94, v94
  v_cvt_pk_bf16_f32 v46, v92, v93
  v_mfma_f32_16x16x32_bf16 v[124:127], a[28:31], a[188:191], v[124:127]
  ds_read_b128 a[52:55], v3 offset:5120
  ds_read_b128 a[56:59], v3 offset:6144
  ds_read_b128 a[60:63], v3 offset:7168
  ds_read_b128 a[0:3], v4 offset:0
  ds_read_b128 a[4:7], v4 offset:1024
  ds_read_b128 a[8:11], v4 offset:2048
  v_exp_f32 v95, v95
  s_nop 0
  v_cvt_pk_bf16_f32 v47, v94, v95
  s_cmp_eq_u32 s25, 0
  s_cbranch_scc1 La_d1
  .p2align 6
La_lo:
  s_waitcnt lgkmcnt(7)
  v_mfma_f32_16x16x32_bf16 v[64:67], a[32:35], a[128:131], v[16:19]
  v_exp_f32 v96, v96
  v_mfma_f32_16x16x32_bf16 v[64:67], a[36:39], a[132:135], v[64:67]
  buffer_store_dwordx4 a[244:247], v2, s[64:67], s90 offen offset:0 sc1
  ds_read_b128 a[12:15], v4 offset:3072
  v_mfma_f32_16x16x32_bf16 v[64:67], a[40:43], a[136:139], v[64:67]
  v_exp_f32 v97, v97
  v_mfma_f32_16x16x32_bf16 v[64:67], a[44:47], a[140:143], v[64:67]
  v_cvt_pk_bf16_f32 v48, v96, v97
  v_mfma_f32_16x16x32_bf16 v[72:75], a[32:35], a[144:147], v[20:23]
  v_exp_f32 v98, v98
  v_mfma_f32_16x16x32_bf16 v[72:75], a[36:39], a[148:151], v[72:75]
  ds_read_b128 a[16:19], v4 offset:4096
  v_mfma_f32_16x16x32_bf16 v[72:75], a[40:43], a[152:155], v[72:75]
  v_exp_f32 v99, v99
  v_mfma_f32_16x16x32_bf16 v[72:75], a[44:47], a[156:159], v[72:75]
  v_cvt_pk_bf16_f32 v49, v98, v99
  v_mfma_f32_16x16x32_bf16 v[80:83], a[32:35], a[160:163], v[24:27]
  v_exp_f32 v100, v100
  v_mfma_f32_16x16x32_bf16 v[80:83], a[36:39], a[164:167], v[80:83]
  ds_read_b128 a[20:23], v4 offset:5120
  v_mfma_f32_16x16x32_bf16 v[80:83], a[40:43], a[168:171], v[80:83]
  v_exp_f32 v101, v101
  v_mfma_f32_16x16x32_bf16 v[80:83], a[44:47], a[172:175], v[80:83]
  v_cvt_pk_bf16_f32 v50, v100, v101
  v_mfma_f32_16x16x32_bf16 v[88:91], a[32:35], a[176:179], v[28:31]
  v_exp_f32 v102, v102
  v_mfma_f32_16x16x32_bf16 v[88:91], a[36:39], a[180:183], v[88:91]
  ds_read_b128 a[24:27], v4 offset:6144
  v_mfma_f32_16x16x32_bf16 v[88:91], a[40:43], a[184:187], v[88:91]
  v_exp_f32 v103, v103
  v_mfma_f32_16x16x32_bf16 v[88:91], a[44:47], a[188:191], v[88:91]
  s_waitcnt lgkmcnt(7)
  v_cvt_pk_bf16_f32 v51, v102, v103
  v_mfma_f32_16x16x32_bf16 v[68:71], a[48:51], a[128:131], v[16:19]
  v_exp_f32 v104, v104
  v_mfma_f32_16x16x32_bf16 v[68:71], a[52:55], a[132:135], v[68:71]
  ds_read_b128 a[28:31], v4 offset:7168
  v_mfma_f32_16x16x32_bf16 v[68:71], a[56:59], a[136:139], v[68:71]
  v_exp_f32 v105, v105
  v_mfma_f32_16x16x32_bf16 v[68:71], a[60:63], a[140:143], v[68:71]
  v_cvt_pk_bf16_f32 v52, v104, v105
  v_mfma_f32_16x16x32_bf16 v[76:79], a[48:51], a[144:147], v[20:23]
  v_exp_f32 v106, v106
  v_mfma_f32_16x16x32_bf16 v[76:79], a[52:55], a[148:151], v[76:79]
  ds_read_b128 a[32:35], v3 offset:8192
  v_mfma_f32_16x16x32_bf16 v[76:79], a[56:59], a[152:155], v[76:79]
  v_exp_f32 v107, v107
  v_mfma_f32_16x16x32_bf16 v[76:79], a[60:63], a[156:159], v[76:79]
  v_cvt_pk_bf16_f32 v53, v106, v107
  v_mfma_f32_16x16x32_bf16 v[84:87], a[48:51], a[160:163], v[24:27]
  v_exp_f32 v108, v108
  v_mfma_f32_16x16x32_bf16 v[84:87], a[52:55], a[164:167], v[84:87]
  ds_read_b128 a[36:39], v3 offset:9216
  v_mfma_f32_16x16x32_bf16 v[84:87], a[56:59], a[168:171], v[84:87]
  v_exp_f32 v109, v109
  v_mfma_f32_16x16x32_bf16 v[84:87], a[60:63], a[172:175], v[84:87]
  v_cvt_pk_bf16_f32 v54, v108, v109
  v_mfma_f32_16x16x32_bf16 v[92:95], a[48:51], a[176:179], v[28:31]
  v_exp_f32 v110, v110
  v_mfma_f32_16x16x32_bf16 v[92:95], a[52:55], a[180:183], v[92:95]
  ds_read_b128 a[40:43], v3 offset:10240
  v_mfma_f32_16x16x32_bf16 v[92:95], a[56:59], a[184:187], v[92:95]
  v_exp_f32 v111, v111
  v_mfma_f32_16x16x32_bf16 v[92:95], a[60:63], a[188:191], v[92:95]
  s_waitcnt lgkmcnt(7)
  v_cvt_pk_bf16_f32 v55, v110, v111
  v_mfma_f32_16x16x32_bf16 v[128:131], a[0:3], v[32:35], v[128:131]
  buffer_store_dwordx4 a[244:247], v2, s[64:67], s90 offen offset:1024 sc1
  ds_read_b128 a[44:47], v3 offset:11264
  v_mfma_f32_16x16x32_bf16 v[160:163], a[0:3], v[36:39], v[160:163]
  s_add_u32 s90, s90, 2048
  v_exp_f32 v112, v112
  v_mfma_f32_16x16x32_bf16 v[192:195], a[0:3], v[40:43], v[192:195]
  s_sub_u32 s88, s88, 1
  v_mfma_f32_16x16x32_bf16 v[224:227], a[0:3], v[44:47], v[224:227]
  v_exp_f32 v113, v113
  v_mfma_f32_16x16x32_bf16 a[192:195], a[208:211], v[32:35], a[192:195]
  v_cvt_pk_bf16_f32 v56, v112, v113
  v_mfma_f32_16x16x32_bf16 v[132:135], a[4:7], v[32:35], v[132:135]
  v_exp_f32 v114, v114
  v_mfma_f32_16x16x32_bf16 v[164:167], a[4:7], v[36:39], v[164:167]
  ds_read_b128 a[48:51], v3 offset:12288
  v_mfma_f32_16x16x32_bf16 v[196:199], a[4:7], v[40:43], v[196:199]
  v_exp_f32 v115, v115
  v_mfma_f32_16x16x32_bf16 v[228:231], a[4:7], v[44:47], v[228:231]
  v_cvt_pk_bf16_f32 v57, v114, v115
  v_mfma_f32_16x16x32_bf16 a[196:199], a[208:211], v[36:39], a[196:199]
  v_exp_f32 v116, v116
  v_mfma_f32_16x16x32_bf16 v[136:139], a[8:11], v[32:35], v[136:139]
  ds_read_b128 a[52:55], v3 offset:13312
  v_mfma_f32_16x16x32_bf16 v[168:171], a[8:11], v[36:39], v[168:171]
  v_exp_f32 v117, v117
  v_mfma_f32_16x16x32_bf16 v[200:203], a[8:11], v[40:43], v[200:203]
  v_cvt_pk_bf16_f32 v58, v116, v117
  v_mfma_f32_16x16x32_bf16 v[232:235], a[8:11], v[44:47], v[232:235]
  v_exp_f32 v118, v118
  v_mfma_f32_16x16x32_bf16 a[200:203], a[208:211], v[40:43], a[200:203]
  v_mfma_f32_16x16x32_bf16 v[140:143], a[12:15], v[32:35], v[140:143]
  v_exp_f32 v119, v119
  v_mfma_f32_16x16x32_bf16 v[172:175], a[12:15], v[36:39], v[172:175]
  ds_read_b128 a[56:59], v3 offset:14336
  v_cvt_pk_bf16_f32 v59, v118, v119
  v_mfma_f32_16x16x32_bf16 v[204:207], a[12:15], v[40:43], v[204:207]
  v_exp_f32 v120, v120
  v_mfma_f32_16x16x32_bf16 v[236:239], a[12:15], v[44:47], v[236:239]
  v_mfma_f32_16x16x32_bf16 a[204:207], a[208:211], v[44:47], a[204:207]
  s_waitcnt lgkmcnt(7)
  v_exp_f32 v121, v121
  v_mfma_f32_16x16x32_bf16 v[144:147], a[16:19], v[32:35], v[144:147]
  ds_read_b128 a[60:63], v3 offset:15360
  v_cvt_pk_bf16_f32 v60, v120, v121
  v_mfma_f32_16x16x32_bf16 v[176:179], a[16:19], v[36:39], v[176:179]
  v_exp_f32 v122, v122
  v_mfma_f32_16x16x32_bf16 v[208:211], a[16:19], v[40:43], v[208:211]
  v_mfma_f32_16x16x32_bf16 v[240:243], a[16:19], v[44:47], v[240:243]
  v_exp_f32 v123, v123
  v_mfma_f32_16x16x32_bf16 v[148:151], a[20:23], v[32:35], v[148:151]
  ds_read_b128 a[0:3], v4 offset:8192
  v_cvt_pk_bf16_f32 v61, v122, v123
  v_mfma_f32_16x16x32_bf16 v[180:183], a[20:23], v[36:39], v[180:183]
  v_exp_f32 v124, v124
  v_mfma_f32_16x16x32_bf16 v[212:215], a[20:23], v[40:43], v[212:215]
  v_mfma_f32_16x16x32_bf16 v[244:247], a[20:23], v[44:47], v[244:247]
  v_exp_f32 v125, v125
  v_mfma_f32_16x16x32_bf16 v[152:155], a[24:27], v[32:35], v[152:155]
  ds_read_b128 a[4:7], v4 offset:9216
  v_cvt_pk_bf16_f32 v62, v124, v125
  v_mfma_f32_16x16x32_bf16 v[184:187], a[24:27], v[36:39], v[184:187]
  v_exp_f32 v126, v126
  v_mfma_f32_16x16x32_bf16 v[216:219], a[24:27], v[40:43], v[216:219]
  v_mfma_f32_16x16x32_bf16 v[248:251], a[24:27], v[44:47], v[248:251]
  v_exp_f32 v127, v127
  v_mfma_f32_16x16x32_bf16 v[156:159], a[28:31], v[32:35], v[156:159]
  ds_read_b128 a[8:11], v4 offset:10240
  v_cvt_pk_bf16_f32 v63, v126, v127
  v_mfma_f32_16x16x32_bf16 v[188:191], a[28:31], v[36:39], v[188:191]
  v_mfma_f32_16x16x32_bf16 v[220:223], a[28:31], v[40:43], v[220:223]
  s_waitcnt vmcnt(10)
  s_barrier
  v_mfma_f32_16x16x32_bf16 v[252:255], a[28:31], v[44:47], v[252:255]
  s_cmp_eq_u32 s88, 0
  s_cbranch_scc1 La_d0
  s_waitcnt lgkmcnt(7)
  v_mfma_f32_16x16x32_bf16 v[96:99], a[32:35], a[128:131], v[16:19]
  s_mov_b32 m0, s26
  v_exp_f32 v64, v64
  v_mfma_f32_16x16x32_bf16 v[96:99], a[36:39], a[132:135], v[96:99]
  buffer_load_dwordx4 v2, s[20:23], s28 offen offset:0 sc1 lds
  ds_read_b128 a[12:15], v4 offset:11264
  v_mfma_f32_16x16x32_bf16 v[96:99], a[40:43], a[136:139], v[96:99]
  v_exp_f32 v65, v65
  v_mfma_f32_16x16x32_bf16 v[96:99], a[44:47], a[140:143], v[96:99]
  v_cvt_pk_bf16_f32 v32, v64, v65
  v_mfma_f32_16x16x32_bf16 v[104:107], a[32:35], a[144:147], v[20:23]
  v_exp_f32 v66, v66
  v_mfma_f32_16x16x32_bf16 v[104:107], a[36:39], a[148:151], v[104:107]
  ds_read_b128 a[16:19], v4 offset:12288
  v_mfma_f32_16x16x32_bf16 v[104:107], a[40:43], a[152:155], v[104:107]
  v_exp_f32 v67, v67
  v_mfma_f32_16x16x32_bf16 v[104:107], a[44:47], a[156:159], v[104:107]
  v_cvt_pk_bf16_f32 v33, v66, v67
  v_mfma_f32_16x16x32_bf16 v[112:115], a[32:35], a[160:163], v[24:27]
  v_exp_f32 v68, v68
  v_mfma_f32_16x16x32_bf16 v[112:115], a[36:39], a[164:167], v[112:115]
  buffer_load_dwordx4 v2, s[20:23], s28 offen offset:1024 sc1 lds
  ds_read_b128 a[20:23], v4 offset:13312
  v_mfma_f32_16x16x32_bf16 v[112:115], a[40:43], a[168:171], v[112:115]
  v_exp_f32 v69, v69
  v_mfma_f32_16x16x32_bf16 v[112:115], a[44:47], a[172:175], v[112:115]
  v_cvt_pk_bf16_f32 v34, v68, v69
  v_mfma_f32_16x16x32_bf16 v[120:123], a[32:35], a[176:179], v[28:31]
  v_exp_f32 v70, v70
  v_mfma_f32_16x16x32_bf16 v[120:123], a[36:39], a[180:183], v[120:123]
  ds_read_b128 a[24:27], v4 offset:14336
  v_mfma_f32_16x16x32_bf16 v[120:123], a[40:43], a[184:187], v[120:123]
  v_exp_f32 v71, v71
  v_mfma_f32_16x16x32_bf16 v[120:123], a[44:47], a[188:191], v[120:123]
  s_waitcnt lgkmcnt(7)
  v_cvt_pk_bf16_f32 v35, v70, v71
  v_mfma_f32_16x16x32_bf16 v[100:103], a[48:51], a[128:131], v[16:19]
  v_exp_f32 v72, v72
  v_mfma_f32_16x16x32_bf16 v[100:103], a[52:55], a[132:135], v[100:103]
  buffer_load_dwordx4 v2, s[20:23], s28 offen offset:2048 sc1 lds
  ds_read_b128 a[28:31], v4 offset:15360
  v_mfma_f32_16x16x32_bf16 v[100:103], a[56:59], a[136:139], v[100:103]
  v_exp_f32 v73, v73
  v_mfma_f32_16x16x32_bf16 v[100:103], a[60:63], a[140:143], v[100:103]
  v_xor_b32 v3, s30, v3
  v_cvt_pk_bf16_f32 v36, v72, v73
  v_mfma_f32_16x16x32_bf16 v[108:111], a[48:51], a[144:147], v[20:23]
  v_exp_f32 v74, v74
  v_mfma_f32_16x16x32_bf16 v[108:111], a[52:55], a[148:151], v[108:111]
  ds_read_b128 a[32:35], v3 offset:0
  v_mfma_f32_16x16x32_bf16 v[108:111], a[56:59], a[152:155], v[108:111]
  v_exp_f32 v75, v75
  v_mfma_f32_16x16x32_bf16 v[108:111], a[60:63], a[156:159], v[108:111]
  v_cvt_pk_bf16_f32 v37, v74, v75
  v_mfma_f32_16x16x32_bf16 v[116:119], a[48:51], a[160:163], v[24:27]
  v_exp_f32 v76, v76
  v_mfma_f32_16x16x32_bf16 v[116:119], a[52:55], a[164:167], v[116:119]
  buffer_load_dwordx4 v2, s[20:23], s28 offen offset:3072 sc1 lds
  ds_read_b128 a[36:39], v3 offset:1024
  v_mfma_f32_16x16x32_bf16 v[116:119], a[56:59], a[168:171], v[116:119]
  s_xor_b32 s26, s26, s31
  v_exp_f32 v77, v77
  v_mfma_f32_16x16x32_bf16 v[116:119], a[60:63], a[172:175], v[116:119]
  s_add_u32 s28, s28, 0x8000
  s_mov_b32 m0, s27
  v_cvt_pk_bf16_f32 v38, v76, v77
  v_mfma_f32_16x16x32_bf16 v[124:127], a[48:51], a[176:179], v[28:31]
  v_exp_f32 v78, v78
  v_mfma_f32_16x16x32_bf16 v[124:127], a[52:55], a[180:183], v[124:127]
  ds_read_b128 a[40:43], v3 offset:2048
  v_mfma_f32_16x16x32_bf16 v[124:127], a[56:59], a[184:187], v[124:127]
  v_exp_f32 v79, v79
  v_mfma_f32_16x16x32_bf16 v[124:127], a[60:63], a[188:191], v[124:127]
  s_waitcnt lgkmcnt(7)
  v_cvt_pk_bf16_f32 v39, v78, v79
  v_mfma_f32_16x16x32_bf16 v[128:131], a[0:3], v[48:51], v[128:131]
  buffer_load_dwordx4 v2, s[20:23], s29 offen offset:0 sc1 lds
  ds_read_b128 a[44:47], v3 offset:3072
  v_mfma_f32_16x16x32_bf16 v[160:163], a[0:3], v[52:55], v[160:163]
  v_exp_f32 v80, v80
  v_mfma_f32_16x16x32_bf16 v[192:195], a[0:3], v[56:59], v[192:195]
  v_mfma_f32_16x16x32_bf16 v[224:227], a[0:3], v[60:63], v[224:227]
  v_exp_f32 v81, v81
  v_mfma_f32_16x16x32_bf16 a[192:195], a[208:211], v[48:51], a[192:195]
  v_cvt_pk_bf16_f32 v40, v80, v81
  v_mfma_f32_16x16x32_bf16 v[132:135], a[4:7], v[48:51], v[132:135]
  v_exp_f32 v82, v82
  v_mfma_f32_16x16x32_bf16 v[164:167], a[4:7], v[52:55], v[164:167]
  ds_read_b128 a[48:51], v3 offset:4096
  v_mfma_f32_16x16x32_bf16 v[196:199], a[4:7], v[56:59], v[196:199]
  v_exp_f32 v83, v83
  v_mfma_f32_16x16x32_bf16 v[228:231], a[4:7], v[60:63], v[228:231]
  buffer_load_dwordx4 v2, s[20:23], s29 offen offset:1024 sc1 lds
  v_cvt_pk_bf16_f32 v41, v82, v83
  v_mfma_f32_16x16x32_bf16 a[196:199], a[208:211], v[52:55], a[196:199]
  v_exp_f32 v84, v84
  v_mfma_f32_16x16x32_bf16 v[136:139], a[8:11], v[48:51], v[136:139]
  ds_read_b128 a[52:55], v3 offset:5120
  v_mfma_f32_16x16x32_bf16 v[168:171], a[8:11], v[52:55], v[168:171]
  v_exp_f32 v85, v85
  v_mfma_f32_16x16x32_bf16 v[200:203], a[8:11], v[56:59], v[200:203]
  v_cvt_pk_bf16_f32 v42, v84, v85
  v_mfma_f32_16x16x32_bf16 v[232:235], a[8:11], v[60:63], v[232:235]
  v_exp_f32 v86, v86
  v_mfma_f32_16x16x32_bf16 a[200:203], a[208:211], v[56:59], a[200:203]
  v_mfma_f32_16x16x32_bf16 v[140:143], a[12:15], v[48:51], v[140:143]
  v_exp_f32 v87, v87
  v_mfma_f32_16x16x32_bf16 v[172:175], a[12:15], v[52:55], v[172:175]
  buffer_load_dwordx4 v2, s[20:23], s29 offen offset:2048 sc1 lds
  ds_read_b128 a[56:59], v3 offset:6144
  v_mfma_f32_16x16x32_bf16 v[204:207], a[12:15], v[56:59], v[204:207]
  v_exp_f32 v88, v88
  v_mfma_f32_16x16x32_bf16 v[236:239], a[12:15], v[60:63], v[236:239]
  v_cvt_pk_bf16_f32 v43, v86, v87
  v_mfma_f32_16x16x32_bf16 a[204:207], a[208:211], v[60:63], a[204:207]
  s_waitcnt lgkmcnt(7)
  v_exp_f32 v89, v89
  v_mfma_f32_16x16x32_bf16 v[144:147], a[16:19], v[48:51], v[144:147]
  ds_read_b128 a[60:63], v3 offset:7168
  v_cvt_pk_bf16_f32 v44, v88, v89
  v_mfma_f32_16x16x32_bf16 v[176:179], a[16:19], v[52:55], v[176:179]
  v_exp_f32 v90, v90
  v_mfma_f32_16x16x32_bf16 v[208:211], a[16:19], v[56:59], v[208:211]
  v_mfma_f32_16x16x32_bf16 v[240:243], a[16:19], v[60:63], v[240:243]
  v_exp_f32 v91, v91
  v_mfma_f32_16x16x32_bf16 v[148:151], a[20:23], v[48:51], v[148:151]
  buffer_load_dwordx4 v2, s[20:23], s29 offen offset:3072 sc1 lds
  v_xor_b32 v4, s31, v4
  v_mfma_f32_16x16x32_bf16 v[180:183], a[20:23], v[52:55], v[180:183]
  s_xor_b32 s27, s27, s30
  v_exp_f32 v92, v92
  v_mfma_f32_16x16x32_bf16 v[212:215], a[20:23], v[56:59], v[212:215]
  s_add_u32 s29, s29, 0x8000
  ds_read_b128 a[0:3], v4 offset:0
  v_cvt_pk_bf16_f32 v45, v90, v91
  v_mfma_f32_16x16x32_bf16 v[244:247], a[20:23], v[60:63], v[244:247]
  v_exp_f32 v93, v93
  v_mfma_f32_16x16x32_bf16 v[152:155], a[24:27], v[48:51], v[152:155]
  ds_read_b128 a[4:7], v4 offset:1024
  v_cvt_pk_bf16_f32 v46, v92, v93
  v_mfma_f32_16x16x32_bf16 v[184:187], a[24:27], v[52:55], v[184:187]
  v_exp_f32 v94, v94
  v_mfma_f32_16x16x32_bf16 v[216:219], a[24:27], v[56:59], v[216:219]
  v_mfma_f32_16x16x32_bf16 v[248:251], a[24:27], v[60:63], v[248:251]
  v_exp_f32 v95, v95
  v_mfma_f32_16x16x32_bf16 v[156:159], a[28:31], v[48:51], v[156:159]
  ds_read_b128 a[8:11], v4 offset:2048
  v_cvt_pk_bf16_f32 v47, v94, v95
  v_mfma_f32_16x16x32_bf16 v[188:191], a[28:31], v[52:55], v[188:191]
  v_mfma_f32_16x16x32_bf16 v[220:223], a[28:31], v[56:59], v[220:223]
  v_mfma_f32_16x16x32_bf16 v[252:255], a[28:31], v[60:63], v[252:255]
  s_xor_b32 s30, s30, 0xc000
  s_xor_b32 s31, s31, 0xc000
  s_branch La_lo
La_d0:
  s_waitcnt lgkmcnt(7)
  v_mfma_f32_16x16x32_bf16 v[96:99], a[32:35], a[128:131], v[16:19]
  s_mov_b32 m0, s26
  ds_read_b128 a[12:15], v4 offset:11264
  v_cndmask_b32 v64, v64, v5, s[32:33]
  v_mfma_f32_16x16x32_bf16 v[96:99], a[36:39], a[132:135], v[96:99]
  v_exp_f32 v64, v64
  v_mfma_f32_16x16x32_bf16 v[96:99], a[40:43], a[136:139], v[96:99]
  v_cndmask_b32 v65, v65, v5, s[34:35]
  v_exp_f32 v65, v65
  v_mfma_f32_16x16x32_bf16 v[96:99], a[44:47], a[140:143], v[96:99]
  buffer_load_dwordx4 v2, s[20:23], s28 offen offset:0 sc1 lds
  v_cndmask_b32 v66, v66, v5, s[36:37]
  v_mfma_f32_16x16x32_bf16 v[104:107], a[32:35], a[144:147], v[20:23]
  v_exp_f32 v66, v66
  v_mfma_f32_16x16x32_bf16 v[104:107], a[36:39], a[148:151], v[104:107]
  ds_read_b128 a[16:19], v4 offset:12288
  v_cndmask_b32 v67, v67, v5, s[38:39]
  v_mfma_f32_16x16x32_bf16 v[104:107], a[40:43], a[152:155], v[104:107]
  v_exp_f32 v67, v67
  v_mfma_f32_16x16x32_bf16 v[104:107], a[44:47], a[156:159], v[104:107]
  v_cndmask_b32 v68, v68, v5, s[40:41]
  v_cndmask_b32 v69, v69, v5, s[42:43]
  v_mfma_f32_16x16x32_bf16 v[112:115], a[32:35], a[160:163], v[24:27]
  v_exp_f32 v68, v68
  v_mfma_f32_16x16x32_bf16 v[112:115], a[36:39], a[164:167], v[112:115]
  buffer_load_dwordx4 v2, s[20:23], s28 offen offset:1024 sc1 lds
  ds_read_b128 a[20:23], v4 offset:13312
  v_mfma_f32_16x16x32_bf16 v[112:115], a[40:43], a[168:171], v[112:115]
  v_exp_f32 v69, v69
  v_mfma_f32_16x16x32_bf16 v[112:115], a[44:47], a[172:175], v[112:115]
  v_cndmask_b32 v70, v70, v5, s[44:45]
  v_cvt_pk_bf16_f32 v32, v64, v65
  v_mfma_f32_16x16x32_bf16 v[120:123], a[32:35], a[176:179], v[28:31]
  v_exp_f32 v70, v70
  v_mfma_f32_16x16x32_bf16 v[120:123], a[36:39], a[180:183], v[120:123]
  ds_read_b128 a[24:27], v4 offset:14336
  v_cndmask_b32 v71, v71, v5, s[46:47]
  v_mfma_f32_16x16x32_bf16 v[120:123], a[40:43], a[184:187], v[120:123]
  v_exp_f32 v71, v71
  v_mfma_f32_16x16x32_bf16 v[120:123], a[44:47], a[188:191], v[120:123]
  s_waitcnt lgkmcnt(7)
  v_cvt_pk_bf16_f32 v33, v66, v67
  v_cvt_pk_bf16_f32 v34, v68, v69
  v_mfma_f32_16x16x32_bf16 v[100:103], a[48:51], a[128:131], v[16:19]
  v_exp_f32 v72, v72
  v_mfma_f32_16x16x32_bf16 v[100:103], a[52:55], a[132:135], v[100:103]
  buffer_load_dwordx4 v2, s[20:23], s28 offen offset:2048 sc1 lds
  ds_read_b128 a[28:31], v4 offset:15360
  v_mfma_f32_16x16x32_bf16 v[100:103], a[56:59], a[136:139], v[100:103]
  v_exp_f32 v73, v73
  v_mfma_f32_16x16x32_bf16 v[100:103], a[60:63], a[140:143], v[100:103]
  v_xor_b32 v3, 0x4000, v3
  v_cvt_pk_bf16_f32 v35, v70, v71
  v_mfma_f32_16x16x32_bf16 v[108:111], a[48:51], a[144:147], v[20:23]
  v_exp_f32 v74, v74
  v_mfma_f32_16x16x32_bf16 v[108:111], a[52:55], a[148:151], v[108:111]
  ds_read_b128 a[32:35], v3 offset:0
  v_cvt_pk_bf16_f32 v36, v72, v73
  v_mfma_f32_16x16x32_bf16 v[108:111], a[56:59], a[152:155], v[108:111]
  v_exp_f32 v75, v75
  v_mfma_f32_16x16x32_bf16 v[108:111], a[60:63], a[156:159], v[108:111]
  v_cvt_pk_bf16_f32 v37, v74, v75
  v_mfma_f32_16x16x32_bf16 v[116:119], a[48:51], a[160:163], v[24:27]
  v_exp_f32 v76, v76
  v_mfma_f32_16x16x32_bf16 v[116:119], a[52:55], a[164:167], v[116:119]
  buffer_load_dwordx4 v2, s[20:23], s28 offen offset:3072 sc1 lds
  ds_read_b128 a[36:39], v3 offset:1024
  v_mfma_f32_16x16x32_bf16 v[116:119], a[56:59], a[168:171], v[116:119]
  s_xor_b32 s26, s26, 0x8000
  v_exp_f32 v77, v77
  v_mfma_f32_16x16x32_bf16 v[116:119], a[60:63], a[172:175], v[116:119]
  s_add_u32 s28, s28, 0x8000
  s_mov_b32 m0, s27
  v_cvt_pk_bf16_f32 v38, v76, v77
  v_mfma_f32_16x16x32_bf16 v[124:127], a[48:51], a[176:179], v[28:31]
  v_exp_f32 v78, v78
  v_mfma_f32_16x16x32_bf16 v[124:127], a[52:55], a[180:183], v[124:127]
  ds_read_b128 a[40:43], v3 offset:2048
  v_mfma_f32_16x16x32_bf16 v[124:127], a[56:59], a[184:187], v[124:127]
  v_exp_f32 v79, v79
  v_mfma_f32_16x16x32_bf16 v[124:127], a[60:63], a[188:191], v[124:127]
  s_waitcnt lgkmcnt(7)
  v_cvt_pk_bf16_f32 v39, v78, v79
  v_mfma_f32_16x16x32_bf16 v[128:131], a[0:3], v[48:51], v[128:131]
  buffer_load_dwordx4 v2, s[20:23], s29 offen offset:0 sc1 lds
  ds_read_b128 a[44:47], v3 offset:3072
  v_mfma_f32_16x16x32_bf16 v[160:163], a[0:3], v[52:55], v[160:163]
  v_exp_f32 v80, v80
  v_mfma_f32_16x16x32_bf16 v[192:195], a[0:3], v[56:59], v[192:195]
  v_mfma_f32_16x16x32_bf16 v[224:227], a[0:3], v[60:63], v[224:227]
  v_exp_f32 v81, v81
  v_mfma_f32_16x16x32_bf16 a[192:195], a[208:211], v[48:51], a[192:195]
  v_cvt_pk_bf16_f32 v40, v80, v81
  v_mfma_f32_16x16x32_bf16 v[132:135], a[4:7], v[48:51], v[132:135]
  v_exp_f32 v82, v82
  v_mfma_f32_16x16x32_bf16 v[164:167], a[4:7], v[52:55], v[164:167]
  ds_read_b128 a[48:51], v3 offset:4096
  v_mfma_f32_16x16x32_bf16 v[196:199], a[4:7], v[56:59], v[196:199]
  v_exp_f32 v83, v83
  v_mfma_f32_16x16x32_bf16 v[228:231], a[4:7], v[60:63], v[228:231]
  buffer_load_dwordx4 v2, s[20:23], s29 offen offset:1024 sc1 lds
  v_cvt_pk_bf16_f32 v41, v82, v83
  v_mfma_f32_16x16x32_bf16 a[196:199], a[208:211], v[52:55], a[196:199]
  v_exp_f32 v84, v84
  v_mfma_f32_16x16x32_bf16 v[136:139], a[8:11], v[48:51], v[136:139]
  ds_read_b128 a[52:55], v3 offset:5120
  v_mfma_f32_16x16x32_bf16 v[168:171], a[8:11], v[52:55], v[168:171]
  v_exp_f32 v85, v85
  v_mfma_f32_16x16x32_bf16 v[200:203], a[8:11], v[56:59], v[200:203]
  v_cvt_pk_bf16_f32 v42, v84, v85
  v_mfma_f32_16x16x32_bf16 v[232:235], a[8:11], v[60:63], v[232:235]
  v_exp_f32 v86, v86
  v_mfma_f32_16x16x32_bf16 a[200:203], a[208:211], v[56:59], a[200:203]
  v_mfma_f32_16x16x32_bf16 v[140:143], a[12:15], v[48:51], v[140:143]
  v_exp_f32 v87, v87
  v_mfma_f32_16x16x32_bf16 v[172:175], a[12:15], v[52:55], v[172:175]
  buffer_load_dwordx4 v2, s[20:23], s29 offen offset:2048 sc1 lds
  ds_read_b128 a[56:59], v3 offset:6144
  v_mfma_f32_16x16x32_bf16 v[204:207], a[12:15], v[56:59], v[204:207]
  v_exp_f32 v88, v88
  v_mfma_f32_16x16x32_bf16 v[236:239], a[12:15], v[60:63], v[236:239]
  v_cvt_pk_bf16_f32 v43, v86, v87
  v_mfma_f32_16x16x32_bf16 a[204:207], a[208:211], v[60:63], a[204:207]
  s_waitcnt lgkmcnt(7)
  v_exp_f32 v89, v89
  v_mfma_f32_16x16x32_bf16 v[144:147], a[16:19], v[48:51], v[144:147]
  ds_read_b128 a[60:63], v3 offset:7168
  v_cvt_pk_bf16_f32 v44, v88, v89
  v_mfma_f32_16x16x32_bf16 v[176:179], a[16:19], v[52:55], v[176:179]
  v_exp_f32 v90, v90
  v_mfma_f32_16x16x32_bf16 v[208:211], a[16:19], v[56:59], v[208:211]
  v_mfma_f32_16x16x32_bf16 v[240:243], a[16:19], v[60:63], v[240:243]
  v_exp_f32 v91, v91
  v_mfma_f32_16x16x32_bf16 v[148:151], a[20:23], v[48:51], v[148:151]
  buffer_load_dwordx4 v2, s[20:23], s29 offen offset:3072 sc1 lds
  v_xor_b32 v4, 0x8000, v4
  v_mfma_f32_16x16x32_bf16 v[180:183], a[20:23], v[52:55], v[180:183]
  s_xor_b32 s27, s27, 0x4000
  v_exp_f32 v92, v92
  v_mfma_f32_16x16x32_bf16 v[212:215], a[20:23], v[56:59], v[212:215]
  s_add_u32 s29, s29, 0x8000
  ds_read_b128 a[0:3], v4 offset:0
  v_cvt_pk_bf16_f32 v45, v90, v91
  v_mfma_f32_16x16x32_bf16 v[244:247], a[20:23], v[60:63], v[244:247]
  v_exp_f32 v93, v93
  v_mfma_f32_16x16x32_bf16 v[152:155], a[24:27], v[48:51], v[152:155]
  ds_read_b128 a[4:7], v4 offset:1024
  v_cvt_pk_bf16_f32 v46, v92, v93
  v_mfma_f32_16x16x32_bf16 v[184:187], a[24:27], v[52:55], v[184:187]
  v_exp_f32 v94, v94
  v_mfma_f32_16x16x32_bf16 v[216:219], a[24:27], v[56:59], v[216:219]
  v_mfma_f32_16x16x32_bf16 v[248:251], a[24:27], v[60:63], v[248:251]
  v_exp_f32 v95, v95
  v_mfma_f32_16x16x32_bf16 v[156:159], a[28:31], v[48:51], v[156:159]
  ds_read_b128 a[8:11], v4 offset:2048
  v_cvt_pk_bf16_f32 v47, v94, v95
  v_mfma_f32_16x16x32_bf16 v[188:191], a[28:31], v[52:55], v[188:191]
  v_mfma_f32_16x16x32_bf16 v[220:223], a[28:31], v[56:59], v[220:223]
  v_mfma_f32_16x16x32_bf16 v[252:255], a[28:31], v[60:63], v[252:255]
La_d1:
  s_waitcnt lgkmcnt(7)
  v_mfma_f32_16x16x32_bf16 v[72:75], a[32:35], a[144:147], v[20:23]
  buffer_load_dwordx4 a[64:67], v2, s[8:11], s6 offen offset:0
  ds_read_b128 a[12:15], v4 offset:3072
  v_mfma_f32_16x16x32_bf16 v[72:75], a[36:39], a[148:151], v[72:75]
  v_cndmask_b32 v96, v96, v5, s[48:49]
  v_exp_f32 v96, v96
  v_mfma_f32_16x16x32_bf16 v[72:75], a[40:43], a[152:155], v[72:75]
  v_cndmask_b32 v97, v97, v5, s[50:51]
  v_exp_f32 v97, v97
  v_mfma_f32_16x16x32_bf16 v[72:75], a[44:47], a[156:159], v[72:75]
  v_cndmask_b32 v98, v98, v5, s[52:53]
  v_exp_f32 v98, v98
  v_mfma_f32_16x16x32_bf16 v[80:83], a[32:35], a[160:163], v[24:27]
  ds_read_b128 a[16:19], v4 offset:4096
  v_cndmask_b32 v99, v99, v5, s[54:55]
  v_mfma_f32_16x16x32_bf16 v[80:83], a[36:39], a[164:167], v[80:83]
  v_exp_f32 v99, v99
  v_mfma_f32_16x16x32_bf16 v[80:83], a[40:43], a[168:171], v[80:83]
  buffer_load_dwordx4 a[64:67], v2, s[8:11], s6 offen offset:1024
  ds_read_b128 a[20:23], v4 offset:5120
  v_mfma_f32_16x16x32_bf16 v[80:83], a[44:47], a[172:175], v[80:83]
  v_cndmask_b32 v100, v100, v5, s[56:57]
  v_exp_f32 v100, v100
  v_mfma_f32_16x16x32_bf16 v[88:91], a[32:35], a[176:179], v[28:31]
  v_cndmask_b32 v101, v101, v5, s[58:59]
  v_cndmask_b32 v102, v102, v5, s[60:61]
  v_mfma_f32_16x16x32_bf16 v[88:91], a[36:39], a[180:183], v[88:91]
  v_exp_f32 v101, v101
  v_mfma_f32_16x16x32_bf16 v[88:91], a[40:43], a[184:187], v[88:91]
  v_exp_f32 v102, v102
  v_mfma_f32_16x16x32_bf16 v[88:91], a[44:47], a[188:191], v[88:91]
  s_waitcnt lgkmcnt(6)
  buffer_load_dwordx4 a[64:67], v2, s[8:11], s6 offen offset:2048
  ds_read_b128 a[24:27], v4 offset:6144
  v_mfma_f32_16x16x32_bf16 v[76:79], a[48:51], a[144:147], v[20:23]
  v_cndmask_b32 v103, v103, v5, s[62:63]
  v_exp_f32 v103, v103
  v_mfma_f32_16x16x32_bf16 v[76:79], a[52:55], a[148:151], v[76:79]
  ds_read_b128 a[28:31], v4 offset:7168
  v_cvt_pk_bf16_f32 v48, v96, v97
  v_mfma_f32_16x16x32_bf16 v[76:79], a[56:59], a[152:155], v[76:79]
  v_exp_f32 v104, v104
  v_mfma_f32_16x16x32_bf16 v[76:79], a[60:63], a[156:159], v[76:79]
  ds_read_b128 a[32:35], v3 offset:8192
  v_cvt_pk_bf16_f32 v49, v98, v99
  v_mfma_f32_16x16x32_bf16 v[84:87], a[48:51], a[160:163], v[24:27]
  v_exp_f32 v105, v105
  v_mfma_f32_16x16x32_bf16 v[84:87], a[52:55], a[164:167], v[84:87]
  buffer_load_dwordx4 a[64:67], v2, s[8:11], s6 offen offset:3072
  v_cvt_pk_bf16_f32 v50, v100, v101
  v_mfma_f32_16x16x32_bf16 v[84:87], a[56:59], a[168:171], v[84:87]
  s_add_u32 s6, s6, 4096
  v_exp_f32 v106, v106
  v_mfma_f32_16x16x32_bf16 v[84:87], a[60:63], a[172:175], v[84:87]
  v_exp_f32 v107, v107
  v_mfma_f32_16x16x32_bf16 v[92:95], a[48:51], a[176:179], v[28:31]
  ds_read_b128 a[36:39], v3 offset:9216
  v_cvt_pk_bf16_f32 v51, v102, v103
  v_mfma_f32_16x16x32_bf16 v[92:95], a[52:55], a[180:183], v[92:95]
  v_exp_f32 v108, v108
  v_mfma_f32_16x16x32_bf16 v[92:95], a[56:59], a[184:187], v[92:95]
  buffer_load_dwordx4 a[64:67], v2, s[8:11], s6 offen offset:0
  ds_read_b128 a[40:43], v3 offset:10240
  v_mfma_f32_16x16x32_bf16 v[92:95], a[60:63], a[188:191], v[92:95]
  s_waitcnt lgkmcnt(7)
  v_exp_f32 v109, v109
  v_mfma_f32_16x16x32_bf16 v[128:131], a[0:3], v[32:35], v[128:131]
  ds_read_b128 a[44:47], v3 offset:11264
  v_cvt_pk_bf16_f32 v52, v104, v105
  v_mfma_f32_16x16x32_bf16 v[160:163], a[0:3], v[36:39], v[160:163]
  v_exp_f32 v110, v110
  v_mfma_f32_16x16x32_bf16 v[192:195], a[0:3], v[40:43], v[192:195]
  v_cvt_pk_bf16_f32 v53, v106, v107
  v_cvt_pk_bf16_f32 v54, v108, v109
  v_mfma_f32_16x16x32_bf16 v[224:227], a[0:3], v[44:47], v[224:227]
  v_exp_f32 v111, v111
  v_mfma_f32_16x16x32_bf16 a[192:195], a[208:211], v[32:35], a[192:195]
  buffer_load_dwordx4 a[64:67], v2, s[8:11], s6 offen offset:1024
  v_cvt_pk_bf16_f32 v55, v110, v111
  v_mfma_f32_16x16x32_bf16 v[132:135], a[4:7], v[32:35], v[132:135]
  v_exp_f32 v112, v112
  v_mfma_f32_16x16x32_bf16 v[164:167], a[4:7], v[36:39], v[164:167]
  v_exp_f32 v113, v113
  v_mfma_f32_16x16x32_bf16 v[196:199], a[4:7], v[40:43], v[196:199]
  ds_read_b128 a[48:51], v3 offset:12288
  v_cvt_pk_bf16_f32 v56, v112, v113
  v_mfma_f32_16x16x32_bf16 v[228:231], a[4:7], v[44:47], v[228:231]
  v_exp_f32 v114, v114
  v_mfma_f32_16x16x32_bf16 a[196:199], a[208:211], v[36:39], a[196:199]
  buffer_load_dwordx4 a[64:67], v2, s[8:11], s6 offen offset:2048
  v_mfma_f32_16x16x32_bf16 v[136:139], a[8:11], v[32:35], v[136:139]
  v_exp_f32 v115, v115
  v_mfma_f32_16x16x32_bf16 v[168:171], a[8:11], v[36:39], v[168:171]
  ds_read_b128 a[52:55], v3 offset:13312
  v_cvt_pk_bf16_f32 v57, v114, v115
  v_mfma_f32_16x16x32_bf16 v[200:203], a[8:11], v[40:43], v[200:203]
  v_exp_f32 v116, v116
  v_mfma_f32_16x16x32_bf16 v[232:235], a[8:11], v[44:47], v[232:235]
  v_mfma_f32_16x16x32_bf16 a[200:203], a[208:211], v[40:43], a[200:203]
  v_exp_f32 v117, v117
  v_mfma_f32_16x16x32_bf16 v[140:143], a[12:15], v[32:35], v[140:143]
  v_exp_f32 v118, v118
  v_mfma_f32_16x16x32_bf16 v[172:175], a[12:15], v[36:39], v[172:175]
  buffer_load_dwordx4 a[64:67], v2, s[8:11], s6 offen offset:3072
  ds_read_b128 a[56:59], v3 offset:14336
  v_mfma_f32_16x16x32_bf16 v[204:207], a[12:15], v[40:43], v[204:207]
  v_exp_f32 v119, v119
  v_mfma_f32_16x16x32_bf16 v[236:239], a[12:15], v[44:47], v[236:239]
  v_cvt_pk_bf16_f32 v58, v116, v117
  v_cvt_pk_bf16_f32 v59, v118, v119
  v_mfma_f32_16x16x32_bf16 a[204:207], a[208:211], v[44:47], a[204:207]
  s_waitcnt lgkmcnt(7)
  v_exp_f32 v120, v120
  v_mfma_f32_16x16x32_bf16 v[144:147], a[16:19], v[32:35], v[144:147]
  buffer_load_dwordx4 a[64:67], v2, s[12:15], s7 offen offset:0
  ds_read_b128 a[60:63], v3 offset:15360
  v_mfma_f32_16x16x32_bf16 v[176:179], a[16:19], v[36:39], v[176:179]
  v_exp_f32 v121, v121
  v_mfma_f32_16x16x32_bf16 v[208:211], a[16:19], v[40:43], v[208:211]
  v_cvt_pk_bf16_f32 v60, v120, v121
  v_mfma_f32_16x16x32_bf16 v[240:243], a[16:19], v[44:47], v[240:243]
  v_exp_f32 v122, v122
  v_mfma_f32_16x16x32_bf16 v[148:151], a[20:23], v[32:35], v[148:151]
  v_exp_f32 v123, v123
  v_mfma_f32_16x16x32_bf16 v[180:183], a[20:23], v[36:39], v[180:183]
  ds_read_b128 a[0:3], v4 offset:8192
  v_cvt_pk_bf16_f32 v61, v122, v123
  v_mfma_f32_16x16x32_bf16 v[212:215], a[20:23], v[40:43], v[212:215]
  v_exp_f32 v124, v124
  v_mfma_f32_16x16x32_bf16 v[244:247], a[20:23], v[44:47], v[244:247]
  buffer_load_dwordx4 a[64:67], v2, s[12:15], s7 offen offset:1024
  v_mfma_f32_16x16x32_bf16 v[152:155], a[24:27], v[32:35], v[152:155]
  v_exp_f32 v125, v125
  v_mfma_f32_16x16x32_bf16 v[184:187], a[24:27], v[36:39], v[184:187]
  ds_read_b128 a[4:7], v4 offset:9216
  v_cvt_pk_bf16_f32 v62, v124, v125
  v_mfma_f32_16x16x32_bf16 v[216:219], a[24:27], v[40:43], v[216:219]
  v_exp_f32 v126, v126
  v_mfma_f32_16x16x32_bf16 v[248:251], a[24:27], v[44:47], v[248:251]
  v_mfma_f32_16x16x32_bf16 v[156:159], a[28:31], v[32:35], v[156:159]
  v_exp_f32 v127, v127
  v_mfma_f32_16x16x32_bf16 v[188:191], a[28:31], v[36:39], v[188:191]
  ds_read_b128 a[8:11], v4 offset:10240
  v_cvt_pk_bf16_f32 v63, v126, v127
  v_mfma_f32_16x16x32_bf16 v[220:223], a[28:31], v[40:43], v[220:223]
  s_waitcnt vmcnt(22)
  s_barrier
  v_mfma_f32_16x16x32_bf16 v[252:255], a[28:31], v[44:47], v[252:255]
  s_waitcnt lgkmcnt(7)
  v_mfma_f32_16x16x32_bf16 v[104:107], a[32:35], a[144:147], v[20:23]
  s_mov_b32 m0, s26
  ds_read_b128 a[12:15], v4 offset:11264
  v_cndmask_b32 v72, v72, v5, s[32:33]
  v_mfma_f32_16x16x32_bf16 v[104:107], a[36:39], a[148:151], v[104:107]
  v_exp_f32 v72, v72
  v_mfma_f32_16x16x32_bf16 v[104:107], a[40:43], a[152:155], v[104:107]
  v_cndmask_b32 v73, v73, v5, s[34:35]
  v_exp_f32 v73, v73
  v_mfma_f32_16x16x32_bf16 v[104:107], a[44:47], a[156:159], v[104:107]
  buffer_load_dwordx4 v2, s[20:23], s28 offen offset:0 sc1 lds
  ds_read_b128 a[16:19], v4 offset:12288
  v_mfma_f32_16x16x32_bf16 v[112:115], a[32:35], a[160:163], v[24:27]
  v_cndmask_b32 v74, v74, v5, s[36:37]
  v_exp_f32 v74, v74
  v_mfma_f32_16x16x32_bf16 v[112:115], a[36:39], a[164:167], v[112:115]
  v_cvt_pk_bf16_f32 v36, v72, v73
  v_mfma_f32_16x16x32_bf16 v[112:115], a[40:43], a[168:171], v[112:115]
  ds_read_b128 a[20:23], v4 offset:13312
  v_cndmask_b32 v75, v75, v5, s[38:39]
  v_mfma_f32_16x16x32_bf16 v[112:115], a[44:47], a[172:175], v[112:115]
  v_exp_f32 v75, v75
  v_mfma_f32_16x16x32_bf16 v[120:123], a[32:35], a[176:179], v[28:31]
  buffer_load_dwordx4 v2, s[20:23], s28 offen offset:1024 sc1 lds
  v_cndmask_b32 v76, v76, v5, s[40:41]
  v_mfma_f32_16x16x32_bf16 v[120:123], a[36:39], a[180:183], v[120:123]
  v_exp_f32 v76, v76
  v_mfma_f32_16x16x32_bf16 v[120:123], a[40:43], a[184:187], v[120:123]
  ds_read_b128 a[24:27], v4 offset:14336
  v_cndmask_b32 v79, v79, v5, s[46:47]
  v_mfma_f32_16x16x32_bf16 v[120:123], a[44:47], a[188:191], v[120:123]
  s_waitcnt lgkmcnt(7)
  v_cndmask_b32 v77, v77, v5, s[42:43]
  v_cndmask_b32 v78, v78, v5, s[44:45]
  v_mfma_f32_16x16x32_bf16 v[108:111], a[48:51], a[144:147], v[20:23]
  v_exp_f32 v77, v77
  v_mfma_f32_16x16x32_bf16 v[108:111], a[52:55], a[148:151], v[108:111]
  ds_read_b128 a[28:31], v4 offset:15360
  v_xor_b32 v4, 0x4000, v4
  v_mfma_f32_16x16x32_bf16 v[108:111], a[56:59], a[152:155], v[108:111]
  v_exp_f32 v78, v78
  v_mfma_f32_16x16x32_bf16 v[108:111], a[60:63], a[156:159], v[108:111]
  buffer_load_dwordx4 v2, s[20:23], s28 offen offset:2048 sc1 lds
  v_xor_b32 v3, 0x8000, v3
  v_mfma_f32_16x16x32_bf16 v[116:119], a[48:51], a[160:163], v[24:27]
  v_exp_f32 v79, v79
  v_mfma_f32_16x16x32_bf16 v[116:119], a[52:55], a[164:167], v[116:119]
  ds_read_b128 a[32:35], v3 offset:0
  v_cvt_pk_bf16_f32 v37, v74, v75
  v_mfma_f32_16x16x32_bf16 v[116:119], a[56:59], a[168:171], v[116:119]
  ds_read_b128 a[36:39], v3 offset:1024
  v_cvt_pk_bf16_f32 v38, v76, v77
  v_mfma_f32_16x16x32_bf16 v[116:119], a[60:63], a[172:175], v[116:119]
  v_exp_f32 v80, v80
  v_mfma_f32_16x16x32_bf16 v[124:127], a[48:51], a[176:179], v[28:31]
  v_cvt_pk_bf16_f32 v39, v78, v79
  v_mfma_f32_16x16x32_bf16 v[124:127], a[52:55], a[180:183], v[124:127]
  v_exp_f32 v81, v81
  v_mfma_f32_16x16x32_bf16 v[124:127], a[56:59], a[184:187], v[124:127]
  buffer_load_dwordx4 v2, s[20:23], s28 offen offset:3072 sc1 lds
  ds_read_b128 a[40:43], v3 offset:2048
  v_mfma_f32_16x16x32_bf16 v[124:127], a[60:63], a[188:191], v[124:127]
  s_waitcnt lgkmcnt(7)
  s_xor_b32 s26, s26, 0x4000
  s_add_u32 s28, s28, 0x8000
  v_mfma_f32_16x16x32_bf16 v[128:131], a[0:3], v[48:51], v[128:131]
  s_mov_b32 m0, s27
  v_exp_f32 v82, v82
  v_mfma_f32_16x16x32_bf16 v[160:163], a[0:3], v[52:55], v[160:163]
  ds_read_b128 a[44:47], v3 offset:3072
  v_cvt_pk_bf16_f32 v40, v80, v81
  v_mfma_f32_16x16x32_bf16 v[192:195], a[0:3], v[56:59], v[192:195]
  v_exp_f32 v83, v83
  v_mfma_f32_16x16x32_bf16 v[224:227], a[0:3], v[60:63], v[224:227]
  v_cvt_pk_bf16_f32 v41, v82, v83
  v_mfma_f32_16x16x32_bf16 a[192:195], a[208:211], v[48:51], a[192:195]
  buffer_load_dwordx4 v2, s[20:23], s29 offen offset:0 sc1 lds
  v_mfma_f32_16x16x32_bf16 v[132:135], a[4:7], v[48:51], v[132:135]
  v_exp_f32 v84, v84
  v_mfma_f32_16x16x32_bf16 v[164:167], a[4:7], v[52:55], v[164:167]
  ds_read_b128 a[48:51], v3 offset:4096
  v_mfma_f32_16x16x32_bf16 v[196:199], a[4:7], v[56:59], v[196:199]
  v_exp_f32 v85, v85
  v_mfma_f32_16x16x32_bf16 v[228:231], a[4:7], v[60:63], v[228:231]
  v_cvt_pk_bf16_f32 v42, v84, v85
  v_mfma_f32_16x16x32_bf16 a[196:199], a[208:211], v[52:55], a[196:199]
  v_exp_f32 v86, v86
  v_mfma_f32_16x16x32_bf16 v[136:139], a[8:11], v[48:51], v[136:139]
  ds_read_b128 a[52:55], v3 offset:5120
  v_mfma_f32_16x16x32_bf16 v[168:171], a[8:11], v[52:55], v[168:171]
  buffer_load_dwordx4 v2, s[20:23], s29 offen offset:1024 sc1 lds
  v_mfma_f32_16x16x32_bf16 v[200:203], a[8:11], v[56:59], v[200:203]
  v_exp_f32 v87, v87
  v_mfma_f32_16x16x32_bf16 v[232:235], a[8:11], v[60:63], v[232:235]
  v_cvt_pk_bf16_f32 v43, v86, v87
  v_mfma_f32_16x16x32_bf16 a[200:203], a[208:211], v[56:59], a[200:203]
  v_exp_f32 v88, v88
  v_mfma_f32_16x16x32_bf16 v[140:143], a[12:15], v[48:51], v[140:143]
  ds_read_b128 a[56:59], v3 offset:6144
  v_mfma_f32_16x16x32_bf16 v[172:175], a[12:15], v[52:55], v[172:175]
  v_mfma_f32_16x16x32_bf16 v[204:207], a[12:15], v[56:59], v[204:207]
  v_exp_f32 v89, v89
  v_mfma_f32_16x16x32_bf16 v[236:239], a[12:15], v[60:63], v[236:239]
  buffer_load_dwordx4 v2, s[20:23], s29 offen offset:2048 sc1 lds
  v_cvt_pk_bf16_f32 v44, v88, v89
  v_mfma_f32_16x16x32_bf16 a[204:207], a[208:211], v[60:63], a[204:207]
  s_waitcnt lgkmcnt(7)
  v_exp_f32 v90, v90
  v_mfma_f32_16x16x32_bf16 v[144:147], a[16:19], v[48:51], v[144:147]
  ds_read_b128 a[60:63], v3 offset:7168
  v_mfma_f32_16x16x32_bf16 v[176:179], a[16:19], v[52:55], v[176:179]
  v_exp_f32 v91, v91
  v_mfma_f32_16x16x32_bf16 v[208:211], a[16:19], v[56:59], v[208:211]
  v_cvt_pk_bf16_f32 v45, v90, v91
  v_mfma_f32_16x16x32_bf16 v[240:243], a[16:19], v[60:63], v[240:243]
  v_mfma_f32_16x16x32_bf16 v[148:151], a[20:23], v[48:51], v[148:151]
  v_exp_f32 v92, v92
  v_mfma_f32_16x16x32_bf16 v[180:183], a[20:23], v[52:55], v[180:183]
  buffer_load_dwordx4 v2, s[20:23], s29 offen offset:3072 sc1 lds
  ds_read_b128 a[0:3], v3 offset:8192
  v_mfma_f32_16x16x32_bf16 v[212:215], a[20:23], v[56:59], v[212:215]
  s_xor_b32 s27, s27, 0x8000
  v_exp_f32 v93, v93
  v_mfma_f32_16x16x32_bf16 v[244:247], a[20:23], v[60:63], v[244:247]
  s_add_u32 s29, s29, 0x8000
  v_cvt_pk_bf16_f32 v46, v92, v93
  v_mfma_f32_16x16x32_bf16 v[152:155], a[24:27], v[48:51], v[152:155]
  ds_read_b128 a[4:7], v3 offset:9216
  v_mfma_f32_16x16x32_bf16 v[184:187], a[24:27], v[52:55], v[184:187]
  v_exp_f32 v94, v94
  v_mfma_f32_16x16x32_bf16 v[216:219], a[24:27], v[56:59], v[216:219]
  v_mfma_f32_16x16x32_bf16 v[248:251], a[24:27], v[60:63], v[248:251]
  v_exp_f32 v95, v95
  v_mfma_f32_16x16x32_bf16 v[156:159], a[28:31], v[48:51], v[156:159]
  ds_read_b128 a[8:11], v3 offset:10240
  v_cvt_pk_bf16_f32 v47, v94, v95
  v_mfma_f32_16x16x32_bf16 v[188:191], a[28:31], v[52:55], v[188:191]
  v_mfma_f32_16x16x32_bf16 v[220:223], a[28:31], v[56:59], v[220:223]
  s_waitcnt vmcnt(22)
  s_barrier
  v_mfma_f32_16x16x32_bf16 v[252:255], a[28:31], v[60:63], v[252:255]
  s_lshr_b32 s91, s73, 1
  s_lshl_b32 s91, s91, 11
  s_add_u32 s91, s91, 32768
  v_and_b32 v14, 15, v1
  v_lshlrev_b32 v14, 7, v14
  s_waitcnt lgkmcnt(3)
  v_mfma_f32_16x16x32_bf16 v[64:67], a[32:35], a[160:163], v[24:27]
  s_mov_b32 m0, s26
  ds_read_b128 a[12:15], v3 offset:11264
  v_cndmask_b32 v104, v104, v5, s[48:49]
  v_mfma_f32_16x16x32_bf16 v[64:67], a[36:39], a[164:167], v[64:67]
  v_exp_f32 v104, v104
  v_mfma_f32_16x16x32_bf16 v[64:67], a[40:43], a[168:171], v[64:67]
  v_cndmask_b32 v105, v105, v5, s[50:51]
  v_exp_f32 v105, v105
  v_mfma_f32_16x16x32_bf16 v[64:67], a[44:47], a[172:175], v[64:67]
  buffer_load_dwordx4 v2, s[20:23], s28 offen offset:0 sc1 lds
  ds_read_b128 a[16:19], v3 offset:12288
  v_mfma_f32_16x16x32_bf16 v[72:75], a[32:35], a[176:179], v[28:31]
  v_cndmask_b32 v106, v106, v5, s[52:53]
  v_exp_f32 v106, v106
  v_mfma_f32_16x16x32_bf16 v[72:75], a[36:39], a[180:183], v[72:75]
  ds_read_b128 a[20:23], v3 offset:13312
  v_cndmask_b32 v107, v107, v5, s[54:55]
  v_mfma_f32_16x16x32_bf16 v[72:75], a[40:43], a[184:187], v[72:75]
  buffer_load_dwordx4 v2, s[20:23], s28 offen offset:1024 sc1 lds
  ds_read_b128 a[24:27], v3 offset:14336
  v_mfma_f32_16x16x32_bf16 v[72:75], a[44:47], a[188:191], v[72:75]
  v_exp_f32 v107, v107
  v_mfma_f32_16x16x32_bf16 v[68:71], a[48:51], a[160:163], v[24:27]
  ds_read_b128 a[28:31], v3 offset:15360
  v_cndmask_b32 v108, v108, v5, s[56:57]
  v_mfma_f32_16x16x32_bf16 v[68:71], a[52:55], a[164:167], v[68:71]
  v_exp_f32 v108, v108
  v_mfma_f32_16x16x32_bf16 v[68:71], a[56:59], a[168:171], v[68:71]
  ds_read_b128 a[32:35], v4 offset:0
  v_cndmask_b32 v109, v109, v5, s[58:59]
  v_mfma_f32_16x16x32_bf16 v[68:71], a[60:63], a[172:175], v[68:71]
  v_exp_f32 v109, v109
  v_mfma_f32_16x16x32_bf16 v[76:79], a[48:51], a[176:179], v[28:31]
  ds_read_b128 a[36:39], v4 offset:1024
  v_cvt_pk_bf16_f32 v52, v104, v105
  v_mfma_f32_16x16x32_bf16 v[76:79], a[52:55], a[180:183], v[76:79]
  buffer_load_dwordx4 v2, s[20:23], s28 offen offset:2048 sc1 lds
  v_cndmask_b32 v110, v110, v5, s[60:61]
  v_mfma_f32_16x16x32_bf16 v[76:79], a[56:59], a[184:187], v[76:79]
  v_exp_f32 v110, v110
  v_mfma_f32_16x16x32_bf16 v[76:79], a[60:63], a[188:191], v[76:79]
  s_waitcnt lgkmcnt(2)
  ds_read_b128 a[40:43], v4 offset:2048
  v_cndmask_b32 v111, v111, v5, s[62:63]
  v_mfma_f32_16x16x32_bf16 v[80:83], a[0:3], a[160:163], v[24:27]
  v_exp_f32 v111, v111
  v_mfma_f32_16x16x32_bf16 v[80:83], a[4:7], a[164:167], v[80:83]
  ds_read_b128 a[44:47], v4 offset:3072
  v_cvt_pk_bf16_f32 v53, v106, v107
  v_mfma_f32_16x16x32_bf16 v[80:83], a[8:11], a[168:171], v[80:83]
  ds_read_b128 a[48:51], v4 offset:4096
  v_cvt_pk_bf16_f32 v54, v108, v109
  v_mfma_f32_16x16x32_bf16 v[80:83], a[12:15], a[172:175], v[80:83]
  v_exp_f32 v112, v112
  v_mfma_f32_16x16x32_bf16 v[88:91], a[0:3], a[176:179], v[28:31]
  buffer_load_dwordx4 v2, s[20:23], s28 offen offset:3072 sc1 lds
  ds_read_b128 a[52:55], v4 offset:5120
  v_mfma_f32_16x16x32_bf16 v[88:91], a[4:7], a[180:183], v[88:91]
  s_xor_b32 s26, s26, 0x8000
  v_exp_f32 v113, v113
  v_mfma_f32_16x16x32_bf16 v[88:91], a[8:11], a[184:187], v[88:91]
  s_add_u32 s28, s28, 0x8000
  s_mov_b32 m0, s27
  ds_read_b128 a[56:59], v4 offset:6144
  v_mfma_f32_16x16x32_bf16 v[88:91], a[12:15], a[188:191], v[88:91]
  v_exp_f32 v114, v114
  v_mfma_f32_16x16x32_bf16 v[84:87], a[16:19], a[160:163], v[24:27]
  ds_read_b128 a[60:63], v4 offset:7168
  v_cvt_pk_bf16_f32 v55, v110, v111
  v_mfma_f32_16x16x32_bf16 v[84:87], a[20:23], a[164:167], v[84:87]
  v_xor_b32 v3, 0x4000, v3
  v_cvt_pk_bf16_f32 v56, v112, v113
  v_mfma_f32_16x16x32_bf16 v[84:87], a[24:27], a[168:171], v[84:87]
  v_exp_f32 v115, v115
  v_mfma_f32_16x16x32_bf16 v[84:87], a[28:31], a[172:175], v[84:87]
  buffer_load_dwordx4 v2, s[20:23], s29 offen offset:0 sc1 lds
  ds_read_b128 a[0:3], v3 offset:0
  v_mfma_f32_16x16x32_bf16 v[92:95], a[16:19], a[176:179], v[28:31]
  v_exp_f32 v116, v116
  v_mfma_f32_16x16x32_bf16 v[92:95], a[20:23], a[180:183], v[92:95]
  ds_read_b128 a[4:7], v3 offset:1024
  v_cvt_pk_bf16_f32 v57, v114, v115
  v_mfma_f32_16x16x32_bf16 v[92:95], a[24:27], a[184:187], v[92:95]
  v_exp_f32 v117, v117
  v_mfma_f32_16x16x32_bf16 v[92:95], a[28:31], a[188:191], v[92:95]
  s_waitcnt lgkmcnt(6)
  ds_read_b128 a[8:11], v3 offset:2048
  v_cvt_pk_bf16_f32 v58, v116, v117
  v_mfma_f32_16x16x32_bf16 v[160:163], a[32:35], v[36:39], v[160:163]
  ds_read_b128 a[12:15], v3 offset:3072
  v_mfma_f32_16x16x32_bf16 v[192:195], a[32:35], v[40:43], v[192:195]
  v_exp_f32 v118, v118
  v_mfma_f32_16x16x32_bf16 v[224:227], a[32:35], v[44:47], v[224:227]
  buffer_load_dwordx4 v2, s[20:23], s29 offen offset:1024 sc1 lds
  v_mfma_f32_16x16x32_bf16 a[196:199], a[208:211], v[36:39], a[196:199]
  v_exp_f32 v119, v119
  v_mfma_f32_16x16x32_bf16 v[164:167], a[36:39], v[36:39], v[164:167]
  ds_read_b128 a[16:19], v3 offset:4096
  v_cvt_pk_bf16_f32 v59, v118, v119
  v_mfma_f32_16x16x32_bf16 v[196:199], a[36:39], v[40:43], v[196:199]
  v_mfma_f32_16x16x32_bf16 v[228:231], a[36:39], v[44:47], v[228:231]
  v_exp_f32 v120, v120
  v_mfma_f32_16x16x32_bf16 a[200:203], a[208:211], v[40:43], a[200:203]
  v_mfma_f32_16x16x32_bf16 v[168:171], a[40:43], v[36:39], v[168:171]
  v_exp_f32 v121, v121
  v_mfma_f32_16x16x32_bf16 v[200:203], a[40:43], v[40:43], v[200:203]
  buffer_load_dwordx4 v2, s[20:23], s29 offen offset:2048 sc1 lds
  ds_read_b128 a[20:23], v3 offset:5120
  v_mfma_f32_16x16x32_bf16 v[232:235], a[40:43], v[44:47], v[232:235]
  v_exp_f32 v122, v122
  v_mfma_f32_16x16x32_bf16 a[204:207], a[208:211], v[44:47], a[204:207]
  v_cvt_pk_bf16_f32 v60, v120, v121
  v_mfma_f32_16x16x32_bf16 v[172:175], a[44:47], v[36:39], v[172:175]
  ds_read_b128 a[24:27], v3 offset:6144
  v_mfma_f32_16x16x32_bf16 v[204:207], a[44:47], v[40:43], v[204:207]
  v_exp_f32 v123, v123
  v_mfma_f32_16x16x32_bf16 v[236:239], a[44:47], v[44:47], v[236:239]
  s_waitcnt lgkmcnt(7)
  v_cvt_pk_bf16_f32 v61, v122, v123
  v_mfma_f32_16x16x32_bf16 v[176:179], a[48:51], v[36:39], v[176:179]
  v_exp_f32 v124, v124
  v_mfma_f32_16x16x32_bf16 v[208:211], a[48:51], v[40:43], v[208:211]
  buffer_load_dwordx4 v2, s[20:23], s29 offen offset:3072 sc1 lds
  ds_read_b128 a[28:31], v3 offset:7168
  v_mfma_f32_16x16x32_bf16 v[240:243], a[48:51], v[44:47], v[240:243]
  s_xor_b32 s27, s27, 0x4000
  v_exp_f32 v125, v125
  v_mfma_f32_16x16x32_bf16 v[180:183], a[52:55], v[36:39], v[180:183]
  s_add_u32 s29, s29, 0x8000
  ds_read_b128 a[32:35], v3 offset:8192
  v_cvt_pk_bf16_f32 v62, v124, v125
  v_mfma_f32_16x16x32_bf16 v[212:215], a[52:55], v[40:43], v[212:215]
  v_mfma_f32_16x16x32_bf16 v[244:247], a[52:55], v[44:47], v[244:247]
  v_exp_f32 v126, v126
  v_mfma_f32_16x16x32_bf16 v[184:187], a[56:59], v[36:39], v[184:187]
  ds_read_b128 a[36:39], v3 offset:9216
  v_mfma_f32_16x16x32_bf16 v[216:219], a[56:59], v[40:43], v[216:219]
  v_exp_f32 v127, v127
  v_mfma_f32_16x16x32_bf16 v[248:251], a[56:59], v[44:47], v[248:251]
  v_cvt_pk_bf16_f32 v63, v126, v127
  v_mfma_f32_16x16x32_bf16 v[188:191], a[60:63], v[36:39], v[188:191]
  ds_read_b128 a[40:43], v3 offset:10240
  v_mfma_f32_16x16x32_bf16 v[220:223], a[60:63], v[40:43], v[220:223]
  s_waitcnt vmcnt(12)
  s_barrier
  v_mfma_f32_16x16x32_bf16 v[252:255], a[60:63], v[44:47], v[252:255]
  s_waitcnt lgkmcnt(3)
  v_mfma_f32_16x16x32_bf16 v[96:99], a[0:3], a[160:163], v[24:27]
  s_mov_b32 m0, s26
  v_exp_f32 v64, v64
  v_mfma_f32_16x16x32_bf16 v[96:99], a[4:7], a[164:167], v[96:99]
  v_exp_f32 v65, v65
  v_mfma_f32_16x16x32_bf16 v[96:99], a[8:11], a[168:171], v[96:99]
  buffer_load_dwordx4 v2, s[20:23], s28 offen offset:0 sc1 lds
  ds_read_b128 a[44:47], v3 offset:11264
  v_mfma_f32_16x16x32_bf16 v[96:99], a[12:15], a[172:175], v[96:99]
  v_exp_f32 v66, v66
  v_mfma_f32_16x16x32_bf16 v[104:107], a[0:3], a[176:179], v[28:31]
  ds_read_b128 a[48:51], v3 offset:12288
  ds_read_b128 a[52:55], v3 offset:13312
  v_mfma_f32_16x16x32_bf16 v[104:107], a[4:7], a[180:183], v[104:107]
  v_exp_f32 v67, v67
  v_mfma_f32_16x16x32_bf16 v[104:107], a[8:11], a[184:187], v[104:107]
  ds_read_b128 a[56:59], v3 offset:14336
  v_cvt_pk_bf16_f32 v32, v64, v65
  v_mfma_f32_16x16x32_bf16 v[104:107], a[12:15], a[188:191], v[104:107]
  v_exp_f32 v68, v68
  v_mfma_f32_16x16x32_bf16 v[100:103], a[16:19], a[160:163], v[24:27]
  v_exp_f32 v69, v69
  v_mfma_f32_16x16x32_bf16 v[100:103], a[20:23], a[164:167], v[100:103]
  ds_read_b128 a[60:63], v3 offset:15360
  v_cvt_pk_bf16_f32 v33, v66, v67
  v_mfma_f32_16x16x32_bf16 v[100:103], a[24:27], a[168:171], v[100:103]
  v_exp_f32 v70, v70
  v_mfma_f32_16x16x32_bf16 v[100:103], a[28:31], a[172:175], v[100:103]
  ds_read_b128 a[0:3], v4 offset:8192
  v_cvt_pk_bf16_f32 v34, v68, v69
  v_mfma_f32_16x16x32_bf16 v[108:111], a[16:19], a[176:179], v[28:31]
  v_exp_f32 v71, v71
  v_mfma_f32_16x16x32_bf16 v[108:111], a[20:23], a[180:183], v[108:111]
  buffer_load_dwordx4 v2, s[20:23], s28 offen offset:1024 sc1 lds
  ds_read_b128 a[4:7], v4 offset:9216
  v_mfma_f32_16x16x32_bf16 v[108:111], a[24:27], a[184:187], v[108:111]
  v_exp_f32 v72, v72
  v_mfma_f32_16x16x32_bf16 v[108:111], a[28:31], a[188:191], v[108:111]
  s_waitcnt lgkmcnt(2)
  ds_read_b128 a[8:11], v4 offset:10240
  v_cvt_pk_bf16_f32 v35, v70, v71
  v_mfma_f32_16x16x32_bf16 v[112:115], a[32:35], a[160:163], v[24:27]
  v_exp_f32 v73, v73
  v_mfma_f32_16x16x32_bf16 v[112:115], a[36:39], a[164:167], v[112:115]
  v_exp_f32 v74, v74
  v_mfma_f32_16x16x32_bf16 v[112:115], a[40:43], a[168:171], v[112:115]
  ds_read_b128 a[12:15], v4 offset:11264
  ds_read_b128 a[16:19], v4 offset:12288
  v_mfma_f32_16x16x32_bf16 v[112:115], a[44:47], a[172:175], v[112:115]
  v_exp_f32 v75, v75
  v_mfma_f32_16x16x32_bf16 v[120:123], a[32:35], a[176:179], v[28:31]
  ds_read_b128 a[20:23], v4 offset:13312
  v_cvt_pk_bf16_f32 v36, v72, v73
  v_mfma_f32_16x16x32_bf16 v[120:123], a[36:39], a[180:183], v[120:123]
  v_exp_f32 v76, v76
  v_mfma_f32_16x16x32_bf16 v[120:123], a[40:43], a[184:187], v[120:123]
  ds_read_b128 a[24:27], v4 offset:14336
  v_cvt_pk_bf16_f32 v37, v74, v75
  v_mfma_f32_16x16x32_bf16 v[120:123], a[44:47], a[188:191], v[120:123]
  v_exp_f32 v77, v77
  v_mfma_f32_16x16x32_bf16 v[116:119], a[48:51], a[160:163], v[24:27]
  v_exp_f32 v78, v78
  v_mfma_f32_16x16x32_bf16 v[116:119], a[52:55], a[164:167], v[116:119]
  ds_read_b128 a[28:31], v4 offset:15360
  v_xor_b32 v4, 0x8000, v4
  v_mfma_f32_16x16x32_bf16 v[116:119], a[56:59], a[168:171], v[116:119]
  v_exp_f32 v79, v79
  v_mfma_f32_16x16x32_bf16 v[116:119], a[60:63], a[172:175], v[116:119]
  buffer_load_dwordx4 v2, s[20:23], s28 offen offset:2048 sc1 lds
  v_xor_b32 v3, 0x8000, v3
  v_mfma_f32_16x16x32_bf16 v[124:127], a[48:51], a[176:179], v[28:31]
  v_exp_f32 v80, v80
  v_mfma_f32_16x16x32_bf16 v[124:127], a[52:55], a[180:183], v[124:127]
  ds_read_b128 a[32:35], v3 offset:0
  ds_read_b128 a[36:39], v3 offset:1024
  v_mfma_f32_16x16x32_bf16 v[124:127], a[56:59], a[184:187], v[124:127]
  v_exp_f32 v81, v81
  v_mfma_f32_16x16x32_bf16 v[124:127], a[60:63], a[188:191], v[124:127]
  s_waitcnt lgkmcnt(6)
  ds_read_b128 a[40:43], v3 offset:2048
  v_cvt_pk_bf16_f32 v38, v76, v77
  v_mfma_f32_16x16x32_bf16 v[160:163], a[0:3], v[52:55], v[160:163]
  v_exp_f32 v82, v82
  v_mfma_f32_16x16x32_bf16 v[192:195], a[0:3], v[56:59], v[192:195]
  v_exp_f32 v83, v83
  v_mfma_f32_16x16x32_bf16 v[224:227], a[0:3], v[60:63], v[224:227]
  ds_read_b128 a[44:47], v3 offset:3072
  v_cvt_pk_bf16_f32 v39, v78, v79
  v_mfma_f32_16x16x32_bf16 a[196:199], a[208:211], v[52:55], a[196:199]
  v_exp_f32 v84, v84
  v_mfma_f32_16x16x32_bf16 v[164:167], a[4:7], v[52:55], v[164:167]
  ds_read_b128 a[48:51], v3 offset:4096
  v_cvt_pk_bf16_f32 v40, v80, v81
  v_mfma_f32_16x16x32_bf16 v[196:199], a[4:7], v[56:59], v[196:199]
  v_exp_f32 v85, v85
  v_mfma_f32_16x16x32_bf16 v[228:231], a[4:7], v[60:63], v[228:231]
  v_cvt_pk_bf16_f32 v41, v82, v83
  v_cvt_pk_bf16_f32 v42, v84, v85
  v_mfma_f32_16x16x32_bf16 a[200:203], a[208:211], v[56:59], a[200:203]
  v_exp_f32 v86, v86
  v_mfma_f32_16x16x32_bf16 v[168:171], a[8:11], v[52:55], v[168:171]
  v_exp_f32 v87, v87
  v_mfma_f32_16x16x32_bf16 v[200:203], a[8:11], v[56:59], v[200:203]
  buffer_load_dwordx4 v2, s[20:23], s28 offen offset:3072 sc1 lds
  ds_read_b128 a[52:55], v3 offset:5120
  v_mfma_f32_16x16x32_bf16 v[232:235], a[8:11], v[60:63], v[232:235]
  s_xor_b32 s26, s26, 0x4000
  v_exp_f32 v88, v88
  v_mfma_f32_16x16x32_bf16 a[204:207], a[208:211], v[60:63], a[204:207]
  s_add_u32 s28, s28, 0x8000
  v_cvt_pk_bf16_f32 v43, v86, v87
  v_mfma_f32_16x16x32_bf16 v[172:175], a[12:15], v[52:55], v[172:175]
  v_exp_f32 v89, v89
  v_mfma_f32_16x16x32_bf16 v[204:207], a[12:15], v[56:59], v[204:207]
  ds_read_b128 a[56:59], v3 offset:6144
  v_cvt_pk_bf16_f32 v44, v88, v89
  v_mfma_f32_16x16x32_bf16 v[236:239], a[12:15], v[60:63], v[236:239]
  s_waitcnt lgkmcnt(7)
  v_exp_f32 v90, v90
  v_mfma_f32_16x16x32_bf16 v[176:179], a[16:19], v[52:55], v[176:179]
  ds_read_b128 a[60:63], v3 offset:7168
  v_mfma_f32_16x16x32_bf16 v[208:211], a[16:19], v[56:59], v[208:211]
  v_exp_f32 v91, v91
  v_mfma_f32_16x16x32_bf16 v[240:243], a[16:19], v[60:63], v[240:243]
  v_exp_f32 v92, v92
  v_mfma_f32_16x16x32_bf16 v[180:183], a[20:23], v[52:55], v[180:183]
  ds_read_b128 a[0:3], v3 offset:8192
  v_cvt_pk_bf16_f32 v45, v90, v91
  v_mfma_f32_16x16x32_bf16 v[212:215], a[20:23], v[56:59], v[212:215]
  v_exp_f32 v93, v93
  v_mfma_f32_16x16x32_bf16 v[244:247], a[20:23], v[60:63], v[244:247]
  v_cvt_pk_bf16_f32 v46, v92, v93
  v_mfma_f32_16x16x32_bf16 v[184:187], a[24:27], v[52:55], v[184:187]
  v_exp_f32 v94, v94
  v_mfma_f32_16x16x32_bf16 v[216:219], a[24:27], v[56:59], v[216:219]
  ds_read_b128 a[4:7], v3 offset:9216
  v_mfma_f32_16x16x32_bf16 v[248:251], a[24:27], v[60:63], v[248:251]
  v_exp_f32 v95, v95
  v_mfma_f32_16x16x32_bf16 v[188:191], a[28:31], v[52:55], v[188:191]
  ds_read_b128 a[8:11], v3 offset:10240
  v_cvt_pk_bf16_f32 v47, v94, v95
  v_mfma_f32_16x16x32_bf16 v[220:223], a[28:31], v[56:59], v[220:223]
  s_waitcnt vmcnt(8)
  s_barrier
  v_mfma_f32_16x16x32_bf16 v[252:255], a[28:31], v[60:63], v[252:255]
  s_lshl_b32 s4, s25, 20
  s_lshl_b32 s5, s24, 15
  s_add_u32 s4, s4, s5
  s_lshl_b32 s5, s3, 11
  s_add_u32 s4, s4, s5
  v_accvgpr_read_b32 v6, a192
  v_accvgpr_read_b32 v8, a196
  s_mov_b32 s5, 0x5f800000
  v_cmp_ngt_f32 vcc, s5, v6
  v_rcp_f32 v6, v6
  s_or_b32 s89, s89, vcc_lo
  s_or_b32 s89, s89, vcc_hi
  v_mov_b32 v7, v6
  v_cmp_ngt_f32 vcc, s5, v8
  v_rcp_f32 v8, v8
  s_or_b32 s89, s89, vcc_lo
  s_or_b32 s89, s89, vcc_hi
  v_mov_b32 v9, v8
  v_pk_mul_f32 v[128:129], v[128:129], v[6:7]
  v_pk_mul_f32 v[130:131], v[130:131], v[6:7]
  v_pk_mul_f32 v[132:133], v[132:133], v[6:7]
  v_pk_mul_f32 v[134:135], v[134:135], v[6:7]
  v_cvt_pk_bf16_f32 v128, v128, v129
  v_cvt_pk_bf16_f32 v129, v130, v131
  v_cvt_pk_bf16_f32 v130, v132, v133
  v_cvt_pk_bf16_f32 v131, v134, v135
  buffer_store_dwordx4 v[128:131], v2, s[16:19], s4 offen offset:0 sc1
  v_pk_mul_f32 v[160:161], v[160:161], v[8:9]
  v_pk_mul_f32 v[162:163], v[162:163], v[8:9]
  v_pk_mul_f32 v[164:165], v[164:165], v[8:9]
  v_pk_mul_f32 v[166:167], v[166:167], v[8:9]
  v_cvt_pk_bf16_f32 v160, v160, v161
  v_cvt_pk_bf16_f32 v161, v162, v163
  v_cvt_pk_bf16_f32 v162, v164, v165
  v_cvt_pk_bf16_f32 v163, v166, v167
  buffer_store_dwordx4 v[160:163], v2, s[16:19], s4 offen offset:1024 sc1
  s_add_u32 s4, s4, 8192
  v_pk_mul_f32 v[136:137], v[136:137], v[6:7]
  v_pk_mul_f32 v[138:139], v[138:139], v[6:7]
  v_pk_mul_f32 v[140:141], v[140:141], v[6:7]
  v_pk_mul_f32 v[142:143], v[142:143], v[6:7]
  v_cvt_pk_bf16_f32 v136, v136, v137
  v_cvt_pk_bf16_f32 v137, v138, v139
  v_cvt_pk_bf16_f32 v138, v140, v141
  v_cvt_pk_bf16_f32 v139, v142, v143
  buffer_store_dwordx4 v[136:139], v2, s[16:19], s4 offen offset:0 sc1
  v_pk_mul_f32 v[168:169], v[168:169], v[8:9]
  v_pk_mul_f32 v[170:171], v[170:171], v[8:9]
  v_pk_mul_f32 v[172:173], v[172:173], v[8:9]
  v_pk_mul_f32 v[174:175], v[174:175], v[8:9]
  v_cvt_pk_bf16_f32 v168, v168, v169
  v_cvt_pk_bf16_f32 v169, v170, v171
  v_cvt_pk_bf16_f32 v170, v172, v173
  v_cvt_pk_bf16_f32 v171, v174, v175
  buffer_store_dwordx4 v[168:171], v2, s[16:19], s4 offen offset:1024 sc1
  s_add_u32 s4, s4, 8192
  v_pk_mul_f32 v[144:145], v[144:145], v[6:7]
  v_pk_mul_f32 v[146:147], v[146:147], v[6:7]
  v_pk_mul_f32 v[148:149], v[148:149], v[6:7]
  v_pk_mul_f32 v[150:151], v[150:151], v[6:7]
  v_cvt_pk_bf16_f32 v144, v144, v145
  v_cvt_pk_bf16_f32 v145, v146, v147
  v_cvt_pk_bf16_f32 v146, v148, v149
  v_cvt_pk_bf16_f32 v147, v150, v151
  buffer_store_dwordx4 v[144:147], v2, s[16:19], s4 offen offset:0 sc1
  v_pk_mul_f32 v[176:177], v[176:177], v[8:9]
  v_pk_mul_f32 v[178:179], v[178:179], v[8:9]
  v_pk_mul_f32 v[180:181], v[180:181], v[8:9]
  v_pk_mul_f32 v[182:183], v[182:183], v[8:9]
  v_cvt_pk_bf16_f32 v176, v176, v177
  v_cvt_pk_bf16_f32 v177, v178, v179
  v_cvt_pk_bf16_f32 v178, v180, v181
  v_cvt_pk_bf16_f32 v179, v182, v183
  buffer_store_dwordx4 v[176:179], v2, s[16:19], s4 offen offset:1024 sc1
  s_add_u32 s4, s4, 8192
  v_pk_mul_f32 v[152:153], v[152:153], v[6:7]
  v_pk_mul_f32 v[154:155], v[154:155], v[6:7]
  v_pk_mul_f32 v[156:157], v[156:157], v[6:7]
  v_pk_mul_f32 v[158:159], v[158:159], v[6:7]
  v_cvt_pk_bf16_f32 v152, v152, v153
  v_cvt_pk_bf16_f32 v153, v154, v155
  v_cvt_pk_bf16_f32 v154, v156, v157
  v_cvt_pk_bf16_f32 v155, v158, v159
  buffer_store_dwordx4 v[152:155], v2, s[16:19], s4 offen offset:0 sc1
  v_pk_mul_f32 v[184:185], v[184:185], v[8:9]
  v_pk_mul_f32 v[186:187], v[186:187], v[8:9]
  v_pk_mul_f32 v[188:189], v[188:189], v[8:9]
  v_pk_mul_f32 v[190:191], v[190:191], v[8:9]
  v_cvt_pk_bf16_f32 v184, v184, v185
  v_cvt_pk_bf16_f32 v185, v186, v187
  v_cvt_pk_bf16_f32 v186, v188, v189
  v_cvt_pk_bf16_f32 v187, v190, v191
  buffer_store_dwordx4 v[184:187], v2, s[16:19], s4 offen offset:1024 sc1
  s_and_b32 s88, s25, 1
  s_lshl_b32 s88, s88, 1
  s_add_u32 s88, s88, 14
  s_sub_u32 s88, s88, s25
  s_sub_u32 s88, s88, s25
  s_sub_u32 s88, s88, 1
  .p2align 6
La_so:
  s_waitcnt lgkmcnt(3)
  v_mfma_f32_16x16x32_bf16 v[64:67], a[32:35], a[160:163], v[24:27]
  v_exp_f32 v96, v96
  v_mfma_f32_16x16x32_bf16 v[64:67], a[36:39], a[164:167], v[64:67]
  buffer_store_dwordx4 a[244:247], v2, s[64:67], s90 offen offset:0 sc1
  ds_read_b128 a[12:15], v3 offset:11264
  v_mfma_f32_16x16x32_bf16 v[64:67], a[40:43], a[168:171], v[64:67]
  v_exp_f32 v97, v97
  v_mfma_f32_16x16x32_bf16 v[64:67], a[44:47], a[172:175], v[64:67]
  ds_read_b128 a[16:19], v3 offset:12288
  v_cvt_pk_bf16_f32 v48, v96, v97
  v_mfma_f32_16x16x32_bf16 v[72:75], a[32:35], a[176:179], v[28:31]
  v_exp_f32 v98, v98
  v_mfma_f32_16x16x32_bf16 v[72:75], a[36:39], a[180:183], v[72:75]
  ds_read_b128 a[20:23], v3 offset:13312
  v_mfma_f32_16x16x32_bf16 v[72:75], a[40:43], a[184:187], v[72:75]
  v_exp_f32 v99, v99
  v_mfma_f32_16x16x32_bf16 v[72:75], a[44:47], a[188:191], v[72:75]
  buffer_store_dwordx4 a[244:247], v2, s[64:67], s90 offen offset:1024 sc1
  ds_read_b128 a[24:27], v3 offset:14336
  v_mfma_f32_16x16x32_bf16 v[68:71], a[48:51], a[160:163], v[24:27]
  s_add_u32 s90, s90, 2048
  v_exp_f32 v100, v100
  v_mfma_f32_16x16x32_bf16 v[68:71], a[52:55], a[164:167], v[68:71]
  s_mov_b32 m0, s26
  ds_read_b128 a[28:31], v3 offset:15360
  v_cvt_pk_bf16_f32 v49, v98, v99
  v_mfma_f32_16x16x32_bf16 v[68:71], a[56:59], a[168:171], v[68:71]
  v_exp_f32 v101, v101
  v_mfma_f32_16x16x32_bf16 v[68:71], a[60:63], a[172:175], v[68:71]
  ds_read_b128 a[32:35], v4 offset:0
  v_cvt_pk_bf16_f32 v50, v100, v101
  v_mfma_f32_16x16x32_bf16 v[76:79], a[48:51], a[176:179], v[28:31]
  v_exp_f32 v102, v102
  v_mfma_f32_16x16x32_bf16 v[76:79], a[52:55], a[180:183], v[76:79]
  buffer_load_dwordx4 v2, s[20:23], s28 offen offset:0 sc1 lds
  ds_read_b128 a[36:39], v4 offset:1024
  v_mfma_f32_16x16x32_bf16 v[76:79], a[56:59], a[184:187], v[76:79]
  v_exp_f32 v103, v103
  v_mfma_f32_16x16x32_bf16 v[76:79], a[60:63], a[188:191], v[76:79]
  s_waitcnt lgkmcnt(2)
  ds_read_b128 a[40:43], v4 offset:2048
  v_cvt_pk_bf16_f32 v51, v102, v103
  v_mfma_f32_16x16x32_bf16 v[80:83], a[0:3], a[160:163], v[24:27]
  v_exp_f32 v104, v104
  v_mfma_f32_16x16x32_bf16 v[80:83], a[4:7], a[164:167], v[80:83]
  ds_read_b128 a[44:47], v4 offset:3072
  v_mfma_f32_16x16x32_bf16 v[80:83], a[8:11], a[168:171], v[80:83]
  v_exp_f32 v105, v105
  v_mfma_f32_16x16x32_bf16 v[80:83], a[12:15], a[172:175], v[80:83]
  buffer_load_dwordx4 v2, s[20:23], s28 offen offset:1024 sc1 lds
  ds_read_b128 a[48:51], v4 offset:4096
  v_mfma_f32_16x16x32_bf16 v[88:91], a[0:3], a[176:179], v[28:31]
  v_exp_f32 v106, v106
  v_mfma_f32_16x16x32_bf16 v[88:91], a[4:7], a[180:183], v[88:91]
  ds_read_b128 a[52:55], v4 offset:5120
  v_cvt_pk_bf16_f32 v52, v104, v105
  v_mfma_f32_16x16x32_bf16 v[88:91], a[8:11], a[184:187], v[88:91]
  v_exp_f32 v107, v107
  v_mfma_f32_16x16x32_bf16 v[88:91], a[12:15], a[188:191], v[88:91]
  ds_read_b128 a[56:59], v4 offset:6144
  v_cvt_pk_bf16_f32 v53, v106, v107
  v_mfma_f32_16x16x32_bf16 v[84:87], a[16:19], a[160:163], v[24:27]
  v_exp_f32 v108, v108
  v_mfma_f32_16x16x32_bf16 v[84:87], a[20:23], a[164:167], v[84:87]
  buffer_load_dwordx4 v2, s[20:23], s28 offen offset:2048 sc1 lds
  ds_read_b128 a[60:63], v4 offset:7168
  v_mfma_f32_16x16x32_bf16 v[84:87], a[24:27], a[168:171], v[84:87]
  v_exp_f32 v109, v109
  v_mfma_f32_16x16x32_bf16 v[84:87], a[28:31], a[172:175], v[84:87]
  ds_read_b128 a[0:3], v4 offset:8192
  v_cvt_pk_bf16_f32 v54, v108, v109
  v_mfma_f32_16x16x32_bf16 v[92:95], a[16:19], a[176:179], v[28:31]
  v_exp_f32 v110, v110
  v_mfma_f32_16x16x32_bf16 v[92:95], a[20:23], a[180:183], v[92:95]
  ds_read_b128 a[4:7], v4 offset:9216
  v_mfma_f32_16x16x32_bf16 v[92:95], a[24:27], a[184:187], v[92:95]
  v_exp_f32 v111, v111
  v_mfma_f32_16x16x32_bf16 v[92:95], a[28:31], a[188:191], v[92:95]
  s_waitcnt lgkmcnt(2)
  ds_read_b128 a[8:11], v4 offset:10240
  v_cvt_pk_bf16_f32 v55, v110, v111
  v_mfma_f32_16x16x32_bf16 v[192:195], a[32:35], v[32:35], v[192:195]
  buffer_load_dwordx4 v2, s[20:23], s28 offen offset:3072 sc1 lds
  ds_read_b128 a[12:15], v4 offset:11264
  v_mfma_f32_16x16x32_bf16 v[224:227], a[32:35], v[36:39], v[224:227]
  s_xor_b32 s26, s26, 0x8000
  v_exp_f32 v112, v112
  v_mfma_f32_16x16x32_bf16 a[200:203], a[208:211], v[32:35], a[200:203]
  s_add_u32 s28, s28, 0x8000
  s_mov_b32 m0, s27
  s_sub_u32 s88, s88, 1
  v_mfma_f32_16x16x32_bf16 v[196:199], a[36:39], v[32:35], v[196:199]
  v_exp_f32 v113, v113
  v_mfma_f32_16x16x32_bf16 v[228:231], a[36:39], v[36:39], v[228:231]
  ds_read_b128 a[16:19], v4 offset:12288
  v_cvt_pk_bf16_f32 v56, v112, v113
  v_mfma_f32_16x16x32_bf16 a[204:207], a[208:211], v[36:39], a[204:207]
  v_exp_f32 v114, v114
  v_mfma_f32_16x16x32_bf16 v[200:203], a[40:43], v[32:35], v[200:203]
  buffer_load_dwordx4 v2, s[20:23], s29 offen offset:0 sc1 lds
  ds_read_b128 a[20:23], v4 offset:13312
  v_mfma_f32_16x16x32_bf16 v[232:235], a[40:43], v[36:39], v[232:235]
  v_exp_f32 v115, v115
  v_mfma_f32_16x16x32_bf16 v[204:207], a[44:47], v[32:35], v[204:207]
  ds_read_b128 a[24:27], v4 offset:14336
  v_cvt_pk_bf16_f32 v57, v114, v115
  v_mfma_f32_16x16x32_bf16 v[236:239], a[44:47], v[36:39], v[236:239]
  v_exp_f32 v116, v116
  v_mfma_f32_16x16x32_bf16 v[208:211], a[48:51], v[32:35], v[208:211]
  ds_read_b128 a[28:31], v4 offset:15360
  v_xor_b32 v4, 0x4000, v4
  v_mfma_f32_16x16x32_bf16 v[240:243], a[48:51], v[36:39], v[240:243]
  v_exp_f32 v117, v117
  v_mfma_f32_16x16x32_bf16 v[212:215], a[52:55], v[32:35], v[212:215]
  buffer_load_dwordx4 v2, s[20:23], s29 offen offset:1024 sc1 lds
  v_xor_b32 v3, 0x4000, v3
  v_mfma_f32_16x16x32_bf16 v[244:247], a[52:55], v[36:39], v[244:247]
  v_exp_f32 v118, v118
  v_mfma_f32_16x16x32_bf16 v[216:219], a[56:59], v[32:35], v[216:219]
  ds_read_b128 a[32:35], v3 offset:0
  ds_read_b128 a[36:39], v3 offset:1024
  v_mfma_f32_16x16x32_bf16 v[248:251], a[56:59], v[36:39], v[248:251]
  v_exp_f32 v119, v119
  v_mfma_f32_16x16x32_bf16 v[220:223], a[60:63], v[32:35], v[220:223]
  ds_read_b128 a[40:43], v3 offset:2048
  v_cvt_pk_bf16_f32 v58, v116, v117
  v_mfma_f32_16x16x32_bf16 v[252:255], a[60:63], v[36:39], v[252:255]
  s_waitcnt lgkmcnt(3)
  v_exp_f32 v120, v120
  v_mfma_f32_16x16x32_bf16 v[192:195], a[0:3], v[40:43], v[192:195]
  ds_read_b128 a[44:47], v3 offset:3072
  v_cvt_pk_bf16_f32 v59, v118, v119
  v_mfma_f32_16x16x32_bf16 v[224:227], a[0:3], v[44:47], v[224:227]
  v_exp_f32 v121, v121
  v_mfma_f32_16x16x32_bf16 a[200:203], a[208:211], v[40:43], a[200:203]
  buffer_load_dwordx4 v2, s[20:23], s29 offen offset:2048 sc1 lds
  v_cvt_pk_bf16_f32 v60, v120, v121
  v_mfma_f32_16x16x32_bf16 v[196:199], a[4:7], v[40:43], v[196:199]
  v_exp_f32 v122, v122
  v_mfma_f32_16x16x32_bf16 v[228:231], a[4:7], v[44:47], v[228:231]
  ds_read_b128 a[48:51], v3 offset:4096
  v_mfma_f32_16x16x32_bf16 a[204:207], a[208:211], v[44:47], a[204:207]
  v_exp_f32 v123, v123
  v_mfma_f32_16x16x32_bf16 v[200:203], a[8:11], v[40:43], v[200:203]
  ds_read_b128 a[52:55], v3 offset:5120
  v_cvt_pk_bf16_f32 v61, v122, v123
  v_mfma_f32_16x16x32_bf16 v[232:235], a[8:11], v[44:47], v[232:235]
  v_exp_f32 v124, v124
  v_mfma_f32_16x16x32_bf16 v[204:207], a[12:15], v[40:43], v[204:207]
  buffer_load_dwordx4 v2, s[20:23], s29 offen offset:3072 sc1 lds
  ds_read_b128 a[56:59], v3 offset:6144
  v_mfma_f32_16x16x32_bf16 v[236:239], a[12:15], v[44:47], v[236:239]
  s_xor_b32 s27, s27, 0x8000
  v_exp_f32 v125, v125
  v_mfma_f32_16x16x32_bf16 v[208:211], a[16:19], v[40:43], v[208:211]
  s_add_u32 s29, s29, 0x8000
  ds_read_b128 a[60:63], v3 offset:7168
  v_cvt_pk_bf16_f32 v62, v124, v125
  v_mfma_f32_16x16x32_bf16 v[240:243], a[16:19], v[44:47], v[240:243]
  v_exp_f32 v126, v126
  v_mfma_f32_16x16x32_bf16 v[212:215], a[20:23], v[40:43], v[212:215]
  ds_read_b128 a[0:3], v3 offset:8192
  v_mfma_f32_16x16x32_bf16 v[244:247], a[20:23], v[44:47], v[244:247]
  v_exp_f32 v127, v127
  v_mfma_f32_16x16x32_bf16 v[216:219], a[24:27], v[40:43], v[216:219]
  ds_read_b128 a[4:7], v3 offset:9216
  v_cvt_pk_bf16_f32 v63, v126, v127
  v_mfma_f32_16x16x32_bf16 v[248:251], a[24:27], v[44:47], v[248:251]
  v_mfma_f32_16x16x32_bf16 v[220:223], a[28:31], v[40:43], v[220:223]
  s_waitcnt vmcnt(10)
  s_barrier
  v_mfma_f32_16x16x32_bf16 v[252:255], a[28:31], v[44:47], v[252:255]
  ds_read_b128 a[8:11], v3 offset:10240
  s_cmp_eq_u32 s88, 0
  s_cbranch_scc1 La_e0
  s_waitcnt lgkmcnt(3)
  v_mfma_f32_16x16x32_bf16 v[96:99], a[32:35], a[160:163], v[24:27]
  s_mov_b32 m0, s26
  v_exp_f32 v64, v64
  v_mfma_f32_16x16x32_bf16 v[96:99], a[36:39], a[164:167], v[96:99]
  buffer_load_dwordx4 v2, s[20:23], s28 offen offset:0 sc1 lds
  ds_read_b128 a[12:15], v3 offset:11264
  v_mfma_f32_16x16x32_bf16 v[96:99], a[40:43], a[168:171], v[96:99]
  v_exp_f32 v65, v65
  v_mfma_f32_16x16x32_bf16 v[96:99], a[44:47], a[172:175], v[96:99]
  ds_read_b128 a[16:19], v3 offset:12288
  v_cvt_pk_bf16_f32 v32, v64, v65
  v_mfma_f32_16x16x32_bf16 v[104:107], a[32:35], a[176:179], v[28:31]
  v_exp_f32 v66, v66
  v_mfma_f32_16x16x32_bf16 v[104:107], a[36:39], a[180:183], v[104:107]
  ds_read_b128 a[20:23], v3 offset:13312
  v_mfma_f32_16x16x32_bf16 v[104:107], a[40:43], a[184:187], v[104:107]
  v_exp_f32 v67, v67
  v_mfma_f32_16x16x32_bf16 v[104:107], a[44:47], a[188:191], v[104:107]
  ds_read_b128 a[24:27], v3 offset:14336
  v_cvt_pk_bf16_f32 v33, v66, v67
  v_mfma_f32_16x16x32_bf16 v[100:103], a[48:51], a[160:163], v[24:27]
  v_exp_f32 v68, v68
  v_mfma_f32_16x16x32_bf16 v[100:103], a[52:55], a[164:167], v[100:103]
  buffer_load_dwordx4 v2, s[20:23], s28 offen offset:1024 sc1 lds
  ds_read_b128 a[28:31], v3 offset:15360
  v_mfma_f32_16x16x32_bf16 v[100:103], a[56:59], a[168:171], v[100:103]
  v_exp_f32 v69, v69
  v_mfma_f32_16x16x32_bf16 v[100:103], a[60:63], a[172:175], v[100:103]
  ds_read_b128 a[32:35], v4 offset:0
  v_cvt_pk_bf16_f32 v34, v68, v69
  v_mfma_f32_16x16x32_bf16 v[108:111], a[48:51], a[176:179], v[28:31]
  v_exp_f32 v70, v70
  v_mfma_f32_16x16x32_bf16 v[108:111], a[52:55], a[180:183], v[108:111]
  ds_read_b128 a[36:39], v4 offset:1024
  v_mfma_f32_16x16x32_bf16 v[108:111], a[56:59], a[184:187], v[108:111]
  v_exp_f32 v71, v71
  v_mfma_f32_16x16x32_bf16 v[108:111], a[60:63], a[188:191], v[108:111]
  s_waitcnt lgkmcnt(2)
  ds_read_b128 a[40:43], v4 offset:2048
  v_cvt_pk_bf16_f32 v35, v70, v71
  v_mfma_f32_16x16x32_bf16 v[112:115], a[0:3], a[160:163], v[24:27]
  v_exp_f32 v72, v72
  v_mfma_f32_16x16x32_bf16 v[112:115], a[4:7], a[164:167], v[112:115]
  buffer_load_dwordx4 v2, s[20:23], s28 offen offset:2048 sc1 lds
  ds_read_b128 a[44:47], v4 offset:3072
  v_mfma_f32_16x16x32_bf16 v[112:115], a[8:11], a[168:171], v[112:115]
  v_exp_f32 v73, v73
  v_mfma_f32_16x16x32_bf16 v[112:115], a[12:15], a[172:175], v[112:115]
  ds_read_b128 a[48:51], v4 offset:4096
  v_cvt_pk_bf16_f32 v36, v72, v73
  v_mfma_f32_16x16x32_bf16 v[120:123], a[0:3], a[176:179], v[28:31]
  v_exp_f32 v74, v74
  v_mfma_f32_16x16x32_bf16 v[120:123], a[4:7], a[180:183], v[120:123]
  ds_read_b128 a[52:55], v4 offset:5120
  v_mfma_f32_16x16x32_bf16 v[120:123], a[8:11], a[184:187], v[120:123]
  v_exp_f32 v75, v75
  v_mfma_f32_16x16x32_bf16 v[120:123], a[12:15], a[188:191], v[120:123]
  ds_read_b128 a[56:59], v4 offset:6144
  v_cvt_pk_bf16_f32 v37, v74, v75
  v_mfma_f32_16x16x32_bf16 v[116:119], a[16:19], a[160:163], v[24:27]
  v_exp_f32 v76, v76
  v_mfma_f32_16x16x32_bf16 v[116:119], a[20:23], a[164:167], v[116:119]
  buffer_load_dwordx4 v2, s[20:23], s28 offen offset:3072 sc1 lds
  ds_read_b128 a[60:63], v4 offset:7168
  v_mfma_f32_16x16x32_bf16 v[116:119], a[24:27], a[168:171], v[116:119]
  s_xor_b32 s26, s26, 0x4000
  v_exp_f32 v77, v77
  v_mfma_f32_16x16x32_bf16 v[116:119], a[28:31], a[172:175], v[116:119]
  s_add_u32 s28, s28, 0x8000
  s_mov_b32 m0, s27
  ds_read_b128 a[0:3], v4 offset:8192
  v_mfma_f32_16x16x32_bf16 v[124:127], a[16:19], a[176:179], v[28:31]
  v_exp_f32 v78, v78
  v_mfma_f32_16x16x32_bf16 v[124:127], a[20:23], a[180:183], v[124:127]
  ds_read_b128 a[4:7], v4 offset:9216
  v_cvt_pk_bf16_f32 v38, v76, v77
  v_mfma_f32_16x16x32_bf16 v[124:127], a[24:27], a[184:187], v[124:127]
  v_exp_f32 v79, v79
  v_mfma_f32_16x16x32_bf16 v[124:127], a[28:31], a[188:191], v[124:127]
  s_waitcnt lgkmcnt(2)
  ds_read_b128 a[8:11], v4 offset:10240
  v_cvt_pk_bf16_f32 v39, v78, v79
  v_mfma_f32_16x16x32_bf16 v[192:195], a[32:35], v[48:51], v[192:195]
  buffer_load_dwordx4 v2, s[20:23], s29 offen offset:0 sc1 lds
  ds_read_b128 a[12:15], v4 offset:11264
  v_mfma_f32_16x16x32_bf16 v[224:227], a[32:35], v[52:55], v[224:227]
  v_exp_f32 v80, v80
  v_mfma_f32_16x16x32_bf16 a[200:203], a[208:211], v[48:51], a[200:203]
  v_mfma_f32_16x16x32_bf16 v[196:199], a[36:39], v[48:51], v[196:199]
  v_exp_f32 v81, v81
  v_mfma_f32_16x16x32_bf16 v[228:231], a[36:39], v[52:55], v[228:231]
  ds_read_b128 a[16:19], v4 offset:12288
  v_cvt_pk_bf16_f32 v40, v80, v81
  v_mfma_f32_16x16x32_bf16 a[204:207], a[208:211], v[52:55], a[204:207]
  v_exp_f32 v82, v82
  v_mfma_f32_16x16x32_bf16 v[200:203], a[40:43], v[48:51], v[200:203]
  ds_read_b128 a[20:23], v4 offset:13312
  v_mfma_f32_16x16x32_bf16 v[232:235], a[40:43], v[52:55], v[232:235]
  v_exp_f32 v83, v83
  v_mfma_f32_16x16x32_bf16 v[204:207], a[44:47], v[48:51], v[204:207]
  buffer_load_dwordx4 v2, s[20:23], s29 offen offset:1024 sc1 lds
  ds_read_b128 a[24:27], v4 offset:14336
  v_mfma_f32_16x16x32_bf16 v[236:239], a[44:47], v[52:55], v[236:239]
  v_exp_f32 v84, v84
  v_mfma_f32_16x16x32_bf16 v[208:211], a[48:51], v[48:51], v[208:211]
  ds_read_b128 a[28:31], v4 offset:15360
  v_xor_b32 v4, 0x8000, v4
  v_mfma_f32_16x16x32_bf16 v[240:243], a[48:51], v[52:55], v[240:243]
  v_exp_f32 v85, v85
  v_mfma_f32_16x16x32_bf16 v[212:215], a[52:55], v[48:51], v[212:215]
  v_xor_b32 v3, 0x8000, v3
  v_cvt_pk_bf16_f32 v41, v82, v83
  v_mfma_f32_16x16x32_bf16 v[244:247], a[52:55], v[52:55], v[244:247]
  v_exp_f32 v86, v86
  v_mfma_f32_16x16x32_bf16 v[216:219], a[56:59], v[48:51], v[216:219]
  ds_read_b128 a[32:35], v3 offset:0
  ds_read_b128 a[36:39], v3 offset:1024
  v_mfma_f32_16x16x32_bf16 v[248:251], a[56:59], v[52:55], v[248:251]
  v_exp_f32 v87, v87
  v_mfma_f32_16x16x32_bf16 v[220:223], a[60:63], v[48:51], v[220:223]
  buffer_load_dwordx4 v2, s[20:23], s29 offen offset:2048 sc1 lds
  ds_read_b128 a[40:43], v3 offset:2048
  v_mfma_f32_16x16x32_bf16 v[252:255], a[60:63], v[52:55], v[252:255]
  s_waitcnt lgkmcnt(3)
  v_exp_f32 v88, v88
  v_mfma_f32_16x16x32_bf16 v[192:195], a[0:3], v[56:59], v[192:195]
  ds_read_b128 a[44:47], v3 offset:3072
  v_cvt_pk_bf16_f32 v42, v84, v85
  v_mfma_f32_16x16x32_bf16 v[224:227], a[0:3], v[60:63], v[224:227]
  v_exp_f32 v89, v89
  v_mfma_f32_16x16x32_bf16 a[200:203], a[208:211], v[56:59], a[200:203]
  v_cvt_pk_bf16_f32 v43, v86, v87
  v_cvt_pk_bf16_f32 v44, v88, v89
  v_mfma_f32_16x16x32_bf16 v[196:199], a[4:7], v[56:59], v[196:199]
  v_exp_f32 v90, v90
  v_mfma_f32_16x16x32_bf16 v[228:231], a[4:7], v[60:63], v[228:231]
  ds_read_b128 a[48:51], v3 offset:4096
  v_mfma_f32_16x16x32_bf16 a[204:207], a[208:211], v[60:63], a[204:207]
  v_exp_f32 v91, v91
  v_mfma_f32_16x16x32_bf16 v[200:203], a[8:11], v[56:59], v[200:203]
  buffer_load_dwordx4 v2, s[20:23], s29 offen offset:3072 sc1 lds
  ds_read_b128 a[52:55], v3 offset:5120
  v_mfma_f32_16x16x32_bf16 v[232:235], a[8:11], v[60:63], v[232:235]
  s_xor_b32 s27, s27, 0x4000
  v_exp_f32 v92, v92
  v_mfma_f32_16x16x32_bf16 v[204:207], a[12:15], v[56:59], v[204:207]
  s_add_u32 s29, s29, 0x8000
  ds_read_b128 a[56:59], v3 offset:6144
  v_cvt_pk_bf16_f32 v45, v90, v91
  v_mfma_f32_16x16x32_bf16 v[236:239], a[12:15], v[60:63], v[236:239]
  v_exp_f32 v93, v93
  v_mfma_f32_16x16x32_bf16 v[208:211], a[16:19], v[56:59], v[208:211]
  ds_read_b128 a[60:63], v3 offset:7168
  v_cvt_pk_bf16_f32 v46, v92, v93
  v_mfma_f32_16x16x32_bf16 v[240:243], a[16:19], v[60:63], v[240:243]
  v_exp_f32 v94, v94
  v_mfma_f32_16x16x32_bf16 v[212:215], a[20:23], v[56:59], v[212:215]
  ds_read_b128 a[0:3], v3 offset:8192
  v_mfma_f32_16x16x32_bf16 v[244:247], a[20:23], v[60:63], v[244:247]
  v_exp_f32 v95, v95
  v_mfma_f32_16x16x32_bf16 v[216:219], a[24:27], v[56:59], v[216:219]
  ds_read_b128 a[4:7], v3 offset:9216
  v_cvt_pk_bf16_f32 v47, v94, v95
  v_mfma_f32_16x16x32_bf16 v[248:251], a[24:27], v[60:63], v[248:251]
  v_mfma_f32_16x16x32_bf16 v[220:223], a[28:31], v[56:59], v[220:223]
  s_waitcnt vmcnt(12)
  s_barrier
  v_mfma_f32_16x16x32_bf16 v[252:255], a[28:31], v[60:63], v[252:255]
  ds_read_b128 a[8:11], v3 offset:10240
  s_branch La_so
La_e0:
  s_waitcnt lgkmcnt(7)
  v_mfma_f32_16x16x32_bf16 v[104:107], a[32:35], a[176:179], v[28:31]
  buffer_load_dwordx2 v[12:13], v14, s[96:99], s91 offen sc1
  ds_read_b128 a[12:15], v3 offset:11264
  v_mfma_f32_16x16x32_bf16 v[104:107], a[36:39], a[180:183], v[104:107]
  v_cndmask_b32 v64, v64, v5, s[32:33]
  v_exp_f32 v64, v64
  v_mfma_f32_16x16x32_bf16 v[104:107], a[40:43], a[184:187], v[104:107]
  v_cndmask_b32 v65, v65, v5, s[34:35]
  v_exp_f32 v65, v65
  v_mfma_f32_16x16x32_bf16 v[104:107], a[44:47], a[188:191], v[104:107]
  s_waitcnt lgkmcnt(4)
  v_cndmask_b32 v66, v66, v5, s[36:37]
  v_exp_f32 v66, v66
  v_mfma_f32_16x16x32_bf16 v[108:111], a[48:51], a[176:179], v[28:31]
  v_cndmask_b32 v67, v67, v5, s[38:39]
  v_exp_f32 v67, v67
  v_mfma_f32_16x16x32_bf16 v[108:111], a[52:55], a[180:183], v[108:111]
  ds_read_b128 a[16:19], v3 offset:12288
  ds_read_b128 a[20:23], v3 offset:13312
  v_mfma_f32_16x16x32_bf16 v[108:111], a[56:59], a[184:187], v[108:111]
  v_cndmask_b32 v68, v68, v5, s[40:41]
  v_exp_f32 v68, v68
  v_mfma_f32_16x16x32_bf16 v[108:111], a[60:63], a[188:191], v[108:111]
  s_waitcnt lgkmcnt(2)
  v_cndmask_b32 v69, v69, v5, s[42:43]
  v_exp_f32 v69, v69
  v_mfma_f32_16x16x32_bf16 v[120:123], a[0:3], a[176:179], v[28:31]
  ds_read_b128 a[24:27], v3 offset:14336
  ds_read_b128 a[28:31], v3 offset:15360
  v_mfma_f32_16x16x32_bf16 v[120:123], a[4:7], a[180:183], v[120:123]
  v_cndmask_b32 v70, v70, v5, s[44:45]
  v_exp_f32 v70, v70
  v_mfma_f32_16x16x32_bf16 v[120:123], a[8:11], a[184:187], v[120:123]
  v_cndmask_b32 v71, v71, v5, s[46:47]
  v_exp_f32 v71, v71
  v_mfma_f32_16x16x32_bf16 v[120:123], a[12:15], a[188:191], v[120:123]
  s_waitcnt lgkmcnt(0)
  ds_read_b128 a[32:35], v4 offset:0
  ds_read_b128 a[36:39], v4 offset:1024
  v_mfma_f32_16x16x32_bf16 v[124:127], a[16:19], a[176:179], v[28:31]
  v_exp_f32 v72, v72
  v_mfma_f32_16x16x32_bf16 v[124:127], a[20:23], a[180:183], v[124:127]
  ds_read_b128 a[40:43], v4 offset:2048
  ds_read_b128 a[44:47], v4 offset:3072
  ds_read_b128 a[48:51], v4 offset:4096
  v_mfma_f32_16x16x32_bf16 v[124:127], a[24:27], a[184:187], v[124:127]
  ds_read_b128 a[52:55], v4 offset:5120
  ds_read_b128 a[56:59], v4 offset:6144
  ds_read_b128 a[60:63], v4 offset:7168
  v_exp_f32 v73, v73
  v_mfma_f32_16x16x32_bf16 v[124:127], a[28:31], a[188:191], v[124:127]
  s_waitcnt lgkmcnt(0)
  v_exp_f32 v74, v74
  v_mfma_f32_16x16x32_bf16 v[192:195], a[32:35], v[48:51], v[192:195]
  ds_read_b128 a[0:3], v4 offset:8192
  ds_read_b128 a[4:7], v4 offset:9216
  v_mfma_f32_16x16x32_bf16 v[224:227], a[32:35], v[52:55], v[224:227]
  v_exp_f32 v75, v75
  v_mfma_f32_16x16x32_bf16 a[200:203], a[208:211], v[48:51], a[200:203]
  v_exp_f32 v76, v76
  v_mfma_f32_16x16x32_bf16 v[196:199], a[36:39], v[48:51], v[196:199]
  ds_read_b128 a[8:11], v4 offset:10240
  ds_read_b128 a[12:15], v4 offset:11264
  v_mfma_f32_16x16x32_bf16 v[228:231], a[36:39], v[52:55], v[228:231]
  v_exp_f32 v77, v77
  v_mfma_f32_16x16x32_bf16 a[204:207], a[208:211], v[52:55], a[204:207]
  v_exp_f32 v78, v78
  v_mfma_f32_16x16x32_bf16 v[200:203], a[40:43], v[48:51], v[200:203]
  ds_read_b128 a[16:19], v4 offset:12288
  ds_read_b128 a[20:23], v4 offset:13312
  v_mfma_f32_16x16x32_bf16 v[232:235], a[40:43], v[52:55], v[232:235]
  v_exp_f32 v79, v79
  v_mfma_f32_16x16x32_bf16 v[204:207], a[44:47], v[48:51], v[204:207]
  ds_read_b128 a[24:27], v4 offset:14336
  v_cvt_pk_bf16_f32 v32, v64, v65
  v_mfma_f32_16x16x32_bf16 v[236:239], a[44:47], v[52:55], v[236:239]
  v_cndmask_b32 v80, v80, v5, s[48:49]
  v_exp_f32 v80, v80
  v_mfma_f32_16x16x32_bf16 v[208:211], a[48:51], v[48:51], v[208:211]
  v_cndmask_b32 v81, v81, v5, s[50:51]
  v_exp_f32 v81, v81
  v_mfma_f32_16x16x32_bf16 v[240:243], a[48:51], v[52:55], v[240:243]
  ds_read_b128 a[28:31], v4 offset:15360
  v_xor_b32 v4, 0x8000, v4
  v_cvt_pk_bf16_f32 v40, v80, v81
  v_mfma_f32_16x16x32_bf16 v[212:215], a[52:55], v[48:51], v[212:215]
  v_cndmask_b32 v82, v82, v5, s[52:53]
  v_exp_f32 v82, v82
  v_mfma_f32_16x16x32_bf16 v[244:247], a[52:55], v[52:55], v[244:247]
  v_cndmask_b32 v83, v83, v5, s[54:55]
  v_exp_f32 v83, v83
  v_mfma_f32_16x16x32_bf16 v[216:219], a[56:59], v[48:51], v[216:219]
  ds_read_b128 a[32:35], v4 offset:0
  ds_read_b128 a[36:39], v4 offset:1024
  v_cvt_pk_bf16_f32 v41, v82, v83
  v_mfma_f32_16x16x32_bf16 v[248:251], a[56:59], v[52:55], v[248:251]
  v_cndmask_b32 v84, v84, v5, s[56:57]
  v_exp_f32 v84, v84
  v_mfma_f32_16x16x32_bf16 v[220:223], a[60:63], v[48:51], v[220:223]
  v_cndmask_b32 v85, v85, v5, s[58:59]
  v_exp_f32 v85, v85
  v_mfma_f32_16x16x32_bf16 v[252:255], a[60:63], v[52:55], v[252:255]
  s_waitcnt lgkmcnt(2)
  ds_read_b128 a[40:43], v4 offset:2048
  v_cvt_pk_bf16_f32 v33, v66, v67
  v_cvt_pk_bf16_f32 v42, v84, v85
  v_mfma_f32_16x16x32_bf16 v[192:195], a[0:3], v[56:59], v[192:195]
  v_cndmask_b32 v86, v86, v5, s[60:61]
  v_exp_f32 v86, v86
  v_mfma_f32_16x16x32_bf16 v[224:227], a[0:3], v[60:63], v[224:227]
  v_cndmask_b32 v87, v87, v5, s[62:63]
  v_exp_f32 v87, v87
  v_mfma_f32_16x16x32_bf16 a[200:203], a[208:211], v[56:59], a[200:203]
  ds_read_b128 a[44:47], v4 offset:3072
  v_cvt_pk_bf16_f32 v34, v68, v69
  v_cvt_pk_bf16_f32 v43, v86, v87
  v_mfma_f32_16x16x32_bf16 v[196:199], a[4:7], v[56:59], v[196:199]
  v_exp_f32 v88, v88
  v_mfma_f32_16x16x32_bf16 v[228:231], a[4:7], v[60:63], v[228:231]
  ds_read_b128 a[48:51], v4 offset:4096
  v_cvt_pk_bf16_f32 v35, v70, v71
  v_mfma_f32_16x16x32_bf16 a[204:207], a[208:211], v[60:63], a[204:207]
  v_exp_f32 v89, v89
  v_mfma_f32_16x16x32_bf16 v[200:203], a[8:11], v[56:59], v[200:203]
  v_exp_f32 v90, v90
  v_cvt_pk_bf16_f32 v44, v88, v89
  v_mfma_f32_16x16x32_bf16 v[232:235], a[8:11], v[60:63], v[232:235]
  ds_read_b128 a[52:55], v4 offset:5120
  v_cvt_pk_bf16_f32 v36, v72, v73
  v_mfma_f32_16x16x32_bf16 v[204:207], a[12:15], v[56:59], v[204:207]
  v_exp_f32 v91, v91
  v_mfma_f32_16x16x32_bf16 v[236:239], a[12:15], v[60:63], v[236:239]
  v_exp_f32 v92, v92
  v_cvt_pk_bf16_f32 v45, v90, v91
  v_mfma_f32_16x16x32_bf16 v[208:211], a[16:19], v[56:59], v[208:211]
  ds_read_b128 a[56:59], v4 offset:6144
  ds_read_b128 a[60:63], v4 offset:7168
  v_mfma_f32_16x16x32_bf16 v[240:243], a[16:19], v[60:63], v[240:243]
  v_exp_f32 v93, v93
  v_mfma_f32_16x16x32_bf16 v[212:215], a[20:23], v[56:59], v[212:215]
  v_exp_f32 v94, v94
  v_cvt_pk_bf16_f32 v46, v92, v93
  v_mfma_f32_16x16x32_bf16 v[244:247], a[20:23], v[60:63], v[244:247]
  ds_read_b128 a[0:3], v4 offset:8192
  v_cvt_pk_bf16_f32 v37, v74, v75
  v_mfma_f32_16x16x32_bf16 v[216:219], a[24:27], v[56:59], v[216:219]
  v_exp_f32 v95, v95
  v_mfma_f32_16x16x32_bf16 v[248:251], a[24:27], v[60:63], v[248:251]
  ds_read_b128 a[4:7], v4 offset:9216
  v_cvt_pk_bf16_f32 v38, v76, v77
  v_cvt_pk_bf16_f32 v47, v94, v95
  v_mfma_f32_16x16x32_bf16 v[220:223], a[28:31], v[56:59], v[220:223]
  s_waitcnt vmcnt(0)
  s_barrier
  v_mfma_f32_16x16x32_bf16 v[252:255], a[28:31], v[60:63], v[252:255]
  ds_read_b128 a[8:11], v4 offset:10240
  v_cvt_pk_bf16_f32 v39, v78, v79
La_e1:
  s_mov_b32 s5, 0x40000
Lpoll_7:
  v_cmp_ne_u64 vcc, s[94:95], v[12:13]
  s_nop 0
  s_cbranch_vccz Lpolld_8
  s_sleep 4
  buffer_load_dwordx2 v[12:13], v14, s[96:99], s91 offen sc1
  s_sub_u32 s5, s5, 1
  s_waitcnt vmcnt(0)
  s_cbranch_scc0 Lpoll_7
Lpolld_8:
  s_add_u32 s64, s79, 131072
  v_accvgpr_read_b32 v10, a212
  v_accvgpr_read_b32 v11, a213
  v_accvgpr_read_b32 v12, a214
  v_accvgpr_read_b32 v13, a215
  s_mov_b32 s12, s80
  s_mov_b32 s13, s81
  s_mov_b32 s14, 2097152
  s_mov_b32 s15, 0x00020000
  s_lshl_b32 s93, s77, 20
  s_lshl_b32 s72, s76, 8
  s_add_u32 s93, s93, s72
  s_add_u32 s72, s73, s76
  s_and_b32 s31, s72, 3
  s_lshl_b32 s31, s31, 3
  s_or_b32 s31, s31, 0x80000
  s_bfe_u32 s30, 0x70702, s31
  s_add_u32 s30, s30, 0
  s_and_b32 s30, s30, 7
  s_lshl_b32 s72, s30, 17
  s_add_u32 s71, s93, s72
  s_add_u32 s8, s86, 83886080
  s_addc_u32 s9, s87, 0
  s_mov_b32 s10, 4194304
  s_mov_b32 s11, 0x00020000
  s_lshl_b32 s92, s73, 1
  s_add_u32 s92, s92, s77
  s_lshl_b32 s92, s92, 17
  s_add_u32 s92, s92, s79
  s_add_u32 s72, s73, s76
  s_and_b32 s1, s72, 3
  s_lshl_b32 s1, s1, 3
  s_or_b32 s1, s1, 0x80000
  s_bfe_u32 s0, 0x70702, s1
  s_add_u32 s0, s0, 0
  s_and_b32 s0, s0, 7
  s_lshl_b32 s72, s0, 14
  s_add_u32 s70, s92, s72
  s_waitcnt lgkmcnt(3)
  v_mfma_f32_16x16x32_bf16 v[192:195], a[32:35], v[32:35], v[192:195]
  s_add_u32 m0, s79, 147456
  ds_read_b128 a[12:15], v4 offset:11264
  v_cndmask_b32 v104, v104, v5, s[32:33]
  v_mfma_f32_16x16x32_bf16 v[224:227], a[32:35], v[36:39], v[224:227]
  v_exp_f32 v104, v104
  v_mfma_f32_16x16x32_bf16 a[200:203], a[208:211], v[32:35], a[200:203]
  v_cndmask_b32 v105, v105, v5, s[34:35]
  v_exp_f32 v105, v105
  v_mfma_f32_16x16x32_bf16 v[196:199], a[36:39], v[32:35], v[196:199]
  buffer_load_dwordx4 v10, s[12:15], s71 offen offset:0 lds
  ds_read_b128 a[16:19], v4 offset:12288
  v_mfma_f32_16x16x32_bf16 v[228:231], a[36:39], v[36:39], v[228:231]
  v_cndmask_b32 v106, v106, v5, s[36:37]
  v_exp_f32 v106, v106
  v_mfma_f32_16x16x32_bf16 a[204:207], a[208:211], v[36:39], a[204:207]
  buffer_load_dwordx4 v11, s[12:15], s71 offen offset:1024 lds
  v_cndmask_b32 v107, v107, v5, s[38:39]
  v_mfma_f32_16x16x32_bf16 v[200:203], a[40:43], v[32:35], v[200:203]
  v_exp_f32 v107, v107
  v_mfma_f32_16x16x32_bf16 v[232:235], a[40:43], v[36:39], v[232:235]
  ds_read_b128 a[20:23], v4 offset:13312
  v_cndmask_b32 v108, v108, v5, s[40:41]
  v_mfma_f32_16x16x32_bf16 v[204:207], a[44:47], v[32:35], v[204:207]
  v_exp_f32 v108, v108
  v_mfma_f32_16x16x32_bf16 v[236:239], a[44:47], v[36:39], v[236:239]
  buffer_load_dwordx4 v12, s[12:15], s71 offen offset:2048 lds
  ds_read_b128 a[24:27], v4 offset:14336
  v_mfma_f32_16x16x32_bf16 v[208:211], a[48:51], v[32:35], v[208:211]
  v_cndmask_b32 v109, v109, v5, s[42:43]
  v_exp_f32 v109, v109
  v_mfma_f32_16x16x32_bf16 v[240:243], a[48:51], v[36:39], v[240:243]
  ds_read_b128 a[28:31], v4 offset:15360
  v_xor_b32 v4, 0x4000, v4
  v_mfma_f32_16x16x32_bf16 v[212:215], a[52:55], v[32:35], v[212:215]
  v_cndmask_b32 v110, v110, v5, s[44:45]
  v_exp_f32 v110, v110
  v_mfma_f32_16x16x32_bf16 v[244:247], a[52:55], v[36:39], v[244:247]
  buffer_load_dwordx4 v13, s[12:15], s71 offen offset:3072 lds
  ds_read_b128 a[32:35], v4 offset:0
  v_mfma_f32_16x16x32_bf16 v[216:219], a[56:59], v[32:35], v[216:219]
  s_bfe_u32 s72, 0x3020106, s31
  v_cndmask_b32 v111, v111, v5, s[46:47]
  v_exp_f32 v111, v111
  v_mfma_f32_16x16x32_bf16 v[248:251], a[56:59], v[36:39], v[248:251]
  s_add_u32 s30, s30, s72
  s_add_u32 s31, s31, 8
  s_and_b32 s31, s31, 0x8001f
  v_mfma_f32_16x16x32_bf16 v[220:223], a[60:63], v[32:35], v[220:223]
  s_and_b32 s30, s30, 7
  s_lshl_b32 s72, s30, 17
  s_add_u32 s71, s93, s72
  v_mfma_f32_16x16x32_bf16 v[252:255], a[60:63], v[36:39], v[252:255]
  s_waitcnt lgkmcnt(1)
  v_cndmask_b32 v120, v120, v5, s[48:49]
  v_exp_f32 v120, v120
  v_mfma_f32_16x16x32_bf16 v[192:195], a[0:3], v[40:43], v[192:195]
  s_add_u32 m0, s79, 131072
  ds_read_b128 a[36:39], v4 offset:1024
  ds_read_b128 a[40:43], v4 offset:2048
  v_mfma_f32_16x16x32_bf16 v[224:227], a[0:3], v[44:47], v[224:227]
  v_cndmask_b32 v121, v121, v5, s[50:51]
  v_exp_f32 v121, v121
  v_mfma_f32_16x16x32_bf16 a[200:203], a[208:211], v[40:43], a[200:203]
  buffer_load_dwordx4 v2, s[8:11], s70 offen offset:0 sc1 lds
  ds_read_b128 a[44:47], v4 offset:3072
  v_mfma_f32_16x16x32_bf16 v[196:199], a[4:7], v[40:43], v[196:199]
  v_cndmask_b32 v122, v122, v5, s[52:53]
  v_exp_f32 v122, v122
  v_mfma_f32_16x16x32_bf16 v[228:231], a[4:7], v[44:47], v[228:231]
  buffer_load_dwordx4 v2, s[8:11], s70 offen offset:1024 sc1 lds
  ds_read_b128 a[48:51], v4 offset:4096
  v_mfma_f32_16x16x32_bf16 a[204:207], a[208:211], v[44:47], a[204:207]
  v_cndmask_b32 v123, v123, v5, s[54:55]
  v_exp_f32 v123, v123
  v_mfma_f32_16x16x32_bf16 v[200:203], a[8:11], v[40:43], v[200:203]
  buffer_load_dwordx4 v2, s[8:11], s70 offen offset:2048 sc1 lds
  ds_read_b128 a[52:55], v4 offset:5120
  v_cvt_pk_bf16_f32 v61, v122, v123
  v_mfma_f32_16x16x32_bf16 v[232:235], a[8:11], v[44:47], v[232:235]
  v_cndmask_b32 v124, v124, v5, s[56:57]
  v_exp_f32 v124, v124
  v_mfma_f32_16x16x32_bf16 v[204:207], a[12:15], v[40:43], v[204:207]
  ds_read_b128 a[56:59], v4 offset:6144
  v_cvt_pk_bf16_f32 v52, v104, v105
  v_mfma_f32_16x16x32_bf16 v[236:239], a[12:15], v[44:47], v[236:239]
  v_cndmask_b32 v125, v125, v5, s[58:59]
  v_exp_f32 v125, v125
  v_mfma_f32_16x16x32_bf16 v[208:211], a[16:19], v[40:43], v[208:211]
  buffer_load_dwordx4 v2, s[8:11], s70 offen offset:3072 sc1 lds
  ds_read_b128 a[60:63], v4 offset:7168
  v_cvt_pk_bf16_f32 v62, v124, v125
  v_mfma_f32_16x16x32_bf16 v[240:243], a[16:19], v[44:47], v[240:243]
  s_bfe_u32 s72, 0x3020106, s1
  v_cndmask_b32 v126, v126, v5, s[60:61]
  v_exp_f32 v126, v126
  v_mfma_f32_16x16x32_bf16 v[212:215], a[20:23], v[40:43], v[212:215]
  s_add_u32 s0, s0, s72
  s_add_u32 s1, s1, 8
  s_and_b32 s1, s1, 0x8001f
  v_mfma_f32_16x16x32_bf16 v[244:247], a[20:23], v[44:47], v[244:247]
  s_and_b32 s0, s0, 7
  v_cndmask_b32 v127, v127, v5, s[62:63]
  v_exp_f32 v127, v127
  v_mfma_f32_16x16x32_bf16 v[216:219], a[24:27], v[40:43], v[216:219]
  s_lshl_b32 s72, s0, 14
  s_add_u32 s70, s92, s72
  ds_read_b128 a[0:3], v4 offset:8192
  v_cvt_pk_bf16_f32 v63, v126, v127
  v_mfma_f32_16x16x32_bf16 v[248:251], a[24:27], v[44:47], v[248:251]
  ds_read_b128 a[4:7], v4 offset:9216
  v_cvt_pk_bf16_f32 v53, v106, v107
  v_mfma_f32_16x16x32_bf16 v[220:223], a[28:31], v[40:43], v[220:223]
  ds_read_b128 a[8:11], v4 offset:10240
  v_cvt_pk_bf16_f32 v54, v108, v109
  v_mfma_f32_16x16x32_bf16 v[252:255], a[28:31], v[44:47], v[252:255]
  v_cvt_pk_bf16_f32 v55, v110, v111
  v_cvt_pk_bf16_f32 v60, v120, v121
  s_waitcnt lgkmcnt(7)
  v_mfma_f32_16x16x32_bf16 v[224:227], a[32:35], v[52:55], v[224:227]
  s_add_u32 m0, s79, 49152
  ds_read_b128 a[12:15], v4 offset:11264
  v_mfma_f32_16x16x32_bf16 a[204:207], a[208:211], v[52:55], a[204:207]
  buffer_load_dwordx4 v10, s[12:15], s71 offen offset:0 lds
  v_mfma_f32_16x16x32_bf16 v[228:231], a[36:39], v[52:55], v[228:231]
  buffer_load_dwordx4 v11, s[12:15], s71 offen offset:1024 lds
  ds_read_b128 a[16:19], v4 offset:12288
  v_mfma_f32_16x16x32_bf16 v[232:235], a[40:43], v[52:55], v[232:235]
  buffer_load_dwordx4 v12, s[12:15], s71 offen offset:2048 lds
  ds_read_b128 a[20:23], v4 offset:13312
  v_mfma_f32_16x16x32_bf16 v[236:239], a[44:47], v[52:55], v[236:239]
  s_waitcnt lgkmcnt(6)
  ds_read_b128 a[24:27], v4 offset:14336
  v_mfma_f32_16x16x32_bf16 v[240:243], a[48:51], v[52:55], v[240:243]
  buffer_load_dwordx4 v13, s[12:15], s71 offen offset:3072 lds
  ds_read_b128 a[28:31], v4 offset:15360
  v_mfma_f32_16x16x32_bf16 v[244:247], a[52:55], v[52:55], v[244:247]
  s_bfe_u32 s72, 0x3020106, s31
  s_add_u32 s30, s30, s72
  s_add_u32 s31, s31, 8
  v_mfma_f32_16x16x32_bf16 v[248:251], a[56:59], v[52:55], v[248:251]
  s_and_b32 s31, s31, 0x8001f
  s_and_b32 s30, s30, 7
  s_lshl_b32 s72, s30, 17
  v_mfma_f32_16x16x32_bf16 v[252:255], a[60:63], v[52:55], v[252:255]
  s_waitcnt lgkmcnt(4)
  s_add_u32 s71, s93, s72
  s_add_u32 m0, s79, 32768
  v_mfma_f32_16x16x32_bf16 v[224:227], a[0:3], v[60:63], v[224:227]
  buffer_load_dwordx4 v2, s[8:11], s70 offen offset:0 sc1 lds
  v_mfma_f32_16x16x32_bf16 a[204:207], a[208:211], v[60:63], a[204:207]
  buffer_load_dwordx4 v2, s[8:11], s70 offen offset:1024 sc1 lds
  v_mfma_f32_16x16x32_bf16 v[228:231], a[4:7], v[60:63], v[228:231]
  buffer_load_dwordx4 v2, s[8:11], s70 offen offset:2048 sc1 lds
  v_mfma_f32_16x16x32_bf16 v[232:235], a[8:11], v[60:63], v[232:235]
  buffer_load_dwordx4 v2, s[8:11], s70 offen offset:3072 sc1 lds
  v_mfma_f32_16x16x32_bf16 v[236:239], a[12:15], v[60:63], v[236:239]
  s_waitcnt lgkmcnt(0)
  s_bfe_u32 s72, 0x3020106, s1
  s_add_u32 s0, s0, s72
  v_mfma_f32_16x16x32_bf16 v[240:243], a[16:19], v[60:63], v[240:243]
  s_add_u32 s1, s1, 8
  s_and_b32 s1, s1, 0x8001f
  s_and_b32 s0, s0, 7
  v_mfma_f32_16x16x32_bf16 v[244:247], a[20:23], v[60:63], v[244:247]
  s_lshl_b32 s72, s0, 14
  s_add_u32 s70, s92, s72
  v_mfma_f32_16x16x32_bf16 v[248:251], a[24:27], v[60:63], v[248:251]
  v_mfma_f32_16x16x32_bf16 v[252:255], a[28:31], v[60:63], v[252:255]
  s_and_b32 s88, s25, 1
  s_lshl_b32 s88, s88, 1
  s_add_u32 s88, s88, 14
  s_sub_u32 s88, s88, s25
  s_lshl_b32 s4, s88, 20
  s_lshl_b32 s5, s24, 15
  s_add_u32 s4, s4, s5
  s_lshl_b32 s5, s3, 11
  s_add_u32 s4, s4, s5
  v_accvgpr_read_b32 v6, a200
  v_accvgpr_read_b32 v8, a204
  s_mov_b32 s5, 0x5f800000
  v_cmp_ngt_f32 vcc, s5, v6
  v_rcp_f32 v6, v6
  s_or_b32 s89, s89, vcc_lo
  s_or_b32 s89, s89, vcc_hi
  v_mov_b32 v7, v6
  v_cmp_ngt_f32 vcc, s5, v8
  v_rcp_f32 v8, v8
  s_or_b32 s89, s89, vcc_lo
  s_or_b32 s89, s89, vcc_hi
  v_mov_b32 v9, v8
  v_pk_mul_f32 v[192:193], v[192:193], v[6:7]
  v_pk_mul_f32 v[194:195], v[194:195], v[6:7]
  v_pk_mul_f32 v[196:197], v[196:197], v[6:7]
  v_pk_mul_f32 v[198:199], v[198:199], v[6:7]
  v_cvt_pk_bf16_f32 v192, v192, v193
  v_cvt_pk_bf16_f32 v193, v194, v195
  v_cvt_pk_bf16_f32 v194, v196, v197
  v_cvt_pk_bf16_f32 v195, v198, v199
  buffer_store_dwordx4 v[192:195], v2, s[16:19], s4 offen offset:0 sc1
  v_pk_mul_f32 v[224:225], v[224:225], v[8:9]
  v_pk_mul_f32 v[226:227], v[226:227], v[8:9]
  v_pk_mul_f32 v[228:229], v[228:229], v[8:9]
  v_pk_mul_f32 v[230:231], v[230:231], v[8:9]
  v_cvt_pk_bf16_f32 v224, v224, v225
  v_cvt_pk_bf16_f32 v225, v226, v227
  v_cvt_pk_bf16_f32 v226, v228, v229
  v_cvt_pk_bf16_f32 v227, v230, v231
  buffer_store_dwordx4 v[224:227], v2, s[16:19], s4 offen offset:1024 sc1
  s_add_u32 s4, s4, 8192
  v_pk_mul_f32 v[200:201], v[200:201], v[6:7]
  v_pk_mul_f32 v[202:203], v[202:203], v[6:7]
  v_pk_mul_f32 v[204:205], v[204:205], v[6:7]
  v_pk_mul_f32 v[206:207], v[206:207], v[6:7]
  v_cvt_pk_bf16_f32 v200, v200, v201
  v_cvt_pk_bf16_f32 v201, v202, v203
  v_cvt_pk_bf16_f32 v202, v204, v205
  v_cvt_pk_bf16_f32 v203, v206, v207
  buffer_store_dwordx4 v[200:203], v2, s[16:19], s4 offen offset:0 sc1
  v_pk_mul_f32 v[232:233], v[232:233], v[8:9]
  v_pk_mul_f32 v[234:235], v[234:235], v[8:9]
  v_pk_mul_f32 v[236:237], v[236:237], v[8:9]
  v_pk_mul_f32 v[238:239], v[238:239], v[8:9]
  v_cvt_pk_bf16_f32 v232, v232, v233
  v_cvt_pk_bf16_f32 v233, v234, v235
  v_cvt_pk_bf16_f32 v234, v236, v237
  v_cvt_pk_bf16_f32 v235, v238, v239
  buffer_store_dwordx4 v[232:235], v2, s[16:19], s4 offen offset:1024 sc1
  s_add_u32 s4, s4, 8192
  v_pk_mul_f32 v[208:209], v[208:209], v[6:7]
  v_pk_mul_f32 v[210:211], v[210:211], v[6:7]
  v_pk_mul_f32 v[212:213], v[212:213], v[6:7]
  v_pk_mul_f32 v[214:215], v[214:215], v[6:7]
  v_cvt_pk_bf16_f32 v208, v208, v209
  v_cvt_pk_bf16_f32 v209, v210, v211
  v_cvt_pk_bf16_f32 v210, v212, v213
  v_cvt_pk_bf16_f32 v211, v214, v215
  buffer_store_dwordx4 v[208:211], v2, s[16:19], s4 offen offset:0 sc1
  v_pk_mul_f32 v[240:241], v[240:241], v[8:9]
  v_pk_mul_f32 v[242:243], v[242:243], v[8:9]
  v_pk_mul_f32 v[244:245], v[244:245], v[8:9]
  v_pk_mul_f32 v[246:247], v[246:247], v[8:9]
  v_cvt_pk_bf16_f32 v240, v240, v241
  v_cvt_pk_bf16_f32 v241, v242, v243
  v_cvt_pk_bf16_f32 v242, v244, v245
  v_cvt_pk_bf16_f32 v243, v246, v247
  buffer_store_dwordx4 v[240:243], v2, s[16:19], s4 offen offset:1024 sc1
  s_add_u32 s4, s4, 8192
  v_pk_mul_f32 v[216:217], v[216:217], v[6:7]
  v_pk_mul_f32 v[218:219], v[218:219], v[6:7]
  v_pk_mul_f32 v[220:221], v[220:221], v[6:7]
  v_pk_mul_f32 v[222:223], v[222:223], v[6:7]
  v_cvt_pk_bf16_f32 v216, v216, v217
  v_cvt_pk_bf16_f32 v217, v218, v219
  v_cvt_pk_bf16_f32 v218, v220, v221
  v_cvt_pk_bf16_f32 v219, v222, v223
  buffer_store_dwordx4 v[216:219], v2, s[16:19], s4 offen offset:0 sc1
  v_pk_mul_f32 v[248:249], v[248:249], v[8:9]
  v_pk_mul_f32 v[250:251], v[250:251], v[8:9]
  v_pk_mul_f32 v[252:253], v[252:253], v[8:9]
  v_pk_mul_f32 v[254:255], v[254:255], v[8:9]
  v_cvt_pk_bf16_f32 v248, v248, v249
  v_cvt_pk_bf16_f32 v249, v250, v251
  v_cvt_pk_bf16_f32 v250, v252, v253
  v_cvt_pk_bf16_f32 v251, v254, v255
  buffer_store_dwordx4 v[248:251], v2, s[16:19], s4 offen offset:1024 sc1
  s_cmp_eq_u32 s89, 0
  s_cbranch_scc1 La_done
  s_waitcnt vmcnt(0)
  s_and_b32 s6, s25, 1
  s_lshl_b32 s6, s6, 1
  s_add_u32 s6, s6, 14
  s_sub_u32 s6, s6, s25
La_sl_blk:
  v_mov_b32 v192, 0
  v_mov_b32 v193, 0
  v_mov_b32 v194, 0
  v_mov_b32 v195, 0
  v_mov_b32 v196, 0
  v_mov_b32 v197, 0
  v_mov_b32 v198, 0
  v_mov_b32 v199, 0
  v_mov_b32 v200, 0
  v_mov_b32 v201, 0
  v_mov_b32 v202, 0
  v_mov_b32 v203, 0
  v_mov_b32 v204, 0
  v_mov_b32 v205, 0
  v_mov_b32 v206, 0
  v_mov_b32 v207, 0
  v_mov_b32 v208, 0
  v_mov_b32 v209, 0
  v_mov_b32 v210, 0
  v_mov_b32 v211, 0
  v_mov_b32 v212, 0
  v_mov_b32 v213, 0
  v_mov_b32 v214, 0
  v_mov_b32 v215, 0
  v_mov_b32 v216, 0
  v_mov_b32 v217, 0
  v_mov_b32 v218, 0
  v_mov_b32 v219, 0
  v_mov_b32 v220, 0
  v_mov_b32 v221, 0
  v_mov_b32 v222, 0
  v_mov_b32 v223, 0
  v_mov_b32 v224, 0
  v_mov_b32 v225, 0
  v_mov_b32 v226, 0
  v_mov_b32 v227, 0
  v_mov_b32 v228, 0
  v_mov_b32 v229, 0
  v_mov_b32 v230, 0
  v_mov_b32 v231, 0
  v_mov_b32 v232, 0
  v_mov_b32 v233, 0
  v_mov_b32 v234, 0
  v_mov_b32 v235, 0
  v_mov_b32 v236, 0
  v_mov_b32 v237, 0
  v_mov_b32 v238, 0
  v_mov_b32 v239, 0
  v_mov_b32 v240, 0
  v_mov_b32 v241, 0
  v_mov_b32 v242, 0
  v_mov_b32 v243, 0
  v_mov_b32 v244, 0
  v_mov_b32 v245, 0
  v_mov_b32 v246, 0
  v_mov_b32 v247, 0
  v_mov_b32 v248, 0
  v_mov_b32 v249, 0
  v_mov_b32 v250, 0
  v_mov_b32 v251, 0
  v_mov_b32 v252, 0
  v_mov_b32 v253, 0
  v_mov_b32 v254, 0
  v_mov_b32 v255, 0
  v_mov_b32 v24, 0
  v_mov_b32 v25, 0
  v_mov_b32 v26, 0
  v_mov_b32 v27, 0
  v_mov_b32 v28, 0
  v_mov_b32 v29, 0
  v_mov_b32 v30, 0
  v_mov_b32 v31, 0
  v_mov_b32 v16, v5
  v_mov_b32 v17, v5
  v_and_b32 v20, 15, v1
  v_lshrrev_b32 v21, 4, v1
  v_sub_u32 v20, v20, v21
  v_lshlrev_b32 v20, 2, v20
  s_lshl_b32 s4, s6, 7
  s_add_u32 s4, s4, s3
  v_add_u32 v20, s4, v20
  v_add_u32 v21, 64, v20
  s_add_u32 s7, s6, 1
  s_lshl_b32 s7, s7, 2
  s_mov_b32 s90, 0
La_sl_loop:
  s_add_u32 s4, s90, 0
  buffer_load_dwordx4 a[0:3], v2, s[20:23], s4 offen offset:0 sc1
  buffer_load_dwordx4 a[4:7], v2, s[20:23], s4 offen offset:1024 sc1
  buffer_load_dwordx4 a[8:11], v2, s[20:23], s4 offen offset:2048 sc1
  buffer_load_dwordx4 a[12:15], v2, s[20:23], s4 offen offset:3072 sc1
  s_add_u32 s4, s90, 4096
  buffer_load_dwordx4 a[16:19], v2, s[20:23], s4 offen offset:0 sc1
  buffer_load_dwordx4 a[20:23], v2, s[20:23], s4 offen offset:1024 sc1
  buffer_load_dwordx4 a[24:27], v2, s[20:23], s4 offen offset:2048 sc1
  buffer_load_dwordx4 a[28:31], v2, s[20:23], s4 offen offset:3072 sc1
  s_add_u32 s4, s90, 16384
  buffer_load_dwordx4 a[32:35], v2, s[20:23], s4 offen offset:0 sc1
  buffer_load_dwordx4 a[36:39], v2, s[20:23], s4 offen offset:1024 sc1
  buffer_load_dwordx4 a[40:43], v2, s[20:23], s4 offen offset:2048 sc1
  buffer_load_dwordx4 a[44:47], v2, s[20:23], s4 offen offset:3072 sc1
  s_add_u32 s4, s90, 20480
  buffer_load_dwordx4 a[48:51], v2, s[20:23], s4 offen offset:0 sc1
  buffer_load_dwordx4 a[52:55], v2, s[20:23], s4 offen offset:1024 sc1
  buffer_load_dwordx4 a[56:59], v2, s[20:23], s4 offen offset:2048 sc1
  buffer_load_dwordx4 a[60:63], v2, s[20:23], s4 offen offset:3072 sc1
  s_waitcnt vmcnt(0)
  v_mfma_f32_16x16x32_bf16 v[64:67], a[0:3], a[160:163], 0
  v_mfma_f32_16x16x32_bf16 v[72:75], a[0:3], a[176:179], 0
  v_mfma_f32_16x16x32_bf16 v[64:67], a[4:7], a[164:167], v[64:67]
  v_mfma_f32_16x16x32_bf16 v[72:75], a[4:7], a[180:183], v[72:75]
  v_mfma_f32_16x16x32_bf16 v[64:67], a[8:11], a[168:171], v[64:67]
  v_mfma_f32_16x16x32_bf16 v[72:75], a[8:11], a[184:187], v[72:75]
  v_mfma_f32_16x16x32_bf16 v[64:67], a[12:15], a[172:175], v[64:67]
  v_mfma_f32_16x16x32_bf16 v[72:75], a[12:15], a[188:191], v[72:75]
  v_mfma_f32_16x16x32_bf16 v[68:71], a[16:19], a[160:163], 0
  v_mfma_f32_16x16x32_bf16 v[76:79], a[16:19], a[176:179], 0
  v_mfma_f32_16x16x32_bf16 v[68:71], a[20:23], a[164:167], v[68:71]
  v_mfma_f32_16x16x32_bf16 v[76:79], a[20:23], a[180:183], v[76:79]
  v_mfma_f32_16x16x32_bf16 v[68:71], a[24:27], a[168:171], v[68:71]
  v_mfma_f32_16x16x32_bf16 v[76:79], a[24:27], a[184:187], v[76:79]
  v_mfma_f32_16x16x32_bf16 v[68:71], a[28:31], a[172:175], v[68:71]
  v_mfma_f32_16x16x32_bf16 v[76:79], a[28:31], a[188:191], v[76:79]
  v_cmp_gt_i32 vcc, 0, v20
  s_nop 1
  v_cndmask_b32 v64, v64, v5, vcc
  v_cmp_gt_i32 vcc, 1, v20
  s_nop 1
  v_cndmask_b32 v65, v65, v5, vcc
  v_cmp_gt_i32 vcc, 2, v20
  s_nop 1
  v_cndmask_b32 v66, v66, v5, vcc
  v_cmp_gt_i32 vcc, 3, v20
  s_nop 1
  v_cndmask_b32 v67, v67, v5, vcc
  v_cmp_gt_i32 vcc, 16, v20
  s_nop 1
  v_cndmask_b32 v68, v68, v5, vcc
  v_cmp_gt_i32 vcc, 17, v20
  s_nop 1
  v_cndmask_b32 v69, v69, v5, vcc
  v_cmp_gt_i32 vcc, 18, v20
  s_nop 1
  v_cndmask_b32 v70, v70, v5, vcc
  v_cmp_gt_i32 vcc, 19, v20
  s_nop 1
  v_cndmask_b32 v71, v71, v5, vcc
  v_subrev_u32 v20, 32, v20
  v_max3_f32 v6, v64, v65, v66
  v_max3_f32 v7, v67, v68, v69
  v_max3_f32 v6, v6, v70, v71
  v_max_f32 v6, v6, v7
  v_cmp_gt_i32 vcc, 0, v21
  s_nop 1
  v_cndmask_b32 v72, v72, v5, vcc
  v_cmp_gt_i32 vcc, 1, v21
  s_nop 1
  v_cndmask_b32 v73, v73, v5, vcc
  v_cmp_gt_i32 vcc, 2, v21
  s_nop 1
  v_cndmask_b32 v74, v74, v5, vcc
  v_cmp_gt_i32 vcc, 3, v21
  s_nop 1
  v_cndmask_b32 v75, v75, v5, vcc
  v_cmp_gt_i32 vcc, 16, v21
  s_nop 1
  v_cndmask_b32 v76, v76, v5, vcc
  v_cmp_gt_i32 vcc, 17, v21
  s_nop 1
  v_cndmask_b32 v77, v77, v5, vcc
  v_cmp_gt_i32 vcc, 18, v21
  s_nop 1
  v_cndmask_b32 v78, v78, v5, vcc
  v_cmp_gt_i32 vcc, 19, v21
  s_nop 1
  v_cndmask_b32 v79, v79, v5, vcc
  v_subrev_u32 v21, 32, v21
  v_max3_f32 v8, v72, v73, v74
  v_max3_f32 v9, v75, v76, v77
  v_max3_f32 v8, v8, v78, v79
  v_max_f32 v8, v8, v9
  v_mov_b32 v7, v6
  v_mov_b32 v9, v8
  s_nop 0
  v_permlane32_swap_b32 v6, v7
  v_permlane32_swap_b32 v8, v9
  v_max_f32 v6, v6, v7
  v_max_f32 v8, v8, v9
  v_mov_b32 v7, v6
  v_mov_b32 v9, v8
  s_nop 0
  v_permlane16_swap_b32 v6, v7
  v_permlane16_swap_b32 v8, v9
  v_max_f32 v6, v6, v7
  v_max_f32 v8, v8, v9
  v_max_f32 v6, v6, v16
  v_sub_f32 v7, v16, v6
  v_exp_f32 v7, v7
  v_mov_b32 v16, v6
  v_sub_f32 v64, v64, v16
  v_sub_f32 v65, v65, v16
  v_sub_f32 v66, v66, v16
  v_sub_f32 v67, v67, v16
  v_sub_f32 v68, v68, v16
  v_sub_f32 v69, v69, v16
  v_sub_f32 v70, v70, v16
  v_sub_f32 v71, v71, v16
  v_exp_f32 v64, v64
  v_exp_f32 v65, v65
  v_exp_f32 v66, v66
  v_exp_f32 v67, v67
  v_exp_f32 v68, v68
  v_exp_f32 v69, v69
  v_exp_f32 v70, v70
  v_exp_f32 v71, v71
  v_mul_f32 v24, v24, v7
  v_mul_f32 v25, v25, v7
  v_mul_f32 v26, v26, v7
  v_mul_f32 v27, v27, v7
  v_mul_f32 v192, v192, v7
  v_mul_f32 v193, v193, v7
  v_mul_f32 v194, v194, v7
  v_mul_f32 v195, v195, v7
  v_mul_f32 v196, v196, v7
  v_mul_f32 v197, v197, v7
  v_mul_f32 v198, v198, v7
  v_mul_f32 v199, v199, v7
  v_mul_f32 v200, v200, v7
  v_mul_f32 v201, v201, v7
  v_mul_f32 v202, v202, v7
  v_mul_f32 v203, v203, v7
  v_mul_f32 v204, v204, v7
  v_mul_f32 v205, v205, v7
  v_mul_f32 v206, v206, v7
  v_mul_f32 v207, v207, v7
  v_mul_f32 v208, v208, v7
  v_mul_f32 v209, v209, v7
  v_mul_f32 v210, v210, v7
  v_mul_f32 v211, v211, v7
  v_mul_f32 v212, v212, v7
  v_mul_f32 v213, v213, v7
  v_mul_f32 v214, v214, v7
  v_mul_f32 v215, v215, v7
  v_mul_f32 v216, v216, v7
  v_mul_f32 v217, v217, v7
  v_mul_f32 v218, v218, v7
  v_mul_f32 v219, v219, v7
  v_mul_f32 v220, v220, v7
  v_mul_f32 v221, v221, v7
  v_mul_f32 v222, v222, v7
  v_mul_f32 v223, v223, v7
  v_cvt_pk_bf16_f32 v32, v64, v65
  v_cvt_pk_bf16_f32 v33, v66, v67
  v_cvt_pk_bf16_f32 v34, v68, v69
  v_cvt_pk_bf16_f32 v35, v70, v71
  v_max_f32 v8, v8, v17
  v_sub_f32 v9, v17, v8
  v_exp_f32 v9, v9
  v_mov_b32 v17, v8
  v_sub_f32 v72, v72, v17
  v_sub_f32 v73, v73, v17
  v_sub_f32 v74, v74, v17
  v_sub_f32 v75, v75, v17
  v_sub_f32 v76, v76, v17
  v_sub_f32 v77, v77, v17
  v_sub_f32 v78, v78, v17
  v_sub_f32 v79, v79, v17
  v_exp_f32 v72, v72
  v_exp_f32 v73, v73
  v_exp_f32 v74, v74
  v_exp_f32 v75, v75
  v_exp_f32 v76, v76
  v_exp_f32 v77, v77
  v_exp_f32 v78, v78
  v_exp_f32 v79, v79
  v_mul_f32 v28, v28, v9
  v_mul_f32 v29, v29, v9
  v_mul_f32 v30, v30, v9
  v_mul_f32 v31, v31, v9
  v_mul_f32 v224, v224, v9
  v_mul_f32 v225, v225, v9
  v_mul_f32 v226, v226, v9
  v_mul_f32 v227, v227, v9
  v_mul_f32 v228, v228, v9
  v_mul_f32 v229, v229, v9
  v_mul_f32 v230, v230, v9
  v_mul_f32 v231, v231, v9
  v_mul_f32 v232, v232, v9
  v_mul_f32 v233, v233, v9
  v_mul_f32 v234, v234, v9
  v_mul_f32 v235, v235, v9
  v_mul_f32 v236, v236, v9
  v_mul_f32 v237, v237, v9
  v_mul_f32 v238, v238, v9
  v_mul_f32 v239, v239, v9
  v_mul_f32 v240, v240, v9
  v_mul_f32 v241, v241, v9
  v_mul_f32 v242, v242, v9
  v_mul_f32 v243, v243, v9
  v_mul_f32 v244, v244, v9
  v_mul_f32 v245, v245, v9
  v_mul_f32 v246, v246, v9
  v_mul_f32 v247, v247, v9
  v_mul_f32 v248, v248, v9
  v_mul_f32 v249, v249, v9
  v_mul_f32 v250, v250, v9
  v_mul_f32 v251, v251, v9
  v_mul_f32 v252, v252, v9
  v_mul_f32 v253, v253, v9
  v_mul_f32 v254, v254, v9
  v_mul_f32 v255, v255, v9
  v_cvt_pk_bf16_f32 v36, v72, v73
  v_cvt_pk_bf16_f32 v37, v74, v75
  v_cvt_pk_bf16_f32 v38, v76, v77
  v_cvt_pk_bf16_f32 v39, v78, v79
  v_mfma_f32_16x16x32_bf16 v[24:27], a[208:211], v[32:35], v[24:27]
  v_mfma_f32_16x16x32_bf16 v[192:195], a[32:35], v[32:35], v[192:195]
  v_mfma_f32_16x16x32_bf16 v[196:199], a[36:39], v[32:35], v[196:199]
  v_mfma_f32_16x16x32_bf16 v[200:203], a[40:43], v[32:35], v[200:203]
  v_mfma_f32_16x16x32_bf16 v[204:207], a[44:47], v[32:35], v[204:207]
  v_mfma_f32_16x16x32_bf16 v[208:211], a[48:51], v[32:35], v[208:211]
  v_mfma_f32_16x16x32_bf16 v[212:215], a[52:55], v[32:35], v[212:215]
  v_mfma_f32_16x16x32_bf16 v[216:219], a[56:59], v[32:35], v[216:219]
  v_mfma_f32_16x16x32_bf16 v[220:223], a[60:63], v[32:35], v[220:223]
  v_mfma_f32_16x16x32_bf16 v[28:31], a[208:211], v[36:39], v[28:31]
  v_mfma_f32_16x16x32_bf16 v[224:227], a[32:35], v[36:39], v[224:227]
  v_mfma_f32_16x16x32_bf16 v[228:231], a[36:39], v[36:39], v[228:231]
  v_mfma_f32_16x16x32_bf16 v[232:235], a[40:43], v[36:39], v[232:235]
  v_mfma_f32_16x16x32_bf16 v[236:239], a[44:47], v[36:39], v[236:239]
  v_mfma_f32_16x16x32_bf16 v[240:243], a[48:51], v[36:39], v[240:243]
  v_mfma_f32_16x16x32_bf16 v[244:247], a[52:55], v[36:39], v[244:247]
  v_mfma_f32_16x16x32_bf16 v[248:251], a[56:59], v[36:39], v[248:251]
  v_mfma_f32_16x16x32_bf16 v[252:255], a[60:63], v[36:39], v[252:255]
  s_add_u32 s90, s90, 8192
  s_and_b32 s4, s90, 0x4000
  s_add_u32 s90, s90, s4
  s_sub_u32 s7, s7, 1
  s_cmp_lg_u32 s7, 0
  s_cbranch_scc1 La_sl_loop
  s_lshl_b32 s4, s6, 20
  s_lshl_b32 s5, s24, 15
  s_add_u32 s4, s4, s5
  s_lshl_b32 s5, s3, 11
  s_add_u32 s4, s4, s5
  v_rcp_f32 v6, v24
  s_nop 0
  v_mov_b32 v7, v6
  v_rcp_f32 v8, v28
  s_nop 0
  v_mov_b32 v9, v8
  v_pk_mul_f32 v[192:193], v[192:193], v[6:7]
  v_pk_mul_f32 v[194:195], v[194:195], v[6:7]
  v_pk_mul_f32 v[196:197], v[196:197], v[6:7]
  v_pk_mul_f32 v[198:199], v[198:199], v[6:7]
  v_cvt_pk_bf16_f32 v192, v192, v193
  v_cvt_pk_bf16_f32 v193, v194, v195
  v_cvt_pk_bf16_f32 v194, v196, v197
  v_cvt_pk_bf16_f32 v195, v198, v199
  buffer_store_dwordx4 v[192:195], v2, s[16:19], s4 offen offset:0 sc1
  v_pk_mul_f32 v[224:225], v[224:225], v[8:9]
  v_pk_mul_f32 v[226:227], v[226:227], v[8:9]
  v_pk_mul_f32 v[228:229], v[228:229], v[8:9]
  v_pk_mul_f32 v[230:231], v[230:231], v[8:9]
  v_cvt_pk_bf16_f32 v224, v224, v225
  v_cvt_pk_bf16_f32 v225, v226, v227
  v_cvt_pk_bf16_f32 v226, v228, v229
  v_cvt_pk_bf16_f32 v227, v230, v231
  buffer_store_dwordx4 v[224:227], v2, s[16:19], s4 offen offset:1024 sc1
  s_add_u32 s4, s4, 8192
  v_pk_mul_f32 v[200:201], v[200:201], v[6:7]
  v_pk_mul_f32 v[202:203], v[202:203], v[6:7]
  v_pk_mul_f32 v[204:205], v[204:205], v[6:7]
  v_pk_mul_f32 v[206:207], v[206:207], v[6:7]
  v_cvt_pk_bf16_f32 v200, v200, v201
  v_cvt_pk_bf16_f32 v201, v202, v203
  v_cvt_pk_bf16_f32 v202, v204, v205
  v_cvt_pk_bf16_f32 v203, v206, v207
  buffer_store_dwordx4 v[200:203], v2, s[16:19], s4 offen offset:0 sc1
  v_pk_mul_f32 v[232:233], v[232:233], v[8:9]
  v_pk_mul_f32 v[234:235], v[234:235], v[8:9]
  v_pk_mul_f32 v[236:237], v[236:237], v[8:9]
  v_pk_mul_f32 v[238:239], v[238:239], v[8:9]
  v_cvt_pk_bf16_f32 v232, v232, v233
  v_cvt_pk_bf16_f32 v233, v234, v235
  v_cvt_pk_bf16_f32 v234, v236, v237
  v_cvt_pk_bf16_f32 v235, v238, v239
  buffer_store_dwordx4 v[232:235], v2, s[16:19], s4 offen offset:1024 sc1
  s_add_u32 s4, s4, 8192
  v_pk_mul_f32 v[208:209], v[208:209], v[6:7]
  v_pk_mul_f32 v[210:211], v[210:211], v[6:7]
  v_pk_mul_f32 v[212:213], v[212:213], v[6:7]
  v_pk_mul_f32 v[214:215], v[214:215], v[6:7]
  v_cvt_pk_bf16_f32 v208, v208, v209
  v_cvt_pk_bf16_f32 v209, v210, v211
  v_cvt_pk_bf16_f32 v210, v212, v213
  v_cvt_pk_bf16_f32 v211, v214, v215
  buffer_store_dwordx4 v[208:211], v2, s[16:19], s4 offen offset:0 sc1
  v_pk_mul_f32 v[240:241], v[240:241], v[8:9]
  v_pk_mul_f32 v[242:243], v[242:243], v[8:9]
  v_pk_mul_f32 v[244:245], v[244:245], v[8:9]
  v_pk_mul_f32 v[246:247], v[246:247], v[8:9]
  v_cvt_pk_bf16_f32 v240, v240, v241
  v_cvt_pk_bf16_f32 v241, v242, v243
  v_cvt_pk_bf16_f32 v242, v244, v245
  v_cvt_pk_bf16_f32 v243, v246, v247
  buffer_store_dwordx4 v[240:243], v2, s[16:19], s4 offen offset:1024 sc1
  s_add_u32 s4, s4, 8192
  v_pk_mul_f32 v[216:217], v[216:217], v[6:7]
  v_pk_mul_f32 v[218:219], v[218:219], v[6:7]
  v_pk_mul_f32 v[220:221], v[220:221], v[6:7]
  v_pk_mul_f32 v[222:223], v[222:223], v[6:7]
  v_cvt_pk_bf16_f32 v216, v216, v217
  v_cvt_pk_bf16_f32 v217, v218, v219
  v_cvt_pk_bf16_f32 v218, v220, v221
  v_cvt_pk_bf16_f32 v219, v222, v223
  buffer_store_dwordx4 v[216:219], v2, s[16:19], s4 offen offset:0 sc1
  v_pk_mul_f32 v[248:249], v[248:249], v[8:9]
  v_pk_mul_f32 v[250:251], v[250:251], v[8:9]
  v_pk_mul_f32 v[252:253], v[252:253], v[8:9]
  v_pk_mul_f32 v[254:255], v[254:255], v[8:9]
  v_cvt_pk_bf16_f32 v248, v248, v249
  v_cvt_pk_bf16_f32 v249, v250, v251
  v_cvt_pk_bf16_f32 v250, v252, v253
  v_cvt_pk_bf16_f32 v251, v254, v255
  buffer_store_dwordx4 v[248:251], v2, s[16:19], s4 offen offset:1024 sc1
  s_cmp_eq_u32 s6, s25
  s_cbranch_scc1 La_done
  v_accvgpr_read_b32 v64, a128
  v_accvgpr_read_b32 v65, a129
  v_accvgpr_read_b32 v66, a130
  v_accvgpr_read_b32 v67, a131
  v_accvgpr_read_b32 v68, a132
  v_accvgpr_read_b32 v69, a133
  v_accvgpr_read_b32 v70, a134
  v_accvgpr_read_b32 v71, a135
  v_accvgpr_read_b32 v72, a136
  v_accvgpr_read_b32 v73, a137
  v_accvgpr_read_b32 v74, a138
  v_accvgpr_read_b32 v75, a139
  v_accvgpr_read_b32 v76, a140
  v_accvgpr_read_b32 v77, a141
  v_accvgpr_read_b32 v78, a142
  v_accvgpr_read_b32 v79, a143
  v_accvgpr_read_b32 v80, a144
  v_accvgpr_read_b32 v81, a145
  v_accvgpr_read_b32 v82, a146
  v_accvgpr_read_b32 v83, a147
  v_accvgpr_read_b32 v84, a148
  v_accvgpr_read_b32 v85, a149
  v_accvgpr_read_b32 v86, a150
  v_accvgpr_read_b32 v87, a151
  v_accvgpr_read_b32 v88, a152
  v_accvgpr_read_b32 v89, a153
  v_accvgpr_read_b32 v90, a154
  v_accvgpr_read_b32 v91, a155
  v_accvgpr_read_b32 v92, a156
  v_accvgpr_read_b32 v93, a157
  v_accvgpr_read_b32 v94, a158
  v_accvgpr_read_b32 v95, a159
  v_accvgpr_write_b32 a160, v64
  v_accvgpr_write_b32 a161, v65
  v_accvgpr_write_b32 a162, v66
  v_accvgpr_write_b32 a163, v67
  v_accvgpr_write_b32 a164, v68
  v_accvgpr_write_b32 a165, v69
  v_accvgpr_write_b32 a166, v70
  v_accvgpr_write_b32 a167, v71
  v_accvgpr_write_b32 a168, v72
  v_accvgpr_write_b32 a169, v73
  v_accvgpr_write_b32 a170, v74
  v_accvgpr_write_b32 a171, v75
  v_accvgpr_write_b32 a172, v76
  v_accvgpr_write_b32 a173, v77
  v_accvgpr_write_b32 a174, v78
  v_accvgpr_write_b32 a175, v79
  v_accvgpr_write_b32 a176, v80
  v_accvgpr_write_b32 a177, v81
  v_accvgpr_write_b32 a178, v82
  v_accvgpr_write_b32 a179, v83
  v_accvgpr_write_b32 a180, v84
  v_accvgpr_write_b32 a181, v85
  v_accvgpr_write_b32 a182, v86
  v_accvgpr_write_b32 a183, v87
  v_accvgpr_write_b32 a184, v88
  v_accvgpr_write_b32 a185, v89
  v_accvgpr_write_b32 a186, v90
  v_accvgpr_write_b32 a187, v91
  v_accvgpr_write_b32 a188, v92
  v_accvgpr_write_b32 a189, v93
  v_accvgpr_write_b32 a190, v94
  v_accvgpr_write_b32 a191, v95
  s_mov_b32 s6, s25
  s_branch La_sl_blk
La_done:
  s_lshr_b32 s4, s3, 1
  s_lshl_b32 s4, s4, 12
  s_add_u32 s4, s4, 131072
  s_lshl_b32 s5, s77, 11
  s_add_u32 s4, s4, s5
  v_add_u32 v16, s4, v2
  v_xor_b32 v17, 0x800, v16
  s_and_b32 s4, s3, 1
  s_lshl_b32 s4, s4, 13
  s_add_u32 s4, s4, 131072
  v_lshrrev_b32 v24, 2, v1
  v_and_b32 v25, 6, v24
  v_lshlrev_b32 v24, 7, v24
  v_and_b32 v26, 1, v1
  v_lshl_add_u32 v24, v26, 3, v24
  v_add_u32 v24, s4, v24
  v_bfe_u32 v26, v1, 1, 1
  v_xor_b32 v25, v25, v26
  v_xor_b32 v26, 0, v25
  v_lshl_add_u32 v18, v26, 4, v24
  v_xor_b32 v26, 2, v25
  v_lshl_add_u32 v19, v26, 4, v24
  v_xor_b32 v26, 4, v25
  v_lshl_add_u32 v20, v26, 4, v24
  v_xor_b32 v26, 6, v25
  v_lshl_add_u32 v21, v26, 4, v24
  s_mov_b32 s65, 0
  s_mov_b32 s67, 4294868992
  s_mov_b32 s68, 32768
  s_mov_b32 s65, 3
  s_lshl_b32 s36, s24, 7
  s_add_u32 s36, s36, 65536
  s_and_b32 s37, s25, 1
  s_lshl_b32 s37, s37, 1
  s_add_u32 s37, s37, 14
  s_sub_u32 s37, s37, s25
  s_lshl_b32 s37, s37, 12
  s_add_u32 s37, s37, s36
  s_lshl_b32 s38, s25, 12
  s_add_u32 s36, s36, s38
  s_lshl_b32 s38, s78, 1
  s_add_u32 s38, s38, s77
  s_lshl_b32 s38, s38, 7
  s_add_u32 s38, s38, 163840
  s_lshl_b32 s91, s73, 12
  s_add_u32 s91, s91, 65536
  s_lshl_b32 s39, s78, 1
  s_add_u32 s39, s39, s77
  s_xor_b32 s39, s39, 1
  s_lshl_b32 s39, s39, 7
  s_add_u32 s39, s39, 163840
  s_sub_u32 s39, s39, s91
  v_mov_b32 v8, 0x40000000
  v_mov_b32 v6, s94
  v_cmp_eq_u32 vcc, 0, v0
  v_mov_b32 v7, s95
  s_nop 0
  v_cndmask_b32_e64 v8, v8, 0, vcc
  v_lshlrev_b32 v14, 7, v1
  v_mov_b32 v9, s39
  v_cmp_gt_u32 vcc, 32, v1
  s_nop 1
  v_cndmask_b32 v14, v9, v14, vcc
  s_waitcnt vmcnt(16)
  s_barrier
  ds_read_b128 a[64:67], v16 offset:0
  ds_read_b64_tr_b16 a[96:97], v18 offset:16384
  ds_read_b64_tr_b16 a[98:99], v18 offset:18432
  ds_read_b128 a[68:71], v16 offset:1024
  ds_read_b128 a[72:75], v17 offset:0
  ds_read_b128 a[76:79], v17 offset:1024
  ds_read_b64_tr_b16 a[100:101], v19 offset:16384
  ds_read_b64_tr_b16 a[102:103], v19 offset:18432
  ds_read_b64_tr_b16 a[104:105], v20 offset:16384
  ds_read_b64_tr_b16 a[106:107], v20 offset:18432
  ds_read_b64_tr_b16 a[108:109], v21 offset:16384
  ds_read_b64_tr_b16 a[110:111], v21 offset:18432
  s_waitcnt lgkmcnt(0)
  v_mfma_f32_16x16x32_bf16 v[32:35], a[96:99], a[64:67], 0
  s_add_u32 m0, s79, 81920
  ds_read_b128 a[80:83], v16 offset:8192
  ds_read_b64_tr_b16 a[112:113], v18 offset:20480
  v_mfma_f32_16x16x32_bf16 v[48:51], a[96:99], a[68:71], 0
  buffer_load_dwordx4 v10, s[12:15], s71 offen offset:0 lds
  ds_read_b64_tr_b16 a[114:115], v18 offset:22528
  v_mfma_f32_16x16x32_bf16 v[64:67], a[96:99], a[72:75], 0
  buffer_load_dwordx4 v11, s[12:15], s71 offen offset:1024 lds
  ds_read_b128 a[84:87], v16 offset:9216
  v_mfma_f32_16x16x32_bf16 v[80:83], a[96:99], a[76:79], 0
  buffer_load_dwordx4 v12, s[12:15], s71 offen offset:2048 lds
  ds_read_b128 a[88:91], v17 offset:8192
  v_mfma_f32_16x16x32_bf16 v[36:39], a[100:103], a[64:67], 0
  buffer_load_dwordx4 v13, s[12:15], s71 offen offset:3072 lds
  ds_read_b128 a[92:95], v17 offset:9216
  v_mfma_f32_16x16x32_bf16 v[52:55], a[100:103], a[68:71], 0
  s_bfe_u32 s72, 0x3020106, s31
  s_add_u32 s30, s30, s72
  s_add_u32 s31, s31, 8
  v_mfma_f32_16x16x32_bf16 v[68:71], a[100:103], a[72:75], 0
  s_and_b32 s31, s31, 0x8001f
  s_and_b32 s30, s30, 7
  s_lshl_b32 s72, s30, 17
  v_mfma_f32_16x16x32_bf16 v[84:87], a[100:103], a[76:79], 0
  s_add_u32 s71, s93, s72
  s_add_u32 m0, s79, 65536
  ds_read_b64_tr_b16 a[116:117], v19 offset:20480
  v_mfma_f32_16x16x32_bf16 v[40:43], a[104:107], a[64:67], 0
  buffer_load_dwordx4 v2, s[8:11], s70 offen offset:0 sc1 lds
  ds_read_b64_tr_b16 a[118:119], v19 offset:22528
  v_mfma_f32_16x16x32_bf16 v[56:59], a[104:107], a[68:71], 0
  buffer_load_dwordx4 v2, s[8:11], s70 offen offset:1024 sc1 lds
  ds_read_b64_tr_b16 a[120:121], v20 offset:20480
  v_mfma_f32_16x16x32_bf16 v[72:75], a[104:107], a[72:75], 0
  buffer_load_dwordx4 v2, s[8:11], s70 offen offset:2048 sc1 lds
  ds_read_b64_tr_b16 a[122:123], v20 offset:22528
  v_mfma_f32_16x16x32_bf16 v[88:91], a[104:107], a[76:79], 0
  buffer_load_dwordx4 v2, s[8:11], s70 offen offset:3072 sc1 lds
  ds_read_b64_tr_b16 a[124:125], v21 offset:20480
  v_mfma_f32_16x16x32_bf16 v[44:47], a[108:111], a[64:67], 0
  s_bfe_u32 s72, 0x3020106, s1
  s_add_u32 s0, s0, s72
  s_add_u32 s1, s1, 8
  v_mfma_f32_16x16x32_bf16 v[60:63], a[108:111], a[68:71], 0
  s_and_b32 s1, s1, 0x8001f
  s_and_b32 s0, s0, 7
  s_lshl_b32 s72, s0, 14
  v_mfma_f32_16x16x32_bf16 v[76:79], a[108:111], a[72:75], 0
  s_add_u32 s70, s92, s72
  ds_read_b64_tr_b16 a[126:127], v21 offset:22528
  v_mfma_f32_16x16x32_bf16 v[92:95], a[108:111], a[76:79], 0
  s_add_u32 s65, s65, 1
  s_cmp_eq_u32 s65, 4
  s_cselect_b32 s65, 0, s65
  s_cselect_b32 s66, s67, s68
  v_add_u32 v16, s66, v16
  v_add_u32 v17, s66, v17
  v_add_u32 v18, s66, v18
  v_add_u32 v19, s66, v19
  v_add_u32 v20, s66, v20
  v_add_u32 v21, s66, v21
  s_waitcnt vmcnt(8) lgkmcnt(0)
  s_barrier
  v_mfma_f32_16x16x32_bf16 v[32:35], a[112:115], a[80:83], v[32:35]
  buffer_store_dwordx2 v[6:7], v8, s[96:99], s36 offen sc1
  ds_read_b128 a[64:67], v16 offset:0
  v_mfma_f32_16x16x32_bf16 v[48:51], a[112:115], a[84:87], v[48:51]
  buffer_store_dwordx2 v[6:7], v8, s[96:99], s37 offen sc1
  ds_read_b64_tr_b16 a[96:97], v18 offset:16384
  v_mfma_f32_16x16x32_bf16 v[64:67], a[112:115], a[88:91], v[64:67]
  ds_read_b64_tr_b16 a[98:99], v18 offset:18432
  ds_read_b128 a[68:71], v16 offset:1024
  v_mfma_f32_16x16x32_bf16 v[80:83], a[112:115], a[92:95], v[80:83]
  buffer_store_dwordx2 v[6:7], v8, s[96:99], s38 offen sc1
  ds_read_b128 a[72:75], v17 offset:0
  v_mfma_f32_16x16x32_bf16 v[36:39], a[116:119], a[80:83], v[36:39]
  s_add_u32 m0, s79, 114688
  ds_read_b128 a[76:79], v17 offset:1024
  ds_read_b64_tr_b16 a[100:101], v19 offset:16384
  v_mfma_f32_16x16x32_bf16 v[52:55], a[116:119], a[84:87], v[52:55]
  buffer_load_dwordx4 v10, s[12:15], s71 offen offset:0 lds
  ds_read_b64_tr_b16 a[102:103], v19 offset:18432
  v_mfma_f32_16x16x32_bf16 v[68:71], a[116:119], a[88:91], v[68:71]
  buffer_load_dwordx4 v11, s[12:15], s71 offen offset:1024 lds
  ds_read_b64_tr_b16 a[104:105], v20 offset:16384
  v_mfma_f32_16x16x32_bf16 v[84:87], a[116:119], a[92:95], v[84:87]
  buffer_load_dwordx4 v12, s[12:15], s71 offen offset:2048 lds
  ds_read_b64_tr_b16 a[106:107], v20 offset:18432
  v_mfma_f32_16x16x32_bf16 v[40:43], a[120:123], a[80:83], v[40:43]
  ds_read_b64_tr_b16 a[108:109], v21 offset:16384
  ds_read_b64_tr_b16 a[110:111], v21 offset:18432
  v_mfma_f32_16x16x32_bf16 v[56:59], a[120:123], a[84:87], v[56:59]
  buffer_load_dwordx4 v13, s[12:15], s71 offen offset:3072 lds
  v_mfma_f32_16x16x32_bf16 v[72:75], a[120:123], a[88:91], v[72:75]
  s_bfe_u32 s72, 0x3020106, s31
  s_add_u32 s30, s30, s72
  s_add_u32 s31, s31, 8
  v_mfma_f32_16x16x32_bf16 v[88:91], a[120:123], a[92:95], v[88:91]
  s_and_b32 s31, s31, 0x8001f
  s_and_b32 s30, s30, 7
  s_lshl_b32 s72, s30, 17
  v_mfma_f32_16x16x32_bf16 v[44:47], a[124:127], a[80:83], v[44:47]
  s_add_u32 s71, s93, s72
  s_add_u32 m0, s79, 98304
  v_mfma_f32_16x16x32_bf16 v[60:63], a[124:127], a[84:87], v[60:63]
  buffer_load_dwordx4 v2, s[8:11], s70 offen offset:0 sc1 lds
  v_mfma_f32_16x16x32_bf16 v[76:79], a[124:127], a[88:91], v[76:79]
  buffer_load_dwordx4 v2, s[8:11], s70 offen offset:1024 sc1 lds
  v_mfma_f32_16x16x32_bf16 v[92:95], a[124:127], a[92:95], v[92:95]
  buffer_load_dwordx4 v2, s[8:11], s70 offen offset:2048 sc1 lds
  s_waitcnt lgkmcnt(0)
  v_mfma_f32_16x16x32_bf16 v[32:35], a[96:99], a[64:67], v[32:35]
  buffer_load_dwordx4 v2, s[8:11], s70 offen offset:3072 sc1 lds
  ds_read_b128 a[80:83], v16 offset:8192
  v_mfma_f32_16x16x32_bf16 v[48:51], a[96:99], a[68:71], v[48:51]
  s_bfe_u32 s72, 0x3020106, s1
  s_add_u32 s0, s0, s72
  s_add_u32 s1, s1, 8
  v_mfma_f32_16x16x32_bf16 v[64:67], a[96:99], a[72:75], v[64:67]
  s_and_b32 s1, s1, 0x8001f
  s_and_b32 s0, s0, 7
  s_lshl_b32 s72, s0, 14
  v_mfma_f32_16x16x32_bf16 v[80:83], a[96:99], a[76:79], v[80:83]
  s_add_u32 s70, s92, s72
  s_add_u32 m0, s64, 16384
  ds_read_b64_tr_b16 a[112:113], v18 offset:20480
  v_mfma_f32_16x16x32_bf16 v[36:39], a[100:103], a[64:67], v[36:39]
  buffer_load_dwordx4 v10, s[12:15], s71 offen offset:0 lds
  ds_read_b64_tr_b16 a[114:115], v18 offset:22528
  v_mfma_f32_16x16x32_bf16 v[52:55], a[100:103], a[68:71], v[52:55]
  buffer_load_dwordx4 v11, s[12:15], s71 offen offset:1024 lds
  ds_read_b128 a[84:87], v16 offset:9216
  v_mfma_f32_16x16x32_bf16 v[68:71], a[100:103], a[72:75], v[68:71]
  buffer_load_dwordx4 v12, s[12:15], s71 offen offset:2048 lds
  ds_read_b128 a[88:91], v17 offset:8192
  v_mfma_f32_16x16x32_bf16 v[84:87], a[100:103], a[76:79], v[84:87]
  buffer_load_dwordx4 v13, s[12:15], s71 offen offset:3072 lds
  ds_read_b128 a[92:95], v17 offset:9216
  v_mfma_f32_16x16x32_bf16 v[40:43], a[104:107], a[64:67], v[40:43]
  s_bfe_u32 s72, 0x3020106, s31
  s_add_u32 s30, s30, s72
  s_add_u32 s31, s31, 8
  v_mfma_f32_16x16x32_bf16 v[56:59], a[104:107], a[68:71], v[56:59]
  s_and_b32 s31, s31, 0x8001f
  s_and_b32 s30, s30, 7
  s_lshl_b32 s72, s30, 17
  v_mfma_f32_16x16x32_bf16 v[72:75], a[104:107], a[72:75], v[72:75]
  s_add_u32 s71, s93, s72
  s_mov_b32 m0, s64
  ds_read_b64_tr_b16 a[116:117], v19 offset:20480
  v_mfma_f32_16x16x32_bf16 v[88:91], a[104:107], a[76:79], v[88:91]
  buffer_load_dwordx4 v2, s[8:11], s70 offen offset:0 sc1 lds
  ds_read_b64_tr_b16 a[118:119], v19 offset:22528
  v_mfma_f32_16x16x32_bf16 v[44:47], a[108:111], a[64:67], v[44:47]
  buffer_load_dwordx4 v2, s[8:11], s70 offen offset:1024 sc1 lds
  ds_read_b64_tr_b16 a[120:121], v20 offset:20480
  v_mfma_f32_16x16x32_bf16 v[60:63], a[108:111], a[68:71], v[60:63]
  buffer_load_dwordx4 v2, s[8:11], s70 offen offset:2048 sc1 lds
  ds_read_b64_tr_b16 a[122:123], v20 offset:22528
  v_mfma_f32_16x16x32_bf16 v[76:79], a[108:111], a[72:75], v[76:79]
  buffer_load_dwordx4 v2, s[8:11], s70 offen offset:3072 sc1 lds
  ds_read_b64_tr_b16 a[124:125], v21 offset:20480
  ds_read_b64_tr_b16 a[126:127], v21 offset:22528
  v_mfma_f32_16x16x32_bf16 v[92:95], a[108:111], a[76:79], v[92:95]
  s_bfe_u32 s72, 0x3020106, s1
  s_add_u32 s0, s0, s72
  s_add_u32 s1, s1, 8
  s_and_b32 s1, s1, 0x8001f
  s_and_b32 s0, s0, 7
  s_lshl_b32 s72, s0, 14
  s_add_u32 s70, s92, s72
  s_add_u32 s64, s64, s66
  s_add_u32 s65, s65, 1
  s_cmp_eq_u32 s65, 4
  s_cselect_b32 s65, 0, s65
  s_cselect_b32 s66, s67, s68
  v_add_u32 v16, s66, v16
  v_add_u32 v17, s66, v17
  v_add_u32 v18, s66, v18
  v_add_u32 v19, s66, v19
  v_add_u32 v20, s66, v20
  v_add_u32 v21, s66, v21
  s_waitcnt vmcnt(19) lgkmcnt(0)
  s_barrier
  v_mfma_f32_16x16x32_bf16 v[32:35], a[112:115], a[80:83], v[32:35]
  s_add_u32 s16, s86, 100663296
  s_addc_u32 s17, s87, 0
  s_mov_b32 s18, 16777216
  v_mfma_f32_16x16x32_bf16 v[48:51], a[112:115], a[84:87], v[48:51]
  s_mov_b32 s19, 0x00020000
  s_add_u32 m0, s64, 16384
  ds_read_b128 a[64:67], v16 offset:0
  v_mfma_f32_16x16x32_bf16 v[64:67], a[112:115], a[88:91], v[64:67]
  buffer_load_dwordx4 v10, s[12:15], s71 offen offset:0 lds
  ds_read_b64_tr_b16 a[96:97], v18 offset:16384
  v_mfma_f32_16x16x32_bf16 v[80:83], a[112:115], a[92:95], v[80:83]
  buffer_load_dwordx4 v11, s[12:15], s71 offen offset:1024 lds
  ds_read_b64_tr_b16 a[98:99], v18 offset:18432
  v_mfma_f32_16x16x32_bf16 v[36:39], a[116:119], a[80:83], v[36:39]
  ds_read_b128 a[68:71], v16 offset:1024
  ds_read_b128 a[72:75], v17 offset:0
  v_mfma_f32_16x16x32_bf16 v[52:55], a[116:119], a[84:87], v[52:55]
  ds_read_b128 a[76:79], v17 offset:1024
  ds_read_b64_tr_b16 a[100:101], v19 offset:16384
  v_mfma_f32_16x16x32_bf16 v[68:71], a[116:119], a[88:91], v[68:71]
  ds_read_b64_tr_b16 a[102:103], v19 offset:18432
  ds_read_b64_tr_b16 a[104:105], v20 offset:16384
  v_mfma_f32_16x16x32_bf16 v[84:87], a[116:119], a[92:95], v[84:87]
  buffer_load_dwordx4 v12, s[12:15], s71 offen offset:2048 lds
  ds_read_b64_tr_b16 a[106:107], v20 offset:18432
  v_mfma_f32_16x16x32_bf16 v[40:43], a[120:123], a[80:83], v[40:43]
  ds_read_b64_tr_b16 a[108:109], v21 offset:16384
  ds_read_b64_tr_b16 a[110:111], v21 offset:18432
  v_mfma_f32_16x16x32_bf16 v[56:59], a[120:123], a[84:87], v[56:59]
  v_mfma_f32_16x16x32_bf16 v[72:75], a[120:123], a[88:91], v[72:75]
  v_mfma_f32_16x16x32_bf16 v[88:91], a[120:123], a[92:95], v[88:91]
  buffer_load_dwordx4 v13, s[12:15], s71 offen offset:3072 lds
  v_mfma_f32_16x16x32_bf16 v[44:47], a[124:127], a[80:83], v[44:47]
  s_bfe_u32 s72, 0x3020106, s31
  s_add_u32 s30, s30, s72
  s_add_u32 s31, s31, 8
  v_mfma_f32_16x16x32_bf16 v[60:63], a[124:127], a[84:87], v[60:63]
  s_and_b32 s31, s31, 0x8001f
  s_and_b32 s30, s30, 7
  s_lshl_b32 s72, s30, 17
  v_mfma_f32_16x16x32_bf16 v[76:79], a[124:127], a[88:91], v[76:79]
  s_add_u32 s71, s93, s72
  v_mfma_f32_16x16x32_bf16 v[92:95], a[124:127], a[92:95], v[92:95]
  s_waitcnt lgkmcnt(0)
  v_mfma_f32_16x16x32_bf16 v[32:35], a[96:99], a[64:67], v[32:35]
  s_mov_b32 m0, s64
  ds_read_b128 a[80:83], v16 offset:8192
  ds_read_b64_tr_b16 a[112:113], v18 offset:20480
  v_mfma_f32_16x16x32_bf16 v[48:51], a[96:99], a[68:71], v[48:51]
  buffer_load_dwordx4 v2, s[8:11], s70 offen offset:0 sc1 lds
  ds_read_b64_tr_b16 a[114:115], v18 offset:22528
  v_mfma_f32_16x16x32_bf16 v[64:67], a[96:99], a[72:75], v[64:67]
  buffer_load_dwordx4 v2, s[8:11], s70 offen offset:1024 sc1 lds
  ds_read_b128 a[84:87], v16 offset:9216
  v_mfma_f32_16x16x32_bf16 v[80:83], a[96:99], a[76:79], v[80:83]
  ds_read_b128 a[88:91], v17 offset:8192
  ds_read_b128 a[92:95], v17 offset:9216
  v_mfma_f32_16x16x32_bf16 v[36:39], a[100:103], a[64:67], v[36:39]
  buffer_load_dwordx4 v2, s[8:11], s70 offen offset:2048 sc1 lds
  ds_read_b64_tr_b16 a[116:117], v19 offset:20480
  v_mfma_f32_16x16x32_bf16 v[52:55], a[100:103], a[68:71], v[52:55]
  ds_read_b64_tr_b16 a[118:119], v19 offset:22528
  ds_read_b64_tr_b16 a[120:121], v20 offset:20480
  v_mfma_f32_16x16x32_bf16 v[68:71], a[100:103], a[72:75], v[68:71]
  buffer_load_dwordx4 v2, s[8:11], s70 offen offset:3072 sc1 lds
  ds_read_b64_tr_b16 a[122:123], v20 offset:22528
  v_mfma_f32_16x16x32_bf16 v[84:87], a[100:103], a[76:79], v[84:87]
  s_bfe_u32 s72, 0x3020106, s1
  s_add_u32 s0, s0, s72
  s_add_u32 s1, s1, 8
  v_mfma_f32_16x16x32_bf16 v[40:43], a[104:107], a[64:67], v[40:43]
  s_and_b32 s1, s1, 0x8001f
  s_and_b32 s0, s0, 7
  s_lshl_b32 s72, s0, 14
  v_mfma_f32_16x16x32_bf16 v[56:59], a[104:107], a[68:71], v[56:59]
  s_add_u32 s70, s92, s72
  ds_read_b64_tr_b16 a[124:125], v21 offset:20480
  ds_read_b64_tr_b16 a[126:127], v21 offset:22528
  v_mfma_f32_16x16x32_bf16 v[72:75], a[104:107], a[72:75], v[72:75]
  s_add_u32 s64, s64, s66
  s_add_u32 s65, s65, 1
  s_cmp_eq_u32 s65, 4
  s_cselect_b32 s65, 0, s65
  s_cselect_b32 s66, s67, s68
  v_mfma_f32_16x16x32_bf16 v[88:91], a[104:107], a[76:79], v[88:91]
  v_add_u32 v16, s66, v16
  v_add_u32 v17, s66, v17
  v_mfma_f32_16x16x32_bf16 v[44:47], a[108:111], a[64:67], v[44:47]
  v_add_u32 v18, s66, v18
  v_add_u32 v19, s66, v19
  v_mfma_f32_16x16x32_bf16 v[60:63], a[108:111], a[68:71], v[60:63]
  v_add_u32 v20, s66, v20
  v_add_u32 v21, s66, v21
  v_mfma_f32_16x16x32_bf16 v[76:79], a[108:111], a[72:75], v[76:79]
  v_mfma_f32_16x16x32_bf16 v[92:95], a[108:111], a[76:79], v[92:95]
  s_waitcnt vmcnt(16) lgkmcnt(0)
  s_barrier
  v_mfma_f32_16x16x32_bf16 v[32:35], a[112:115], a[80:83], v[32:35]
  s_add_u32 m0, s64, 16384
  ds_read_b128 a[64:67], v16 offset:0
  ds_read_b64_tr_b16 a[96:97], v18 offset:16384
  v_mfma_f32_16x16x32_bf16 v[48:51], a[112:115], a[84:87], v[48:51]
  buffer_load_dwordx4 v10, s[12:15], s71 offen offset:0 lds
  ds_read_b64_tr_b16 a[98:99], v18 offset:18432
  v_mfma_f32_16x16x32_bf16 v[64:67], a[112:115], a[88:91], v[64:67]
  ds_read_b128 a[68:71], v16 offset:1024
  ds_read_b128 a[72:75], v17 offset:0
  v_mfma_f32_16x16x32_bf16 v[80:83], a[112:115], a[92:95], v[80:83]
  buffer_load_dwordx4 v11, s[12:15], s71 offen offset:1024 lds
  ds_read_b128 a[76:79], v17 offset:1024
  v_mfma_f32_16x16x32_bf16 v[36:39], a[116:119], a[80:83], v[36:39]
  ds_read_b64_tr_b16 a[100:101], v19 offset:16384
  ds_read_b64_tr_b16 a[102:103], v19 offset:18432
  v_mfma_f32_16x16x32_bf16 v[52:55], a[116:119], a[84:87], v[52:55]
  ds_read_b64_tr_b16 a[104:105], v20 offset:16384
  ds_read_b64_tr_b16 a[106:107], v20 offset:18432
  v_mfma_f32_16x16x32_bf16 v[68:71], a[116:119], a[88:91], v[68:71]
  ds_read_b64_tr_b16 a[108:109], v21 offset:16384
  ds_read_b64_tr_b16 a[110:111], v21 offset:18432
  v_mfma_f32_16x16x32_bf16 v[84:87], a[116:119], a[92:95], v[84:87]
  buffer_load_dwordx4 v12, s[12:15], s71 offen offset:2048 lds
  v_mfma_f32_16x16x32_bf16 v[40:43], a[120:123], a[80:83], v[40:43]
  v_mfma_f32_16x16x32_bf16 v[56:59], a[120:123], a[84:87], v[56:59]
  v_mfma_f32_16x16x32_bf16 v[72:75], a[120:123], a[88:91], v[72:75]
  v_mfma_f32_16x16x32_bf16 v[88:91], a[120:123], a[92:95], v[88:91]
  buffer_load_dwordx4 v13, s[12:15], s71 offen offset:3072 lds
  v_mfma_f32_16x16x32_bf16 v[44:47], a[124:127], a[80:83], v[44:47]
  s_bfe_u32 s72, 0x3020106, s31
  s_add_u32 s30, s30, s72
  s_add_u32 s31, s31, 8
  v_mfma_f32_16x16x32_bf16 v[60:63], a[124:127], a[84:87], v[60:63]
  s_and_b32 s31, s31, 0x8001f
  s_and_b32 s30, s30, 7
  s_lshl_b32 s72, s30, 17
  v_mfma_f32_16x16x32_bf16 v[76:79], a[124:127], a[88:91], v[76:79]
  s_add_u32 s71, s93, s72
  v_mfma_f32_16x16x32_bf16 v[92:95], a[124:127], a[92:95], v[92:95]
  s_waitcnt lgkmcnt(0)
  v_mfma_f32_16x16x32_bf16 v[32:35], a[96:99], a[64:67], v[32:35]
  s_mov_b32 m0, s64
  ds_read_b128 a[80:83], v16 offset:8192
  ds_read_b64_tr_b16 a[112:113], v18 offset:20480
  v_mfma_f32_16x16x32_bf16 v[48:51], a[96:99], a[68:71], v[48:51]
  buffer_load_dwordx4 v2, s[8:11], s70 offen offset:0 sc1 lds
  ds_read_b64_tr_b16 a[114:115], v18 offset:22528
  v_mfma_f32_16x16x32_bf16 v[64:67], a[96:99], a[72:75], v[64:67]
  buffer_load_dwordx4 v2, s[8:11], s70 offen offset:1024 sc1 lds
  ds_read_b128 a[84:87], v16 offset:9216
  v_mfma_f32_16x16x32_bf16 v[80:83], a[96:99], a[76:79], v[80:83]
  ds_read_b128 a[88:91], v17 offset:8192
  ds_read_b128 a[92:95], v17 offset:9216
  v_mfma_f32_16x16x32_bf16 v[36:39], a[100:103], a[64:67], v[36:39]
  buffer_load_dwordx4 v2, s[8:11], s70 offen offset:2048 sc1 lds
  ds_read_b64_tr_b16 a[116:117], v19 offset:20480
  v_mfma_f32_16x16x32_bf16 v[52:55], a[100:103], a[68:71], v[52:55]
  ds_read_b64_tr_b16 a[118:119], v19 offset:22528
  ds_read_b64_tr_b16 a[120:121], v20 offset:20480
  v_mfma_f32_16x16x32_bf16 v[68:71], a[100:103], a[72:75], v[68:71]
  buffer_load_dwordx4 v2, s[8:11], s70 offen offset:3072 sc1 lds
  ds_read_b64_tr_b16 a[122:123], v20 offset:22528
  v_mfma_f32_16x16x32_bf16 v[84:87], a[100:103], a[76:79], v[84:87]
  s_bfe_u32 s72, 0x3020106, s1
  s_add_u32 s0, s0, s72
  s_add_u32 s1, s1, 8
  v_mfma_f32_16x16x32_bf16 v[40:43], a[104:107], a[64:67], v[40:43]
  s_and_b32 s1, s1, 0x8001f
  s_and_b32 s0, s0, 7
  s_lshl_b32 s72, s0, 14
  v_mfma_f32_16x16x32_bf16 v[56:59], a[104:107], a[68:71], v[56:59]
  s_add_u32 s70, s92, s72
  ds_read_b64_tr_b16 a[124:125], v21 offset:20480
  ds_read_b64_tr_b16 a[126:127], v21 offset:22528
  v_mfma_f32_16x16x32_bf16 v[72:75], a[104:107], a[72:75], v[72:75]
  s_add_u32 s64, s64, s66
  s_add_u32 s65, s65, 1
  s_cmp_eq_u32 s65, 4
  s_cselect_b32 s65, 0, s65
  s_cselect_b32 s66, s67, s68
  v_mfma_f32_16x16x32_bf16 v[88:91], a[104:107], a[76:79], v[88:91]
  v_add_u32 v16, s66, v16
  v_add_u32 v17, s66, v17
  v_mfma_f32_16x16x32_bf16 v[44:47], a[108:111], a[64:67], v[44:47]
  v_add_u32 v18, s66, v18
  v_add_u32 v19, s66, v19
  v_mfma_f32_16x16x32_bf16 v[60:63], a[108:111], a[68:71], v[60:63]
  v_add_u32 v20, s66, v20
  v_add_u32 v21, s66, v21
  v_mfma_f32_16x16x32_bf16 v[76:79], a[108:111], a[72:75], v[76:79]
  v_mfma_f32_16x16x32_bf16 v[92:95], a[108:111], a[76:79], v[92:95]
  s_waitcnt vmcnt(16) lgkmcnt(0)
  s_barrier
  v_mfma_f32_16x16x32_bf16 v[32:35], a[112:115], a[80:83], v[32:35]
  s_add_u32 m0, s64, 16384
  ds_read_b128 a[64:67], v16 offset:0
  ds_read_b64_tr_b16 a[96:97], v18 offset:16384
  v_mfma_f32_16x16x32_bf16 v[48:51], a[112:115], a[84:87], v[48:51]
  buffer_load_dwordx4 v10, s[12:15], s71 offen offset:0 lds
  ds_read_b64_tr_b16 a[98:99], v18 offset:18432
  v_mfma_f32_16x16x32_bf16 v[64:67], a[112:115], a[88:91], v[64:67]
  ds_read_b128 a[68:71], v16 offset:1024
  ds_read_b128 a[72:75], v17 offset:0
  v_mfma_f32_16x16x32_bf16 v[80:83], a[112:115], a[92:95], v[80:83]
  buffer_load_dwordx4 v11, s[12:15], s71 offen offset:1024 lds
  ds_read_b128 a[76:79], v17 offset:1024
  v_mfma_f32_16x16x32_bf16 v[36:39], a[116:119], a[80:83], v[36:39]
  ds_read_b64_tr_b16 a[100:101], v19 offset:16384
  ds_read_b64_tr_b16 a[102:103], v19 offset:18432
  v_mfma_f32_16x16x32_bf16 v[52:55], a[116:119], a[84:87], v[52:55]
  ds_read_b64_tr_b16 a[104:105], v20 offset:16384
  ds_read_b64_tr_b16 a[106:107], v20 offset:18432
  v_mfma_f32_16x16x32_bf16 v[68:71], a[116:119], a[88:91], v[68:71]
  ds_read_b64_tr_b16 a[108:109], v21 offset:16384
  ds_read_b64_tr_b16 a[110:111], v21 offset:18432
  v_mfma_f32_16x16x32_bf16 v[84:87], a[116:119], a[92:95], v[84:87]
  buffer_load_dwordx4 v12, s[12:15], s71 offen offset:2048 lds
  v_mfma_f32_16x16x32_bf16 v[40:43], a[120:123], a[80:83], v[40:43]
  v_mfma_f32_16x16x32_bf16 v[56:59], a[120:123], a[84:87], v[56:59]
  v_mfma_f32_16x16x32_bf16 v[72:75], a[120:123], a[88:91], v[72:75]
  v_mfma_f32_16x16x32_bf16 v[88:91], a[120:123], a[92:95], v[88:91]
  buffer_load_dwordx4 v13, s[12:15], s71 offen offset:3072 lds
  v_mfma_f32_16x16x32_bf16 v[44:47], a[124:127], a[80:83], v[44:47]
  s_bfe_u32 s72, 0x3020106, s31
  s_add_u32 s30, s30, s72
  s_add_u32 s31, s31, 8
  v_mfma_f32_16x16x32_bf16 v[60:63], a[124:127], a[84:87], v[60:63]
  s_and_b32 s31, s31, 0x8001f
  s_and_b32 s30, s30, 7
  s_lshl_b32 s72, s30, 17
  v_mfma_f32_16x16x32_bf16 v[76:79], a[124:127], a[88:91], v[76:79]
  s_add_u32 s71, s93, s72
  v_mfma_f32_16x16x32_bf16 v[92:95], a[124:127], a[92:95], v[92:95]
  s_waitcnt lgkmcnt(0)
  v_mfma_f32_16x16x32_bf16 v[32:35], a[96:99], a[64:67], v[32:35]
  s_mov_b32 m0, s64
  ds_read_b128 a[80:83], v16 offset:8192
  ds_read_b64_tr_b16 a[112:113], v18 offset:20480
  v_mfma_f32_16x16x32_bf16 v[48:51], a[96:99], a[68:71], v[48:51]
  buffer_load_dwordx4 v2, s[8:11], s70 offen offset:0 sc1 lds
  ds_read_b64_tr_b16 a[114:115], v18 offset:22528
  v_mfma_f32_16x16x32_bf16 v[64:67], a[96:99], a[72:75], v[64:67]
  buffer_load_dwordx4 v2, s[8:11], s70 offen offset:1024 sc1 lds
  ds_read_b128 a[84:87], v16 offset:9216
  v_mfma_f32_16x16x32_bf16 v[80:83], a[96:99], a[76:79], v[80:83]
  ds_read_b128 a[88:91], v17 offset:8192
  ds_read_b128 a[92:95], v17 offset:9216
  v_mfma_f32_16x16x32_bf16 v[36:39], a[100:103], a[64:67], v[36:39]
  buffer_load_dwordx4 v2, s[8:11], s70 offen offset:2048 sc1 lds
  ds_read_b64_tr_b16 a[116:117], v19 offset:20480
  v_mfma_f32_16x16x32_bf16 v[52:55], a[100:103], a[68:71], v[52:55]
  ds_read_b64_tr_b16 a[118:119], v19 offset:22528
  ds_read_b64_tr_b16 a[120:121], v20 offset:20480
  v_mfma_f32_16x16x32_bf16 v[68:71], a[100:103], a[72:75], v[68:71]
  buffer_load_dwordx4 v2, s[8:11], s70 offen offset:3072 sc1 lds
  ds_read_b64_tr_b16 a[122:123], v20 offset:22528
  v_mfma_f32_16x16x32_bf16 v[84:87], a[100:103], a[76:79], v[84:87]
  s_bfe_u32 s72, 0x3020106, s1
  s_add_u32 s0, s0, s72
  s_add_u32 s1, s1, 8
  v_mfma_f32_16x16x32_bf16 v[40:43], a[104:107], a[64:67], v[40:43]
  s_and_b32 s1, s1, 0x8001f
  s_and_b32 s0, s0, 7
  s_lshl_b32 s72, s0, 14
  v_mfma_f32_16x16x32_bf16 v[56:59], a[104:107], a[68:71], v[56:59]
  s_add_u32 s70, s92, s72
  ds_read_b64_tr_b16 a[124:125], v21 offset:20480
  ds_read_b64_tr_b16 a[126:127], v21 offset:22528
  v_mfma_f32_16x16x32_bf16 v[72:75], a[104:107], a[72:75], v[72:75]
  s_add_u32 s64, s64, s66
  s_add_u32 s65, s65, 1
  s_cmp_eq_u32 s65, 4
  s_cselect_b32 s65, 0, s65
  s_cselect_b32 s66, s67, s68
  v_mfma_f32_16x16x32_bf16 v[88:91], a[104:107], a[76:79], v[88:91]
  v_add_u32 v16, s66, v16
  v_add_u32 v17, s66, v17
  v_mfma_f32_16x16x32_bf16 v[44:47], a[108:111], a[64:67], v[44:47]
  v_add_u32 v18, s66, v18
  v_add_u32 v19, s66, v19
  v_mfma_f32_16x16x32_bf16 v[60:63], a[108:111], a[68:71], v[60:63]
  v_add_u32 v20, s66, v20
  v_add_u32 v21, s66, v21
  v_mfma_f32_16x16x32_bf16 v[76:79], a[108:111], a[72:75], v[76:79]
  v_mfma_f32_16x16x32_bf16 v[92:95], a[108:111], a[76:79], v[92:95]
  s_waitcnt vmcnt(16) lgkmcnt(0)
  s_barrier
  v_mfma_f32_16x16x32_bf16 v[32:35], a[112:115], a[80:83], v[32:35]
  buffer_load_dwordx2 v[6:7], v14, s[96:99], s91 offen sc1
  ds_read_b128 a[64:67], v16 offset:0
  v_mfma_f32_16x16x32_bf16 v[48:51], a[112:115], a[84:87], v[48:51]
  s_mov_b32 s12, s74
  s_mov_b32 s13, s75
  s_mov_b32 s14, 8388608
  v_mfma_f32_16x16x32_bf16 v[64:67], a[112:115], a[88:91], v[64:67]
  s_mov_b32 s15, 0x00020000
  s_lshl_b32 s93, s77, 22
  s_lshl_b32 s72, s76, 8
  v_mfma_f32_16x16x32_bf16 v[80:83], a[112:115], a[92:95], v[80:83]
  s_add_u32 s93, s93, s72
  s_add_u32 s72, s73, s76
  s_and_b32 s31, s72, 3
  v_mfma_f32_16x16x32_bf16 v[36:39], a[116:119], a[80:83], v[36:39]
  s_lshl_b32 s31, s31, 3
  s_or_b32 s31, s31, 0x80000
  s_bfe_u32 s30, 0x1b1b02, s31
  v_mfma_f32_16x16x32_bf16 v[52:55], a[116:119], a[84:87], v[52:55]
  s_add_u32 s30, s30, 0
  s_cmp_ge_u32 s30, 28
  s_cselect_b32 s72, 28, 0
  v_mfma_f32_16x16x32_bf16 v[68:71], a[116:119], a[88:91], v[68:71]
  s_sub_u32 s30, s30, s72
  s_lshl_b32 s72, s30, 17
  s_add_u32 s71, s93, s72
  v_mfma_f32_16x16x32_bf16 v[84:87], a[116:119], a[92:95], v[84:87]
  s_add_u32 m0, s64, 16384
  ds_read_b64_tr_b16 a[96:97], v18 offset:16384
  ds_read_b64_tr_b16 a[98:99], v18 offset:18432
  v_mfma_f32_16x16x32_bf16 v[40:43], a[120:123], a[80:83], v[40:43]
  buffer_load_dwordx4 v10, s[12:15], s71 offen offset:0 lds
  ds_read_b128 a[68:71], v16 offset:1024
  v_mfma_f32_16x16x32_bf16 v[56:59], a[120:123], a[84:87], v[56:59]
  ds_read_b128 a[72:75], v17 offset:0
  ds_read_b128 a[76:79], v17 offset:1024
  v_mfma_f32_16x16x32_bf16 v[72:75], a[120:123], a[88:91], v[72:75]
  buffer_load_dwordx4 v11, s[12:15], s71 offen offset:1024 lds
  ds_read_b64_tr_b16 a[100:101], v19 offset:16384
  v_mfma_f32_16x16x32_bf16 v[88:91], a[120:123], a[92:95], v[88:91]
  ds_read_b64_tr_b16 a[102:103], v19 offset:18432
  ds_read_b64_tr_b16 a[104:105], v20 offset:16384
  v_mfma_f32_16x16x32_bf16 v[44:47], a[124:127], a[80:83], v[44:47]
  ds_read_b64_tr_b16 a[106:107], v20 offset:18432
  ds_read_b64_tr_b16 a[108:109], v21 offset:16384
  v_mfma_f32_16x16x32_bf16 v[60:63], a[124:127], a[84:87], v[60:63]
  ds_read_b64_tr_b16 a[110:111], v21 offset:18432
  v_mfma_f32_16x16x32_bf16 v[76:79], a[124:127], a[88:91], v[76:79]
  v_mfma_f32_16x16x32_bf16 v[92:95], a[124:127], a[92:95], v[92:95]
  s_waitcnt lgkmcnt(0)
  v_mfma_f32_16x16x32_bf16 v[32:35], a[96:99], a[64:67], v[32:35]
  buffer_load_dwordx4 v12, s[12:15], s71 offen offset:2048 lds
  ds_read_b128 a[80:83], v16 offset:8192
  v_mfma_f32_16x16x32_bf16 v[48:51], a[96:99], a[68:71], v[48:51]
  ds_read_b64_tr_b16 a[112:113], v18 offset:20480
  ds_read_b64_tr_b16 a[114:115], v18 offset:22528
  v_mfma_f32_16x16x32_bf16 v[64:67], a[96:99], a[72:75], v[64:67]
  ds_read_b128 a[84:87], v16 offset:9216
  ds_read_b128 a[88:91], v17 offset:8192
  v_mfma_f32_16x16x32_bf16 v[80:83], a[96:99], a[76:79], v[80:83]
  ds_read_b128 a[92:95], v17 offset:9216
  ds_read_b64_tr_b16 a[116:117], v19 offset:20480
  v_mfma_f32_16x16x32_bf16 v[36:39], a[100:103], a[64:67], v[36:39]
  buffer_load_dwordx4 v13, s[12:15], s71 offen offset:3072 lds
  ds_read_b64_tr_b16 a[118:119], v19 offset:22528
  v_mfma_f32_16x16x32_bf16 v[52:55], a[100:103], a[68:71], v[52:55]
  s_bfe_u32 s72, 0x302011a, s31
  s_add_u32 s30, s30, s72
  s_add_u32 s31, s31, 8
  v_mfma_f32_16x16x32_bf16 v[68:71], a[100:103], a[72:75], v[68:71]
  s_and_b32 s31, s31, 0x8001f
  s_cmp_ge_u32 s30, 28
  s_cselect_b32 s72, 28, 0
  v_mfma_f32_16x16x32_bf16 v[84:87], a[100:103], a[76:79], v[84:87]
  s_sub_u32 s30, s30, s72
  s_lshl_b32 s72, s30, 17
  s_add_u32 s71, s93, s72
  v_mfma_f32_16x16x32_bf16 v[40:43], a[104:107], a[64:67], v[40:43]
  s_add_u32 s64, s64, s66
  ds_read_b64_tr_b16 a[120:121], v20 offset:20480
  ds_read_b64_tr_b16 a[122:123], v20 offset:22528
  v_mfma_f32_16x16x32_bf16 v[56:59], a[104:107], a[68:71], v[56:59]
  s_add_u32 s65, s65, 1
  ds_read_b64_tr_b16 a[124:125], v21 offset:20480
  ds_read_b64_tr_b16 a[126:127], v21 offset:22528
  v_mfma_f32_16x16x32_bf16 v[72:75], a[104:107], a[72:75], v[72:75]
  s_cmp_eq_u32 s65, 4
  s_cselect_b32 s65, 0, s65
  s_cselect_b32 s66, s67, s68
  v_mfma_f32_16x16x32_bf16 v[88:91], a[104:107], a[76:79], v[88:91]
  v_add_u32 v16, s66, v16
  v_add_u32 v17, s66, v17
  v_mfma_f32_16x16x32_bf16 v[44:47], a[108:111], a[64:67], v[44:47]
  v_add_u32 v18, s66, v18
  v_add_u32 v19, s66, v19
  v_mfma_f32_16x16x32_bf16 v[60:63], a[108:111], a[68:71], v[60:63]
  v_add_u32 v20, s66, v20
  v_add_u32 v21, s66, v21
  v_mfma_f32_16x16x32_bf16 v[76:79], a[108:111], a[72:75], v[76:79]
  v_mfma_f32_16x16x32_bf16 v[92:95], a[108:111], a[76:79], v[92:95]
  s_waitcnt vmcnt(4)
  v_cmp_ne_u64 vcc, s[94:95], v[6:7]
  s_nop 1
  v_cndmask_b32_e64 v8, 0, 1, vcc
  v_lshlrev_b32 v9, 2, v0
  ds_write_b32 v9, v8
  v_lshlrev_b32 v9, 4, v1
  s_waitcnt lgkmcnt(0)
  s_barrier
  ds_read_b128 v[160:163], v9
  s_waitcnt lgkmcnt(0)
  v_or3_b32 v160, v160, v161, v162
  v_or_b32 v160, v160, v163
  v_cmp_ne_u32 vcc, 0, v160
  s_nop 0
  s_cbranch_vccnz Lp6_late
  s_add_u32 s8, s86, 67108864
  s_addc_u32 s9, s87, 0
  s_mov_b32 s10, 16777216
  s_mov_b32 s11, 0x00020000
  s_lshl_b32 s92, s73, 1
  s_add_u32 s92, s92, s77
  s_lshl_b32 s92, s92, 19
  s_add_u32 s92, s92, s79
  s_add_u32 s72, s73, s76
  s_and_b32 s1, s72, 3
  s_lshl_b32 s1, s1, 3
  s_or_b32 s1, s1, 0x80000
  s_bfe_u32 s0, 0x1b1b02, s1
  s_add_u32 s0, s0, 0
  s_cmp_ge_u32 s0, 28
  s_cselect_b32 s72, 28, 0
  s_sub_u32 s0, s0, s72
  s_lshl_b32 s72, s0, 14
  s_add_u32 s70, s92, s72
  v_mfma_f32_16x16x32_bf16 v[32:35], a[112:115], a[80:83], v[32:35]
  s_add_u32 m0, s79, 131072
  ds_read_b128 a[64:67], v16 offset:0
  ds_read_b64_tr_b16 a[96:97], v18 offset:16384
  v_mfma_f32_16x16x32_bf16 v[48:51], a[112:115], a[84:87], v[48:51]
  buffer_load_dwordx4 v2, s[8:11], s70 offen offset:0 sc1 lds
  ds_read_b64_tr_b16 a[98:99], v18 offset:18432
  v_mfma_f32_16x16x32_bf16 v[64:67], a[112:115], a[88:91], v[64:67]
  buffer_load_dwordx4 v2, s[8:11], s70 offen offset:1024 sc1 lds
  ds_read_b128 a[68:71], v16 offset:1024
  v_mfma_f32_16x16x32_bf16 v[80:83], a[112:115], a[92:95], v[80:83]
  ds_read_b128 a[72:75], v17 offset:0
  ds_read_b128 a[76:79], v17 offset:1024
  v_mfma_f32_16x16x32_bf16 v[36:39], a[116:119], a[80:83], v[36:39]
  ds_read_b64_tr_b16 a[100:101], v19 offset:16384
  ds_read_b64_tr_b16 a[102:103], v19 offset:18432
  v_mfma_f32_16x16x32_bf16 v[52:55], a[116:119], a[84:87], v[52:55]
  buffer_load_dwordx4 v2, s[8:11], s70 offen offset:2048 sc1 lds
  ds_read_b64_tr_b16 a[104:105], v20 offset:16384
  v_mfma_f32_16x16x32_bf16 v[68:71], a[116:119], a[88:91], v[68:71]
  ds_read_b64_tr_b16 a[106:107], v20 offset:18432
  ds_read_b64_tr_b16 a[108:109], v21 offset:16384
  v_mfma_f32_16x16x32_bf16 v[84:87], a[116:119], a[92:95], v[84:87]
  buffer_load_dwordx4 v2, s[8:11], s70 offen offset:3072 sc1 lds
  ds_read_b64_tr_b16 a[110:111], v21 offset:18432
  v_mfma_f32_16x16x32_bf16 v[40:43], a[120:123], a[80:83], v[40:43]
  s_bfe_u32 s72, 0x302011a, s1
  s_add_u32 s0, s0, s72
  s_add_u32 s1, s1, 8
  v_mfma_f32_16x16x32_bf16 v[56:59], a[120:123], a[84:87], v[56:59]
  s_and_b32 s1, s1, 0x8001f
  s_cmp_ge_u32 s0, 28
  s_cselect_b32 s72, 28, 0
  v_mfma_f32_16x16x32_bf16 v[72:75], a[120:123], a[88:91], v[72:75]
  s_sub_u32 s0, s0, s72
  s_lshl_b32 s72, s0, 14
  s_add_u32 s70, s92, s72
  v_mfma_f32_16x16x32_bf16 v[88:91], a[120:123], a[92:95], v[88:91]
  s_add_u32 m0, s64, 16384
  v_mfma_f32_16x16x32_bf16 v[44:47], a[124:127], a[80:83], v[44:47]
  buffer_load_dwordx4 v10, s[12:15], s71 offen offset:0 lds
  v_mfma_f32_16x16x32_bf16 v[60:63], a[124:127], a[84:87], v[60:63]
  buffer_load_dwordx4 v11, s[12:15], s71 offen offset:1024 lds
  v_mfma_f32_16x16x32_bf16 v[76:79], a[124:127], a[88:91], v[76:79]
  v_mfma_f32_16x16x32_bf16 v[92:95], a[124:127], a[92:95], v[92:95]
  s_waitcnt lgkmcnt(0)
  v_mfma_f32_16x16x32_bf16 v[32:35], a[96:99], a[64:67], v[32:35]
  buffer_load_dwordx4 v12, s[12:15], s71 offen offset:2048 lds
  ds_read_b128 a[80:83], v16 offset:8192
  v_mfma_f32_16x16x32_bf16 v[48:51], a[96:99], a[68:71], v[48:51]
  buffer_load_dwordx4 v13, s[12:15], s71 offen offset:3072 lds
  ds_read_b64_tr_b16 a[112:113], v18 offset:20480
  v_mfma_f32_16x16x32_bf16 v[64:67], a[96:99], a[72:75], v[64:67]
  s_bfe_u32 s72, 0x302011a, s31
  s_add_u32 s30, s30, s72
  s_add_u32 s31, s31, 8
  v_mfma_f32_16x16x32_bf16 v[80:83], a[96:99], a[76:79], v[80:83]
  s_and_b32 s31, s31, 0x8001f
  s_cmp_ge_u32 s30, 28
  s_cselect_b32 s72, 28, 0
  v_mfma_f32_16x16x32_bf16 v[36:39], a[100:103], a[64:67], v[36:39]
  s_sub_u32 s30, s30, s72
  s_lshl_b32 s72, s30, 17
  s_add_u32 s71, s93, s72
  v_mfma_f32_16x16x32_bf16 v[52:55], a[100:103], a[68:71], v[52:55]
  s_mov_b32 m0, s64
  ds_read_b64_tr_b16 a[114:115], v18 offset:22528
  ds_read_b128 a[84:87], v16 offset:9216
  v_mfma_f32_16x16x32_bf16 v[68:71], a[100:103], a[72:75], v[68:71]
  buffer_load_dwordx4 v2, s[8:11], s70 offen offset:0 sc1 lds
  ds_read_b128 a[88:91], v17 offset:8192
  v_mfma_f32_16x16x32_bf16 v[84:87], a[100:103], a[76:79], v[84:87]
  buffer_load_dwordx4 v2, s[8:11], s70 offen offset:1024 sc1 lds
  ds_read_b128 a[92:95], v17 offset:9216
  v_mfma_f32_16x16x32_bf16 v[40:43], a[104:107], a[64:67], v[40:43]
  buffer_load_dwordx4 v2, s[8:11], s70 offen offset:2048 sc1 lds
  ds_read_b64_tr_b16 a[116:117], v19 offset:20480
  v_mfma_f32_16x16x32_bf16 v[56:59], a[104:107], a[68:71], v[56:59]
  buffer_load_dwordx4 v2, s[8:11], s70 offen offset:3072 sc1 lds
  ds_read_b64_tr_b16 a[118:119], v19 offset:22528
  v_mfma_f32_16x16x32_bf16 v[72:75], a[104:107], a[72:75], v[72:75]
  s_bfe_u32 s72, 0x302011a, s1
  s_add_u32 s0, s0, s72
  s_add_u32 s1, s1, 8
  v_mfma_f32_16x16x32_bf16 v[88:91], a[104:107], a[76:79], v[88:91]
  s_and_b32 s1, s1, 0x8001f
  s_cmp_ge_u32 s0, 28
  s_cselect_b32 s72, 28, 0
  v_mfma_f32_16x16x32_bf16 v[44:47], a[108:111], a[64:67], v[44:47]
  s_sub_u32 s0, s0, s72
  s_lshl_b32 s72, s0, 14
  s_add_u32 s70, s92, s72
  v_mfma_f32_16x16x32_bf16 v[60:63], a[108:111], a[68:71], v[60:63]
  s_add_u32 s64, s64, s66
  ds_read_b64_tr_b16 a[120:121], v20 offset:20480
  ds_read_b64_tr_b16 a[122:123], v20 offset:22528
  v_mfma_f32_16x16x32_bf16 v[76:79], a[108:111], a[72:75], v[76:79]
  s_add_u32 s65, s65, 1
  ds_read_b64_tr_b16 a[124:125], v21 offset:20480
  ds_read_b64_tr_b16 a[126:127], v21 offset:22528
  v_mfma_f32_16x16x32_bf16 v[92:95], a[108:111], a[76:79], v[92:95]
  s_cmp_eq_u32 s65, 4
  s_cselect_b32 s65, 0, s65
  s_cselect_b32 s66, s67, s68
  v_add_u32 v16, s66, v16
  v_add_u32 v17, s66, v17
  v_add_u32 v18, s66, v18
  v_add_u32 v19, s66, v19
  v_add_u32 v20, s66, v20
  v_add_u32 v21, s66, v21
  s_waitcnt vmcnt(16) lgkmcnt(0)
  s_barrier
  v_mfma_f32_16x16x32_bf16 v[32:35], a[112:115], a[80:83], v[32:35]
  s_add_u32 m0, s64, 16384
  ds_read_b128 a[64:67], v16 offset:0
  ds_read_b64_tr_b16 a[96:97], v18 offset:16384
  v_mfma_f32_16x16x32_bf16 v[48:51], a[112:115], a[84:87], v[48:51]
  buffer_load_dwordx4 v10, s[12:15], s71 offen offset:0 lds
  ds_read_b64_tr_b16 a[98:99], v18 offset:18432
  v_mfma_f32_16x16x32_bf16 v[64:67], a[112:115], a[88:91], v[64:67]
  ds_read_b128 a[68:71], v16 offset:1024
  ds_read_b128 a[72:75], v17 offset:0
  v_mfma_f32_16x16x32_bf16 v[80:83], a[112:115], a[92:95], v[80:83]
  buffer_load_dwordx4 v11, s[12:15], s71 offen offset:1024 lds
  ds_read_b128 a[76:79], v17 offset:1024
  v_mfma_f32_16x16x32_bf16 v[36:39], a[116:119], a[80:83], v[36:39]
  ds_read_b64_tr_b16 a[100:101], v19 offset:16384
  ds_read_b64_tr_b16 a[102:103], v19 offset:18432
  v_mfma_f32_16x16x32_bf16 v[52:55], a[116:119], a[84:87], v[52:55]
  ds_read_b64_tr_b16 a[104:105], v20 offset:16384
  ds_read_b64_tr_b16 a[106:107], v20 offset:18432
  v_mfma_f32_16x16x32_bf16 v[68:71], a[116:119], a[88:91], v[68:71]
  ds_read_b64_tr_b16 a[108:109], v21 offset:16384
  ds_read_b64_tr_b16 a[110:111], v21 offset:18432
  v_mfma_f32_16x16x32_bf16 v[84:87], a[116:119], a[92:95], v[84:87]
  buffer_load_dwordx4 v12, s[12:15], s71 offen offset:2048 lds
  v_mfma_f32_16x16x32_bf16 v[40:43], a[120:123], a[80:83], v[40:43]
  v_mfma_f32_16x16x32_bf16 v[56:59], a[120:123], a[84:87], v[56:59]
  v_mfma_f32_16x16x32_bf16 v[72:75], a[120:123], a[88:91], v[72:75]
  v_mfma_f32_16x16x32_bf16 v[88:91], a[120:123], a[92:95], v[88:91]
  buffer_load_dwordx4 v13, s[12:15], s71 offen offset:3072 lds
  v_mfma_f32_16x16x32_bf16 v[44:47], a[124:127], a[80:83], v[44:47]
  s_bfe_u32 s72, 0x302011a, s31
  s_add_u32 s30, s30, s72
  s_add_u32 s31, s31, 8
  v_mfma_f32_16x16x32_bf16 v[60:63], a[124:127], a[84:87], v[60:63]
  s_and_b32 s31, s31, 0x8001f
  s_cmp_ge_u32 s30, 28
  s_cselect_b32 s72, 28, 0
  v_mfma_f32_16x16x32_bf16 v[76:79], a[124:127], a[88:91], v[76:79]
  s_sub_u32 s30, s30, s72
  s_lshl_b32 s72, s30, 17
  s_add_u32 s71, s93, s72
  v_mfma_f32_16x16x32_bf16 v[92:95], a[124:127], a[92:95], v[92:95]
  s_waitcnt lgkmcnt(0)
  v_mfma_f32_16x16x32_bf16 v[32:35], a[96:99], a[64:67], v[32:35]
  s_mov_b32 m0, s64
  ds_read_b128 a[80:83], v16 offset:8192
  ds_read_b64_tr_b16 a[112:113], v18 offset:20480
  v_mfma_f32_16x16x32_bf16 v[48:51], a[96:99], a[68:71], v[48:51]
  buffer_load_dwordx4 v2, s[8:11], s70 offen offset:0 sc1 lds
  ds_read_b64_tr_b16 a[114:115], v18 offset:22528
  v_mfma_f32_16x16x32_bf16 v[64:67], a[96:99], a[72:75], v[64:67]
  buffer_load_dwordx4 v2, s[8:11], s70 offen offset:1024 sc1 lds
  ds_read_b128 a[84:87], v16 offset:9216
  v_mfma_f32_16x16x32_bf16 v[80:83], a[96:99], a[76:79], v[80:83]
  ds_read_b128 a[88:91], v17 offset:8192
  ds_read_b128 a[92:95], v17 offset:9216
  v_mfma_f32_16x16x32_bf16 v[36:39], a[100:103], a[64:67], v[36:39]
  buffer_load_dwordx4 v2, s[8:11], s70 offen offset:2048 sc1 lds
  ds_read_b64_tr_b16 a[116:117], v19 offset:20480
  v_mfma_f32_16x16x32_bf16 v[52:55], a[100:103], a[68:71], v[52:55]
  ds_read_b64_tr_b16 a[118:119], v19 offset:22528
  ds_read_b64_tr_b16 a[120:121], v20 offset:20480
  v_mfma_f32_16x16x32_bf16 v[68:71], a[100:103], a[72:75], v[68:71]
  buffer_load_dwordx4 v2, s[8:11], s70 offen offset:3072 sc1 lds
  ds_read_b64_tr_b16 a[122:123], v20 offset:22528
  v_mfma_f32_16x16x32_bf16 v[84:87], a[100:103], a[76:79], v[84:87]
  s_bfe_u32 s72, 0x302011a, s1
  s_add_u32 s0, s0, s72
  s_add_u32 s1, s1, 8
  v_mfma_f32_16x16x32_bf16 v[40:43], a[104:107], a[64:67], v[40:43]
  s_and_b32 s1, s1, 0x8001f
  s_cmp_ge_u32 s0, 28
  s_cselect_b32 s72, 28, 0
  v_mfma_f32_16x16x32_bf16 v[56:59], a[104:107], a[68:71], v[56:59]
  s_sub_u32 s0, s0, s72
  s_lshl_b32 s72, s0, 14
  s_add_u32 s70, s92, s72
  v_mfma_f32_16x16x32_bf16 v[72:75], a[104:107], a[72:75], v[72:75]
  s_add_u32 s64, s64, s66
  ds_read_b64_tr_b16 a[124:125], v21 offset:20480
  ds_read_b64_tr_b16 a[126:127], v21 offset:22528
  v_mfma_f32_16x16x32_bf16 v[88:91], a[104:107], a[76:79], v[88:91]
  s_add_u32 s65, s65, 1
  s_cmp_eq_u32 s65, 4
  s_cselect_b32 s65, 0, s65
  s_cselect_b32 s66, s67, s68
  v_mfma_f32_16x16x32_bf16 v[44:47], a[108:111], a[64:67], v[44:47]
  v_add_u32 v16, s66, v16
  v_add_u32 v17, s66, v17
  v_mfma_f32_16x16x32_bf16 v[60:63], a[108:111], a[68:71], v[60:63]
  v_add_u32 v18, s66, v18
  v_add_u32 v19, s66, v19
  v_mfma_f32_16x16x32_bf16 v[76:79], a[108:111], a[72:75], v[76:79]
  v_add_u32 v20, s66, v20
  v_add_u32 v21, s66, v21
  v_mfma_f32_16x16x32_bf16 v[92:95], a[108:111], a[76:79], v[92:95]
  s_waitcnt vmcnt(16) lgkmcnt(0)
  s_barrier
  v_mfma_f32_16x16x32_bf16 v[32:35], a[112:115], a[80:83], v[32:35]
  s_add_u32 m0, s64, 16384
  ds_read_b128 a[64:67], v16 offset:0
  ds_read_b64_tr_b16 a[96:97], v18 offset:16384
  v_mfma_f32_16x16x32_bf16 v[48:51], a[112:115], a[84:87], v[48:51]
  buffer_load_dwordx4 v10, s[12:15], s71 offen offset:0 lds
  ds_read_b64_tr_b16 a[98:99], v18 offset:18432
  v_mfma_f32_16x16x32_bf16 v[64:67], a[112:115], a[88:91], v[64:67]
  buffer_load_dwordx4 v11, s[12:15], s71 offen offset:1024 lds
  ds_read_b128 a[68:71], v16 offset:1024
  v_mfma_f32_16x16x32_bf16 v[80:83], a[112:115], a[92:95], v[80:83]
  buffer_load_dwordx4 v12, s[12:15], s71 offen offset:2048 lds
  ds_read_b128 a[72:75], v17 offset:0
  v_mfma_f32_16x16x32_bf16 v[36:39], a[116:119], a[80:83], v[36:39]
  ds_read_b128 a[76:79], v17 offset:1024
  ds_read_b64_tr_b16 a[100:101], v19 offset:16384
  v_mfma_f32_16x16x32_bf16 v[52:55], a[116:119], a[84:87], v[52:55]
  buffer_load_dwordx4 v13, s[12:15], s71 offen offset:3072 lds
  ds_read_b64_tr_b16 a[102:103], v19 offset:18432
  v_mfma_f32_16x16x32_bf16 v[68:71], a[116:119], a[88:91], v[68:71]
  s_bfe_u32 s72, 0x302011a, s31
  s_add_u32 s30, s30, s72
  s_add_u32 s31, s31, 8
  v_mfma_f32_16x16x32_bf16 v[84:87], a[116:119], a[92:95], v[84:87]
  s_and_b32 s31, s31, 0x8001f
  s_cmp_ge_u32 s30, 28
  s_cselect_b32 s72, 28, 0
  v_mfma_f32_16x16x32_bf16 v[40:43], a[120:123], a[80:83], v[40:43]
  s_sub_u32 s30, s30, s72
  s_lshl_b32 s72, s30, 17
  s_add_u32 s71, s93, s72
  v_mfma_f32_16x16x32_bf16 v[56:59], a[120:123], a[84:87], v[56:59]
  s_mov_b32 m0, s64
  ds_read_b64_tr_b16 a[104:105], v20 offset:16384
  ds_read_b64_tr_b16 a[106:107], v20 offset:18432
  v_mfma_f32_16x16x32_bf16 v[72:75], a[120:123], a[88:91], v[72:75]
  buffer_load_dwordx4 v2, s[8:11], s70 offen offset:0 sc1 lds
  ds_read_b64_tr_b16 a[108:109], v21 offset:16384
  v_mfma_f32_16x16x32_bf16 v[88:91], a[120:123], a[92:95], v[88:91]
  buffer_load_dwordx4 v2, s[8:11], s70 offen offset:1024 sc1 lds
  ds_read_b64_tr_b16 a[110:111], v21 offset:18432
  v_mfma_f32_16x16x32_bf16 v[44:47], a[124:127], a[80:83], v[44:47]
  buffer_load_dwordx4 v2, s[8:11], s70 offen offset:2048 sc1 lds
  v_mfma_f32_16x16x32_bf16 v[60:63], a[124:127], a[84:87], v[60:63]
  buffer_load_dwordx4 v2, s[8:11], s70 offen offset:3072 sc1 lds
  v_mfma_f32_16x16x32_bf16 v[76:79], a[124:127], a[88:91], v[76:79]
  s_bfe_u32 s72, 0x302011a, s1
  s_add_u32 s0, s0, s72
  s_add_u32 s1, s1, 8
  v_mfma_f32_16x16x32_bf16 v[92:95], a[124:127], a[92:95], v[92:95]
  s_and_b32 s1, s1, 0x8001f
  s_cmp_ge_u32 s0, 28
  s_cselect_b32 s72, 28, 0
  s_sub_u32 s0, s0, s72
  s_lshl_b32 s72, s0, 14
  s_add_u32 s70, s92, s72
  s_waitcnt lgkmcnt(0)
  s_lshl_b32 s6, s78, 1
  s_add_u32 s6, s6, s77
  s_xor_b32 s6, s6, 1
  s_lshl_b32 s6, s6, 2
  s_add_u32 s6, s6, s3
  s_lshl_b32 s6, s6, 14
  s_add_u32 s6, s6, 8192
  s_add_u32 s7, s6, 4096
  v_mfma_f32_16x16x32_bf16 v[96:99], a[96:99], a[64:67], 0
  s_add_u32 s64, s64, s66
  ds_read_b128 a[80:83], v16 offset:8192
  ds_read_b64_tr_b16 a[112:113], v18 offset:20480
  v_mfma_f32_16x16x32_bf16 v[112:115], a[96:99], a[68:71], 0
  s_add_u32 s65, s65, 1
  ds_read_b64_tr_b16 a[114:115], v18 offset:22528
  ds_read_b128 a[84:87], v16 offset:9216
  v_mfma_f32_16x16x32_bf16 v[128:131], a[96:99], a[72:75], 0
  s_cmp_eq_u32 s65, 4
  s_cselect_b32 s65, 0, s65
  s_cselect_b32 s66, s67, s68
  ds_read_b128 a[88:91], v17 offset:8192
  ds_read_b128 a[92:95], v17 offset:9216
  v_mfma_f32_16x16x32_bf16 v[144:147], a[96:99], a[76:79], 0
  ds_read_b64_tr_b16 a[116:117], v19 offset:20480
  v_mfma_f32_16x16x32_bf16 v[100:103], a[100:103], a[64:67], 0
  ds_read_b64_tr_b16 a[118:119], v19 offset:22528
  ds_read_b64_tr_b16 a[120:121], v20 offset:20480
  v_mfma_f32_16x16x32_bf16 v[116:119], a[100:103], a[68:71], 0
  ds_read_b64_tr_b16 a[122:123], v20 offset:22528
  ds_read_b64_tr_b16 a[124:125], v21 offset:20480
  v_mfma_f32_16x16x32_bf16 v[132:135], a[100:103], a[72:75], 0
  buffer_store_dwordx4 v[64:67], v2, s[16:19], s6 offen offset:0 sc1
  ds_read_b64_tr_b16 a[126:127], v21 offset:22528
  v_mfma_f32_16x16x32_bf16 v[148:151], a[100:103], a[76:79], 0
  v_add_u32 v16, s66, v16
  v_add_u32 v17, s66, v17
  v_mfma_f32_16x16x32_bf16 v[104:107], a[104:107], a[64:67], 0
  v_add_u32 v18, s66, v18
  v_add_u32 v19, s66, v19
  v_mfma_f32_16x16x32_bf16 v[120:123], a[104:107], a[68:71], 0
  v_add_u32 v20, s66, v20
  v_add_u32 v21, s66, v21
  v_mfma_f32_16x16x32_bf16 v[136:139], a[104:107], a[72:75], 0
  buffer_store_dwordx4 v[68:71], v2, s[16:19], s6 offen offset:1024 sc1
  v_mfma_f32_16x16x32_bf16 v[152:155], a[104:107], a[76:79], 0
  buffer_store_dwordx4 v[72:75], v2, s[16:19], s6 offen offset:2048 sc1
  v_mfma_f32_16x16x32_bf16 v[108:111], a[108:111], a[64:67], 0
  buffer_store_dwordx4 v[76:79], v2, s[16:19], s6 offen offset:3072 sc1
  v_mfma_f32_16x16x32_bf16 v[124:127], a[108:111], a[68:71], 0
  buffer_store_dwordx4 v[80:83], v2, s[16:19], s7 offen offset:0 sc1
  v_mfma_f32_16x16x32_bf16 v[140:143], a[108:111], a[72:75], 0
  buffer_store_dwordx4 v[84:87], v2, s[16:19], s7 offen offset:1024 sc1
  v_mfma_f32_16x16x32_bf16 v[156:159], a[108:111], a[76:79], 0
  buffer_store_dwordx4 v[88:91], v2, s[16:19], s7 offen offset:2048 sc1
  buffer_store_dwordx4 v[92:95], v2, s[16:19], s7 offen offset:3072 sc1
  s_branch Lp7
Lp6_late:
  v_mfma_f32_16x16x32_bf16 v[32:35], a[112:115], a[80:83], v[32:35]
  s_add_u32 m0, s64, 16384
  ds_read_b128 a[64:67], v16 offset:0
  ds_read_b64_tr_b16 a[96:97], v18 offset:16384
  v_mfma_f32_16x16x32_bf16 v[48:51], a[112:115], a[84:87], v[48:51]
  buffer_load_dwordx4 v10, s[12:15], s71 offen offset:0 lds
  ds_read_b64_tr_b16 a[98:99], v18 offset:18432
  v_mfma_f32_16x16x32_bf16 v[64:67], a[112:115], a[88:91], v[64:67]
  ds_read_b128 a[68:71], v16 offset:1024
  ds_read_b128 a[72:75], v17 offset:0
  v_mfma_f32_16x16x32_bf16 v[80:83], a[112:115], a[92:95], v[80:83]
  ds_read_b128 a[76:79], v17 offset:1024
  ds_read_b64_tr_b16 a[100:101], v19 offset:16384
  v_mfma_f32_16x16x32_bf16 v[36:39], a[116:119], a[80:83], v[36:39]
  ds_read_b64_tr_b16 a[102:103], v19 offset:18432
  ds_read_b64_tr_b16 a[104:105], v20 offset:16384
  v_mfma_f32_16x16x32_bf16 v[52:55], a[116:119], a[84:87], v[52:55]
  ds_read_b64_tr_b16 a[106:107], v20 offset:18432
  ds_read_b64_tr_b16 a[108:109], v21 offset:16384
  v_mfma_f32_16x16x32_bf16 v[68:71], a[116:119], a[88:91], v[68:71]
  ds_read_b64_tr_b16 a[110:111], v21 offset:18432
  v_mfma_f32_16x16x32_bf16 v[84:87], a[116:119], a[92:95], v[84:87]
  buffer_load_dwordx4 v11, s[12:15], s71 offen offset:1024 lds
  v_mfma_f32_16x16x32_bf16 v[40:43], a[120:123], a[80:83], v[40:43]
  v_mfma_f32_16x16x32_bf16 v[56:59], a[120:123], a[84:87], v[56:59]
  v_mfma_f32_16x16x32_bf16 v[72:75], a[120:123], a[88:91], v[72:75]
  v_mfma_f32_16x16x32_bf16 v[88:91], a[120:123], a[92:95], v[88:91]
  v_mfma_f32_16x16x32_bf16 v[44:47], a[124:127], a[80:83], v[44:47]
  v_mfma_f32_16x16x32_bf16 v[60:63], a[124:127], a[84:87], v[60:63]
  v_mfma_f32_16x16x32_bf16 v[76:79], a[124:127], a[88:91], v[76:79]
  v_mfma_f32_16x16x32_bf16 v[92:95], a[124:127], a[92:95], v[92:95]
  s_waitcnt lgkmcnt(0)
  v_mfma_f32_16x16x32_bf16 v[32:35], a[96:99], a[64:67], v[32:35]
  buffer_load_dwordx4 v12, s[12:15], s71 offen offset:2048 lds
  ds_read_b128 a[80:83], v16 offset:8192
  v_mfma_f32_16x16x32_bf16 v[48:51], a[96:99], a[68:71], v[48:51]
  ds_read_b64_tr_b16 a[112:113], v18 offset:20480
  ds_read_b64_tr_b16 a[114:115], v18 offset:22528
  v_mfma_f32_16x16x32_bf16 v[64:67], a[96:99], a[72:75], v[64:67]
  ds_read_b128 a[84:87], v16 offset:9216
  ds_read_b128 a[88:91], v17 offset:8192
  v_mfma_f32_16x16x32_bf16 v[80:83], a[96:99], a[76:79], v[80:83]
  ds_read_b128 a[92:95], v17 offset:9216
  ds_read_b64_tr_b16 a[116:117], v19 offset:20480
  v_mfma_f32_16x16x32_bf16 v[36:39], a[100:103], a[64:67], v[36:39]
  buffer_load_dwordx4 v13, s[12:15], s71 offen offset:3072 lds
  ds_read_b64_tr_b16 a[118:119], v19 offset:22528
  v_mfma_f32_16x16x32_bf16 v[52:55], a[100:103], a[68:71], v[52:55]
  s_bfe_u32 s72, 0x302011a, s31
  s_add_u32 s30, s30, s72
  s_add_u32 s31, s31, 8
  v_mfma_f32_16x16x32_bf16 v[68:71], a[100:103], a[72:75], v[68:71]
  s_and_b32 s31, s31, 0x8001f
  s_cmp_ge_u32 s30, 28
  s_cselect_b32 s72, 28, 0
  v_mfma_f32_16x16x32_bf16 v[84:87], a[100:103], a[76:79], v[84:87]
  s_sub_u32 s30, s30, s72
  s_lshl_b32 s72, s30, 17
  s_add_u32 s71, s93, s72
  v_mfma_f32_16x16x32_bf16 v[40:43], a[104:107], a[64:67], v[40:43]
  s_add_u32 s64, s64, s66
  ds_read_b64_tr_b16 a[120:121], v20 offset:20480
  ds_read_b64_tr_b16 a[122:123], v20 offset:22528
  v_mfma_f32_16x16x32_bf16 v[56:59], a[104:107], a[68:71], v[56:59]
  s_add_u32 s65, s65, 1
  ds_read_b64_tr_b16 a[124:125], v21 offset:20480
  ds_read_b64_tr_b16 a[126:127], v21 offset:22528
  v_mfma_f32_16x16x32_bf16 v[72:75], a[104:107], a[72:75], v[72:75]
  s_cmp_eq_u32 s65, 4
  s_cselect_b32 s65, 0, s65
  s_cselect_b32 s66, s67, s68
  v_mfma_f32_16x16x32_bf16 v[88:91], a[104:107], a[76:79], v[88:91]
  v_add_u32 v16, s66, v16
  v_add_u32 v17, s66, v17
  v_mfma_f32_16x16x32_bf16 v[44:47], a[108:111], a[64:67], v[44:47]
  v_add_u32 v18, s66, v18
  v_add_u32 v19, s66, v19
  v_mfma_f32_16x16x32_bf16 v[60:63], a[108:111], a[68:71], v[60:63]
  v_add_u32 v20, s66, v20
  v_add_u32 v21, s66, v21
  v_mfma_f32_16x16x32_bf16 v[76:79], a[108:111], a[72:75], v[76:79]
  v_mfma_f32_16x16x32_bf16 v[92:95], a[108:111], a[76:79], v[92:95]
  s_waitcnt vmcnt(8) lgkmcnt(0)
  s_barrier
  v_mfma_f32_16x16x32_bf16 v[32:35], a[112:115], a[80:83], v[32:35]
  s_add_u32 m0, s64, 16384
  ds_read_b128 a[64:67], v16 offset:0
  ds_read_b64_tr_b16 a[96:97], v18 offset:16384
  v_mfma_f32_16x16x32_bf16 v[48:51], a[112:115], a[84:87], v[48:51]
  buffer_load_dwordx4 v10, s[12:15], s71 offen offset:0 lds
  ds_read_b64_tr_b16 a[98:99], v18 offset:18432
  v_mfma_f32_16x16x32_bf16 v[64:67], a[112:115], a[88:91], v[64:67]
  ds_read_b128 a[68:71], v16 offset:1024
  ds_read_b128 a[72:75], v17 offset:0
  v_mfma_f32_16x16x32_bf16 v[80:83], a[112:115], a[92:95], v[80:83]
  ds_read_b128 a[76:79], v17 offset:1024
  ds_read_b64_tr_b16 a[100:101], v19 offset:16384
  v_mfma_f32_16x16x32_bf16 v[36:39], a[116:119], a[80:83], v[36:39]
  ds_read_b64_tr_b16 a[102:103], v19 offset:18432
  ds_read_b64_tr_b16 a[104:105], v20 offset:16384
  v_mfma_f32_16x16x32_bf16 v[52:55], a[116:119], a[84:87], v[52:55]
  buffer_load_dwordx4 v11, s[12:15], s71 offen offset:1024 lds
  ds_read_b64_tr_b16 a[106:107], v20 offset:18432
  v_mfma_f32_16x16x32_bf16 v[68:71], a[116:119], a[88:91], v[68:71]
  ds_read_b64_tr_b16 a[108:109], v21 offset:16384
  ds_read_b64_tr_b16 a[110:111], v21 offset:18432
  v_mfma_f32_16x16x32_bf16 v[84:87], a[116:119], a[92:95], v[84:87]
  v_mfma_f32_16x16x32_bf16 v[40:43], a[120:123], a[80:83], v[40:43]
  v_mfma_f32_16x16x32_bf16 v[56:59], a[120:123], a[84:87], v[56:59]
  v_mfma_f32_16x16x32_bf16 v[72:75], a[120:123], a[88:91], v[72:75]
  buffer_load_dwordx4 v12, s[12:15], s71 offen offset:2048 lds
  v_mfma_f32_16x16x32_bf16 v[88:91], a[120:123], a[92:95], v[88:91]
  v_mfma_f32_16x16x32_bf16 v[44:47], a[124:127], a[80:83], v[44:47]
  v_mfma_f32_16x16x32_bf16 v[60:63], a[124:127], a[84:87], v[60:63]
  v_mfma_f32_16x16x32_bf16 v[76:79], a[124:127], a[88:91], v[76:79]
  v_mfma_f32_16x16x32_bf16 v[92:95], a[124:127], a[92:95], v[92:95]
  s_waitcnt lgkmcnt(0)
  v_mfma_f32_16x16x32_bf16 v[32:35], a[96:99], a[64:67], v[32:35]
  buffer_load_dwordx4 v13, s[12:15], s71 offen offset:3072 lds
  ds_read_b128 a[80:83], v16 offset:8192
  v_mfma_f32_16x16x32_bf16 v[48:51], a[96:99], a[68:71], v[48:51]
  s_bfe_u32 s72, 0x302011a, s31
  s_add_u32 s30, s30, s72
  s_add_u32 s31, s31, 8
  v_mfma_f32_16x16x32_bf16 v[64:67], a[96:99], a[72:75], v[64:67]
  s_and_b32 s31, s31, 0x8001f
  s_cmp_ge_u32 s30, 28
  s_cselect_b32 s72, 28, 0
  v_mfma_f32_16x16x32_bf16 v[80:83], a[96:99], a[76:79], v[80:83]
  s_sub_u32 s30, s30, s72
  s_lshl_b32 s72, s30, 17
  s_add_u32 s71, s93, s72
  v_mfma_f32_16x16x32_bf16 v[36:39], a[100:103], a[64:67], v[36:39]
  buffer_load_dwordx2 v[6:7], v14, s[96:99], s91 offen sc1
  ds_read_b64_tr_b16 a[112:113], v18 offset:20480
  v_mfma_f32_16x16x32_bf16 v[52:55], a[100:103], a[68:71], v[52:55]
  s_add_u32 s64, s64, s66
  ds_read_b64_tr_b16 a[114:115], v18 offset:22528
  ds_read_b128 a[84:87], v16 offset:9216
  v_mfma_f32_16x16x32_bf16 v[68:71], a[100:103], a[72:75], v[68:71]
  s_add_u32 s65, s65, 1
  ds_read_b128 a[88:91], v17 offset:8192
  ds_read_b128 a[92:95], v17 offset:9216
  v_mfma_f32_16x16x32_bf16 v[84:87], a[100:103], a[76:79], v[84:87]
  s_cmp_eq_u32 s65, 4
  s_cselect_b32 s65, 0, s65
  s_cselect_b32 s66, s67, s68
  ds_read_b64_tr_b16 a[116:117], v19 offset:20480
  ds_read_b64_tr_b16 a[118:119], v19 offset:22528
  v_mfma_f32_16x16x32_bf16 v[40:43], a[104:107], a[64:67], v[40:43]
  ds_read_b64_tr_b16 a[120:121], v20 offset:20480
  ds_read_b64_tr_b16 a[122:123], v20 offset:22528
  v_mfma_f32_16x16x32_bf16 v[56:59], a[104:107], a[68:71], v[56:59]
  ds_read_b64_tr_b16 a[124:125], v21 offset:20480
  ds_read_b64_tr_b16 a[126:127], v21 offset:22528
  v_mfma_f32_16x16x32_bf16 v[72:75], a[104:107], a[72:75], v[72:75]
  v_add_u32 v16, s66, v16
  v_add_u32 v17, s66, v17
  v_mfma_f32_16x16x32_bf16 v[88:91], a[104:107], a[76:79], v[88:91]
  v_add_u32 v18, s66, v18
  v_add_u32 v19, s66, v19
  v_mfma_f32_16x16x32_bf16 v[44:47], a[108:111], a[64:67], v[44:47]
  v_add_u32 v20, s66, v20
  v_add_u32 v21, s66, v21
  v_mfma_f32_16x16x32_bf16 v[60:63], a[108:111], a[68:71], v[60:63]
  v_mfma_f32_16x16x32_bf16 v[76:79], a[108:111], a[72:75], v[76:79]
  v_mfma_f32_16x16x32_bf16 v[92:95], a[108:111], a[76:79], v[92:95]
  s_waitcnt vmcnt(0) lgkmcnt(0)
  s_barrier
  s_mov_b32 s5, 0x40000
Lpoll_9:
  v_cmp_ne_u64 vcc, s[94:95], v[6:7]
  s_nop 0
  s_cbranch_vccz Lpolld_10
  s_sleep 4
  buffer_load_dwordx2 v[6:7], v14, s[96:99], s91 offen sc1
  s_sub_u32 s5, s5, 1
  s_waitcnt vmcnt(0)
  s_cbranch_scc0 Lpoll_9
Lpolld_10:
  s_add_u32 s8, s86, 67108864
  s_addc_u32 s9, s87, 0
  s_mov_b32 s10, 16777216
  s_mov_b32 s11, 0x00020000
  s_lshl_b32 s92, s73, 1
  s_add_u32 s92, s92, s77
  s_lshl_b32 s92, s92, 19
  s_add_u32 s92, s92, s79
  s_add_u32 s72, s73, s76
  s_and_b32 s1, s72, 3
  s_lshl_b32 s1, s1, 3
  s_or_b32 s1, s1, 0x80000
  s_bfe_u32 s0, 0x1b1b02, s1
  s_add_u32 s0, s0, 0
  s_cmp_ge_u32 s0, 28
  s_cselect_b32 s72, 28, 0
  s_sub_u32 s0, s0, s72
  s_lshl_b32 s72, s0, 14
  s_add_u32 s70, s92, s72
  v_mfma_f32_16x16x32_bf16 v[32:35], a[112:115], a[80:83], v[32:35]
  s_add_u32 m0, s79, 131072
  v_mfma_f32_16x16x32_bf16 v[48:51], a[112:115], a[84:87], v[48:51]
  buffer_load_dwordx4 v2, s[8:11], s70 offen offset:0 sc1 lds
  v_mfma_f32_16x16x32_bf16 v[64:67], a[112:115], a[88:91], v[64:67]
  buffer_load_dwordx4 v2, s[8:11], s70 offen offset:1024 sc1 lds
  v_mfma_f32_16x16x32_bf16 v[80:83], a[112:115], a[92:95], v[80:83]
  buffer_load_dwordx4 v2, s[8:11], s70 offen offset:2048 sc1 lds
  v_mfma_f32_16x16x32_bf16 v[36:39], a[116:119], a[80:83], v[36:39]
  buffer_load_dwordx4 v2, s[8:11], s70 offen offset:3072 sc1 lds
  v_mfma_f32_16x16x32_bf16 v[52:55], a[116:119], a[84:87], v[52:55]
  s_bfe_u32 s72, 0x302011a, s1
  s_add_u32 s0, s0, s72
  s_add_u32 s1, s1, 8
  v_mfma_f32_16x16x32_bf16 v[68:71], a[116:119], a[88:91], v[68:71]
  s_and_b32 s1, s1, 0x8001f
  s_cmp_ge_u32 s0, 28
  s_cselect_b32 s72, 28, 0
  v_mfma_f32_16x16x32_bf16 v[84:87], a[116:119], a[92:95], v[84:87]
  s_sub_u32 s0, s0, s72
  s_lshl_b32 s72, s0, 14
  s_add_u32 s70, s92, s72
  v_mfma_f32_16x16x32_bf16 v[40:43], a[120:123], a[80:83], v[40:43]
  s_add_u32 m0, s79, 32768
  v_mfma_f32_16x16x32_bf16 v[56:59], a[120:123], a[84:87], v[56:59]
  buffer_load_dwordx4 v2, s[8:11], s70 offen offset:0 sc1 lds
  v_mfma_f32_16x16x32_bf16 v[72:75], a[120:123], a[88:91], v[72:75]
  buffer_load_dwordx4 v2, s[8:11], s70 offen offset:1024 sc1 lds
  v_mfma_f32_16x16x32_bf16 v[88:91], a[120:123], a[92:95], v[88:91]
  buffer_load_dwordx4 v2, s[8:11], s70 offen offset:2048 sc1 lds
  v_mfma_f32_16x16x32_bf16 v[44:47], a[124:127], a[80:83], v[44:47]
  buffer_load_dwordx4 v2, s[8:11], s70 offen offset:3072 sc1 lds
  v_mfma_f32_16x16x32_bf16 v[60:63], a[124:127], a[84:87], v[60:63]
  s_bfe_u32 s72, 0x302011a, s1
  s_add_u32 s0, s0, s72
  s_add_u32 s1, s1, 8
  v_mfma_f32_16x16x32_bf16 v[76:79], a[124:127], a[88:91], v[76:79]
  s_and_b32 s1, s1, 0x8001f
  s_cmp_ge_u32 s0, 28
  s_cselect_b32 s72, 28, 0
  v_mfma_f32_16x16x32_bf16 v[92:95], a[124:127], a[92:95], v[92:95]
  s_sub_u32 s0, s0, s72
  s_lshl_b32 s72, s0, 14
  s_add_u32 s70, s92, s72
  s_add_u32 m0, s79, 65536
  s_nop 0
  buffer_load_dwordx4 v2, s[8:11], s70 offen offset:0 sc1 lds
  buffer_load_dwordx4 v2, s[8:11], s70 offen offset:1024 sc1 lds
  buffer_load_dwordx4 v2, s[8:11], s70 offen offset:2048 sc1 lds
  buffer_load_dwordx4 v2, s[8:11], s70 offen offset:3072 sc1 lds
  s_bfe_u32 s72, 0x302011a, s1
  s_add_u32 s0, s0, s72
  s_add_u32 s1, s1, 8
  s_and_b32 s1, s1, 0x8001f
  s_cmp_ge_u32 s0, 28
  s_cselect_b32 s72, 28, 0
  s_sub_u32 s0, s0, s72
  s_lshl_b32 s72, s0, 14
  s_add_u32 s70, s92, s72
  s_add_u32 m0, s79, 114688
  s_nop 0
  buffer_load_dwordx4 v10, s[12:15], s71 offen offset:0 lds
  buffer_load_dwordx4 v11, s[12:15], s71 offen offset:1024 lds
  buffer_load_dwordx4 v12, s[12:15], s71 offen offset:2048 lds
  buffer_load_dwordx4 v13, s[12:15], s71 offen offset:3072 lds
  s_bfe_u32 s72, 0x302011a, s31
  s_add_u32 s30, s30, s72
  s_add_u32 s31, s31, 8
  s_and_b32 s31, s31, 0x8001f
  s_cmp_ge_u32 s30, 28
  s_cselect_b32 s72, 28, 0
  s_sub_u32 s30, s30, s72
  s_lshl_b32 s72, s30, 17
  s_add_u32 s71, s93, s72
  s_add_u32 m0, s79, 98304
  s_nop 0
  buffer_load_dwordx4 v2, s[8:11], s70 offen offset:0 sc1 lds
  buffer_load_dwordx4 v2, s[8:11], s70 offen offset:1024 sc1 lds
  buffer_load_dwordx4 v2, s[8:11], s70 offen offset:2048 sc1 lds
  buffer_load_dwordx4 v2, s[8:11], s70 offen offset:3072 sc1 lds
  s_bfe_u32 s72, 0x302011a, s1
  s_add_u32 s0, s0, s72
  s_add_u32 s1, s1, 8
  s_and_b32 s1, s1, 0x8001f
  s_cmp_ge_u32 s0, 28
  s_cselect_b32 s72, 28, 0
  s_sub_u32 s0, s0, s72
  s_lshl_b32 s72, s0, 14
  s_add_u32 s70, s92, s72
  s_lshl_b32 s6, s78, 1
  s_add_u32 s6, s6, s77
  s_xor_b32 s6, s6, 1
  s_lshl_b32 s6, s6, 2
  s_add_u32 s6, s6, s3
  s_lshl_b32 s6, s6, 14
  s_add_u32 s6, s6, 8192
  s_add_u32 s7, s6, 4096
  buffer_store_dwordx4 v[64:67], v2, s[16:19], s6 offen offset:0 sc1
  buffer_store_dwordx4 v[68:71], v2, s[16:19], s6 offen offset:1024 sc1
  buffer_store_dwordx4 v[72:75], v2, s[16:19], s6 offen offset:2048 sc1
  buffer_store_dwordx4 v[76:79], v2, s[16:19], s6 offen offset:3072 sc1
  buffer_store_dwordx4 v[80:83], v2, s[16:19], s7 offen offset:0 sc1
  buffer_store_dwordx4 v[84:87], v2, s[16:19], s7 offen offset:1024 sc1
  buffer_store_dwordx4 v[88:91], v2, s[16:19], s7 offen offset:2048 sc1
  buffer_store_dwordx4 v[92:95], v2, s[16:19], s7 offen offset:3072 sc1
  s_waitcnt vmcnt(24)
  s_barrier
  ds_read_b128 a[64:67], v16 offset:0
  ds_read_b64_tr_b16 a[96:97], v18 offset:16384
  ds_read_b64_tr_b16 a[98:99], v18 offset:18432
  ds_read_b128 a[68:71], v16 offset:1024
  ds_read_b128 a[72:75], v17 offset:0
  ds_read_b128 a[76:79], v17 offset:1024
  ds_read_b64_tr_b16 a[100:101], v19 offset:16384
  ds_read_b64_tr_b16 a[102:103], v19 offset:18432
  ds_read_b64_tr_b16 a[104:105], v20 offset:16384
  ds_read_b64_tr_b16 a[106:107], v20 offset:18432
  ds_read_b64_tr_b16 a[108:109], v21 offset:16384
  ds_read_b64_tr_b16 a[110:111], v21 offset:18432
  s_waitcnt lgkmcnt(0)
  v_mfma_f32_16x16x32_bf16 v[96:99], a[96:99], a[64:67], 0
  s_add_u32 s64, s64, s66
  ds_read_b128 a[80:83], v16 offset:8192
  ds_read_b64_tr_b16 a[112:113], v18 offset:20480
  v_mfma_f32_16x16x32_bf16 v[112:115], a[96:99], a[68:71], 0
  s_add_u32 s65, s65, 1
  ds_read_b64_tr_b16 a[114:115], v18 offset:22528
  ds_read_b128 a[84:87], v16 offset:9216
  v_mfma_f32_16x16x32_bf16 v[128:131], a[96:99], a[72:75], 0
  s_cmp_eq_u32 s65, 4
  s_cselect_b32 s65, 0, s65
  s_cselect_b32 s66, s67, s68
  ds_read_b128 a[88:91], v17 offset:8192
  ds_read_b128 a[92:95], v17 offset:9216
  v_mfma_f32_16x16x32_bf16 v[144:147], a[96:99], a[76:79], 0
  ds_read_b64_tr_b16 a[116:117], v19 offset:20480
  v_mfma_f32_16x16x32_bf16 v[100:103], a[100:103], a[64:67], 0
  ds_read_b64_tr_b16 a[118:119], v19 offset:22528
  ds_read_b64_tr_b16 a[120:121], v20 offset:20480
  v_mfma_f32_16x16x32_bf16 v[116:119], a[100:103], a[68:71], 0
  ds_read_b64_tr_b16 a[122:123], v20 offset:22528
  ds_read_b64_tr_b16 a[124:125], v21 offset:20480
  v_mfma_f32_16x16x32_bf16 v[132:135], a[100:103], a[72:75], 0
  ds_read_b64_tr_b16 a[126:127], v21 offset:22528
  v_mfma_f32_16x16x32_bf16 v[148:151], a[100:103], a[76:79], 0
  v_add_u32 v16, s66, v16
  v_add_u32 v17, s66, v17
  v_mfma_f32_16x16x32_bf16 v[104:107], a[104:107], a[64:67], 0
  v_add_u32 v18, s66, v18
  v_add_u32 v19, s66, v19
  v_mfma_f32_16x16x32_bf16 v[120:123], a[104:107], a[68:71], 0
  v_add_u32 v20, s66, v20
  v_add_u32 v21, s66, v21
  v_mfma_f32_16x16x32_bf16 v[136:139], a[104:107], a[72:75], 0
  v_mfma_f32_16x16x32_bf16 v[152:155], a[104:107], a[76:79], 0
  v_mfma_f32_16x16x32_bf16 v[108:111], a[108:111], a[64:67], 0
  v_mfma_f32_16x16x32_bf16 v[124:127], a[108:111], a[68:71], 0
  v_mfma_f32_16x16x32_bf16 v[140:143], a[108:111], a[72:75], 0
  v_mfma_f32_16x16x32_bf16 v[156:159], a[108:111], a[76:79], 0
Lp7:
  s_mov_b32 s69, 24
  s_waitcnt vmcnt(16) lgkmcnt(0)
  s_barrier
  .p2align 6
Lp7_loop:
  v_mfma_f32_16x16x32_bf16 v[96:99], a[112:115], a[80:83], v[96:99]
  s_add_u32 m0, s64, 16384
  ds_read_b128 a[64:67], v16 offset:0
  ds_read_b64_tr_b16 a[96:97], v18 offset:16384
  v_mfma_f32_16x16x32_bf16 v[112:115], a[112:115], a[84:87], v[112:115]
  buffer_load_dwordx4 v10, s[12:15], s71 offen offset:0 lds
  ds_read_b64_tr_b16 a[98:99], v18 offset:18432
  v_mfma_f32_16x16x32_bf16 v[128:131], a[112:115], a[88:91], v[128:131]
  ds_read_b128 a[68:71], v16 offset:1024
  ds_read_b128 a[72:75], v17 offset:0
  v_mfma_f32_16x16x32_bf16 v[144:147], a[112:115], a[92:95], v[144:147]
  buffer_load_dwordx4 v11, s[12:15], s71 offen offset:1024 lds
  ds_read_b128 a[76:79], v17 offset:1024
  v_mfma_f32_16x16x32_bf16 v[100:103], a[116:119], a[80:83], v[100:103]
  ds_read_b64_tr_b16 a[100:101], v19 offset:16384
  ds_read_b64_tr_b16 a[102:103], v19 offset:18432
  v_mfma_f32_16x16x32_bf16 v[116:119], a[116:119], a[84:87], v[116:119]
  ds_read_b64_tr_b16 a[104:105], v20 offset:16384
  ds_read_b64_tr_b16 a[106:107], v20 offset:18432
  v_mfma_f32_16x16x32_bf16 v[132:135], a[116:119], a[88:91], v[132:135]
  ds_read_b64_tr_b16 a[108:109], v21 offset:16384
  ds_read_b64_tr_b16 a[110:111], v21 offset:18432
  v_mfma_f32_16x16x32_bf16 v[148:151], a[116:119], a[92:95], v[148:151]
  buffer_load_dwordx4 v12, s[12:15], s71 offen offset:2048 lds
  v_mfma_f32_16x16x32_bf16 v[104:107], a[120:123], a[80:83], v[104:107]
  v_mfma_f32_16x16x32_bf16 v[120:123], a[120:123], a[84:87], v[120:123]
  v_mfma_f32_16x16x32_bf16 v[136:139], a[120:123], a[88:91], v[136:139]
  v_mfma_f32_16x16x32_bf16 v[152:155], a[120:123], a[92:95], v[152:155]
  buffer_load_dwordx4 v13, s[12:15], s71 offen offset:3072 lds
  v_mfma_f32_16x16x32_bf16 v[108:111], a[124:127], a[80:83], v[108:111]
  s_bfe_u32 s72, 0x302011a, s31
  s_add_u32 s30, s30, s72
  s_add_u32 s31, s31, 8
  v_mfma_f32_16x16x32_bf16 v[124:127], a[124:127], a[84:87], v[124:127]
  s_and_b32 s31, s31, 0x8001f
  s_cmp_ge_u32 s30, 28
  s_cselect_b32 s72, 28, 0
  v_mfma_f32_16x16x32_bf16 v[140:143], a[124:127], a[88:91], v[140:143]
  s_sub_u32 s30, s30, s72
  s_lshl_b32 s72, s30, 17
  s_add_u32 s71, s93, s72
  v_mfma_f32_16x16x32_bf16 v[156:159], a[124:127], a[92:95], v[156:159]
  s_waitcnt lgkmcnt(0)
  v_mfma_f32_16x16x32_bf16 v[96:99], a[96:99], a[64:67], v[96:99]
  s_mov_b32 m0, s64
  ds_read_b128 a[80:83], v16 offset:8192
  ds_read_b64_tr_b16 a[112:113], v18 offset:20480
  v_mfma_f32_16x16x32_bf16 v[112:115], a[96:99], a[68:71], v[112:115]
  buffer_load_dwordx4 v2, s[8:11], s70 offen offset:0 sc1 lds
  ds_read_b64_tr_b16 a[114:115], v18 offset:22528
  v_mfma_f32_16x16x32_bf16 v[128:131], a[96:99], a[72:75], v[128:131]
  buffer_load_dwordx4 v2, s[8:11], s70 offen offset:1024 sc1 lds
  ds_read_b128 a[84:87], v16 offset:9216
  v_mfma_f32_16x16x32_bf16 v[144:147], a[96:99], a[76:79], v[144:147]
  ds_read_b128 a[88:91], v17 offset:8192
  ds_read_b128 a[92:95], v17 offset:9216
  v_mfma_f32_16x16x32_bf16 v[100:103], a[100:103], a[64:67], v[100:103]
  buffer_load_dwordx4 v2, s[8:11], s70 offen offset:2048 sc1 lds
  ds_read_b64_tr_b16 a[116:117], v19 offset:20480
  v_mfma_f32_16x16x32_bf16 v[116:119], a[100:103], a[68:71], v[116:119]
  ds_read_b64_tr_b16 a[118:119], v19 offset:22528
  ds_read_b64_tr_b16 a[120:121], v20 offset:20480
  v_mfma_f32_16x16x32_bf16 v[132:135], a[100:103], a[72:75], v[132:135]
  buffer_load_dwordx4 v2, s[8:11], s70 offen offset:3072 sc1 lds
  ds_read_b64_tr_b16 a[122:123], v20 offset:22528
  v_mfma_f32_16x16x32_bf16 v[148:151], a[100:103], a[76:79], v[148:151]
  s_bfe_u32 s72, 0x302011a, s1
  s_add_u32 s0, s0, s72
  s_add_u32 s1, s1, 8
  v_mfma_f32_16x16x32_bf16 v[104:107], a[104:107], a[64:67], v[104:107]
  s_and_b32 s1, s1, 0x8001f
  s_cmp_ge_u32 s0, 28
  s_cselect_b32 s72, 28, 0
  v_mfma_f32_16x16x32_bf16 v[120:123], a[104:107], a[68:71], v[120:123]
  s_sub_u32 s0, s0, s72
  s_lshl_b32 s72, s0, 14
  s_add_u32 s70, s92, s72
  v_mfma_f32_16x16x32_bf16 v[136:139], a[104:107], a[72:75], v[136:139]
  s_add_u32 s64, s64, s66
  ds_read_b64_tr_b16 a[124:125], v21 offset:20480
  ds_read_b64_tr_b16 a[126:127], v21 offset:22528
  v_mfma_f32_16x16x32_bf16 v[152:155], a[104:107], a[76:79], v[152:155]
  s_add_u32 s65, s65, 1
  s_cmp_eq_u32 s65, 4
  s_cselect_b32 s65, 0, s65
  s_cselect_b32 s66, s67, s68
  v_mfma_f32_16x16x32_bf16 v[108:111], a[108:111], a[64:67], v[108:111]
  v_add_u32 v16, s66, v16
  v_add_u32 v17, s66, v17
  v_mfma_f32_16x16x32_bf16 v[124:127], a[108:111], a[68:71], v[124:127]
  s_waitcnt vmcnt(16) lgkmcnt(0)
  s_barrier
  v_add_u32 v18, s66, v18
  v_add_u32 v19, s66, v19
  v_mfma_f32_16x16x32_bf16 v[140:143], a[108:111], a[72:75], v[140:143]
  s_sub_u32 s69, s69, 1
  v_add_u32 v20, s66, v20
  v_add_u32 v21, s66, v21
  v_mfma_f32_16x16x32_bf16 v[156:159], a[108:111], a[76:79], v[156:159]
  s_cmp_lg_u32 s69, 0
  s_cbranch_scc1 Lp7_loop
  s_mov_b32 s20, s82
  s_mov_b32 s21, s83
  s_mov_b32 s22, 8388608
  s_mov_b32 s23, 0x00020000
  v_bfe_u32 v25, v1, 4, 1
  v_lshrrev_b32 v26, 5, v1
  v_lshl_or_b32 v25, v25, 1, v26
  v_lshlrev_b32 v25, 4, v25
  v_and_b32 v24, 15, v1
  v_lshl_add_u32 v26, v24, 14, v25
  v_lshl_add_u32 v27, v24, 12, v25
  v_mfma_f32_16x16x32_bf16 v[96:99], a[112:115], a[80:83], v[96:99]
  s_lshl_b32 s6, s78, 1
  s_add_u32 s6, s6, s77
  s_lshl_b32 s6, s6, 2
  v_mfma_f32_16x16x32_bf16 v[112:115], a[112:115], a[84:87], v[112:115]
  s_add_u32 s6, s6, s3
  s_lshl_b32 s6, s6, 14
  s_add_u32 s6, s6, 8192
  v_mfma_f32_16x16x32_bf16 v[128:131], a[112:115], a[88:91], v[128:131]
  s_add_u32 s7, s6, 4096
  buffer_load_dwordx4 v[160:163], v2, s[16:19], s6 offen offset:0 sc1
  ds_read_b128 a[64:67], v16 offset:0
  v_mfma_f32_16x16x32_bf16 v[144:147], a[112:115], a[92:95], v[144:147]
  buffer_load_dwordx4 v[164:167], v2, s[16:19], s6 offen offset:1024 sc1
  ds_read_b64_tr_b16 a[96:97], v18 offset:16384
  v_mfma_f32_16x16x32_bf16 v[100:103], a[116:119], a[80:83], v[100:103]
  buffer_load_dwordx4 v[168:171], v2, s[16:19], s6 offen offset:2048 sc1
  ds_read_b64_tr_b16 a[98:99], v18 offset:18432
  v_mfma_f32_16x16x32_bf16 v[116:119], a[116:119], a[84:87], v[116:119]
  buffer_load_dwordx4 v[172:175], v2, s[16:19], s6 offen offset:3072 sc1
  ds_read_b128 a[68:71], v16 offset:1024
  v_mfma_f32_16x16x32_bf16 v[132:135], a[116:119], a[88:91], v[132:135]
  ds_read_b128 a[72:75], v17 offset:0
  ds_read_b128 a[76:79], v17 offset:1024
  v_mfma_f32_16x16x32_bf16 v[148:151], a[116:119], a[92:95], v[148:151]
  buffer_load_dwordx4 v[176:179], v2, s[16:19], s7 offen offset:0 sc1
  ds_read_b64_tr_b16 a[100:101], v19 offset:16384
  v_mfma_f32_16x16x32_bf16 v[104:107], a[120:123], a[80:83], v[104:107]
  ds_read_b64_tr_b16 a[102:103], v19 offset:18432
  ds_read_b64_tr_b16 a[104:105], v20 offset:16384
  v_mfma_f32_16x16x32_bf16 v[120:123], a[120:123], a[84:87], v[120:123]
  buffer_load_dwordx4 v[180:183], v2, s[16:19], s7 offen offset:1024 sc1
  ds_read_b64_tr_b16 a[106:107], v20 offset:18432
  v_mfma_f32_16x16x32_bf16 v[136:139], a[120:123], a[88:91], v[136:139]
  ds_read_b64_tr_b16 a[108:109], v21 offset:16384
  ds_read_b64_tr_b16 a[110:111], v21 offset:18432
  v_mfma_f32_16x16x32_bf16 v[152:155], a[120:123], a[92:95], v[152:155]
  buffer_load_dwordx4 v[184:187], v2, s[16:19], s7 offen offset:2048 sc1
  v_mfma_f32_16x16x32_bf16 v[108:111], a[124:127], a[80:83], v[108:111]
  v_mfma_f32_16x16x32_bf16 v[124:127], a[124:127], a[84:87], v[124:127]
  buffer_load_dwordx4 v[188:191], v2, s[16:19], s7 offen offset:3072 sc1
  v_mfma_f32_16x16x32_bf16 v[140:143], a[124:127], a[88:91], v[140:143]
  s_lshl_b32 s32, s73, 19
  s_lshl_b32 s72, s76, 8
  s_add_u32 s32, s32, s72
  v_mfma_f32_16x16x32_bf16 v[156:159], a[124:127], a[92:95], v[156:159]
  s_and_b32 s72, s3, 1
  s_lshl_b32 s72, s72, 7
  s_add_u32 s32, s32, s72
  s_lshr_b32 s72, s3, 1
  s_lshl_b32 s72, s72, 1
  s_add_u32 s72, s72, s77
  s_lshl_b32 s72, s72, 17
  s_add_u32 s32, s32, s72
  s_add_u32 s32, s32, 2048
  s_add_u32 s33, s32, 65536
  s_lshl_b32 s34, s73, 19
  s_lshl_b32 s72, s76, 8
  s_add_u32 s34, s34, s72
  s_and_b32 s72, s3, 1
  s_lshl_b32 s72, s72, 7
  s_add_u32 s34, s34, s72
  s_lshr_b32 s72, s3, 1
  s_lshl_b32 s72, s72, 1
  s_add_u32 s72, s72, s77
  s_lshl_b32 s72, s72, 12
  s_add_u32 s34, s34, s72
  s_add_u32 s35, s34, 262144
  s_add_u32 s70, s92, 458752
  s_add_u32 s71, s93, 3670016
  s_waitcnt lgkmcnt(0)
  v_mfma_f32_16x16x32_bf16 v[96:99], a[96:99], a[64:67], v[96:99]
  s_add_u32 m0, s64, 16384
  ds_read_b128 a[80:83], v16 offset:8192
  ds_read_b64_tr_b16 a[112:113], v18 offset:20480
  v_mfma_f32_16x16x32_bf16 v[112:115], a[96:99], a[68:71], v[112:115]
  buffer_load_dwordx4 v10, s[12:15], s71 offen offset:0 lds
  ds_read_b64_tr_b16 a[114:115], v18 offset:22528
  v_mfma_f32_16x16x32_bf16 v[128:131], a[96:99], a[72:75], v[128:131]
  buffer_load_dwordx4 v11, s[12:15], s71 offen offset:1024 lds
  ds_read_b128 a[84:87], v16 offset:9216
  v_mfma_f32_16x16x32_bf16 v[144:147], a[96:99], a[76:79], v[144:147]
  buffer_load_dwordx4 v12, s[12:15], s71 offen offset:2048 lds
  ds_read_b128 a[88:91], v17 offset:8192
  v_mfma_f32_16x16x32_bf16 v[100:103], a[100:103], a[64:67], v[100:103]
  buffer_load_dwordx4 v13, s[12:15], s71 offen offset:3072 lds
  ds_read_b128 a[92:95], v17 offset:9216
  v_mfma_f32_16x16x32_bf16 v[116:119], a[100:103], a[68:71], v[116:119]
  s_add_u32 s71, s71, 131072
  s_mov_b32 m0, s64
  ds_read_b64_tr_b16 a[116:117], v19 offset:20480
  v_mfma_f32_16x16x32_bf16 v[132:135], a[100:103], a[72:75], v[132:135]
  buffer_load_dwordx4 v2, s[8:11], s70 offen offset:0 sc1 lds
  ds_read_b64_tr_b16 a[118:119], v19 offset:22528
  v_mfma_f32_16x16x32_bf16 v[148:151], a[100:103], a[76:79], v[148:151]
  buffer_load_dwordx4 v2, s[8:11], s70 offen offset:1024 sc1 lds
  ds_read_b64_tr_b16 a[120:121], v20 offset:20480
  v_mfma_f32_16x16x32_bf16 v[104:107], a[104:107], a[64:67], v[104:107]
  buffer_load_dwordx4 v2, s[8:11], s70 offen offset:2048 sc1 lds
  ds_read_b64_tr_b16 a[122:123], v20 offset:22528
  v_mfma_f32_16x16x32_bf16 v[120:123], a[104:107], a[68:71], v[120:123]
  buffer_load_dwordx4 v2, s[8:11], s70 offen offset:3072 sc1 lds
  ds_read_b64_tr_b16 a[124:125], v21 offset:20480
  v_mfma_f32_16x16x32_bf16 v[136:139], a[104:107], a[72:75], v[136:139]
  s_add_u32 s70, s70, 16384
  ds_read_b64_tr_b16 a[126:127], v21 offset:22528
  v_mfma_f32_16x16x32_bf16 v[152:155], a[104:107], a[76:79], v[152:155]
  s_add_u32 s64, s64, s66
  s_add_u32 s65, s65, 1
  s_cmp_eq_u32 s65, 4
  s_cselect_b32 s65, 0, s65
  s_cselect_b32 s66, s67, s68
  v_mfma_f32_16x16x32_bf16 v[108:111], a[108:111], a[64:67], v[108:111]
  v_add_u32 v16, s66, v16
  v_add_u32 v17, s66, v17
  v_mfma_f32_16x16x32_bf16 v[124:127], a[108:111], a[68:71], v[124:127]
  v_add_u32 v18, s66, v18
  v_add_u32 v19, s66, v19
  v_mfma_f32_16x16x32_bf16 v[140:143], a[108:111], a[72:75], v[140:143]
  v_add_u32 v20, s66, v20
  v_add_u32 v21, s66, v21
  v_mfma_f32_16x16x32_bf16 v[156:159], a[108:111], a[76:79], v[156:159]
  s_waitcnt vmcnt(24) lgkmcnt(0)
  s_barrier
  v_mfma_f32_16x16x32_bf16 v[96:99], a[112:115], a[80:83], v[96:99]
  s_add_u32 m0, s64, 16384
  ds_read_b128 a[64:67], v16 offset:0
  ds_read_b64_tr_b16 a[96:97], v18 offset:16384
  v_mfma_f32_16x16x32_bf16 v[112:115], a[112:115], a[84:87], v[112:115]
  buffer_load_dwordx4 v10, s[12:15], s71 offen offset:0 lds
  ds_read_b64_tr_b16 a[98:99], v18 offset:18432
  v_mfma_f32_16x16x32_bf16 v[128:131], a[112:115], a[88:91], v[128:131]
  ds_read_b128 a[68:71], v16 offset:1024
  ds_read_b128 a[72:75], v17 offset:0
  v_mfma_f32_16x16x32_bf16 v[144:147], a[112:115], a[92:95], v[144:147]
  buffer_load_dwordx4 v11, s[12:15], s71 offen offset:1024 lds
  ds_read_b128 a[76:79], v17 offset:1024
  v_mfma_f32_16x16x32_bf16 v[100:103], a[116:119], a[80:83], v[100:103]
  ds_read_b64_tr_b16 a[100:101], v19 offset:16384
  ds_read_b64_tr_b16 a[102:103], v19 offset:18432
  v_mfma_f32_16x16x32_bf16 v[116:119], a[116:119], a[84:87], v[116:119]
  ds_read_b64_tr_b16 a[104:105], v20 offset:16384
  ds_read_b64_tr_b16 a[106:107], v20 offset:18432
  v_mfma_f32_16x16x32_bf16 v[132:135], a[116:119], a[88:91], v[132:135]
  ds_read_b64_tr_b16 a[108:109], v21 offset:16384
  ds_read_b64_tr_b16 a[110:111], v21 offset:18432
  v_mfma_f32_16x16x32_bf16 v[148:151], a[116:119], a[92:95], v[148:151]
  buffer_load_dwordx4 v12, s[12:15], s71 offen offset:2048 lds
  v_mfma_f32_16x16x32_bf16 v[104:107], a[120:123], a[80:83], v[104:107]
  v_mfma_f32_16x16x32_bf16 v[120:123], a[120:123], a[84:87], v[120:123]
  v_mfma_f32_16x16x32_bf16 v[136:139], a[120:123], a[88:91], v[136:139]
  v_mfma_f32_16x16x32_bf16 v[152:155], a[120:123], a[92:95], v[152:155]
  buffer_load_dwordx4 v13, s[12:15], s71 offen offset:3072 lds
  v_mfma_f32_16x16x32_bf16 v[108:111], a[124:127], a[80:83], v[108:111]
  s_add_u32 s71, s71, 131072
  v_mfma_f32_16x16x32_bf16 v[124:127], a[124:127], a[84:87], v[124:127]
  v_mfma_f32_16x16x32_bf16 v[140:143], a[124:127], a[88:91], v[140:143]
  v_mfma_f32_16x16x32_bf16 v[156:159], a[124:127], a[92:95], v[156:159]
  s_waitcnt lgkmcnt(0)
  v_mfma_f32_16x16x32_bf16 v[96:99], a[96:99], a[64:67], v[96:99]
  s_mov_b32 m0, s64
  ds_read_b128 a[80:83], v16 offset:8192
  ds_read_b64_tr_b16 a[112:113], v18 offset:20480
  v_mfma_f32_16x16x32_bf16 v[112:115], a[96:99], a[68:71], v[112:115]
  buffer_load_dwordx4 v2, s[8:11], s70 offen offset:0 sc1 lds
  ds_read_b64_tr_b16 a[114:115], v18 offset:22528
  v_mfma_f32_16x16x32_bf16 v[128:131], a[96:99], a[72:75], v[128:131]
  buffer_load_dwordx4 v2, s[8:11], s70 offen offset:1024 sc1 lds
  ds_read_b128 a[84:87], v16 offset:9216
  v_mfma_f32_16x16x32_bf16 v[144:147], a[96:99], a[76:79], v[144:147]
  ds_read_b128 a[88:91], v17 offset:8192
  ds_read_b128 a[92:95], v17 offset:9216
  v_mfma_f32_16x16x32_bf16 v[100:103], a[100:103], a[64:67], v[100:103]
  buffer_load_dwordx4 v2, s[8:11], s70 offen offset:2048 sc1 lds
  ds_read_b64_tr_b16 a[116:117], v19 offset:20480
  v_mfma_f32_16x16x32_bf16 v[116:119], a[100:103], a[68:71], v[116:119]
  ds_read_b64_tr_b16 a[118:119], v19 offset:22528
  ds_read_b64_tr_b16 a[120:121], v20 offset:20480
  v_mfma_f32_16x16x32_bf16 v[132:135], a[100:103], a[72:75], v[132:135]
  buffer_load_dwordx4 v2, s[8:11], s70 offen offset:3072 sc1 lds
  ds_read_b64_tr_b16 a[122:123], v20 offset:22528
  v_mfma_f32_16x16x32_bf16 v[148:151], a[100:103], a[76:79], v[148:151]
  s_add_u32 s70, s70, 16384
  ds_read_b64_tr_b16 a[124:125], v21 offset:20480
  ds_read_b64_tr_b16 a[126:127], v21 offset:22528
  v_mfma_f32_16x16x32_bf16 v[104:107], a[104:107], a[64:67], v[104:107]
  s_add_u32 s64, s64, s66
  s_add_u32 s65, s65, 1
  s_cmp_eq_u32 s65, 4
  s_cselect_b32 s65, 0, s65
  s_cselect_b32 s66, s67, s68
  v_mfma_f32_16x16x32_bf16 v[120:123], a[104:107], a[68:71], v[120:123]
  v_add_u32 v16, s66, v16
  v_add_u32 v17, s66, v17
  v_mfma_f32_16x16x32_bf16 v[136:139], a[104:107], a[72:75], v[136:139]
  v_add_u32 v18, s66, v18
  v_add_u32 v19, s66, v19
  v_mfma_f32_16x16x32_bf16 v[152:155], a[104:107], a[76:79], v[152:155]
  v_add_u32 v20, s66, v20
  v_add_u32 v21, s66, v21
  v_mfma_f32_16x16x32_bf16 v[108:111], a[108:111], a[64:67], v[108:111]
  v_mfma_f32_16x16x32_bf16 v[124:127], a[108:111], a[68:71], v[124:127]
  v_mfma_f32_16x16x32_bf16 v[140:143], a[108:111], a[72:75], v[140:143]
  v_mfma_f32_16x16x32_bf16 v[156:159], a[108:111], a[76:79], v[156:159]
  s_waitcnt vmcnt(16) lgkmcnt(0)
  s_barrier
  s_mov_b32 s72, 0x40000
Lrc_11:
  v_max3_u32 v4, v160, v161, v162
  v_max3_u32 v5, v168, v169, v170
  v_max3_u32 v6, v176, v177, v178
  v_max3_u32 v7, v184, v185, v186
  v_max3_u32 v4, v4, v163, v164
  v_max3_u32 v5, v5, v171, v172
  v_max3_u32 v6, v6, v179, v180
  v_max3_u32 v7, v7, v187, v188
  v_max3_u32 v4, v4, v165, v166
  v_max3_u32 v5, v5, v173, v174
  v_max3_u32 v6, v6, v181, v182
  v_max3_u32 v7, v7, v189, v190
  v_max_u32 v4, v4, v167
  v_max_u32 v5, v5, v175
  v_max_u32 v6, v6, v183
  v_max_u32 v7, v7, v191
  v_max3_u32 v4, v4, v5, v6
  v_max_u32 v4, v4, v7
  v_cmp_eq_u32 vcc, -1, v4
  s_nop 0
  s_cbranch_vccz Lpolld_12
  buffer_load_dwordx4 v[160:163], v2, s[16:19], s6 offen offset:0 sc1
  buffer_load_dwordx4 v[164:167], v2, s[16:19], s6 offen offset:1024 sc1
  buffer_load_dwordx4 v[168:171], v2, s[16:19], s6 offen offset:2048 sc1
  buffer_load_dwordx4 v[172:175], v2, s[16:19], s6 offen offset:3072 sc1
  buffer_load_dwordx4 v[176:179], v2, s[16:19], s7 offen offset:0 sc1
  buffer_load_dwordx4 v[180:183], v2, s[16:19], s7 offen offset:1024 sc1
  buffer_load_dwordx4 v[184:187], v2, s[16:19], s7 offen offset:2048 sc1
  buffer_load_dwordx4 v[188:191], v2, s[16:19], s7 offen offset:3072 sc1
  s_sub_u32 s72, s72, 1
  s_waitcnt vmcnt(0)
  s_cbranch_scc0 Lrc_11
Lpolld_12:
  v_mfma_f32_16x16x32_bf16 v[96:99], a[112:115], a[80:83], v[96:99]
  s_and_b32 s88, s3, 1
  s_lshl_b32 s88, s88, 12
  s_lshr_b32 s72, s3, 1
  v_mfma_f32_16x16x32_bf16 v[112:115], a[112:115], a[84:87], v[112:115]
  s_lshl_b32 s72, s72, 13
  s_add_u32 s88, s88, s72
  s_lshl_b32 s72, s77, 11
  v_mfma_f32_16x16x32_bf16 v[128:131], a[112:115], a[88:91], v[128:131]
  s_add_u32 s88, s88, s72
  s_sub_u32 s88, s88, s79
  s_add_u32 s70, s92, s88
  v_mfma_f32_16x16x32_bf16 v[144:147], a[112:115], a[92:95], v[144:147]
  s_add_u32 s70, s70, 491520
  s_add_u32 s71, s93, 3932160
  s_add_u32 m0, s64, 16384
  v_mfma_f32_16x16x32_bf16 v[100:103], a[116:119], a[80:83], v[100:103]
  buffer_load_dwordx4 v10, s[12:15], s71 offen offset:0 lds
  ds_read_b128 a[64:67], v16 offset:0
  v_mfma_f32_16x16x32_bf16 v[116:119], a[116:119], a[84:87], v[116:119]
  buffer_load_dwordx4 v11, s[12:15], s71 offen offset:1024 lds
  ds_read_b64_tr_b16 a[96:97], v18 offset:16384
  v_mfma_f32_16x16x32_bf16 v[132:135], a[116:119], a[88:91], v[132:135]
  ds_read_b64_tr_b16 a[98:99], v18 offset:18432
  ds_read_b128 a[68:71], v16 offset:1024
  v_mfma_f32_16x16x32_bf16 v[148:151], a[116:119], a[92:95], v[148:151]
  ds_read_b128 a[72:75], v17 offset:0
  ds_read_b128 a[76:79], v17 offset:1024
  v_mfma_f32_16x16x32_bf16 v[104:107], a[120:123], a[80:83], v[104:107]
  ds_read_b64_tr_b16 a[100:101], v19 offset:16384
  ds_read_b64_tr_b16 a[102:103], v19 offset:18432
  v_mfma_f32_16x16x32_bf16 v[120:123], a[120:123], a[84:87], v[120:123]
  ds_read_b64_tr_b16 a[104:105], v20 offset:16384
  ds_read_b64_tr_b16 a[106:107], v20 offset:18432
  v_mfma_f32_16x16x32_bf16 v[136:139], a[120:123], a[88:91], v[136:139]
  buffer_load_dwordx4 v12, s[12:15], s71 offen offset:2048 lds
  ds_read_b64_tr_b16 a[108:109], v21 offset:16384
  v_mfma_f32_16x16x32_bf16 v[152:155], a[120:123], a[92:95], v[152:155]
  ds_read_b64_tr_b16 a[110:111], v21 offset:18432
  v_pk_add_f32 v[160:161], v[160:161], v[32:33]
  v_mfma_f32_16x16x32_bf16 v[108:111], a[124:127], a[80:83], v[108:111]
  v_pk_add_f32 v[162:163], v[162:163], v[34:35]
  v_pk_add_f32 v[164:165], v[164:165], v[36:37]
  v_mfma_f32_16x16x32_bf16 v[124:127], a[124:127], a[84:87], v[124:127]
  v_pk_add_f32 v[166:167], v[166:167], v[38:39]
  v_cvt_pk_bf16_f32 v160, v160, v161
  v_mfma_f32_16x16x32_bf16 v[140:143], a[124:127], a[88:91], v[140:143]
  v_cvt_pk_bf16_f32 v161, v162, v163
  v_cvt_pk_bf16_f32 v162, v164, v165
  v_mfma_f32_16x16x32_bf16 v[156:159], a[124:127], a[92:95], v[156:159]
  v_cvt_pk_bf16_f32 v163, v166, v167
  v_permlane16_swap_b32 v160, v162
  s_nop 0
  v_permlane16_swap_b32 v161, v163
  s_waitcnt lgkmcnt(0)
  v_mfma_f32_16x16x32_bf16 v[96:99], a[96:99], a[64:67], v[96:99]
  buffer_load_dwordx4 v13, s[12:15], s71 offen offset:3072 lds
  ds_read_b128 a[80:83], v16 offset:8192
  v_mfma_f32_16x16x32_bf16 v[112:115], a[96:99], a[68:71], v[112:115]
  s_add_u32 s71, s71, 131072
  s_add_u32 m0, s64, s88
  ds_read_b64_tr_b16 a[112:113], v18 offset:20480
  v_mfma_f32_16x16x32_bf16 v[128:131], a[96:99], a[72:75], v[128:131]
  ds_read_b64_tr_b16 a[114:115], v18 offset:22528
  ds_read_b128 a[84:87], v16 offset:9216
  v_mfma_f32_16x16x32_bf16 v[144:147], a[96:99], a[76:79], v[144:147]
  buffer_load_dwordx4 v2, s[8:11], s70 offen offset:0 sc1 lds
  ds_read_b128 a[88:91], v17 offset:8192
  v_mfma_f32_16x16x32_bf16 v[100:103], a[100:103], a[64:67], v[100:103]
  ds_read_b128 a[92:95], v17 offset:9216
  ds_read_b64_tr_b16 a[116:117], v19 offset:20480
  v_mfma_f32_16x16x32_bf16 v[116:119], a[100:103], a[68:71], v[116:119]
  ds_read_b64_tr_b16 a[118:119], v19 offset:22528
  ds_read_b64_tr_b16 a[120:121], v20 offset:20480
  v_mfma_f32_16x16x32_bf16 v[132:135], a[100:103], a[72:75], v[132:135]
  buffer_load_dwordx4 v2, s[8:11], s70 offen offset:1024 sc1 lds
  ds_read_b64_tr_b16 a[122:123], v20 offset:22528
  v_mfma_f32_16x16x32_bf16 v[148:151], a[100:103], a[76:79], v[148:151]
  s_add_u32 s70, s70, 16384
  ds_read_b64_tr_b16 a[124:125], v21 offset:20480
  ds_read_b64_tr_b16 a[126:127], v21 offset:22528
  v_mfma_f32_16x16x32_bf16 v[104:107], a[104:107], a[64:67], v[104:107]
  s_add_u32 s64, s64, s66
  s_add_u32 s65, s65, 1
  s_cmp_eq_u32 s65, 4
  s_cselect_b32 s65, 0, s65
  s_cselect_b32 s66, s67, s68
  v_mfma_f32_16x16x32_bf16 v[120:123], a[104:107], a[68:71], v[120:123]
  v_add_u32 v16, s66, v16
  v_add_u32 v17, s66, v17
  v_mfma_f32_16x16x32_bf16 v[136:139], a[104:107], a[72:75], v[136:139]
  v_add_u32 v18, s66, v18
  v_add_u32 v19, s66, v19
  v_mfma_f32_16x16x32_bf16 v[152:155], a[104:107], a[76:79], v[152:155]
  v_add_u32 v20, s66, v20
  v_add_u32 v21, s66, v21
  v_mfma_f32_16x16x32_bf16 v[108:111], a[108:111], a[64:67], v[108:111]
  v_mfma_f32_16x16x32_bf16 v[124:127], a[108:111], a[68:71], v[124:127]
  v_mfma_f32_16x16x32_bf16 v[140:143], a[108:111], a[72:75], v[140:143]
  v_mfma_f32_16x16x32_bf16 v[156:159], a[108:111], a[76:79], v[156:159]
  buffer_store_dwordx4 v[160:163], v27, s[20:23], s32 offen offset:0
  s_waitcnt vmcnt(15) lgkmcnt(0)
  s_barrier
  v_mfma_f32_16x16x32_bf16 v[96:99], a[112:115], a[80:83], v[96:99]
  s_add_u32 m0, s64, 16384
  ds_read_b128 a[64:67], v16 offset:0
  ds_read_b64_tr_b16 a[96:97], v18 offset:16384
  v_mfma_f32_16x16x32_bf16 v[112:115], a[112:115], a[84:87], v[112:115]
  buffer_load_dwordx4 v10, s[12:15], s71 offen offset:0 lds
  ds_read_b64_tr_b16 a[98:99], v18 offset:18432
  v_mfma_f32_16x16x32_bf16 v[128:131], a[112:115], a[88:91], v[128:131]
  ds_read_b128 a[68:71], v16 offset:1024
  ds_read_b128 a[72:75], v17 offset:0
  v_mfma_f32_16x16x32_bf16 v[144:147], a[112:115], a[92:95], v[144:147]
  ds_read_b128 a[76:79], v17 offset:1024
  ds_read_b64_tr_b16 a[100:101], v19 offset:16384
  v_mfma_f32_16x16x32_bf16 v[100:103], a[116:119], a[80:83], v[100:103]
  ds_read_b64_tr_b16 a[102:103], v19 offset:18432
  ds_read_b64_tr_b16 a[104:105], v20 offset:16384
  v_mfma_f32_16x16x32_bf16 v[116:119], a[116:119], a[84:87], v[116:119]
  buffer_load_dwordx4 v11, s[12:15], s71 offen offset:1024 lds
  ds_read_b64_tr_b16 a[106:107], v20 offset:18432
  v_mfma_f32_16x16x32_bf16 v[132:135], a[116:119], a[88:91], v[132:135]
  ds_read_b64_tr_b16 a[108:109], v21 offset:16384
  ds_read_b64_tr_b16 a[110:111], v21 offset:18432
  v_mfma_f32_16x16x32_bf16 v[148:151], a[116:119], a[92:95], v[148:151]
  v_pk_add_f32 v[168:169], v[168:169], v[40:41]
  v_pk_add_f32 v[170:171], v[170:171], v[42:43]
  v_mfma_f32_16x16x32_bf16 v[104:107], a[120:123], a[80:83], v[104:107]
  v_pk_add_f32 v[172:173], v[172:173], v[44:45]
  v_pk_add_f32 v[174:175], v[174:175], v[46:47]
  v_mfma_f32_16x16x32_bf16 v[120:123], a[120:123], a[84:87], v[120:123]
  v_cvt_pk_bf16_f32 v168, v168, v169
  v_cvt_pk_bf16_f32 v169, v170, v171
  v_mfma_f32_16x16x32_bf16 v[136:139], a[120:123], a[88:91], v[136:139]
  buffer_load_dwordx4 v12, s[12:15], s71 offen offset:2048 lds
  v_cvt_pk_bf16_f32 v170, v172, v173
  v_mfma_f32_16x16x32_bf16 v[152:155], a[120:123], a[92:95], v[152:155]
  v_cvt_pk_bf16_f32 v171, v174, v175
  v_permlane16_swap_b32 v168, v170
  v_mfma_f32_16x16x32_bf16 v[108:111], a[124:127], a[80:83], v[108:111]
  v_permlane16_swap_b32 v169, v171
  v_mfma_f32_16x16x32_bf16 v[124:127], a[124:127], a[84:87], v[124:127]
  v_mfma_f32_16x16x32_bf16 v[140:143], a[124:127], a[88:91], v[140:143]
  v_mfma_f32_16x16x32_bf16 v[156:159], a[124:127], a[92:95], v[156:159]
  s_waitcnt lgkmcnt(0)
  v_mfma_f32_16x16x32_bf16 v[96:99], a[96:99], a[64:67], v[96:99]
  buffer_load_dwordx4 v13, s[12:15], s71 offen offset:3072 lds
  ds_read_b128 a[80:83], v16 offset:8192
  v_mfma_f32_16x16x32_bf16 v[112:115], a[96:99], a[68:71], v[112:115]
  s_add_u32 s71, s71, 131072
  s_add_u32 m0, s64, s88
  ds_read_b64_tr_b16 a[112:113], v18 offset:20480
  v_mfma_f32_16x16x32_bf16 v[128:131], a[96:99], a[72:75], v[128:131]
  ds_read_b64_tr_b16 a[114:115], v18 offset:22528
  ds_read_b128 a[84:87], v16 offset:9216
  v_mfma_f32_16x16x32_bf16 v[144:147], a[96:99], a[76:79], v[144:147]
  buffer_load_dwordx4 v2, s[8:11], s70 offen offset:0 sc1 lds
  ds_read_b128 a[88:91], v17 offset:8192
  v_mfma_f32_16x16x32_bf16 v[100:103], a[100:103], a[64:67], v[100:103]
  ds_read_b128 a[92:95], v17 offset:9216
  ds_read_b64_tr_b16 a[116:117], v19 offset:20480
  v_mfma_f32_16x16x32_bf16 v[116:119], a[100:103], a[68:71], v[116:119]
  ds_read_b64_tr_b16 a[118:119], v19 offset:22528
  ds_read_b64_tr_b16 a[120:121], v20 offset:20480
  v_mfma_f32_16x16x32_bf16 v[132:135], a[100:103], a[72:75], v[132:135]
  buffer_load_dwordx4 v2, s[8:11], s70 offen offset:1024 sc1 lds
  ds_read_b64_tr_b16 a[122:123], v20 offset:22528
  v_mfma_f32_16x16x32_bf16 v[148:151], a[100:103], a[76:79], v[148:151]
  s_add_u32 s70, s70, 16384
  ds_read_b64_tr_b16 a[124:125], v21 offset:20480
  ds_read_b64_tr_b16 a[126:127], v21 offset:22528
  v_mfma_f32_16x16x32_bf16 v[104:107], a[104:107], a[64:67], v[104:107]
  s_add_u32 s64, s64, s66
  s_add_u32 s65, s65, 1
  s_cmp_eq_u32 s65, 4
  s_cselect_b32 s65, 0, s65
  s_cselect_b32 s66, s67, s68
  v_mfma_f32_16x16x32_bf16 v[120:123], a[104:107], a[68:71], v[120:123]
  v_add_u32 v16, s66, v16
  v_add_u32 v17, s66, v17
  v_mfma_f32_16x16x32_bf16 v[136:139], a[104:107], a[72:75], v[136:139]
  v_add_u32 v18, s66, v18
  v_add_u32 v19, s66, v19
  v_mfma_f32_16x16x32_bf16 v[152:155], a[104:107], a[76:79], v[152:155]
  v_add_u32 v20, s66, v20
  v_add_u32 v21, s66, v21
  v_mfma_f32_16x16x32_bf16 v[108:111], a[108:111], a[64:67], v[108:111]
  v_mfma_f32_16x16x32_bf16 v[124:127], a[108:111], a[68:71], v[124:127]
  v_mfma_f32_16x16x32_bf16 v[140:143], a[108:111], a[72:75], v[140:143]
  v_mfma_f32_16x16x32_bf16 v[156:159], a[108:111], a[76:79], v[156:159]
  buffer_store_dwordx4 v[168:171], v27, s[20:23], s32 offen offset:64
  s_waitcnt vmcnt(14) lgkmcnt(0)
  s_barrier
  v_mfma_f32_16x16x32_bf16 v[96:99], a[112:115], a[80:83], v[96:99]
  s_sub_u32 s70, s70, 32768
  s_xor_b32 s70, s70, 524288
  s_sub_u32 s71, s71, 262144
  v_mfma_f32_16x16x32_bf16 v[112:115], a[112:115], a[84:87], v[112:115]
  s_xor_b32 s71, s71, 4194304
  s_add_u32 m0, s64, 16384
  ds_read_b128 a[64:67], v16 offset:0
  v_mfma_f32_16x16x32_bf16 v[128:131], a[112:115], a[88:91], v[128:131]
  buffer_load_dwordx4 v10, s[12:15], s71 offen offset:0 lds
  ds_read_b64_tr_b16 a[96:97], v18 offset:16384
  v_mfma_f32_16x16x32_bf16 v[144:147], a[112:115], a[92:95], v[144:147]
  ds_read_b64_tr_b16 a[98:99], v18 offset:18432
  ds_read_b128 a[68:71], v16 offset:1024
  v_mfma_f32_16x16x32_bf16 v[100:103], a[116:119], a[80:83], v[100:103]
  ds_read_b128 a[72:75], v17 offset:0
  ds_read_b128 a[76:79], v17 offset:1024
  v_mfma_f32_16x16x32_bf16 v[116:119], a[116:119], a[84:87], v[116:119]
  buffer_load_dwordx4 v11, s[12:15], s71 offen offset:1024 lds
  ds_read_b64_tr_b16 a[100:101], v19 offset:16384
  v_mfma_f32_16x16x32_bf16 v[132:135], a[116:119], a[88:91], v[132:135]
  ds_read_b64_tr_b16 a[102:103], v19 offset:18432
  ds_read_b64_tr_b16 a[104:105], v20 offset:16384
  v_mfma_f32_16x16x32_bf16 v[148:151], a[116:119], a[92:95], v[148:151]
  ds_read_b64_tr_b16 a[106:107], v20 offset:18432
  ds_read_b64_tr_b16 a[108:109], v21 offset:16384
  v_mfma_f32_16x16x32_bf16 v[104:107], a[120:123], a[80:83], v[104:107]
  ds_read_b64_tr_b16 a[110:111], v21 offset:18432
  v_pk_add_f32 v[176:177], v[176:177], v[48:49]
  v_mfma_f32_16x16x32_bf16 v[120:123], a[120:123], a[84:87], v[120:123]
  v_pk_add_f32 v[178:179], v[178:179], v[50:51]
  v_pk_add_f32 v[180:181], v[180:181], v[52:53]
  v_mfma_f32_16x16x32_bf16 v[136:139], a[120:123], a[88:91], v[136:139]
  buffer_load_dwordx4 v12, s[12:15], s71 offen offset:2048 lds
  v_pk_add_f32 v[182:183], v[182:183], v[54:55]
  v_mfma_f32_16x16x32_bf16 v[152:155], a[120:123], a[92:95], v[152:155]
  v_cvt_pk_bf16_f32 v176, v176, v177
  v_cvt_pk_bf16_f32 v177, v178, v179
  v_mfma_f32_16x16x32_bf16 v[108:111], a[124:127], a[80:83], v[108:111]
  v_cvt_pk_bf16_f32 v178, v180, v181
  v_cvt_pk_bf16_f32 v179, v182, v183
  v_mfma_f32_16x16x32_bf16 v[124:127], a[124:127], a[84:87], v[124:127]
  v_permlane16_swap_b32 v176, v178
  v_permlane16_swap_b32 v177, v179
  v_mfma_f32_16x16x32_bf16 v[140:143], a[124:127], a[88:91], v[140:143]
  v_mfma_f32_16x16x32_bf16 v[156:159], a[124:127], a[92:95], v[156:159]
  s_waitcnt lgkmcnt(0)
  v_mfma_f32_16x16x32_bf16 v[96:99], a[96:99], a[64:67], v[96:99]
  buffer_load_dwordx4 v13, s[12:15], s71 offen offset:3072 lds
  ds_read_b128 a[80:83], v16 offset:8192
  v_mfma_f32_16x16x32_bf16 v[112:115], a[96:99], a[68:71], v[112:115]
  s_add_u32 s71, s71, 131072
  s_add_u32 m0, s64, s88
  ds_read_b64_tr_b16 a[112:113], v18 offset:20480
  v_mfma_f32_16x16x32_bf16 v[128:131], a[96:99], a[72:75], v[128:131]
  ds_read_b64_tr_b16 a[114:115], v18 offset:22528
  ds_read_b128 a[84:87], v16 offset:9216
  v_mfma_f32_16x16x32_bf16 v[144:147], a[96:99], a[76:79], v[144:147]
  buffer_load_dwordx4 v2, s[8:11], s70 offen offset:0 sc1 lds
  ds_read_b128 a[88:91], v17 offset:8192
  v_mfma_f32_16x16x32_bf16 v[100:103], a[100:103], a[64:67], v[100:103]
  ds_read_b128 a[92:95], v17 offset:9216
  ds_read_b64_tr_b16 a[116:117], v19 offset:20480
  v_mfma_f32_16x16x32_bf16 v[116:119], a[100:103], a[68:71], v[116:119]
  ds_read_b64_tr_b16 a[118:119], v19 offset:22528
  ds_read_b64_tr_b16 a[120:121], v20 offset:20480
  v_mfma_f32_16x16x32_bf16 v[132:135], a[100:103], a[72:75], v[132:135]
  buffer_load_dwordx4 v2, s[8:11], s70 offen offset:1024 sc1 lds
  ds_read_b64_tr_b16 a[122:123], v20 offset:22528
  v_mfma_f32_16x16x32_bf16 v[148:151], a[100:103], a[76:79], v[148:151]
  s_add_u32 s70, s70, 16384
  ds_read_b64_tr_b16 a[124:125], v21 offset:20480
  ds_read_b64_tr_b16 a[126:127], v21 offset:22528
  v_mfma_f32_16x16x32_bf16 v[104:107], a[104:107], a[64:67], v[104:107]
  s_add_u32 s64, s64, s66
  s_add_u32 s65, s65, 1
  s_cmp_eq_u32 s65, 4
  s_cselect_b32 s65, 0, s65
  s_cselect_b32 s66, s67, s68
  v_mfma_f32_16x16x32_bf16 v[120:123], a[104:107], a[68:71], v[120:123]
  v_add_u32 v16, s66, v16
  v_add_u32 v17, s66, v17
  v_mfma_f32_16x16x32_bf16 v[136:139], a[104:107], a[72:75], v[136:139]
  v_add_u32 v18, s66, v18
  v_add_u32 v19, s66, v19
  v_mfma_f32_16x16x32_bf16 v[152:155], a[104:107], a[76:79], v[152:155]
  v_add_u32 v20, s66, v20
  v_add_u32 v21, s66, v21
  v_mfma_f32_16x16x32_bf16 v[108:111], a[108:111], a[64:67], v[108:111]
  v_mfma_f32_16x16x32_bf16 v[124:127], a[108:111], a[68:71], v[124:127]
  v_mfma_f32_16x16x32_bf16 v[140:143], a[108:111], a[72:75], v[140:143]
  v_mfma_f32_16x16x32_bf16 v[156:159], a[108:111], a[76:79], v[156:159]
  buffer_store_dwordx4 v[176:179], v27, s[20:23], s33 offen offset:0
  s_waitcnt vmcnt(15) lgkmcnt(0)
  s_barrier
  v_mfma_f32_16x16x32_bf16 v[96:99], a[112:115], a[80:83], v[96:99]
  s_add_u32 m0, s64, 16384
  ds_read_b128 a[64:67], v16 offset:0
  ds_read_b64_tr_b16 a[96:97], v18 offset:16384
  v_mfma_f32_16x16x32_bf16 v[112:115], a[112:115], a[84:87], v[112:115]
  buffer_load_dwordx4 v10, s[12:15], s71 offen offset:0 lds
  ds_read_b64_tr_b16 a[98:99], v18 offset:18432
  v_mfma_f32_16x16x32_bf16 v[128:131], a[112:115], a[88:91], v[128:131]
  buffer_load_dwordx4 v11, s[12:15], s71 offen offset:1024 lds
  ds_read_b128 a[68:71], v16 offset:1024
  v_mfma_f32_16x16x32_bf16 v[144:147], a[112:115], a[92:95], v[144:147]
  ds_read_b64_tr_b16 a[100:101], v19 offset:16384
  ds_read_b64_tr_b16 a[102:103], v19 offset:18432
  v_mfma_f32_16x16x32_bf16 v[100:103], a[116:119], a[80:83], v[100:103]
  ds_read_b64_tr_b16 a[104:105], v20 offset:16384
  ds_read_b64_tr_b16 a[106:107], v20 offset:18432
  v_mfma_f32_16x16x32_bf16 v[116:119], a[116:119], a[84:87], v[116:119]
  buffer_load_dwordx4 v12, s[12:15], s71 offen offset:2048 lds
  ds_read_b64_tr_b16 a[108:109], v21 offset:16384
  v_mfma_f32_16x16x32_bf16 v[132:135], a[116:119], a[88:91], v[132:135]
  ds_read_b64_tr_b16 a[110:111], v21 offset:18432
  v_pk_add_f32 v[184:185], v[184:185], v[56:57]
  v_mfma_f32_16x16x32_bf16 v[148:151], a[116:119], a[92:95], v[148:151]
  buffer_load_dwordx4 v13, s[12:15], s71 offen offset:3072 lds
  v_pk_add_f32 v[186:187], v[186:187], v[58:59]
  v_mfma_f32_16x16x32_bf16 v[104:107], a[120:123], a[80:83], v[104:107]
  s_add_u32 s71, s71, 131072
  s_add_u32 m0, s64, s88
  v_pk_add_f32 v[188:189], v[188:189], v[60:61]
  v_mfma_f32_16x16x32_bf16 v[120:123], a[120:123], a[84:87], v[120:123]
  v_pk_add_f32 v[190:191], v[190:191], v[62:63]
  v_cvt_pk_bf16_f32 v184, v184, v185
  v_mfma_f32_16x16x32_bf16 v[136:139], a[120:123], a[88:91], v[136:139]
  buffer_load_dwordx4 v2, s[8:11], s70 offen offset:0 sc1 lds
  v_cvt_pk_bf16_f32 v185, v186, v187
  v_mfma_f32_16x16x32_bf16 v[152:155], a[120:123], a[92:95], v[152:155]
  v_cvt_pk_bf16_f32 v186, v188, v189
  v_cvt_pk_bf16_f32 v187, v190, v191
  v_mfma_f32_16x16x32_bf16 v[108:111], a[124:127], a[80:83], v[108:111]
  buffer_load_dwordx4 v2, s[8:11], s70 offen offset:1024 sc1 lds
  v_permlane16_swap_b32 v184, v186
  v_mfma_f32_16x16x32_bf16 v[124:127], a[124:127], a[84:87], v[124:127]
  s_add_u32 s70, s70, 16384
  s_lshl_b32 s36, s78, 1
  s_add_u32 s36, s36, s77
  v_mfma_f32_16x16x32_bf16 v[140:143], a[124:127], a[88:91], v[140:143]
  s_xor_b32 s36, s36, 1
  s_lshl_b32 s36, s36, 2
  s_add_u32 s36, s36, s3
  v_mfma_f32_16x16x32_bf16 v[156:159], a[124:127], a[92:95], v[156:159]
  s_lshl_b32 s36, s36, 14
  s_add_u32 s37, s36, 4096
  v_permlane16_swap_b32 v185, v187
  s_waitcnt lgkmcnt(0)
  v_mfma_f32_16x16x32_bf16 v[96:99], a[96:99], a[64:67], v[96:99]
  buffer_store_dwordx4 v[128:131], v2, s[16:19], s36 offen offset:0 sc1
  ds_read_b128 a[80:83], v16 offset:8192
  v_mfma_f32_16x16x32_bf16 v[112:115], a[96:99], a[68:71], v[112:115]
  buffer_store_dwordx4 v[132:135], v2, s[16:19], s36 offen offset:1024 sc1
  ds_read_b64_tr_b16 a[112:113], v18 offset:20480
  v_mfma_f32_16x16x32_bf16 v[100:103], a[100:103], a[64:67], v[100:103]
  buffer_store_dwordx4 v[136:139], v2, s[16:19], s36 offen offset:2048 sc1
  ds_read_b64_tr_b16 a[114:115], v18 offset:22528
  v_mfma_f32_16x16x32_bf16 v[116:119], a[100:103], a[68:71], v[116:119]
  buffer_store_dwordx4 v[140:143], v2, s[16:19], s36 offen offset:3072 sc1
  ds_read_b128 a[84:87], v16 offset:9216
  v_mfma_f32_16x16x32_bf16 v[104:107], a[104:107], a[64:67], v[104:107]
  buffer_store_dwordx4 v[144:147], v2, s[16:19], s37 offen offset:0 sc1
  ds_read_b64_tr_b16 a[116:117], v19 offset:20480
  v_mfma_f32_16x16x32_bf16 v[120:123], a[104:107], a[68:71], v[120:123]
  buffer_store_dwordx4 v[148:151], v2, s[16:19], s37 offen offset:1024 sc1
  ds_read_b64_tr_b16 a[118:119], v19 offset:22528
  v_mfma_f32_16x16x32_bf16 v[108:111], a[108:111], a[64:67], v[108:111]
  buffer_store_dwordx4 v[152:155], v2, s[16:19], s37 offen offset:2048 sc1
  ds_read_b64_tr_b16 a[120:121], v20 offset:20480
  v_mfma_f32_16x16x32_bf16 v[124:127], a[108:111], a[68:71], v[124:127]
  buffer_store_dwordx4 v[156:159], v2, s[16:19], s37 offen offset:3072 sc1
  ds_read_b64_tr_b16 a[122:123], v20 offset:22528
  ds_read_b64_tr_b16 a[124:125], v21 offset:20480
  ds_read_b64_tr_b16 a[126:127], v21 offset:22528
  s_add_u32 s64, s64, s66
  s_add_u32 s65, s65, 1
  s_cmp_eq_u32 s65, 4
  s_cselect_b32 s65, 0, s65
  s_cselect_b32 s66, s67, s68
  v_add_u32 v16, s66, v16
  v_add_u32 v17, s66, v17
  v_add_u32 v18, s66, v18
  v_add_u32 v19, s66, v19
  v_add_u32 v20, s66, v20
  v_add_u32 v21, s66, v21
  buffer_store_dwordx4 v[184:187], v27, s[20:23], s33 offen offset:64
  s_waitcnt vmcnt(23) lgkmcnt(0)
  s_barrier
  v_mfma_f32_16x16x32_bf16 v[96:99], a[112:115], a[80:83], v[96:99]
  ds_read_b128 a[64:67], v16 offset:0
  ds_read_b64_tr_b16 a[96:97], v18 offset:16384
  v_mfma_f32_16x16x32_bf16 v[112:115], a[112:115], a[84:87], v[112:115]
  ds_read_b64_tr_b16 a[98:99], v18 offset:18432
  ds_read_b128 a[68:71], v16 offset:1024
  v_mfma_f32_16x16x32_bf16 v[100:103], a[116:119], a[80:83], v[100:103]
  ds_read_b64_tr_b16 a[100:101], v19 offset:16384
  v_mfma_f32_16x16x32_bf16 v[116:119], a[116:119], a[84:87], v[116:119]
  ds_read_b64_tr_b16 a[102:103], v19 offset:18432
  ds_read_b64_tr_b16 a[104:105], v20 offset:16384
  v_mfma_f32_16x16x32_bf16 v[104:107], a[120:123], a[80:83], v[104:107]
  ds_read_b64_tr_b16 a[106:107], v20 offset:18432
  ds_read_b64_tr_b16 a[108:109], v21 offset:16384
  v_mfma_f32_16x16x32_bf16 v[120:123], a[120:123], a[84:87], v[120:123]
  ds_read_b64_tr_b16 a[110:111], v21 offset:18432
  v_mfma_f32_16x16x32_bf16 v[108:111], a[124:127], a[80:83], v[108:111]
  v_mfma_f32_16x16x32_bf16 v[124:127], a[124:127], a[84:87], v[124:127]
  s_waitcnt lgkmcnt(0)
  v_mfma_f32_16x16x32_bf16 v[96:99], a[96:99], a[64:67], v[96:99]
  s_add_u32 s64, s64, s66
  ds_read_b128 a[80:83], v16 offset:8192
  ds_read_b64_tr_b16 a[112:113], v18 offset:20480
  v_mfma_f32_16x16x32_bf16 v[112:115], a[96:99], a[68:71], v[112:115]
  s_add_u32 s65, s65, 1
  ds_read_b64_tr_b16 a[114:115], v18 offset:22528
  ds_read_b128 a[84:87], v16 offset:9216
  v_mfma_f32_16x16x32_bf16 v[100:103], a[100:103], a[64:67], v[100:103]
  s_cmp_eq_u32 s65, 4
  s_cselect_b32 s65, 0, s65
  s_cselect_b32 s66, s67, s68
  ds_read_b64_tr_b16 a[116:117], v19 offset:20480
  v_mfma_f32_16x16x32_bf16 v[116:119], a[100:103], a[68:71], v[116:119]
  ds_read_b64_tr_b16 a[118:119], v19 offset:22528
  ds_read_b64_tr_b16 a[120:121], v20 offset:20480
  v_mfma_f32_16x16x32_bf16 v[104:107], a[104:107], a[64:67], v[104:107]
  ds_read_b64_tr_b16 a[122:123], v20 offset:22528
  ds_read_b64_tr_b16 a[124:125], v21 offset:20480
  v_mfma_f32_16x16x32_bf16 v[120:123], a[104:107], a[68:71], v[120:123]
  ds_read_b64_tr_b16 a[126:127], v21 offset:22528
  v_mfma_f32_16x16x32_bf16 v[108:111], a[108:111], a[64:67], v[108:111]
  v_add_u32 v16, s66, v16
  v_add_u32 v17, s66, v17
  v_add_u32 v20, s66, v20
  v_mfma_f32_16x16x32_bf16 v[124:127], a[108:111], a[68:71], v[124:127]
  v_add_u32 v18, s66, v18
  v_add_u32 v19, s66, v19
  v_add_u32 v21, s66, v21
  s_waitcnt vmcnt(16) lgkmcnt(0)
  s_barrier
  v_mfma_f32_16x16x32_bf16 v[96:99], a[112:115], a[80:83], v[96:99]
  ds_read_b128 a[64:67], v16 offset:0
  ds_read_b64_tr_b16 a[96:97], v18 offset:16384
  v_mfma_f32_16x16x32_bf16 v[112:115], a[112:115], a[84:87], v[112:115]
  ds_read_b64_tr_b16 a[98:99], v18 offset:18432
  ds_read_b128 a[68:71], v16 offset:1024
  v_mfma_f32_16x16x32_bf16 v[100:103], a[116:119], a[80:83], v[100:103]
  ds_read_b64_tr_b16 a[100:101], v19 offset:16384
  v_mfma_f32_16x16x32_bf16 v[116:119], a[116:119], a[84:87], v[116:119]
  ds_read_b64_tr_b16 a[102:103], v19 offset:18432
  ds_read_b64_tr_b16 a[104:105], v20 offset:16384
  v_mfma_f32_16x16x32_bf16 v[104:107], a[120:123], a[80:83], v[104:107]
  ds_read_b64_tr_b16 a[106:107], v20 offset:18432
  ds_read_b64_tr_b16 a[108:109], v21 offset:16384
  v_mfma_f32_16x16x32_bf16 v[120:123], a[120:123], a[84:87], v[120:123]
  ds_read_b64_tr_b16 a[110:111], v21 offset:18432
  v_mfma_f32_16x16x32_bf16 v[108:111], a[124:127], a[80:83], v[108:111]
  v_mfma_f32_16x16x32_bf16 v[124:127], a[124:127], a[84:87], v[124:127]
  s_waitcnt lgkmcnt(0)
  v_mfma_f32_16x16x32_bf16 v[96:99], a[96:99], a[64:67], v[96:99]
  s_add_u32 s64, s64, s66
  ds_read_b128 a[80:83], v16 offset:8192
  ds_read_b64_tr_b16 a[112:113], v18 offset:20480
  v_mfma_f32_16x16x32_bf16 v[112:115], a[96:99], a[68:71], v[112:115]
  s_add_u32 s65, s65, 1
  ds_read_b64_tr_b16 a[114:115], v18 offset:22528
  ds_read_b128 a[84:87], v16 offset:9216
  v_mfma_f32_16x16x32_bf16 v[100:103], a[100:103], a[64:67], v[100:103]
  s_cmp_eq_u32 s65, 4
  s_cselect_b32 s65, 0, s65
  s_cselect_b32 s66, s67, s68
  ds_read_b64_tr_b16 a[116:117], v19 offset:20480
  v_mfma_f32_16x16x32_bf16 v[116:119], a[100:103], a[68:71], v[116:119]
  ds_read_b64_tr_b16 a[118:119], v19 offset:22528
  ds_read_b64_tr_b16 a[120:121], v20 offset:20480
  v_mfma_f32_16x16x32_bf16 v[104:107], a[104:107], a[64:67], v[104:107]
  ds_read_b64_tr_b16 a[122:123], v20 offset:22528
  ds_read_b64_tr_b16 a[124:125], v21 offset:20480
  v_mfma_f32_16x16x32_bf16 v[120:123], a[104:107], a[68:71], v[120:123]
  ds_read_b64_tr_b16 a[126:127], v21 offset:22528
  v_mfma_f32_16x16x32_bf16 v[108:111], a[108:111], a[64:67], v[108:111]
  v_add_u32 v16, s66, v16
  v_add_u32 v17, s66, v17
  v_add_u32 v20, s66, v20
  v_mfma_f32_16x16x32_bf16 v[124:127], a[108:111], a[68:71], v[124:127]
  v_add_u32 v18, s66, v18
  v_add_u32 v19, s66, v19
  v_add_u32 v21, s66, v21
  s_waitcnt vmcnt(9) lgkmcnt(0)
  s_barrier
  v_mfma_f32_16x16x32_bf16 v[96:99], a[112:115], a[80:83], v[96:99]
  s_lshl_b32 s6, s78, 1
  s_add_u32 s6, s6, s77
  s_lshl_b32 s6, s6, 2
  v_mfma_f32_16x16x32_bf16 v[112:115], a[112:115], a[84:87], v[112:115]
  s_add_u32 s6, s6, s3
  s_lshl_b32 s6, s6, 14
  s_add_u32 s7, s6, 4096
  v_mfma_f32_16x16x32_bf16 v[100:103], a[116:119], a[80:83], v[100:103]
  buffer_load_dwordx4 v[192:195], v2, s[16:19], s6 offen offset:0 sc1
  ds_read_b128 a[64:67], v16 offset:0
  v_mfma_f32_16x16x32_bf16 v[116:119], a[116:119], a[84:87], v[116:119]
  buffer_load_dwordx4 v[196:199], v2, s[16:19], s6 offen offset:1024 sc1
  ds_read_b64_tr_b16 a[96:97], v18 offset:16384
  v_mfma_f32_16x16x32_bf16 v[104:107], a[120:123], a[80:83], v[104:107]
  buffer_load_dwordx4 v[200:203], v2, s[16:19], s6 offen offset:2048 sc1
  ds_read_b64_tr_b16 a[98:99], v18 offset:18432
  v_mfma_f32_16x16x32_bf16 v[120:123], a[120:123], a[84:87], v[120:123]
  buffer_load_dwordx4 v[204:207], v2, s[16:19], s6 offen offset:3072 sc1
  ds_read_b128 a[68:71], v16 offset:1024
  v_mfma_f32_16x16x32_bf16 v[108:111], a[124:127], a[80:83], v[108:111]
  ds_read_b64_tr_b16 a[100:101], v19 offset:16384
  ds_read_b64_tr_b16 a[102:103], v19 offset:18432
  v_mfma_f32_16x16x32_bf16 v[124:127], a[124:127], a[84:87], v[124:127]
  ds_read_b64_tr_b16 a[104:105], v20 offset:16384
  ds_read_b64_tr_b16 a[106:107], v20 offset:18432
  ds_read_b64_tr_b16 a[108:109], v21 offset:16384
  ds_read_b64_tr_b16 a[110:111], v21 offset:18432
  s_waitcnt lgkmcnt(0)
  v_mfma_f32_16x16x32_bf16 v[96:99], a[96:99], a[64:67], v[96:99]
  buffer_load_dwordx4 v[208:211], v2, s[16:19], s7 offen offset:0 sc1
  ds_read_b128 a[80:83], v16 offset:8192
  v_mfma_f32_16x16x32_bf16 v[112:115], a[96:99], a[68:71], v[112:115]
  buffer_load_dwordx4 v[212:215], v2, s[16:19], s7 offen offset:1024 sc1
  ds_read_b64_tr_b16 a[112:113], v18 offset:20480
  v_mfma_f32_16x16x32_bf16 v[100:103], a[100:103], a[64:67], v[100:103]
  ds_read_b64_tr_b16 a[114:115], v18 offset:22528
  ds_read_b128 a[84:87], v16 offset:9216
  v_mfma_f32_16x16x32_bf16 v[116:119], a[100:103], a[68:71], v[116:119]
  buffer_load_dwordx4 v[216:219], v2, s[16:19], s7 offen offset:2048 sc1
  ds_read_b64_tr_b16 a[116:117], v19 offset:20480
  v_mfma_f32_16x16x32_bf16 v[104:107], a[104:107], a[64:67], v[104:107]
  ds_read_b64_tr_b16 a[118:119], v19 offset:22528
  ds_read_b64_tr_b16 a[120:121], v20 offset:20480
  v_mfma_f32_16x16x32_bf16 v[120:123], a[104:107], a[68:71], v[120:123]
  buffer_load_dwordx4 v[220:223], v2, s[16:19], s7 offen offset:3072 sc1
  ds_read_b64_tr_b16 a[122:123], v20 offset:22528
  v_mfma_f32_16x16x32_bf16 v[108:111], a[108:111], a[64:67], v[108:111]
  ds_read_b64_tr_b16 a[124:125], v21 offset:20480
  ds_read_b64_tr_b16 a[126:127], v21 offset:22528
  v_mfma_f32_16x16x32_bf16 v[124:127], a[108:111], a[68:71], v[124:127]
  s_waitcnt lgkmcnt(0)
  v_mfma_f32_16x16x32_bf16 v[96:99], a[112:115], a[80:83], v[96:99]
  v_mfma_f32_16x16x32_bf16 v[112:115], a[112:115], a[84:87], v[112:115]
  v_mfma_f32_16x16x32_bf16 v[100:103], a[116:119], a[80:83], v[100:103]
  v_mfma_f32_16x16x32_bf16 v[116:119], a[116:119], a[84:87], v[116:119]
  v_mfma_f32_16x16x32_bf16 v[104:107], a[120:123], a[80:83], v[104:107]
  v_mfma_f32_16x16x32_bf16 v[120:123], a[120:123], a[84:87], v[120:123]
  v_mfma_f32_16x16x32_bf16 v[108:111], a[124:127], a[80:83], v[108:111]
  v_mfma_f32_16x16x32_bf16 v[124:127], a[124:127], a[84:87], v[124:127]
  s_waitcnt vmcnt(0)
  s_mov_b32 s72, 0x40000
Lrc_13:
  v_max3_u32 v4, v192, v193, v194
  v_max3_u32 v5, v200, v201, v202
  v_max3_u32 v6, v208, v209, v210
  v_max3_u32 v7, v216, v217, v218
  v_max3_u32 v4, v4, v195, v196
  v_max3_u32 v5, v5, v203, v204
  v_max3_u32 v6, v6, v211, v212
  v_max3_u32 v7, v7, v219, v220
  v_max3_u32 v4, v4, v197, v198
  v_max3_u32 v5, v5, v205, v206
  v_max3_u32 v6, v6, v213, v214
  v_max3_u32 v7, v7, v221, v222
  v_max_u32 v4, v4, v199
  v_max_u32 v5, v5, v207
  v_max_u32 v6, v6, v215
  v_max_u32 v7, v7, v223
  v_max3_u32 v4, v4, v5, v6
  v_max_u32 v4, v4, v7
  v_cmp_eq_u32 vcc, -1, v4
  s_nop 0
  s_cbranch_vccz Lpolld_14
  buffer_load_dwordx4 v[192:195], v2, s[16:19], s6 offen offset:0 sc1
  buffer_load_dwordx4 v[196:199], v2, s[16:19], s6 offen offset:1024 sc1
  buffer_load_dwordx4 v[200:203], v2, s[16:19], s6 offen offset:2048 sc1
  buffer_load_dwordx4 v[204:207], v2, s[16:19], s6 offen offset:3072 sc1
  buffer_load_dwordx4 v[208:211], v2, s[16:19], s7 offen offset:0 sc1
  buffer_load_dwordx4 v[212:215], v2, s[16:19], s7 offen offset:1024 sc1
  buffer_load_dwordx4 v[216:219], v2, s[16:19], s7 offen offset:2048 sc1
  buffer_load_dwordx4 v[220:223], v2, s[16:19], s7 offen offset:3072 sc1
  s_sub_u32 s72, s72, 1
  s_waitcnt vmcnt(0)
  s_cbranch_scc0 Lrc_13
Lpolld_14:
  v_pk_add_f32 v[192:193], v[192:193], v[96:97]
  v_pk_add_f32 v[200:201], v[200:201], v[104:105]
  v_pk_add_f32 v[208:209], v[208:209], v[112:113]
  v_pk_add_f32 v[216:217], v[216:217], v[120:121]
  v_pk_add_f32 v[194:195], v[194:195], v[98:99]
  v_pk_add_f32 v[202:203], v[202:203], v[106:107]
  v_pk_add_f32 v[210:211], v[210:211], v[114:115]
  v_pk_add_f32 v[218:219], v[218:219], v[122:123]
  v_pk_add_f32 v[196:197], v[196:197], v[100:101]
  v_pk_add_f32 v[204:205], v[204:205], v[108:109]
  v_pk_add_f32 v[212:213], v[212:213], v[116:117]
  v_pk_add_f32 v[220:221], v[220:221], v[124:125]
  v_pk_add_f32 v[198:199], v[198:199], v[102:103]
  v_pk_add_f32 v[206:207], v[206:207], v[110:111]
  v_pk_add_f32 v[214:215], v[214:215], v[118:119]
  v_pk_add_f32 v[222:223], v[222:223], v[126:127]
  v_cvt_pk_bf16_f32 v192, v192, v193
  v_cvt_pk_bf16_f32 v200, v200, v201
  v_cvt_pk_bf16_f32 v208, v208, v209
  v_cvt_pk_bf16_f32 v216, v216, v217
  v_cvt_pk_bf16_f32 v193, v194, v195
  v_cvt_pk_bf16_f32 v201, v202, v203
  v_cvt_pk_bf16_f32 v209, v210, v211
  v_cvt_pk_bf16_f32 v217, v218, v219
  v_cvt_pk_bf16_f32 v194, v196, v197
  v_cvt_pk_bf16_f32 v202, v204, v205
  v_cvt_pk_bf16_f32 v210, v212, v213
  v_cvt_pk_bf16_f32 v218, v220, v221
  v_cvt_pk_bf16_f32 v195, v198, v199
  v_cvt_pk_bf16_f32 v203, v206, v207
  v_cvt_pk_bf16_f32 v211, v214, v215
  v_cvt_pk_bf16_f32 v219, v222, v223
  v_permlane16_swap_b32 v192, v194
  v_permlane16_swap_b32 v200, v202
  v_permlane16_swap_b32 v208, v210
  v_permlane16_swap_b32 v216, v218
  v_permlane16_swap_b32 v193, v195
  v_permlane16_swap_b32 v201, v203
  v_permlane16_swap_b32 v209, v211
  v_permlane16_swap_b32 v217, v219
  buffer_store_dwordx4 v[192:195], v26, s[20:23], s34 offen offset:0
  buffer_store_dwordx4 v[200:203], v26, s[20:23], s34 offen offset:64
  buffer_store_dwordx4 v[208:211], v26, s[20:23], s35 offen offset:0
  buffer_store_dwordx4 v[216:219], v26, s[20:23], s35 offen offset:64
Lend:
  s_endpgm
.section .rodata,"a"
.p2align 6
.amdhsa_kernel concat_heads__compressed_kv_cla__sliding_local_dilated__prompt_kernel
  .amdhsa_next_free_vgpr 512
  .amdhsa_next_free_sgpr 102
  .amdhsa_accum_offset 256
  .amdhsa_group_segment_fixed_size 0
  .amdhsa_kernarg_size 96
  .amdhsa_user_sgpr_count 2
  .amdhsa_user_sgpr_kernarg_segment_ptr 1
  .amdhsa_system_sgpr_workgroup_id_x 1
.end_amdhsa_kernel
```

```asm
; @launch grid=(256,1,1) block=(256,1,1) lds=163840
.amdgcn_target "amdgcn-amd-amdhsa--gfx950"
.text
.globl concat_heads__compressed_kv_cla__sliding_local_dilated__prompt_kernel
.p2align 8
.type concat_heads__compressed_kv_cla__sliding_local_dilated__prompt_kernel,@function
concat_heads__compressed_kv_cla__sliding_local_dilated__prompt_kernel:
  s_cmp_ge_u32 s2, 256
  s_cbranch_scc1 Lend
  s_load_dwordx16 s[64:79], s[0:1], 0
  s_load_dwordx8 s[80:87], s[0:1], 64
  v_lshrrev_b32 v2, 6, v0
  v_and_b32 v1, 63, v0
  v_readfirstlane_b32 s3, v2
  v_lshlrev_b32 v2, 4, v1
  s_bfe_u32 s59, s2, 0x30003
  s_lshr_b32 s4, s2, 7
  s_lshl_b32 s4, s4, 3
  s_add_u32 s59, s59, s4
  s_lshr_b32 s4, s2, 3
  s_xor_b32 s4, s4, s2
  s_bitcmp1_b32 s4, 3
  s_cbranch_scc1 Lp2
  s_and_b32 s4, s2, 1
  s_lshl_b32 s4, s4, 2
  s_and_b32 s5, s59, 3
  s_add_u32 s61, s4, s5
  s_bfe_u32 s4, s2, 0x20001
  s_lshl_b32 s4, s4, 2
  s_lshr_b32 s5, s59, 2
  s_add_u32 s62, s4, s5
  s_lshl_b32 s4, s3, 13
  s_add_u32 s36, s4, 65536
  s_add_u32 s41, s4, 98304
  v_lshrrev_b32 v32, 3, v1
  v_and_b32 v33, 6, v32
  v_and_b32 v34, 7, v1
  v_xor_b32 v33, v33, v34
  v_lshlrev_b32 v33, 4, v33
  s_lshl_b32 s4, s61, 2
  s_add_u32 s4, s4, s3
  s_lshl_b32 s4, s4, 6
  v_add_u32 v34, s4, v32
  v_lshl_add_u32 v34, v34, 10, v33
  v_add_u32 v48, 0, v34
  v_add_u32 v49, 7168, v34
  v_add_u32 v50, 14336, v34
  v_add_u32 v51, 21504, v34
  v_add_u32 v52, 32768, v34
  v_add_u32 v53, 39936, v34
  v_add_u32 v54, 47104, v34
  v_add_u32 v55, 54272, v34
  v_lshrrev_b32 v34, 2, v32
  v_and_b32 v35, 3, v32
  v_lshl_add_u32 v34, v34, 3, v35
  s_lshl_b32 s4, s62, 2
  s_add_u32 s4, s4, s3
  s_lshl_b32 s4, s4, 7
  v_lshl_add_u32 v34, v34, 13, v33
  v_add_u32 v34, s4, v34
  v_add_u32 v56, 0, v34
  v_add_u32 v57, 130048, v34
  v_add_u32 v58, 30720, v34
  v_add_u32 v59, 160768, v34
  v_add_u32 v60, 262144, v34
  v_add_u32 v61, 392192, v34
  v_add_u32 v62, 292864, v34
  v_add_u32 v63, 422912, v34
  s_and_b32 s6, s2, 7
  s_add_u32 s4, s61, s62
  s_and_b32 s49, s4, 3
  s_lshl_b32 s49, s49, 3
  s_or_b32 s49, s49, 0x80000
  s_bfe_u32 s48, 0x70702, s49
  s_add_u32 s48, s48, s6
  s_and_b32 s48, s48, 7
  s_lshl_b32 s46, s48, 7
  s_waitcnt lgkmcnt(0)
  s_mov_b32 s8, s66
  s_mov_b32 s9, s67
  s_mov_b32 s10, 2097152
  s_mov_b32 s11, 0x00020000
  s_mov_b32 s12, s70
  s_mov_b32 s13, s71
  s_mov_b32 s14, 4194304
  s_mov_b32 s15, 0x00020000
  s_mov_b32 s50, 9
  s_add_u32 s96, s86, 125829120
  s_addc_u32 s97, s87, 0
  s_mov_b32 s98, 262144
  s_mov_b32 s99, 0x00020000
  s_or_b32 s4, s2, s3
  s_cbranch_scc1 Ltag_1
  s_mov_b32 s4, 196608
  buffer_load_dwordx2 v[22:23], off, s[96:99], s4 sc1
Ltag_1:
  s_mov_b32 m0, s36
  s_nop 0
  buffer_load_dwordx4 v48, s[8:11], s46 offen offset:0 lds
  buffer_load_dwordx4 v49, s[8:11], s46 offen offset:1024 lds
  buffer_load_dwordx4 v50, s[8:11], s46 offen offset:2048 lds
  buffer_load_dwordx4 v51, s[8:11], s46 offen offset:3072 lds
  s_add_u32 m0, s36, 4096
  s_nop 0
  buffer_load_dwordx4 v52, s[8:11], s46 offen offset:0 lds
  buffer_load_dwordx4 v53, s[8:11], s46 offen offset:1024 lds
  buffer_load_dwordx4 v54, s[8:11], s46 offen offset:2048 lds
  buffer_load_dwordx4 v55, s[8:11], s46 offen offset:3072 lds
  s_sub_u32 s50, s50, 1
  s_cmp_eq_u32 s50, 0
  s_cselect_b32 s12, s72, s12
  s_cselect_b32 s13, s73, s13
  s_lshl_b32 s47, s48, 19
  s_bfe_u32 s34, 0x3020106, s49
  s_add_u32 s48, s48, s34
  s_add_u32 s49, s49, 8
  s_and_b32 s49, s49, 0x8001f
  s_and_b32 s48, s48, 7
  s_lshl_b32 s46, s48, 7
  s_mov_b32 m0, s41
  s_nop 0
  buffer_load_dwordx4 v56, s[12:15], s47 offen offset:0 lds
  buffer_load_dwordx4 v57, s[12:15], s47 offen offset:1024 lds
  buffer_load_dwordx4 v58, s[12:15], s47 offen offset:2048 lds
  buffer_load_dwordx4 v59, s[12:15], s47 offen offset:3072 lds
  s_add_u32 m0, s41, 4096
  s_nop 0
  buffer_load_dwordx4 v60, s[12:15], s47 offen offset:0 lds
  buffer_load_dwordx4 v61, s[12:15], s47 offen offset:1024 lds
  buffer_load_dwordx4 v62, s[12:15], s47 offen offset:2048 lds
  buffer_load_dwordx4 v63, s[12:15], s47 offen offset:3072 lds
  s_lshr_b32 s4, s3, 1
  s_lshl_b32 s4, s4, 14
  s_add_u32 s4, s4, 65536
  v_and_b32 v32, 15, v1
  v_lshlrev_b32 v32, 7, v32
  v_lshrrev_b32 v33, 4, v1
  v_and_b32 v34, 6, v1
  v_xor_b32 v33, v33, v34
  v_lshl_add_u32 v32, v33, 4, v32
  v_add_u32 v16, s4, v32
  v_xor_b32 v17, 64, v16
  s_and_b32 s4, s3, 1
  s_lshl_b32 s4, s4, 14
  s_add_u32 s4, s4, 98304
  v_lshrrev_b32 v32, 2, v1
  v_and_b32 v33, 6, v32
  v_lshlrev_b32 v32, 7, v32
  v_and_b32 v34, 1, v1
  v_lshl_add_u32 v32, v34, 3, v32
  v_add_u32 v32, s4, v32
  v_bfe_u32 v34, v1, 1, 1
  v_xor_b32 v33, v33, v34
  v_xor_b32 v34, 0, v33
  v_lshl_add_u32 v18, v34, 4, v32
  v_xor_b32 v34, 2, v33
  v_lshl_add_u32 v19, v34, 4, v32
  v_xor_b32 v34, 4, v33
  v_lshl_add_u32 v20, v34, 4, v32
  v_xor_b32 v34, 6, v33
  v_lshl_add_u32 v21, v34, 4, v32
  s_and_b32 s24, s2, 7
  s_lshr_b32 s4, s2, 6
  s_lshl_b32 s4, s4, 3
  s_add_u32 s24, s24, s4
  s_lshr_b32 s4, s2, 3
  s_and_b32 s25, s4, 6
  s_xor_b32 s4, s4, s2
  s_bfe_u32 s4, s4, 0x10003
  s_add_u32 s25, s25, s4
  v_accvgpr_write_b32 a244, -1
  v_accvgpr_write_b32 a245, -1
  v_accvgpr_write_b32 a246, -1
  v_accvgpr_write_b32 a247, -1
  v_lshrrev_b32 v24, 3, v1
  v_and_b32 v25, 6, v24
  v_and_b32 v26, 7, v1
  v_xor_b32 v25, v25, v26
  v_lshlrev_b32 v25, 4, v25
  s_and_b32 s4, s3, 1
  s_lshl_b32 s4, s4, 16
  s_lshr_b32 s5, s3, 1
  s_lshl_b32 s5, s5, 7
  s_add_u32 s4, s4, s5
  v_lshl_add_u32 v24, v24, 11, v25
  v_add_u32 v24, s4, v24
  v_add_u32 v25, 0, v24
  v_accvgpr_write_b32 a212, v25
  v_add_u32 v25, 15360, v24
  v_accvgpr_write_b32 a213, v25
  v_add_u32 v25, 30720, v24
  v_accvgpr_write_b32 a214, v25
  v_add_u32 v25, 46080, v24
  v_accvgpr_write_b32 a215, v25
  v_accvgpr_write_b32 a236, 0
  v_mov_b32 v27, 0x3f803f80
  v_accvgpr_write_b32 a208, v27
  v_accvgpr_write_b32 a237, 0
  v_accvgpr_write_b32 a209, v27
  v_accvgpr_write_b32 a238, 0
  v_accvgpr_write_b32 a210, v27
  v_accvgpr_write_b32 a239, 0
  v_accvgpr_write_b32 a211, v27
  v_lshrrev_b32 v24, 3, v1
  v_and_b32 v25, 6, v24
  v_and_b32 v26, 7, v1
  v_xor_b32 v25, v25, v26
  v_lshlrev_b32 v25, 4, v25
  v_lshlrev_b32 v26, 2, v24
  v_add_u32 v26, s3, v26
  v_lshl_add_u32 v26, v26, 11, v25
  v_add_u32 v27, 0, v26
  v_accvgpr_write_b32 a222, v27
  v_add_u32 v27, 64512, v26
  v_accvgpr_write_b32 a223, v27
  v_add_u32 v27, 129024, v26
  v_accvgpr_write_b32 a224, v27
  v_add_u32 v27, 193536, v26
  v_accvgpr_write_b32 a225, v27
  v_lshrrev_b32 v26, 2, v24
  v_and_b32 v27, 3, v24
  v_lshl_add_u32 v26, v26, 3, v27
  s_and_b32 s4, s3, 1
  s_lshl_b32 s4, s4, 18
  s_lshr_b32 s5, s3, 1
  s_lshl_b32 s5, s5, 7
  s_add_u32 s4, s4, s5
  s_lshl_b32 s5, s24, 8
  s_add_u32 s4, s4, s5
  v_lshl_add_u32 v26, v26, 13, v25
  v_add_u32 v26, s4, v26
  v_add_u32 v27, 0, v26
  v_accvgpr_write_b32 a226, v27
  v_add_u32 v27, 130048, v26
  v_accvgpr_write_b32 a227, v27
  v_add_u32 v27, 30720, v26
  v_accvgpr_write_b32 a228, v27
  v_add_u32 v27, 160768, v26
  v_accvgpr_write_b32 a229, v27
  s_lshl_b32 s4, s3, 13
  s_add_u32 s4, s4, 98304
  v_and_b32 v24, 15, v1
  v_lshlrev_b32 v24, 7, v24
  v_lshrrev_b32 v25, 4, v1
  v_and_b32 v26, 6, v1
  v_xor_b32 v25, v25, v26
  v_lshl_add_u32 v24, v25, 4, v24
  v_add_u32 v28, s4, v24
  v_xor_b32 v29, 64, v28
  v_lshrrev_b32 v24, 2, v1
  v_and_b32 v25, 6, v24
  v_lshlrev_b32 v24, 7, v24
  v_and_b32 v26, 1, v1
  v_lshl_add_u32 v24, v26, 3, v24
  v_add_u32 v24, 0, v24
  v_bfe_u32 v26, v1, 1, 1
  v_xor_b32 v25, v25, v26
  v_xor_b32 v26, 0, v25
  v_lshl_add_u32 v30, v26, 4, v24
  v_xor_b32 v26, 2, v25
  v_lshl_add_u32 v31, v26, 4, v24
  v_xor_b32 v26, 4, v25
  v_lshl_add_u32 v32, v26, 4, v24
  v_xor_b32 v26, 6, v25
  v_lshl_add_u32 v33, v26, 4, v24
  v_accvgpr_write_b32 a230, v28
  v_accvgpr_write_b32 a231, v29
  v_accvgpr_write_b32 a232, v30
  v_accvgpr_write_b32 a233, v31
  v_accvgpr_write_b32 a234, v32
  v_accvgpr_write_b32 a235, v33
  s_and_b32 s4, s3, 1
  s_lshl_b32 s5, s62, 1
  s_add_u32 s4, s4, s5
  s_lshr_b32 s5, s3, 1
  s_lshl_b32 s6, s61, 1
  s_add_u32 s5, s5, s6
  s_add_u32 s16, s86, 16777216
  s_addc_u32 s17, s87, 0
  s_mov_b32 s18, 33554432
  s_mov_b32 s19, 0x00020000
  s_lshl_b32 s4, s4, 20
  s_lshl_b32 s5, s5, 16
  s_add_u32 s63, s4, s5
  s_mov_b32 s37, 0
  s_mov_b32 s39, 4294901760
  s_mov_b32 s40, 32768
  s_mov_b32 s37, 2
  s_mov_b32 s42, 0
  s_mov_b32 s44, 4294934528
  s_mov_b32 s45, 32768
  s_mov_b32 s43, s44
  s_or_b32 s4, s2, s3
  s_cbranch_scc1 Ltag_2
  s_mov_b32 s4, 196608
  s_mov_b32 s92, s84
  s_mov_b32 s93, s85
  s_mov_b32 s94, 256
  s_mov_b32 s95, 0x00020000
  s_waitcnt vmcnt(16)
  v_add_u32 v22, 1, v22
  v_or_b32 v23, 0x80000000, v23
  buffer_store_dwordx2 v[22:23], off, s[96:99], s4 sc1
  buffer_store_dwordx2 v[22:23], off, s[92:95], 0 sc1
Ltag_2:
  s_waitcnt vmcnt(0)
  s_barrier
  ds_read_b128 a[0:3], v16 offset:0
  ds_read_b64_tr_b16 a[64:65], v18 offset:0
  ds_read_b64_tr_b16 a[66:67], v18 offset:2048
  ds_read_b128 a[4:7], v16 offset:2048
  ds_read_b128 a[8:11], v16 offset:4096
  ds_read_b128 a[12:15], v16 offset:6144
  ds_read_b128 a[16:19], v16 offset:8192
  ds_read_b128 a[20:23], v16 offset:10240
  ds_read_b128 a[24:27], v16 offset:12288
  ds_read_b128 a[28:31], v16 offset:14336
  ds_read_b64_tr_b16 a[68:69], v19 offset:0
  ds_read_b64_tr_b16 a[70:71], v19 offset:2048
  ds_read_b64_tr_b16 a[72:73], v20 offset:0
  ds_read_b64_tr_b16 a[74:75], v20 offset:2048
  ds_read_b64_tr_b16 a[76:77], v21 offset:0
  ds_read_b64_tr_b16 a[78:79], v21 offset:2048
  ds_read_b64_tr_b16 a[80:81], v18 offset:8192
  ds_read_b64_tr_b16 a[82:83], v18 offset:10240
  ds_read_b64_tr_b16 a[84:85], v19 offset:8192
  ds_read_b64_tr_b16 a[86:87], v19 offset:10240
  ds_read_b64_tr_b16 a[88:89], v20 offset:8192
  ds_read_b64_tr_b16 a[90:91], v20 offset:10240
  ds_read_b64_tr_b16 a[92:93], v21 offset:8192
  ds_read_b64_tr_b16 a[94:95], v21 offset:10240
  s_waitcnt lgkmcnt(0)
  v_mfma_f32_16x16x32_bf16 v[64:67], a[64:67], a[0:3], 0
  s_add_u32 m0, s36, -65536
  ds_read_b128 a[32:35], v17 offset:0
  v_mfma_f32_16x16x32_bf16 v[96:99], a[64:67], a[4:7], 0
  buffer_load_dwordx4 v48, s[8:11], s46 offen offset:0 lds
  v_mfma_f32_16x16x32_bf16 v[128:131], a[64:67], a[8:11], 0
  buffer_load_dwordx4 v49, s[8:11], s46 offen offset:1024 lds
  v_mfma_f32_16x16x32_bf16 v[160:163], a[64:67], a[12:15], 0
  ds_read_b64_tr_b16 a[96:97], v18 offset:4096
  v_mfma_f32_16x16x32_bf16 v[192:195], a[64:67], a[16:19], 0
  buffer_load_dwordx4 v50, s[8:11], s46 offen offset:2048 lds
  v_mfma_f32_16x16x32_bf16 v[224:227], a[64:67], a[20:23], 0
  ds_read_b64_tr_b16 a[98:99], v18 offset:6144
  v_mfma_f32_16x16x32_bf16 a[128:131], a[64:67], a[24:27], 0
  ds_read_b128 a[36:39], v17 offset:2048
  v_mfma_f32_16x16x32_bf16 a[160:163], a[64:67], a[28:31], 0
  buffer_load_dwordx4 v51, s[8:11], s46 offen offset:3072 lds
  v_mfma_f32_16x16x32_bf16 v[68:71], a[68:71], a[0:3], 0
  s_add_u32 m0, s36, -61440
  v_mfma_f32_16x16x32_bf16 v[100:103], a[68:71], a[4:7], 0
  buffer_load_dwordx4 v52, s[8:11], s46 offen offset:0 lds
  v_mfma_f32_16x16x32_bf16 v[132:135], a[68:71], a[8:11], 0
  ds_read_b128 a[40:43], v17 offset:4096
  v_mfma_f32_16x16x32_bf16 v[164:167], a[68:71], a[12:15], 0
  buffer_load_dwordx4 v53, s[8:11], s46 offen offset:1024 lds
  v_mfma_f32_16x16x32_bf16 v[196:199], a[68:71], a[16:19], 0
  ds_read_b128 a[44:47], v17 offset:6144
  v_mfma_f32_16x16x32_bf16 v[228:231], a[68:71], a[20:23], 0
  ds_read_b128 a[48:51], v17 offset:8192
  v_mfma_f32_16x16x32_bf16 a[132:135], a[68:71], a[24:27], 0
  buffer_load_dwordx4 v54, s[8:11], s46 offen offset:2048 lds
  v_mfma_f32_16x16x32_bf16 a[164:167], a[68:71], a[28:31], 0
  ds_read_b128 a[52:55], v17 offset:10240
  v_mfma_f32_16x16x32_bf16 v[72:75], a[72:75], a[0:3], 0
  buffer_load_dwordx4 v55, s[8:11], s46 offen offset:3072 lds
  v_mfma_f32_16x16x32_bf16 v[104:107], a[72:75], a[4:7], 0
  s_sub_u32 s50, s50, 1
  s_cmp_eq_u32 s50, 0
  s_cselect_b32 s12, s72, s12
  s_cselect_b32 s13, s73, s13
  v_mfma_f32_16x16x32_bf16 v[136:139], a[72:75], a[8:11], 0
  s_lshl_b32 s47, s48, 19
  s_bfe_u32 s34, 0x3020106, s49
  s_add_u32 s48, s48, s34
  v_mfma_f32_16x16x32_bf16 v[168:171], a[72:75], a[12:15], 0
  s_add_u32 s49, s49, 8
  s_and_b32 s49, s49, 0x8001f
  s_and_b32 s48, s48, 7
  v_mfma_f32_16x16x32_bf16 v[200:203], a[72:75], a[16:19], 0
  s_lshl_b32 s46, s48, 7
  s_add_u32 m0, s41, 32768
  ds_read_b128 a[56:59], v17 offset:12288
  v_mfma_f32_16x16x32_bf16 v[232:235], a[72:75], a[20:23], 0
  buffer_load_dwordx4 v56, s[12:15], s47 offen offset:0 lds
  v_mfma_f32_16x16x32_bf16 a[136:139], a[72:75], a[24:27], 0
  buffer_load_dwordx4 v57, s[12:15], s47 offen offset:1024 lds
  v_mfma_f32_16x16x32_bf16 a[168:171], a[72:75], a[28:31], 0
  buffer_load_dwordx4 v58, s[12:15], s47 offen offset:2048 lds
  v_mfma_f32_16x16x32_bf16 v[76:79], a[76:79], a[0:3], 0
  ds_read_b128 a[60:63], v17 offset:14336
  ds_read_b64_tr_b16 a[100:101], v19 offset:4096
  v_mfma_f32_16x16x32_bf16 v[108:111], a[76:79], a[4:7], 0
  ds_read_b64_tr_b16 a[102:103], v19 offset:6144
  v_mfma_f32_16x16x32_bf16 v[140:143], a[76:79], a[8:11], 0
  buffer_load_dwordx4 v59, s[12:15], s47 offen offset:3072 lds
  v_mfma_f32_16x16x32_bf16 v[172:175], a[76:79], a[12:15], 0
  s_add_u32 m0, s41, 36864
  ds_read_b64_tr_b16 a[104:105], v20 offset:4096
  v_mfma_f32_16x16x32_bf16 v[204:207], a[76:79], a[16:19], 0
  buffer_load_dwordx4 v60, s[12:15], s47 offen offset:0 lds
  v_mfma_f32_16x16x32_bf16 v[236:239], a[76:79], a[20:23], 0
  ds_read_b64_tr_b16 a[106:107], v20 offset:6144
  v_mfma_f32_16x16x32_bf16 a[140:143], a[76:79], a[24:27], 0
  buffer_load_dwordx4 v61, s[12:15], s47 offen offset:1024 lds
  v_mfma_f32_16x16x32_bf16 a[172:175], a[76:79], a[28:31], 0
  ds_read_b64_tr_b16 a[108:109], v21 offset:4096
  v_mfma_f32_16x16x32_bf16 v[80:83], a[80:83], a[0:3], 0
  v_mfma_f32_16x16x32_bf16 v[112:115], a[80:83], a[4:7], 0
  buffer_load_dwordx4 v62, s[12:15], s47 offen offset:2048 lds
  v_mfma_f32_16x16x32_bf16 v[144:147], a[80:83], a[8:11], 0
  ds_read_b64_tr_b16 a[110:111], v21 offset:6144
  v_mfma_f32_16x16x32_bf16 v[176:179], a[80:83], a[12:15], 0
  buffer_load_dwordx4 v63, s[12:15], s47 offen offset:3072 lds
  v_mfma_f32_16x16x32_bf16 v[208:211], a[80:83], a[16:19], 0
  s_add_u32 m0, s36, -32768
  ds_read_b64_tr_b16 a[112:113], v18 offset:12288
  v_mfma_f32_16x16x32_bf16 v[240:243], a[80:83], a[20:23], 0
  v_mfma_f32_16x16x32_bf16 a[144:147], a[80:83], a[24:27], 0
  buffer_load_dwordx4 v48, s[8:11], s46 offen offset:0 lds
  v_mfma_f32_16x16x32_bf16 a[176:179], a[80:83], a[28:31], 0
  ds_read_b64_tr_b16 a[114:115], v18 offset:14336
  v_mfma_f32_16x16x32_bf16 v[84:87], a[84:87], a[0:3], 0
  buffer_load_dwordx4 v49, s[8:11], s46 offen offset:1024 lds
  v_mfma_f32_16x16x32_bf16 v[116:119], a[84:87], a[4:7], 0
  ds_read_b64_tr_b16 a[116:117], v19 offset:12288
  v_mfma_f32_16x16x32_bf16 v[148:151], a[84:87], a[8:11], 0
  buffer_load_dwordx4 v50, s[8:11], s46 offen offset:2048 lds
  v_mfma_f32_16x16x32_bf16 v[180:183], a[84:87], a[12:15], 0
  ds_read_b64_tr_b16 a[118:119], v19 offset:14336
  v_mfma_f32_16x16x32_bf16 v[212:215], a[84:87], a[16:19], 0
  v_mfma_f32_16x16x32_bf16 v[244:247], a[84:87], a[20:23], 0
  buffer_load_dwordx4 v51, s[8:11], s46 offen offset:3072 lds
  v_mfma_f32_16x16x32_bf16 a[148:151], a[84:87], a[24:27], 0
  s_add_u32 m0, s36, -28672
  ds_read_b64_tr_b16 a[120:121], v20 offset:12288
  v_mfma_f32_16x16x32_bf16 a[180:183], a[84:87], a[28:31], 0
  buffer_load_dwordx4 v52, s[8:11], s46 offen offset:0 lds
  v_mfma_f32_16x16x32_bf16 v[88:91], a[88:91], a[0:3], 0
  s_add_u32 s37, s37, 1
  ds_read_b64_tr_b16 a[122:123], v20 offset:14336
  v_mfma_f32_16x16x32_bf16 v[120:123], a[88:91], a[4:7], 0
  buffer_load_dwordx4 v53, s[8:11], s46 offen offset:1024 lds
  v_mfma_f32_16x16x32_bf16 v[152:155], a[88:91], a[8:11], 0
  ds_read_b64_tr_b16 a[124:125], v21 offset:12288
  v_mfma_f32_16x16x32_bf16 v[184:187], a[88:91], a[12:15], 0
  ds_read_b64_tr_b16 a[126:127], v21 offset:14336
  v_mfma_f32_16x16x32_bf16 v[216:219], a[88:91], a[16:19], 0
  buffer_load_dwordx4 v54, s[8:11], s46 offen offset:2048 lds
  v_mfma_f32_16x16x32_bf16 v[248:251], a[88:91], a[20:23], 0
  s_cmp_eq_u32 s37, 3
  s_cselect_b32 s37, 0, s37
  s_cselect_b32 s38, s39, s40
  v_mfma_f32_16x16x32_bf16 a[152:155], a[88:91], a[24:27], 0
  buffer_load_dwordx4 v55, s[8:11], s46 offen offset:3072 lds
  v_mfma_f32_16x16x32_bf16 a[184:187], a[88:91], a[28:31], 0
  s_sub_u32 s43, 0, s43
  v_mfma_f32_16x16x32_bf16 v[92:95], a[92:95], a[0:3], 0
  s_sub_u32 s50, s50, 1
  v_add_u32 v16, s38, v16
  v_add_u32 v17, s38, v17
  v_mfma_f32_16x16x32_bf16 v[124:127], a[92:95], a[4:7], 0
  s_cmp_eq_u32 s50, 0
  s_cselect_b32 s12, s72, s12
  s_cselect_b32 s13, s73, s13
  v_mfma_f32_16x16x32_bf16 v[156:159], a[92:95], a[8:11], 0
  s_lshl_b32 s47, s48, 19
  v_add_u32 v18, s43, v18
  v_add_u32 v19, s43, v19
  v_mfma_f32_16x16x32_bf16 v[188:191], a[92:95], a[12:15], 0
  s_bfe_u32 s34, 0x3020106, s49
  s_add_u32 s48, s48, s34
  s_add_u32 s49, s49, 8
  v_mfma_f32_16x16x32_bf16 v[220:223], a[92:95], a[16:19], 0
  s_and_b32 s49, s49, 0x8001f
  s_and_b32 s48, s48, 7
  s_lshl_b32 s46, s48, 7
  v_mfma_f32_16x16x32_bf16 v[252:255], a[92:95], a[20:23], 0
  v_add_u32 v20, s43, v20
  v_add_u32 v21, s43, v21
  v_mfma_f32_16x16x32_bf16 a[156:159], a[92:95], a[24:27], 0
  v_mfma_f32_16x16x32_bf16 a[188:191], a[92:95], a[28:31], 0
  s_mov_b32 s35, 6
  s_waitcnt vmcnt(8) lgkmcnt(0)
  s_barrier
  .p2align 6
Lp1wx_loop:
  v_mfma_f32_16x16x32_bf16 v[64:67], a[96:99], a[32:35], v[64:67]
  s_mov_b32 m0, s41
  ds_read_b128 a[0:3], v16 offset:0
  v_mfma_f32_16x16x32_bf16 v[96:99], a[96:99], a[36:39], v[96:99]
  buffer_load_dwordx4 v56, s[12:15], s47 offen offset:0 lds
  v_mfma_f32_16x16x32_bf16 v[128:131], a[96:99], a[40:43], v[128:131]
  ds_read_b64_tr_b16 a[64:65], v18 offset:0
  v_mfma_f32_16x16x32_bf16 v[160:163], a[96:99], a[44:47], v[160:163]
  v_mfma_f32_16x16x32_bf16 v[192:195], a[96:99], a[48:51], v[192:195]
  ds_read_b64_tr_b16 a[66:67], v18 offset:2048
  v_mfma_f32_16x16x32_bf16 v[224:227], a[96:99], a[52:55], v[224:227]
  v_mfma_f32_16x16x32_bf16 a[128:131], a[96:99], a[56:59], a[128:131]
  ds_read_b128 a[4:7], v16 offset:2048
  v_mfma_f32_16x16x32_bf16 a[160:163], a[96:99], a[60:63], a[160:163]
  buffer_load_dwordx4 v57, s[12:15], s47 offen offset:1024 lds
  v_mfma_f32_16x16x32_bf16 v[68:71], a[100:103], a[32:35], v[68:71]
  v_mfma_f32_16x16x32_bf16 v[100:103], a[100:103], a[36:39], v[100:103]
  ds_read_b128 a[8:11], v16 offset:4096
  v_mfma_f32_16x16x32_bf16 v[132:135], a[100:103], a[40:43], v[132:135]
  v_mfma_f32_16x16x32_bf16 v[164:167], a[100:103], a[44:47], v[164:167]
  ds_read_b128 a[12:15], v16 offset:6144
  v_mfma_f32_16x16x32_bf16 v[196:199], a[100:103], a[48:51], v[196:199]
  v_mfma_f32_16x16x32_bf16 v[228:231], a[100:103], a[52:55], v[228:231]
  ds_read_b128 a[16:19], v16 offset:8192
  v_mfma_f32_16x16x32_bf16 a[132:135], a[100:103], a[56:59], a[132:135]
  v_mfma_f32_16x16x32_bf16 a[164:167], a[100:103], a[60:63], a[164:167]
  buffer_load_dwordx4 v58, s[12:15], s47 offen offset:2048 lds
  v_mfma_f32_16x16x32_bf16 v[72:75], a[104:107], a[32:35], v[72:75]
  ds_read_b128 a[20:23], v16 offset:10240
  v_mfma_f32_16x16x32_bf16 v[104:107], a[104:107], a[36:39], v[104:107]
  v_mfma_f32_16x16x32_bf16 v[136:139], a[104:107], a[40:43], v[136:139]
  ds_read_b128 a[24:27], v16 offset:12288
  v_mfma_f32_16x16x32_bf16 v[168:171], a[104:107], a[44:47], v[168:171]
  v_mfma_f32_16x16x32_bf16 v[200:203], a[104:107], a[48:51], v[200:203]
  ds_read_b128 a[28:31], v16 offset:14336
  v_mfma_f32_16x16x32_bf16 v[232:235], a[104:107], a[52:55], v[232:235]
  v_mfma_f32_16x16x32_bf16 a[136:139], a[104:107], a[56:59], a[136:139]
  ds_read_b64_tr_b16 a[68:69], v19 offset:0
  v_mfma_f32_16x16x32_bf16 a[168:171], a[104:107], a[60:63], a[168:171]
  buffer_load_dwordx4 v59, s[12:15], s47 offen offset:3072 lds
  v_mfma_f32_16x16x32_bf16 v[76:79], a[108:111], a[32:35], v[76:79]
  s_add_u32 m0, s41, 4096
  ds_read_b64_tr_b16 a[70:71], v19 offset:2048
  v_mfma_f32_16x16x32_bf16 v[108:111], a[108:111], a[36:39], v[108:111]
  v_mfma_f32_16x16x32_bf16 v[140:143], a[108:111], a[40:43], v[140:143]
  v_mfma_f32_16x16x32_bf16 v[172:175], a[108:111], a[44:47], v[172:175]
  ds_read_b64_tr_b16 a[72:73], v20 offset:0
  v_mfma_f32_16x16x32_bf16 v[204:207], a[108:111], a[48:51], v[204:207]
  v_mfma_f32_16x16x32_bf16 v[236:239], a[108:111], a[52:55], v[236:239]
  ds_read_b64_tr_b16 a[74:75], v20 offset:2048
  v_mfma_f32_16x16x32_bf16 a[140:143], a[108:111], a[56:59], a[140:143]
  v_mfma_f32_16x16x32_bf16 a[172:175], a[108:111], a[60:63], a[172:175]
  buffer_load_dwordx4 v60, s[12:15], s47 offen offset:0 lds
  v_mfma_f32_16x16x32_bf16 v[80:83], a[112:115], a[32:35], v[80:83]
  ds_read_b64_tr_b16 a[76:77], v21 offset:0
  v_mfma_f32_16x16x32_bf16 v[112:115], a[112:115], a[36:39], v[112:115]
  ds_read_b64_tr_b16 a[78:79], v21 offset:2048
  v_mfma_f32_16x16x32_bf16 v[144:147], a[112:115], a[40:43], v[144:147]
  v_mfma_f32_16x16x32_bf16 v[176:179], a[112:115], a[44:47], v[176:179]
  v_mfma_f32_16x16x32_bf16 v[208:211], a[112:115], a[48:51], v[208:211]
  ds_read_b64_tr_b16 a[80:81], v18 offset:8192
  v_mfma_f32_16x16x32_bf16 v[240:243], a[112:115], a[52:55], v[240:243]
  v_mfma_f32_16x16x32_bf16 a[144:147], a[112:115], a[56:59], a[144:147]
  ds_read_b64_tr_b16 a[82:83], v18 offset:10240
  v_mfma_f32_16x16x32_bf16 a[176:179], a[112:115], a[60:63], a[176:179]
  buffer_load_dwordx4 v61, s[12:15], s47 offen offset:1024 lds
  v_mfma_f32_16x16x32_bf16 v[84:87], a[116:119], a[32:35], v[84:87]
  ds_read_b64_tr_b16 a[84:85], v19 offset:8192
  v_mfma_f32_16x16x32_bf16 v[116:119], a[116:119], a[36:39], v[116:119]
  v_mfma_f32_16x16x32_bf16 v[148:151], a[116:119], a[40:43], v[148:151]
  ds_read_b64_tr_b16 a[86:87], v19 offset:10240
  v_mfma_f32_16x16x32_bf16 v[180:183], a[116:119], a[44:47], v[180:183]
  v_mfma_f32_16x16x32_bf16 v[212:215], a[116:119], a[48:51], v[212:215]
  v_mfma_f32_16x16x32_bf16 v[244:247], a[116:119], a[52:55], v[244:247]
  ds_read_b64_tr_b16 a[88:89], v20 offset:8192
  v_mfma_f32_16x16x32_bf16 a[148:151], a[116:119], a[56:59], a[148:151]
  v_mfma_f32_16x16x32_bf16 a[180:183], a[116:119], a[60:63], a[180:183]
  buffer_load_dwordx4 v62, s[12:15], s47 offen offset:2048 lds
  v_mfma_f32_16x16x32_bf16 v[88:91], a[120:123], a[32:35], v[88:91]
  ds_read_b64_tr_b16 a[90:91], v20 offset:10240
  v_mfma_f32_16x16x32_bf16 v[120:123], a[120:123], a[36:39], v[120:123]
  ds_read_b64_tr_b16 a[92:93], v21 offset:8192
  v_mfma_f32_16x16x32_bf16 v[152:155], a[120:123], a[40:43], v[152:155]
  v_mfma_f32_16x16x32_bf16 v[184:187], a[120:123], a[44:47], v[184:187]
  ds_read_b64_tr_b16 a[94:95], v21 offset:10240
  v_mfma_f32_16x16x32_bf16 v[216:219], a[120:123], a[48:51], v[216:219]
  v_mfma_f32_16x16x32_bf16 v[248:251], a[120:123], a[52:55], v[248:251]
  v_mfma_f32_16x16x32_bf16 a[152:155], a[120:123], a[56:59], a[152:155]
  v_mfma_f32_16x16x32_bf16 a[184:187], a[120:123], a[60:63], a[184:187]
  buffer_load_dwordx4 v63, s[12:15], s47 offen offset:3072 lds
  v_mfma_f32_16x16x32_bf16 v[92:95], a[124:127], a[32:35], v[92:95]
  v_mfma_f32_16x16x32_bf16 v[124:127], a[124:127], a[36:39], v[124:127]
  v_mfma_f32_16x16x32_bf16 v[156:159], a[124:127], a[40:43], v[156:159]
  v_mfma_f32_16x16x32_bf16 v[188:191], a[124:127], a[44:47], v[188:191]
  v_mfma_f32_16x16x32_bf16 v[220:223], a[124:127], a[48:51], v[220:223]
  v_mfma_f32_16x16x32_bf16 v[252:255], a[124:127], a[52:55], v[252:255]
  v_mfma_f32_16x16x32_bf16 a[156:159], a[124:127], a[56:59], a[156:159]
  v_mfma_f32_16x16x32_bf16 a[188:191], a[124:127], a[60:63], a[188:191]
  s_waitcnt lgkmcnt(0)
  v_mfma_f32_16x16x32_bf16 v[64:67], a[64:67], a[0:3], v[64:67]
  s_mov_b32 m0, s36
  ds_read_b128 a[32:35], v17 offset:0
  v_mfma_f32_16x16x32_bf16 v[96:99], a[64:67], a[4:7], v[96:99]
  buffer_load_dwordx4 v48, s[8:11], s46 offen offset:0 lds
  v_mfma_f32_16x16x32_bf16 v[128:131], a[64:67], a[8:11], v[128:131]
  ds_read_b64_tr_b16 a[96:97], v18 offset:4096
  v_mfma_f32_16x16x32_bf16 v[160:163], a[64:67], a[12:15], v[160:163]
  v_mfma_f32_16x16x32_bf16 v[192:195], a[64:67], a[16:19], v[192:195]
  ds_read_b64_tr_b16 a[98:99], v18 offset:6144
  v_mfma_f32_16x16x32_bf16 v[224:227], a[64:67], a[20:23], v[224:227]
  v_mfma_f32_16x16x32_bf16 a[128:131], a[64:67], a[24:27], a[128:131]
  ds_read_b128 a[36:39], v17 offset:2048
  v_mfma_f32_16x16x32_bf16 a[160:163], a[64:67], a[28:31], a[160:163]
  buffer_load_dwordx4 v49, s[8:11], s46 offen offset:1024 lds
  v_mfma_f32_16x16x32_bf16 v[68:71], a[68:71], a[0:3], v[68:71]
  v_mfma_f32_16x16x32_bf16 v[100:103], a[68:71], a[4:7], v[100:103]
  ds_read_b128 a[40:43], v17 offset:4096
  v_mfma_f32_16x16x32_bf16 v[132:135], a[68:71], a[8:11], v[132:135]
  v_mfma_f32_16x16x32_bf16 v[164:167], a[68:71], a[12:15], v[164:167]
  ds_read_b128 a[44:47], v17 offset:6144
  v_mfma_f32_16x16x32_bf16 v[196:199], a[68:71], a[16:19], v[196:199]
  v_mfma_f32_16x16x32_bf16 v[228:231], a[68:71], a[20:23], v[228:231]
  ds_read_b128 a[48:51], v17 offset:8192
  v_mfma_f32_16x16x32_bf16 a[132:135], a[68:71], a[24:27], a[132:135]
  buffer_load_dwordx4 v50, s[8:11], s46 offen offset:2048 lds
  v_mfma_f32_16x16x32_bf16 a[164:167], a[68:71], a[28:31], a[164:167]
  ds_read_b128 a[52:55], v17 offset:10240
  v_mfma_f32_16x16x32_bf16 v[72:75], a[72:75], a[0:3], v[72:75]
  v_mfma_f32_16x16x32_bf16 v[104:107], a[72:75], a[4:7], v[104:107]
  v_mfma_f32_16x16x32_bf16 v[136:139], a[72:75], a[8:11], v[136:139]
  ds_read_b128 a[56:59], v17 offset:12288
  v_mfma_f32_16x16x32_bf16 v[168:171], a[72:75], a[12:15], v[168:171]
  v_mfma_f32_16x16x32_bf16 v[200:203], a[72:75], a[16:19], v[200:203]
  ds_read_b128 a[60:63], v17 offset:14336
  v_mfma_f32_16x16x32_bf16 v[232:235], a[72:75], a[20:23], v[232:235]
  buffer_load_dwordx4 v51, s[8:11], s46 offen offset:3072 lds
  v_mfma_f32_16x16x32_bf16 a[136:139], a[72:75], a[24:27], a[136:139]
  s_add_u32 m0, s36, 4096
  ds_read_b64_tr_b16 a[100:101], v19 offset:4096
  v_mfma_f32_16x16x32_bf16 a[168:171], a[72:75], a[28:31], a[168:171]
  s_add_u32 s36, s36, s38
  v_mfma_f32_16x16x32_bf16 v[76:79], a[76:79], a[0:3], v[76:79]
  s_add_u32 s37, s37, 1
  ds_read_b64_tr_b16 a[102:103], v19 offset:6144
  v_mfma_f32_16x16x32_bf16 v[108:111], a[76:79], a[4:7], v[108:111]
  s_cmp_eq_u32 s37, 3
  s_cselect_b32 s37, 0, s37
  s_cselect_b32 s38, s39, s40
  v_mfma_f32_16x16x32_bf16 v[140:143], a[76:79], a[8:11], v[140:143]
  s_add_u32 s41, s41, s43
  v_mfma_f32_16x16x32_bf16 v[172:175], a[76:79], a[12:15], v[172:175]
  s_sub_u32 s43, 0, s43
  ds_read_b64_tr_b16 a[104:105], v20 offset:4096
  v_mfma_f32_16x16x32_bf16 v[204:207], a[76:79], a[16:19], v[204:207]
  buffer_load_dwordx4 v52, s[8:11], s46 offen offset:0 lds
  v_mfma_f32_16x16x32_bf16 v[236:239], a[76:79], a[20:23], v[236:239]
  ds_read_b64_tr_b16 a[106:107], v20 offset:6144
  v_mfma_f32_16x16x32_bf16 a[140:143], a[76:79], a[24:27], a[140:143]
  v_mfma_f32_16x16x32_bf16 a[172:175], a[76:79], a[28:31], a[172:175]
  ds_read_b64_tr_b16 a[108:109], v21 offset:4096
  v_mfma_f32_16x16x32_bf16 v[80:83], a[80:83], a[0:3], v[80:83]
  v_mfma_f32_16x16x32_bf16 v[112:115], a[80:83], a[4:7], v[112:115]
  ds_read_b64_tr_b16 a[110:111], v21 offset:6144
  v_mfma_f32_16x16x32_bf16 v[144:147], a[80:83], a[8:11], v[144:147]
  v_mfma_f32_16x16x32_bf16 v[176:179], a[80:83], a[12:15], v[176:179]
  buffer_load_dwordx4 v53, s[8:11], s46 offen offset:1024 lds
  v_mfma_f32_16x16x32_bf16 v[208:211], a[80:83], a[16:19], v[208:211]
  ds_read_b64_tr_b16 a[112:113], v18 offset:12288
  v_mfma_f32_16x16x32_bf16 v[240:243], a[80:83], a[20:23], v[240:243]
  v_mfma_f32_16x16x32_bf16 a[144:147], a[80:83], a[24:27], a[144:147]
  ds_read_b64_tr_b16 a[114:115], v18 offset:14336
  v_mfma_f32_16x16x32_bf16 a[176:179], a[80:83], a[28:31], a[176:179]
  v_mfma_f32_16x16x32_bf16 v[84:87], a[84:87], a[0:3], v[84:87]
  ds_read_b64_tr_b16 a[116:117], v19 offset:12288
  v_mfma_f32_16x16x32_bf16 v[116:119], a[84:87], a[4:7], v[116:119]
  v_mfma_f32_16x16x32_bf16 v[148:151], a[84:87], a[8:11], v[148:151]
  buffer_load_dwordx4 v54, s[8:11], s46 offen offset:2048 lds
  v_mfma_f32_16x16x32_bf16 v[180:183], a[84:87], a[12:15], v[180:183]
  ds_read_b64_tr_b16 a[118:119], v19 offset:14336
  v_mfma_f32_16x16x32_bf16 v[212:215], a[84:87], a[16:19], v[212:215]
  v_mfma_f32_16x16x32_bf16 v[244:247], a[84:87], a[20:23], v[244:247]
  ds_read_b64_tr_b16 a[120:121], v20 offset:12288
  v_mfma_f32_16x16x32_bf16 a[148:151], a[84:87], a[24:27], a[148:151]
  v_mfma_f32_16x16x32_bf16 a[180:183], a[84:87], a[28:31], a[180:183]
  ds_read_b64_tr_b16 a[122:123], v20 offset:14336
  v_mfma_f32_16x16x32_bf16 v[88:91], a[88:91], a[0:3], v[88:91]
  v_mfma_f32_16x16x32_bf16 v[120:123], a[88:91], a[4:7], v[120:123]
  buffer_load_dwordx4 v55, s[8:11], s46 offen offset:3072 lds
  v_mfma_f32_16x16x32_bf16 v[152:155], a[88:91], a[8:11], v[152:155]
  s_sub_u32 s50, s50, 1
  ds_read_b64_tr_b16 a[124:125], v21 offset:12288
  v_mfma_f32_16x16x32_bf16 v[184:187], a[88:91], a[12:15], v[184:187]
  ds_read_b64_tr_b16 a[126:127], v21 offset:14336
  v_mfma_f32_16x16x32_bf16 v[216:219], a[88:91], a[16:19], v[216:219]
  s_cmp_eq_u32 s50, 0
  s_cselect_b32 s12, s72, s12
  s_cselect_b32 s13, s73, s13
  v_mfma_f32_16x16x32_bf16 v[248:251], a[88:91], a[20:23], v[248:251]
  s_lshl_b32 s47, s48, 19
  v_add_u32 v16, s38, v16
  v_add_u32 v17, s38, v17
  v_mfma_f32_16x16x32_bf16 a[152:155], a[88:91], a[24:27], a[152:155]
  s_bfe_u32 s34, 0x3020106, s49
  v_add_u32 v18, s43, v18
  v_add_u32 v19, s43, v19
  v_mfma_f32_16x16x32_bf16 a[184:187], a[88:91], a[28:31], a[184:187]
  s_add_u32 s48, s48, s34
  v_add_u32 v20, s43, v20
  v_add_u32 v21, s43, v21
  v_mfma_f32_16x16x32_bf16 v[92:95], a[92:95], a[0:3], v[92:95]
  s_add_u32 s49, s49, 8
  v_mfma_f32_16x16x32_bf16 v[124:127], a[92:95], a[4:7], v[124:127]
  s_and_b32 s49, s49, 0x8001f
  v_mfma_f32_16x16x32_bf16 v[156:159], a[92:95], a[8:11], v[156:159]
  s_and_b32 s48, s48, 7
  v_mfma_f32_16x16x32_bf16 v[188:191], a[92:95], a[12:15], v[188:191]
  s_lshl_b32 s46, s48, 7
  v_mfma_f32_16x16x32_bf16 v[220:223], a[92:95], a[16:19], v[220:223]
  v_mfma_f32_16x16x32_bf16 v[252:255], a[92:95], a[20:23], v[252:255]
  s_waitcnt vmcnt(8) lgkmcnt(0)
  s_barrier
  v_mfma_f32_16x16x32_bf16 a[156:159], a[92:95], a[24:27], a[156:159]
  s_sub_u32 s35, s35, 1
  v_mfma_f32_16x16x32_bf16 a[188:191], a[92:95], a[28:31], a[188:191]
  s_cmp_lg_u32 s35, 0
  s_cbranch_scc1 Lp1wx_loop
  v_mfma_f32_16x16x32_bf16 v[64:67], a[96:99], a[32:35], v[64:67]
  s_mov_b32 m0, s41
  ds_read_b128 a[0:3], v16 offset:0
  v_mfma_f32_16x16x32_bf16 v[96:99], a[96:99], a[36:39], v[96:99]
  buffer_load_dwordx4 v56, s[12:15], s47 offen offset:0 lds
  v_mfma_f32_16x16x32_bf16 v[128:131], a[96:99], a[40:43], v[128:131]
  ds_read_b64_tr_b16 a[64:65], v18 offset:0
  v_mfma_f32_16x16x32_bf16 v[160:163], a[96:99], a[44:47], v[160:163]
  buffer_load_dwordx4 v57, s[12:15], s47 offen offset:1024 lds
  v_mfma_f32_16x16x32_bf16 v[192:195], a[96:99], a[48:51], v[192:195]
  ds_read_b64_tr_b16 a[66:67], v18 offset:2048
  v_mfma_f32_16x16x32_bf16 v[224:227], a[96:99], a[52:55], v[224:227]
  v_mfma_f32_16x16x32_bf16 a[128:131], a[96:99], a[56:59], a[128:131]
  ds_read_b128 a[4:7], v16 offset:2048
  v_mfma_f32_16x16x32_bf16 a[160:163], a[96:99], a[60:63], a[160:163]
  buffer_load_dwordx4 v58, s[12:15], s47 offen offset:2048 lds
  v_mfma_f32_16x16x32_bf16 v[68:71], a[100:103], a[32:35], v[68:71]
  v_mfma_f32_16x16x32_bf16 v[100:103], a[100:103], a[36:39], v[100:103]
  ds_read_b128 a[8:11], v16 offset:4096
  v_mfma_f32_16x16x32_bf16 v[132:135], a[100:103], a[40:43], v[132:135]
  v_mfma_f32_16x16x32_bf16 v[164:167], a[100:103], a[44:47], v[164:167]
  buffer_load_dwordx4 v59, s[12:15], s47 offen offset:3072 lds
  v_mfma_f32_16x16x32_bf16 v[196:199], a[100:103], a[48:51], v[196:199]
  s_add_u32 m0, s41, 4096
  ds_read_b128 a[12:15], v16 offset:6144
  v_mfma_f32_16x16x32_bf16 v[228:231], a[100:103], a[52:55], v[228:231]
  ds_read_b128 a[16:19], v16 offset:8192
  v_mfma_f32_16x16x32_bf16 a[132:135], a[100:103], a[56:59], a[132:135]
  v_mfma_f32_16x16x32_bf16 a[164:167], a[100:103], a[60:63], a[164:167]
  buffer_load_dwordx4 v60, s[12:15], s47 offen offset:0 lds
  v_mfma_f32_16x16x32_bf16 v[72:75], a[104:107], a[32:35], v[72:75]
  ds_read_b128 a[20:23], v16 offset:10240
  v_mfma_f32_16x16x32_bf16 v[104:107], a[104:107], a[36:39], v[104:107]
  v_mfma_f32_16x16x32_bf16 v[136:139], a[104:107], a[40:43], v[136:139]
  ds_read_b128 a[24:27], v16 offset:12288
  v_mfma_f32_16x16x32_bf16 v[168:171], a[104:107], a[44:47], v[168:171]
  buffer_load_dwordx4 v61, s[12:15], s47 offen offset:1024 lds
  v_mfma_f32_16x16x32_bf16 v[200:203], a[104:107], a[48:51], v[200:203]
  ds_read_b128 a[28:31], v16 offset:14336
  v_mfma_f32_16x16x32_bf16 v[232:235], a[104:107], a[52:55], v[232:235]
  v_mfma_f32_16x16x32_bf16 a[136:139], a[104:107], a[56:59], a[136:139]
  ds_read_b64_tr_b16 a[68:69], v19 offset:0
  v_mfma_f32_16x16x32_bf16 a[168:171], a[104:107], a[60:63], a[168:171]
  buffer_load_dwordx4 v62, s[12:15], s47 offen offset:2048 lds
  v_mfma_f32_16x16x32_bf16 v[76:79], a[108:111], a[32:35], v[76:79]
  ds_read_b64_tr_b16 a[70:71], v19 offset:2048
  v_mfma_f32_16x16x32_bf16 v[108:111], a[108:111], a[36:39], v[108:111]
  v_mfma_f32_16x16x32_bf16 v[140:143], a[108:111], a[40:43], v[140:143]
  v_mfma_f32_16x16x32_bf16 v[172:175], a[108:111], a[44:47], v[172:175]
  buffer_load_dwordx4 v63, s[12:15], s47 offen offset:3072 lds
  v_mfma_f32_16x16x32_bf16 v[204:207], a[108:111], a[48:51], v[204:207]
  s_mov_b32 m0, s36
  ds_read_b64_tr_b16 a[72:73], v20 offset:0
  v_mfma_f32_16x16x32_bf16 v[236:239], a[108:111], a[52:55], v[236:239]
  ds_read_b64_tr_b16 a[74:75], v20 offset:2048
  v_mfma_f32_16x16x32_bf16 a[140:143], a[108:111], a[56:59], a[140:143]
  v_mfma_f32_16x16x32_bf16 a[172:175], a[108:111], a[60:63], a[172:175]
  buffer_load_dwordx4 v48, s[8:11], s46 offen offset:0 lds
  v_mfma_f32_16x16x32_bf16 v[80:83], a[112:115], a[32:35], v[80:83]
  ds_read_b64_tr_b16 a[76:77], v21 offset:0
  v_mfma_f32_16x16x32_bf16 v[112:115], a[112:115], a[36:39], v[112:115]
  ds_read_b64_tr_b16 a[78:79], v21 offset:2048
  v_mfma_f32_16x16x32_bf16 v[144:147], a[112:115], a[40:43], v[144:147]
  v_mfma_f32_16x16x32_bf16 v[176:179], a[112:115], a[44:47], v[176:179]
  buffer_load_dwordx4 v49, s[8:11], s46 offen offset:1024 lds
  v_mfma_f32_16x16x32_bf16 v[208:211], a[112:115], a[48:51], v[208:211]
  ds_read_b64_tr_b16 a[80:81], v18 offset:8192
  v_mfma_f32_16x16x32_bf16 v[240:243], a[112:115], a[52:55], v[240:243]
  v_mfma_f32_16x16x32_bf16 a[144:147], a[112:115], a[56:59], a[144:147]
  ds_read_b64_tr_b16 a[82:83], v18 offset:10240
  v_mfma_f32_16x16x32_bf16 a[176:179], a[112:115], a[60:63], a[176:179]
  buffer_load_dwordx4 v50, s[8:11], s46 offen offset:2048 lds
  v_mfma_f32_16x16x32_bf16 v[84:87], a[116:119], a[32:35], v[84:87]
  ds_read_b64_tr_b16 a[84:85], v19 offset:8192
  v_mfma_f32_16x16x32_bf16 v[116:119], a[116:119], a[36:39], v[116:119]
  v_mfma_f32_16x16x32_bf16 v[148:151], a[116:119], a[40:43], v[148:151]
  ds_read_b64_tr_b16 a[86:87], v19 offset:10240
  v_mfma_f32_16x16x32_bf16 v[180:183], a[116:119], a[44:47], v[180:183]
  buffer_load_dwordx4 v51, s[8:11], s46 offen offset:3072 lds
  v_mfma_f32_16x16x32_bf16 v[212:215], a[116:119], a[48:51], v[212:215]
  s_add_u32 m0, s36, 4096
  v_mfma_f32_16x16x32_bf16 v[244:247], a[116:119], a[52:55], v[244:247]
  ds_read_b64_tr_b16 a[88:89], v20 offset:8192
  v_mfma_f32_16x16x32_bf16 a[148:151], a[116:119], a[56:59], a[148:151]
  v_mfma_f32_16x16x32_bf16 a[180:183], a[116:119], a[60:63], a[180:183]
  buffer_load_dwordx4 v52, s[8:11], s46 offen offset:0 lds
  v_mfma_f32_16x16x32_bf16 v[88:91], a[120:123], a[32:35], v[88:91]
  ds_read_b64_tr_b16 a[90:91], v20 offset:10240
  v_mfma_f32_16x16x32_bf16 v[120:123], a[120:123], a[36:39], v[120:123]
  ds_read_b64_tr_b16 a[92:93], v21 offset:8192
  v_mfma_f32_16x16x32_bf16 v[152:155], a[120:123], a[40:43], v[152:155]
  v_mfma_f32_16x16x32_bf16 v[184:187], a[120:123], a[44:47], v[184:187]
  buffer_load_dwordx4 v53, s[8:11], s46 offen offset:1024 lds
  v_mfma_f32_16x16x32_bf16 v[216:219], a[120:123], a[48:51], v[216:219]
  ds_read_b64_tr_b16 a[94:95], v21 offset:10240
  v_mfma_f32_16x16x32_bf16 v[248:251], a[120:123], a[52:55], v[248:251]
  v_mfma_f32_16x16x32_bf16 a[152:155], a[120:123], a[56:59], a[152:155]
  v_mfma_f32_16x16x32_bf16 a[184:187], a[120:123], a[60:63], a[184:187]
  buffer_load_dwordx4 v54, s[8:11], s46 offen offset:2048 lds
  v_mfma_f32_16x16x32_bf16 v[92:95], a[124:127], a[32:35], v[92:95]
  v_mfma_f32_16x16x32_bf16 v[124:127], a[124:127], a[36:39], v[124:127]
  v_mfma_f32_16x16x32_bf16 v[156:159], a[124:127], a[40:43], v[156:159]
  v_mfma_f32_16x16x32_bf16 v[188:191], a[124:127], a[44:47], v[188:191]
  buffer_load_dwordx4 v55, s[8:11], s46 offen offset:3072 lds
  v_mfma_f32_16x16x32_bf16 v[220:223], a[124:127], a[48:51], v[220:223]
  s_sub_u32 s50, s50, 1
  v_mfma_f32_16x16x32_bf16 v[252:255], a[124:127], a[52:55], v[252:255]
  s_cmp_eq_u32 s50, 0
  s_cselect_b32 s12, s72, s12
  s_cselect_b32 s13, s73, s13
  v_mfma_f32_16x16x32_bf16 a[156:159], a[124:127], a[56:59], a[156:159]
  s_lshl_b32 s47, s48, 19
  s_bfe_u32 s34, 0x3020106, s49
  s_add_u32 s48, s48, s34
  v_mfma_f32_16x16x32_bf16 a[188:191], a[124:127], a[60:63], a[188:191]
  s_add_u32 s49, s49, 8
  s_and_b32 s49, s49, 0x8001f
  s_and_b32 s48, s48, 7
  s_lshl_b32 s46, s48, 7
  s_waitcnt lgkmcnt(0)
  v_mfma_f32_16x16x32_bf16 v[128:131], a[64:67], a[8:11], v[128:131]
  ds_read_b128 a[32:35], v17 offset:0
  ds_read_b64_tr_b16 a[96:97], v18 offset:4096
  v_mfma_f32_16x16x32_bf16 v[132:135], a[68:71], a[8:11], v[132:135]
  ds_read_b64_tr_b16 a[98:99], v18 offset:6144
  ds_read_b128 a[36:39], v17 offset:2048
  v_mfma_f32_16x16x32_bf16 a[128:131], a[64:67], a[24:27], a[128:131]
  ds_read_b128 a[40:43], v17 offset:4096
  ds_read_b128 a[44:47], v17 offset:6144
  v_mfma_f32_16x16x32_bf16 a[132:135], a[68:71], a[24:27], a[132:135]
  ds_read_b128 a[48:51], v17 offset:8192
  ds_read_b128 a[52:55], v17 offset:10240
  v_mfma_f32_16x16x32_bf16 v[136:139], a[72:75], a[8:11], v[136:139]
  ds_read_b128 a[56:59], v17 offset:12288
  ds_read_b128 a[60:63], v17 offset:14336
  v_mfma_f32_16x16x32_bf16 v[140:143], a[76:79], a[8:11], v[140:143]
  ds_read_b64_tr_b16 a[100:101], v19 offset:4096
  ds_read_b64_tr_b16 a[102:103], v19 offset:6144
  v_mfma_f32_16x16x32_bf16 a[136:139], a[72:75], a[24:27], a[136:139]
  ds_read_b64_tr_b16 a[104:105], v20 offset:4096
  v_mfma_f32_16x16x32_bf16 a[140:143], a[76:79], a[24:27], a[140:143]
  ds_read_b64_tr_b16 a[106:107], v20 offset:6144
  ds_read_b64_tr_b16 a[108:109], v21 offset:4096
  v_mfma_f32_16x16x32_bf16 v[144:147], a[80:83], a[8:11], v[144:147]
  ds_read_b64_tr_b16 a[110:111], v21 offset:6144
  ds_read_b64_tr_b16 a[112:113], v18 offset:12288
  v_mfma_f32_16x16x32_bf16 v[148:151], a[84:87], a[8:11], v[148:151]
  ds_read_b64_tr_b16 a[114:115], v18 offset:14336
  ds_read_b64_tr_b16 a[116:117], v19 offset:12288
  v_mfma_f32_16x16x32_bf16 a[144:147], a[80:83], a[24:27], a[144:147]
  ds_read_b64_tr_b16 a[118:119], v19 offset:14336
  ds_read_b64_tr_b16 a[120:121], v20 offset:12288
  v_mfma_f32_16x16x32_bf16 a[148:151], a[84:87], a[24:27], a[148:151]
  ds_read_b64_tr_b16 a[122:123], v20 offset:14336
  ds_read_b64_tr_b16 a[124:125], v21 offset:12288
  v_mfma_f32_16x16x32_bf16 v[152:155], a[88:91], a[8:11], v[152:155]
  ds_read_b64_tr_b16 a[126:127], v21 offset:14336
  v_mfma_f32_16x16x32_bf16 v[156:159], a[92:95], a[8:11], v[156:159]
  v_mfma_f32_16x16x32_bf16 a[152:155], a[88:91], a[24:27], a[152:155]
  v_mfma_f32_16x16x32_bf16 a[156:159], a[92:95], a[24:27], a[156:159]
  v_mfma_f32_16x16x32_bf16 v[160:163], a[64:67], a[12:15], v[160:163]
  v_mfma_f32_16x16x32_bf16 v[164:167], a[68:71], a[12:15], v[164:167]
  s_add_u32 s36, s36, s38
  s_add_u32 s37, s37, 1
  s_cmp_eq_u32 s37, 3
  s_cselect_b32 s37, 0, s37
  s_cselect_b32 s38, s39, s40
  v_add_u32 v16, s38, v16
  v_add_u32 v17, s38, v17
  s_add_u32 s41, s41, s43
  s_sub_u32 s43, 0, s43
  v_add_u32 v18, s43, v18
  v_add_u32 v19, s43, v19
  v_add_u32 v20, s43, v20
  v_add_u32 v21, s43, v21
  s_waitcnt vmcnt(8) lgkmcnt(0)
  s_barrier
  v_mfma_f32_16x16x32_bf16 v[128:131], a[96:99], a[40:43], v[128:131]
  s_mov_b32 m0, s41
  v_mfma_f32_16x16x32_bf16 v[132:135], a[100:103], a[40:43], v[132:135]
  buffer_load_dwordx4 v56, s[12:15], s47 offen offset:0 lds
  v_mfma_f32_16x16x32_bf16 a[128:131], a[96:99], a[56:59], a[128:131]
  v_mfma_f32_16x16x32_bf16 a[132:135], a[100:103], a[56:59], a[132:135]
  v_mfma_f32_16x16x32_bf16 v[136:139], a[104:107], a[40:43], v[136:139]
  v_mfma_f32_16x16x32_bf16 v[140:143], a[108:111], a[40:43], v[140:143]
  buffer_load_dwordx4 v57, s[12:15], s47 offen offset:1024 lds
  v_cvt_pk_bf16_f32 v128, v128, v129
  v_mfma_f32_16x16x32_bf16 a[136:139], a[104:107], a[56:59], a[136:139]
  v_cvt_pk_bf16_f32 v129, v130, v131
  v_cvt_pk_bf16_f32 v130, v132, v133
  v_mfma_f32_16x16x32_bf16 a[140:143], a[108:111], a[56:59], a[140:143]
  v_cvt_pk_bf16_f32 v131, v134, v135
  v_accvgpr_read_b32 v24, a128
  v_mfma_f32_16x16x32_bf16 v[144:147], a[112:115], a[40:43], v[144:147]
  v_accvgpr_read_b32 v25, a129
  v_accvgpr_read_b32 v26, a130
  v_mfma_f32_16x16x32_bf16 v[148:151], a[116:119], a[40:43], v[148:151]
  v_accvgpr_read_b32 v27, a131
  v_accvgpr_read_b32 v28, a132
  v_mfma_f32_16x16x32_bf16 a[144:147], a[112:115], a[56:59], a[144:147]
  v_accvgpr_read_b32 v29, a133
  v_accvgpr_read_b32 v30, a134
  v_mfma_f32_16x16x32_bf16 a[148:151], a[116:119], a[56:59], a[148:151]
  buffer_load_dwordx4 v58, s[12:15], s47 offen offset:2048 lds
  v_accvgpr_read_b32 v31, a135
  v_mfma_f32_16x16x32_bf16 v[152:155], a[120:123], a[40:43], v[152:155]
  v_cvt_pk_bf16_f32 v132, v24, v25
  v_cvt_pk_bf16_f32 v133, v26, v27
  v_mfma_f32_16x16x32_bf16 v[156:159], a[124:127], a[40:43], v[156:159]
  v_cvt_pk_bf16_f32 v134, v28, v29
  v_cvt_pk_bf16_f32 v135, v30, v31
  v_mfma_f32_16x16x32_bf16 a[152:155], a[120:123], a[56:59], a[152:155]
  s_add_u32 s60, s63, 8192
  buffer_store_dwordx4 v[128:131], v2, s[16:19], s60 offen offset:0 sc1
  v_cvt_pk_bf16_f32 v136, v136, v137
  v_mfma_f32_16x16x32_bf16 a[156:159], a[124:127], a[56:59], a[156:159]
  v_cvt_pk_bf16_f32 v137, v138, v139
  v_cvt_pk_bf16_f32 v138, v140, v141
  v_mfma_f32_16x16x32_bf16 v[160:163], a[96:99], a[44:47], v[160:163]
  v_cvt_pk_bf16_f32 v139, v142, v143
  v_mfma_f32_16x16x32_bf16 v[164:167], a[100:103], a[44:47], v[164:167]
  buffer_load_dwordx4 v59, s[12:15], s47 offen offset:3072 lds
  v_mfma_f32_16x16x32_bf16 a[160:163], a[64:67], a[28:31], a[160:163]
  s_add_u32 m0, s41, 4096
  v_mfma_f32_16x16x32_bf16 a[164:167], a[68:71], a[28:31], a[164:167]
  s_add_u32 s60, s63, 40960
  buffer_store_dwordx4 v[132:135], v2, s[16:19], s60 offen offset:0 sc1
  v_accvgpr_read_b32 v32, a136
  v_mfma_f32_16x16x32_bf16 a[160:163], a[96:99], a[60:63], a[160:163]
  v_accvgpr_read_b32 v33, a137
  v_accvgpr_read_b32 v34, a138
  v_mfma_f32_16x16x32_bf16 a[164:167], a[100:103], a[60:63], a[164:167]
  v_accvgpr_read_b32 v35, a139
  v_accvgpr_read_b32 v36, a140
  v_mfma_f32_16x16x32_bf16 v[168:171], a[72:75], a[12:15], v[168:171]
  buffer_load_dwordx4 v60, s[12:15], s47 offen offset:0 lds
  v_accvgpr_read_b32 v37, a141
  v_mfma_f32_16x16x32_bf16 v[172:175], a[76:79], a[12:15], v[172:175]
  v_accvgpr_read_b32 v38, a142
  v_accvgpr_read_b32 v39, a143
  v_mfma_f32_16x16x32_bf16 v[168:171], a[104:107], a[44:47], v[168:171]
  v_cvt_pk_bf16_f32 v140, v32, v33
  v_cvt_pk_bf16_f32 v141, v34, v35
  v_mfma_f32_16x16x32_bf16 v[172:175], a[108:111], a[44:47], v[172:175]
  v_cvt_pk_bf16_f32 v142, v36, v37
  v_cvt_pk_bf16_f32 v143, v38, v39
  v_mfma_f32_16x16x32_bf16 a[168:171], a[72:75], a[28:31], a[168:171]
  s_add_u32 s60, s63, 8192
  buffer_store_dwordx4 v[136:139], v2, s[16:19], s60 offen offset:1024 sc1
  v_cvt_pk_bf16_f32 v144, v144, v145
  v_mfma_f32_16x16x32_bf16 a[172:175], a[76:79], a[28:31], a[172:175]
  v_cvt_pk_bf16_f32 v145, v146, v147
  v_cvt_pk_bf16_f32 v146, v148, v149
  v_mfma_f32_16x16x32_bf16 a[168:171], a[104:107], a[60:63], a[168:171]
  buffer_load_dwordx4 v61, s[12:15], s47 offen offset:1024 lds
  v_cvt_pk_bf16_f32 v147, v150, v151
  v_mfma_f32_16x16x32_bf16 a[172:175], a[108:111], a[60:63], a[172:175]
  s_add_u32 s60, s63, 40960
  buffer_store_dwordx4 v[140:143], v2, s[16:19], s60 offen offset:1024 sc1
  v_accvgpr_read_b32 v40, a144
  v_mfma_f32_16x16x32_bf16 v[176:179], a[80:83], a[12:15], v[176:179]
  v_accvgpr_read_b32 v41, a145
  v_accvgpr_read_b32 v42, a146
  v_mfma_f32_16x16x32_bf16 v[180:183], a[84:87], a[12:15], v[180:183]
  v_accvgpr_read_b32 v43, a147
  v_accvgpr_read_b32 v44, a148
  v_mfma_f32_16x16x32_bf16 v[176:179], a[112:115], a[44:47], v[176:179]
  v_accvgpr_read_b32 v45, a149
  v_accvgpr_read_b32 v46, a150
  v_mfma_f32_16x16x32_bf16 v[180:183], a[116:119], a[44:47], v[180:183]
  v_accvgpr_read_b32 v47, a151
  v_cvt_pk_bf16_f32 v148, v40, v41
  v_mfma_f32_16x16x32_bf16 a[176:179], a[80:83], a[28:31], a[176:179]
  buffer_load_dwordx4 v62, s[12:15], s47 offen offset:2048 lds
  v_cvt_pk_bf16_f32 v149, v42, v43
  v_mfma_f32_16x16x32_bf16 a[180:183], a[84:87], a[28:31], a[180:183]
  v_cvt_pk_bf16_f32 v150, v44, v45
  v_cvt_pk_bf16_f32 v151, v46, v47
  v_mfma_f32_16x16x32_bf16 a[176:179], a[112:115], a[60:63], a[176:179]
  s_add_u32 s60, s63, 8192
  buffer_store_dwordx4 v[144:147], v2, s[16:19], s60 offen offset:2048 sc1
  v_cvt_pk_bf16_f32 v152, v152, v153
  v_mfma_f32_16x16x32_bf16 a[180:183], a[116:119], a[60:63], a[180:183]
  v_cvt_pk_bf16_f32 v153, v154, v155
  v_cvt_pk_bf16_f32 v154, v156, v157
  v_mfma_f32_16x16x32_bf16 v[184:187], a[88:91], a[12:15], v[184:187]
  v_cvt_pk_bf16_f32 v155, v158, v159
  v_mfma_f32_16x16x32_bf16 v[188:191], a[92:95], a[12:15], v[188:191]
  buffer_load_dwordx4 v63, s[12:15], s47 offen offset:3072 lds
  v_mfma_f32_16x16x32_bf16 v[184:187], a[120:123], a[44:47], v[184:187]
  s_mov_b32 m0, s36
  v_mfma_f32_16x16x32_bf16 v[188:191], a[124:127], a[44:47], v[188:191]
  s_add_u32 s60, s63, 40960
  buffer_store_dwordx4 v[148:151], v2, s[16:19], s60 offen offset:2048 sc1
  v_accvgpr_read_b32 v24, a152
  v_mfma_f32_16x16x32_bf16 a[184:187], a[88:91], a[28:31], a[184:187]
  v_accvgpr_read_b32 v25, a153
  v_accvgpr_read_b32 v26, a154
  v_mfma_f32_16x16x32_bf16 a[188:191], a[92:95], a[28:31], a[188:191]
  v_accvgpr_read_b32 v27, a155
  v_accvgpr_read_b32 v28, a156
  v_mfma_f32_16x16x32_bf16 a[184:187], a[120:123], a[60:63], a[184:187]
  v_accvgpr_read_b32 v29, a157
  v_accvgpr_read_b32 v30, a158
  v_mfma_f32_16x16x32_bf16 a[188:191], a[124:127], a[60:63], a[188:191]
  buffer_load_dwordx4 v48, s[8:11], s46 offen offset:0 lds
  v_accvgpr_read_b32 v31, a159
  v_mfma_f32_16x16x32_bf16 v[192:195], a[64:67], a[16:19], v[192:195]
  v_cvt_pk_bf16_f32 v156, v24, v25
  v_cvt_pk_bf16_f32 v157, v26, v27
  v_mfma_f32_16x16x32_bf16 v[196:199], a[68:71], a[16:19], v[196:199]
  v_cvt_pk_bf16_f32 v158, v28, v29
  v_cvt_pk_bf16_f32 v159, v30, v31
  v_mfma_f32_16x16x32_bf16 v[192:195], a[96:99], a[48:51], v[192:195]
  v_cvt_pk_bf16_f32 v160, v160, v161
  v_cvt_pk_bf16_f32 v161, v162, v163
  v_mfma_f32_16x16x32_bf16 v[196:199], a[100:103], a[48:51], v[196:199]
  v_cvt_pk_bf16_f32 v162, v164, v165
  v_cvt_pk_bf16_f32 v163, v166, v167
  v_mfma_f32_16x16x32_bf16 v[64:67], a[64:67], a[0:3], v[64:67]
  s_add_u32 s60, s63, 8192
  buffer_store_dwordx4 v[152:155], v2, s[16:19], s60 offen offset:3072 sc1
  v_accvgpr_read_b32 v32, a160
  v_mfma_f32_16x16x32_bf16 v[68:71], a[68:71], a[0:3], v[68:71]
  buffer_load_dwordx4 v49, s[8:11], s46 offen offset:1024 lds
  v_accvgpr_read_b32 v33, a161
  v_mfma_f32_16x16x32_bf16 v[64:67], a[96:99], a[32:35], v[64:67]
  v_accvgpr_read_b32 v34, a162
  v_accvgpr_read_b32 v35, a163
  v_mfma_f32_16x16x32_bf16 v[68:71], a[100:103], a[32:35], v[68:71]
  v_accvgpr_read_b32 v36, a164
  v_accvgpr_read_b32 v37, a165
  v_mfma_f32_16x16x32_bf16 v[200:203], a[72:75], a[16:19], v[200:203]
  v_accvgpr_read_b32 v38, a166
  v_accvgpr_read_b32 v39, a167
  v_mfma_f32_16x16x32_bf16 v[204:207], a[76:79], a[16:19], v[204:207]
  v_cvt_pk_bf16_f32 v164, v32, v33
  v_cvt_pk_bf16_f32 v165, v34, v35
  v_mfma_f32_16x16x32_bf16 v[200:203], a[104:107], a[48:51], v[200:203]
  buffer_load_dwordx4 v50, s[8:11], s46 offen offset:2048 lds
  v_cvt_pk_bf16_f32 v166, v36, v37
  v_mfma_f32_16x16x32_bf16 v[204:207], a[108:111], a[48:51], v[204:207]
  v_cvt_pk_bf16_f32 v167, v38, v39
  v_mfma_f32_16x16x32_bf16 v[72:75], a[72:75], a[0:3], v[72:75]
  s_add_u32 s60, s63, 40960
  buffer_store_dwordx4 v[156:159], v2, s[16:19], s60 offen offset:3072 sc1
  v_cvt_pk_bf16_f32 v168, v168, v169
  v_mfma_f32_16x16x32_bf16 v[76:79], a[76:79], a[0:3], v[76:79]
  v_cvt_pk_bf16_f32 v169, v170, v171
  v_cvt_pk_bf16_f32 v170, v172, v173
  v_mfma_f32_16x16x32_bf16 v[72:75], a[104:107], a[32:35], v[72:75]
  v_cvt_pk_bf16_f32 v171, v174, v175
  v_mfma_f32_16x16x32_bf16 v[76:79], a[108:111], a[32:35], v[76:79]
  s_add_u32 s60, s63, 12288
  buffer_store_dwordx4 v[160:163], v2, s[16:19], s60 offen offset:0 sc1
  v_accvgpr_read_b32 v40, a168
  v_mfma_f32_16x16x32_bf16 v[208:211], a[80:83], a[16:19], v[208:211]
  buffer_load_dwordx4 v51, s[8:11], s46 offen offset:3072 lds
  v_accvgpr_read_b32 v41, a169
  v_mfma_f32_16x16x32_bf16 v[212:215], a[84:87], a[16:19], v[212:215]
  s_add_u32 m0, s36, 4096
  v_accvgpr_read_b32 v42, a170
  v_accvgpr_read_b32 v43, a171
  v_mfma_f32_16x16x32_bf16 v[208:211], a[112:115], a[48:51], v[208:211]
  v_accvgpr_read_b32 v44, a172
  v_accvgpr_read_b32 v45, a173
  v_mfma_f32_16x16x32_bf16 v[212:215], a[116:119], a[48:51], v[212:215]
  v_accvgpr_read_b32 v46, a174
  v_accvgpr_read_b32 v47, a175
  v_mfma_f32_16x16x32_bf16 v[80:83], a[80:83], a[0:3], v[80:83]
  v_cvt_pk_bf16_f32 v172, v40, v41
  v_cvt_pk_bf16_f32 v173, v42, v43
  v_mfma_f32_16x16x32_bf16 v[84:87], a[84:87], a[0:3], v[84:87]
  v_cvt_pk_bf16_f32 v174, v44, v45
  v_cvt_pk_bf16_f32 v175, v46, v47
  v_mfma_f32_16x16x32_bf16 v[80:83], a[112:115], a[32:35], v[80:83]
  buffer_load_dwordx4 v52, s[8:11], s46 offen offset:0 lds
  v_mfma_f32_16x16x32_bf16 v[84:87], a[116:119], a[32:35], v[84:87]
  s_add_u32 s60, s63, 45056
  buffer_store_dwordx4 v[164:167], v2, s[16:19], s60 offen offset:0 sc1
  v_cvt_pk_bf16_f32 v176, v176, v177
  v_mfma_f32_16x16x32_bf16 v[216:219], a[88:91], a[16:19], v[216:219]
  v_cvt_pk_bf16_f32 v177, v178, v179
  v_cvt_pk_bf16_f32 v178, v180, v181
  v_mfma_f32_16x16x32_bf16 v[220:223], a[92:95], a[16:19], v[220:223]
  v_cvt_pk_bf16_f32 v179, v182, v183
  v_mfma_f32_16x16x32_bf16 v[216:219], a[120:123], a[48:51], v[216:219]
  s_add_u32 s60, s63, 12288
  buffer_store_dwordx4 v[168:171], v2, s[16:19], s60 offen offset:1024 sc1
  v_accvgpr_read_b32 v24, a176
  v_mfma_f32_16x16x32_bf16 v[220:223], a[124:127], a[48:51], v[220:223]
  buffer_load_dwordx4 v53, s[8:11], s46 offen offset:1024 lds
  v_accvgpr_read_b32 v25, a177
  v_mfma_f32_16x16x32_bf16 v[88:91], a[88:91], a[0:3], v[88:91]
  v_accvgpr_read_b32 v26, a178
  v_accvgpr_read_b32 v27, a179
  v_mfma_f32_16x16x32_bf16 v[92:95], a[92:95], a[0:3], v[92:95]
  v_accvgpr_read_b32 v28, a180
  v_accvgpr_read_b32 v29, a181
  v_mfma_f32_16x16x32_bf16 v[224:227], a[64:67], a[20:23], v[224:227]
  v_accvgpr_read_b32 v30, a182
  v_accvgpr_read_b32 v31, a183
  v_mfma_f32_16x16x32_bf16 v[228:231], a[68:71], a[20:23], v[228:231]
  v_cvt_pk_bf16_f32 v180, v24, v25
  v_cvt_pk_bf16_f32 v181, v26, v27
  v_mfma_f32_16x16x32_bf16 v[96:99], a[64:67], a[4:7], v[96:99]
  v_cvt_pk_bf16_f32 v182, v28, v29
  v_cvt_pk_bf16_f32 v183, v30, v31
  v_mfma_f32_16x16x32_bf16 v[100:103], a[68:71], a[4:7], v[100:103]
  buffer_load_dwordx4 v54, s[8:11], s46 offen offset:2048 lds
  v_mfma_f32_16x16x32_bf16 v[232:235], a[72:75], a[20:23], v[232:235]
  s_add_u32 s60, s63, 45056
  buffer_store_dwordx4 v[172:175], v2, s[16:19], s60 offen offset:1024 sc1
  v_cvt_pk_bf16_f32 v184, v184, v185
  v_mfma_f32_16x16x32_bf16 v[236:239], a[76:79], a[20:23], v[236:239]
  v_cvt_pk_bf16_f32 v185, v186, v187
  v_cvt_pk_bf16_f32 v186, v188, v189
  v_mfma_f32_16x16x32_bf16 v[104:107], a[72:75], a[4:7], v[104:107]
  v_cvt_pk_bf16_f32 v187, v190, v191
  v_accvgpr_read_b32 v32, a184
  v_mfma_f32_16x16x32_bf16 v[108:111], a[76:79], a[4:7], v[108:111]
  v_accvgpr_read_b32 v33, a185
  v_accvgpr_read_b32 v34, a186
  v_mfma_f32_16x16x32_bf16 v[240:243], a[80:83], a[20:23], v[240:243]
  v_accvgpr_read_b32 v35, a187
  v_accvgpr_read_b32 v36, a188
  v_mfma_f32_16x16x32_bf16 v[244:247], a[84:87], a[20:23], v[244:247]
  buffer_load_dwordx4 v55, s[8:11], s46 offen offset:3072 lds
  v_accvgpr_read_b32 v37, a189
  v_mfma_f32_16x16x32_bf16 v[112:115], a[80:83], a[4:7], v[112:115]
  s_sub_u32 s50, s50, 1
  s_cmp_eq_u32 s50, 0
  s_cselect_b32 s12, s72, s12
  s_cselect_b32 s13, s73, s13
  v_mfma_f32_16x16x32_bf16 v[116:119], a[84:87], a[4:7], v[116:119]
  s_lshl_b32 s47, s48, 19
  s_bfe_u32 s34, 0x3020106, s49
  s_add_u32 s48, s48, s34
  v_mfma_f32_16x16x32_bf16 v[248:251], a[88:91], a[20:23], v[248:251]
  s_add_u32 s49, s49, 8
  s_and_b32 s49, s49, 0x8001f
  s_and_b32 s48, s48, 7
  v_mfma_f32_16x16x32_bf16 v[252:255], a[92:95], a[20:23], v[252:255]
  s_lshl_b32 s46, s48, 7
  v_accvgpr_read_b32 v38, a190
  v_accvgpr_read_b32 v39, a191
  v_mfma_f32_16x16x32_bf16 v[120:123], a[88:91], a[4:7], v[120:123]
  v_cvt_pk_bf16_f32 v188, v32, v33
  v_cvt_pk_bf16_f32 v189, v34, v35
  v_mfma_f32_16x16x32_bf16 v[124:127], a[92:95], a[4:7], v[124:127]
  v_cvt_pk_bf16_f32 v190, v36, v37
  v_cvt_pk_bf16_f32 v191, v38, v39
  v_mfma_f32_16x16x32_bf16 v[88:91], a[120:123], a[32:35], v[88:91]
  ds_read_b128 a[0:3], v16 offset:0
  ds_read_b64_tr_b16 a[64:65], v18 offset:0
  v_mfma_f32_16x16x32_bf16 v[92:95], a[124:127], a[32:35], v[92:95]
  ds_read_b64_tr_b16 a[66:67], v18 offset:2048
  ds_read_b128 a[4:7], v16 offset:2048
  v_mfma_f32_16x16x32_bf16 v[224:227], a[96:99], a[52:55], v[224:227]
  ds_read_b128 a[8:11], v16 offset:4096
  ds_read_b128 a[12:15], v16 offset:6144
  v_mfma_f32_16x16x32_bf16 v[228:231], a[100:103], a[52:55], v[228:231]
  ds_read_b128 a[16:19], v16 offset:8192
  ds_read_b128 a[20:23], v16 offset:10240
  v_mfma_f32_16x16x32_bf16 v[96:99], a[96:99], a[36:39], v[96:99]
  ds_read_b128 a[24:27], v16 offset:12288
  ds_read_b128 a[28:31], v16 offset:14336
  v_mfma_f32_16x16x32_bf16 v[100:103], a[100:103], a[36:39], v[100:103]
  ds_read_b64_tr_b16 a[68:69], v19 offset:0
  ds_read_b64_tr_b16 a[70:71], v19 offset:2048
  v_mfma_f32_16x16x32_bf16 v[232:235], a[104:107], a[52:55], v[232:235]
  ds_read_b64_tr_b16 a[72:73], v20 offset:0
  ds_read_b64_tr_b16 a[74:75], v20 offset:2048
  v_mfma_f32_16x16x32_bf16 v[236:239], a[108:111], a[52:55], v[236:239]
  ds_read_b64_tr_b16 a[76:77], v21 offset:0
  ds_read_b64_tr_b16 a[78:79], v21 offset:2048
  v_mfma_f32_16x16x32_bf16 v[104:107], a[104:107], a[36:39], v[104:107]
  ds_read_b64_tr_b16 a[80:81], v18 offset:8192
  ds_read_b64_tr_b16 a[82:83], v18 offset:10240
  v_mfma_f32_16x16x32_bf16 v[108:111], a[108:111], a[36:39], v[108:111]
  ds_read_b64_tr_b16 a[84:85], v19 offset:8192
  ds_read_b64_tr_b16 a[86:87], v19 offset:10240
  v_mfma_f32_16x16x32_bf16 v[240:243], a[112:115], a[52:55], v[240:243]
  ds_read_b64_tr_b16 a[88:89], v20 offset:8192
  ds_read_b64_tr_b16 a[90:91], v20 offset:10240
  v_mfma_f32_16x16x32_bf16 v[244:247], a[116:119], a[52:55], v[244:247]
  ds_read_b64_tr_b16 a[92:93], v21 offset:8192
  ds_read_b64_tr_b16 a[94:95], v21 offset:10240
  v_mfma_f32_16x16x32_bf16 v[112:115], a[112:115], a[36:39], v[112:115]
  v_cvt_pk_bf16_f32 v192, v192, v193
  v_cvt_pk_bf16_f32 v193, v194, v195
  v_mfma_f32_16x16x32_bf16 v[116:119], a[116:119], a[36:39], v[116:119]
  v_cvt_pk_bf16_f32 v194, v196, v197
  v_cvt_pk_bf16_f32 v195, v198, v199
  v_mfma_f32_16x16x32_bf16 v[248:251], a[120:123], a[52:55], v[248:251]
  v_cvt_pk_bf16_f32 v196, v64, v65
  v_cvt_pk_bf16_f32 v197, v66, v67
  v_mfma_f32_16x16x32_bf16 v[252:255], a[124:127], a[52:55], v[252:255]
  v_cvt_pk_bf16_f32 v198, v68, v69
  v_cvt_pk_bf16_f32 v199, v70, v71
  v_mfma_f32_16x16x32_bf16 v[120:123], a[120:123], a[36:39], v[120:123]
  v_cvt_pk_bf16_f32 v200, v200, v201
  v_cvt_pk_bf16_f32 v201, v202, v203
  v_mfma_f32_16x16x32_bf16 v[124:127], a[124:127], a[36:39], v[124:127]
  v_cvt_pk_bf16_f32 v202, v204, v205
  v_cvt_pk_bf16_f32 v203, v206, v207
  s_waitcnt lgkmcnt(0)
  v_mfma_f32_16x16x32_bf16 a[128:131], a[24:27], a[64:67], 0
  ds_read_b128 a[32:35], v17 offset:0
  ds_read_b64_tr_b16 a[96:97], v18 offset:4096
  v_mfma_f32_16x16x32_bf16 a[132:135], a[24:27], a[68:71], 0
  ds_read_b64_tr_b16 a[98:99], v18 offset:6144
  ds_read_b128 a[36:39], v17 offset:2048
  v_mfma_f32_16x16x32_bf16 a[136:139], a[24:27], a[72:75], 0
  ds_read_b128 a[40:43], v17 offset:4096
  ds_read_b128 a[44:47], v17 offset:6144
  v_mfma_f32_16x16x32_bf16 a[140:143], a[24:27], a[76:79], 0
  ds_read_b128 a[48:51], v17 offset:8192
  ds_read_b128 a[52:55], v17 offset:10240
  v_mfma_f32_16x16x32_bf16 a[144:147], a[24:27], a[80:83], 0
  ds_read_b128 a[56:59], v17 offset:12288
  ds_read_b128 a[60:63], v17 offset:14336
  v_mfma_f32_16x16x32_bf16 a[148:151], a[24:27], a[84:87], 0
  ds_read_b64_tr_b16 a[100:101], v19 offset:4096
  ds_read_b64_tr_b16 a[102:103], v19 offset:6144
  v_mfma_f32_16x16x32_bf16 a[152:155], a[24:27], a[88:91], 0
  ds_read_b64_tr_b16 a[104:105], v20 offset:4096
  v_cvt_pk_bf16_f32 v204, v72, v73
  v_mfma_f32_16x16x32_bf16 a[156:159], a[24:27], a[92:95], 0
  ds_read_b64_tr_b16 a[106:107], v20 offset:6144
  ds_read_b64_tr_b16 a[108:109], v21 offset:4096
  v_mfma_f32_16x16x32_bf16 a[160:163], a[28:31], a[64:67], 0
  ds_read_b64_tr_b16 a[110:111], v21 offset:6144
  ds_read_b64_tr_b16 a[112:113], v18 offset:12288
  v_mfma_f32_16x16x32_bf16 a[164:167], a[28:31], a[68:71], 0
  ds_read_b64_tr_b16 a[114:115], v18 offset:14336
  ds_read_b64_tr_b16 a[116:117], v19 offset:12288
  v_mfma_f32_16x16x32_bf16 a[168:171], a[28:31], a[72:75], 0
  ds_read_b64_tr_b16 a[118:119], v19 offset:14336
  ds_read_b64_tr_b16 a[120:121], v20 offset:12288
  v_mfma_f32_16x16x32_bf16 a[172:175], a[28:31], a[76:79], 0
  ds_read_b64_tr_b16 a[122:123], v20 offset:14336
  ds_read_b64_tr_b16 a[124:125], v21 offset:12288
  v_mfma_f32_16x16x32_bf16 a[176:179], a[28:31], a[80:83], 0
  ds_read_b64_tr_b16 a[126:127], v21 offset:14336
  v_cvt_pk_bf16_f32 v205, v74, v75
  v_mfma_f32_16x16x32_bf16 a[180:183], a[28:31], a[84:87], 0
  v_cvt_pk_bf16_f32 v206, v76, v77
  v_cvt_pk_bf16_f32 v207, v78, v79
  v_mfma_f32_16x16x32_bf16 a[184:187], a[28:31], a[88:91], 0
  v_cvt_pk_bf16_f32 v208, v208, v209
  v_cvt_pk_bf16_f32 v209, v210, v211
  v_mfma_f32_16x16x32_bf16 a[188:191], a[28:31], a[92:95], 0
  v_cvt_pk_bf16_f32 v210, v212, v213
  v_cvt_pk_bf16_f32 v211, v214, v215
  v_mfma_f32_16x16x32_bf16 v[128:131], a[8:11], a[64:67], 0
  v_cvt_pk_bf16_f32 v212, v80, v81
  v_cvt_pk_bf16_f32 v213, v82, v83
  v_mfma_f32_16x16x32_bf16 v[132:135], a[8:11], a[68:71], 0
  v_cvt_pk_bf16_f32 v214, v84, v85
  v_cvt_pk_bf16_f32 v215, v86, v87
  v_mfma_f32_16x16x32_bf16 v[136:139], a[8:11], a[72:75], 0
  v_cvt_pk_bf16_f32 v216, v216, v217
  v_cvt_pk_bf16_f32 v217, v218, v219
  v_mfma_f32_16x16x32_bf16 v[140:143], a[8:11], a[76:79], 0
  s_add_u32 s36, s36, s38
  s_add_u32 s37, s37, 1
  s_cmp_eq_u32 s37, 3
  s_cselect_b32 s37, 0, s37
  s_cselect_b32 s38, s39, s40
  v_add_u32 v16, s38, v16
  v_add_u32 v17, s38, v17
  s_add_u32 s41, s41, s43
  s_sub_u32 s43, 0, s43
  v_add_u32 v18, s43, v18
  v_add_u32 v19, s43, v19
  v_add_u32 v20, s43, v20
  v_add_u32 v21, s43, v21
  s_waitcnt vmcnt(8) lgkmcnt(0)
  s_barrier
  v_mfma_f32_16x16x32_bf16 a[128:131], a[56:59], a[96:99], a[128:131]
  s_mov_b32 m0, s41
  v_cvt_pk_bf16_f32 v218, v220, v221
  v_cvt_pk_bf16_f32 v219, v222, v223
  v_mfma_f32_16x16x32_bf16 a[132:135], a[56:59], a[100:103], a[132:135]
  v_cvt_pk_bf16_f32 v220, v88, v89
  v_cvt_pk_bf16_f32 v221, v90, v91
  v_mfma_f32_16x16x32_bf16 a[136:139], a[56:59], a[104:107], a[136:139]
  v_cvt_pk_bf16_f32 v222, v92, v93
  v_cvt_pk_bf16_f32 v223, v94, v95
  v_mfma_f32_16x16x32_bf16 a[140:143], a[56:59], a[108:111], a[140:143]
  v_cvt_pk_bf16_f32 v224, v224, v225
  v_cvt_pk_bf16_f32 v225, v226, v227
  v_mfma_f32_16x16x32_bf16 a[144:147], a[56:59], a[112:115], a[144:147]
  v_cvt_pk_bf16_f32 v226, v228, v229
  v_cvt_pk_bf16_f32 v227, v230, v231
  v_mfma_f32_16x16x32_bf16 a[148:151], a[56:59], a[116:119], a[148:151]
  v_cvt_pk_bf16_f32 v228, v96, v97
  v_cvt_pk_bf16_f32 v229, v98, v99
  v_mfma_f32_16x16x32_bf16 a[152:155], a[56:59], a[120:123], a[152:155]
  v_cvt_pk_bf16_f32 v230, v100, v101
  v_cvt_pk_bf16_f32 v231, v102, v103
  v_mfma_f32_16x16x32_bf16 a[156:159], a[56:59], a[124:127], a[156:159]
  v_cvt_pk_bf16_f32 v232, v232, v233
  v_cvt_pk_bf16_f32 v233, v234, v235
  v_mfma_f32_16x16x32_bf16 a[160:163], a[60:63], a[96:99], a[160:163]
  v_cvt_pk_bf16_f32 v234, v236, v237
  v_cvt_pk_bf16_f32 v235, v238, v239
  v_mfma_f32_16x16x32_bf16 a[164:167], a[60:63], a[100:103], a[164:167]
  v_cvt_pk_bf16_f32 v236, v104, v105
  v_cvt_pk_bf16_f32 v237, v106, v107
  v_mfma_f32_16x16x32_bf16 a[168:171], a[60:63], a[104:107], a[168:171]
  v_cvt_pk_bf16_f32 v238, v108, v109
  v_cvt_pk_bf16_f32 v239, v110, v111
  v_mfma_f32_16x16x32_bf16 a[172:175], a[60:63], a[108:111], a[172:175]
  v_cvt_pk_bf16_f32 v240, v240, v241
  v_cvt_pk_bf16_f32 v241, v242, v243
  v_mfma_f32_16x16x32_bf16 a[176:179], a[60:63], a[112:115], a[176:179]
  v_cvt_pk_bf16_f32 v242, v244, v245
  v_cvt_pk_bf16_f32 v243, v246, v247
  v_mfma_f32_16x16x32_bf16 a[180:183], a[60:63], a[116:119], a[180:183]
  v_cvt_pk_bf16_f32 v244, v112, v113
  v_cvt_pk_bf16_f32 v245, v114, v115
  v_mfma_f32_16x16x32_bf16 a[184:187], a[60:63], a[120:123], a[184:187]
  v_cvt_pk_bf16_f32 v246, v116, v117
  v_cvt_pk_bf16_f32 v247, v118, v119
  v_mfma_f32_16x16x32_bf16 a[188:191], a[60:63], a[124:127], a[188:191]
  v_cvt_pk_bf16_f32 v248, v248, v249
  v_cvt_pk_bf16_f32 v249, v250, v251
  v_mfma_f32_16x16x32_bf16 v[128:131], a[40:43], a[96:99], v[128:131]
  v_cvt_pk_bf16_f32 v250, v252, v253
  v_cvt_pk_bf16_f32 v251, v254, v255
  v_mfma_f32_16x16x32_bf16 v[132:135], a[40:43], a[100:103], v[132:135]
  v_cvt_pk_bf16_f32 v252, v120, v121
  v_cvt_pk_bf16_f32 v253, v122, v123
  v_mfma_f32_16x16x32_bf16 v[136:139], a[40:43], a[104:107], v[136:139]
  v_cvt_pk_bf16_f32 v254, v124, v125
  v_cvt_pk_bf16_f32 v255, v126, v127
  v_mfma_f32_16x16x32_bf16 v[140:143], a[40:43], a[108:111], v[140:143]
  s_add_u32 s60, s63, 12288
  buffer_store_dwordx4 v[176:179], v2, s[16:19], s60 offen offset:2048 sc1
  v_mfma_f32_16x16x32_bf16 v[144:147], a[8:11], a[80:83], 0
  s_add_u32 s60, s63, 45056
  buffer_store_dwordx4 v[180:183], v2, s[16:19], s60 offen offset:2048 sc1
  v_mfma_f32_16x16x32_bf16 v[148:151], a[8:11], a[84:87], 0
  s_add_u32 s60, s63, 12288
  buffer_store_dwordx4 v[184:187], v2, s[16:19], s60 offen offset:3072 sc1
  v_mfma_f32_16x16x32_bf16 v[144:147], a[40:43], a[112:115], v[144:147]
  s_add_u32 s60, s63, 45056
  buffer_store_dwordx4 v[188:191], v2, s[16:19], s60 offen offset:3072 sc1
  v_mfma_f32_16x16x32_bf16 v[148:151], a[40:43], a[116:119], v[148:151]
  s_add_u32 s60, s63, 32768
  buffer_store_dwordx4 v[192:195], v2, s[16:19], s60 offen offset:0 sc1
  v_mfma_f32_16x16x32_bf16 v[152:155], a[8:11], a[88:91], 0
  s_add_u32 s60, s63, 0
  buffer_store_dwordx4 v[196:199], v2, s[16:19], s60 offen offset:0 sc1
  v_mfma_f32_16x16x32_bf16 v[156:159], a[8:11], a[92:95], 0
  buffer_load_dwordx4 v56, s[12:15], s47 offen offset:0 lds
  v_mfma_f32_16x16x32_bf16 v[152:155], a[40:43], a[120:123], v[152:155]
  s_add_u32 s60, s63, 32768
  buffer_store_dwordx4 v[200:203], v2, s[16:19], s60 offen offset:1024 sc1
  v_mfma_f32_16x16x32_bf16 v[156:159], a[40:43], a[124:127], v[156:159]
  buffer_load_dwordx4 v57, s[12:15], s47 offen offset:1024 lds
  v_mfma_f32_16x16x32_bf16 v[160:163], a[12:15], a[64:67], 0
  buffer_load_dwordx4 v58, s[12:15], s47 offen offset:2048 lds
  v_mfma_f32_16x16x32_bf16 v[164:167], a[12:15], a[68:71], 0
  buffer_load_dwordx4 v59, s[12:15], s47 offen offset:3072 lds
  v_mfma_f32_16x16x32_bf16 v[160:163], a[44:47], a[96:99], v[160:163]
  s_add_u32 m0, s41, 4096
  v_mfma_f32_16x16x32_bf16 v[164:167], a[44:47], a[100:103], v[164:167]
  s_add_u32 s60, s63, 0
  buffer_store_dwordx4 v[204:207], v2, s[16:19], s60 offen offset:1024 sc1
  v_mfma_f32_16x16x32_bf16 v[168:171], a[12:15], a[72:75], 0
  buffer_load_dwordx4 v60, s[12:15], s47 offen offset:0 lds
  v_mfma_f32_16x16x32_bf16 v[172:175], a[12:15], a[76:79], 0
  buffer_load_dwordx4 v61, s[12:15], s47 offen offset:1024 lds
  v_mfma_f32_16x16x32_bf16 v[168:171], a[44:47], a[104:107], v[168:171]
  buffer_load_dwordx4 v62, s[12:15], s47 offen offset:2048 lds
  v_mfma_f32_16x16x32_bf16 v[172:175], a[44:47], a[108:111], v[172:175]
  s_add_u32 s60, s63, 32768
  buffer_store_dwordx4 v[208:211], v2, s[16:19], s60 offen offset:2048 sc1
  v_mfma_f32_16x16x32_bf16 v[64:67], a[0:3], a[64:67], 0
  v_mfma_f32_16x16x32_bf16 v[68:71], a[0:3], a[68:71], 0
  v_mfma_f32_16x16x32_bf16 v[64:67], a[32:35], a[96:99], v[64:67]
  buffer_load_dwordx4 v63, s[12:15], s47 offen offset:3072 lds
  v_mfma_f32_16x16x32_bf16 v[68:71], a[32:35], a[100:103], v[68:71]
  s_add_u32 s60, s63, 0
  buffer_store_dwordx4 v[212:215], v2, s[16:19], s60 offen offset:2048 sc1
  s_mov_b32 m0, s36
  s_nop 0
  buffer_load_dwordx4 v48, s[8:11], s46 offen offset:0 lds
  buffer_load_dwordx4 v49, s[8:11], s46 offen offset:1024 lds
  buffer_load_dwordx4 v50, s[8:11], s46 offen offset:2048 lds
  buffer_load_dwordx4 v51, s[8:11], s46 offen offset:3072 lds
  v_mfma_f32_16x16x32_bf16 v[72:75], a[0:3], a[72:75], 0
  s_add_u32 m0, s36, 4096
  v_mfma_f32_16x16x32_bf16 v[76:79], a[0:3], a[76:79], 0
  v_mfma_f32_16x16x32_bf16 v[72:75], a[32:35], a[104:107], v[72:75]
  v_mfma_f32_16x16x32_bf16 v[76:79], a[32:35], a[108:111], v[76:79]
  v_mfma_f32_16x16x32_bf16 v[80:83], a[0:3], a[80:83], 0
  s_add_u32 s60, s63, 32768
  buffer_store_dwordx4 v[216:219], v2, s[16:19], s60 offen offset:3072 sc1
  v_mfma_f32_16x16x32_bf16 v[84:87], a[0:3], a[84:87], 0
  v_mfma_f32_16x16x32_bf16 v[80:83], a[32:35], a[112:115], v[80:83]
  v_mfma_f32_16x16x32_bf16 v[84:87], a[32:35], a[116:119], v[84:87]
  v_mfma_f32_16x16x32_bf16 v[88:91], a[0:3], a[88:91], 0
  s_add_u32 s60, s63, 0
  buffer_store_dwordx4 v[220:223], v2, s[16:19], s60 offen offset:3072 sc1
  v_mfma_f32_16x16x32_bf16 v[92:95], a[0:3], a[92:95], 0
  v_mfma_f32_16x16x32_bf16 v[88:91], a[32:35], a[120:123], v[88:91]
  v_mfma_f32_16x16x32_bf16 v[92:95], a[32:35], a[124:127], v[92:95]
  v_mfma_f32_16x16x32_bf16 v[96:99], a[4:7], a[64:67], 0
  s_add_u32 s60, s63, 36864
  buffer_store_dwordx4 v[224:227], v2, s[16:19], s60 offen offset:0 sc1
  v_mfma_f32_16x16x32_bf16 v[100:103], a[4:7], a[68:71], 0
  v_mfma_f32_16x16x32_bf16 v[96:99], a[36:39], a[96:99], v[96:99]
  v_mfma_f32_16x16x32_bf16 v[100:103], a[36:39], a[100:103], v[100:103]
  v_mfma_f32_16x16x32_bf16 v[104:107], a[4:7], a[72:75], 0
  s_add_u32 s60, s63, 4096
  buffer_store_dwordx4 v[228:231], v2, s[16:19], s60 offen offset:0 sc1
  v_mfma_f32_16x16x32_bf16 v[108:111], a[4:7], a[76:79], 0
  v_mfma_f32_16x16x32_bf16 v[104:107], a[36:39], a[104:107], v[104:107]
  v_mfma_f32_16x16x32_bf16 v[108:111], a[36:39], a[108:111], v[108:111]
  v_mfma_f32_16x16x32_bf16 v[112:115], a[4:7], a[80:83], 0
  v_mfma_f32_16x16x32_bf16 v[116:119], a[4:7], a[84:87], 0
  s_add_u32 s60, s63, 36864
  buffer_store_dwordx4 v[232:235], v2, s[16:19], s60 offen offset:1024 sc1
  v_mfma_f32_16x16x32_bf16 v[112:115], a[36:39], a[112:115], v[112:115]
  v_mfma_f32_16x16x32_bf16 v[116:119], a[36:39], a[116:119], v[116:119]
  v_mfma_f32_16x16x32_bf16 v[120:123], a[4:7], a[88:91], 0
  v_mfma_f32_16x16x32_bf16 v[124:127], a[4:7], a[92:95], 0
  s_add_u32 s60, s63, 4096
  buffer_store_dwordx4 v[236:239], v2, s[16:19], s60 offen offset:1024 sc1
  v_mfma_f32_16x16x32_bf16 v[120:123], a[36:39], a[120:123], v[120:123]
  buffer_load_dwordx4 v52, s[8:11], s46 offen offset:0 lds
  v_mfma_f32_16x16x32_bf16 v[124:127], a[36:39], a[124:127], v[124:127]
  v_mfma_f32_16x16x32_bf16 v[176:179], a[12:15], a[80:83], 0
  v_mfma_f32_16x16x32_bf16 v[180:183], a[12:15], a[84:87], 0
  s_add_u32 s60, s63, 36864
  buffer_store_dwordx4 v[240:243], v2, s[16:19], s60 offen offset:2048 sc1
  v_mfma_f32_16x16x32_bf16 v[176:179], a[44:47], a[112:115], v[176:179]
  v_mfma_f32_16x16x32_bf16 v[180:183], a[44:47], a[116:119], v[180:183]
  v_mfma_f32_16x16x32_bf16 v[184:187], a[12:15], a[88:91], 0
  buffer_load_dwordx4 v53, s[8:11], s46 offen offset:1024 lds
  v_mfma_f32_16x16x32_bf16 v[188:191], a[12:15], a[92:95], 0
  v_mfma_f32_16x16x32_bf16 v[192:195], a[16:19], a[64:67], 0
  s_add_u32 s60, s63, 4096
  buffer_store_dwordx4 v[244:247], v2, s[16:19], s60 offen offset:2048 sc1
  v_mfma_f32_16x16x32_bf16 v[196:199], a[16:19], a[68:71], 0
  v_mfma_f32_16x16x32_bf16 v[200:203], a[16:19], a[72:75], 0
  v_mfma_f32_16x16x32_bf16 v[204:207], a[16:19], a[76:79], 0
  buffer_load_dwordx4 v54, s[8:11], s46 offen offset:2048 lds
  v_mfma_f32_16x16x32_bf16 v[208:211], a[16:19], a[80:83], 0
  s_add_u32 s60, s63, 36864
  buffer_store_dwordx4 v[248:251], v2, s[16:19], s60 offen offset:3072 sc1
  v_mfma_f32_16x16x32_bf16 v[212:215], a[16:19], a[84:87], 0
  v_mfma_f32_16x16x32_bf16 v[216:219], a[16:19], a[88:91], 0
  v_mfma_f32_16x16x32_bf16 v[220:223], a[16:19], a[92:95], 0
  v_mfma_f32_16x16x32_bf16 v[224:227], a[20:23], a[64:67], 0
  s_add_u32 s60, s63, 4096
  buffer_store_dwordx4 v[252:255], v2, s[16:19], s60 offen offset:3072 sc1
  v_mfma_f32_16x16x32_bf16 v[228:231], a[20:23], a[68:71], 0
  buffer_load_dwordx4 v55, s[8:11], s46 offen offset:3072 lds
  v_mfma_f32_16x16x32_bf16 v[232:235], a[20:23], a[72:75], 0
  s_sub_u32 s50, s50, 1
  s_cmp_eq_u32 s50, 0
  s_cselect_b32 s12, s72, s12
  s_cselect_b32 s13, s73, s13
  v_mfma_f32_16x16x32_bf16 v[236:239], a[20:23], a[76:79], 0
  s_lshl_b32 s47, s48, 19
  s_bfe_u32 s34, 0x3020106, s49
  s_add_u32 s48, s48, s34
  v_mfma_f32_16x16x32_bf16 v[240:243], a[20:23], a[80:83], 0
  s_add_u32 s49, s49, 8
  s_and_b32 s49, s49, 0x8001f
  s_and_b32 s48, s48, 7
  v_mfma_f32_16x16x32_bf16 v[244:247], a[20:23], a[84:87], 0
  s_lshl_b32 s46, s48, 7
  v_mfma_f32_16x16x32_bf16 v[248:251], a[20:23], a[88:91], 0
  v_mfma_f32_16x16x32_bf16 v[252:255], a[20:23], a[92:95], 0
  v_mfma_f32_16x16x32_bf16 v[184:187], a[44:47], a[120:123], v[184:187]
  ds_read_b128 a[0:3], v16 offset:0
  ds_read_b64_tr_b16 a[64:65], v18 offset:0
  v_mfma_f32_16x16x32_bf16 v[188:191], a[44:47], a[124:127], v[188:191]
  ds_read_b64_tr_b16 a[66:67], v18 offset:2048
  ds_read_b128 a[4:7], v16 offset:2048
  v_mfma_f32_16x16x32_bf16 v[192:195], a[48:51], a[96:99], v[192:195]
  ds_read_b128 a[8:11], v16 offset:4096
  ds_read_b128 a[12:15], v16 offset:6144
  v_mfma_f32_16x16x32_bf16 v[196:199], a[48:51], a[100:103], v[196:199]
  ds_read_b128 a[16:19], v16 offset:8192
  ds_read_b128 a[20:23], v16 offset:10240
  v_mfma_f32_16x16x32_bf16 v[200:203], a[48:51], a[104:107], v[200:203]
  ds_read_b128 a[24:27], v16 offset:12288
  ds_read_b128 a[28:31], v16 offset:14336
  v_mfma_f32_16x16x32_bf16 v[204:207], a[48:51], a[108:111], v[204:207]
  ds_read_b64_tr_b16 a[68:69], v19 offset:0
  ds_read_b64_tr_b16 a[70:71], v19 offset:2048
  v_mfma_f32_16x16x32_bf16 v[208:211], a[48:51], a[112:115], v[208:211]
  ds_read_b64_tr_b16 a[72:73], v20 offset:0
  ds_read_b64_tr_b16 a[74:75], v20 offset:2048
  v_mfma_f32_16x16x32_bf16 v[212:215], a[48:51], a[116:119], v[212:215]
  ds_read_b64_tr_b16 a[76:77], v21 offset:0
  ds_read_b64_tr_b16 a[78:79], v21 offset:2048
  v_mfma_f32_16x16x32_bf16 v[216:219], a[48:51], a[120:123], v[216:219]
  ds_read_b64_tr_b16 a[80:81], v18 offset:8192
  ds_read_b64_tr_b16 a[82:83], v18 offset:10240
  v_mfma_f32_16x16x32_bf16 v[220:223], a[48:51], a[124:127], v[220:223]
  ds_read_b64_tr_b16 a[84:85], v19 offset:8192
  ds_read_b64_tr_b16 a[86:87], v19 offset:10240
  v_mfma_f32_16x16x32_bf16 v[224:227], a[52:55], a[96:99], v[224:227]
  ds_read_b64_tr_b16 a[88:89], v20 offset:8192
  ds_read_b64_tr_b16 a[90:91], v20 offset:10240
  v_mfma_f32_16x16x32_bf16 v[228:231], a[52:55], a[100:103], v[228:231]
  ds_read_b64_tr_b16 a[92:93], v21 offset:8192
  ds_read_b64_tr_b16 a[94:95], v21 offset:10240
  v_mfma_f32_16x16x32_bf16 v[232:235], a[52:55], a[104:107], v[232:235]
  v_mfma_f32_16x16x32_bf16 v[236:239], a[52:55], a[108:111], v[236:239]
  v_mfma_f32_16x16x32_bf16 v[240:243], a[52:55], a[112:115], v[240:243]
  v_mfma_f32_16x16x32_bf16 v[244:247], a[52:55], a[116:119], v[244:247]
  v_mfma_f32_16x16x32_bf16 v[248:251], a[52:55], a[120:123], v[248:251]
  v_mfma_f32_16x16x32_bf16 v[252:255], a[52:55], a[124:127], v[252:255]
  s_add_u32 s63, s63, 0x4000
  s_waitcnt lgkmcnt(0)
  v_mfma_f32_16x16x32_bf16 v[64:67], a[0:3], a[64:67], v[64:67]
  s_add_u32 s36, s36, s38
  ds_read_b128 a[32:35], v17 offset:0
  v_mfma_f32_16x16x32_bf16 v[96:99], a[4:7], a[64:67], v[96:99]
  s_add_u32 s37, s37, 1
  v_mfma_f32_16x16x32_bf16 v[128:131], a[8:11], a[64:67], v[128:131]
  ds_read_b64_tr_b16 a[96:97], v18 offset:4096
  v_mfma_f32_16x16x32_bf16 v[160:163], a[12:15], a[64:67], v[160:163]
  s_cmp_eq_u32 s37, 3
  s_cselect_b32 s37, 0, s37
  s_cselect_b32 s38, s39, s40
  v_mfma_f32_16x16x32_bf16 v[192:195], a[16:19], a[64:67], v[192:195]
  s_add_u32 s41, s41, s43
  ds_read_b64_tr_b16 a[98:99], v18 offset:6144
  v_mfma_f32_16x16x32_bf16 v[224:227], a[20:23], a[64:67], v[224:227]
  s_sub_u32 s43, 0, s43
  v_mfma_f32_16x16x32_bf16 a[128:131], a[24:27], a[64:67], a[128:131]
  ds_read_b128 a[36:39], v17 offset:2048
  v_mfma_f32_16x16x32_bf16 a[160:163], a[28:31], a[64:67], a[160:163]
  v_mfma_f32_16x16x32_bf16 v[68:71], a[0:3], a[68:71], v[68:71]
  v_mfma_f32_16x16x32_bf16 v[100:103], a[4:7], a[68:71], v[100:103]
  ds_read_b128 a[40:43], v17 offset:4096
  v_mfma_f32_16x16x32_bf16 v[132:135], a[8:11], a[68:71], v[132:135]
  v_mfma_f32_16x16x32_bf16 v[164:167], a[12:15], a[68:71], v[164:167]
  ds_read_b128 a[44:47], v17 offset:6144
  v_mfma_f32_16x16x32_bf16 v[196:199], a[16:19], a[68:71], v[196:199]
  v_mfma_f32_16x16x32_bf16 v[228:231], a[20:23], a[68:71], v[228:231]
  ds_read_b128 a[48:51], v17 offset:8192
  v_mfma_f32_16x16x32_bf16 a[132:135], a[24:27], a[68:71], a[132:135]
  v_mfma_f32_16x16x32_bf16 a[164:167], a[28:31], a[68:71], a[164:167]
  ds_read_b128 a[52:55], v17 offset:10240
  v_mfma_f32_16x16x32_bf16 v[72:75], a[0:3], a[72:75], v[72:75]
  v_mfma_f32_16x16x32_bf16 v[104:107], a[4:7], a[72:75], v[104:107]
  v_mfma_f32_16x16x32_bf16 v[136:139], a[8:11], a[72:75], v[136:139]
  ds_read_b128 a[56:59], v17 offset:12288
  v_mfma_f32_16x16x32_bf16 v[168:171], a[12:15], a[72:75], v[168:171]
  v_mfma_f32_16x16x32_bf16 v[200:203], a[16:19], a[72:75], v[200:203]
  ds_read_b128 a[60:63], v17 offset:14336
  v_mfma_f32_16x16x32_bf16 v[232:235], a[20:23], a[72:75], v[232:235]
  v_mfma_f32_16x16x32_bf16 a[136:139], a[24:27], a[72:75], a[136:139]
  ds_read_b64_tr_b16 a[100:101], v19 offset:4096
  v_mfma_f32_16x16x32_bf16 a[168:171], a[28:31], a[72:75], a[168:171]
  v_mfma_f32_16x16x32_bf16 v[76:79], a[0:3], a[76:79], v[76:79]
  ds_read_b64_tr_b16 a[102:103], v19 offset:6144
  v_mfma_f32_16x16x32_bf16 v[108:111], a[4:7], a[76:79], v[108:111]
  v_mfma_f32_16x16x32_bf16 v[140:143], a[8:11], a[76:79], v[140:143]
  v_mfma_f32_16x16x32_bf16 v[172:175], a[12:15], a[76:79], v[172:175]
  ds_read_b64_tr_b16 a[104:105], v20 offset:4096
  v_mfma_f32_16x16x32_bf16 v[204:207], a[16:19], a[76:79], v[204:207]
  v_mfma_f32_16x16x32_bf16 v[236:239], a[20:23], a[76:79], v[236:239]
  ds_read_b64_tr_b16 a[106:107], v20 offset:6144
  v_mfma_f32_16x16x32_bf16 a[140:143], a[24:27], a[76:79], a[140:143]
  v_mfma_f32_16x16x32_bf16 a[172:175], a[28:31], a[76:79], a[172:175]
  ds_read_b64_tr_b16 a[108:109], v21 offset:4096
  v_mfma_f32_16x16x32_bf16 v[80:83], a[0:3], a[80:83], v[80:83]
  v_mfma_f32_16x16x32_bf16 v[112:115], a[4:7], a[80:83], v[112:115]
  ds_read_b64_tr_b16 a[110:111], v21 offset:6144
  v_mfma_f32_16x16x32_bf16 v[144:147], a[8:11], a[80:83], v[144:147]
  v_mfma_f32_16x16x32_bf16 v[176:179], a[12:15], a[80:83], v[176:179]
  v_mfma_f32_16x16x32_bf16 v[208:211], a[16:19], a[80:83], v[208:211]
  ds_read_b64_tr_b16 a[112:113], v18 offset:12288
  v_mfma_f32_16x16x32_bf16 v[240:243], a[20:23], a[80:83], v[240:243]
  v_mfma_f32_16x16x32_bf16 a[144:147], a[24:27], a[80:83], a[144:147]
  ds_read_b64_tr_b16 a[114:115], v18 offset:14336
  v_mfma_f32_16x16x32_bf16 a[176:179], a[28:31], a[80:83], a[176:179]
  v_mfma_f32_16x16x32_bf16 v[84:87], a[0:3], a[84:87], v[84:87]
  ds_read_b64_tr_b16 a[116:117], v19 offset:12288
  v_mfma_f32_16x16x32_bf16 v[116:119], a[4:7], a[84:87], v[116:119]
  v_mfma_f32_16x16x32_bf16 v[148:151], a[8:11], a[84:87], v[148:151]
  ds_read_b64_tr_b16 a[118:119], v19 offset:14336
  v_mfma_f32_16x16x32_bf16 v[180:183], a[12:15], a[84:87], v[180:183]
  v_mfma_f32_16x16x32_bf16 v[212:215], a[16:19], a[84:87], v[212:215]
  v_mfma_f32_16x16x32_bf16 v[244:247], a[20:23], a[84:87], v[244:247]
  ds_read_b64_tr_b16 a[120:121], v20 offset:12288
  v_mfma_f32_16x16x32_bf16 a[148:151], a[24:27], a[84:87], a[148:151]
  v_mfma_f32_16x16x32_bf16 a[180:183], a[28:31], a[84:87], a[180:183]
  ds_read_b64_tr_b16 a[122:123], v20 offset:14336
  v_mfma_f32_16x16x32_bf16 v[88:91], a[0:3], a[88:91], v[88:91]
  v_mfma_f32_16x16x32_bf16 v[120:123], a[4:7], a[88:91], v[120:123]
  ds_read_b64_tr_b16 a[124:125], v21 offset:12288
  v_mfma_f32_16x16x32_bf16 v[152:155], a[8:11], a[88:91], v[152:155]
  v_mfma_f32_16x16x32_bf16 v[184:187], a[12:15], a[88:91], v[184:187]
  ds_read_b64_tr_b16 a[126:127], v21 offset:14336
  v_mfma_f32_16x16x32_bf16 v[216:219], a[16:19], a[88:91], v[216:219]
  v_add_u32 v16, s38, v16
  v_add_u32 v17, s38, v17
  v_mfma_f32_16x16x32_bf16 v[248:251], a[20:23], a[88:91], v[248:251]
  v_add_u32 v18, s43, v18
  v_add_u32 v19, s43, v19
  v_mfma_f32_16x16x32_bf16 a[152:155], a[24:27], a[88:91], a[152:155]
  v_add_u32 v20, s43, v20
  v_add_u32 v21, s43, v21
  v_mfma_f32_16x16x32_bf16 a[184:187], a[28:31], a[88:91], a[184:187]
  v_mfma_f32_16x16x32_bf16 v[92:95], a[0:3], a[92:95], v[92:95]
  v_mfma_f32_16x16x32_bf16 v[124:127], a[4:7], a[92:95], v[124:127]
  v_mfma_f32_16x16x32_bf16 v[156:159], a[8:11], a[92:95], v[156:159]
  v_mfma_f32_16x16x32_bf16 v[188:191], a[12:15], a[92:95], v[188:191]
  v_mfma_f32_16x16x32_bf16 v[220:223], a[16:19], a[92:95], v[220:223]
  v_mfma_f32_16x16x32_bf16 v[252:255], a[20:23], a[92:95], v[252:255]
  v_mfma_f32_16x16x32_bf16 a[156:159], a[24:27], a[92:95], a[156:159]
  v_mfma_f32_16x16x32_bf16 a[188:191], a[28:31], a[92:95], a[188:191]
  s_mov_b32 s35, 4
  s_waitcnt vmcnt(8) lgkmcnt(0)
  s_barrier
  .p2align 6
Lp1xw_loop:
  v_mfma_f32_16x16x32_bf16 v[64:67], a[32:35], a[96:99], v[64:67]
  s_mov_b32 m0, s41
  ds_read_b128 a[0:3], v16 offset:0
  v_mfma_f32_16x16x32_bf16 v[96:99], a[36:39], a[96:99], v[96:99]
  buffer_load_dwordx4 v56, s[12:15], s47 offen offset:0 lds
  v_mfma_f32_16x16x32_bf16 v[128:131], a[40:43], a[96:99], v[128:131]
  ds_read_b64_tr_b16 a[64:65], v18 offset:0
  v_mfma_f32_16x16x32_bf16 v[160:163], a[44:47], a[96:99], v[160:163]
  v_mfma_f32_16x16x32_bf16 v[192:195], a[48:51], a[96:99], v[192:195]
  ds_read_b64_tr_b16 a[66:67], v18 offset:2048
  v_mfma_f32_16x16x32_bf16 v[224:227], a[52:55], a[96:99], v[224:227]
  v_mfma_f32_16x16x32_bf16 a[128:131], a[56:59], a[96:99], a[128:131]
  ds_read_b128 a[4:7], v16 offset:2048
  v_mfma_f32_16x16x32_bf16 a[160:163], a[60:63], a[96:99], a[160:163]
  buffer_load_dwordx4 v57, s[12:15], s47 offen offset:1024 lds
  v_mfma_f32_16x16x32_bf16 v[68:71], a[32:35], a[100:103], v[68:71]
  v_mfma_f32_16x16x32_bf16 v[100:103], a[36:39], a[100:103], v[100:103]
  ds_read_b128 a[8:11], v16 offset:4096
  v_mfma_f32_16x16x32_bf16 v[132:135], a[40:43], a[100:103], v[132:135]
  v_mfma_f32_16x16x32_bf16 v[164:167], a[44:47], a[100:103], v[164:167]
  ds_read_b128 a[12:15], v16 offset:6144
  v_mfma_f32_16x16x32_bf16 v[196:199], a[48:51], a[100:103], v[196:199]
  v_mfma_f32_16x16x32_bf16 v[228:231], a[52:55], a[100:103], v[228:231]
  ds_read_b128 a[16:19], v16 offset:8192
  v_mfma_f32_16x16x32_bf16 a[132:135], a[56:59], a[100:103], a[132:135]
  v_mfma_f32_16x16x32_bf16 a[164:167], a[60:63], a[100:103], a[164:167]
  buffer_load_dwordx4 v58, s[12:15], s47 offen offset:2048 lds
  v_mfma_f32_16x16x32_bf16 v[72:75], a[32:35], a[104:107], v[72:75]
  ds_read_b128 a[20:23], v16 offset:10240
  v_mfma_f32_16x16x32_bf16 v[104:107], a[36:39], a[104:107], v[104:107]
  v_mfma_f32_16x16x32_bf16 v[136:139], a[40:43], a[104:107], v[136:139]
  ds_read_b128 a[24:27], v16 offset:12288
  v_mfma_f32_16x16x32_bf16 v[168:171], a[44:47], a[104:107], v[168:171]
  v_mfma_f32_16x16x32_bf16 v[200:203], a[48:51], a[104:107], v[200:203]
  ds_read_b128 a[28:31], v16 offset:14336
  v_mfma_f32_16x16x32_bf16 v[232:235], a[52:55], a[104:107], v[232:235]
  v_mfma_f32_16x16x32_bf16 a[136:139], a[56:59], a[104:107], a[136:139]
  ds_read_b64_tr_b16 a[68:69], v19 offset:0
  v_mfma_f32_16x16x32_bf16 a[168:171], a[60:63], a[104:107], a[168:171]
  buffer_load_dwordx4 v59, s[12:15], s47 offen offset:3072 lds
  v_mfma_f32_16x16x32_bf16 v[76:79], a[32:35], a[108:111], v[76:79]
  s_add_u32 m0, s41, 4096
  ds_read_b64_tr_b16 a[70:71], v19 offset:2048
  v_mfma_f32_16x16x32_bf16 v[108:111], a[36:39], a[108:111], v[108:111]
  v_mfma_f32_16x16x32_bf16 v[140:143], a[40:43], a[108:111], v[140:143]
  v_mfma_f32_16x16x32_bf16 v[172:175], a[44:47], a[108:111], v[172:175]
  ds_read_b64_tr_b16 a[72:73], v20 offset:0
  v_mfma_f32_16x16x32_bf16 v[204:207], a[48:51], a[108:111], v[204:207]
  v_mfma_f32_16x16x32_bf16 v[236:239], a[52:55], a[108:111], v[236:239]
  ds_read_b64_tr_b16 a[74:75], v20 offset:2048
  v_mfma_f32_16x16x32_bf16 a[140:143], a[56:59], a[108:111], a[140:143]
  v_mfma_f32_16x16x32_bf16 a[172:175], a[60:63], a[108:111], a[172:175]
  buffer_load_dwordx4 v60, s[12:15], s47 offen offset:0 lds
  v_mfma_f32_16x16x32_bf16 v[80:83], a[32:35], a[112:115], v[80:83]
  ds_read_b64_tr_b16 a[76:77], v21 offset:0
  v_mfma_f32_16x16x32_bf16 v[112:115], a[36:39], a[112:115], v[112:115]
  ds_read_b64_tr_b16 a[78:79], v21 offset:2048
  v_mfma_f32_16x16x32_bf16 v[144:147], a[40:43], a[112:115], v[144:147]
  v_mfma_f32_16x16x32_bf16 v[176:179], a[44:47], a[112:115], v[176:179]
  v_mfma_f32_16x16x32_bf16 v[208:211], a[48:51], a[112:115], v[208:211]
  ds_read_b64_tr_b16 a[80:81], v18 offset:8192
  v_mfma_f32_16x16x32_bf16 v[240:243], a[52:55], a[112:115], v[240:243]
  v_mfma_f32_16x16x32_bf16 a[144:147], a[56:59], a[112:115], a[144:147]
  ds_read_b64_tr_b16 a[82:83], v18 offset:10240
  v_mfma_f32_16x16x32_bf16 a[176:179], a[60:63], a[112:115], a[176:179]
  buffer_load_dwordx4 v61, s[12:15], s47 offen offset:1024 lds
  v_mfma_f32_16x16x32_bf16 v[84:87], a[32:35], a[116:119], v[84:87]
  ds_read_b64_tr_b16 a[84:85], v19 offset:8192
  v_mfma_f32_16x16x32_bf16 v[116:119], a[36:39], a[116:119], v[116:119]
  v_mfma_f32_16x16x32_bf16 v[148:151], a[40:43], a[116:119], v[148:151]
  ds_read_b64_tr_b16 a[86:87], v19 offset:10240
  v_mfma_f32_16x16x32_bf16 v[180:183], a[44:47], a[116:119], v[180:183]
  v_mfma_f32_16x16x32_bf16 v[212:215], a[48:51], a[116:119], v[212:215]
  v_mfma_f32_16x16x32_bf16 v[244:247], a[52:55], a[116:119], v[244:247]
  ds_read_b64_tr_b16 a[88:89], v20 offset:8192
  v_mfma_f32_16x16x32_bf16 a[148:151], a[56:59], a[116:119], a[148:151]
  v_mfma_f32_16x16x32_bf16 a[180:183], a[60:63], a[116:119], a[180:183]
  buffer_load_dwordx4 v62, s[12:15], s47 offen offset:2048 lds
  v_mfma_f32_16x16x32_bf16 v[88:91], a[32:35], a[120:123], v[88:91]
  ds_read_b64_tr_b16 a[90:91], v20 offset:10240
  v_mfma_f32_16x16x32_bf16 v[120:123], a[36:39], a[120:123], v[120:123]
  ds_read_b64_tr_b16 a[92:93], v21 offset:8192
  v_mfma_f32_16x16x32_bf16 v[152:155], a[40:43], a[120:123], v[152:155]
  v_mfma_f32_16x16x32_bf16 v[184:187], a[44:47], a[120:123], v[184:187]
  ds_read_b64_tr_b16 a[94:95], v21 offset:10240
  v_mfma_f32_16x16x32_bf16 v[216:219], a[48:51], a[120:123], v[216:219]
  v_mfma_f32_16x16x32_bf16 v[248:251], a[52:55], a[120:123], v[248:251]
  v_mfma_f32_16x16x32_bf16 a[152:155], a[56:59], a[120:123], a[152:155]
  v_mfma_f32_16x16x32_bf16 a[184:187], a[60:63], a[120:123], a[184:187]
  buffer_load_dwordx4 v63, s[12:15], s47 offen offset:3072 lds
  v_mfma_f32_16x16x32_bf16 v[92:95], a[32:35], a[124:127], v[92:95]
  v_mfma_f32_16x16x32_bf16 v[124:127], a[36:39], a[124:127], v[124:127]
  v_mfma_f32_16x16x32_bf16 v[156:159], a[40:43], a[124:127], v[156:159]
  v_mfma_f32_16x16x32_bf16 v[188:191], a[44:47], a[124:127], v[188:191]
  v_mfma_f32_16x16x32_bf16 v[220:223], a[48:51], a[124:127], v[220:223]
  v_mfma_f32_16x16x32_bf16 v[252:255], a[52:55], a[124:127], v[252:255]
  v_mfma_f32_16x16x32_bf16 a[156:159], a[56:59], a[124:127], a[156:159]
  v_mfma_f32_16x16x32_bf16 a[188:191], a[60:63], a[124:127], a[188:191]
  s_waitcnt lgkmcnt(0)
  v_mfma_f32_16x16x32_bf16 v[64:67], a[0:3], a[64:67], v[64:67]
  s_mov_b32 m0, s36
  ds_read_b128 a[32:35], v17 offset:0
  v_mfma_f32_16x16x32_bf16 v[96:99], a[4:7], a[64:67], v[96:99]
  buffer_load_dwordx4 v48, s[8:11], s46 offen offset:0 lds
  v_mfma_f32_16x16x32_bf16 v[128:131], a[8:11], a[64:67], v[128:131]
  ds_read_b64_tr_b16 a[96:97], v18 offset:4096
  v_mfma_f32_16x16x32_bf16 v[160:163], a[12:15], a[64:67], v[160:163]
  v_mfma_f32_16x16x32_bf16 v[192:195], a[16:19], a[64:67], v[192:195]
  ds_read_b64_tr_b16 a[98:99], v18 offset:6144
  v_mfma_f32_16x16x32_bf16 v[224:227], a[20:23], a[64:67], v[224:227]
  v_mfma_f32_16x16x32_bf16 a[128:131], a[24:27], a[64:67], a[128:131]
  ds_read_b128 a[36:39], v17 offset:2048
  v_mfma_f32_16x16x32_bf16 a[160:163], a[28:31], a[64:67], a[160:163]
  buffer_load_dwordx4 v49, s[8:11], s46 offen offset:1024 lds
  v_mfma_f32_16x16x32_bf16 v[68:71], a[0:3], a[68:71], v[68:71]
  v_mfma_f32_16x16x32_bf16 v[100:103], a[4:7], a[68:71], v[100:103]
  ds_read_b128 a[40:43], v17 offset:4096
  v_mfma_f32_16x16x32_bf16 v[132:135], a[8:11], a[68:71], v[132:135]
  v_mfma_f32_16x16x32_bf16 v[164:167], a[12:15], a[68:71], v[164:167]
  ds_read_b128 a[44:47], v17 offset:6144
  v_mfma_f32_16x16x32_bf16 v[196:199], a[16:19], a[68:71], v[196:199]
  v_mfma_f32_16x16x32_bf16 v[228:231], a[20:23], a[68:71], v[228:231]
  ds_read_b128 a[48:51], v17 offset:8192
  v_mfma_f32_16x16x32_bf16 a[132:135], a[24:27], a[68:71], a[132:135]
  buffer_load_dwordx4 v50, s[8:11], s46 offen offset:2048 lds
  v_mfma_f32_16x16x32_bf16 a[164:167], a[28:31], a[68:71], a[164:167]
  ds_read_b128 a[52:55], v17 offset:10240
  v_mfma_f32_16x16x32_bf16 v[72:75], a[0:3], a[72:75], v[72:75]
  v_mfma_f32_16x16x32_bf16 v[104:107], a[4:7], a[72:75], v[104:107]
  v_mfma_f32_16x16x32_bf16 v[136:139], a[8:11], a[72:75], v[136:139]
  ds_read_b128 a[56:59], v17 offset:12288
  v_mfma_f32_16x16x32_bf16 v[168:171], a[12:15], a[72:75], v[168:171]
  v_mfma_f32_16x16x32_bf16 v[200:203], a[16:19], a[72:75], v[200:203]
  ds_read_b128 a[60:63], v17 offset:14336
  v_mfma_f32_16x16x32_bf16 v[232:235], a[20:23], a[72:75], v[232:235]
  buffer_load_dwordx4 v51, s[8:11], s46 offen offset:3072 lds
  v_mfma_f32_16x16x32_bf16 a[136:139], a[24:27], a[72:75], a[136:139]
  s_add_u32 m0, s36, 4096
  ds_read_b64_tr_b16 a[100:101], v19 offset:4096
  v_mfma_f32_16x16x32_bf16 a[168:171], a[28:31], a[72:75], a[168:171]
  s_add_u32 s36, s36, s38
  v_mfma_f32_16x16x32_bf16 v[76:79], a[0:3], a[76:79], v[76:79]
  s_add_u32 s37, s37, 1
  ds_read_b64_tr_b16 a[102:103], v19 offset:6144
  v_mfma_f32_16x16x32_bf16 v[108:111], a[4:7], a[76:79], v[108:111]
  s_cmp_eq_u32 s37, 3
  s_cselect_b32 s37, 0, s37
  s_cselect_b32 s38, s39, s40
  v_mfma_f32_16x16x32_bf16 v[140:143], a[8:11], a[76:79], v[140:143]
  s_add_u32 s41, s41, s43
  v_mfma_f32_16x16x32_bf16 v[172:175], a[12:15], a[76:79], v[172:175]
  s_sub_u32 s43, 0, s43
  ds_read_b64_tr_b16 a[104:105], v20 offset:4096
  v_mfma_f32_16x16x32_bf16 v[204:207], a[16:19], a[76:79], v[204:207]
  buffer_load_dwordx4 v52, s[8:11], s46 offen offset:0 lds
  v_mfma_f32_16x16x32_bf16 v[236:239], a[20:23], a[76:79], v[236:239]
  ds_read_b64_tr_b16 a[106:107], v20 offset:6144
  v_mfma_f32_16x16x32_bf16 a[140:143], a[24:27], a[76:79], a[140:143]
  v_mfma_f32_16x16x32_bf16 a[172:175], a[28:31], a[76:79], a[172:175]
  ds_read_b64_tr_b16 a[108:109], v21 offset:4096
  v_mfma_f32_16x16x32_bf16 v[80:83], a[0:3], a[80:83], v[80:83]
  v_mfma_f32_16x16x32_bf16 v[112:115], a[4:7], a[80:83], v[112:115]
  ds_read_b64_tr_b16 a[110:111], v21 offset:6144
  v_mfma_f32_16x16x32_bf16 v[144:147], a[8:11], a[80:83], v[144:147]
  v_mfma_f32_16x16x32_bf16 v[176:179], a[12:15], a[80:83], v[176:179]
  buffer_load_dwordx4 v53, s[8:11], s46 offen offset:1024 lds
  v_mfma_f32_16x16x32_bf16 v[208:211], a[16:19], a[80:83], v[208:211]
  ds_read_b64_tr_b16 a[112:113], v18 offset:12288
  v_mfma_f32_16x16x32_bf16 v[240:243], a[20:23], a[80:83], v[240:243]
  v_mfma_f32_16x16x32_bf16 a[144:147], a[24:27], a[80:83], a[144:147]
  ds_read_b64_tr_b16 a[114:115], v18 offset:14336
  v_mfma_f32_16x16x32_bf16 a[176:179], a[28:31], a[80:83], a[176:179]
  v_mfma_f32_16x16x32_bf16 v[84:87], a[0:3], a[84:87], v[84:87]
  ds_read_b64_tr_b16 a[116:117], v19 offset:12288
  v_mfma_f32_16x16x32_bf16 v[116:119], a[4:7], a[84:87], v[116:119]
  v_mfma_f32_16x16x32_bf16 v[148:151], a[8:11], a[84:87], v[148:151]
  buffer_load_dwordx4 v54, s[8:11], s46 offen offset:2048 lds
  v_mfma_f32_16x16x32_bf16 v[180:183], a[12:15], a[84:87], v[180:183]
  ds_read_b64_tr_b16 a[118:119], v19 offset:14336
  v_mfma_f32_16x16x32_bf16 v[212:215], a[16:19], a[84:87], v[212:215]
  v_mfma_f32_16x16x32_bf16 v[244:247], a[20:23], a[84:87], v[244:247]
  ds_read_b64_tr_b16 a[120:121], v20 offset:12288
  v_mfma_f32_16x16x32_bf16 a[148:151], a[24:27], a[84:87], a[148:151]
  v_mfma_f32_16x16x32_bf16 a[180:183], a[28:31], a[84:87], a[180:183]
  ds_read_b64_tr_b16 a[122:123], v20 offset:14336
  v_mfma_f32_16x16x32_bf16 v[88:91], a[0:3], a[88:91], v[88:91]
  v_mfma_f32_16x16x32_bf16 v[120:123], a[4:7], a[88:91], v[120:123]
  buffer_load_dwordx4 v55, s[8:11], s46 offen offset:3072 lds
  v_mfma_f32_16x16x32_bf16 v[152:155], a[8:11], a[88:91], v[152:155]
  s_sub_u32 s50, s50, 1
  ds_read_b64_tr_b16 a[124:125], v21 offset:12288
  v_mfma_f32_16x16x32_bf16 v[184:187], a[12:15], a[88:91], v[184:187]
  ds_read_b64_tr_b16 a[126:127], v21 offset:14336
  v_mfma_f32_16x16x32_bf16 v[216:219], a[16:19], a[88:91], v[216:219]
  s_cmp_eq_u32 s50, 0
  s_cselect_b32 s12, s72, s12
  s_cselect_b32 s13, s73, s13
  v_mfma_f32_16x16x32_bf16 v[248:251], a[20:23], a[88:91], v[248:251]
  s_lshl_b32 s47, s48, 19
  v_add_u32 v16, s38, v16
  v_add_u32 v17, s38, v17
  v_mfma_f32_16x16x32_bf16 a[152:155], a[24:27], a[88:91], a[152:155]
  s_bfe_u32 s34, 0x3020106, s49
  v_add_u32 v18, s43, v18
  v_add_u32 v19, s43, v19
  v_mfma_f32_16x16x32_bf16 a[184:187], a[28:31], a[88:91], a[184:187]
  s_add_u32 s48, s48, s34
  v_add_u32 v20, s43, v20
  v_add_u32 v21, s43, v21
  v_mfma_f32_16x16x32_bf16 v[92:95], a[0:3], a[92:95], v[92:95]
  s_add_u32 s49, s49, 8
  v_mfma_f32_16x16x32_bf16 v[124:127], a[4:7], a[92:95], v[124:127]
  s_and_b32 s49, s49, 0x8001f
  v_mfma_f32_16x16x32_bf16 v[156:159], a[8:11], a[92:95], v[156:159]
  s_and_b32 s48, s48, 7
  v_mfma_f32_16x16x32_bf16 v[188:191], a[12:15], a[92:95], v[188:191]
  s_lshl_b32 s46, s48, 7
  v_mfma_f32_16x16x32_bf16 v[220:223], a[16:19], a[92:95], v[220:223]
  v_mfma_f32_16x16x32_bf16 v[252:255], a[20:23], a[92:95], v[252:255]
  s_waitcnt vmcnt(8) lgkmcnt(0)
  s_barrier
  v_mfma_f32_16x16x32_bf16 a[156:159], a[24:27], a[92:95], a[156:159]
  s_sub_u32 s35, s35, 1
  v_mfma_f32_16x16x32_bf16 a[188:191], a[28:31], a[92:95], a[188:191]
  s_cmp_lg_u32 s35, 0
  s_cbranch_scc1 Lp1xw_loop
  v_accvgpr_read_b32 v4, a222
  v_accvgpr_read_b32 v5, a223
  v_accvgpr_read_b32 v6, a224
  v_accvgpr_read_b32 v7, a225
  v_accvgpr_read_b32 v8, a226
  v_accvgpr_read_b32 v9, a227
  v_accvgpr_read_b32 v10, a228
  v_accvgpr_read_b32 v11, a229
  s_mov_b32 s8, s64
  s_mov_b32 s9, s65
  s_mov_b32 s10, 4194304
  s_mov_b32 s11, 0x00020000
  s_mov_b32 s20, s68
  s_mov_b32 s21, s69
  s_mov_b32 s22, 8388608
  s_mov_b32 s23, 0x00020000
  s_and_b32 s4, s2, 7
  s_lshl_b32 s4, s4, 1
  s_lshr_b32 s5, s2, 6
  s_lshr_b32 s30, s2, 4
  s_add_u32 s5, s5, s30
  s_and_b32 s53, s5, 3
  s_lshl_b32 s53, s53, 3
  s_or_b32 s53, s53, 0x80000
  s_bfe_u32 s52, 0xf0f02, s53
  s_add_u32 s52, s52, s4
  s_and_b32 s52, s52, 15
  s_mov_b32 s54, s52
  s_mov_b32 s55, s53
  s_lshl_b32 s29, s52, 7
  s_lshl_b32 s28, s54, 19
  s_lshl_b32 s30, s25, 18
  s_and_b32 s31, s25, 1
  s_lshl_b32 s31, s31, 1
  s_add_u32 s31, s31, 14
  s_sub_u32 s31, s31, s25
  s_lshl_b32 s31, s31, 18
  s_or_b32 s26, s30, s29
  s_or_b32 s27, s31, s29
  s_lshl_b32 s68, s3, 12
  s_lshl_b32 s88, s3, 13
  s_add_u32 s88, s88, 98304
  v_mfma_f32_16x16x32_bf16 v[64:67], a[32:35], a[96:99], v[64:67]
  s_mov_b32 m0, s41
  ds_read_b128 a[0:3], v16 offset:0
  v_mfma_f32_16x16x32_bf16 v[96:99], a[36:39], a[96:99], v[96:99]
  buffer_load_dwordx4 v56, s[12:15], s47 offen offset:0 lds
  v_mfma_f32_16x16x32_bf16 v[128:131], a[40:43], a[96:99], v[128:131]
  ds_read_b64_tr_b16 a[64:65], v18 offset:0
  v_mfma_f32_16x16x32_bf16 v[160:163], a[44:47], a[96:99], v[160:163]
  v_mfma_f32_16x16x32_bf16 v[192:195], a[48:51], a[96:99], v[192:195]
  ds_read_b64_tr_b16 a[66:67], v18 offset:2048
  v_mfma_f32_16x16x32_bf16 v[224:227], a[52:55], a[96:99], v[224:227]
  v_mfma_f32_16x16x32_bf16 a[128:131], a[56:59], a[96:99], a[128:131]
  ds_read_b128 a[4:7], v16 offset:2048
  v_mfma_f32_16x16x32_bf16 a[160:163], a[60:63], a[96:99], a[160:163]
  buffer_load_dwordx4 v57, s[12:15], s47 offen offset:1024 lds
  v_mfma_f32_16x16x32_bf16 v[68:71], a[32:35], a[100:103], v[68:71]
  v_mfma_f32_16x16x32_bf16 v[100:103], a[36:39], a[100:103], v[100:103]
  ds_read_b128 a[8:11], v16 offset:4096
  v_mfma_f32_16x16x32_bf16 v[132:135], a[40:43], a[100:103], v[132:135]
  v_mfma_f32_16x16x32_bf16 v[164:167], a[44:47], a[100:103], v[164:167]
  ds_read_b128 a[12:15], v16 offset:6144
  v_mfma_f32_16x16x32_bf16 v[196:199], a[48:51], a[100:103], v[196:199]
  v_mfma_f32_16x16x32_bf16 v[228:231], a[52:55], a[100:103], v[228:231]
  ds_read_b128 a[16:19], v16 offset:8192
  v_mfma_f32_16x16x32_bf16 a[132:135], a[56:59], a[100:103], a[132:135]
  v_mfma_f32_16x16x32_bf16 a[164:167], a[60:63], a[100:103], a[164:167]
  buffer_load_dwordx4 v58, s[12:15], s47 offen offset:2048 lds
  v_mfma_f32_16x16x32_bf16 v[72:75], a[32:35], a[104:107], v[72:75]
  ds_read_b128 a[20:23], v16 offset:10240
  v_mfma_f32_16x16x32_bf16 v[104:107], a[36:39], a[104:107], v[104:107]
  v_mfma_f32_16x16x32_bf16 v[136:139], a[40:43], a[104:107], v[136:139]
  ds_read_b128 a[24:27], v16 offset:12288
  v_mfma_f32_16x16x32_bf16 v[168:171], a[44:47], a[104:107], v[168:171]
  v_mfma_f32_16x16x32_bf16 v[200:203], a[48:51], a[104:107], v[200:203]
  ds_read_b128 a[28:31], v16 offset:14336
  v_mfma_f32_16x16x32_bf16 v[232:235], a[52:55], a[104:107], v[232:235]
  v_mfma_f32_16x16x32_bf16 a[136:139], a[56:59], a[104:107], a[136:139]
  ds_read_b64_tr_b16 a[68:69], v19 offset:0
  v_mfma_f32_16x16x32_bf16 a[168:171], a[60:63], a[104:107], a[168:171]
  buffer_load_dwordx4 v59, s[12:15], s47 offen offset:3072 lds
  v_mfma_f32_16x16x32_bf16 v[76:79], a[32:35], a[108:111], v[76:79]
  s_add_u32 m0, s41, 4096
  ds_read_b64_tr_b16 a[70:71], v19 offset:2048
  v_mfma_f32_16x16x32_bf16 v[108:111], a[36:39], a[108:111], v[108:111]
  v_mfma_f32_16x16x32_bf16 v[140:143], a[40:43], a[108:111], v[140:143]
  v_mfma_f32_16x16x32_bf16 v[172:175], a[44:47], a[108:111], v[172:175]
  ds_read_b64_tr_b16 a[72:73], v20 offset:0
  v_mfma_f32_16x16x32_bf16 v[204:207], a[48:51], a[108:111], v[204:207]
  v_mfma_f32_16x16x32_bf16 v[236:239], a[52:55], a[108:111], v[236:239]
  ds_read_b64_tr_b16 a[74:75], v20 offset:2048
  v_mfma_f32_16x16x32_bf16 a[140:143], a[56:59], a[108:111], a[140:143]
  v_mfma_f32_16x16x32_bf16 a[172:175], a[60:63], a[108:111], a[172:175]
  buffer_load_dwordx4 v60, s[12:15], s47 offen offset:0 lds
  v_mfma_f32_16x16x32_bf16 v[80:83], a[32:35], a[112:115], v[80:83]
  ds_read_b64_tr_b16 a[76:77], v21 offset:0
  v_mfma_f32_16x16x32_bf16 v[112:115], a[36:39], a[112:115], v[112:115]
  ds_read_b64_tr_b16 a[78:79], v21 offset:2048
  v_mfma_f32_16x16x32_bf16 v[144:147], a[40:43], a[112:115], v[144:147]
  v_mfma_f32_16x16x32_bf16 v[176:179], a[44:47], a[112:115], v[176:179]
  v_mfma_f32_16x16x32_bf16 v[208:211], a[48:51], a[112:115], v[208:211]
  ds_read_b64_tr_b16 a[80:81], v18 offset:8192
  v_mfma_f32_16x16x32_bf16 v[240:243], a[52:55], a[112:115], v[240:243]
  v_mfma_f32_16x16x32_bf16 a[144:147], a[56:59], a[112:115], a[144:147]
  ds_read_b64_tr_b16 a[82:83], v18 offset:10240
  v_mfma_f32_16x16x32_bf16 a[176:179], a[60:63], a[112:115], a[176:179]
  buffer_load_dwordx4 v61, s[12:15], s47 offen offset:1024 lds
  v_mfma_f32_16x16x32_bf16 v[84:87], a[32:35], a[116:119], v[84:87]
  ds_read_b64_tr_b16 a[84:85], v19 offset:8192
  v_mfma_f32_16x16x32_bf16 v[116:119], a[36:39], a[116:119], v[116:119]
  v_mfma_f32_16x16x32_bf16 v[148:151], a[40:43], a[116:119], v[148:151]
  ds_read_b64_tr_b16 a[86:87], v19 offset:10240
  v_mfma_f32_16x16x32_bf16 v[180:183], a[44:47], a[116:119], v[180:183]
  v_mfma_f32_16x16x32_bf16 v[212:215], a[48:51], a[116:119], v[212:215]
  v_mfma_f32_16x16x32_bf16 v[244:247], a[52:55], a[116:119], v[244:247]
  ds_read_b64_tr_b16 a[88:89], v20 offset:8192
  v_mfma_f32_16x16x32_bf16 a[148:151], a[56:59], a[116:119], a[148:151]
  v_mfma_f32_16x16x32_bf16 a[180:183], a[60:63], a[116:119], a[180:183]
  buffer_load_dwordx4 v62, s[12:15], s47 offen offset:2048 lds
  v_mfma_f32_16x16x32_bf16 v[88:91], a[32:35], a[120:123], v[88:91]
  ds_read_b64_tr_b16 a[90:91], v20 offset:10240
  v_mfma_f32_16x16x32_bf16 v[120:123], a[36:39], a[120:123], v[120:123]
  ds_read_b64_tr_b16 a[92:93], v21 offset:8192
  v_mfma_f32_16x16x32_bf16 v[152:155], a[40:43], a[120:123], v[152:155]
  v_mfma_f32_16x16x32_bf16 v[184:187], a[44:47], a[120:123], v[184:187]
  ds_read_b64_tr_b16 a[94:95], v21 offset:10240
  v_mfma_f32_16x16x32_bf16 v[216:219], a[48:51], a[120:123], v[216:219]
  v_mfma_f32_16x16x32_bf16 v[248:251], a[52:55], a[120:123], v[248:251]
  v_mfma_f32_16x16x32_bf16 a[152:155], a[56:59], a[120:123], a[152:155]
  v_mfma_f32_16x16x32_bf16 a[184:187], a[60:63], a[120:123], a[184:187]
  buffer_load_dwordx4 v63, s[12:15], s47 offen offset:3072 lds
  v_mfma_f32_16x16x32_bf16 v[92:95], a[32:35], a[124:127], v[92:95]
  v_mfma_f32_16x16x32_bf16 v[124:127], a[36:39], a[124:127], v[124:127]
  v_mfma_f32_16x16x32_bf16 v[156:159], a[40:43], a[124:127], v[156:159]
  v_mfma_f32_16x16x32_bf16 v[188:191], a[44:47], a[124:127], v[188:191]
  v_mfma_f32_16x16x32_bf16 v[220:223], a[48:51], a[124:127], v[220:223]
  v_mfma_f32_16x16x32_bf16 v[252:255], a[52:55], a[124:127], v[252:255]
  v_mfma_f32_16x16x32_bf16 a[156:159], a[56:59], a[124:127], a[156:159]
  v_mfma_f32_16x16x32_bf16 a[188:191], a[60:63], a[124:127], a[188:191]
  s_waitcnt lgkmcnt(0)
  v_mfma_f32_16x16x32_bf16 v[64:67], a[0:3], a[64:67], v[64:67]
  s_mov_b32 m0, s68
  ds_read_b128 a[32:35], v17 offset:0
  v_mfma_f32_16x16x32_bf16 v[96:99], a[4:7], a[64:67], v[96:99]
  buffer_load_dwordx4 v8, s[20:23], s28 offen offset:0 lds
  v_mfma_f32_16x16x32_bf16 v[128:131], a[8:11], a[64:67], v[128:131]
  ds_read_b64_tr_b16 a[96:97], v18 offset:4096
  v_mfma_f32_16x16x32_bf16 v[160:163], a[12:15], a[64:67], v[160:163]
  v_mfma_f32_16x16x32_bf16 v[192:195], a[16:19], a[64:67], v[192:195]
  ds_read_b64_tr_b16 a[98:99], v18 offset:6144
  v_mfma_f32_16x16x32_bf16 v[224:227], a[20:23], a[64:67], v[224:227]
  v_mfma_f32_16x16x32_bf16 a[128:131], a[24:27], a[64:67], a[128:131]
  ds_read_b128 a[36:39], v17 offset:2048
  v_mfma_f32_16x16x32_bf16 a[160:163], a[28:31], a[64:67], a[160:163]
  buffer_load_dwordx4 v9, s[20:23], s28 offen offset:1024 lds
  v_mfma_f32_16x16x32_bf16 v[68:71], a[0:3], a[68:71], v[68:71]
  v_mfma_f32_16x16x32_bf16 v[100:103], a[4:7], a[68:71], v[100:103]
  ds_read_b128 a[40:43], v17 offset:4096
  v_mfma_f32_16x16x32_bf16 v[132:135], a[8:11], a[68:71], v[132:135]
  v_mfma_f32_16x16x32_bf16 v[164:167], a[12:15], a[68:71], v[164:167]
  ds_read_b128 a[44:47], v17 offset:6144
  v_mfma_f32_16x16x32_bf16 v[196:199], a[16:19], a[68:71], v[196:199]
  v_mfma_f32_16x16x32_bf16 v[228:231], a[20:23], a[68:71], v[228:231]
  ds_read_b128 a[48:51], v17 offset:8192
  v_mfma_f32_16x16x32_bf16 a[132:135], a[24:27], a[68:71], a[132:135]
  buffer_load_dwordx4 v10, s[20:23], s28 offen offset:2048 lds
  v_mfma_f32_16x16x32_bf16 a[164:167], a[28:31], a[68:71], a[164:167]
  ds_read_b128 a[52:55], v17 offset:10240
  v_mfma_f32_16x16x32_bf16 v[72:75], a[0:3], a[72:75], v[72:75]
  v_mfma_f32_16x16x32_bf16 v[104:107], a[4:7], a[72:75], v[104:107]
  v_mfma_f32_16x16x32_bf16 v[136:139], a[8:11], a[72:75], v[136:139]
  ds_read_b128 a[56:59], v17 offset:12288
  v_mfma_f32_16x16x32_bf16 v[168:171], a[12:15], a[72:75], v[168:171]
  v_mfma_f32_16x16x32_bf16 v[200:203], a[16:19], a[72:75], v[200:203]
  ds_read_b128 a[60:63], v17 offset:14336
  v_mfma_f32_16x16x32_bf16 v[232:235], a[20:23], a[72:75], v[232:235]
  buffer_load_dwordx4 v11, s[20:23], s28 offen offset:3072 lds
  v_mfma_f32_16x16x32_bf16 a[136:139], a[24:27], a[72:75], a[136:139]
  s_bfe_u32 s56, 0x302010e, s55
  s_add_u32 s54, s54, s56
  s_add_u32 s55, s55, 8
  v_mfma_f32_16x16x32_bf16 a[168:171], a[28:31], a[72:75], a[168:171]
  s_and_b32 s55, s55, 0x8001f
  s_and_b32 s54, s54, 15
  s_lshl_b32 s28, s54, 19
  v_mfma_f32_16x16x32_bf16 v[76:79], a[0:3], a[76:79], v[76:79]
  s_add_u32 m0, s68, 16384
  ds_read_b64_tr_b16 a[100:101], v19 offset:4096
  ds_read_b64_tr_b16 a[102:103], v19 offset:6144
  v_mfma_f32_16x16x32_bf16 v[108:111], a[4:7], a[76:79], v[108:111]
  s_add_u32 s36, s36, s38
  v_mfma_f32_16x16x32_bf16 v[140:143], a[8:11], a[76:79], v[140:143]
  s_add_u32 s37, s37, 1
  v_mfma_f32_16x16x32_bf16 v[172:175], a[12:15], a[76:79], v[172:175]
  ds_read_b64_tr_b16 a[104:105], v20 offset:4096
  v_mfma_f32_16x16x32_bf16 v[204:207], a[16:19], a[76:79], v[204:207]
  buffer_load_dwordx4 v8, s[20:23], s28 offen offset:0 lds
  v_mfma_f32_16x16x32_bf16 v[236:239], a[20:23], a[76:79], v[236:239]
  ds_read_b64_tr_b16 a[106:107], v20 offset:6144
  v_mfma_f32_16x16x32_bf16 a[140:143], a[24:27], a[76:79], a[140:143]
  s_cmp_eq_u32 s37, 3
  s_cselect_b32 s37, 0, s37
  s_cselect_b32 s38, s39, s40
  v_mfma_f32_16x16x32_bf16 a[172:175], a[28:31], a[76:79], a[172:175]
  s_add_u32 s41, s41, s43
  ds_read_b64_tr_b16 a[108:109], v21 offset:4096
  v_mfma_f32_16x16x32_bf16 v[80:83], a[0:3], a[80:83], v[80:83]
  s_sub_u32 s43, 0, s43
  v_mfma_f32_16x16x32_bf16 v[112:115], a[4:7], a[80:83], v[112:115]
  ds_read_b64_tr_b16 a[110:111], v21 offset:6144
  v_mfma_f32_16x16x32_bf16 v[144:147], a[8:11], a[80:83], v[144:147]
  v_mfma_f32_16x16x32_bf16 v[176:179], a[12:15], a[80:83], v[176:179]
  buffer_load_dwordx4 v9, s[20:23], s28 offen offset:1024 lds
  v_mfma_f32_16x16x32_bf16 v[208:211], a[16:19], a[80:83], v[208:211]
  ds_read_b64_tr_b16 a[112:113], v18 offset:12288
  v_mfma_f32_16x16x32_bf16 v[240:243], a[20:23], a[80:83], v[240:243]
  v_mfma_f32_16x16x32_bf16 a[144:147], a[24:27], a[80:83], a[144:147]
  ds_read_b64_tr_b16 a[114:115], v18 offset:14336
  v_mfma_f32_16x16x32_bf16 a[176:179], a[28:31], a[80:83], a[176:179]
  v_mfma_f32_16x16x32_bf16 v[84:87], a[0:3], a[84:87], v[84:87]
  ds_read_b64_tr_b16 a[116:117], v19 offset:12288
  v_mfma_f32_16x16x32_bf16 v[116:119], a[4:7], a[84:87], v[116:119]
  v_mfma_f32_16x16x32_bf16 v[148:151], a[8:11], a[84:87], v[148:151]
  buffer_load_dwordx4 v10, s[20:23], s28 offen offset:2048 lds
  v_mfma_f32_16x16x32_bf16 v[180:183], a[12:15], a[84:87], v[180:183]
  ds_read_b64_tr_b16 a[118:119], v19 offset:14336
  v_mfma_f32_16x16x32_bf16 v[212:215], a[16:19], a[84:87], v[212:215]
  v_mfma_f32_16x16x32_bf16 v[244:247], a[20:23], a[84:87], v[244:247]
  ds_read_b64_tr_b16 a[120:121], v20 offset:12288
  v_mfma_f32_16x16x32_bf16 a[148:151], a[24:27], a[84:87], a[148:151]
  v_mfma_f32_16x16x32_bf16 a[180:183], a[28:31], a[84:87], a[180:183]
  ds_read_b64_tr_b16 a[122:123], v20 offset:14336
  v_mfma_f32_16x16x32_bf16 v[88:91], a[0:3], a[88:91], v[88:91]
  v_mfma_f32_16x16x32_bf16 v[120:123], a[4:7], a[88:91], v[120:123]
  buffer_load_dwordx4 v11, s[20:23], s28 offen offset:3072 lds
  v_mfma_f32_16x16x32_bf16 v[152:155], a[8:11], a[88:91], v[152:155]
  s_bfe_u32 s56, 0x302010e, s55
  ds_read_b64_tr_b16 a[124:125], v21 offset:12288
  v_mfma_f32_16x16x32_bf16 v[184:187], a[12:15], a[88:91], v[184:187]
  s_add_u32 s54, s54, s56
  ds_read_b64_tr_b16 a[126:127], v21 offset:14336
  v_mfma_f32_16x16x32_bf16 v[216:219], a[16:19], a[88:91], v[216:219]
  s_add_u32 s55, s55, 8
  v_add_u32 v16, s38, v16
  v_add_u32 v17, s38, v17
  v_mfma_f32_16x16x32_bf16 v[248:251], a[20:23], a[88:91], v[248:251]
  s_and_b32 s55, s55, 0x8001f
  v_add_u32 v18, s43, v18
  v_add_u32 v19, s43, v19
  v_mfma_f32_16x16x32_bf16 a[152:155], a[24:27], a[88:91], a[152:155]
  s_and_b32 s54, s54, 15
  v_add_u32 v20, s43, v20
  v_add_u32 v21, s43, v21
  v_mfma_f32_16x16x32_bf16 a[184:187], a[28:31], a[88:91], a[184:187]
  s_lshl_b32 s28, s54, 19
  v_mfma_f32_16x16x32_bf16 v[92:95], a[0:3], a[92:95], v[92:95]
  v_mfma_f32_16x16x32_bf16 v[124:127], a[4:7], a[92:95], v[124:127]
  v_mfma_f32_16x16x32_bf16 v[156:159], a[8:11], a[92:95], v[156:159]
  v_mfma_f32_16x16x32_bf16 v[188:191], a[12:15], a[92:95], v[188:191]
  v_mfma_f32_16x16x32_bf16 v[220:223], a[16:19], a[92:95], v[220:223]
  v_mfma_f32_16x16x32_bf16 v[252:255], a[20:23], a[92:95], v[252:255]
  v_mfma_f32_16x16x32_bf16 a[156:159], a[24:27], a[92:95], a[156:159]
  v_mfma_f32_16x16x32_bf16 a[188:191], a[28:31], a[92:95], a[188:191]
  s_waitcnt vmcnt(8) lgkmcnt(0)
  s_barrier
  v_mfma_f32_16x16x32_bf16 v[64:67], a[32:35], a[96:99], v[64:67]
  s_mov_b32 m0, s88
  ds_read_b128 a[0:3], v16 offset:0
  v_mfma_f32_16x16x32_bf16 v[96:99], a[36:39], a[96:99], v[96:99]
  buffer_load_dwordx4 v4, s[8:11], s26 offen offset:0 lds
  v_mfma_f32_16x16x32_bf16 v[128:131], a[40:43], a[96:99], v[128:131]
  ds_read_b64_tr_b16 a[64:65], v18 offset:0
  v_mfma_f32_16x16x32_bf16 v[160:163], a[44:47], a[96:99], v[160:163]
  v_mfma_f32_16x16x32_bf16 v[192:195], a[48:51], a[96:99], v[192:195]
  ds_read_b64_tr_b16 a[66:67], v18 offset:2048
  v_mfma_f32_16x16x32_bf16 v[224:227], a[52:55], a[96:99], v[224:227]
  v_mfma_f32_16x16x32_bf16 a[128:131], a[56:59], a[96:99], a[128:131]
  ds_read_b128 a[4:7], v16 offset:2048
  v_mfma_f32_16x16x32_bf16 a[160:163], a[60:63], a[96:99], a[160:163]
  buffer_load_dwordx4 v5, s[8:11], s26 offen offset:1024 lds
  v_mfma_f32_16x16x32_bf16 v[68:71], a[32:35], a[100:103], v[68:71]
  v_mfma_f32_16x16x32_bf16 v[100:103], a[36:39], a[100:103], v[100:103]
  ds_read_b128 a[8:11], v16 offset:4096
  v_mfma_f32_16x16x32_bf16 v[132:135], a[40:43], a[100:103], v[132:135]
  v_mfma_f32_16x16x32_bf16 v[164:167], a[44:47], a[100:103], v[164:167]
  ds_read_b128 a[12:15], v16 offset:6144
  v_mfma_f32_16x16x32_bf16 v[196:199], a[48:51], a[100:103], v[196:199]
  v_mfma_f32_16x16x32_bf16 v[228:231], a[52:55], a[100:103], v[228:231]
  ds_read_b128 a[16:19], v16 offset:8192
  v_mfma_f32_16x16x32_bf16 a[132:135], a[56:59], a[100:103], a[132:135]
  v_mfma_f32_16x16x32_bf16 a[164:167], a[60:63], a[100:103], a[164:167]
  buffer_load_dwordx4 v6, s[8:11], s26 offen offset:2048 lds
  v_mfma_f32_16x16x32_bf16 v[72:75], a[32:35], a[104:107], v[72:75]
  ds_read_b128 a[20:23], v16 offset:10240
  v_mfma_f32_16x16x32_bf16 v[104:107], a[36:39], a[104:107], v[104:107]
  v_mfma_f32_16x16x32_bf16 v[136:139], a[40:43], a[104:107], v[136:139]
  ds_read_b128 a[24:27], v16 offset:12288
  v_mfma_f32_16x16x32_bf16 v[168:171], a[44:47], a[104:107], v[168:171]
  v_mfma_f32_16x16x32_bf16 v[200:203], a[48:51], a[104:107], v[200:203]
  ds_read_b128 a[28:31], v16 offset:14336
  v_mfma_f32_16x16x32_bf16 v[232:235], a[52:55], a[104:107], v[232:235]
  v_mfma_f32_16x16x32_bf16 a[136:139], a[56:59], a[104:107], a[136:139]
  ds_read_b64_tr_b16 a[68:69], v19 offset:0
  v_mfma_f32_16x16x32_bf16 a[168:171], a[60:63], a[104:107], a[168:171]
  buffer_load_dwordx4 v7, s[8:11], s26 offen offset:3072 lds
  v_mfma_f32_16x16x32_bf16 v[76:79], a[32:35], a[108:111], v[76:79]
  s_add_u32 m0, s88, 4096
  ds_read_b64_tr_b16 a[70:71], v19 offset:2048
  v_mfma_f32_16x16x32_bf16 v[108:111], a[36:39], a[108:111], v[108:111]
  v_mfma_f32_16x16x32_bf16 v[140:143], a[40:43], a[108:111], v[140:143]
  v_mfma_f32_16x16x32_bf16 v[172:175], a[44:47], a[108:111], v[172:175]
  ds_read_b64_tr_b16 a[72:73], v20 offset:0
  v_mfma_f32_16x16x32_bf16 v[204:207], a[48:51], a[108:111], v[204:207]
  v_mfma_f32_16x16x32_bf16 v[236:239], a[52:55], a[108:111], v[236:239]
  ds_read_b64_tr_b16 a[74:75], v20 offset:2048
  v_mfma_f32_16x16x32_bf16 a[140:143], a[56:59], a[108:111], a[140:143]
  v_mfma_f32_16x16x32_bf16 a[172:175], a[60:63], a[108:111], a[172:175]
  buffer_load_dwordx4 v4, s[8:11], s27 offen offset:0 lds
  v_mfma_f32_16x16x32_bf16 v[80:83], a[32:35], a[112:115], v[80:83]
  ds_read_b64_tr_b16 a[76:77], v21 offset:0
  v_mfma_f32_16x16x32_bf16 v[112:115], a[36:39], a[112:115], v[112:115]
  ds_read_b64_tr_b16 a[78:79], v21 offset:2048
  v_mfma_f32_16x16x32_bf16 v[144:147], a[40:43], a[112:115], v[144:147]
  v_mfma_f32_16x16x32_bf16 v[176:179], a[44:47], a[112:115], v[176:179]
  v_mfma_f32_16x16x32_bf16 v[208:211], a[48:51], a[112:115], v[208:211]
  ds_read_b64_tr_b16 a[80:81], v18 offset:8192
  v_mfma_f32_16x16x32_bf16 v[240:243], a[52:55], a[112:115], v[240:243]
  v_mfma_f32_16x16x32_bf16 a[144:147], a[56:59], a[112:115], a[144:147]
  ds_read_b64_tr_b16 a[82:83], v18 offset:10240
  v_mfma_f32_16x16x32_bf16 a[176:179], a[60:63], a[112:115], a[176:179]
  buffer_load_dwordx4 v5, s[8:11], s27 offen offset:1024 lds
  v_mfma_f32_16x16x32_bf16 v[84:87], a[32:35], a[116:119], v[84:87]
  ds_read_b64_tr_b16 a[84:85], v19 offset:8192
  v_mfma_f32_16x16x32_bf16 v[116:119], a[36:39], a[116:119], v[116:119]
  v_mfma_f32_16x16x32_bf16 v[148:151], a[40:43], a[116:119], v[148:151]
  ds_read_b64_tr_b16 a[86:87], v19 offset:10240
  v_mfma_f32_16x16x32_bf16 v[180:183], a[44:47], a[116:119], v[180:183]
  v_mfma_f32_16x16x32_bf16 v[212:215], a[48:51], a[116:119], v[212:215]
  v_mfma_f32_16x16x32_bf16 v[244:247], a[52:55], a[116:119], v[244:247]
  ds_read_b64_tr_b16 a[88:89], v20 offset:8192
  v_mfma_f32_16x16x32_bf16 a[148:151], a[56:59], a[116:119], a[148:151]
  v_mfma_f32_16x16x32_bf16 a[180:183], a[60:63], a[116:119], a[180:183]
  buffer_load_dwordx4 v6, s[8:11], s27 offen offset:2048 lds
  v_mfma_f32_16x16x32_bf16 v[88:91], a[32:35], a[120:123], v[88:91]
  ds_read_b64_tr_b16 a[90:91], v20 offset:10240
  v_mfma_f32_16x16x32_bf16 v[120:123], a[36:39], a[120:123], v[120:123]
  ds_read_b64_tr_b16 a[92:93], v21 offset:8192
  v_mfma_f32_16x16x32_bf16 v[152:155], a[40:43], a[120:123], v[152:155]
  v_mfma_f32_16x16x32_bf16 v[184:187], a[44:47], a[120:123], v[184:187]
  ds_read_b64_tr_b16 a[94:95], v21 offset:10240
  v_mfma_f32_16x16x32_bf16 v[216:219], a[48:51], a[120:123], v[216:219]
  v_mfma_f32_16x16x32_bf16 v[248:251], a[52:55], a[120:123], v[248:251]
  v_mfma_f32_16x16x32_bf16 a[152:155], a[56:59], a[120:123], a[152:155]
  v_mfma_f32_16x16x32_bf16 a[184:187], a[60:63], a[120:123], a[184:187]
  buffer_load_dwordx4 v7, s[8:11], s27 offen offset:3072 lds
  v_mfma_f32_16x16x32_bf16 v[92:95], a[32:35], a[124:127], v[92:95]
  s_bfe_u32 s29, 0x302010e, s53
  v_mfma_f32_16x16x32_bf16 v[124:127], a[36:39], a[124:127], v[124:127]
  s_add_u32 s52, s52, s29
  v_mfma_f32_16x16x32_bf16 v[156:159], a[40:43], a[124:127], v[156:159]
  s_add_u32 s53, s53, 8
  v_mfma_f32_16x16x32_bf16 v[188:191], a[44:47], a[124:127], v[188:191]
  s_and_b32 s53, s53, 0x8001f
  v_mfma_f32_16x16x32_bf16 v[220:223], a[48:51], a[124:127], v[220:223]
  s_and_b32 s52, s52, 15
  v_mfma_f32_16x16x32_bf16 v[252:255], a[52:55], a[124:127], v[252:255]
  s_lshl_b32 s29, s52, 7
  v_mfma_f32_16x16x32_bf16 a[156:159], a[56:59], a[124:127], a[156:159]
  s_or_b32 s26, s30, s29
  v_mfma_f32_16x16x32_bf16 a[188:191], a[60:63], a[124:127], a[188:191]
  s_or_b32 s27, s31, s29
  s_waitcnt lgkmcnt(0)
  v_mfma_f32_16x16x32_bf16 v[128:131], a[8:11], a[64:67], v[128:131]
  ds_read_b128 a[32:35], v17 offset:0
  ds_read_b64_tr_b16 a[96:97], v18 offset:4096
  v_mfma_f32_16x16x32_bf16 v[160:163], a[12:15], a[64:67], v[160:163]
  ds_read_b64_tr_b16 a[98:99], v18 offset:6144
  ds_read_b128 a[36:39], v17 offset:2048
  v_mfma_f32_16x16x32_bf16 v[132:135], a[8:11], a[68:71], v[132:135]
  ds_read_b128 a[40:43], v17 offset:4096
  ds_read_b128 a[44:47], v17 offset:6144
  v_mfma_f32_16x16x32_bf16 v[164:167], a[12:15], a[68:71], v[164:167]
  ds_read_b128 a[48:51], v17 offset:8192
  ds_read_b128 a[52:55], v17 offset:10240
  v_mfma_f32_16x16x32_bf16 v[136:139], a[8:11], a[72:75], v[136:139]
  ds_read_b128 a[56:59], v17 offset:12288
  ds_read_b128 a[60:63], v17 offset:14336
  v_mfma_f32_16x16x32_bf16 v[168:171], a[12:15], a[72:75], v[168:171]
  ds_read_b64_tr_b16 a[100:101], v19 offset:4096
  ds_read_b64_tr_b16 a[102:103], v19 offset:6144
  v_mfma_f32_16x16x32_bf16 v[140:143], a[8:11], a[76:79], v[140:143]
  ds_read_b64_tr_b16 a[104:105], v20 offset:4096
  v_mfma_f32_16x16x32_bf16 v[172:175], a[12:15], a[76:79], v[172:175]
  ds_read_b64_tr_b16 a[106:107], v20 offset:6144
  ds_read_b64_tr_b16 a[108:109], v21 offset:4096
  v_mfma_f32_16x16x32_bf16 v[144:147], a[8:11], a[80:83], v[144:147]
  ds_read_b64_tr_b16 a[110:111], v21 offset:6144
  ds_read_b64_tr_b16 a[112:113], v18 offset:12288
  v_mfma_f32_16x16x32_bf16 v[176:179], a[12:15], a[80:83], v[176:179]
  ds_read_b64_tr_b16 a[114:115], v18 offset:14336
  ds_read_b64_tr_b16 a[116:117], v19 offset:12288
  v_mfma_f32_16x16x32_bf16 v[148:151], a[8:11], a[84:87], v[148:151]
  ds_read_b64_tr_b16 a[118:119], v19 offset:14336
  ds_read_b64_tr_b16 a[120:121], v20 offset:12288
  v_mfma_f32_16x16x32_bf16 v[180:183], a[12:15], a[84:87], v[180:183]
  ds_read_b64_tr_b16 a[122:123], v20 offset:14336
  ds_read_b64_tr_b16 a[124:125], v21 offset:12288
  v_mfma_f32_16x16x32_bf16 v[152:155], a[8:11], a[88:91], v[152:155]
  ds_read_b64_tr_b16 a[126:127], v21 offset:14336
  v_mfma_f32_16x16x32_bf16 v[184:187], a[12:15], a[88:91], v[184:187]
  v_mfma_f32_16x16x32_bf16 v[156:159], a[8:11], a[92:95], v[156:159]
  v_mfma_f32_16x16x32_bf16 v[188:191], a[12:15], a[92:95], v[188:191]
  v_mfma_f32_16x16x32_bf16 v[192:195], a[16:19], a[64:67], v[192:195]
  v_mfma_f32_16x16x32_bf16 v[224:227], a[20:23], a[64:67], v[224:227]
  s_waitcnt lgkmcnt(0)
  s_barrier
  s_mov_b32 s12, s84
  s_mov_b32 s13, s85
  s_mov_b32 s14, 256
  s_mov_b32 s15, 0x00020000
  buffer_load_dwordx2 v[22:23], off, s[12:15], 0 sc1
  v_mfma_f32_16x16x32_bf16 v[128:131], a[40:43], a[96:99], v[128:131]
  s_add_u32 m0, s88, 32768
  v_mfma_f32_16x16x32_bf16 v[160:163], a[44:47], a[96:99], v[160:163]
  buffer_load_dwordx4 v4, s[8:11], s26 offen offset:0 lds
  v_mfma_f32_16x16x32_bf16 v[132:135], a[40:43], a[100:103], v[132:135]
  v_mfma_f32_16x16x32_bf16 v[164:167], a[44:47], a[100:103], v[164:167]
  v_mfma_f32_16x16x32_bf16 v[136:139], a[40:43], a[104:107], v[136:139]
  v_mfma_f32_16x16x32_bf16 v[168:171], a[44:47], a[104:107], v[168:171]
  buffer_load_dwordx4 v5, s[8:11], s26 offen offset:1024 lds
  v_cvt_pk_bf16_f32 v128, v128, v129
  v_mfma_f32_16x16x32_bf16 v[140:143], a[40:43], a[108:111], v[140:143]
  v_cvt_pk_bf16_f32 v129, v130, v131
  v_cvt_pk_bf16_f32 v130, v160, v161
  v_mfma_f32_16x16x32_bf16 v[172:175], a[44:47], a[108:111], v[172:175]
  v_cvt_pk_bf16_f32 v131, v162, v163
  v_cvt_pk_bf16_f32 v132, v132, v133
  v_mfma_f32_16x16x32_bf16 v[144:147], a[40:43], a[112:115], v[144:147]
  v_cvt_pk_bf16_f32 v133, v134, v135
  v_cvt_pk_bf16_f32 v134, v164, v165
  v_mfma_f32_16x16x32_bf16 v[176:179], a[44:47], a[112:115], v[176:179]
  v_cvt_pk_bf16_f32 v135, v166, v167
  v_mfma_f32_16x16x32_bf16 v[148:151], a[40:43], a[116:119], v[148:151]
  buffer_load_dwordx4 v6, s[8:11], s26 offen offset:2048 lds
  v_mfma_f32_16x16x32_bf16 v[180:183], a[44:47], a[116:119], v[180:183]
  s_add_u32 s60, s63, 8192
  buffer_store_dwordx4 v[128:131], v2, s[16:19], s60 offen offset:0 sc1
  v_cvt_pk_bf16_f32 v136, v136, v137
  v_mfma_f32_16x16x32_bf16 v[152:155], a[40:43], a[120:123], v[152:155]
  v_cvt_pk_bf16_f32 v137, v138, v139
  v_cvt_pk_bf16_f32 v138, v168, v169
  v_mfma_f32_16x16x32_bf16 v[184:187], a[44:47], a[120:123], v[184:187]
  v_cvt_pk_bf16_f32 v139, v170, v171
  v_cvt_pk_bf16_f32 v140, v140, v141
  v_mfma_f32_16x16x32_bf16 v[156:159], a[40:43], a[124:127], v[156:159]
  v_cvt_pk_bf16_f32 v141, v142, v143
  v_cvt_pk_bf16_f32 v142, v172, v173
  v_mfma_f32_16x16x32_bf16 v[188:191], a[44:47], a[124:127], v[188:191]
  v_cvt_pk_bf16_f32 v143, v174, v175
  v_cvt_pk_bf16_f32 v144, v144, v145
  v_mfma_f32_16x16x32_bf16 v[192:195], a[48:51], a[96:99], v[192:195]
  buffer_load_dwordx4 v7, s[8:11], s26 offen offset:3072 lds
  v_cvt_pk_bf16_f32 v145, v146, v147
  v_mfma_f32_16x16x32_bf16 v[224:227], a[52:55], a[96:99], v[224:227]
  s_add_u32 m0, s88, 36864
  v_cvt_pk_bf16_f32 v146, v176, v177
  v_cvt_pk_bf16_f32 v147, v178, v179
  v_mfma_f32_16x16x32_bf16 a[128:131], a[24:27], a[64:67], a[128:131]
  s_add_u32 s60, s63, 8192
  buffer_store_dwordx4 v[132:135], v2, s[16:19], s60 offen offset:1024 sc1
  v_cvt_pk_bf16_f32 v148, v148, v149
  v_mfma_f32_16x16x32_bf16 a[160:163], a[28:31], a[64:67], a[160:163]
  v_cvt_pk_bf16_f32 v149, v150, v151
  v_cvt_pk_bf16_f32 v150, v180, v181
  v_mfma_f32_16x16x32_bf16 a[128:131], a[56:59], a[96:99], a[128:131]
  v_cvt_pk_bf16_f32 v151, v182, v183
  v_cvt_pk_bf16_f32 v152, v152, v153
  v_mfma_f32_16x16x32_bf16 a[160:163], a[60:63], a[96:99], a[160:163]
  buffer_load_dwordx4 v4, s[8:11], s27 offen offset:0 lds
  v_cvt_pk_bf16_f32 v153, v154, v155
  v_mfma_f32_16x16x32_bf16 v[196:199], a[16:19], a[68:71], v[196:199]
  v_cvt_pk_bf16_f32 v154, v184, v185
  v_cvt_pk_bf16_f32 v155, v186, v187
  v_mfma_f32_16x16x32_bf16 v[228:231], a[20:23], a[68:71], v[228:231]
  v_cvt_pk_bf16_f32 v156, v156, v157
  v_cvt_pk_bf16_f32 v157, v158, v159
  v_mfma_f32_16x16x32_bf16 v[196:199], a[48:51], a[100:103], v[196:199]
  v_cvt_pk_bf16_f32 v158, v188, v189
  v_cvt_pk_bf16_f32 v159, v190, v191
  v_mfma_f32_16x16x32_bf16 v[228:231], a[52:55], a[100:103], v[228:231]
  v_cvt_pk_bf16_f32 v192, v192, v193
  v_cvt_pk_bf16_f32 v193, v194, v195
  v_mfma_f32_16x16x32_bf16 a[132:135], a[24:27], a[68:71], a[132:135]
  v_cvt_pk_bf16_f32 v194, v224, v225
  v_cvt_pk_bf16_f32 v195, v226, v227
  v_mfma_f32_16x16x32_bf16 a[164:167], a[28:31], a[68:71], a[164:167]
  buffer_load_dwordx4 v5, s[8:11], s27 offen offset:1024 lds
  v_mfma_f32_16x16x32_bf16 a[132:135], a[56:59], a[100:103], a[132:135]
  s_add_u32 s60, s63, 8192
  buffer_store_dwordx4 v[136:139], v2, s[16:19], s60 offen offset:2048 sc1
  v_accvgpr_read_b32 v24, a128
  v_mfma_f32_16x16x32_bf16 a[164:167], a[60:63], a[100:103], a[164:167]
  v_accvgpr_read_b32 v25, a129
  v_accvgpr_read_b32 v26, a130
  v_mfma_f32_16x16x32_bf16 v[200:203], a[16:19], a[72:75], v[200:203]
  v_accvgpr_read_b32 v27, a131
  v_accvgpr_read_b32 v28, a160
  v_mfma_f32_16x16x32_bf16 v[232:235], a[20:23], a[72:75], v[232:235]
  v_accvgpr_read_b32 v29, a161
  v_accvgpr_read_b32 v30, a162
  v_mfma_f32_16x16x32_bf16 v[200:203], a[48:51], a[104:107], v[200:203]
  buffer_load_dwordx4 v6, s[8:11], s27 offen offset:2048 lds
  v_accvgpr_read_b32 v31, a163
  v_mfma_f32_16x16x32_bf16 v[232:235], a[52:55], a[104:107], v[232:235]
  v_cvt_pk_bf16_f32 v224, v24, v25
  v_cvt_pk_bf16_f32 v225, v26, v27
  v_mfma_f32_16x16x32_bf16 a[136:139], a[24:27], a[72:75], a[136:139]
  v_cvt_pk_bf16_f32 v226, v28, v29
  v_cvt_pk_bf16_f32 v227, v30, v31
  v_mfma_f32_16x16x32_bf16 a[168:171], a[28:31], a[72:75], a[168:171]
  v_cvt_pk_bf16_f32 v196, v196, v197
  v_cvt_pk_bf16_f32 v197, v198, v199
  v_mfma_f32_16x16x32_bf16 a[136:139], a[56:59], a[104:107], a[136:139]
  v_cvt_pk_bf16_f32 v198, v228, v229
  v_cvt_pk_bf16_f32 v199, v230, v231
  v_mfma_f32_16x16x32_bf16 a[168:171], a[60:63], a[104:107], a[168:171]
  v_accvgpr_read_b32 v32, a132
  v_accvgpr_read_b32 v33, a133
  v_mfma_f32_16x16x32_bf16 v[204:207], a[16:19], a[76:79], v[204:207]
  buffer_load_dwordx4 v7, s[8:11], s27 offen offset:3072 lds
  v_accvgpr_read_b32 v34, a134
  v_mfma_f32_16x16x32_bf16 v[236:239], a[20:23], a[76:79], v[236:239]
  s_bfe_u32 s29, 0x302010e, s53
  s_add_u32 s52, s52, s29
  s_add_u32 s53, s53, 8
  v_mfma_f32_16x16x32_bf16 v[204:207], a[48:51], a[108:111], v[204:207]
  s_and_b32 s53, s53, 0x8001f
  s_and_b32 s52, s52, 15
  s_lshl_b32 s29, s52, 7
  v_mfma_f32_16x16x32_bf16 v[236:239], a[52:55], a[108:111], v[236:239]
  s_or_b32 s26, s30, s29
  s_or_b32 s27, s31, s29
  s_add_u32 m0, s68, 32768
  v_mfma_f32_16x16x32_bf16 a[140:143], a[24:27], a[76:79], a[140:143]
  v_accvgpr_read_b32 v35, a135
  v_accvgpr_read_b32 v36, a164
  v_mfma_f32_16x16x32_bf16 a[172:175], a[28:31], a[76:79], a[172:175]
  buffer_load_dwordx4 v8, s[20:23], s28 offen offset:0 lds
  v_accvgpr_read_b32 v37, a165
  v_mfma_f32_16x16x32_bf16 a[140:143], a[56:59], a[108:111], a[140:143]
  v_accvgpr_read_b32 v38, a166
  v_accvgpr_read_b32 v39, a167
  v_mfma_f32_16x16x32_bf16 a[172:175], a[60:63], a[108:111], a[172:175]
  v_cvt_pk_bf16_f32 v228, v32, v33
  v_cvt_pk_bf16_f32 v229, v34, v35
  v_mfma_f32_16x16x32_bf16 v[208:211], a[16:19], a[80:83], v[208:211]
  v_cvt_pk_bf16_f32 v230, v36, v37
  v_cvt_pk_bf16_f32 v231, v38, v39
  v_mfma_f32_16x16x32_bf16 v[240:243], a[20:23], a[80:83], v[240:243]
  s_add_u32 s60, s63, 8192
  buffer_store_dwordx4 v[140:143], v2, s[16:19], s60 offen offset:3072 sc1
  v_cvt_pk_bf16_f32 v200, v200, v201
  v_mfma_f32_16x16x32_bf16 v[208:211], a[48:51], a[112:115], v[208:211]
  v_cvt_pk_bf16_f32 v201, v202, v203
  v_cvt_pk_bf16_f32 v202, v232, v233
  v_mfma_f32_16x16x32_bf16 v[240:243], a[52:55], a[112:115], v[240:243]
  buffer_load_dwordx4 v9, s[20:23], s28 offen offset:1024 lds
  v_cvt_pk_bf16_f32 v203, v234, v235
  v_mfma_f32_16x16x32_bf16 a[144:147], a[24:27], a[80:83], a[144:147]
  v_accvgpr_read_b32 v40, a136
  v_accvgpr_read_b32 v41, a137
  v_mfma_f32_16x16x32_bf16 a[176:179], a[28:31], a[80:83], a[176:179]
  v_accvgpr_read_b32 v42, a138
  v_accvgpr_read_b32 v43, a139
  v_mfma_f32_16x16x32_bf16 a[144:147], a[56:59], a[112:115], a[144:147]
  v_accvgpr_read_b32 v44, a168
  v_accvgpr_read_b32 v45, a169
  v_mfma_f32_16x16x32_bf16 a[176:179], a[60:63], a[112:115], a[176:179]
  v_accvgpr_read_b32 v46, a170
  v_accvgpr_read_b32 v47, a171
  v_mfma_f32_16x16x32_bf16 v[212:215], a[16:19], a[84:87], v[212:215]
  buffer_load_dwordx4 v10, s[20:23], s28 offen offset:2048 lds
  v_cvt_pk_bf16_f32 v232, v40, v41
  v_mfma_f32_16x16x32_bf16 v[244:247], a[20:23], a[84:87], v[244:247]
  v_cvt_pk_bf16_f32 v233, v42, v43
  v_cvt_pk_bf16_f32 v234, v44, v45
  v_mfma_f32_16x16x32_bf16 v[212:215], a[48:51], a[116:119], v[212:215]
  v_cvt_pk_bf16_f32 v235, v46, v47
  v_cvt_pk_bf16_f32 v204, v204, v205
  v_mfma_f32_16x16x32_bf16 v[244:247], a[52:55], a[116:119], v[244:247]
  v_cvt_pk_bf16_f32 v205, v206, v207
  v_cvt_pk_bf16_f32 v206, v236, v237
  v_mfma_f32_16x16x32_bf16 a[148:151], a[24:27], a[84:87], a[148:151]
  v_cvt_pk_bf16_f32 v207, v238, v239
  v_accvgpr_read_b32 v24, a140
  v_mfma_f32_16x16x32_bf16 a[180:183], a[28:31], a[84:87], a[180:183]
  buffer_load_dwordx4 v11, s[20:23], s28 offen offset:3072 lds
  v_accvgpr_read_b32 v25, a141
  v_mfma_f32_16x16x32_bf16 a[148:151], a[56:59], a[116:119], a[148:151]
  s_bfe_u32 s56, 0x302010e, s55
  s_add_u32 s54, s54, s56
  s_add_u32 s55, s55, 8
  v_mfma_f32_16x16x32_bf16 a[180:183], a[60:63], a[116:119], a[180:183]
  s_and_b32 s55, s55, 0x8001f
  s_and_b32 s54, s54, 15
  s_lshl_b32 s28, s54, 19
  v_mfma_f32_16x16x32_bf16 v[216:219], a[16:19], a[88:91], v[216:219]
  s_add_u32 m0, s88, -32768
  v_accvgpr_read_b32 v26, a142
  v_accvgpr_read_b32 v27, a143
  v_mfma_f32_16x16x32_bf16 v[248:251], a[20:23], a[88:91], v[248:251]
  v_accvgpr_read_b32 v28, a172
  v_accvgpr_read_b32 v29, a173
  v_mfma_f32_16x16x32_bf16 v[216:219], a[48:51], a[120:123], v[216:219]
  v_accvgpr_read_b32 v30, a174
  v_accvgpr_read_b32 v31, a175
  v_mfma_f32_16x16x32_bf16 v[248:251], a[52:55], a[120:123], v[248:251]
  buffer_load_dwordx4 v4, s[8:11], s26 offen offset:0 lds
  v_cvt_pk_bf16_f32 v236, v24, v25
  v_mfma_f32_16x16x32_bf16 a[152:155], a[24:27], a[88:91], a[152:155]
  v_cvt_pk_bf16_f32 v237, v26, v27
  v_cvt_pk_bf16_f32 v238, v28, v29
  v_mfma_f32_16x16x32_bf16 a[184:187], a[28:31], a[88:91], a[184:187]
  v_cvt_pk_bf16_f32 v239, v30, v31
  v_mfma_f32_16x16x32_bf16 a[152:155], a[56:59], a[120:123], a[152:155]
  s_add_u32 s60, s63, 12288
  buffer_store_dwordx4 v[144:147], v2, s[16:19], s60 offen offset:0 sc1
  v_cvt_pk_bf16_f32 v208, v208, v209
  v_mfma_f32_16x16x32_bf16 a[184:187], a[60:63], a[120:123], a[184:187]
  v_cvt_pk_bf16_f32 v209, v210, v211
  v_cvt_pk_bf16_f32 v210, v240, v241
  v_mfma_f32_16x16x32_bf16 v[220:223], a[16:19], a[92:95], v[220:223]
  buffer_load_dwordx4 v5, s[8:11], s26 offen offset:1024 lds
  v_cvt_pk_bf16_f32 v211, v242, v243
  v_mfma_f32_16x16x32_bf16 v[252:255], a[20:23], a[92:95], v[252:255]
  v_accvgpr_read_b32 v32, a144
  v_accvgpr_read_b32 v33, a145
  v_mfma_f32_16x16x32_bf16 v[220:223], a[48:51], a[124:127], v[220:223]
  v_accvgpr_read_b32 v34, a146
  v_accvgpr_read_b32 v35, a147
  v_mfma_f32_16x16x32_bf16 v[252:255], a[52:55], a[124:127], v[252:255]
  v_accvgpr_read_b32 v36, a176
  v_accvgpr_read_b32 v37, a177
  v_mfma_f32_16x16x32_bf16 a[156:159], a[24:27], a[92:95], a[156:159]
  v_accvgpr_read_b32 v38, a178
  v_accvgpr_read_b32 v39, a179
  v_mfma_f32_16x16x32_bf16 a[188:191], a[28:31], a[92:95], a[188:191]
  v_cvt_pk_bf16_f32 v240, v32, v33
  v_cvt_pk_bf16_f32 v241, v34, v35
  v_mfma_f32_16x16x32_bf16 a[156:159], a[56:59], a[124:127], a[156:159]
  buffer_load_dwordx4 v6, s[8:11], s26 offen offset:2048 lds
  v_cvt_pk_bf16_f32 v242, v36, v37
  v_mfma_f32_16x16x32_bf16 a[188:191], a[60:63], a[124:127], a[188:191]
  v_cvt_pk_bf16_f32 v243, v38, v39
  v_cvt_pk_bf16_f32 v212, v212, v213
  v_mfma_f32_16x16x32_bf16 v[64:67], a[0:3], a[64:67], v[64:67]
  v_cvt_pk_bf16_f32 v213, v214, v215
  v_cvt_pk_bf16_f32 v214, v244, v245
  v_mfma_f32_16x16x32_bf16 v[96:99], a[4:7], a[64:67], v[96:99]
  v_cvt_pk_bf16_f32 v215, v246, v247
  v_mfma_f32_16x16x32_bf16 v[64:67], a[32:35], a[96:99], v[64:67]
  s_add_u32 s60, s63, 12288
  buffer_store_dwordx4 v[148:151], v2, s[16:19], s60 offen offset:1024 sc1
  v_accvgpr_read_b32 v40, a148
  v_mfma_f32_16x16x32_bf16 v[96:99], a[36:39], a[96:99], v[96:99]
  buffer_load_dwordx4 v7, s[8:11], s26 offen offset:3072 lds
  v_accvgpr_read_b32 v41, a149
  v_mfma_f32_16x16x32_bf16 v[68:71], a[0:3], a[68:71], v[68:71]
  s_add_u32 m0, s88, -28672
  v_accvgpr_read_b32 v42, a150
  v_accvgpr_read_b32 v43, a151
  v_mfma_f32_16x16x32_bf16 v[100:103], a[4:7], a[68:71], v[100:103]
  v_accvgpr_read_b32 v44, a180
  v_accvgpr_read_b32 v45, a181
  v_mfma_f32_16x16x32_bf16 v[68:71], a[32:35], a[100:103], v[68:71]
  v_accvgpr_read_b32 v46, a182
  v_accvgpr_read_b32 v47, a183
  v_mfma_f32_16x16x32_bf16 v[100:103], a[36:39], a[100:103], v[100:103]
  v_cvt_pk_bf16_f32 v244, v40, v41
  v_cvt_pk_bf16_f32 v245, v42, v43
  v_mfma_f32_16x16x32_bf16 v[72:75], a[0:3], a[72:75], v[72:75]
  v_cvt_pk_bf16_f32 v246, v44, v45
  v_cvt_pk_bf16_f32 v247, v46, v47
  v_mfma_f32_16x16x32_bf16 v[104:107], a[4:7], a[72:75], v[104:107]
  buffer_load_dwordx4 v4, s[8:11], s27 offen offset:0 lds
  v_cvt_pk_bf16_f32 v216, v216, v217
  v_mfma_f32_16x16x32_bf16 v[72:75], a[32:35], a[104:107], v[72:75]
  v_cvt_pk_bf16_f32 v217, v218, v219
  v_cvt_pk_bf16_f32 v218, v248, v249
  v_mfma_f32_16x16x32_bf16 v[104:107], a[36:39], a[104:107], v[104:107]
  v_cvt_pk_bf16_f32 v219, v250, v251
  v_accvgpr_read_b32 v24, a152
  v_mfma_f32_16x16x32_bf16 v[76:79], a[0:3], a[76:79], v[76:79]
  v_accvgpr_read_b32 v25, a153
  v_accvgpr_read_b32 v26, a154
  v_mfma_f32_16x16x32_bf16 v[108:111], a[4:7], a[76:79], v[108:111]
  v_accvgpr_read_b32 v27, a155
  v_accvgpr_read_b32 v28, a184
  v_mfma_f32_16x16x32_bf16 v[76:79], a[32:35], a[108:111], v[76:79]
  buffer_load_dwordx4 v5, s[8:11], s27 offen offset:1024 lds
  v_accvgpr_read_b32 v29, a185
  v_mfma_f32_16x16x32_bf16 v[108:111], a[36:39], a[108:111], v[108:111]
  v_accvgpr_read_b32 v30, a186
  v_accvgpr_read_b32 v31, a187
  v_mfma_f32_16x16x32_bf16 v[80:83], a[0:3], a[80:83], v[80:83]
  v_cvt_pk_bf16_f32 v248, v24, v25
  v_cvt_pk_bf16_f32 v249, v26, v27
  v_mfma_f32_16x16x32_bf16 v[112:115], a[4:7], a[80:83], v[112:115]
  v_cvt_pk_bf16_f32 v250, v28, v29
  v_cvt_pk_bf16_f32 v251, v30, v31
  v_mfma_f32_16x16x32_bf16 v[80:83], a[32:35], a[112:115], v[80:83]
  v_cvt_pk_bf16_f32 v220, v220, v221
  v_cvt_pk_bf16_f32 v221, v222, v223
  v_mfma_f32_16x16x32_bf16 v[112:115], a[36:39], a[112:115], v[112:115]
  v_cvt_pk_bf16_f32 v222, v252, v253
  v_cvt_pk_bf16_f32 v223, v254, v255
  v_mfma_f32_16x16x32_bf16 v[84:87], a[0:3], a[84:87], v[84:87]
  buffer_load_dwordx4 v6, s[8:11], s27 offen offset:2048 lds
  v_mfma_f32_16x16x32_bf16 v[116:119], a[4:7], a[84:87], v[116:119]
  s_add_u32 s60, s63, 12288
  buffer_store_dwordx4 v[152:155], v2, s[16:19], s60 offen offset:2048 sc1
  v_accvgpr_read_b32 v32, a156
  v_mfma_f32_16x16x32_bf16 v[84:87], a[32:35], a[116:119], v[84:87]
  v_accvgpr_read_b32 v33, a157
  v_accvgpr_read_b32 v34, a158
  v_mfma_f32_16x16x32_bf16 v[116:119], a[36:39], a[116:119], v[116:119]
  v_accvgpr_read_b32 v35, a159
  v_accvgpr_read_b32 v36, a188
  v_mfma_f32_16x16x32_bf16 v[88:91], a[0:3], a[88:91], v[88:91]
  v_accvgpr_read_b32 v37, a189
  v_accvgpr_read_b32 v38, a190
  v_mfma_f32_16x16x32_bf16 v[120:123], a[4:7], a[88:91], v[120:123]
  buffer_load_dwordx4 v7, s[8:11], s27 offen offset:3072 lds
  v_accvgpr_read_b32 v39, a191
  v_mfma_f32_16x16x32_bf16 v[88:91], a[32:35], a[120:123], v[88:91]
  s_bfe_u32 s29, 0x302010e, s53
  s_add_u32 s52, s52, s29
  s_add_u32 s53, s53, 8
  v_mfma_f32_16x16x32_bf16 v[120:123], a[36:39], a[120:123], v[120:123]
  s_and_b32 s53, s53, 0x8001f
  s_and_b32 s52, s52, 15
  s_lshl_b32 s29, s52, 7
  v_mfma_f32_16x16x32_bf16 v[92:95], a[0:3], a[92:95], v[92:95]
  s_or_b32 s26, s30, s29
  s_or_b32 s27, s31, s29
  v_cvt_pk_bf16_f32 v252, v32, v33
  v_mfma_f32_16x16x32_bf16 v[124:127], a[4:7], a[92:95], v[124:127]
  v_cvt_pk_bf16_f32 v253, v34, v35
  v_cvt_pk_bf16_f32 v254, v36, v37
  v_mfma_f32_16x16x32_bf16 v[92:95], a[32:35], a[124:127], v[92:95]
  v_cvt_pk_bf16_f32 v255, v38, v39
  v_cvt_pk_bf16_f32 v160, v64, v65
  v_mfma_f32_16x16x32_bf16 v[124:127], a[36:39], a[124:127], v[124:127]
  v_cvt_pk_bf16_f32 v161, v66, v67
  v_cvt_pk_bf16_f32 v162, v96, v97
  v_cvt_pk_bf16_f32 v163, v98, v99
  v_cvt_pk_bf16_f32 v164, v68, v69
  v_cvt_pk_bf16_f32 v165, v70, v71
  v_cvt_pk_bf16_f32 v166, v100, v101
  v_cvt_pk_bf16_f32 v167, v102, v103
  s_add_u32 s60, s63, 12288
  buffer_store_dwordx4 v[156:159], v2, s[16:19], s60 offen offset:3072 sc1
  v_cvt_pk_bf16_f32 v168, v72, v73
  v_cvt_pk_bf16_f32 v169, v74, v75
  v_cvt_pk_bf16_f32 v170, v104, v105
  v_cvt_pk_bf16_f32 v171, v106, v107
  v_cvt_pk_bf16_f32 v172, v76, v77
  v_cvt_pk_bf16_f32 v173, v78, v79
  v_cvt_pk_bf16_f32 v174, v108, v109
  v_cvt_pk_bf16_f32 v175, v110, v111
  v_cvt_pk_bf16_f32 v176, v80, v81
  v_cvt_pk_bf16_f32 v177, v82, v83
  v_cvt_pk_bf16_f32 v178, v112, v113
  v_cvt_pk_bf16_f32 v179, v114, v115
  v_cvt_pk_bf16_f32 v180, v84, v85
  v_cvt_pk_bf16_f32 v181, v86, v87
  v_cvt_pk_bf16_f32 v182, v116, v117
  v_cvt_pk_bf16_f32 v183, v118, v119
  v_cvt_pk_bf16_f32 v184, v88, v89
  v_cvt_pk_bf16_f32 v185, v90, v91
  v_cvt_pk_bf16_f32 v186, v120, v121
  v_cvt_pk_bf16_f32 v187, v122, v123
  v_cvt_pk_bf16_f32 v188, v92, v93
  v_cvt_pk_bf16_f32 v189, v94, v95
  v_cvt_pk_bf16_f32 v190, v124, v125
  v_cvt_pk_bf16_f32 v191, v126, v127
  s_lshl_b32 s34, s62, 4
  s_add_u32 s34, s34, s61
  s_lshl_b32 s34, s34, 7
  s_branch Lp3
Lp2:
  s_and_b32 s4, s2, 1
  s_lshl_b32 s4, s4, 2
  s_and_b32 s5, s59, 3
  s_add_u32 s32, s4, s5
  s_bfe_u32 s4, s2, 0x20001
  s_lshl_b32 s4, s4, 2
  s_lshr_b32 s5, s59, 2
  s_add_u32 s33, s4, s5
  s_and_b32 s4, s2, 7
  s_lshl_b32 s4, s4, 1
  s_add_u32 s5, s32, s33
  s_and_b32 s49, s5, 3
  s_lshl_b32 s49, s49, 3
  s_or_b32 s49, s49, 0x80000
  s_bfe_u32 s48, 0xf0f02, s49
  s_add_u32 s48, s48, s4
  s_and_b32 s48, s48, 15
  s_lshl_b32 s46, s48, 7
  s_lshl_b32 s36, s3, 13
  s_mul_i32 s41, s3, 6144
  s_add_u32 s41, s41, 104448
  s_mul_i32 s4, s3, 7168
  s_sub_u32 s50, 32768, s4
  v_lshrrev_b32 v240, 3, v1
  v_and_b32 v241, 6, v240
  v_and_b32 v242, 7, v1
  v_xor_b32 v241, v241, v242
  v_lshlrev_b32 v241, 4, v241
  s_lshl_b32 s4, s3, 6
  s_add_u32 s4, s4, 16
  v_add_u32 v242, s4, v240
  v_lshl_add_u32 v242, v242, 11, v241
  v_add_u32 v224, 0, v242
  v_add_u32 v225, 15360, v242
  v_add_u32 v226, 30720, v242
  v_add_u32 v227, 46080, v242
  v_add_u32 v228, 65536, v242
  v_add_u32 v229, 80896, v242
  v_add_u32 v230, 96256, v242
  v_add_u32 v231, 111616, v242
  s_lshl_b32 s4, s3, 14
  s_cmp_eq_u32 s32, 0
  s_cselect_b32 s4, 0x40000000, s4
  v_lshl_add_u32 v242, v240, 11, v241
  v_add_u32 v232, s4, v242
  v_lshrrev_b32 v242, 2, v240
  v_and_b32 v243, 3, v240
  v_lshl_add_u32 v242, v242, 3, v243
  v_mul_u32_u24 v242, 6144, v242
  v_add_u32 v242, v242, v241
  s_lshl_b32 s4, s33, 7
  v_add_u32 v242, s4, v242
  s_mul_i32 s6, s3, 6
  s_add_u32 s7, s6, 0
  s_bfe_u32 s4, s7, 0x10002
  s_lshl_b32 s4, s4, 5
  s_and_b32 s5, s7, 1
  s_lshl_b32 s5, s5, 4
  s_add_u32 s4, s4, s5
  s_bfe_u32 s5, s7, 0x10001
  s_lshl_b32 s5, s5, 2
  s_add_u32 s4, s4, s5
  s_mul_i32 s4, s4, 6144
  s_lshr_b32 s5, s7, 3
  s_lshl_b32 s5, s5, 11
  s_add_u32 s4, s4, s5
  s_add_u32 s4, s4, 2048
  v_add_u32 v233, s4, v242
  s_add_u32 s7, s6, 1
  s_bfe_u32 s4, s7, 0x10002
  s_lshl_b32 s4, s4, 5
  s_and_b32 s5, s7, 1
  s_lshl_b32 s5, s5, 4
  s_add_u32 s4, s4, s5
  s_bfe_u32 s5, s7, 0x10001
  s_lshl_b32 s5, s5, 2
  s_add_u32 s4, s4, s5
  s_mul_i32 s4, s4, 6144
  s_lshr_b32 s5, s7, 3
  s_lshl_b32 s5, s5, 11
  s_add_u32 s4, s4, s5
  s_add_u32 s4, s4, 1024
  v_add_u32 v234, s4, v242
  s_add_u32 s7, s6, 2
  s_bfe_u32 s4, s7, 0x10002
  s_lshl_b32 s4, s4, 5
  s_and_b32 s5, s7, 1
  s_lshl_b32 s5, s5, 4
  s_add_u32 s4, s4, s5
  s_bfe_u32 s5, s7, 0x10001
  s_lshl_b32 s5, s5, 2
  s_add_u32 s4, s4, s5
  s_mul_i32 s4, s4, 6144
  s_lshr_b32 s5, s7, 3
  s_lshl_b32 s5, s5, 11
  s_add_u32 s4, s4, s5
  s_add_u32 s4, s4, 0
  v_add_u32 v235, s4, v242
  s_add_u32 s7, s6, 3
  s_bfe_u32 s4, s7, 0x10002
  s_lshl_b32 s4, s4, 5
  s_and_b32 s5, s7, 1
  s_lshl_b32 s5, s5, 4
  s_add_u32 s4, s4, s5
  s_bfe_u32 s5, s7, 0x10001
  s_lshl_b32 s5, s5, 2
  s_add_u32 s4, s4, s5
  s_mul_i32 s4, s4, 6144
  s_lshr_b32 s5, s7, 3
  s_lshl_b32 s5, s5, 11
  s_add_u32 s4, s4, s5
  s_add_u32 s4, s4, 2048
  v_add_u32 v236, s4, v242
  s_add_u32 s7, s6, 4
  s_bfe_u32 s4, s7, 0x10002
  s_lshl_b32 s4, s4, 5
  s_and_b32 s5, s7, 1
  s_lshl_b32 s5, s5, 4
  s_add_u32 s4, s4, s5
  s_bfe_u32 s5, s7, 0x10001
  s_lshl_b32 s5, s5, 2
  s_add_u32 s4, s4, s5
  s_mul_i32 s4, s4, 6144
  s_lshr_b32 s5, s7, 3
  s_lshl_b32 s5, s5, 11
  s_add_u32 s4, s4, s5
  s_add_u32 s4, s4, 1024
  v_add_u32 v237, s4, v242
  s_add_u32 s7, s6, 5
  s_bfe_u32 s4, s7, 0x10002
  s_lshl_b32 s4, s4, 5
  s_and_b32 s5, s7, 1
  s_lshl_b32 s5, s5, 4
  s_add_u32 s4, s4, s5
  s_bfe_u32 s5, s7, 0x10001
  s_lshl_b32 s5, s5, 2
  s_add_u32 s4, s4, s5
  s_mul_i32 s4, s4, 6144
  s_lshr_b32 s5, s7, 3
  s_lshl_b32 s5, s5, 11
  s_add_u32 s4, s4, s5
  s_add_u32 s4, s4, 0
  v_add_u32 v238, s4, v242
  s_waitcnt lgkmcnt(0)
  s_lshl_b32 s10, s32, 19
  s_add_u32 s8, s76, s10
  s_addc_u32 s9, s77, 0
  s_sub_u32 s8, s8, 32768
  s_subb_u32 s9, s9, 0
  s_mov_b32 s10, 557056
  s_mov_b32 s11, 0x00020000
  s_sub_u32 s12, s78, 2048
  s_subb_u32 s13, s79, 0
  s_mov_b32 s14, 6293504
  s_mov_b32 s15, 0x00020000
  s_add_u32 s96, s86, 125829120
  s_addc_u32 s97, s87, 0
  s_mov_b32 s98, 262144
  s_mov_b32 s99, 0x00020000
  s_cmp_ge_u32 s3, 2
  s_cbranch_scc1 Lp2_r1
  s_and_b32 s4, s2, 7
  s_lshl_b32 s4, s4, 4
  s_add_u32 s4, s4, s59
  s_lshl_b32 s4, s4, 2
  s_add_u32 s4, s4, s3
  s_lshl_b32 s51, s4, 13
  s_add_u32 m0, s36, s50
  s_nop 0
  buffer_load_dwordx4 v232, s[8:11], s46 offen offset:0 lds
  s_mov_b32 m0, s36
  s_nop 0
  buffer_load_dwordx4 v224, s[8:11], s46 offen offset:0 lds
  buffer_load_dwordx4 v225, s[8:11], s46 offen offset:1024 lds
  buffer_load_dwordx4 v226, s[8:11], s46 offen offset:2048 lds
  buffer_load_dwordx4 v227, s[8:11], s46 offen offset:3072 lds
  s_add_u32 m0, s36, 4096
  s_nop 0
  buffer_load_dwordx4 v228, s[8:11], s46 offen offset:0 lds
  buffer_load_dwordx4 v229, s[8:11], s46 offen offset:1024 lds
  buffer_load_dwordx4 v230, s[8:11], s46 offen offset:2048 lds
  buffer_load_dwordx4 v231, s[8:11], s46 offen offset:3072 lds
  s_mul_i32 s47, s48, 393216
  s_bfe_u32 s34, 0x302010e, s49
  s_add_u32 s48, s48, s34
  s_add_u32 s49, s49, 8
  s_and_b32 s49, s49, 0x8001f
  s_and_b32 s48, s48, 15
  s_lshl_b32 s46, s48, 7
  s_mov_b32 m0, s41
  s_nop 0
  buffer_load_dwordx4 v233, s[12:15], s47 offen offset:0 lds
  buffer_load_dwordx4 v234, s[12:15], s47 offen offset:1024 lds
  buffer_load_dwordx4 v235, s[12:15], s47 offen offset:2048 lds
  s_add_u32 m0, s41, 3072
  s_nop 0
  buffer_load_dwordx4 v236, s[12:15], s47 offen offset:0 lds
  buffer_load_dwordx4 v237, s[12:15], s47 offen offset:1024 lds
  buffer_load_dwordx4 v238, s[12:15], s47 offen offset:2048 lds
  s_lshr_b32 s4, s3, 1
  s_lshl_b32 s4, s4, 14
  v_and_b32 v240, 15, v1
  v_lshlrev_b32 v240, 7, v240
  v_lshrrev_b32 v241, 4, v1
  v_and_b32 v242, 6, v1
  v_xor_b32 v241, v241, v242
  v_lshl_add_u32 v240, v241, 4, v240
  v_add_u32 v16, s4, v240
  v_xor_b32 v17, 64, v16
  v_and_b32 v240, 15, v1
  v_lshlrev_b32 v240, 7, v240
  v_lshrrev_b32 v241, 4, v1
  v_and_b32 v242, 6, v1
  v_xor_b32 v241, v241, v242
  v_lshl_add_u32 v240, v241, 4, v240
  v_add_u32 v18, 32768, v240
  v_xor_b32 v19, 64, v18
  v_lshrrev_b32 v240, 2, v1
  v_and_b32 v241, 6, v240
  v_lshlrev_b32 v240, 7, v240
  v_and_b32 v242, 1, v1
  v_lshl_add_u32 v240, v242, 3, v240
  v_add_u32 v240, 104448, v240
  v_bfe_u32 v242, v1, 1, 1
  v_xor_b32 v241, v241, v242
  v_xor_b32 v242, 0, v241
  v_lshl_add_u32 v20, v242, 4, v240
  v_xor_b32 v242, 2, v241
  v_lshl_add_u32 v21, v242, 4, v240
  s_and_b32 s4, s3, 1
  s_lshl_b32 s4, s4, 6
  v_xor_b32 v20, s4, v20
  v_xor_b32 v21, s4, v21
  s_and_b32 s24, s2, 7
  s_lshr_b32 s4, s2, 6
  s_lshl_b32 s4, s4, 3
  s_add_u32 s24, s24, s4
  s_lshr_b32 s4, s2, 3
  s_and_b32 s25, s4, 6
  s_xor_b32 s4, s4, s2
  s_bfe_u32 s4, s4, 0x10003
  s_add_u32 s25, s25, s4
  v_accvgpr_write_b32 a244, -1
  v_accvgpr_write_b32 a245, -1
  v_accvgpr_write_b32 a246, -1
  v_accvgpr_write_b32 a247, -1
  v_lshrrev_b32 v24, 3, v1
  v_and_b32 v25, 6, v24
  v_and_b32 v26, 7, v1
  v_xor_b32 v25, v25, v26
  v_lshlrev_b32 v25, 4, v25
  s_and_b32 s4, s3, 1
  s_lshl_b32 s4, s4, 16
  s_lshr_b32 s5, s3, 1
  s_lshl_b32 s5, s5, 7
  s_add_u32 s4, s4, s5
  v_lshl_add_u32 v24, v24, 11, v25
  v_add_u32 v24, s4, v24
  v_add_u32 v25, 0, v24
  v_accvgpr_write_b32 a212, v25
  v_add_u32 v25, 15360, v24
  v_accvgpr_write_b32 a213, v25
  v_add_u32 v25, 30720, v24
  v_accvgpr_write_b32 a214, v25
  v_add_u32 v25, 46080, v24
  v_accvgpr_write_b32 a215, v25
  v_accvgpr_write_b32 a236, 0
  v_mov_b32 v27, 0x3f803f80
  v_accvgpr_write_b32 a208, v27
  v_accvgpr_write_b32 a237, 0
  v_accvgpr_write_b32 a209, v27
  v_accvgpr_write_b32 a238, 0
  v_accvgpr_write_b32 a210, v27
  v_accvgpr_write_b32 a239, 0
  v_accvgpr_write_b32 a211, v27
  v_lshrrev_b32 v24, 3, v1
  v_and_b32 v25, 6, v24
  v_and_b32 v26, 7, v1
  v_xor_b32 v25, v25, v26
  v_lshlrev_b32 v25, 4, v25
  v_lshlrev_b32 v26, 2, v24
  v_add_u32 v26, s3, v26
  v_lshl_add_u32 v26, v26, 11, v25
  v_add_u32 v27, 0, v26
  v_accvgpr_write_b32 a222, v27
  v_add_u32 v27, 64512, v26
  v_accvgpr_write_b32 a223, v27
  v_add_u32 v27, 129024, v26
  v_accvgpr_write_b32 a224, v27
  v_add_u32 v27, 193536, v26
  v_accvgpr_write_b32 a225, v27
  v_lshrrev_b32 v26, 2, v24
  v_and_b32 v27, 3, v24
  v_lshl_add_u32 v26, v26, 3, v27
  s_and_b32 s4, s3, 1
  s_lshl_b32 s4, s4, 18
  s_lshr_b32 s5, s3, 1
  s_lshl_b32 s5, s5, 7
  s_add_u32 s4, s4, s5
  s_lshl_b32 s5, s24, 8
  s_add_u32 s4, s4, s5
  v_lshl_add_u32 v26, v26, 13, v25
  v_add_u32 v26, s4, v26
  v_add_u32 v27, 0, v26
  v_accvgpr_write_b32 a226, v27
  v_add_u32 v27, 130048, v26
  v_accvgpr_write_b32 a227, v27
  v_add_u32 v27, 30720, v26
  v_accvgpr_write_b32 a228, v27
  v_add_u32 v27, 160768, v26
  v_accvgpr_write_b32 a229, v27
  s_lshl_b32 s4, s3, 13
  s_add_u32 s4, s4, 98304
  v_and_b32 v24, 15, v1
  v_lshlrev_b32 v24, 7, v24
  v_lshrrev_b32 v25, 4, v1
  v_and_b32 v26, 6, v1
  v_xor_b32 v25, v25, v26
  v_lshl_add_u32 v24, v25, 4, v24
  v_add_u32 v28, s4, v24
  v_xor_b32 v29, 64, v28
  v_lshrrev_b32 v24, 2, v1
  v_and_b32 v25, 6, v24
  v_lshlrev_b32 v24, 7, v24
  v_and_b32 v26, 1, v1
  v_lshl_add_u32 v24, v26, 3, v24
  v_add_u32 v24, 0, v24
  v_bfe_u32 v26, v1, 1, 1
  v_xor_b32 v25, v25, v26
  v_xor_b32 v26, 0, v25
  v_lshl_add_u32 v30, v26, 4, v24
  v_xor_b32 v26, 2, v25
  v_lshl_add_u32 v31, v26, 4, v24
  v_xor_b32 v26, 4, v25
  v_lshl_add_u32 v32, v26, 4, v24
  v_xor_b32 v26, 6, v25
  v_lshl_add_u32 v33, v26, 4, v24
  v_accvgpr_write_b32 a230, v28
  v_accvgpr_write_b32 a231, v29
  v_accvgpr_write_b32 a232, v30
  v_accvgpr_write_b32 a233, v31
  v_accvgpr_write_b32 a234, v32
  v_accvgpr_write_b32 a235, v33
  v_and_b32 v253, 15, v1
  v_lshrrev_b32 v254, 4, v1
  v_lshlrev_b32 v254, 2, v254
  v_sub_u32 v253, v253, v254
  v_mov_b32 v254, 0xf149f2ca
  s_lshr_b32 s4, s3, 1
  s_or_b32 s4, s4, s32
  s_cselect_b64 s[6:7], 0, -1
  v_subrev_u32 v255, 0, v253
  v_and_b32 v252, 0x80000001, v255
  v_cmp_ne_u32 vcc, 0, v252
  s_nop 1
  v_cndmask_b32 v244, 0, v254, vcc
  v_add_u32 v255, 1, v255
  v_and_b32 v252, 0x80000001, v255
  v_cmp_ne_u32 vcc, 0x80000001, v252
  s_nop 1
  v_cndmask_b32 v240, 0, v254, vcc
  v_cndmask_b32 v248, v240, v254, s[6:7]
  v_subrev_u32 v255, 1, v253
  v_and_b32 v252, 0x80000001, v255
  v_cmp_ne_u32 vcc, 0, v252
  s_nop 1
  v_cndmask_b32 v245, 0, v254, vcc
  v_add_u32 v255, 1, v255
  v_and_b32 v252, 0x80000001, v255
  v_cmp_ne_u32 vcc, 0x80000001, v252
  s_nop 1
  v_cndmask_b32 v241, 0, v254, vcc
  v_cndmask_b32 v249, v241, v254, s[6:7]
  v_subrev_u32 v255, 2, v253
  v_and_b32 v252, 0x80000001, v255
  v_cmp_ne_u32 vcc, 0, v252
  s_nop 1
  v_cndmask_b32 v246, 0, v254, vcc
  v_add_u32 v255, 1, v255
  v_and_b32 v252, 0x80000001, v255
  v_cmp_ne_u32 vcc, 0x80000001, v252
  s_nop 1
  v_cndmask_b32 v242, 0, v254, vcc
  v_cndmask_b32 v250, v242, v254, s[6:7]
  v_subrev_u32 v255, 3, v253
  v_and_b32 v252, 0x80000001, v255
  v_cmp_ne_u32 vcc, 0, v252
  s_nop 1
  v_cndmask_b32 v247, 0, v254, vcc
  v_add_u32 v255, 1, v255
  v_and_b32 v252, 0x80000001, v255
  v_cmp_ne_u32 vcc, 0x80000001, v252
  s_nop 1
  v_cndmask_b32 v243, 0, v254, vcc
  v_cndmask_b32 v251, v243, v254, s[6:7]
  s_and_b32 s4, s3, 1
  s_lshl_b32 s4, s4, 12
  s_add_u32 s4, s4, 49152
  v_add_u32 v252, s4, v2
  s_lshr_b32 s5, s3, 1
  s_lshl_b32 s5, s5, 11
  v_add_u32 v253, s5, v252
  s_add_u32 s16, s86, 83886080
  s_addc_u32 s17, s87, 0
  s_mov_b32 s18, 4194304
  s_mov_b32 s19, 0x00020000
  s_lshl_b32 s57, s32, 19
  s_lshl_b32 s5, s5, 7
  s_add_u32 s57, s57, s5
  s_lshl_b32 s4, s33, 14
  s_add_u32 s57, s57, s4
  s_and_b32 s4, s3, 1
  s_lshl_b32 s4, s4, 13
  s_add_u32 s57, s57, s4
  s_add_u32 s58, s57, 4096
  s_mov_b32 s37, 0
  s_mov_b32 s39, 4294897664
  s_mov_b32 s40, 34816
  s_mov_b32 s42, 0
  s_mov_b32 s44, 4294942720
  s_mov_b32 s45, 24576
  s_mov_b32 s43, s44
  s_mov_b32 s52, s72
  s_mov_b32 s53, s73
  s_mov_b32 s54, 4194304
  s_mov_b32 s55, 0x00020000
  s_lshl_b32 s1, s51, 1
  s_mov_b32 s56, s51
  s_mov_b32 s0, 0
  s_waitcnt vmcnt(0)
  s_barrier
  ds_read_b128 a[0:3], v16 offset:0
  ds_read_b64_tr_b16 a[72:73], v20 offset:0
  ds_read_b64_tr_b16 a[74:75], v20 offset:2048
  ds_read_b128 a[4:7], v16 offset:2048
  ds_read_b128 a[8:11], v16 offset:4096
  ds_read_b128 a[12:15], v16 offset:6144
  ds_read_b128 a[16:19], v16 offset:8192
  ds_read_b128 a[20:23], v16 offset:10240
  ds_read_b128 a[24:27], v16 offset:12288
  ds_read_b128 a[28:31], v16 offset:14336
  ds_read_b64_tr_b16 a[76:77], v21 offset:0
  ds_read_b64_tr_b16 a[78:79], v21 offset:2048
  ds_read_b64_tr_b16 a[80:81], v20 offset:8192
  ds_read_b64_tr_b16 a[82:83], v20 offset:10240
  ds_read_b128 a[32:35], v18 offset:0
  ds_read_b64_tr_b16 a[84:85], v21 offset:8192
  ds_read_b64_tr_b16 a[86:87], v21 offset:10240
  ds_read_b64_tr_b16 a[88:89], v20 offset:16384
  ds_read_b64_tr_b16 a[90:91], v20 offset:18432
  ds_read_b64_tr_b16 a[92:93], v21 offset:16384
  ds_read_b64_tr_b16 a[94:95], v21 offset:18432
  s_waitcnt lgkmcnt(0)
  v_mfma_f32_16x16x32_bf16 v[24:27], a[72:75], a[0:3], 0
  s_add_u32 m0, s36, s50
  s_add_u32 m0, m0, 34816
  ds_read_b128 a[36:39], v17 offset:0
  v_mfma_f32_16x16x32_bf16 v[28:31], a[72:75], a[4:7], 0
  buffer_load_dwordx4 v232, s[8:11], s46 offen offset:0 lds
  v_mfma_f32_16x16x32_bf16 v[32:35], a[72:75], a[8:11], 0
  s_add_u32 m0, s36, 34816
  ds_read_b64_tr_b16 a[96:97], v20 offset:4096
  v_mfma_f32_16x16x32_bf16 v[36:39], a[72:75], a[12:15], 0
  buffer_load_dwordx4 v224, s[8:11], s46 offen offset:0 lds
  v_mfma_f32_16x16x32_bf16 v[40:43], a[72:75], a[16:19], 0
  buffer_load_dwordx4 v225, s[8:11], s46 offen offset:1024 lds
  v_mfma_f32_16x16x32_bf16 v[44:47], a[72:75], a[20:23], 0
  buffer_load_dwordx4 v226, s[8:11], s46 offen offset:2048 lds
  v_mfma_f32_16x16x32_bf16 v[48:51], a[72:75], a[24:27], 0
  ds_read_b64_tr_b16 a[98:99], v20 offset:6144
  ds_read_b128 a[40:43], v17 offset:2048
  v_mfma_f32_16x16x32_bf16 v[52:55], a[72:75], a[28:31], 0
  buffer_load_dwordx4 v227, s[8:11], s46 offen offset:3072 lds
  v_mfma_f32_16x16x32_bf16 v[56:59], a[76:79], a[0:3], 0
  s_add_u32 m0, s36, 38912
  ds_read_b128 a[44:47], v17 offset:4096
  v_mfma_f32_16x16x32_bf16 v[60:63], a[76:79], a[4:7], 0
  buffer_load_dwordx4 v228, s[8:11], s46 offen offset:0 lds
  v_mfma_f32_16x16x32_bf16 v[64:67], a[76:79], a[8:11], 0
  buffer_load_dwordx4 v229, s[8:11], s46 offen offset:1024 lds
  v_mfma_f32_16x16x32_bf16 v[68:71], a[76:79], a[12:15], 0
  ds_read_b128 a[48:51], v17 offset:6144
  ds_read_b128 a[52:55], v17 offset:8192
  v_mfma_f32_16x16x32_bf16 v[72:75], a[76:79], a[16:19], 0
  buffer_load_dwordx4 v230, s[8:11], s46 offen offset:2048 lds
  v_mfma_f32_16x16x32_bf16 v[76:79], a[76:79], a[20:23], 0
  ds_read_b128 a[56:59], v17 offset:10240
  v_mfma_f32_16x16x32_bf16 v[80:83], a[76:79], a[24:27], 0
  buffer_load_dwordx4 v231, s[8:11], s46 offen offset:3072 lds
  v_mfma_f32_16x16x32_bf16 v[84:87], a[76:79], a[28:31], 0
  s_mul_i32 s47, s48, 393216
  s_bfe_u32 s34, 0x302010e, s49
  s_add_u32 s48, s48, s34
  v_mfma_f32_16x16x32_bf16 v[88:91], a[80:83], a[0:3], 0
  s_add_u32 s49, s49, 8
  s_and_b32 s49, s49, 0x8001f
  s_and_b32 s48, s48, 15
  v_mfma_f32_16x16x32_bf16 v[92:95], a[80:83], a[4:7], 0
  s_lshl_b32 s46, s48, 7
  s_add_u32 m0, s41, 24576
  ds_read_b128 a[60:63], v17 offset:12288
  v_mfma_f32_16x16x32_bf16 v[96:99], a[80:83], a[8:11], 0
  buffer_load_dwordx4 v233, s[12:15], s47 offen offset:0 lds
  v_mfma_f32_16x16x32_bf16 v[100:103], a[80:83], a[12:15], 0
  buffer_load_dwordx4 v234, s[12:15], s47 offen offset:1024 lds
  v_mfma_f32_16x16x32_bf16 v[104:107], a[80:83], a[16:19], 0
  buffer_load_dwordx4 v235, s[12:15], s47 offen offset:2048 lds
  v_mfma_f32_16x16x32_bf16 v[108:111], a[80:83], a[20:23], 0
  s_add_u32 m0, s41, 27648
  ds_read_b128 a[64:67], v17 offset:14336
  ds_read_b64_tr_b16 a[100:101], v21 offset:4096
  v_mfma_f32_16x16x32_bf16 v[112:115], a[80:83], a[24:27], 0
  buffer_load_dwordx4 v236, s[12:15], s47 offen offset:0 lds
  v_mfma_f32_16x16x32_bf16 v[116:119], a[80:83], a[28:31], 0
  buffer_load_dwordx4 v237, s[12:15], s47 offen offset:1024 lds
  v_mfma_f32_16x16x32_bf16 v[216:219], a[80:83], a[32:35], 0
  ds_read_b64_tr_b16 a[102:103], v21 offset:6144
  ds_read_b64_tr_b16 a[104:105], v20 offset:12288
  v_mfma_f32_16x16x32_bf16 v[120:123], a[84:87], a[0:3], 0
  buffer_load_dwordx4 v238, s[12:15], s47 offen offset:2048 lds
  v_mfma_f32_16x16x32_bf16 v[124:127], a[84:87], a[4:7], 0
  s_add_u32 m0, s36, s50
  s_add_u32 m0, m0, 69632
  ds_read_b64_tr_b16 a[106:107], v20 offset:14336
  v_mfma_f32_16x16x32_bf16 v[128:131], a[84:87], a[8:11], 0
  buffer_load_dwordx4 v232, s[8:11], s46 offen offset:0 lds
  v_mfma_f32_16x16x32_bf16 v[132:135], a[84:87], a[12:15], 0
  s_add_u32 m0, s36, 69632
  ds_read_b128 a[68:71], v19 offset:0
  ds_read_b64_tr_b16 a[108:109], v21 offset:12288
  v_mfma_f32_16x16x32_bf16 v[136:139], a[84:87], a[16:19], 0
  buffer_load_dwordx4 v224, s[8:11], s46 offen offset:0 lds
  v_mfma_f32_16x16x32_bf16 v[140:143], a[84:87], a[20:23], 0
  buffer_load_dwordx4 v225, s[8:11], s46 offen offset:1024 lds
  v_mfma_f32_16x16x32_bf16 v[144:147], a[84:87], a[24:27], 0
  ds_read_b64_tr_b16 a[110:111], v21 offset:14336
  v_mfma_f32_16x16x32_bf16 v[148:151], a[84:87], a[28:31], 0
  buffer_load_dwordx4 v226, s[8:11], s46 offen offset:2048 lds
  v_mfma_f32_16x16x32_bf16 v[220:223], a[84:87], a[32:35], 0
  ds_read_b64_tr_b16 a[112:113], v20 offset:20480
  v_mfma_f32_16x16x32_bf16 v[152:155], a[0:3], a[88:91], 0
  buffer_load_dwordx4 v227, s[8:11], s46 offen offset:3072 lds
  v_mfma_f32_16x16x32_bf16 v[156:159], a[4:7], a[88:91], 0
  s_add_u32 m0, s36, 73728
  ds_read_b64_tr_b16 a[114:115], v20 offset:22528
  v_mfma_f32_16x16x32_bf16 v[160:163], a[8:11], a[88:91], 0
  buffer_load_dwordx4 v228, s[8:11], s46 offen offset:0 lds
  v_mfma_f32_16x16x32_bf16 v[164:167], a[12:15], a[88:91], 0
  buffer_load_dwordx4 v229, s[8:11], s46 offen offset:1024 lds
  v_mfma_f32_16x16x32_bf16 v[168:171], a[16:19], a[88:91], 0
  s_add_u32 s37, s37, 1
  ds_read_b64_tr_b16 a[116:117], v21 offset:20480
  ds_read_b64_tr_b16 a[118:119], v21 offset:22528
  v_mfma_f32_16x16x32_bf16 v[172:175], a[20:23], a[88:91], 0
  buffer_load_dwordx4 v230, s[8:11], s46 offen offset:2048 lds
  v_mfma_f32_16x16x32_bf16 v[176:179], a[24:27], a[88:91], 0
  s_cmp_eq_u32 s37, 3
  s_cselect_b32 s37, 0, s37
  s_cselect_b32 s38, s39, s40
  v_mfma_f32_16x16x32_bf16 v[180:183], a[28:31], a[88:91], 0
  buffer_load_dwordx4 v231, s[8:11], s46 offen offset:3072 lds
  v_mfma_f32_16x16x32_bf16 v[184:187], a[0:3], a[92:95], 0
  s_sub_u32 s43, 0, s43
  v_mfma_f32_16x16x32_bf16 v[188:191], a[4:7], a[92:95], 0
  s_mul_i32 s47, s48, 393216
  v_add_u32 v16, s38, v16
  v_add_u32 v17, s38, v17
  v_mfma_f32_16x16x32_bf16 v[192:195], a[8:11], a[92:95], 0
  s_bfe_u32 s34, 0x302010e, s49
  v_add_u32 v18, s38, v18
  v_add_u32 v19, s38, v19
  v_mfma_f32_16x16x32_bf16 v[196:199], a[12:15], a[92:95], 0
  s_add_u32 s48, s48, s34
  s_add_u32 s49, s49, 8
  v_add_u32 v20, s43, v20
  v_mfma_f32_16x16x32_bf16 v[200:203], a[16:19], a[92:95], 0
  s_and_b32 s49, s49, 0x8001f
  s_and_b32 s48, s48, 15
  s_lshl_b32 s46, s48, 7
  v_mfma_f32_16x16x32_bf16 v[204:207], a[20:23], a[92:95], 0
  v_add_u32 v21, s43, v21
  v_mfma_f32_16x16x32_bf16 v[208:211], a[24:27], a[92:95], 0
  v_mfma_f32_16x16x32_bf16 v[212:215], a[28:31], a[92:95], 0
  s_mov_b32 s35, 13
  s_waitcnt vmcnt(9) lgkmcnt(0)
  s_barrier
  .p2align 6
Lp2r0_loop:
  v_mfma_f32_16x16x32_bf16 v[24:27], a[96:99], a[36:39], v[24:27]
  buffer_load_dwordx4 a[192:195], v2, s[52:55], s51 offen offset:0
  v_mfma_f32_16x16x32_bf16 v[28:31], a[96:99], a[40:43], v[28:31]
  ds_read_b128 a[0:3], v16 offset:0
  ds_read_b64_tr_b16 a[72:73], v20 offset:0
  v_mfma_f32_16x16x32_bf16 v[32:35], a[96:99], a[44:47], v[32:35]
  v_mfma_f32_16x16x32_bf16 v[36:39], a[96:99], a[48:51], v[36:39]
  ds_read_b64_tr_b16 a[74:75], v20 offset:2048
  v_mfma_f32_16x16x32_bf16 v[40:43], a[96:99], a[52:55], v[40:43]
  buffer_load_dwordx4 a[192:195], v2, s[52:55], s51 offen offset:1024
  v_mfma_f32_16x16x32_bf16 v[44:47], a[96:99], a[56:59], v[44:47]
  ds_read_b128 a[4:7], v16 offset:2048
  v_mfma_f32_16x16x32_bf16 v[48:51], a[96:99], a[60:63], v[48:51]
  v_mfma_f32_16x16x32_bf16 v[52:55], a[96:99], a[64:67], v[52:55]
  ds_read_b128 a[8:11], v16 offset:4096
  v_mfma_f32_16x16x32_bf16 v[56:59], a[100:103], a[36:39], v[56:59]
  v_mfma_f32_16x16x32_bf16 v[60:63], a[100:103], a[40:43], v[60:63]
  buffer_load_dwordx4 a[192:195], v2, s[52:55], s51 offen offset:2048
  v_mfma_f32_16x16x32_bf16 v[64:67], a[100:103], a[44:47], v[64:67]
  ds_read_b128 a[12:15], v16 offset:6144
  v_mfma_f32_16x16x32_bf16 v[68:71], a[100:103], a[48:51], v[68:71]
  ds_read_b128 a[16:19], v16 offset:8192
  v_mfma_f32_16x16x32_bf16 v[72:75], a[100:103], a[52:55], v[72:75]
  v_mfma_f32_16x16x32_bf16 v[76:79], a[100:103], a[56:59], v[76:79]
  ds_read_b128 a[20:23], v16 offset:10240
  v_mfma_f32_16x16x32_bf16 v[80:83], a[100:103], a[60:63], v[80:83]
  buffer_load_dwordx4 a[192:195], v2, s[52:55], s51 offen offset:3072
  v_mfma_f32_16x16x32_bf16 v[84:87], a[100:103], a[64:67], v[84:87]
  s_add_u32 s51, s51, 4096
  s_add_u32 s0, s0, 1
  s_cmp_eq_u32 s0, 2
  s_cselect_b32 s52, s68, s52
  s_cselect_b32 s53, s69, s53
  s_cselect_b32 s51, s1, s51
  s_cselect_b32 s54, 0, s54
  v_mfma_f32_16x16x32_bf16 v[88:91], a[104:107], a[36:39], v[88:91]
  s_cmp_eq_u32 s0, 6
  s_cselect_b32 s52, s64, s52
  s_cselect_b32 s53, s65, s53
  s_cselect_b32 s51, s56, s51
  s_cselect_b32 s54, 0, s54
  v_mfma_f32_16x16x32_bf16 v[92:95], a[104:107], a[40:43], v[92:95]
  s_cmp_eq_u32 s0, 8
  s_cselect_b32 s54, 0, s54
  s_mov_b32 m0, s41
  v_mfma_f32_16x16x32_bf16 v[96:99], a[104:107], a[44:47], v[96:99]
  ds_read_b128 a[24:27], v16 offset:12288
  ds_read_b128 a[28:31], v16 offset:14336
  v_mfma_f32_16x16x32_bf16 v[100:103], a[104:107], a[48:51], v[100:103]
  buffer_load_dwordx4 v233, s[12:15], s47 offen offset:0 lds
  v_mfma_f32_16x16x32_bf16 v[104:107], a[104:107], a[52:55], v[104:107]
  ds_read_b64_tr_b16 a[76:77], v21 offset:0
  ds_read_b64_tr_b16 a[78:79], v21 offset:2048
  v_mfma_f32_16x16x32_bf16 v[108:111], a[104:107], a[56:59], v[108:111]
  v_mfma_f32_16x16x32_bf16 v[112:115], a[104:107], a[60:63], v[112:115]
  ds_read_b64_tr_b16 a[80:81], v20 offset:8192
  v_mfma_f32_16x16x32_bf16 v[116:119], a[104:107], a[64:67], v[116:119]
  v_mfma_f32_16x16x32_bf16 v[216:219], a[104:107], a[68:71], v[216:219]
  buffer_load_dwordx4 v234, s[12:15], s47 offen offset:1024 lds
  v_mfma_f32_16x16x32_bf16 v[120:123], a[108:111], a[36:39], v[120:123]
  ds_read_b64_tr_b16 a[82:83], v20 offset:10240
  v_mfma_f32_16x16x32_bf16 v[124:127], a[108:111], a[40:43], v[124:127]
  ds_read_b128 a[32:35], v18 offset:0
  v_mfma_f32_16x16x32_bf16 v[128:131], a[108:111], a[44:47], v[128:131]
  v_mfma_f32_16x16x32_bf16 v[132:135], a[108:111], a[48:51], v[132:135]
  ds_read_b64_tr_b16 a[84:85], v21 offset:8192
  v_mfma_f32_16x16x32_bf16 v[136:139], a[108:111], a[52:55], v[136:139]
  buffer_load_dwordx4 v235, s[12:15], s47 offen offset:2048 lds
  v_mfma_f32_16x16x32_bf16 v[140:143], a[108:111], a[56:59], v[140:143]
  s_add_u32 m0, s41, 3072
  ds_read_b64_tr_b16 a[86:87], v21 offset:10240
  v_mfma_f32_16x16x32_bf16 v[144:147], a[108:111], a[60:63], v[144:147]
  v_mfma_f32_16x16x32_bf16 v[148:151], a[108:111], a[64:67], v[148:151]
  ds_read_b64_tr_b16 a[88:89], v20 offset:16384
  v_mfma_f32_16x16x32_bf16 v[220:223], a[108:111], a[68:71], v[220:223]
  v_mfma_f32_16x16x32_bf16 v[152:155], a[36:39], a[112:115], v[152:155]
  buffer_load_dwordx4 v236, s[12:15], s47 offen offset:0 lds
  v_mfma_f32_16x16x32_bf16 v[156:159], a[40:43], a[112:115], v[156:159]
  ds_read_b64_tr_b16 a[90:91], v20 offset:18432
  v_mfma_f32_16x16x32_bf16 v[160:163], a[44:47], a[112:115], v[160:163]
  ds_read_b64_tr_b16 a[92:93], v21 offset:16384
  v_mfma_f32_16x16x32_bf16 v[164:167], a[48:51], a[112:115], v[164:167]
  v_mfma_f32_16x16x32_bf16 v[168:171], a[52:55], a[112:115], v[168:171]
  ds_read_b64_tr_b16 a[94:95], v21 offset:18432
  v_mfma_f32_16x16x32_bf16 v[172:175], a[56:59], a[112:115], v[172:175]
  buffer_load_dwordx4 v237, s[12:15], s47 offen offset:1024 lds
  v_mfma_f32_16x16x32_bf16 v[176:179], a[60:63], a[112:115], v[176:179]
  v_mfma_f32_16x16x32_bf16 v[180:183], a[64:67], a[112:115], v[180:183]
  v_mfma_f32_16x16x32_bf16 v[184:187], a[36:39], a[116:119], v[184:187]
  v_mfma_f32_16x16x32_bf16 v[188:191], a[40:43], a[116:119], v[188:191]
  v_mfma_f32_16x16x32_bf16 v[192:195], a[44:47], a[116:119], v[192:195]
  buffer_load_dwordx4 v238, s[12:15], s47 offen offset:2048 lds
  v_mfma_f32_16x16x32_bf16 v[196:199], a[48:51], a[116:119], v[196:199]
  v_mfma_f32_16x16x32_bf16 v[200:203], a[52:55], a[116:119], v[200:203]
  v_mfma_f32_16x16x32_bf16 v[204:207], a[56:59], a[116:119], v[204:207]
  v_mfma_f32_16x16x32_bf16 v[208:211], a[60:63], a[116:119], v[208:211]
  v_mfma_f32_16x16x32_bf16 v[212:215], a[64:67], a[116:119], v[212:215]
  s_waitcnt lgkmcnt(0)
  v_mfma_f32_16x16x32_bf16 v[24:27], a[72:75], a[0:3], v[24:27]
  s_add_u32 m0, s36, s50
  ds_read_b128 a[36:39], v17 offset:0
  v_mfma_f32_16x16x32_bf16 v[28:31], a[72:75], a[4:7], v[28:31]
  buffer_load_dwordx4 v232, s[8:11], s46 offen offset:0 lds
  v_mfma_f32_16x16x32_bf16 v[32:35], a[72:75], a[8:11], v[32:35]
  s_mov_b32 m0, s36
  ds_read_b64_tr_b16 a[96:97], v20 offset:4096
  v_mfma_f32_16x16x32_bf16 v[36:39], a[72:75], a[12:15], v[36:39]
  ds_read_b64_tr_b16 a[98:99], v20 offset:6144
  v_mfma_f32_16x16x32_bf16 v[40:43], a[72:75], a[16:19], v[40:43]
  buffer_load_dwordx4 v224, s[8:11], s46 offen offset:0 lds
  v_mfma_f32_16x16x32_bf16 v[44:47], a[72:75], a[20:23], v[44:47]
  ds_read_b128 a[40:43], v17 offset:2048
  v_mfma_f32_16x16x32_bf16 v[48:51], a[72:75], a[24:27], v[48:51]
  v_mfma_f32_16x16x32_bf16 v[52:55], a[72:75], a[28:31], v[52:55]
  ds_read_b128 a[44:47], v17 offset:4096
  v_mfma_f32_16x16x32_bf16 v[56:59], a[76:79], a[0:3], v[56:59]
  v_mfma_f32_16x16x32_bf16 v[60:63], a[76:79], a[4:7], v[60:63]
  buffer_load_dwordx4 v225, s[8:11], s46 offen offset:1024 lds
  v_mfma_f32_16x16x32_bf16 v[64:67], a[76:79], a[8:11], v[64:67]
  ds_read_b128 a[48:51], v17 offset:6144
  v_mfma_f32_16x16x32_bf16 v[68:71], a[76:79], a[12:15], v[68:71]
  ds_read_b128 a[52:55], v17 offset:8192
  v_mfma_f32_16x16x32_bf16 v[72:75], a[76:79], a[16:19], v[72:75]
  v_mfma_f32_16x16x32_bf16 v[76:79], a[76:79], a[20:23], v[76:79]
  ds_read_b128 a[56:59], v17 offset:10240
  v_mfma_f32_16x16x32_bf16 v[80:83], a[76:79], a[24:27], v[80:83]
  buffer_load_dwordx4 v226, s[8:11], s46 offen offset:2048 lds
  v_mfma_f32_16x16x32_bf16 v[84:87], a[76:79], a[28:31], v[84:87]
  ds_read_b128 a[60:63], v17 offset:12288
  v_mfma_f32_16x16x32_bf16 v[88:91], a[80:83], a[0:3], v[88:91]
  v_mfma_f32_16x16x32_bf16 v[92:95], a[80:83], a[4:7], v[92:95]
  ds_read_b128 a[64:67], v17 offset:14336
  v_mfma_f32_16x16x32_bf16 v[96:99], a[80:83], a[8:11], v[96:99]
  v_mfma_f32_16x16x32_bf16 v[100:103], a[80:83], a[12:15], v[100:103]
  buffer_load_dwordx4 v227, s[8:11], s46 offen offset:3072 lds
  v_mfma_f32_16x16x32_bf16 v[104:107], a[80:83], a[16:19], v[104:107]
  s_add_u32 m0, s36, 4096
  ds_read_b64_tr_b16 a[100:101], v21 offset:4096
  ds_read_b64_tr_b16 a[102:103], v21 offset:6144
  v_mfma_f32_16x16x32_bf16 v[108:111], a[80:83], a[20:23], v[108:111]
  s_add_u32 s36, s36, s38
  v_mfma_f32_16x16x32_bf16 v[112:115], a[80:83], a[24:27], v[112:115]
  s_add_u32 s37, s37, 1
  ds_read_b64_tr_b16 a[104:105], v20 offset:12288
  v_mfma_f32_16x16x32_bf16 v[116:119], a[80:83], a[28:31], v[116:119]
  buffer_load_dwordx4 v228, s[8:11], s46 offen offset:0 lds
  v_mfma_f32_16x16x32_bf16 v[216:219], a[80:83], a[32:35], v[216:219]
  ds_read_b64_tr_b16 a[106:107], v20 offset:14336
  v_mfma_f32_16x16x32_bf16 v[120:123], a[84:87], a[0:3], v[120:123]
  s_cmp_eq_u32 s37, 3
  s_cselect_b32 s37, 0, s37
  s_cselect_b32 s38, s39, s40
  v_mfma_f32_16x16x32_bf16 v[124:127], a[84:87], a[4:7], v[124:127]
  s_add_u32 s41, s41, s43
  ds_read_b128 a[68:71], v19 offset:0
  v_mfma_f32_16x16x32_bf16 v[128:131], a[84:87], a[8:11], v[128:131]
  s_sub_u32 s43, 0, s43
  v_mfma_f32_16x16x32_bf16 v[132:135], a[84:87], a[12:15], v[132:135]
  buffer_load_dwordx4 v229, s[8:11], s46 offen offset:1024 lds
  v_mfma_f32_16x16x32_bf16 v[136:139], a[84:87], a[16:19], v[136:139]
  ds_read_b64_tr_b16 a[108:109], v21 offset:12288
  v_mfma_f32_16x16x32_bf16 v[140:143], a[84:87], a[20:23], v[140:143]
  ds_read_b64_tr_b16 a[110:111], v21 offset:14336
  v_mfma_f32_16x16x32_bf16 v[144:147], a[84:87], a[24:27], v[144:147]
  v_mfma_f32_16x16x32_bf16 v[148:151], a[84:87], a[28:31], v[148:151]
  ds_read_b64_tr_b16 a[112:113], v20 offset:20480
  v_mfma_f32_16x16x32_bf16 v[220:223], a[84:87], a[32:35], v[220:223]
  buffer_load_dwordx4 v230, s[8:11], s46 offen offset:2048 lds
  v_mfma_f32_16x16x32_bf16 v[152:155], a[0:3], a[88:91], v[152:155]
  ds_read_b64_tr_b16 a[114:115], v20 offset:22528
  v_mfma_f32_16x16x32_bf16 v[156:159], a[4:7], a[88:91], v[156:159]
  v_mfma_f32_16x16x32_bf16 v[160:163], a[8:11], a[88:91], v[160:163]
  ds_read_b64_tr_b16 a[116:117], v21 offset:20480
  v_mfma_f32_16x16x32_bf16 v[164:167], a[12:15], a[88:91], v[164:167]
  v_mfma_f32_16x16x32_bf16 v[168:171], a[16:19], a[88:91], v[168:171]
  buffer_load_dwordx4 v231, s[8:11], s46 offen offset:3072 lds
  v_mfma_f32_16x16x32_bf16 v[172:175], a[20:23], a[88:91], v[172:175]
  s_mul_i32 s47, s48, 393216
  ds_read_b64_tr_b16 a[118:119], v21 offset:22528
  v_mfma_f32_16x16x32_bf16 v[176:179], a[24:27], a[88:91], v[176:179]
  s_bfe_u32 s34, 0x302010e, s49
  v_add_u32 v16, s38, v16
  v_add_u32 v17, s38, v17
  v_mfma_f32_16x16x32_bf16 v[180:183], a[28:31], a[88:91], v[180:183]
  s_add_u32 s48, s48, s34
  v_add_u32 v18, s38, v18
  v_add_u32 v19, s38, v19
  v_mfma_f32_16x16x32_bf16 v[184:187], a[0:3], a[92:95], v[184:187]
  s_add_u32 s49, s49, 8
  v_add_u32 v20, s43, v20
  v_add_u32 v21, s43, v21
  v_mfma_f32_16x16x32_bf16 v[188:191], a[4:7], a[92:95], v[188:191]
  s_and_b32 s49, s49, 0x8001f
  v_mfma_f32_16x16x32_bf16 v[192:195], a[8:11], a[92:95], v[192:195]
  s_and_b32 s48, s48, 15
  v_mfma_f32_16x16x32_bf16 v[196:199], a[12:15], a[92:95], v[196:199]
  s_lshl_b32 s46, s48, 7
  v_mfma_f32_16x16x32_bf16 v[200:203], a[16:19], a[92:95], v[200:203]
  v_mfma_f32_16x16x32_bf16 v[204:207], a[20:23], a[92:95], v[204:207]
  s_waitcnt vmcnt(9) lgkmcnt(0)
  s_barrier
  v_mfma_f32_16x16x32_bf16 v[208:211], a[24:27], a[92:95], v[208:211]
  s_sub_u32 s35, s35, 1
  v_mfma_f32_16x16x32_bf16 v[212:215], a[28:31], a[92:95], v[212:215]
  s_cmp_lg_u32 s35, 0
  s_cbranch_scc1 Lp2r0_loop
  v_accvgpr_read_b32 v4, a222
  v_accvgpr_read_b32 v5, a223
  v_accvgpr_read_b32 v6, a224
  v_accvgpr_read_b32 v7, a225
  v_accvgpr_read_b32 v8, a226
  v_accvgpr_read_b32 v9, a227
  v_accvgpr_read_b32 v10, a228
  v_accvgpr_read_b32 v11, a229
  s_mov_b32 s8, s64
  s_mov_b32 s9, s65
  s_mov_b32 s10, 4194304
  s_mov_b32 s11, 0x00020000
  s_mov_b32 s20, s68
  s_mov_b32 s21, s69
  s_mov_b32 s22, 8388608
  s_mov_b32 s23, 0x00020000
  s_and_b32 s4, s2, 7
  s_lshl_b32 s4, s4, 1
  s_lshr_b32 s5, s2, 6
  s_lshr_b32 s30, s2, 4
  s_add_u32 s5, s5, s30
  s_and_b32 s53, s5, 3
  s_lshl_b32 s53, s53, 3
  s_or_b32 s53, s53, 0x80000
  s_bfe_u32 s52, 0xf0f02, s53
  s_add_u32 s52, s52, s4
  s_and_b32 s52, s52, 15
  s_mov_b32 s54, s52
  s_mov_b32 s55, s53
  s_lshl_b32 s29, s52, 7
  s_lshl_b32 s28, s54, 19
  s_lshl_b32 s30, s25, 18
  s_and_b32 s31, s25, 1
  s_lshl_b32 s31, s31, 1
  s_add_u32 s31, s31, 14
  s_sub_u32 s31, s31, s25
  s_lshl_b32 s31, s31, 18
  s_or_b32 s26, s30, s29
  s_or_b32 s27, s31, s29
  s_lshl_b32 s68, s3, 12
  s_lshl_b32 s88, s3, 13
  s_add_u32 s88, s88, 98304
  v_mfma_f32_16x16x32_bf16 v[24:27], a[96:99], a[36:39], v[24:27]
  s_mov_b32 m0, s41
  ds_read_b128 a[0:3], v16 offset:0
  v_mfma_f32_16x16x32_bf16 v[28:31], a[96:99], a[40:43], v[28:31]
  buffer_load_dwordx4 v233, s[12:15], s47 offen offset:0 lds
  v_mfma_f32_16x16x32_bf16 v[32:35], a[96:99], a[44:47], v[32:35]
  ds_read_b64_tr_b16 a[72:73], v20 offset:0
  v_mfma_f32_16x16x32_bf16 v[36:39], a[96:99], a[48:51], v[36:39]
  ds_read_b64_tr_b16 a[74:75], v20 offset:2048
  v_mfma_f32_16x16x32_bf16 v[40:43], a[96:99], a[52:55], v[40:43]
  v_mfma_f32_16x16x32_bf16 v[44:47], a[96:99], a[56:59], v[44:47]
  ds_read_b128 a[4:7], v16 offset:2048
  v_mfma_f32_16x16x32_bf16 v[48:51], a[96:99], a[60:63], v[48:51]
  v_mfma_f32_16x16x32_bf16 v[52:55], a[96:99], a[64:67], v[52:55]
  ds_read_b128 a[8:11], v16 offset:4096
  v_mfma_f32_16x16x32_bf16 v[56:59], a[100:103], a[36:39], v[56:59]
  v_mfma_f32_16x16x32_bf16 v[60:63], a[100:103], a[40:43], v[60:63]
  ds_read_b128 a[12:15], v16 offset:6144
  v_mfma_f32_16x16x32_bf16 v[64:67], a[100:103], a[44:47], v[64:67]
  v_mfma_f32_16x16x32_bf16 v[68:71], a[100:103], a[48:51], v[68:71]
  ds_read_b128 a[16:19], v16 offset:8192
  v_mfma_f32_16x16x32_bf16 v[72:75], a[100:103], a[52:55], v[72:75]
  v_mfma_f32_16x16x32_bf16 v[76:79], a[100:103], a[56:59], v[76:79]
  ds_read_b128 a[20:23], v16 offset:10240
  v_mfma_f32_16x16x32_bf16 v[80:83], a[100:103], a[60:63], v[80:83]
  v_mfma_f32_16x16x32_bf16 v[84:87], a[100:103], a[64:67], v[84:87]
  ds_read_b128 a[24:27], v16 offset:12288
  v_mfma_f32_16x16x32_bf16 v[88:91], a[104:107], a[36:39], v[88:91]
  buffer_load_dwordx4 v234, s[12:15], s47 offen offset:1024 lds
  v_mfma_f32_16x16x32_bf16 v[92:95], a[104:107], a[40:43], v[92:95]
  ds_read_b128 a[28:31], v16 offset:14336
  v_mfma_f32_16x16x32_bf16 v[96:99], a[104:107], a[44:47], v[96:99]
  v_mfma_f32_16x16x32_bf16 v[100:103], a[104:107], a[48:51], v[100:103]
  ds_read_b64_tr_b16 a[76:77], v21 offset:0
  v_mfma_f32_16x16x32_bf16 v[104:107], a[104:107], a[52:55], v[104:107]
  ds_read_b64_tr_b16 a[78:79], v21 offset:2048
  v_mfma_f32_16x16x32_bf16 v[108:111], a[104:107], a[56:59], v[108:111]
  v_mfma_f32_16x16x32_bf16 v[112:115], a[104:107], a[60:63], v[112:115]
  ds_read_b64_tr_b16 a[80:81], v20 offset:8192
  v_mfma_f32_16x16x32_bf16 v[116:119], a[104:107], a[64:67], v[116:119]
  v_mfma_f32_16x16x32_bf16 v[216:219], a[104:107], a[68:71], v[216:219]
  ds_read_b64_tr_b16 a[82:83], v20 offset:10240
  v_mfma_f32_16x16x32_bf16 v[120:123], a[108:111], a[36:39], v[120:123]
  v_mfma_f32_16x16x32_bf16 v[124:127], a[108:111], a[40:43], v[124:127]
  ds_read_b128 a[32:35], v18 offset:0
  v_mfma_f32_16x16x32_bf16 v[128:131], a[108:111], a[44:47], v[128:131]
  v_mfma_f32_16x16x32_bf16 v[132:135], a[108:111], a[48:51], v[132:135]
  ds_read_b64_tr_b16 a[84:85], v21 offset:8192
  v_mfma_f32_16x16x32_bf16 v[136:139], a[108:111], a[52:55], v[136:139]
  v_mfma_f32_16x16x32_bf16 v[140:143], a[108:111], a[56:59], v[140:143]
  ds_read_b64_tr_b16 a[86:87], v21 offset:10240
  v_mfma_f32_16x16x32_bf16 v[144:147], a[108:111], a[60:63], v[144:147]
  v_mfma_f32_16x16x32_bf16 v[148:151], a[108:111], a[64:67], v[148:151]
  buffer_load_dwordx4 v235, s[12:15], s47 offen offset:2048 lds
  v_mfma_f32_16x16x32_bf16 v[220:223], a[108:111], a[68:71], v[220:223]
  ds_read_b64_tr_b16 a[88:89], v20 offset:16384
  v_mfma_f32_16x16x32_bf16 v[152:155], a[36:39], a[112:115], v[152:155]
  ds_read_b64_tr_b16 a[90:91], v20 offset:18432
  v_mfma_f32_16x16x32_bf16 v[156:159], a[40:43], a[112:115], v[156:159]
  v_mfma_f32_16x16x32_bf16 v[160:163], a[44:47], a[112:115], v[160:163]
  ds_read_b64_tr_b16 a[92:93], v21 offset:16384
  v_mfma_f32_16x16x32_bf16 v[164:167], a[48:51], a[112:115], v[164:167]
  v_mfma_f32_16x16x32_bf16 v[168:171], a[52:55], a[112:115], v[168:171]
  ds_read_b64_tr_b16 a[94:95], v21 offset:18432
  v_mfma_f32_16x16x32_bf16 v[172:175], a[56:59], a[112:115], v[172:175]
  v_mfma_f32_16x16x32_bf16 v[176:179], a[60:63], a[112:115], v[176:179]
  v_mfma_f32_16x16x32_bf16 v[180:183], a[64:67], a[112:115], v[180:183]
  v_mfma_f32_16x16x32_bf16 v[184:187], a[36:39], a[116:119], v[184:187]
  v_mfma_f32_16x16x32_bf16 v[188:191], a[40:43], a[116:119], v[188:191]
  v_mfma_f32_16x16x32_bf16 v[192:195], a[44:47], a[116:119], v[192:195]
  v_mfma_f32_16x16x32_bf16 v[196:199], a[48:51], a[116:119], v[196:199]
  v_mfma_f32_16x16x32_bf16 v[200:203], a[52:55], a[116:119], v[200:203]
  v_mfma_f32_16x16x32_bf16 v[204:207], a[56:59], a[116:119], v[204:207]
  v_mfma_f32_16x16x32_bf16 v[208:211], a[60:63], a[116:119], v[208:211]
  v_mfma_f32_16x16x32_bf16 v[212:215], a[64:67], a[116:119], v[212:215]
  s_waitcnt lgkmcnt(0)
  v_mfma_f32_16x16x32_bf16 v[24:27], a[72:75], a[0:3], v[24:27]
  s_add_u32 m0, s41, 3072
  ds_read_b128 a[36:39], v17 offset:0
  v_mfma_f32_16x16x32_bf16 v[28:31], a[72:75], a[4:7], v[28:31]
  buffer_load_dwordx4 v236, s[12:15], s47 offen offset:0 lds
  v_mfma_f32_16x16x32_bf16 v[32:35], a[72:75], a[8:11], v[32:35]
  s_add_u32 s36, s36, s38
  ds_read_b64_tr_b16 a[96:97], v20 offset:4096
  v_mfma_f32_16x16x32_bf16 v[36:39], a[72:75], a[12:15], v[36:39]
  s_add_u32 s37, s37, 1
  ds_read_b64_tr_b16 a[98:99], v20 offset:6144
  v_mfma_f32_16x16x32_bf16 v[40:43], a[72:75], a[16:19], v[40:43]
  s_cmp_eq_u32 s37, 3
  s_cselect_b32 s37, 0, s37
  s_cselect_b32 s38, s39, s40
  v_mfma_f32_16x16x32_bf16 v[44:47], a[72:75], a[20:23], v[44:47]
  s_add_u32 s41, s41, s43
  ds_read_b128 a[40:43], v17 offset:2048
  v_mfma_f32_16x16x32_bf16 v[48:51], a[72:75], a[24:27], v[48:51]
  s_sub_u32 s43, 0, s43
  v_mfma_f32_16x16x32_bf16 v[52:55], a[72:75], a[28:31], v[52:55]
  ds_read_b128 a[44:47], v17 offset:4096
  v_mfma_f32_16x16x32_bf16 v[56:59], a[76:79], a[0:3], v[56:59]
  v_mfma_f32_16x16x32_bf16 v[60:63], a[76:79], a[4:7], v[60:63]
  ds_read_b128 a[48:51], v17 offset:6144
  v_mfma_f32_16x16x32_bf16 v[64:67], a[76:79], a[8:11], v[64:67]
  v_mfma_f32_16x16x32_bf16 v[68:71], a[76:79], a[12:15], v[68:71]
  ds_read_b128 a[52:55], v17 offset:8192
  v_mfma_f32_16x16x32_bf16 v[72:75], a[76:79], a[16:19], v[72:75]
  v_mfma_f32_16x16x32_bf16 v[76:79], a[76:79], a[20:23], v[76:79]
  ds_read_b128 a[56:59], v17 offset:10240
  v_mfma_f32_16x16x32_bf16 v[80:83], a[76:79], a[24:27], v[80:83]
  buffer_load_dwordx4 v237, s[12:15], s47 offen offset:1024 lds
  v_mfma_f32_16x16x32_bf16 v[84:87], a[76:79], a[28:31], v[84:87]
  ds_read_b128 a[60:63], v17 offset:12288
  v_mfma_f32_16x16x32_bf16 v[88:91], a[80:83], a[0:3], v[88:91]
  v_mfma_f32_16x16x32_bf16 v[92:95], a[80:83], a[4:7], v[92:95]
  ds_read_b128 a[64:67], v17 offset:14336
  v_mfma_f32_16x16x32_bf16 v[96:99], a[80:83], a[8:11], v[96:99]
  v_mfma_f32_16x16x32_bf16 v[100:103], a[80:83], a[12:15], v[100:103]
  ds_read_b64_tr_b16 a[100:101], v21 offset:4096
  v_mfma_f32_16x16x32_bf16 v[104:107], a[80:83], a[16:19], v[104:107]
  ds_read_b64_tr_b16 a[102:103], v21 offset:6144
  v_mfma_f32_16x16x32_bf16 v[108:111], a[80:83], a[20:23], v[108:111]
  v_mfma_f32_16x16x32_bf16 v[112:115], a[80:83], a[24:27], v[112:115]
  ds_read_b64_tr_b16 a[104:105], v20 offset:12288
  v_mfma_f32_16x16x32_bf16 v[116:119], a[80:83], a[28:31], v[116:119]
  v_mfma_f32_16x16x32_bf16 v[216:219], a[80:83], a[32:35], v[216:219]
  ds_read_b64_tr_b16 a[106:107], v20 offset:14336
  v_mfma_f32_16x16x32_bf16 v[120:123], a[84:87], a[0:3], v[120:123]
  v_mfma_f32_16x16x32_bf16 v[124:127], a[84:87], a[4:7], v[124:127]
  ds_read_b128 a[68:71], v19 offset:0
  v_mfma_f32_16x16x32_bf16 v[128:131], a[84:87], a[8:11], v[128:131]
  v_mfma_f32_16x16x32_bf16 v[132:135], a[84:87], a[12:15], v[132:135]
  buffer_load_dwordx4 v238, s[12:15], s47 offen offset:2048 lds
  v_mfma_f32_16x16x32_bf16 v[136:139], a[84:87], a[16:19], v[136:139]
  ds_read_b64_tr_b16 a[108:109], v21 offset:12288
  v_mfma_f32_16x16x32_bf16 v[140:143], a[84:87], a[20:23], v[140:143]
  ds_read_b64_tr_b16 a[110:111], v21 offset:14336
  v_mfma_f32_16x16x32_bf16 v[144:147], a[84:87], a[24:27], v[144:147]
  v_mfma_f32_16x16x32_bf16 v[148:151], a[84:87], a[28:31], v[148:151]
  ds_read_b64_tr_b16 a[112:113], v20 offset:20480
  v_mfma_f32_16x16x32_bf16 v[220:223], a[84:87], a[32:35], v[220:223]
  v_mfma_f32_16x16x32_bf16 v[152:155], a[0:3], a[88:91], v[152:155]
  ds_read_b64_tr_b16 a[114:115], v20 offset:22528
  v_mfma_f32_16x16x32_bf16 v[156:159], a[4:7], a[88:91], v[156:159]
  v_mfma_f32_16x16x32_bf16 v[160:163], a[8:11], a[88:91], v[160:163]
  ds_read_b64_tr_b16 a[116:117], v21 offset:20480
  v_mfma_f32_16x16x32_bf16 v[164:167], a[12:15], a[88:91], v[164:167]
  v_mfma_f32_16x16x32_bf16 v[168:171], a[16:19], a[88:91], v[168:171]
  ds_read_b64_tr_b16 a[118:119], v21 offset:22528
  v_mfma_f32_16x16x32_bf16 v[172:175], a[20:23], a[88:91], v[172:175]
  v_add_u32 v16, s38, v16
  v_add_u32 v17, s38, v17
  v_mfma_f32_16x16x32_bf16 v[176:179], a[24:27], a[88:91], v[176:179]
  v_add_u32 v18, s38, v18
  v_add_u32 v19, s38, v19
  v_mfma_f32_16x16x32_bf16 v[180:183], a[28:31], a[88:91], v[180:183]
  v_add_u32 v20, s43, v20
  v_add_u32 v21, s43, v21
  v_mfma_f32_16x16x32_bf16 v[184:187], a[0:3], a[92:95], v[184:187]
  v_mfma_f32_16x16x32_bf16 v[188:191], a[4:7], a[92:95], v[188:191]
  v_mfma_f32_16x16x32_bf16 v[192:195], a[8:11], a[92:95], v[192:195]
  v_mfma_f32_16x16x32_bf16 v[196:199], a[12:15], a[92:95], v[196:199]
  v_mfma_f32_16x16x32_bf16 v[200:203], a[16:19], a[92:95], v[200:203]
  v_mfma_f32_16x16x32_bf16 v[204:207], a[20:23], a[92:95], v[204:207]
  v_mfma_f32_16x16x32_bf16 v[208:211], a[24:27], a[92:95], v[208:211]
  v_mfma_f32_16x16x32_bf16 v[212:215], a[28:31], a[92:95], v[212:215]
  s_waitcnt vmcnt(0) lgkmcnt(0)
  s_barrier
  s_mov_b32 s6, 0x3e8293ee
  s_mov_b32 s7, s6
  v_mfma_f32_16x16x32_bf16 v[24:27], a[96:99], a[36:39], v[24:27]
  ds_read_b128 a[0:3], v16 offset:0
  v_mfma_f32_16x16x32_bf16 v[28:31], a[96:99], a[40:43], v[28:31]
  ds_read_b64_tr_b16 a[72:73], v20 offset:0
  v_mfma_f32_16x16x32_bf16 v[32:35], a[96:99], a[44:47], v[32:35]
  v_mfma_f32_16x16x32_bf16 v[36:39], a[96:99], a[48:51], v[36:39]
  ds_read_b64_tr_b16 a[74:75], v20 offset:2048
  v_mfma_f32_16x16x32_bf16 v[40:43], a[96:99], a[52:55], v[40:43]
  v_mfma_f32_16x16x32_bf16 v[44:47], a[96:99], a[56:59], v[44:47]
  ds_read_b128 a[4:7], v16 offset:2048
  v_mfma_f32_16x16x32_bf16 v[48:51], a[96:99], a[60:63], v[48:51]
  v_mfma_f32_16x16x32_bf16 v[52:55], a[96:99], a[64:67], v[52:55]
  ds_read_b128 a[8:11], v16 offset:4096
  v_mfma_f32_16x16x32_bf16 v[56:59], a[100:103], a[36:39], v[56:59]
  v_mfma_f32_16x16x32_bf16 v[60:63], a[100:103], a[40:43], v[60:63]
  ds_read_b128 a[12:15], v16 offset:6144
  v_mfma_f32_16x16x32_bf16 v[64:67], a[100:103], a[44:47], v[64:67]
  v_mfma_f32_16x16x32_bf16 v[68:71], a[100:103], a[48:51], v[68:71]
  ds_read_b128 a[16:19], v16 offset:8192
  v_mfma_f32_16x16x32_bf16 v[72:75], a[100:103], a[52:55], v[72:75]
  v_mfma_f32_16x16x32_bf16 v[76:79], a[100:103], a[56:59], v[76:79]
  ds_read_b128 a[20:23], v16 offset:10240
  v_mfma_f32_16x16x32_bf16 v[80:83], a[100:103], a[60:63], v[80:83]
  v_mfma_f32_16x16x32_bf16 v[84:87], a[100:103], a[64:67], v[84:87]
  ds_read_b128 a[24:27], v16 offset:12288
  v_mfma_f32_16x16x32_bf16 v[88:91], a[104:107], a[36:39], v[88:91]
  v_mfma_f32_16x16x32_bf16 v[92:95], a[104:107], a[40:43], v[92:95]
  ds_read_b128 a[28:31], v16 offset:14336
  v_mfma_f32_16x16x32_bf16 v[96:99], a[104:107], a[44:47], v[96:99]
  v_mfma_f32_16x16x32_bf16 v[100:103], a[104:107], a[48:51], v[100:103]
  ds_read_b64_tr_b16 a[76:77], v21 offset:0
  v_mfma_f32_16x16x32_bf16 v[104:107], a[104:107], a[52:55], v[104:107]
  ds_read_b64_tr_b16 a[78:79], v21 offset:2048
  v_mfma_f32_16x16x32_bf16 v[108:111], a[104:107], a[56:59], v[108:111]
  v_mfma_f32_16x16x32_bf16 v[112:115], a[104:107], a[60:63], v[112:115]
  ds_read_b64_tr_b16 a[80:81], v20 offset:8192
  v_mfma_f32_16x16x32_bf16 v[116:119], a[104:107], a[64:67], v[116:119]
  v_mfma_f32_16x16x32_bf16 v[216:219], a[104:107], a[68:71], v[216:219]
  ds_read_b64_tr_b16 a[82:83], v20 offset:10240
  v_mfma_f32_16x16x32_bf16 v[120:123], a[108:111], a[36:39], v[120:123]
  v_mfma_f32_16x16x32_bf16 v[124:127], a[108:111], a[40:43], v[124:127]
  ds_read_b128 a[32:35], v18 offset:0
  v_mfma_f32_16x16x32_bf16 v[128:131], a[108:111], a[44:47], v[128:131]
  v_mfma_f32_16x16x32_bf16 v[132:135], a[108:111], a[48:51], v[132:135]
  ds_read_b64_tr_b16 a[84:85], v21 offset:8192
  v_mfma_f32_16x16x32_bf16 v[136:139], a[108:111], a[52:55], v[136:139]
  v_mfma_f32_16x16x32_bf16 v[140:143], a[108:111], a[56:59], v[140:143]
  ds_read_b64_tr_b16 a[86:87], v21 offset:10240
  v_mfma_f32_16x16x32_bf16 v[144:147], a[108:111], a[60:63], v[144:147]
  v_mfma_f32_16x16x32_bf16 v[148:151], a[108:111], a[64:67], v[148:151]
  ds_read_b64_tr_b16 a[88:89], v20 offset:16384
  v_mfma_f32_16x16x32_bf16 v[220:223], a[108:111], a[68:71], v[220:223]
  v_mfma_f32_16x16x32_bf16 v[152:155], a[36:39], a[112:115], v[152:155]
  ds_read_b64_tr_b16 a[90:91], v20 offset:18432
  v_mfma_f32_16x16x32_bf16 v[156:159], a[40:43], a[112:115], v[156:159]
  v_mfma_f32_16x16x32_bf16 v[160:163], a[44:47], a[112:115], v[160:163]
  ds_read_b64_tr_b16 a[92:93], v21 offset:16384
  v_mfma_f32_16x16x32_bf16 v[164:167], a[48:51], a[112:115], v[164:167]
  v_mfma_f32_16x16x32_bf16 v[168:171], a[52:55], a[112:115], v[168:171]
  ds_read_b64_tr_b16 a[94:95], v21 offset:18432
  v_mfma_f32_16x16x32_bf16 v[172:175], a[56:59], a[112:115], v[172:175]
  v_mfma_f32_16x16x32_bf16 v[176:179], a[60:63], a[112:115], v[176:179]
  v_mfma_f32_16x16x32_bf16 v[180:183], a[64:67], a[112:115], v[180:183]
  v_mfma_f32_16x16x32_bf16 v[184:187], a[36:39], a[116:119], v[184:187]
  v_mfma_f32_16x16x32_bf16 v[188:191], a[40:43], a[116:119], v[188:191]
  v_mfma_f32_16x16x32_bf16 v[192:195], a[44:47], a[116:119], v[192:195]
  v_mfma_f32_16x16x32_bf16 v[196:199], a[48:51], a[116:119], v[196:199]
  v_mfma_f32_16x16x32_bf16 v[200:203], a[52:55], a[116:119], v[200:203]
  v_mfma_f32_16x16x32_bf16 v[204:207], a[56:59], a[116:119], v[204:207]
  v_mfma_f32_16x16x32_bf16 v[208:211], a[60:63], a[116:119], v[208:211]
  v_mfma_f32_16x16x32_bf16 v[212:215], a[64:67], a[116:119], v[212:215]
  s_waitcnt lgkmcnt(0)
  v_mfma_f32_16x16x32_bf16 v[24:27], a[72:75], a[0:3], v[24:27]
  ds_read_b128 a[36:39], v17 offset:0
  ds_read_b64_tr_b16 a[96:97], v20 offset:4096
  v_mfma_f32_16x16x32_bf16 v[56:59], a[76:79], a[0:3], v[56:59]
  ds_read_b64_tr_b16 a[98:99], v20 offset:6144
  ds_read_b128 a[40:43], v17 offset:2048
  v_mfma_f32_16x16x32_bf16 v[28:31], a[72:75], a[4:7], v[28:31]
  ds_read_b128 a[44:47], v17 offset:4096
  ds_read_b128 a[48:51], v17 offset:6144
  v_mfma_f32_16x16x32_bf16 v[60:63], a[76:79], a[4:7], v[60:63]
  ds_read_b128 a[52:55], v17 offset:8192
  ds_read_b128 a[56:59], v17 offset:10240
  v_mfma_f32_16x16x32_bf16 v[32:35], a[72:75], a[8:11], v[32:35]
  ds_read_b128 a[60:63], v17 offset:12288
  ds_read_b128 a[64:67], v17 offset:14336
  v_mfma_f32_16x16x32_bf16 v[64:67], a[76:79], a[8:11], v[64:67]
  ds_read_b64_tr_b16 a[100:101], v21 offset:4096
  ds_read_b64_tr_b16 a[102:103], v21 offset:6144
  v_mfma_f32_16x16x32_bf16 v[36:39], a[72:75], a[12:15], v[36:39]
  ds_read_b64_tr_b16 a[104:105], v20 offset:12288
  ds_read_b64_tr_b16 a[106:107], v20 offset:14336
  v_mfma_f32_16x16x32_bf16 v[68:71], a[76:79], a[12:15], v[68:71]
  ds_read_b128 a[68:71], v19 offset:0
  ds_read_b64_tr_b16 a[108:109], v21 offset:12288
  v_mfma_f32_16x16x32_bf16 v[40:43], a[72:75], a[16:19], v[40:43]
  ds_read_b64_tr_b16 a[110:111], v21 offset:14336
  ds_read_b64_tr_b16 a[112:113], v20 offset:20480
  v_mfma_f32_16x16x32_bf16 v[72:75], a[76:79], a[16:19], v[72:75]
  ds_read_b64_tr_b16 a[114:115], v20 offset:22528
  ds_read_b64_tr_b16 a[116:117], v21 offset:20480
  v_mfma_f32_16x16x32_bf16 v[44:47], a[72:75], a[20:23], v[44:47]
  ds_read_b64_tr_b16 a[118:119], v21 offset:22528
  v_mfma_f32_16x16x32_bf16 v[76:79], a[76:79], a[20:23], v[76:79]
  v_mfma_f32_16x16x32_bf16 v[48:51], a[72:75], a[24:27], v[48:51]
  v_mfma_f32_16x16x32_bf16 v[80:83], a[76:79], a[24:27], v[80:83]
  v_mfma_f32_16x16x32_bf16 v[52:55], a[72:75], a[28:31], v[52:55]
  v_mfma_f32_16x16x32_bf16 v[84:87], a[76:79], a[28:31], v[84:87]
  s_waitcnt lgkmcnt(0)
  s_barrier
  s_mov_b32 s12, s84
  s_mov_b32 s13, s85
  s_mov_b32 s14, 256
  s_mov_b32 s15, 0x00020000
  buffer_load_dwordx2 v[22:23], off, s[12:15], 0 sc1
  v_mfma_f32_16x16x32_bf16 v[24:27], a[96:99], a[36:39], v[24:27]
  s_mov_b32 m0, s68
  v_mfma_f32_16x16x32_bf16 v[56:59], a[100:103], a[36:39], v[56:59]
  buffer_load_dwordx4 v8, s[20:23], s28 offen offset:0 lds
  v_mfma_f32_16x16x32_bf16 v[28:31], a[96:99], a[40:43], v[28:31]
  v_mfma_f32_16x16x32_bf16 v[60:63], a[100:103], a[40:43], v[60:63]
  v_mfma_f32_16x16x32_bf16 v[32:35], a[96:99], a[44:47], v[32:35]
  v_mfma_f32_16x16x32_bf16 v[64:67], a[100:103], a[44:47], v[64:67]
  buffer_load_dwordx4 v9, s[20:23], s28 offen offset:1024 lds
  v_pk_mul_f32 v[24:25], v[24:25], s[6:7]
  v_mfma_f32_16x16x32_bf16 v[36:39], a[96:99], a[48:51], v[36:39]
  v_pk_mul_f32 v[26:27], v[26:27], s[6:7]
  v_pk_mul_f32 v[56:57], v[56:57], s[6:7]
  v_mfma_f32_16x16x32_bf16 v[68:71], a[100:103], a[48:51], v[68:71]
  v_pk_mul_f32 v[58:59], v[58:59], s[6:7]
  v_cvt_pk_bf16_f32 v24, v24, v25
  v_mfma_f32_16x16x32_bf16 v[40:43], a[96:99], a[52:55], v[40:43]
  v_cvt_pk_bf16_f32 v25, v26, v27
  v_cvt_pk_bf16_f32 v26, v56, v57
  v_mfma_f32_16x16x32_bf16 v[72:75], a[100:103], a[52:55], v[72:75]
  v_cvt_pk_bf16_f32 v27, v58, v59
  v_pk_mul_f32 v[28:29], v[28:29], s[6:7]
  v_mfma_f32_16x16x32_bf16 v[44:47], a[96:99], a[56:59], v[44:47]
  buffer_load_dwordx4 v10, s[20:23], s28 offen offset:2048 lds
  v_pk_mul_f32 v[30:31], v[30:31], s[6:7]
  v_mfma_f32_16x16x32_bf16 v[76:79], a[100:103], a[56:59], v[76:79]
  v_pk_mul_f32 v[60:61], v[60:61], s[6:7]
  v_pk_mul_f32 v[62:63], v[62:63], s[6:7]
  v_mfma_f32_16x16x32_bf16 v[48:51], a[96:99], a[60:63], v[48:51]
  v_cvt_pk_bf16_f32 v28, v28, v29
  v_cvt_pk_bf16_f32 v29, v30, v31
  v_mfma_f32_16x16x32_bf16 v[80:83], a[100:103], a[60:63], v[80:83]
  v_cvt_pk_bf16_f32 v30, v60, v61
  v_cvt_pk_bf16_f32 v31, v62, v63
  v_mfma_f32_16x16x32_bf16 v[52:55], a[96:99], a[64:67], v[52:55]
  v_pk_mul_f32 v[32:33], v[32:33], s[6:7]
  v_pk_mul_f32 v[34:35], v[34:35], s[6:7]
  v_mfma_f32_16x16x32_bf16 v[84:87], a[100:103], a[64:67], v[84:87]
  buffer_load_dwordx4 v11, s[20:23], s28 offen offset:3072 lds
  v_pk_mul_f32 v[64:65], v[64:65], s[6:7]
  v_mfma_f32_16x16x32_bf16 v[216:219], a[80:83], a[32:35], v[216:219]
  s_bfe_u32 s56, 0x302010e, s55
  s_add_u32 s54, s54, s56
  s_add_u32 s55, s55, 8
  v_mfma_f32_16x16x32_bf16 v[220:223], a[84:87], a[32:35], v[220:223]
  s_and_b32 s55, s55, 0x8001f
  s_and_b32 s54, s54, 15
  s_lshl_b32 s28, s54, 19
  v_mfma_f32_16x16x32_bf16 v[216:219], a[104:107], a[68:71], v[216:219]
  s_add_u32 m0, s68, 16384
  v_pk_mul_f32 v[66:67], v[66:67], s[6:7]
  v_cvt_pk_bf16_f32 v32, v32, v33
  v_mfma_f32_16x16x32_bf16 v[220:223], a[108:111], a[68:71], v[220:223]
  v_cvt_pk_bf16_f32 v33, v34, v35
  v_cvt_pk_bf16_f32 v34, v64, v65
  v_mfma_f32_16x16x32_bf16 v[88:91], a[80:83], a[0:3], v[88:91]
  buffer_load_dwordx4 v8, s[20:23], s28 offen offset:0 lds
  v_cvt_pk_bf16_f32 v35, v66, v67
  v_mfma_f32_16x16x32_bf16 v[120:123], a[84:87], a[0:3], v[120:123]
  v_pk_mul_f32 v[36:37], v[36:37], s[6:7]
  v_pk_mul_f32 v[38:39], v[38:39], s[6:7]
  v_mfma_f32_16x16x32_bf16 v[88:91], a[104:107], a[36:39], v[88:91]
  v_pk_mul_f32 v[68:69], v[68:69], s[6:7]
  v_pk_mul_f32 v[70:71], v[70:71], s[6:7]
  v_mfma_f32_16x16x32_bf16 v[120:123], a[108:111], a[36:39], v[120:123]
  v_cvt_pk_bf16_f32 v36, v36, v37
  v_cvt_pk_bf16_f32 v37, v38, v39
  v_mfma_f32_16x16x32_bf16 v[92:95], a[80:83], a[4:7], v[92:95]
  v_cvt_pk_bf16_f32 v38, v68, v69
  v_cvt_pk_bf16_f32 v39, v70, v71
  v_mfma_f32_16x16x32_bf16 v[124:127], a[84:87], a[4:7], v[124:127]
  buffer_load_dwordx4 v9, s[20:23], s28 offen offset:1024 lds
  v_pk_mul_f32 v[40:41], v[40:41], s[6:7]
  v_mfma_f32_16x16x32_bf16 v[92:95], a[104:107], a[40:43], v[92:95]
  v_pk_mul_f32 v[42:43], v[42:43], s[6:7]
  v_pk_mul_f32 v[72:73], v[72:73], s[6:7]
  v_mfma_f32_16x16x32_bf16 v[124:127], a[108:111], a[40:43], v[124:127]
  v_pk_mul_f32 v[74:75], v[74:75], s[6:7]
  v_cvt_pk_bf16_f32 v40, v40, v41
  v_mfma_f32_16x16x32_bf16 v[96:99], a[80:83], a[8:11], v[96:99]
  v_cvt_pk_bf16_f32 v41, v42, v43
  v_cvt_pk_bf16_f32 v42, v72, v73
  v_mfma_f32_16x16x32_bf16 v[128:131], a[84:87], a[8:11], v[128:131]
  v_cvt_pk_bf16_f32 v43, v74, v75
  v_pk_mul_f32 v[44:45], v[44:45], s[6:7]
  v_mfma_f32_16x16x32_bf16 v[96:99], a[104:107], a[44:47], v[96:99]
  v_pk_mul_f32 v[46:47], v[46:47], s[6:7]
  v_pk_mul_f32 v[76:77], v[76:77], s[6:7]
  v_mfma_f32_16x16x32_bf16 v[128:131], a[108:111], a[44:47], v[128:131]
  buffer_load_dwordx4 v10, s[20:23], s28 offen offset:2048 lds
  v_pk_mul_f32 v[78:79], v[78:79], s[6:7]
  v_mfma_f32_16x16x32_bf16 v[100:103], a[80:83], a[12:15], v[100:103]
  v_cvt_pk_bf16_f32 v44, v44, v45
  v_cvt_pk_bf16_f32 v45, v46, v47
  v_mfma_f32_16x16x32_bf16 v[132:135], a[84:87], a[12:15], v[132:135]
  v_cvt_pk_bf16_f32 v46, v76, v77
  v_cvt_pk_bf16_f32 v47, v78, v79
  v_mfma_f32_16x16x32_bf16 v[100:103], a[104:107], a[48:51], v[100:103]
  v_pk_mul_f32 v[48:49], v[48:49], s[6:7]
  v_pk_mul_f32 v[50:51], v[50:51], s[6:7]
  v_mfma_f32_16x16x32_bf16 v[132:135], a[108:111], a[48:51], v[132:135]
  v_pk_mul_f32 v[80:81], v[80:81], s[6:7]
  v_pk_mul_f32 v[82:83], v[82:83], s[6:7]
  v_mfma_f32_16x16x32_bf16 v[104:107], a[80:83], a[16:19], v[104:107]
  buffer_load_dwordx4 v11, s[20:23], s28 offen offset:3072 lds
  v_cvt_pk_bf16_f32 v48, v48, v49
  v_mfma_f32_16x16x32_bf16 v[136:139], a[84:87], a[16:19], v[136:139]
  s_bfe_u32 s56, 0x302010e, s55
  s_add_u32 s54, s54, s56
  s_add_u32 s55, s55, 8
  v_mfma_f32_16x16x32_bf16 v[104:107], a[104:107], a[52:55], v[104:107]
  s_and_b32 s55, s55, 0x8001f
  s_and_b32 s54, s54, 15
  s_lshl_b32 s28, s54, 19
  v_mfma_f32_16x16x32_bf16 v[136:139], a[108:111], a[52:55], v[136:139]
  s_mov_b32 m0, s88
  v_cvt_pk_bf16_f32 v49, v50, v51
  v_cvt_pk_bf16_f32 v50, v80, v81
  v_mfma_f32_16x16x32_bf16 v[108:111], a[80:83], a[20:23], v[108:111]
  v_cvt_pk_bf16_f32 v51, v82, v83
  v_pk_mul_f32 v[52:53], v[52:53], s[6:7]
  v_mfma_f32_16x16x32_bf16 v[140:143], a[84:87], a[20:23], v[140:143]
  buffer_load_dwordx4 v4, s[8:11], s26 offen offset:0 lds
  v_pk_mul_f32 v[54:55], v[54:55], s[6:7]
  v_mfma_f32_16x16x32_bf16 v[108:111], a[104:107], a[56:59], v[108:111]
  v_pk_mul_f32 v[84:85], v[84:85], s[6:7]
  v_pk_mul_f32 v[86:87], v[86:87], s[6:7]
  v_mfma_f32_16x16x32_bf16 v[140:143], a[108:111], a[56:59], v[140:143]
  v_cvt_pk_bf16_f32 v52, v52, v53
  v_cvt_pk_bf16_f32 v53, v54, v55
  v_mfma_f32_16x16x32_bf16 v[112:115], a[80:83], a[24:27], v[112:115]
  v_cvt_pk_bf16_f32 v54, v84, v85
  v_cvt_pk_bf16_f32 v55, v86, v87
  v_mfma_f32_16x16x32_bf16 v[144:147], a[84:87], a[24:27], v[144:147]
  v_cvt_pk_bf16_f32 v216, v216, v217
  v_cvt_pk_bf16_f32 v217, v218, v219
  v_mfma_f32_16x16x32_bf16 v[112:115], a[104:107], a[60:63], v[112:115]
  buffer_load_dwordx4 v5, s[8:11], s26 offen offset:1024 lds
  v_cvt_pk_bf16_f32 v218, v220, v221
  v_mfma_f32_16x16x32_bf16 v[144:147], a[108:111], a[60:63], v[144:147]
  v_cvt_pk_bf16_f32 v219, v222, v223
  v_mfma_f32_16x16x32_bf16 v[116:119], a[80:83], a[28:31], v[116:119]
  ds_write_b128 v252, v[216:219]
  v_cvt_pk_bf16_f32 v88, v88, v89
  v_mfma_f32_16x16x32_bf16 v[148:151], a[84:87], a[28:31], v[148:151]
  v_cvt_pk_bf16_f32 v89, v90, v91
  v_cvt_pk_bf16_f32 v90, v120, v121
  v_mfma_f32_16x16x32_bf16 v[116:119], a[104:107], a[64:67], v[116:119]
  v_cvt_pk_bf16_f32 v91, v122, v123
  v_cvt_pk_bf16_f32 v92, v92, v93
  v_mfma_f32_16x16x32_bf16 v[148:151], a[108:111], a[64:67], v[148:151]
  buffer_load_dwordx4 v6, s[8:11], s26 offen offset:2048 lds
  v_cvt_pk_bf16_f32 v93, v94, v95
  v_mfma_f32_16x16x32_bf16 v[180:183], a[28:31], a[88:91], v[180:183]
  v_cvt_pk_bf16_f32 v94, v124, v125
  v_cvt_pk_bf16_f32 v95, v126, v127
  v_mfma_f32_16x16x32_bf16 v[212:215], a[28:31], a[92:95], v[212:215]
  v_cvt_pk_bf16_f32 v96, v96, v97
  v_cvt_pk_bf16_f32 v97, v98, v99
  v_mfma_f32_16x16x32_bf16 v[180:183], a[64:67], a[112:115], v[180:183]
  v_cvt_pk_bf16_f32 v98, v128, v129
  v_cvt_pk_bf16_f32 v99, v130, v131
  v_mfma_f32_16x16x32_bf16 v[212:215], a[64:67], a[116:119], v[212:215]
  v_cvt_pk_bf16_f32 v100, v100, v101
  v_cvt_pk_bf16_f32 v101, v102, v103
  v_mfma_f32_16x16x32_bf16 v[176:179], a[24:27], a[88:91], v[176:179]
  v_cvt_pk_bf16_f32 v102, v132, v133
  v_cvt_pk_bf16_f32 v103, v134, v135
  v_mfma_f32_16x16x32_bf16 v[208:211], a[24:27], a[92:95], v[208:211]
  buffer_load_dwordx4 v7, s[8:11], s26 offen offset:3072 lds
  v_cvt_pk_bf16_f32 v104, v104, v105
  v_mfma_f32_16x16x32_bf16 v[176:179], a[60:63], a[112:115], v[176:179]
  s_add_u32 m0, s88, 4096
  v_cvt_pk_bf16_f32 v105, v106, v107
  v_cvt_pk_bf16_f32 v106, v136, v137
  v_mfma_f32_16x16x32_bf16 v[208:211], a[60:63], a[116:119], v[208:211]
  v_cvt_pk_bf16_f32 v107, v138, v139
  v_cvt_pk_bf16_f32 v108, v108, v109
  v_mfma_f32_16x16x32_bf16 v[172:175], a[20:23], a[88:91], v[172:175]
  v_cvt_pk_bf16_f32 v109, v110, v111
  v_cvt_pk_bf16_f32 v110, v140, v141
  v_mfma_f32_16x16x32_bf16 v[204:207], a[20:23], a[92:95], v[204:207]
  v_cvt_pk_bf16_f32 v111, v142, v143
  v_cvt_pk_bf16_f32 v112, v112, v113
  v_mfma_f32_16x16x32_bf16 v[172:175], a[56:59], a[112:115], v[172:175]
  buffer_load_dwordx4 v4, s[8:11], s27 offen offset:0 lds
  v_cvt_pk_bf16_f32 v113, v114, v115
  v_mfma_f32_16x16x32_bf16 v[204:207], a[56:59], a[116:119], v[204:207]
  v_cvt_pk_bf16_f32 v114, v144, v145
  v_cvt_pk_bf16_f32 v115, v146, v147
  v_mfma_f32_16x16x32_bf16 v[168:171], a[16:19], a[88:91], v[168:171]
  v_cvt_pk_bf16_f32 v116, v116, v117
  v_cvt_pk_bf16_f32 v117, v118, v119
  v_mfma_f32_16x16x32_bf16 v[200:203], a[16:19], a[92:95], v[200:203]
  v_cvt_pk_bf16_f32 v118, v148, v149
  v_cvt_pk_bf16_f32 v119, v150, v151
  v_mfma_f32_16x16x32_bf16 v[168:171], a[52:55], a[112:115], v[168:171]
  ds_write_b128 v252, v[116:119] offset:2048
  v_cvt_pk_bf16_f32 v72, v180, v181
  v_mfma_f32_16x16x32_bf16 v[200:203], a[52:55], a[116:119], v[200:203]
  buffer_load_dwordx4 v5, s[8:11], s27 offen offset:1024 lds
  v_cvt_pk_bf16_f32 v73, v182, v183
  v_mfma_f32_16x16x32_bf16 v[164:167], a[12:15], a[88:91], v[164:167]
  v_cvt_pk_bf16_f32 v136, v212, v213
  v_cvt_pk_bf16_f32 v137, v214, v215
  v_mfma_f32_16x16x32_bf16 v[196:199], a[12:15], a[92:95], v[196:199]
  ds_write_b64 v252, v[72:73] offset:3072
  ds_write_b64 v252, v[136:137] offset:3080
  v_mfma_f32_16x16x32_bf16 v[164:167], a[48:51], a[112:115], v[164:167]
  v_cvt_pk_bf16_f32 v70, v176, v177
  v_cvt_pk_bf16_f32 v71, v178, v179
  v_mfma_f32_16x16x32_bf16 v[196:199], a[48:51], a[116:119], v[196:199]
  v_cvt_pk_bf16_f32 v134, v208, v209
  v_cvt_pk_bf16_f32 v135, v210, v211
  v_mfma_f32_16x16x32_bf16 v[160:163], a[8:11], a[88:91], v[160:163]
  buffer_load_dwordx4 v6, s[8:11], s27 offen offset:2048 lds
  v_cvt_pk_bf16_f32 v68, v172, v173
  v_mfma_f32_16x16x32_bf16 v[192:195], a[8:11], a[92:95], v[192:195]
  v_cvt_pk_bf16_f32 v69, v174, v175
  v_cvt_pk_bf16_f32 v132, v204, v205
  v_mfma_f32_16x16x32_bf16 v[160:163], a[44:47], a[112:115], v[160:163]
  v_cvt_pk_bf16_f32 v133, v206, v207
  v_cvt_pk_bf16_f32 v66, v168, v169
  v_mfma_f32_16x16x32_bf16 v[192:195], a[44:47], a[116:119], v[192:195]
  v_cvt_pk_bf16_f32 v67, v170, v171
  v_cvt_pk_bf16_f32 v130, v200, v201
  v_mfma_f32_16x16x32_bf16 v[156:159], a[4:7], a[88:91], v[156:159]
  v_cvt_pk_bf16_f32 v131, v202, v203
  v_cvt_pk_bf16_f32 v64, v164, v165
  v_mfma_f32_16x16x32_bf16 v[188:191], a[4:7], a[92:95], v[188:191]
  buffer_load_dwordx4 v7, s[8:11], s27 offen offset:3072 lds
  v_cvt_pk_bf16_f32 v65, v166, v167
  v_mfma_f32_16x16x32_bf16 v[156:159], a[40:43], a[112:115], v[156:159]
  s_bfe_u32 s29, 0x302010e, s53
  s_add_u32 s52, s52, s29
  s_add_u32 s53, s53, 8
  v_mfma_f32_16x16x32_bf16 v[188:191], a[40:43], a[116:119], v[188:191]
  s_and_b32 s53, s53, 0x8001f
  s_and_b32 s52, s52, 15
  s_lshl_b32 s29, s52, 7
  v_mfma_f32_16x16x32_bf16 v[152:155], a[0:3], a[88:91], v[152:155]
  s_or_b32 s26, s30, s29
  s_or_b32 s27, s31, s29
  v_cvt_pk_bf16_f32 v128, v196, v197
  v_mfma_f32_16x16x32_bf16 v[184:187], a[0:3], a[92:95], v[184:187]
  v_cvt_pk_bf16_f32 v129, v198, v199
  v_cvt_pk_bf16_f32 v62, v160, v161
  v_mfma_f32_16x16x32_bf16 v[152:155], a[36:39], a[112:115], v[152:155]
  v_cvt_pk_bf16_f32 v63, v162, v163
  v_cvt_pk_bf16_f32 v126, v192, v193
  v_mfma_f32_16x16x32_bf16 v[184:187], a[36:39], a[116:119], v[184:187]
  v_cvt_pk_bf16_f32 v127, v194, v195
  v_cvt_pk_bf16_f32 v60, v156, v157
  v_cvt_pk_bf16_f32 v61, v158, v159
  v_cvt_pk_bf16_f32 v124, v188, v189
  v_cvt_pk_bf16_f32 v125, v190, v191
  v_cvt_pk_bf16_f32 v58, v152, v153
  v_cvt_pk_bf16_f32 v59, v154, v155
  s_nop 0
  v_cvt_pk_bf16_f32 v122, v184, v185
  v_cvt_pk_bf16_f32 v123, v186, v187
  s_waitcnt lgkmcnt(0)
  s_barrier
  s_branch Lp2_at
Lp2_r1:
  s_and_b32 s4, s2, 7
  s_lshl_b32 s4, s4, 4
  s_add_u32 s4, s4, s59
  s_lshl_b32 s4, s4, 2
  s_add_u32 s4, s4, s3
  s_lshl_b32 s51, s4, 13
  s_mov_b32 m0, s36
  s_nop 0
  buffer_load_dwordx4 v224, s[8:11], s46 offen offset:0 lds
  buffer_load_dwordx4 v225, s[8:11], s46 offen offset:1024 lds
  buffer_load_dwordx4 v226, s[8:11], s46 offen offset:2048 lds
  buffer_load_dwordx4 v227, s[8:11], s46 offen offset:3072 lds
  s_add_u32 m0, s36, 4096
  s_nop 0
  buffer_load_dwordx4 v228, s[8:11], s46 offen offset:0 lds
  buffer_load_dwordx4 v229, s[8:11], s46 offen offset:1024 lds
  buffer_load_dwordx4 v230, s[8:11], s46 offen offset:2048 lds
  buffer_load_dwordx4 v231, s[8:11], s46 offen offset:3072 lds
  s_mul_i32 s47, s48, 393216
  s_bfe_u32 s34, 0x302010e, s49
  s_add_u32 s48, s48, s34
  s_add_u32 s49, s49, 8
  s_and_b32 s49, s49, 0x8001f
  s_and_b32 s48, s48, 15
  s_lshl_b32 s46, s48, 7
  s_mov_b32 m0, s41
  s_nop 0
  buffer_load_dwordx4 v233, s[12:15], s47 offen offset:0 lds
  buffer_load_dwordx4 v234, s[12:15], s47 offen offset:1024 lds
  buffer_load_dwordx4 v235, s[12:15], s47 offen offset:2048 lds
  s_add_u32 m0, s41, 3072
  s_nop 0
  buffer_load_dwordx4 v236, s[12:15], s47 offen offset:0 lds
  buffer_load_dwordx4 v237, s[12:15], s47 offen offset:1024 lds
  buffer_load_dwordx4 v238, s[12:15], s47 offen offset:2048 lds
  s_lshr_b32 s4, s3, 1
  s_lshl_b32 s4, s4, 14
  v_and_b32 v240, 15, v1
  v_lshlrev_b32 v240, 7, v240
  v_lshrrev_b32 v241, 4, v1
  v_and_b32 v242, 6, v1
  v_xor_b32 v241, v241, v242
  v_lshl_add_u32 v240, v241, 4, v240
  v_add_u32 v16, s4, v240
  v_xor_b32 v17, 64, v16
  v_and_b32 v240, 15, v1
  v_lshlrev_b32 v240, 7, v240
  v_lshrrev_b32 v241, 4, v1
  v_and_b32 v242, 6, v1
  v_xor_b32 v241, v241, v242
  v_lshl_add_u32 v240, v241, 4, v240
  v_add_u32 v18, 32768, v240
  v_xor_b32 v19, 64, v18
  v_lshrrev_b32 v240, 2, v1
  v_and_b32 v241, 6, v240
  v_lshlrev_b32 v240, 7, v240
  v_and_b32 v242, 1, v1
  v_lshl_add_u32 v240, v242, 3, v240
  v_add_u32 v240, 104448, v240
  v_bfe_u32 v242, v1, 1, 1
  v_xor_b32 v241, v241, v242
  v_xor_b32 v242, 0, v241
  v_lshl_add_u32 v20, v242, 4, v240
  v_xor_b32 v242, 2, v241
  v_lshl_add_u32 v21, v242, 4, v240
  s_and_b32 s4, s3, 1
  s_lshl_b32 s4, s4, 6
  v_xor_b32 v20, s4, v20
  v_xor_b32 v21, s4, v21
  s_and_b32 s24, s2, 7
  s_lshr_b32 s4, s2, 6
  s_lshl_b32 s4, s4, 3
  s_add_u32 s24, s24, s4
  s_lshr_b32 s4, s2, 3
  s_and_b32 s25, s4, 6
  s_xor_b32 s4, s4, s2
  s_bfe_u32 s4, s4, 0x10003
  s_add_u32 s25, s25, s4
  v_accvgpr_write_b32 a244, -1
  v_accvgpr_write_b32 a245, -1
  v_accvgpr_write_b32 a246, -1
  v_accvgpr_write_b32 a247, -1
  v_lshrrev_b32 v24, 3, v1
  v_and_b32 v25, 6, v24
  v_and_b32 v26, 7, v1
  v_xor_b32 v25, v25, v26
  v_lshlrev_b32 v25, 4, v25
  s_and_b32 s4, s3, 1
  s_lshl_b32 s4, s4, 16
  s_lshr_b32 s5, s3, 1
  s_lshl_b32 s5, s5, 7
  s_add_u32 s4, s4, s5
  v_lshl_add_u32 v24, v24, 11, v25
  v_add_u32 v24, s4, v24
  v_add_u32 v25, 0, v24
  v_accvgpr_write_b32 a212, v25
  v_add_u32 v25, 15360, v24
  v_accvgpr_write_b32 a213, v25
  v_add_u32 v25, 30720, v24
  v_accvgpr_write_b32 a214, v25
  v_add_u32 v25, 46080, v24
  v_accvgpr_write_b32 a215, v25
  v_accvgpr_write_b32 a236, 0
  v_mov_b32 v27, 0x3f803f80
  v_accvgpr_write_b32 a208, v27
  v_accvgpr_write_b32 a237, 0
  v_accvgpr_write_b32 a209, v27
  v_accvgpr_write_b32 a238, 0
  v_accvgpr_write_b32 a210, v27
  v_accvgpr_write_b32 a239, 0
  v_accvgpr_write_b32 a211, v27
  v_lshrrev_b32 v24, 3, v1
  v_and_b32 v25, 6, v24
  v_and_b32 v26, 7, v1
  v_xor_b32 v25, v25, v26
  v_lshlrev_b32 v25, 4, v25
  v_lshlrev_b32 v26, 2, v24
  v_add_u32 v26, s3, v26
  v_lshl_add_u32 v26, v26, 11, v25
  v_add_u32 v27, 0, v26
  v_accvgpr_write_b32 a222, v27
  v_add_u32 v27, 64512, v26
  v_accvgpr_write_b32 a223, v27
  v_add_u32 v27, 129024, v26
  v_accvgpr_write_b32 a224, v27
  v_add_u32 v27, 193536, v26
  v_accvgpr_write_b32 a225, v27
  v_lshrrev_b32 v26, 2, v24
  v_and_b32 v27, 3, v24
  v_lshl_add_u32 v26, v26, 3, v27
  s_and_b32 s4, s3, 1
  s_lshl_b32 s4, s4, 18
  s_lshr_b32 s5, s3, 1
  s_lshl_b32 s5, s5, 7
  s_add_u32 s4, s4, s5
  s_lshl_b32 s5, s24, 8
  s_add_u32 s4, s4, s5
  v_lshl_add_u32 v26, v26, 13, v25
  v_add_u32 v26, s4, v26
  v_add_u32 v27, 0, v26
  v_accvgpr_write_b32 a226, v27
  v_add_u32 v27, 130048, v26
  v_accvgpr_write_b32 a227, v27
  v_add_u32 v27, 30720, v26
  v_accvgpr_write_b32 a228, v27
  v_add_u32 v27, 160768, v26
  v_accvgpr_write_b32 a229, v27
  s_lshl_b32 s4, s3, 13
  s_add_u32 s4, s4, 98304
  v_and_b32 v24, 15, v1
  v_lshlrev_b32 v24, 7, v24
  v_lshrrev_b32 v25, 4, v1
  v_and_b32 v26, 6, v1
  v_xor_b32 v25, v25, v26
  v_lshl_add_u32 v24, v25, 4, v24
  v_add_u32 v28, s4, v24
  v_xor_b32 v29, 64, v28
  v_lshrrev_b32 v24, 2, v1
  v_and_b32 v25, 6, v24
  v_lshlrev_b32 v24, 7, v24
  v_and_b32 v26, 1, v1
  v_lshl_add_u32 v24, v26, 3, v24
  v_add_u32 v24, 0, v24
  v_bfe_u32 v26, v1, 1, 1
  v_xor_b32 v25, v25, v26
  v_xor_b32 v26, 0, v25
  v_lshl_add_u32 v30, v26, 4, v24
  v_xor_b32 v26, 2, v25
  v_lshl_add_u32 v31, v26, 4, v24
  v_xor_b32 v26, 4, v25
  v_lshl_add_u32 v32, v26, 4, v24
  v_xor_b32 v26, 6, v25
  v_lshl_add_u32 v33, v26, 4, v24
  v_accvgpr_write_b32 a230, v28
  v_accvgpr_write_b32 a231, v29
  v_accvgpr_write_b32 a232, v30
  v_accvgpr_write_b32 a233, v31
  v_accvgpr_write_b32 a234, v32
  v_accvgpr_write_b32 a235, v33
  v_and_b32 v253, 15, v1
  v_lshrrev_b32 v254, 4, v1
  v_lshlrev_b32 v254, 2, v254
  v_sub_u32 v253, v253, v254
  v_mov_b32 v254, 0xf149f2ca
  s_lshr_b32 s4, s3, 1
  s_or_b32 s4, s4, s32
  s_cselect_b64 s[6:7], 0, -1
  v_subrev_u32 v255, 0, v253
  v_and_b32 v252, 0x80000001, v255
  v_cmp_ne_u32 vcc, 0, v252
  s_nop 1
  v_cndmask_b32 v244, 0, v254, vcc
  v_add_u32 v255, 1, v255
  v_and_b32 v252, 0x80000001, v255
  v_cmp_ne_u32 vcc, 0x80000001, v252
  s_nop 1
  v_cndmask_b32 v240, 0, v254, vcc
  v_cndmask_b32 v248, v240, v254, s[6:7]
  v_subrev_u32 v255, 1, v253
  v_and_b32 v252, 0x80000001, v255
  v_cmp_ne_u32 vcc, 0, v252
  s_nop 1
  v_cndmask_b32 v245, 0, v254, vcc
  v_add_u32 v255, 1, v255
  v_and_b32 v252, 0x80000001, v255
  v_cmp_ne_u32 vcc, 0x80000001, v252
  s_nop 1
  v_cndmask_b32 v241, 0, v254, vcc
  v_cndmask_b32 v249, v241, v254, s[6:7]
  v_subrev_u32 v255, 2, v253
  v_and_b32 v252, 0x80000001, v255
  v_cmp_ne_u32 vcc, 0, v252
  s_nop 1
  v_cndmask_b32 v246, 0, v254, vcc
  v_add_u32 v255, 1, v255
  v_and_b32 v252, 0x80000001, v255
  v_cmp_ne_u32 vcc, 0x80000001, v252
  s_nop 1
  v_cndmask_b32 v242, 0, v254, vcc
  v_cndmask_b32 v250, v242, v254, s[6:7]
  v_subrev_u32 v255, 3, v253
  v_and_b32 v252, 0x80000001, v255
  v_cmp_ne_u32 vcc, 0, v252
  s_nop 1
  v_cndmask_b32 v247, 0, v254, vcc
  v_add_u32 v255, 1, v255
  v_and_b32 v252, 0x80000001, v255
  v_cmp_ne_u32 vcc, 0x80000001, v252
  s_nop 1
  v_cndmask_b32 v243, 0, v254, vcc
  v_cndmask_b32 v251, v243, v254, s[6:7]
  s_and_b32 s4, s3, 1
  s_lshl_b32 s4, s4, 12
  s_add_u32 s4, s4, 49152
  v_add_u32 v252, s4, v2
  s_lshr_b32 s5, s3, 1
  s_lshl_b32 s5, s5, 11
  v_add_u32 v253, s5, v252
  s_add_u32 s16, s86, 83886080
  s_addc_u32 s17, s87, 0
  s_mov_b32 s18, 4194304
  s_mov_b32 s19, 0x00020000
  s_lshl_b32 s57, s32, 19
  s_lshl_b32 s5, s5, 7
  s_add_u32 s57, s57, s5
  s_lshl_b32 s4, s33, 14
  s_add_u32 s57, s57, s4
  s_and_b32 s4, s3, 1
  s_lshl_b32 s4, s4, 13
  s_add_u32 s57, s57, s4
  s_add_u32 s58, s57, 4096
  s_mov_b32 s37, 0
  s_mov_b32 s39, 4294897664
  s_mov_b32 s40, 34816
  s_mov_b32 s42, 0
  s_mov_b32 s44, 4294942720
  s_mov_b32 s45, 24576
  s_mov_b32 s43, s44
  s_mov_b32 s52, s72
  s_mov_b32 s53, s73
  s_mov_b32 s54, 4194304
  s_mov_b32 s55, 0x00020000
  s_lshl_b32 s1, s51, 1
  s_mov_b32 s56, s51
  s_mov_b32 s0, 0
  s_waitcnt vmcnt(0)
  s_barrier
  ds_read_b128 a[0:3], v16 offset:0
  ds_read_b64_tr_b16 a[72:73], v20 offset:0
  ds_read_b64_tr_b16 a[74:75], v20 offset:2048
  ds_read_b128 a[4:7], v16 offset:2048
  ds_read_b128 a[8:11], v16 offset:4096
  ds_read_b128 a[12:15], v16 offset:6144
  ds_read_b128 a[16:19], v16 offset:8192
  ds_read_b128 a[20:23], v16 offset:10240
  ds_read_b128 a[24:27], v16 offset:12288
  ds_read_b128 a[28:31], v16 offset:14336
  ds_read_b64_tr_b16 a[76:77], v21 offset:0
  ds_read_b64_tr_b16 a[78:79], v21 offset:2048
  ds_read_b64_tr_b16 a[80:81], v20 offset:8192
  ds_read_b64_tr_b16 a[82:83], v20 offset:10240
  ds_read_b64_tr_b16 a[84:85], v21 offset:8192
  ds_read_b64_tr_b16 a[86:87], v21 offset:10240
  ds_read_b64_tr_b16 a[88:89], v20 offset:16384
  ds_read_b64_tr_b16 a[90:91], v20 offset:18432
  ds_read_b128 a[32:35], v18 offset:0
  ds_read_b64_tr_b16 a[92:93], v21 offset:16384
  ds_read_b64_tr_b16 a[94:95], v21 offset:18432
  s_waitcnt lgkmcnt(0)
  v_mfma_f32_16x16x32_bf16 v[24:27], a[72:75], a[0:3], 0
  s_add_u32 m0, s36, 34816
  ds_read_b128 a[36:39], v17 offset:0
  v_mfma_f32_16x16x32_bf16 v[28:31], a[72:75], a[4:7], 0
  buffer_load_dwordx4 v224, s[8:11], s46 offen offset:0 lds
  v_mfma_f32_16x16x32_bf16 v[32:35], a[72:75], a[8:11], 0
  buffer_load_dwordx4 v225, s[8:11], s46 offen offset:1024 lds
  v_mfma_f32_16x16x32_bf16 v[36:39], a[72:75], a[12:15], 0
  buffer_load_dwordx4 v226, s[8:11], s46 offen offset:2048 lds
  v_mfma_f32_16x16x32_bf16 v[40:43], a[72:75], a[16:19], 0
  ds_read_b64_tr_b16 a[96:97], v20 offset:4096
  ds_read_b64_tr_b16 a[98:99], v20 offset:6144
  v_mfma_f32_16x16x32_bf16 v[44:47], a[72:75], a[20:23], 0
  buffer_load_dwordx4 v227, s[8:11], s46 offen offset:3072 lds
  v_mfma_f32_16x16x32_bf16 v[48:51], a[72:75], a[24:27], 0
  s_add_u32 m0, s36, 38912
  ds_read_b128 a[40:43], v17 offset:2048
  v_mfma_f32_16x16x32_bf16 v[52:55], a[72:75], a[28:31], 0
  buffer_load_dwordx4 v228, s[8:11], s46 offen offset:0 lds
  v_mfma_f32_16x16x32_bf16 v[56:59], a[76:79], a[0:3], 0
  ds_read_b128 a[44:47], v17 offset:4096
  v_mfma_f32_16x16x32_bf16 v[60:63], a[76:79], a[4:7], 0
  buffer_load_dwordx4 v229, s[8:11], s46 offen offset:1024 lds
  v_mfma_f32_16x16x32_bf16 v[64:67], a[76:79], a[8:11], 0
  ds_read_b128 a[48:51], v17 offset:6144
  v_mfma_f32_16x16x32_bf16 v[68:71], a[76:79], a[12:15], 0
  buffer_load_dwordx4 v230, s[8:11], s46 offen offset:2048 lds
  v_mfma_f32_16x16x32_bf16 v[72:75], a[76:79], a[16:19], 0
  ds_read_b128 a[52:55], v17 offset:8192
  v_mfma_f32_16x16x32_bf16 v[76:79], a[76:79], a[20:23], 0
  buffer_load_dwordx4 v231, s[8:11], s46 offen offset:3072 lds
  v_mfma_f32_16x16x32_bf16 v[80:83], a[76:79], a[24:27], 0
  s_mul_i32 s47, s48, 393216
  s_bfe_u32 s34, 0x302010e, s49
  s_add_u32 s48, s48, s34
  v_mfma_f32_16x16x32_bf16 v[84:87], a[76:79], a[28:31], 0
  s_add_u32 s49, s49, 8
  s_and_b32 s49, s49, 0x8001f
  s_and_b32 s48, s48, 15
  v_mfma_f32_16x16x32_bf16 v[88:91], a[80:83], a[0:3], 0
  s_lshl_b32 s46, s48, 7
  s_add_u32 m0, s41, 24576
  ds_read_b128 a[56:59], v17 offset:10240
  v_mfma_f32_16x16x32_bf16 v[92:95], a[80:83], a[4:7], 0
  buffer_load_dwordx4 v233, s[12:15], s47 offen offset:0 lds
  v_mfma_f32_16x16x32_bf16 v[96:99], a[80:83], a[8:11], 0
  buffer_load_dwordx4 v234, s[12:15], s47 offen offset:1024 lds
  v_mfma_f32_16x16x32_bf16 v[100:103], a[80:83], a[12:15], 0
  buffer_load_dwordx4 v235, s[12:15], s47 offen offset:2048 lds
  v_mfma_f32_16x16x32_bf16 v[104:107], a[80:83], a[16:19], 0
  s_add_u32 m0, s41, 27648
  ds_read_b128 a[60:63], v17 offset:12288
  ds_read_b128 a[64:67], v17 offset:14336
  v_mfma_f32_16x16x32_bf16 v[108:111], a[80:83], a[20:23], 0
  buffer_load_dwordx4 v236, s[12:15], s47 offen offset:0 lds
  v_mfma_f32_16x16x32_bf16 v[112:115], a[80:83], a[24:27], 0
  ds_read_b64_tr_b16 a[100:101], v21 offset:4096
  ds_read_b64_tr_b16 a[102:103], v21 offset:6144
  v_mfma_f32_16x16x32_bf16 v[116:119], a[80:83], a[28:31], 0
  buffer_load_dwordx4 v237, s[12:15], s47 offen offset:1024 lds
  v_mfma_f32_16x16x32_bf16 v[120:123], a[84:87], a[0:3], 0
  ds_read_b64_tr_b16 a[104:105], v20 offset:12288
  ds_read_b64_tr_b16 a[106:107], v20 offset:14336
  v_mfma_f32_16x16x32_bf16 v[124:127], a[84:87], a[4:7], 0
  buffer_load_dwordx4 v238, s[12:15], s47 offen offset:2048 lds
  v_mfma_f32_16x16x32_bf16 v[128:131], a[84:87], a[8:11], 0
  s_add_u32 m0, s36, 69632
  ds_read_b64_tr_b16 a[108:109], v21 offset:12288
  v_mfma_f32_16x16x32_bf16 v[132:135], a[84:87], a[12:15], 0
  buffer_load_dwordx4 v224, s[8:11], s46 offen offset:0 lds
  v_mfma_f32_16x16x32_bf16 v[136:139], a[84:87], a[16:19], 0
  ds_read_b64_tr_b16 a[110:111], v21 offset:14336
  v_mfma_f32_16x16x32_bf16 v[140:143], a[84:87], a[20:23], 0
  buffer_load_dwordx4 v225, s[8:11], s46 offen offset:1024 lds
  v_mfma_f32_16x16x32_bf16 v[144:147], a[84:87], a[24:27], 0
  ds_read_b64_tr_b16 a[112:113], v20 offset:20480
  v_mfma_f32_16x16x32_bf16 v[148:151], a[84:87], a[28:31], 0
  buffer_load_dwordx4 v226, s[8:11], s46 offen offset:2048 lds
  v_mfma_f32_16x16x32_bf16 v[152:155], a[0:3], a[88:91], 0
  ds_read_b64_tr_b16 a[114:115], v20 offset:22528
  v_mfma_f32_16x16x32_bf16 v[156:159], a[4:7], a[88:91], 0
  buffer_load_dwordx4 v227, s[8:11], s46 offen offset:3072 lds
  v_mfma_f32_16x16x32_bf16 v[160:163], a[8:11], a[88:91], 0
  s_add_u32 m0, s36, 73728
  ds_read_b128 a[68:71], v19 offset:0
  v_mfma_f32_16x16x32_bf16 v[164:167], a[12:15], a[88:91], 0
  buffer_load_dwordx4 v228, s[8:11], s46 offen offset:0 lds
  v_mfma_f32_16x16x32_bf16 v[168:171], a[16:19], a[88:91], 0
  s_add_u32 s37, s37, 1
  ds_read_b64_tr_b16 a[116:117], v21 offset:20480
  v_mfma_f32_16x16x32_bf16 v[172:175], a[20:23], a[88:91], 0
  buffer_load_dwordx4 v229, s[8:11], s46 offen offset:1024 lds
  v_mfma_f32_16x16x32_bf16 v[176:179], a[24:27], a[88:91], 0
  ds_read_b64_tr_b16 a[118:119], v21 offset:22528
  v_mfma_f32_16x16x32_bf16 v[180:183], a[28:31], a[88:91], 0
  buffer_load_dwordx4 v230, s[8:11], s46 offen offset:2048 lds
  v_mfma_f32_16x16x32_bf16 v[216:219], a[32:35], a[88:91], 0
  s_cmp_eq_u32 s37, 3
  s_cselect_b32 s37, 0, s37
  s_cselect_b32 s38, s39, s40
  v_mfma_f32_16x16x32_bf16 v[184:187], a[0:3], a[92:95], 0
  buffer_load_dwordx4 v231, s[8:11], s46 offen offset:3072 lds
  v_mfma_f32_16x16x32_bf16 v[188:191], a[4:7], a[92:95], 0
  s_sub_u32 s43, 0, s43
  v_mfma_f32_16x16x32_bf16 v[192:195], a[8:11], a[92:95], 0
  s_mul_i32 s47, s48, 393216
  v_add_u32 v16, s38, v16
  v_add_u32 v17, s38, v17
  v_mfma_f32_16x16x32_bf16 v[196:199], a[12:15], a[92:95], 0
  s_bfe_u32 s34, 0x302010e, s49
  v_add_u32 v18, s38, v18
  v_add_u32 v19, s38, v19
  v_mfma_f32_16x16x32_bf16 v[200:203], a[16:19], a[92:95], 0
  s_add_u32 s48, s48, s34
  s_add_u32 s49, s49, 8
  v_add_u32 v20, s43, v20
  v_mfma_f32_16x16x32_bf16 v[204:207], a[20:23], a[92:95], 0
  s_and_b32 s49, s49, 0x8001f
  s_and_b32 s48, s48, 15
  s_lshl_b32 s46, s48, 7
  v_mfma_f32_16x16x32_bf16 v[208:211], a[24:27], a[92:95], 0
  v_add_u32 v21, s43, v21
  v_mfma_f32_16x16x32_bf16 v[212:215], a[28:31], a[92:95], 0
  v_mfma_f32_16x16x32_bf16 v[220:223], a[32:35], a[92:95], 0
  s_mov_b32 s35, 13
  s_waitcnt vmcnt(8) lgkmcnt(0)
  s_barrier
  .p2align 6
Lp2r1_loop:
  v_mfma_f32_16x16x32_bf16 v[24:27], a[96:99], a[36:39], v[24:27]
  buffer_load_dwordx4 a[192:195], v2, s[52:55], s51 offen offset:0
  v_mfma_f32_16x16x32_bf16 v[28:31], a[96:99], a[40:43], v[28:31]
  ds_read_b128 a[0:3], v16 offset:0
  ds_read_b64_tr_b16 a[72:73], v20 offset:0
  v_mfma_f32_16x16x32_bf16 v[32:35], a[96:99], a[44:47], v[32:35]
  v_mfma_f32_16x16x32_bf16 v[36:39], a[96:99], a[48:51], v[36:39]
  ds_read_b64_tr_b16 a[74:75], v20 offset:2048
  v_mfma_f32_16x16x32_bf16 v[40:43], a[96:99], a[52:55], v[40:43]
  v_mfma_f32_16x16x32_bf16 v[44:47], a[96:99], a[56:59], v[44:47]
  buffer_load_dwordx4 a[192:195], v2, s[52:55], s51 offen offset:1024
  v_mfma_f32_16x16x32_bf16 v[48:51], a[96:99], a[60:63], v[48:51]
  ds_read_b128 a[4:7], v16 offset:2048
  v_mfma_f32_16x16x32_bf16 v[52:55], a[96:99], a[64:67], v[52:55]
  ds_read_b128 a[8:11], v16 offset:4096
  v_mfma_f32_16x16x32_bf16 v[56:59], a[100:103], a[36:39], v[56:59]
  v_mfma_f32_16x16x32_bf16 v[60:63], a[100:103], a[40:43], v[60:63]
  ds_read_b128 a[12:15], v16 offset:6144
  v_mfma_f32_16x16x32_bf16 v[64:67], a[100:103], a[44:47], v[64:67]
  buffer_load_dwordx4 a[192:195], v2, s[52:55], s51 offen offset:2048
  v_mfma_f32_16x16x32_bf16 v[68:71], a[100:103], a[48:51], v[68:71]
  ds_read_b128 a[16:19], v16 offset:8192
  v_mfma_f32_16x16x32_bf16 v[72:75], a[100:103], a[52:55], v[72:75]
  v_mfma_f32_16x16x32_bf16 v[76:79], a[100:103], a[56:59], v[76:79]
  ds_read_b128 a[20:23], v16 offset:10240
  v_mfma_f32_16x16x32_bf16 v[80:83], a[100:103], a[60:63], v[80:83]
  v_mfma_f32_16x16x32_bf16 v[84:87], a[100:103], a[64:67], v[84:87]
  ds_read_b128 a[24:27], v16 offset:12288
  v_mfma_f32_16x16x32_bf16 v[88:91], a[104:107], a[36:39], v[88:91]
  buffer_load_dwordx4 a[192:195], v2, s[52:55], s51 offen offset:3072
  v_mfma_f32_16x16x32_bf16 v[92:95], a[104:107], a[40:43], v[92:95]
  s_add_u32 s51, s51, 4096
  s_add_u32 s0, s0, 1
  s_cmp_eq_u32 s0, 2
  s_cselect_b32 s52, s68, s52
  s_cselect_b32 s53, s69, s53
  s_cselect_b32 s51, s1, s51
  s_cselect_b32 s54, 0, s54
  v_mfma_f32_16x16x32_bf16 v[96:99], a[104:107], a[44:47], v[96:99]
  s_cmp_eq_u32 s0, 6
  s_cselect_b32 s52, s64, s52
  s_cselect_b32 s53, s65, s53
  s_cselect_b32 s51, s56, s51
  s_cselect_b32 s54, 0, s54
  v_mfma_f32_16x16x32_bf16 v[100:103], a[104:107], a[48:51], v[100:103]
  s_cmp_eq_u32 s0, 8
  s_cselect_b32 s54, 0, s54
  s_mov_b32 m0, s41
  v_mfma_f32_16x16x32_bf16 v[104:107], a[104:107], a[52:55], v[104:107]
  ds_read_b128 a[28:31], v16 offset:14336
  ds_read_b64_tr_b16 a[76:77], v21 offset:0
  v_mfma_f32_16x16x32_bf16 v[108:111], a[104:107], a[56:59], v[108:111]
  buffer_load_dwordx4 v233, s[12:15], s47 offen offset:0 lds
  v_mfma_f32_16x16x32_bf16 v[112:115], a[104:107], a[60:63], v[112:115]
  ds_read_b64_tr_b16 a[78:79], v21 offset:2048
  ds_read_b64_tr_b16 a[80:81], v20 offset:8192
  v_mfma_f32_16x16x32_bf16 v[116:119], a[104:107], a[64:67], v[116:119]
  v_mfma_f32_16x16x32_bf16 v[120:123], a[108:111], a[36:39], v[120:123]
  ds_read_b64_tr_b16 a[82:83], v20 offset:10240
  v_mfma_f32_16x16x32_bf16 v[124:127], a[108:111], a[40:43], v[124:127]
  v_mfma_f32_16x16x32_bf16 v[128:131], a[108:111], a[44:47], v[128:131]
  ds_read_b64_tr_b16 a[84:85], v21 offset:8192
  v_mfma_f32_16x16x32_bf16 v[132:135], a[108:111], a[48:51], v[132:135]
  buffer_load_dwordx4 v234, s[12:15], s47 offen offset:1024 lds
  v_mfma_f32_16x16x32_bf16 v[136:139], a[108:111], a[52:55], v[136:139]
  ds_read_b64_tr_b16 a[86:87], v21 offset:10240
  v_mfma_f32_16x16x32_bf16 v[140:143], a[108:111], a[56:59], v[140:143]
  v_mfma_f32_16x16x32_bf16 v[144:147], a[108:111], a[60:63], v[144:147]
  ds_read_b64_tr_b16 a[88:89], v20 offset:16384
  v_mfma_f32_16x16x32_bf16 v[148:151], a[108:111], a[64:67], v[148:151]
  v_mfma_f32_16x16x32_bf16 v[152:155], a[36:39], a[112:115], v[152:155]
  buffer_load_dwordx4 v235, s[12:15], s47 offen offset:2048 lds
  v_mfma_f32_16x16x32_bf16 v[156:159], a[40:43], a[112:115], v[156:159]
  s_add_u32 m0, s41, 3072
  ds_read_b64_tr_b16 a[90:91], v20 offset:18432
  v_mfma_f32_16x16x32_bf16 v[160:163], a[44:47], a[112:115], v[160:163]
  ds_read_b128 a[32:35], v18 offset:0
  v_mfma_f32_16x16x32_bf16 v[164:167], a[48:51], a[112:115], v[164:167]
  v_mfma_f32_16x16x32_bf16 v[168:171], a[52:55], a[112:115], v[168:171]
  ds_read_b64_tr_b16 a[92:93], v21 offset:16384
  v_mfma_f32_16x16x32_bf16 v[172:175], a[56:59], a[112:115], v[172:175]
  v_mfma_f32_16x16x32_bf16 v[176:179], a[60:63], a[112:115], v[176:179]
  buffer_load_dwordx4 v236, s[12:15], s47 offen offset:0 lds
  v_mfma_f32_16x16x32_bf16 v[180:183], a[64:67], a[112:115], v[180:183]
  ds_read_b64_tr_b16 a[94:95], v21 offset:18432
  v_mfma_f32_16x16x32_bf16 v[216:219], a[68:71], a[112:115], v[216:219]
  v_mfma_f32_16x16x32_bf16 v[184:187], a[36:39], a[116:119], v[184:187]
  v_mfma_f32_16x16x32_bf16 v[188:191], a[40:43], a[116:119], v[188:191]
  v_mfma_f32_16x16x32_bf16 v[192:195], a[44:47], a[116:119], v[192:195]
  buffer_load_dwordx4 v237, s[12:15], s47 offen offset:1024 lds
  v_mfma_f32_16x16x32_bf16 v[196:199], a[48:51], a[116:119], v[196:199]
  v_mfma_f32_16x16x32_bf16 v[200:203], a[52:55], a[116:119], v[200:203]
  v_mfma_f32_16x16x32_bf16 v[204:207], a[56:59], a[116:119], v[204:207]
  v_mfma_f32_16x16x32_bf16 v[208:211], a[60:63], a[116:119], v[208:211]
  v_mfma_f32_16x16x32_bf16 v[212:215], a[64:67], a[116:119], v[212:215]
  v_mfma_f32_16x16x32_bf16 v[220:223], a[68:71], a[116:119], v[220:223]
  s_waitcnt lgkmcnt(0)
  v_mfma_f32_16x16x32_bf16 v[24:27], a[72:75], a[0:3], v[24:27]
  buffer_load_dwordx4 v238, s[12:15], s47 offen offset:2048 lds
  v_mfma_f32_16x16x32_bf16 v[28:31], a[72:75], a[4:7], v[28:31]
  s_mov_b32 m0, s36
  ds_read_b128 a[36:39], v17 offset:0
  ds_read_b64_tr_b16 a[96:97], v20 offset:4096
  v_mfma_f32_16x16x32_bf16 v[32:35], a[72:75], a[8:11], v[32:35]
  v_mfma_f32_16x16x32_bf16 v[36:39], a[72:75], a[12:15], v[36:39]
  ds_read_b64_tr_b16 a[98:99], v20 offset:6144
  v_mfma_f32_16x16x32_bf16 v[40:43], a[72:75], a[16:19], v[40:43]
  buffer_load_dwordx4 v224, s[8:11], s46 offen offset:0 lds
  v_mfma_f32_16x16x32_bf16 v[44:47], a[72:75], a[20:23], v[44:47]
  ds_read_b128 a[40:43], v17 offset:2048
  v_mfma_f32_16x16x32_bf16 v[48:51], a[72:75], a[24:27], v[48:51]
  v_mfma_f32_16x16x32_bf16 v[52:55], a[72:75], a[28:31], v[52:55]
  ds_read_b128 a[44:47], v17 offset:4096
  v_mfma_f32_16x16x32_bf16 v[56:59], a[76:79], a[0:3], v[56:59]
  v_mfma_f32_16x16x32_bf16 v[60:63], a[76:79], a[4:7], v[60:63]
  buffer_load_dwordx4 v225, s[8:11], s46 offen offset:1024 lds
  v_mfma_f32_16x16x32_bf16 v[64:67], a[76:79], a[8:11], v[64:67]
  ds_read_b128 a[48:51], v17 offset:6144
  v_mfma_f32_16x16x32_bf16 v[68:71], a[76:79], a[12:15], v[68:71]
  ds_read_b128 a[52:55], v17 offset:8192
  v_mfma_f32_16x16x32_bf16 v[72:75], a[76:79], a[16:19], v[72:75]
  v_mfma_f32_16x16x32_bf16 v[76:79], a[76:79], a[20:23], v[76:79]
  ds_read_b128 a[56:59], v17 offset:10240
  v_mfma_f32_16x16x32_bf16 v[80:83], a[76:79], a[24:27], v[80:83]
  buffer_load_dwordx4 v226, s[8:11], s46 offen offset:2048 lds
  v_mfma_f32_16x16x32_bf16 v[84:87], a[76:79], a[28:31], v[84:87]
  ds_read_b128 a[60:63], v17 offset:12288
  v_mfma_f32_16x16x32_bf16 v[88:91], a[80:83], a[0:3], v[88:91]
  v_mfma_f32_16x16x32_bf16 v[92:95], a[80:83], a[4:7], v[92:95]
  ds_read_b128 a[64:67], v17 offset:14336
  v_mfma_f32_16x16x32_bf16 v[96:99], a[80:83], a[8:11], v[96:99]
  v_mfma_f32_16x16x32_bf16 v[100:103], a[80:83], a[12:15], v[100:103]
  buffer_load_dwordx4 v227, s[8:11], s46 offen offset:3072 lds
  v_mfma_f32_16x16x32_bf16 v[104:107], a[80:83], a[16:19], v[104:107]
  s_add_u32 m0, s36, 4096
  ds_read_b64_tr_b16 a[100:101], v21 offset:4096
  ds_read_b64_tr_b16 a[102:103], v21 offset:6144
  v_mfma_f32_16x16x32_bf16 v[108:111], a[80:83], a[20:23], v[108:111]
  s_add_u32 s36, s36, s38
  v_mfma_f32_16x16x32_bf16 v[112:115], a[80:83], a[24:27], v[112:115]
  s_add_u32 s37, s37, 1
  ds_read_b64_tr_b16 a[104:105], v20 offset:12288
  v_mfma_f32_16x16x32_bf16 v[116:119], a[80:83], a[28:31], v[116:119]
  buffer_load_dwordx4 v228, s[8:11], s46 offen offset:0 lds
  v_mfma_f32_16x16x32_bf16 v[120:123], a[84:87], a[0:3], v[120:123]
  ds_read_b64_tr_b16 a[106:107], v20 offset:14336
  v_mfma_f32_16x16x32_bf16 v[124:127], a[84:87], a[4:7], v[124:127]
  s_cmp_eq_u32 s37, 3
  s_cselect_b32 s37, 0, s37
  s_cselect_b32 s38, s39, s40
  v_mfma_f32_16x16x32_bf16 v[128:131], a[84:87], a[8:11], v[128:131]
  s_add_u32 s41, s41, s43
  ds_read_b64_tr_b16 a[108:109], v21 offset:12288
  v_mfma_f32_16x16x32_bf16 v[132:135], a[84:87], a[12:15], v[132:135]
  s_sub_u32 s43, 0, s43
  v_mfma_f32_16x16x32_bf16 v[136:139], a[84:87], a[16:19], v[136:139]
  buffer_load_dwordx4 v229, s[8:11], s46 offen offset:1024 lds
  v_mfma_f32_16x16x32_bf16 v[140:143], a[84:87], a[20:23], v[140:143]
  ds_read_b64_tr_b16 a[110:111], v21 offset:14336
  v_mfma_f32_16x16x32_bf16 v[144:147], a[84:87], a[24:27], v[144:147]
  ds_read_b64_tr_b16 a[112:113], v20 offset:20480
  v_mfma_f32_16x16x32_bf16 v[148:151], a[84:87], a[28:31], v[148:151]
  v_mfma_f32_16x16x32_bf16 v[152:155], a[0:3], a[88:91], v[152:155]
  ds_read_b64_tr_b16 a[114:115], v20 offset:22528
  v_mfma_f32_16x16x32_bf16 v[156:159], a[4:7], a[88:91], v[156:159]
  buffer_load_dwordx4 v230, s[8:11], s46 offen offset:2048 lds
  v_mfma_f32_16x16x32_bf16 v[160:163], a[8:11], a[88:91], v[160:163]
  ds_read_b128 a[68:71], v19 offset:0
  v_mfma_f32_16x16x32_bf16 v[164:167], a[12:15], a[88:91], v[164:167]
  v_mfma_f32_16x16x32_bf16 v[168:171], a[16:19], a[88:91], v[168:171]
  ds_read_b64_tr_b16 a[116:117], v21 offset:20480
  v_mfma_f32_16x16x32_bf16 v[172:175], a[20:23], a[88:91], v[172:175]
  v_mfma_f32_16x16x32_bf16 v[176:179], a[24:27], a[88:91], v[176:179]
  buffer_load_dwordx4 v231, s[8:11], s46 offen offset:3072 lds
  v_mfma_f32_16x16x32_bf16 v[180:183], a[28:31], a[88:91], v[180:183]
  s_mul_i32 s47, s48, 393216
  ds_read_b64_tr_b16 a[118:119], v21 offset:22528
  v_mfma_f32_16x16x32_bf16 v[216:219], a[32:35], a[88:91], v[216:219]
  s_bfe_u32 s34, 0x302010e, s49
  v_add_u32 v16, s38, v16
  v_add_u32 v17, s38, v17
  v_mfma_f32_16x16x32_bf16 v[184:187], a[0:3], a[92:95], v[184:187]
  s_add_u32 s48, s48, s34
  v_add_u32 v18, s38, v18
  v_add_u32 v19, s38, v19
  v_mfma_f32_16x16x32_bf16 v[188:191], a[4:7], a[92:95], v[188:191]
  s_add_u32 s49, s49, 8
  v_add_u32 v20, s43, v20
  v_add_u32 v21, s43, v21
  v_mfma_f32_16x16x32_bf16 v[192:195], a[8:11], a[92:95], v[192:195]
  s_and_b32 s49, s49, 0x8001f
  v_mfma_f32_16x16x32_bf16 v[196:199], a[12:15], a[92:95], v[196:199]
  s_and_b32 s48, s48, 15
  v_mfma_f32_16x16x32_bf16 v[200:203], a[16:19], a[92:95], v[200:203]
  s_lshl_b32 s46, s48, 7
  v_mfma_f32_16x16x32_bf16 v[204:207], a[20:23], a[92:95], v[204:207]
  v_mfma_f32_16x16x32_bf16 v[208:211], a[24:27], a[92:95], v[208:211]
  s_waitcnt vmcnt(8) lgkmcnt(0)
  s_barrier
  v_mfma_f32_16x16x32_bf16 v[212:215], a[28:31], a[92:95], v[212:215]
  s_sub_u32 s35, s35, 1
  v_mfma_f32_16x16x32_bf16 v[220:223], a[32:35], a[92:95], v[220:223]
  s_cmp_lg_u32 s35, 0
  s_cbranch_scc1 Lp2r1_loop
  v_accvgpr_read_b32 v4, a222
  v_accvgpr_read_b32 v5, a223
  v_accvgpr_read_b32 v6, a224
  v_accvgpr_read_b32 v7, a225
  v_accvgpr_read_b32 v8, a226
  v_accvgpr_read_b32 v9, a227
  v_accvgpr_read_b32 v10, a228
  v_accvgpr_read_b32 v11, a229
  s_mov_b32 s8, s64
  s_mov_b32 s9, s65
  s_mov_b32 s10, 4194304
  s_mov_b32 s11, 0x00020000
  s_mov_b32 s20, s68
  s_mov_b32 s21, s69
  s_mov_b32 s22, 8388608
  s_mov_b32 s23, 0x00020000
  s_and_b32 s4, s2, 7
  s_lshl_b32 s4, s4, 1
  s_lshr_b32 s5, s2, 6
  s_lshr_b32 s30, s2, 4
  s_add_u32 s5, s5, s30
  s_and_b32 s53, s5, 3
  s_lshl_b32 s53, s53, 3
  s_or_b32 s53, s53, 0x80000
  s_bfe_u32 s52, 0xf0f02, s53
  s_add_u32 s52, s52, s4
  s_and_b32 s52, s52, 15
  s_mov_b32 s54, s52
  s_mov_b32 s55, s53
  s_lshl_b32 s29, s52, 7
  s_lshl_b32 s28, s54, 19
  s_lshl_b32 s30, s25, 18
  s_and_b32 s31, s25, 1
  s_lshl_b32 s31, s31, 1
  s_add_u32 s31, s31, 14
  s_sub_u32 s31, s31, s25
  s_lshl_b32 s31, s31, 18
  s_or_b32 s26, s30, s29
  s_or_b32 s27, s31, s29
  s_lshl_b32 s68, s3, 12
  s_lshl_b32 s88, s3, 13
  s_add_u32 s88, s88, 98304
  v_mfma_f32_16x16x32_bf16 v[24:27], a[96:99], a[36:39], v[24:27]
  s_mov_b32 m0, s41
  ds_read_b128 a[0:3], v16 offset:0
  v_mfma_f32_16x16x32_bf16 v[28:31], a[96:99], a[40:43], v[28:31]
  buffer_load_dwordx4 v233, s[12:15], s47 offen offset:0 lds
  v_mfma_f32_16x16x32_bf16 v[32:35], a[96:99], a[44:47], v[32:35]
  ds_read_b64_tr_b16 a[72:73], v20 offset:0
  v_mfma_f32_16x16x32_bf16 v[36:39], a[96:99], a[48:51], v[36:39]
  ds_read_b64_tr_b16 a[74:75], v20 offset:2048
  v_mfma_f32_16x16x32_bf16 v[40:43], a[96:99], a[52:55], v[40:43]
  v_mfma_f32_16x16x32_bf16 v[44:47], a[96:99], a[56:59], v[44:47]
  ds_read_b128 a[4:7], v16 offset:2048
  v_mfma_f32_16x16x32_bf16 v[48:51], a[96:99], a[60:63], v[48:51]
  v_mfma_f32_16x16x32_bf16 v[52:55], a[96:99], a[64:67], v[52:55]
  ds_read_b128 a[8:11], v16 offset:4096
  v_mfma_f32_16x16x32_bf16 v[56:59], a[100:103], a[36:39], v[56:59]
  v_mfma_f32_16x16x32_bf16 v[60:63], a[100:103], a[40:43], v[60:63]
  ds_read_b128 a[12:15], v16 offset:6144
  v_mfma_f32_16x16x32_bf16 v[64:67], a[100:103], a[44:47], v[64:67]
  v_mfma_f32_16x16x32_bf16 v[68:71], a[100:103], a[48:51], v[68:71]
  ds_read_b128 a[16:19], v16 offset:8192
  v_mfma_f32_16x16x32_bf16 v[72:75], a[100:103], a[52:55], v[72:75]
  v_mfma_f32_16x16x32_bf16 v[76:79], a[100:103], a[56:59], v[76:79]
  ds_read_b128 a[20:23], v16 offset:10240
  v_mfma_f32_16x16x32_bf16 v[80:83], a[100:103], a[60:63], v[80:83]
  v_mfma_f32_16x16x32_bf16 v[84:87], a[100:103], a[64:67], v[84:87]
  ds_read_b128 a[24:27], v16 offset:12288
  v_mfma_f32_16x16x32_bf16 v[88:91], a[104:107], a[36:39], v[88:91]
  buffer_load_dwordx4 v234, s[12:15], s47 offen offset:1024 lds
  v_mfma_f32_16x16x32_bf16 v[92:95], a[104:107], a[40:43], v[92:95]
  ds_read_b128 a[28:31], v16 offset:14336
  v_mfma_f32_16x16x32_bf16 v[96:99], a[104:107], a[44:47], v[96:99]
  v_mfma_f32_16x16x32_bf16 v[100:103], a[104:107], a[48:51], v[100:103]
  ds_read_b64_tr_b16 a[76:77], v21 offset:0
  v_mfma_f32_16x16x32_bf16 v[104:107], a[104:107], a[52:55], v[104:107]
  ds_read_b64_tr_b16 a[78:79], v21 offset:2048
  v_mfma_f32_16x16x32_bf16 v[108:111], a[104:107], a[56:59], v[108:111]
  v_mfma_f32_16x16x32_bf16 v[112:115], a[104:107], a[60:63], v[112:115]
  ds_read_b64_tr_b16 a[80:81], v20 offset:8192
  v_mfma_f32_16x16x32_bf16 v[116:119], a[104:107], a[64:67], v[116:119]
  v_mfma_f32_16x16x32_bf16 v[120:123], a[108:111], a[36:39], v[120:123]
  ds_read_b64_tr_b16 a[82:83], v20 offset:10240
  v_mfma_f32_16x16x32_bf16 v[124:127], a[108:111], a[40:43], v[124:127]
  v_mfma_f32_16x16x32_bf16 v[128:131], a[108:111], a[44:47], v[128:131]
  ds_read_b64_tr_b16 a[84:85], v21 offset:8192
  v_mfma_f32_16x16x32_bf16 v[132:135], a[108:111], a[48:51], v[132:135]
  v_mfma_f32_16x16x32_bf16 v[136:139], a[108:111], a[52:55], v[136:139]
  ds_read_b64_tr_b16 a[86:87], v21 offset:10240
  v_mfma_f32_16x16x32_bf16 v[140:143], a[108:111], a[56:59], v[140:143]
  v_mfma_f32_16x16x32_bf16 v[144:147], a[108:111], a[60:63], v[144:147]
  ds_read_b64_tr_b16 a[88:89], v20 offset:16384
  v_mfma_f32_16x16x32_bf16 v[148:151], a[108:111], a[64:67], v[148:151]
  v_mfma_f32_16x16x32_bf16 v[152:155], a[36:39], a[112:115], v[152:155]
  buffer_load_dwordx4 v235, s[12:15], s47 offen offset:2048 lds
  v_mfma_f32_16x16x32_bf16 v[156:159], a[40:43], a[112:115], v[156:159]
  ds_read_b64_tr_b16 a[90:91], v20 offset:18432
  v_mfma_f32_16x16x32_bf16 v[160:163], a[44:47], a[112:115], v[160:163]
  ds_read_b128 a[32:35], v18 offset:0
  v_mfma_f32_16x16x32_bf16 v[164:167], a[48:51], a[112:115], v[164:167]
  v_mfma_f32_16x16x32_bf16 v[168:171], a[52:55], a[112:115], v[168:171]
  ds_read_b64_tr_b16 a[92:93], v21 offset:16384
  v_mfma_f32_16x16x32_bf16 v[172:175], a[56:59], a[112:115], v[172:175]
  v_mfma_f32_16x16x32_bf16 v[176:179], a[60:63], a[112:115], v[176:179]
  ds_read_b64_tr_b16 a[94:95], v21 offset:18432
  v_mfma_f32_16x16x32_bf16 v[180:183], a[64:67], a[112:115], v[180:183]
  v_mfma_f32_16x16x32_bf16 v[216:219], a[68:71], a[112:115], v[216:219]
  v_mfma_f32_16x16x32_bf16 v[184:187], a[36:39], a[116:119], v[184:187]
  v_mfma_f32_16x16x32_bf16 v[188:191], a[40:43], a[116:119], v[188:191]
  v_mfma_f32_16x16x32_bf16 v[192:195], a[44:47], a[116:119], v[192:195]
  v_mfma_f32_16x16x32_bf16 v[196:199], a[48:51], a[116:119], v[196:199]
  v_mfma_f32_16x16x32_bf16 v[200:203], a[52:55], a[116:119], v[200:203]
  v_mfma_f32_16x16x32_bf16 v[204:207], a[56:59], a[116:119], v[204:207]
  v_mfma_f32_16x16x32_bf16 v[208:211], a[60:63], a[116:119], v[208:211]
  v_mfma_f32_16x16x32_bf16 v[212:215], a[64:67], a[116:119], v[212:215]
  v_mfma_f32_16x16x32_bf16 v[220:223], a[68:71], a[116:119], v[220:223]
  s_waitcnt lgkmcnt(0)
  v_mfma_f32_16x16x32_bf16 v[24:27], a[72:75], a[0:3], v[24:27]
  s_add_u32 m0, s41, 3072
  ds_read_b128 a[36:39], v17 offset:0
  v_mfma_f32_16x16x32_bf16 v[28:31], a[72:75], a[4:7], v[28:31]
  buffer_load_dwordx4 v236, s[12:15], s47 offen offset:0 lds
  v_mfma_f32_16x16x32_bf16 v[32:35], a[72:75], a[8:11], v[32:35]
  s_add_u32 s36, s36, s38
  ds_read_b64_tr_b16 a[96:97], v20 offset:4096
  v_mfma_f32_16x16x32_bf16 v[36:39], a[72:75], a[12:15], v[36:39]
  s_add_u32 s37, s37, 1
  ds_read_b64_tr_b16 a[98:99], v20 offset:6144
  v_mfma_f32_16x16x32_bf16 v[40:43], a[72:75], a[16:19], v[40:43]
  s_cmp_eq_u32 s37, 3
  s_cselect_b32 s37, 0, s37
  s_cselect_b32 s38, s39, s40
  v_mfma_f32_16x16x32_bf16 v[44:47], a[72:75], a[20:23], v[44:47]
  s_add_u32 s41, s41, s43
  ds_read_b128 a[40:43], v17 offset:2048
  v_mfma_f32_16x16x32_bf16 v[48:51], a[72:75], a[24:27], v[48:51]
  s_sub_u32 s43, 0, s43
  v_mfma_f32_16x16x32_bf16 v[52:55], a[72:75], a[28:31], v[52:55]
  ds_read_b128 a[44:47], v17 offset:4096
  v_mfma_f32_16x16x32_bf16 v[56:59], a[76:79], a[0:3], v[56:59]
  v_mfma_f32_16x16x32_bf16 v[60:63], a[76:79], a[4:7], v[60:63]
  ds_read_b128 a[48:51], v17 offset:6144
  v_mfma_f32_16x16x32_bf16 v[64:67], a[76:79], a[8:11], v[64:67]
  v_mfma_f32_16x16x32_bf16 v[68:71], a[76:79], a[12:15], v[68:71]
  ds_read_b128 a[52:55], v17 offset:8192
  v_mfma_f32_16x16x32_bf16 v[72:75], a[76:79], a[16:19], v[72:75]
  v_mfma_f32_16x16x32_bf16 v[76:79], a[76:79], a[20:23], v[76:79]
  ds_read_b128 a[56:59], v17 offset:10240
  v_mfma_f32_16x16x32_bf16 v[80:83], a[76:79], a[24:27], v[80:83]
  buffer_load_dwordx4 v237, s[12:15], s47 offen offset:1024 lds
  v_mfma_f32_16x16x32_bf16 v[84:87], a[76:79], a[28:31], v[84:87]
  ds_read_b128 a[60:63], v17 offset:12288
  v_mfma_f32_16x16x32_bf16 v[88:91], a[80:83], a[0:3], v[88:91]
  v_mfma_f32_16x16x32_bf16 v[92:95], a[80:83], a[4:7], v[92:95]
  ds_read_b128 a[64:67], v17 offset:14336
  v_mfma_f32_16x16x32_bf16 v[96:99], a[80:83], a[8:11], v[96:99]
  v_mfma_f32_16x16x32_bf16 v[100:103], a[80:83], a[12:15], v[100:103]
  ds_read_b64_tr_b16 a[100:101], v21 offset:4096
  v_mfma_f32_16x16x32_bf16 v[104:107], a[80:83], a[16:19], v[104:107]
  ds_read_b64_tr_b16 a[102:103], v21 offset:6144
  v_mfma_f32_16x16x32_bf16 v[108:111], a[80:83], a[20:23], v[108:111]
  v_mfma_f32_16x16x32_bf16 v[112:115], a[80:83], a[24:27], v[112:115]
  ds_read_b64_tr_b16 a[104:105], v20 offset:12288
  v_mfma_f32_16x16x32_bf16 v[116:119], a[80:83], a[28:31], v[116:119]
  v_mfma_f32_16x16x32_bf16 v[120:123], a[84:87], a[0:3], v[120:123]
  ds_read_b64_tr_b16 a[106:107], v20 offset:14336
  v_mfma_f32_16x16x32_bf16 v[124:127], a[84:87], a[4:7], v[124:127]
  v_mfma_f32_16x16x32_bf16 v[128:131], a[84:87], a[8:11], v[128:131]
  ds_read_b64_tr_b16 a[108:109], v21 offset:12288
  v_mfma_f32_16x16x32_bf16 v[132:135], a[84:87], a[12:15], v[132:135]
  v_mfma_f32_16x16x32_bf16 v[136:139], a[84:87], a[16:19], v[136:139]
  buffer_load_dwordx4 v238, s[12:15], s47 offen offset:2048 lds
  v_mfma_f32_16x16x32_bf16 v[140:143], a[84:87], a[20:23], v[140:143]
  ds_read_b64_tr_b16 a[110:111], v21 offset:14336
  v_mfma_f32_16x16x32_bf16 v[144:147], a[84:87], a[24:27], v[144:147]
  ds_read_b64_tr_b16 a[112:113], v20 offset:20480
  v_mfma_f32_16x16x32_bf16 v[148:151], a[84:87], a[28:31], v[148:151]
  v_mfma_f32_16x16x32_bf16 v[152:155], a[0:3], a[88:91], v[152:155]
  ds_read_b64_tr_b16 a[114:115], v20 offset:22528
  v_mfma_f32_16x16x32_bf16 v[156:159], a[4:7], a[88:91], v[156:159]
  v_mfma_f32_16x16x32_bf16 v[160:163], a[8:11], a[88:91], v[160:163]
  ds_read_b128 a[68:71], v19 offset:0
  v_mfma_f32_16x16x32_bf16 v[164:167], a[12:15], a[88:91], v[164:167]
  v_mfma_f32_16x16x32_bf16 v[168:171], a[16:19], a[88:91], v[168:171]
  ds_read_b64_tr_b16 a[116:117], v21 offset:20480
  v_mfma_f32_16x16x32_bf16 v[172:175], a[20:23], a[88:91], v[172:175]
  v_mfma_f32_16x16x32_bf16 v[176:179], a[24:27], a[88:91], v[176:179]
  ds_read_b64_tr_b16 a[118:119], v21 offset:22528
  v_mfma_f32_16x16x32_bf16 v[180:183], a[28:31], a[88:91], v[180:183]
  v_add_u32 v16, s38, v16
  v_add_u32 v17, s38, v17
  v_mfma_f32_16x16x32_bf16 v[216:219], a[32:35], a[88:91], v[216:219]
  v_add_u32 v18, s38, v18
  v_add_u32 v19, s38, v19
  v_mfma_f32_16x16x32_bf16 v[184:187], a[0:3], a[92:95], v[184:187]
  v_add_u32 v20, s43, v20
  v_add_u32 v21, s43, v21
  v_mfma_f32_16x16x32_bf16 v[188:191], a[4:7], a[92:95], v[188:191]
  v_mfma_f32_16x16x32_bf16 v[192:195], a[8:11], a[92:95], v[192:195]
  v_mfma_f32_16x16x32_bf16 v[196:199], a[12:15], a[92:95], v[196:199]
  v_mfma_f32_16x16x32_bf16 v[200:203], a[16:19], a[92:95], v[200:203]
  v_mfma_f32_16x16x32_bf16 v[204:207], a[20:23], a[92:95], v[204:207]
  v_mfma_f32_16x16x32_bf16 v[208:211], a[24:27], a[92:95], v[208:211]
  v_mfma_f32_16x16x32_bf16 v[212:215], a[28:31], a[92:95], v[212:215]
  v_mfma_f32_16x16x32_bf16 v[220:223], a[32:35], a[92:95], v[220:223]
  s_waitcnt vmcnt(0) lgkmcnt(0)
  s_barrier
  s_mov_b32 s6, 0x3e8293ee
  s_mov_b32 s7, s6
  v_mfma_f32_16x16x32_bf16 v[24:27], a[96:99], a[36:39], v[24:27]
  ds_read_b128 a[0:3], v16 offset:0
  v_mfma_f32_16x16x32_bf16 v[28:31], a[96:99], a[40:43], v[28:31]
  ds_read_b64_tr_b16 a[72:73], v20 offset:0
  v_mfma_f32_16x16x32_bf16 v[32:35], a[96:99], a[44:47], v[32:35]
  v_mfma_f32_16x16x32_bf16 v[36:39], a[96:99], a[48:51], v[36:39]
  ds_read_b64_tr_b16 a[74:75], v20 offset:2048
  v_mfma_f32_16x16x32_bf16 v[40:43], a[96:99], a[52:55], v[40:43]
  v_mfma_f32_16x16x32_bf16 v[44:47], a[96:99], a[56:59], v[44:47]
  ds_read_b128 a[4:7], v16 offset:2048
  v_mfma_f32_16x16x32_bf16 v[48:51], a[96:99], a[60:63], v[48:51]
  v_mfma_f32_16x16x32_bf16 v[52:55], a[96:99], a[64:67], v[52:55]
  ds_read_b128 a[8:11], v16 offset:4096
  v_mfma_f32_16x16x32_bf16 v[56:59], a[100:103], a[36:39], v[56:59]
  v_mfma_f32_16x16x32_bf16 v[60:63], a[100:103], a[40:43], v[60:63]
  ds_read_b128 a[12:15], v16 offset:6144
  v_mfma_f32_16x16x32_bf16 v[64:67], a[100:103], a[44:47], v[64:67]
  v_mfma_f32_16x16x32_bf16 v[68:71], a[100:103], a[48:51], v[68:71]
  ds_read_b128 a[16:19], v16 offset:8192
  v_mfma_f32_16x16x32_bf16 v[72:75], a[100:103], a[52:55], v[72:75]
  v_mfma_f32_16x16x32_bf16 v[76:79], a[100:103], a[56:59], v[76:79]
  ds_read_b128 a[20:23], v16 offset:10240
  v_mfma_f32_16x16x32_bf16 v[80:83], a[100:103], a[60:63], v[80:83]
  v_mfma_f32_16x16x32_bf16 v[84:87], a[100:103], a[64:67], v[84:87]
  ds_read_b128 a[24:27], v16 offset:12288
  v_mfma_f32_16x16x32_bf16 v[88:91], a[104:107], a[36:39], v[88:91]
  v_mfma_f32_16x16x32_bf16 v[92:95], a[104:107], a[40:43], v[92:95]
  ds_read_b128 a[28:31], v16 offset:14336
  v_mfma_f32_16x16x32_bf16 v[96:99], a[104:107], a[44:47], v[96:99]
  v_mfma_f32_16x16x32_bf16 v[100:103], a[104:107], a[48:51], v[100:103]
  ds_read_b64_tr_b16 a[76:77], v21 offset:0
  v_mfma_f32_16x16x32_bf16 v[104:107], a[104:107], a[52:55], v[104:107]
  ds_read_b64_tr_b16 a[78:79], v21 offset:2048
  v_mfma_f32_16x16x32_bf16 v[108:111], a[104:107], a[56:59], v[108:111]
  v_mfma_f32_16x16x32_bf16 v[112:115], a[104:107], a[60:63], v[112:115]
  ds_read_b64_tr_b16 a[80:81], v20 offset:8192
  v_mfma_f32_16x16x32_bf16 v[116:119], a[104:107], a[64:67], v[116:119]
  v_mfma_f32_16x16x32_bf16 v[120:123], a[108:111], a[36:39], v[120:123]
  ds_read_b64_tr_b16 a[82:83], v20 offset:10240
  v_mfma_f32_16x16x32_bf16 v[124:127], a[108:111], a[40:43], v[124:127]
  v_mfma_f32_16x16x32_bf16 v[128:131], a[108:111], a[44:47], v[128:131]
  ds_read_b64_tr_b16 a[84:85], v21 offset:8192
  v_mfma_f32_16x16x32_bf16 v[132:135], a[108:111], a[48:51], v[132:135]
  v_mfma_f32_16x16x32_bf16 v[136:139], a[108:111], a[52:55], v[136:139]
  ds_read_b64_tr_b16 a[86:87], v21 offset:10240
  v_mfma_f32_16x16x32_bf16 v[140:143], a[108:111], a[56:59], v[140:143]
  v_mfma_f32_16x16x32_bf16 v[144:147], a[108:111], a[60:63], v[144:147]
  ds_read_b64_tr_b16 a[88:89], v20 offset:16384
  v_mfma_f32_16x16x32_bf16 v[148:151], a[108:111], a[64:67], v[148:151]
  v_mfma_f32_16x16x32_bf16 v[152:155], a[36:39], a[112:115], v[152:155]
  ds_read_b64_tr_b16 a[90:91], v20 offset:18432
  v_mfma_f32_16x16x32_bf16 v[156:159], a[40:43], a[112:115], v[156:159]
  v_mfma_f32_16x16x32_bf16 v[160:163], a[44:47], a[112:115], v[160:163]
  ds_read_b128 a[32:35], v18 offset:0
  v_mfma_f32_16x16x32_bf16 v[164:167], a[48:51], a[112:115], v[164:167]
  v_mfma_f32_16x16x32_bf16 v[168:171], a[52:55], a[112:115], v[168:171]
  ds_read_b64_tr_b16 a[92:93], v21 offset:16384
  v_mfma_f32_16x16x32_bf16 v[172:175], a[56:59], a[112:115], v[172:175]
  v_mfma_f32_16x16x32_bf16 v[176:179], a[60:63], a[112:115], v[176:179]
  ds_read_b64_tr_b16 a[94:95], v21 offset:18432
  v_mfma_f32_16x16x32_bf16 v[180:183], a[64:67], a[112:115], v[180:183]
  v_mfma_f32_16x16x32_bf16 v[216:219], a[68:71], a[112:115], v[216:219]
  v_mfma_f32_16x16x32_bf16 v[184:187], a[36:39], a[116:119], v[184:187]
  v_mfma_f32_16x16x32_bf16 v[188:191], a[40:43], a[116:119], v[188:191]
  v_mfma_f32_16x16x32_bf16 v[192:195], a[44:47], a[116:119], v[192:195]
  v_mfma_f32_16x16x32_bf16 v[196:199], a[48:51], a[116:119], v[196:199]
  v_mfma_f32_16x16x32_bf16 v[200:203], a[52:55], a[116:119], v[200:203]
  v_mfma_f32_16x16x32_bf16 v[204:207], a[56:59], a[116:119], v[204:207]
  v_mfma_f32_16x16x32_bf16 v[208:211], a[60:63], a[116:119], v[208:211]
  v_mfma_f32_16x16x32_bf16 v[212:215], a[64:67], a[116:119], v[212:215]
  v_mfma_f32_16x16x32_bf16 v[220:223], a[68:71], a[116:119], v[220:223]
  s_waitcnt lgkmcnt(0)
  v_mfma_f32_16x16x32_bf16 v[24:27], a[72:75], a[0:3], v[24:27]
  ds_read_b128 a[36:39], v17 offset:0
  ds_read_b64_tr_b16 a[96:97], v20 offset:4096
  v_mfma_f32_16x16x32_bf16 v[56:59], a[76:79], a[0:3], v[56:59]
  ds_read_b64_tr_b16 a[98:99], v20 offset:6144
  ds_read_b128 a[40:43], v17 offset:2048
  v_mfma_f32_16x16x32_bf16 v[28:31], a[72:75], a[4:7], v[28:31]
  ds_read_b128 a[44:47], v17 offset:4096
  ds_read_b128 a[48:51], v17 offset:6144
  v_mfma_f32_16x16x32_bf16 v[60:63], a[76:79], a[4:7], v[60:63]
  ds_read_b128 a[52:55], v17 offset:8192
  ds_read_b128 a[56:59], v17 offset:10240
  v_mfma_f32_16x16x32_bf16 v[32:35], a[72:75], a[8:11], v[32:35]
  ds_read_b128 a[60:63], v17 offset:12288
  ds_read_b128 a[64:67], v17 offset:14336
  v_mfma_f32_16x16x32_bf16 v[64:67], a[76:79], a[8:11], v[64:67]
  ds_read_b64_tr_b16 a[100:101], v21 offset:4096
  ds_read_b64_tr_b16 a[102:103], v21 offset:6144
  v_mfma_f32_16x16x32_bf16 v[36:39], a[72:75], a[12:15], v[36:39]
  ds_read_b64_tr_b16 a[104:105], v20 offset:12288
  ds_read_b64_tr_b16 a[106:107], v20 offset:14336
  v_mfma_f32_16x16x32_bf16 v[68:71], a[76:79], a[12:15], v[68:71]
  ds_read_b64_tr_b16 a[108:109], v21 offset:12288
  ds_read_b64_tr_b16 a[110:111], v21 offset:14336
  v_mfma_f32_16x16x32_bf16 v[40:43], a[72:75], a[16:19], v[40:43]
  ds_read_b64_tr_b16 a[112:113], v20 offset:20480
  ds_read_b64_tr_b16 a[114:115], v20 offset:22528
  v_mfma_f32_16x16x32_bf16 v[72:75], a[76:79], a[16:19], v[72:75]
  ds_read_b128 a[68:71], v19 offset:0
  ds_read_b64_tr_b16 a[116:117], v21 offset:20480
  v_mfma_f32_16x16x32_bf16 v[44:47], a[72:75], a[20:23], v[44:47]
  ds_read_b64_tr_b16 a[118:119], v21 offset:22528
  v_mfma_f32_16x16x32_bf16 v[76:79], a[76:79], a[20:23], v[76:79]
  v_mfma_f32_16x16x32_bf16 v[48:51], a[72:75], a[24:27], v[48:51]
  v_mfma_f32_16x16x32_bf16 v[80:83], a[76:79], a[24:27], v[80:83]
  v_mfma_f32_16x16x32_bf16 v[52:55], a[72:75], a[28:31], v[52:55]
  v_mfma_f32_16x16x32_bf16 v[84:87], a[76:79], a[28:31], v[84:87]
  s_waitcnt lgkmcnt(0)
  s_barrier
  s_mov_b32 s12, s84
  s_mov_b32 s13, s85
  s_mov_b32 s14, 256
  s_mov_b32 s15, 0x00020000
  buffer_load_dwordx2 v[22:23], off, s[12:15], 0 sc1
  v_mfma_f32_16x16x32_bf16 v[24:27], a[96:99], a[36:39], v[24:27]
  s_mov_b32 m0, s68
  v_mfma_f32_16x16x32_bf16 v[56:59], a[100:103], a[36:39], v[56:59]
  buffer_load_dwordx4 v8, s[20:23], s28 offen offset:0 lds
  v_mfma_f32_16x16x32_bf16 v[28:31], a[96:99], a[40:43], v[28:31]
  v_mfma_f32_16x16x32_bf16 v[60:63], a[100:103], a[40:43], v[60:63]
  v_mfma_f32_16x16x32_bf16 v[32:35], a[96:99], a[44:47], v[32:35]
  v_mfma_f32_16x16x32_bf16 v[64:67], a[100:103], a[44:47], v[64:67]
  buffer_load_dwordx4 v9, s[20:23], s28 offen offset:1024 lds
  v_pk_mul_f32 v[24:25], v[24:25], s[6:7]
  v_mfma_f32_16x16x32_bf16 v[36:39], a[96:99], a[48:51], v[36:39]
  v_pk_mul_f32 v[26:27], v[26:27], s[6:7]
  v_pk_mul_f32 v[56:57], v[56:57], s[6:7]
  v_mfma_f32_16x16x32_bf16 v[68:71], a[100:103], a[48:51], v[68:71]
  v_pk_mul_f32 v[58:59], v[58:59], s[6:7]
  v_cvt_pk_bf16_f32 v24, v24, v25
  v_mfma_f32_16x16x32_bf16 v[40:43], a[96:99], a[52:55], v[40:43]
  v_cvt_pk_bf16_f32 v25, v26, v27
  v_cvt_pk_bf16_f32 v26, v56, v57
  v_mfma_f32_16x16x32_bf16 v[72:75], a[100:103], a[52:55], v[72:75]
  v_cvt_pk_bf16_f32 v27, v58, v59
  v_pk_mul_f32 v[28:29], v[28:29], s[6:7]
  v_mfma_f32_16x16x32_bf16 v[44:47], a[96:99], a[56:59], v[44:47]
  buffer_load_dwordx4 v10, s[20:23], s28 offen offset:2048 lds
  v_pk_mul_f32 v[30:31], v[30:31], s[6:7]
  v_mfma_f32_16x16x32_bf16 v[76:79], a[100:103], a[56:59], v[76:79]
  v_pk_mul_f32 v[60:61], v[60:61], s[6:7]
  v_pk_mul_f32 v[62:63], v[62:63], s[6:7]
  v_mfma_f32_16x16x32_bf16 v[48:51], a[96:99], a[60:63], v[48:51]
  v_cvt_pk_bf16_f32 v28, v28, v29
  v_cvt_pk_bf16_f32 v29, v30, v31
  v_mfma_f32_16x16x32_bf16 v[80:83], a[100:103], a[60:63], v[80:83]
  v_cvt_pk_bf16_f32 v30, v60, v61
  v_cvt_pk_bf16_f32 v31, v62, v63
  v_mfma_f32_16x16x32_bf16 v[52:55], a[96:99], a[64:67], v[52:55]
  v_pk_mul_f32 v[32:33], v[32:33], s[6:7]
  v_pk_mul_f32 v[34:35], v[34:35], s[6:7]
  v_mfma_f32_16x16x32_bf16 v[84:87], a[100:103], a[64:67], v[84:87]
  buffer_load_dwordx4 v11, s[20:23], s28 offen offset:3072 lds
  v_pk_mul_f32 v[64:65], v[64:65], s[6:7]
  v_mfma_f32_16x16x32_bf16 v[88:91], a[80:83], a[0:3], v[88:91]
  s_bfe_u32 s56, 0x302010e, s55
  s_add_u32 s54, s54, s56
  s_add_u32 s55, s55, 8
  v_mfma_f32_16x16x32_bf16 v[120:123], a[84:87], a[0:3], v[120:123]
  s_and_b32 s55, s55, 0x8001f
  s_and_b32 s54, s54, 15
  s_lshl_b32 s28, s54, 19
  v_mfma_f32_16x16x32_bf16 v[88:91], a[104:107], a[36:39], v[88:91]
  s_add_u32 m0, s68, 16384
  v_pk_mul_f32 v[66:67], v[66:67], s[6:7]
  v_cvt_pk_bf16_f32 v32, v32, v33
  v_mfma_f32_16x16x32_bf16 v[120:123], a[108:111], a[36:39], v[120:123]
  v_cvt_pk_bf16_f32 v33, v34, v35
  v_cvt_pk_bf16_f32 v34, v64, v65
  v_mfma_f32_16x16x32_bf16 v[92:95], a[80:83], a[4:7], v[92:95]
  buffer_load_dwordx4 v8, s[20:23], s28 offen offset:0 lds
  v_cvt_pk_bf16_f32 v35, v66, v67
  v_mfma_f32_16x16x32_bf16 v[124:127], a[84:87], a[4:7], v[124:127]
  v_pk_mul_f32 v[36:37], v[36:37], s[6:7]
  v_pk_mul_f32 v[38:39], v[38:39], s[6:7]
  v_mfma_f32_16x16x32_bf16 v[92:95], a[104:107], a[40:43], v[92:95]
  v_pk_mul_f32 v[68:69], v[68:69], s[6:7]
  v_pk_mul_f32 v[70:71], v[70:71], s[6:7]
  v_mfma_f32_16x16x32_bf16 v[124:127], a[108:111], a[40:43], v[124:127]
  v_cvt_pk_bf16_f32 v36, v36, v37
  v_cvt_pk_bf16_f32 v37, v38, v39
  v_mfma_f32_16x16x32_bf16 v[96:99], a[80:83], a[8:11], v[96:99]
  v_cvt_pk_bf16_f32 v38, v68, v69
  v_cvt_pk_bf16_f32 v39, v70, v71
  v_mfma_f32_16x16x32_bf16 v[128:131], a[84:87], a[8:11], v[128:131]
  buffer_load_dwordx4 v9, s[20:23], s28 offen offset:1024 lds
  v_pk_mul_f32 v[40:41], v[40:41], s[6:7]
  v_mfma_f32_16x16x32_bf16 v[96:99], a[104:107], a[44:47], v[96:99]
  v_pk_mul_f32 v[42:43], v[42:43], s[6:7]
  v_pk_mul_f32 v[72:73], v[72:73], s[6:7]
  v_mfma_f32_16x16x32_bf16 v[128:131], a[108:111], a[44:47], v[128:131]
  v_pk_mul_f32 v[74:75], v[74:75], s[6:7]
  v_cvt_pk_bf16_f32 v40, v40, v41
  v_mfma_f32_16x16x32_bf16 v[100:103], a[80:83], a[12:15], v[100:103]
  v_cvt_pk_bf16_f32 v41, v42, v43
  v_cvt_pk_bf16_f32 v42, v72, v73
  v_mfma_f32_16x16x32_bf16 v[132:135], a[84:87], a[12:15], v[132:135]
  v_cvt_pk_bf16_f32 v43, v74, v75
  v_pk_mul_f32 v[44:45], v[44:45], s[6:7]
  v_mfma_f32_16x16x32_bf16 v[100:103], a[104:107], a[48:51], v[100:103]
  v_pk_mul_f32 v[46:47], v[46:47], s[6:7]
  v_pk_mul_f32 v[76:77], v[76:77], s[6:7]
  v_mfma_f32_16x16x32_bf16 v[132:135], a[108:111], a[48:51], v[132:135]
  buffer_load_dwordx4 v10, s[20:23], s28 offen offset:2048 lds
  v_pk_mul_f32 v[78:79], v[78:79], s[6:7]
  v_mfma_f32_16x16x32_bf16 v[104:107], a[80:83], a[16:19], v[104:107]
  v_cvt_pk_bf16_f32 v44, v44, v45
  v_cvt_pk_bf16_f32 v45, v46, v47
  v_mfma_f32_16x16x32_bf16 v[136:139], a[84:87], a[16:19], v[136:139]
  v_cvt_pk_bf16_f32 v46, v76, v77
  v_cvt_pk_bf16_f32 v47, v78, v79
  v_mfma_f32_16x16x32_bf16 v[104:107], a[104:107], a[52:55], v[104:107]
  v_pk_mul_f32 v[48:49], v[48:49], s[6:7]
  v_pk_mul_f32 v[50:51], v[50:51], s[6:7]
  v_mfma_f32_16x16x32_bf16 v[136:139], a[108:111], a[52:55], v[136:139]
  v_pk_mul_f32 v[80:81], v[80:81], s[6:7]
  v_pk_mul_f32 v[82:83], v[82:83], s[6:7]
  v_mfma_f32_16x16x32_bf16 v[108:111], a[80:83], a[20:23], v[108:111]
  buffer_load_dwordx4 v11, s[20:23], s28 offen offset:3072 lds
  v_cvt_pk_bf16_f32 v48, v48, v49
  v_mfma_f32_16x16x32_bf16 v[140:143], a[84:87], a[20:23], v[140:143]
  s_bfe_u32 s56, 0x302010e, s55
  s_add_u32 s54, s54, s56
  s_add_u32 s55, s55, 8
  v_mfma_f32_16x16x32_bf16 v[108:111], a[104:107], a[56:59], v[108:111]
  s_and_b32 s55, s55, 0x8001f
  s_and_b32 s54, s54, 15
  s_lshl_b32 s28, s54, 19
  v_mfma_f32_16x16x32_bf16 v[140:143], a[108:111], a[56:59], v[140:143]
  s_mov_b32 m0, s88
  v_cvt_pk_bf16_f32 v49, v50, v51
  v_cvt_pk_bf16_f32 v50, v80, v81
  v_mfma_f32_16x16x32_bf16 v[112:115], a[80:83], a[24:27], v[112:115]
  v_cvt_pk_bf16_f32 v51, v82, v83
  v_pk_mul_f32 v[52:53], v[52:53], s[6:7]
  v_mfma_f32_16x16x32_bf16 v[144:147], a[84:87], a[24:27], v[144:147]
  buffer_load_dwordx4 v4, s[8:11], s26 offen offset:0 lds
  v_pk_mul_f32 v[54:55], v[54:55], s[6:7]
  v_mfma_f32_16x16x32_bf16 v[112:115], a[104:107], a[60:63], v[112:115]
  v_pk_mul_f32 v[84:85], v[84:85], s[6:7]
  v_pk_mul_f32 v[86:87], v[86:87], s[6:7]
  v_mfma_f32_16x16x32_bf16 v[144:147], a[108:111], a[60:63], v[144:147]
  v_cvt_pk_bf16_f32 v52, v52, v53
  v_cvt_pk_bf16_f32 v53, v54, v55
  v_mfma_f32_16x16x32_bf16 v[116:119], a[80:83], a[28:31], v[116:119]
  v_cvt_pk_bf16_f32 v54, v84, v85
  v_cvt_pk_bf16_f32 v55, v86, v87
  v_mfma_f32_16x16x32_bf16 v[148:151], a[84:87], a[28:31], v[148:151]
  v_cvt_pk_bf16_f32 v88, v88, v89
  v_cvt_pk_bf16_f32 v89, v90, v91
  v_mfma_f32_16x16x32_bf16 v[116:119], a[104:107], a[64:67], v[116:119]
  buffer_load_dwordx4 v5, s[8:11], s26 offen offset:1024 lds
  v_cvt_pk_bf16_f32 v90, v120, v121
  v_mfma_f32_16x16x32_bf16 v[148:151], a[108:111], a[64:67], v[148:151]
  v_cvt_pk_bf16_f32 v91, v122, v123
  v_cvt_pk_bf16_f32 v92, v92, v93
  v_mfma_f32_16x16x32_bf16 v[216:219], a[32:35], a[88:91], v[216:219]
  v_cvt_pk_bf16_f32 v93, v94, v95
  v_cvt_pk_bf16_f32 v94, v124, v125
  v_mfma_f32_16x16x32_bf16 v[220:223], a[32:35], a[92:95], v[220:223]
  v_cvt_pk_bf16_f32 v95, v126, v127
  v_cvt_pk_bf16_f32 v96, v96, v97
  v_mfma_f32_16x16x32_bf16 v[216:219], a[68:71], a[112:115], v[216:219]
  v_cvt_pk_bf16_f32 v97, v98, v99
  v_cvt_pk_bf16_f32 v98, v128, v129
  v_mfma_f32_16x16x32_bf16 v[220:223], a[68:71], a[116:119], v[220:223]
  buffer_load_dwordx4 v6, s[8:11], s26 offen offset:2048 lds
  v_cvt_pk_bf16_f32 v99, v130, v131
  v_mfma_f32_16x16x32_bf16 v[180:183], a[28:31], a[88:91], v[180:183]
  v_cvt_pk_bf16_f32 v100, v100, v101
  v_cvt_pk_bf16_f32 v101, v102, v103
  v_mfma_f32_16x16x32_bf16 v[212:215], a[28:31], a[92:95], v[212:215]
  v_cvt_pk_bf16_f32 v102, v132, v133
  v_cvt_pk_bf16_f32 v103, v134, v135
  v_mfma_f32_16x16x32_bf16 v[180:183], a[64:67], a[112:115], v[180:183]
  v_cvt_pk_bf16_f32 v104, v104, v105
  v_cvt_pk_bf16_f32 v105, v106, v107
  v_mfma_f32_16x16x32_bf16 v[212:215], a[64:67], a[116:119], v[212:215]
  v_cvt_pk_bf16_f32 v106, v136, v137
  v_cvt_pk_bf16_f32 v107, v138, v139
  v_mfma_f32_16x16x32_bf16 v[176:179], a[24:27], a[88:91], v[176:179]
  v_cvt_pk_bf16_f32 v108, v108, v109
  v_cvt_pk_bf16_f32 v109, v110, v111
  v_mfma_f32_16x16x32_bf16 v[208:211], a[24:27], a[92:95], v[208:211]
  buffer_load_dwordx4 v7, s[8:11], s26 offen offset:3072 lds
  v_cvt_pk_bf16_f32 v110, v140, v141
  v_mfma_f32_16x16x32_bf16 v[176:179], a[60:63], a[112:115], v[176:179]
  s_add_u32 m0, s88, 4096
  v_cvt_pk_bf16_f32 v111, v142, v143
  v_cvt_pk_bf16_f32 v112, v112, v113
  v_mfma_f32_16x16x32_bf16 v[208:211], a[60:63], a[116:119], v[208:211]
  v_cvt_pk_bf16_f32 v113, v114, v115
  v_cvt_pk_bf16_f32 v114, v144, v145
  v_mfma_f32_16x16x32_bf16 v[172:175], a[20:23], a[88:91], v[172:175]
  v_cvt_pk_bf16_f32 v115, v146, v147
  v_cvt_pk_bf16_f32 v116, v116, v117
  v_mfma_f32_16x16x32_bf16 v[204:207], a[20:23], a[92:95], v[204:207]
  v_cvt_pk_bf16_f32 v117, v118, v119
  v_cvt_pk_bf16_f32 v118, v148, v149
  v_mfma_f32_16x16x32_bf16 v[172:175], a[56:59], a[112:115], v[172:175]
  buffer_load_dwordx4 v4, s[8:11], s27 offen offset:0 lds
  v_cvt_pk_bf16_f32 v119, v150, v151
  v_mfma_f32_16x16x32_bf16 v[204:207], a[56:59], a[116:119], v[204:207]
  v_cvt_pk_bf16_f32 v216, v216, v217
  v_cvt_pk_bf16_f32 v217, v218, v219
  v_mfma_f32_16x16x32_bf16 v[168:171], a[16:19], a[88:91], v[168:171]
  v_cvt_pk_bf16_f32 v218, v220, v221
  v_cvt_pk_bf16_f32 v219, v222, v223
  v_mfma_f32_16x16x32_bf16 v[200:203], a[16:19], a[92:95], v[200:203]
  ds_write_b128 v252, v[216:219] offset:1024
  v_cvt_pk_bf16_f32 v72, v180, v181
  v_mfma_f32_16x16x32_bf16 v[168:171], a[52:55], a[112:115], v[168:171]
  v_cvt_pk_bf16_f32 v73, v182, v183
  v_cvt_pk_bf16_f32 v136, v212, v213
  v_mfma_f32_16x16x32_bf16 v[200:203], a[52:55], a[116:119], v[200:203]
  buffer_load_dwordx4 v5, s[8:11], s27 offen offset:1024 lds
  v_cvt_pk_bf16_f32 v137, v214, v215
  v_mfma_f32_16x16x32_bf16 v[164:167], a[12:15], a[88:91], v[164:167]
  v_cvt_pk_bf16_f32 v70, v176, v177
  v_cvt_pk_bf16_f32 v71, v178, v179
  v_mfma_f32_16x16x32_bf16 v[196:199], a[12:15], a[92:95], v[196:199]
  v_cvt_pk_bf16_f32 v134, v208, v209
  v_cvt_pk_bf16_f32 v135, v210, v211
  v_mfma_f32_16x16x32_bf16 v[164:167], a[48:51], a[112:115], v[164:167]
  v_cvt_pk_bf16_f32 v68, v172, v173
  v_cvt_pk_bf16_f32 v69, v174, v175
  v_mfma_f32_16x16x32_bf16 v[196:199], a[48:51], a[116:119], v[196:199]
  v_cvt_pk_bf16_f32 v132, v204, v205
  v_cvt_pk_bf16_f32 v133, v206, v207
  v_mfma_f32_16x16x32_bf16 v[160:163], a[8:11], a[88:91], v[160:163]
  buffer_load_dwordx4 v6, s[8:11], s27 offen offset:2048 lds
  v_cvt_pk_bf16_f32 v66, v168, v169
  v_mfma_f32_16x16x32_bf16 v[192:195], a[8:11], a[92:95], v[192:195]
  v_cvt_pk_bf16_f32 v67, v170, v171
  v_cvt_pk_bf16_f32 v130, v200, v201
  v_mfma_f32_16x16x32_bf16 v[160:163], a[44:47], a[112:115], v[160:163]
  v_cvt_pk_bf16_f32 v131, v202, v203
  v_mfma_f32_16x16x32_bf16 v[192:195], a[44:47], a[116:119], v[192:195]
  v_cvt_pk_bf16_f32 v64, v164, v165
  v_cvt_pk_bf16_f32 v65, v166, v167
  v_mfma_f32_16x16x32_bf16 v[156:159], a[4:7], a[88:91], v[156:159]
  v_cvt_pk_bf16_f32 v128, v196, v197
  v_cvt_pk_bf16_f32 v129, v198, v199
  v_mfma_f32_16x16x32_bf16 v[188:191], a[4:7], a[92:95], v[188:191]
  buffer_load_dwordx4 v7, s[8:11], s27 offen offset:3072 lds
  v_mfma_f32_16x16x32_bf16 v[156:159], a[40:43], a[112:115], v[156:159]
  s_bfe_u32 s29, 0x302010e, s53
  s_add_u32 s52, s52, s29
  s_add_u32 s53, s53, 8
  v_mfma_f32_16x16x32_bf16 v[188:191], a[40:43], a[116:119], v[188:191]
  s_and_b32 s53, s53, 0x8001f
  s_and_b32 s52, s52, 15
  s_lshl_b32 s29, s52, 7
  v_mfma_f32_16x16x32_bf16 v[152:155], a[0:3], a[88:91], v[152:155]
  s_or_b32 s26, s30, s29
  s_or_b32 s27, s31, s29
  v_cvt_pk_bf16_f32 v62, v160, v161
  v_mfma_f32_16x16x32_bf16 v[184:187], a[0:3], a[92:95], v[184:187]
  v_cvt_pk_bf16_f32 v63, v162, v163
  v_cvt_pk_bf16_f32 v126, v192, v193
  v_mfma_f32_16x16x32_bf16 v[152:155], a[36:39], a[112:115], v[152:155]
  v_cvt_pk_bf16_f32 v127, v194, v195
  v_mfma_f32_16x16x32_bf16 v[184:187], a[36:39], a[116:119], v[184:187]
  v_cvt_pk_bf16_f32 v60, v156, v157
  v_cvt_pk_bf16_f32 v61, v158, v159
  v_cvt_pk_bf16_f32 v124, v188, v189
  v_cvt_pk_bf16_f32 v125, v190, v191
  s_nop 1
  v_cvt_pk_bf16_f32 v58, v152, v153
  v_cvt_pk_bf16_f32 v59, v154, v155
  v_cvt_pk_bf16_f32 v122, v184, v185
  v_cvt_pk_bf16_f32 v123, v186, v187
  s_waitcnt lgkmcnt(0)
  s_barrier
Lp2_at:
  ds_read_b128 v[76:79], v253
  ds_read_b64 v[56:57], v253 offset:1024
  ds_read_b64 v[120:121], v253 offset:1032
  v_mfma_f32_16x16x32_bf16 v[208:211], v[112:115], v[52:55], v[240:243]
  s_add_u32 m0, s88, 32768
  s_nop 0
  buffer_load_dwordx4 v4, s[8:11], s26 offen offset:0 lds
  v_mfma_f32_16x16x32_bf16 v[212:215], v[116:119], v[52:55], v[244:247]
  v_mfma_f32_16x16x32_bf16 v[200:203], v[108:111], v[48:51], v[240:243]
  v_mfma_f32_16x16x32_bf16 v[204:207], v[112:115], v[48:51], v[244:247]
  v_mfma_f32_16x16x32_bf16 v[192:195], v[104:107], v[44:47], v[240:243]
  v_mfma_f32_16x16x32_bf16 v[196:199], v[108:111], v[44:47], v[244:247]
  v_mfma_f32_16x16x32_bf16 v[184:187], v[100:103], v[40:43], v[240:243]
  v_mfma_f32_16x16x32_bf16 v[188:191], v[104:107], v[40:43], v[244:247]
  v_mfma_f32_16x16x32_bf16 v[176:179], v[96:99], v[36:39], v[240:243]
  v_mfma_f32_16x16x32_bf16 v[180:183], v[100:103], v[36:39], v[244:247]
  v_mfma_f32_16x16x32_bf16 v[168:171], v[92:95], v[32:35], v[240:243]
  v_mfma_f32_16x16x32_bf16 v[172:175], v[96:99], v[32:35], v[244:247]
  v_mfma_f32_16x16x32_bf16 v[160:163], v[88:91], v[28:31], v[240:243]
  buffer_load_dwordx4 v5, s[8:11], s26 offen offset:1024 lds
  v_mfma_f32_16x16x32_bf16 v[164:167], v[92:95], v[28:31], v[244:247]
  s_waitcnt lgkmcnt(0)
  v_mfma_f32_16x16x32_bf16 v[152:155], v[76:79], v[24:27], v[248:251]
  v_mfma_f32_16x16x32_bf16 v[156:159], v[88:91], v[24:27], v[244:247]
  v_max3_f32 v238, v208, v209, v210
  v_max3_f32 v239, v211, v212, v213
  v_max3_f32 v238, v238, v214, v215
  v_max_f32 v238, v238, v239
  v_max3_f32 v236, v200, v201, v202
  v_max3_f32 v237, v203, v204, v205
  v_max3_f32 v236, v236, v206, v207
  v_max_f32 v236, v236, v237
  v_max3_f32 v234, v192, v193, v194
  v_max3_f32 v235, v195, v196, v197
  buffer_load_dwordx4 v6, s[8:11], s26 offen offset:2048 lds
  v_max3_f32 v234, v234, v198, v199
  v_max_f32 v234, v234, v235
  v_max3_f32 v232, v184, v185, v186
  v_max3_f32 v233, v187, v188, v189
  v_max3_f32 v232, v232, v190, v191
  v_max_f32 v232, v232, v233
  v_max3_f32 v230, v176, v177, v178
  v_max3_f32 v231, v179, v180, v181
  v_max3_f32 v230, v230, v182, v183
  v_max_f32 v230, v230, v231
  v_max3_f32 v228, v168, v169, v170
  v_max3_f32 v229, v171, v172, v173
  buffer_load_dwordx4 v7, s[8:11], s26 offen offset:3072 lds
  v_max3_f32 v228, v228, v174, v175
  v_max_f32 v228, v228, v229
  v_max3_f32 v226, v160, v161, v162
  v_max3_f32 v227, v163, v164, v165
  v_max3_f32 v226, v226, v166, v167
  v_max_f32 v226, v226, v227
  v_max3_f32 v224, v152, v153, v154
  v_max3_f32 v225, v155, v156, v157
  v_max3_f32 v224, v224, v158, v159
  v_max_f32 v224, v224, v225
  v_mov_b32 v239, v238
  v_mov_b32 v237, v236
  v_mov_b32 v235, v234
  s_add_u32 m0, s88, 36864
  s_nop 0
  buffer_load_dwordx4 v4, s[8:11], s27 offen offset:0 lds
  v_mov_b32 v233, v232
  v_mov_b32 v231, v230
  v_mov_b32 v229, v228
  v_mov_b32 v227, v226
  v_mov_b32 v225, v224
  v_permlane32_swap_b32 v238, v239
  v_permlane32_swap_b32 v236, v237
  v_permlane32_swap_b32 v234, v235
  v_permlane32_swap_b32 v232, v233
  v_permlane32_swap_b32 v230, v231
  v_permlane32_swap_b32 v228, v229
  v_permlane32_swap_b32 v226, v227
  buffer_load_dwordx4 v5, s[8:11], s27 offen offset:1024 lds
  v_permlane32_swap_b32 v224, v225
  v_max_f32 v238, v238, v239
  v_max_f32 v236, v236, v237
  v_max_f32 v234, v234, v235
  v_max_f32 v232, v232, v233
  v_max_f32 v230, v230, v231
  v_max_f32 v228, v228, v229
  v_max_f32 v226, v226, v227
  v_max_f32 v224, v224, v225
  v_mov_b32 v239, v238
  v_mov_b32 v237, v236
  v_mov_b32 v235, v234
  buffer_load_dwordx4 v6, s[8:11], s27 offen offset:2048 lds
  v_mov_b32 v233, v232
  v_mov_b32 v231, v230
  v_mov_b32 v229, v228
  v_mov_b32 v227, v226
  v_mov_b32 v225, v224
  v_permlane16_swap_b32 v238, v239
  v_permlane16_swap_b32 v236, v237
  v_permlane16_swap_b32 v234, v235
  v_permlane16_swap_b32 v232, v233
  v_permlane16_swap_b32 v230, v231
  v_permlane16_swap_b32 v228, v229
  v_permlane16_swap_b32 v226, v227
  buffer_load_dwordx4 v7, s[8:11], s27 offen offset:3072 lds
  v_permlane16_swap_b32 v224, v225
  v_max_f32 v238, v238, v239
  v_max_f32 v236, v236, v237
  v_max_f32 v234, v234, v235
  v_max_f32 v232, v232, v233
  v_max_f32 v230, v230, v231
  v_max_f32 v228, v228, v229
  v_max_f32 v226, v226, v227
  v_max_f32 v224, v224, v225
  v_sub_f32 v208, v208, v238
  v_sub_f32 v209, v209, v238
  v_sub_f32 v210, v210, v238
  v_sub_f32 v211, v211, v238
  s_bfe_u32 s29, 0x302010e, s53
  s_add_u32 s52, s52, s29
  s_add_u32 s53, s53, 8
  s_and_b32 s53, s53, 0x8001f
  s_and_b32 s52, s52, 15
  s_lshl_b32 s29, s52, 7
  s_or_b32 s26, s30, s29
  s_or_b32 s27, s31, s29
  s_add_u32 m0, s68, 32768
  s_nop 0
  buffer_load_dwordx4 v8, s[20:23], s28 offen offset:0 lds
  v_sub_f32 v212, v212, v238
  v_sub_f32 v213, v213, v238
  v_sub_f32 v214, v214, v238
  v_sub_f32 v215, v215, v238
  v_exp_f32 v208, v208
  v_exp_f32 v209, v209
  v_exp_f32 v210, v210
  v_exp_f32 v211, v211
  v_exp_f32 v212, v212
  v_exp_f32 v213, v213
  v_exp_f32 v214, v214
  v_exp_f32 v215, v215
  buffer_load_dwordx4 v9, s[20:23], s28 offen offset:1024 lds
  v_sub_f32 v200, v200, v236
  v_sub_f32 v201, v201, v236
  v_sub_f32 v202, v202, v236
  v_sub_f32 v203, v203, v236
  v_sub_f32 v204, v204, v236
  v_sub_f32 v205, v205, v236
  v_sub_f32 v206, v206, v236
  v_sub_f32 v207, v207, v236
  v_exp_f32 v200, v200
  v_exp_f32 v201, v201
  v_exp_f32 v202, v202
  v_exp_f32 v203, v203
  buffer_load_dwordx4 v10, s[20:23], s28 offen offset:2048 lds
  v_exp_f32 v204, v204
  v_exp_f32 v205, v205
  v_exp_f32 v206, v206
  v_exp_f32 v207, v207
  v_cvt_pk_bf16_f32 v116, v208, v209
  v_cvt_pk_bf16_f32 v117, v210, v211
  v_cvt_pk_bf16_f32 v118, v212, v213
  v_cvt_pk_bf16_f32 v119, v214, v215
  s_nop 1
  v_mfma_f32_16x16x32_bf16 v[52:55], a[208:211], v[116:119], 0
  v_mfma_f32_16x16x32_bf16 v[208:211], v[70:73], v[116:119], 0
  v_mfma_f32_16x16x32_bf16 v[212:215], v[134:137], v[116:119], 0
  v_sub_f32 v192, v192, v234
  buffer_load_dwordx4 v11, s[20:23], s28 offen offset:3072 lds
  v_sub_f32 v193, v193, v234
  v_sub_f32 v194, v194, v234
  v_sub_f32 v195, v195, v234
  v_sub_f32 v196, v196, v234
  v_sub_f32 v197, v197, v234
  v_sub_f32 v198, v198, v234
  v_sub_f32 v199, v199, v234
  v_exp_f32 v192, v192
  v_exp_f32 v193, v193
  v_exp_f32 v194, v194
  v_exp_f32 v195, v195
  v_exp_f32 v196, v196
  v_exp_f32 v197, v197
  s_bfe_u32 s56, 0x302010e, s55
  s_add_u32 s54, s54, s56
  s_add_u32 s55, s55, 8
  s_and_b32 s55, s55, 0x8001f
  s_and_b32 s54, s54, 15
  s_lshl_b32 s28, s54, 19
  s_add_u32 m0, s88, -32768
  s_nop 0
  buffer_load_dwordx4 v4, s[8:11], s26 offen offset:0 lds
  v_exp_f32 v198, v198
  v_exp_f32 v199, v199
  v_cvt_pk_bf16_f32 v112, v200, v201
  v_cvt_pk_bf16_f32 v113, v202, v203
  v_cvt_pk_bf16_f32 v114, v204, v205
  v_cvt_pk_bf16_f32 v115, v206, v207
  s_nop 1
  v_mfma_f32_16x16x32_bf16 v[48:51], a[208:211], v[112:115], 0
  v_mfma_f32_16x16x32_bf16 v[200:203], v[68:71], v[112:115], 0
  v_mfma_f32_16x16x32_bf16 v[204:207], v[132:135], v[112:115], 0
  v_sub_f32 v184, v184, v232
  v_sub_f32 v185, v185, v232
  v_sub_f32 v186, v186, v232
  buffer_load_dwordx4 v5, s[8:11], s26 offen offset:1024 lds
  v_sub_f32 v187, v187, v232
  v_sub_f32 v188, v188, v232
  v_sub_f32 v189, v189, v232
  v_sub_f32 v190, v190, v232
  v_sub_f32 v191, v191, v232
  v_exp_f32 v184, v184
  v_exp_f32 v185, v185
  v_exp_f32 v186, v186
  v_exp_f32 v187, v187
  v_exp_f32 v188, v188
  v_exp_f32 v189, v189
  v_exp_f32 v190, v190
  buffer_load_dwordx4 v6, s[8:11], s26 offen offset:2048 lds
  v_exp_f32 v191, v191
  v_cvt_pk_bf16_f32 v108, v192, v193
  v_cvt_pk_bf16_f32 v109, v194, v195
  v_cvt_pk_bf16_f32 v110, v196, v197
  v_cvt_pk_bf16_f32 v111, v198, v199
  s_nop 1
  v_mfma_f32_16x16x32_bf16 v[44:47], a[208:211], v[108:111], 0
  v_mfma_f32_16x16x32_bf16 v[192:195], v[66:69], v[108:111], 0
  v_mfma_f32_16x16x32_bf16 v[196:199], v[130:133], v[108:111], 0
  v_sub_f32 v176, v176, v230
  v_sub_f32 v177, v177, v230
  v_sub_f32 v178, v178, v230
  v_sub_f32 v179, v179, v230
  buffer_load_dwordx4 v7, s[8:11], s26 offen offset:3072 lds
  v_sub_f32 v180, v180, v230
  v_sub_f32 v181, v181, v230
  v_sub_f32 v182, v182, v230
  v_sub_f32 v183, v183, v230
  v_exp_f32 v176, v176
  v_exp_f32 v177, v177
  v_exp_f32 v178, v178
  v_exp_f32 v179, v179
  v_exp_f32 v180, v180
  v_exp_f32 v181, v181
  v_exp_f32 v182, v182
  v_exp_f32 v183, v183
  v_cvt_pk_bf16_f32 v104, v184, v185
  s_add_u32 m0, s88, -28672
  s_nop 0
  buffer_load_dwordx4 v4, s[8:11], s27 offen offset:0 lds
  v_cvt_pk_bf16_f32 v105, v186, v187
  v_cvt_pk_bf16_f32 v106, v188, v189
  v_cvt_pk_bf16_f32 v107, v190, v191
  s_nop 1
  v_mfma_f32_16x16x32_bf16 v[40:43], a[208:211], v[104:107], 0
  v_mfma_f32_16x16x32_bf16 v[184:187], v[64:67], v[104:107], 0
  v_mfma_f32_16x16x32_bf16 v[188:191], v[128:131], v[104:107], 0
  v_sub_f32 v168, v168, v228
  v_sub_f32 v169, v169, v228
  v_sub_f32 v170, v170, v228
  v_sub_f32 v171, v171, v228
  v_sub_f32 v172, v172, v228
  v_sub_f32 v173, v173, v228
  buffer_load_dwordx4 v5, s[8:11], s27 offen offset:1024 lds
  v_sub_f32 v174, v174, v228
  v_sub_f32 v175, v175, v228
  v_exp_f32 v168, v168
  v_exp_f32 v169, v169
  v_exp_f32 v170, v170
  v_exp_f32 v171, v171
  v_exp_f32 v172, v172
  v_exp_f32 v173, v173
  v_exp_f32 v174, v174
  v_exp_f32 v175, v175
  v_cvt_pk_bf16_f32 v100, v176, v177
  v_cvt_pk_bf16_f32 v101, v178, v179
  buffer_load_dwordx4 v6, s[8:11], s27 offen offset:2048 lds
  v_cvt_pk_bf16_f32 v102, v180, v181
  v_cvt_pk_bf16_f32 v103, v182, v183
  s_nop 1
  v_mfma_f32_16x16x32_bf16 v[36:39], a[208:211], v[100:103], 0
  v_mfma_f32_16x16x32_bf16 v[176:179], v[62:65], v[100:103], 0
  v_mfma_f32_16x16x32_bf16 v[180:183], v[126:129], v[100:103], 0
  v_sub_f32 v160, v160, v226
  v_sub_f32 v161, v161, v226
  v_sub_f32 v162, v162, v226
  v_sub_f32 v163, v163, v226
  v_sub_f32 v164, v164, v226
  v_sub_f32 v165, v165, v226
  v_sub_f32 v166, v166, v226
  buffer_load_dwordx4 v7, s[8:11], s27 offen offset:3072 lds
  s_bfe_u32 s29, 0x302010e, s53
  s_add_u32 s52, s52, s29
  s_add_u32 s53, s53, 8
  s_and_b32 s53, s53, 0x8001f
  s_and_b32 s52, s52, 15
  s_lshl_b32 s29, s52, 7
  s_or_b32 s26, s30, s29
  s_or_b32 s27, s31, s29
  v_sub_f32 v167, v167, v226
  v_exp_f32 v160, v160
  v_exp_f32 v161, v161
  v_exp_f32 v162, v162
  v_exp_f32 v163, v163
  v_exp_f32 v164, v164
  v_exp_f32 v165, v165
  v_exp_f32 v166, v166
  v_exp_f32 v167, v167
  v_cvt_pk_bf16_f32 v96, v168, v169
  v_cvt_pk_bf16_f32 v97, v170, v171
  v_cvt_pk_bf16_f32 v98, v172, v173
  v_cvt_pk_bf16_f32 v99, v174, v175
  s_nop 1
  v_mfma_f32_16x16x32_bf16 v[32:35], a[208:211], v[96:99], 0
  v_mfma_f32_16x16x32_bf16 v[168:171], v[60:63], v[96:99], 0
  v_mfma_f32_16x16x32_bf16 v[172:175], v[124:127], v[96:99], 0
  v_sub_f32 v152, v152, v224
  v_sub_f32 v153, v153, v224
  v_sub_f32 v154, v154, v224
  v_sub_f32 v155, v155, v224
  v_sub_f32 v156, v156, v224
  v_sub_f32 v157, v157, v224
  v_sub_f32 v158, v158, v224
  v_sub_f32 v159, v159, v224
  v_exp_f32 v152, v152
  v_exp_f32 v153, v153
  v_exp_f32 v154, v154
  v_exp_f32 v155, v155
  v_exp_f32 v156, v156
  v_exp_f32 v157, v157
  v_exp_f32 v158, v158
  v_exp_f32 v159, v159
  v_cvt_pk_bf16_f32 v92, v160, v161
  v_cvt_pk_bf16_f32 v93, v162, v163
  v_cvt_pk_bf16_f32 v94, v164, v165
  v_cvt_pk_bf16_f32 v95, v166, v167
  s_nop 1
  v_mfma_f32_16x16x32_bf16 v[28:31], a[208:211], v[92:95], 0
  v_mfma_f32_16x16x32_bf16 v[160:163], v[58:61], v[92:95], 0
  v_mfma_f32_16x16x32_bf16 v[164:167], v[122:125], v[92:95], 0
  v_cvt_pk_bf16_f32 v88, v152, v153
  v_cvt_pk_bf16_f32 v89, v154, v155
  v_cvt_pk_bf16_f32 v90, v156, v157
  v_cvt_pk_bf16_f32 v91, v158, v159
  s_nop 1
  v_mfma_f32_16x16x32_bf16 v[24:27], a[208:211], v[88:91], 0
  v_mfma_f32_16x16x32_bf16 v[152:155], v[56:59], v[88:91], 0
  v_mfma_f32_16x16x32_bf16 v[156:159], v[120:123], v[88:91], 0
  v_rcp_f32 v52, v52
  v_rcp_f32 v48, v48
  v_rcp_f32 v44, v44
  v_rcp_f32 v40, v40
  v_rcp_f32 v36, v36
  v_rcp_f32 v32, v32
  v_rcp_f32 v28, v28
  v_rcp_f32 v24, v24
  v_mov_b32 v53, v52
  v_mov_b32 v49, v48
  v_mov_b32 v45, v44
  v_mov_b32 v41, v40
  v_mov_b32 v37, v36
  v_mov_b32 v33, v32
  v_mov_b32 v29, v28
  v_mov_b32 v25, v24
  v_pk_mul_f32 v[208:209], v[208:209], v[52:53]
  v_pk_mul_f32 v[210:211], v[210:211], v[52:53]
  v_pk_mul_f32 v[212:213], v[212:213], v[52:53]
  v_pk_mul_f32 v[214:215], v[214:215], v[52:53]
  v_cvt_pk_bf16_f32 v208, v208, v209
  v_cvt_pk_bf16_f32 v209, v210, v211
  v_cvt_pk_bf16_f32 v210, v212, v213
  v_cvt_pk_bf16_f32 v211, v214, v215
  buffer_store_dwordx4 v[208:211], v2, s[16:19], s58 offen offset:3072 sc1
  v_pk_mul_f32 v[200:201], v[200:201], v[48:49]
  v_pk_mul_f32 v[202:203], v[202:203], v[48:49]
  v_pk_mul_f32 v[204:205], v[204:205], v[48:49]
  v_pk_mul_f32 v[206:207], v[206:207], v[48:49]
  v_cvt_pk_bf16_f32 v200, v200, v201
  v_cvt_pk_bf16_f32 v201, v202, v203
  v_cvt_pk_bf16_f32 v202, v204, v205
  v_cvt_pk_bf16_f32 v203, v206, v207
  buffer_store_dwordx4 v[200:203], v2, s[16:19], s58 offen offset:2048 sc1
  v_pk_mul_f32 v[192:193], v[192:193], v[44:45]
  v_pk_mul_f32 v[194:195], v[194:195], v[44:45]
  v_pk_mul_f32 v[196:197], v[196:197], v[44:45]
  v_pk_mul_f32 v[198:199], v[198:199], v[44:45]
  v_cvt_pk_bf16_f32 v192, v192, v193
  v_cvt_pk_bf16_f32 v193, v194, v195
  v_cvt_pk_bf16_f32 v194, v196, v197
  v_cvt_pk_bf16_f32 v195, v198, v199
  buffer_store_dwordx4 v[192:195], v2, s[16:19], s58 offen offset:1024 sc1
  v_pk_mul_f32 v[184:185], v[184:185], v[40:41]
  v_pk_mul_f32 v[186:187], v[186:187], v[40:41]
  v_pk_mul_f32 v[188:189], v[188:189], v[40:41]
  v_pk_mul_f32 v[190:191], v[190:191], v[40:41]
  v_cvt_pk_bf16_f32 v184, v184, v185
  v_cvt_pk_bf16_f32 v185, v186, v187
  v_cvt_pk_bf16_f32 v186, v188, v189
  v_cvt_pk_bf16_f32 v187, v190, v191
  buffer_store_dwordx4 v[184:187], v2, s[16:19], s58 offen offset:0 sc1
  v_pk_mul_f32 v[176:177], v[176:177], v[36:37]
  v_pk_mul_f32 v[178:179], v[178:179], v[36:37]
  v_pk_mul_f32 v[180:181], v[180:181], v[36:37]
  v_pk_mul_f32 v[182:183], v[182:183], v[36:37]
  v_cvt_pk_bf16_f32 v176, v176, v177
  v_cvt_pk_bf16_f32 v177, v178, v179
  v_cvt_pk_bf16_f32 v178, v180, v181
  v_cvt_pk_bf16_f32 v179, v182, v183
  buffer_store_dwordx4 v[176:179], v2, s[16:19], s57 offen offset:3072 sc1
  v_pk_mul_f32 v[168:169], v[168:169], v[32:33]
  v_pk_mul_f32 v[170:171], v[170:171], v[32:33]
  v_pk_mul_f32 v[172:173], v[172:173], v[32:33]
  v_pk_mul_f32 v[174:175], v[174:175], v[32:33]
  v_cvt_pk_bf16_f32 v168, v168, v169
  v_cvt_pk_bf16_f32 v169, v170, v171
  v_cvt_pk_bf16_f32 v170, v172, v173
  v_cvt_pk_bf16_f32 v171, v174, v175
  buffer_store_dwordx4 v[168:171], v2, s[16:19], s57 offen offset:2048 sc1
  v_pk_mul_f32 v[160:161], v[160:161], v[28:29]
  v_pk_mul_f32 v[162:163], v[162:163], v[28:29]
  v_pk_mul_f32 v[164:165], v[164:165], v[28:29]
  v_pk_mul_f32 v[166:167], v[166:167], v[28:29]
  v_cvt_pk_bf16_f32 v160, v160, v161
  v_cvt_pk_bf16_f32 v161, v162, v163
  v_cvt_pk_bf16_f32 v162, v164, v165
  v_cvt_pk_bf16_f32 v163, v166, v167
  buffer_store_dwordx4 v[160:163], v2, s[16:19], s57 offen offset:1024 sc1
  v_pk_mul_f32 v[152:153], v[152:153], v[24:25]
  v_pk_mul_f32 v[154:155], v[154:155], v[24:25]
  v_pk_mul_f32 v[156:157], v[156:157], v[24:25]
  v_pk_mul_f32 v[158:159], v[158:159], v[24:25]
  v_cvt_pk_bf16_f32 v152, v152, v153
  v_cvt_pk_bf16_f32 v153, v154, v155
  v_cvt_pk_bf16_f32 v154, v156, v157
  v_cvt_pk_bf16_f32 v155, v158, v159
  buffer_store_dwordx4 v[152:155], v2, s[16:19], s57 offen offset:0 sc1
  s_lshl_b32 s34, s32, 4
  s_add_u32 s34, s34, s33
  s_lshl_b32 s34, s34, 7
  s_add_u32 s34, s34, 32768
  s_mov_b32 s63, 0x70000000
Lp3:
  v_accvgpr_read_b32 v16, a230
  v_accvgpr_read_b32 v17, a231
  v_accvgpr_read_b32 v18, a232
  v_accvgpr_read_b32 v19, a233
  v_accvgpr_read_b32 v20, a234
  v_accvgpr_read_b32 v21, a235
  s_mov_b32 s89, 0
  s_mov_b32 s91, 4294901760
  s_mov_b32 s92, 32768
  s_mov_b32 s89, 1
  s_mov_b32 s69, 0
  s_mov_b32 s71, 4294934528
  s_mov_b32 s72, 16384
  s_waitcnt vmcnt(28)
  s_barrier
  ds_read_b128 a[0:3], v16 offset:0
  ds_read_b64_tr_b16 a[32:33], v18 offset:0
  ds_read_b64_tr_b16 a[34:35], v18 offset:2048
  ds_read_b128 a[4:7], v16 offset:2048
  ds_read_b128 a[8:11], v16 offset:4096
  ds_read_b128 a[12:15], v16 offset:6144
  ds_read_b64_tr_b16 a[36:37], v19 offset:0
  ds_read_b64_tr_b16 a[38:39], v19 offset:2048
  ds_read_b64_tr_b16 a[40:41], v20 offset:0
  ds_read_b64_tr_b16 a[42:43], v20 offset:2048
  ds_read_b64_tr_b16 a[44:45], v21 offset:0
  ds_read_b64_tr_b16 a[46:47], v21 offset:2048
  ds_read_b64_tr_b16 a[48:49], v18 offset:8192
  ds_read_b64_tr_b16 a[50:51], v18 offset:10240
  ds_read_b64_tr_b16 a[52:53], v19 offset:8192
  ds_read_b64_tr_b16 a[54:55], v19 offset:10240
  ds_read_b64_tr_b16 a[56:57], v20 offset:8192
  ds_read_b64_tr_b16 a[58:59], v20 offset:10240
  ds_read_b64_tr_b16 a[60:61], v21 offset:8192
  ds_read_b64_tr_b16 a[62:63], v21 offset:10240
  s_waitcnt lgkmcnt(0)
  v_mfma_f32_16x16x32_bf16 v[32:35], a[32:35], a[0:3], 0
  s_add_u32 s60, s63, 32768
  ds_read_b128 a[16:19], v17 offset:0
  v_mfma_f32_16x16x32_bf16 v[64:67], a[32:35], a[4:7], 0
  buffer_store_dwordx4 v[192:195], v2, s[16:19], s60 offen offset:0 sc1
  v_mfma_f32_16x16x32_bf16 v[96:99], a[32:35], a[8:11], 0
  s_add_u32 s60, s63, 40960
  ds_read_b64_tr_b16 a[64:65], v18 offset:4096
  ds_read_b64_tr_b16 a[66:67], v18 offset:6144
  v_mfma_f32_16x16x32_bf16 v[128:131], a[32:35], a[12:15], 0
  buffer_store_dwordx4 v[224:227], v2, s[16:19], s60 offen offset:0 sc1
  v_mfma_f32_16x16x32_bf16 v[36:39], a[36:39], a[0:3], 0
  s_add_u32 s60, s63, 32768
  ds_read_b128 a[20:23], v17 offset:2048
  ds_read_b128 a[24:27], v17 offset:4096
  v_mfma_f32_16x16x32_bf16 v[68:71], a[36:39], a[4:7], 0
  s_add_u32 s89, s89, 1
  ds_read_b128 a[28:31], v17 offset:6144
  v_mfma_f32_16x16x32_bf16 v[100:103], a[36:39], a[8:11], 0
  buffer_store_dwordx4 v[196:199], v2, s[16:19], s60 offen offset:1024 sc1
  v_mfma_f32_16x16x32_bf16 v[132:135], a[36:39], a[12:15], 0
  s_add_u32 s60, s63, 40960
  ds_read_b64_tr_b16 a[68:69], v19 offset:4096
  ds_read_b64_tr_b16 a[70:71], v19 offset:6144
  v_mfma_f32_16x16x32_bf16 v[40:43], a[40:43], a[0:3], 0
  ds_read_b64_tr_b16 a[72:73], v20 offset:4096
  v_mfma_f32_16x16x32_bf16 v[72:75], a[40:43], a[4:7], 0
  buffer_store_dwordx4 v[228:231], v2, s[16:19], s60 offen offset:1024 sc1
  v_mfma_f32_16x16x32_bf16 v[104:107], a[40:43], a[8:11], 0
  s_add_u32 s60, s63, 32768
  ds_read_b64_tr_b16 a[74:75], v20 offset:6144
  v_mfma_f32_16x16x32_bf16 v[136:139], a[40:43], a[12:15], 0
  ds_read_b64_tr_b16 a[76:77], v21 offset:4096
  v_mfma_f32_16x16x32_bf16 v[44:47], a[44:47], a[0:3], 0
  buffer_store_dwordx4 v[200:203], v2, s[16:19], s60 offen offset:2048 sc1
  v_mfma_f32_16x16x32_bf16 v[76:79], a[44:47], a[4:7], 0
  s_add_u32 s60, s63, 40960
  ds_read_b64_tr_b16 a[78:79], v21 offset:6144
  ds_read_b64_tr_b16 a[80:81], v18 offset:12288
  v_mfma_f32_16x16x32_bf16 v[108:111], a[44:47], a[8:11], 0
  ds_read_b64_tr_b16 a[82:83], v18 offset:14336
  v_mfma_f32_16x16x32_bf16 v[140:143], a[44:47], a[12:15], 0
  buffer_store_dwordx4 v[232:235], v2, s[16:19], s60 offen offset:2048 sc1
  v_mfma_f32_16x16x32_bf16 v[48:51], a[48:51], a[0:3], 0
  s_add_u32 s60, s63, 32768
  ds_read_b64_tr_b16 a[84:85], v19 offset:12288
  ds_read_b64_tr_b16 a[86:87], v19 offset:14336
  v_mfma_f32_16x16x32_bf16 v[80:83], a[48:51], a[4:7], 0
  ds_read_b64_tr_b16 a[88:89], v20 offset:12288
  v_mfma_f32_16x16x32_bf16 v[112:115], a[48:51], a[8:11], 0
  buffer_store_dwordx4 v[204:207], v2, s[16:19], s60 offen offset:3072 sc1
  v_mfma_f32_16x16x32_bf16 v[144:147], a[48:51], a[12:15], 0
  s_add_u32 s60, s63, 40960
  ds_read_b64_tr_b16 a[90:91], v20 offset:14336
  ds_read_b64_tr_b16 a[92:93], v21 offset:12288
  v_mfma_f32_16x16x32_bf16 v[52:55], a[52:55], a[0:3], 0
  ds_read_b64_tr_b16 a[94:95], v21 offset:14336
  v_mfma_f32_16x16x32_bf16 v[84:87], a[52:55], a[4:7], 0
  buffer_store_dwordx4 v[236:239], v2, s[16:19], s60 offen offset:3072 sc1
  v_mfma_f32_16x16x32_bf16 v[116:119], a[52:55], a[8:11], 0
  s_cmp_eq_u32 s89, 3
  s_cselect_b32 s89, 0, s89
  s_cselect_b32 s90, s91, s92
  v_mfma_f32_16x16x32_bf16 v[148:151], a[52:55], a[12:15], 0
  s_add_u32 s69, s69, 1
  v_mfma_f32_16x16x32_bf16 v[56:59], a[56:59], a[0:3], 0
  s_cmp_eq_u32 s69, 3
  s_cselect_b32 s69, 0, s69
  s_cselect_b32 s70, s71, s72
  v_mfma_f32_16x16x32_bf16 v[88:91], a[56:59], a[4:7], 0
  v_add_u32 v16, s90, v16
  v_add_u32 v17, s90, v17
  v_mfma_f32_16x16x32_bf16 v[120:123], a[56:59], a[8:11], 0
  v_add_u32 v18, s70, v18
  v_add_u32 v19, s70, v19
  v_mfma_f32_16x16x32_bf16 v[152:155], a[56:59], a[12:15], 0
  v_add_u32 v20, s70, v20
  v_add_u32 v21, s70, v21
  v_mfma_f32_16x16x32_bf16 v[60:63], a[60:63], a[0:3], 0
  v_mfma_f32_16x16x32_bf16 v[92:95], a[60:63], a[4:7], 0
  v_mfma_f32_16x16x32_bf16 v[124:127], a[60:63], a[8:11], 0
  v_mfma_f32_16x16x32_bf16 v[156:159], a[60:63], a[12:15], 0
  s_waitcnt vmcnt(20) lgkmcnt(0)
  s_barrier
  v_mfma_f32_16x16x32_bf16 v[32:35], a[64:67], a[16:19], v[32:35]
  s_mov_b32 m0, s68
  ds_read_b128 a[0:3], v16 offset:0
  v_mfma_f32_16x16x32_bf16 v[64:67], a[64:67], a[20:23], v[64:67]
  buffer_load_dwordx4 v8, s[20:23], s28 offen offset:0 lds
  v_mfma_f32_16x16x32_bf16 v[96:99], a[64:67], a[24:27], v[96:99]
  ds_read_b64_tr_b16 a[32:33], v18 offset:0
  ds_read_b64_tr_b16 a[34:35], v18 offset:2048
  v_mfma_f32_16x16x32_bf16 v[128:131], a[64:67], a[28:31], v[128:131]
  ds_read_b128 a[4:7], v16 offset:2048
  v_mfma_f32_16x16x32_bf16 v[36:39], a[68:71], a[16:19], v[36:39]
  ds_read_b128 a[8:11], v16 offset:4096
  v_mfma_f32_16x16x32_bf16 v[68:71], a[68:71], a[20:23], v[68:71]
  buffer_load_dwordx4 v9, s[20:23], s28 offen offset:1024 lds
  v_mfma_f32_16x16x32_bf16 v[100:103], a[68:71], a[24:27], v[100:103]
  ds_read_b128 a[12:15], v16 offset:6144
  ds_read_b64_tr_b16 a[36:37], v19 offset:0
  v_mfma_f32_16x16x32_bf16 v[132:135], a[68:71], a[28:31], v[132:135]
  ds_read_b64_tr_b16 a[38:39], v19 offset:2048
  v_mfma_f32_16x16x32_bf16 v[40:43], a[72:75], a[16:19], v[40:43]
  ds_read_b64_tr_b16 a[40:41], v20 offset:0
  v_mfma_f32_16x16x32_bf16 v[72:75], a[72:75], a[20:23], v[72:75]
  ds_read_b64_tr_b16 a[42:43], v20 offset:2048
  v_mfma_f32_16x16x32_bf16 v[104:107], a[72:75], a[24:27], v[104:107]
  buffer_load_dwordx4 v10, s[20:23], s28 offen offset:2048 lds
  v_mfma_f32_16x16x32_bf16 v[136:139], a[72:75], a[28:31], v[136:139]
  ds_read_b64_tr_b16 a[44:45], v21 offset:0
  v_mfma_f32_16x16x32_bf16 v[44:47], a[76:79], a[16:19], v[44:47]
  ds_read_b64_tr_b16 a[46:47], v21 offset:2048
  v_mfma_f32_16x16x32_bf16 v[76:79], a[76:79], a[20:23], v[76:79]
  ds_read_b64_tr_b16 a[48:49], v18 offset:8192
  v_mfma_f32_16x16x32_bf16 v[108:111], a[76:79], a[24:27], v[108:111]
  ds_read_b64_tr_b16 a[50:51], v18 offset:10240
  v_mfma_f32_16x16x32_bf16 v[140:143], a[76:79], a[28:31], v[140:143]
  buffer_load_dwordx4 v11, s[20:23], s28 offen offset:3072 lds
  v_mfma_f32_16x16x32_bf16 v[48:51], a[80:83], a[16:19], v[48:51]
  s_bfe_u32 s56, 0x302010e, s55
  s_add_u32 s54, s54, s56
  s_add_u32 s55, s55, 8
  v_mfma_f32_16x16x32_bf16 v[80:83], a[80:83], a[20:23], v[80:83]
  s_and_b32 s55, s55, 0x8001f
  s_and_b32 s54, s54, 15
  s_lshl_b32 s28, s54, 19
  v_mfma_f32_16x16x32_bf16 v[112:115], a[80:83], a[24:27], v[112:115]
  s_mov_b32 m0, s88
  ds_read_b64_tr_b16 a[52:53], v19 offset:8192
  ds_read_b64_tr_b16 a[54:55], v19 offset:10240
  v_mfma_f32_16x16x32_bf16 v[144:147], a[80:83], a[28:31], v[144:147]
  ds_read_b64_tr_b16 a[56:57], v20 offset:8192
  ds_read_b64_tr_b16 a[58:59], v20 offset:10240
  v_mfma_f32_16x16x32_bf16 v[52:55], a[84:87], a[16:19], v[52:55]
  buffer_load_dwordx4 v4, s[8:11], s26 offen offset:0 lds
  v_mfma_f32_16x16x32_bf16 v[84:87], a[84:87], a[20:23], v[84:87]
  ds_read_b64_tr_b16 a[60:61], v21 offset:8192
  ds_read_b64_tr_b16 a[62:63], v21 offset:10240
  v_mfma_f32_16x16x32_bf16 v[116:119], a[84:87], a[24:27], v[116:119]
  v_mfma_f32_16x16x32_bf16 v[148:151], a[84:87], a[28:31], v[148:151]
  v_mfma_f32_16x16x32_bf16 v[56:59], a[88:91], a[16:19], v[56:59]
  v_mfma_f32_16x16x32_bf16 v[88:91], a[88:91], a[20:23], v[88:91]
  buffer_load_dwordx4 v5, s[8:11], s26 offen offset:1024 lds
  v_mfma_f32_16x16x32_bf16 v[120:123], a[88:91], a[24:27], v[120:123]
  v_mfma_f32_16x16x32_bf16 v[152:155], a[88:91], a[28:31], v[152:155]
  v_mfma_f32_16x16x32_bf16 v[60:63], a[92:95], a[16:19], v[60:63]
  v_mfma_f32_16x16x32_bf16 v[92:95], a[92:95], a[20:23], v[92:95]
  v_mfma_f32_16x16x32_bf16 v[124:127], a[92:95], a[24:27], v[124:127]
  v_mfma_f32_16x16x32_bf16 v[156:159], a[92:95], a[28:31], v[156:159]
  s_waitcnt lgkmcnt(0)
  v_mfma_f32_16x16x32_bf16 v[32:35], a[32:35], a[0:3], v[32:35]
  buffer_load_dwordx4 v6, s[8:11], s26 offen offset:2048 lds
  v_mfma_f32_16x16x32_bf16 v[64:67], a[32:35], a[4:7], v[64:67]
  ds_read_b128 a[16:19], v17 offset:0
  ds_read_b64_tr_b16 a[64:65], v18 offset:4096
  v_mfma_f32_16x16x32_bf16 v[96:99], a[32:35], a[8:11], v[96:99]
  ds_read_b64_tr_b16 a[66:67], v18 offset:6144
  v_mfma_f32_16x16x32_bf16 v[128:131], a[32:35], a[12:15], v[128:131]
  ds_read_b128 a[20:23], v17 offset:2048
  v_mfma_f32_16x16x32_bf16 v[36:39], a[36:39], a[0:3], v[36:39]
  buffer_load_dwordx4 v7, s[8:11], s26 offen offset:3072 lds
  v_mfma_f32_16x16x32_bf16 v[68:71], a[36:39], a[4:7], v[68:71]
  s_add_u32 m0, s88, 4096
  ds_read_b128 a[24:27], v17 offset:4096
  ds_read_b128 a[28:31], v17 offset:6144
  v_mfma_f32_16x16x32_bf16 v[100:103], a[36:39], a[8:11], v[100:103]
  s_add_u32 s88, s88, s90
  ds_read_b64_tr_b16 a[68:69], v19 offset:4096
  v_mfma_f32_16x16x32_bf16 v[132:135], a[36:39], a[12:15], v[132:135]
  s_add_u32 s89, s89, 1
  ds_read_b64_tr_b16 a[70:71], v19 offset:6144
  v_mfma_f32_16x16x32_bf16 v[40:43], a[40:43], a[0:3], v[40:43]
  buffer_load_dwordx4 v4, s[8:11], s27 offen offset:0 lds
  v_mfma_f32_16x16x32_bf16 v[72:75], a[40:43], a[4:7], v[72:75]
  ds_read_b64_tr_b16 a[72:73], v20 offset:4096
  ds_read_b64_tr_b16 a[74:75], v20 offset:6144
  v_mfma_f32_16x16x32_bf16 v[104:107], a[40:43], a[8:11], v[104:107]
  s_cmp_eq_u32 s89, 3
  s_cselect_b32 s89, 0, s89
  s_cselect_b32 s90, s91, s92
  v_mfma_f32_16x16x32_bf16 v[136:139], a[40:43], a[12:15], v[136:139]
  s_add_u32 s68, s68, s70
  ds_read_b64_tr_b16 a[76:77], v21 offset:4096
  v_mfma_f32_16x16x32_bf16 v[44:47], a[44:47], a[0:3], v[44:47]
  buffer_load_dwordx4 v5, s[8:11], s27 offen offset:1024 lds
  v_mfma_f32_16x16x32_bf16 v[76:79], a[44:47], a[4:7], v[76:79]
  s_add_u32 s69, s69, 1
  ds_read_b64_tr_b16 a[78:79], v21 offset:6144
  ds_read_b64_tr_b16 a[80:81], v18 offset:12288
  v_mfma_f32_16x16x32_bf16 v[108:111], a[44:47], a[8:11], v[108:111]
  ds_read_b64_tr_b16 a[82:83], v18 offset:14336
  v_mfma_f32_16x16x32_bf16 v[140:143], a[44:47], a[12:15], v[140:143]
  ds_read_b64_tr_b16 a[84:85], v19 offset:12288
  v_mfma_f32_16x16x32_bf16 v[48:51], a[48:51], a[0:3], v[48:51]
  buffer_load_dwordx4 v6, s[8:11], s27 offen offset:2048 lds
  v_mfma_f32_16x16x32_bf16 v[80:83], a[48:51], a[4:7], v[80:83]
  ds_read_b64_tr_b16 a[86:87], v19 offset:14336
  ds_read_b64_tr_b16 a[88:89], v20 offset:12288
  v_mfma_f32_16x16x32_bf16 v[112:115], a[48:51], a[8:11], v[112:115]
  ds_read_b64_tr_b16 a[90:91], v20 offset:14336
  v_mfma_f32_16x16x32_bf16 v[144:147], a[48:51], a[12:15], v[144:147]
  ds_read_b64_tr_b16 a[92:93], v21 offset:12288
  v_mfma_f32_16x16x32_bf16 v[52:55], a[52:55], a[0:3], v[52:55]
  buffer_load_dwordx4 v7, s[8:11], s27 offen offset:3072 lds
  v_mfma_f32_16x16x32_bf16 v[84:87], a[52:55], a[4:7], v[84:87]
  s_bfe_u32 s29, 0x302010e, s53
  ds_read_b64_tr_b16 a[94:95], v21 offset:14336
  v_mfma_f32_16x16x32_bf16 v[116:119], a[52:55], a[8:11], v[116:119]
  s_cmp_eq_u32 s69, 3
  s_cselect_b32 s69, 0, s69
  s_cselect_b32 s70, s71, s72
  v_mfma_f32_16x16x32_bf16 v[148:151], a[52:55], a[12:15], v[148:151]
  s_add_u32 s52, s52, s29
  v_add_u32 v16, s90, v16
  v_add_u32 v17, s90, v17
  v_mfma_f32_16x16x32_bf16 v[56:59], a[56:59], a[0:3], v[56:59]
  s_add_u32 s53, s53, 8
  v_add_u32 v18, s70, v18
  v_add_u32 v19, s70, v19
  v_mfma_f32_16x16x32_bf16 v[88:91], a[56:59], a[4:7], v[88:91]
  s_and_b32 s53, s53, 0x8001f
  v_add_u32 v20, s70, v20
  v_add_u32 v21, s70, v21
  v_mfma_f32_16x16x32_bf16 v[120:123], a[56:59], a[8:11], v[120:123]
  s_and_b32 s52, s52, 15
  v_mfma_f32_16x16x32_bf16 v[152:155], a[56:59], a[12:15], v[152:155]
  s_lshl_b32 s29, s52, 7
  v_mfma_f32_16x16x32_bf16 v[60:63], a[60:63], a[0:3], v[60:63]
  s_or_b32 s26, s30, s29
  s_or_b32 s27, s31, s29
  v_mfma_f32_16x16x32_bf16 v[92:95], a[60:63], a[4:7], v[92:95]
  v_mfma_f32_16x16x32_bf16 v[124:127], a[60:63], a[8:11], v[124:127]
  v_mfma_f32_16x16x32_bf16 v[156:159], a[60:63], a[12:15], v[156:159]
  s_waitcnt vmcnt(20) lgkmcnt(0)
  s_barrier
  v_mfma_f32_16x16x32_bf16 v[32:35], a[64:67], a[16:19], v[32:35]
  s_mov_b32 m0, s68
  ds_read_b128 a[0:3], v16 offset:0
  v_mfma_f32_16x16x32_bf16 v[64:67], a[64:67], a[20:23], v[64:67]
  buffer_load_dwordx4 v8, s[20:23], s28 offen offset:0 lds
  v_mfma_f32_16x16x32_bf16 v[96:99], a[64:67], a[24:27], v[96:99]
  ds_read_b64_tr_b16 a[32:33], v18 offset:0
  ds_read_b64_tr_b16 a[34:35], v18 offset:2048
  v_mfma_f32_16x16x32_bf16 v[128:131], a[64:67], a[28:31], v[128:131]
  buffer_load_dwordx4 v9, s[20:23], s28 offen offset:1024 lds
  v_mfma_f32_16x16x32_bf16 v[36:39], a[68:71], a[16:19], v[36:39]
  ds_read_b128 a[4:7], v16 offset:2048
  ds_read_b128 a[8:11], v16 offset:4096
  v_mfma_f32_16x16x32_bf16 v[68:71], a[68:71], a[20:23], v[68:71]
  ds_read_b128 a[12:15], v16 offset:6144
  v_mfma_f32_16x16x32_bf16 v[100:103], a[68:71], a[24:27], v[100:103]
  buffer_load_dwordx4 v10, s[20:23], s28 offen offset:2048 lds
  v_mfma_f32_16x16x32_bf16 v[132:135], a[68:71], a[28:31], v[132:135]
  ds_read_b64_tr_b16 a[36:37], v19 offset:0
  ds_read_b64_tr_b16 a[38:39], v19 offset:2048
  v_mfma_f32_16x16x32_bf16 v[40:43], a[72:75], a[16:19], v[40:43]
  ds_read_b64_tr_b16 a[40:41], v20 offset:0
  v_mfma_f32_16x16x32_bf16 v[72:75], a[72:75], a[20:23], v[72:75]
  buffer_load_dwordx4 v11, s[20:23], s28 offen offset:3072 lds
  v_mfma_f32_16x16x32_bf16 v[104:107], a[72:75], a[24:27], v[104:107]
  s_bfe_u32 s56, 0x302010e, s55
  s_add_u32 s54, s54, s56
  s_add_u32 s55, s55, 8
  v_mfma_f32_16x16x32_bf16 v[136:139], a[72:75], a[28:31], v[136:139]
  s_and_b32 s55, s55, 0x8001f
  s_and_b32 s54, s54, 15
  s_lshl_b32 s28, s54, 19
  v_mfma_f32_16x16x32_bf16 v[44:47], a[76:79], a[16:19], v[44:47]
  s_mov_b32 m0, s88
  ds_read_b64_tr_b16 a[42:43], v20 offset:2048
  ds_read_b64_tr_b16 a[44:45], v21 offset:0
  v_mfma_f32_16x16x32_bf16 v[76:79], a[76:79], a[20:23], v[76:79]
  buffer_load_dwordx4 v4, s[8:11], s26 offen offset:0 lds
  v_mfma_f32_16x16x32_bf16 v[108:111], a[76:79], a[24:27], v[108:111]
  ds_read_b64_tr_b16 a[46:47], v21 offset:2048
  ds_read_b64_tr_b16 a[48:49], v18 offset:8192
  v_mfma_f32_16x16x32_bf16 v[140:143], a[76:79], a[28:31], v[140:143]
  buffer_load_dwordx4 v5, s[8:11], s26 offen offset:1024 lds
  v_mfma_f32_16x16x32_bf16 v[48:51], a[80:83], a[16:19], v[48:51]
  ds_read_b64_tr_b16 a[50:51], v18 offset:10240
  ds_read_b64_tr_b16 a[52:53], v19 offset:8192
  v_mfma_f32_16x16x32_bf16 v[80:83], a[80:83], a[20:23], v[80:83]
  ds_read_b64_tr_b16 a[54:55], v19 offset:10240
  ds_read_b64_tr_b16 a[56:57], v20 offset:8192
  v_mfma_f32_16x16x32_bf16 v[112:115], a[80:83], a[24:27], v[112:115]
  buffer_load_dwordx4 v6, s[8:11], s26 offen offset:2048 lds
  v_mfma_f32_16x16x32_bf16 v[144:147], a[80:83], a[28:31], v[144:147]
  ds_read_b64_tr_b16 a[58:59], v20 offset:10240
  ds_read_b64_tr_b16 a[60:61], v21 offset:8192
  v_mfma_f32_16x16x32_bf16 v[52:55], a[84:87], a[16:19], v[52:55]
  ds_read_b64_tr_b16 a[62:63], v21 offset:10240
  v_mfma_f32_16x16x32_bf16 v[84:87], a[84:87], a[20:23], v[84:87]
  buffer_load_dwordx4 v7, s[8:11], s26 offen offset:3072 lds
  v_mfma_f32_16x16x32_bf16 v[116:119], a[84:87], a[24:27], v[116:119]
  s_add_u32 m0, s88, 4096
  v_mfma_f32_16x16x32_bf16 v[148:151], a[84:87], a[28:31], v[148:151]
  v_mfma_f32_16x16x32_bf16 v[56:59], a[88:91], a[16:19], v[56:59]
  buffer_load_dwordx4 v4, s[8:11], s27 offen offset:0 lds
  v_mfma_f32_16x16x32_bf16 v[88:91], a[88:91], a[20:23], v[88:91]
  v_mfma_f32_16x16x32_bf16 v[120:123], a[88:91], a[24:27], v[120:123]
  v_mfma_f32_16x16x32_bf16 v[152:155], a[88:91], a[28:31], v[152:155]
  buffer_load_dwordx4 v5, s[8:11], s27 offen offset:1024 lds
  v_mfma_f32_16x16x32_bf16 v[60:63], a[92:95], a[16:19], v[60:63]
  v_mfma_f32_16x16x32_bf16 v[92:95], a[92:95], a[20:23], v[92:95]
  v_mfma_f32_16x16x32_bf16 v[124:127], a[92:95], a[24:27], v[124:127]
  v_mfma_f32_16x16x32_bf16 v[156:159], a[92:95], a[28:31], v[156:159]
  s_waitcnt lgkmcnt(0)
  v_mfma_f32_16x16x32_bf16 v[32:35], a[32:35], a[0:3], v[32:35]
  buffer_load_dwordx4 v6, s[8:11], s27 offen offset:2048 lds
  v_mfma_f32_16x16x32_bf16 v[64:67], a[32:35], a[4:7], v[64:67]
  s_add_u32 s88, s88, s90
  ds_read_b128 a[16:19], v17 offset:0
  ds_read_b64_tr_b16 a[64:65], v18 offset:4096
  v_mfma_f32_16x16x32_bf16 v[96:99], a[32:35], a[8:11], v[96:99]
  buffer_load_dwordx4 v7, s[8:11], s27 offen offset:3072 lds
  v_mfma_f32_16x16x32_bf16 v[128:131], a[32:35], a[12:15], v[128:131]
  s_bfe_u32 s29, 0x302010e, s53
  s_add_u32 s52, s52, s29
  s_add_u32 s53, s53, 8
  v_mfma_f32_16x16x32_bf16 v[36:39], a[36:39], a[0:3], v[36:39]
  s_and_b32 s53, s53, 0x8001f
  s_and_b32 s52, s52, 15
  s_lshl_b32 s29, s52, 7
  v_mfma_f32_16x16x32_bf16 v[68:71], a[36:39], a[4:7], v[68:71]
  s_or_b32 s26, s30, s29
  s_or_b32 s27, s31, s29
  s_add_u32 s60, s63, 36864
  v_mfma_f32_16x16x32_bf16 v[100:103], a[36:39], a[8:11], v[100:103]
  buffer_store_dwordx4 v[208:211], v2, s[16:19], s60 offen offset:0 sc1
  v_mfma_f32_16x16x32_bf16 v[132:135], a[36:39], a[12:15], v[132:135]
  s_add_u32 s60, s63, 45056
  ds_read_b64_tr_b16 a[66:67], v18 offset:6144
  ds_read_b128 a[20:23], v17 offset:2048
  v_mfma_f32_16x16x32_bf16 v[40:43], a[40:43], a[0:3], v[40:43]
  buffer_store_dwordx4 v[240:243], v2, s[16:19], s60 offen offset:0 sc1
  v_mfma_f32_16x16x32_bf16 v[72:75], a[40:43], a[4:7], v[72:75]
  s_add_u32 s60, s63, 36864
  ds_read_b128 a[24:27], v17 offset:4096
  ds_read_b128 a[28:31], v17 offset:6144
  v_mfma_f32_16x16x32_bf16 v[104:107], a[40:43], a[8:11], v[104:107]
  buffer_store_dwordx4 v[212:215], v2, s[16:19], s60 offen offset:1024 sc1
  v_mfma_f32_16x16x32_bf16 v[136:139], a[40:43], a[12:15], v[136:139]
  s_add_u32 s60, s63, 45056
  ds_read_b64_tr_b16 a[68:69], v19 offset:4096
  ds_read_b64_tr_b16 a[70:71], v19 offset:6144
  v_mfma_f32_16x16x32_bf16 v[44:47], a[44:47], a[0:3], v[44:47]
  buffer_store_dwordx4 v[244:247], v2, s[16:19], s60 offen offset:1024 sc1
  v_mfma_f32_16x16x32_bf16 v[76:79], a[44:47], a[4:7], v[76:79]
  s_add_u32 s60, s63, 36864
  ds_read_b64_tr_b16 a[72:73], v20 offset:4096
  ds_read_b64_tr_b16 a[74:75], v20 offset:6144
  v_mfma_f32_16x16x32_bf16 v[108:111], a[44:47], a[8:11], v[108:111]
  s_add_u32 s89, s89, 1
  ds_read_b64_tr_b16 a[76:77], v21 offset:4096
  ds_read_b64_tr_b16 a[78:79], v21 offset:6144
  v_mfma_f32_16x16x32_bf16 v[140:143], a[44:47], a[12:15], v[140:143]
  buffer_store_dwordx4 v[216:219], v2, s[16:19], s60 offen offset:2048 sc1
  v_mfma_f32_16x16x32_bf16 v[48:51], a[48:51], a[0:3], v[48:51]
  s_add_u32 s60, s63, 45056
  ds_read_b64_tr_b16 a[80:81], v18 offset:12288
  ds_read_b64_tr_b16 a[82:83], v18 offset:14336
  v_mfma_f32_16x16x32_bf16 v[80:83], a[48:51], a[4:7], v[80:83]
  buffer_store_dwordx4 v[248:251], v2, s[16:19], s60 offen offset:2048 sc1
  v_mfma_f32_16x16x32_bf16 v[112:115], a[48:51], a[8:11], v[112:115]
  s_add_u32 s60, s63, 36864
  ds_read_b64_tr_b16 a[84:85], v19 offset:12288
  ds_read_b64_tr_b16 a[86:87], v19 offset:14336
  v_mfma_f32_16x16x32_bf16 v[144:147], a[48:51], a[12:15], v[144:147]
  ds_read_b64_tr_b16 a[88:89], v20 offset:12288
  ds_read_b64_tr_b16 a[90:91], v20 offset:14336
  v_mfma_f32_16x16x32_bf16 v[52:55], a[52:55], a[0:3], v[52:55]
  buffer_store_dwordx4 v[220:223], v2, s[16:19], s60 offen offset:3072 sc1
  v_mfma_f32_16x16x32_bf16 v[84:87], a[52:55], a[4:7], v[84:87]
  s_add_u32 s60, s63, 45056
  ds_read_b64_tr_b16 a[92:93], v21 offset:12288
  ds_read_b64_tr_b16 a[94:95], v21 offset:14336
  v_mfma_f32_16x16x32_bf16 v[116:119], a[52:55], a[8:11], v[116:119]
  buffer_store_dwordx4 v[252:255], v2, s[16:19], s60 offen offset:3072 sc1
  v_mfma_f32_16x16x32_bf16 v[148:151], a[52:55], a[12:15], v[148:151]
  s_cmp_eq_u32 s89, 3
  s_cselect_b32 s89, 0, s89
  s_cselect_b32 s90, s91, s92
  v_mfma_f32_16x16x32_bf16 v[56:59], a[56:59], a[0:3], v[56:59]
  s_add_u32 s68, s68, s70
  v_mfma_f32_16x16x32_bf16 v[88:91], a[56:59], a[4:7], v[88:91]
  s_add_u32 s69, s69, 1
  v_mfma_f32_16x16x32_bf16 v[120:123], a[56:59], a[8:11], v[120:123]
  s_cmp_eq_u32 s69, 3
  s_cselect_b32 s69, 0, s69
  s_cselect_b32 s70, s71, s72
  v_mfma_f32_16x16x32_bf16 v[152:155], a[56:59], a[12:15], v[152:155]
  v_add_u32 v16, s90, v16
  v_add_u32 v17, s90, v17
  v_mfma_f32_16x16x32_bf16 v[60:63], a[60:63], a[0:3], v[60:63]
  v_add_u32 v18, s70, v18
  v_add_u32 v19, s70, v19
  v_mfma_f32_16x16x32_bf16 v[92:95], a[60:63], a[4:7], v[92:95]
  v_add_u32 v20, s70, v20
  v_add_u32 v21, s70, v21
  v_mfma_f32_16x16x32_bf16 v[124:127], a[60:63], a[8:11], v[124:127]
  v_mfma_f32_16x16x32_bf16 v[156:159], a[60:63], a[12:15], v[156:159]
  s_waitcnt vmcnt(20) lgkmcnt(0)
  s_barrier
  v_mfma_f32_16x16x32_bf16 v[32:35], a[64:67], a[16:19], v[32:35]
  s_mov_b32 m0, s68
  ds_read_b128 a[0:3], v16 offset:0
  v_mfma_f32_16x16x32_bf16 v[64:67], a[64:67], a[20:23], v[64:67]
  buffer_load_dwordx4 v8, s[20:23], s28 offen offset:0 lds
  v_mfma_f32_16x16x32_bf16 v[96:99], a[64:67], a[24:27], v[96:99]
  ds_read_b64_tr_b16 a[32:33], v18 offset:0
  ds_read_b64_tr_b16 a[34:35], v18 offset:2048
  v_mfma_f32_16x16x32_bf16 v[128:131], a[64:67], a[28:31], v[128:131]
  ds_read_b128 a[4:7], v16 offset:2048
  v_mfma_f32_16x16x32_bf16 v[36:39], a[68:71], a[16:19], v[36:39]
  ds_read_b128 a[8:11], v16 offset:4096
  v_mfma_f32_16x16x32_bf16 v[68:71], a[68:71], a[20:23], v[68:71]
  buffer_load_dwordx4 v9, s[20:23], s28 offen offset:1024 lds
  v_mfma_f32_16x16x32_bf16 v[100:103], a[68:71], a[24:27], v[100:103]
  ds_read_b128 a[12:15], v16 offset:6144
  ds_read_b64_tr_b16 a[36:37], v19 offset:0
  v_mfma_f32_16x16x32_bf16 v[132:135], a[68:71], a[28:31], v[132:135]
  ds_read_b64_tr_b16 a[38:39], v19 offset:2048
  v_mfma_f32_16x16x32_bf16 v[40:43], a[72:75], a[16:19], v[40:43]
  ds_read_b64_tr_b16 a[40:41], v20 offset:0
  v_mfma_f32_16x16x32_bf16 v[72:75], a[72:75], a[20:23], v[72:75]
  ds_read_b64_tr_b16 a[42:43], v20 offset:2048
  v_mfma_f32_16x16x32_bf16 v[104:107], a[72:75], a[24:27], v[104:107]
  buffer_load_dwordx4 v10, s[20:23], s28 offen offset:2048 lds
  v_mfma_f32_16x16x32_bf16 v[136:139], a[72:75], a[28:31], v[136:139]
  ds_read_b64_tr_b16 a[44:45], v21 offset:0
  v_mfma_f32_16x16x32_bf16 v[44:47], a[76:79], a[16:19], v[44:47]
  ds_read_b64_tr_b16 a[46:47], v21 offset:2048
  v_mfma_f32_16x16x32_bf16 v[76:79], a[76:79], a[20:23], v[76:79]
  ds_read_b64_tr_b16 a[48:49], v18 offset:8192
  v_mfma_f32_16x16x32_bf16 v[108:111], a[76:79], a[24:27], v[108:111]
  ds_read_b64_tr_b16 a[50:51], v18 offset:10240
  v_mfma_f32_16x16x32_bf16 v[140:143], a[76:79], a[28:31], v[140:143]
  buffer_load_dwordx4 v11, s[20:23], s28 offen offset:3072 lds
  v_mfma_f32_16x16x32_bf16 v[48:51], a[80:83], a[16:19], v[48:51]
  s_bfe_u32 s56, 0x302010e, s55
  s_add_u32 s54, s54, s56
  s_add_u32 s55, s55, 8
  v_mfma_f32_16x16x32_bf16 v[80:83], a[80:83], a[20:23], v[80:83]
  s_and_b32 s55, s55, 0x8001f
  s_and_b32 s54, s54, 15
  s_lshl_b32 s28, s54, 19
  v_mfma_f32_16x16x32_bf16 v[112:115], a[80:83], a[24:27], v[112:115]
  s_mov_b32 m0, s88
  ds_read_b64_tr_b16 a[52:53], v19 offset:8192
  ds_read_b64_tr_b16 a[54:55], v19 offset:10240
  v_mfma_f32_16x16x32_bf16 v[144:147], a[80:83], a[28:31], v[144:147]
  ds_read_b64_tr_b16 a[56:57], v20 offset:8192
  ds_read_b64_tr_b16 a[58:59], v20 offset:10240
  v_mfma_f32_16x16x32_bf16 v[52:55], a[84:87], a[16:19], v[52:55]
  buffer_load_dwordx4 v4, s[8:11], s26 offen offset:0 lds
  v_mfma_f32_16x16x32_bf16 v[84:87], a[84:87], a[20:23], v[84:87]
  ds_read_b64_tr_b16 a[60:61], v21 offset:8192
  ds_read_b64_tr_b16 a[62:63], v21 offset:10240
  v_mfma_f32_16x16x32_bf16 v[116:119], a[84:87], a[24:27], v[116:119]
  v_mfma_f32_16x16x32_bf16 v[148:151], a[84:87], a[28:31], v[148:151]
  v_mfma_f32_16x16x32_bf16 v[56:59], a[88:91], a[16:19], v[56:59]
  v_mfma_f32_16x16x32_bf16 v[88:91], a[88:91], a[20:23], v[88:91]
  buffer_load_dwordx4 v5, s[8:11], s26 offen offset:1024 lds
  v_mfma_f32_16x16x32_bf16 v[120:123], a[88:91], a[24:27], v[120:123]
  v_mfma_f32_16x16x32_bf16 v[152:155], a[88:91], a[28:31], v[152:155]
  v_mfma_f32_16x16x32_bf16 v[60:63], a[92:95], a[16:19], v[60:63]
  v_mfma_f32_16x16x32_bf16 v[92:95], a[92:95], a[20:23], v[92:95]
  v_mfma_f32_16x16x32_bf16 v[124:127], a[92:95], a[24:27], v[124:127]
  v_mfma_f32_16x16x32_bf16 v[156:159], a[92:95], a[28:31], v[156:159]
  s_waitcnt lgkmcnt(0)
  v_mfma_f32_16x16x32_bf16 v[32:35], a[32:35], a[0:3], v[32:35]
  buffer_load_dwordx4 v6, s[8:11], s26 offen offset:2048 lds
  v_mfma_f32_16x16x32_bf16 v[64:67], a[32:35], a[4:7], v[64:67]
  ds_read_b128 a[16:19], v17 offset:0
  ds_read_b64_tr_b16 a[64:65], v18 offset:4096
  v_mfma_f32_16x16x32_bf16 v[96:99], a[32:35], a[8:11], v[96:99]
  ds_read_b64_tr_b16 a[66:67], v18 offset:6144
  v_mfma_f32_16x16x32_bf16 v[128:131], a[32:35], a[12:15], v[128:131]
  ds_read_b128 a[20:23], v17 offset:2048
  v_mfma_f32_16x16x32_bf16 v[36:39], a[36:39], a[0:3], v[36:39]
  buffer_load_dwordx4 v7, s[8:11], s26 offen offset:3072 lds
  v_mfma_f32_16x16x32_bf16 v[68:71], a[36:39], a[4:7], v[68:71]
  s_add_u32 m0, s88, 4096
  ds_read_b128 a[24:27], v17 offset:4096
  ds_read_b128 a[28:31], v17 offset:6144
  v_mfma_f32_16x16x32_bf16 v[100:103], a[36:39], a[8:11], v[100:103]
  s_add_u32 s88, s88, s90
  ds_read_b64_tr_b16 a[68:69], v19 offset:4096
  v_mfma_f32_16x16x32_bf16 v[132:135], a[36:39], a[12:15], v[132:135]
  s_add_u32 s89, s89, 1
  ds_read_b64_tr_b16 a[70:71], v19 offset:6144
  v_mfma_f32_16x16x32_bf16 v[40:43], a[40:43], a[0:3], v[40:43]
  buffer_load_dwordx4 v4, s[8:11], s27 offen offset:0 lds
  v_mfma_f32_16x16x32_bf16 v[72:75], a[40:43], a[4:7], v[72:75]
  ds_read_b64_tr_b16 a[72:73], v20 offset:4096
  ds_read_b64_tr_b16 a[74:75], v20 offset:6144
  v_mfma_f32_16x16x32_bf16 v[104:107], a[40:43], a[8:11], v[104:107]
  s_cmp_eq_u32 s89, 3
  s_cselect_b32 s89, 0, s89
  s_cselect_b32 s90, s91, s92
  v_mfma_f32_16x16x32_bf16 v[136:139], a[40:43], a[12:15], v[136:139]
  s_add_u32 s68, s68, s70
  ds_read_b64_tr_b16 a[76:77], v21 offset:4096
  v_mfma_f32_16x16x32_bf16 v[44:47], a[44:47], a[0:3], v[44:47]
  buffer_load_dwordx4 v5, s[8:11], s27 offen offset:1024 lds
  v_mfma_f32_16x16x32_bf16 v[76:79], a[44:47], a[4:7], v[76:79]
  s_add_u32 s69, s69, 1
  ds_read_b64_tr_b16 a[78:79], v21 offset:6144
  ds_read_b64_tr_b16 a[80:81], v18 offset:12288
  v_mfma_f32_16x16x32_bf16 v[108:111], a[44:47], a[8:11], v[108:111]
  ds_read_b64_tr_b16 a[82:83], v18 offset:14336
  v_mfma_f32_16x16x32_bf16 v[140:143], a[44:47], a[12:15], v[140:143]
  ds_read_b64_tr_b16 a[84:85], v19 offset:12288
  v_mfma_f32_16x16x32_bf16 v[48:51], a[48:51], a[0:3], v[48:51]
  buffer_load_dwordx4 v6, s[8:11], s27 offen offset:2048 lds
  v_mfma_f32_16x16x32_bf16 v[80:83], a[48:51], a[4:7], v[80:83]
  ds_read_b64_tr_b16 a[86:87], v19 offset:14336
  ds_read_b64_tr_b16 a[88:89], v20 offset:12288
  v_mfma_f32_16x16x32_bf16 v[112:115], a[48:51], a[8:11], v[112:115]
  ds_read_b64_tr_b16 a[90:91], v20 offset:14336
  v_mfma_f32_16x16x32_bf16 v[144:147], a[48:51], a[12:15], v[144:147]
  ds_read_b64_tr_b16 a[92:93], v21 offset:12288
  v_mfma_f32_16x16x32_bf16 v[52:55], a[52:55], a[0:3], v[52:55]
  buffer_load_dwordx4 v7, s[8:11], s27 offen offset:3072 lds
  v_mfma_f32_16x16x32_bf16 v[84:87], a[52:55], a[4:7], v[84:87]
  s_bfe_u32 s29, 0x302010e, s53
  ds_read_b64_tr_b16 a[94:95], v21 offset:14336
  v_mfma_f32_16x16x32_bf16 v[116:119], a[52:55], a[8:11], v[116:119]
  s_cmp_eq_u32 s69, 3
  s_cselect_b32 s69, 0, s69
  s_cselect_b32 s70, s71, s72
  v_mfma_f32_16x16x32_bf16 v[148:151], a[52:55], a[12:15], v[148:151]
  s_add_u32 s52, s52, s29
  v_add_u32 v16, s90, v16
  v_add_u32 v17, s90, v17
  v_mfma_f32_16x16x32_bf16 v[56:59], a[56:59], a[0:3], v[56:59]
  s_add_u32 s53, s53, 8
  v_add_u32 v18, s70, v18
  v_add_u32 v19, s70, v19
  v_mfma_f32_16x16x32_bf16 v[88:91], a[56:59], a[4:7], v[88:91]
  s_and_b32 s53, s53, 0x8001f
  v_add_u32 v20, s70, v20
  v_add_u32 v21, s70, v21
  v_mfma_f32_16x16x32_bf16 v[120:123], a[56:59], a[8:11], v[120:123]
  s_and_b32 s52, s52, 15
  v_mfma_f32_16x16x32_bf16 v[152:155], a[56:59], a[12:15], v[152:155]
  s_lshl_b32 s29, s52, 7
  v_mfma_f32_16x16x32_bf16 v[60:63], a[60:63], a[0:3], v[60:63]
  s_or_b32 s26, s30, s29
  s_or_b32 s27, s31, s29
  v_mfma_f32_16x16x32_bf16 v[92:95], a[60:63], a[4:7], v[92:95]
  v_mfma_f32_16x16x32_bf16 v[124:127], a[60:63], a[8:11], v[124:127]
  v_mfma_f32_16x16x32_bf16 v[156:159], a[60:63], a[12:15], v[156:159]
  s_waitcnt vmcnt(20) lgkmcnt(0)
  s_barrier
  v_mfma_f32_16x16x32_bf16 v[32:35], a[64:67], a[16:19], v[32:35]
  s_mov_b32 m0, s68
  ds_read_b128 a[0:3], v16 offset:0
  v_mfma_f32_16x16x32_bf16 v[64:67], a[64:67], a[20:23], v[64:67]
  buffer_load_dwordx4 v8, s[20:23], s28 offen offset:0 lds
  v_mfma_f32_16x16x32_bf16 v[96:99], a[64:67], a[24:27], v[96:99]
  ds_read_b64_tr_b16 a[32:33], v18 offset:0
  ds_read_b64_tr_b16 a[34:35], v18 offset:2048
  v_mfma_f32_16x16x32_bf16 v[128:131], a[64:67], a[28:31], v[128:131]
  buffer_load_dwordx4 v9, s[20:23], s28 offen offset:1024 lds
  v_mfma_f32_16x16x32_bf16 v[36:39], a[68:71], a[16:19], v[36:39]
  ds_read_b128 a[4:7], v16 offset:2048
  ds_read_b128 a[8:11], v16 offset:4096
  v_mfma_f32_16x16x32_bf16 v[68:71], a[68:71], a[20:23], v[68:71]
  ds_read_b128 a[12:15], v16 offset:6144
  v_mfma_f32_16x16x32_bf16 v[100:103], a[68:71], a[24:27], v[100:103]
  buffer_load_dwordx4 v10, s[20:23], s28 offen offset:2048 lds
  v_mfma_f32_16x16x32_bf16 v[132:135], a[68:71], a[28:31], v[132:135]
  ds_read_b64_tr_b16 a[36:37], v19 offset:0
  ds_read_b64_tr_b16 a[38:39], v19 offset:2048
  v_mfma_f32_16x16x32_bf16 v[40:43], a[72:75], a[16:19], v[40:43]
  ds_read_b64_tr_b16 a[40:41], v20 offset:0
  v_mfma_f32_16x16x32_bf16 v[72:75], a[72:75], a[20:23], v[72:75]
  buffer_load_dwordx4 v11, s[20:23], s28 offen offset:3072 lds
  v_mfma_f32_16x16x32_bf16 v[104:107], a[72:75], a[24:27], v[104:107]
  s_bfe_u32 s56, 0x302010e, s55
  s_add_u32 s54, s54, s56
  s_add_u32 s55, s55, 8
  v_mfma_f32_16x16x32_bf16 v[136:139], a[72:75], a[28:31], v[136:139]
  s_and_b32 s55, s55, 0x8001f
  s_and_b32 s54, s54, 15
  s_lshl_b32 s28, s54, 19
  v_mfma_f32_16x16x32_bf16 v[44:47], a[76:79], a[16:19], v[44:47]
  s_mov_b32 m0, s88
  ds_read_b64_tr_b16 a[42:43], v20 offset:2048
  ds_read_b64_tr_b16 a[44:45], v21 offset:0
  v_mfma_f32_16x16x32_bf16 v[76:79], a[76:79], a[20:23], v[76:79]
  buffer_load_dwordx4 v4, s[8:11], s26 offen offset:0 lds
  v_mfma_f32_16x16x32_bf16 v[108:111], a[76:79], a[24:27], v[108:111]
  ds_read_b64_tr_b16 a[46:47], v21 offset:2048
  ds_read_b64_tr_b16 a[48:49], v18 offset:8192
  v_mfma_f32_16x16x32_bf16 v[140:143], a[76:79], a[28:31], v[140:143]
  buffer_load_dwordx4 v5, s[8:11], s26 offen offset:1024 lds
  v_mfma_f32_16x16x32_bf16 v[48:51], a[80:83], a[16:19], v[48:51]
  ds_read_b64_tr_b16 a[50:51], v18 offset:10240
  ds_read_b64_tr_b16 a[52:53], v19 offset:8192
  v_mfma_f32_16x16x32_bf16 v[80:83], a[80:83], a[20:23], v[80:83]
  ds_read_b64_tr_b16 a[54:55], v19 offset:10240
  ds_read_b64_tr_b16 a[56:57], v20 offset:8192
  v_mfma_f32_16x16x32_bf16 v[112:115], a[80:83], a[24:27], v[112:115]
  buffer_load_dwordx4 v6, s[8:11], s26 offen offset:2048 lds
  v_mfma_f32_16x16x32_bf16 v[144:147], a[80:83], a[28:31], v[144:147]
  ds_read_b64_tr_b16 a[58:59], v20 offset:10240
  ds_read_b64_tr_b16 a[60:61], v21 offset:8192
  v_mfma_f32_16x16x32_bf16 v[52:55], a[84:87], a[16:19], v[52:55]
  ds_read_b64_tr_b16 a[62:63], v21 offset:10240
  v_mfma_f32_16x16x32_bf16 v[84:87], a[84:87], a[20:23], v[84:87]
  buffer_load_dwordx4 v7, s[8:11], s26 offen offset:3072 lds
  v_mfma_f32_16x16x32_bf16 v[116:119], a[84:87], a[24:27], v[116:119]
  s_add_u32 m0, s88, 4096
  v_mfma_f32_16x16x32_bf16 v[148:151], a[84:87], a[28:31], v[148:151]
  v_mfma_f32_16x16x32_bf16 v[56:59], a[88:91], a[16:19], v[56:59]
  buffer_load_dwordx4 v4, s[8:11], s27 offen offset:0 lds
  v_mfma_f32_16x16x32_bf16 v[88:91], a[88:91], a[20:23], v[88:91]
  v_mfma_f32_16x16x32_bf16 v[120:123], a[88:91], a[24:27], v[120:123]
  v_mfma_f32_16x16x32_bf16 v[152:155], a[88:91], a[28:31], v[152:155]
  buffer_load_dwordx4 v5, s[8:11], s27 offen offset:1024 lds
  v_mfma_f32_16x16x32_bf16 v[60:63], a[92:95], a[16:19], v[60:63]
  v_mfma_f32_16x16x32_bf16 v[92:95], a[92:95], a[20:23], v[92:95]
  v_mfma_f32_16x16x32_bf16 v[124:127], a[92:95], a[24:27], v[124:127]
  v_mfma_f32_16x16x32_bf16 v[156:159], a[92:95], a[28:31], v[156:159]
  s_waitcnt lgkmcnt(0)
  v_mfma_f32_16x16x32_bf16 v[32:35], a[32:35], a[0:3], v[32:35]
  buffer_load_dwordx4 v6, s[8:11], s27 offen offset:2048 lds
  v_mfma_f32_16x16x32_bf16 v[64:67], a[32:35], a[4:7], v[64:67]
  s_add_u32 s88, s88, s90
  ds_read_b128 a[16:19], v17 offset:0
  ds_read_b64_tr_b16 a[64:65], v18 offset:4096
  v_mfma_f32_16x16x32_bf16 v[96:99], a[32:35], a[8:11], v[96:99]
  buffer_load_dwordx4 v7, s[8:11], s27 offen offset:3072 lds
  v_mfma_f32_16x16x32_bf16 v[128:131], a[32:35], a[12:15], v[128:131]
  s_bfe_u32 s29, 0x302010e, s53
  s_add_u32 s52, s52, s29
  s_add_u32 s53, s53, 8
  v_mfma_f32_16x16x32_bf16 v[36:39], a[36:39], a[0:3], v[36:39]
  s_and_b32 s53, s53, 0x8001f
  s_and_b32 s52, s52, 15
  s_lshl_b32 s29, s52, 7
  v_mfma_f32_16x16x32_bf16 v[68:71], a[36:39], a[4:7], v[68:71]
  s_or_b32 s26, s30, s29
  s_or_b32 s27, s31, s29
  s_add_u32 s60, s63, 0
  v_mfma_f32_16x16x32_bf16 v[100:103], a[36:39], a[8:11], v[100:103]
  buffer_store_dwordx4 v[160:163], v2, s[16:19], s60 offen offset:0 sc1
  v_mfma_f32_16x16x32_bf16 v[132:135], a[36:39], a[12:15], v[132:135]
  buffer_store_dwordx4 v[164:167], v2, s[16:19], s60 offen offset:1024 sc1
  v_mfma_f32_16x16x32_bf16 v[40:43], a[40:43], a[0:3], v[40:43]
  s_add_u32 s89, s89, 1
  ds_read_b64_tr_b16 a[66:67], v18 offset:6144
  ds_read_b128 a[20:23], v17 offset:2048
  v_mfma_f32_16x16x32_bf16 v[72:75], a[40:43], a[4:7], v[72:75]
  ds_read_b128 a[24:27], v17 offset:4096
  ds_read_b128 a[28:31], v17 offset:6144
  v_mfma_f32_16x16x32_bf16 v[104:107], a[40:43], a[8:11], v[104:107]
  buffer_store_dwordx4 v[168:171], v2, s[16:19], s60 offen offset:2048 sc1
  v_mfma_f32_16x16x32_bf16 v[136:139], a[40:43], a[12:15], v[136:139]
  ds_read_b64_tr_b16 a[68:69], v19 offset:4096
  ds_read_b64_tr_b16 a[70:71], v19 offset:6144
  v_mfma_f32_16x16x32_bf16 v[44:47], a[44:47], a[0:3], v[44:47]
  buffer_store_dwordx4 v[172:175], v2, s[16:19], s60 offen offset:3072 sc1
  v_mfma_f32_16x16x32_bf16 v[76:79], a[44:47], a[4:7], v[76:79]
  s_add_u32 s60, s63, 4096
  ds_read_b64_tr_b16 a[72:73], v20 offset:4096
  ds_read_b64_tr_b16 a[74:75], v20 offset:6144
  v_mfma_f32_16x16x32_bf16 v[108:111], a[44:47], a[8:11], v[108:111]
  ds_read_b64_tr_b16 a[76:77], v21 offset:4096
  ds_read_b64_tr_b16 a[78:79], v21 offset:6144
  v_mfma_f32_16x16x32_bf16 v[140:143], a[44:47], a[12:15], v[140:143]
  buffer_store_dwordx4 v[176:179], v2, s[16:19], s60 offen offset:0 sc1
  v_mfma_f32_16x16x32_bf16 v[48:51], a[48:51], a[0:3], v[48:51]
  ds_read_b64_tr_b16 a[80:81], v18 offset:12288
  ds_read_b64_tr_b16 a[82:83], v18 offset:14336
  v_mfma_f32_16x16x32_bf16 v[80:83], a[48:51], a[4:7], v[80:83]
  buffer_store_dwordx4 v[180:183], v2, s[16:19], s60 offen offset:1024 sc1
  v_mfma_f32_16x16x32_bf16 v[112:115], a[48:51], a[8:11], v[112:115]
  ds_read_b64_tr_b16 a[84:85], v19 offset:12288
  ds_read_b64_tr_b16 a[86:87], v19 offset:14336
  v_mfma_f32_16x16x32_bf16 v[144:147], a[48:51], a[12:15], v[144:147]
  ds_read_b64_tr_b16 a[88:89], v20 offset:12288
  ds_read_b64_tr_b16 a[90:91], v20 offset:14336
  v_mfma_f32_16x16x32_bf16 v[52:55], a[52:55], a[0:3], v[52:55]
  buffer_store_dwordx4 v[184:187], v2, s[16:19], s60 offen offset:2048 sc1
  v_mfma_f32_16x16x32_bf16 v[84:87], a[52:55], a[4:7], v[84:87]
  ds_read_b64_tr_b16 a[92:93], v21 offset:12288
  ds_read_b64_tr_b16 a[94:95], v21 offset:14336
  v_mfma_f32_16x16x32_bf16 v[116:119], a[52:55], a[8:11], v[116:119]
  buffer_store_dwordx4 v[188:191], v2, s[16:19], s60 offen offset:3072 sc1
  v_mfma_f32_16x16x32_bf16 v[148:151], a[52:55], a[12:15], v[148:151]
  s_cmp_eq_u32 s89, 3
  s_cselect_b32 s89, 0, s89
  s_cselect_b32 s90, s91, s92
  v_mfma_f32_16x16x32_bf16 v[56:59], a[56:59], a[0:3], v[56:59]
  s_add_u32 s68, s68, s70
  v_mfma_f32_16x16x32_bf16 v[88:91], a[56:59], a[4:7], v[88:91]
  s_add_u32 s69, s69, 1
  v_mfma_f32_16x16x32_bf16 v[120:123], a[56:59], a[8:11], v[120:123]
  s_cmp_eq_u32 s69, 3
  s_cselect_b32 s69, 0, s69
  s_cselect_b32 s70, s71, s72
  v_mfma_f32_16x16x32_bf16 v[152:155], a[56:59], a[12:15], v[152:155]
  v_add_u32 v16, s90, v16
  v_add_u32 v17, s90, v17
  v_mfma_f32_16x16x32_bf16 v[60:63], a[60:63], a[0:3], v[60:63]
  v_add_u32 v18, s70, v18
  v_add_u32 v19, s70, v19
  v_mfma_f32_16x16x32_bf16 v[92:95], a[60:63], a[4:7], v[92:95]
  v_add_u32 v20, s70, v20
  v_add_u32 v21, s70, v21
  v_mfma_f32_16x16x32_bf16 v[124:127], a[60:63], a[8:11], v[124:127]
  v_mfma_f32_16x16x32_bf16 v[156:159], a[60:63], a[12:15], v[156:159]
  s_waitcnt vmcnt(20) lgkmcnt(0)
  s_barrier
  v_mfma_f32_16x16x32_bf16 v[32:35], a[64:67], a[16:19], v[32:35]
  s_mov_b32 m0, s68
  ds_read_b128 a[0:3], v16 offset:0
  v_mfma_f32_16x16x32_bf16 v[64:67], a[64:67], a[20:23], v[64:67]
  buffer_load_dwordx4 v8, s[20:23], s28 offen offset:0 lds
  v_mfma_f32_16x16x32_bf16 v[96:99], a[64:67], a[24:27], v[96:99]
  ds_read_b64_tr_b16 a[32:33], v18 offset:0
  ds_read_b64_tr_b16 a[34:35], v18 offset:2048
  v_mfma_f32_16x16x32_bf16 v[128:131], a[64:67], a[28:31], v[128:131]
  ds_read_b128 a[4:7], v16 offset:2048
  v_mfma_f32_16x16x32_bf16 v[36:39], a[68:71], a[16:19], v[36:39]
  ds_read_b128 a[8:11], v16 offset:4096
  v_mfma_f32_16x16x32_bf16 v[68:71], a[68:71], a[20:23], v[68:71]
  buffer_load_dwordx4 v9, s[20:23], s28 offen offset:1024 lds
  v_mfma_f32_16x16x32_bf16 v[100:103], a[68:71], a[24:27], v[100:103]
  ds_read_b128 a[12:15], v16 offset:6144
  ds_read_b64_tr_b16 a[36:37], v19 offset:0
  v_mfma_f32_16x16x32_bf16 v[132:135], a[68:71], a[28:31], v[132:135]
  ds_read_b64_tr_b16 a[38:39], v19 offset:2048
  v_mfma_f32_16x16x32_bf16 v[40:43], a[72:75], a[16:19], v[40:43]
  ds_read_b64_tr_b16 a[40:41], v20 offset:0
  v_mfma_f32_16x16x32_bf16 v[72:75], a[72:75], a[20:23], v[72:75]
  ds_read_b64_tr_b16 a[42:43], v20 offset:2048
  v_mfma_f32_16x16x32_bf16 v[104:107], a[72:75], a[24:27], v[104:107]
  buffer_load_dwordx4 v10, s[20:23], s28 offen offset:2048 lds
  v_mfma_f32_16x16x32_bf16 v[136:139], a[72:75], a[28:31], v[136:139]
  ds_read_b64_tr_b16 a[44:45], v21 offset:0
  v_mfma_f32_16x16x32_bf16 v[44:47], a[76:79], a[16:19], v[44:47]
  ds_read_b64_tr_b16 a[46:47], v21 offset:2048
  v_mfma_f32_16x16x32_bf16 v[76:79], a[76:79], a[20:23], v[76:79]
  ds_read_b64_tr_b16 a[48:49], v18 offset:8192
  v_mfma_f32_16x16x32_bf16 v[108:111], a[76:79], a[24:27], v[108:111]
  ds_read_b64_tr_b16 a[50:51], v18 offset:10240
  v_mfma_f32_16x16x32_bf16 v[140:143], a[76:79], a[28:31], v[140:143]
  buffer_load_dwordx4 v11, s[20:23], s28 offen offset:3072 lds
  v_mfma_f32_16x16x32_bf16 v[48:51], a[80:83], a[16:19], v[48:51]
  s_bfe_u32 s56, 0x302010e, s55
  s_add_u32 s54, s54, s56
  s_add_u32 s55, s55, 8
  v_mfma_f32_16x16x32_bf16 v[80:83], a[80:83], a[20:23], v[80:83]
  s_and_b32 s55, s55, 0x8001f
  s_and_b32 s54, s54, 15
  s_lshl_b32 s28, s54, 19
  v_mfma_f32_16x16x32_bf16 v[112:115], a[80:83], a[24:27], v[112:115]
  s_mov_b32 m0, s88
  ds_read_b64_tr_b16 a[52:53], v19 offset:8192
  ds_read_b64_tr_b16 a[54:55], v19 offset:10240
  v_mfma_f32_16x16x32_bf16 v[144:147], a[80:83], a[28:31], v[144:147]
  ds_read_b64_tr_b16 a[56:57], v20 offset:8192
  ds_read_b64_tr_b16 a[58:59], v20 offset:10240
  v_mfma_f32_16x16x32_bf16 v[52:55], a[84:87], a[16:19], v[52:55]
  buffer_load_dwordx4 v4, s[8:11], s26 offen offset:0 lds
  v_mfma_f32_16x16x32_bf16 v[84:87], a[84:87], a[20:23], v[84:87]
  ds_read_b64_tr_b16 a[60:61], v21 offset:8192
  ds_read_b64_tr_b16 a[62:63], v21 offset:10240
  v_mfma_f32_16x16x32_bf16 v[116:119], a[84:87], a[24:27], v[116:119]
  v_mfma_f32_16x16x32_bf16 v[148:151], a[84:87], a[28:31], v[148:151]
  v_mfma_f32_16x16x32_bf16 v[56:59], a[88:91], a[16:19], v[56:59]
  v_mfma_f32_16x16x32_bf16 v[88:91], a[88:91], a[20:23], v[88:91]
  buffer_load_dwordx4 v5, s[8:11], s26 offen offset:1024 lds
  v_mfma_f32_16x16x32_bf16 v[120:123], a[88:91], a[24:27], v[120:123]
  v_mfma_f32_16x16x32_bf16 v[152:155], a[88:91], a[28:31], v[152:155]
  v_mfma_f32_16x16x32_bf16 v[60:63], a[92:95], a[16:19], v[60:63]
  v_mfma_f32_16x16x32_bf16 v[92:95], a[92:95], a[20:23], v[92:95]
  v_mfma_f32_16x16x32_bf16 v[124:127], a[92:95], a[24:27], v[124:127]
  v_mfma_f32_16x16x32_bf16 v[156:159], a[92:95], a[28:31], v[156:159]
  s_waitcnt lgkmcnt(0)
  v_mfma_f32_16x16x32_bf16 v[32:35], a[32:35], a[0:3], v[32:35]
  buffer_load_dwordx4 v6, s[8:11], s26 offen offset:2048 lds
  v_mfma_f32_16x16x32_bf16 v[64:67], a[32:35], a[4:7], v[64:67]
  ds_read_b128 a[16:19], v17 offset:0
  ds_read_b64_tr_b16 a[64:65], v18 offset:4096
  v_mfma_f32_16x16x32_bf16 v[96:99], a[32:35], a[8:11], v[96:99]
  ds_read_b64_tr_b16 a[66:67], v18 offset:6144
  v_mfma_f32_16x16x32_bf16 v[128:131], a[32:35], a[12:15], v[128:131]
  ds_read_b128 a[20:23], v17 offset:2048
  v_mfma_f32_16x16x32_bf16 v[36:39], a[36:39], a[0:3], v[36:39]
  buffer_load_dwordx4 v7, s[8:11], s26 offen offset:3072 lds
  v_mfma_f32_16x16x32_bf16 v[68:71], a[36:39], a[4:7], v[68:71]
  s_add_u32 m0, s88, 4096
  ds_read_b128 a[24:27], v17 offset:4096
  ds_read_b128 a[28:31], v17 offset:6144
  v_mfma_f32_16x16x32_bf16 v[100:103], a[36:39], a[8:11], v[100:103]
  s_add_u32 s88, s88, s90
  ds_read_b64_tr_b16 a[68:69], v19 offset:4096
  v_mfma_f32_16x16x32_bf16 v[132:135], a[36:39], a[12:15], v[132:135]
  s_add_u32 s89, s89, 1
  ds_read_b64_tr_b16 a[70:71], v19 offset:6144
  v_mfma_f32_16x16x32_bf16 v[40:43], a[40:43], a[0:3], v[40:43]
  buffer_load_dwordx4 v4, s[8:11], s27 offen offset:0 lds
  v_mfma_f32_16x16x32_bf16 v[72:75], a[40:43], a[4:7], v[72:75]
  ds_read_b64_tr_b16 a[72:73], v20 offset:4096
  ds_read_b64_tr_b16 a[74:75], v20 offset:6144
  v_mfma_f32_16x16x32_bf16 v[104:107], a[40:43], a[8:11], v[104:107]
  s_cmp_eq_u32 s89, 3
  s_cselect_b32 s89, 0, s89
  s_cselect_b32 s90, s91, s92
  v_mfma_f32_16x16x32_bf16 v[136:139], a[40:43], a[12:15], v[136:139]
  s_add_u32 s68, s68, s70
  ds_read_b64_tr_b16 a[76:77], v21 offset:4096
  v_mfma_f32_16x16x32_bf16 v[44:47], a[44:47], a[0:3], v[44:47]
  buffer_load_dwordx4 v5, s[8:11], s27 offen offset:1024 lds
  v_mfma_f32_16x16x32_bf16 v[76:79], a[44:47], a[4:7], v[76:79]
  s_add_u32 s69, s69, 1
  ds_read_b64_tr_b16 a[78:79], v21 offset:6144
  ds_read_b64_tr_b16 a[80:81], v18 offset:12288
  v_mfma_f32_16x16x32_bf16 v[108:111], a[44:47], a[8:11], v[108:111]
  ds_read_b64_tr_b16 a[82:83], v18 offset:14336
  v_mfma_f32_16x16x32_bf16 v[140:143], a[44:47], a[12:15], v[140:143]
  ds_read_b64_tr_b16 a[84:85], v19 offset:12288
  v_mfma_f32_16x16x32_bf16 v[48:51], a[48:51], a[0:3], v[48:51]
  buffer_load_dwordx4 v6, s[8:11], s27 offen offset:2048 lds
  v_mfma_f32_16x16x32_bf16 v[80:83], a[48:51], a[4:7], v[80:83]
  ds_read_b64_tr_b16 a[86:87], v19 offset:14336
  ds_read_b64_tr_b16 a[88:89], v20 offset:12288
  v_mfma_f32_16x16x32_bf16 v[112:115], a[48:51], a[8:11], v[112:115]
  ds_read_b64_tr_b16 a[90:91], v20 offset:14336
  v_mfma_f32_16x16x32_bf16 v[144:147], a[48:51], a[12:15], v[144:147]
  ds_read_b64_tr_b16 a[92:93], v21 offset:12288
  v_mfma_f32_16x16x32_bf16 v[52:55], a[52:55], a[0:3], v[52:55]
  buffer_load_dwordx4 v7, s[8:11], s27 offen offset:3072 lds
  v_mfma_f32_16x16x32_bf16 v[84:87], a[52:55], a[4:7], v[84:87]
  s_bfe_u32 s29, 0x302010e, s53
  ds_read_b64_tr_b16 a[94:95], v21 offset:14336
  v_mfma_f32_16x16x32_bf16 v[116:119], a[52:55], a[8:11], v[116:119]
  s_cmp_eq_u32 s69, 3
  s_cselect_b32 s69, 0, s69
  s_cselect_b32 s70, s71, s72
  v_mfma_f32_16x16x32_bf16 v[148:151], a[52:55], a[12:15], v[148:151]
  s_add_u32 s52, s52, s29
  v_add_u32 v16, s90, v16
  v_add_u32 v17, s90, v17
  v_mfma_f32_16x16x32_bf16 v[56:59], a[56:59], a[0:3], v[56:59]
  s_add_u32 s53, s53, 8
  v_add_u32 v18, s70, v18
  v_add_u32 v19, s70, v19
  v_mfma_f32_16x16x32_bf16 v[88:91], a[56:59], a[4:7], v[88:91]
  s_and_b32 s53, s53, 0x8001f
  v_add_u32 v20, s70, v20
  v_add_u32 v21, s70, v21
  v_mfma_f32_16x16x32_bf16 v[120:123], a[56:59], a[8:11], v[120:123]
  s_and_b32 s52, s52, 15
  v_mfma_f32_16x16x32_bf16 v[152:155], a[56:59], a[12:15], v[152:155]
  s_lshl_b32 s29, s52, 7
  v_mfma_f32_16x16x32_bf16 v[60:63], a[60:63], a[0:3], v[60:63]
  s_or_b32 s26, s30, s29
  s_or_b32 s27, s31, s29
  v_mfma_f32_16x16x32_bf16 v[92:95], a[60:63], a[4:7], v[92:95]
  v_mfma_f32_16x16x32_bf16 v[124:127], a[60:63], a[8:11], v[124:127]
  v_mfma_f32_16x16x32_bf16 v[156:159], a[60:63], a[12:15], v[156:159]
  s_waitcnt vmcnt(12) lgkmcnt(0)
  s_barrier
  s_mov_b32 s5, 0x40000
Ltg_3:
  v_readfirstlane_b32 s94, v22
  v_readfirstlane_b32 s95, v23
  s_nop 0
  s_cmp_lg_u32 s95, 0
  s_cbranch_scc1 Lpolld_4
  s_sleep 4
  s_mov_b32 s12, s84
  s_mov_b32 s13, s85
  s_mov_b32 s14, 256
  s_mov_b32 s15, 0x00020000
  buffer_load_dwordx2 v[22:23], off, s[12:15], 0 sc1
  s_sub_u32 s5, s5, 1
  s_waitcnt vmcnt(0)
  s_cbranch_scc0 Ltg_3
Lpolld_4:
  v_mov_b32 v3, 0x40000000
  v_mov_b32 v22, s94
  v_cmp_eq_u32 vcc, 0, v0
  v_mov_b32 v23, s95
  s_nop 0
  v_cndmask_b32_e64 v3, v3, 0, vcc
  buffer_store_dwordx2 v[22:23], v3, s[96:99], s34 offen sc1
  v_mfma_f32_16x16x32_bf16 v[32:35], a[64:67], a[16:19], v[32:35]
  s_mov_b32 m0, s68
  ds_read_b128 a[0:3], v16 offset:0
  v_mfma_f32_16x16x32_bf16 v[64:67], a[64:67], a[20:23], v[64:67]
  buffer_load_dwordx4 v8, s[20:23], s28 offen offset:0 lds
  v_mfma_f32_16x16x32_bf16 v[96:99], a[64:67], a[24:27], v[96:99]
  ds_read_b64_tr_b16 a[32:33], v18 offset:0
  ds_read_b64_tr_b16 a[34:35], v18 offset:2048
  v_mfma_f32_16x16x32_bf16 v[128:131], a[64:67], a[28:31], v[128:131]
  ds_read_b128 a[4:7], v16 offset:2048
  v_mfma_f32_16x16x32_bf16 v[36:39], a[68:71], a[16:19], v[36:39]
  ds_read_b128 a[8:11], v16 offset:4096
  v_mfma_f32_16x16x32_bf16 v[68:71], a[68:71], a[20:23], v[68:71]
  buffer_load_dwordx4 v9, s[20:23], s28 offen offset:1024 lds
  v_mfma_f32_16x16x32_bf16 v[100:103], a[68:71], a[24:27], v[100:103]
  ds_read_b128 a[12:15], v16 offset:6144
  ds_read_b64_tr_b16 a[36:37], v19 offset:0
  v_mfma_f32_16x16x32_bf16 v[132:135], a[68:71], a[28:31], v[132:135]
  ds_read_b64_tr_b16 a[38:39], v19 offset:2048
  v_mfma_f32_16x16x32_bf16 v[40:43], a[72:75], a[16:19], v[40:43]
  ds_read_b64_tr_b16 a[40:41], v20 offset:0
  v_mfma_f32_16x16x32_bf16 v[72:75], a[72:75], a[20:23], v[72:75]
  ds_read_b64_tr_b16 a[42:43], v20 offset:2048
  v_mfma_f32_16x16x32_bf16 v[104:107], a[72:75], a[24:27], v[104:107]
  buffer_load_dwordx4 v10, s[20:23], s28 offen offset:2048 lds
  v_mfma_f32_16x16x32_bf16 v[136:139], a[72:75], a[28:31], v[136:139]
  ds_read_b64_tr_b16 a[44:45], v21 offset:0
  v_mfma_f32_16x16x32_bf16 v[44:47], a[76:79], a[16:19], v[44:47]
  ds_read_b64_tr_b16 a[46:47], v21 offset:2048
  v_mfma_f32_16x16x32_bf16 v[76:79], a[76:79], a[20:23], v[76:79]
  ds_read_b64_tr_b16 a[48:49], v18 offset:8192
  v_mfma_f32_16x16x32_bf16 v[108:111], a[76:79], a[24:27], v[108:111]
  ds_read_b64_tr_b16 a[50:51], v18 offset:10240
  v_mfma_f32_16x16x32_bf16 v[140:143], a[76:79], a[28:31], v[140:143]
  buffer_load_dwordx4 v11, s[20:23], s28 offen offset:3072 lds
  v_mfma_f32_16x16x32_bf16 v[48:51], a[80:83], a[16:19], v[48:51]
  s_bfe_u32 s56, 0x302010e, s55
  s_add_u32 s54, s54, s56
  s_add_u32 s55, s55, 8
  v_mfma_f32_16x16x32_bf16 v[80:83], a[80:83], a[20:23], v[80:83]
  s_and_b32 s55, s55, 0x8001f
  s_and_b32 s54, s54, 15
  s_lshl_b32 s28, s54, 19
  v_mfma_f32_16x16x32_bf16 v[112:115], a[80:83], a[24:27], v[112:115]
  s_mov_b32 m0, s88
  ds_read_b64_tr_b16 a[52:53], v19 offset:8192
  ds_read_b64_tr_b16 a[54:55], v19 offset:10240
  v_mfma_f32_16x16x32_bf16 v[144:147], a[80:83], a[28:31], v[144:147]
  ds_read_b64_tr_b16 a[56:57], v20 offset:8192
  ds_read_b64_tr_b16 a[58:59], v20 offset:10240
  v_mfma_f32_16x16x32_bf16 v[52:55], a[84:87], a[16:19], v[52:55]
  buffer_load_dwordx4 v4, s[8:11], s26 offen offset:0 lds
  v_mfma_f32_16x16x32_bf16 v[84:87], a[84:87], a[20:23], v[84:87]
  ds_read_b64_tr_b16 a[60:61], v21 offset:8192
  ds_read_b64_tr_b16 a[62:63], v21 offset:10240
  v_mfma_f32_16x16x32_bf16 v[116:119], a[84:87], a[24:27], v[116:119]
  v_mfma_f32_16x16x32_bf16 v[148:151], a[84:87], a[28:31], v[148:151]
  v_mfma_f32_16x16x32_bf16 v[56:59], a[88:91], a[16:19], v[56:59]
  v_mfma_f32_16x16x32_bf16 v[88:91], a[88:91], a[20:23], v[88:91]
  buffer_load_dwordx4 v5, s[8:11], s26 offen offset:1024 lds
  v_mfma_f32_16x16x32_bf16 v[120:123], a[88:91], a[24:27], v[120:123]
  v_mfma_f32_16x16x32_bf16 v[152:155], a[88:91], a[28:31], v[152:155]
  v_mfma_f32_16x16x32_bf16 v[60:63], a[92:95], a[16:19], v[60:63]
  v_mfma_f32_16x16x32_bf16 v[92:95], a[92:95], a[20:23], v[92:95]
  v_mfma_f32_16x16x32_bf16 v[124:127], a[92:95], a[24:27], v[124:127]
  v_mfma_f32_16x16x32_bf16 v[156:159], a[92:95], a[28:31], v[156:159]
  s_waitcnt lgkmcnt(0)
  v_mfma_f32_16x16x32_bf16 v[32:35], a[32:35], a[0:3], v[32:35]
  buffer_load_dwordx4 v6, s[8:11], s26 offen offset:2048 lds
  v_mfma_f32_16x16x32_bf16 v[64:67], a[32:35], a[4:7], v[64:67]
  ds_read_b128 a[16:19], v17 offset:0
  ds_read_b64_tr_b16 a[64:65], v18 offset:4096
  v_mfma_f32_16x16x32_bf16 v[96:99], a[32:35], a[8:11], v[96:99]
  ds_read_b64_tr_b16 a[66:67], v18 offset:6144
  v_mfma_f32_16x16x32_bf16 v[128:131], a[32:35], a[12:15], v[128:131]
  ds_read_b128 a[20:23], v17 offset:2048
  v_mfma_f32_16x16x32_bf16 v[36:39], a[36:39], a[0:3], v[36:39]
  buffer_load_dwordx4 v7, s[8:11], s26 offen offset:3072 lds
  v_mfma_f32_16x16x32_bf16 v[68:71], a[36:39], a[4:7], v[68:71]
  s_add_u32 m0, s88, 4096
  ds_read_b128 a[24:27], v17 offset:4096
  ds_read_b128 a[28:31], v17 offset:6144
  v_mfma_f32_16x16x32_bf16 v[100:103], a[36:39], a[8:11], v[100:103]
  s_add_u32 s88, s88, s90
  ds_read_b64_tr_b16 a[68:69], v19 offset:4096
  v_mfma_f32_16x16x32_bf16 v[132:135], a[36:39], a[12:15], v[132:135]
  s_add_u32 s89, s89, 1
  ds_read_b64_tr_b16 a[70:71], v19 offset:6144
  v_mfma_f32_16x16x32_bf16 v[40:43], a[40:43], a[0:3], v[40:43]
  buffer_load_dwordx4 v4, s[8:11], s27 offen offset:0 lds
  v_mfma_f32_16x16x32_bf16 v[72:75], a[40:43], a[4:7], v[72:75]
  ds_read_b64_tr_b16 a[72:73], v20 offset:4096
  ds_read_b64_tr_b16 a[74:75], v20 offset:6144
  v_mfma_f32_16x16x32_bf16 v[104:107], a[40:43], a[8:11], v[104:107]
  s_cmp_eq_u32 s89, 3
  s_cselect_b32 s89, 0, s89
  s_cselect_b32 s90, s91, s92
  v_mfma_f32_16x16x32_bf16 v[136:139], a[40:43], a[12:15], v[136:139]
  s_add_u32 s68, s68, s70
  ds_read_b64_tr_b16 a[76:77], v21 offset:4096
  v_mfma_f32_16x16x32_bf16 v[44:47], a[44:47], a[0:3], v[44:47]
  buffer_load_dwordx4 v5, s[8:11], s27 offen offset:1024 lds
  v_mfma_f32_16x16x32_bf16 v[76:79], a[44:47], a[4:7], v[76:79]
  s_add_u32 s69, s69, 1
  ds_read_b64_tr_b16 a[78:79], v21 offset:6144
  ds_read_b64_tr_b16 a[80:81], v18 offset:12288
  v_mfma_f32_16x16x32_bf16 v[108:111], a[44:47], a[8:11], v[108:111]
  ds_read_b64_tr_b16 a[82:83], v18 offset:14336
  v_mfma_f32_16x16x32_bf16 v[140:143], a[44:47], a[12:15], v[140:143]
  ds_read_b64_tr_b16 a[84:85], v19 offset:12288
  v_mfma_f32_16x16x32_bf16 v[48:51], a[48:51], a[0:3], v[48:51]
  buffer_load_dwordx4 v6, s[8:11], s27 offen offset:2048 lds
  v_mfma_f32_16x16x32_bf16 v[80:83], a[48:51], a[4:7], v[80:83]
  ds_read_b64_tr_b16 a[86:87], v19 offset:14336
  ds_read_b64_tr_b16 a[88:89], v20 offset:12288
  v_mfma_f32_16x16x32_bf16 v[112:115], a[48:51], a[8:11], v[112:115]
  ds_read_b64_tr_b16 a[90:91], v20 offset:14336
  v_mfma_f32_16x16x32_bf16 v[144:147], a[48:51], a[12:15], v[144:147]
  ds_read_b64_tr_b16 a[92:93], v21 offset:12288
  v_mfma_f32_16x16x32_bf16 v[52:55], a[52:55], a[0:3], v[52:55]
  buffer_load_dwordx4 v7, s[8:11], s27 offen offset:3072 lds
  v_mfma_f32_16x16x32_bf16 v[84:87], a[52:55], a[4:7], v[84:87]
  s_bfe_u32 s29, 0x302010e, s53
  ds_read_b64_tr_b16 a[94:95], v21 offset:14336
  v_mfma_f32_16x16x32_bf16 v[116:119], a[52:55], a[8:11], v[116:119]
  s_cmp_eq_u32 s69, 3
  s_cselect_b32 s69, 0, s69
  s_cselect_b32 s70, s71, s72
  v_mfma_f32_16x16x32_bf16 v[148:151], a[52:55], a[12:15], v[148:151]
  s_add_u32 s52, s52, s29
  v_add_u32 v16, s90, v16
  v_add_u32 v17, s90, v17
  v_mfma_f32_16x16x32_bf16 v[56:59], a[56:59], a[0:3], v[56:59]
  s_add_u32 s53, s53, 8
  v_add_u32 v18, s70, v18
  v_add_u32 v19, s70, v19
  v_mfma_f32_16x16x32_bf16 v[88:91], a[56:59], a[4:7], v[88:91]
  s_and_b32 s53, s53, 0x8001f
  v_add_u32 v20, s70, v20
  v_add_u32 v21, s70, v21
  v_mfma_f32_16x16x32_bf16 v[120:123], a[56:59], a[8:11], v[120:123]
  s_and_b32 s52, s52, 15
  v_mfma_f32_16x16x32_bf16 v[152:155], a[56:59], a[12:15], v[152:155]
  s_lshl_b32 s29, s52, 7
  v_mfma_f32_16x16x32_bf16 v[60:63], a[60:63], a[0:3], v[60:63]
  s_or_b32 s26, s30, s29
  s_or_b32 s27, s31, s29
  v_mfma_f32_16x16x32_bf16 v[92:95], a[60:63], a[4:7], v[92:95]
  v_mfma_f32_16x16x32_bf16 v[124:127], a[60:63], a[8:11], v[124:127]
  v_mfma_f32_16x16x32_bf16 v[156:159], a[60:63], a[12:15], v[156:159]
  s_mov_b32 s35, 6
  s_waitcnt vmcnt(12) lgkmcnt(0)
  s_barrier
  .p2align 6
Lp3_loop:
  v_mfma_f32_16x16x32_bf16 v[32:35], a[64:67], a[16:19], v[32:35]
  s_mov_b32 m0, s68
  ds_read_b128 a[0:3], v16 offset:0
  v_mfma_f32_16x16x32_bf16 v[64:67], a[64:67], a[20:23], v[64:67]
  buffer_load_dwordx4 v8, s[20:23], s28 offen offset:0 lds
  v_mfma_f32_16x16x32_bf16 v[96:99], a[64:67], a[24:27], v[96:99]
  ds_read_b64_tr_b16 a[32:33], v18 offset:0
  ds_read_b64_tr_b16 a[34:35], v18 offset:2048
  v_mfma_f32_16x16x32_bf16 v[128:131], a[64:67], a[28:31], v[128:131]
  ds_read_b128 a[4:7], v16 offset:2048
  v_mfma_f32_16x16x32_bf16 v[36:39], a[68:71], a[16:19], v[36:39]
  ds_read_b128 a[8:11], v16 offset:4096
  v_mfma_f32_16x16x32_bf16 v[68:71], a[68:71], a[20:23], v[68:71]
  buffer_load_dwordx4 v9, s[20:23], s28 offen offset:1024 lds
  v_mfma_f32_16x16x32_bf16 v[100:103], a[68:71], a[24:27], v[100:103]
  ds_read_b128 a[12:15], v16 offset:6144
  ds_read_b64_tr_b16 a[36:37], v19 offset:0
  v_mfma_f32_16x16x32_bf16 v[132:135], a[68:71], a[28:31], v[132:135]
  ds_read_b64_tr_b16 a[38:39], v19 offset:2048
  v_mfma_f32_16x16x32_bf16 v[40:43], a[72:75], a[16:19], v[40:43]
  ds_read_b64_tr_b16 a[40:41], v20 offset:0
  v_mfma_f32_16x16x32_bf16 v[72:75], a[72:75], a[20:23], v[72:75]
  ds_read_b64_tr_b16 a[42:43], v20 offset:2048
  v_mfma_f32_16x16x32_bf16 v[104:107], a[72:75], a[24:27], v[104:107]
  buffer_load_dwordx4 v10, s[20:23], s28 offen offset:2048 lds
  v_mfma_f32_16x16x32_bf16 v[136:139], a[72:75], a[28:31], v[136:139]
  ds_read_b64_tr_b16 a[44:45], v21 offset:0
  v_mfma_f32_16x16x32_bf16 v[44:47], a[76:79], a[16:19], v[44:47]
  ds_read_b64_tr_b16 a[46:47], v21 offset:2048
  v_mfma_f32_16x16x32_bf16 v[76:79], a[76:79], a[20:23], v[76:79]
  ds_read_b64_tr_b16 a[48:49], v18 offset:8192
  v_mfma_f32_16x16x32_bf16 v[108:111], a[76:79], a[24:27], v[108:111]
  ds_read_b64_tr_b16 a[50:51], v18 offset:10240
  v_mfma_f32_16x16x32_bf16 v[140:143], a[76:79], a[28:31], v[140:143]
  buffer_load_dwordx4 v11, s[20:23], s28 offen offset:3072 lds
  v_mfma_f32_16x16x32_bf16 v[48:51], a[80:83], a[16:19], v[48:51]
  s_bfe_u32 s56, 0x302010e, s55
  s_add_u32 s54, s54, s56
  s_add_u32 s55, s55, 8
  v_mfma_f32_16x16x32_bf16 v[80:83], a[80:83], a[20:23], v[80:83]
  s_and_b32 s55, s55, 0x8001f
  s_and_b32 s54, s54, 15
  s_lshl_b32 s28, s54, 19
  v_mfma_f32_16x16x32_bf16 v[112:115], a[80:83], a[24:27], v[112:115]
  s_mov_b32 m0, s88
  ds_read_b64_tr_b16 a[52:53], v19 offset:8192
  ds_read_b64_tr_b16 a[54:55], v19 offset:10240
  v_mfma_f32_16x16x32_bf16 v[144:147], a[80:83], a[28:31], v[144:147]
  ds_read_b64_tr_b16 a[56:57], v20 offset:8192
  ds_read_b64_tr_b16 a[58:59], v20 offset:10240
  v_mfma_f32_16x16x32_bf16 v[52:55], a[84:87], a[16:19], v[52:55]
  buffer_load_dwordx4 v4, s[8:11], s26 offen offset:0 lds
  v_mfma_f32_16x16x32_bf16 v[84:87], a[84:87], a[20:23], v[84:87]
  ds_read_b64_tr_b16 a[60:61], v21 offset:8192
  ds_read_b64_tr_b16 a[62:63], v21 offset:10240
  v_mfma_f32_16x16x32_bf16 v[116:119], a[84:87], a[24:27], v[116:119]
  v_mfma_f32_16x16x32_bf16 v[148:151], a[84:87], a[28:31], v[148:151]
  v_mfma_f32_16x16x32_bf16 v[56:59], a[88:91], a[16:19], v[56:59]
  v_mfma_f32_16x16x32_bf16 v[88:91], a[88:91], a[20:23], v[88:91]
  buffer_load_dwordx4 v5, s[8:11], s26 offen offset:1024 lds
  v_mfma_f32_16x16x32_bf16 v[120:123], a[88:91], a[24:27], v[120:123]
  v_mfma_f32_16x16x32_bf16 v[152:155], a[88:91], a[28:31], v[152:155]
  v_mfma_f32_16x16x32_bf16 v[60:63], a[92:95], a[16:19], v[60:63]
  v_mfma_f32_16x16x32_bf16 v[92:95], a[92:95], a[20:23], v[92:95]
  v_mfma_f32_16x16x32_bf16 v[124:127], a[92:95], a[24:27], v[124:127]
  v_mfma_f32_16x16x32_bf16 v[156:159], a[92:95], a[28:31], v[156:159]
  s_waitcnt lgkmcnt(0)
  v_mfma_f32_16x16x32_bf16 v[32:35], a[32:35], a[0:3], v[32:35]
  buffer_load_dwordx4 v6, s[8:11], s26 offen offset:2048 lds
  v_mfma_f32_16x16x32_bf16 v[64:67], a[32:35], a[4:7], v[64:67]
  ds_read_b128 a[16:19], v17 offset:0
  ds_read_b64_tr_b16 a[64:65], v18 offset:4096
  v_mfma_f32_16x16x32_bf16 v[96:99], a[32:35], a[8:11], v[96:99]
  ds_read_b64_tr_b16 a[66:67], v18 offset:6144
  v_mfma_f32_16x16x32_bf16 v[128:131], a[32:35], a[12:15], v[128:131]
  ds_read_b128 a[20:23], v17 offset:2048
  v_mfma_f32_16x16x32_bf16 v[36:39], a[36:39], a[0:3], v[36:39]
  buffer_load_dwordx4 v7, s[8:11], s26 offen offset:3072 lds
  v_mfma_f32_16x16x32_bf16 v[68:71], a[36:39], a[4:7], v[68:71]
  s_add_u32 m0, s88, 4096
  ds_read_b128 a[24:27], v17 offset:4096
  ds_read_b128 a[28:31], v17 offset:6144
  v_mfma_f32_16x16x32_bf16 v[100:103], a[36:39], a[8:11], v[100:103]
  s_add_u32 s88, s88, s90
  ds_read_b64_tr_b16 a[68:69], v19 offset:4096
  v_mfma_f32_16x16x32_bf16 v[132:135], a[36:39], a[12:15], v[132:135]
  s_add_u32 s89, s89, 1
  ds_read_b64_tr_b16 a[70:71], v19 offset:6144
  v_mfma_f32_16x16x32_bf16 v[40:43], a[40:43], a[0:3], v[40:43]
  buffer_load_dwordx4 v4, s[8:11], s27 offen offset:0 lds
  v_mfma_f32_16x16x32_bf16 v[72:75], a[40:43], a[4:7], v[72:75]
  ds_read_b64_tr_b16 a[72:73], v20 offset:4096
  ds_read_b64_tr_b16 a[74:75], v20 offset:6144
  v_mfma_f32_16x16x32_bf16 v[104:107], a[40:43], a[8:11], v[104:107]
  s_cmp_eq_u32 s89, 3
  s_cselect_b32 s89, 0, s89
  s_cselect_b32 s90, s91, s92
  v_mfma_f32_16x16x32_bf16 v[136:139], a[40:43], a[12:15], v[136:139]
  s_add_u32 s68, s68, s70
  ds_read_b64_tr_b16 a[76:77], v21 offset:4096
  v_mfma_f32_16x16x32_bf16 v[44:47], a[44:47], a[0:3], v[44:47]
  buffer_load_dwordx4 v5, s[8:11], s27 offen offset:1024 lds
  v_mfma_f32_16x16x32_bf16 v[76:79], a[44:47], a[4:7], v[76:79]
  s_add_u32 s69, s69, 1
  ds_read_b64_tr_b16 a[78:79], v21 offset:6144
  ds_read_b64_tr_b16 a[80:81], v18 offset:12288
  v_mfma_f32_16x16x32_bf16 v[108:111], a[44:47], a[8:11], v[108:111]
  ds_read_b64_tr_b16 a[82:83], v18 offset:14336
  v_mfma_f32_16x16x32_bf16 v[140:143], a[44:47], a[12:15], v[140:143]
  ds_read_b64_tr_b16 a[84:85], v19 offset:12288
  v_mfma_f32_16x16x32_bf16 v[48:51], a[48:51], a[0:3], v[48:51]
  buffer_load_dwordx4 v6, s[8:11], s27 offen offset:2048 lds
  v_mfma_f32_16x16x32_bf16 v[80:83], a[48:51], a[4:7], v[80:83]
  ds_read_b64_tr_b16 a[86:87], v19 offset:14336
  ds_read_b64_tr_b16 a[88:89], v20 offset:12288
  v_mfma_f32_16x16x32_bf16 v[112:115], a[48:51], a[8:11], v[112:115]
  ds_read_b64_tr_b16 a[90:91], v20 offset:14336
  v_mfma_f32_16x16x32_bf16 v[144:147], a[48:51], a[12:15], v[144:147]
  ds_read_b64_tr_b16 a[92:93], v21 offset:12288
  v_mfma_f32_16x16x32_bf16 v[52:55], a[52:55], a[0:3], v[52:55]
  buffer_load_dwordx4 v7, s[8:11], s27 offen offset:3072 lds
  v_mfma_f32_16x16x32_bf16 v[84:87], a[52:55], a[4:7], v[84:87]
  s_bfe_u32 s29, 0x302010e, s53
  ds_read_b64_tr_b16 a[94:95], v21 offset:14336
  v_mfma_f32_16x16x32_bf16 v[116:119], a[52:55], a[8:11], v[116:119]
  s_cmp_eq_u32 s69, 3
  s_cselect_b32 s69, 0, s69
  s_cselect_b32 s70, s71, s72
  v_mfma_f32_16x16x32_bf16 v[148:151], a[52:55], a[12:15], v[148:151]
  s_add_u32 s52, s52, s29
  v_add_u32 v16, s90, v16
  v_add_u32 v17, s90, v17
  v_mfma_f32_16x16x32_bf16 v[56:59], a[56:59], a[0:3], v[56:59]
  s_add_u32 s53, s53, 8
  v_add_u32 v18, s70, v18
  v_add_u32 v19, s70, v19
  v_mfma_f32_16x16x32_bf16 v[88:91], a[56:59], a[4:7], v[88:91]
  s_and_b32 s53, s53, 0x8001f
  v_add_u32 v20, s70, v20
  v_add_u32 v21, s70, v21
  v_mfma_f32_16x16x32_bf16 v[120:123], a[56:59], a[8:11], v[120:123]
  s_and_b32 s52, s52, 15
  v_mfma_f32_16x16x32_bf16 v[152:155], a[56:59], a[12:15], v[152:155]
  s_lshl_b32 s29, s52, 7
  v_mfma_f32_16x16x32_bf16 v[60:63], a[60:63], a[0:3], v[60:63]
  s_or_b32 s26, s30, s29
  s_or_b32 s27, s31, s29
  v_mfma_f32_16x16x32_bf16 v[92:95], a[60:63], a[4:7], v[92:95]
  s_waitcnt vmcnt(12) lgkmcnt(0)
  s_barrier
  v_mfma_f32_16x16x32_bf16 v[124:127], a[60:63], a[8:11], v[124:127]
  s_sub_u32 s35, s35, 1
  v_mfma_f32_16x16x32_bf16 v[156:159], a[60:63], a[12:15], v[156:159]
  s_cmp_lg_u32 s35, 0
  s_cbranch_scc1 Lp3_loop
  s_lshr_b32 s34, s24, 1
  s_lshl_b32 s34, s34, 11
  v_and_b32 v3, 7, v1
  v_lshlrev_b32 v3, 7, v3
  v_mfma_f32_16x16x32_bf16 v[32:35], a[64:67], a[16:19], v[32:35]
  buffer_load_dwordx2 v[22:23], v3, s[96:99], s34 offen sc1
  v_mfma_f32_16x16x32_bf16 v[64:67], a[64:67], a[20:23], v[64:67]
  s_mov_b32 m0, s68
  ds_read_b128 a[0:3], v16 offset:0
  ds_read_b64_tr_b16 a[32:33], v18 offset:0
  v_mfma_f32_16x16x32_bf16 v[96:99], a[64:67], a[24:27], v[96:99]
  ds_read_b64_tr_b16 a[34:35], v18 offset:2048
  v_mfma_f32_16x16x32_bf16 v[128:131], a[64:67], a[28:31], v[128:131]
  ds_read_b128 a[4:7], v16 offset:2048
  v_mfma_f32_16x16x32_bf16 v[36:39], a[68:71], a[16:19], v[36:39]
  buffer_load_dwordx4 v8, s[20:23], s28 offen offset:0 lds
  v_mfma_f32_16x16x32_bf16 v[68:71], a[68:71], a[20:23], v[68:71]
  ds_read_b128 a[8:11], v16 offset:4096
  ds_read_b128 a[12:15], v16 offset:6144
  v_mfma_f32_16x16x32_bf16 v[100:103], a[68:71], a[24:27], v[100:103]
  ds_read_b64_tr_b16 a[36:37], v19 offset:0
  v_mfma_f32_16x16x32_bf16 v[132:135], a[68:71], a[28:31], v[132:135]
  ds_read_b64_tr_b16 a[38:39], v19 offset:2048
  v_mfma_f32_16x16x32_bf16 v[40:43], a[72:75], a[16:19], v[40:43]
  buffer_load_dwordx4 v9, s[20:23], s28 offen offset:1024 lds
  v_mfma_f32_16x16x32_bf16 v[72:75], a[72:75], a[20:23], v[72:75]
  ds_read_b64_tr_b16 a[40:41], v20 offset:0
  ds_read_b64_tr_b16 a[42:43], v20 offset:2048
  v_mfma_f32_16x16x32_bf16 v[104:107], a[72:75], a[24:27], v[104:107]
  v_mfma_f32_16x16x32_bf16 v[136:139], a[72:75], a[28:31], v[136:139]
  ds_read_b64_tr_b16 a[44:45], v21 offset:0
  v_mfma_f32_16x16x32_bf16 v[44:47], a[76:79], a[16:19], v[44:47]
  ds_read_b64_tr_b16 a[46:47], v21 offset:2048
  v_mfma_f32_16x16x32_bf16 v[76:79], a[76:79], a[20:23], v[76:79]
  buffer_load_dwordx4 v10, s[20:23], s28 offen offset:2048 lds
  v_mfma_f32_16x16x32_bf16 v[108:111], a[76:79], a[24:27], v[108:111]
  ds_read_b64_tr_b16 a[48:49], v18 offset:8192
  ds_read_b64_tr_b16 a[50:51], v18 offset:10240
  v_mfma_f32_16x16x32_bf16 v[140:143], a[76:79], a[28:31], v[140:143]
  ds_read_b64_tr_b16 a[52:53], v19 offset:8192
  v_mfma_f32_16x16x32_bf16 v[48:51], a[80:83], a[16:19], v[48:51]
  ds_read_b64_tr_b16 a[54:55], v19 offset:10240
  v_mfma_f32_16x16x32_bf16 v[80:83], a[80:83], a[20:23], v[80:83]
  buffer_load_dwordx4 v11, s[20:23], s28 offen offset:3072 lds
  v_mfma_f32_16x16x32_bf16 v[112:115], a[80:83], a[24:27], v[112:115]
  s_bfe_u32 s56, 0x302010e, s55
  s_add_u32 s54, s54, s56
  s_add_u32 s55, s55, 8
  v_mfma_f32_16x16x32_bf16 v[144:147], a[80:83], a[28:31], v[144:147]
  s_and_b32 s55, s55, 0x8001f
  s_and_b32 s54, s54, 15
  s_lshl_b32 s28, s54, 19
  v_mfma_f32_16x16x32_bf16 v[52:55], a[84:87], a[16:19], v[52:55]
  s_mov_b32 m0, s88
  ds_read_b64_tr_b16 a[56:57], v20 offset:8192
  ds_read_b64_tr_b16 a[58:59], v20 offset:10240
  v_mfma_f32_16x16x32_bf16 v[84:87], a[84:87], a[20:23], v[84:87]
  ds_read_b64_tr_b16 a[60:61], v21 offset:8192
  ds_read_b64_tr_b16 a[62:63], v21 offset:10240
  v_mfma_f32_16x16x32_bf16 v[116:119], a[84:87], a[24:27], v[116:119]
  buffer_load_dwordx4 v4, s[8:11], s26 offen offset:0 lds
  v_mfma_f32_16x16x32_bf16 v[148:151], a[84:87], a[28:31], v[148:151]
  v_mfma_f32_16x16x32_bf16 v[56:59], a[88:91], a[16:19], v[56:59]
  v_mfma_f32_16x16x32_bf16 v[88:91], a[88:91], a[20:23], v[88:91]
  v_mfma_f32_16x16x32_bf16 v[120:123], a[88:91], a[24:27], v[120:123]
  buffer_load_dwordx4 v5, s[8:11], s26 offen offset:1024 lds
  v_mfma_f32_16x16x32_bf16 v[152:155], a[88:91], a[28:31], v[152:155]
  v_mfma_f32_16x16x32_bf16 v[60:63], a[92:95], a[16:19], v[60:63]
  v_mfma_f32_16x16x32_bf16 v[92:95], a[92:95], a[20:23], v[92:95]
  v_mfma_f32_16x16x32_bf16 v[124:127], a[92:95], a[24:27], v[124:127]
  v_mfma_f32_16x16x32_bf16 v[156:159], a[92:95], a[28:31], v[156:159]
  s_waitcnt lgkmcnt(0)
  v_mfma_f32_16x16x32_bf16 v[32:35], a[32:35], a[0:3], v[32:35]
  buffer_load_dwordx4 v6, s[8:11], s26 offen offset:2048 lds
  v_mfma_f32_16x16x32_bf16 v[64:67], a[32:35], a[4:7], v[64:67]
  ds_read_b128 a[16:19], v17 offset:0
  ds_read_b64_tr_b16 a[64:65], v18 offset:4096
  v_mfma_f32_16x16x32_bf16 v[96:99], a[32:35], a[8:11], v[96:99]
  ds_read_b64_tr_b16 a[66:67], v18 offset:6144
  v_mfma_f32_16x16x32_bf16 v[128:131], a[32:35], a[12:15], v[128:131]
  ds_read_b128 a[20:23], v17 offset:2048
  v_mfma_f32_16x16x32_bf16 v[36:39], a[36:39], a[0:3], v[36:39]
  buffer_load_dwordx4 v7, s[8:11], s26 offen offset:3072 lds
  v_mfma_f32_16x16x32_bf16 v[68:71], a[36:39], a[4:7], v[68:71]
  s_add_u32 m0, s88, 4096
  ds_read_b128 a[24:27], v17 offset:4096
  ds_read_b128 a[28:31], v17 offset:6144
  v_mfma_f32_16x16x32_bf16 v[100:103], a[36:39], a[8:11], v[100:103]
  s_add_u32 s88, s88, s90
  ds_read_b64_tr_b16 a[68:69], v19 offset:4096
  v_mfma_f32_16x16x32_bf16 v[132:135], a[36:39], a[12:15], v[132:135]
  s_add_u32 s89, s89, 1
  ds_read_b64_tr_b16 a[70:71], v19 offset:6144
  v_mfma_f32_16x16x32_bf16 v[40:43], a[40:43], a[0:3], v[40:43]
  buffer_load_dwordx4 v4, s[8:11], s27 offen offset:0 lds
  v_mfma_f32_16x16x32_bf16 v[72:75], a[40:43], a[4:7], v[72:75]
  ds_read_b64_tr_b16 a[72:73], v20 offset:4096
  ds_read_b64_tr_b16 a[74:75], v20 offset:6144
  v_mfma_f32_16x16x32_bf16 v[104:107], a[40:43], a[8:11], v[104:107]
  s_cmp_eq_u32 s89, 3
  s_cselect_b32 s89, 0, s89
  s_cselect_b32 s90, s91, s92
  v_mfma_f32_16x16x32_bf16 v[136:139], a[40:43], a[12:15], v[136:139]
  s_add_u32 s68, s68, s70
  ds_read_b64_tr_b16 a[76:77], v21 offset:4096
  v_mfma_f32_16x16x32_bf16 v[44:47], a[44:47], a[0:3], v[44:47]
  buffer_load_dwordx4 v5, s[8:11], s27 offen offset:1024 lds
  v_mfma_f32_16x16x32_bf16 v[76:79], a[44:47], a[4:7], v[76:79]
  s_add_u32 s69, s69, 1
  ds_read_b64_tr_b16 a[78:79], v21 offset:6144
  ds_read_b64_tr_b16 a[80:81], v18 offset:12288
  v_mfma_f32_16x16x32_bf16 v[108:111], a[44:47], a[8:11], v[108:111]
  ds_read_b64_tr_b16 a[82:83], v18 offset:14336
  v_mfma_f32_16x16x32_bf16 v[140:143], a[44:47], a[12:15], v[140:143]
  ds_read_b64_tr_b16 a[84:85], v19 offset:12288
  v_mfma_f32_16x16x32_bf16 v[48:51], a[48:51], a[0:3], v[48:51]
  buffer_load_dwordx4 v6, s[8:11], s27 offen offset:2048 lds
  v_mfma_f32_16x16x32_bf16 v[80:83], a[48:51], a[4:7], v[80:83]
  ds_read_b64_tr_b16 a[86:87], v19 offset:14336
  ds_read_b64_tr_b16 a[88:89], v20 offset:12288
  v_mfma_f32_16x16x32_bf16 v[112:115], a[48:51], a[8:11], v[112:115]
  ds_read_b64_tr_b16 a[90:91], v20 offset:14336
  v_mfma_f32_16x16x32_bf16 v[144:147], a[48:51], a[12:15], v[144:147]
  ds_read_b64_tr_b16 a[92:93], v21 offset:12288
  v_mfma_f32_16x16x32_bf16 v[52:55], a[52:55], a[0:3], v[52:55]
  buffer_load_dwordx4 v7, s[8:11], s27 offen offset:3072 lds
  v_mfma_f32_16x16x32_bf16 v[84:87], a[52:55], a[4:7], v[84:87]
  s_bfe_u32 s29, 0x302010e, s53
  ds_read_b64_tr_b16 a[94:95], v21 offset:14336
  v_mfma_f32_16x16x32_bf16 v[116:119], a[52:55], a[8:11], v[116:119]
  s_cmp_eq_u32 s69, 3
  s_cselect_b32 s69, 0, s69
  s_cselect_b32 s70, s71, s72
  v_mfma_f32_16x16x32_bf16 v[148:151], a[52:55], a[12:15], v[148:151]
  s_add_u32 s52, s52, s29
  v_add_u32 v16, s90, v16
  v_add_u32 v17, s90, v17
  v_mfma_f32_16x16x32_bf16 v[56:59], a[56:59], a[0:3], v[56:59]
  s_add_u32 s53, s53, 8
  v_add_u32 v18, s70, v18
  v_add_u32 v19, s70, v19
  v_mfma_f32_16x16x32_bf16 v[88:91], a[56:59], a[4:7], v[88:91]
  s_and_b32 s53, s53, 0x8001f
  v_add_u32 v20, s70, v20
  v_add_u32 v21, s70, v21
  v_mfma_f32_16x16x32_bf16 v[120:123], a[56:59], a[8:11], v[120:123]
  s_and_b32 s52, s52, 15
  v_mfma_f32_16x16x32_bf16 v[152:155], a[56:59], a[12:15], v[152:155]
  s_lshl_b32 s29, s52, 7
  v_mfma_f32_16x16x32_bf16 v[60:63], a[60:63], a[0:3], v[60:63]
  s_or_b32 s26, s30, s29
  s_or_b32 s27, s31, s29
  v_mfma_f32_16x16x32_bf16 v[92:95], a[60:63], a[4:7], v[92:95]
  v_mfma_f32_16x16x32_bf16 v[124:127], a[60:63], a[8:11], v[124:127]
  v_mfma_f32_16x16x32_bf16 v[156:159], a[60:63], a[12:15], v[156:159]
  s_waitcnt vmcnt(12) lgkmcnt(0)
  s_barrier
  s_mov_b32 s5, 0x40000
Lpoll_5:
  v_cmp_ne_u64 vcc, s[94:95], v[22:23]
  s_nop 0
  s_cbranch_vccz Lpolld_6
  s_sleep 4
  buffer_load_dwordx2 v[22:23], v3, s[96:99], s34 offen sc1
  s_sub_u32 s5, s5, 1
  s_waitcnt vmcnt(0)
  s_cbranch_scc0 Lpoll_5
Lpolld_6:
  s_lshl_b32 s4, s24, 20
  s_and_b32 s5, s25, 1
  s_lshl_b32 s5, s5, 1
  s_add_u32 s5, s5, 14
  s_sub_u32 s5, s5, s25
  s_add_u32 s5, s5, 1
  s_lshl_b32 s5, s5, 16
  s_add_u32 s20, s86, 16777216
  s_addc_u32 s21, s87, 0
  s_add_u32 s20, s20, s4
  s_addc_u32 s21, s21, 0
  s_mov_b32 s22, s5
  s_mov_b32 s23, 0x00020000
  s_lshl_b32 s28, s3, 12
  s_add_u32 s26, s28, 0xc000
  s_add_u32 s27, s28, 0x10000
  s_add_u32 s29, s28, 0x4000
  s_and_b32 s4, s2, 1
  s_lshl_b32 s4, s4, 3
  s_bfe_u32 s5, s2, 0x30003
  s_add_u32 s73, s4, s5
  s_bfe_u32 s4, s2, 0x10001
  s_lshl_b32 s4, s4, 2
  s_lshr_b32 s5, s2, 6
  s_add_u32 s76, s4, s5
  s_bfe_u32 s77, s2, 0x10002
  s_lshl_b32 s78, s73, 3
  s_add_u32 s78, s78, s76
  s_lshl_b32 s79, s3, 12
  v_mfma_f32_16x16x32_bf16 v[32:35], a[64:67], a[16:19], v[32:35]
  s_mov_b32 m0, s26
  ds_read_b128 a[0:3], v16 offset:0
  v_mfma_f32_16x16x32_bf16 v[64:67], a[64:67], a[20:23], v[64:67]
  buffer_load_dwordx4 v2, s[20:23], s28 offen offset:0 sc1 lds
  v_mfma_f32_16x16x32_bf16 v[96:99], a[64:67], a[24:27], v[96:99]
  ds_read_b64_tr_b16 a[32:33], v18 offset:0
  ds_read_b64_tr_b16 a[34:35], v18 offset:2048
  v_mfma_f32_16x16x32_bf16 v[128:131], a[64:67], a[28:31], v[128:131]
  ds_read_b128 a[4:7], v16 offset:2048
  v_mfma_f32_16x16x32_bf16 v[36:39], a[68:71], a[16:19], v[36:39]
  ds_read_b128 a[8:11], v16 offset:4096
  v_mfma_f32_16x16x32_bf16 v[68:71], a[68:71], a[20:23], v[68:71]
  ds_read_b128 a[12:15], v16 offset:6144
  v_mfma_f32_16x16x32_bf16 v[100:103], a[68:71], a[24:27], v[100:103]
  ds_read_b64_tr_b16 a[36:37], v19 offset:0
  v_mfma_f32_16x16x32_bf16 v[132:135], a[68:71], a[28:31], v[132:135]
  ds_read_b64_tr_b16 a[38:39], v19 offset:2048
  v_mfma_f32_16x16x32_bf16 v[40:43], a[72:75], a[16:19], v[40:43]
  ds_read_b64_tr_b16 a[40:41], v20 offset:0
  v_mfma_f32_16x16x32_bf16 v[72:75], a[72:75], a[20:23], v[72:75]
  ds_read_b64_tr_b16 a[42:43], v20 offset:2048
  v_mfma_f32_16x16x32_bf16 v[104:107], a[72:75], a[24:27], v[104:107]
  v_mfma_f32_16x16x32_bf16 v[136:139], a[72:75], a[28:31], v[136:139]
  ds_read_b64_tr_b16 a[44:45], v21 offset:0
  v_mfma_f32_16x16x32_bf16 v[44:47], a[76:79], a[16:19], v[44:47]
  ds_read_b64_tr_b16 a[46:47], v21 offset:2048
  v_mfma_f32_16x16x32_bf16 v[76:79], a[76:79], a[20:23], v[76:79]
  ds_read_b64_tr_b16 a[48:49], v18 offset:8192
  v_mfma_f32_16x16x32_bf16 v[108:111], a[76:79], a[24:27], v[108:111]
  ds_read_b64_tr_b16 a[50:51], v18 offset:10240
  v_mfma_f32_16x16x32_bf16 v[140:143], a[76:79], a[28:31], v[140:143]
  buffer_load_dwordx4 v2, s[20:23], s28 offen offset:1024 sc1 lds
  v_mfma_f32_16x16x32_bf16 v[48:51], a[80:83], a[16:19], v[48:51]
  ds_read_b64_tr_b16 a[52:53], v19 offset:8192
  ds_read_b64_tr_b16 a[54:55], v19 offset:10240
  v_mfma_f32_16x16x32_bf16 v[80:83], a[80:83], a[20:23], v[80:83]
  ds_read_b64_tr_b16 a[56:57], v20 offset:8192
  v_mfma_f32_16x16x32_bf16 v[112:115], a[80:83], a[24:27], v[112:115]
  ds_read_b64_tr_b16 a[58:59], v20 offset:10240
  v_mfma_f32_16x16x32_bf16 v[144:147], a[80:83], a[28:31], v[144:147]
  ds_read_b64_tr_b16 a[60:61], v21 offset:8192
  v_mfma_f32_16x16x32_bf16 v[52:55], a[84:87], a[16:19], v[52:55]
  ds_read_b64_tr_b16 a[62:63], v21 offset:10240
  v_mfma_f32_16x16x32_bf16 v[84:87], a[84:87], a[20:23], v[84:87]
  v_mfma_f32_16x16x32_bf16 v[116:119], a[84:87], a[24:27], v[116:119]
  v_mfma_f32_16x16x32_bf16 v[148:151], a[84:87], a[28:31], v[148:151]
  v_mfma_f32_16x16x32_bf16 v[56:59], a[88:91], a[16:19], v[56:59]
  v_mfma_f32_16x16x32_bf16 v[88:91], a[88:91], a[20:23], v[88:91]
  v_mfma_f32_16x16x32_bf16 v[120:123], a[88:91], a[24:27], v[120:123]
  v_mfma_f32_16x16x32_bf16 v[152:155], a[88:91], a[28:31], v[152:155]
  v_mfma_f32_16x16x32_bf16 v[60:63], a[92:95], a[16:19], v[60:63]
  v_mfma_f32_16x16x32_bf16 v[92:95], a[92:95], a[20:23], v[92:95]
  v_mfma_f32_16x16x32_bf16 v[124:127], a[92:95], a[24:27], v[124:127]
  v_mfma_f32_16x16x32_bf16 v[156:159], a[92:95], a[28:31], v[156:159]
  s_waitcnt lgkmcnt(0)
  v_mfma_f32_16x16x32_bf16 v[32:35], a[32:35], a[0:3], v[32:35]
  buffer_load_dwordx4 v2, s[20:23], s28 offen offset:2048 sc1 lds
  v_mfma_f32_16x16x32_bf16 v[64:67], a[32:35], a[4:7], v[64:67]
  s_add_u32 s88, s88, s90
  ds_read_b128 a[16:19], v17 offset:0
  ds_read_b64_tr_b16 a[64:65], v18 offset:4096
  v_mfma_f32_16x16x32_bf16 v[96:99], a[32:35], a[8:11], v[96:99]
  s_add_u32 s89, s89, 1
  ds_read_b64_tr_b16 a[66:67], v18 offset:6144
  v_mfma_f32_16x16x32_bf16 v[128:131], a[32:35], a[12:15], v[128:131]
  ds_read_b128 a[20:23], v17 offset:2048
  v_mfma_f32_16x16x32_bf16 v[36:39], a[36:39], a[0:3], v[36:39]
  ds_read_b128 a[24:27], v17 offset:4096
  v_mfma_f32_16x16x32_bf16 v[68:71], a[36:39], a[4:7], v[68:71]
  ds_read_b128 a[28:31], v17 offset:6144
  v_mfma_f32_16x16x32_bf16 v[100:103], a[36:39], a[8:11], v[100:103]
  ds_read_b64_tr_b16 a[68:69], v19 offset:4096
  v_mfma_f32_16x16x32_bf16 v[132:135], a[36:39], a[12:15], v[132:135]
  ds_read_b64_tr_b16 a[70:71], v19 offset:6144
  v_mfma_f32_16x16x32_bf16 v[40:43], a[40:43], a[0:3], v[40:43]
  ds_read_b64_tr_b16 a[72:73], v20 offset:4096
  v_mfma_f32_16x16x32_bf16 v[72:75], a[40:43], a[4:7], v[72:75]
  ds_read_b64_tr_b16 a[74:75], v20 offset:6144
  v_mfma_f32_16x16x32_bf16 v[104:107], a[40:43], a[8:11], v[104:107]
  s_cmp_eq_u32 s89, 3
  s_cselect_b32 s89, 0, s89
  s_cselect_b32 s90, s91, s92
  v_mfma_f32_16x16x32_bf16 v[136:139], a[40:43], a[12:15], v[136:139]
  s_add_u32 s68, s68, s70
  ds_read_b64_tr_b16 a[76:77], v21 offset:4096
  v_mfma_f32_16x16x32_bf16 v[44:47], a[44:47], a[0:3], v[44:47]
  buffer_load_dwordx4 v2, s[20:23], s28 offen offset:3072 sc1 lds
  v_mfma_f32_16x16x32_bf16 v[76:79], a[44:47], a[4:7], v[76:79]
  s_add_u32 s69, s69, 1
  ds_read_b64_tr_b16 a[78:79], v21 offset:6144
  ds_read_b64_tr_b16 a[80:81], v18 offset:12288
  v_mfma_f32_16x16x32_bf16 v[108:111], a[44:47], a[8:11], v[108:111]
  s_xor_b32 s26, s26, 0x4000
  ds_read_b64_tr_b16 a[82:83], v18 offset:14336
  v_mfma_f32_16x16x32_bf16 v[140:143], a[44:47], a[12:15], v[140:143]
  s_add_u32 s28, s28, 0x8000
  ds_read_b64_tr_b16 a[84:85], v19 offset:12288
  v_mfma_f32_16x16x32_bf16 v[48:51], a[48:51], a[0:3], v[48:51]
  ds_read_b64_tr_b16 a[86:87], v19 offset:14336
  v_mfma_f32_16x16x32_bf16 v[80:83], a[48:51], a[4:7], v[80:83]
  ds_read_b64_tr_b16 a[88:89], v20 offset:12288
  v_mfma_f32_16x16x32_bf16 v[112:115], a[48:51], a[8:11], v[112:115]
  ds_read_b64_tr_b16 a[90:91], v20 offset:14336
  v_mfma_f32_16x16x32_bf16 v[144:147], a[48:51], a[12:15], v[144:147]
  ds_read_b64_tr_b16 a[92:93], v21 offset:12288
  v_mfma_f32_16x16x32_bf16 v[52:55], a[52:55], a[0:3], v[52:55]
  ds_read_b64_tr_b16 a[94:95], v21 offset:14336
  v_mfma_f32_16x16x32_bf16 v[84:87], a[52:55], a[4:7], v[84:87]
  s_cmp_eq_u32 s69, 3
  s_cselect_b32 s69, 0, s69
  s_cselect_b32 s70, s71, s72
  v_mfma_f32_16x16x32_bf16 v[116:119], a[52:55], a[8:11], v[116:119]
  v_add_u32 v16, s90, v16
  v_add_u32 v17, s90, v17
  v_mfma_f32_16x16x32_bf16 v[148:151], a[52:55], a[12:15], v[148:151]
  v_add_u32 v18, s70, v18
  v_add_u32 v19, s70, v19
  v_mfma_f32_16x16x32_bf16 v[56:59], a[56:59], a[0:3], v[56:59]
  v_add_u32 v20, s70, v20
  v_add_u32 v21, s70, v21
  v_mfma_f32_16x16x32_bf16 v[88:91], a[56:59], a[4:7], v[88:91]
  v_mfma_f32_16x16x32_bf16 v[120:123], a[56:59], a[8:11], v[120:123]
  v_mfma_f32_16x16x32_bf16 v[152:155], a[56:59], a[12:15], v[152:155]
  v_mfma_f32_16x16x32_bf16 v[60:63], a[60:63], a[0:3], v[60:63]
  v_mfma_f32_16x16x32_bf16 v[92:95], a[60:63], a[4:7], v[92:95]
  v_mfma_f32_16x16x32_bf16 v[124:127], a[60:63], a[8:11], v[124:127]
  v_mfma_f32_16x16x32_bf16 v[156:159], a[60:63], a[12:15], v[156:159]
  s_waitcnt vmcnt(4) lgkmcnt(0)
  s_barrier
  s_mov_b32 s6, 0x3e0293ee
  s_mov_b32 s7, s6
  v_mfma_f32_16x16x32_bf16 v[32:35], a[64:67], a[16:19], v[32:35]
  s_mov_b32 m0, s26
  ds_read_b128 a[0:3], v16 offset:0
  v_mfma_f32_16x16x32_bf16 v[64:67], a[64:67], a[20:23], v[64:67]
  buffer_load_dwordx4 v2, s[20:23], s28 offen offset:0 sc1 lds
  v_mfma_f32_16x16x32_bf16 v[96:99], a[64:67], a[24:27], v[96:99]
  ds_read_b64_tr_b16 a[32:33], v18 offset:0
  ds_read_b64_tr_b16 a[34:35], v18 offset:2048
  v_mfma_f32_16x16x32_bf16 v[128:131], a[64:67], a[28:31], v[128:131]
  buffer_load_dwordx4 v2, s[20:23], s28 offen offset:1024 sc1 lds
  v_mfma_f32_16x16x32_bf16 v[36:39], a[68:71], a[16:19], v[36:39]
  ds_read_b128 a[4:7], v16 offset:2048
  ds_read_b128 a[8:11], v16 offset:4096
  v_mfma_f32_16x16x32_bf16 v[68:71], a[68:71], a[20:23], v[68:71]
  ds_read_b128 a[12:15], v16 offset:6144
  v_mfma_f32_16x16x32_bf16 v[100:103], a[68:71], a[24:27], v[100:103]
  ds_read_b64_tr_b16 a[36:37], v19 offset:0
  v_mfma_f32_16x16x32_bf16 v[132:135], a[68:71], a[28:31], v[132:135]
  buffer_load_dwordx4 v2, s[20:23], s28 offen offset:2048 sc1 lds
  v_mfma_f32_16x16x32_bf16 v[40:43], a[72:75], a[16:19], v[40:43]
  ds_read_b64_tr_b16 a[38:39], v19 offset:2048
  ds_read_b64_tr_b16 a[40:41], v20 offset:0
  v_mfma_f32_16x16x32_bf16 v[72:75], a[72:75], a[20:23], v[72:75]
  ds_read_b64_tr_b16 a[42:43], v20 offset:2048
  v_mfma_f32_16x16x32_bf16 v[104:107], a[72:75], a[24:27], v[104:107]
  v_mfma_f32_16x16x32_bf16 v[136:139], a[72:75], a[28:31], v[136:139]
  buffer_load_dwordx4 v2, s[20:23], s28 offen offset:3072 sc1 lds
  v_mfma_f32_16x16x32_bf16 v[44:47], a[76:79], a[16:19], v[44:47]
  s_xor_b32 s26, s26, 0x8000
  s_add_u32 s28, s28, 0x8000
  s_mov_b32 m0, s27
  v_mfma_f32_16x16x32_bf16 v[76:79], a[76:79], a[20:23], v[76:79]
  ds_read_b64_tr_b16 a[44:45], v21 offset:0
  ds_read_b64_tr_b16 a[46:47], v21 offset:2048
  v_mfma_f32_16x16x32_bf16 v[108:111], a[76:79], a[24:27], v[108:111]
  ds_read_b64_tr_b16 a[48:49], v18 offset:8192
  ds_read_b64_tr_b16 a[50:51], v18 offset:10240
  v_mfma_f32_16x16x32_bf16 v[140:143], a[76:79], a[28:31], v[140:143]
  buffer_load_dwordx4 v2, s[20:23], s29 offen offset:0 sc1 lds
  v_mfma_f32_16x16x32_bf16 v[48:51], a[80:83], a[16:19], v[48:51]
  ds_read_b64_tr_b16 a[52:53], v19 offset:8192
  ds_read_b64_tr_b16 a[54:55], v19 offset:10240
  v_mfma_f32_16x16x32_bf16 v[80:83], a[80:83], a[20:23], v[80:83]
  ds_read_b64_tr_b16 a[56:57], v20 offset:8192
  v_mfma_f32_16x16x32_bf16 v[112:115], a[80:83], a[24:27], v[112:115]
  ds_read_b64_tr_b16 a[58:59], v20 offset:10240
  v_mfma_f32_16x16x32_bf16 v[144:147], a[80:83], a[28:31], v[144:147]
  buffer_load_dwordx4 v2, s[20:23], s29 offen offset:1024 sc1 lds
  v_mfma_f32_16x16x32_bf16 v[52:55], a[84:87], a[16:19], v[52:55]
  ds_read_b64_tr_b16 a[60:61], v21 offset:8192
  ds_read_b64_tr_b16 a[62:63], v21 offset:10240
  v_mfma_f32_16x16x32_bf16 v[84:87], a[84:87], a[20:23], v[84:87]
  v_mfma_f32_16x16x32_bf16 v[116:119], a[84:87], a[24:27], v[116:119]
  v_mfma_f32_16x16x32_bf16 v[148:151], a[84:87], a[28:31], v[148:151]
  buffer_load_dwordx4 v2, s[20:23], s29 offen offset:2048 sc1 lds
  v_mfma_f32_16x16x32_bf16 v[56:59], a[88:91], a[16:19], v[56:59]
  v_mfma_f32_16x16x32_bf16 v[88:91], a[88:91], a[20:23], v[88:91]
  v_mfma_f32_16x16x32_bf16 v[120:123], a[88:91], a[24:27], v[120:123]
  v_mfma_f32_16x16x32_bf16 v[152:155], a[88:91], a[28:31], v[152:155]
  buffer_load_dwordx4 v2, s[20:23], s29 offen offset:3072 sc1 lds
  v_mfma_f32_16x16x32_bf16 v[60:63], a[92:95], a[16:19], v[60:63]
  s_xor_b32 s27, s27, 0x4000
  v_mfma_f32_16x16x32_bf16 v[92:95], a[92:95], a[20:23], v[92:95]
  s_add_u32 s29, s29, 0x8000
  v_mfma_f32_16x16x32_bf16 v[124:127], a[92:95], a[24:27], v[124:127]
  v_mfma_f32_16x16x32_bf16 v[156:159], a[92:95], a[28:31], v[156:159]
  s_waitcnt lgkmcnt(0)
  v_mfma_f32_16x16x32_bf16 v[32:35], a[32:35], a[0:3], v[32:35]
  ds_read_b128 a[16:19], v17 offset:0
  ds_read_b64_tr_b16 a[64:65], v18 offset:4096
  v_mfma_f32_16x16x32_bf16 v[36:39], a[36:39], a[0:3], v[36:39]
  ds_read_b64_tr_b16 a[66:67], v18 offset:6144
  ds_read_b128 a[20:23], v17 offset:2048
  v_mfma_f32_16x16x32_bf16 v[40:43], a[40:43], a[0:3], v[40:43]
  ds_read_b128 a[24:27], v17 offset:4096
  ds_read_b128 a[28:31], v17 offset:6144
  v_mfma_f32_16x16x32_bf16 v[44:47], a[44:47], a[0:3], v[44:47]
  ds_read_b64_tr_b16 a[68:69], v19 offset:4096
  ds_read_b64_tr_b16 a[70:71], v19 offset:6144
  v_mfma_f32_16x16x32_bf16 v[48:51], a[48:51], a[0:3], v[48:51]
  ds_read_b64_tr_b16 a[72:73], v20 offset:4096
  ds_read_b64_tr_b16 a[74:75], v20 offset:6144
  v_mfma_f32_16x16x32_bf16 v[52:55], a[52:55], a[0:3], v[52:55]
  ds_read_b64_tr_b16 a[76:77], v21 offset:4096
  v_mfma_f32_16x16x32_bf16 v[56:59], a[56:59], a[0:3], v[56:59]
  ds_read_b64_tr_b16 a[78:79], v21 offset:6144
  ds_read_b64_tr_b16 a[80:81], v18 offset:12288
  v_mfma_f32_16x16x32_bf16 v[60:63], a[60:63], a[0:3], v[60:63]
  ds_read_b64_tr_b16 a[82:83], v18 offset:14336
  ds_read_b64_tr_b16 a[84:85], v19 offset:12288
  v_mfma_f32_16x16x32_bf16 v[64:67], a[32:35], a[4:7], v[64:67]
  ds_read_b64_tr_b16 a[86:87], v19 offset:14336
  ds_read_b64_tr_b16 a[88:89], v20 offset:12288
  v_mfma_f32_16x16x32_bf16 v[68:71], a[36:39], a[4:7], v[68:71]
  ds_read_b64_tr_b16 a[90:91], v20 offset:14336
  ds_read_b64_tr_b16 a[92:93], v21 offset:12288
  v_mfma_f32_16x16x32_bf16 v[72:75], a[40:43], a[4:7], v[72:75]
  ds_read_b64_tr_b16 a[94:95], v21 offset:14336
  v_mfma_f32_16x16x32_bf16 v[76:79], a[44:47], a[4:7], v[76:79]
  v_mfma_f32_16x16x32_bf16 v[80:83], a[48:51], a[4:7], v[80:83]
  v_mfma_f32_16x16x32_bf16 v[84:87], a[52:55], a[4:7], v[84:87]
  v_mfma_f32_16x16x32_bf16 v[88:91], a[56:59], a[4:7], v[88:91]
  v_mfma_f32_16x16x32_bf16 v[92:95], a[60:63], a[4:7], v[92:95]
  s_waitcnt lgkmcnt(0)
  v_mfma_f32_16x16x32_bf16 v[32:35], a[64:67], a[16:19], v[32:35]
  v_mfma_f32_16x16x32_bf16 v[36:39], a[68:71], a[16:19], v[36:39]
  v_mfma_f32_16x16x32_bf16 v[40:43], a[72:75], a[16:19], v[40:43]
  v_mfma_f32_16x16x32_bf16 v[44:47], a[76:79], a[16:19], v[44:47]
  v_mfma_f32_16x16x32_bf16 v[48:51], a[80:83], a[16:19], v[48:51]
  v_mfma_f32_16x16x32_bf16 v[52:55], a[84:87], a[16:19], v[52:55]
  s_nop 2
  v_pk_mul_f32 v[32:33], v[32:33], s[6:7]
  v_pk_mul_f32 v[34:35], v[34:35], s[6:7]
  v_mfma_f32_16x16x32_bf16 v[56:59], a[88:91], a[16:19], v[56:59]
  v_pk_mul_f32 v[36:37], v[36:37], s[6:7]
  v_pk_mul_f32 v[38:39], v[38:39], s[6:7]
  v_mfma_f32_16x16x32_bf16 v[60:63], a[92:95], a[16:19], v[60:63]
  v_cvt_pk_bf16_f32 v32, v32, v33
  v_cvt_pk_bf16_f32 v33, v34, v35
  v_mfma_f32_16x16x32_bf16 v[64:67], a[64:67], a[20:23], v[64:67]
  v_cvt_pk_bf16_f32 v34, v36, v37
  v_cvt_pk_bf16_f32 v35, v38, v39
  v_mfma_f32_16x16x32_bf16 v[68:71], a[68:71], a[20:23], v[68:71]
  v_accvgpr_write_b32 a128, v32
  v_accvgpr_write_b32 a129, v33
  v_mfma_f32_16x16x32_bf16 v[72:75], a[72:75], a[20:23], v[72:75]
  v_accvgpr_write_b32 a130, v34
  v_accvgpr_write_b32 a131, v35
  v_mfma_f32_16x16x32_bf16 v[76:79], a[76:79], a[20:23], v[76:79]
  v_pk_mul_f32 v[40:41], v[40:41], s[6:7]
  v_pk_mul_f32 v[42:43], v[42:43], s[6:7]
  v_mfma_f32_16x16x32_bf16 v[80:83], a[80:83], a[20:23], v[80:83]
  v_pk_mul_f32 v[44:45], v[44:45], s[6:7]
  v_pk_mul_f32 v[46:47], v[46:47], s[6:7]
  v_mfma_f32_16x16x32_bf16 v[84:87], a[84:87], a[20:23], v[84:87]
  v_cvt_pk_bf16_f32 v40, v40, v41
  v_cvt_pk_bf16_f32 v41, v42, v43
  v_mfma_f32_16x16x32_bf16 v[88:91], a[88:91], a[20:23], v[88:91]
  v_cvt_pk_bf16_f32 v42, v44, v45
  v_cvt_pk_bf16_f32 v43, v46, v47
  v_mfma_f32_16x16x32_bf16 v[92:95], a[92:95], a[20:23], v[92:95]
  v_accvgpr_write_b32 a132, v40
  v_accvgpr_write_b32 a133, v41
  v_mfma_f32_16x16x32_bf16 v[96:99], a[32:35], a[8:11], v[96:99]
  v_accvgpr_write_b32 a134, v42
  v_accvgpr_write_b32 a135, v43
  v_mfma_f32_16x16x32_bf16 v[100:103], a[36:39], a[8:11], v[100:103]
  v_mfma_f32_32x32x16_bf16 v[160:175], a[236:239], a[236:239], 0
  v_pk_mul_f32 v[48:49], v[48:49], s[6:7]
  v_mfma_f32_16x16x32_bf16 v[96:99], a[64:67], a[24:27], v[96:99]
  v_pk_mul_f32 v[50:51], v[50:51], s[6:7]
  v_pk_mul_f32 v[52:53], v[52:53], s[6:7]
  v_mfma_f32_16x16x32_bf16 v[100:103], a[68:71], a[24:27], v[100:103]
  v_pk_mul_f32 v[54:55], v[54:55], s[6:7]
  v_cvt_pk_bf16_f32 v48, v48, v49
  v_mfma_f32_16x16x32_bf16 v[104:107], a[40:43], a[8:11], v[104:107]
  v_cvt_pk_bf16_f32 v49, v50, v51
  v_cvt_pk_bf16_f32 v50, v52, v53
  v_mfma_f32_16x16x32_bf16 v[108:111], a[44:47], a[8:11], v[108:111]
  v_cvt_pk_bf16_f32 v51, v54, v55
  v_accvgpr_write_b32 a136, v48
  v_mfma_f32_16x16x32_bf16 v[104:107], a[72:75], a[24:27], v[104:107]
  v_accvgpr_write_b32 a137, v49
  v_accvgpr_write_b32 a138, v50
  v_mfma_f32_16x16x32_bf16 v[108:111], a[76:79], a[24:27], v[108:111]
  v_accvgpr_write_b32 a139, v51
  v_pk_mul_f32 v[56:57], v[56:57], s[6:7]
  v_mfma_f32_16x16x32_bf16 v[112:115], a[48:51], a[8:11], v[112:115]
  v_pk_mul_f32 v[58:59], v[58:59], s[6:7]
  v_pk_mul_f32 v[60:61], v[60:61], s[6:7]
  v_mfma_f32_16x16x32_bf16 v[116:119], a[52:55], a[8:11], v[116:119]
  v_pk_mul_f32 v[62:63], v[62:63], s[6:7]
  v_cvt_pk_bf16_f32 v56, v56, v57
  v_mfma_f32_16x16x32_bf16 v[112:115], a[80:83], a[24:27], v[112:115]
  v_cvt_pk_bf16_f32 v57, v58, v59
  v_cvt_pk_bf16_f32 v58, v60, v61
  v_mfma_f32_16x16x32_bf16 v[116:119], a[84:87], a[24:27], v[116:119]
  v_cvt_pk_bf16_f32 v59, v62, v63
  v_accvgpr_write_b32 a140, v56
  v_mfma_f32_16x16x32_bf16 v[120:123], a[56:59], a[8:11], v[120:123]
  v_accvgpr_write_b32 a141, v57
  v_accvgpr_write_b32 a142, v58
  v_mfma_f32_16x16x32_bf16 v[124:127], a[60:63], a[8:11], v[124:127]
  v_accvgpr_write_b32 a143, v59
  v_mfma_f32_32x32x16_bf16 v[176:191], a[236:239], a[236:239], 0
  v_mfma_f32_16x16x32_bf16 v[120:123], a[88:91], a[24:27], v[120:123]
  v_pk_mul_f32 v[64:65], v[64:65], s[6:7]
  v_pk_mul_f32 v[66:67], v[66:67], s[6:7]
  v_mfma_f32_16x16x32_bf16 v[124:127], a[92:95], a[24:27], v[124:127]
  v_pk_mul_f32 v[68:69], v[68:69], s[6:7]
  v_pk_mul_f32 v[70:71], v[70:71], s[6:7]
  v_mfma_f32_16x16x32_bf16 v[128:131], a[32:35], a[12:15], v[128:131]
  v_cvt_pk_bf16_f32 v64, v64, v65
  v_cvt_pk_bf16_f32 v65, v66, v67
  v_mfma_f32_16x16x32_bf16 v[132:135], a[36:39], a[12:15], v[132:135]
  v_cvt_pk_bf16_f32 v66, v68, v69
  v_cvt_pk_bf16_f32 v67, v70, v71
  v_mfma_f32_16x16x32_bf16 v[128:131], a[64:67], a[28:31], v[128:131]
  v_accvgpr_write_b32 a144, v64
  v_accvgpr_write_b32 a145, v65
  v_mfma_f32_16x16x32_bf16 v[132:135], a[68:71], a[28:31], v[132:135]
  v_accvgpr_write_b32 a146, v66
  v_accvgpr_write_b32 a147, v67
  v_mfma_f32_16x16x32_bf16 v[136:139], a[40:43], a[12:15], v[136:139]
  v_pk_mul_f32 v[72:73], v[72:73], s[6:7]
  v_pk_mul_f32 v[74:75], v[74:75], s[6:7]
  v_mfma_f32_16x16x32_bf16 v[140:143], a[44:47], a[12:15], v[140:143]
  v_pk_mul_f32 v[76:77], v[76:77], s[6:7]
  v_pk_mul_f32 v[78:79], v[78:79], s[6:7]
  v_mfma_f32_16x16x32_bf16 v[136:139], a[72:75], a[28:31], v[136:139]
  v_cvt_pk_bf16_f32 v72, v72, v73
  v_cvt_pk_bf16_f32 v73, v74, v75
  v_mfma_f32_16x16x32_bf16 v[140:143], a[76:79], a[28:31], v[140:143]
  v_cvt_pk_bf16_f32 v74, v76, v77
  v_cvt_pk_bf16_f32 v75, v78, v79
  v_mfma_f32_16x16x32_bf16 v[144:147], a[48:51], a[12:15], v[144:147]
  v_accvgpr_write_b32 a148, v72
  v_accvgpr_write_b32 a149, v73
  v_mfma_f32_16x16x32_bf16 v[148:151], a[52:55], a[12:15], v[148:151]
  v_accvgpr_write_b32 a150, v74
  v_accvgpr_write_b32 a151, v75
  v_mfma_f32_16x16x32_bf16 v[144:147], a[80:83], a[28:31], v[144:147]
  v_mfma_f32_32x32x16_bf16 v[192:207], a[236:239], a[236:239], 0
  v_pk_mul_f32 v[80:81], v[80:81], s[6:7]
  v_mfma_f32_16x16x32_bf16 v[148:151], a[84:87], a[28:31], v[148:151]
  v_pk_mul_f32 v[82:83], v[82:83], s[6:7]
  v_pk_mul_f32 v[84:85], v[84:85], s[6:7]
  v_mfma_f32_16x16x32_bf16 v[152:155], a[56:59], a[12:15], v[152:155]
  v_pk_mul_f32 v[86:87], v[86:87], s[6:7]
  v_cvt_pk_bf16_f32 v80, v80, v81
  v_mfma_f32_16x16x32_bf16 v[156:159], a[60:63], a[12:15], v[156:159]
  v_cvt_pk_bf16_f32 v81, v82, v83
  v_cvt_pk_bf16_f32 v82, v84, v85
  v_mfma_f32_16x16x32_bf16 v[152:155], a[88:91], a[28:31], v[152:155]
  v_cvt_pk_bf16_f32 v83, v86, v87
  v_accvgpr_write_b32 a152, v80
  v_mfma_f32_16x16x32_bf16 v[156:159], a[92:95], a[28:31], v[156:159]
  v_accvgpr_write_b32 a153, v81
  v_accvgpr_write_b32 a154, v82
  v_accvgpr_write_b32 a155, v83
  v_pk_mul_f32 v[88:89], v[88:89], s[6:7]
  v_pk_mul_f32 v[90:91], v[90:91], s[6:7]
  v_pk_mul_f32 v[92:93], v[92:93], s[6:7]
  v_pk_mul_f32 v[94:95], v[94:95], s[6:7]
  v_cvt_pk_bf16_f32 v88, v88, v89
  v_cvt_pk_bf16_f32 v89, v90, v91
  v_cvt_pk_bf16_f32 v90, v92, v93
  v_cvt_pk_bf16_f32 v91, v94, v95
  v_accvgpr_write_b32 a156, v88
  v_accvgpr_write_b32 a157, v89
  v_accvgpr_write_b32 a158, v90
  v_accvgpr_write_b32 a159, v91
  v_mfma_f32_32x32x16_bf16 v[208:223], a[236:239], a[236:239], 0
  v_pk_mul_f32 v[96:97], v[96:97], s[6:7]
  v_pk_mul_f32 v[98:99], v[98:99], s[6:7]
  v_pk_mul_f32 v[100:101], v[100:101], s[6:7]
  v_pk_mul_f32 v[102:103], v[102:103], s[6:7]
  v_cvt_pk_bf16_f32 v96, v96, v97
  v_cvt_pk_bf16_f32 v97, v98, v99
  v_cvt_pk_bf16_f32 v98, v100, v101
  v_cvt_pk_bf16_f32 v99, v102, v103
  v_accvgpr_write_b32 a160, v96
  v_accvgpr_write_b32 a161, v97
  v_accvgpr_write_b32 a162, v98
  v_accvgpr_write_b32 a163, v99
  v_pk_mul_f32 v[104:105], v[104:105], s[6:7]
  v_pk_mul_f32 v[106:107], v[106:107], s[6:7]
  v_pk_mul_f32 v[108:109], v[108:109], s[6:7]
  v_pk_mul_f32 v[110:111], v[110:111], s[6:7]
  v_cvt_pk_bf16_f32 v104, v104, v105
  v_cvt_pk_bf16_f32 v105, v106, v107
  v_cvt_pk_bf16_f32 v106, v108, v109
  v_cvt_pk_bf16_f32 v107, v110, v111
  v_accvgpr_write_b32 a164, v104
  v_accvgpr_write_b32 a165, v105
  v_accvgpr_write_b32 a166, v106
  v_accvgpr_write_b32 a167, v107
  v_mfma_f32_32x32x16_bf16 v[224:239], a[236:239], a[236:239], 0
  v_pk_mul_f32 v[112:113], v[112:113], s[6:7]
  v_pk_mul_f32 v[114:115], v[114:115], s[6:7]
  v_pk_mul_f32 v[116:117], v[116:117], s[6:7]
  v_pk_mul_f32 v[118:119], v[118:119], s[6:7]
  v_cvt_pk_bf16_f32 v112, v112, v113
  v_cvt_pk_bf16_f32 v113, v114, v115
  v_cvt_pk_bf16_f32 v114, v116, v117
  v_cvt_pk_bf16_f32 v115, v118, v119
  v_accvgpr_write_b32 a168, v112
  v_accvgpr_write_b32 a169, v113
  v_accvgpr_write_b32 a170, v114
  v_accvgpr_write_b32 a171, v115
  v_pk_mul_f32 v[120:121], v[120:121], s[6:7]
  v_pk_mul_f32 v[122:123], v[122:123], s[6:7]
  v_pk_mul_f32 v[124:125], v[124:125], s[6:7]
  v_pk_mul_f32 v[126:127], v[126:127], s[6:7]
  v_cvt_pk_bf16_f32 v120, v120, v121
  v_cvt_pk_bf16_f32 v121, v122, v123
  v_cvt_pk_bf16_f32 v122, v124, v125
  v_cvt_pk_bf16_f32 v123, v126, v127
  v_accvgpr_write_b32 a172, v120
  v_accvgpr_write_b32 a173, v121
  v_accvgpr_write_b32 a174, v122
  v_accvgpr_write_b32 a175, v123
  v_mfma_f32_32x32x16_bf16 v[240:255], a[236:239], a[236:239], 0
  v_pk_mul_f32 v[128:129], v[128:129], s[6:7]
  v_pk_mul_f32 v[130:131], v[130:131], s[6:7]
  v_pk_mul_f32 v[132:133], v[132:133], s[6:7]
  v_pk_mul_f32 v[134:135], v[134:135], s[6:7]
  v_cvt_pk_bf16_f32 v128, v128, v129
  v_cvt_pk_bf16_f32 v129, v130, v131
  v_cvt_pk_bf16_f32 v130, v132, v133
  v_cvt_pk_bf16_f32 v131, v134, v135
  v_accvgpr_write_b32 a176, v128
  v_accvgpr_write_b32 a177, v129
  v_accvgpr_write_b32 a178, v130
  v_accvgpr_write_b32 a179, v131
  v_pk_mul_f32 v[136:137], v[136:137], s[6:7]
  v_pk_mul_f32 v[138:139], v[138:139], s[6:7]
  v_pk_mul_f32 v[140:141], v[140:141], s[6:7]
  v_pk_mul_f32 v[142:143], v[142:143], s[6:7]
  v_cvt_pk_bf16_f32 v136, v136, v137
  v_cvt_pk_bf16_f32 v137, v138, v139
  v_cvt_pk_bf16_f32 v138, v140, v141
  v_cvt_pk_bf16_f32 v139, v142, v143
  v_accvgpr_write_b32 a180, v136
  v_accvgpr_write_b32 a181, v137
  v_accvgpr_write_b32 a182, v138
  v_accvgpr_write_b32 a183, v139
  v_mfma_f32_32x32x16_bf16 v[128:143], a[236:239], a[236:239], 0
  v_pk_mul_f32 v[144:145], v[144:145], s[6:7]
  v_pk_mul_f32 v[146:147], v[146:147], s[6:7]
  v_pk_mul_f32 v[148:149], v[148:149], s[6:7]
  v_pk_mul_f32 v[150:151], v[150:151], s[6:7]
  v_cvt_pk_bf16_f32 v144, v144, v145
  v_cvt_pk_bf16_f32 v145, v146, v147
  v_cvt_pk_bf16_f32 v146, v148, v149
  v_cvt_pk_bf16_f32 v147, v150, v151
  v_accvgpr_write_b32 a184, v144
  v_accvgpr_write_b32 a185, v145
  v_accvgpr_write_b32 a186, v146
  v_accvgpr_write_b32 a187, v147
  v_pk_mul_f32 v[152:153], v[152:153], s[6:7]
  v_pk_mul_f32 v[154:155], v[154:155], s[6:7]
  v_pk_mul_f32 v[156:157], v[156:157], s[6:7]
  v_pk_mul_f32 v[158:159], v[158:159], s[6:7]
  v_cvt_pk_bf16_f32 v152, v152, v153
  v_cvt_pk_bf16_f32 v153, v154, v155
  v_cvt_pk_bf16_f32 v154, v156, v157
  v_cvt_pk_bf16_f32 v155, v158, v159
  v_accvgpr_write_b32 a188, v152
  v_accvgpr_write_b32 a189, v153
  v_accvgpr_write_b32 a190, v154
  v_accvgpr_write_b32 a191, v155
  v_mfma_f32_32x32x16_bf16 v[144:159], a[236:239], a[236:239], 0
  v_add_u32 v3, 0xc000, v2
  v_add_u32 v4, 0x10000, v2
  v_mov_b32 v5, 0xf149f2ca
  s_mov_b32 s89, 0
  v_mfma_f32_32x32x16_bf16 a[192:207], a[236:239], a[236:239], 0
  s_lshl_b32 s90, s78, 1
  s_add_u32 s90, s90, s77
  s_lshl_b32 s90, s90, 2
  s_add_u32 s90, s90, s3
  s_lshl_b32 s90, s90, 14
  s_add_u32 s64, s86, 100663296
  s_addc_u32 s65, s87, 0
  s_add_u32 s64, s64, s90
  s_addc_u32 s65, s65, 0
  s_mov_b32 s66, 16384
  s_mov_b32 s67, 0x00020000
  s_mov_b32 s90, 0
  s_waitcnt vmcnt(8)
  s_barrier
  ds_read_b128 a[32:35], v3 offset:0
  ds_read_b128 a[36:39], v3 offset:1024
  ds_read_b128 a[40:43], v3 offset:2048
  ds_read_b128 a[44:47], v3 offset:3072
  ds_read_b128 a[48:51], v3 offset:4096
  ds_read_b128 a[52:55], v3 offset:5120
  ds_read_b128 a[56:59], v3 offset:6144
  ds_read_b128 a[60:63], v3 offset:7168
  s_waitcnt lgkmcnt(6)
  v_mfma_f32_16x16x32_bf16 v[64:67], a[32:35], a[128:131], 0
  s_lshl_b32 s4, s2, 2
  s_add_u32 s4, s4, s3
  s_lshl_b32 s6, s4, 13
  v_mfma_f32_16x16x32_bf16 v[72:75], a[32:35], a[144:147], 0
  s_lshl_b32 s7, s4, 11
  s_mov_b32 s8, s74
  s_mov_b32 s9, s75
  v_mfma_f32_16x16x32_bf16 v[80:83], a[32:35], a[160:163], 0
  s_mov_b32 s10, 8388608
  s_mov_b32 s11, 0x00020000
  s_mov_b32 s12, s80
  v_mfma_f32_16x16x32_bf16 v[88:91], a[32:35], a[176:179], 0
  s_mov_b32 s13, s81
  s_mov_b32 s14, 2097152
  ds_read_b128 a[0:3], v3 offset:8192
  v_mfma_f32_16x16x32_bf16 v[64:67], a[36:39], a[132:135], v[64:67]
  s_mov_b32 s15, 0x00020000
  s_add_u32 s16, s86, 67108864
  s_addc_u32 s17, s87, 0
  v_mfma_f32_16x16x32_bf16 v[72:75], a[36:39], a[148:151], v[72:75]
  s_mov_b32 s18, 16777216
  s_mov_b32 s19, 0x00020000
  v_mfma_f32_16x16x32_bf16 v[80:83], a[36:39], a[164:167], v[80:83]
  v_and_b32 v6, 15, v1
  v_lshrrev_b32 v7, 4, v1
  v_mfma_f32_16x16x32_bf16 v[88:91], a[36:39], a[180:183], v[88:91]
  s_waitcnt lgkmcnt(5)
  ds_read_b128 a[4:7], v3 offset:9216
  v_sub_u32 v6, v6, v7
  v_mfma_f32_16x16x32_bf16 v[64:67], a[40:43], a[136:139], v[64:67]
  v_lshlrev_b32 v6, 2, v6
  v_add_u32 v6, s3, v6
  v_mfma_f32_16x16x32_bf16 v[72:75], a[40:43], a[152:155], v[72:75]
  v_cmp_gt_i32 s[32:33], 0, v6
  v_cmp_gt_i32 s[34:35], 1, v6
  v_mfma_f32_16x16x32_bf16 v[80:83], a[40:43], a[168:171], v[80:83]
  v_cmp_gt_i32 s[36:37], 2, v6
  v_cmp_gt_i32 s[38:39], 3, v6
  v_mfma_f32_16x16x32_bf16 v[88:91], a[40:43], a[184:187], v[88:91]
  ds_read_b128 a[8:11], v3 offset:10240
  v_cmp_gt_i32 s[40:41], 16, v6
  v_mfma_f32_16x16x32_bf16 v[64:67], a[44:47], a[140:143], v[64:67]
  v_cmp_gt_i32 s[42:43], 17, v6
  v_cmp_gt_i32 s[44:45], 18, v6
  v_mfma_f32_16x16x32_bf16 v[72:75], a[44:47], a[156:159], v[72:75]
  v_cmp_gt_i32 s[46:47], 19, v6
  v_cmp_gt_i32 s[48:49], 32, v6
  v_mfma_f32_16x16x32_bf16 v[80:83], a[44:47], a[172:175], v[80:83]
  v_cmp_gt_i32 s[50:51], 33, v6
  v_cmp_gt_i32 s[52:53], 34, v6
  v_mfma_f32_16x16x32_bf16 v[88:91], a[44:47], a[188:191], v[88:91]
  s_waitcnt lgkmcnt(5)
  ds_read_b128 a[12:15], v3 offset:11264
  v_cmp_gt_i32 s[54:55], 35, v6
  v_mfma_f32_16x16x32_bf16 v[68:71], a[48:51], a[128:131], 0
  v_cmp_gt_i32 s[56:57], 48, v6
  v_cmp_gt_i32 s[58:59], 49, v6
  v_mfma_f32_16x16x32_bf16 v[76:79], a[48:51], a[144:147], 0
  s_mov_b32 s30, 0x8000
  v_cmp_gt_i32 s[60:61], 50, v6
  v_cmp_gt_i32 s[62:63], 51, v6
  v_mfma_f32_16x16x32_bf16 v[84:87], a[48:51], a[160:163], 0
  s_mov_b32 s31, 0x4000
  v_mfma_f32_16x16x32_bf16 v[92:95], a[48:51], a[176:179], 0
  ds_read_b128 a[16:19], v3 offset:12288
  v_mfma_f32_16x16x32_bf16 v[68:71], a[52:55], a[132:135], v[68:71]
  v_mfma_f32_16x16x32_bf16 v[76:79], a[52:55], a[148:151], v[76:79]
  v_mfma_f32_16x16x32_bf16 v[84:87], a[52:55], a[164:167], v[84:87]
  v_mfma_f32_16x16x32_bf16 v[92:95], a[52:55], a[180:183], v[92:95]
  s_waitcnt lgkmcnt(5)
  ds_read_b128 a[20:23], v3 offset:13312
  v_mfma_f32_16x16x32_bf16 v[68:71], a[56:59], a[136:139], v[68:71]
  v_mfma_f32_16x16x32_bf16 v[76:79], a[56:59], a[152:155], v[76:79]
  v_mfma_f32_16x16x32_bf16 v[84:87], a[56:59], a[168:171], v[84:87]
  v_mfma_f32_16x16x32_bf16 v[92:95], a[56:59], a[184:187], v[92:95]
  ds_read_b128 a[24:27], v3 offset:14336
  v_mfma_f32_16x16x32_bf16 v[68:71], a[60:63], a[140:143], v[68:71]
  v_mfma_f32_16x16x32_bf16 v[76:79], a[60:63], a[156:159], v[76:79]
  v_mfma_f32_16x16x32_bf16 v[84:87], a[60:63], a[172:175], v[84:87]
  v_mfma_f32_16x16x32_bf16 v[92:95], a[60:63], a[188:191], v[92:95]
  ds_read_b128 a[28:31], v3 offset:15360
  s_cmp_lg_u32 s25, 0
  s_nop 0
  s_cbranch_scc1 La_nomask0
  v_cndmask_b32 v64, v64, v5, s[32:33]
  v_cndmask_b32 v65, v65, v5, s[34:35]
  v_cndmask_b32 v66, v66, v5, s[36:37]
  v_cndmask_b32 v67, v67, v5, s[38:39]
  v_cndmask_b32 v68, v68, v5, s[40:41]
  v_cndmask_b32 v69, v69, v5, s[42:43]
  v_cndmask_b32 v70, v70, v5, s[44:45]
  v_cndmask_b32 v71, v71, v5, s[46:47]
La_nomask0:
  v_max3_f32 v6, v64, v65, v66
  v_max3_f32 v7, v67, v68, v69
  v_max3_f32 v6, v6, v70, v71
  v_max_f32 v6, v6, v7
  v_max3_f32 v8, v72, v73, v74
  v_max3_f32 v9, v75, v76, v77
  v_max3_f32 v8, v8, v78, v79
  v_max_f32 v8, v8, v9
  v_max3_f32 v10, v80, v81, v82
  v_max3_f32 v11, v83, v84, v85
  v_max3_f32 v10, v10, v86, v87
  v_max_f32 v10, v10, v11
  v_max3_f32 v12, v88, v89, v90
  v_max3_f32 v13, v91, v92, v93
  v_max3_f32 v12, v12, v94, v95
  v_max_f32 v12, v12, v13
  v_mov_b32 v7, v6
  v_mov_b32 v9, v8
  v_mov_b32 v11, v10
  v_mov_b32 v13, v12
  v_permlane32_swap_b32 v6, v7
  v_permlane32_swap_b32 v8, v9
  v_permlane32_swap_b32 v10, v11
  v_permlane32_swap_b32 v12, v13
  v_max_f32 v6, v6, v7
  v_max_f32 v8, v8, v9
  v_max_f32 v10, v10, v11
  v_max_f32 v12, v12, v13
  v_mov_b32 v7, v6
  v_mov_b32 v9, v8
  v_mov_b32 v11, v10
  v_mov_b32 v13, v12
  v_permlane16_swap_b32 v6, v7
  v_permlane16_swap_b32 v8, v9
  v_permlane16_swap_b32 v10, v11
  v_permlane16_swap_b32 v12, v13
  v_max_f32 v6, v6, v7
  v_max_f32 v8, v8, v9
  v_max_f32 v10, v10, v11
  v_max_f32 v12, v12, v13
  v_sub_f32 v16, 0, v6
  v_sub_f32 v17, 0, v6
  v_sub_f32 v18, 0, v6
  v_sub_f32 v19, 0, v6
  v_sub_f32 v20, 0, v8
  v_sub_f32 v21, 0, v8
  v_sub_f32 v22, 0, v8
  v_sub_f32 v23, 0, v8
  v_sub_f32 v24, 0, v10
  v_sub_f32 v25, 0, v10
  v_sub_f32 v26, 0, v10
  v_sub_f32 v27, 0, v10
  v_sub_f32 v28, 0, v12
  v_sub_f32 v29, 0, v12
  v_sub_f32 v30, 0, v12
  v_sub_f32 v31, 0, v12
  v_pk_add_f32 v[64:65], v[64:65], v[16:17]
  v_pk_add_f32 v[66:67], v[66:67], v[16:17]
  v_pk_add_f32 v[68:69], v[68:69], v[16:17]
  v_pk_add_f32 v[70:71], v[70:71], v[16:17]
  v_pk_add_f32 v[72:73], v[72:73], v[20:21]
  v_pk_add_f32 v[74:75], v[74:75], v[20:21]
  v_pk_add_f32 v[76:77], v[76:77], v[20:21]
  v_pk_add_f32 v[78:79], v[78:79], v[20:21]
  v_pk_add_f32 v[80:81], v[80:81], v[24:25]
  v_pk_add_f32 v[82:83], v[82:83], v[24:25]
  v_pk_add_f32 v[84:85], v[84:85], v[24:25]
  v_pk_add_f32 v[86:87], v[86:87], v[24:25]
  v_pk_add_f32 v[88:89], v[88:89], v[28:29]
  v_pk_add_f32 v[90:91], v[90:91], v[28:29]
  v_pk_add_f32 v[92:93], v[92:93], v[28:29]
  v_pk_add_f32 v[94:95], v[94:95], v[28:29]
  s_lshl_b32 s88, s25, 1
  s_waitcnt vmcnt(0)
  s_barrier
  s_waitcnt lgkmcnt(4)
  v_mfma_f32_16x16x32_bf16 v[96:99], a[0:3], a[128:131], v[16:19]
  s_mov_b32 m0, s26
  v_exp_f32 v64, v64
  v_mfma_f32_16x16x32_bf16 v[96:99], a[4:7], a[132:135], v[96:99]
  buffer_load_dwordx4 v2, s[20:23], s28 offen offset:0 sc1 lds
  v_exp_f32 v65, v65
  v_mfma_f32_16x16x32_bf16 v[96:99], a[8:11], a[136:139], v[96:99]
  buffer_load_dwordx4 v2, s[20:23], s28 offen offset:1024 sc1 lds
  v_exp_f32 v66, v66
  v_mfma_f32_16x16x32_bf16 v[96:99], a[12:15], a[140:143], v[96:99]
  buffer_load_dwordx4 v2, s[20:23], s28 offen offset:2048 sc1 lds
  v_exp_f32 v67, v67
  v_mfma_f32_16x16x32_bf16 v[104:107], a[0:3], a[144:147], v[20:23]
  v_exp_f32 v68, v68
  v_cvt_pk_bf16_f32 v32, v64, v65
  v_mfma_f32_16x16x32_bf16 v[104:107], a[4:7], a[148:151], v[104:107]
  buffer_load_dwordx4 v2, s[20:23], s28 offen offset:3072 sc1 lds
  v_exp_f32 v69, v69
  v_mfma_f32_16x16x32_bf16 v[104:107], a[8:11], a[152:155], v[104:107]
  s_xor_b32 s26, s26, 0x4000
  v_exp_f32 v70, v70
  v_cvt_pk_bf16_f32 v33, v66, v67
  v_mfma_f32_16x16x32_bf16 v[104:107], a[12:15], a[156:159], v[104:107]
  s_add_u32 s28, s28, 0x8000
  v_exp_f32 v71, v71
  v_cvt_pk_bf16_f32 v34, v68, v69
  v_mfma_f32_16x16x32_bf16 v[112:115], a[0:3], a[160:163], v[24:27]
  s_mov_b32 m0, s27
  v_exp_f32 v72, v72
  v_cvt_pk_bf16_f32 v35, v70, v71
  v_mfma_f32_16x16x32_bf16 v[112:115], a[4:7], a[164:167], v[112:115]
  buffer_load_dwordx4 v2, s[20:23], s29 offen offset:0 sc1 lds
  v_exp_f32 v73, v73
  v_mfma_f32_16x16x32_bf16 v[112:115], a[8:11], a[168:171], v[112:115]
  buffer_load_dwordx4 v2, s[20:23], s29 offen offset:1024 sc1 lds
  v_exp_f32 v74, v74
  v_mfma_f32_16x16x32_bf16 v[112:115], a[12:15], a[172:175], v[112:115]
  buffer_load_dwordx4 v2, s[20:23], s29 offen offset:2048 sc1 lds
  v_exp_f32 v75, v75
  v_mfma_f32_16x16x32_bf16 v[120:123], a[0:3], a[176:179], v[28:31]
  buffer_load_dwordx4 v2, s[20:23], s29 offen offset:3072 sc1 lds
  v_exp_f32 v76, v76
  v_mfma_f32_16x16x32_bf16 v[120:123], a[4:7], a[180:183], v[120:123]
  s_xor_b32 s27, s27, 0x8000
  v_exp_f32 v77, v77
  v_cvt_pk_bf16_f32 v36, v72, v73
  v_mfma_f32_16x16x32_bf16 v[120:123], a[8:11], a[184:187], v[120:123]
  s_add_u32 s29, s29, 0x8000
  v_exp_f32 v78, v78
  v_cvt_pk_bf16_f32 v37, v74, v75
  v_mfma_f32_16x16x32_bf16 v[120:123], a[12:15], a[188:191], v[120:123]
  s_waitcnt lgkmcnt(0)
  v_exp_f32 v79, v79
  v_cvt_pk_bf16_f32 v38, v76, v77
  v_mfma_f32_16x16x32_bf16 v[100:103], a[16:19], a[128:131], v[16:19]
  s_mov_b32 m0, s26
  v_exp_f32 v80, v80
  v_cvt_pk_bf16_f32 v39, v78, v79
  v_mfma_f32_16x16x32_bf16 v[100:103], a[20:23], a[132:135], v[100:103]
  buffer_load_dwordx4 v2, s[20:23], s28 offen offset:0 sc1 lds
  v_exp_f32 v81, v81
  v_mfma_f32_16x16x32_bf16 v[100:103], a[24:27], a[136:139], v[100:103]
  buffer_load_dwordx4 v2, s[20:23], s28 offen offset:1024 sc1 lds
  v_exp_f32 v82, v82
  v_cvt_pk_bf16_f32 v40, v80, v81
  v_mfma_f32_16x16x32_bf16 v[100:103], a[28:31], a[140:143], v[100:103]
  buffer_load_dwordx4 v2, s[20:23], s28 offen offset:2048 sc1 lds
  v_exp_f32 v83, v83
  v_mfma_f32_16x16x32_bf16 v[108:111], a[16:19], a[144:147], v[20:23]
  buffer_load_dwordx4 v2, s[20:23], s28 offen offset:3072 sc1 lds
  v_exp_f32 v84, v84
  v_cvt_pk_bf16_f32 v41, v82, v83
  v_mfma_f32_16x16x32_bf16 v[108:111], a[20:23], a[148:151], v[108:111]
  s_xor_b32 s26, s26, 0x8000
  v_exp_f32 v85, v85
  v_xor_b32 v3, 0x4000, v3
  v_mfma_f32_16x16x32_bf16 v[108:111], a[24:27], a[152:155], v[108:111]
  s_add_u32 s28, s28, 0x8000
  ds_read_b128 a[32:35], v3 offset:0
  v_exp_f32 v86, v86
  v_cvt_pk_bf16_f32 v42, v84, v85
  v_mfma_f32_16x16x32_bf16 v[108:111], a[28:31], a[156:159], v[108:111]
  s_mov_b32 m0, s27
  ds_read_b128 a[36:39], v3 offset:1024
  v_exp_f32 v87, v87
  v_mfma_f32_16x16x32_bf16 v[116:119], a[16:19], a[160:163], v[24:27]
  buffer_load_dwordx4 v2, s[20:23], s29 offen offset:0 sc1 lds
  v_exp_f32 v88, v88
  v_cvt_pk_bf16_f32 v43, v86, v87
  v_mfma_f32_16x16x32_bf16 v[116:119], a[20:23], a[164:167], v[116:119]
  buffer_load_dwordx4 v2, s[20:23], s29 offen offset:1024 sc1 lds
  v_exp_f32 v89, v89
  v_mfma_f32_16x16x32_bf16 v[116:119], a[24:27], a[168:171], v[116:119]
  buffer_load_dwordx4 v2, s[20:23], s29 offen offset:2048 sc1 lds
  v_exp_f32 v90, v90
  v_cvt_pk_bf16_f32 v44, v88, v89
  v_mfma_f32_16x16x32_bf16 v[116:119], a[28:31], a[172:175], v[116:119]
  buffer_load_dwordx4 v2, s[20:23], s29 offen offset:3072 sc1 lds
  v_exp_f32 v91, v91
  v_mfma_f32_16x16x32_bf16 v[124:127], a[16:19], a[176:179], v[28:31]
  s_xor_b32 s27, s27, 0x4000
  ds_read_b128 a[40:43], v3 offset:2048
  v_exp_f32 v92, v92
  v_cvt_pk_bf16_f32 v45, v90, v91
  v_mfma_f32_16x16x32_bf16 v[124:127], a[20:23], a[180:183], v[124:127]
  s_add_u32 s29, s29, 0x8000
  ds_read_b128 a[44:47], v3 offset:3072
  v_exp_f32 v93, v93
  v_mfma_f32_16x16x32_bf16 v[124:127], a[24:27], a[184:187], v[124:127]
  ds_read_b128 a[48:51], v3 offset:4096
  v_exp_f32 v94, v94
  v_cvt_pk_bf16_f32 v46, v92, v93
  v_mfma_f32_16x16x32_bf16 v[124:127], a[28:31], a[188:191], v[124:127]
  ds_read_b128 a[52:55], v3 offset:5120
  ds_read_b128 a[56:59], v3 offset:6144
  ds_read_b128 a[60:63], v3 offset:7168
  ds_read_b128 a[0:3], v4 offset:0
  ds_read_b128 a[4:7], v4 offset:1024
  ds_read_b128 a[8:11], v4 offset:2048
  v_exp_f32 v95, v95
  s_nop 0
  v_cvt_pk_bf16_f32 v47, v94, v95
  s_cmp_eq_u32 s25, 0
  s_cbranch_scc1 La_d1
  .p2align 6
La_lo:
  s_waitcnt lgkmcnt(7)
  v_mfma_f32_16x16x32_bf16 v[64:67], a[32:35], a[128:131], v[16:19]
  v_exp_f32 v96, v96
  v_mfma_f32_16x16x32_bf16 v[64:67], a[36:39], a[132:135], v[64:67]
  buffer_store_dwordx4 a[244:247], v2, s[64:67], s90 offen offset:0 sc1
  v_mfma_f32_16x16x32_bf16 v[64:67], a[40:43], a[136:139], v[64:67]
  v_exp_f32 v97, v97
  v_mfma_f32_16x16x32_bf16 v[64:67], a[44:47], a[140:143], v[64:67]
  ds_read_b128 a[12:15], v4 offset:3072
  v_cvt_pk_bf16_f32 v48, v96, v97
  v_mfma_f32_16x16x32_bf16 v[72:75], a[32:35], a[144:147], v[20:23]
  v_exp_f32 v98, v98
  v_mfma_f32_16x16x32_bf16 v[72:75], a[36:39], a[148:151], v[72:75]
  ds_read_b128 a[16:19], v4 offset:4096
  v_mfma_f32_16x16x32_bf16 v[72:75], a[40:43], a[152:155], v[72:75]
  v_exp_f32 v99, v99
  v_mfma_f32_16x16x32_bf16 v[72:75], a[44:47], a[156:159], v[72:75]
  v_cvt_pk_bf16_f32 v49, v98, v99
  v_mfma_f32_16x16x32_bf16 v[80:83], a[32:35], a[160:163], v[24:27]
  v_exp_f32 v100, v100
  v_mfma_f32_16x16x32_bf16 v[80:83], a[36:39], a[164:167], v[80:83]
  ds_read_b128 a[20:23], v4 offset:5120
  v_mfma_f32_16x16x32_bf16 v[80:83], a[40:43], a[168:171], v[80:83]
  v_exp_f32 v101, v101
  v_mfma_f32_16x16x32_bf16 v[80:83], a[44:47], a[172:175], v[80:83]
  v_cvt_pk_bf16_f32 v50, v100, v101
  v_mfma_f32_16x16x32_bf16 v[88:91], a[32:35], a[176:179], v[28:31]
  v_exp_f32 v102, v102
  v_mfma_f32_16x16x32_bf16 v[88:91], a[36:39], a[180:183], v[88:91]
  ds_read_b128 a[24:27], v4 offset:6144
  v_mfma_f32_16x16x32_bf16 v[88:91], a[40:43], a[184:187], v[88:91]
  v_exp_f32 v103, v103
  v_mfma_f32_16x16x32_bf16 v[88:91], a[44:47], a[188:191], v[88:91]
  s_waitcnt lgkmcnt(7)
  v_cvt_pk_bf16_f32 v51, v102, v103
  v_mfma_f32_16x16x32_bf16 v[68:71], a[48:51], a[128:131], v[16:19]
  v_exp_f32 v104, v104
  v_mfma_f32_16x16x32_bf16 v[68:71], a[52:55], a[132:135], v[68:71]
  ds_read_b128 a[28:31], v4 offset:7168
  v_mfma_f32_16x16x32_bf16 v[68:71], a[56:59], a[136:139], v[68:71]
  v_exp_f32 v105, v105
  v_mfma_f32_16x16x32_bf16 v[68:71], a[60:63], a[140:143], v[68:71]
  v_cvt_pk_bf16_f32 v52, v104, v105
  v_mfma_f32_16x16x32_bf16 v[76:79], a[48:51], a[144:147], v[20:23]
  v_exp_f32 v106, v106
  v_mfma_f32_16x16x32_bf16 v[76:79], a[52:55], a[148:151], v[76:79]
  ds_read_b128 a[32:35], v3 offset:8192
  v_mfma_f32_16x16x32_bf16 v[76:79], a[56:59], a[152:155], v[76:79]
  v_exp_f32 v107, v107
  v_mfma_f32_16x16x32_bf16 v[76:79], a[60:63], a[156:159], v[76:79]
  v_cvt_pk_bf16_f32 v53, v106, v107
  v_mfma_f32_16x16x32_bf16 v[84:87], a[48:51], a[160:163], v[24:27]
  v_exp_f32 v108, v108
  v_mfma_f32_16x16x32_bf16 v[84:87], a[52:55], a[164:167], v[84:87]
  ds_read_b128 a[36:39], v3 offset:9216
  v_mfma_f32_16x16x32_bf16 v[84:87], a[56:59], a[168:171], v[84:87]
  v_exp_f32 v109, v109
  v_mfma_f32_16x16x32_bf16 v[84:87], a[60:63], a[172:175], v[84:87]
  v_cvt_pk_bf16_f32 v54, v108, v109
  v_mfma_f32_16x16x32_bf16 v[92:95], a[48:51], a[176:179], v[28:31]
  v_exp_f32 v110, v110
  v_mfma_f32_16x16x32_bf16 v[92:95], a[52:55], a[180:183], v[92:95]
  ds_read_b128 a[40:43], v3 offset:10240
  v_mfma_f32_16x16x32_bf16 v[92:95], a[56:59], a[184:187], v[92:95]
  v_exp_f32 v111, v111
  v_mfma_f32_16x16x32_bf16 v[92:95], a[60:63], a[188:191], v[92:95]
  s_waitcnt lgkmcnt(7)
  v_cvt_pk_bf16_f32 v55, v110, v111
  v_mfma_f32_16x16x32_bf16 v[128:131], a[0:3], v[32:35], v[128:131]
  buffer_store_dwordx4 a[244:247], v2, s[64:67], s90 offen offset:1024 sc1
  v_mfma_f32_16x16x32_bf16 v[160:163], a[0:3], v[36:39], v[160:163]
  s_add_u32 s90, s90, 2048
  v_exp_f32 v112, v112
  v_mfma_f32_16x16x32_bf16 v[192:195], a[0:3], v[40:43], v[192:195]
  s_sub_u32 s88, s88, 1
  ds_read_b128 a[44:47], v3 offset:11264
  v_mfma_f32_16x16x32_bf16 v[224:227], a[0:3], v[44:47], v[224:227]
  v_exp_f32 v113, v113
  v_mfma_f32_16x16x32_bf16 a[192:195], a[208:211], v[32:35], a[192:195]
  v_cvt_pk_bf16_f32 v56, v112, v113
  v_mfma_f32_16x16x32_bf16 v[132:135], a[4:7], v[32:35], v[132:135]
  v_exp_f32 v114, v114
  v_mfma_f32_16x16x32_bf16 v[164:167], a[4:7], v[36:39], v[164:167]
  ds_read_b128 a[48:51], v3 offset:12288
  v_mfma_f32_16x16x32_bf16 v[196:199], a[4:7], v[40:43], v[196:199]
  v_exp_f32 v115, v115
  v_mfma_f32_16x16x32_bf16 v[228:231], a[4:7], v[44:47], v[228:231]
  v_cvt_pk_bf16_f32 v57, v114, v115
  v_mfma_f32_16x16x32_bf16 a[196:199], a[208:211], v[36:39], a[196:199]
  v_exp_f32 v116, v116
  v_mfma_f32_16x16x32_bf16 v[136:139], a[8:11], v[32:35], v[136:139]
  ds_read_b128 a[52:55], v3 offset:13312
  v_mfma_f32_16x16x32_bf16 v[168:171], a[8:11], v[36:39], v[168:171]
  v_exp_f32 v117, v117
  v_mfma_f32_16x16x32_bf16 v[200:203], a[8:11], v[40:43], v[200:203]
  v_cvt_pk_bf16_f32 v58, v116, v117
  v_mfma_f32_16x16x32_bf16 v[232:235], a[8:11], v[44:47], v[232:235]
  v_exp_f32 v118, v118
  v_mfma_f32_16x16x32_bf16 a[200:203], a[208:211], v[40:43], a[200:203]
  v_mfma_f32_16x16x32_bf16 v[140:143], a[12:15], v[32:35], v[140:143]
  v_exp_f32 v119, v119
  v_mfma_f32_16x16x32_bf16 v[172:175], a[12:15], v[36:39], v[172:175]
  ds_read_b128 a[56:59], v3 offset:14336
  v_cvt_pk_bf16_f32 v59, v118, v119
  v_mfma_f32_16x16x32_bf16 v[204:207], a[12:15], v[40:43], v[204:207]
  v_exp_f32 v120, v120
  v_mfma_f32_16x16x32_bf16 v[236:239], a[12:15], v[44:47], v[236:239]
  v_mfma_f32_16x16x32_bf16 a[204:207], a[208:211], v[44:47], a[204:207]
  s_waitcnt lgkmcnt(7)
  v_exp_f32 v121, v121
  v_mfma_f32_16x16x32_bf16 v[144:147], a[16:19], v[32:35], v[144:147]
  ds_read_b128 a[60:63], v3 offset:15360
  v_cvt_pk_bf16_f32 v60, v120, v121
  v_mfma_f32_16x16x32_bf16 v[176:179], a[16:19], v[36:39], v[176:179]
  v_exp_f32 v122, v122
  v_mfma_f32_16x16x32_bf16 v[208:211], a[16:19], v[40:43], v[208:211]
  v_mfma_f32_16x16x32_bf16 v[240:243], a[16:19], v[44:47], v[240:243]
  v_exp_f32 v123, v123
  v_mfma_f32_16x16x32_bf16 v[148:151], a[20:23], v[32:35], v[148:151]
  ds_read_b128 a[0:3], v4 offset:8192
  v_cvt_pk_bf16_f32 v61, v122, v123
  v_mfma_f32_16x16x32_bf16 v[180:183], a[20:23], v[36:39], v[180:183]
  v_exp_f32 v124, v124
  v_mfma_f32_16x16x32_bf16 v[212:215], a[20:23], v[40:43], v[212:215]
  v_mfma_f32_16x16x32_bf16 v[244:247], a[20:23], v[44:47], v[244:247]
  v_exp_f32 v125, v125
  v_mfma_f32_16x16x32_bf16 v[152:155], a[24:27], v[32:35], v[152:155]
  ds_read_b128 a[4:7], v4 offset:9216
  v_cvt_pk_bf16_f32 v62, v124, v125
  v_mfma_f32_16x16x32_bf16 v[184:187], a[24:27], v[36:39], v[184:187]
  v_exp_f32 v126, v126
  v_mfma_f32_16x16x32_bf16 v[216:219], a[24:27], v[40:43], v[216:219]
  v_mfma_f32_16x16x32_bf16 v[248:251], a[24:27], v[44:47], v[248:251]
  v_exp_f32 v127, v127
  v_mfma_f32_16x16x32_bf16 v[156:159], a[28:31], v[32:35], v[156:159]
  ds_read_b128 a[8:11], v4 offset:10240
  v_cvt_pk_bf16_f32 v63, v126, v127
  v_mfma_f32_16x16x32_bf16 v[188:191], a[28:31], v[36:39], v[188:191]
  v_mfma_f32_16x16x32_bf16 v[220:223], a[28:31], v[40:43], v[220:223]
  s_waitcnt vmcnt(10)
  s_barrier
  v_mfma_f32_16x16x32_bf16 v[252:255], a[28:31], v[44:47], v[252:255]
  s_cmp_eq_u32 s88, 0
  s_cbranch_scc1 La_d0
  s_waitcnt lgkmcnt(7)
  v_mfma_f32_16x16x32_bf16 v[96:99], a[32:35], a[128:131], v[16:19]
  s_mov_b32 m0, s26
  v_exp_f32 v64, v64
  v_mfma_f32_16x16x32_bf16 v[96:99], a[36:39], a[132:135], v[96:99]
  buffer_load_dwordx4 v2, s[20:23], s28 offen offset:0 sc1 lds
  v_mfma_f32_16x16x32_bf16 v[96:99], a[40:43], a[136:139], v[96:99]
  v_exp_f32 v65, v65
  v_mfma_f32_16x16x32_bf16 v[96:99], a[44:47], a[140:143], v[96:99]
  ds_read_b128 a[12:15], v4 offset:11264
  v_cvt_pk_bf16_f32 v32, v64, v65
  v_mfma_f32_16x16x32_bf16 v[104:107], a[32:35], a[144:147], v[20:23]
  v_exp_f32 v66, v66
  v_mfma_f32_16x16x32_bf16 v[104:107], a[36:39], a[148:151], v[104:107]
  ds_read_b128 a[16:19], v4 offset:12288
  v_mfma_f32_16x16x32_bf16 v[104:107], a[40:43], a[152:155], v[104:107]
  v_exp_f32 v67, v67
  v_mfma_f32_16x16x32_bf16 v[104:107], a[44:47], a[156:159], v[104:107]
  v_cvt_pk_bf16_f32 v33, v66, v67
  v_mfma_f32_16x16x32_bf16 v[112:115], a[32:35], a[160:163], v[24:27]
  v_exp_f32 v68, v68
  v_mfma_f32_16x16x32_bf16 v[112:115], a[36:39], a[164:167], v[112:115]
  buffer_load_dwordx4 v2, s[20:23], s28 offen offset:1024 sc1 lds
  v_mfma_f32_16x16x32_bf16 v[112:115], a[40:43], a[168:171], v[112:115]
  v_exp_f32 v69, v69
  v_mfma_f32_16x16x32_bf16 v[112:115], a[44:47], a[172:175], v[112:115]
  ds_read_b128 a[20:23], v4 offset:13312
  v_cvt_pk_bf16_f32 v34, v68, v69
  v_mfma_f32_16x16x32_bf16 v[120:123], a[32:35], a[176:179], v[28:31]
  v_exp_f32 v70, v70
  v_mfma_f32_16x16x32_bf16 v[120:123], a[36:39], a[180:183], v[120:123]
  ds_read_b128 a[24:27], v4 offset:14336
  v_mfma_f32_16x16x32_bf16 v[120:123], a[40:43], a[184:187], v[120:123]
  v_exp_f32 v71, v71
  v_mfma_f32_16x16x32_bf16 v[120:123], a[44:47], a[188:191], v[120:123]
  s_waitcnt lgkmcnt(7)
  v_cvt_pk_bf16_f32 v35, v70, v71
  v_mfma_f32_16x16x32_bf16 v[100:103], a[48:51], a[128:131], v[16:19]
  v_exp_f32 v72, v72
  v_mfma_f32_16x16x32_bf16 v[100:103], a[52:55], a[132:135], v[100:103]
  buffer_load_dwordx4 v2, s[20:23], s28 offen offset:2048 sc1 lds
  v_mfma_f32_16x16x32_bf16 v[100:103], a[56:59], a[136:139], v[100:103]
  v_exp_f32 v73, v73
  v_mfma_f32_16x16x32_bf16 v[100:103], a[60:63], a[140:143], v[100:103]
  ds_read_b128 a[28:31], v4 offset:15360
  v_xor_b32 v3, s30, v3
  v_mfma_f32_16x16x32_bf16 v[108:111], a[48:51], a[144:147], v[20:23]
  v_exp_f32 v74, v74
  v_mfma_f32_16x16x32_bf16 v[108:111], a[52:55], a[148:151], v[108:111]
  ds_read_b128 a[32:35], v3 offset:0
  v_cvt_pk_bf16_f32 v36, v72, v73
  v_mfma_f32_16x16x32_bf16 v[108:111], a[56:59], a[152:155], v[108:111]
  v_exp_f32 v75, v75
  v_mfma_f32_16x16x32_bf16 v[108:111], a[60:63], a[156:159], v[108:111]
  v_cvt_pk_bf16_f32 v37, v74, v75
  v_mfma_f32_16x16x32_bf16 v[116:119], a[48:51], a[160:163], v[24:27]
  v_exp_f32 v76, v76
  v_mfma_f32_16x16x32_bf16 v[116:119], a[52:55], a[164:167], v[116:119]
  buffer_load_dwordx4 v2, s[20:23], s28 offen offset:3072 sc1 lds
  v_mfma_f32_16x16x32_bf16 v[116:119], a[56:59], a[168:171], v[116:119]
  s_xor_b32 s26, s26, s31
  v_exp_f32 v77, v77
  v_mfma_f32_16x16x32_bf16 v[116:119], a[60:63], a[172:175], v[116:119]
  s_add_u32 s28, s28, 0x8000
  s_mov_b32 m0, s27
  ds_read_b128 a[36:39], v3 offset:1024
  v_mfma_f32_16x16x32_bf16 v[124:127], a[48:51], a[176:179], v[28:31]
  v_exp_f32 v78, v78
  v_mfma_f32_16x16x32_bf16 v[124:127], a[52:55], a[180:183], v[124:127]
  ds_read_b128 a[40:43], v3 offset:2048
  v_cvt_pk_bf16_f32 v38, v76, v77
  v_mfma_f32_16x16x32_bf16 v[124:127], a[56:59], a[184:187], v[124:127]
  v_exp_f32 v79, v79
  v_mfma_f32_16x16x32_bf16 v[124:127], a[60:63], a[188:191], v[124:127]
  s_waitcnt lgkmcnt(7)
  v_cvt_pk_bf16_f32 v39, v78, v79
  v_mfma_f32_16x16x32_bf16 v[128:131], a[0:3], v[48:51], v[128:131]
  buffer_load_dwordx4 v2, s[20:23], s29 offen offset:0 sc1 lds
  v_mfma_f32_16x16x32_bf16 v[160:163], a[0:3], v[52:55], v[160:163]
  v_exp_f32 v80, v80
  v_mfma_f32_16x16x32_bf16 v[192:195], a[0:3], v[56:59], v[192:195]
  ds_read_b128 a[44:47], v3 offset:3072
  v_mfma_f32_16x16x32_bf16 v[224:227], a[0:3], v[60:63], v[224:227]
  v_exp_f32 v81, v81
  v_mfma_f32_16x16x32_bf16 a[192:195], a[208:211], v[48:51], a[192:195]
  v_cvt_pk_bf16_f32 v40, v80, v81
  v_mfma_f32_16x16x32_bf16 v[132:135], a[4:7], v[48:51], v[132:135]
  v_exp_f32 v82, v82
  v_mfma_f32_16x16x32_bf16 v[164:167], a[4:7], v[52:55], v[164:167]
  ds_read_b128 a[48:51], v3 offset:4096
  v_mfma_f32_16x16x32_bf16 v[196:199], a[4:7], v[56:59], v[196:199]
  v_exp_f32 v83, v83
  v_mfma_f32_16x16x32_bf16 v[228:231], a[4:7], v[60:63], v[228:231]
  buffer_load_dwordx4 v2, s[20:23], s29 offen offset:1024 sc1 lds
  v_mfma_f32_16x16x32_bf16 a[196:199], a[208:211], v[52:55], a[196:199]
  v_exp_f32 v84, v84
  v_mfma_f32_16x16x32_bf16 v[136:139], a[8:11], v[48:51], v[136:139]
  ds_read_b128 a[52:55], v3 offset:5120
  v_cvt_pk_bf16_f32 v41, v82, v83
  v_mfma_f32_16x16x32_bf16 v[168:171], a[8:11], v[52:55], v[168:171]
  v_exp_f32 v85, v85
  v_mfma_f32_16x16x32_bf16 v[200:203], a[8:11], v[56:59], v[200:203]
  v_cvt_pk_bf16_f32 v42, v84, v85
  v_mfma_f32_16x16x32_bf16 v[232:235], a[8:11], v[60:63], v[232:235]
  v_exp_f32 v86, v86
  v_mfma_f32_16x16x32_bf16 a[200:203], a[208:211], v[56:59], a[200:203]
  v_mfma_f32_16x16x32_bf16 v[140:143], a[12:15], v[48:51], v[140:143]
  v_exp_f32 v87, v87
  v_mfma_f32_16x16x32_bf16 v[172:175], a[12:15], v[52:55], v[172:175]
  buffer_load_dwordx4 v2, s[20:23], s29 offen offset:2048 sc1 lds
  v_mfma_f32_16x16x32_bf16 v[204:207], a[12:15], v[56:59], v[204:207]
  v_exp_f32 v88, v88
  v_mfma_f32_16x16x32_bf16 v[236:239], a[12:15], v[60:63], v[236:239]
  ds_read_b128 a[56:59], v3 offset:6144
  v_cvt_pk_bf16_f32 v43, v86, v87
  v_mfma_f32_16x16x32_bf16 a[204:207], a[208:211], v[60:63], a[204:207]
  s_waitcnt lgkmcnt(7)
  v_exp_f32 v89, v89
  v_mfma_f32_16x16x32_bf16 v[144:147], a[16:19], v[48:51], v[144:147]
  ds_read_b128 a[60:63], v3 offset:7168
  v_cvt_pk_bf16_f32 v44, v88, v89
  v_mfma_f32_16x16x32_bf16 v[176:179], a[16:19], v[52:55], v[176:179]
  v_exp_f32 v90, v90
  v_mfma_f32_16x16x32_bf16 v[208:211], a[16:19], v[56:59], v[208:211]
  v_mfma_f32_16x16x32_bf16 v[240:243], a[16:19], v[60:63], v[240:243]
  v_exp_f32 v91, v91
  v_mfma_f32_16x16x32_bf16 v[148:151], a[20:23], v[48:51], v[148:151]
  buffer_load_dwordx4 v2, s[20:23], s29 offen offset:3072 sc1 lds
  v_mfma_f32_16x16x32_bf16 v[180:183], a[20:23], v[52:55], v[180:183]
  s_xor_b32 s27, s27, s30
  v_exp_f32 v92, v92
  v_mfma_f32_16x16x32_bf16 v[212:215], a[20:23], v[56:59], v[212:215]
  s_add_u32 s29, s29, 0x8000
  v_xor_b32 v4, s31, v4
  v_cvt_pk_bf16_f32 v45, v90, v91
  v_mfma_f32_16x16x32_bf16 v[244:247], a[20:23], v[60:63], v[244:247]
  v_exp_f32 v93, v93
  v_mfma_f32_16x16x32_bf16 v[152:155], a[24:27], v[48:51], v[152:155]
  ds_read_b128 a[0:3], v4 offset:0
  ds_read_b128 a[4:7], v4 offset:1024
  v_mfma_f32_16x16x32_bf16 v[184:187], a[24:27], v[52:55], v[184:187]
  v_exp_f32 v94, v94
  v_mfma_f32_16x16x32_bf16 v[216:219], a[24:27], v[56:59], v[216:219]
  v_cvt_pk_bf16_f32 v46, v92, v93
  v_mfma_f32_16x16x32_bf16 v[248:251], a[24:27], v[60:63], v[248:251]
  v_exp_f32 v95, v95
  v_mfma_f32_16x16x32_bf16 v[156:159], a[28:31], v[48:51], v[156:159]
  ds_read_b128 a[8:11], v4 offset:2048
  v_cvt_pk_bf16_f32 v47, v94, v95
  v_mfma_f32_16x16x32_bf16 v[188:191], a[28:31], v[52:55], v[188:191]
  v_mfma_f32_16x16x32_bf16 v[220:223], a[28:31], v[56:59], v[220:223]
  v_mfma_f32_16x16x32_bf16 v[252:255], a[28:31], v[60:63], v[252:255]
  s_xor_b32 s30, s30, 0xc000
  s_xor_b32 s31, s31, 0xc000
  s_branch La_lo
La_d0:
  s_waitcnt lgkmcnt(7)
  v_mfma_f32_16x16x32_bf16 v[96:99], a[32:35], a[128:131], v[16:19]
  s_mov_b32 m0, s26
  ds_read_b128 a[12:15], v4 offset:11264
  v_cndmask_b32 v64, v64, v5, s[32:33]
  v_mfma_f32_16x16x32_bf16 v[96:99], a[36:39], a[132:135], v[96:99]
  v_exp_f32 v64, v64
  v_mfma_f32_16x16x32_bf16 v[96:99], a[40:43], a[136:139], v[96:99]
  v_cndmask_b32 v65, v65, v5, s[34:35]
  v_exp_f32 v65, v65
  v_mfma_f32_16x16x32_bf16 v[96:99], a[44:47], a[140:143], v[96:99]
  buffer_load_dwordx4 v2, s[20:23], s28 offen offset:0 sc1 lds
  v_mfma_f32_16x16x32_bf16 v[104:107], a[32:35], a[144:147], v[20:23]
  v_cndmask_b32 v66, v66, v5, s[36:37]
  v_exp_f32 v66, v66
  v_mfma_f32_16x16x32_bf16 v[104:107], a[36:39], a[148:151], v[104:107]
  ds_read_b128 a[16:19], v4 offset:12288
  v_cndmask_b32 v67, v67, v5, s[38:39]
  v_mfma_f32_16x16x32_bf16 v[104:107], a[40:43], a[152:155], v[104:107]
  v_exp_f32 v67, v67
  v_mfma_f32_16x16x32_bf16 v[104:107], a[44:47], a[156:159], v[104:107]
  v_cndmask_b32 v68, v68, v5, s[40:41]
  v_cndmask_b32 v69, v69, v5, s[42:43]
  v_mfma_f32_16x16x32_bf16 v[112:115], a[32:35], a[160:163], v[24:27]
  v_exp_f32 v68, v68
  v_mfma_f32_16x16x32_bf16 v[112:115], a[36:39], a[164:167], v[112:115]
  buffer_load_dwordx4 v2, s[20:23], s28 offen offset:1024 sc1 lds
  v_mfma_f32_16x16x32_bf16 v[112:115], a[40:43], a[168:171], v[112:115]
  v_exp_f32 v69, v69
  v_mfma_f32_16x16x32_bf16 v[112:115], a[44:47], a[172:175], v[112:115]
  ds_read_b128 a[20:23], v4 offset:13312
  v_cndmask_b32 v70, v70, v5, s[44:45]
  v_mfma_f32_16x16x32_bf16 v[120:123], a[32:35], a[176:179], v[28:31]
  v_exp_f32 v70, v70
  v_mfma_f32_16x16x32_bf16 v[120:123], a[36:39], a[180:183], v[120:123]
  ds_read_b128 a[24:27], v4 offset:14336
  v_cndmask_b32 v71, v71, v5, s[46:47]
  v_mfma_f32_16x16x32_bf16 v[120:123], a[40:43], a[184:187], v[120:123]
  v_exp_f32 v71, v71
  v_mfma_f32_16x16x32_bf16 v[120:123], a[44:47], a[188:191], v[120:123]
  s_waitcnt lgkmcnt(7)
  v_cvt_pk_bf16_f32 v32, v64, v65
  v_cvt_pk_bf16_f32 v33, v66, v67
  v_mfma_f32_16x16x32_bf16 v[100:103], a[48:51], a[128:131], v[16:19]
  v_exp_f32 v72, v72
  v_mfma_f32_16x16x32_bf16 v[100:103], a[52:55], a[132:135], v[100:103]
  buffer_load_dwordx4 v2, s[20:23], s28 offen offset:2048 sc1 lds
  v_mfma_f32_16x16x32_bf16 v[100:103], a[56:59], a[136:139], v[100:103]
  v_exp_f32 v73, v73
  v_mfma_f32_16x16x32_bf16 v[100:103], a[60:63], a[140:143], v[100:103]
  ds_read_b128 a[28:31], v4 offset:15360
  v_xor_b32 v3, 0x4000, v3
  v_mfma_f32_16x16x32_bf16 v[108:111], a[48:51], a[144:147], v[20:23]
  v_exp_f32 v74, v74
  v_mfma_f32_16x16x32_bf16 v[108:111], a[52:55], a[148:151], v[108:111]
  ds_read_b128 a[32:35], v3 offset:0
  v_cvt_pk_bf16_f32 v34, v68, v69
  v_mfma_f32_16x16x32_bf16 v[108:111], a[56:59], a[152:155], v[108:111]
  v_exp_f32 v75, v75
  v_mfma_f32_16x16x32_bf16 v[108:111], a[60:63], a[156:159], v[108:111]
  v_cvt_pk_bf16_f32 v35, v70, v71
  v_cvt_pk_bf16_f32 v36, v72, v73
  v_mfma_f32_16x16x32_bf16 v[116:119], a[48:51], a[160:163], v[24:27]
  v_exp_f32 v76, v76
  v_mfma_f32_16x16x32_bf16 v[116:119], a[52:55], a[164:167], v[116:119]
  buffer_load_dwordx4 v2, s[20:23], s28 offen offset:3072 sc1 lds
  v_mfma_f32_16x16x32_bf16 v[116:119], a[56:59], a[168:171], v[116:119]
  s_xor_b32 s26, s26, 0x8000
  v_exp_f32 v77, v77
  v_mfma_f32_16x16x32_bf16 v[116:119], a[60:63], a[172:175], v[116:119]
  s_add_u32 s28, s28, 0x8000
  s_mov_b32 m0, s27
  ds_read_b128 a[36:39], v3 offset:1024
  v_mfma_f32_16x16x32_bf16 v[124:127], a[48:51], a[176:179], v[28:31]
  v_exp_f32 v78, v78
  v_mfma_f32_16x16x32_bf16 v[124:127], a[52:55], a[180:183], v[124:127]
  ds_read_b128 a[40:43], v3 offset:2048
  v_cvt_pk_bf16_f32 v37, v74, v75
  v_mfma_f32_16x16x32_bf16 v[124:127], a[56:59], a[184:187], v[124:127]
  v_exp_f32 v79, v79
  v_mfma_f32_16x16x32_bf16 v[124:127], a[60:63], a[188:191], v[124:127]
  s_waitcnt lgkmcnt(7)
  v_cvt_pk_bf16_f32 v38, v76, v77
  v_cvt_pk_bf16_f32 v39, v78, v79
  v_mfma_f32_16x16x32_bf16 v[128:131], a[0:3], v[48:51], v[128:131]
  buffer_load_dwordx4 v2, s[20:23], s29 offen offset:0 sc1 lds
  v_mfma_f32_16x16x32_bf16 v[160:163], a[0:3], v[52:55], v[160:163]
  v_exp_f32 v80, v80
  v_mfma_f32_16x16x32_bf16 v[192:195], a[0:3], v[56:59], v[192:195]
  ds_read_b128 a[44:47], v3 offset:3072
  v_mfma_f32_16x16x32_bf16 v[224:227], a[0:3], v[60:63], v[224:227]
  v_exp_f32 v81, v81
  v_mfma_f32_16x16x32_bf16 a[192:195], a[208:211], v[48:51], a[192:195]
  v_cvt_pk_bf16_f32 v40, v80, v81
  v_mfma_f32_16x16x32_bf16 v[132:135], a[4:7], v[48:51], v[132:135]
  v_exp_f32 v82, v82
  v_mfma_f32_16x16x32_bf16 v[164:167], a[4:7], v[52:55], v[164:167]
  ds_read_b128 a[48:51], v3 offset:4096
  v_mfma_f32_16x16x32_bf16 v[196:199], a[4:7], v[56:59], v[196:199]
  v_exp_f32 v83, v83
  v_mfma_f32_16x16x32_bf16 v[228:231], a[4:7], v[60:63], v[228:231]
  buffer_load_dwordx4 v2, s[20:23], s29 offen offset:1024 sc1 lds
  v_mfma_f32_16x16x32_bf16 a[196:199], a[208:211], v[52:55], a[196:199]
  v_exp_f32 v84, v84
  v_mfma_f32_16x16x32_bf16 v[136:139], a[8:11], v[48:51], v[136:139]
  ds_read_b128 a[52:55], v3 offset:5120
  v_cvt_pk_bf16_f32 v41, v82, v83
  v_mfma_f32_16x16x32_bf16 v[168:171], a[8:11], v[52:55], v[168:171]
  v_exp_f32 v85, v85
  v_mfma_f32_16x16x32_bf16 v[200:203], a[8:11], v[56:59], v[200:203]
  v_cvt_pk_bf16_f32 v42, v84, v85
  v_mfma_f32_16x16x32_bf16 v[232:235], a[8:11], v[60:63], v[232:235]
  v_exp_f32 v86, v86
  v_mfma_f32_16x16x32_bf16 a[200:203], a[208:211], v[56:59], a[200:203]
  v_mfma_f32_16x16x32_bf16 v[140:143], a[12:15], v[48:51], v[140:143]
  v_exp_f32 v87, v87
  v_mfma_f32_16x16x32_bf16 v[172:175], a[12:15], v[52:55], v[172:175]
  buffer_load_dwordx4 v2, s[20:23], s29 offen offset:2048 sc1 lds
  v_mfma_f32_16x16x32_bf16 v[204:207], a[12:15], v[56:59], v[204:207]
  v_exp_f32 v88, v88
  v_mfma_f32_16x16x32_bf16 v[236:239], a[12:15], v[60:63], v[236:239]
  ds_read_b128 a[56:59], v3 offset:6144
  v_cvt_pk_bf16_f32 v43, v86, v87
  v_mfma_f32_16x16x32_bf16 a[204:207], a[208:211], v[60:63], a[204:207]
  s_waitcnt lgkmcnt(7)
  v_exp_f32 v89, v89
  v_mfma_f32_16x16x32_bf16 v[144:147], a[16:19], v[48:51], v[144:147]
  ds_read_b128 a[60:63], v3 offset:7168
  v_cvt_pk_bf16_f32 v44, v88, v89
  v_mfma_f32_16x16x32_bf16 v[176:179], a[16:19], v[52:55], v[176:179]
  v_exp_f32 v90, v90
  v_mfma_f32_16x16x32_bf16 v[208:211], a[16:19], v[56:59], v[208:211]
  v_mfma_f32_16x16x32_bf16 v[240:243], a[16:19], v[60:63], v[240:243]
  v_exp_f32 v91, v91
  v_mfma_f32_16x16x32_bf16 v[148:151], a[20:23], v[48:51], v[148:151]
  buffer_load_dwordx4 v2, s[20:23], s29 offen offset:3072 sc1 lds
  v_mfma_f32_16x16x32_bf16 v[180:183], a[20:23], v[52:55], v[180:183]
  s_xor_b32 s27, s27, 0x4000
  v_exp_f32 v92, v92
  v_mfma_f32_16x16x32_bf16 v[212:215], a[20:23], v[56:59], v[212:215]
  s_add_u32 s29, s29, 0x8000
  v_xor_b32 v4, 0x8000, v4
  v_cvt_pk_bf16_f32 v45, v90, v91
  v_mfma_f32_16x16x32_bf16 v[244:247], a[20:23], v[60:63], v[244:247]
  v_exp_f32 v93, v93
  v_mfma_f32_16x16x32_bf16 v[152:155], a[24:27], v[48:51], v[152:155]
  ds_read_b128 a[0:3], v4 offset:0
  ds_read_b128 a[4:7], v4 offset:1024
  v_mfma_f32_16x16x32_bf16 v[184:187], a[24:27], v[52:55], v[184:187]
  v_exp_f32 v94, v94
  v_mfma_f32_16x16x32_bf16 v[216:219], a[24:27], v[56:59], v[216:219]
  v_cvt_pk_bf16_f32 v46, v92, v93
  v_mfma_f32_16x16x32_bf16 v[248:251], a[24:27], v[60:63], v[248:251]
  v_exp_f32 v95, v95
  v_mfma_f32_16x16x32_bf16 v[156:159], a[28:31], v[48:51], v[156:159]
  ds_read_b128 a[8:11], v4 offset:2048
  v_cvt_pk_bf16_f32 v47, v94, v95
  v_mfma_f32_16x16x32_bf16 v[188:191], a[28:31], v[52:55], v[188:191]
  v_mfma_f32_16x16x32_bf16 v[220:223], a[28:31], v[56:59], v[220:223]
  v_mfma_f32_16x16x32_bf16 v[252:255], a[28:31], v[60:63], v[252:255]
La_d1:
  s_waitcnt lgkmcnt(7)
  v_mfma_f32_16x16x32_bf16 v[72:75], a[32:35], a[144:147], v[20:23]
  buffer_load_dwordx4 a[64:67], v2, s[8:11], s6 offen offset:0
  v_mfma_f32_16x16x32_bf16 v[72:75], a[36:39], a[148:151], v[72:75]
  v_cndmask_b32 v96, v96, v5, s[48:49]
  v_exp_f32 v96, v96
  v_mfma_f32_16x16x32_bf16 v[72:75], a[40:43], a[152:155], v[72:75]
  v_cndmask_b32 v97, v97, v5, s[50:51]
  v_exp_f32 v97, v97
  v_mfma_f32_16x16x32_bf16 v[72:75], a[44:47], a[156:159], v[72:75]
  v_cndmask_b32 v98, v98, v5, s[52:53]
  v_exp_f32 v98, v98
  v_mfma_f32_16x16x32_bf16 v[80:83], a[32:35], a[160:163], v[24:27]
  ds_read_b128 a[12:15], v4 offset:3072
  ds_read_b128 a[16:19], v4 offset:4096
  v_mfma_f32_16x16x32_bf16 v[80:83], a[36:39], a[164:167], v[80:83]
  v_cndmask_b32 v99, v99, v5, s[54:55]
  v_exp_f32 v99, v99
  v_mfma_f32_16x16x32_bf16 v[80:83], a[40:43], a[168:171], v[80:83]
  buffer_load_dwordx4 a[64:67], v2, s[8:11], s6 offen offset:1024
  v_mfma_f32_16x16x32_bf16 v[80:83], a[44:47], a[172:175], v[80:83]
  v_cndmask_b32 v100, v100, v5, s[56:57]
  v_exp_f32 v100, v100
  v_mfma_f32_16x16x32_bf16 v[88:91], a[32:35], a[176:179], v[28:31]
  ds_read_b128 a[20:23], v4 offset:5120
  v_cndmask_b32 v101, v101, v5, s[58:59]
  v_mfma_f32_16x16x32_bf16 v[88:91], a[36:39], a[180:183], v[88:91]
  v_exp_f32 v101, v101
  v_mfma_f32_16x16x32_bf16 v[88:91], a[40:43], a[184:187], v[88:91]
  v_cndmask_b32 v102, v102, v5, s[60:61]
  v_exp_f32 v102, v102
  v_mfma_f32_16x16x32_bf16 v[88:91], a[44:47], a[188:191], v[88:91]
  s_waitcnt lgkmcnt(6)
  ds_read_b128 a[24:27], v4 offset:6144
  v_cndmask_b32 v103, v103, v5, s[62:63]
  v_mfma_f32_16x16x32_bf16 v[76:79], a[48:51], a[144:147], v[20:23]
  v_exp_f32 v103, v103
  v_mfma_f32_16x16x32_bf16 v[76:79], a[52:55], a[148:151], v[76:79]
  buffer_load_dwordx4 a[64:67], v2, s[8:11], s6 offen offset:2048
  v_mfma_f32_16x16x32_bf16 v[76:79], a[56:59], a[152:155], v[76:79]
  v_exp_f32 v104, v104
  v_mfma_f32_16x16x32_bf16 v[76:79], a[60:63], a[156:159], v[76:79]
  ds_read_b128 a[28:31], v4 offset:7168
  ds_read_b128 a[32:35], v3 offset:8192
  v_mfma_f32_16x16x32_bf16 v[84:87], a[48:51], a[160:163], v[24:27]
  v_exp_f32 v105, v105
  v_mfma_f32_16x16x32_bf16 v[84:87], a[52:55], a[164:167], v[84:87]
  buffer_load_dwordx4 a[64:67], v2, s[8:11], s6 offen offset:3072
  v_mfma_f32_16x16x32_bf16 v[84:87], a[56:59], a[168:171], v[84:87]
  s_add_u32 s6, s6, 4096
  v_exp_f32 v106, v106
  v_mfma_f32_16x16x32_bf16 v[84:87], a[60:63], a[172:175], v[84:87]
  v_exp_f32 v107, v107
  v_mfma_f32_16x16x32_bf16 v[92:95], a[48:51], a[176:179], v[28:31]
  ds_read_b128 a[36:39], v3 offset:9216
  v_cvt_pk_bf16_f32 v48, v96, v97
  v_mfma_f32_16x16x32_bf16 v[92:95], a[52:55], a[180:183], v[92:95]
  v_exp_f32 v108, v108
  v_mfma_f32_16x16x32_bf16 v[92:95], a[56:59], a[184:187], v[92:95]
  buffer_load_dwordx4 a[64:67], v2, s[8:11], s6 offen offset:0
  v_mfma_f32_16x16x32_bf16 v[92:95], a[60:63], a[188:191], v[92:95]
  s_waitcnt lgkmcnt(6)
  v_exp_f32 v109, v109
  v_mfma_f32_16x16x32_bf16 v[128:131], a[0:3], v[32:35], v[128:131]
  ds_read_b128 a[40:43], v3 offset:10240
  ds_read_b128 a[44:47], v3 offset:11264
  v_mfma_f32_16x16x32_bf16 v[160:163], a[0:3], v[36:39], v[160:163]
  v_exp_f32 v110, v110
  v_mfma_f32_16x16x32_bf16 v[192:195], a[0:3], v[40:43], v[192:195]
  v_cvt_pk_bf16_f32 v49, v98, v99
  v_cvt_pk_bf16_f32 v50, v100, v101
  v_mfma_f32_16x16x32_bf16 v[224:227], a[0:3], v[44:47], v[224:227]
  v_exp_f32 v111, v111
  v_mfma_f32_16x16x32_bf16 a[192:195], a[208:211], v[32:35], a[192:195]
  buffer_load_dwordx4 a[64:67], v2, s[8:11], s6 offen offset:1024
  v_mfma_f32_16x16x32_bf16 v[132:135], a[4:7], v[32:35], v[132:135]
  v_exp_f32 v112, v112
  v_mfma_f32_16x16x32_bf16 v[164:167], a[4:7], v[36:39], v[164:167]
  v_exp_f32 v113, v113
  v_mfma_f32_16x16x32_bf16 v[196:199], a[4:7], v[40:43], v[196:199]
  ds_read_b128 a[48:51], v3 offset:12288
  v_cvt_pk_bf16_f32 v51, v102, v103
  v_mfma_f32_16x16x32_bf16 v[228:231], a[4:7], v[44:47], v[228:231]
  v_exp_f32 v114, v114
  v_mfma_f32_16x16x32_bf16 a[196:199], a[208:211], v[36:39], a[196:199]
  buffer_load_dwordx4 a[64:67], v2, s[8:11], s6 offen offset:2048
  v_mfma_f32_16x16x32_bf16 v[136:139], a[8:11], v[32:35], v[136:139]
  v_exp_f32 v115, v115
  v_mfma_f32_16x16x32_bf16 v[168:171], a[8:11], v[36:39], v[168:171]
  ds_read_b128 a[52:55], v3 offset:13312
  v_cvt_pk_bf16_f32 v52, v104, v105
  v_mfma_f32_16x16x32_bf16 v[200:203], a[8:11], v[40:43], v[200:203]
  v_exp_f32 v116, v116
  v_mfma_f32_16x16x32_bf16 v[232:235], a[8:11], v[44:47], v[232:235]
  v_cvt_pk_bf16_f32 v53, v106, v107
  v_cvt_pk_bf16_f32 v54, v108, v109
  v_mfma_f32_16x16x32_bf16 a[200:203], a[208:211], v[40:43], a[200:203]
  v_exp_f32 v117, v117
  v_mfma_f32_16x16x32_bf16 v[140:143], a[12:15], v[32:35], v[140:143]
  v_exp_f32 v118, v118
  v_mfma_f32_16x16x32_bf16 v[172:175], a[12:15], v[36:39], v[172:175]
  buffer_load_dwordx4 a[64:67], v2, s[8:11], s6 offen offset:3072
  v_mfma_f32_16x16x32_bf16 v[204:207], a[12:15], v[40:43], v[204:207]
  v_exp_f32 v119, v119
  v_mfma_f32_16x16x32_bf16 v[236:239], a[12:15], v[44:47], v[236:239]
  ds_read_b128 a[56:59], v3 offset:14336
  v_cvt_pk_bf16_f32 v55, v110, v111
  v_mfma_f32_16x16x32_bf16 a[204:207], a[208:211], v[44:47], a[204:207]
  s_waitcnt lgkmcnt(7)
  v_exp_f32 v120, v120
  v_mfma_f32_16x16x32_bf16 v[144:147], a[16:19], v[32:35], v[144:147]
  buffer_load_dwordx4 a[64:67], v2, s[12:15], s7 offen offset:0
  v_mfma_f32_16x16x32_bf16 v[176:179], a[16:19], v[36:39], v[176:179]
  v_exp_f32 v121, v121
  v_mfma_f32_16x16x32_bf16 v[208:211], a[16:19], v[40:43], v[208:211]
  ds_read_b128 a[60:63], v3 offset:15360
  v_cvt_pk_bf16_f32 v56, v112, v113
  v_mfma_f32_16x16x32_bf16 v[240:243], a[16:19], v[44:47], v[240:243]
  v_exp_f32 v122, v122
  v_mfma_f32_16x16x32_bf16 v[148:151], a[20:23], v[32:35], v[148:151]
  v_exp_f32 v123, v123
  v_mfma_f32_16x16x32_bf16 v[180:183], a[20:23], v[36:39], v[180:183]
  ds_read_b128 a[0:3], v4 offset:8192
  v_cvt_pk_bf16_f32 v57, v114, v115
  v_mfma_f32_16x16x32_bf16 v[212:215], a[20:23], v[40:43], v[212:215]
  v_exp_f32 v124, v124
  v_mfma_f32_16x16x32_bf16 v[244:247], a[20:23], v[44:47], v[244:247]
  buffer_load_dwordx4 a[64:67], v2, s[12:15], s7 offen offset:1024
  v_mfma_f32_16x16x32_bf16 v[152:155], a[24:27], v[32:35], v[152:155]
  v_exp_f32 v125, v125
  v_mfma_f32_16x16x32_bf16 v[184:187], a[24:27], v[36:39], v[184:187]
  ds_read_b128 a[4:7], v4 offset:9216
  v_cvt_pk_bf16_f32 v58, v116, v117
  v_mfma_f32_16x16x32_bf16 v[216:219], a[24:27], v[40:43], v[216:219]
  v_exp_f32 v126, v126
  v_mfma_f32_16x16x32_bf16 v[248:251], a[24:27], v[44:47], v[248:251]
  v_cvt_pk_bf16_f32 v59, v118, v119
  v_cvt_pk_bf16_f32 v60, v120, v121
  v_mfma_f32_16x16x32_bf16 v[156:159], a[28:31], v[32:35], v[156:159]
  v_exp_f32 v127, v127
  v_mfma_f32_16x16x32_bf16 v[188:191], a[28:31], v[36:39], v[188:191]
  ds_read_b128 a[8:11], v4 offset:10240
  v_cvt_pk_bf16_f32 v61, v122, v123
  v_mfma_f32_16x16x32_bf16 v[220:223], a[28:31], v[40:43], v[220:223]
  s_waitcnt vmcnt(22)
  s_barrier
  v_mfma_f32_16x16x32_bf16 v[252:255], a[28:31], v[44:47], v[252:255]
  v_cvt_pk_bf16_f32 v62, v124, v125
  v_cvt_pk_bf16_f32 v63, v126, v127
  s_waitcnt lgkmcnt(7)
  v_mfma_f32_16x16x32_bf16 v[104:107], a[32:35], a[144:147], v[20:23]
  s_mov_b32 m0, s26
  ds_read_b128 a[12:15], v4 offset:11264
  v_cndmask_b32 v72, v72, v5, s[32:33]
  v_mfma_f32_16x16x32_bf16 v[104:107], a[36:39], a[148:151], v[104:107]
  v_exp_f32 v72, v72
  v_mfma_f32_16x16x32_bf16 v[104:107], a[40:43], a[152:155], v[104:107]
  v_cndmask_b32 v73, v73, v5, s[34:35]
  v_exp_f32 v73, v73
  v_mfma_f32_16x16x32_bf16 v[104:107], a[44:47], a[156:159], v[104:107]
  buffer_load_dwordx4 v2, s[20:23], s28 offen offset:0 sc1 lds
  v_mfma_f32_16x16x32_bf16 v[112:115], a[32:35], a[160:163], v[24:27]
  v_cndmask_b32 v74, v74, v5, s[36:37]
  v_exp_f32 v74, v74
  v_mfma_f32_16x16x32_bf16 v[112:115], a[36:39], a[164:167], v[112:115]
  ds_read_b128 a[16:19], v4 offset:12288
  v_cndmask_b32 v76, v76, v5, s[40:41]
  v_mfma_f32_16x16x32_bf16 v[112:115], a[40:43], a[168:171], v[112:115]
  ds_read_b128 a[20:23], v4 offset:13312
  v_cndmask_b32 v75, v75, v5, s[38:39]
  v_mfma_f32_16x16x32_bf16 v[112:115], a[44:47], a[172:175], v[112:115]
  v_exp_f32 v75, v75
  v_mfma_f32_16x16x32_bf16 v[120:123], a[32:35], a[176:179], v[28:31]
  buffer_load_dwordx4 v2, s[20:23], s28 offen offset:1024 sc1 lds
  v_mfma_f32_16x16x32_bf16 v[120:123], a[36:39], a[180:183], v[120:123]
  v_exp_f32 v76, v76
  v_mfma_f32_16x16x32_bf16 v[120:123], a[40:43], a[184:187], v[120:123]
  ds_read_b128 a[24:27], v4 offset:14336
  v_cndmask_b32 v79, v79, v5, s[46:47]
  v_mfma_f32_16x16x32_bf16 v[120:123], a[44:47], a[188:191], v[120:123]
  s_waitcnt lgkmcnt(7)
  v_cndmask_b32 v77, v77, v5, s[42:43]
  v_cndmask_b32 v78, v78, v5, s[44:45]
  v_mfma_f32_16x16x32_bf16 v[108:111], a[48:51], a[144:147], v[20:23]
  v_exp_f32 v77, v77
  v_mfma_f32_16x16x32_bf16 v[108:111], a[52:55], a[148:151], v[108:111]
  ds_read_b128 a[28:31], v4 offset:15360
  v_xor_b32 v4, 0x4000, v4
  v_mfma_f32_16x16x32_bf16 v[108:111], a[56:59], a[152:155], v[108:111]
  v_exp_f32 v78, v78
  v_mfma_f32_16x16x32_bf16 v[108:111], a[60:63], a[156:159], v[108:111]
  buffer_load_dwordx4 v2, s[20:23], s28 offen offset:2048 sc1 lds
  v_mfma_f32_16x16x32_bf16 v[116:119], a[48:51], a[160:163], v[24:27]
  v_exp_f32 v79, v79
  v_mfma_f32_16x16x32_bf16 v[116:119], a[52:55], a[164:167], v[116:119]
  v_xor_b32 v3, 0x8000, v3
  v_cvt_pk_bf16_f32 v36, v72, v73
  v_mfma_f32_16x16x32_bf16 v[116:119], a[56:59], a[168:171], v[116:119]
  ds_read_b128 a[32:35], v3 offset:0
  ds_read_b128 a[36:39], v3 offset:1024
  v_mfma_f32_16x16x32_bf16 v[116:119], a[60:63], a[172:175], v[116:119]
  v_exp_f32 v80, v80
  v_mfma_f32_16x16x32_bf16 v[124:127], a[48:51], a[176:179], v[28:31]
  v_cvt_pk_bf16_f32 v37, v74, v75
  v_cvt_pk_bf16_f32 v38, v76, v77
  v_mfma_f32_16x16x32_bf16 v[124:127], a[52:55], a[180:183], v[124:127]
  v_exp_f32 v81, v81
  v_mfma_f32_16x16x32_bf16 v[124:127], a[56:59], a[184:187], v[124:127]
  buffer_load_dwordx4 v2, s[20:23], s28 offen offset:3072 sc1 lds
  v_mfma_f32_16x16x32_bf16 v[124:127], a[60:63], a[188:191], v[124:127]
  s_waitcnt lgkmcnt(6)
  s_xor_b32 s26, s26, 0x4000
  s_add_u32 s28, s28, 0x8000
  v_mfma_f32_16x16x32_bf16 v[128:131], a[0:3], v[48:51], v[128:131]
  s_mov_b32 m0, s27
  v_exp_f32 v82, v82
  v_mfma_f32_16x16x32_bf16 v[160:163], a[0:3], v[52:55], v[160:163]
  ds_read_b128 a[40:43], v3 offset:2048
  ds_read_b128 a[44:47], v3 offset:3072
  v_mfma_f32_16x16x32_bf16 v[192:195], a[0:3], v[56:59], v[192:195]
  v_exp_f32 v83, v83
  v_mfma_f32_16x16x32_bf16 v[224:227], a[0:3], v[60:63], v[224:227]
  v_cvt_pk_bf16_f32 v39, v78, v79
  v_cvt_pk_bf16_f32 v40, v80, v81
  v_mfma_f32_16x16x32_bf16 a[192:195], a[208:211], v[48:51], a[192:195]
  buffer_load_dwordx4 v2, s[20:23], s29 offen offset:0 sc1 lds
  v_mfma_f32_16x16x32_bf16 v[132:135], a[4:7], v[48:51], v[132:135]
  v_exp_f32 v84, v84
  v_mfma_f32_16x16x32_bf16 v[164:167], a[4:7], v[52:55], v[164:167]
  ds_read_b128 a[48:51], v3 offset:4096
  v_cvt_pk_bf16_f32 v41, v82, v83
  v_mfma_f32_16x16x32_bf16 v[196:199], a[4:7], v[56:59], v[196:199]
  v_exp_f32 v85, v85
  v_mfma_f32_16x16x32_bf16 v[228:231], a[4:7], v[60:63], v[228:231]
  v_cvt_pk_bf16_f32 v42, v84, v85
  v_mfma_f32_16x16x32_bf16 a[196:199], a[208:211], v[52:55], a[196:199]
  v_exp_f32 v86, v86
  v_mfma_f32_16x16x32_bf16 v[136:139], a[8:11], v[48:51], v[136:139]
  ds_read_b128 a[52:55], v3 offset:5120
  v_mfma_f32_16x16x32_bf16 v[168:171], a[8:11], v[52:55], v[168:171]
  buffer_load_dwordx4 v2, s[20:23], s29 offen offset:1024 sc1 lds
  v_mfma_f32_16x16x32_bf16 v[200:203], a[8:11], v[56:59], v[200:203]
  v_exp_f32 v87, v87
  v_mfma_f32_16x16x32_bf16 v[232:235], a[8:11], v[60:63], v[232:235]
  v_cvt_pk_bf16_f32 v43, v86, v87
  v_mfma_f32_16x16x32_bf16 a[200:203], a[208:211], v[56:59], a[200:203]
  v_exp_f32 v88, v88
  v_mfma_f32_16x16x32_bf16 v[140:143], a[12:15], v[48:51], v[140:143]
  ds_read_b128 a[56:59], v3 offset:6144
  v_mfma_f32_16x16x32_bf16 v[172:175], a[12:15], v[52:55], v[172:175]
  v_mfma_f32_16x16x32_bf16 v[204:207], a[12:15], v[56:59], v[204:207]
  v_exp_f32 v89, v89
  v_mfma_f32_16x16x32_bf16 v[236:239], a[12:15], v[60:63], v[236:239]
  buffer_load_dwordx4 v2, s[20:23], s29 offen offset:2048 sc1 lds
  v_mfma_f32_16x16x32_bf16 a[204:207], a[208:211], v[60:63], a[204:207]
  s_waitcnt lgkmcnt(7)
  v_exp_f32 v90, v90
  v_mfma_f32_16x16x32_bf16 v[144:147], a[16:19], v[48:51], v[144:147]
  ds_read_b128 a[60:63], v3 offset:7168
  v_cvt_pk_bf16_f32 v44, v88, v89
  v_mfma_f32_16x16x32_bf16 v[176:179], a[16:19], v[52:55], v[176:179]
  v_exp_f32 v91, v91
  v_mfma_f32_16x16x32_bf16 v[208:211], a[16:19], v[56:59], v[208:211]
  v_cvt_pk_bf16_f32 v45, v90, v91
  v_mfma_f32_16x16x32_bf16 v[240:243], a[16:19], v[60:63], v[240:243]
  v_mfma_f32_16x16x32_bf16 v[148:151], a[20:23], v[48:51], v[148:151]
  v_exp_f32 v92, v92
  v_mfma_f32_16x16x32_bf16 v[180:183], a[20:23], v[52:55], v[180:183]
  buffer_load_dwordx4 v2, s[20:23], s29 offen offset:3072 sc1 lds
  v_mfma_f32_16x16x32_bf16 v[212:215], a[20:23], v[56:59], v[212:215]
  s_xor_b32 s27, s27, 0x8000
  v_exp_f32 v93, v93
  v_mfma_f32_16x16x32_bf16 v[244:247], a[20:23], v[60:63], v[244:247]
  s_add_u32 s29, s29, 0x8000
  ds_read_b128 a[0:3], v3 offset:8192
  v_cvt_pk_bf16_f32 v46, v92, v93
  v_mfma_f32_16x16x32_bf16 v[152:155], a[24:27], v[48:51], v[152:155]
  ds_read_b128 a[4:7], v3 offset:9216
  v_mfma_f32_16x16x32_bf16 v[184:187], a[24:27], v[52:55], v[184:187]
  v_exp_f32 v94, v94
  v_mfma_f32_16x16x32_bf16 v[216:219], a[24:27], v[56:59], v[216:219]
  v_mfma_f32_16x16x32_bf16 v[248:251], a[24:27], v[60:63], v[248:251]
  v_exp_f32 v95, v95
  v_mfma_f32_16x16x32_bf16 v[156:159], a[28:31], v[48:51], v[156:159]
  ds_read_b128 a[8:11], v3 offset:10240
  v_cvt_pk_bf16_f32 v47, v94, v95
  v_mfma_f32_16x16x32_bf16 v[188:191], a[28:31], v[52:55], v[188:191]
  v_mfma_f32_16x16x32_bf16 v[220:223], a[28:31], v[56:59], v[220:223]
  s_waitcnt vmcnt(22)
  s_barrier
  v_mfma_f32_16x16x32_bf16 v[252:255], a[28:31], v[60:63], v[252:255]
  s_lshr_b32 s91, s73, 1
  s_lshl_b32 s91, s91, 11
  s_add_u32 s91, s91, 32768
  v_and_b32 v14, 15, v1
  v_lshlrev_b32 v14, 7, v14
  s_waitcnt lgkmcnt(3)
  v_mfma_f32_16x16x32_bf16 v[64:67], a[32:35], a[160:163], v[24:27]
  s_mov_b32 m0, s26
  ds_read_b128 a[12:15], v3 offset:11264
  v_cndmask_b32 v104, v104, v5, s[48:49]
  v_mfma_f32_16x16x32_bf16 v[64:67], a[36:39], a[164:167], v[64:67]
  v_exp_f32 v104, v104
  v_mfma_f32_16x16x32_bf16 v[64:67], a[40:43], a[168:171], v[64:67]
  v_cndmask_b32 v105, v105, v5, s[50:51]
  v_exp_f32 v105, v105
  v_mfma_f32_16x16x32_bf16 v[64:67], a[44:47], a[172:175], v[64:67]
  buffer_load_dwordx4 v2, s[20:23], s28 offen offset:0 sc1 lds
  v_mfma_f32_16x16x32_bf16 v[72:75], a[32:35], a[176:179], v[28:31]
  v_cndmask_b32 v106, v106, v5, s[52:53]
  v_exp_f32 v106, v106
  v_mfma_f32_16x16x32_bf16 v[72:75], a[36:39], a[180:183], v[72:75]
  ds_read_b128 a[16:19], v3 offset:12288
  ds_read_b128 a[20:23], v3 offset:13312
  v_mfma_f32_16x16x32_bf16 v[72:75], a[40:43], a[184:187], v[72:75]
  buffer_load_dwordx4 v2, s[20:23], s28 offen offset:1024 sc1 lds
  v_mfma_f32_16x16x32_bf16 v[72:75], a[44:47], a[188:191], v[72:75]
  v_cndmask_b32 v107, v107, v5, s[54:55]
  v_exp_f32 v107, v107
  v_mfma_f32_16x16x32_bf16 v[68:71], a[48:51], a[160:163], v[24:27]
  ds_read_b128 a[24:27], v3 offset:14336
  ds_read_b128 a[28:31], v3 offset:15360
  v_mfma_f32_16x16x32_bf16 v[68:71], a[52:55], a[164:167], v[68:71]
  v_cndmask_b32 v108, v108, v5, s[56:57]
  v_exp_f32 v108, v108
  v_mfma_f32_16x16x32_bf16 v[68:71], a[56:59], a[168:171], v[68:71]
  ds_read_b128 a[32:35], v4 offset:0
  v_cndmask_b32 v109, v109, v5, s[58:59]
  v_mfma_f32_16x16x32_bf16 v[68:71], a[60:63], a[172:175], v[68:71]
  v_exp_f32 v109, v109
  v_mfma_f32_16x16x32_bf16 v[76:79], a[48:51], a[176:179], v[28:31]
  ds_read_b128 a[36:39], v4 offset:1024
  v_cndmask_b32 v110, v110, v5, s[60:61]
  v_mfma_f32_16x16x32_bf16 v[76:79], a[52:55], a[180:183], v[76:79]
  buffer_load_dwordx4 v2, s[20:23], s28 offen offset:2048 sc1 lds
  v_mfma_f32_16x16x32_bf16 v[76:79], a[56:59], a[184:187], v[76:79]
  v_exp_f32 v110, v110
  v_mfma_f32_16x16x32_bf16 v[76:79], a[60:63], a[188:191], v[76:79]
  s_waitcnt lgkmcnt(2)
  ds_read_b128 a[40:43], v4 offset:2048
  v_cndmask_b32 v111, v111, v5, s[62:63]
  v_mfma_f32_16x16x32_bf16 v[80:83], a[0:3], a[160:163], v[24:27]
  v_exp_f32 v111, v111
  v_mfma_f32_16x16x32_bf16 v[80:83], a[4:7], a[164:167], v[80:83]
  ds_read_b128 a[44:47], v4 offset:3072
  v_cvt_pk_bf16_f32 v52, v104, v105
  v_mfma_f32_16x16x32_bf16 v[80:83], a[8:11], a[168:171], v[80:83]
  ds_read_b128 a[48:51], v4 offset:4096
  v_cvt_pk_bf16_f32 v53, v106, v107
  v_mfma_f32_16x16x32_bf16 v[80:83], a[12:15], a[172:175], v[80:83]
  v_exp_f32 v112, v112
  v_mfma_f32_16x16x32_bf16 v[88:91], a[0:3], a[176:179], v[28:31]
  buffer_load_dwordx4 v2, s[20:23], s28 offen offset:3072 sc1 lds
  v_mfma_f32_16x16x32_bf16 v[88:91], a[4:7], a[180:183], v[88:91]
  s_xor_b32 s26, s26, 0x8000
  v_exp_f32 v113, v113
  v_mfma_f32_16x16x32_bf16 v[88:91], a[8:11], a[184:187], v[88:91]
  s_add_u32 s28, s28, 0x8000
  s_mov_b32 m0, s27
  ds_read_b128 a[52:55], v4 offset:5120
  v_mfma_f32_16x16x32_bf16 v[88:91], a[12:15], a[188:191], v[88:91]
  v_exp_f32 v114, v114
  v_mfma_f32_16x16x32_bf16 v[84:87], a[16:19], a[160:163], v[24:27]
  ds_read_b128 a[56:59], v4 offset:6144
  ds_read_b128 a[60:63], v4 offset:7168
  v_mfma_f32_16x16x32_bf16 v[84:87], a[20:23], a[164:167], v[84:87]
  v_xor_b32 v3, 0x4000, v3
  v_cvt_pk_bf16_f32 v54, v108, v109
  v_mfma_f32_16x16x32_bf16 v[84:87], a[24:27], a[168:171], v[84:87]
  v_exp_f32 v115, v115
  v_mfma_f32_16x16x32_bf16 v[84:87], a[28:31], a[172:175], v[84:87]
  buffer_load_dwordx4 v2, s[20:23], s29 offen offset:0 sc1 lds
  v_mfma_f32_16x16x32_bf16 v[92:95], a[16:19], a[176:179], v[28:31]
  v_exp_f32 v116, v116
  v_mfma_f32_16x16x32_bf16 v[92:95], a[20:23], a[180:183], v[92:95]
  ds_read_b128 a[0:3], v3 offset:0
  ds_read_b128 a[4:7], v3 offset:1024
  v_mfma_f32_16x16x32_bf16 v[92:95], a[24:27], a[184:187], v[92:95]
  v_exp_f32 v117, v117
  v_mfma_f32_16x16x32_bf16 v[92:95], a[28:31], a[188:191], v[92:95]
  s_waitcnt lgkmcnt(6)
  ds_read_b128 a[8:11], v3 offset:2048
  v_cvt_pk_bf16_f32 v55, v110, v111
  v_mfma_f32_16x16x32_bf16 v[160:163], a[32:35], v[36:39], v[160:163]
  ds_read_b128 a[12:15], v3 offset:3072
  v_cvt_pk_bf16_f32 v56, v112, v113
  v_mfma_f32_16x16x32_bf16 v[192:195], a[32:35], v[40:43], v[192:195]
  v_exp_f32 v118, v118
  v_mfma_f32_16x16x32_bf16 v[224:227], a[32:35], v[44:47], v[224:227]
  buffer_load_dwordx4 v2, s[20:23], s29 offen offset:1024 sc1 lds
  v_mfma_f32_16x16x32_bf16 a[196:199], a[208:211], v[36:39], a[196:199]
  v_exp_f32 v119, v119
  v_mfma_f32_16x16x32_bf16 v[164:167], a[36:39], v[36:39], v[164:167]
  ds_read_b128 a[16:19], v3 offset:4096
  v_cvt_pk_bf16_f32 v57, v114, v115
  v_mfma_f32_16x16x32_bf16 v[196:199], a[36:39], v[40:43], v[196:199]
  v_cvt_pk_bf16_f32 v58, v116, v117
  v_cvt_pk_bf16_f32 v59, v118, v119
  v_mfma_f32_16x16x32_bf16 v[228:231], a[36:39], v[44:47], v[228:231]
  v_exp_f32 v120, v120
  v_mfma_f32_16x16x32_bf16 a[200:203], a[208:211], v[40:43], a[200:203]
  v_mfma_f32_16x16x32_bf16 v[168:171], a[40:43], v[36:39], v[168:171]
  v_exp_f32 v121, v121
  v_mfma_f32_16x16x32_bf16 v[200:203], a[40:43], v[40:43], v[200:203]
  buffer_load_dwordx4 v2, s[20:23], s29 offen offset:2048 sc1 lds
  v_mfma_f32_16x16x32_bf16 v[232:235], a[40:43], v[44:47], v[232:235]
  v_exp_f32 v122, v122
  v_mfma_f32_16x16x32_bf16 a[204:207], a[208:211], v[44:47], a[204:207]
  ds_read_b128 a[20:23], v3 offset:5120
  v_cvt_pk_bf16_f32 v60, v120, v121
  v_mfma_f32_16x16x32_bf16 v[172:175], a[44:47], v[36:39], v[172:175]
  ds_read_b128 a[24:27], v3 offset:6144
  v_mfma_f32_16x16x32_bf16 v[204:207], a[44:47], v[40:43], v[204:207]
  v_exp_f32 v123, v123
  v_mfma_f32_16x16x32_bf16 v[236:239], a[44:47], v[44:47], v[236:239]
  s_waitcnt lgkmcnt(7)
  v_cvt_pk_bf16_f32 v61, v122, v123
  v_mfma_f32_16x16x32_bf16 v[176:179], a[48:51], v[36:39], v[176:179]
  v_exp_f32 v124, v124
  v_mfma_f32_16x16x32_bf16 v[208:211], a[48:51], v[40:43], v[208:211]
  buffer_load_dwordx4 v2, s[20:23], s29 offen offset:3072 sc1 lds
  v_mfma_f32_16x16x32_bf16 v[240:243], a[48:51], v[44:47], v[240:243]
  s_xor_b32 s27, s27, 0x4000
  v_exp_f32 v125, v125
  v_mfma_f32_16x16x32_bf16 v[180:183], a[52:55], v[36:39], v[180:183]
  s_add_u32 s29, s29, 0x8000
  ds_read_b128 a[28:31], v3 offset:7168
  ds_read_b128 a[32:35], v3 offset:8192
  v_mfma_f32_16x16x32_bf16 v[212:215], a[52:55], v[40:43], v[212:215]
  v_cvt_pk_bf16_f32 v62, v124, v125
  v_mfma_f32_16x16x32_bf16 v[244:247], a[52:55], v[44:47], v[244:247]
  v_exp_f32 v126, v126
  v_mfma_f32_16x16x32_bf16 v[184:187], a[56:59], v[36:39], v[184:187]
  ds_read_b128 a[36:39], v3 offset:9216
  v_mfma_f32_16x16x32_bf16 v[216:219], a[56:59], v[40:43], v[216:219]
  v_exp_f32 v127, v127
  v_mfma_f32_16x16x32_bf16 v[248:251], a[56:59], v[44:47], v[248:251]
  v_cvt_pk_bf16_f32 v63, v126, v127
  v_mfma_f32_16x16x32_bf16 v[188:191], a[60:63], v[36:39], v[188:191]
  ds_read_b128 a[40:43], v3 offset:10240
  v_mfma_f32_16x16x32_bf16 v[220:223], a[60:63], v[40:43], v[220:223]
  s_waitcnt vmcnt(12)
  s_barrier
  v_mfma_f32_16x16x32_bf16 v[252:255], a[60:63], v[44:47], v[252:255]
  s_waitcnt lgkmcnt(3)
  v_mfma_f32_16x16x32_bf16 v[96:99], a[0:3], a[160:163], v[24:27]
  s_mov_b32 m0, s26
  v_exp_f32 v64, v64
  v_mfma_f32_16x16x32_bf16 v[96:99], a[4:7], a[164:167], v[96:99]
  v_exp_f32 v65, v65
  v_mfma_f32_16x16x32_bf16 v[96:99], a[8:11], a[168:171], v[96:99]
  buffer_load_dwordx4 v2, s[20:23], s28 offen offset:0 sc1 lds
  v_mfma_f32_16x16x32_bf16 v[96:99], a[12:15], a[172:175], v[96:99]
  v_exp_f32 v66, v66
  v_mfma_f32_16x16x32_bf16 v[104:107], a[0:3], a[176:179], v[28:31]
  ds_read_b128 a[44:47], v3 offset:11264
  ds_read_b128 a[48:51], v3 offset:12288
  v_mfma_f32_16x16x32_bf16 v[104:107], a[4:7], a[180:183], v[104:107]
  v_exp_f32 v67, v67
  v_mfma_f32_16x16x32_bf16 v[104:107], a[8:11], a[184:187], v[104:107]
  ds_read_b128 a[52:55], v3 offset:13312
  ds_read_b128 a[56:59], v3 offset:14336
  v_mfma_f32_16x16x32_bf16 v[104:107], a[12:15], a[188:191], v[104:107]
  v_exp_f32 v68, v68
  v_mfma_f32_16x16x32_bf16 v[100:103], a[16:19], a[160:163], v[24:27]
  v_exp_f32 v69, v69
  v_mfma_f32_16x16x32_bf16 v[100:103], a[20:23], a[164:167], v[100:103]
  ds_read_b128 a[60:63], v3 offset:15360
  v_cvt_pk_bf16_f32 v32, v64, v65
  v_mfma_f32_16x16x32_bf16 v[100:103], a[24:27], a[168:171], v[100:103]
  v_exp_f32 v70, v70
  v_mfma_f32_16x16x32_bf16 v[100:103], a[28:31], a[172:175], v[100:103]
  ds_read_b128 a[0:3], v4 offset:8192
  v_cvt_pk_bf16_f32 v33, v66, v67
  v_mfma_f32_16x16x32_bf16 v[108:111], a[16:19], a[176:179], v[28:31]
  v_exp_f32 v71, v71
  v_mfma_f32_16x16x32_bf16 v[108:111], a[20:23], a[180:183], v[108:111]
  buffer_load_dwordx4 v2, s[20:23], s28 offen offset:1024 sc1 lds
  v_mfma_f32_16x16x32_bf16 v[108:111], a[24:27], a[184:187], v[108:111]
  v_exp_f32 v72, v72
  v_mfma_f32_16x16x32_bf16 v[108:111], a[28:31], a[188:191], v[108:111]
  s_waitcnt lgkmcnt(1)
  ds_read_b128 a[4:7], v4 offset:9216
  ds_read_b128 a[8:11], v4 offset:10240
  v_mfma_f32_16x16x32_bf16 v[112:115], a[32:35], a[160:163], v[24:27]
  v_exp_f32 v73, v73
  v_mfma_f32_16x16x32_bf16 v[112:115], a[36:39], a[164:167], v[112:115]
  v_exp_f32 v74, v74
  v_mfma_f32_16x16x32_bf16 v[112:115], a[40:43], a[168:171], v[112:115]
  ds_read_b128 a[12:15], v4 offset:11264
  ds_read_b128 a[16:19], v4 offset:12288
  v_mfma_f32_16x16x32_bf16 v[112:115], a[44:47], a[172:175], v[112:115]
  v_exp_f32 v75, v75
  v_mfma_f32_16x16x32_bf16 v[120:123], a[32:35], a[176:179], v[28:31]
  ds_read_b128 a[20:23], v4 offset:13312
  v_cvt_pk_bf16_f32 v34, v68, v69
  v_mfma_f32_16x16x32_bf16 v[120:123], a[36:39], a[180:183], v[120:123]
  v_exp_f32 v76, v76
  v_mfma_f32_16x16x32_bf16 v[120:123], a[40:43], a[184:187], v[120:123]
  ds_read_b128 a[24:27], v4 offset:14336
  v_cvt_pk_bf16_f32 v35, v70, v71
  v_mfma_f32_16x16x32_bf16 v[120:123], a[44:47], a[188:191], v[120:123]
  v_exp_f32 v77, v77
  v_mfma_f32_16x16x32_bf16 v[116:119], a[48:51], a[160:163], v[24:27]
  v_exp_f32 v78, v78
  v_mfma_f32_16x16x32_bf16 v[116:119], a[52:55], a[164:167], v[116:119]
  ds_read_b128 a[28:31], v4 offset:15360
  v_xor_b32 v4, 0x8000, v4
  v_mfma_f32_16x16x32_bf16 v[116:119], a[56:59], a[168:171], v[116:119]
  v_exp_f32 v79, v79
  v_mfma_f32_16x16x32_bf16 v[116:119], a[60:63], a[172:175], v[116:119]
  buffer_load_dwordx4 v2, s[20:23], s28 offen offset:2048 sc1 lds
  v_mfma_f32_16x16x32_bf16 v[124:127], a[48:51], a[176:179], v[28:31]
  v_exp_f32 v80, v80
  v_mfma_f32_16x16x32_bf16 v[124:127], a[52:55], a[180:183], v[124:127]
  v_xor_b32 v3, 0x8000, v3
  v_cvt_pk_bf16_f32 v36, v72, v73
  v_mfma_f32_16x16x32_bf16 v[124:127], a[56:59], a[184:187], v[124:127]
  v_exp_f32 v81, v81
  v_mfma_f32_16x16x32_bf16 v[124:127], a[60:63], a[188:191], v[124:127]
  s_waitcnt lgkmcnt(4)
  ds_read_b128 a[32:35], v3 offset:0
  ds_read_b128 a[36:39], v3 offset:1024
  v_mfma_f32_16x16x32_bf16 v[160:163], a[0:3], v[52:55], v[160:163]
  v_exp_f32 v82, v82
  v_mfma_f32_16x16x32_bf16 v[192:195], a[0:3], v[56:59], v[192:195]
  v_exp_f32 v83, v83
  v_mfma_f32_16x16x32_bf16 v[224:227], a[0:3], v[60:63], v[224:227]
  ds_read_b128 a[40:43], v3 offset:2048
  ds_read_b128 a[44:47], v3 offset:3072
  v_mfma_f32_16x16x32_bf16 a[196:199], a[208:211], v[52:55], a[196:199]
  v_exp_f32 v84, v84
  v_mfma_f32_16x16x32_bf16 v[164:167], a[4:7], v[52:55], v[164:167]
  ds_read_b128 a[48:51], v3 offset:4096
  v_cvt_pk_bf16_f32 v37, v74, v75
  v_mfma_f32_16x16x32_bf16 v[196:199], a[4:7], v[56:59], v[196:199]
  v_exp_f32 v85, v85
  v_mfma_f32_16x16x32_bf16 v[228:231], a[4:7], v[60:63], v[228:231]
  v_cvt_pk_bf16_f32 v38, v76, v77
  v_cvt_pk_bf16_f32 v39, v78, v79
  v_mfma_f32_16x16x32_bf16 a[200:203], a[208:211], v[56:59], a[200:203]
  v_exp_f32 v86, v86
  v_mfma_f32_16x16x32_bf16 v[168:171], a[8:11], v[52:55], v[168:171]
  v_exp_f32 v87, v87
  v_mfma_f32_16x16x32_bf16 v[200:203], a[8:11], v[56:59], v[200:203]
  buffer_load_dwordx4 v2, s[20:23], s28 offen offset:3072 sc1 lds
  v_mfma_f32_16x16x32_bf16 v[232:235], a[8:11], v[60:63], v[232:235]
  s_xor_b32 s26, s26, 0x4000
  v_exp_f32 v88, v88
  v_mfma_f32_16x16x32_bf16 a[204:207], a[208:211], v[60:63], a[204:207]
  s_add_u32 s28, s28, 0x8000
  ds_read_b128 a[52:55], v3 offset:5120
  v_cvt_pk_bf16_f32 v40, v80, v81
  v_mfma_f32_16x16x32_bf16 v[172:175], a[12:15], v[52:55], v[172:175]
  v_exp_f32 v89, v89
  v_mfma_f32_16x16x32_bf16 v[204:207], a[12:15], v[56:59], v[204:207]
  ds_read_b128 a[56:59], v3 offset:6144
  v_cvt_pk_bf16_f32 v41, v82, v83
  v_mfma_f32_16x16x32_bf16 v[236:239], a[12:15], v[60:63], v[236:239]
  s_waitcnt lgkmcnt(7)
  v_exp_f32 v90, v90
  v_mfma_f32_16x16x32_bf16 v[176:179], a[16:19], v[52:55], v[176:179]
  ds_read_b128 a[60:63], v3 offset:7168
  v_cvt_pk_bf16_f32 v42, v84, v85
  v_mfma_f32_16x16x32_bf16 v[208:211], a[16:19], v[56:59], v[208:211]
  v_exp_f32 v91, v91
  v_mfma_f32_16x16x32_bf16 v[240:243], a[16:19], v[60:63], v[240:243]
  v_exp_f32 v92, v92
  v_mfma_f32_16x16x32_bf16 v[180:183], a[20:23], v[52:55], v[180:183]
  ds_read_b128 a[0:3], v3 offset:8192
  v_cvt_pk_bf16_f32 v43, v86, v87
  v_mfma_f32_16x16x32_bf16 v[212:215], a[20:23], v[56:59], v[212:215]
  v_exp_f32 v93, v93
  v_mfma_f32_16x16x32_bf16 v[244:247], a[20:23], v[60:63], v[244:247]
  v_cvt_pk_bf16_f32 v44, v88, v89
  v_cvt_pk_bf16_f32 v45, v90, v91
  v_mfma_f32_16x16x32_bf16 v[184:187], a[24:27], v[52:55], v[184:187]
  v_exp_f32 v94, v94
  v_mfma_f32_16x16x32_bf16 v[216:219], a[24:27], v[56:59], v[216:219]
  ds_read_b128 a[4:7], v3 offset:9216
  v_cvt_pk_bf16_f32 v46, v92, v93
  v_mfma_f32_16x16x32_bf16 v[248:251], a[24:27], v[60:63], v[248:251]
  v_exp_f32 v95, v95
  v_mfma_f32_16x16x32_bf16 v[188:191], a[28:31], v[52:55], v[188:191]
  ds_read_b128 a[8:11], v3 offset:10240
  v_cvt_pk_bf16_f32 v47, v94, v95
  v_mfma_f32_16x16x32_bf16 v[220:223], a[28:31], v[56:59], v[220:223]
  s_waitcnt vmcnt(8)
  s_barrier
  v_mfma_f32_16x16x32_bf16 v[252:255], a[28:31], v[60:63], v[252:255]
  s_lshl_b32 s4, s25, 20
  s_lshl_b32 s5, s24, 15
  s_add_u32 s4, s4, s5
  s_lshl_b32 s5, s3, 11
  s_add_u32 s4, s4, s5
  v_accvgpr_read_b32 v6, a192
  v_accvgpr_read_b32 v8, a196
  s_mov_b32 s5, 0x5f800000
  v_cmp_ngt_f32 vcc, s5, v6
  v_rcp_f32 v6, v6
  s_or_b32 s89, s89, vcc_lo
  s_or_b32 s89, s89, vcc_hi
  v_mov_b32 v7, v6
  v_cmp_ngt_f32 vcc, s5, v8
  v_rcp_f32 v8, v8
  s_or_b32 s89, s89, vcc_lo
  s_or_b32 s89, s89, vcc_hi
  v_mov_b32 v9, v8
  v_pk_mul_f32 v[128:129], v[128:129], v[6:7]
  v_pk_mul_f32 v[130:131], v[130:131], v[6:7]
  v_pk_mul_f32 v[132:133], v[132:133], v[6:7]
  v_pk_mul_f32 v[134:135], v[134:135], v[6:7]
  v_cvt_pk_bf16_f32 v128, v128, v129
  v_cvt_pk_bf16_f32 v129, v130, v131
  v_cvt_pk_bf16_f32 v130, v132, v133
  v_cvt_pk_bf16_f32 v131, v134, v135
  buffer_store_dwordx4 v[128:131], v2, s[16:19], s4 offen offset:0 sc1
  v_pk_mul_f32 v[160:161], v[160:161], v[8:9]
  v_pk_mul_f32 v[162:163], v[162:163], v[8:9]
  v_pk_mul_f32 v[164:165], v[164:165], v[8:9]
  v_pk_mul_f32 v[166:167], v[166:167], v[8:9]
  v_cvt_pk_bf16_f32 v160, v160, v161
  v_cvt_pk_bf16_f32 v161, v162, v163
  v_cvt_pk_bf16_f32 v162, v164, v165
  v_cvt_pk_bf16_f32 v163, v166, v167
  buffer_store_dwordx4 v[160:163], v2, s[16:19], s4 offen offset:1024 sc1
  s_add_u32 s4, s4, 8192
  v_pk_mul_f32 v[136:137], v[136:137], v[6:7]
  v_pk_mul_f32 v[138:139], v[138:139], v[6:7]
  v_pk_mul_f32 v[140:141], v[140:141], v[6:7]
  v_pk_mul_f32 v[142:143], v[142:143], v[6:7]
  v_cvt_pk_bf16_f32 v136, v136, v137
  v_cvt_pk_bf16_f32 v137, v138, v139
  v_cvt_pk_bf16_f32 v138, v140, v141
  v_cvt_pk_bf16_f32 v139, v142, v143
  buffer_store_dwordx4 v[136:139], v2, s[16:19], s4 offen offset:0 sc1
  v_pk_mul_f32 v[168:169], v[168:169], v[8:9]
  v_pk_mul_f32 v[170:171], v[170:171], v[8:9]
  v_pk_mul_f32 v[172:173], v[172:173], v[8:9]
  v_pk_mul_f32 v[174:175], v[174:175], v[8:9]
  v_cvt_pk_bf16_f32 v168, v168, v169
  v_cvt_pk_bf16_f32 v169, v170, v171
  v_cvt_pk_bf16_f32 v170, v172, v173
  v_cvt_pk_bf16_f32 v171, v174, v175
  buffer_store_dwordx4 v[168:171], v2, s[16:19], s4 offen offset:1024 sc1
  s_add_u32 s4, s4, 8192
  v_pk_mul_f32 v[144:145], v[144:145], v[6:7]
  v_pk_mul_f32 v[146:147], v[146:147], v[6:7]
  v_pk_mul_f32 v[148:149], v[148:149], v[6:7]
  v_pk_mul_f32 v[150:151], v[150:151], v[6:7]
  v_cvt_pk_bf16_f32 v144, v144, v145
  v_cvt_pk_bf16_f32 v145, v146, v147
  v_cvt_pk_bf16_f32 v146, v148, v149
  v_cvt_pk_bf16_f32 v147, v150, v151
  buffer_store_dwordx4 v[144:147], v2, s[16:19], s4 offen offset:0 sc1
  v_pk_mul_f32 v[176:177], v[176:177], v[8:9]
  v_pk_mul_f32 v[178:179], v[178:179], v[8:9]
  v_pk_mul_f32 v[180:181], v[180:181], v[8:9]
  v_pk_mul_f32 v[182:183], v[182:183], v[8:9]
  v_cvt_pk_bf16_f32 v176, v176, v177
  v_cvt_pk_bf16_f32 v177, v178, v179
  v_cvt_pk_bf16_f32 v178, v180, v181
  v_cvt_pk_bf16_f32 v179, v182, v183
  buffer_store_dwordx4 v[176:179], v2, s[16:19], s4 offen offset:1024 sc1
  s_add_u32 s4, s4, 8192
  v_pk_mul_f32 v[152:153], v[152:153], v[6:7]
  v_pk_mul_f32 v[154:155], v[154:155], v[6:7]
  v_pk_mul_f32 v[156:157], v[156:157], v[6:7]
  v_pk_mul_f32 v[158:159], v[158:159], v[6:7]
  v_cvt_pk_bf16_f32 v152, v152, v153
  v_cvt_pk_bf16_f32 v153, v154, v155
  v_cvt_pk_bf16_f32 v154, v156, v157
  v_cvt_pk_bf16_f32 v155, v158, v159
  buffer_store_dwordx4 v[152:155], v2, s[16:19], s4 offen offset:0 sc1
  v_pk_mul_f32 v[184:185], v[184:185], v[8:9]
  v_pk_mul_f32 v[186:187], v[186:187], v[8:9]
  v_pk_mul_f32 v[188:189], v[188:189], v[8:9]
  v_pk_mul_f32 v[190:191], v[190:191], v[8:9]
  v_cvt_pk_bf16_f32 v184, v184, v185
  v_cvt_pk_bf16_f32 v185, v186, v187
  v_cvt_pk_bf16_f32 v186, v188, v189
  v_cvt_pk_bf16_f32 v187, v190, v191
  buffer_store_dwordx4 v[184:187], v2, s[16:19], s4 offen offset:1024 sc1
  s_and_b32 s88, s25, 1
  s_lshl_b32 s88, s88, 1
  s_add_u32 s88, s88, 14
  s_sub_u32 s88, s88, s25
  s_sub_u32 s88, s88, s25
  s_sub_u32 s88, s88, 1
  .p2align 6
La_so:
  s_waitcnt lgkmcnt(3)
  v_mfma_f32_16x16x32_bf16 v[64:67], a[32:35], a[160:163], v[24:27]
  v_exp_f32 v96, v96
  v_mfma_f32_16x16x32_bf16 v[64:67], a[36:39], a[164:167], v[64:67]
  buffer_store_dwordx4 a[244:247], v2, s[64:67], s90 offen offset:0 sc1
  v_mfma_f32_16x16x32_bf16 v[64:67], a[40:43], a[168:171], v[64:67]
  v_exp_f32 v97, v97
  v_mfma_f32_16x16x32_bf16 v[64:67], a[44:47], a[172:175], v[64:67]
  ds_read_b128 a[12:15], v3 offset:11264
  ds_read_b128 a[16:19], v3 offset:12288
  v_mfma_f32_16x16x32_bf16 v[72:75], a[32:35], a[176:179], v[28:31]
  v_exp_f32 v98, v98
  v_mfma_f32_16x16x32_bf16 v[72:75], a[36:39], a[180:183], v[72:75]
  ds_read_b128 a[20:23], v3 offset:13312
  v_cvt_pk_bf16_f32 v48, v96, v97
  v_mfma_f32_16x16x32_bf16 v[72:75], a[40:43], a[184:187], v[72:75]
  v_exp_f32 v99, v99
  v_mfma_f32_16x16x32_bf16 v[72:75], a[44:47], a[188:191], v[72:75]
  buffer_store_dwordx4 a[244:247], v2, s[64:67], s90 offen offset:1024 sc1
  v_mfma_f32_16x16x32_bf16 v[68:71], a[48:51], a[160:163], v[24:27]
  s_add_u32 s90, s90, 2048
  v_exp_f32 v100, v100
  v_mfma_f32_16x16x32_bf16 v[68:71], a[52:55], a[164:167], v[68:71]
  s_mov_b32 m0, s26
  ds_read_b128 a[24:27], v3 offset:14336
  ds_read_b128 a[28:31], v3 offset:15360
  v_mfma_f32_16x16x32_bf16 v[68:71], a[56:59], a[168:171], v[68:71]
  v_exp_f32 v101, v101
  v_mfma_f32_16x16x32_bf16 v[68:71], a[60:63], a[172:175], v[68:71]
  ds_read_b128 a[32:35], v4 offset:0
  v_cvt_pk_bf16_f32 v49, v98, v99
  v_mfma_f32_16x16x32_bf16 v[76:79], a[48:51], a[176:179], v[28:31]
  v_exp_f32 v102, v102
  v_mfma_f32_16x16x32_bf16 v[76:79], a[52:55], a[180:183], v[76:79]
  buffer_load_dwordx4 v2, s[20:23], s28 offen offset:0 sc1 lds
  v_mfma_f32_16x16x32_bf16 v[76:79], a[56:59], a[184:187], v[76:79]
  v_exp_f32 v103, v103
  v_mfma_f32_16x16x32_bf16 v[76:79], a[60:63], a[188:191], v[76:79]
  s_waitcnt lgkmcnt(1)
  ds_read_b128 a[36:39], v4 offset:1024
  ds_read_b128 a[40:43], v4 offset:2048
  v_mfma_f32_16x16x32_bf16 v[80:83], a[0:3], a[160:163], v[24:27]
  v_exp_f32 v104, v104
  v_mfma_f32_16x16x32_bf16 v[80:83], a[4:7], a[164:167], v[80:83]
  ds_read_b128 a[44:47], v4 offset:3072
  v_cvt_pk_bf16_f32 v50, v100, v101
  v_mfma_f32_16x16x32_bf16 v[80:83], a[8:11], a[168:171], v[80:83]
  v_exp_f32 v105, v105
  v_mfma_f32_16x16x32_bf16 v[80:83], a[12:15], a[172:175], v[80:83]
  buffer_load_dwordx4 v2, s[20:23], s28 offen offset:1024 sc1 lds
  v_mfma_f32_16x16x32_bf16 v[88:91], a[0:3], a[176:179], v[28:31]
  v_exp_f32 v106, v106
  v_mfma_f32_16x16x32_bf16 v[88:91], a[4:7], a[180:183], v[88:91]
  ds_read_b128 a[48:51], v4 offset:4096
  ds_read_b128 a[52:55], v4 offset:5120
  v_mfma_f32_16x16x32_bf16 v[88:91], a[8:11], a[184:187], v[88:91]
  v_exp_f32 v107, v107
  v_mfma_f32_16x16x32_bf16 v[88:91], a[12:15], a[188:191], v[88:91]
  ds_read_b128 a[56:59], v4 offset:6144
  v_cvt_pk_bf16_f32 v51, v102, v103
  v_mfma_f32_16x16x32_bf16 v[84:87], a[16:19], a[160:163], v[24:27]
  v_exp_f32 v108, v108
  v_mfma_f32_16x16x32_bf16 v[84:87], a[20:23], a[164:167], v[84:87]
  buffer_load_dwordx4 v2, s[20:23], s28 offen offset:2048 sc1 lds
  v_mfma_f32_16x16x32_bf16 v[84:87], a[24:27], a[168:171], v[84:87]
  v_exp_f32 v109, v109
  v_mfma_f32_16x16x32_bf16 v[84:87], a[28:31], a[172:175], v[84:87]
  ds_read_b128 a[60:63], v4 offset:7168
  ds_read_b128 a[0:3], v4 offset:8192
  v_mfma_f32_16x16x32_bf16 v[92:95], a[16:19], a[176:179], v[28:31]
  v_exp_f32 v110, v110
  v_mfma_f32_16x16x32_bf16 v[92:95], a[20:23], a[180:183], v[92:95]
  ds_read_b128 a[4:7], v4 offset:9216
  v_cvt_pk_bf16_f32 v52, v104, v105
  v_mfma_f32_16x16x32_bf16 v[92:95], a[24:27], a[184:187], v[92:95]
  v_exp_f32 v111, v111
  v_mfma_f32_16x16x32_bf16 v[92:95], a[28:31], a[188:191], v[92:95]
  s_waitcnt lgkmcnt(2)
  ds_read_b128 a[8:11], v4 offset:10240
  v_cvt_pk_bf16_f32 v53, v106, v107
  v_mfma_f32_16x16x32_bf16 v[192:195], a[32:35], v[32:35], v[192:195]
  buffer_load_dwordx4 v2, s[20:23], s28 offen offset:3072 sc1 lds
  v_mfma_f32_16x16x32_bf16 v[224:227], a[32:35], v[36:39], v[224:227]
  s_xor_b32 s26, s26, 0x8000
  v_exp_f32 v112, v112
  v_mfma_f32_16x16x32_bf16 a[200:203], a[208:211], v[32:35], a[200:203]
  s_add_u32 s28, s28, 0x8000
  s_mov_b32 m0, s27
  ds_read_b128 a[12:15], v4 offset:11264
  v_mfma_f32_16x16x32_bf16 v[196:199], a[36:39], v[32:35], v[196:199]
  s_sub_u32 s88, s88, 1
  v_exp_f32 v113, v113
  v_mfma_f32_16x16x32_bf16 v[228:231], a[36:39], v[36:39], v[228:231]
  ds_read_b128 a[16:19], v4 offset:12288
  v_cvt_pk_bf16_f32 v54, v108, v109
  v_mfma_f32_16x16x32_bf16 a[204:207], a[208:211], v[36:39], a[204:207]
  v_exp_f32 v114, v114
  v_mfma_f32_16x16x32_bf16 v[200:203], a[40:43], v[32:35], v[200:203]
  buffer_load_dwordx4 v2, s[20:23], s29 offen offset:0 sc1 lds
  v_mfma_f32_16x16x32_bf16 v[232:235], a[40:43], v[36:39], v[232:235]
  v_exp_f32 v115, v115
  v_mfma_f32_16x16x32_bf16 v[204:207], a[44:47], v[32:35], v[204:207]
  ds_read_b128 a[20:23], v4 offset:13312
  ds_read_b128 a[24:27], v4 offset:14336
  v_mfma_f32_16x16x32_bf16 v[236:239], a[44:47], v[36:39], v[236:239]
  v_exp_f32 v116, v116
  v_mfma_f32_16x16x32_bf16 v[208:211], a[48:51], v[32:35], v[208:211]
  ds_read_b128 a[28:31], v4 offset:15360
  v_xor_b32 v4, 0x4000, v4
  v_mfma_f32_16x16x32_bf16 v[240:243], a[48:51], v[36:39], v[240:243]
  v_exp_f32 v117, v117
  v_mfma_f32_16x16x32_bf16 v[212:215], a[52:55], v[32:35], v[212:215]
  buffer_load_dwordx4 v2, s[20:23], s29 offen offset:1024 sc1 lds
  v_mfma_f32_16x16x32_bf16 v[244:247], a[52:55], v[36:39], v[244:247]
  v_exp_f32 v118, v118
  v_mfma_f32_16x16x32_bf16 v[216:219], a[56:59], v[32:35], v[216:219]
  v_xor_b32 v3, 0x4000, v3
  v_cvt_pk_bf16_f32 v55, v110, v111
  v_mfma_f32_16x16x32_bf16 v[248:251], a[56:59], v[36:39], v[248:251]
  v_exp_f32 v119, v119
  v_mfma_f32_16x16x32_bf16 v[220:223], a[60:63], v[32:35], v[220:223]
  ds_read_b128 a[32:35], v3 offset:0
  ds_read_b128 a[36:39], v3 offset:1024
  v_mfma_f32_16x16x32_bf16 v[252:255], a[60:63], v[36:39], v[252:255]
  s_waitcnt lgkmcnt(2)
  v_exp_f32 v120, v120
  v_mfma_f32_16x16x32_bf16 v[192:195], a[0:3], v[40:43], v[192:195]
  ds_read_b128 a[40:43], v3 offset:2048
  ds_read_b128 a[44:47], v3 offset:3072
  v_mfma_f32_16x16x32_bf16 v[224:227], a[0:3], v[44:47], v[224:227]
  v_exp_f32 v121, v121
  v_mfma_f32_16x16x32_bf16 a[200:203], a[208:211], v[40:43], a[200:203]
  buffer_load_dwordx4 v2, s[20:23], s29 offen offset:2048 sc1 lds
  v_mfma_f32_16x16x32_bf16 v[196:199], a[4:7], v[40:43], v[196:199]
  v_exp_f32 v122, v122
  v_mfma_f32_16x16x32_bf16 v[228:231], a[4:7], v[44:47], v[228:231]
  ds_read_b128 a[48:51], v3 offset:4096
  v_cvt_pk_bf16_f32 v56, v112, v113
  v_mfma_f32_16x16x32_bf16 a[204:207], a[208:211], v[44:47], a[204:207]
  v_exp_f32 v123, v123
  v_mfma_f32_16x16x32_bf16 v[200:203], a[8:11], v[40:43], v[200:203]
  ds_read_b128 a[52:55], v3 offset:5120
  v_cvt_pk_bf16_f32 v57, v114, v115
  v_mfma_f32_16x16x32_bf16 v[232:235], a[8:11], v[44:47], v[232:235]
  v_exp_f32 v124, v124
  v_mfma_f32_16x16x32_bf16 v[204:207], a[12:15], v[40:43], v[204:207]
  buffer_load_dwordx4 v2, s[20:23], s29 offen offset:3072 sc1 lds
  v_mfma_f32_16x16x32_bf16 v[236:239], a[12:15], v[44:47], v[236:239]
  s_xor_b32 s27, s27, 0x8000
  v_exp_f32 v125, v125
  v_mfma_f32_16x16x32_bf16 v[208:211], a[16:19], v[40:43], v[208:211]
  s_add_u32 s29, s29, 0x8000
  ds_read_b128 a[56:59], v3 offset:6144
  ds_read_b128 a[60:63], v3 offset:7168
  v_mfma_f32_16x16x32_bf16 v[240:243], a[16:19], v[44:47], v[240:243]
  v_exp_f32 v126, v126
  v_mfma_f32_16x16x32_bf16 v[212:215], a[20:23], v[40:43], v[212:215]
  ds_read_b128 a[0:3], v3 offset:8192
  v_cvt_pk_bf16_f32 v58, v116, v117
  v_mfma_f32_16x16x32_bf16 v[244:247], a[20:23], v[44:47], v[244:247]
  v_exp_f32 v127, v127
  v_mfma_f32_16x16x32_bf16 v[216:219], a[24:27], v[40:43], v[216:219]
  ds_read_b128 a[4:7], v3 offset:9216
  v_cvt_pk_bf16_f32 v59, v118, v119
  v_cvt_pk_bf16_f32 v63, v126, v127
  v_mfma_f32_16x16x32_bf16 v[248:251], a[24:27], v[44:47], v[248:251]
  v_cvt_pk_bf16_f32 v60, v120, v121
  v_cvt_pk_bf16_f32 v61, v122, v123
  v_mfma_f32_16x16x32_bf16 v[220:223], a[28:31], v[40:43], v[220:223]
  s_waitcnt vmcnt(10)
  s_barrier
  v_mfma_f32_16x16x32_bf16 v[252:255], a[28:31], v[44:47], v[252:255]
  ds_read_b128 a[8:11], v3 offset:10240
  v_cvt_pk_bf16_f32 v62, v124, v125
  s_cmp_eq_u32 s88, 0
  s_cbranch_scc1 La_e0
  s_waitcnt lgkmcnt(3)
  v_mfma_f32_16x16x32_bf16 v[96:99], a[32:35], a[160:163], v[24:27]
  s_mov_b32 m0, s26
  v_exp_f32 v64, v64
  v_mfma_f32_16x16x32_bf16 v[96:99], a[36:39], a[164:167], v[96:99]
  buffer_load_dwordx4 v2, s[20:23], s28 offen offset:0 sc1 lds
  v_mfma_f32_16x16x32_bf16 v[96:99], a[40:43], a[168:171], v[96:99]
  v_exp_f32 v65, v65
  v_mfma_f32_16x16x32_bf16 v[96:99], a[44:47], a[172:175], v[96:99]
  ds_read_b128 a[12:15], v3 offset:11264
  ds_read_b128 a[16:19], v3 offset:12288
  v_mfma_f32_16x16x32_bf16 v[104:107], a[32:35], a[176:179], v[28:31]
  v_exp_f32 v66, v66
  v_mfma_f32_16x16x32_bf16 v[104:107], a[36:39], a[180:183], v[104:107]
  ds_read_b128 a[20:23], v3 offset:13312
  v_cvt_pk_bf16_f32 v32, v64, v65
  v_mfma_f32_16x16x32_bf16 v[104:107], a[40:43], a[184:187], v[104:107]
  v_exp_f32 v67, v67
  v_mfma_f32_16x16x32_bf16 v[104:107], a[44:47], a[188:191], v[104:107]
  ds_read_b128 a[24:27], v3 offset:14336
  v_cvt_pk_bf16_f32 v33, v66, v67
  v_mfma_f32_16x16x32_bf16 v[100:103], a[48:51], a[160:163], v[24:27]
  v_exp_f32 v68, v68
  v_mfma_f32_16x16x32_bf16 v[100:103], a[52:55], a[164:167], v[100:103]
  buffer_load_dwordx4 v2, s[20:23], s28 offen offset:1024 sc1 lds
  v_mfma_f32_16x16x32_bf16 v[100:103], a[56:59], a[168:171], v[100:103]
  v_exp_f32 v69, v69
  v_mfma_f32_16x16x32_bf16 v[100:103], a[60:63], a[172:175], v[100:103]
  ds_read_b128 a[28:31], v3 offset:15360
  ds_read_b128 a[32:35], v4 offset:0
  v_mfma_f32_16x16x32_bf16 v[108:111], a[48:51], a[176:179], v[28:31]
  v_exp_f32 v70, v70
  v_mfma_f32_16x16x32_bf16 v[108:111], a[52:55], a[180:183], v[108:111]
  ds_read_b128 a[36:39], v4 offset:1024
  v_cvt_pk_bf16_f32 v34, v68, v69
  v_mfma_f32_16x16x32_bf16 v[108:111], a[56:59], a[184:187], v[108:111]
  v_exp_f32 v71, v71
  v_mfma_f32_16x16x32_bf16 v[108:111], a[60:63], a[188:191], v[108:111]
  s_waitcnt lgkmcnt(2)
  ds_read_b128 a[40:43], v4 offset:2048
  v_cvt_pk_bf16_f32 v35, v70, v71
  v_mfma_f32_16x16x32_bf16 v[112:115], a[0:3], a[160:163], v[24:27]
  v_exp_f32 v72, v72
  v_mfma_f32_16x16x32_bf16 v[112:115], a[4:7], a[164:167], v[112:115]
  buffer_load_dwordx4 v2, s[20:23], s28 offen offset:2048 sc1 lds
  v_mfma_f32_16x16x32_bf16 v[112:115], a[8:11], a[168:171], v[112:115]
  v_exp_f32 v73, v73
  v_mfma_f32_16x16x32_bf16 v[112:115], a[12:15], a[172:175], v[112:115]
  ds_read_b128 a[44:47], v4 offset:3072
  ds_read_b128 a[48:51], v4 offset:4096
  v_mfma_f32_16x16x32_bf16 v[120:123], a[0:3], a[176:179], v[28:31]
  v_exp_f32 v74, v74
  v_mfma_f32_16x16x32_bf16 v[120:123], a[4:7], a[180:183], v[120:123]
  ds_read_b128 a[52:55], v4 offset:5120
  v_cvt_pk_bf16_f32 v36, v72, v73
  v_mfma_f32_16x16x32_bf16 v[120:123], a[8:11], a[184:187], v[120:123]
  v_exp_f32 v75, v75
  v_mfma_f32_16x16x32_bf16 v[120:123], a[12:15], a[188:191], v[120:123]
  ds_read_b128 a[56:59], v4 offset:6144
  v_cvt_pk_bf16_f32 v37, v74, v75
  v_mfma_f32_16x16x32_bf16 v[116:119], a[16:19], a[160:163], v[24:27]
  v_exp_f32 v76, v76
  v_mfma_f32_16x16x32_bf16 v[116:119], a[20:23], a[164:167], v[116:119]
  buffer_load_dwordx4 v2, s[20:23], s28 offen offset:3072 sc1 lds
  v_mfma_f32_16x16x32_bf16 v[116:119], a[24:27], a[168:171], v[116:119]
  s_xor_b32 s26, s26, 0x4000
  v_exp_f32 v77, v77
  v_mfma_f32_16x16x32_bf16 v[116:119], a[28:31], a[172:175], v[116:119]
  s_add_u32 s28, s28, 0x8000
  s_mov_b32 m0, s27
  ds_read_b128 a[60:63], v4 offset:7168
  v_mfma_f32_16x16x32_bf16 v[124:127], a[16:19], a[176:179], v[28:31]
  v_exp_f32 v78, v78
  v_mfma_f32_16x16x32_bf16 v[124:127], a[20:23], a[180:183], v[124:127]
  ds_read_b128 a[0:3], v4 offset:8192
  ds_read_b128 a[4:7], v4 offset:9216
  v_mfma_f32_16x16x32_bf16 v[124:127], a[24:27], a[184:187], v[124:127]
  v_exp_f32 v79, v79
  v_mfma_f32_16x16x32_bf16 v[124:127], a[28:31], a[188:191], v[124:127]
  s_waitcnt lgkmcnt(2)
  ds_read_b128 a[8:11], v4 offset:10240
  v_cvt_pk_bf16_f32 v38, v76, v77
  v_mfma_f32_16x16x32_bf16 v[192:195], a[32:35], v[48:51], v[192:195]
  buffer_load_dwordx4 v2, s[20:23], s29 offen offset:0 sc1 lds
  v_mfma_f32_16x16x32_bf16 v[224:227], a[32:35], v[52:55], v[224:227]
  v_exp_f32 v80, v80
  v_mfma_f32_16x16x32_bf16 a[200:203], a[208:211], v[48:51], a[200:203]
  ds_read_b128 a[12:15], v4 offset:11264
  v_cvt_pk_bf16_f32 v39, v78, v79
  v_mfma_f32_16x16x32_bf16 v[196:199], a[36:39], v[48:51], v[196:199]
  v_exp_f32 v81, v81
  v_mfma_f32_16x16x32_bf16 v[228:231], a[36:39], v[52:55], v[228:231]
  ds_read_b128 a[16:19], v4 offset:12288
  v_cvt_pk_bf16_f32 v40, v80, v81
  v_mfma_f32_16x16x32_bf16 a[204:207], a[208:211], v[52:55], a[204:207]
  v_exp_f32 v82, v82
  v_mfma_f32_16x16x32_bf16 v[200:203], a[40:43], v[48:51], v[200:203]
  ds_read_b128 a[20:23], v4 offset:13312
  v_mfma_f32_16x16x32_bf16 v[232:235], a[40:43], v[52:55], v[232:235]
  v_exp_f32 v83, v83
  v_mfma_f32_16x16x32_bf16 v[204:207], a[44:47], v[48:51], v[204:207]
  buffer_load_dwordx4 v2, s[20:23], s29 offen offset:1024 sc1 lds
  v_mfma_f32_16x16x32_bf16 v[236:239], a[44:47], v[52:55], v[236:239]
  v_exp_f32 v84, v84
  v_mfma_f32_16x16x32_bf16 v[208:211], a[48:51], v[48:51], v[208:211]
  ds_read_b128 a[24:27], v4 offset:14336
  ds_read_b128 a[28:31], v4 offset:15360
  v_mfma_f32_16x16x32_bf16 v[240:243], a[48:51], v[52:55], v[240:243]
  v_exp_f32 v85, v85
  v_mfma_f32_16x16x32_bf16 v[212:215], a[52:55], v[48:51], v[212:215]
  v_xor_b32 v4, 0x8000, v4
  v_xor_b32 v3, 0x8000, v3
  v_mfma_f32_16x16x32_bf16 v[244:247], a[52:55], v[52:55], v[244:247]
  v_exp_f32 v86, v86
  v_mfma_f32_16x16x32_bf16 v[216:219], a[56:59], v[48:51], v[216:219]
  ds_read_b128 a[32:35], v3 offset:0
  ds_read_b128 a[36:39], v3 offset:1024
  v_mfma_f32_16x16x32_bf16 v[248:251], a[56:59], v[52:55], v[248:251]
  v_exp_f32 v87, v87
  v_mfma_f32_16x16x32_bf16 v[220:223], a[60:63], v[48:51], v[220:223]
  buffer_load_dwordx4 v2, s[20:23], s29 offen offset:2048 sc1 lds
  v_mfma_f32_16x16x32_bf16 v[252:255], a[60:63], v[52:55], v[252:255]
  s_waitcnt lgkmcnt(2)
  v_exp_f32 v88, v88
  v_mfma_f32_16x16x32_bf16 v[192:195], a[0:3], v[56:59], v[192:195]
  ds_read_b128 a[40:43], v3 offset:2048
  ds_read_b128 a[44:47], v3 offset:3072
  v_mfma_f32_16x16x32_bf16 v[224:227], a[0:3], v[60:63], v[224:227]
  v_exp_f32 v89, v89
  v_mfma_f32_16x16x32_bf16 a[200:203], a[208:211], v[56:59], a[200:203]
  v_cvt_pk_bf16_f32 v41, v82, v83
  v_cvt_pk_bf16_f32 v42, v84, v85
  v_mfma_f32_16x16x32_bf16 v[196:199], a[4:7], v[56:59], v[196:199]
  v_exp_f32 v90, v90
  v_mfma_f32_16x16x32_bf16 v[228:231], a[4:7], v[60:63], v[228:231]
  ds_read_b128 a[48:51], v3 offset:4096
  v_cvt_pk_bf16_f32 v43, v86, v87
  v_mfma_f32_16x16x32_bf16 a[204:207], a[208:211], v[60:63], a[204:207]
  v_exp_f32 v91, v91
  v_mfma_f32_16x16x32_bf16 v[200:203], a[8:11], v[56:59], v[200:203]
  buffer_load_dwordx4 v2, s[20:23], s29 offen offset:3072 sc1 lds
  v_mfma_f32_16x16x32_bf16 v[232:235], a[8:11], v[60:63], v[232:235]
  s_xor_b32 s27, s27, 0x4000
  v_exp_f32 v92, v92
  v_mfma_f32_16x16x32_bf16 v[204:207], a[12:15], v[56:59], v[204:207]
  s_add_u32 s29, s29, 0x8000
  ds_read_b128 a[52:55], v3 offset:5120
  ds_read_b128 a[56:59], v3 offset:6144
  v_mfma_f32_16x16x32_bf16 v[236:239], a[12:15], v[60:63], v[236:239]
  v_exp_f32 v93, v93
  v_mfma_f32_16x16x32_bf16 v[208:211], a[16:19], v[56:59], v[208:211]
  ds_read_b128 a[60:63], v3 offset:7168
  v_cvt_pk_bf16_f32 v44, v88, v89
  v_mfma_f32_16x16x32_bf16 v[240:243], a[16:19], v[60:63], v[240:243]
  v_exp_f32 v94, v94
  v_mfma_f32_16x16x32_bf16 v[212:215], a[20:23], v[56:59], v[212:215]
  ds_read_b128 a[0:3], v3 offset:8192
  v_cvt_pk_bf16_f32 v45, v90, v91
  v_mfma_f32_16x16x32_bf16 v[244:247], a[20:23], v[60:63], v[244:247]
  v_exp_f32 v95, v95
  v_mfma_f32_16x16x32_bf16 v[216:219], a[24:27], v[56:59], v[216:219]
  ds_read_b128 a[4:7], v3 offset:9216
  v_cvt_pk_bf16_f32 v46, v92, v93
  v_mfma_f32_16x16x32_bf16 v[248:251], a[24:27], v[60:63], v[248:251]
  v_cvt_pk_bf16_f32 v47, v94, v95
  v_mfma_f32_16x16x32_bf16 v[220:223], a[28:31], v[56:59], v[220:223]
  s_waitcnt vmcnt(12)
  s_barrier
  v_mfma_f32_16x16x32_bf16 v[252:255], a[28:31], v[60:63], v[252:255]
  ds_read_b128 a[8:11], v3 offset:10240
  s_branch La_so
La_e0:
  s_waitcnt lgkmcnt(7)
  v_mfma_f32_16x16x32_bf16 v[104:107], a[32:35], a[176:179], v[28:31]
  buffer_load_dwordx2 v[12:13], v14, s[96:99], s91 offen sc1
  v_mfma_f32_16x16x32_bf16 v[104:107], a[36:39], a[180:183], v[104:107]
  v_cndmask_b32 v64, v64, v5, s[32:33]
  v_exp_f32 v64, v64
  v_mfma_f32_16x16x32_bf16 v[104:107], a[40:43], a[184:187], v[104:107]
  v_cndmask_b32 v65, v65, v5, s[34:35]
  v_exp_f32 v65, v65
  v_mfma_f32_16x16x32_bf16 v[104:107], a[44:47], a[188:191], v[104:107]
  s_waitcnt lgkmcnt(3)
  v_cndmask_b32 v66, v66, v5, s[36:37]
  v_exp_f32 v66, v66
  v_mfma_f32_16x16x32_bf16 v[108:111], a[48:51], a[176:179], v[28:31]
  v_cndmask_b32 v67, v67, v5, s[38:39]
  v_exp_f32 v67, v67
  v_mfma_f32_16x16x32_bf16 v[108:111], a[52:55], a[180:183], v[108:111]
  ds_read_b128 a[12:15], v3 offset:11264
  ds_read_b128 a[16:19], v3 offset:12288
  v_mfma_f32_16x16x32_bf16 v[108:111], a[56:59], a[184:187], v[108:111]
  v_cndmask_b32 v68, v68, v5, s[40:41]
  v_exp_f32 v68, v68
  v_mfma_f32_16x16x32_bf16 v[108:111], a[60:63], a[188:191], v[108:111]
  s_waitcnt lgkmcnt(1)
  v_cndmask_b32 v69, v69, v5, s[42:43]
  v_exp_f32 v69, v69
  v_mfma_f32_16x16x32_bf16 v[120:123], a[0:3], a[176:179], v[28:31]
  ds_read_b128 a[20:23], v3 offset:13312
  ds_read_b128 a[24:27], v3 offset:14336
  ds_read_b128 a[28:31], v3 offset:15360
  v_mfma_f32_16x16x32_bf16 v[120:123], a[4:7], a[180:183], v[120:123]
  v_cndmask_b32 v70, v70, v5, s[44:45]
  v_exp_f32 v70, v70
  v_mfma_f32_16x16x32_bf16 v[120:123], a[8:11], a[184:187], v[120:123]
  v_cndmask_b32 v71, v71, v5, s[46:47]
  v_exp_f32 v71, v71
  v_mfma_f32_16x16x32_bf16 v[120:123], a[12:15], a[188:191], v[120:123]
  s_waitcnt lgkmcnt(0)
  ds_read_b128 a[32:35], v4 offset:0
  ds_read_b128 a[36:39], v4 offset:1024
  v_mfma_f32_16x16x32_bf16 v[124:127], a[16:19], a[176:179], v[28:31]
  v_exp_f32 v72, v72
  v_mfma_f32_16x16x32_bf16 v[124:127], a[20:23], a[180:183], v[124:127]
  ds_read_b128 a[40:43], v4 offset:2048
  ds_read_b128 a[44:47], v4 offset:3072
  ds_read_b128 a[48:51], v4 offset:4096
  v_mfma_f32_16x16x32_bf16 v[124:127], a[24:27], a[184:187], v[124:127]
  ds_read_b128 a[52:55], v4 offset:5120
  ds_read_b128 a[56:59], v4 offset:6144
  ds_read_b128 a[60:63], v4 offset:7168
  v_exp_f32 v73, v73
  v_mfma_f32_16x16x32_bf16 v[124:127], a[28:31], a[188:191], v[124:127]
  s_waitcnt lgkmcnt(0)
  v_exp_f32 v74, v74
  v_mfma_f32_16x16x32_bf16 v[192:195], a[32:35], v[48:51], v[192:195]
  ds_read_b128 a[0:3], v4 offset:8192
  ds_read_b128 a[4:7], v4 offset:9216
  v_mfma_f32_16x16x32_bf16 v[224:227], a[32:35], v[52:55], v[224:227]
  v_exp_f32 v75, v75
  v_mfma_f32_16x16x32_bf16 a[200:203], a[208:211], v[48:51], a[200:203]
  v_exp_f32 v76, v76
  v_mfma_f32_16x16x32_bf16 v[196:199], a[36:39], v[48:51], v[196:199]
  ds_read_b128 a[8:11], v4 offset:10240
  ds_read_b128 a[12:15], v4 offset:11264
  v_mfma_f32_16x16x32_bf16 v[228:231], a[36:39], v[52:55], v[228:231]
  v_exp_f32 v77, v77
  v_mfma_f32_16x16x32_bf16 a[204:207], a[208:211], v[52:55], a[204:207]
  v_exp_f32 v78, v78
  v_mfma_f32_16x16x32_bf16 v[200:203], a[40:43], v[48:51], v[200:203]
  ds_read_b128 a[16:19], v4 offset:12288
  ds_read_b128 a[20:23], v4 offset:13312
  v_mfma_f32_16x16x32_bf16 v[232:235], a[40:43], v[52:55], v[232:235]
  v_exp_f32 v79, v79
  v_mfma_f32_16x16x32_bf16 v[204:207], a[44:47], v[48:51], v[204:207]
  ds_read_b128 a[24:27], v4 offset:14336
  v_cvt_pk_bf16_f32 v32, v64, v65
  v_mfma_f32_16x16x32_bf16 v[236:239], a[44:47], v[52:55], v[236:239]
  v_cndmask_b32 v80, v80, v5, s[48:49]
  v_exp_f32 v80, v80
  v_mfma_f32_16x16x32_bf16 v[208:211], a[48:51], v[48:51], v[208:211]
  v_cndmask_b32 v81, v81, v5, s[50:51]
  v_exp_f32 v81, v81
  v_mfma_f32_16x16x32_bf16 v[240:243], a[48:51], v[52:55], v[240:243]
  ds_read_b128 a[28:31], v4 offset:15360
  v_xor_b32 v4, 0x8000, v4
  v_cvt_pk_bf16_f32 v40, v80, v81
  v_mfma_f32_16x16x32_bf16 v[212:215], a[52:55], v[48:51], v[212:215]
  v_cndmask_b32 v82, v82, v5, s[52:53]
  v_exp_f32 v82, v82
  v_mfma_f32_16x16x32_bf16 v[244:247], a[52:55], v[52:55], v[244:247]
  v_cndmask_b32 v83, v83, v5, s[54:55]
  v_exp_f32 v83, v83
  v_mfma_f32_16x16x32_bf16 v[216:219], a[56:59], v[48:51], v[216:219]
  ds_read_b128 a[32:35], v4 offset:0
  ds_read_b128 a[36:39], v4 offset:1024
  v_cvt_pk_bf16_f32 v41, v82, v83
  v_mfma_f32_16x16x32_bf16 v[248:251], a[56:59], v[52:55], v[248:251]
  v_cndmask_b32 v84, v84, v5, s[56:57]
  v_exp_f32 v84, v84
  v_mfma_f32_16x16x32_bf16 v[220:223], a[60:63], v[48:51], v[220:223]
  v_cndmask_b32 v85, v85, v5, s[58:59]
  v_exp_f32 v85, v85
  v_mfma_f32_16x16x32_bf16 v[252:255], a[60:63], v[52:55], v[252:255]
  s_waitcnt lgkmcnt(2)
  ds_read_b128 a[40:43], v4 offset:2048
  v_cvt_pk_bf16_f32 v33, v66, v67
  v_cvt_pk_bf16_f32 v42, v84, v85
  v_mfma_f32_16x16x32_bf16 v[192:195], a[0:3], v[56:59], v[192:195]
  v_cndmask_b32 v86, v86, v5, s[60:61]
  v_exp_f32 v86, v86
  v_mfma_f32_16x16x32_bf16 v[224:227], a[0:3], v[60:63], v[224:227]
  v_cndmask_b32 v87, v87, v5, s[62:63]
  v_exp_f32 v87, v87
  v_mfma_f32_16x16x32_bf16 a[200:203], a[208:211], v[56:59], a[200:203]
  ds_read_b128 a[44:47], v4 offset:3072
  v_cvt_pk_bf16_f32 v34, v68, v69
  v_cvt_pk_bf16_f32 v43, v86, v87
  v_mfma_f32_16x16x32_bf16 v[196:199], a[4:7], v[56:59], v[196:199]
  v_exp_f32 v88, v88
  v_mfma_f32_16x16x32_bf16 v[228:231], a[4:7], v[60:63], v[228:231]
  ds_read_b128 a[48:51], v4 offset:4096
  v_cvt_pk_bf16_f32 v35, v70, v71
  v_mfma_f32_16x16x32_bf16 a[204:207], a[208:211], v[60:63], a[204:207]
  v_exp_f32 v89, v89
  v_mfma_f32_16x16x32_bf16 v[200:203], a[8:11], v[56:59], v[200:203]
  v_exp_f32 v90, v90
  v_cvt_pk_bf16_f32 v44, v88, v89
  v_mfma_f32_16x16x32_bf16 v[232:235], a[8:11], v[60:63], v[232:235]
  ds_read_b128 a[52:55], v4 offset:5120
  v_cvt_pk_bf16_f32 v36, v72, v73
  v_mfma_f32_16x16x32_bf16 v[204:207], a[12:15], v[56:59], v[204:207]
  v_exp_f32 v91, v91
  v_mfma_f32_16x16x32_bf16 v[236:239], a[12:15], v[60:63], v[236:239]
  v_exp_f32 v92, v92
  v_cvt_pk_bf16_f32 v45, v90, v91
  v_mfma_f32_16x16x32_bf16 v[208:211], a[16:19], v[56:59], v[208:211]
  ds_read_b128 a[56:59], v4 offset:6144
  ds_read_b128 a[60:63], v4 offset:7168
  v_mfma_f32_16x16x32_bf16 v[240:243], a[16:19], v[60:63], v[240:243]
  v_exp_f32 v93, v93
  v_mfma_f32_16x16x32_bf16 v[212:215], a[20:23], v[56:59], v[212:215]
  v_exp_f32 v94, v94
  v_cvt_pk_bf16_f32 v46, v92, v93
  v_mfma_f32_16x16x32_bf16 v[244:247], a[20:23], v[60:63], v[244:247]
  ds_read_b128 a[0:3], v4 offset:8192
  v_cvt_pk_bf16_f32 v37, v74, v75
  v_mfma_f32_16x16x32_bf16 v[216:219], a[24:27], v[56:59], v[216:219]
  v_exp_f32 v95, v95
  v_mfma_f32_16x16x32_bf16 v[248:251], a[24:27], v[60:63], v[248:251]
  ds_read_b128 a[4:7], v4 offset:9216
  v_cvt_pk_bf16_f32 v38, v76, v77
  v_cvt_pk_bf16_f32 v47, v94, v95
  v_mfma_f32_16x16x32_bf16 v[220:223], a[28:31], v[56:59], v[220:223]
  s_waitcnt vmcnt(0)
  s_barrier
  v_mfma_f32_16x16x32_bf16 v[252:255], a[28:31], v[60:63], v[252:255]
  ds_read_b128 a[8:11], v4 offset:10240
  v_cvt_pk_bf16_f32 v39, v78, v79
La_e1:
  s_mov_b32 s5, 0x40000
Lpoll_7:
  v_cmp_ne_u64 vcc, s[94:95], v[12:13]
  s_nop 0
  s_cbranch_vccz Lpolld_8
  s_sleep 4
  buffer_load_dwordx2 v[12:13], v14, s[96:99], s91 offen sc1
  s_sub_u32 s5, s5, 1
  s_waitcnt vmcnt(0)
  s_cbranch_scc0 Lpoll_7
Lpolld_8:
  s_add_u32 s64, s79, 131072
  v_accvgpr_read_b32 v10, a212
  v_accvgpr_read_b32 v11, a213
  v_accvgpr_read_b32 v12, a214
  v_accvgpr_read_b32 v13, a215
  s_mov_b32 s12, s80
  s_mov_b32 s13, s81
  s_mov_b32 s14, 2097152
  s_mov_b32 s15, 0x00020000
  s_lshl_b32 s93, s77, 20
  s_lshl_b32 s72, s76, 8
  s_add_u32 s93, s93, s72
  s_add_u32 s72, s73, s76
  s_and_b32 s31, s72, 3
  s_lshl_b32 s31, s31, 3
  s_or_b32 s31, s31, 0x80000
  s_bfe_u32 s30, 0x70702, s31
  s_add_u32 s30, s30, 0
  s_and_b32 s30, s30, 7
  s_lshl_b32 s72, s30, 17
  s_add_u32 s71, s93, s72
  s_add_u32 s8, s86, 83886080
  s_addc_u32 s9, s87, 0
  s_mov_b32 s10, 4194304
  s_mov_b32 s11, 0x00020000
  s_lshl_b32 s92, s73, 1
  s_add_u32 s92, s92, s77
  s_lshl_b32 s92, s92, 17
  s_add_u32 s92, s92, s79
  s_add_u32 s72, s73, s76
  s_and_b32 s1, s72, 3
  s_lshl_b32 s1, s1, 3
  s_or_b32 s1, s1, 0x80000
  s_bfe_u32 s0, 0x70702, s1
  s_add_u32 s0, s0, 0
  s_and_b32 s0, s0, 7
  s_lshl_b32 s72, s0, 14
  s_add_u32 s70, s92, s72
  s_waitcnt lgkmcnt(3)
  v_mfma_f32_16x16x32_bf16 v[192:195], a[32:35], v[32:35], v[192:195]
  s_add_u32 m0, s79, 147456
  ds_read_b128 a[12:15], v4 offset:11264
  v_cndmask_b32 v104, v104, v5, s[32:33]
  v_mfma_f32_16x16x32_bf16 v[224:227], a[32:35], v[36:39], v[224:227]
  v_exp_f32 v104, v104
  v_mfma_f32_16x16x32_bf16 a[200:203], a[208:211], v[32:35], a[200:203]
  v_cndmask_b32 v105, v105, v5, s[34:35]
  v_exp_f32 v105, v105
  v_mfma_f32_16x16x32_bf16 v[196:199], a[36:39], v[32:35], v[196:199]
  buffer_load_dwordx4 v10, s[12:15], s71 offen offset:0 lds
  v_mfma_f32_16x16x32_bf16 v[228:231], a[36:39], v[36:39], v[228:231]
  v_cndmask_b32 v106, v106, v5, s[36:37]
  v_exp_f32 v106, v106
  v_mfma_f32_16x16x32_bf16 a[204:207], a[208:211], v[36:39], a[204:207]
  buffer_load_dwordx4 v11, s[12:15], s71 offen offset:1024 lds
  v_mfma_f32_16x16x32_bf16 v[200:203], a[40:43], v[32:35], v[200:203]
  v_cndmask_b32 v107, v107, v5, s[38:39]
  v_exp_f32 v107, v107
  v_mfma_f32_16x16x32_bf16 v[232:235], a[40:43], v[36:39], v[232:235]
  ds_read_b128 a[16:19], v4 offset:12288
  ds_read_b128 a[20:23], v4 offset:13312
  v_mfma_f32_16x16x32_bf16 v[204:207], a[44:47], v[32:35], v[204:207]
  v_cndmask_b32 v108, v108, v5, s[40:41]
  v_exp_f32 v108, v108
  v_mfma_f32_16x16x32_bf16 v[236:239], a[44:47], v[36:39], v[236:239]
  buffer_load_dwordx4 v12, s[12:15], s71 offen offset:2048 lds
  v_cvt_pk_bf16_f32 v53, v106, v107
  v_mfma_f32_16x16x32_bf16 v[208:211], a[48:51], v[32:35], v[208:211]
  v_cndmask_b32 v109, v109, v5, s[42:43]
  v_exp_f32 v109, v109
  v_mfma_f32_16x16x32_bf16 v[240:243], a[48:51], v[36:39], v[240:243]
  ds_read_b128 a[24:27], v4 offset:14336
  ds_read_b128 a[28:31], v4 offset:15360
  v_mfma_f32_16x16x32_bf16 v[212:215], a[52:55], v[32:35], v[212:215]
  v_cndmask_b32 v110, v110, v5, s[44:45]
  v_exp_f32 v110, v110
  v_mfma_f32_16x16x32_bf16 v[244:247], a[52:55], v[36:39], v[244:247]
  buffer_load_dwordx4 v13, s[12:15], s71 offen offset:3072 lds
  v_cvt_pk_bf16_f32 v54, v108, v109
  v_mfma_f32_16x16x32_bf16 v[216:219], a[56:59], v[32:35], v[216:219]
  s_bfe_u32 s72, 0x3020106, s31
  v_cndmask_b32 v111, v111, v5, s[46:47]
  v_exp_f32 v111, v111
  v_mfma_f32_16x16x32_bf16 v[248:251], a[56:59], v[36:39], v[248:251]
  s_add_u32 s30, s30, s72
  s_add_u32 s31, s31, 8
  s_and_b32 s31, s31, 0x8001f
  v_mfma_f32_16x16x32_bf16 v[220:223], a[60:63], v[32:35], v[220:223]
  s_and_b32 s30, s30, 7
  s_lshl_b32 s72, s30, 17
  s_add_u32 s71, s93, s72
  v_mfma_f32_16x16x32_bf16 v[252:255], a[60:63], v[36:39], v[252:255]
  s_waitcnt lgkmcnt(0)
  v_cndmask_b32 v120, v120, v5, s[48:49]
  v_exp_f32 v120, v120
  v_mfma_f32_16x16x32_bf16 v[192:195], a[0:3], v[40:43], v[192:195]
  s_add_u32 m0, s79, 131072
  v_xor_b32 v4, 0x4000, v4
  v_cvt_pk_bf16_f32 v52, v104, v105
  v_mfma_f32_16x16x32_bf16 v[224:227], a[0:3], v[44:47], v[224:227]
  v_cndmask_b32 v121, v121, v5, s[50:51]
  v_exp_f32 v121, v121
  v_mfma_f32_16x16x32_bf16 a[200:203], a[208:211], v[40:43], a[200:203]
  buffer_load_dwordx4 v2, s[8:11], s70 offen offset:0 sc1 lds
  v_cvt_pk_bf16_f32 v55, v110, v111
  v_mfma_f32_16x16x32_bf16 v[196:199], a[4:7], v[40:43], v[196:199]
  v_cndmask_b32 v122, v122, v5, s[52:53]
  v_exp_f32 v122, v122
  v_mfma_f32_16x16x32_bf16 v[228:231], a[4:7], v[44:47], v[228:231]
  buffer_load_dwordx4 v2, s[8:11], s70 offen offset:1024 sc1 lds
  v_cvt_pk_bf16_f32 v60, v120, v121
  v_mfma_f32_16x16x32_bf16 a[204:207], a[208:211], v[44:47], a[204:207]
  v_cndmask_b32 v123, v123, v5, s[54:55]
  v_exp_f32 v123, v123
  v_mfma_f32_16x16x32_bf16 v[200:203], a[8:11], v[40:43], v[200:203]
  buffer_load_dwordx4 v2, s[8:11], s70 offen offset:2048 sc1 lds
  v_cvt_pk_bf16_f32 v61, v122, v123
  v_mfma_f32_16x16x32_bf16 v[232:235], a[8:11], v[44:47], v[232:235]
  v_cndmask_b32 v124, v124, v5, s[56:57]
  v_exp_f32 v124, v124
  v_mfma_f32_16x16x32_bf16 v[204:207], a[12:15], v[40:43], v[204:207]
  ds_read_b128 a[32:35], v4 offset:0
  ds_read_b128 a[36:39], v4 offset:1024
  v_mfma_f32_16x16x32_bf16 v[236:239], a[12:15], v[44:47], v[236:239]
  v_cndmask_b32 v125, v125, v5, s[58:59]
  v_exp_f32 v125, v125
  v_mfma_f32_16x16x32_bf16 v[208:211], a[16:19], v[40:43], v[208:211]
  buffer_load_dwordx4 v2, s[8:11], s70 offen offset:3072 sc1 lds
  v_cvt_pk_bf16_f32 v62, v124, v125
  v_mfma_f32_16x16x32_bf16 v[240:243], a[16:19], v[44:47], v[240:243]
  s_bfe_u32 s72, 0x3020106, s1
  v_cndmask_b32 v126, v126, v5, s[60:61]
  v_exp_f32 v126, v126
  v_mfma_f32_16x16x32_bf16 v[212:215], a[20:23], v[40:43], v[212:215]
  s_add_u32 s0, s0, s72
  s_add_u32 s1, s1, 8
  s_and_b32 s1, s1, 0x8001f
  v_mfma_f32_16x16x32_bf16 v[244:247], a[20:23], v[44:47], v[244:247]
  s_and_b32 s0, s0, 7
  v_cndmask_b32 v127, v127, v5, s[62:63]
  v_exp_f32 v127, v127
  v_mfma_f32_16x16x32_bf16 v[216:219], a[24:27], v[40:43], v[216:219]
  s_lshl_b32 s72, s0, 14
  s_add_u32 s70, s92, s72
  ds_read_b128 a[40:43], v4 offset:2048
  v_cvt_pk_bf16_f32 v63, v126, v127
  v_mfma_f32_16x16x32_bf16 v[248:251], a[24:27], v[44:47], v[248:251]
  ds_read_b128 a[44:47], v4 offset:3072
  ds_read_b128 a[48:51], v4 offset:4096
  v_mfma_f32_16x16x32_bf16 v[220:223], a[28:31], v[40:43], v[220:223]
  ds_read_b128 a[52:55], v4 offset:5120
  ds_read_b128 a[56:59], v4 offset:6144
  v_mfma_f32_16x16x32_bf16 v[252:255], a[28:31], v[44:47], v[252:255]
  ds_read_b128 a[60:63], v4 offset:7168
  ds_read_b128 a[0:3], v4 offset:8192
  ds_read_b128 a[4:7], v4 offset:9216
  ds_read_b128 a[8:11], v4 offset:10240
  s_waitcnt lgkmcnt(7)
  v_mfma_f32_16x16x32_bf16 v[224:227], a[32:35], v[52:55], v[224:227]
  s_add_u32 m0, s79, 49152
  ds_read_b128 a[12:15], v4 offset:11264
  v_mfma_f32_16x16x32_bf16 a[204:207], a[208:211], v[52:55], a[204:207]
  buffer_load_dwordx4 v10, s[12:15], s71 offen offset:0 lds
  v_mfma_f32_16x16x32_bf16 v[228:231], a[36:39], v[52:55], v[228:231]
  buffer_load_dwordx4 v11, s[12:15], s71 offen offset:1024 lds
  v_mfma_f32_16x16x32_bf16 v[232:235], a[40:43], v[52:55], v[232:235]
  buffer_load_dwordx4 v12, s[12:15], s71 offen offset:2048 lds
  v_mfma_f32_16x16x32_bf16 v[236:239], a[44:47], v[52:55], v[236:239]
  s_waitcnt lgkmcnt(4)
  ds_read_b128 a[16:19], v4 offset:12288
  ds_read_b128 a[20:23], v4 offset:13312
  v_mfma_f32_16x16x32_bf16 v[240:243], a[48:51], v[52:55], v[240:243]
  buffer_load_dwordx4 v13, s[12:15], s71 offen offset:3072 lds
  ds_read_b128 a[24:27], v4 offset:14336
  v_mfma_f32_16x16x32_bf16 v[244:247], a[52:55], v[52:55], v[244:247]
  s_bfe_u32 s72, 0x3020106, s31
  s_add_u32 s30, s30, s72
  s_add_u32 s31, s31, 8
  v_mfma_f32_16x16x32_bf16 v[248:251], a[56:59], v[52:55], v[248:251]
  s_and_b32 s31, s31, 0x8001f
  s_and_b32 s30, s30, 7
  s_lshl_b32 s72, s30, 17
  v_mfma_f32_16x16x32_bf16 v[252:255], a[60:63], v[52:55], v[252:255]
  s_waitcnt lgkmcnt(3)
  s_add_u32 s71, s93, s72
  s_add_u32 m0, s79, 32768
  v_mfma_f32_16x16x32_bf16 v[224:227], a[0:3], v[60:63], v[224:227]
  buffer_load_dwordx4 v2, s[8:11], s70 offen offset:0 sc1 lds
  ds_read_b128 a[28:31], v4 offset:15360
  v_mfma_f32_16x16x32_bf16 a[204:207], a[208:211], v[60:63], a[204:207]
  buffer_load_dwordx4 v2, s[8:11], s70 offen offset:1024 sc1 lds
  v_mfma_f32_16x16x32_bf16 v[228:231], a[4:7], v[60:63], v[228:231]
  buffer_load_dwordx4 v2, s[8:11], s70 offen offset:2048 sc1 lds
  v_mfma_f32_16x16x32_bf16 v[232:235], a[8:11], v[60:63], v[232:235]
  buffer_load_dwordx4 v2, s[8:11], s70 offen offset:3072 sc1 lds
  v_mfma_f32_16x16x32_bf16 v[236:239], a[12:15], v[60:63], v[236:239]
  s_waitcnt lgkmcnt(0)
  s_bfe_u32 s72, 0x3020106, s1
  s_add_u32 s0, s0, s72
  v_mfma_f32_16x16x32_bf16 v[240:243], a[16:19], v[60:63], v[240:243]
  s_add_u32 s1, s1, 8
  s_and_b32 s1, s1, 0x8001f
  s_and_b32 s0, s0, 7
  v_mfma_f32_16x16x32_bf16 v[244:247], a[20:23], v[60:63], v[244:247]
  s_lshl_b32 s72, s0, 14
  s_add_u32 s70, s92, s72
  v_mfma_f32_16x16x32_bf16 v[248:251], a[24:27], v[60:63], v[248:251]
  v_mfma_f32_16x16x32_bf16 v[252:255], a[28:31], v[60:63], v[252:255]
  s_and_b32 s88, s25, 1
  s_lshl_b32 s88, s88, 1
  s_add_u32 s88, s88, 14
  s_sub_u32 s88, s88, s25
  s_lshl_b32 s4, s88, 20
  s_lshl_b32 s5, s24, 15
  s_add_u32 s4, s4, s5
  s_lshl_b32 s5, s3, 11
  s_add_u32 s4, s4, s5
  v_accvgpr_read_b32 v6, a200
  v_accvgpr_read_b32 v8, a204
  s_mov_b32 s5, 0x5f800000
  v_cmp_ngt_f32 vcc, s5, v6
  v_rcp_f32 v6, v6
  s_or_b32 s89, s89, vcc_lo
  s_or_b32 s89, s89, vcc_hi
  v_mov_b32 v7, v6
  v_cmp_ngt_f32 vcc, s5, v8
  v_rcp_f32 v8, v8
  s_or_b32 s89, s89, vcc_lo
  s_or_b32 s89, s89, vcc_hi
  v_mov_b32 v9, v8
  v_pk_mul_f32 v[192:193], v[192:193], v[6:7]
  v_pk_mul_f32 v[194:195], v[194:195], v[6:7]
  v_pk_mul_f32 v[196:197], v[196:197], v[6:7]
  v_pk_mul_f32 v[198:199], v[198:199], v[6:7]
  v_cvt_pk_bf16_f32 v192, v192, v193
  v_cvt_pk_bf16_f32 v193, v194, v195
  v_cvt_pk_bf16_f32 v194, v196, v197
  v_cvt_pk_bf16_f32 v195, v198, v199
  buffer_store_dwordx4 v[192:195], v2, s[16:19], s4 offen offset:0 sc1
  v_pk_mul_f32 v[224:225], v[224:225], v[8:9]
  v_pk_mul_f32 v[226:227], v[226:227], v[8:9]
  v_pk_mul_f32 v[228:229], v[228:229], v[8:9]
  v_pk_mul_f32 v[230:231], v[230:231], v[8:9]
  v_cvt_pk_bf16_f32 v224, v224, v225
  v_cvt_pk_bf16_f32 v225, v226, v227
  v_cvt_pk_bf16_f32 v226, v228, v229
  v_cvt_pk_bf16_f32 v227, v230, v231
  buffer_store_dwordx4 v[224:227], v2, s[16:19], s4 offen offset:1024 sc1
  s_add_u32 s4, s4, 8192
  v_pk_mul_f32 v[200:201], v[200:201], v[6:7]
  v_pk_mul_f32 v[202:203], v[202:203], v[6:7]
  v_pk_mul_f32 v[204:205], v[204:205], v[6:7]
  v_pk_mul_f32 v[206:207], v[206:207], v[6:7]
  v_cvt_pk_bf16_f32 v200, v200, v201
  v_cvt_pk_bf16_f32 v201, v202, v203
  v_cvt_pk_bf16_f32 v202, v204, v205
  v_cvt_pk_bf16_f32 v203, v206, v207
  buffer_store_dwordx4 v[200:203], v2, s[16:19], s4 offen offset:0 sc1
  v_pk_mul_f32 v[232:233], v[232:233], v[8:9]
  v_pk_mul_f32 v[234:235], v[234:235], v[8:9]
  v_pk_mul_f32 v[236:237], v[236:237], v[8:9]
  v_pk_mul_f32 v[238:239], v[238:239], v[8:9]
  v_cvt_pk_bf16_f32 v232, v232, v233
  v_cvt_pk_bf16_f32 v233, v234, v235
  v_cvt_pk_bf16_f32 v234, v236, v237
  v_cvt_pk_bf16_f32 v235, v238, v239
  buffer_store_dwordx4 v[232:235], v2, s[16:19], s4 offen offset:1024 sc1
  s_add_u32 s4, s4, 8192
  v_pk_mul_f32 v[208:209], v[208:209], v[6:7]
  v_pk_mul_f32 v[210:211], v[210:211], v[6:7]
  v_pk_mul_f32 v[212:213], v[212:213], v[6:7]
  v_pk_mul_f32 v[214:215], v[214:215], v[6:7]
  v_cvt_pk_bf16_f32 v208, v208, v209
  v_cvt_pk_bf16_f32 v209, v210, v211
  v_cvt_pk_bf16_f32 v210, v212, v213
  v_cvt_pk_bf16_f32 v211, v214, v215
  buffer_store_dwordx4 v[208:211], v2, s[16:19], s4 offen offset:0 sc1
  v_pk_mul_f32 v[240:241], v[240:241], v[8:9]
  v_pk_mul_f32 v[242:243], v[242:243], v[8:9]
  v_pk_mul_f32 v[244:245], v[244:245], v[8:9]
  v_pk_mul_f32 v[246:247], v[246:247], v[8:9]
  v_cvt_pk_bf16_f32 v240, v240, v241
  v_cvt_pk_bf16_f32 v241, v242, v243
  v_cvt_pk_bf16_f32 v242, v244, v245
  v_cvt_pk_bf16_f32 v243, v246, v247
  buffer_store_dwordx4 v[240:243], v2, s[16:19], s4 offen offset:1024 sc1
  s_add_u32 s4, s4, 8192
  v_pk_mul_f32 v[216:217], v[216:217], v[6:7]
  v_pk_mul_f32 v[218:219], v[218:219], v[6:7]
  v_pk_mul_f32 v[220:221], v[220:221], v[6:7]
  v_pk_mul_f32 v[222:223], v[222:223], v[6:7]
  v_cvt_pk_bf16_f32 v216, v216, v217
  v_cvt_pk_bf16_f32 v217, v218, v219
  v_cvt_pk_bf16_f32 v218, v220, v221
  v_cvt_pk_bf16_f32 v219, v222, v223
  buffer_store_dwordx4 v[216:219], v2, s[16:19], s4 offen offset:0 sc1
  v_pk_mul_f32 v[248:249], v[248:249], v[8:9]
  v_pk_mul_f32 v[250:251], v[250:251], v[8:9]
  v_pk_mul_f32 v[252:253], v[252:253], v[8:9]
  v_pk_mul_f32 v[254:255], v[254:255], v[8:9]
  v_cvt_pk_bf16_f32 v248, v248, v249
  v_cvt_pk_bf16_f32 v249, v250, v251
  v_cvt_pk_bf16_f32 v250, v252, v253
  v_cvt_pk_bf16_f32 v251, v254, v255
  buffer_store_dwordx4 v[248:251], v2, s[16:19], s4 offen offset:1024 sc1
  s_cmp_eq_u32 s89, 0
  s_cbranch_scc1 La_done
  s_waitcnt vmcnt(0)
  s_and_b32 s6, s25, 1
  s_lshl_b32 s6, s6, 1
  s_add_u32 s6, s6, 14
  s_sub_u32 s6, s6, s25
La_sl_blk:
  v_mov_b32 v192, 0
  v_mov_b32 v193, 0
  v_mov_b32 v194, 0
  v_mov_b32 v195, 0
  v_mov_b32 v196, 0
  v_mov_b32 v197, 0
  v_mov_b32 v198, 0
  v_mov_b32 v199, 0
  v_mov_b32 v200, 0
  v_mov_b32 v201, 0
  v_mov_b32 v202, 0
  v_mov_b32 v203, 0
  v_mov_b32 v204, 0
  v_mov_b32 v205, 0
  v_mov_b32 v206, 0
  v_mov_b32 v207, 0
  v_mov_b32 v208, 0
  v_mov_b32 v209, 0
  v_mov_b32 v210, 0
  v_mov_b32 v211, 0
  v_mov_b32 v212, 0
  v_mov_b32 v213, 0
  v_mov_b32 v214, 0
  v_mov_b32 v215, 0
  v_mov_b32 v216, 0
  v_mov_b32 v217, 0
  v_mov_b32 v218, 0
  v_mov_b32 v219, 0
  v_mov_b32 v220, 0
  v_mov_b32 v221, 0
  v_mov_b32 v222, 0
  v_mov_b32 v223, 0
  v_mov_b32 v224, 0
  v_mov_b32 v225, 0
  v_mov_b32 v226, 0
  v_mov_b32 v227, 0
  v_mov_b32 v228, 0
  v_mov_b32 v229, 0
  v_mov_b32 v230, 0
  v_mov_b32 v231, 0
  v_mov_b32 v232, 0
  v_mov_b32 v233, 0
  v_mov_b32 v234, 0
  v_mov_b32 v235, 0
  v_mov_b32 v236, 0
  v_mov_b32 v237, 0
  v_mov_b32 v238, 0
  v_mov_b32 v239, 0
  v_mov_b32 v240, 0
  v_mov_b32 v241, 0
  v_mov_b32 v242, 0
  v_mov_b32 v243, 0
  v_mov_b32 v244, 0
  v_mov_b32 v245, 0
  v_mov_b32 v246, 0
  v_mov_b32 v247, 0
  v_mov_b32 v248, 0
  v_mov_b32 v249, 0
  v_mov_b32 v250, 0
  v_mov_b32 v251, 0
  v_mov_b32 v252, 0
  v_mov_b32 v253, 0
  v_mov_b32 v254, 0
  v_mov_b32 v255, 0
  v_mov_b32 v24, 0
  v_mov_b32 v25, 0
  v_mov_b32 v26, 0
  v_mov_b32 v27, 0
  v_mov_b32 v28, 0
  v_mov_b32 v29, 0
  v_mov_b32 v30, 0
  v_mov_b32 v31, 0
  v_mov_b32 v16, v5
  v_mov_b32 v17, v5
  v_and_b32 v20, 15, v1
  v_lshrrev_b32 v21, 4, v1
  v_sub_u32 v20, v20, v21
  v_lshlrev_b32 v20, 2, v20
  s_lshl_b32 s4, s6, 7
  s_add_u32 s4, s4, s3
  v_add_u32 v20, s4, v20
  v_add_u32 v21, 64, v20
  s_add_u32 s7, s6, 1
  s_lshl_b32 s7, s7, 2
  s_mov_b32 s90, 0
La_sl_loop:
  s_add_u32 s4, s90, 0
  buffer_load_dwordx4 a[0:3], v2, s[20:23], s4 offen offset:0 sc1
  buffer_load_dwordx4 a[4:7], v2, s[20:23], s4 offen offset:1024 sc1
  buffer_load_dwordx4 a[8:11], v2, s[20:23], s4 offen offset:2048 sc1
  buffer_load_dwordx4 a[12:15], v2, s[20:23], s4 offen offset:3072 sc1
  s_add_u32 s4, s90, 4096
  buffer_load_dwordx4 a[16:19], v2, s[20:23], s4 offen offset:0 sc1
  buffer_load_dwordx4 a[20:23], v2, s[20:23], s4 offen offset:1024 sc1
  buffer_load_dwordx4 a[24:27], v2, s[20:23], s4 offen offset:2048 sc1
  buffer_load_dwordx4 a[28:31], v2, s[20:23], s4 offen offset:3072 sc1
  s_add_u32 s4, s90, 16384
  buffer_load_dwordx4 a[32:35], v2, s[20:23], s4 offen offset:0 sc1
  buffer_load_dwordx4 a[36:39], v2, s[20:23], s4 offen offset:1024 sc1
  buffer_load_dwordx4 a[40:43], v2, s[20:23], s4 offen offset:2048 sc1
  buffer_load_dwordx4 a[44:47], v2, s[20:23], s4 offen offset:3072 sc1
  s_add_u32 s4, s90, 20480
  buffer_load_dwordx4 a[48:51], v2, s[20:23], s4 offen offset:0 sc1
  buffer_load_dwordx4 a[52:55], v2, s[20:23], s4 offen offset:1024 sc1
  buffer_load_dwordx4 a[56:59], v2, s[20:23], s4 offen offset:2048 sc1
  buffer_load_dwordx4 a[60:63], v2, s[20:23], s4 offen offset:3072 sc1
  s_waitcnt vmcnt(0)
  v_mfma_f32_16x16x32_bf16 v[64:67], a[0:3], a[160:163], 0
  v_mfma_f32_16x16x32_bf16 v[72:75], a[0:3], a[176:179], 0
  v_mfma_f32_16x16x32_bf16 v[64:67], a[4:7], a[164:167], v[64:67]
  v_mfma_f32_16x16x32_bf16 v[72:75], a[4:7], a[180:183], v[72:75]
  v_mfma_f32_16x16x32_bf16 v[64:67], a[8:11], a[168:171], v[64:67]
  v_mfma_f32_16x16x32_bf16 v[72:75], a[8:11], a[184:187], v[72:75]
  v_mfma_f32_16x16x32_bf16 v[64:67], a[12:15], a[172:175], v[64:67]
  v_mfma_f32_16x16x32_bf16 v[72:75], a[12:15], a[188:191], v[72:75]
  v_mfma_f32_16x16x32_bf16 v[68:71], a[16:19], a[160:163], 0
  v_mfma_f32_16x16x32_bf16 v[76:79], a[16:19], a[176:179], 0
  v_mfma_f32_16x16x32_bf16 v[68:71], a[20:23], a[164:167], v[68:71]
  v_mfma_f32_16x16x32_bf16 v[76:79], a[20:23], a[180:183], v[76:79]
  v_mfma_f32_16x16x32_bf16 v[68:71], a[24:27], a[168:171], v[68:71]
  v_mfma_f32_16x16x32_bf16 v[76:79], a[24:27], a[184:187], v[76:79]
  v_mfma_f32_16x16x32_bf16 v[68:71], a[28:31], a[172:175], v[68:71]
  v_mfma_f32_16x16x32_bf16 v[76:79], a[28:31], a[188:191], v[76:79]
  v_cmp_gt_i32 vcc, 0, v20
  s_nop 1
  v_cndmask_b32 v64, v64, v5, vcc
  v_cmp_gt_i32 vcc, 1, v20
  s_nop 1
  v_cndmask_b32 v65, v65, v5, vcc
  v_cmp_gt_i32 vcc, 2, v20
  s_nop 1
  v_cndmask_b32 v66, v66, v5, vcc
  v_cmp_gt_i32 vcc, 3, v20
  s_nop 1
  v_cndmask_b32 v67, v67, v5, vcc
  v_cmp_gt_i32 vcc, 16, v20
  s_nop 1
  v_cndmask_b32 v68, v68, v5, vcc
  v_cmp_gt_i32 vcc, 17, v20
  s_nop 1
  v_cndmask_b32 v69, v69, v5, vcc
  v_cmp_gt_i32 vcc, 18, v20
  s_nop 1
  v_cndmask_b32 v70, v70, v5, vcc
  v_cmp_gt_i32 vcc, 19, v20
  s_nop 1
  v_cndmask_b32 v71, v71, v5, vcc
  v_subrev_u32 v20, 32, v20
  v_max3_f32 v6, v64, v65, v66
  v_max3_f32 v7, v67, v68, v69
  v_max3_f32 v6, v6, v70, v71
  v_max_f32 v6, v6, v7
  v_cmp_gt_i32 vcc, 0, v21
  s_nop 1
  v_cndmask_b32 v72, v72, v5, vcc
  v_cmp_gt_i32 vcc, 1, v21
  s_nop 1
  v_cndmask_b32 v73, v73, v5, vcc
  v_cmp_gt_i32 vcc, 2, v21
  s_nop 1
  v_cndmask_b32 v74, v74, v5, vcc
  v_cmp_gt_i32 vcc, 3, v21
  s_nop 1
  v_cndmask_b32 v75, v75, v5, vcc
  v_cmp_gt_i32 vcc, 16, v21
  s_nop 1
  v_cndmask_b32 v76, v76, v5, vcc
  v_cmp_gt_i32 vcc, 17, v21
  s_nop 1
  v_cndmask_b32 v77, v77, v5, vcc
  v_cmp_gt_i32 vcc, 18, v21
  s_nop 1
  v_cndmask_b32 v78, v78, v5, vcc
  v_cmp_gt_i32 vcc, 19, v21
  s_nop 1
  v_cndmask_b32 v79, v79, v5, vcc
  v_subrev_u32 v21, 32, v21
  v_max3_f32 v8, v72, v73, v74
  v_max3_f32 v9, v75, v76, v77
  v_max3_f32 v8, v8, v78, v79
  v_max_f32 v8, v8, v9
  v_mov_b32 v7, v6
  v_mov_b32 v9, v8
  s_nop 0
  v_permlane32_swap_b32 v6, v7
  v_permlane32_swap_b32 v8, v9
  v_max_f32 v6, v6, v7
  v_max_f32 v8, v8, v9
  v_mov_b32 v7, v6
  v_mov_b32 v9, v8
  s_nop 0
  v_permlane16_swap_b32 v6, v7
  v_permlane16_swap_b32 v8, v9
  v_max_f32 v6, v6, v7
  v_max_f32 v8, v8, v9
  v_max_f32 v6, v6, v16
  v_sub_f32 v7, v16, v6
  v_exp_f32 v7, v7
  v_mov_b32 v16, v6
  v_sub_f32 v64, v64, v16
  v_sub_f32 v65, v65, v16
  v_sub_f32 v66, v66, v16
  v_sub_f32 v67, v67, v16
  v_sub_f32 v68, v68, v16
  v_sub_f32 v69, v69, v16
  v_sub_f32 v70, v70, v16
  v_sub_f32 v71, v71, v16
  v_exp_f32 v64, v64
  v_exp_f32 v65, v65
  v_exp_f32 v66, v66
  v_exp_f32 v67, v67
  v_exp_f32 v68, v68
  v_exp_f32 v69, v69
  v_exp_f32 v70, v70
  v_exp_f32 v71, v71
  v_mul_f32 v24, v24, v7
  v_mul_f32 v25, v25, v7
  v_mul_f32 v26, v26, v7
  v_mul_f32 v27, v27, v7
  v_mul_f32 v192, v192, v7
  v_mul_f32 v193, v193, v7
  v_mul_f32 v194, v194, v7
  v_mul_f32 v195, v195, v7
  v_mul_f32 v196, v196, v7
  v_mul_f32 v197, v197, v7
  v_mul_f32 v198, v198, v7
  v_mul_f32 v199, v199, v7
  v_mul_f32 v200, v200, v7
  v_mul_f32 v201, v201, v7
  v_mul_f32 v202, v202, v7
  v_mul_f32 v203, v203, v7
  v_mul_f32 v204, v204, v7
  v_mul_f32 v205, v205, v7
  v_mul_f32 v206, v206, v7
  v_mul_f32 v207, v207, v7
  v_mul_f32 v208, v208, v7
  v_mul_f32 v209, v209, v7
  v_mul_f32 v210, v210, v7
  v_mul_f32 v211, v211, v7
  v_mul_f32 v212, v212, v7
  v_mul_f32 v213, v213, v7
  v_mul_f32 v214, v214, v7
  v_mul_f32 v215, v215, v7
  v_mul_f32 v216, v216, v7
  v_mul_f32 v217, v217, v7
  v_mul_f32 v218, v218, v7
  v_mul_f32 v219, v219, v7
  v_mul_f32 v220, v220, v7
  v_mul_f32 v221, v221, v7
  v_mul_f32 v222, v222, v7
  v_mul_f32 v223, v223, v7
  v_cvt_pk_bf16_f32 v32, v64, v65
  v_cvt_pk_bf16_f32 v33, v66, v67
  v_cvt_pk_bf16_f32 v34, v68, v69
  v_cvt_pk_bf16_f32 v35, v70, v71
  v_max_f32 v8, v8, v17
  v_sub_f32 v9, v17, v8
  v_exp_f32 v9, v9
  v_mov_b32 v17, v8
  v_sub_f32 v72, v72, v17
  v_sub_f32 v73, v73, v17
  v_sub_f32 v74, v74, v17
  v_sub_f32 v75, v75, v17
  v_sub_f32 v76, v76, v17
  v_sub_f32 v77, v77, v17
  v_sub_f32 v78, v78, v17
  v_sub_f32 v79, v79, v17
  v_exp_f32 v72, v72
  v_exp_f32 v73, v73
  v_exp_f32 v74, v74
  v_exp_f32 v75, v75
  v_exp_f32 v76, v76
  v_exp_f32 v77, v77
  v_exp_f32 v78, v78
  v_exp_f32 v79, v79
  v_mul_f32 v28, v28, v9
  v_mul_f32 v29, v29, v9
  v_mul_f32 v30, v30, v9
  v_mul_f32 v31, v31, v9
  v_mul_f32 v224, v224, v9
  v_mul_f32 v225, v225, v9
  v_mul_f32 v226, v226, v9
  v_mul_f32 v227, v227, v9
  v_mul_f32 v228, v228, v9
  v_mul_f32 v229, v229, v9
  v_mul_f32 v230, v230, v9
  v_mul_f32 v231, v231, v9
  v_mul_f32 v232, v232, v9
  v_mul_f32 v233, v233, v9
  v_mul_f32 v234, v234, v9
  v_mul_f32 v235, v235, v9
  v_mul_f32 v236, v236, v9
  v_mul_f32 v237, v237, v9
  v_mul_f32 v238, v238, v9
  v_mul_f32 v239, v239, v9
  v_mul_f32 v240, v240, v9
  v_mul_f32 v241, v241, v9
  v_mul_f32 v242, v242, v9
  v_mul_f32 v243, v243, v9
  v_mul_f32 v244, v244, v9
  v_mul_f32 v245, v245, v9
  v_mul_f32 v246, v246, v9
  v_mul_f32 v247, v247, v9
  v_mul_f32 v248, v248, v9
  v_mul_f32 v249, v249, v9
  v_mul_f32 v250, v250, v9
  v_mul_f32 v251, v251, v9
  v_mul_f32 v252, v252, v9
  v_mul_f32 v253, v253, v9
  v_mul_f32 v254, v254, v9
  v_mul_f32 v255, v255, v9
  v_cvt_pk_bf16_f32 v36, v72, v73
  v_cvt_pk_bf16_f32 v37, v74, v75
  v_cvt_pk_bf16_f32 v38, v76, v77
  v_cvt_pk_bf16_f32 v39, v78, v79
  v_mfma_f32_16x16x32_bf16 v[24:27], a[208:211], v[32:35], v[24:27]
  v_mfma_f32_16x16x32_bf16 v[192:195], a[32:35], v[32:35], v[192:195]
  v_mfma_f32_16x16x32_bf16 v[196:199], a[36:39], v[32:35], v[196:199]
  v_mfma_f32_16x16x32_bf16 v[200:203], a[40:43], v[32:35], v[200:203]
  v_mfma_f32_16x16x32_bf16 v[204:207], a[44:47], v[32:35], v[204:207]
  v_mfma_f32_16x16x32_bf16 v[208:211], a[48:51], v[32:35], v[208:211]
  v_mfma_f32_16x16x32_bf16 v[212:215], a[52:55], v[32:35], v[212:215]
  v_mfma_f32_16x16x32_bf16 v[216:219], a[56:59], v[32:35], v[216:219]
  v_mfma_f32_16x16x32_bf16 v[220:223], a[60:63], v[32:35], v[220:223]
  v_mfma_f32_16x16x32_bf16 v[28:31], a[208:211], v[36:39], v[28:31]
  v_mfma_f32_16x16x32_bf16 v[224:227], a[32:35], v[36:39], v[224:227]
  v_mfma_f32_16x16x32_bf16 v[228:231], a[36:39], v[36:39], v[228:231]
  v_mfma_f32_16x16x32_bf16 v[232:235], a[40:43], v[36:39], v[232:235]
  v_mfma_f32_16x16x32_bf16 v[236:239], a[44:47], v[36:39], v[236:239]
  v_mfma_f32_16x16x32_bf16 v[240:243], a[48:51], v[36:39], v[240:243]
  v_mfma_f32_16x16x32_bf16 v[244:247], a[52:55], v[36:39], v[244:247]
  v_mfma_f32_16x16x32_bf16 v[248:251], a[56:59], v[36:39], v[248:251]
  v_mfma_f32_16x16x32_bf16 v[252:255], a[60:63], v[36:39], v[252:255]
  s_add_u32 s90, s90, 8192
  s_and_b32 s4, s90, 0x4000
  s_add_u32 s90, s90, s4
  s_sub_u32 s7, s7, 1
  s_cmp_lg_u32 s7, 0
  s_cbranch_scc1 La_sl_loop
  s_lshl_b32 s4, s6, 20
  s_lshl_b32 s5, s24, 15
  s_add_u32 s4, s4, s5
  s_lshl_b32 s5, s3, 11
  s_add_u32 s4, s4, s5
  v_rcp_f32 v6, v24
  s_nop 0
  v_mov_b32 v7, v6
  v_rcp_f32 v8, v28
  s_nop 0
  v_mov_b32 v9, v8
  v_pk_mul_f32 v[192:193], v[192:193], v[6:7]
  v_pk_mul_f32 v[194:195], v[194:195], v[6:7]
  v_pk_mul_f32 v[196:197], v[196:197], v[6:7]
  v_pk_mul_f32 v[198:199], v[198:199], v[6:7]
  v_cvt_pk_bf16_f32 v192, v192, v193
  v_cvt_pk_bf16_f32 v193, v194, v195
  v_cvt_pk_bf16_f32 v194, v196, v197
  v_cvt_pk_bf16_f32 v195, v198, v199
  buffer_store_dwordx4 v[192:195], v2, s[16:19], s4 offen offset:0 sc1
  v_pk_mul_f32 v[224:225], v[224:225], v[8:9]
  v_pk_mul_f32 v[226:227], v[226:227], v[8:9]
  v_pk_mul_f32 v[228:229], v[228:229], v[8:9]
  v_pk_mul_f32 v[230:231], v[230:231], v[8:9]
  v_cvt_pk_bf16_f32 v224, v224, v225
  v_cvt_pk_bf16_f32 v225, v226, v227
  v_cvt_pk_bf16_f32 v226, v228, v229
  v_cvt_pk_bf16_f32 v227, v230, v231
  buffer_store_dwordx4 v[224:227], v2, s[16:19], s4 offen offset:1024 sc1
  s_add_u32 s4, s4, 8192
  v_pk_mul_f32 v[200:201], v[200:201], v[6:7]
  v_pk_mul_f32 v[202:203], v[202:203], v[6:7]
  v_pk_mul_f32 v[204:205], v[204:205], v[6:7]
  v_pk_mul_f32 v[206:207], v[206:207], v[6:7]
  v_cvt_pk_bf16_f32 v200, v200, v201
  v_cvt_pk_bf16_f32 v201, v202, v203
  v_cvt_pk_bf16_f32 v202, v204, v205
  v_cvt_pk_bf16_f32 v203, v206, v207
  buffer_store_dwordx4 v[200:203], v2, s[16:19], s4 offen offset:0 sc1
  v_pk_mul_f32 v[232:233], v[232:233], v[8:9]
  v_pk_mul_f32 v[234:235], v[234:235], v[8:9]
  v_pk_mul_f32 v[236:237], v[236:237], v[8:9]
  v_pk_mul_f32 v[238:239], v[238:239], v[8:9]
  v_cvt_pk_bf16_f32 v232, v232, v233
  v_cvt_pk_bf16_f32 v233, v234, v235
  v_cvt_pk_bf16_f32 v234, v236, v237
  v_cvt_pk_bf16_f32 v235, v238, v239
  buffer_store_dwordx4 v[232:235], v2, s[16:19], s4 offen offset:1024 sc1
  s_add_u32 s4, s4, 8192
  v_pk_mul_f32 v[208:209], v[208:209], v[6:7]
  v_pk_mul_f32 v[210:211], v[210:211], v[6:7]
  v_pk_mul_f32 v[212:213], v[212:213], v[6:7]
  v_pk_mul_f32 v[214:215], v[214:215], v[6:7]
  v_cvt_pk_bf16_f32 v208, v208, v209
  v_cvt_pk_bf16_f32 v209, v210, v211
  v_cvt_pk_bf16_f32 v210, v212, v213
  v_cvt_pk_bf16_f32 v211, v214, v215
  buffer_store_dwordx4 v[208:211], v2, s[16:19], s4 offen offset:0 sc1
  v_pk_mul_f32 v[240:241], v[240:241], v[8:9]
  v_pk_mul_f32 v[242:243], v[242:243], v[8:9]
  v_pk_mul_f32 v[244:245], v[244:245], v[8:9]
  v_pk_mul_f32 v[246:247], v[246:247], v[8:9]
  v_cvt_pk_bf16_f32 v240, v240, v241
  v_cvt_pk_bf16_f32 v241, v242, v243
  v_cvt_pk_bf16_f32 v242, v244, v245
  v_cvt_pk_bf16_f32 v243, v246, v247
  buffer_store_dwordx4 v[240:243], v2, s[16:19], s4 offen offset:1024 sc1
  s_add_u32 s4, s4, 8192
  v_pk_mul_f32 v[216:217], v[216:217], v[6:7]
  v_pk_mul_f32 v[218:219], v[218:219], v[6:7]
  v_pk_mul_f32 v[220:221], v[220:221], v[6:7]
  v_pk_mul_f32 v[222:223], v[222:223], v[6:7]
  v_cvt_pk_bf16_f32 v216, v216, v217
  v_cvt_pk_bf16_f32 v217, v218, v219
  v_cvt_pk_bf16_f32 v218, v220, v221
  v_cvt_pk_bf16_f32 v219, v222, v223
  buffer_store_dwordx4 v[216:219], v2, s[16:19], s4 offen offset:0 sc1
  v_pk_mul_f32 v[248:249], v[248:249], v[8:9]
  v_pk_mul_f32 v[250:251], v[250:251], v[8:9]
  v_pk_mul_f32 v[252:253], v[252:253], v[8:9]
  v_pk_mul_f32 v[254:255], v[254:255], v[8:9]
  v_cvt_pk_bf16_f32 v248, v248, v249
  v_cvt_pk_bf16_f32 v249, v250, v251
  v_cvt_pk_bf16_f32 v250, v252, v253
  v_cvt_pk_bf16_f32 v251, v254, v255
  buffer_store_dwordx4 v[248:251], v2, s[16:19], s4 offen offset:1024 sc1
  s_cmp_eq_u32 s6, s25
  s_cbranch_scc1 La_done
  v_accvgpr_read_b32 v64, a128
  v_accvgpr_read_b32 v65, a129
  v_accvgpr_read_b32 v66, a130
  v_accvgpr_read_b32 v67, a131
  v_accvgpr_read_b32 v68, a132
  v_accvgpr_read_b32 v69, a133
  v_accvgpr_read_b32 v70, a134
  v_accvgpr_read_b32 v71, a135
  v_accvgpr_read_b32 v72, a136
  v_accvgpr_read_b32 v73, a137
  v_accvgpr_read_b32 v74, a138
  v_accvgpr_read_b32 v75, a139
  v_accvgpr_read_b32 v76, a140
  v_accvgpr_read_b32 v77, a141
  v_accvgpr_read_b32 v78, a142
  v_accvgpr_read_b32 v79, a143
  v_accvgpr_read_b32 v80, a144
  v_accvgpr_read_b32 v81, a145
  v_accvgpr_read_b32 v82, a146
  v_accvgpr_read_b32 v83, a147
  v_accvgpr_read_b32 v84, a148
  v_accvgpr_read_b32 v85, a149
  v_accvgpr_read_b32 v86, a150
  v_accvgpr_read_b32 v87, a151
  v_accvgpr_read_b32 v88, a152
  v_accvgpr_read_b32 v89, a153
  v_accvgpr_read_b32 v90, a154
  v_accvgpr_read_b32 v91, a155
  v_accvgpr_read_b32 v92, a156
  v_accvgpr_read_b32 v93, a157
  v_accvgpr_read_b32 v94, a158
  v_accvgpr_read_b32 v95, a159
  v_accvgpr_write_b32 a160, v64
  v_accvgpr_write_b32 a161, v65
  v_accvgpr_write_b32 a162, v66
  v_accvgpr_write_b32 a163, v67
  v_accvgpr_write_b32 a164, v68
  v_accvgpr_write_b32 a165, v69
  v_accvgpr_write_b32 a166, v70
  v_accvgpr_write_b32 a167, v71
  v_accvgpr_write_b32 a168, v72
  v_accvgpr_write_b32 a169, v73
  v_accvgpr_write_b32 a170, v74
  v_accvgpr_write_b32 a171, v75
  v_accvgpr_write_b32 a172, v76
  v_accvgpr_write_b32 a173, v77
  v_accvgpr_write_b32 a174, v78
  v_accvgpr_write_b32 a175, v79
  v_accvgpr_write_b32 a176, v80
  v_accvgpr_write_b32 a177, v81
  v_accvgpr_write_b32 a178, v82
  v_accvgpr_write_b32 a179, v83
  v_accvgpr_write_b32 a180, v84
  v_accvgpr_write_b32 a181, v85
  v_accvgpr_write_b32 a182, v86
  v_accvgpr_write_b32 a183, v87
  v_accvgpr_write_b32 a184, v88
  v_accvgpr_write_b32 a185, v89
  v_accvgpr_write_b32 a186, v90
  v_accvgpr_write_b32 a187, v91
  v_accvgpr_write_b32 a188, v92
  v_accvgpr_write_b32 a189, v93
  v_accvgpr_write_b32 a190, v94
  v_accvgpr_write_b32 a191, v95
  s_mov_b32 s6, s25
  s_branch La_sl_blk
La_done:
  s_lshr_b32 s4, s3, 1
  s_lshl_b32 s4, s4, 12
  s_add_u32 s4, s4, 131072
  s_lshl_b32 s5, s77, 11
  s_add_u32 s4, s4, s5
  v_add_u32 v16, s4, v2
  v_xor_b32 v17, 0x800, v16
  s_and_b32 s4, s3, 1
  s_lshl_b32 s4, s4, 13
  s_add_u32 s4, s4, 131072
  v_lshrrev_b32 v24, 2, v1
  v_and_b32 v25, 6, v24
  v_lshlrev_b32 v24, 7, v24
  v_and_b32 v26, 1, v1
  v_lshl_add_u32 v24, v26, 3, v24
  v_add_u32 v24, s4, v24
  v_bfe_u32 v26, v1, 1, 1
  v_xor_b32 v25, v25, v26
  v_xor_b32 v26, 0, v25
  v_lshl_add_u32 v18, v26, 4, v24
  v_xor_b32 v26, 2, v25
  v_lshl_add_u32 v19, v26, 4, v24
  v_xor_b32 v26, 4, v25
  v_lshl_add_u32 v20, v26, 4, v24
  v_xor_b32 v26, 6, v25
  v_lshl_add_u32 v21, v26, 4, v24
  s_mov_b32 s65, 0
  s_mov_b32 s67, 4294868992
  s_mov_b32 s68, 32768
  s_mov_b32 s65, 3
  s_lshl_b32 s36, s24, 7
  s_add_u32 s36, s36, 65536
  s_and_b32 s37, s25, 1
  s_lshl_b32 s37, s37, 1
  s_add_u32 s37, s37, 14
  s_sub_u32 s37, s37, s25
  s_lshl_b32 s37, s37, 12
  s_add_u32 s37, s37, s36
  s_lshl_b32 s38, s25, 12
  s_add_u32 s36, s36, s38
  s_lshl_b32 s38, s78, 1
  s_add_u32 s38, s38, s77
  s_lshl_b32 s38, s38, 7
  s_add_u32 s38, s38, 163840
  s_lshl_b32 s91, s73, 12
  s_add_u32 s91, s91, 65536
  s_lshl_b32 s39, s78, 1
  s_add_u32 s39, s39, s77
  s_xor_b32 s39, s39, 1
  s_lshl_b32 s39, s39, 7
  s_add_u32 s39, s39, 163840
  s_sub_u32 s39, s39, s91
  v_mov_b32 v8, 0x40000000
  v_mov_b32 v6, s94
  v_cmp_eq_u32 vcc, 0, v0
  v_mov_b32 v7, s95
  s_nop 0
  v_cndmask_b32_e64 v8, v8, 0, vcc
  v_lshlrev_b32 v14, 7, v1
  v_mov_b32 v9, s39
  v_cmp_gt_u32 vcc, 32, v1
  s_nop 1
  v_cndmask_b32 v14, v9, v14, vcc
  s_waitcnt vmcnt(16)
  s_barrier
  ds_read_b128 a[64:67], v16 offset:0
  ds_read_b64_tr_b16 a[96:97], v18 offset:16384
  ds_read_b64_tr_b16 a[98:99], v18 offset:18432
  ds_read_b128 a[68:71], v16 offset:1024
  ds_read_b128 a[72:75], v17 offset:0
  ds_read_b128 a[76:79], v17 offset:1024
  ds_read_b64_tr_b16 a[100:101], v19 offset:16384
  ds_read_b64_tr_b16 a[102:103], v19 offset:18432
  ds_read_b64_tr_b16 a[104:105], v20 offset:16384
  ds_read_b64_tr_b16 a[106:107], v20 offset:18432
  ds_read_b64_tr_b16 a[108:109], v21 offset:16384
  ds_read_b64_tr_b16 a[110:111], v21 offset:18432
  s_waitcnt lgkmcnt(0)
  v_mfma_f32_16x16x32_bf16 v[32:35], a[96:99], a[64:67], 0
  s_add_u32 m0, s79, 81920
  ds_read_b128 a[80:83], v16 offset:8192
  ds_read_b64_tr_b16 a[112:113], v18 offset:20480
  v_mfma_f32_16x16x32_bf16 v[48:51], a[96:99], a[68:71], 0
  buffer_load_dwordx4 v10, s[12:15], s71 offen offset:0 lds
  v_mfma_f32_16x16x32_bf16 v[64:67], a[96:99], a[72:75], 0
  buffer_load_dwordx4 v11, s[12:15], s71 offen offset:1024 lds
  v_mfma_f32_16x16x32_bf16 v[80:83], a[96:99], a[76:79], 0
  buffer_load_dwordx4 v12, s[12:15], s71 offen offset:2048 lds
  v_mfma_f32_16x16x32_bf16 v[36:39], a[100:103], a[64:67], 0
  buffer_load_dwordx4 v13, s[12:15], s71 offen offset:3072 lds
  v_mfma_f32_16x16x32_bf16 v[52:55], a[100:103], a[68:71], 0
  s_bfe_u32 s72, 0x3020106, s31
  s_add_u32 s30, s30, s72
  s_add_u32 s31, s31, 8
  v_mfma_f32_16x16x32_bf16 v[68:71], a[100:103], a[72:75], 0
  s_and_b32 s31, s31, 0x8001f
  s_and_b32 s30, s30, 7
  s_lshl_b32 s72, s30, 17
  v_mfma_f32_16x16x32_bf16 v[84:87], a[100:103], a[76:79], 0
  s_add_u32 s71, s93, s72
  s_add_u32 m0, s79, 65536
  ds_read_b64_tr_b16 a[114:115], v18 offset:22528
  v_mfma_f32_16x16x32_bf16 v[40:43], a[104:107], a[64:67], 0
  buffer_load_dwordx4 v2, s[8:11], s70 offen offset:0 sc1 lds
  v_mfma_f32_16x16x32_bf16 v[56:59], a[104:107], a[68:71], 0
  buffer_load_dwordx4 v2, s[8:11], s70 offen offset:1024 sc1 lds
  v_mfma_f32_16x16x32_bf16 v[72:75], a[104:107], a[72:75], 0
  buffer_load_dwordx4 v2, s[8:11], s70 offen offset:2048 sc1 lds
  v_mfma_f32_16x16x32_bf16 v[88:91], a[104:107], a[76:79], 0
  buffer_load_dwordx4 v2, s[8:11], s70 offen offset:3072 sc1 lds
  v_mfma_f32_16x16x32_bf16 v[44:47], a[108:111], a[64:67], 0
  s_add_u32 s65, s65, 1
  ds_read_b128 a[84:87], v16 offset:9216
  ds_read_b128 a[88:91], v17 offset:8192
  v_mfma_f32_16x16x32_bf16 v[60:63], a[108:111], a[68:71], 0
  s_cmp_eq_u32 s65, 4
  s_cselect_b32 s65, 0, s65
  s_cselect_b32 s66, s67, s68
  ds_read_b128 a[92:95], v17 offset:9216
  ds_read_b64_tr_b16 a[116:117], v19 offset:20480
  v_mfma_f32_16x16x32_bf16 v[76:79], a[108:111], a[72:75], 0
  s_bfe_u32 s72, 0x3020106, s1
  ds_read_b64_tr_b16 a[118:119], v19 offset:22528
  ds_read_b64_tr_b16 a[120:121], v20 offset:20480
  v_mfma_f32_16x16x32_bf16 v[92:95], a[108:111], a[76:79], 0
  s_add_u32 s0, s0, s72
  s_add_u32 s1, s1, 8
  s_and_b32 s1, s1, 0x8001f
  s_and_b32 s0, s0, 7
  s_lshl_b32 s72, s0, 14
  s_add_u32 s70, s92, s72
  ds_read_b64_tr_b16 a[122:123], v20 offset:22528
  ds_read_b64_tr_b16 a[124:125], v21 offset:20480
  ds_read_b64_tr_b16 a[126:127], v21 offset:22528
  v_add_u32 v16, s66, v16
  v_add_u32 v17, s66, v17
  v_add_u32 v18, s66, v18
  v_add_u32 v19, s66, v19
  v_add_u32 v20, s66, v20
  v_add_u32 v21, s66, v21
  s_waitcnt vmcnt(8) lgkmcnt(0)
  s_barrier
  v_mfma_f32_16x16x32_bf16 v[32:35], a[112:115], a[80:83], v[32:35]
  buffer_store_dwordx2 v[6:7], v8, s[96:99], s36 offen sc1
  v_mfma_f32_16x16x32_bf16 v[48:51], a[112:115], a[84:87], v[48:51]
  buffer_store_dwordx2 v[6:7], v8, s[96:99], s37 offen sc1
  v_mfma_f32_16x16x32_bf16 v[64:67], a[112:115], a[88:91], v[64:67]
  ds_read_b128 a[64:67], v16 offset:0
  ds_read_b64_tr_b16 a[96:97], v18 offset:16384
  v_mfma_f32_16x16x32_bf16 v[80:83], a[112:115], a[92:95], v[80:83]
  buffer_store_dwordx2 v[6:7], v8, s[96:99], s38 offen sc1
  v_mfma_f32_16x16x32_bf16 v[36:39], a[116:119], a[80:83], v[36:39]
  s_add_u32 m0, s79, 114688
  ds_read_b64_tr_b16 a[98:99], v18 offset:18432
  ds_read_b128 a[68:71], v16 offset:1024
  v_mfma_f32_16x16x32_bf16 v[52:55], a[116:119], a[84:87], v[52:55]
  buffer_load_dwordx4 v10, s[12:15], s71 offen offset:0 lds
  v_mfma_f32_16x16x32_bf16 v[68:71], a[116:119], a[88:91], v[68:71]
  buffer_load_dwordx4 v11, s[12:15], s71 offen offset:1024 lds
  v_mfma_f32_16x16x32_bf16 v[84:87], a[116:119], a[92:95], v[84:87]
  buffer_load_dwordx4 v12, s[12:15], s71 offen offset:2048 lds
  v_mfma_f32_16x16x32_bf16 v[40:43], a[120:123], a[80:83], v[40:43]
  ds_read_b128 a[72:75], v17 offset:0
  ds_read_b128 a[76:79], v17 offset:1024
  v_mfma_f32_16x16x32_bf16 v[56:59], a[120:123], a[84:87], v[56:59]
  buffer_load_dwordx4 v13, s[12:15], s71 offen offset:3072 lds
  v_mfma_f32_16x16x32_bf16 v[72:75], a[120:123], a[88:91], v[72:75]
  s_bfe_u32 s72, 0x3020106, s31
  s_add_u32 s30, s30, s72
  s_add_u32 s31, s31, 8
  v_mfma_f32_16x16x32_bf16 v[88:91], a[120:123], a[92:95], v[88:91]
  s_and_b32 s31, s31, 0x8001f
  s_and_b32 s30, s30, 7
  s_lshl_b32 s72, s30, 17
  v_mfma_f32_16x16x32_bf16 v[44:47], a[124:127], a[80:83], v[44:47]
  s_add_u32 s71, s93, s72
  s_add_u32 m0, s79, 98304
  ds_read_b64_tr_b16 a[100:101], v19 offset:16384
  v_mfma_f32_16x16x32_bf16 v[60:63], a[124:127], a[84:87], v[60:63]
  buffer_load_dwordx4 v2, s[8:11], s70 offen offset:0 sc1 lds
  ds_read_b64_tr_b16 a[102:103], v19 offset:18432
  v_mfma_f32_16x16x32_bf16 v[76:79], a[124:127], a[88:91], v[76:79]
  buffer_load_dwordx4 v2, s[8:11], s70 offen offset:1024 sc1 lds
  ds_read_b64_tr_b16 a[104:105], v20 offset:16384
  v_mfma_f32_16x16x32_bf16 v[92:95], a[124:127], a[92:95], v[92:95]
  buffer_load_dwordx4 v2, s[8:11], s70 offen offset:2048 sc1 lds
  ds_read_b64_tr_b16 a[106:107], v20 offset:18432
  ds_read_b64_tr_b16 a[108:109], v21 offset:16384
  ds_read_b64_tr_b16 a[110:111], v21 offset:18432
  s_waitcnt lgkmcnt(0)
  v_mfma_f32_16x16x32_bf16 v[32:35], a[96:99], a[64:67], v[32:35]
  buffer_load_dwordx4 v2, s[8:11], s70 offen offset:3072 sc1 lds
  v_mfma_f32_16x16x32_bf16 v[48:51], a[96:99], a[68:71], v[48:51]
  s_bfe_u32 s72, 0x3020106, s1
  s_add_u32 s0, s0, s72
  s_add_u32 s1, s1, 8
  v_mfma_f32_16x16x32_bf16 v[64:67], a[96:99], a[72:75], v[64:67]
  s_and_b32 s1, s1, 0x8001f
  s_and_b32 s0, s0, 7
  s_lshl_b32 s72, s0, 14
  v_mfma_f32_16x16x32_bf16 v[80:83], a[96:99], a[76:79], v[80:83]
  s_add_u32 s70, s92, s72
  s_add_u32 m0, s64, 16384
  ds_read_b128 a[80:83], v16 offset:8192
  v_mfma_f32_16x16x32_bf16 v[36:39], a[100:103], a[64:67], v[36:39]
  buffer_load_dwordx4 v10, s[12:15], s71 offen offset:0 lds
  v_mfma_f32_16x16x32_bf16 v[52:55], a[100:103], a[68:71], v[52:55]
  buffer_load_dwordx4 v11, s[12:15], s71 offen offset:1024 lds
  v_mfma_f32_16x16x32_bf16 v[68:71], a[100:103], a[72:75], v[68:71]
  buffer_load_dwordx4 v12, s[12:15], s71 offen offset:2048 lds
  v_mfma_f32_16x16x32_bf16 v[84:87], a[100:103], a[76:79], v[84:87]
  buffer_load_dwordx4 v13, s[12:15], s71 offen offset:3072 lds
  v_mfma_f32_16x16x32_bf16 v[40:43], a[104:107], a[64:67], v[40:43]
  s_bfe_u32 s72, 0x3020106, s31
  s_add_u32 s30, s30, s72
  s_add_u32 s31, s31, 8
  v_mfma_f32_16x16x32_bf16 v[56:59], a[104:107], a[68:71], v[56:59]
  s_and_b32 s31, s31, 0x8001f
  s_and_b32 s30, s30, 7
  s_lshl_b32 s72, s30, 17
  v_mfma_f32_16x16x32_bf16 v[72:75], a[104:107], a[72:75], v[72:75]
  s_add_u32 s71, s93, s72
  s_mov_b32 m0, s64
  ds_read_b64_tr_b16 a[112:113], v18 offset:20480
  v_mfma_f32_16x16x32_bf16 v[88:91], a[104:107], a[76:79], v[88:91]
  buffer_load_dwordx4 v2, s[8:11], s70 offen offset:0 sc1 lds
  s_add_u32 s64, s64, s66
  s_add_u32 s65, s65, 1
  s_cmp_eq_u32 s65, 4
  s_cselect_b32 s65, 0, s65
  s_cselect_b32 s66, s67, s68
  v_mfma_f32_16x16x32_bf16 v[44:47], a[108:111], a[64:67], v[44:47]
  buffer_load_dwordx4 v2, s[8:11], s70 offen offset:1024 sc1 lds
  v_mfma_f32_16x16x32_bf16 v[60:63], a[108:111], a[68:71], v[60:63]
  buffer_load_dwordx4 v2, s[8:11], s70 offen offset:2048 sc1 lds
  v_mfma_f32_16x16x32_bf16 v[76:79], a[108:111], a[72:75], v[76:79]
  buffer_load_dwordx4 v2, s[8:11], s70 offen offset:3072 sc1 lds
  v_mfma_f32_16x16x32_bf16 v[92:95], a[108:111], a[76:79], v[92:95]
  s_bfe_u32 s72, 0x3020106, s1
  s_add_u32 s0, s0, s72
  s_add_u32 s1, s1, 8
  s_and_b32 s1, s1, 0x8001f
  s_and_b32 s0, s0, 7
  s_lshl_b32 s72, s0, 14
  s_add_u32 s70, s92, s72
  ds_read_b64_tr_b16 a[114:115], v18 offset:22528
  ds_read_b128 a[84:87], v16 offset:9216
  ds_read_b128 a[88:91], v17 offset:8192
  ds_read_b128 a[92:95], v17 offset:9216
  ds_read_b64_tr_b16 a[116:117], v19 offset:20480
  ds_read_b64_tr_b16 a[118:119], v19 offset:22528
  ds_read_b64_tr_b16 a[120:121], v20 offset:20480
  ds_read_b64_tr_b16 a[122:123], v20 offset:22528
  ds_read_b64_tr_b16 a[124:125], v21 offset:20480
  ds_read_b64_tr_b16 a[126:127], v21 offset:22528
  v_add_u32 v16, s66, v16
  v_add_u32 v17, s66, v17
  v_add_u32 v18, s66, v18
  v_add_u32 v19, s66, v19
  v_add_u32 v20, s66, v20
  v_add_u32 v21, s66, v21
  s_waitcnt vmcnt(19) lgkmcnt(0)
  s_barrier
  v_mfma_f32_16x16x32_bf16 v[32:35], a[112:115], a[80:83], v[32:35]
  s_add_u32 s16, s86, 100663296
  s_addc_u32 s17, s87, 0
  s_mov_b32 s18, 16777216
  v_mfma_f32_16x16x32_bf16 v[48:51], a[112:115], a[84:87], v[48:51]
  s_mov_b32 s19, 0x00020000
  s_add_u32 m0, s64, 16384
  ds_read_b128 a[64:67], v16 offset:0
  v_mfma_f32_16x16x32_bf16 v[64:67], a[112:115], a[88:91], v[64:67]
  buffer_load_dwordx4 v10, s[12:15], s71 offen offset:0 lds
  v_mfma_f32_16x16x32_bf16 v[80:83], a[112:115], a[92:95], v[80:83]
  buffer_load_dwordx4 v11, s[12:15], s71 offen offset:1024 lds
  v_mfma_f32_16x16x32_bf16 v[36:39], a[116:119], a[80:83], v[36:39]
  ds_read_b64_tr_b16 a[96:97], v18 offset:16384
  ds_read_b64_tr_b16 a[98:99], v18 offset:18432
  v_mfma_f32_16x16x32_bf16 v[52:55], a[116:119], a[84:87], v[52:55]
  ds_read_b128 a[68:71], v16 offset:1024
  ds_read_b128 a[72:75], v17 offset:0
  v_mfma_f32_16x16x32_bf16 v[68:71], a[116:119], a[88:91], v[68:71]
  ds_read_b128 a[76:79], v17 offset:1024
  ds_read_b64_tr_b16 a[100:101], v19 offset:16384
  v_mfma_f32_16x16x32_bf16 v[84:87], a[116:119], a[92:95], v[84:87]
  buffer_load_dwordx4 v12, s[12:15], s71 offen offset:2048 lds
  v_mfma_f32_16x16x32_bf16 v[40:43], a[120:123], a[80:83], v[40:43]
  ds_read_b64_tr_b16 a[102:103], v19 offset:18432
  ds_read_b64_tr_b16 a[104:105], v20 offset:16384
  v_mfma_f32_16x16x32_bf16 v[56:59], a[120:123], a[84:87], v[56:59]
  ds_read_b64_tr_b16 a[106:107], v20 offset:18432
  ds_read_b64_tr_b16 a[108:109], v21 offset:16384
  v_mfma_f32_16x16x32_bf16 v[72:75], a[120:123], a[88:91], v[72:75]
  ds_read_b64_tr_b16 a[110:111], v21 offset:18432
  v_mfma_f32_16x16x32_bf16 v[88:91], a[120:123], a[92:95], v[88:91]
  buffer_load_dwordx4 v13, s[12:15], s71 offen offset:3072 lds
  v_mfma_f32_16x16x32_bf16 v[44:47], a[124:127], a[80:83], v[44:47]
  s_bfe_u32 s72, 0x3020106, s31
  v_mfma_f32_16x16x32_bf16 v[60:63], a[124:127], a[84:87], v[60:63]
  s_add_u32 s30, s30, s72
  v_mfma_f32_16x16x32_bf16 v[76:79], a[124:127], a[88:91], v[76:79]
  s_add_u32 s31, s31, 8
  s_and_b32 s31, s31, 0x8001f
  v_mfma_f32_16x16x32_bf16 v[92:95], a[124:127], a[92:95], v[92:95]
  s_and_b32 s30, s30, 7
  s_lshl_b32 s72, s30, 17
  s_add_u32 s71, s93, s72
  s_waitcnt lgkmcnt(0)
  v_mfma_f32_16x16x32_bf16 v[32:35], a[96:99], a[64:67], v[32:35]
  s_mov_b32 m0, s64
  ds_read_b128 a[80:83], v16 offset:8192
  ds_read_b64_tr_b16 a[112:113], v18 offset:20480
  v_mfma_f32_16x16x32_bf16 v[48:51], a[96:99], a[68:71], v[48:51]
  buffer_load_dwordx4 v2, s[8:11], s70 offen offset:0 sc1 lds
  v_mfma_f32_16x16x32_bf16 v[64:67], a[96:99], a[72:75], v[64:67]
  buffer_load_dwordx4 v2, s[8:11], s70 offen offset:1024 sc1 lds
  v_mfma_f32_16x16x32_bf16 v[80:83], a[96:99], a[76:79], v[80:83]
  s_add_u32 s64, s64, s66
  ds_read_b64_tr_b16 a[114:115], v18 offset:22528
  ds_read_b128 a[84:87], v16 offset:9216
  v_mfma_f32_16x16x32_bf16 v[36:39], a[100:103], a[64:67], v[36:39]
  buffer_load_dwordx4 v2, s[8:11], s70 offen offset:2048 sc1 lds
  v_mfma_f32_16x16x32_bf16 v[52:55], a[100:103], a[68:71], v[52:55]
  s_add_u32 s65, s65, 1
  ds_read_b128 a[88:91], v17 offset:8192
  ds_read_b128 a[92:95], v17 offset:9216
  v_mfma_f32_16x16x32_bf16 v[68:71], a[100:103], a[72:75], v[68:71]
  buffer_load_dwordx4 v2, s[8:11], s70 offen offset:3072 sc1 lds
  v_mfma_f32_16x16x32_bf16 v[84:87], a[100:103], a[76:79], v[84:87]
  s_bfe_u32 s72, 0x3020106, s1
  ds_read_b64_tr_b16 a[116:117], v19 offset:20480
  ds_read_b64_tr_b16 a[118:119], v19 offset:22528
  v_mfma_f32_16x16x32_bf16 v[40:43], a[104:107], a[64:67], v[40:43]
  s_add_u32 s0, s0, s72
  ds_read_b64_tr_b16 a[120:121], v20 offset:20480
  ds_read_b64_tr_b16 a[122:123], v20 offset:22528
  v_mfma_f32_16x16x32_bf16 v[56:59], a[104:107], a[68:71], v[56:59]
  s_add_u32 s1, s1, 8
  ds_read_b64_tr_b16 a[124:125], v21 offset:20480
  ds_read_b64_tr_b16 a[126:127], v21 offset:22528
  v_mfma_f32_16x16x32_bf16 v[72:75], a[104:107], a[72:75], v[72:75]
  s_cmp_eq_u32 s65, 4
  s_cselect_b32 s65, 0, s65
  s_cselect_b32 s66, s67, s68
  v_mfma_f32_16x16x32_bf16 v[88:91], a[104:107], a[76:79], v[88:91]
  s_and_b32 s1, s1, 0x8001f
  v_add_u32 v16, s66, v16
  v_add_u32 v17, s66, v17
  v_mfma_f32_16x16x32_bf16 v[44:47], a[108:111], a[64:67], v[44:47]
  s_and_b32 s0, s0, 7
  s_lshl_b32 s72, s0, 14
  s_add_u32 s70, s92, s72
  v_mfma_f32_16x16x32_bf16 v[60:63], a[108:111], a[68:71], v[60:63]
  v_add_u32 v18, s66, v18
  v_add_u32 v19, s66, v19
  v_mfma_f32_16x16x32_bf16 v[76:79], a[108:111], a[72:75], v[76:79]
  v_add_u32 v20, s66, v20
  v_add_u32 v21, s66, v21
  v_mfma_f32_16x16x32_bf16 v[92:95], a[108:111], a[76:79], v[92:95]
  s_waitcnt vmcnt(16) lgkmcnt(0)
  s_barrier
  v_mfma_f32_16x16x32_bf16 v[32:35], a[112:115], a[80:83], v[32:35]
  s_add_u32 m0, s64, 16384
  ds_read_b128 a[64:67], v16 offset:0
  ds_read_b64_tr_b16 a[96:97], v18 offset:16384
  v_mfma_f32_16x16x32_bf16 v[48:51], a[112:115], a[84:87], v[48:51]
  buffer_load_dwordx4 v10, s[12:15], s71 offen offset:0 lds
  v_mfma_f32_16x16x32_bf16 v[64:67], a[112:115], a[88:91], v[64:67]
  ds_read_b64_tr_b16 a[98:99], v18 offset:18432
  ds_read_b128 a[68:71], v16 offset:1024
  v_mfma_f32_16x16x32_bf16 v[80:83], a[112:115], a[92:95], v[80:83]
  buffer_load_dwordx4 v11, s[12:15], s71 offen offset:1024 lds
  v_mfma_f32_16x16x32_bf16 v[36:39], a[116:119], a[80:83], v[36:39]
  ds_read_b128 a[72:75], v17 offset:0
  ds_read_b128 a[76:79], v17 offset:1024
  v_mfma_f32_16x16x32_bf16 v[52:55], a[116:119], a[84:87], v[52:55]
  ds_read_b64_tr_b16 a[100:101], v19 offset:16384
  ds_read_b64_tr_b16 a[102:103], v19 offset:18432
  v_mfma_f32_16x16x32_bf16 v[68:71], a[116:119], a[88:91], v[68:71]
  ds_read_b64_tr_b16 a[104:105], v20 offset:16384
  ds_read_b64_tr_b16 a[106:107], v20 offset:18432
  v_mfma_f32_16x16x32_bf16 v[84:87], a[116:119], a[92:95], v[84:87]
  buffer_load_dwordx4 v12, s[12:15], s71 offen offset:2048 lds
  v_mfma_f32_16x16x32_bf16 v[40:43], a[120:123], a[80:83], v[40:43]
  ds_read_b64_tr_b16 a[108:109], v21 offset:16384
  ds_read_b64_tr_b16 a[110:111], v21 offset:18432
  v_mfma_f32_16x16x32_bf16 v[56:59], a[120:123], a[84:87], v[56:59]
  v_mfma_f32_16x16x32_bf16 v[72:75], a[120:123], a[88:91], v[72:75]
  v_mfma_f32_16x16x32_bf16 v[88:91], a[120:123], a[92:95], v[88:91]
  buffer_load_dwordx4 v13, s[12:15], s71 offen offset:3072 lds
  v_mfma_f32_16x16x32_bf16 v[44:47], a[124:127], a[80:83], v[44:47]
  s_bfe_u32 s72, 0x3020106, s31
  v_mfma_f32_16x16x32_bf16 v[60:63], a[124:127], a[84:87], v[60:63]
  s_add_u32 s30, s30, s72
  v_mfma_f32_16x16x32_bf16 v[76:79], a[124:127], a[88:91], v[76:79]
  s_add_u32 s31, s31, 8
  s_and_b32 s31, s31, 0x8001f
  v_mfma_f32_16x16x32_bf16 v[92:95], a[124:127], a[92:95], v[92:95]
  s_and_b32 s30, s30, 7
  s_lshl_b32 s72, s30, 17
  s_add_u32 s71, s93, s72
  s_waitcnt lgkmcnt(0)
  v_mfma_f32_16x16x32_bf16 v[32:35], a[96:99], a[64:67], v[32:35]
  s_mov_b32 m0, s64
  ds_read_b128 a[80:83], v16 offset:8192
  ds_read_b64_tr_b16 a[112:113], v18 offset:20480
  v_mfma_f32_16x16x32_bf16 v[48:51], a[96:99], a[68:71], v[48:51]
  buffer_load_dwordx4 v2, s[8:11], s70 offen offset:0 sc1 lds
  v_mfma_f32_16x16x32_bf16 v[64:67], a[96:99], a[72:75], v[64:67]
  buffer_load_dwordx4 v2, s[8:11], s70 offen offset:1024 sc1 lds
  v_mfma_f32_16x16x32_bf16 v[80:83], a[96:99], a[76:79], v[80:83]
  s_add_u32 s64, s64, s66
  ds_read_b64_tr_b16 a[114:115], v18 offset:22528
  ds_read_b128 a[84:87], v16 offset:9216
  v_mfma_f32_16x16x32_bf16 v[36:39], a[100:103], a[64:67], v[36:39]
  buffer_load_dwordx4 v2, s[8:11], s70 offen offset:2048 sc1 lds
  v_mfma_f32_16x16x32_bf16 v[52:55], a[100:103], a[68:71], v[52:55]
  s_add_u32 s65, s65, 1
  ds_read_b128 a[88:91], v17 offset:8192
  ds_read_b128 a[92:95], v17 offset:9216
  v_mfma_f32_16x16x32_bf16 v[68:71], a[100:103], a[72:75], v[68:71]
  buffer_load_dwordx4 v2, s[8:11], s70 offen offset:3072 sc1 lds
  v_mfma_f32_16x16x32_bf16 v[84:87], a[100:103], a[76:79], v[84:87]
  s_bfe_u32 s72, 0x3020106, s1
  ds_read_b64_tr_b16 a[116:117], v19 offset:20480
  ds_read_b64_tr_b16 a[118:119], v19 offset:22528
  v_mfma_f32_16x16x32_bf16 v[40:43], a[104:107], a[64:67], v[40:43]
  s_add_u32 s0, s0, s72
  ds_read_b64_tr_b16 a[120:121], v20 offset:20480
  ds_read_b64_tr_b16 a[122:123], v20 offset:22528
  v_mfma_f32_16x16x32_bf16 v[56:59], a[104:107], a[68:71], v[56:59]
  s_add_u32 s1, s1, 8
  ds_read_b64_tr_b16 a[124:125], v21 offset:20480
  ds_read_b64_tr_b16 a[126:127], v21 offset:22528
  v_mfma_f32_16x16x32_bf16 v[72:75], a[104:107], a[72:75], v[72:75]
  s_cmp_eq_u32 s65, 4
  s_cselect_b32 s65, 0, s65
  s_cselect_b32 s66, s67, s68
  v_mfma_f32_16x16x32_bf16 v[88:91], a[104:107], a[76:79], v[88:91]
  s_and_b32 s1, s1, 0x8001f
  v_add_u32 v16, s66, v16
  v_add_u32 v17, s66, v17
  v_mfma_f32_16x16x32_bf16 v[44:47], a[108:111], a[64:67], v[44:47]
  s_and_b32 s0, s0, 7
  s_lshl_b32 s72, s0, 14
  s_add_u32 s70, s92, s72
  v_mfma_f32_16x16x32_bf16 v[60:63], a[108:111], a[68:71], v[60:63]
  v_add_u32 v18, s66, v18
  v_add_u32 v19, s66, v19
  v_mfma_f32_16x16x32_bf16 v[76:79], a[108:111], a[72:75], v[76:79]
  v_add_u32 v20, s66, v20
  v_add_u32 v21, s66, v21
  v_mfma_f32_16x16x32_bf16 v[92:95], a[108:111], a[76:79], v[92:95]
  s_waitcnt vmcnt(16) lgkmcnt(0)
  s_barrier
  v_mfma_f32_16x16x32_bf16 v[32:35], a[112:115], a[80:83], v[32:35]
  s_add_u32 m0, s64, 16384
  ds_read_b128 a[64:67], v16 offset:0
  ds_read_b64_tr_b16 a[96:97], v18 offset:16384
  v_mfma_f32_16x16x32_bf16 v[48:51], a[112:115], a[84:87], v[48:51]
  buffer_load_dwordx4 v10, s[12:15], s71 offen offset:0 lds
  v_mfma_f32_16x16x32_bf16 v[64:67], a[112:115], a[88:91], v[64:67]
  ds_read_b64_tr_b16 a[98:99], v18 offset:18432
  ds_read_b128 a[68:71], v16 offset:1024
  v_mfma_f32_16x16x32_bf16 v[80:83], a[112:115], a[92:95], v[80:83]
  buffer_load_dwordx4 v11, s[12:15], s71 offen offset:1024 lds
  v_mfma_f32_16x16x32_bf16 v[36:39], a[116:119], a[80:83], v[36:39]
  ds_read_b128 a[72:75], v17 offset:0
  ds_read_b128 a[76:79], v17 offset:1024
  v_mfma_f32_16x16x32_bf16 v[52:55], a[116:119], a[84:87], v[52:55]
  ds_read_b64_tr_b16 a[100:101], v19 offset:16384
  ds_read_b64_tr_b16 a[102:103], v19 offset:18432
  v_mfma_f32_16x16x32_bf16 v[68:71], a[116:119], a[88:91], v[68:71]
  ds_read_b64_tr_b16 a[104:105], v20 offset:16384
  ds_read_b64_tr_b16 a[106:107], v20 offset:18432
  v_mfma_f32_16x16x32_bf16 v[84:87], a[116:119], a[92:95], v[84:87]
  buffer_load_dwordx4 v12, s[12:15], s71 offen offset:2048 lds
  v_mfma_f32_16x16x32_bf16 v[40:43], a[120:123], a[80:83], v[40:43]
  ds_read_b64_tr_b16 a[108:109], v21 offset:16384
  ds_read_b64_tr_b16 a[110:111], v21 offset:18432
  v_mfma_f32_16x16x32_bf16 v[56:59], a[120:123], a[84:87], v[56:59]
  v_mfma_f32_16x16x32_bf16 v[72:75], a[120:123], a[88:91], v[72:75]
  v_mfma_f32_16x16x32_bf16 v[88:91], a[120:123], a[92:95], v[88:91]
  buffer_load_dwordx4 v13, s[12:15], s71 offen offset:3072 lds
  v_mfma_f32_16x16x32_bf16 v[44:47], a[124:127], a[80:83], v[44:47]
  s_bfe_u32 s72, 0x3020106, s31
  v_mfma_f32_16x16x32_bf16 v[60:63], a[124:127], a[84:87], v[60:63]
  s_add_u32 s30, s30, s72
  v_mfma_f32_16x16x32_bf16 v[76:79], a[124:127], a[88:91], v[76:79]
  s_add_u32 s31, s31, 8
  s_and_b32 s31, s31, 0x8001f
  v_mfma_f32_16x16x32_bf16 v[92:95], a[124:127], a[92:95], v[92:95]
  s_and_b32 s30, s30, 7
  s_lshl_b32 s72, s30, 17
  s_add_u32 s71, s93, s72
  s_waitcnt lgkmcnt(0)
  v_mfma_f32_16x16x32_bf16 v[32:35], a[96:99], a[64:67], v[32:35]
  s_mov_b32 m0, s64
  ds_read_b128 a[80:83], v16 offset:8192
  ds_read_b64_tr_b16 a[112:113], v18 offset:20480
  v_mfma_f32_16x16x32_bf16 v[48:51], a[96:99], a[68:71], v[48:51]
  buffer_load_dwordx4 v2, s[8:11], s70 offen offset:0 sc1 lds
  v_mfma_f32_16x16x32_bf16 v[64:67], a[96:99], a[72:75], v[64:67]
  buffer_load_dwordx4 v2, s[8:11], s70 offen offset:1024 sc1 lds
  v_mfma_f32_16x16x32_bf16 v[80:83], a[96:99], a[76:79], v[80:83]
  s_add_u32 s64, s64, s66
  ds_read_b64_tr_b16 a[114:115], v18 offset:22528
  ds_read_b128 a[84:87], v16 offset:9216
  v_mfma_f32_16x16x32_bf16 v[36:39], a[100:103], a[64:67], v[36:39]
  buffer_load_dwordx4 v2, s[8:11], s70 offen offset:2048 sc1 lds
  v_mfma_f32_16x16x32_bf16 v[52:55], a[100:103], a[68:71], v[52:55]
  s_add_u32 s65, s65, 1
  ds_read_b128 a[88:91], v17 offset:8192
  ds_read_b128 a[92:95], v17 offset:9216
  v_mfma_f32_16x16x32_bf16 v[68:71], a[100:103], a[72:75], v[68:71]
  buffer_load_dwordx4 v2, s[8:11], s70 offen offset:3072 sc1 lds
  v_mfma_f32_16x16x32_bf16 v[84:87], a[100:103], a[76:79], v[84:87]
  s_bfe_u32 s72, 0x3020106, s1
  ds_read_b64_tr_b16 a[116:117], v19 offset:20480
  ds_read_b64_tr_b16 a[118:119], v19 offset:22528
  v_mfma_f32_16x16x32_bf16 v[40:43], a[104:107], a[64:67], v[40:43]
  s_add_u32 s0, s0, s72
  ds_read_b64_tr_b16 a[120:121], v20 offset:20480
  ds_read_b64_tr_b16 a[122:123], v20 offset:22528
  v_mfma_f32_16x16x32_bf16 v[56:59], a[104:107], a[68:71], v[56:59]
  s_add_u32 s1, s1, 8
  ds_read_b64_tr_b16 a[124:125], v21 offset:20480
  ds_read_b64_tr_b16 a[126:127], v21 offset:22528
  v_mfma_f32_16x16x32_bf16 v[72:75], a[104:107], a[72:75], v[72:75]
  s_cmp_eq_u32 s65, 4
  s_cselect_b32 s65, 0, s65
  s_cselect_b32 s66, s67, s68
  v_mfma_f32_16x16x32_bf16 v[88:91], a[104:107], a[76:79], v[88:91]
  s_and_b32 s1, s1, 0x8001f
  v_add_u32 v16, s66, v16
  v_add_u32 v17, s66, v17
  v_mfma_f32_16x16x32_bf16 v[44:47], a[108:111], a[64:67], v[44:47]
  s_and_b32 s0, s0, 7
  s_lshl_b32 s72, s0, 14
  s_add_u32 s70, s92, s72
  v_mfma_f32_16x16x32_bf16 v[60:63], a[108:111], a[68:71], v[60:63]
  v_add_u32 v18, s66, v18
  v_add_u32 v19, s66, v19
  v_mfma_f32_16x16x32_bf16 v[76:79], a[108:111], a[72:75], v[76:79]
  v_add_u32 v20, s66, v20
  v_add_u32 v21, s66, v21
  v_mfma_f32_16x16x32_bf16 v[92:95], a[108:111], a[76:79], v[92:95]
  s_waitcnt vmcnt(16) lgkmcnt(0)
  s_barrier
  v_mfma_f32_16x16x32_bf16 v[32:35], a[112:115], a[80:83], v[32:35]
  buffer_load_dwordx2 v[6:7], v14, s[96:99], s91 offen sc1
  v_mfma_f32_16x16x32_bf16 v[48:51], a[112:115], a[84:87], v[48:51]
  s_mov_b32 s12, s74
  s_mov_b32 s13, s75
  s_mov_b32 s14, 8388608
  v_mfma_f32_16x16x32_bf16 v[64:67], a[112:115], a[88:91], v[64:67]
  s_mov_b32 s15, 0x00020000
  s_lshl_b32 s93, s77, 22
  s_lshl_b32 s72, s76, 8
  v_mfma_f32_16x16x32_bf16 v[80:83], a[112:115], a[92:95], v[80:83]
  s_add_u32 s93, s93, s72
  s_add_u32 s72, s73, s76
  s_and_b32 s31, s72, 3
  v_mfma_f32_16x16x32_bf16 v[36:39], a[116:119], a[80:83], v[36:39]
  s_lshl_b32 s31, s31, 3
  s_or_b32 s31, s31, 0x80000
  s_bfe_u32 s30, 0x1b1b02, s31
  v_mfma_f32_16x16x32_bf16 v[52:55], a[116:119], a[84:87], v[52:55]
  s_add_u32 s30, s30, 0
  s_cmp_ge_u32 s30, 28
  s_cselect_b32 s72, 28, 0
  v_mfma_f32_16x16x32_bf16 v[68:71], a[116:119], a[88:91], v[68:71]
  s_sub_u32 s30, s30, s72
  s_lshl_b32 s72, s30, 17
  s_add_u32 s71, s93, s72
  v_mfma_f32_16x16x32_bf16 v[84:87], a[116:119], a[92:95], v[84:87]
  s_add_u32 m0, s64, 16384
  ds_read_b128 a[64:67], v16 offset:0
  ds_read_b64_tr_b16 a[96:97], v18 offset:16384
  v_mfma_f32_16x16x32_bf16 v[40:43], a[120:123], a[80:83], v[40:43]
  buffer_load_dwordx4 v10, s[12:15], s71 offen offset:0 lds
  v_mfma_f32_16x16x32_bf16 v[56:59], a[120:123], a[84:87], v[56:59]
  ds_read_b64_tr_b16 a[98:99], v18 offset:18432
  ds_read_b128 a[68:71], v16 offset:1024
  v_mfma_f32_16x16x32_bf16 v[72:75], a[120:123], a[88:91], v[72:75]
  buffer_load_dwordx4 v11, s[12:15], s71 offen offset:1024 lds
  v_mfma_f32_16x16x32_bf16 v[88:91], a[120:123], a[92:95], v[88:91]
  ds_read_b128 a[72:75], v17 offset:0
  ds_read_b128 a[76:79], v17 offset:1024
  v_mfma_f32_16x16x32_bf16 v[44:47], a[124:127], a[80:83], v[44:47]
  ds_read_b64_tr_b16 a[100:101], v19 offset:16384
  ds_read_b64_tr_b16 a[102:103], v19 offset:18432
  v_mfma_f32_16x16x32_bf16 v[60:63], a[124:127], a[84:87], v[60:63]
  ds_read_b64_tr_b16 a[104:105], v20 offset:16384
  ds_read_b64_tr_b16 a[106:107], v20 offset:18432
  v_mfma_f32_16x16x32_bf16 v[76:79], a[124:127], a[88:91], v[76:79]
  ds_read_b64_tr_b16 a[108:109], v21 offset:16384
  ds_read_b64_tr_b16 a[110:111], v21 offset:18432
  v_mfma_f32_16x16x32_bf16 v[92:95], a[124:127], a[92:95], v[92:95]
  s_waitcnt lgkmcnt(0)
  v_mfma_f32_16x16x32_bf16 v[32:35], a[96:99], a[64:67], v[32:35]
  buffer_load_dwordx4 v12, s[12:15], s71 offen offset:2048 lds
  v_mfma_f32_16x16x32_bf16 v[48:51], a[96:99], a[68:71], v[48:51]
  s_add_u32 s64, s64, s66
  ds_read_b128 a[80:83], v16 offset:8192
  ds_read_b64_tr_b16 a[112:113], v18 offset:20480
  v_mfma_f32_16x16x32_bf16 v[64:67], a[96:99], a[72:75], v[64:67]
  s_add_u32 s65, s65, 1
  ds_read_b64_tr_b16 a[114:115], v18 offset:22528
  ds_read_b128 a[84:87], v16 offset:9216
  v_mfma_f32_16x16x32_bf16 v[80:83], a[96:99], a[76:79], v[80:83]
  ds_read_b128 a[88:91], v17 offset:8192
  ds_read_b128 a[92:95], v17 offset:9216
  v_mfma_f32_16x16x32_bf16 v[36:39], a[100:103], a[64:67], v[36:39]
  buffer_load_dwordx4 v13, s[12:15], s71 offen offset:3072 lds
  v_mfma_f32_16x16x32_bf16 v[52:55], a[100:103], a[68:71], v[52:55]
  s_bfe_u32 s72, 0x302011a, s31
  ds_read_b64_tr_b16 a[116:117], v19 offset:20480
  ds_read_b64_tr_b16 a[118:119], v19 offset:22528
  v_mfma_f32_16x16x32_bf16 v[68:71], a[100:103], a[72:75], v[68:71]
  s_add_u32 s30, s30, s72
  ds_read_b64_tr_b16 a[120:121], v20 offset:20480
  ds_read_b64_tr_b16 a[122:123], v20 offset:22528
  v_mfma_f32_16x16x32_bf16 v[84:87], a[100:103], a[76:79], v[84:87]
  s_add_u32 s31, s31, 8
  ds_read_b64_tr_b16 a[124:125], v21 offset:20480
  ds_read_b64_tr_b16 a[126:127], v21 offset:22528
  v_mfma_f32_16x16x32_bf16 v[40:43], a[104:107], a[64:67], v[40:43]
  s_cmp_eq_u32 s65, 4
  s_cselect_b32 s65, 0, s65
  s_cselect_b32 s66, s67, s68
  v_mfma_f32_16x16x32_bf16 v[56:59], a[104:107], a[68:71], v[56:59]
  s_and_b32 s31, s31, 0x8001f
  v_add_u32 v16, s66, v16
  v_add_u32 v17, s66, v17
  v_mfma_f32_16x16x32_bf16 v[72:75], a[104:107], a[72:75], v[72:75]
  s_cmp_ge_u32 s30, 28
  s_cselect_b32 s72, 28, 0
  v_add_u32 v18, s66, v18
  v_mfma_f32_16x16x32_bf16 v[88:91], a[104:107], a[76:79], v[88:91]
  s_sub_u32 s30, s30, s72
  v_add_u32 v19, s66, v19
  v_add_u32 v20, s66, v20
  v_mfma_f32_16x16x32_bf16 v[44:47], a[108:111], a[64:67], v[44:47]
  s_lshl_b32 s72, s30, 17
  s_add_u32 s71, s93, s72
  v_add_u32 v21, s66, v21
  v_mfma_f32_16x16x32_bf16 v[60:63], a[108:111], a[68:71], v[60:63]
  v_mfma_f32_16x16x32_bf16 v[76:79], a[108:111], a[72:75], v[76:79]
  v_mfma_f32_16x16x32_bf16 v[92:95], a[108:111], a[76:79], v[92:95]
  s_waitcnt vmcnt(4)
  v_cmp_ne_u64 vcc, s[94:95], v[6:7]
  s_nop 1
  v_cndmask_b32_e64 v8, 0, 1, vcc
  v_lshlrev_b32 v9, 2, v0
  ds_write_b32 v9, v8
  v_lshlrev_b32 v9, 4, v1
  s_waitcnt lgkmcnt(0)
  s_barrier
  ds_read_b128 v[160:163], v9
  s_waitcnt lgkmcnt(0)
  v_or3_b32 v160, v160, v161, v162
  v_or_b32 v160, v160, v163
  v_cmp_ne_u32 vcc, 0, v160
  s_nop 0
  s_cbranch_vccnz Lp6_late
  s_add_u32 s8, s86, 67108864
  s_addc_u32 s9, s87, 0
  s_mov_b32 s10, 16777216
  s_mov_b32 s11, 0x00020000
  s_lshl_b32 s92, s73, 1
  s_add_u32 s92, s92, s77
  s_lshl_b32 s92, s92, 19
  s_add_u32 s92, s92, s79
  s_add_u32 s72, s73, s76
  s_and_b32 s1, s72, 3
  s_lshl_b32 s1, s1, 3
  s_or_b32 s1, s1, 0x80000
  s_bfe_u32 s0, 0x1b1b02, s1
  s_add_u32 s0, s0, 0
  s_cmp_ge_u32 s0, 28
  s_cselect_b32 s72, 28, 0
  s_sub_u32 s0, s0, s72
  s_lshl_b32 s72, s0, 14
  s_add_u32 s70, s92, s72
  v_mfma_f32_16x16x32_bf16 v[32:35], a[112:115], a[80:83], v[32:35]
  s_add_u32 m0, s79, 131072
  ds_read_b128 a[64:67], v16 offset:0
  ds_read_b64_tr_b16 a[96:97], v18 offset:16384
  v_mfma_f32_16x16x32_bf16 v[48:51], a[112:115], a[84:87], v[48:51]
  buffer_load_dwordx4 v2, s[8:11], s70 offen offset:0 sc1 lds
  v_mfma_f32_16x16x32_bf16 v[64:67], a[112:115], a[88:91], v[64:67]
  buffer_load_dwordx4 v2, s[8:11], s70 offen offset:1024 sc1 lds
  v_mfma_f32_16x16x32_bf16 v[80:83], a[112:115], a[92:95], v[80:83]
  ds_read_b64_tr_b16 a[98:99], v18 offset:18432
  ds_read_b128 a[68:71], v16 offset:1024
  v_mfma_f32_16x16x32_bf16 v[36:39], a[116:119], a[80:83], v[36:39]
  ds_read_b128 a[72:75], v17 offset:0
  ds_read_b128 a[76:79], v17 offset:1024
  v_mfma_f32_16x16x32_bf16 v[52:55], a[116:119], a[84:87], v[52:55]
  buffer_load_dwordx4 v2, s[8:11], s70 offen offset:2048 sc1 lds
  v_mfma_f32_16x16x32_bf16 v[68:71], a[116:119], a[88:91], v[68:71]
  ds_read_b64_tr_b16 a[100:101], v19 offset:16384
  ds_read_b64_tr_b16 a[102:103], v19 offset:18432
  v_mfma_f32_16x16x32_bf16 v[84:87], a[116:119], a[92:95], v[84:87]
  buffer_load_dwordx4 v2, s[8:11], s70 offen offset:3072 sc1 lds
  v_mfma_f32_16x16x32_bf16 v[40:43], a[120:123], a[80:83], v[40:43]
  s_bfe_u32 s72, 0x302011a, s1
  s_add_u32 s0, s0, s72
  s_add_u32 s1, s1, 8
  v_mfma_f32_16x16x32_bf16 v[56:59], a[120:123], a[84:87], v[56:59]
  s_and_b32 s1, s1, 0x8001f
  s_cmp_ge_u32 s0, 28
  s_cselect_b32 s72, 28, 0
  v_mfma_f32_16x16x32_bf16 v[72:75], a[120:123], a[88:91], v[72:75]
  s_sub_u32 s0, s0, s72
  s_lshl_b32 s72, s0, 14
  s_add_u32 s70, s92, s72
  v_mfma_f32_16x16x32_bf16 v[88:91], a[120:123], a[92:95], v[88:91]
  s_add_u32 m0, s64, 16384
  ds_read_b64_tr_b16 a[104:105], v20 offset:16384
  ds_read_b64_tr_b16 a[106:107], v20 offset:18432
  v_mfma_f32_16x16x32_bf16 v[44:47], a[124:127], a[80:83], v[44:47]
  buffer_load_dwordx4 v10, s[12:15], s71 offen offset:0 lds
  v_mfma_f32_16x16x32_bf16 v[60:63], a[124:127], a[84:87], v[60:63]
  buffer_load_dwordx4 v11, s[12:15], s71 offen offset:1024 lds
  v_mfma_f32_16x16x32_bf16 v[76:79], a[124:127], a[88:91], v[76:79]
  ds_read_b64_tr_b16 a[108:109], v21 offset:16384
  ds_read_b64_tr_b16 a[110:111], v21 offset:18432
  v_mfma_f32_16x16x32_bf16 v[92:95], a[124:127], a[92:95], v[92:95]
  s_waitcnt lgkmcnt(0)
  v_mfma_f32_16x16x32_bf16 v[32:35], a[96:99], a[64:67], v[32:35]
  buffer_load_dwordx4 v12, s[12:15], s71 offen offset:2048 lds
  v_mfma_f32_16x16x32_bf16 v[48:51], a[96:99], a[68:71], v[48:51]
  buffer_load_dwordx4 v13, s[12:15], s71 offen offset:3072 lds
  v_mfma_f32_16x16x32_bf16 v[64:67], a[96:99], a[72:75], v[64:67]
  s_bfe_u32 s72, 0x302011a, s31
  s_add_u32 s30, s30, s72
  s_add_u32 s31, s31, 8
  v_mfma_f32_16x16x32_bf16 v[80:83], a[96:99], a[76:79], v[80:83]
  s_and_b32 s31, s31, 0x8001f
  s_cmp_ge_u32 s30, 28
  s_cselect_b32 s72, 28, 0
  v_mfma_f32_16x16x32_bf16 v[36:39], a[100:103], a[64:67], v[36:39]
  s_sub_u32 s30, s30, s72
  s_lshl_b32 s72, s30, 17
  s_add_u32 s71, s93, s72
  v_mfma_f32_16x16x32_bf16 v[52:55], a[100:103], a[68:71], v[52:55]
  s_mov_b32 m0, s64
  ds_read_b128 a[80:83], v16 offset:8192
  ds_read_b64_tr_b16 a[112:113], v18 offset:20480
  v_mfma_f32_16x16x32_bf16 v[68:71], a[100:103], a[72:75], v[68:71]
  buffer_load_dwordx4 v2, s[8:11], s70 offen offset:0 sc1 lds
  v_mfma_f32_16x16x32_bf16 v[84:87], a[100:103], a[76:79], v[84:87]
  buffer_load_dwordx4 v2, s[8:11], s70 offen offset:1024 sc1 lds
  v_mfma_f32_16x16x32_bf16 v[40:43], a[104:107], a[64:67], v[40:43]
  buffer_load_dwordx4 v2, s[8:11], s70 offen offset:2048 sc1 lds
  v_mfma_f32_16x16x32_bf16 v[56:59], a[104:107], a[68:71], v[56:59]
  buffer_load_dwordx4 v2, s[8:11], s70 offen offset:3072 sc1 lds
  v_mfma_f32_16x16x32_bf16 v[72:75], a[104:107], a[72:75], v[72:75]
  s_add_u32 s64, s64, s66
  ds_read_b64_tr_b16 a[114:115], v18 offset:22528
  ds_read_b128 a[84:87], v16 offset:9216
  v_mfma_f32_16x16x32_bf16 v[88:91], a[104:107], a[76:79], v[88:91]
  s_add_u32 s65, s65, 1
  ds_read_b128 a[88:91], v17 offset:8192
  ds_read_b128 a[92:95], v17 offset:9216
  v_mfma_f32_16x16x32_bf16 v[44:47], a[108:111], a[64:67], v[44:47]
  s_cmp_eq_u32 s65, 4
  s_cselect_b32 s65, 0, s65
  s_cselect_b32 s66, s67, s68
  ds_read_b64_tr_b16 a[116:117], v19 offset:20480
  ds_read_b64_tr_b16 a[118:119], v19 offset:22528
  v_mfma_f32_16x16x32_bf16 v[60:63], a[108:111], a[68:71], v[60:63]
  s_bfe_u32 s72, 0x302011a, s1
  ds_read_b64_tr_b16 a[120:121], v20 offset:20480
  ds_read_b64_tr_b16 a[122:123], v20 offset:22528
  v_mfma_f32_16x16x32_bf16 v[76:79], a[108:111], a[72:75], v[76:79]
  s_add_u32 s0, s0, s72
  ds_read_b64_tr_b16 a[124:125], v21 offset:20480
  ds_read_b64_tr_b16 a[126:127], v21 offset:22528
  v_mfma_f32_16x16x32_bf16 v[92:95], a[108:111], a[76:79], v[92:95]
  s_add_u32 s1, s1, 8
  s_and_b32 s1, s1, 0x8001f
  s_cmp_ge_u32 s0, 28
  s_cselect_b32 s72, 28, 0
  s_sub_u32 s0, s0, s72
  s_lshl_b32 s72, s0, 14
  s_add_u32 s70, s92, s72
  v_add_u32 v16, s66, v16
  v_add_u32 v17, s66, v17
  v_add_u32 v18, s66, v18
  v_add_u32 v19, s66, v19
  v_add_u32 v20, s66, v20
  v_add_u32 v21, s66, v21
  s_waitcnt vmcnt(16) lgkmcnt(0)
  s_barrier
  v_mfma_f32_16x16x32_bf16 v[32:35], a[112:115], a[80:83], v[32:35]
  s_add_u32 m0, s64, 16384
  ds_read_b128 a[64:67], v16 offset:0
  ds_read_b64_tr_b16 a[96:97], v18 offset:16384
  v_mfma_f32_16x16x32_bf16 v[48:51], a[112:115], a[84:87], v[48:51]
  buffer_load_dwordx4 v10, s[12:15], s71 offen offset:0 lds
  v_mfma_f32_16x16x32_bf16 v[64:67], a[112:115], a[88:91], v[64:67]
  ds_read_b64_tr_b16 a[98:99], v18 offset:18432
  ds_read_b128 a[68:71], v16 offset:1024
  v_mfma_f32_16x16x32_bf16 v[80:83], a[112:115], a[92:95], v[80:83]
  buffer_load_dwordx4 v11, s[12:15], s71 offen offset:1024 lds
  v_mfma_f32_16x16x32_bf16 v[36:39], a[116:119], a[80:83], v[36:39]
  ds_read_b128 a[72:75], v17 offset:0
  ds_read_b128 a[76:79], v17 offset:1024
  v_mfma_f32_16x16x32_bf16 v[52:55], a[116:119], a[84:87], v[52:55]
  ds_read_b64_tr_b16 a[100:101], v19 offset:16384
  ds_read_b64_tr_b16 a[102:103], v19 offset:18432
  v_mfma_f32_16x16x32_bf16 v[68:71], a[116:119], a[88:91], v[68:71]
  ds_read_b64_tr_b16 a[104:105], v20 offset:16384
  ds_read_b64_tr_b16 a[106:107], v20 offset:18432
  v_mfma_f32_16x16x32_bf16 v[84:87], a[116:119], a[92:95], v[84:87]
  buffer_load_dwordx4 v12, s[12:15], s71 offen offset:2048 lds
  v_mfma_f32_16x16x32_bf16 v[40:43], a[120:123], a[80:83], v[40:43]
  ds_read_b64_tr_b16 a[108:109], v21 offset:16384
  ds_read_b64_tr_b16 a[110:111], v21 offset:18432
  v_mfma_f32_16x16x32_bf16 v[56:59], a[120:123], a[84:87], v[56:59]
  v_mfma_f32_16x16x32_bf16 v[72:75], a[120:123], a[88:91], v[72:75]
  v_mfma_f32_16x16x32_bf16 v[88:91], a[120:123], a[92:95], v[88:91]
  buffer_load_dwordx4 v13, s[12:15], s71 offen offset:3072 lds
  v_mfma_f32_16x16x32_bf16 v[44:47], a[124:127], a[80:83], v[44:47]
  s_bfe_u32 s72, 0x302011a, s31
  v_mfma_f32_16x16x32_bf16 v[60:63], a[124:127], a[84:87], v[60:63]
  s_add_u32 s30, s30, s72
  v_mfma_f32_16x16x32_bf16 v[76:79], a[124:127], a[88:91], v[76:79]
  s_add_u32 s31, s31, 8
  s_and_b32 s31, s31, 0x8001f
  s_cmp_ge_u32 s30, 28
  s_cselect_b32 s72, 28, 0
  v_mfma_f32_16x16x32_bf16 v[92:95], a[124:127], a[92:95], v[92:95]
  s_sub_u32 s30, s30, s72
  s_lshl_b32 s72, s30, 17
  s_add_u32 s71, s93, s72
  s_waitcnt lgkmcnt(0)
  v_mfma_f32_16x16x32_bf16 v[32:35], a[96:99], a[64:67], v[32:35]
  s_mov_b32 m0, s64
  ds_read_b128 a[80:83], v16 offset:8192
  ds_read_b64_tr_b16 a[112:113], v18 offset:20480
  v_mfma_f32_16x16x32_bf16 v[48:51], a[96:99], a[68:71], v[48:51]
  buffer_load_dwordx4 v2, s[8:11], s70 offen offset:0 sc1 lds
  v_mfma_f32_16x16x32_bf16 v[64:67], a[96:99], a[72:75], v[64:67]
  buffer_load_dwordx4 v2, s[8:11], s70 offen offset:1024 sc1 lds
  v_mfma_f32_16x16x32_bf16 v[80:83], a[96:99], a[76:79], v[80:83]
  s_add_u32 s64, s64, s66
  ds_read_b64_tr_b16 a[114:115], v18 offset:22528
  ds_read_b128 a[84:87], v16 offset:9216
  v_mfma_f32_16x16x32_bf16 v[36:39], a[100:103], a[64:67], v[36:39]
  buffer_load_dwordx4 v2, s[8:11], s70 offen offset:2048 sc1 lds
  v_mfma_f32_16x16x32_bf16 v[52:55], a[100:103], a[68:71], v[52:55]
  s_add_u32 s65, s65, 1
  ds_read_b128 a[88:91], v17 offset:8192
  ds_read_b128 a[92:95], v17 offset:9216
  v_mfma_f32_16x16x32_bf16 v[68:71], a[100:103], a[72:75], v[68:71]
  buffer_load_dwordx4 v2, s[8:11], s70 offen offset:3072 sc1 lds
  v_mfma_f32_16x16x32_bf16 v[84:87], a[100:103], a[76:79], v[84:87]
  s_bfe_u32 s72, 0x302011a, s1
  ds_read_b64_tr_b16 a[116:117], v19 offset:20480
  ds_read_b64_tr_b16 a[118:119], v19 offset:22528
  v_mfma_f32_16x16x32_bf16 v[40:43], a[104:107], a[64:67], v[40:43]
  s_add_u32 s0, s0, s72
  ds_read_b64_tr_b16 a[120:121], v20 offset:20480
  ds_read_b64_tr_b16 a[122:123], v20 offset:22528
  v_mfma_f32_16x16x32_bf16 v[56:59], a[104:107], a[68:71], v[56:59]
  s_add_u32 s1, s1, 8
  ds_read_b64_tr_b16 a[124:125], v21 offset:20480
  ds_read_b64_tr_b16 a[126:127], v21 offset:22528
  v_mfma_f32_16x16x32_bf16 v[72:75], a[104:107], a[72:75], v[72:75]
  s_cmp_eq_u32 s65, 4
  s_cselect_b32 s65, 0, s65
  s_cselect_b32 s66, s67, s68
  v_mfma_f32_16x16x32_bf16 v[88:91], a[104:107], a[76:79], v[88:91]
  s_and_b32 s1, s1, 0x8001f
  s_cmp_ge_u32 s0, 28
  s_cselect_b32 s72, 28, 0
  v_mfma_f32_16x16x32_bf16 v[44:47], a[108:111], a[64:67], v[44:47]
  s_sub_u32 s0, s0, s72
  s_lshl_b32 s72, s0, 14
  s_add_u32 s70, s92, s72
  v_mfma_f32_16x16x32_bf16 v[60:63], a[108:111], a[68:71], v[60:63]
  v_add_u32 v16, s66, v16
  v_add_u32 v17, s66, v17
  v_mfma_f32_16x16x32_bf16 v[76:79], a[108:111], a[72:75], v[76:79]
  v_add_u32 v18, s66, v18
  v_add_u32 v19, s66, v19
  v_mfma_f32_16x16x32_bf16 v[92:95], a[108:111], a[76:79], v[92:95]
  v_add_u32 v20, s66, v20
  v_add_u32 v21, s66, v21
  s_waitcnt vmcnt(16) lgkmcnt(0)
  s_barrier
  v_mfma_f32_16x16x32_bf16 v[32:35], a[112:115], a[80:83], v[32:35]
  s_add_u32 m0, s64, 16384
  ds_read_b128 a[64:67], v16 offset:0
  ds_read_b64_tr_b16 a[96:97], v18 offset:16384
  v_mfma_f32_16x16x32_bf16 v[48:51], a[112:115], a[84:87], v[48:51]
  buffer_load_dwordx4 v10, s[12:15], s71 offen offset:0 lds
  v_mfma_f32_16x16x32_bf16 v[64:67], a[112:115], a[88:91], v[64:67]
  buffer_load_dwordx4 v11, s[12:15], s71 offen offset:1024 lds
  v_mfma_f32_16x16x32_bf16 v[80:83], a[112:115], a[92:95], v[80:83]
  buffer_load_dwordx4 v12, s[12:15], s71 offen offset:2048 lds
  v_mfma_f32_16x16x32_bf16 v[36:39], a[116:119], a[80:83], v[36:39]
  ds_read_b64_tr_b16 a[98:99], v18 offset:18432
  ds_read_b128 a[68:71], v16 offset:1024
  v_mfma_f32_16x16x32_bf16 v[52:55], a[116:119], a[84:87], v[52:55]
  buffer_load_dwordx4 v13, s[12:15], s71 offen offset:3072 lds
  v_mfma_f32_16x16x32_bf16 v[68:71], a[116:119], a[88:91], v[68:71]
  s_bfe_u32 s72, 0x302011a, s31
  s_add_u32 s30, s30, s72
  s_add_u32 s31, s31, 8
  v_mfma_f32_16x16x32_bf16 v[84:87], a[116:119], a[92:95], v[84:87]
  s_and_b32 s31, s31, 0x8001f
  s_cmp_ge_u32 s30, 28
  s_cselect_b32 s72, 28, 0
  v_mfma_f32_16x16x32_bf16 v[40:43], a[120:123], a[80:83], v[40:43]
  s_sub_u32 s30, s30, s72
  s_lshl_b32 s72, s30, 17
  s_add_u32 s71, s93, s72
  v_mfma_f32_16x16x32_bf16 v[56:59], a[120:123], a[84:87], v[56:59]
  s_mov_b32 m0, s64
  ds_read_b128 a[72:75], v17 offset:0
  ds_read_b128 a[76:79], v17 offset:1024
  v_mfma_f32_16x16x32_bf16 v[72:75], a[120:123], a[88:91], v[72:75]
  buffer_load_dwordx4 v2, s[8:11], s70 offen offset:0 sc1 lds
  v_mfma_f32_16x16x32_bf16 v[88:91], a[120:123], a[92:95], v[88:91]
  buffer_load_dwordx4 v2, s[8:11], s70 offen offset:1024 sc1 lds
  v_mfma_f32_16x16x32_bf16 v[44:47], a[124:127], a[80:83], v[44:47]
  buffer_load_dwordx4 v2, s[8:11], s70 offen offset:2048 sc1 lds
  v_mfma_f32_16x16x32_bf16 v[60:63], a[124:127], a[84:87], v[60:63]
  buffer_load_dwordx4 v2, s[8:11], s70 offen offset:3072 sc1 lds
  v_mfma_f32_16x16x32_bf16 v[76:79], a[124:127], a[88:91], v[76:79]
  s_bfe_u32 s72, 0x302011a, s1
  ds_read_b64_tr_b16 a[100:101], v19 offset:16384
  ds_read_b64_tr_b16 a[102:103], v19 offset:18432
  v_mfma_f32_16x16x32_bf16 v[92:95], a[124:127], a[92:95], v[92:95]
  s_add_u32 s0, s0, s72
  s_add_u32 s1, s1, 8
  s_and_b32 s1, s1, 0x8001f
  s_cmp_ge_u32 s0, 28
  s_cselect_b32 s72, 28, 0
  s_sub_u32 s0, s0, s72
  s_lshl_b32 s72, s0, 14
  s_add_u32 s70, s92, s72
  ds_read_b64_tr_b16 a[104:105], v20 offset:16384
  ds_read_b64_tr_b16 a[106:107], v20 offset:18432
  ds_read_b64_tr_b16 a[108:109], v21 offset:16384
  ds_read_b64_tr_b16 a[110:111], v21 offset:18432
  s_waitcnt lgkmcnt(0)
  s_lshl_b32 s6, s78, 1
  s_add_u32 s6, s6, s77
  s_xor_b32 s6, s6, 1
  s_lshl_b32 s6, s6, 2
  s_add_u32 s6, s6, s3
  s_lshl_b32 s6, s6, 14
  s_add_u32 s6, s6, 8192
  s_add_u32 s7, s6, 4096
  v_mfma_f32_16x16x32_bf16 v[96:99], a[96:99], a[64:67], 0
  s_add_u32 s64, s64, s66
  ds_read_b128 a[80:83], v16 offset:8192
  ds_read_b64_tr_b16 a[112:113], v18 offset:20480
  v_mfma_f32_16x16x32_bf16 v[112:115], a[96:99], a[68:71], 0
  s_add_u32 s65, s65, 1
  ds_read_b64_tr_b16 a[114:115], v18 offset:22528
  ds_read_b128 a[84:87], v16 offset:9216
  v_mfma_f32_16x16x32_bf16 v[128:131], a[96:99], a[72:75], 0
  ds_read_b128 a[88:91], v17 offset:8192
  ds_read_b128 a[92:95], v17 offset:9216
  v_mfma_f32_16x16x32_bf16 v[144:147], a[96:99], a[76:79], 0
  ds_read_b64_tr_b16 a[116:117], v19 offset:20480
  v_mfma_f32_16x16x32_bf16 v[100:103], a[100:103], a[64:67], 0
  ds_read_b64_tr_b16 a[118:119], v19 offset:22528
  ds_read_b64_tr_b16 a[120:121], v20 offset:20480
  v_mfma_f32_16x16x32_bf16 v[116:119], a[100:103], a[68:71], 0
  ds_read_b64_tr_b16 a[122:123], v20 offset:22528
  ds_read_b64_tr_b16 a[124:125], v21 offset:20480
  v_mfma_f32_16x16x32_bf16 v[132:135], a[100:103], a[72:75], 0
  ds_read_b64_tr_b16 a[126:127], v21 offset:22528
  v_mfma_f32_16x16x32_bf16 v[148:151], a[100:103], a[76:79], 0
  s_cmp_eq_u32 s65, 4
  s_cselect_b32 s65, 0, s65
  s_cselect_b32 s66, s67, s68
  v_mfma_f32_16x16x32_bf16 v[104:107], a[104:107], a[64:67], 0
  v_add_u32 v16, s66, v16
  v_add_u32 v17, s66, v17
  v_mfma_f32_16x16x32_bf16 v[120:123], a[104:107], a[68:71], 0
  v_add_u32 v18, s66, v18
  v_add_u32 v19, s66, v19
  v_mfma_f32_16x16x32_bf16 v[136:139], a[104:107], a[72:75], 0
  v_add_u32 v20, s66, v20
  v_add_u32 v21, s66, v21
  v_mfma_f32_16x16x32_bf16 v[152:155], a[104:107], a[76:79], 0
  buffer_store_dwordx4 v[64:67], v2, s[16:19], s6 offen offset:0 sc1
  v_mfma_f32_16x16x32_bf16 v[108:111], a[108:111], a[64:67], 0
  buffer_store_dwordx4 v[68:71], v2, s[16:19], s6 offen offset:1024 sc1
  v_mfma_f32_16x16x32_bf16 v[124:127], a[108:111], a[68:71], 0
  buffer_store_dwordx4 v[72:75], v2, s[16:19], s6 offen offset:2048 sc1
  v_mfma_f32_16x16x32_bf16 v[140:143], a[108:111], a[72:75], 0
  buffer_store_dwordx4 v[76:79], v2, s[16:19], s6 offen offset:3072 sc1
  v_mfma_f32_16x16x32_bf16 v[156:159], a[108:111], a[76:79], 0
  buffer_store_dwordx4 v[80:83], v2, s[16:19], s7 offen offset:0 sc1
  buffer_store_dwordx4 v[84:87], v2, s[16:19], s7 offen offset:1024 sc1
  buffer_store_dwordx4 v[88:91], v2, s[16:19], s7 offen offset:2048 sc1
  buffer_store_dwordx4 v[92:95], v2, s[16:19], s7 offen offset:3072 sc1
  s_branch Lp7
Lp6_late:
  v_mfma_f32_16x16x32_bf16 v[32:35], a[112:115], a[80:83], v[32:35]
  s_add_u32 m0, s64, 16384
  ds_read_b128 a[64:67], v16 offset:0
  ds_read_b64_tr_b16 a[96:97], v18 offset:16384
  v_mfma_f32_16x16x32_bf16 v[48:51], a[112:115], a[84:87], v[48:51]
  buffer_load_dwordx4 v10, s[12:15], s71 offen offset:0 lds
  v_mfma_f32_16x16x32_bf16 v[64:67], a[112:115], a[88:91], v[64:67]
  ds_read_b64_tr_b16 a[98:99], v18 offset:18432
  ds_read_b128 a[68:71], v16 offset:1024
  v_mfma_f32_16x16x32_bf16 v[80:83], a[112:115], a[92:95], v[80:83]
  ds_read_b128 a[72:75], v17 offset:0
  ds_read_b128 a[76:79], v17 offset:1024
  v_mfma_f32_16x16x32_bf16 v[36:39], a[116:119], a[80:83], v[36:39]
  ds_read_b64_tr_b16 a[100:101], v19 offset:16384
  ds_read_b64_tr_b16 a[102:103], v19 offset:18432
  v_mfma_f32_16x16x32_bf16 v[52:55], a[116:119], a[84:87], v[52:55]
  ds_read_b64_tr_b16 a[104:105], v20 offset:16384
  ds_read_b64_tr_b16 a[106:107], v20 offset:18432
  v_mfma_f32_16x16x32_bf16 v[68:71], a[116:119], a[88:91], v[68:71]
  ds_read_b64_tr_b16 a[108:109], v21 offset:16384
  ds_read_b64_tr_b16 a[110:111], v21 offset:18432
  v_mfma_f32_16x16x32_bf16 v[84:87], a[116:119], a[92:95], v[84:87]
  buffer_load_dwordx4 v11, s[12:15], s71 offen offset:1024 lds
  v_mfma_f32_16x16x32_bf16 v[40:43], a[120:123], a[80:83], v[40:43]
  v_mfma_f32_16x16x32_bf16 v[56:59], a[120:123], a[84:87], v[56:59]
  v_mfma_f32_16x16x32_bf16 v[72:75], a[120:123], a[88:91], v[72:75]
  v_mfma_f32_16x16x32_bf16 v[88:91], a[120:123], a[92:95], v[88:91]
  v_mfma_f32_16x16x32_bf16 v[44:47], a[124:127], a[80:83], v[44:47]
  v_mfma_f32_16x16x32_bf16 v[60:63], a[124:127], a[84:87], v[60:63]
  v_mfma_f32_16x16x32_bf16 v[76:79], a[124:127], a[88:91], v[76:79]
  v_mfma_f32_16x16x32_bf16 v[92:95], a[124:127], a[92:95], v[92:95]
  s_waitcnt lgkmcnt(0)
  v_mfma_f32_16x16x32_bf16 v[32:35], a[96:99], a[64:67], v[32:35]
  buffer_load_dwordx4 v12, s[12:15], s71 offen offset:2048 lds
  v_mfma_f32_16x16x32_bf16 v[48:51], a[96:99], a[68:71], v[48:51]
  s_add_u32 s64, s64, s66
  ds_read_b128 a[80:83], v16 offset:8192
  ds_read_b64_tr_b16 a[112:113], v18 offset:20480
  v_mfma_f32_16x16x32_bf16 v[64:67], a[96:99], a[72:75], v[64:67]
  s_add_u32 s65, s65, 1
  ds_read_b64_tr_b16 a[114:115], v18 offset:22528
  ds_read_b128 a[84:87], v16 offset:9216
  v_mfma_f32_16x16x32_bf16 v[80:83], a[96:99], a[76:79], v[80:83]
  ds_read_b128 a[88:91], v17 offset:8192
  ds_read_b128 a[92:95], v17 offset:9216
  v_mfma_f32_16x16x32_bf16 v[36:39], a[100:103], a[64:67], v[36:39]
  buffer_load_dwordx4 v13, s[12:15], s71 offen offset:3072 lds
  v_mfma_f32_16x16x32_bf16 v[52:55], a[100:103], a[68:71], v[52:55]
  s_bfe_u32 s72, 0x302011a, s31
  ds_read_b64_tr_b16 a[116:117], v19 offset:20480
  ds_read_b64_tr_b16 a[118:119], v19 offset:22528
  v_mfma_f32_16x16x32_bf16 v[68:71], a[100:103], a[72:75], v[68:71]
  s_add_u32 s30, s30, s72
  ds_read_b64_tr_b16 a[120:121], v20 offset:20480
  ds_read_b64_tr_b16 a[122:123], v20 offset:22528
  v_mfma_f32_16x16x32_bf16 v[84:87], a[100:103], a[76:79], v[84:87]
  s_add_u32 s31, s31, 8
  ds_read_b64_tr_b16 a[124:125], v21 offset:20480
  ds_read_b64_tr_b16 a[126:127], v21 offset:22528
  v_mfma_f32_16x16x32_bf16 v[40:43], a[104:107], a[64:67], v[40:43]
  s_cmp_eq_u32 s65, 4
  s_cselect_b32 s65, 0, s65
  s_cselect_b32 s66, s67, s68
  v_mfma_f32_16x16x32_bf16 v[56:59], a[104:107], a[68:71], v[56:59]
  s_and_b32 s31, s31, 0x8001f
  v_add_u32 v16, s66, v16
  v_add_u32 v17, s66, v17
  v_mfma_f32_16x16x32_bf16 v[72:75], a[104:107], a[72:75], v[72:75]
  s_cmp_ge_u32 s30, 28
  s_cselect_b32 s72, 28, 0
  v_add_u32 v18, s66, v18
  v_mfma_f32_16x16x32_bf16 v[88:91], a[104:107], a[76:79], v[88:91]
  s_sub_u32 s30, s30, s72
  v_add_u32 v19, s66, v19
  v_add_u32 v20, s66, v20
  v_mfma_f32_16x16x32_bf16 v[44:47], a[108:111], a[64:67], v[44:47]
  s_lshl_b32 s72, s30, 17
  s_add_u32 s71, s93, s72
  v_add_u32 v21, s66, v21
  v_mfma_f32_16x16x32_bf16 v[60:63], a[108:111], a[68:71], v[60:63]
  v_mfma_f32_16x16x32_bf16 v[76:79], a[108:111], a[72:75], v[76:79]
  v_mfma_f32_16x16x32_bf16 v[92:95], a[108:111], a[76:79], v[92:95]
  s_waitcnt vmcnt(8) lgkmcnt(0)
  s_barrier
  v_mfma_f32_16x16x32_bf16 v[32:35], a[112:115], a[80:83], v[32:35]
  s_add_u32 m0, s64, 16384
  ds_read_b128 a[64:67], v16 offset:0
  ds_read_b64_tr_b16 a[96:97], v18 offset:16384
  v_mfma_f32_16x16x32_bf16 v[48:51], a[112:115], a[84:87], v[48:51]
  buffer_load_dwordx4 v10, s[12:15], s71 offen offset:0 lds
  v_mfma_f32_16x16x32_bf16 v[64:67], a[112:115], a[88:91], v[64:67]
  ds_read_b64_tr_b16 a[98:99], v18 offset:18432
  ds_read_b128 a[68:71], v16 offset:1024
  v_mfma_f32_16x16x32_bf16 v[80:83], a[112:115], a[92:95], v[80:83]
  ds_read_b128 a[72:75], v17 offset:0
  ds_read_b128 a[76:79], v17 offset:1024
  v_mfma_f32_16x16x32_bf16 v[36:39], a[116:119], a[80:83], v[36:39]
  ds_read_b64_tr_b16 a[100:101], v19 offset:16384
  ds_read_b64_tr_b16 a[102:103], v19 offset:18432
  v_mfma_f32_16x16x32_bf16 v[52:55], a[116:119], a[84:87], v[52:55]
  buffer_load_dwordx4 v11, s[12:15], s71 offen offset:1024 lds
  v_mfma_f32_16x16x32_bf16 v[68:71], a[116:119], a[88:91], v[68:71]
  ds_read_b64_tr_b16 a[104:105], v20 offset:16384
  ds_read_b64_tr_b16 a[106:107], v20 offset:18432
  v_mfma_f32_16x16x32_bf16 v[84:87], a[116:119], a[92:95], v[84:87]
  ds_read_b64_tr_b16 a[108:109], v21 offset:16384
  ds_read_b64_tr_b16 a[110:111], v21 offset:18432
  v_mfma_f32_16x16x32_bf16 v[40:43], a[120:123], a[80:83], v[40:43]
  v_mfma_f32_16x16x32_bf16 v[56:59], a[120:123], a[84:87], v[56:59]
  v_mfma_f32_16x16x32_bf16 v[72:75], a[120:123], a[88:91], v[72:75]
  buffer_load_dwordx4 v12, s[12:15], s71 offen offset:2048 lds
  v_mfma_f32_16x16x32_bf16 v[88:91], a[120:123], a[92:95], v[88:91]
  v_mfma_f32_16x16x32_bf16 v[44:47], a[124:127], a[80:83], v[44:47]
  v_mfma_f32_16x16x32_bf16 v[60:63], a[124:127], a[84:87], v[60:63]
  v_mfma_f32_16x16x32_bf16 v[76:79], a[124:127], a[88:91], v[76:79]
  v_mfma_f32_16x16x32_bf16 v[92:95], a[124:127], a[92:95], v[92:95]
  s_waitcnt lgkmcnt(0)
  v_mfma_f32_16x16x32_bf16 v[32:35], a[96:99], a[64:67], v[32:35]
  buffer_load_dwordx4 v13, s[12:15], s71 offen offset:3072 lds
  v_mfma_f32_16x16x32_bf16 v[48:51], a[96:99], a[68:71], v[48:51]
  s_bfe_u32 s72, 0x302011a, s31
  s_add_u32 s30, s30, s72
  s_add_u32 s31, s31, 8
  v_mfma_f32_16x16x32_bf16 v[64:67], a[96:99], a[72:75], v[64:67]
  s_and_b32 s31, s31, 0x8001f
  s_cmp_ge_u32 s30, 28
  s_cselect_b32 s72, 28, 0
  v_mfma_f32_16x16x32_bf16 v[80:83], a[96:99], a[76:79], v[80:83]
  s_sub_u32 s30, s30, s72
  s_lshl_b32 s72, s30, 17
  s_add_u32 s71, s93, s72
  v_mfma_f32_16x16x32_bf16 v[36:39], a[100:103], a[64:67], v[36:39]
  buffer_load_dwordx2 v[6:7], v14, s[96:99], s91 offen sc1
  v_mfma_f32_16x16x32_bf16 v[52:55], a[100:103], a[68:71], v[52:55]
  s_add_u32 s64, s64, s66
  ds_read_b128 a[80:83], v16 offset:8192
  ds_read_b64_tr_b16 a[112:113], v18 offset:20480
  v_mfma_f32_16x16x32_bf16 v[68:71], a[100:103], a[72:75], v[68:71]
  s_add_u32 s65, s65, 1
  ds_read_b64_tr_b16 a[114:115], v18 offset:22528
  ds_read_b128 a[84:87], v16 offset:9216
  v_mfma_f32_16x16x32_bf16 v[84:87], a[100:103], a[76:79], v[84:87]
  ds_read_b128 a[88:91], v17 offset:8192
  ds_read_b128 a[92:95], v17 offset:9216
  v_mfma_f32_16x16x32_bf16 v[40:43], a[104:107], a[64:67], v[40:43]
  ds_read_b64_tr_b16 a[116:117], v19 offset:20480
  ds_read_b64_tr_b16 a[118:119], v19 offset:22528
  v_mfma_f32_16x16x32_bf16 v[56:59], a[104:107], a[68:71], v[56:59]
  ds_read_b64_tr_b16 a[120:121], v20 offset:20480
  ds_read_b64_tr_b16 a[122:123], v20 offset:22528
  v_mfma_f32_16x16x32_bf16 v[72:75], a[104:107], a[72:75], v[72:75]
  ds_read_b64_tr_b16 a[124:125], v21 offset:20480
  ds_read_b64_tr_b16 a[126:127], v21 offset:22528
  v_mfma_f32_16x16x32_bf16 v[88:91], a[104:107], a[76:79], v[88:91]
  s_cmp_eq_u32 s65, 4
  s_cselect_b32 s65, 0, s65
  s_cselect_b32 s66, s67, s68
  v_mfma_f32_16x16x32_bf16 v[44:47], a[108:111], a[64:67], v[44:47]
  v_add_u32 v16, s66, v16
  v_add_u32 v17, s66, v17
  v_mfma_f32_16x16x32_bf16 v[60:63], a[108:111], a[68:71], v[60:63]
  v_add_u32 v18, s66, v18
  v_add_u32 v19, s66, v19
  v_mfma_f32_16x16x32_bf16 v[76:79], a[108:111], a[72:75], v[76:79]
  v_add_u32 v20, s66, v20
  v_add_u32 v21, s66, v21
  v_mfma_f32_16x16x32_bf16 v[92:95], a[108:111], a[76:79], v[92:95]
  s_waitcnt vmcnt(0) lgkmcnt(0)
  s_barrier
  s_mov_b32 s5, 0x40000
Lpoll_9:
  v_cmp_ne_u64 vcc, s[94:95], v[6:7]
  s_nop 0
  s_cbranch_vccz Lpolld_10
  s_sleep 4
  buffer_load_dwordx2 v[6:7], v14, s[96:99], s91 offen sc1
  s_sub_u32 s5, s5, 1
  s_waitcnt vmcnt(0)
  s_cbranch_scc0 Lpoll_9
Lpolld_10:
  s_add_u32 s8, s86, 67108864
  s_addc_u32 s9, s87, 0
  s_mov_b32 s10, 16777216
  s_mov_b32 s11, 0x00020000
  s_lshl_b32 s92, s73, 1
  s_add_u32 s92, s92, s77
  s_lshl_b32 s92, s92, 19
  s_add_u32 s92, s92, s79
  s_add_u32 s72, s73, s76
  s_and_b32 s1, s72, 3
  s_lshl_b32 s1, s1, 3
  s_or_b32 s1, s1, 0x80000
  s_bfe_u32 s0, 0x1b1b02, s1
  s_add_u32 s0, s0, 0
  s_cmp_ge_u32 s0, 28
  s_cselect_b32 s72, 28, 0
  s_sub_u32 s0, s0, s72
  s_lshl_b32 s72, s0, 14
  s_add_u32 s70, s92, s72
  v_mfma_f32_16x16x32_bf16 v[32:35], a[112:115], a[80:83], v[32:35]
  s_add_u32 m0, s79, 131072
  v_mfma_f32_16x16x32_bf16 v[48:51], a[112:115], a[84:87], v[48:51]
  buffer_load_dwordx4 v2, s[8:11], s70 offen offset:0 sc1 lds
  v_mfma_f32_16x16x32_bf16 v[64:67], a[112:115], a[88:91], v[64:67]
  buffer_load_dwordx4 v2, s[8:11], s70 offen offset:1024 sc1 lds
  v_mfma_f32_16x16x32_bf16 v[80:83], a[112:115], a[92:95], v[80:83]
  buffer_load_dwordx4 v2, s[8:11], s70 offen offset:2048 sc1 lds
  v_mfma_f32_16x16x32_bf16 v[36:39], a[116:119], a[80:83], v[36:39]
  buffer_load_dwordx4 v2, s[8:11], s70 offen offset:3072 sc1 lds
  v_mfma_f32_16x16x32_bf16 v[52:55], a[116:119], a[84:87], v[52:55]
  s_bfe_u32 s72, 0x302011a, s1
  s_add_u32 s0, s0, s72
  s_add_u32 s1, s1, 8
  v_mfma_f32_16x16x32_bf16 v[68:71], a[116:119], a[88:91], v[68:71]
  s_and_b32 s1, s1, 0x8001f
  s_cmp_ge_u32 s0, 28
  s_cselect_b32 s72, 28, 0
  v_mfma_f32_16x16x32_bf16 v[84:87], a[116:119], a[92:95], v[84:87]
  s_sub_u32 s0, s0, s72
  s_lshl_b32 s72, s0, 14
  s_add_u32 s70, s92, s72
  v_mfma_f32_16x16x32_bf16 v[40:43], a[120:123], a[80:83], v[40:43]
  s_add_u32 m0, s79, 32768
  v_mfma_f32_16x16x32_bf16 v[56:59], a[120:123], a[84:87], v[56:59]
  buffer_load_dwordx4 v2, s[8:11], s70 offen offset:0 sc1 lds
  v_mfma_f32_16x16x32_bf16 v[72:75], a[120:123], a[88:91], v[72:75]
  buffer_load_dwordx4 v2, s[8:11], s70 offen offset:1024 sc1 lds
  v_mfma_f32_16x16x32_bf16 v[88:91], a[120:123], a[92:95], v[88:91]
  buffer_load_dwordx4 v2, s[8:11], s70 offen offset:2048 sc1 lds
  v_mfma_f32_16x16x32_bf16 v[44:47], a[124:127], a[80:83], v[44:47]
  buffer_load_dwordx4 v2, s[8:11], s70 offen offset:3072 sc1 lds
  v_mfma_f32_16x16x32_bf16 v[60:63], a[124:127], a[84:87], v[60:63]
  s_bfe_u32 s72, 0x302011a, s1
  s_add_u32 s0, s0, s72
  s_add_u32 s1, s1, 8
  v_mfma_f32_16x16x32_bf16 v[76:79], a[124:127], a[88:91], v[76:79]
  s_and_b32 s1, s1, 0x8001f
  s_cmp_ge_u32 s0, 28
  s_cselect_b32 s72, 28, 0
  v_mfma_f32_16x16x32_bf16 v[92:95], a[124:127], a[92:95], v[92:95]
  s_sub_u32 s0, s0, s72
  s_lshl_b32 s72, s0, 14
  s_add_u32 s70, s92, s72
  s_add_u32 m0, s79, 65536
  s_nop 0
  buffer_load_dwordx4 v2, s[8:11], s70 offen offset:0 sc1 lds
  buffer_load_dwordx4 v2, s[8:11], s70 offen offset:1024 sc1 lds
  buffer_load_dwordx4 v2, s[8:11], s70 offen offset:2048 sc1 lds
  buffer_load_dwordx4 v2, s[8:11], s70 offen offset:3072 sc1 lds
  s_bfe_u32 s72, 0x302011a, s1
  s_add_u32 s0, s0, s72
  s_add_u32 s1, s1, 8
  s_and_b32 s1, s1, 0x8001f
  s_cmp_ge_u32 s0, 28
  s_cselect_b32 s72, 28, 0
  s_sub_u32 s0, s0, s72
  s_lshl_b32 s72, s0, 14
  s_add_u32 s70, s92, s72
  s_add_u32 m0, s79, 114688
  s_nop 0
  buffer_load_dwordx4 v10, s[12:15], s71 offen offset:0 lds
  buffer_load_dwordx4 v11, s[12:15], s71 offen offset:1024 lds
  buffer_load_dwordx4 v12, s[12:15], s71 offen offset:2048 lds
  buffer_load_dwordx4 v13, s[12:15], s71 offen offset:3072 lds
  s_bfe_u32 s72, 0x302011a, s31
  s_add_u32 s30, s30, s72
  s_add_u32 s31, s31, 8
  s_and_b32 s31, s31, 0x8001f
  s_cmp_ge_u32 s30, 28
  s_cselect_b32 s72, 28, 0
  s_sub_u32 s30, s30, s72
  s_lshl_b32 s72, s30, 17
  s_add_u32 s71, s93, s72
  s_add_u32 m0, s79, 98304
  s_nop 0
  buffer_load_dwordx4 v2, s[8:11], s70 offen offset:0 sc1 lds
  buffer_load_dwordx4 v2, s[8:11], s70 offen offset:1024 sc1 lds
  buffer_load_dwordx4 v2, s[8:11], s70 offen offset:2048 sc1 lds
  buffer_load_dwordx4 v2, s[8:11], s70 offen offset:3072 sc1 lds
  s_bfe_u32 s72, 0x302011a, s1
  s_add_u32 s0, s0, s72
  s_add_u32 s1, s1, 8
  s_and_b32 s1, s1, 0x8001f
  s_cmp_ge_u32 s0, 28
  s_cselect_b32 s72, 28, 0
  s_sub_u32 s0, s0, s72
  s_lshl_b32 s72, s0, 14
  s_add_u32 s70, s92, s72
  s_lshl_b32 s6, s78, 1
  s_add_u32 s6, s6, s77
  s_xor_b32 s6, s6, 1
  s_lshl_b32 s6, s6, 2
  s_add_u32 s6, s6, s3
  s_lshl_b32 s6, s6, 14
  s_add_u32 s6, s6, 8192
  s_add_u32 s7, s6, 4096
  buffer_store_dwordx4 v[64:67], v2, s[16:19], s6 offen offset:0 sc1
  buffer_store_dwordx4 v[68:71], v2, s[16:19], s6 offen offset:1024 sc1
  buffer_store_dwordx4 v[72:75], v2, s[16:19], s6 offen offset:2048 sc1
  buffer_store_dwordx4 v[76:79], v2, s[16:19], s6 offen offset:3072 sc1
  buffer_store_dwordx4 v[80:83], v2, s[16:19], s7 offen offset:0 sc1
  buffer_store_dwordx4 v[84:87], v2, s[16:19], s7 offen offset:1024 sc1
  buffer_store_dwordx4 v[88:91], v2, s[16:19], s7 offen offset:2048 sc1
  buffer_store_dwordx4 v[92:95], v2, s[16:19], s7 offen offset:3072 sc1
  s_waitcnt vmcnt(24)
  s_barrier
  ds_read_b128 a[64:67], v16 offset:0
  ds_read_b64_tr_b16 a[96:97], v18 offset:16384
  ds_read_b64_tr_b16 a[98:99], v18 offset:18432
  ds_read_b128 a[68:71], v16 offset:1024
  ds_read_b128 a[72:75], v17 offset:0
  ds_read_b128 a[76:79], v17 offset:1024
  ds_read_b64_tr_b16 a[100:101], v19 offset:16384
  ds_read_b64_tr_b16 a[102:103], v19 offset:18432
  ds_read_b64_tr_b16 a[104:105], v20 offset:16384
  ds_read_b64_tr_b16 a[106:107], v20 offset:18432
  ds_read_b64_tr_b16 a[108:109], v21 offset:16384
  ds_read_b64_tr_b16 a[110:111], v21 offset:18432
  s_waitcnt lgkmcnt(0)
  v_mfma_f32_16x16x32_bf16 v[96:99], a[96:99], a[64:67], 0
  s_add_u32 s64, s64, s66
  ds_read_b128 a[80:83], v16 offset:8192
  ds_read_b64_tr_b16 a[112:113], v18 offset:20480
  v_mfma_f32_16x16x32_bf16 v[112:115], a[96:99], a[68:71], 0
  s_add_u32 s65, s65, 1
  ds_read_b64_tr_b16 a[114:115], v18 offset:22528
  ds_read_b128 a[84:87], v16 offset:9216
  v_mfma_f32_16x16x32_bf16 v[128:131], a[96:99], a[72:75], 0
  ds_read_b128 a[88:91], v17 offset:8192
  ds_read_b128 a[92:95], v17 offset:9216
  v_mfma_f32_16x16x32_bf16 v[144:147], a[96:99], a[76:79], 0
  ds_read_b64_tr_b16 a[116:117], v19 offset:20480
  v_mfma_f32_16x16x32_bf16 v[100:103], a[100:103], a[64:67], 0
  ds_read_b64_tr_b16 a[118:119], v19 offset:22528
  ds_read_b64_tr_b16 a[120:121], v20 offset:20480
  v_mfma_f32_16x16x32_bf16 v[116:119], a[100:103], a[68:71], 0
  ds_read_b64_tr_b16 a[122:123], v20 offset:22528
  ds_read_b64_tr_b16 a[124:125], v21 offset:20480
  v_mfma_f32_16x16x32_bf16 v[132:135], a[100:103], a[72:75], 0
  ds_read_b64_tr_b16 a[126:127], v21 offset:22528
  v_mfma_f32_16x16x32_bf16 v[148:151], a[100:103], a[76:79], 0
  s_cmp_eq_u32 s65, 4
  s_cselect_b32 s65, 0, s65
  s_cselect_b32 s66, s67, s68
  v_mfma_f32_16x16x32_bf16 v[104:107], a[104:107], a[64:67], 0
  v_add_u32 v16, s66, v16
  v_add_u32 v17, s66, v17
  v_mfma_f32_16x16x32_bf16 v[120:123], a[104:107], a[68:71], 0
  v_add_u32 v18, s66, v18
  v_add_u32 v19, s66, v19
  v_mfma_f32_16x16x32_bf16 v[136:139], a[104:107], a[72:75], 0
  v_add_u32 v20, s66, v20
  v_add_u32 v21, s66, v21
  v_mfma_f32_16x16x32_bf16 v[152:155], a[104:107], a[76:79], 0
  v_mfma_f32_16x16x32_bf16 v[108:111], a[108:111], a[64:67], 0
  v_mfma_f32_16x16x32_bf16 v[124:127], a[108:111], a[68:71], 0
  v_mfma_f32_16x16x32_bf16 v[140:143], a[108:111], a[72:75], 0
  v_mfma_f32_16x16x32_bf16 v[156:159], a[108:111], a[76:79], 0
Lp7:
  s_mov_b32 s69, 24
  s_waitcnt vmcnt(16) lgkmcnt(0)
  s_barrier
  .p2align 6
Lp7_loop:
  v_mfma_f32_16x16x32_bf16 v[96:99], a[112:115], a[80:83], v[96:99]
  s_add_u32 m0, s64, 16384
  ds_read_b128 a[64:67], v16 offset:0
  ds_read_b64_tr_b16 a[96:97], v18 offset:16384
  v_mfma_f32_16x16x32_bf16 v[112:115], a[112:115], a[84:87], v[112:115]
  buffer_load_dwordx4 v10, s[12:15], s71 offen offset:0 lds
  v_mfma_f32_16x16x32_bf16 v[128:131], a[112:115], a[88:91], v[128:131]
  ds_read_b64_tr_b16 a[98:99], v18 offset:18432
  ds_read_b128 a[68:71], v16 offset:1024
  v_mfma_f32_16x16x32_bf16 v[144:147], a[112:115], a[92:95], v[144:147]
  buffer_load_dwordx4 v11, s[12:15], s71 offen offset:1024 lds
  v_mfma_f32_16x16x32_bf16 v[100:103], a[116:119], a[80:83], v[100:103]
  ds_read_b128 a[72:75], v17 offset:0
  ds_read_b128 a[76:79], v17 offset:1024
  v_mfma_f32_16x16x32_bf16 v[116:119], a[116:119], a[84:87], v[116:119]
  ds_read_b64_tr_b16 a[100:101], v19 offset:16384
  ds_read_b64_tr_b16 a[102:103], v19 offset:18432
  v_mfma_f32_16x16x32_bf16 v[132:135], a[116:119], a[88:91], v[132:135]
  ds_read_b64_tr_b16 a[104:105], v20 offset:16384
  ds_read_b64_tr_b16 a[106:107], v20 offset:18432
  v_mfma_f32_16x16x32_bf16 v[148:151], a[116:119], a[92:95], v[148:151]
  buffer_load_dwordx4 v12, s[12:15], s71 offen offset:2048 lds
  v_mfma_f32_16x16x32_bf16 v[104:107], a[120:123], a[80:83], v[104:107]
  ds_read_b64_tr_b16 a[108:109], v21 offset:16384
  ds_read_b64_tr_b16 a[110:111], v21 offset:18432
  v_mfma_f32_16x16x32_bf16 v[120:123], a[120:123], a[84:87], v[120:123]
  v_mfma_f32_16x16x32_bf16 v[136:139], a[120:123], a[88:91], v[136:139]
  v_mfma_f32_16x16x32_bf16 v[152:155], a[120:123], a[92:95], v[152:155]
  buffer_load_dwordx4 v13, s[12:15], s71 offen offset:3072 lds
  v_mfma_f32_16x16x32_bf16 v[108:111], a[124:127], a[80:83], v[108:111]
  s_bfe_u32 s72, 0x302011a, s31
  v_mfma_f32_16x16x32_bf16 v[124:127], a[124:127], a[84:87], v[124:127]
  s_add_u32 s30, s30, s72
  v_mfma_f32_16x16x32_bf16 v[140:143], a[124:127], a[88:91], v[140:143]
  s_add_u32 s31, s31, 8
  s_and_b32 s31, s31, 0x8001f
  s_cmp_ge_u32 s30, 28
  s_cselect_b32 s72, 28, 0
  v_mfma_f32_16x16x32_bf16 v[156:159], a[124:127], a[92:95], v[156:159]
  s_sub_u32 s30, s30, s72
  s_lshl_b32 s72, s30, 17
  s_add_u32 s71, s93, s72
  s_waitcnt lgkmcnt(0)
  v_mfma_f32_16x16x32_bf16 v[96:99], a[96:99], a[64:67], v[96:99]
  s_mov_b32 m0, s64
  ds_read_b128 a[80:83], v16 offset:8192
  ds_read_b64_tr_b16 a[112:113], v18 offset:20480
  v_mfma_f32_16x16x32_bf16 v[112:115], a[96:99], a[68:71], v[112:115]
  buffer_load_dwordx4 v2, s[8:11], s70 offen offset:0 sc1 lds
  v_mfma_f32_16x16x32_bf16 v[128:131], a[96:99], a[72:75], v[128:131]
  buffer_load_dwordx4 v2, s[8:11], s70 offen offset:1024 sc1 lds
  v_mfma_f32_16x16x32_bf16 v[144:147], a[96:99], a[76:79], v[144:147]
  s_add_u32 s64, s64, s66
  ds_read_b64_tr_b16 a[114:115], v18 offset:22528
  ds_read_b128 a[84:87], v16 offset:9216
  v_mfma_f32_16x16x32_bf16 v[100:103], a[100:103], a[64:67], v[100:103]
  buffer_load_dwordx4 v2, s[8:11], s70 offen offset:2048 sc1 lds
  v_mfma_f32_16x16x32_bf16 v[116:119], a[100:103], a[68:71], v[116:119]
  s_add_u32 s65, s65, 1
  ds_read_b128 a[88:91], v17 offset:8192
  ds_read_b128 a[92:95], v17 offset:9216
  v_mfma_f32_16x16x32_bf16 v[132:135], a[100:103], a[72:75], v[132:135]
  buffer_load_dwordx4 v2, s[8:11], s70 offen offset:3072 sc1 lds
  v_mfma_f32_16x16x32_bf16 v[148:151], a[100:103], a[76:79], v[148:151]
  s_bfe_u32 s72, 0x302011a, s1
  ds_read_b64_tr_b16 a[116:117], v19 offset:20480
  ds_read_b64_tr_b16 a[118:119], v19 offset:22528
  v_mfma_f32_16x16x32_bf16 v[104:107], a[104:107], a[64:67], v[104:107]
  s_add_u32 s0, s0, s72
  ds_read_b64_tr_b16 a[120:121], v20 offset:20480
  ds_read_b64_tr_b16 a[122:123], v20 offset:22528
  v_mfma_f32_16x16x32_bf16 v[120:123], a[104:107], a[68:71], v[120:123]
  s_add_u32 s1, s1, 8
  ds_read_b64_tr_b16 a[124:125], v21 offset:20480
  ds_read_b64_tr_b16 a[126:127], v21 offset:22528
  v_mfma_f32_16x16x32_bf16 v[136:139], a[104:107], a[72:75], v[136:139]
  s_cmp_eq_u32 s65, 4
  s_cselect_b32 s65, 0, s65
  s_cselect_b32 s66, s67, s68
  v_mfma_f32_16x16x32_bf16 v[152:155], a[104:107], a[76:79], v[152:155]
  s_and_b32 s1, s1, 0x8001f
  s_cmp_ge_u32 s0, 28
  s_cselect_b32 s72, 28, 0
  v_mfma_f32_16x16x32_bf16 v[108:111], a[108:111], a[64:67], v[108:111]
  s_sub_u32 s0, s0, s72
  s_lshl_b32 s72, s0, 14
  s_add_u32 s70, s92, s72
  v_mfma_f32_16x16x32_bf16 v[124:127], a[108:111], a[68:71], v[124:127]
  s_waitcnt vmcnt(16) lgkmcnt(0)
  s_barrier
  v_add_u32 v16, s66, v16
  v_add_u32 v17, s66, v17
  v_mfma_f32_16x16x32_bf16 v[140:143], a[108:111], a[72:75], v[140:143]
  s_sub_u32 s69, s69, 1
  v_add_u32 v18, s66, v18
  v_add_u32 v19, s66, v19
  v_mfma_f32_16x16x32_bf16 v[156:159], a[108:111], a[76:79], v[156:159]
  v_add_u32 v20, s66, v20
  v_add_u32 v21, s66, v21
  s_cmp_lg_u32 s69, 0
  s_cbranch_scc1 Lp7_loop
  s_mov_b32 s20, s82
  s_mov_b32 s21, s83
  s_mov_b32 s22, 8388608
  s_mov_b32 s23, 0x00020000
  v_bfe_u32 v25, v1, 4, 1
  v_lshrrev_b32 v26, 5, v1
  v_lshl_or_b32 v25, v25, 1, v26
  v_lshlrev_b32 v25, 4, v25
  v_and_b32 v24, 15, v1
  v_lshl_add_u32 v26, v24, 14, v25
  v_lshl_add_u32 v27, v24, 12, v25
  v_mfma_f32_16x16x32_bf16 v[96:99], a[112:115], a[80:83], v[96:99]
  s_lshl_b32 s6, s78, 1
  s_add_u32 s6, s6, s77
  s_lshl_b32 s6, s6, 2
  v_mfma_f32_16x16x32_bf16 v[112:115], a[112:115], a[84:87], v[112:115]
  s_add_u32 s6, s6, s3
  s_lshl_b32 s6, s6, 14
  s_add_u32 s6, s6, 8192
  v_mfma_f32_16x16x32_bf16 v[128:131], a[112:115], a[88:91], v[128:131]
  s_add_u32 s7, s6, 4096
  ds_read_b128 a[64:67], v16 offset:0
  ds_read_b64_tr_b16 a[96:97], v18 offset:16384
  v_mfma_f32_16x16x32_bf16 v[144:147], a[112:115], a[92:95], v[144:147]
  buffer_load_dwordx4 v[160:163], v2, s[16:19], s6 offen offset:0 sc1
  v_mfma_f32_16x16x32_bf16 v[100:103], a[116:119], a[80:83], v[100:103]
  buffer_load_dwordx4 v[164:167], v2, s[16:19], s6 offen offset:1024 sc1
  v_mfma_f32_16x16x32_bf16 v[116:119], a[116:119], a[84:87], v[116:119]
  buffer_load_dwordx4 v[168:171], v2, s[16:19], s6 offen offset:2048 sc1
  v_mfma_f32_16x16x32_bf16 v[132:135], a[116:119], a[88:91], v[132:135]
  buffer_load_dwordx4 v[172:175], v2, s[16:19], s6 offen offset:3072 sc1
  v_mfma_f32_16x16x32_bf16 v[148:151], a[116:119], a[92:95], v[148:151]
  buffer_load_dwordx4 v[176:179], v2, s[16:19], s7 offen offset:0 sc1
  v_mfma_f32_16x16x32_bf16 v[104:107], a[120:123], a[80:83], v[104:107]
  ds_read_b64_tr_b16 a[98:99], v18 offset:18432
  ds_read_b128 a[68:71], v16 offset:1024
  v_mfma_f32_16x16x32_bf16 v[120:123], a[120:123], a[84:87], v[120:123]
  buffer_load_dwordx4 v[180:183], v2, s[16:19], s7 offen offset:1024 sc1
  v_mfma_f32_16x16x32_bf16 v[136:139], a[120:123], a[88:91], v[136:139]
  ds_read_b128 a[72:75], v17 offset:0
  ds_read_b128 a[76:79], v17 offset:1024
  v_mfma_f32_16x16x32_bf16 v[152:155], a[120:123], a[92:95], v[152:155]
  buffer_load_dwordx4 v[184:187], v2, s[16:19], s7 offen offset:2048 sc1
  v_mfma_f32_16x16x32_bf16 v[108:111], a[124:127], a[80:83], v[108:111]
  ds_read_b64_tr_b16 a[100:101], v19 offset:16384
  ds_read_b64_tr_b16 a[102:103], v19 offset:18432
  v_mfma_f32_16x16x32_bf16 v[124:127], a[124:127], a[84:87], v[124:127]
  buffer_load_dwordx4 v[188:191], v2, s[16:19], s7 offen offset:3072 sc1
  v_mfma_f32_16x16x32_bf16 v[140:143], a[124:127], a[88:91], v[140:143]
  s_lshl_b32 s32, s73, 19
  ds_read_b64_tr_b16 a[104:105], v20 offset:16384
  ds_read_b64_tr_b16 a[106:107], v20 offset:18432
  v_mfma_f32_16x16x32_bf16 v[156:159], a[124:127], a[92:95], v[156:159]
  s_lshl_b32 s72, s76, 8
  s_add_u32 s32, s32, s72
  s_and_b32 s72, s3, 1
  s_lshl_b32 s72, s72, 7
  s_add_u32 s32, s32, s72
  s_lshr_b32 s72, s3, 1
  s_lshl_b32 s72, s72, 1
  s_add_u32 s72, s72, s77
  s_lshl_b32 s72, s72, 17
  s_add_u32 s32, s32, s72
  s_add_u32 s32, s32, 2048
  s_add_u32 s33, s32, 65536
  s_lshl_b32 s34, s73, 19
  s_lshl_b32 s72, s76, 8
  s_add_u32 s34, s34, s72
  s_and_b32 s72, s3, 1
  s_lshl_b32 s72, s72, 7
  s_add_u32 s34, s34, s72
  s_lshr_b32 s72, s3, 1
  s_lshl_b32 s72, s72, 1
  s_add_u32 s72, s72, s77
  s_lshl_b32 s72, s72, 12
  s_add_u32 s34, s34, s72
  s_add_u32 s35, s34, 262144
  s_add_u32 s70, s92, 458752
  s_add_u32 s71, s93, 3670016
  ds_read_b64_tr_b16 a[108:109], v21 offset:16384
  ds_read_b64_tr_b16 a[110:111], v21 offset:18432
  s_waitcnt lgkmcnt(0)
  v_mfma_f32_16x16x32_bf16 v[96:99], a[96:99], a[64:67], v[96:99]
  s_add_u32 m0, s64, 16384
  ds_read_b128 a[80:83], v16 offset:8192
  ds_read_b64_tr_b16 a[112:113], v18 offset:20480
  v_mfma_f32_16x16x32_bf16 v[112:115], a[96:99], a[68:71], v[112:115]
  buffer_load_dwordx4 v10, s[12:15], s71 offen offset:0 lds
  v_mfma_f32_16x16x32_bf16 v[128:131], a[96:99], a[72:75], v[128:131]
  buffer_load_dwordx4 v11, s[12:15], s71 offen offset:1024 lds
  v_mfma_f32_16x16x32_bf16 v[144:147], a[96:99], a[76:79], v[144:147]
  buffer_load_dwordx4 v12, s[12:15], s71 offen offset:2048 lds
  v_mfma_f32_16x16x32_bf16 v[100:103], a[100:103], a[64:67], v[100:103]
  buffer_load_dwordx4 v13, s[12:15], s71 offen offset:3072 lds
  v_mfma_f32_16x16x32_bf16 v[116:119], a[100:103], a[68:71], v[116:119]
  s_add_u32 s71, s71, 131072
  s_mov_b32 m0, s64
  ds_read_b64_tr_b16 a[114:115], v18 offset:22528
  v_mfma_f32_16x16x32_bf16 v[132:135], a[100:103], a[72:75], v[132:135]
  buffer_load_dwordx4 v2, s[8:11], s70 offen offset:0 sc1 lds
  v_mfma_f32_16x16x32_bf16 v[148:151], a[100:103], a[76:79], v[148:151]
  buffer_load_dwordx4 v2, s[8:11], s70 offen offset:1024 sc1 lds
  v_mfma_f32_16x16x32_bf16 v[104:107], a[104:107], a[64:67], v[104:107]
  buffer_load_dwordx4 v2, s[8:11], s70 offen offset:2048 sc1 lds
  v_mfma_f32_16x16x32_bf16 v[120:123], a[104:107], a[68:71], v[120:123]
  buffer_load_dwordx4 v2, s[8:11], s70 offen offset:3072 sc1 lds
  v_mfma_f32_16x16x32_bf16 v[136:139], a[104:107], a[72:75], v[136:139]
  s_add_u32 s64, s64, s66
  ds_read_b128 a[84:87], v16 offset:9216
  ds_read_b128 a[88:91], v17 offset:8192
  v_mfma_f32_16x16x32_bf16 v[152:155], a[104:107], a[76:79], v[152:155]
  s_add_u32 s65, s65, 1
  ds_read_b128 a[92:95], v17 offset:9216
  ds_read_b64_tr_b16 a[116:117], v19 offset:20480
  v_mfma_f32_16x16x32_bf16 v[108:111], a[108:111], a[64:67], v[108:111]
  s_cmp_eq_u32 s65, 4
  s_cselect_b32 s65, 0, s65
  s_cselect_b32 s66, s67, s68
  ds_read_b64_tr_b16 a[118:119], v19 offset:22528
  ds_read_b64_tr_b16 a[120:121], v20 offset:20480
  v_mfma_f32_16x16x32_bf16 v[124:127], a[108:111], a[68:71], v[124:127]
  s_add_u32 s70, s70, 16384
  ds_read_b64_tr_b16 a[122:123], v20 offset:22528
  ds_read_b64_tr_b16 a[124:125], v21 offset:20480
  v_mfma_f32_16x16x32_bf16 v[140:143], a[108:111], a[72:75], v[140:143]
  ds_read_b64_tr_b16 a[126:127], v21 offset:22528
  v_mfma_f32_16x16x32_bf16 v[156:159], a[108:111], a[76:79], v[156:159]
  v_add_u32 v16, s66, v16
  v_add_u32 v17, s66, v17
  v_add_u32 v18, s66, v18
  v_add_u32 v19, s66, v19
  v_add_u32 v20, s66, v20
  v_add_u32 v21, s66, v21
  s_waitcnt vmcnt(24) lgkmcnt(0)
  s_barrier
  v_mfma_f32_16x16x32_bf16 v[96:99], a[112:115], a[80:83], v[96:99]
  s_add_u32 m0, s64, 16384
  ds_read_b128 a[64:67], v16 offset:0
  ds_read_b64_tr_b16 a[96:97], v18 offset:16384
  v_mfma_f32_16x16x32_bf16 v[112:115], a[112:115], a[84:87], v[112:115]
  buffer_load_dwordx4 v10, s[12:15], s71 offen offset:0 lds
  v_mfma_f32_16x16x32_bf16 v[128:131], a[112:115], a[88:91], v[128:131]
  ds_read_b64_tr_b16 a[98:99], v18 offset:18432
  ds_read_b128 a[68:71], v16 offset:1024
  v_mfma_f32_16x16x32_bf16 v[144:147], a[112:115], a[92:95], v[144:147]
  buffer_load_dwordx4 v11, s[12:15], s71 offen offset:1024 lds
  v_mfma_f32_16x16x32_bf16 v[100:103], a[116:119], a[80:83], v[100:103]
  ds_read_b128 a[72:75], v17 offset:0
  ds_read_b128 a[76:79], v17 offset:1024
  v_mfma_f32_16x16x32_bf16 v[116:119], a[116:119], a[84:87], v[116:119]
  ds_read_b64_tr_b16 a[100:101], v19 offset:16384
  ds_read_b64_tr_b16 a[102:103], v19 offset:18432
  v_mfma_f32_16x16x32_bf16 v[132:135], a[116:119], a[88:91], v[132:135]
  ds_read_b64_tr_b16 a[104:105], v20 offset:16384
  ds_read_b64_tr_b16 a[106:107], v20 offset:18432
  v_mfma_f32_16x16x32_bf16 v[148:151], a[116:119], a[92:95], v[148:151]
  buffer_load_dwordx4 v12, s[12:15], s71 offen offset:2048 lds
  v_mfma_f32_16x16x32_bf16 v[104:107], a[120:123], a[80:83], v[104:107]
  ds_read_b64_tr_b16 a[108:109], v21 offset:16384
  ds_read_b64_tr_b16 a[110:111], v21 offset:18432
  v_mfma_f32_16x16x32_bf16 v[120:123], a[120:123], a[84:87], v[120:123]
  v_mfma_f32_16x16x32_bf16 v[136:139], a[120:123], a[88:91], v[136:139]
  v_mfma_f32_16x16x32_bf16 v[152:155], a[120:123], a[92:95], v[152:155]
  buffer_load_dwordx4 v13, s[12:15], s71 offen offset:3072 lds
  v_mfma_f32_16x16x32_bf16 v[108:111], a[124:127], a[80:83], v[108:111]
  s_add_u32 s71, s71, 131072
  v_mfma_f32_16x16x32_bf16 v[124:127], a[124:127], a[84:87], v[124:127]
  v_mfma_f32_16x16x32_bf16 v[140:143], a[124:127], a[88:91], v[140:143]
  v_mfma_f32_16x16x32_bf16 v[156:159], a[124:127], a[92:95], v[156:159]
  s_waitcnt lgkmcnt(0)
  v_mfma_f32_16x16x32_bf16 v[96:99], a[96:99], a[64:67], v[96:99]
  s_mov_b32 m0, s64
  ds_read_b128 a[80:83], v16 offset:8192
  ds_read_b64_tr_b16 a[112:113], v18 offset:20480
  v_mfma_f32_16x16x32_bf16 v[112:115], a[96:99], a[68:71], v[112:115]
  buffer_load_dwordx4 v2, s[8:11], s70 offen offset:0 sc1 lds
  v_mfma_f32_16x16x32_bf16 v[128:131], a[96:99], a[72:75], v[128:131]
  buffer_load_dwordx4 v2, s[8:11], s70 offen offset:1024 sc1 lds
  v_mfma_f32_16x16x32_bf16 v[144:147], a[96:99], a[76:79], v[144:147]
  s_add_u32 s64, s64, s66
  ds_read_b64_tr_b16 a[114:115], v18 offset:22528
  ds_read_b128 a[84:87], v16 offset:9216
  v_mfma_f32_16x16x32_bf16 v[100:103], a[100:103], a[64:67], v[100:103]
  buffer_load_dwordx4 v2, s[8:11], s70 offen offset:2048 sc1 lds
  v_mfma_f32_16x16x32_bf16 v[116:119], a[100:103], a[68:71], v[116:119]
  s_add_u32 s65, s65, 1
  ds_read_b128 a[88:91], v17 offset:8192
  ds_read_b128 a[92:95], v17 offset:9216
  v_mfma_f32_16x16x32_bf16 v[132:135], a[100:103], a[72:75], v[132:135]
  buffer_load_dwordx4 v2, s[8:11], s70 offen offset:3072 sc1 lds
  v_mfma_f32_16x16x32_bf16 v[148:151], a[100:103], a[76:79], v[148:151]
  s_add_u32 s70, s70, 16384
  ds_read_b64_tr_b16 a[116:117], v19 offset:20480
  ds_read_b64_tr_b16 a[118:119], v19 offset:22528
  v_mfma_f32_16x16x32_bf16 v[104:107], a[104:107], a[64:67], v[104:107]
  ds_read_b64_tr_b16 a[120:121], v20 offset:20480
  ds_read_b64_tr_b16 a[122:123], v20 offset:22528
  v_mfma_f32_16x16x32_bf16 v[120:123], a[104:107], a[68:71], v[120:123]
  ds_read_b64_tr_b16 a[124:125], v21 offset:20480
  ds_read_b64_tr_b16 a[126:127], v21 offset:22528
  v_mfma_f32_16x16x32_bf16 v[136:139], a[104:107], a[72:75], v[136:139]
  s_cmp_eq_u32 s65, 4
  s_cselect_b32 s65, 0, s65
  s_cselect_b32 s66, s67, s68
  v_mfma_f32_16x16x32_bf16 v[152:155], a[104:107], a[76:79], v[152:155]
  v_add_u32 v16, s66, v16
  v_add_u32 v17, s66, v17
  v_mfma_f32_16x16x32_bf16 v[108:111], a[108:111], a[64:67], v[108:111]
  v_add_u32 v18, s66, v18
  v_add_u32 v19, s66, v19
  v_mfma_f32_16x16x32_bf16 v[124:127], a[108:111], a[68:71], v[124:127]
  v_add_u32 v20, s66, v20
  v_add_u32 v21, s66, v21
  v_mfma_f32_16x16x32_bf16 v[140:143], a[108:111], a[72:75], v[140:143]
  v_mfma_f32_16x16x32_bf16 v[156:159], a[108:111], a[76:79], v[156:159]
  s_waitcnt vmcnt(16) lgkmcnt(0)
  s_barrier
  s_mov_b32 s72, 0x40000
Lrc_11:
  v_max3_u32 v4, v160, v161, v162
  v_max3_u32 v5, v168, v169, v170
  v_max3_u32 v6, v176, v177, v178
  v_max3_u32 v7, v184, v185, v186
  v_max3_u32 v4, v4, v163, v164
  v_max3_u32 v5, v5, v171, v172
  v_max3_u32 v6, v6, v179, v180
  v_max3_u32 v7, v7, v187, v188
  v_max3_u32 v4, v4, v165, v166
  v_max3_u32 v5, v5, v173, v174
  v_max3_u32 v6, v6, v181, v182
  v_max3_u32 v7, v7, v189, v190
  v_max_u32 v4, v4, v167
  v_max_u32 v5, v5, v175
  v_max_u32 v6, v6, v183
  v_max_u32 v7, v7, v191
  v_max3_u32 v4, v4, v5, v6
  v_max_u32 v4, v4, v7
  v_cmp_eq_u32 vcc, -1, v4
  s_nop 0
  s_cbranch_vccz Lpolld_12
  buffer_load_dwordx4 v[160:163], v2, s[16:19], s6 offen offset:0 sc1
  buffer_load_dwordx4 v[164:167], v2, s[16:19], s6 offen offset:1024 sc1
  buffer_load_dwordx4 v[168:171], v2, s[16:19], s6 offen offset:2048 sc1
  buffer_load_dwordx4 v[172:175], v2, s[16:19], s6 offen offset:3072 sc1
  buffer_load_dwordx4 v[176:179], v2, s[16:19], s7 offen offset:0 sc1
  buffer_load_dwordx4 v[180:183], v2, s[16:19], s7 offen offset:1024 sc1
  buffer_load_dwordx4 v[184:187], v2, s[16:19], s7 offen offset:2048 sc1
  buffer_load_dwordx4 v[188:191], v2, s[16:19], s7 offen offset:3072 sc1
  s_sub_u32 s72, s72, 1
  s_waitcnt vmcnt(0)
  s_cbranch_scc0 Lrc_11
Lpolld_12:
  v_mfma_f32_16x16x32_bf16 v[96:99], a[112:115], a[80:83], v[96:99]
  s_and_b32 s88, s3, 1
  s_lshl_b32 s88, s88, 12
  s_lshr_b32 s72, s3, 1
  v_mfma_f32_16x16x32_bf16 v[112:115], a[112:115], a[84:87], v[112:115]
  s_lshl_b32 s72, s72, 13
  s_add_u32 s88, s88, s72
  s_lshl_b32 s72, s77, 11
  v_mfma_f32_16x16x32_bf16 v[128:131], a[112:115], a[88:91], v[128:131]
  s_add_u32 s88, s88, s72
  s_sub_u32 s88, s88, s79
  s_add_u32 s70, s92, s88
  v_mfma_f32_16x16x32_bf16 v[144:147], a[112:115], a[92:95], v[144:147]
  s_add_u32 s70, s70, 491520
  s_add_u32 s71, s93, 3932160
  s_add_u32 m0, s64, 16384
  v_mfma_f32_16x16x32_bf16 v[100:103], a[116:119], a[80:83], v[100:103]
  buffer_load_dwordx4 v10, s[12:15], s71 offen offset:0 lds
  v_mfma_f32_16x16x32_bf16 v[116:119], a[116:119], a[84:87], v[116:119]
  buffer_load_dwordx4 v11, s[12:15], s71 offen offset:1024 lds
  v_mfma_f32_16x16x32_bf16 v[132:135], a[116:119], a[88:91], v[132:135]
  ds_read_b128 a[64:67], v16 offset:0
  ds_read_b64_tr_b16 a[96:97], v18 offset:16384
  v_mfma_f32_16x16x32_bf16 v[148:151], a[116:119], a[92:95], v[148:151]
  ds_read_b64_tr_b16 a[98:99], v18 offset:18432
  ds_read_b128 a[68:71], v16 offset:1024
  v_mfma_f32_16x16x32_bf16 v[104:107], a[120:123], a[80:83], v[104:107]
  ds_read_b128 a[72:75], v17 offset:0
  ds_read_b128 a[76:79], v17 offset:1024
  v_mfma_f32_16x16x32_bf16 v[120:123], a[120:123], a[84:87], v[120:123]
  ds_read_b64_tr_b16 a[100:101], v19 offset:16384
  ds_read_b64_tr_b16 a[102:103], v19 offset:18432
  v_mfma_f32_16x16x32_bf16 v[136:139], a[120:123], a[88:91], v[136:139]
  buffer_load_dwordx4 v12, s[12:15], s71 offen offset:2048 lds
  v_mfma_f32_16x16x32_bf16 v[152:155], a[120:123], a[92:95], v[152:155]
  ds_read_b64_tr_b16 a[104:105], v20 offset:16384
  ds_read_b64_tr_b16 a[106:107], v20 offset:18432
  v_mfma_f32_16x16x32_bf16 v[108:111], a[124:127], a[80:83], v[108:111]
  ds_read_b64_tr_b16 a[108:109], v21 offset:16384
  ds_read_b64_tr_b16 a[110:111], v21 offset:18432
  v_mfma_f32_16x16x32_bf16 v[124:127], a[124:127], a[84:87], v[124:127]
  v_pk_add_f32 v[160:161], v[160:161], v[32:33]
  v_pk_add_f32 v[162:163], v[162:163], v[34:35]
  v_mfma_f32_16x16x32_bf16 v[140:143], a[124:127], a[88:91], v[140:143]
  v_pk_add_f32 v[164:165], v[164:165], v[36:37]
  v_pk_add_f32 v[166:167], v[166:167], v[38:39]
  v_mfma_f32_16x16x32_bf16 v[156:159], a[124:127], a[92:95], v[156:159]
  v_cvt_pk_bf16_f32 v160, v160, v161
  v_cvt_pk_bf16_f32 v161, v162, v163
  v_cvt_pk_bf16_f32 v162, v164, v165
  v_cvt_pk_bf16_f32 v163, v166, v167
  s_nop 0
  v_permlane16_swap_b32 v160, v162
  v_permlane16_swap_b32 v161, v163
  s_waitcnt lgkmcnt(0)
  v_mfma_f32_16x16x32_bf16 v[96:99], a[96:99], a[64:67], v[96:99]
  buffer_load_dwordx4 v13, s[12:15], s71 offen offset:3072 lds
  v_mfma_f32_16x16x32_bf16 v[112:115], a[96:99], a[68:71], v[112:115]
  s_add_u32 s71, s71, 131072
  s_add_u32 m0, s64, s88
  ds_read_b128 a[80:83], v16 offset:8192
  v_mfma_f32_16x16x32_bf16 v[128:131], a[96:99], a[72:75], v[128:131]
  s_add_u32 s64, s64, s66
  ds_read_b64_tr_b16 a[112:113], v18 offset:20480
  ds_read_b64_tr_b16 a[114:115], v18 offset:22528
  v_mfma_f32_16x16x32_bf16 v[144:147], a[96:99], a[76:79], v[144:147]
  buffer_load_dwordx4 v2, s[8:11], s70 offen offset:0 sc1 lds
  v_mfma_f32_16x16x32_bf16 v[100:103], a[100:103], a[64:67], v[100:103]
  s_add_u32 s65, s65, 1
  ds_read_b128 a[84:87], v16 offset:9216
  ds_read_b128 a[88:91], v17 offset:8192
  v_mfma_f32_16x16x32_bf16 v[116:119], a[100:103], a[68:71], v[116:119]
  ds_read_b128 a[92:95], v17 offset:9216
  ds_read_b64_tr_b16 a[116:117], v19 offset:20480
  v_mfma_f32_16x16x32_bf16 v[132:135], a[100:103], a[72:75], v[132:135]
  buffer_load_dwordx4 v2, s[8:11], s70 offen offset:1024 sc1 lds
  v_mfma_f32_16x16x32_bf16 v[148:151], a[100:103], a[76:79], v[148:151]
  s_add_u32 s70, s70, 16384
  ds_read_b64_tr_b16 a[118:119], v19 offset:22528
  ds_read_b64_tr_b16 a[120:121], v20 offset:20480
  v_mfma_f32_16x16x32_bf16 v[104:107], a[104:107], a[64:67], v[104:107]
  ds_read_b64_tr_b16 a[122:123], v20 offset:22528
  ds_read_b64_tr_b16 a[124:125], v21 offset:20480
  v_mfma_f32_16x16x32_bf16 v[120:123], a[104:107], a[68:71], v[120:123]
  ds_read_b64_tr_b16 a[126:127], v21 offset:22528
  v_mfma_f32_16x16x32_bf16 v[136:139], a[104:107], a[72:75], v[136:139]
  s_cmp_eq_u32 s65, 4
  s_cselect_b32 s65, 0, s65
  s_cselect_b32 s66, s67, s68
  v_mfma_f32_16x16x32_bf16 v[152:155], a[104:107], a[76:79], v[152:155]
  v_add_u32 v16, s66, v16
  v_add_u32 v17, s66, v17
  v_mfma_f32_16x16x32_bf16 v[108:111], a[108:111], a[64:67], v[108:111]
  v_add_u32 v18, s66, v18
  v_add_u32 v19, s66, v19
  v_mfma_f32_16x16x32_bf16 v[124:127], a[108:111], a[68:71], v[124:127]
  v_add_u32 v20, s66, v20
  v_add_u32 v21, s66, v21
  v_mfma_f32_16x16x32_bf16 v[140:143], a[108:111], a[72:75], v[140:143]
  v_mfma_f32_16x16x32_bf16 v[156:159], a[108:111], a[76:79], v[156:159]
  buffer_store_dwordx4 v[160:163], v27, s[20:23], s32 offen offset:0
  s_waitcnt vmcnt(15) lgkmcnt(0)
  s_barrier
  v_mfma_f32_16x16x32_bf16 v[96:99], a[112:115], a[80:83], v[96:99]
  s_add_u32 m0, s64, 16384
  ds_read_b128 a[64:67], v16 offset:0
  ds_read_b64_tr_b16 a[96:97], v18 offset:16384
  v_mfma_f32_16x16x32_bf16 v[112:115], a[112:115], a[84:87], v[112:115]
  buffer_load_dwordx4 v10, s[12:15], s71 offen offset:0 lds
  v_mfma_f32_16x16x32_bf16 v[128:131], a[112:115], a[88:91], v[128:131]
  ds_read_b64_tr_b16 a[98:99], v18 offset:18432
  ds_read_b128 a[68:71], v16 offset:1024
  v_mfma_f32_16x16x32_bf16 v[144:147], a[112:115], a[92:95], v[144:147]
  ds_read_b128 a[72:75], v17 offset:0
  ds_read_b128 a[76:79], v17 offset:1024
  v_mfma_f32_16x16x32_bf16 v[100:103], a[116:119], a[80:83], v[100:103]
  ds_read_b64_tr_b16 a[100:101], v19 offset:16384
  ds_read_b64_tr_b16 a[102:103], v19 offset:18432
  v_mfma_f32_16x16x32_bf16 v[116:119], a[116:119], a[84:87], v[116:119]
  buffer_load_dwordx4 v11, s[12:15], s71 offen offset:1024 lds
  v_mfma_f32_16x16x32_bf16 v[132:135], a[116:119], a[88:91], v[132:135]
  ds_read_b64_tr_b16 a[104:105], v20 offset:16384
  ds_read_b64_tr_b16 a[106:107], v20 offset:18432
  v_mfma_f32_16x16x32_bf16 v[148:151], a[116:119], a[92:95], v[148:151]
  ds_read_b64_tr_b16 a[108:109], v21 offset:16384
  ds_read_b64_tr_b16 a[110:111], v21 offset:18432
  v_mfma_f32_16x16x32_bf16 v[104:107], a[120:123], a[80:83], v[104:107]
  v_pk_add_f32 v[168:169], v[168:169], v[40:41]
  v_pk_add_f32 v[170:171], v[170:171], v[42:43]
  v_mfma_f32_16x16x32_bf16 v[120:123], a[120:123], a[84:87], v[120:123]
  v_pk_add_f32 v[172:173], v[172:173], v[44:45]
  v_pk_add_f32 v[174:175], v[174:175], v[46:47]
  v_mfma_f32_16x16x32_bf16 v[136:139], a[120:123], a[88:91], v[136:139]
  buffer_load_dwordx4 v12, s[12:15], s71 offen offset:2048 lds
  v_mfma_f32_16x16x32_bf16 v[152:155], a[120:123], a[92:95], v[152:155]
  v_cvt_pk_bf16_f32 v168, v168, v169
  v_cvt_pk_bf16_f32 v169, v170, v171
  v_mfma_f32_16x16x32_bf16 v[108:111], a[124:127], a[80:83], v[108:111]
  v_cvt_pk_bf16_f32 v170, v172, v173
  v_cvt_pk_bf16_f32 v171, v174, v175
  v_mfma_f32_16x16x32_bf16 v[124:127], a[124:127], a[84:87], v[124:127]
  v_permlane16_swap_b32 v168, v170
  v_permlane16_swap_b32 v169, v171
  v_mfma_f32_16x16x32_bf16 v[140:143], a[124:127], a[88:91], v[140:143]
  v_mfma_f32_16x16x32_bf16 v[156:159], a[124:127], a[92:95], v[156:159]
  s_waitcnt lgkmcnt(0)
  v_mfma_f32_16x16x32_bf16 v[96:99], a[96:99], a[64:67], v[96:99]
  buffer_load_dwordx4 v13, s[12:15], s71 offen offset:3072 lds
  v_mfma_f32_16x16x32_bf16 v[112:115], a[96:99], a[68:71], v[112:115]
  s_add_u32 s71, s71, 131072
  s_add_u32 m0, s64, s88
  ds_read_b128 a[80:83], v16 offset:8192
  v_mfma_f32_16x16x32_bf16 v[128:131], a[96:99], a[72:75], v[128:131]
  s_add_u32 s64, s64, s66
  ds_read_b64_tr_b16 a[112:113], v18 offset:20480
  ds_read_b64_tr_b16 a[114:115], v18 offset:22528
  v_mfma_f32_16x16x32_bf16 v[144:147], a[96:99], a[76:79], v[144:147]
  buffer_load_dwordx4 v2, s[8:11], s70 offen offset:0 sc1 lds
  v_mfma_f32_16x16x32_bf16 v[100:103], a[100:103], a[64:67], v[100:103]
  s_add_u32 s65, s65, 1
  ds_read_b128 a[84:87], v16 offset:9216
  ds_read_b128 a[88:91], v17 offset:8192
  v_mfma_f32_16x16x32_bf16 v[116:119], a[100:103], a[68:71], v[116:119]
  ds_read_b128 a[92:95], v17 offset:9216
  ds_read_b64_tr_b16 a[116:117], v19 offset:20480
  v_mfma_f32_16x16x32_bf16 v[132:135], a[100:103], a[72:75], v[132:135]
  buffer_load_dwordx4 v2, s[8:11], s70 offen offset:1024 sc1 lds
  v_mfma_f32_16x16x32_bf16 v[148:151], a[100:103], a[76:79], v[148:151]
  s_add_u32 s70, s70, 16384
  ds_read_b64_tr_b16 a[118:119], v19 offset:22528
  ds_read_b64_tr_b16 a[120:121], v20 offset:20480
  v_mfma_f32_16x16x32_bf16 v[104:107], a[104:107], a[64:67], v[104:107]
  ds_read_b64_tr_b16 a[122:123], v20 offset:22528
  ds_read_b64_tr_b16 a[124:125], v21 offset:20480
  v_mfma_f32_16x16x32_bf16 v[120:123], a[104:107], a[68:71], v[120:123]
  ds_read_b64_tr_b16 a[126:127], v21 offset:22528
  v_mfma_f32_16x16x32_bf16 v[136:139], a[104:107], a[72:75], v[136:139]
  s_cmp_eq_u32 s65, 4
  s_cselect_b32 s65, 0, s65
  s_cselect_b32 s66, s67, s68
  v_mfma_f32_16x16x32_bf16 v[152:155], a[104:107], a[76:79], v[152:155]
  v_add_u32 v16, s66, v16
  v_add_u32 v17, s66, v17
  v_mfma_f32_16x16x32_bf16 v[108:111], a[108:111], a[64:67], v[108:111]
  v_add_u32 v18, s66, v18
  v_add_u32 v19, s66, v19
  v_mfma_f32_16x16x32_bf16 v[124:127], a[108:111], a[68:71], v[124:127]
  v_add_u32 v20, s66, v20
  v_add_u32 v21, s66, v21
  v_mfma_f32_16x16x32_bf16 v[140:143], a[108:111], a[72:75], v[140:143]
  v_mfma_f32_16x16x32_bf16 v[156:159], a[108:111], a[76:79], v[156:159]
  buffer_store_dwordx4 v[168:171], v27, s[20:23], s32 offen offset:64
  s_waitcnt vmcnt(14) lgkmcnt(0)
  s_barrier
  v_mfma_f32_16x16x32_bf16 v[96:99], a[112:115], a[80:83], v[96:99]
  s_sub_u32 s70, s70, 32768
  s_xor_b32 s70, s70, 524288
  s_sub_u32 s71, s71, 262144
  v_mfma_f32_16x16x32_bf16 v[112:115], a[112:115], a[84:87], v[112:115]
  s_xor_b32 s71, s71, 4194304
  s_add_u32 m0, s64, 16384
  ds_read_b128 a[64:67], v16 offset:0
  v_mfma_f32_16x16x32_bf16 v[128:131], a[112:115], a[88:91], v[128:131]
  buffer_load_dwordx4 v10, s[12:15], s71 offen offset:0 lds
  v_mfma_f32_16x16x32_bf16 v[144:147], a[112:115], a[92:95], v[144:147]
  ds_read_b64_tr_b16 a[96:97], v18 offset:16384
  ds_read_b64_tr_b16 a[98:99], v18 offset:18432
  v_mfma_f32_16x16x32_bf16 v[100:103], a[116:119], a[80:83], v[100:103]
  ds_read_b128 a[68:71], v16 offset:1024
  ds_read_b128 a[72:75], v17 offset:0
  v_mfma_f32_16x16x32_bf16 v[116:119], a[116:119], a[84:87], v[116:119]
  buffer_load_dwordx4 v11, s[12:15], s71 offen offset:1024 lds
  v_mfma_f32_16x16x32_bf16 v[132:135], a[116:119], a[88:91], v[132:135]
  ds_read_b128 a[76:79], v17 offset:1024
  ds_read_b64_tr_b16 a[100:101], v19 offset:16384
  v_mfma_f32_16x16x32_bf16 v[148:151], a[116:119], a[92:95], v[148:151]
  ds_read_b64_tr_b16 a[102:103], v19 offset:18432
  ds_read_b64_tr_b16 a[104:105], v20 offset:16384
  v_mfma_f32_16x16x32_bf16 v[104:107], a[120:123], a[80:83], v[104:107]
  ds_read_b64_tr_b16 a[106:107], v20 offset:18432
  ds_read_b64_tr_b16 a[108:109], v21 offset:16384
  v_mfma_f32_16x16x32_bf16 v[120:123], a[120:123], a[84:87], v[120:123]
  ds_read_b64_tr_b16 a[110:111], v21 offset:18432
  v_pk_add_f32 v[176:177], v[176:177], v[48:49]
  v_mfma_f32_16x16x32_bf16 v[136:139], a[120:123], a[88:91], v[136:139]
  buffer_load_dwordx4 v12, s[12:15], s71 offen offset:2048 lds
  v_mfma_f32_16x16x32_bf16 v[152:155], a[120:123], a[92:95], v[152:155]
  v_pk_add_f32 v[178:179], v[178:179], v[50:51]
  v_pk_add_f32 v[180:181], v[180:181], v[52:53]
  v_mfma_f32_16x16x32_bf16 v[108:111], a[124:127], a[80:83], v[108:111]
  v_pk_add_f32 v[182:183], v[182:183], v[54:55]
  v_cvt_pk_bf16_f32 v176, v176, v177
  v_mfma_f32_16x16x32_bf16 v[124:127], a[124:127], a[84:87], v[124:127]
  v_cvt_pk_bf16_f32 v177, v178, v179
  v_cvt_pk_bf16_f32 v178, v180, v181
  v_mfma_f32_16x16x32_bf16 v[140:143], a[124:127], a[88:91], v[140:143]
  v_cvt_pk_bf16_f32 v179, v182, v183
  v_permlane16_swap_b32 v176, v178
  v_mfma_f32_16x16x32_bf16 v[156:159], a[124:127], a[92:95], v[156:159]
  v_permlane16_swap_b32 v177, v179
  s_waitcnt lgkmcnt(0)
  v_mfma_f32_16x16x32_bf16 v[96:99], a[96:99], a[64:67], v[96:99]
  buffer_load_dwordx4 v13, s[12:15], s71 offen offset:3072 lds
  v_mfma_f32_16x16x32_bf16 v[112:115], a[96:99], a[68:71], v[112:115]
  s_add_u32 s71, s71, 131072
  s_add_u32 m0, s64, s88
  ds_read_b128 a[80:83], v16 offset:8192
  v_mfma_f32_16x16x32_bf16 v[128:131], a[96:99], a[72:75], v[128:131]
  s_add_u32 s64, s64, s66
  ds_read_b64_tr_b16 a[112:113], v18 offset:20480
  ds_read_b64_tr_b16 a[114:115], v18 offset:22528
  v_mfma_f32_16x16x32_bf16 v[144:147], a[96:99], a[76:79], v[144:147]
  buffer_load_dwordx4 v2, s[8:11], s70 offen offset:0 sc1 lds
  v_mfma_f32_16x16x32_bf16 v[100:103], a[100:103], a[64:67], v[100:103]
  s_add_u32 s65, s65, 1
  ds_read_b128 a[84:87], v16 offset:9216
  ds_read_b128 a[88:91], v17 offset:8192
  v_mfma_f32_16x16x32_bf16 v[116:119], a[100:103], a[68:71], v[116:119]
  ds_read_b128 a[92:95], v17 offset:9216
  ds_read_b64_tr_b16 a[116:117], v19 offset:20480
  v_mfma_f32_16x16x32_bf16 v[132:135], a[100:103], a[72:75], v[132:135]
  buffer_load_dwordx4 v2, s[8:11], s70 offen offset:1024 sc1 lds
  v_mfma_f32_16x16x32_bf16 v[148:151], a[100:103], a[76:79], v[148:151]
  s_add_u32 s70, s70, 16384
  ds_read_b64_tr_b16 a[118:119], v19 offset:22528
  ds_read_b64_tr_b16 a[120:121], v20 offset:20480
  v_mfma_f32_16x16x32_bf16 v[104:107], a[104:107], a[64:67], v[104:107]
  ds_read_b64_tr_b16 a[122:123], v20 offset:22528
  ds_read_b64_tr_b16 a[124:125], v21 offset:20480
  v_mfma_f32_16x16x32_bf16 v[120:123], a[104:107], a[68:71], v[120:123]
  ds_read_b64_tr_b16 a[126:127], v21 offset:22528
  v_mfma_f32_16x16x32_bf16 v[136:139], a[104:107], a[72:75], v[136:139]
  s_cmp_eq_u32 s65, 4
  s_cselect_b32 s65, 0, s65
  s_cselect_b32 s66, s67, s68
  v_mfma_f32_16x16x32_bf16 v[152:155], a[104:107], a[76:79], v[152:155]
  v_add_u32 v16, s66, v16
  v_add_u32 v17, s66, v17
  v_mfma_f32_16x16x32_bf16 v[108:111], a[108:111], a[64:67], v[108:111]
  v_add_u32 v18, s66, v18
  v_add_u32 v19, s66, v19
  v_mfma_f32_16x16x32_bf16 v[124:127], a[108:111], a[68:71], v[124:127]
  v_add_u32 v20, s66, v20
  v_add_u32 v21, s66, v21
  v_mfma_f32_16x16x32_bf16 v[140:143], a[108:111], a[72:75], v[140:143]
  v_mfma_f32_16x16x32_bf16 v[156:159], a[108:111], a[76:79], v[156:159]
  buffer_store_dwordx4 v[176:179], v27, s[20:23], s33 offen offset:0
  s_waitcnt vmcnt(15) lgkmcnt(0)
  s_barrier
  v_mfma_f32_16x16x32_bf16 v[96:99], a[112:115], a[80:83], v[96:99]
  s_add_u32 m0, s64, 16384
  ds_read_b128 a[64:67], v16 offset:0
  ds_read_b64_tr_b16 a[96:97], v18 offset:16384
  v_mfma_f32_16x16x32_bf16 v[112:115], a[112:115], a[84:87], v[112:115]
  buffer_load_dwordx4 v10, s[12:15], s71 offen offset:0 lds
  v_mfma_f32_16x16x32_bf16 v[128:131], a[112:115], a[88:91], v[128:131]
  buffer_load_dwordx4 v11, s[12:15], s71 offen offset:1024 lds
  v_mfma_f32_16x16x32_bf16 v[144:147], a[112:115], a[92:95], v[144:147]
  ds_read_b64_tr_b16 a[98:99], v18 offset:18432
  ds_read_b128 a[68:71], v16 offset:1024
  v_mfma_f32_16x16x32_bf16 v[100:103], a[116:119], a[80:83], v[100:103]
  ds_read_b64_tr_b16 a[100:101], v19 offset:16384
  ds_read_b64_tr_b16 a[102:103], v19 offset:18432
  v_mfma_f32_16x16x32_bf16 v[116:119], a[116:119], a[84:87], v[116:119]
  buffer_load_dwordx4 v12, s[12:15], s71 offen offset:2048 lds
  v_mfma_f32_16x16x32_bf16 v[132:135], a[116:119], a[88:91], v[132:135]
  ds_read_b64_tr_b16 a[104:105], v20 offset:16384
  ds_read_b64_tr_b16 a[106:107], v20 offset:18432
  v_mfma_f32_16x16x32_bf16 v[148:151], a[116:119], a[92:95], v[148:151]
  buffer_load_dwordx4 v13, s[12:15], s71 offen offset:3072 lds
  v_mfma_f32_16x16x32_bf16 v[104:107], a[120:123], a[80:83], v[104:107]
  s_add_u32 s71, s71, 131072
  s_add_u32 m0, s64, s88
  ds_read_b64_tr_b16 a[108:109], v21 offset:16384
  v_mfma_f32_16x16x32_bf16 v[120:123], a[120:123], a[84:87], v[120:123]
  ds_read_b64_tr_b16 a[110:111], v21 offset:18432
  v_pk_add_f32 v[184:185], v[184:185], v[56:57]
  v_mfma_f32_16x16x32_bf16 v[136:139], a[120:123], a[88:91], v[136:139]
  buffer_load_dwordx4 v2, s[8:11], s70 offen offset:0 sc1 lds
  v_mfma_f32_16x16x32_bf16 v[152:155], a[120:123], a[92:95], v[152:155]
  v_pk_add_f32 v[186:187], v[186:187], v[58:59]
  v_pk_add_f32 v[188:189], v[188:189], v[60:61]
  v_mfma_f32_16x16x32_bf16 v[108:111], a[124:127], a[80:83], v[108:111]
  buffer_load_dwordx4 v2, s[8:11], s70 offen offset:1024 sc1 lds
  v_mfma_f32_16x16x32_bf16 v[124:127], a[124:127], a[84:87], v[124:127]
  s_add_u32 s70, s70, 16384
  s_lshl_b32 s36, s78, 1
  v_pk_add_f32 v[190:191], v[190:191], v[62:63]
  v_cvt_pk_bf16_f32 v184, v184, v185
  v_mfma_f32_16x16x32_bf16 v[140:143], a[124:127], a[88:91], v[140:143]
  s_add_u32 s36, s36, s77
  s_xor_b32 s36, s36, 1
  s_lshl_b32 s36, s36, 2
  v_cvt_pk_bf16_f32 v185, v186, v187
  v_mfma_f32_16x16x32_bf16 v[156:159], a[124:127], a[92:95], v[156:159]
  s_add_u32 s36, s36, s3
  s_lshl_b32 s36, s36, 14
  s_add_u32 s37, s36, 4096
  v_cvt_pk_bf16_f32 v186, v188, v189
  v_cvt_pk_bf16_f32 v187, v190, v191
  s_nop 0
  v_permlane16_swap_b32 v184, v186
  v_permlane16_swap_b32 v185, v187
  s_waitcnt lgkmcnt(0)
  v_mfma_f32_16x16x32_bf16 v[96:99], a[96:99], a[64:67], v[96:99]
  buffer_store_dwordx4 v[128:131], v2, s[16:19], s36 offen offset:0 sc1
  ds_read_b128 a[80:83], v16 offset:8192
  s_add_u32 s64, s64, s66
  s_add_u32 s65, s65, 1
  s_cmp_eq_u32 s65, 4
  s_cselect_b32 s65, 0, s65
  s_cselect_b32 s66, s67, s68
  v_mfma_f32_16x16x32_bf16 v[112:115], a[96:99], a[68:71], v[112:115]
  buffer_store_dwordx4 v[132:135], v2, s[16:19], s36 offen offset:1024 sc1
  ds_read_b64_tr_b16 a[112:113], v18 offset:20480
  v_mfma_f32_16x16x32_bf16 v[100:103], a[100:103], a[64:67], v[100:103]
  buffer_store_dwordx4 v[136:139], v2, s[16:19], s36 offen offset:2048 sc1
  ds_read_b64_tr_b16 a[114:115], v18 offset:22528
  v_mfma_f32_16x16x32_bf16 v[116:119], a[100:103], a[68:71], v[116:119]
  buffer_store_dwordx4 v[140:143], v2, s[16:19], s36 offen offset:3072 sc1
  ds_read_b128 a[84:87], v16 offset:9216
  v_mfma_f32_16x16x32_bf16 v[104:107], a[104:107], a[64:67], v[104:107]
  buffer_store_dwordx4 v[144:147], v2, s[16:19], s37 offen offset:0 sc1
  ds_read_b64_tr_b16 a[116:117], v19 offset:20480
  v_mfma_f32_16x16x32_bf16 v[120:123], a[104:107], a[68:71], v[120:123]
  buffer_store_dwordx4 v[148:151], v2, s[16:19], s37 offen offset:1024 sc1
  ds_read_b64_tr_b16 a[118:119], v19 offset:22528
  v_mfma_f32_16x16x32_bf16 v[108:111], a[108:111], a[64:67], v[108:111]
  buffer_store_dwordx4 v[152:155], v2, s[16:19], s37 offen offset:2048 sc1
  ds_read_b64_tr_b16 a[120:121], v20 offset:20480
  v_mfma_f32_16x16x32_bf16 v[124:127], a[108:111], a[68:71], v[124:127]
  buffer_store_dwordx4 v[156:159], v2, s[16:19], s37 offen offset:3072 sc1
  ds_read_b64_tr_b16 a[122:123], v20 offset:22528
  ds_read_b64_tr_b16 a[124:125], v21 offset:20480
  ds_read_b64_tr_b16 a[126:127], v21 offset:22528
  v_add_u32 v16, s66, v16
  v_add_u32 v17, s66, v17
  v_add_u32 v18, s66, v18
  v_add_u32 v19, s66, v19
  v_add_u32 v20, s66, v20
  v_add_u32 v21, s66, v21
  buffer_store_dwordx4 v[184:187], v27, s[20:23], s33 offen offset:64
  s_waitcnt vmcnt(23) lgkmcnt(0)
  s_barrier
  v_mfma_f32_16x16x32_bf16 v[96:99], a[112:115], a[80:83], v[96:99]
  ds_read_b128 a[64:67], v16 offset:0
  ds_read_b64_tr_b16 a[96:97], v18 offset:16384
  v_mfma_f32_16x16x32_bf16 v[112:115], a[112:115], a[84:87], v[112:115]
  ds_read_b64_tr_b16 a[98:99], v18 offset:18432
  ds_read_b128 a[68:71], v16 offset:1024
  v_mfma_f32_16x16x32_bf16 v[100:103], a[116:119], a[80:83], v[100:103]
  ds_read_b64_tr_b16 a[100:101], v19 offset:16384
  v_mfma_f32_16x16x32_bf16 v[116:119], a[116:119], a[84:87], v[116:119]
  ds_read_b64_tr_b16 a[102:103], v19 offset:18432
  ds_read_b64_tr_b16 a[104:105], v20 offset:16384
  v_mfma_f32_16x16x32_bf16 v[104:107], a[120:123], a[80:83], v[104:107]
  ds_read_b64_tr_b16 a[106:107], v20 offset:18432
  ds_read_b64_tr_b16 a[108:109], v21 offset:16384
  v_mfma_f32_16x16x32_bf16 v[120:123], a[120:123], a[84:87], v[120:123]
  ds_read_b64_tr_b16 a[110:111], v21 offset:18432
  v_mfma_f32_16x16x32_bf16 v[108:111], a[124:127], a[80:83], v[108:111]
  v_mfma_f32_16x16x32_bf16 v[124:127], a[124:127], a[84:87], v[124:127]
  s_waitcnt lgkmcnt(0)
  v_mfma_f32_16x16x32_bf16 v[96:99], a[96:99], a[64:67], v[96:99]
  s_add_u32 s64, s64, s66
  ds_read_b128 a[80:83], v16 offset:8192
  ds_read_b64_tr_b16 a[112:113], v18 offset:20480
  v_mfma_f32_16x16x32_bf16 v[112:115], a[96:99], a[68:71], v[112:115]
  s_add_u32 s65, s65, 1
  ds_read_b64_tr_b16 a[114:115], v18 offset:22528
  ds_read_b128 a[84:87], v16 offset:9216
  v_mfma_f32_16x16x32_bf16 v[100:103], a[100:103], a[64:67], v[100:103]
  s_cmp_eq_u32 s65, 4
  s_cselect_b32 s65, 0, s65
  s_cselect_b32 s66, s67, s68
  ds_read_b64_tr_b16 a[116:117], v19 offset:20480
  v_mfma_f32_16x16x32_bf16 v[116:119], a[100:103], a[68:71], v[116:119]
  ds_read_b64_tr_b16 a[118:119], v19 offset:22528
  ds_read_b64_tr_b16 a[120:121], v20 offset:20480
  v_mfma_f32_16x16x32_bf16 v[104:107], a[104:107], a[64:67], v[104:107]
  ds_read_b64_tr_b16 a[122:123], v20 offset:22528
  ds_read_b64_tr_b16 a[124:125], v21 offset:20480
  v_mfma_f32_16x16x32_bf16 v[120:123], a[104:107], a[68:71], v[120:123]
  ds_read_b64_tr_b16 a[126:127], v21 offset:22528
  v_mfma_f32_16x16x32_bf16 v[108:111], a[108:111], a[64:67], v[108:111]
  v_add_u32 v16, s66, v16
  v_add_u32 v17, s66, v17
  v_add_u32 v20, s66, v20
  v_mfma_f32_16x16x32_bf16 v[124:127], a[108:111], a[68:71], v[124:127]
  v_add_u32 v18, s66, v18
  v_add_u32 v19, s66, v19
  v_add_u32 v21, s66, v21
  s_waitcnt vmcnt(16) lgkmcnt(0)
  s_barrier
  v_mfma_f32_16x16x32_bf16 v[96:99], a[112:115], a[80:83], v[96:99]
  ds_read_b128 a[64:67], v16 offset:0
  ds_read_b64_tr_b16 a[96:97], v18 offset:16384
  v_mfma_f32_16x16x32_bf16 v[112:115], a[112:115], a[84:87], v[112:115]
  ds_read_b64_tr_b16 a[98:99], v18 offset:18432
  ds_read_b128 a[68:71], v16 offset:1024
  v_mfma_f32_16x16x32_bf16 v[100:103], a[116:119], a[80:83], v[100:103]
  ds_read_b64_tr_b16 a[100:101], v19 offset:16384
  v_mfma_f32_16x16x32_bf16 v[116:119], a[116:119], a[84:87], v[116:119]
  ds_read_b64_tr_b16 a[102:103], v19 offset:18432
  ds_read_b64_tr_b16 a[104:105], v20 offset:16384
  v_mfma_f32_16x16x32_bf16 v[104:107], a[120:123], a[80:83], v[104:107]
  ds_read_b64_tr_b16 a[106:107], v20 offset:18432
  ds_read_b64_tr_b16 a[108:109], v21 offset:16384
  v_mfma_f32_16x16x32_bf16 v[120:123], a[120:123], a[84:87], v[120:123]
  ds_read_b64_tr_b16 a[110:111], v21 offset:18432
  v_mfma_f32_16x16x32_bf16 v[108:111], a[124:127], a[80:83], v[108:111]
  v_mfma_f32_16x16x32_bf16 v[124:127], a[124:127], a[84:87], v[124:127]
  s_waitcnt lgkmcnt(0)
  v_mfma_f32_16x16x32_bf16 v[96:99], a[96:99], a[64:67], v[96:99]
  s_add_u32 s64, s64, s66
  ds_read_b128 a[80:83], v16 offset:8192
  ds_read_b64_tr_b16 a[112:113], v18 offset:20480
  v_mfma_f32_16x16x32_bf16 v[112:115], a[96:99], a[68:71], v[112:115]
  s_add_u32 s65, s65, 1
  ds_read_b64_tr_b16 a[114:115], v18 offset:22528
  ds_read_b128 a[84:87], v16 offset:9216
  v_mfma_f32_16x16x32_bf16 v[100:103], a[100:103], a[64:67], v[100:103]
  s_cmp_eq_u32 s65, 4
  s_cselect_b32 s65, 0, s65
  s_cselect_b32 s66, s67, s68
  ds_read_b64_tr_b16 a[116:117], v19 offset:20480
  v_mfma_f32_16x16x32_bf16 v[116:119], a[100:103], a[68:71], v[116:119]
  ds_read_b64_tr_b16 a[118:119], v19 offset:22528
  ds_read_b64_tr_b16 a[120:121], v20 offset:20480
  v_mfma_f32_16x16x32_bf16 v[104:107], a[104:107], a[64:67], v[104:107]
  ds_read_b64_tr_b16 a[122:123], v20 offset:22528
  ds_read_b64_tr_b16 a[124:125], v21 offset:20480
  v_mfma_f32_16x16x32_bf16 v[120:123], a[104:107], a[68:71], v[120:123]
  ds_read_b64_tr_b16 a[126:127], v21 offset:22528
  v_mfma_f32_16x16x32_bf16 v[108:111], a[108:111], a[64:67], v[108:111]
  v_add_u32 v16, s66, v16
  v_add_u32 v17, s66, v17
  v_add_u32 v20, s66, v20
  v_mfma_f32_16x16x32_bf16 v[124:127], a[108:111], a[68:71], v[124:127]
  v_add_u32 v18, s66, v18
  v_add_u32 v19, s66, v19
  v_add_u32 v21, s66, v21
  s_waitcnt vmcnt(9) lgkmcnt(0)
  s_barrier
  v_mfma_f32_16x16x32_bf16 v[96:99], a[112:115], a[80:83], v[96:99]
  s_lshl_b32 s6, s78, 1
  s_add_u32 s6, s6, s77
  s_lshl_b32 s6, s6, 2
  v_mfma_f32_16x16x32_bf16 v[112:115], a[112:115], a[84:87], v[112:115]
  s_add_u32 s6, s6, s3
  s_lshl_b32 s6, s6, 14
  s_add_u32 s7, s6, 4096
  v_mfma_f32_16x16x32_bf16 v[100:103], a[116:119], a[80:83], v[100:103]
  buffer_load_dwordx4 v[192:195], v2, s[16:19], s6 offen offset:0 sc1
  v_mfma_f32_16x16x32_bf16 v[116:119], a[116:119], a[84:87], v[116:119]
  buffer_load_dwordx4 v[196:199], v2, s[16:19], s6 offen offset:1024 sc1
  v_mfma_f32_16x16x32_bf16 v[104:107], a[120:123], a[80:83], v[104:107]
  buffer_load_dwordx4 v[200:203], v2, s[16:19], s6 offen offset:2048 sc1
  v_mfma_f32_16x16x32_bf16 v[120:123], a[120:123], a[84:87], v[120:123]
  buffer_load_dwordx4 v[204:207], v2, s[16:19], s6 offen offset:3072 sc1
  v_mfma_f32_16x16x32_bf16 v[108:111], a[124:127], a[80:83], v[108:111]
  ds_read_b128 a[64:67], v16 offset:0
  ds_read_b64_tr_b16 a[96:97], v18 offset:16384
  v_mfma_f32_16x16x32_bf16 v[124:127], a[124:127], a[84:87], v[124:127]
  ds_read_b64_tr_b16 a[98:99], v18 offset:18432
  ds_read_b128 a[68:71], v16 offset:1024
  ds_read_b64_tr_b16 a[100:101], v19 offset:16384
  ds_read_b64_tr_b16 a[102:103], v19 offset:18432
  ds_read_b64_tr_b16 a[104:105], v20 offset:16384
  ds_read_b64_tr_b16 a[106:107], v20 offset:18432
  ds_read_b64_tr_b16 a[108:109], v21 offset:16384
  ds_read_b64_tr_b16 a[110:111], v21 offset:18432
  s_waitcnt lgkmcnt(0)
  v_mfma_f32_16x16x32_bf16 v[96:99], a[96:99], a[64:67], v[96:99]
  buffer_load_dwordx4 v[208:211], v2, s[16:19], s7 offen offset:0 sc1
  v_mfma_f32_16x16x32_bf16 v[112:115], a[96:99], a[68:71], v[112:115]
  buffer_load_dwordx4 v[212:215], v2, s[16:19], s7 offen offset:1024 sc1
  v_mfma_f32_16x16x32_bf16 v[100:103], a[100:103], a[64:67], v[100:103]
  ds_read_b128 a[80:83], v16 offset:8192
  ds_read_b64_tr_b16 a[112:113], v18 offset:20480
  v_mfma_f32_16x16x32_bf16 v[116:119], a[100:103], a[68:71], v[116:119]
  buffer_load_dwordx4 v[216:219], v2, s[16:19], s7 offen offset:2048 sc1
  v_mfma_f32_16x16x32_bf16 v[104:107], a[104:107], a[64:67], v[104:107]
  ds_read_b64_tr_b16 a[114:115], v18 offset:22528
  ds_read_b128 a[84:87], v16 offset:9216
  v_mfma_f32_16x16x32_bf16 v[120:123], a[104:107], a[68:71], v[120:123]
  buffer_load_dwordx4 v[220:223], v2, s[16:19], s7 offen offset:3072 sc1
  v_mfma_f32_16x16x32_bf16 v[108:111], a[108:111], a[64:67], v[108:111]
  ds_read_b64_tr_b16 a[116:117], v19 offset:20480
  ds_read_b64_tr_b16 a[118:119], v19 offset:22528
  v_mfma_f32_16x16x32_bf16 v[124:127], a[108:111], a[68:71], v[124:127]
  ds_read_b64_tr_b16 a[120:121], v20 offset:20480
  ds_read_b64_tr_b16 a[122:123], v20 offset:22528
  ds_read_b64_tr_b16 a[124:125], v21 offset:20480
  ds_read_b64_tr_b16 a[126:127], v21 offset:22528
  s_waitcnt lgkmcnt(0)
  v_mfma_f32_16x16x32_bf16 v[96:99], a[112:115], a[80:83], v[96:99]
  v_mfma_f32_16x16x32_bf16 v[112:115], a[112:115], a[84:87], v[112:115]
  v_mfma_f32_16x16x32_bf16 v[100:103], a[116:119], a[80:83], v[100:103]
  v_mfma_f32_16x16x32_bf16 v[116:119], a[116:119], a[84:87], v[116:119]
  v_mfma_f32_16x16x32_bf16 v[104:107], a[120:123], a[80:83], v[104:107]
  v_mfma_f32_16x16x32_bf16 v[120:123], a[120:123], a[84:87], v[120:123]
  v_mfma_f32_16x16x32_bf16 v[108:111], a[124:127], a[80:83], v[108:111]
  v_mfma_f32_16x16x32_bf16 v[124:127], a[124:127], a[84:87], v[124:127]
  s_waitcnt vmcnt(0)
  s_mov_b32 s72, 0x40000
Lrc_13:
  v_max3_u32 v4, v192, v193, v194
  v_max3_u32 v5, v200, v201, v202
  v_max3_u32 v6, v208, v209, v210
  v_max3_u32 v7, v216, v217, v218
  v_max3_u32 v4, v4, v195, v196
  v_max3_u32 v5, v5, v203, v204
  v_max3_u32 v6, v6, v211, v212
  v_max3_u32 v7, v7, v219, v220
  v_max3_u32 v4, v4, v197, v198
  v_max3_u32 v5, v5, v205, v206
  v_max3_u32 v6, v6, v213, v214
  v_max3_u32 v7, v7, v221, v222
  v_max_u32 v4, v4, v199
  v_max_u32 v5, v5, v207
  v_max_u32 v6, v6, v215
  v_max_u32 v7, v7, v223
  v_max3_u32 v4, v4, v5, v6
  v_max_u32 v4, v4, v7
  v_cmp_eq_u32 vcc, -1, v4
  s_nop 0
  s_cbranch_vccz Lpolld_14
  buffer_load_dwordx4 v[192:195], v2, s[16:19], s6 offen offset:0 sc1
  buffer_load_dwordx4 v[196:199], v2, s[16:19], s6 offen offset:1024 sc1
  buffer_load_dwordx4 v[200:203], v2, s[16:19], s6 offen offset:2048 sc1
  buffer_load_dwordx4 v[204:207], v2, s[16:19], s6 offen offset:3072 sc1
  buffer_load_dwordx4 v[208:211], v2, s[16:19], s7 offen offset:0 sc1
  buffer_load_dwordx4 v[212:215], v2, s[16:19], s7 offen offset:1024 sc1
  buffer_load_dwordx4 v[216:219], v2, s[16:19], s7 offen offset:2048 sc1
  buffer_load_dwordx4 v[220:223], v2, s[16:19], s7 offen offset:3072 sc1
  s_sub_u32 s72, s72, 1
  s_waitcnt vmcnt(0)
  s_cbranch_scc0 Lrc_13
Lpolld_14:
  v_pk_add_f32 v[192:193], v[192:193], v[96:97]
  v_pk_add_f32 v[200:201], v[200:201], v[104:105]
  v_pk_add_f32 v[208:209], v[208:209], v[112:113]
  v_pk_add_f32 v[216:217], v[216:217], v[120:121]
  v_pk_add_f32 v[194:195], v[194:195], v[98:99]
  v_pk_add_f32 v[202:203], v[202:203], v[106:107]
  v_pk_add_f32 v[210:211], v[210:211], v[114:115]
  v_pk_add_f32 v[218:219], v[218:219], v[122:123]
  v_pk_add_f32 v[196:197], v[196:197], v[100:101]
  v_pk_add_f32 v[204:205], v[204:205], v[108:109]
  v_pk_add_f32 v[212:213], v[212:213], v[116:117]
  v_pk_add_f32 v[220:221], v[220:221], v[124:125]
  v_pk_add_f32 v[198:199], v[198:199], v[102:103]
  v_pk_add_f32 v[206:207], v[206:207], v[110:111]
  v_pk_add_f32 v[214:215], v[214:215], v[118:119]
  v_pk_add_f32 v[222:223], v[222:223], v[126:127]
  v_cvt_pk_bf16_f32 v192, v192, v193
  v_cvt_pk_bf16_f32 v200, v200, v201
  v_cvt_pk_bf16_f32 v208, v208, v209
  v_cvt_pk_bf16_f32 v216, v216, v217
  v_cvt_pk_bf16_f32 v193, v194, v195
  v_cvt_pk_bf16_f32 v201, v202, v203
  v_cvt_pk_bf16_f32 v209, v210, v211
  v_cvt_pk_bf16_f32 v217, v218, v219
  v_cvt_pk_bf16_f32 v194, v196, v197
  v_cvt_pk_bf16_f32 v202, v204, v205
  v_cvt_pk_bf16_f32 v210, v212, v213
  v_cvt_pk_bf16_f32 v218, v220, v221
  v_cvt_pk_bf16_f32 v195, v198, v199
  v_cvt_pk_bf16_f32 v203, v206, v207
  v_cvt_pk_bf16_f32 v211, v214, v215
  v_cvt_pk_bf16_f32 v219, v222, v223
  v_permlane16_swap_b32 v192, v194
  v_permlane16_swap_b32 v200, v202
  v_permlane16_swap_b32 v208, v210
  v_permlane16_swap_b32 v216, v218
  v_permlane16_swap_b32 v193, v195
  v_permlane16_swap_b32 v201, v203
  v_permlane16_swap_b32 v209, v211
  v_permlane16_swap_b32 v217, v219
  buffer_store_dwordx4 v[192:195], v26, s[20:23], s34 offen offset:0
  buffer_store_dwordx4 v[200:203], v26, s[20:23], s34 offen offset:64
  buffer_store_dwordx4 v[208:211], v26, s[20:23], s35 offen offset:0
  buffer_store_dwordx4 v[216:219], v26, s[20:23], s35 offen offset:64
Lend:
  s_endpgm
.section .rodata,"a"
.p2align 6
.amdhsa_kernel concat_heads__compressed_kv_cla__sliding_local_dilated__prompt_kernel
  .amdhsa_next_free_vgpr 512
  .amdhsa_next_free_sgpr 102
  .amdhsa_accum_offset 256
  .amdhsa_group_segment_fixed_size 0
  .amdhsa_kernarg_size 96
  .amdhsa_user_sgpr_count 2
  .amdhsa_user_sgpr_kernarg_segment_ptr 1
  .amdhsa_system_sgpr_workgroup_id_x 1
.end_amdhsa_kernel
```

```asm
; @launch grid=(256,1,1) block=(256,1,1) lds=163840
.amdgcn_target "amdgcn-amd-amdhsa--gfx950"
.text
.globl concat_heads__compressed_kv_cla__sliding_local_dilated__prompt_kernel
.p2align 8
.type concat_heads__compressed_kv_cla__sliding_local_dilated__prompt_kernel,@function
concat_heads__compressed_kv_cla__sliding_local_dilated__prompt_kernel:
  s_cmp_ge_u32 s2, 256
  s_cbranch_scc1 Lend
  s_load_dwordx16 s[64:79], s[0:1], 0
  s_load_dwordx8 s[80:87], s[0:1], 64
  v_lshrrev_b32 v2, 6, v0
  v_and_b32 v1, 63, v0
  v_readfirstlane_b32 s3, v2
  v_lshlrev_b32 v2, 4, v1
  s_bfe_u32 s59, s2, 0x30003
  s_lshr_b32 s4, s2, 7
  s_lshl_b32 s4, s4, 3
  s_add_u32 s59, s59, s4
  s_lshr_b32 s4, s2, 3
  s_xor_b32 s4, s4, s2
  s_bitcmp1_b32 s4, 3
  s_cbranch_scc1 Lp2
  s_and_b32 s4, s2, 1
  s_lshl_b32 s4, s4, 2
  s_and_b32 s5, s59, 3
  s_add_u32 s61, s4, s5
  s_bfe_u32 s4, s2, 0x20001
  s_lshl_b32 s4, s4, 2
  s_lshr_b32 s5, s59, 2
  s_add_u32 s62, s4, s5
  s_lshl_b32 s4, s3, 13
  s_add_u32 s36, s4, 65536
  s_add_u32 s41, s4, 98304
  v_lshrrev_b32 v32, 3, v1
  v_and_b32 v33, 6, v32
  v_and_b32 v34, 7, v1
  v_xor_b32 v33, v33, v34
  v_lshlrev_b32 v33, 4, v33
  s_lshl_b32 s4, s61, 2
  s_add_u32 s4, s4, s3
  s_lshl_b32 s4, s4, 6
  v_add_u32 v34, s4, v32
  v_lshl_add_u32 v34, v34, 10, v33
  v_add_u32 v48, 0, v34
  v_add_u32 v49, 7168, v34
  v_add_u32 v50, 14336, v34
  v_add_u32 v51, 21504, v34
  v_add_u32 v52, 32768, v34
  v_add_u32 v53, 39936, v34
  v_add_u32 v54, 47104, v34
  v_add_u32 v55, 54272, v34
  v_lshrrev_b32 v34, 2, v32
  v_and_b32 v35, 3, v32
  v_lshl_add_u32 v34, v34, 3, v35
  s_lshl_b32 s4, s62, 2
  s_add_u32 s4, s4, s3
  s_lshl_b32 s4, s4, 7
  v_lshl_add_u32 v34, v34, 13, v33
  v_add_u32 v34, s4, v34
  v_add_u32 v56, 0, v34
  v_add_u32 v57, 130048, v34
  v_add_u32 v58, 30720, v34
  v_add_u32 v59, 160768, v34
  v_add_u32 v60, 262144, v34
  v_add_u32 v61, 392192, v34
  v_add_u32 v62, 292864, v34
  v_add_u32 v63, 422912, v34
  s_and_b32 s6, s2, 7
  s_add_u32 s4, s61, s62
  s_and_b32 s49, s4, 3
  s_lshl_b32 s49, s49, 3
  s_or_b32 s49, s49, 0x80000
  s_bfe_u32 s48, 0x70702, s49
  s_add_u32 s48, s48, s6
  s_and_b32 s48, s48, 7
  s_lshl_b32 s46, s48, 7
  s_waitcnt lgkmcnt(0)
  s_mov_b32 s8, s66
  s_mov_b32 s9, s67
  s_mov_b32 s10, 2097152
  s_mov_b32 s11, 0x00020000
  s_mov_b32 s12, s70
  s_mov_b32 s13, s71
  s_mov_b32 s14, 4194304
  s_mov_b32 s15, 0x00020000
  s_mov_b32 s50, 9
  s_add_u32 s96, s86, 125829120
  s_addc_u32 s97, s87, 0
  s_mov_b32 s98, 262144
  s_mov_b32 s99, 0x00020000
  s_or_b32 s4, s2, s3
  s_cbranch_scc1 Ltag_1
  s_mov_b32 s4, 196608
  buffer_load_dwordx2 v[22:23], off, s[96:99], s4 sc1
Ltag_1:
  s_mov_b32 m0, s36
  s_nop 0
  buffer_load_dwordx4 v48, s[8:11], s46 offen offset:0 lds
  buffer_load_dwordx4 v49, s[8:11], s46 offen offset:1024 lds
  buffer_load_dwordx4 v50, s[8:11], s46 offen offset:2048 lds
  buffer_load_dwordx4 v51, s[8:11], s46 offen offset:3072 lds
  s_add_u32 m0, s36, 4096
  s_nop 0
  buffer_load_dwordx4 v52, s[8:11], s46 offen offset:0 lds
  buffer_load_dwordx4 v53, s[8:11], s46 offen offset:1024 lds
  buffer_load_dwordx4 v54, s[8:11], s46 offen offset:2048 lds
  buffer_load_dwordx4 v55, s[8:11], s46 offen offset:3072 lds
  s_sub_u32 s50, s50, 1
  s_cmp_eq_u32 s50, 0
  s_cselect_b32 s12, s72, s12
  s_cselect_b32 s13, s73, s13
  s_lshl_b32 s47, s48, 19
  s_bfe_u32 s34, 0x3020106, s49
  s_add_u32 s48, s48, s34
  s_add_u32 s49, s49, 8
  s_and_b32 s49, s49, 0x8001f
  s_and_b32 s48, s48, 7
  s_lshl_b32 s46, s48, 7
  s_mov_b32 m0, s41
  s_nop 0
  buffer_load_dwordx4 v56, s[12:15], s47 offen offset:0 lds
  buffer_load_dwordx4 v57, s[12:15], s47 offen offset:1024 lds
  buffer_load_dwordx4 v58, s[12:15], s47 offen offset:2048 lds
  buffer_load_dwordx4 v59, s[12:15], s47 offen offset:3072 lds
  s_add_u32 m0, s41, 4096
  s_nop 0
  buffer_load_dwordx4 v60, s[12:15], s47 offen offset:0 lds
  buffer_load_dwordx4 v61, s[12:15], s47 offen offset:1024 lds
  buffer_load_dwordx4 v62, s[12:15], s47 offen offset:2048 lds
  buffer_load_dwordx4 v63, s[12:15], s47 offen offset:3072 lds
  s_lshr_b32 s4, s3, 1
  s_lshl_b32 s4, s4, 14
  s_add_u32 s4, s4, 65536
  v_and_b32 v32, 15, v1
  v_lshlrev_b32 v32, 7, v32
  v_lshrrev_b32 v33, 4, v1
  v_and_b32 v34, 6, v1
  v_xor_b32 v33, v33, v34
  v_lshl_add_u32 v32, v33, 4, v32
  v_add_u32 v16, s4, v32
  v_xor_b32 v17, 64, v16
  s_and_b32 s4, s3, 1
  s_lshl_b32 s4, s4, 14
  s_add_u32 s4, s4, 98304
  v_lshrrev_b32 v32, 2, v1
  v_and_b32 v33, 6, v32
  v_lshlrev_b32 v32, 7, v32
  v_and_b32 v34, 1, v1
  v_lshl_add_u32 v32, v34, 3, v32
  v_add_u32 v32, s4, v32
  v_bfe_u32 v34, v1, 1, 1
  v_xor_b32 v33, v33, v34
  v_xor_b32 v34, 0, v33
  v_lshl_add_u32 v18, v34, 4, v32
  v_xor_b32 v34, 2, v33
  v_lshl_add_u32 v19, v34, 4, v32
  v_xor_b32 v34, 4, v33
  v_lshl_add_u32 v20, v34, 4, v32
  v_xor_b32 v34, 6, v33
  v_lshl_add_u32 v21, v34, 4, v32
  s_and_b32 s24, s2, 7
  s_lshr_b32 s4, s2, 6
  s_lshl_b32 s4, s4, 3
  s_add_u32 s24, s24, s4
  s_lshr_b32 s4, s2, 3
  s_and_b32 s25, s4, 6
  s_xor_b32 s4, s4, s2
  s_bfe_u32 s4, s4, 0x10003
  s_add_u32 s25, s25, s4
  v_accvgpr_write_b32 a244, -1
  v_accvgpr_write_b32 a245, -1
  v_accvgpr_write_b32 a246, -1
  v_accvgpr_write_b32 a247, -1
  v_lshrrev_b32 v24, 3, v1
  v_and_b32 v25, 6, v24
  v_and_b32 v26, 7, v1
  v_xor_b32 v25, v25, v26
  v_lshlrev_b32 v25, 4, v25
  s_and_b32 s4, s3, 1
  s_lshl_b32 s4, s4, 16
  s_lshr_b32 s5, s3, 1
  s_lshl_b32 s5, s5, 7
  s_add_u32 s4, s4, s5
  v_lshl_add_u32 v24, v24, 11, v25
  v_add_u32 v24, s4, v24
  v_add_u32 v25, 0, v24
  v_accvgpr_write_b32 a212, v25
  v_add_u32 v25, 15360, v24
  v_accvgpr_write_b32 a213, v25
  v_add_u32 v25, 30720, v24
  v_accvgpr_write_b32 a214, v25
  v_add_u32 v25, 46080, v24
  v_accvgpr_write_b32 a215, v25
  v_accvgpr_write_b32 a236, 0
  v_mov_b32 v27, 0x3f803f80
  v_accvgpr_write_b32 a208, v27
  v_accvgpr_write_b32 a237, 0
  v_accvgpr_write_b32 a209, v27
  v_accvgpr_write_b32 a238, 0
  v_accvgpr_write_b32 a210, v27
  v_accvgpr_write_b32 a239, 0
  v_accvgpr_write_b32 a211, v27
  v_lshrrev_b32 v24, 3, v1
  v_and_b32 v25, 6, v24
  v_and_b32 v26, 7, v1
  v_xor_b32 v25, v25, v26
  v_lshlrev_b32 v25, 4, v25
  v_lshlrev_b32 v26, 2, v24
  v_add_u32 v26, s3, v26
  v_lshl_add_u32 v26, v26, 11, v25
  v_add_u32 v27, 0, v26
  v_accvgpr_write_b32 a222, v27
  v_add_u32 v27, 64512, v26
  v_accvgpr_write_b32 a223, v27
  v_add_u32 v27, 129024, v26
  v_accvgpr_write_b32 a224, v27
  v_add_u32 v27, 193536, v26
  v_accvgpr_write_b32 a225, v27
  v_lshrrev_b32 v26, 2, v24
  v_and_b32 v27, 3, v24
  v_lshl_add_u32 v26, v26, 3, v27
  s_and_b32 s4, s3, 1
  s_lshl_b32 s4, s4, 18
  s_lshr_b32 s5, s3, 1
  s_lshl_b32 s5, s5, 7
  s_add_u32 s4, s4, s5
  s_lshl_b32 s5, s24, 8
  s_add_u32 s4, s4, s5
  v_lshl_add_u32 v26, v26, 13, v25
  v_add_u32 v26, s4, v26
  v_add_u32 v27, 0, v26
  v_accvgpr_write_b32 a226, v27
  v_add_u32 v27, 130048, v26
  v_accvgpr_write_b32 a227, v27
  v_add_u32 v27, 30720, v26
  v_accvgpr_write_b32 a228, v27
  v_add_u32 v27, 160768, v26
  v_accvgpr_write_b32 a229, v27
  s_lshl_b32 s4, s3, 13
  s_add_u32 s4, s4, 98304
  v_and_b32 v24, 15, v1
  v_lshlrev_b32 v24, 7, v24
  v_lshrrev_b32 v25, 4, v1
  v_and_b32 v26, 6, v1
  v_xor_b32 v25, v25, v26
  v_lshl_add_u32 v24, v25, 4, v24
  v_add_u32 v28, s4, v24
  v_xor_b32 v29, 64, v28
  v_lshrrev_b32 v24, 2, v1
  v_and_b32 v25, 6, v24
  v_lshlrev_b32 v24, 7, v24
  v_and_b32 v26, 1, v1
  v_lshl_add_u32 v24, v26, 3, v24
  v_add_u32 v24, 0, v24
  v_bfe_u32 v26, v1, 1, 1
  v_xor_b32 v25, v25, v26
  v_xor_b32 v26, 0, v25
  v_lshl_add_u32 v30, v26, 4, v24
  v_xor_b32 v26, 2, v25
  v_lshl_add_u32 v31, v26, 4, v24
  v_xor_b32 v26, 4, v25
  v_lshl_add_u32 v32, v26, 4, v24
  v_xor_b32 v26, 6, v25
  v_lshl_add_u32 v33, v26, 4, v24
  v_accvgpr_write_b32 a230, v28
  v_accvgpr_write_b32 a231, v29
  v_accvgpr_write_b32 a232, v30
  v_accvgpr_write_b32 a233, v31
  v_accvgpr_write_b32 a234, v32
  v_accvgpr_write_b32 a235, v33
  s_and_b32 s4, s3, 1
  s_lshl_b32 s5, s62, 1
  s_add_u32 s4, s4, s5
  s_lshr_b32 s5, s3, 1
  s_lshl_b32 s6, s61, 1
  s_add_u32 s5, s5, s6
  s_add_u32 s16, s86, 16777216
  s_addc_u32 s17, s87, 0
  s_mov_b32 s18, 33554432
  s_mov_b32 s19, 0x00020000
  s_lshl_b32 s4, s4, 20
  s_lshl_b32 s5, s5, 16
  s_add_u32 s63, s4, s5
  s_mov_b32 s37, 0
  s_mov_b32 s39, 4294901760
  s_mov_b32 s40, 32768
  s_mov_b32 s37, 2
  s_mov_b32 s42, 0
  s_mov_b32 s44, 4294934528
  s_mov_b32 s45, 32768
  s_mov_b32 s43, s44
  s_or_b32 s4, s2, s3
  s_cbranch_scc1 Ltag_2
  s_mov_b32 s4, 196608
  s_mov_b32 s92, s84
  s_mov_b32 s93, s85
  s_mov_b32 s94, 256
  s_mov_b32 s95, 0x00020000
  s_waitcnt vmcnt(16)
  v_add_u32 v22, 1, v22
  v_or_b32 v23, 0x80000000, v23
  buffer_store_dwordx2 v[22:23], off, s[96:99], s4 sc1
  buffer_store_dwordx2 v[22:23], off, s[92:95], 0 sc1
Ltag_2:
  s_waitcnt vmcnt(0)
  s_barrier
  ds_read_b128 a[0:3], v16 offset:0
  ds_read_b64_tr_b16 a[64:65], v18 offset:0
  ds_read_b64_tr_b16 a[66:67], v18 offset:2048
  ds_read_b128 a[4:7], v16 offset:2048
  ds_read_b128 a[8:11], v16 offset:4096
  ds_read_b128 a[12:15], v16 offset:6144
  ds_read_b128 a[16:19], v16 offset:8192
  ds_read_b128 a[20:23], v16 offset:10240
  ds_read_b128 a[24:27], v16 offset:12288
  ds_read_b128 a[28:31], v16 offset:14336
  ds_read_b64_tr_b16 a[68:69], v19 offset:0
  ds_read_b64_tr_b16 a[70:71], v19 offset:2048
  ds_read_b64_tr_b16 a[72:73], v20 offset:0
  ds_read_b64_tr_b16 a[74:75], v20 offset:2048
  ds_read_b64_tr_b16 a[76:77], v21 offset:0
  ds_read_b64_tr_b16 a[78:79], v21 offset:2048
  ds_read_b64_tr_b16 a[80:81], v18 offset:8192
  ds_read_b64_tr_b16 a[82:83], v18 offset:10240
  ds_read_b64_tr_b16 a[84:85], v19 offset:8192
  ds_read_b64_tr_b16 a[86:87], v19 offset:10240
  ds_read_b64_tr_b16 a[88:89], v20 offset:8192
  ds_read_b64_tr_b16 a[90:91], v20 offset:10240
  ds_read_b64_tr_b16 a[92:93], v21 offset:8192
  ds_read_b64_tr_b16 a[94:95], v21 offset:10240
  s_waitcnt lgkmcnt(0)
  v_mfma_f32_16x16x32_bf16 v[64:67], a[64:67], a[0:3], 0
  s_add_u32 m0, s36, -65536
  ds_read_b128 a[32:35], v17 offset:0
  v_mfma_f32_16x16x32_bf16 v[96:99], a[64:67], a[4:7], 0
  buffer_load_dwordx4 v48, s[8:11], s46 offen offset:0 lds
  v_mfma_f32_16x16x32_bf16 v[128:131], a[64:67], a[8:11], 0
  buffer_load_dwordx4 v49, s[8:11], s46 offen offset:1024 lds
  v_mfma_f32_16x16x32_bf16 v[160:163], a[64:67], a[12:15], 0
  ds_read_b64_tr_b16 a[96:97], v18 offset:4096
  v_mfma_f32_16x16x32_bf16 v[192:195], a[64:67], a[16:19], 0
  buffer_load_dwordx4 v50, s[8:11], s46 offen offset:2048 lds
  v_mfma_f32_16x16x32_bf16 v[224:227], a[64:67], a[20:23], 0
  ds_read_b64_tr_b16 a[98:99], v18 offset:6144
  v_mfma_f32_16x16x32_bf16 a[128:131], a[64:67], a[24:27], 0
  ds_read_b128 a[36:39], v17 offset:2048
  v_mfma_f32_16x16x32_bf16 a[160:163], a[64:67], a[28:31], 0
  buffer_load_dwordx4 v51, s[8:11], s46 offen offset:3072 lds
  v_mfma_f32_16x16x32_bf16 v[68:71], a[68:71], a[0:3], 0
  s_add_u32 m0, s36, -61440
  v_mfma_f32_16x16x32_bf16 v[100:103], a[68:71], a[4:7], 0
  buffer_load_dwordx4 v52, s[8:11], s46 offen offset:0 lds
  v_mfma_f32_16x16x32_bf16 v[132:135], a[68:71], a[8:11], 0
  ds_read_b128 a[40:43], v17 offset:4096
  v_mfma_f32_16x16x32_bf16 v[164:167], a[68:71], a[12:15], 0
  buffer_load_dwordx4 v53, s[8:11], s46 offen offset:1024 lds
  v_mfma_f32_16x16x32_bf16 v[196:199], a[68:71], a[16:19], 0
  ds_read_b128 a[44:47], v17 offset:6144
  v_mfma_f32_16x16x32_bf16 v[228:231], a[68:71], a[20:23], 0
  ds_read_b128 a[48:51], v17 offset:8192
  v_mfma_f32_16x16x32_bf16 a[132:135], a[68:71], a[24:27], 0
  buffer_load_dwordx4 v54, s[8:11], s46 offen offset:2048 lds
  v_mfma_f32_16x16x32_bf16 a[164:167], a[68:71], a[28:31], 0
  ds_read_b128 a[52:55], v17 offset:10240
  v_mfma_f32_16x16x32_bf16 v[72:75], a[72:75], a[0:3], 0
  buffer_load_dwordx4 v55, s[8:11], s46 offen offset:3072 lds
  v_mfma_f32_16x16x32_bf16 v[104:107], a[72:75], a[4:7], 0
  s_sub_u32 s50, s50, 1
  s_cmp_eq_u32 s50, 0
  s_cselect_b32 s12, s72, s12
  s_cselect_b32 s13, s73, s13
  v_mfma_f32_16x16x32_bf16 v[136:139], a[72:75], a[8:11], 0
  s_lshl_b32 s47, s48, 19
  s_bfe_u32 s34, 0x3020106, s49
  s_add_u32 s48, s48, s34
  v_mfma_f32_16x16x32_bf16 v[168:171], a[72:75], a[12:15], 0
  s_add_u32 s49, s49, 8
  s_and_b32 s49, s49, 0x8001f
  s_and_b32 s48, s48, 7
  v_mfma_f32_16x16x32_bf16 v[200:203], a[72:75], a[16:19], 0
  s_lshl_b32 s46, s48, 7
  s_add_u32 m0, s41, 32768
  ds_read_b128 a[56:59], v17 offset:12288
  v_mfma_f32_16x16x32_bf16 v[232:235], a[72:75], a[20:23], 0
  buffer_load_dwordx4 v56, s[12:15], s47 offen offset:0 lds
  v_mfma_f32_16x16x32_bf16 a[136:139], a[72:75], a[24:27], 0
  buffer_load_dwordx4 v57, s[12:15], s47 offen offset:1024 lds
  v_mfma_f32_16x16x32_bf16 a[168:171], a[72:75], a[28:31], 0
  buffer_load_dwordx4 v58, s[12:15], s47 offen offset:2048 lds
  v_mfma_f32_16x16x32_bf16 v[76:79], a[76:79], a[0:3], 0
  ds_read_b128 a[60:63], v17 offset:14336
  ds_read_b64_tr_b16 a[100:101], v19 offset:4096
  v_mfma_f32_16x16x32_bf16 v[108:111], a[76:79], a[4:7], 0
  ds_read_b64_tr_b16 a[102:103], v19 offset:6144
  v_mfma_f32_16x16x32_bf16 v[140:143], a[76:79], a[8:11], 0
  buffer_load_dwordx4 v59, s[12:15], s47 offen offset:3072 lds
  v_mfma_f32_16x16x32_bf16 v[172:175], a[76:79], a[12:15], 0
  s_add_u32 m0, s41, 36864
  ds_read_b64_tr_b16 a[104:105], v20 offset:4096
  v_mfma_f32_16x16x32_bf16 v[204:207], a[76:79], a[16:19], 0
  buffer_load_dwordx4 v60, s[12:15], s47 offen offset:0 lds
  v_mfma_f32_16x16x32_bf16 v[236:239], a[76:79], a[20:23], 0
  ds_read_b64_tr_b16 a[106:107], v20 offset:6144
  v_mfma_f32_16x16x32_bf16 a[140:143], a[76:79], a[24:27], 0
  buffer_load_dwordx4 v61, s[12:15], s47 offen offset:1024 lds
  v_mfma_f32_16x16x32_bf16 a[172:175], a[76:79], a[28:31], 0
  ds_read_b64_tr_b16 a[108:109], v21 offset:4096
  v_mfma_f32_16x16x32_bf16 v[80:83], a[80:83], a[0:3], 0
  v_mfma_f32_16x16x32_bf16 v[112:115], a[80:83], a[4:7], 0
  buffer_load_dwordx4 v62, s[12:15], s47 offen offset:2048 lds
  v_mfma_f32_16x16x32_bf16 v[144:147], a[80:83], a[8:11], 0
  ds_read_b64_tr_b16 a[110:111], v21 offset:6144
  v_mfma_f32_16x16x32_bf16 v[176:179], a[80:83], a[12:15], 0
  buffer_load_dwordx4 v63, s[12:15], s47 offen offset:3072 lds
  v_mfma_f32_16x16x32_bf16 v[208:211], a[80:83], a[16:19], 0
  s_add_u32 m0, s36, -32768
  ds_read_b64_tr_b16 a[112:113], v18 offset:12288
  v_mfma_f32_16x16x32_bf16 v[240:243], a[80:83], a[20:23], 0
  v_mfma_f32_16x16x32_bf16 a[144:147], a[80:83], a[24:27], 0
  buffer_load_dwordx4 v48, s[8:11], s46 offen offset:0 lds
  v_mfma_f32_16x16x32_bf16 a[176:179], a[80:83], a[28:31], 0
  ds_read_b64_tr_b16 a[114:115], v18 offset:14336
  v_mfma_f32_16x16x32_bf16 v[84:87], a[84:87], a[0:3], 0
  buffer_load_dwordx4 v49, s[8:11], s46 offen offset:1024 lds
  v_mfma_f32_16x16x32_bf16 v[116:119], a[84:87], a[4:7], 0
  ds_read_b64_tr_b16 a[116:117], v19 offset:12288
  v_mfma_f32_16x16x32_bf16 v[148:151], a[84:87], a[8:11], 0
  buffer_load_dwordx4 v50, s[8:11], s46 offen offset:2048 lds
  v_mfma_f32_16x16x32_bf16 v[180:183], a[84:87], a[12:15], 0
  ds_read_b64_tr_b16 a[118:119], v19 offset:14336
  v_mfma_f32_16x16x32_bf16 v[212:215], a[84:87], a[16:19], 0
  v_mfma_f32_16x16x32_bf16 v[244:247], a[84:87], a[20:23], 0
  buffer_load_dwordx4 v51, s[8:11], s46 offen offset:3072 lds
  v_mfma_f32_16x16x32_bf16 a[148:151], a[84:87], a[24:27], 0
  s_add_u32 m0, s36, -28672
  ds_read_b64_tr_b16 a[120:121], v20 offset:12288
  v_mfma_f32_16x16x32_bf16 a[180:183], a[84:87], a[28:31], 0
  buffer_load_dwordx4 v52, s[8:11], s46 offen offset:0 lds
  v_mfma_f32_16x16x32_bf16 v[88:91], a[88:91], a[0:3], 0
  s_add_u32 s37, s37, 1
  ds_read_b64_tr_b16 a[122:123], v20 offset:14336
  v_mfma_f32_16x16x32_bf16 v[120:123], a[88:91], a[4:7], 0
  buffer_load_dwordx4 v53, s[8:11], s46 offen offset:1024 lds
  v_mfma_f32_16x16x32_bf16 v[152:155], a[88:91], a[8:11], 0
  ds_read_b64_tr_b16 a[124:125], v21 offset:12288
  v_mfma_f32_16x16x32_bf16 v[184:187], a[88:91], a[12:15], 0
  ds_read_b64_tr_b16 a[126:127], v21 offset:14336
  v_mfma_f32_16x16x32_bf16 v[216:219], a[88:91], a[16:19], 0
  buffer_load_dwordx4 v54, s[8:11], s46 offen offset:2048 lds
  v_mfma_f32_16x16x32_bf16 v[248:251], a[88:91], a[20:23], 0
  s_cmp_eq_u32 s37, 3
  s_cselect_b32 s37, 0, s37
  s_cselect_b32 s38, s39, s40
  v_mfma_f32_16x16x32_bf16 a[152:155], a[88:91], a[24:27], 0
  buffer_load_dwordx4 v55, s[8:11], s46 offen offset:3072 lds
  v_mfma_f32_16x16x32_bf16 a[184:187], a[88:91], a[28:31], 0
  s_sub_u32 s43, 0, s43
  v_mfma_f32_16x16x32_bf16 v[92:95], a[92:95], a[0:3], 0
  s_sub_u32 s50, s50, 1
  v_add_u32 v16, s38, v16
  v_add_u32 v17, s38, v17
  v_mfma_f32_16x16x32_bf16 v[124:127], a[92:95], a[4:7], 0
  s_cmp_eq_u32 s50, 0
  s_cselect_b32 s12, s72, s12
  s_cselect_b32 s13, s73, s13
  v_mfma_f32_16x16x32_bf16 v[156:159], a[92:95], a[8:11], 0
  s_lshl_b32 s47, s48, 19
  v_add_u32 v18, s43, v18
  v_add_u32 v19, s43, v19
  v_mfma_f32_16x16x32_bf16 v[188:191], a[92:95], a[12:15], 0
  s_bfe_u32 s34, 0x3020106, s49
  s_add_u32 s48, s48, s34
  s_add_u32 s49, s49, 8
  v_mfma_f32_16x16x32_bf16 v[220:223], a[92:95], a[16:19], 0
  s_and_b32 s49, s49, 0x8001f
  s_and_b32 s48, s48, 7
  s_lshl_b32 s46, s48, 7
  v_mfma_f32_16x16x32_bf16 v[252:255], a[92:95], a[20:23], 0
  v_add_u32 v20, s43, v20
  v_add_u32 v21, s43, v21
  v_mfma_f32_16x16x32_bf16 a[156:159], a[92:95], a[24:27], 0
  v_mfma_f32_16x16x32_bf16 a[188:191], a[92:95], a[28:31], 0
  s_mov_b32 s35, 6
  s_waitcnt vmcnt(8) lgkmcnt(0)
  s_barrier
  .p2align 6
Lp1wx_loop:
  v_mfma_f32_16x16x32_bf16 v[64:67], a[96:99], a[32:35], v[64:67]
  s_mov_b32 m0, s41
  ds_read_b128 a[0:3], v16 offset:0
  v_mfma_f32_16x16x32_bf16 v[96:99], a[96:99], a[36:39], v[96:99]
  buffer_load_dwordx4 v56, s[12:15], s47 offen offset:0 lds
  v_mfma_f32_16x16x32_bf16 v[128:131], a[96:99], a[40:43], v[128:131]
  ds_read_b64_tr_b16 a[64:65], v18 offset:0
  v_mfma_f32_16x16x32_bf16 v[160:163], a[96:99], a[44:47], v[160:163]
  v_mfma_f32_16x16x32_bf16 v[192:195], a[96:99], a[48:51], v[192:195]
  ds_read_b64_tr_b16 a[66:67], v18 offset:2048
  v_mfma_f32_16x16x32_bf16 v[224:227], a[96:99], a[52:55], v[224:227]
  v_mfma_f32_16x16x32_bf16 a[128:131], a[96:99], a[56:59], a[128:131]
  ds_read_b128 a[4:7], v16 offset:2048
  v_mfma_f32_16x16x32_bf16 a[160:163], a[96:99], a[60:63], a[160:163]
  buffer_load_dwordx4 v57, s[12:15], s47 offen offset:1024 lds
  v_mfma_f32_16x16x32_bf16 v[68:71], a[100:103], a[32:35], v[68:71]
  v_mfma_f32_16x16x32_bf16 v[100:103], a[100:103], a[36:39], v[100:103]
  ds_read_b128 a[8:11], v16 offset:4096
  v_mfma_f32_16x16x32_bf16 v[132:135], a[100:103], a[40:43], v[132:135]
  v_mfma_f32_16x16x32_bf16 v[164:167], a[100:103], a[44:47], v[164:167]
  ds_read_b128 a[12:15], v16 offset:6144
  v_mfma_f32_16x16x32_bf16 v[196:199], a[100:103], a[48:51], v[196:199]
  v_mfma_f32_16x16x32_bf16 v[228:231], a[100:103], a[52:55], v[228:231]
  ds_read_b128 a[16:19], v16 offset:8192
  v_mfma_f32_16x16x32_bf16 a[132:135], a[100:103], a[56:59], a[132:135]
  v_mfma_f32_16x16x32_bf16 a[164:167], a[100:103], a[60:63], a[164:167]
  buffer_load_dwordx4 v58, s[12:15], s47 offen offset:2048 lds
  v_mfma_f32_16x16x32_bf16 v[72:75], a[104:107], a[32:35], v[72:75]
  ds_read_b128 a[20:23], v16 offset:10240
  v_mfma_f32_16x16x32_bf16 v[104:107], a[104:107], a[36:39], v[104:107]
  v_mfma_f32_16x16x32_bf16 v[136:139], a[104:107], a[40:43], v[136:139]
  ds_read_b128 a[24:27], v16 offset:12288
  v_mfma_f32_16x16x32_bf16 v[168:171], a[104:107], a[44:47], v[168:171]
  v_mfma_f32_16x16x32_bf16 v[200:203], a[104:107], a[48:51], v[200:203]
  ds_read_b128 a[28:31], v16 offset:14336
  v_mfma_f32_16x16x32_bf16 v[232:235], a[104:107], a[52:55], v[232:235]
  v_mfma_f32_16x16x32_bf16 a[136:139], a[104:107], a[56:59], a[136:139]
  ds_read_b64_tr_b16 a[68:69], v19 offset:0
  v_mfma_f32_16x16x32_bf16 a[168:171], a[104:107], a[60:63], a[168:171]
  buffer_load_dwordx4 v59, s[12:15], s47 offen offset:3072 lds
  v_mfma_f32_16x16x32_bf16 v[76:79], a[108:111], a[32:35], v[76:79]
  s_add_u32 m0, s41, 4096
  ds_read_b64_tr_b16 a[70:71], v19 offset:2048
  v_mfma_f32_16x16x32_bf16 v[108:111], a[108:111], a[36:39], v[108:111]
  v_mfma_f32_16x16x32_bf16 v[140:143], a[108:111], a[40:43], v[140:143]
  v_mfma_f32_16x16x32_bf16 v[172:175], a[108:111], a[44:47], v[172:175]
  ds_read_b64_tr_b16 a[72:73], v20 offset:0
  v_mfma_f32_16x16x32_bf16 v[204:207], a[108:111], a[48:51], v[204:207]
  v_mfma_f32_16x16x32_bf16 v[236:239], a[108:111], a[52:55], v[236:239]
  ds_read_b64_tr_b16 a[74:75], v20 offset:2048
  v_mfma_f32_16x16x32_bf16 a[140:143], a[108:111], a[56:59], a[140:143]
  v_mfma_f32_16x16x32_bf16 a[172:175], a[108:111], a[60:63], a[172:175]
  buffer_load_dwordx4 v60, s[12:15], s47 offen offset:0 lds
  v_mfma_f32_16x16x32_bf16 v[80:83], a[112:115], a[32:35], v[80:83]
  ds_read_b64_tr_b16 a[76:77], v21 offset:0
  v_mfma_f32_16x16x32_bf16 v[112:115], a[112:115], a[36:39], v[112:115]
  ds_read_b64_tr_b16 a[78:79], v21 offset:2048
  v_mfma_f32_16x16x32_bf16 v[144:147], a[112:115], a[40:43], v[144:147]
  v_mfma_f32_16x16x32_bf16 v[176:179], a[112:115], a[44:47], v[176:179]
  v_mfma_f32_16x16x32_bf16 v[208:211], a[112:115], a[48:51], v[208:211]
  ds_read_b64_tr_b16 a[80:81], v18 offset:8192
  v_mfma_f32_16x16x32_bf16 v[240:243], a[112:115], a[52:55], v[240:243]
  v_mfma_f32_16x16x32_bf16 a[144:147], a[112:115], a[56:59], a[144:147]
  ds_read_b64_tr_b16 a[82:83], v18 offset:10240
  v_mfma_f32_16x16x32_bf16 a[176:179], a[112:115], a[60:63], a[176:179]
  buffer_load_dwordx4 v61, s[12:15], s47 offen offset:1024 lds
  v_mfma_f32_16x16x32_bf16 v[84:87], a[116:119], a[32:35], v[84:87]
  ds_read_b64_tr_b16 a[84:85], v19 offset:8192
  v_mfma_f32_16x16x32_bf16 v[116:119], a[116:119], a[36:39], v[116:119]
  v_mfma_f32_16x16x32_bf16 v[148:151], a[116:119], a[40:43], v[148:151]
  ds_read_b64_tr_b16 a[86:87], v19 offset:10240
  v_mfma_f32_16x16x32_bf16 v[180:183], a[116:119], a[44:47], v[180:183]
  v_mfma_f32_16x16x32_bf16 v[212:215], a[116:119], a[48:51], v[212:215]
  v_mfma_f32_16x16x32_bf16 v[244:247], a[116:119], a[52:55], v[244:247]
  ds_read_b64_tr_b16 a[88:89], v20 offset:8192
  v_mfma_f32_16x16x32_bf16 a[148:151], a[116:119], a[56:59], a[148:151]
  v_mfma_f32_16x16x32_bf16 a[180:183], a[116:119], a[60:63], a[180:183]
  buffer_load_dwordx4 v62, s[12:15], s47 offen offset:2048 lds
  v_mfma_f32_16x16x32_bf16 v[88:91], a[120:123], a[32:35], v[88:91]
  ds_read_b64_tr_b16 a[90:91], v20 offset:10240
  v_mfma_f32_16x16x32_bf16 v[120:123], a[120:123], a[36:39], v[120:123]
  ds_read_b64_tr_b16 a[92:93], v21 offset:8192
  v_mfma_f32_16x16x32_bf16 v[152:155], a[120:123], a[40:43], v[152:155]
  v_mfma_f32_16x16x32_bf16 v[184:187], a[120:123], a[44:47], v[184:187]
  ds_read_b64_tr_b16 a[94:95], v21 offset:10240
  v_mfma_f32_16x16x32_bf16 v[216:219], a[120:123], a[48:51], v[216:219]
  v_mfma_f32_16x16x32_bf16 v[248:251], a[120:123], a[52:55], v[248:251]
  v_mfma_f32_16x16x32_bf16 a[152:155], a[120:123], a[56:59], a[152:155]
  v_mfma_f32_16x16x32_bf16 a[184:187], a[120:123], a[60:63], a[184:187]
  buffer_load_dwordx4 v63, s[12:15], s47 offen offset:3072 lds
  v_mfma_f32_16x16x32_bf16 v[92:95], a[124:127], a[32:35], v[92:95]
  v_mfma_f32_16x16x32_bf16 v[124:127], a[124:127], a[36:39], v[124:127]
  v_mfma_f32_16x16x32_bf16 v[156:159], a[124:127], a[40:43], v[156:159]
  v_mfma_f32_16x16x32_bf16 v[188:191], a[124:127], a[44:47], v[188:191]
  v_mfma_f32_16x16x32_bf16 v[220:223], a[124:127], a[48:51], v[220:223]
  v_mfma_f32_16x16x32_bf16 v[252:255], a[124:127], a[52:55], v[252:255]
  v_mfma_f32_16x16x32_bf16 a[156:159], a[124:127], a[56:59], a[156:159]
  v_mfma_f32_16x16x32_bf16 a[188:191], a[124:127], a[60:63], a[188:191]
  s_waitcnt lgkmcnt(0)
  v_mfma_f32_16x16x32_bf16 v[64:67], a[64:67], a[0:3], v[64:67]
  s_mov_b32 m0, s36
  ds_read_b128 a[32:35], v17 offset:0
  v_mfma_f32_16x16x32_bf16 v[96:99], a[64:67], a[4:7], v[96:99]
  buffer_load_dwordx4 v48, s[8:11], s46 offen offset:0 lds
  v_mfma_f32_16x16x32_bf16 v[128:131], a[64:67], a[8:11], v[128:131]
  ds_read_b64_tr_b16 a[96:97], v18 offset:4096
  v_mfma_f32_16x16x32_bf16 v[160:163], a[64:67], a[12:15], v[160:163]
  v_mfma_f32_16x16x32_bf16 v[192:195], a[64:67], a[16:19], v[192:195]
  ds_read_b64_tr_b16 a[98:99], v18 offset:6144
  v_mfma_f32_16x16x32_bf16 v[224:227], a[64:67], a[20:23], v[224:227]
  v_mfma_f32_16x16x32_bf16 a[128:131], a[64:67], a[24:27], a[128:131]
  ds_read_b128 a[36:39], v17 offset:2048
  v_mfma_f32_16x16x32_bf16 a[160:163], a[64:67], a[28:31], a[160:163]
  buffer_load_dwordx4 v49, s[8:11], s46 offen offset:1024 lds
  v_mfma_f32_16x16x32_bf16 v[68:71], a[68:71], a[0:3], v[68:71]
  v_mfma_f32_16x16x32_bf16 v[100:103], a[68:71], a[4:7], v[100:103]
  ds_read_b128 a[40:43], v17 offset:4096
  v_mfma_f32_16x16x32_bf16 v[132:135], a[68:71], a[8:11], v[132:135]
  v_mfma_f32_16x16x32_bf16 v[164:167], a[68:71], a[12:15], v[164:167]
  ds_read_b128 a[44:47], v17 offset:6144
  v_mfma_f32_16x16x32_bf16 v[196:199], a[68:71], a[16:19], v[196:199]
  v_mfma_f32_16x16x32_bf16 v[228:231], a[68:71], a[20:23], v[228:231]
  ds_read_b128 a[48:51], v17 offset:8192
  v_mfma_f32_16x16x32_bf16 a[132:135], a[68:71], a[24:27], a[132:135]
  buffer_load_dwordx4 v50, s[8:11], s46 offen offset:2048 lds
  v_mfma_f32_16x16x32_bf16 a[164:167], a[68:71], a[28:31], a[164:167]
  ds_read_b128 a[52:55], v17 offset:10240
  v_mfma_f32_16x16x32_bf16 v[72:75], a[72:75], a[0:3], v[72:75]
  v_mfma_f32_16x16x32_bf16 v[104:107], a[72:75], a[4:7], v[104:107]
  v_mfma_f32_16x16x32_bf16 v[136:139], a[72:75], a[8:11], v[136:139]
  ds_read_b128 a[56:59], v17 offset:12288
  v_mfma_f32_16x16x32_bf16 v[168:171], a[72:75], a[12:15], v[168:171]
  v_mfma_f32_16x16x32_bf16 v[200:203], a[72:75], a[16:19], v[200:203]
  ds_read_b128 a[60:63], v17 offset:14336
  v_mfma_f32_16x16x32_bf16 v[232:235], a[72:75], a[20:23], v[232:235]
  buffer_load_dwordx4 v51, s[8:11], s46 offen offset:3072 lds
  v_mfma_f32_16x16x32_bf16 a[136:139], a[72:75], a[24:27], a[136:139]
  s_add_u32 m0, s36, 4096
  ds_read_b64_tr_b16 a[100:101], v19 offset:4096
  v_mfma_f32_16x16x32_bf16 a[168:171], a[72:75], a[28:31], a[168:171]
  s_add_u32 s36, s36, s38
  v_mfma_f32_16x16x32_bf16 v[76:79], a[76:79], a[0:3], v[76:79]
  s_add_u32 s37, s37, 1
  ds_read_b64_tr_b16 a[102:103], v19 offset:6144
  v_mfma_f32_16x16x32_bf16 v[108:111], a[76:79], a[4:7], v[108:111]
  s_cmp_eq_u32 s37, 3
  s_cselect_b32 s37, 0, s37
  s_cselect_b32 s38, s39, s40
  v_mfma_f32_16x16x32_bf16 v[140:143], a[76:79], a[8:11], v[140:143]
  s_add_u32 s41, s41, s43
  v_mfma_f32_16x16x32_bf16 v[172:175], a[76:79], a[12:15], v[172:175]
  s_sub_u32 s43, 0, s43
  ds_read_b64_tr_b16 a[104:105], v20 offset:4096
  v_mfma_f32_16x16x32_bf16 v[204:207], a[76:79], a[16:19], v[204:207]
  buffer_load_dwordx4 v52, s[8:11], s46 offen offset:0 lds
  v_mfma_f32_16x16x32_bf16 v[236:239], a[76:79], a[20:23], v[236:239]
  ds_read_b64_tr_b16 a[106:107], v20 offset:6144
  v_mfma_f32_16x16x32_bf16 a[140:143], a[76:79], a[24:27], a[140:143]
  v_mfma_f32_16x16x32_bf16 a[172:175], a[76:79], a[28:31], a[172:175]
  ds_read_b64_tr_b16 a[108:109], v21 offset:4096
  v_mfma_f32_16x16x32_bf16 v[80:83], a[80:83], a[0:3], v[80:83]
  v_mfma_f32_16x16x32_bf16 v[112:115], a[80:83], a[4:7], v[112:115]
  ds_read_b64_tr_b16 a[110:111], v21 offset:6144
  v_mfma_f32_16x16x32_bf16 v[144:147], a[80:83], a[8:11], v[144:147]
  v_mfma_f32_16x16x32_bf16 v[176:179], a[80:83], a[12:15], v[176:179]
  buffer_load_dwordx4 v53, s[8:11], s46 offen offset:1024 lds
  v_mfma_f32_16x16x32_bf16 v[208:211], a[80:83], a[16:19], v[208:211]
  ds_read_b64_tr_b16 a[112:113], v18 offset:12288
  v_mfma_f32_16x16x32_bf16 v[240:243], a[80:83], a[20:23], v[240:243]
  v_mfma_f32_16x16x32_bf16 a[144:147], a[80:83], a[24:27], a[144:147]
  ds_read_b64_tr_b16 a[114:115], v18 offset:14336
  v_mfma_f32_16x16x32_bf16 a[176:179], a[80:83], a[28:31], a[176:179]
  v_mfma_f32_16x16x32_bf16 v[84:87], a[84:87], a[0:3], v[84:87]
  ds_read_b64_tr_b16 a[116:117], v19 offset:12288
  v_mfma_f32_16x16x32_bf16 v[116:119], a[84:87], a[4:7], v[116:119]
  v_mfma_f32_16x16x32_bf16 v[148:151], a[84:87], a[8:11], v[148:151]
  buffer_load_dwordx4 v54, s[8:11], s46 offen offset:2048 lds
  v_mfma_f32_16x16x32_bf16 v[180:183], a[84:87], a[12:15], v[180:183]
  ds_read_b64_tr_b16 a[118:119], v19 offset:14336
  v_mfma_f32_16x16x32_bf16 v[212:215], a[84:87], a[16:19], v[212:215]
  v_mfma_f32_16x16x32_bf16 v[244:247], a[84:87], a[20:23], v[244:247]
  ds_read_b64_tr_b16 a[120:121], v20 offset:12288
  v_mfma_f32_16x16x32_bf16 a[148:151], a[84:87], a[24:27], a[148:151]
  v_mfma_f32_16x16x32_bf16 a[180:183], a[84:87], a[28:31], a[180:183]
  ds_read_b64_tr_b16 a[122:123], v20 offset:14336
  v_mfma_f32_16x16x32_bf16 v[88:91], a[88:91], a[0:3], v[88:91]
  v_mfma_f32_16x16x32_bf16 v[120:123], a[88:91], a[4:7], v[120:123]
  buffer_load_dwordx4 v55, s[8:11], s46 offen offset:3072 lds
  v_mfma_f32_16x16x32_bf16 v[152:155], a[88:91], a[8:11], v[152:155]
  s_sub_u32 s50, s50, 1
  ds_read_b64_tr_b16 a[124:125], v21 offset:12288
  v_mfma_f32_16x16x32_bf16 v[184:187], a[88:91], a[12:15], v[184:187]
  ds_read_b64_tr_b16 a[126:127], v21 offset:14336
  v_mfma_f32_16x16x32_bf16 v[216:219], a[88:91], a[16:19], v[216:219]
  s_cmp_eq_u32 s50, 0
  s_cselect_b32 s12, s72, s12
  s_cselect_b32 s13, s73, s13
  v_mfma_f32_16x16x32_bf16 v[248:251], a[88:91], a[20:23], v[248:251]
  s_lshl_b32 s47, s48, 19
  v_add_u32 v16, s38, v16
  v_add_u32 v17, s38, v17
  v_mfma_f32_16x16x32_bf16 a[152:155], a[88:91], a[24:27], a[152:155]
  s_bfe_u32 s34, 0x3020106, s49
  v_add_u32 v18, s43, v18
  v_add_u32 v19, s43, v19
  v_mfma_f32_16x16x32_bf16 a[184:187], a[88:91], a[28:31], a[184:187]
  s_add_u32 s48, s48, s34
  v_add_u32 v20, s43, v20
  v_add_u32 v21, s43, v21
  v_mfma_f32_16x16x32_bf16 v[92:95], a[92:95], a[0:3], v[92:95]
  s_add_u32 s49, s49, 8
  v_mfma_f32_16x16x32_bf16 v[124:127], a[92:95], a[4:7], v[124:127]
  s_and_b32 s49, s49, 0x8001f
  v_mfma_f32_16x16x32_bf16 v[156:159], a[92:95], a[8:11], v[156:159]
  s_and_b32 s48, s48, 7
  v_mfma_f32_16x16x32_bf16 v[188:191], a[92:95], a[12:15], v[188:191]
  s_lshl_b32 s46, s48, 7
  v_mfma_f32_16x16x32_bf16 v[220:223], a[92:95], a[16:19], v[220:223]
  v_mfma_f32_16x16x32_bf16 v[252:255], a[92:95], a[20:23], v[252:255]
  s_waitcnt vmcnt(8) lgkmcnt(0)
  s_barrier
  v_mfma_f32_16x16x32_bf16 a[156:159], a[92:95], a[24:27], a[156:159]
  s_sub_u32 s35, s35, 1
  v_mfma_f32_16x16x32_bf16 a[188:191], a[92:95], a[28:31], a[188:191]
  s_cmp_lg_u32 s35, 0
  s_cbranch_scc1 Lp1wx_loop
  v_mfma_f32_16x16x32_bf16 v[64:67], a[96:99], a[32:35], v[64:67]
  s_mov_b32 m0, s41
  ds_read_b128 a[0:3], v16 offset:0
  v_mfma_f32_16x16x32_bf16 v[96:99], a[96:99], a[36:39], v[96:99]
  buffer_load_dwordx4 v56, s[12:15], s47 offen offset:0 lds
  v_mfma_f32_16x16x32_bf16 v[128:131], a[96:99], a[40:43], v[128:131]
  ds_read_b64_tr_b16 a[64:65], v18 offset:0
  v_mfma_f32_16x16x32_bf16 v[160:163], a[96:99], a[44:47], v[160:163]
  buffer_load_dwordx4 v57, s[12:15], s47 offen offset:1024 lds
  v_mfma_f32_16x16x32_bf16 v[192:195], a[96:99], a[48:51], v[192:195]
  ds_read_b64_tr_b16 a[66:67], v18 offset:2048
  v_mfma_f32_16x16x32_bf16 v[224:227], a[96:99], a[52:55], v[224:227]
  v_mfma_f32_16x16x32_bf16 a[128:131], a[96:99], a[56:59], a[128:131]
  ds_read_b128 a[4:7], v16 offset:2048
  v_mfma_f32_16x16x32_bf16 a[160:163], a[96:99], a[60:63], a[160:163]
  buffer_load_dwordx4 v58, s[12:15], s47 offen offset:2048 lds
  v_mfma_f32_16x16x32_bf16 v[68:71], a[100:103], a[32:35], v[68:71]
  v_mfma_f32_16x16x32_bf16 v[100:103], a[100:103], a[36:39], v[100:103]
  ds_read_b128 a[8:11], v16 offset:4096
  v_mfma_f32_16x16x32_bf16 v[132:135], a[100:103], a[40:43], v[132:135]
  v_mfma_f32_16x16x32_bf16 v[164:167], a[100:103], a[44:47], v[164:167]
  buffer_load_dwordx4 v59, s[12:15], s47 offen offset:3072 lds
  v_mfma_f32_16x16x32_bf16 v[196:199], a[100:103], a[48:51], v[196:199]
  s_add_u32 m0, s41, 4096
  ds_read_b128 a[12:15], v16 offset:6144
  v_mfma_f32_16x16x32_bf16 v[228:231], a[100:103], a[52:55], v[228:231]
  ds_read_b128 a[16:19], v16 offset:8192
  v_mfma_f32_16x16x32_bf16 a[132:135], a[100:103], a[56:59], a[132:135]
  v_mfma_f32_16x16x32_bf16 a[164:167], a[100:103], a[60:63], a[164:167]
  buffer_load_dwordx4 v60, s[12:15], s47 offen offset:0 lds
  v_mfma_f32_16x16x32_bf16 v[72:75], a[104:107], a[32:35], v[72:75]
  ds_read_b128 a[20:23], v16 offset:10240
  v_mfma_f32_16x16x32_bf16 v[104:107], a[104:107], a[36:39], v[104:107]
  v_mfma_f32_16x16x32_bf16 v[136:139], a[104:107], a[40:43], v[136:139]
  ds_read_b128 a[24:27], v16 offset:12288
  v_mfma_f32_16x16x32_bf16 v[168:171], a[104:107], a[44:47], v[168:171]
  buffer_load_dwordx4 v61, s[12:15], s47 offen offset:1024 lds
  v_mfma_f32_16x16x32_bf16 v[200:203], a[104:107], a[48:51], v[200:203]
  ds_read_b128 a[28:31], v16 offset:14336
  v_mfma_f32_16x16x32_bf16 v[232:235], a[104:107], a[52:55], v[232:235]
  v_mfma_f32_16x16x32_bf16 a[136:139], a[104:107], a[56:59], a[136:139]
  ds_read_b64_tr_b16 a[68:69], v19 offset:0
  v_mfma_f32_16x16x32_bf16 a[168:171], a[104:107], a[60:63], a[168:171]
  buffer_load_dwordx4 v62, s[12:15], s47 offen offset:2048 lds
  v_mfma_f32_16x16x32_bf16 v[76:79], a[108:111], a[32:35], v[76:79]
  ds_read_b64_tr_b16 a[70:71], v19 offset:2048
  v_mfma_f32_16x16x32_bf16 v[108:111], a[108:111], a[36:39], v[108:111]
  v_mfma_f32_16x16x32_bf16 v[140:143], a[108:111], a[40:43], v[140:143]
  v_mfma_f32_16x16x32_bf16 v[172:175], a[108:111], a[44:47], v[172:175]
  buffer_load_dwordx4 v63, s[12:15], s47 offen offset:3072 lds
  v_mfma_f32_16x16x32_bf16 v[204:207], a[108:111], a[48:51], v[204:207]
  s_mov_b32 m0, s36
  ds_read_b64_tr_b16 a[72:73], v20 offset:0
  v_mfma_f32_16x16x32_bf16 v[236:239], a[108:111], a[52:55], v[236:239]
  ds_read_b64_tr_b16 a[74:75], v20 offset:2048
  v_mfma_f32_16x16x32_bf16 a[140:143], a[108:111], a[56:59], a[140:143]
  v_mfma_f32_16x16x32_bf16 a[172:175], a[108:111], a[60:63], a[172:175]
  buffer_load_dwordx4 v48, s[8:11], s46 offen offset:0 lds
  v_mfma_f32_16x16x32_bf16 v[80:83], a[112:115], a[32:35], v[80:83]
  ds_read_b64_tr_b16 a[76:77], v21 offset:0
  v_mfma_f32_16x16x32_bf16 v[112:115], a[112:115], a[36:39], v[112:115]
  ds_read_b64_tr_b16 a[78:79], v21 offset:2048
  v_mfma_f32_16x16x32_bf16 v[144:147], a[112:115], a[40:43], v[144:147]
  v_mfma_f32_16x16x32_bf16 v[176:179], a[112:115], a[44:47], v[176:179]
  buffer_load_dwordx4 v49, s[8:11], s46 offen offset:1024 lds
  v_mfma_f32_16x16x32_bf16 v[208:211], a[112:115], a[48:51], v[208:211]
  ds_read_b64_tr_b16 a[80:81], v18 offset:8192
  v_mfma_f32_16x16x32_bf16 v[240:243], a[112:115], a[52:55], v[240:243]
  v_mfma_f32_16x16x32_bf16 a[144:147], a[112:115], a[56:59], a[144:147]
  ds_read_b64_tr_b16 a[82:83], v18 offset:10240
  v_mfma_f32_16x16x32_bf16 a[176:179], a[112:115], a[60:63], a[176:179]
  buffer_load_dwordx4 v50, s[8:11], s46 offen offset:2048 lds
  v_mfma_f32_16x16x32_bf16 v[84:87], a[116:119], a[32:35], v[84:87]
  ds_read_b64_tr_b16 a[84:85], v19 offset:8192
  v_mfma_f32_16x16x32_bf16 v[116:119], a[116:119], a[36:39], v[116:119]
  v_mfma_f32_16x16x32_bf16 v[148:151], a[116:119], a[40:43], v[148:151]
  ds_read_b64_tr_b16 a[86:87], v19 offset:10240
  v_mfma_f32_16x16x32_bf16 v[180:183], a[116:119], a[44:47], v[180:183]
  buffer_load_dwordx4 v51, s[8:11], s46 offen offset:3072 lds
  v_mfma_f32_16x16x32_bf16 v[212:215], a[116:119], a[48:51], v[212:215]
  s_add_u32 m0, s36, 4096
  v_mfma_f32_16x16x32_bf16 v[244:247], a[116:119], a[52:55], v[244:247]
  ds_read_b64_tr_b16 a[88:89], v20 offset:8192
  v_mfma_f32_16x16x32_bf16 a[148:151], a[116:119], a[56:59], a[148:151]
  v_mfma_f32_16x16x32_bf16 a[180:183], a[116:119], a[60:63], a[180:183]
  buffer_load_dwordx4 v52, s[8:11], s46 offen offset:0 lds
  v_mfma_f32_16x16x32_bf16 v[88:91], a[120:123], a[32:35], v[88:91]
  ds_read_b64_tr_b16 a[90:91], v20 offset:10240
  v_mfma_f32_16x16x32_bf16 v[120:123], a[120:123], a[36:39], v[120:123]
  ds_read_b64_tr_b16 a[92:93], v21 offset:8192
  v_mfma_f32_16x16x32_bf16 v[152:155], a[120:123], a[40:43], v[152:155]
  v_mfma_f32_16x16x32_bf16 v[184:187], a[120:123], a[44:47], v[184:187]
  buffer_load_dwordx4 v53, s[8:11], s46 offen offset:1024 lds
  v_mfma_f32_16x16x32_bf16 v[216:219], a[120:123], a[48:51], v[216:219]
  ds_read_b64_tr_b16 a[94:95], v21 offset:10240
  v_mfma_f32_16x16x32_bf16 v[248:251], a[120:123], a[52:55], v[248:251]
  v_mfma_f32_16x16x32_bf16 a[152:155], a[120:123], a[56:59], a[152:155]
  v_mfma_f32_16x16x32_bf16 a[184:187], a[120:123], a[60:63], a[184:187]
  buffer_load_dwordx4 v54, s[8:11], s46 offen offset:2048 lds
  v_mfma_f32_16x16x32_bf16 v[92:95], a[124:127], a[32:35], v[92:95]
  v_mfma_f32_16x16x32_bf16 v[124:127], a[124:127], a[36:39], v[124:127]
  v_mfma_f32_16x16x32_bf16 v[156:159], a[124:127], a[40:43], v[156:159]
  v_mfma_f32_16x16x32_bf16 v[188:191], a[124:127], a[44:47], v[188:191]
  buffer_load_dwordx4 v55, s[8:11], s46 offen offset:3072 lds
  v_mfma_f32_16x16x32_bf16 v[220:223], a[124:127], a[48:51], v[220:223]
  s_sub_u32 s50, s50, 1
  v_mfma_f32_16x16x32_bf16 v[252:255], a[124:127], a[52:55], v[252:255]
  s_cmp_eq_u32 s50, 0
  s_cselect_b32 s12, s72, s12
  s_cselect_b32 s13, s73, s13
  v_mfma_f32_16x16x32_bf16 a[156:159], a[124:127], a[56:59], a[156:159]
  s_lshl_b32 s47, s48, 19
  s_bfe_u32 s34, 0x3020106, s49
  s_add_u32 s48, s48, s34
  v_mfma_f32_16x16x32_bf16 a[188:191], a[124:127], a[60:63], a[188:191]
  s_add_u32 s49, s49, 8
  s_and_b32 s49, s49, 0x8001f
  s_and_b32 s48, s48, 7
  s_lshl_b32 s46, s48, 7
  s_waitcnt lgkmcnt(0)
  v_mfma_f32_16x16x32_bf16 v[128:131], a[64:67], a[8:11], v[128:131]
  ds_read_b128 a[32:35], v17 offset:0
  ds_read_b64_tr_b16 a[96:97], v18 offset:4096
  v_mfma_f32_16x16x32_bf16 v[132:135], a[68:71], a[8:11], v[132:135]
  ds_read_b64_tr_b16 a[98:99], v18 offset:6144
  ds_read_b128 a[36:39], v17 offset:2048
  v_mfma_f32_16x16x32_bf16 a[128:131], a[64:67], a[24:27], a[128:131]
  ds_read_b128 a[40:43], v17 offset:4096
  ds_read_b128 a[44:47], v17 offset:6144
  v_mfma_f32_16x16x32_bf16 a[132:135], a[68:71], a[24:27], a[132:135]
  ds_read_b128 a[48:51], v17 offset:8192
  ds_read_b128 a[52:55], v17 offset:10240
  v_mfma_f32_16x16x32_bf16 v[136:139], a[72:75], a[8:11], v[136:139]
  ds_read_b128 a[56:59], v17 offset:12288
  ds_read_b128 a[60:63], v17 offset:14336
  v_mfma_f32_16x16x32_bf16 v[140:143], a[76:79], a[8:11], v[140:143]
  ds_read_b64_tr_b16 a[100:101], v19 offset:4096
  ds_read_b64_tr_b16 a[102:103], v19 offset:6144
  v_mfma_f32_16x16x32_bf16 a[136:139], a[72:75], a[24:27], a[136:139]
  ds_read_b64_tr_b16 a[104:105], v20 offset:4096
  v_mfma_f32_16x16x32_bf16 a[140:143], a[76:79], a[24:27], a[140:143]
  ds_read_b64_tr_b16 a[106:107], v20 offset:6144
  ds_read_b64_tr_b16 a[108:109], v21 offset:4096
  v_mfma_f32_16x16x32_bf16 v[144:147], a[80:83], a[8:11], v[144:147]
  ds_read_b64_tr_b16 a[110:111], v21 offset:6144
  ds_read_b64_tr_b16 a[112:113], v18 offset:12288
  v_mfma_f32_16x16x32_bf16 v[148:151], a[84:87], a[8:11], v[148:151]
  ds_read_b64_tr_b16 a[114:115], v18 offset:14336
  ds_read_b64_tr_b16 a[116:117], v19 offset:12288
  v_mfma_f32_16x16x32_bf16 a[144:147], a[80:83], a[24:27], a[144:147]
  ds_read_b64_tr_b16 a[118:119], v19 offset:14336
  ds_read_b64_tr_b16 a[120:121], v20 offset:12288
  v_mfma_f32_16x16x32_bf16 a[148:151], a[84:87], a[24:27], a[148:151]
  ds_read_b64_tr_b16 a[122:123], v20 offset:14336
  ds_read_b64_tr_b16 a[124:125], v21 offset:12288
  v_mfma_f32_16x16x32_bf16 v[152:155], a[88:91], a[8:11], v[152:155]
  ds_read_b64_tr_b16 a[126:127], v21 offset:14336
  v_mfma_f32_16x16x32_bf16 v[156:159], a[92:95], a[8:11], v[156:159]
  v_mfma_f32_16x16x32_bf16 a[152:155], a[88:91], a[24:27], a[152:155]
  v_mfma_f32_16x16x32_bf16 a[156:159], a[92:95], a[24:27], a[156:159]
  v_mfma_f32_16x16x32_bf16 v[160:163], a[64:67], a[12:15], v[160:163]
  v_mfma_f32_16x16x32_bf16 v[164:167], a[68:71], a[12:15], v[164:167]
  s_add_u32 s36, s36, s38
  s_add_u32 s37, s37, 1
  s_cmp_eq_u32 s37, 3
  s_cselect_b32 s37, 0, s37
  s_cselect_b32 s38, s39, s40
  v_add_u32 v16, s38, v16
  v_add_u32 v17, s38, v17
  s_add_u32 s41, s41, s43
  s_sub_u32 s43, 0, s43
  v_add_u32 v18, s43, v18
  v_add_u32 v19, s43, v19
  v_add_u32 v20, s43, v20
  v_add_u32 v21, s43, v21
  s_waitcnt vmcnt(8) lgkmcnt(0)
  s_barrier
  v_mfma_f32_16x16x32_bf16 v[128:131], a[96:99], a[40:43], v[128:131]
  s_mov_b32 m0, s41
  v_mfma_f32_16x16x32_bf16 v[132:135], a[100:103], a[40:43], v[132:135]
  buffer_load_dwordx4 v56, s[12:15], s47 offen offset:0 lds
  v_mfma_f32_16x16x32_bf16 a[128:131], a[96:99], a[56:59], a[128:131]
  v_mfma_f32_16x16x32_bf16 a[132:135], a[100:103], a[56:59], a[132:135]
  v_mfma_f32_16x16x32_bf16 v[136:139], a[104:107], a[40:43], v[136:139]
  v_mfma_f32_16x16x32_bf16 v[140:143], a[108:111], a[40:43], v[140:143]
  buffer_load_dwordx4 v57, s[12:15], s47 offen offset:1024 lds
  v_cvt_pk_bf16_f32 v128, v128, v129
  v_mfma_f32_16x16x32_bf16 a[136:139], a[104:107], a[56:59], a[136:139]
  v_cvt_pk_bf16_f32 v129, v130, v131
  v_cvt_pk_bf16_f32 v130, v132, v133
  v_mfma_f32_16x16x32_bf16 a[140:143], a[108:111], a[56:59], a[140:143]
  v_cvt_pk_bf16_f32 v131, v134, v135
  v_accvgpr_read_b32 v24, a128
  v_mfma_f32_16x16x32_bf16 v[144:147], a[112:115], a[40:43], v[144:147]
  v_accvgpr_read_b32 v25, a129
  v_accvgpr_read_b32 v26, a130
  v_mfma_f32_16x16x32_bf16 v[148:151], a[116:119], a[40:43], v[148:151]
  v_accvgpr_read_b32 v27, a131
  v_accvgpr_read_b32 v28, a132
  v_mfma_f32_16x16x32_bf16 a[144:147], a[112:115], a[56:59], a[144:147]
  v_accvgpr_read_b32 v29, a133
  v_accvgpr_read_b32 v30, a134
  v_mfma_f32_16x16x32_bf16 a[148:151], a[116:119], a[56:59], a[148:151]
  buffer_load_dwordx4 v58, s[12:15], s47 offen offset:2048 lds
  v_accvgpr_read_b32 v31, a135
  v_mfma_f32_16x16x32_bf16 v[152:155], a[120:123], a[40:43], v[152:155]
  v_cvt_pk_bf16_f32 v132, v24, v25
  v_cvt_pk_bf16_f32 v133, v26, v27
  v_mfma_f32_16x16x32_bf16 v[156:159], a[124:127], a[40:43], v[156:159]
  v_cvt_pk_bf16_f32 v134, v28, v29
  v_cvt_pk_bf16_f32 v135, v30, v31
  v_mfma_f32_16x16x32_bf16 a[152:155], a[120:123], a[56:59], a[152:155]
  s_add_u32 s60, s63, 8192
  buffer_store_dwordx4 v[128:131], v2, s[16:19], s60 offen offset:0 sc1
  v_cvt_pk_bf16_f32 v136, v136, v137
  v_mfma_f32_16x16x32_bf16 a[156:159], a[124:127], a[56:59], a[156:159]
  v_cvt_pk_bf16_f32 v137, v138, v139
  v_cvt_pk_bf16_f32 v138, v140, v141
  v_mfma_f32_16x16x32_bf16 v[160:163], a[96:99], a[44:47], v[160:163]
  v_cvt_pk_bf16_f32 v139, v142, v143
  v_mfma_f32_16x16x32_bf16 v[164:167], a[100:103], a[44:47], v[164:167]
  buffer_load_dwordx4 v59, s[12:15], s47 offen offset:3072 lds
  v_mfma_f32_16x16x32_bf16 a[160:163], a[64:67], a[28:31], a[160:163]
  s_add_u32 m0, s41, 4096
  v_mfma_f32_16x16x32_bf16 a[164:167], a[68:71], a[28:31], a[164:167]
  s_add_u32 s60, s63, 40960
  buffer_store_dwordx4 v[132:135], v2, s[16:19], s60 offen offset:0 sc1
  v_accvgpr_read_b32 v32, a136
  v_mfma_f32_16x16x32_bf16 a[160:163], a[96:99], a[60:63], a[160:163]
  v_accvgpr_read_b32 v33, a137
  v_accvgpr_read_b32 v34, a138
  v_mfma_f32_16x16x32_bf16 a[164:167], a[100:103], a[60:63], a[164:167]
  v_accvgpr_read_b32 v35, a139
  v_accvgpr_read_b32 v36, a140
  v_mfma_f32_16x16x32_bf16 v[168:171], a[72:75], a[12:15], v[168:171]
  buffer_load_dwordx4 v60, s[12:15], s47 offen offset:0 lds
  v_accvgpr_read_b32 v37, a141
  v_mfma_f32_16x16x32_bf16 v[172:175], a[76:79], a[12:15], v[172:175]
  v_accvgpr_read_b32 v38, a142
  v_accvgpr_read_b32 v39, a143
  v_mfma_f32_16x16x32_bf16 v[168:171], a[104:107], a[44:47], v[168:171]
  v_cvt_pk_bf16_f32 v140, v32, v33
  v_cvt_pk_bf16_f32 v141, v34, v35
  v_mfma_f32_16x16x32_bf16 v[172:175], a[108:111], a[44:47], v[172:175]
  v_cvt_pk_bf16_f32 v142, v36, v37
  v_cvt_pk_bf16_f32 v143, v38, v39
  v_mfma_f32_16x16x32_bf16 a[168:171], a[72:75], a[28:31], a[168:171]
  s_add_u32 s60, s63, 8192
  buffer_store_dwordx4 v[136:139], v2, s[16:19], s60 offen offset:1024 sc1
  v_cvt_pk_bf16_f32 v144, v144, v145
  v_mfma_f32_16x16x32_bf16 a[172:175], a[76:79], a[28:31], a[172:175]
  v_cvt_pk_bf16_f32 v145, v146, v147
  v_cvt_pk_bf16_f32 v146, v148, v149
  v_mfma_f32_16x16x32_bf16 a[168:171], a[104:107], a[60:63], a[168:171]
  buffer_load_dwordx4 v61, s[12:15], s47 offen offset:1024 lds
  v_cvt_pk_bf16_f32 v147, v150, v151
  v_mfma_f32_16x16x32_bf16 a[172:175], a[108:111], a[60:63], a[172:175]
  s_add_u32 s60, s63, 40960
  buffer_store_dwordx4 v[140:143], v2, s[16:19], s60 offen offset:1024 sc1
  v_accvgpr_read_b32 v40, a144
  v_mfma_f32_16x16x32_bf16 v[176:179], a[80:83], a[12:15], v[176:179]
  v_accvgpr_read_b32 v41, a145
  v_accvgpr_read_b32 v42, a146
  v_mfma_f32_16x16x32_bf16 v[180:183], a[84:87], a[12:15], v[180:183]
  v_accvgpr_read_b32 v43, a147
  v_accvgpr_read_b32 v44, a148
  v_mfma_f32_16x16x32_bf16 v[176:179], a[112:115], a[44:47], v[176:179]
  v_accvgpr_read_b32 v45, a149
  v_accvgpr_read_b32 v46, a150
  v_mfma_f32_16x16x32_bf16 v[180:183], a[116:119], a[44:47], v[180:183]
  v_accvgpr_read_b32 v47, a151
  v_cvt_pk_bf16_f32 v148, v40, v41
  v_mfma_f32_16x16x32_bf16 a[176:179], a[80:83], a[28:31], a[176:179]
  buffer_load_dwordx4 v62, s[12:15], s47 offen offset:2048 lds
  v_cvt_pk_bf16_f32 v149, v42, v43
  v_mfma_f32_16x16x32_bf16 a[180:183], a[84:87], a[28:31], a[180:183]
  v_cvt_pk_bf16_f32 v150, v44, v45
  v_cvt_pk_bf16_f32 v151, v46, v47
  v_mfma_f32_16x16x32_bf16 a[176:179], a[112:115], a[60:63], a[176:179]
  s_add_u32 s60, s63, 8192
  buffer_store_dwordx4 v[144:147], v2, s[16:19], s60 offen offset:2048 sc1
  v_cvt_pk_bf16_f32 v152, v152, v153
  v_mfma_f32_16x16x32_bf16 a[180:183], a[116:119], a[60:63], a[180:183]
  v_cvt_pk_bf16_f32 v153, v154, v155
  v_cvt_pk_bf16_f32 v154, v156, v157
  v_mfma_f32_16x16x32_bf16 v[184:187], a[88:91], a[12:15], v[184:187]
  v_cvt_pk_bf16_f32 v155, v158, v159
  v_mfma_f32_16x16x32_bf16 v[188:191], a[92:95], a[12:15], v[188:191]
  buffer_load_dwordx4 v63, s[12:15], s47 offen offset:3072 lds
  v_mfma_f32_16x16x32_bf16 v[184:187], a[120:123], a[44:47], v[184:187]
  s_mov_b32 m0, s36
  v_mfma_f32_16x16x32_bf16 v[188:191], a[124:127], a[44:47], v[188:191]
  s_add_u32 s60, s63, 40960
  buffer_store_dwordx4 v[148:151], v2, s[16:19], s60 offen offset:2048 sc1
  v_accvgpr_read_b32 v24, a152
  v_mfma_f32_16x16x32_bf16 a[184:187], a[88:91], a[28:31], a[184:187]
  v_accvgpr_read_b32 v25, a153
  v_accvgpr_read_b32 v26, a154
  v_mfma_f32_16x16x32_bf16 a[188:191], a[92:95], a[28:31], a[188:191]
  v_accvgpr_read_b32 v27, a155
  v_accvgpr_read_b32 v28, a156
  v_mfma_f32_16x16x32_bf16 a[184:187], a[120:123], a[60:63], a[184:187]
  v_accvgpr_read_b32 v29, a157
  v_accvgpr_read_b32 v30, a158
  v_mfma_f32_16x16x32_bf16 a[188:191], a[124:127], a[60:63], a[188:191]
  buffer_load_dwordx4 v48, s[8:11], s46 offen offset:0 lds
  v_accvgpr_read_b32 v31, a159
  v_mfma_f32_16x16x32_bf16 v[192:195], a[64:67], a[16:19], v[192:195]
  v_cvt_pk_bf16_f32 v156, v24, v25
  v_cvt_pk_bf16_f32 v157, v26, v27
  v_mfma_f32_16x16x32_bf16 v[196:199], a[68:71], a[16:19], v[196:199]
  v_cvt_pk_bf16_f32 v158, v28, v29
  v_cvt_pk_bf16_f32 v159, v30, v31
  v_mfma_f32_16x16x32_bf16 v[192:195], a[96:99], a[48:51], v[192:195]
  v_cvt_pk_bf16_f32 v160, v160, v161
  v_cvt_pk_bf16_f32 v161, v162, v163
  v_mfma_f32_16x16x32_bf16 v[196:199], a[100:103], a[48:51], v[196:199]
  v_cvt_pk_bf16_f32 v162, v164, v165
  v_cvt_pk_bf16_f32 v163, v166, v167
  v_mfma_f32_16x16x32_bf16 v[64:67], a[64:67], a[0:3], v[64:67]
  s_add_u32 s60, s63, 8192
  buffer_store_dwordx4 v[152:155], v2, s[16:19], s60 offen offset:3072 sc1
  v_accvgpr_read_b32 v32, a160
  v_mfma_f32_16x16x32_bf16 v[68:71], a[68:71], a[0:3], v[68:71]
  buffer_load_dwordx4 v49, s[8:11], s46 offen offset:1024 lds
  v_accvgpr_read_b32 v33, a161
  v_mfma_f32_16x16x32_bf16 v[64:67], a[96:99], a[32:35], v[64:67]
  v_accvgpr_read_b32 v34, a162
  v_accvgpr_read_b32 v35, a163
  v_mfma_f32_16x16x32_bf16 v[68:71], a[100:103], a[32:35], v[68:71]
  v_accvgpr_read_b32 v36, a164
  v_accvgpr_read_b32 v37, a165
  v_mfma_f32_16x16x32_bf16 v[200:203], a[72:75], a[16:19], v[200:203]
  v_accvgpr_read_b32 v38, a166
  v_accvgpr_read_b32 v39, a167
  v_mfma_f32_16x16x32_bf16 v[204:207], a[76:79], a[16:19], v[204:207]
  v_cvt_pk_bf16_f32 v164, v32, v33
  v_cvt_pk_bf16_f32 v165, v34, v35
  v_mfma_f32_16x16x32_bf16 v[200:203], a[104:107], a[48:51], v[200:203]
  buffer_load_dwordx4 v50, s[8:11], s46 offen offset:2048 lds
  v_cvt_pk_bf16_f32 v166, v36, v37
  v_mfma_f32_16x16x32_bf16 v[204:207], a[108:111], a[48:51], v[204:207]
  v_cvt_pk_bf16_f32 v167, v38, v39
  v_mfma_f32_16x16x32_bf16 v[72:75], a[72:75], a[0:3], v[72:75]
  s_add_u32 s60, s63, 40960
  buffer_store_dwordx4 v[156:159], v2, s[16:19], s60 offen offset:3072 sc1
  v_cvt_pk_bf16_f32 v168, v168, v169
  v_mfma_f32_16x16x32_bf16 v[76:79], a[76:79], a[0:3], v[76:79]
  v_cvt_pk_bf16_f32 v169, v170, v171
  v_cvt_pk_bf16_f32 v170, v172, v173
  v_mfma_f32_16x16x32_bf16 v[72:75], a[104:107], a[32:35], v[72:75]
  v_cvt_pk_bf16_f32 v171, v174, v175
  v_mfma_f32_16x16x32_bf16 v[76:79], a[108:111], a[32:35], v[76:79]
  s_add_u32 s60, s63, 12288
  buffer_store_dwordx4 v[160:163], v2, s[16:19], s60 offen offset:0 sc1
  v_accvgpr_read_b32 v40, a168
  v_mfma_f32_16x16x32_bf16 v[208:211], a[80:83], a[16:19], v[208:211]
  buffer_load_dwordx4 v51, s[8:11], s46 offen offset:3072 lds
  v_accvgpr_read_b32 v41, a169
  v_mfma_f32_16x16x32_bf16 v[212:215], a[84:87], a[16:19], v[212:215]
  s_add_u32 m0, s36, 4096
  v_accvgpr_read_b32 v42, a170
  v_accvgpr_read_b32 v43, a171
  v_mfma_f32_16x16x32_bf16 v[208:211], a[112:115], a[48:51], v[208:211]
  v_accvgpr_read_b32 v44, a172
  v_accvgpr_read_b32 v45, a173
  v_mfma_f32_16x16x32_bf16 v[212:215], a[116:119], a[48:51], v[212:215]
  v_accvgpr_read_b32 v46, a174
  v_accvgpr_read_b32 v47, a175
  v_mfma_f32_16x16x32_bf16 v[80:83], a[80:83], a[0:3], v[80:83]
  v_cvt_pk_bf16_f32 v172, v40, v41
  v_cvt_pk_bf16_f32 v173, v42, v43
  v_mfma_f32_16x16x32_bf16 v[84:87], a[84:87], a[0:3], v[84:87]
  v_cvt_pk_bf16_f32 v174, v44, v45
  v_cvt_pk_bf16_f32 v175, v46, v47
  v_mfma_f32_16x16x32_bf16 v[80:83], a[112:115], a[32:35], v[80:83]
  buffer_load_dwordx4 v52, s[8:11], s46 offen offset:0 lds
  v_mfma_f32_16x16x32_bf16 v[84:87], a[116:119], a[32:35], v[84:87]
  s_add_u32 s60, s63, 45056
  buffer_store_dwordx4 v[164:167], v2, s[16:19], s60 offen offset:0 sc1
  v_cvt_pk_bf16_f32 v176, v176, v177
  v_mfma_f32_16x16x32_bf16 v[216:219], a[88:91], a[16:19], v[216:219]
  v_cvt_pk_bf16_f32 v177, v178, v179
  v_cvt_pk_bf16_f32 v178, v180, v181
  v_mfma_f32_16x16x32_bf16 v[220:223], a[92:95], a[16:19], v[220:223]
  v_cvt_pk_bf16_f32 v179, v182, v183
  v_mfma_f32_16x16x32_bf16 v[216:219], a[120:123], a[48:51], v[216:219]
  s_add_u32 s60, s63, 12288
  buffer_store_dwordx4 v[168:171], v2, s[16:19], s60 offen offset:1024 sc1
  v_accvgpr_read_b32 v24, a176
  v_mfma_f32_16x16x32_bf16 v[220:223], a[124:127], a[48:51], v[220:223]
  buffer_load_dwordx4 v53, s[8:11], s46 offen offset:1024 lds
  v_accvgpr_read_b32 v25, a177
  v_mfma_f32_16x16x32_bf16 v[88:91], a[88:91], a[0:3], v[88:91]
  v_accvgpr_read_b32 v26, a178
  v_accvgpr_read_b32 v27, a179
  v_mfma_f32_16x16x32_bf16 v[92:95], a[92:95], a[0:3], v[92:95]
  v_accvgpr_read_b32 v28, a180
  v_accvgpr_read_b32 v29, a181
  v_mfma_f32_16x16x32_bf16 v[224:227], a[64:67], a[20:23], v[224:227]
  v_accvgpr_read_b32 v30, a182
  v_accvgpr_read_b32 v31, a183
  v_mfma_f32_16x16x32_bf16 v[228:231], a[68:71], a[20:23], v[228:231]
  v_cvt_pk_bf16_f32 v180, v24, v25
  v_cvt_pk_bf16_f32 v181, v26, v27
  v_mfma_f32_16x16x32_bf16 v[96:99], a[64:67], a[4:7], v[96:99]
  v_cvt_pk_bf16_f32 v182, v28, v29
  v_cvt_pk_bf16_f32 v183, v30, v31
  v_mfma_f32_16x16x32_bf16 v[100:103], a[68:71], a[4:7], v[100:103]
  buffer_load_dwordx4 v54, s[8:11], s46 offen offset:2048 lds
  v_mfma_f32_16x16x32_bf16 v[232:235], a[72:75], a[20:23], v[232:235]
  s_add_u32 s60, s63, 45056
  buffer_store_dwordx4 v[172:175], v2, s[16:19], s60 offen offset:1024 sc1
  v_cvt_pk_bf16_f32 v184, v184, v185
  v_mfma_f32_16x16x32_bf16 v[236:239], a[76:79], a[20:23], v[236:239]
  v_cvt_pk_bf16_f32 v185, v186, v187
  v_cvt_pk_bf16_f32 v186, v188, v189
  v_mfma_f32_16x16x32_bf16 v[104:107], a[72:75], a[4:7], v[104:107]
  v_cvt_pk_bf16_f32 v187, v190, v191
  v_accvgpr_read_b32 v32, a184
  v_mfma_f32_16x16x32_bf16 v[108:111], a[76:79], a[4:7], v[108:111]
  v_accvgpr_read_b32 v33, a185
  v_accvgpr_read_b32 v34, a186
  v_mfma_f32_16x16x32_bf16 v[240:243], a[80:83], a[20:23], v[240:243]
  v_accvgpr_read_b32 v35, a187
  v_accvgpr_read_b32 v36, a188
  v_mfma_f32_16x16x32_bf16 v[244:247], a[84:87], a[20:23], v[244:247]
  buffer_load_dwordx4 v55, s[8:11], s46 offen offset:3072 lds
  v_accvgpr_read_b32 v37, a189
  v_mfma_f32_16x16x32_bf16 v[112:115], a[80:83], a[4:7], v[112:115]
  s_sub_u32 s50, s50, 1
  s_cmp_eq_u32 s50, 0
  s_cselect_b32 s12, s72, s12
  s_cselect_b32 s13, s73, s13
  v_mfma_f32_16x16x32_bf16 v[116:119], a[84:87], a[4:7], v[116:119]
  s_lshl_b32 s47, s48, 19
  s_bfe_u32 s34, 0x3020106, s49
  s_add_u32 s48, s48, s34
  v_mfma_f32_16x16x32_bf16 v[248:251], a[88:91], a[20:23], v[248:251]
  s_add_u32 s49, s49, 8
  s_and_b32 s49, s49, 0x8001f
  s_and_b32 s48, s48, 7
  v_mfma_f32_16x16x32_bf16 v[252:255], a[92:95], a[20:23], v[252:255]
  s_lshl_b32 s46, s48, 7
  v_accvgpr_read_b32 v38, a190
  v_accvgpr_read_b32 v39, a191
  v_mfma_f32_16x16x32_bf16 v[120:123], a[88:91], a[4:7], v[120:123]
  v_cvt_pk_bf16_f32 v188, v32, v33
  v_cvt_pk_bf16_f32 v189, v34, v35
  v_mfma_f32_16x16x32_bf16 v[124:127], a[92:95], a[4:7], v[124:127]
  v_cvt_pk_bf16_f32 v190, v36, v37
  v_cvt_pk_bf16_f32 v191, v38, v39
  v_mfma_f32_16x16x32_bf16 v[88:91], a[120:123], a[32:35], v[88:91]
  ds_read_b128 a[0:3], v16 offset:0
  ds_read_b64_tr_b16 a[64:65], v18 offset:0
  v_mfma_f32_16x16x32_bf16 v[92:95], a[124:127], a[32:35], v[92:95]
  ds_read_b64_tr_b16 a[66:67], v18 offset:2048
  ds_read_b128 a[4:7], v16 offset:2048
  v_mfma_f32_16x16x32_bf16 v[224:227], a[96:99], a[52:55], v[224:227]
  ds_read_b128 a[8:11], v16 offset:4096
  ds_read_b128 a[12:15], v16 offset:6144
  v_mfma_f32_16x16x32_bf16 v[228:231], a[100:103], a[52:55], v[228:231]
  ds_read_b128 a[16:19], v16 offset:8192
  ds_read_b128 a[20:23], v16 offset:10240
  v_mfma_f32_16x16x32_bf16 v[96:99], a[96:99], a[36:39], v[96:99]
  ds_read_b128 a[24:27], v16 offset:12288
  ds_read_b128 a[28:31], v16 offset:14336
  v_mfma_f32_16x16x32_bf16 v[100:103], a[100:103], a[36:39], v[100:103]
  ds_read_b64_tr_b16 a[68:69], v19 offset:0
  ds_read_b64_tr_b16 a[70:71], v19 offset:2048
  v_mfma_f32_16x16x32_bf16 v[232:235], a[104:107], a[52:55], v[232:235]
  ds_read_b64_tr_b16 a[72:73], v20 offset:0
  ds_read_b64_tr_b16 a[74:75], v20 offset:2048
  v_mfma_f32_16x16x32_bf16 v[236:239], a[108:111], a[52:55], v[236:239]
  ds_read_b64_tr_b16 a[76:77], v21 offset:0
  ds_read_b64_tr_b16 a[78:79], v21 offset:2048
  v_mfma_f32_16x16x32_bf16 v[104:107], a[104:107], a[36:39], v[104:107]
  ds_read_b64_tr_b16 a[80:81], v18 offset:8192
  ds_read_b64_tr_b16 a[82:83], v18 offset:10240
  v_mfma_f32_16x16x32_bf16 v[108:111], a[108:111], a[36:39], v[108:111]
  ds_read_b64_tr_b16 a[84:85], v19 offset:8192
  ds_read_b64_tr_b16 a[86:87], v19 offset:10240
  v_mfma_f32_16x16x32_bf16 v[240:243], a[112:115], a[52:55], v[240:243]
  ds_read_b64_tr_b16 a[88:89], v20 offset:8192
  ds_read_b64_tr_b16 a[90:91], v20 offset:10240
  v_mfma_f32_16x16x32_bf16 v[244:247], a[116:119], a[52:55], v[244:247]
  ds_read_b64_tr_b16 a[92:93], v21 offset:8192
  ds_read_b64_tr_b16 a[94:95], v21 offset:10240
  v_mfma_f32_16x16x32_bf16 v[112:115], a[112:115], a[36:39], v[112:115]
  v_cvt_pk_bf16_f32 v192, v192, v193
  v_cvt_pk_bf16_f32 v193, v194, v195
  v_mfma_f32_16x16x32_bf16 v[116:119], a[116:119], a[36:39], v[116:119]
  v_cvt_pk_bf16_f32 v194, v196, v197
  v_cvt_pk_bf16_f32 v195, v198, v199
  v_mfma_f32_16x16x32_bf16 v[248:251], a[120:123], a[52:55], v[248:251]
  v_cvt_pk_bf16_f32 v196, v64, v65
  v_cvt_pk_bf16_f32 v197, v66, v67
  v_mfma_f32_16x16x32_bf16 v[252:255], a[124:127], a[52:55], v[252:255]
  v_cvt_pk_bf16_f32 v198, v68, v69
  v_cvt_pk_bf16_f32 v199, v70, v71
  v_mfma_f32_16x16x32_bf16 v[120:123], a[120:123], a[36:39], v[120:123]
  v_cvt_pk_bf16_f32 v200, v200, v201
  v_cvt_pk_bf16_f32 v201, v202, v203
  v_mfma_f32_16x16x32_bf16 v[124:127], a[124:127], a[36:39], v[124:127]
  v_cvt_pk_bf16_f32 v202, v204, v205
  v_cvt_pk_bf16_f32 v203, v206, v207
  s_waitcnt lgkmcnt(0)
  v_mfma_f32_16x16x32_bf16 a[128:131], a[24:27], a[64:67], 0
  ds_read_b128 a[32:35], v17 offset:0
  ds_read_b64_tr_b16 a[96:97], v18 offset:4096
  v_mfma_f32_16x16x32_bf16 a[132:135], a[24:27], a[68:71], 0
  ds_read_b64_tr_b16 a[98:99], v18 offset:6144
  ds_read_b128 a[36:39], v17 offset:2048
  v_mfma_f32_16x16x32_bf16 a[136:139], a[24:27], a[72:75], 0
  ds_read_b128 a[40:43], v17 offset:4096
  ds_read_b128 a[44:47], v17 offset:6144
  v_mfma_f32_16x16x32_bf16 a[140:143], a[24:27], a[76:79], 0
  ds_read_b128 a[48:51], v17 offset:8192
  ds_read_b128 a[52:55], v17 offset:10240
  v_mfma_f32_16x16x32_bf16 a[144:147], a[24:27], a[80:83], 0
  ds_read_b128 a[56:59], v17 offset:12288
  ds_read_b128 a[60:63], v17 offset:14336
  v_mfma_f32_16x16x32_bf16 a[148:151], a[24:27], a[84:87], 0
  ds_read_b64_tr_b16 a[100:101], v19 offset:4096
  ds_read_b64_tr_b16 a[102:103], v19 offset:6144
  v_mfma_f32_16x16x32_bf16 a[152:155], a[24:27], a[88:91], 0
  ds_read_b64_tr_b16 a[104:105], v20 offset:4096
  v_cvt_pk_bf16_f32 v204, v72, v73
  v_mfma_f32_16x16x32_bf16 a[156:159], a[24:27], a[92:95], 0
  ds_read_b64_tr_b16 a[106:107], v20 offset:6144
  ds_read_b64_tr_b16 a[108:109], v21 offset:4096
  v_mfma_f32_16x16x32_bf16 a[160:163], a[28:31], a[64:67], 0
  ds_read_b64_tr_b16 a[110:111], v21 offset:6144
  ds_read_b64_tr_b16 a[112:113], v18 offset:12288
  v_mfma_f32_16x16x32_bf16 a[164:167], a[28:31], a[68:71], 0
  ds_read_b64_tr_b16 a[114:115], v18 offset:14336
  ds_read_b64_tr_b16 a[116:117], v19 offset:12288
  v_mfma_f32_16x16x32_bf16 a[168:171], a[28:31], a[72:75], 0
  ds_read_b64_tr_b16 a[118:119], v19 offset:14336
  ds_read_b64_tr_b16 a[120:121], v20 offset:12288
  v_mfma_f32_16x16x32_bf16 a[172:175], a[28:31], a[76:79], 0
  ds_read_b64_tr_b16 a[122:123], v20 offset:14336
  ds_read_b64_tr_b16 a[124:125], v21 offset:12288
  v_mfma_f32_16x16x32_bf16 a[176:179], a[28:31], a[80:83], 0
  ds_read_b64_tr_b16 a[126:127], v21 offset:14336
  v_cvt_pk_bf16_f32 v205, v74, v75
  v_mfma_f32_16x16x32_bf16 a[180:183], a[28:31], a[84:87], 0
  v_cvt_pk_bf16_f32 v206, v76, v77
  v_cvt_pk_bf16_f32 v207, v78, v79
  v_mfma_f32_16x16x32_bf16 a[184:187], a[28:31], a[88:91], 0
  v_cvt_pk_bf16_f32 v208, v208, v209
  v_cvt_pk_bf16_f32 v209, v210, v211
  v_mfma_f32_16x16x32_bf16 a[188:191], a[28:31], a[92:95], 0
  v_cvt_pk_bf16_f32 v210, v212, v213
  v_cvt_pk_bf16_f32 v211, v214, v215
  v_mfma_f32_16x16x32_bf16 v[128:131], a[8:11], a[64:67], 0
  v_cvt_pk_bf16_f32 v212, v80, v81
  v_cvt_pk_bf16_f32 v213, v82, v83
  v_mfma_f32_16x16x32_bf16 v[132:135], a[8:11], a[68:71], 0
  v_cvt_pk_bf16_f32 v214, v84, v85
  v_cvt_pk_bf16_f32 v215, v86, v87
  v_mfma_f32_16x16x32_bf16 v[136:139], a[8:11], a[72:75], 0
  v_cvt_pk_bf16_f32 v216, v216, v217
  v_cvt_pk_bf16_f32 v217, v218, v219
  v_mfma_f32_16x16x32_bf16 v[140:143], a[8:11], a[76:79], 0
  s_add_u32 s36, s36, s38
  s_add_u32 s37, s37, 1
  s_cmp_eq_u32 s37, 3
  s_cselect_b32 s37, 0, s37
  s_cselect_b32 s38, s39, s40
  v_add_u32 v16, s38, v16
  v_add_u32 v17, s38, v17
  s_add_u32 s41, s41, s43
  s_sub_u32 s43, 0, s43
  v_add_u32 v18, s43, v18
  v_add_u32 v19, s43, v19
  v_add_u32 v20, s43, v20
  v_add_u32 v21, s43, v21
  s_waitcnt vmcnt(8) lgkmcnt(0)
  s_barrier
  v_mfma_f32_16x16x32_bf16 a[128:131], a[56:59], a[96:99], a[128:131]
  s_mov_b32 m0, s41
  v_cvt_pk_bf16_f32 v218, v220, v221
  v_cvt_pk_bf16_f32 v219, v222, v223
  v_mfma_f32_16x16x32_bf16 a[132:135], a[56:59], a[100:103], a[132:135]
  v_cvt_pk_bf16_f32 v220, v88, v89
  v_cvt_pk_bf16_f32 v221, v90, v91
  v_mfma_f32_16x16x32_bf16 a[136:139], a[56:59], a[104:107], a[136:139]
  v_cvt_pk_bf16_f32 v222, v92, v93
  v_cvt_pk_bf16_f32 v223, v94, v95
  v_mfma_f32_16x16x32_bf16 a[140:143], a[56:59], a[108:111], a[140:143]
  v_cvt_pk_bf16_f32 v224, v224, v225
  v_cvt_pk_bf16_f32 v225, v226, v227
  v_mfma_f32_16x16x32_bf16 a[144:147], a[56:59], a[112:115], a[144:147]
  v_cvt_pk_bf16_f32 v226, v228, v229
  v_cvt_pk_bf16_f32 v227, v230, v231
  v_mfma_f32_16x16x32_bf16 a[148:151], a[56:59], a[116:119], a[148:151]
  v_cvt_pk_bf16_f32 v228, v96, v97
  v_cvt_pk_bf16_f32 v229, v98, v99
  v_mfma_f32_16x16x32_bf16 a[152:155], a[56:59], a[120:123], a[152:155]
  v_cvt_pk_bf16_f32 v230, v100, v101
  v_cvt_pk_bf16_f32 v231, v102, v103
  v_mfma_f32_16x16x32_bf16 a[156:159], a[56:59], a[124:127], a[156:159]
  v_cvt_pk_bf16_f32 v232, v232, v233
  v_cvt_pk_bf16_f32 v233, v234, v235
  v_mfma_f32_16x16x32_bf16 a[160:163], a[60:63], a[96:99], a[160:163]
  v_cvt_pk_bf16_f32 v234, v236, v237
  v_cvt_pk_bf16_f32 v235, v238, v239
  v_mfma_f32_16x16x32_bf16 a[164:167], a[60:63], a[100:103], a[164:167]
  v_cvt_pk_bf16_f32 v236, v104, v105
  v_cvt_pk_bf16_f32 v237, v106, v107
  v_mfma_f32_16x16x32_bf16 a[168:171], a[60:63], a[104:107], a[168:171]
  v_cvt_pk_bf16_f32 v238, v108, v109
  v_cvt_pk_bf16_f32 v239, v110, v111
  v_mfma_f32_16x16x32_bf16 a[172:175], a[60:63], a[108:111], a[172:175]
  v_cvt_pk_bf16_f32 v240, v240, v241
  v_cvt_pk_bf16_f32 v241, v242, v243
  v_mfma_f32_16x16x32_bf16 a[176:179], a[60:63], a[112:115], a[176:179]
  v_cvt_pk_bf16_f32 v242, v244, v245
  v_cvt_pk_bf16_f32 v243, v246, v247
  v_mfma_f32_16x16x32_bf16 a[180:183], a[60:63], a[116:119], a[180:183]
  v_cvt_pk_bf16_f32 v244, v112, v113
  v_cvt_pk_bf16_f32 v245, v114, v115
  v_mfma_f32_16x16x32_bf16 a[184:187], a[60:63], a[120:123], a[184:187]
  v_cvt_pk_bf16_f32 v246, v116, v117
  v_cvt_pk_bf16_f32 v247, v118, v119
  v_mfma_f32_16x16x32_bf16 a[188:191], a[60:63], a[124:127], a[188:191]
  v_cvt_pk_bf16_f32 v248, v248, v249
  v_cvt_pk_bf16_f32 v249, v250, v251
  v_mfma_f32_16x16x32_bf16 v[128:131], a[40:43], a[96:99], v[128:131]
  v_cvt_pk_bf16_f32 v250, v252, v253
  v_cvt_pk_bf16_f32 v251, v254, v255
  v_mfma_f32_16x16x32_bf16 v[132:135], a[40:43], a[100:103], v[132:135]
  v_cvt_pk_bf16_f32 v252, v120, v121
  v_cvt_pk_bf16_f32 v253, v122, v123
  v_mfma_f32_16x16x32_bf16 v[136:139], a[40:43], a[104:107], v[136:139]
  v_cvt_pk_bf16_f32 v254, v124, v125
  v_cvt_pk_bf16_f32 v255, v126, v127
  v_mfma_f32_16x16x32_bf16 v[140:143], a[40:43], a[108:111], v[140:143]
  s_add_u32 s60, s63, 12288
  buffer_store_dwordx4 v[176:179], v2, s[16:19], s60 offen offset:2048 sc1
  v_mfma_f32_16x16x32_bf16 v[144:147], a[8:11], a[80:83], 0
  s_add_u32 s60, s63, 45056
  buffer_store_dwordx4 v[180:183], v2, s[16:19], s60 offen offset:2048 sc1
  v_mfma_f32_16x16x32_bf16 v[148:151], a[8:11], a[84:87], 0
  s_add_u32 s60, s63, 12288
  buffer_store_dwordx4 v[184:187], v2, s[16:19], s60 offen offset:3072 sc1
  v_mfma_f32_16x16x32_bf16 v[144:147], a[40:43], a[112:115], v[144:147]
  s_add_u32 s60, s63, 45056
  buffer_store_dwordx4 v[188:191], v2, s[16:19], s60 offen offset:3072 sc1
  v_mfma_f32_16x16x32_bf16 v[148:151], a[40:43], a[116:119], v[148:151]
  s_add_u32 s60, s63, 32768
  buffer_store_dwordx4 v[192:195], v2, s[16:19], s60 offen offset:0 sc1
  v_mfma_f32_16x16x32_bf16 v[152:155], a[8:11], a[88:91], 0
  s_add_u32 s60, s63, 0
  buffer_store_dwordx4 v[196:199], v2, s[16:19], s60 offen offset:0 sc1
  v_mfma_f32_16x16x32_bf16 v[156:159], a[8:11], a[92:95], 0
  buffer_load_dwordx4 v56, s[12:15], s47 offen offset:0 lds
  v_mfma_f32_16x16x32_bf16 v[152:155], a[40:43], a[120:123], v[152:155]
  s_add_u32 s60, s63, 32768
  buffer_store_dwordx4 v[200:203], v2, s[16:19], s60 offen offset:1024 sc1
  v_mfma_f32_16x16x32_bf16 v[156:159], a[40:43], a[124:127], v[156:159]
  buffer_load_dwordx4 v57, s[12:15], s47 offen offset:1024 lds
  v_mfma_f32_16x16x32_bf16 v[160:163], a[12:15], a[64:67], 0
  buffer_load_dwordx4 v58, s[12:15], s47 offen offset:2048 lds
  v_mfma_f32_16x16x32_bf16 v[164:167], a[12:15], a[68:71], 0
  buffer_load_dwordx4 v59, s[12:15], s47 offen offset:3072 lds
  v_mfma_f32_16x16x32_bf16 v[160:163], a[44:47], a[96:99], v[160:163]
  s_add_u32 m0, s41, 4096
  v_mfma_f32_16x16x32_bf16 v[164:167], a[44:47], a[100:103], v[164:167]
  s_add_u32 s60, s63, 0
  buffer_store_dwordx4 v[204:207], v2, s[16:19], s60 offen offset:1024 sc1
  v_mfma_f32_16x16x32_bf16 v[168:171], a[12:15], a[72:75], 0
  buffer_load_dwordx4 v60, s[12:15], s47 offen offset:0 lds
  v_mfma_f32_16x16x32_bf16 v[172:175], a[12:15], a[76:79], 0
  buffer_load_dwordx4 v61, s[12:15], s47 offen offset:1024 lds
  v_mfma_f32_16x16x32_bf16 v[168:171], a[44:47], a[104:107], v[168:171]
  buffer_load_dwordx4 v62, s[12:15], s47 offen offset:2048 lds
  v_mfma_f32_16x16x32_bf16 v[172:175], a[44:47], a[108:111], v[172:175]
  s_add_u32 s60, s63, 32768
  buffer_store_dwordx4 v[208:211], v2, s[16:19], s60 offen offset:2048 sc1
  v_mfma_f32_16x16x32_bf16 v[64:67], a[0:3], a[64:67], 0
  v_mfma_f32_16x16x32_bf16 v[68:71], a[0:3], a[68:71], 0
  v_mfma_f32_16x16x32_bf16 v[64:67], a[32:35], a[96:99], v[64:67]
  buffer_load_dwordx4 v63, s[12:15], s47 offen offset:3072 lds
  v_mfma_f32_16x16x32_bf16 v[68:71], a[32:35], a[100:103], v[68:71]
  s_add_u32 s60, s63, 0
  buffer_store_dwordx4 v[212:215], v2, s[16:19], s60 offen offset:2048 sc1
  s_mov_b32 m0, s36
  s_nop 0
  buffer_load_dwordx4 v48, s[8:11], s46 offen offset:0 lds
  buffer_load_dwordx4 v49, s[8:11], s46 offen offset:1024 lds
  buffer_load_dwordx4 v50, s[8:11], s46 offen offset:2048 lds
  buffer_load_dwordx4 v51, s[8:11], s46 offen offset:3072 lds
  v_mfma_f32_16x16x32_bf16 v[72:75], a[0:3], a[72:75], 0
  s_add_u32 m0, s36, 4096
  v_mfma_f32_16x16x32_bf16 v[76:79], a[0:3], a[76:79], 0
  v_mfma_f32_16x16x32_bf16 v[72:75], a[32:35], a[104:107], v[72:75]
  v_mfma_f32_16x16x32_bf16 v[76:79], a[32:35], a[108:111], v[76:79]
  v_mfma_f32_16x16x32_bf16 v[80:83], a[0:3], a[80:83], 0
  s_add_u32 s60, s63, 32768
  buffer_store_dwordx4 v[216:219], v2, s[16:19], s60 offen offset:3072 sc1
  v_mfma_f32_16x16x32_bf16 v[84:87], a[0:3], a[84:87], 0
  v_mfma_f32_16x16x32_bf16 v[80:83], a[32:35], a[112:115], v[80:83]
  v_mfma_f32_16x16x32_bf16 v[84:87], a[32:35], a[116:119], v[84:87]
  v_mfma_f32_16x16x32_bf16 v[88:91], a[0:3], a[88:91], 0
  s_add_u32 s60, s63, 0
  buffer_store_dwordx4 v[220:223], v2, s[16:19], s60 offen offset:3072 sc1
  v_mfma_f32_16x16x32_bf16 v[92:95], a[0:3], a[92:95], 0
  v_mfma_f32_16x16x32_bf16 v[88:91], a[32:35], a[120:123], v[88:91]
  v_mfma_f32_16x16x32_bf16 v[92:95], a[32:35], a[124:127], v[92:95]
  v_mfma_f32_16x16x32_bf16 v[96:99], a[4:7], a[64:67], 0
  s_add_u32 s60, s63, 36864
  buffer_store_dwordx4 v[224:227], v2, s[16:19], s60 offen offset:0 sc1
  v_mfma_f32_16x16x32_bf16 v[100:103], a[4:7], a[68:71], 0
  v_mfma_f32_16x16x32_bf16 v[96:99], a[36:39], a[96:99], v[96:99]
  v_mfma_f32_16x16x32_bf16 v[100:103], a[36:39], a[100:103], v[100:103]
  v_mfma_f32_16x16x32_bf16 v[104:107], a[4:7], a[72:75], 0
  s_add_u32 s60, s63, 4096
  buffer_store_dwordx4 v[228:231], v2, s[16:19], s60 offen offset:0 sc1
  v_mfma_f32_16x16x32_bf16 v[108:111], a[4:7], a[76:79], 0
  v_mfma_f32_16x16x32_bf16 v[104:107], a[36:39], a[104:107], v[104:107]
  v_mfma_f32_16x16x32_bf16 v[108:111], a[36:39], a[108:111], v[108:111]
  v_mfma_f32_16x16x32_bf16 v[112:115], a[4:7], a[80:83], 0
  v_mfma_f32_16x16x32_bf16 v[116:119], a[4:7], a[84:87], 0
  s_add_u32 s60, s63, 36864
  buffer_store_dwordx4 v[232:235], v2, s[16:19], s60 offen offset:1024 sc1
  v_mfma_f32_16x16x32_bf16 v[112:115], a[36:39], a[112:115], v[112:115]
  v_mfma_f32_16x16x32_bf16 v[116:119], a[36:39], a[116:119], v[116:119]
  v_mfma_f32_16x16x32_bf16 v[120:123], a[4:7], a[88:91], 0
  v_mfma_f32_16x16x32_bf16 v[124:127], a[4:7], a[92:95], 0
  s_add_u32 s60, s63, 4096
  buffer_store_dwordx4 v[236:239], v2, s[16:19], s60 offen offset:1024 sc1
  v_mfma_f32_16x16x32_bf16 v[120:123], a[36:39], a[120:123], v[120:123]
  buffer_load_dwordx4 v52, s[8:11], s46 offen offset:0 lds
  v_mfma_f32_16x16x32_bf16 v[124:127], a[36:39], a[124:127], v[124:127]
  v_mfma_f32_16x16x32_bf16 v[176:179], a[12:15], a[80:83], 0
  v_mfma_f32_16x16x32_bf16 v[180:183], a[12:15], a[84:87], 0
  s_add_u32 s60, s63, 36864
  buffer_store_dwordx4 v[240:243], v2, s[16:19], s60 offen offset:2048 sc1
  v_mfma_f32_16x16x32_bf16 v[176:179], a[44:47], a[112:115], v[176:179]
  v_mfma_f32_16x16x32_bf16 v[180:183], a[44:47], a[116:119], v[180:183]
  v_mfma_f32_16x16x32_bf16 v[184:187], a[12:15], a[88:91], 0
  buffer_load_dwordx4 v53, s[8:11], s46 offen offset:1024 lds
  v_mfma_f32_16x16x32_bf16 v[188:191], a[12:15], a[92:95], 0
  v_mfma_f32_16x16x32_bf16 v[192:195], a[16:19], a[64:67], 0
  s_add_u32 s60, s63, 4096
  buffer_store_dwordx4 v[244:247], v2, s[16:19], s60 offen offset:2048 sc1
  v_mfma_f32_16x16x32_bf16 v[196:199], a[16:19], a[68:71], 0
  v_mfma_f32_16x16x32_bf16 v[200:203], a[16:19], a[72:75], 0
  v_mfma_f32_16x16x32_bf16 v[204:207], a[16:19], a[76:79], 0
  buffer_load_dwordx4 v54, s[8:11], s46 offen offset:2048 lds
  v_mfma_f32_16x16x32_bf16 v[208:211], a[16:19], a[80:83], 0
  s_add_u32 s60, s63, 36864
  buffer_store_dwordx4 v[248:251], v2, s[16:19], s60 offen offset:3072 sc1
  v_mfma_f32_16x16x32_bf16 v[212:215], a[16:19], a[84:87], 0
  v_mfma_f32_16x16x32_bf16 v[216:219], a[16:19], a[88:91], 0
  v_mfma_f32_16x16x32_bf16 v[220:223], a[16:19], a[92:95], 0
  v_mfma_f32_16x16x32_bf16 v[224:227], a[20:23], a[64:67], 0
  s_add_u32 s60, s63, 4096
  buffer_store_dwordx4 v[252:255], v2, s[16:19], s60 offen offset:3072 sc1
  v_mfma_f32_16x16x32_bf16 v[228:231], a[20:23], a[68:71], 0
  buffer_load_dwordx4 v55, s[8:11], s46 offen offset:3072 lds
  v_mfma_f32_16x16x32_bf16 v[232:235], a[20:23], a[72:75], 0
  s_sub_u32 s50, s50, 1
  s_cmp_eq_u32 s50, 0
  s_cselect_b32 s12, s72, s12
  s_cselect_b32 s13, s73, s13
  v_mfma_f32_16x16x32_bf16 v[236:239], a[20:23], a[76:79], 0
  s_lshl_b32 s47, s48, 19
  s_bfe_u32 s34, 0x3020106, s49
  s_add_u32 s48, s48, s34
  v_mfma_f32_16x16x32_bf16 v[240:243], a[20:23], a[80:83], 0
  s_add_u32 s49, s49, 8
  s_and_b32 s49, s49, 0x8001f
  s_and_b32 s48, s48, 7
  v_mfma_f32_16x16x32_bf16 v[244:247], a[20:23], a[84:87], 0
  s_lshl_b32 s46, s48, 7
  v_mfma_f32_16x16x32_bf16 v[248:251], a[20:23], a[88:91], 0
  v_mfma_f32_16x16x32_bf16 v[252:255], a[20:23], a[92:95], 0
  v_mfma_f32_16x16x32_bf16 v[184:187], a[44:47], a[120:123], v[184:187]
  ds_read_b128 a[0:3], v16 offset:0
  ds_read_b64_tr_b16 a[64:65], v18 offset:0
  v_mfma_f32_16x16x32_bf16 v[188:191], a[44:47], a[124:127], v[188:191]
  ds_read_b64_tr_b16 a[66:67], v18 offset:2048
  ds_read_b128 a[4:7], v16 offset:2048
  v_mfma_f32_16x16x32_bf16 v[192:195], a[48:51], a[96:99], v[192:195]
  ds_read_b128 a[8:11], v16 offset:4096
  ds_read_b128 a[12:15], v16 offset:6144
  v_mfma_f32_16x16x32_bf16 v[196:199], a[48:51], a[100:103], v[196:199]
  ds_read_b128 a[16:19], v16 offset:8192
  ds_read_b128 a[20:23], v16 offset:10240
  v_mfma_f32_16x16x32_bf16 v[200:203], a[48:51], a[104:107], v[200:203]
  ds_read_b128 a[24:27], v16 offset:12288
  ds_read_b128 a[28:31], v16 offset:14336
  v_mfma_f32_16x16x32_bf16 v[204:207], a[48:51], a[108:111], v[204:207]
  ds_read_b64_tr_b16 a[68:69], v19 offset:0
  ds_read_b64_tr_b16 a[70:71], v19 offset:2048
  v_mfma_f32_16x16x32_bf16 v[208:211], a[48:51], a[112:115], v[208:211]
  ds_read_b64_tr_b16 a[72:73], v20 offset:0
  ds_read_b64_tr_b16 a[74:75], v20 offset:2048
  v_mfma_f32_16x16x32_bf16 v[212:215], a[48:51], a[116:119], v[212:215]
  ds_read_b64_tr_b16 a[76:77], v21 offset:0
  ds_read_b64_tr_b16 a[78:79], v21 offset:2048
  v_mfma_f32_16x16x32_bf16 v[216:219], a[48:51], a[120:123], v[216:219]
  ds_read_b64_tr_b16 a[80:81], v18 offset:8192
  ds_read_b64_tr_b16 a[82:83], v18 offset:10240
  v_mfma_f32_16x16x32_bf16 v[220:223], a[48:51], a[124:127], v[220:223]
  ds_read_b64_tr_b16 a[84:85], v19 offset:8192
  ds_read_b64_tr_b16 a[86:87], v19 offset:10240
  v_mfma_f32_16x16x32_bf16 v[224:227], a[52:55], a[96:99], v[224:227]
  ds_read_b64_tr_b16 a[88:89], v20 offset:8192
  ds_read_b64_tr_b16 a[90:91], v20 offset:10240
  v_mfma_f32_16x16x32_bf16 v[228:231], a[52:55], a[100:103], v[228:231]
  ds_read_b64_tr_b16 a[92:93], v21 offset:8192
  ds_read_b64_tr_b16 a[94:95], v21 offset:10240
  v_mfma_f32_16x16x32_bf16 v[232:235], a[52:55], a[104:107], v[232:235]
  v_mfma_f32_16x16x32_bf16 v[236:239], a[52:55], a[108:111], v[236:239]
  v_mfma_f32_16x16x32_bf16 v[240:243], a[52:55], a[112:115], v[240:243]
  v_mfma_f32_16x16x32_bf16 v[244:247], a[52:55], a[116:119], v[244:247]
  v_mfma_f32_16x16x32_bf16 v[248:251], a[52:55], a[120:123], v[248:251]
  v_mfma_f32_16x16x32_bf16 v[252:255], a[52:55], a[124:127], v[252:255]
  s_add_u32 s63, s63, 0x4000
  s_waitcnt lgkmcnt(0)
  v_mfma_f32_16x16x32_bf16 v[64:67], a[0:3], a[64:67], v[64:67]
  s_add_u32 s36, s36, s38
  ds_read_b128 a[32:35], v17 offset:0
  v_mfma_f32_16x16x32_bf16 v[96:99], a[4:7], a[64:67], v[96:99]
  s_add_u32 s37, s37, 1
  v_mfma_f32_16x16x32_bf16 v[128:131], a[8:11], a[64:67], v[128:131]
  ds_read_b64_tr_b16 a[96:97], v18 offset:4096
  v_mfma_f32_16x16x32_bf16 v[160:163], a[12:15], a[64:67], v[160:163]
  s_cmp_eq_u32 s37, 3
  s_cselect_b32 s37, 0, s37
  s_cselect_b32 s38, s39, s40
  v_mfma_f32_16x16x32_bf16 v[192:195], a[16:19], a[64:67], v[192:195]
  s_add_u32 s41, s41, s43
  ds_read_b64_tr_b16 a[98:99], v18 offset:6144
  v_mfma_f32_16x16x32_bf16 v[224:227], a[20:23], a[64:67], v[224:227]
  s_sub_u32 s43, 0, s43
  v_mfma_f32_16x16x32_bf16 a[128:131], a[24:27], a[64:67], a[128:131]
  ds_read_b128 a[36:39], v17 offset:2048
  v_mfma_f32_16x16x32_bf16 a[160:163], a[28:31], a[64:67], a[160:163]
  v_mfma_f32_16x16x32_bf16 v[68:71], a[0:3], a[68:71], v[68:71]
  v_mfma_f32_16x16x32_bf16 v[100:103], a[4:7], a[68:71], v[100:103]
  ds_read_b128 a[40:43], v17 offset:4096
  v_mfma_f32_16x16x32_bf16 v[132:135], a[8:11], a[68:71], v[132:135]
  v_mfma_f32_16x16x32_bf16 v[164:167], a[12:15], a[68:71], v[164:167]
  ds_read_b128 a[44:47], v17 offset:6144
  v_mfma_f32_16x16x32_bf16 v[196:199], a[16:19], a[68:71], v[196:199]
  v_mfma_f32_16x16x32_bf16 v[228:231], a[20:23], a[68:71], v[228:231]
  ds_read_b128 a[48:51], v17 offset:8192
  v_mfma_f32_16x16x32_bf16 a[132:135], a[24:27], a[68:71], a[132:135]
  v_mfma_f32_16x16x32_bf16 a[164:167], a[28:31], a[68:71], a[164:167]
  ds_read_b128 a[52:55], v17 offset:10240
  v_mfma_f32_16x16x32_bf16 v[72:75], a[0:3], a[72:75], v[72:75]
  v_mfma_f32_16x16x32_bf16 v[104:107], a[4:7], a[72:75], v[104:107]
  v_mfma_f32_16x16x32_bf16 v[136:139], a[8:11], a[72:75], v[136:139]
  ds_read_b128 a[56:59], v17 offset:12288
  v_mfma_f32_16x16x32_bf16 v[168:171], a[12:15], a[72:75], v[168:171]
  v_mfma_f32_16x16x32_bf16 v[200:203], a[16:19], a[72:75], v[200:203]
  ds_read_b128 a[60:63], v17 offset:14336
  v_mfma_f32_16x16x32_bf16 v[232:235], a[20:23], a[72:75], v[232:235]
  v_mfma_f32_16x16x32_bf16 a[136:139], a[24:27], a[72:75], a[136:139]
  ds_read_b64_tr_b16 a[100:101], v19 offset:4096
  v_mfma_f32_16x16x32_bf16 a[168:171], a[28:31], a[72:75], a[168:171]
  v_mfma_f32_16x16x32_bf16 v[76:79], a[0:3], a[76:79], v[76:79]
  ds_read_b64_tr_b16 a[102:103], v19 offset:6144
  v_mfma_f32_16x16x32_bf16 v[108:111], a[4:7], a[76:79], v[108:111]
  v_mfma_f32_16x16x32_bf16 v[140:143], a[8:11], a[76:79], v[140:143]
  v_mfma_f32_16x16x32_bf16 v[172:175], a[12:15], a[76:79], v[172:175]
  ds_read_b64_tr_b16 a[104:105], v20 offset:4096
  v_mfma_f32_16x16x32_bf16 v[204:207], a[16:19], a[76:79], v[204:207]
  v_mfma_f32_16x16x32_bf16 v[236:239], a[20:23], a[76:79], v[236:239]
  ds_read_b64_tr_b16 a[106:107], v20 offset:6144
  v_mfma_f32_16x16x32_bf16 a[140:143], a[24:27], a[76:79], a[140:143]
  v_mfma_f32_16x16x32_bf16 a[172:175], a[28:31], a[76:79], a[172:175]
  ds_read_b64_tr_b16 a[108:109], v21 offset:4096
  v_mfma_f32_16x16x32_bf16 v[80:83], a[0:3], a[80:83], v[80:83]
  v_mfma_f32_16x16x32_bf16 v[112:115], a[4:7], a[80:83], v[112:115]
  ds_read_b64_tr_b16 a[110:111], v21 offset:6144
  v_mfma_f32_16x16x32_bf16 v[144:147], a[8:11], a[80:83], v[144:147]
  v_mfma_f32_16x16x32_bf16 v[176:179], a[12:15], a[80:83], v[176:179]
  v_mfma_f32_16x16x32_bf16 v[208:211], a[16:19], a[80:83], v[208:211]
  ds_read_b64_tr_b16 a[112:113], v18 offset:12288
  v_mfma_f32_16x16x32_bf16 v[240:243], a[20:23], a[80:83], v[240:243]
  v_mfma_f32_16x16x32_bf16 a[144:147], a[24:27], a[80:83], a[144:147]
  ds_read_b64_tr_b16 a[114:115], v18 offset:14336
  v_mfma_f32_16x16x32_bf16 a[176:179], a[28:31], a[80:83], a[176:179]
  v_mfma_f32_16x16x32_bf16 v[84:87], a[0:3], a[84:87], v[84:87]
  ds_read_b64_tr_b16 a[116:117], v19 offset:12288
  v_mfma_f32_16x16x32_bf16 v[116:119], a[4:7], a[84:87], v[116:119]
  v_mfma_f32_16x16x32_bf16 v[148:151], a[8:11], a[84:87], v[148:151]
  ds_read_b64_tr_b16 a[118:119], v19 offset:14336
  v_mfma_f32_16x16x32_bf16 v[180:183], a[12:15], a[84:87], v[180:183]
  v_mfma_f32_16x16x32_bf16 v[212:215], a[16:19], a[84:87], v[212:215]
  v_mfma_f32_16x16x32_bf16 v[244:247], a[20:23], a[84:87], v[244:247]
  ds_read_b64_tr_b16 a[120:121], v20 offset:12288
  v_mfma_f32_16x16x32_bf16 a[148:151], a[24:27], a[84:87], a[148:151]
  v_mfma_f32_16x16x32_bf16 a[180:183], a[28:31], a[84:87], a[180:183]
  ds_read_b64_tr_b16 a[122:123], v20 offset:14336
  v_mfma_f32_16x16x32_bf16 v[88:91], a[0:3], a[88:91], v[88:91]
  v_mfma_f32_16x16x32_bf16 v[120:123], a[4:7], a[88:91], v[120:123]
  ds_read_b64_tr_b16 a[124:125], v21 offset:12288
  v_mfma_f32_16x16x32_bf16 v[152:155], a[8:11], a[88:91], v[152:155]
  v_mfma_f32_16x16x32_bf16 v[184:187], a[12:15], a[88:91], v[184:187]
  ds_read_b64_tr_b16 a[126:127], v21 offset:14336
  v_mfma_f32_16x16x32_bf16 v[216:219], a[16:19], a[88:91], v[216:219]
  v_add_u32 v16, s38, v16
  v_add_u32 v17, s38, v17
  v_mfma_f32_16x16x32_bf16 v[248:251], a[20:23], a[88:91], v[248:251]
  v_add_u32 v18, s43, v18
  v_add_u32 v19, s43, v19
  v_mfma_f32_16x16x32_bf16 a[152:155], a[24:27], a[88:91], a[152:155]
  v_add_u32 v20, s43, v20
  v_add_u32 v21, s43, v21
  v_mfma_f32_16x16x32_bf16 a[184:187], a[28:31], a[88:91], a[184:187]
  v_mfma_f32_16x16x32_bf16 v[92:95], a[0:3], a[92:95], v[92:95]
  v_mfma_f32_16x16x32_bf16 v[124:127], a[4:7], a[92:95], v[124:127]
  v_mfma_f32_16x16x32_bf16 v[156:159], a[8:11], a[92:95], v[156:159]
  v_mfma_f32_16x16x32_bf16 v[188:191], a[12:15], a[92:95], v[188:191]
  v_mfma_f32_16x16x32_bf16 v[220:223], a[16:19], a[92:95], v[220:223]
  v_mfma_f32_16x16x32_bf16 v[252:255], a[20:23], a[92:95], v[252:255]
  v_mfma_f32_16x16x32_bf16 a[156:159], a[24:27], a[92:95], a[156:159]
  v_mfma_f32_16x16x32_bf16 a[188:191], a[28:31], a[92:95], a[188:191]
  s_mov_b32 s35, 4
  s_waitcnt vmcnt(8) lgkmcnt(0)
  s_barrier
  .p2align 6
Lp1xw_loop:
  v_mfma_f32_16x16x32_bf16 v[64:67], a[32:35], a[96:99], v[64:67]
  s_mov_b32 m0, s41
  ds_read_b128 a[0:3], v16 offset:0
  v_mfma_f32_16x16x32_bf16 v[96:99], a[36:39], a[96:99], v[96:99]
  buffer_load_dwordx4 v56, s[12:15], s47 offen offset:0 lds
  v_mfma_f32_16x16x32_bf16 v[128:131], a[40:43], a[96:99], v[128:131]
  ds_read_b64_tr_b16 a[64:65], v18 offset:0
  v_mfma_f32_16x16x32_bf16 v[160:163], a[44:47], a[96:99], v[160:163]
  v_mfma_f32_16x16x32_bf16 v[192:195], a[48:51], a[96:99], v[192:195]
  ds_read_b64_tr_b16 a[66:67], v18 offset:2048
  v_mfma_f32_16x16x32_bf16 v[224:227], a[52:55], a[96:99], v[224:227]
  v_mfma_f32_16x16x32_bf16 a[128:131], a[56:59], a[96:99], a[128:131]
  ds_read_b128 a[4:7], v16 offset:2048
  v_mfma_f32_16x16x32_bf16 a[160:163], a[60:63], a[96:99], a[160:163]
  buffer_load_dwordx4 v57, s[12:15], s47 offen offset:1024 lds
  v_mfma_f32_16x16x32_bf16 v[68:71], a[32:35], a[100:103], v[68:71]
  v_mfma_f32_16x16x32_bf16 v[100:103], a[36:39], a[100:103], v[100:103]
  ds_read_b128 a[8:11], v16 offset:4096
  v_mfma_f32_16x16x32_bf16 v[132:135], a[40:43], a[100:103], v[132:135]
  v_mfma_f32_16x16x32_bf16 v[164:167], a[44:47], a[100:103], v[164:167]
  ds_read_b128 a[12:15], v16 offset:6144
  v_mfma_f32_16x16x32_bf16 v[196:199], a[48:51], a[100:103], v[196:199]
  v_mfma_f32_16x16x32_bf16 v[228:231], a[52:55], a[100:103], v[228:231]
  ds_read_b128 a[16:19], v16 offset:8192
  v_mfma_f32_16x16x32_bf16 a[132:135], a[56:59], a[100:103], a[132:135]
  v_mfma_f32_16x16x32_bf16 a[164:167], a[60:63], a[100:103], a[164:167]
  buffer_load_dwordx4 v58, s[12:15], s47 offen offset:2048 lds
  v_mfma_f32_16x16x32_bf16 v[72:75], a[32:35], a[104:107], v[72:75]
  ds_read_b128 a[20:23], v16 offset:10240
  v_mfma_f32_16x16x32_bf16 v[104:107], a[36:39], a[104:107], v[104:107]
  v_mfma_f32_16x16x32_bf16 v[136:139], a[40:43], a[104:107], v[136:139]
  ds_read_b128 a[24:27], v16 offset:12288
  v_mfma_f32_16x16x32_bf16 v[168:171], a[44:47], a[104:107], v[168:171]
  v_mfma_f32_16x16x32_bf16 v[200:203], a[48:51], a[104:107], v[200:203]
  ds_read_b128 a[28:31], v16 offset:14336
  v_mfma_f32_16x16x32_bf16 v[232:235], a[52:55], a[104:107], v[232:235]
  v_mfma_f32_16x16x32_bf16 a[136:139], a[56:59], a[104:107], a[136:139]
  ds_read_b64_tr_b16 a[68:69], v19 offset:0
  v_mfma_f32_16x16x32_bf16 a[168:171], a[60:63], a[104:107], a[168:171]
  buffer_load_dwordx4 v59, s[12:15], s47 offen offset:3072 lds
  v_mfma_f32_16x16x32_bf16 v[76:79], a[32:35], a[108:111], v[76:79]
  s_add_u32 m0, s41, 4096
  ds_read_b64_tr_b16 a[70:71], v19 offset:2048
  v_mfma_f32_16x16x32_bf16 v[108:111], a[36:39], a[108:111], v[108:111]
  v_mfma_f32_16x16x32_bf16 v[140:143], a[40:43], a[108:111], v[140:143]
  v_mfma_f32_16x16x32_bf16 v[172:175], a[44:47], a[108:111], v[172:175]
  ds_read_b64_tr_b16 a[72:73], v20 offset:0
  v_mfma_f32_16x16x32_bf16 v[204:207], a[48:51], a[108:111], v[204:207]
  v_mfma_f32_16x16x32_bf16 v[236:239], a[52:55], a[108:111], v[236:239]
  ds_read_b64_tr_b16 a[74:75], v20 offset:2048
  v_mfma_f32_16x16x32_bf16 a[140:143], a[56:59], a[108:111], a[140:143]
  v_mfma_f32_16x16x32_bf16 a[172:175], a[60:63], a[108:111], a[172:175]
  buffer_load_dwordx4 v60, s[12:15], s47 offen offset:0 lds
  v_mfma_f32_16x16x32_bf16 v[80:83], a[32:35], a[112:115], v[80:83]
  ds_read_b64_tr_b16 a[76:77], v21 offset:0
  v_mfma_f32_16x16x32_bf16 v[112:115], a[36:39], a[112:115], v[112:115]
  ds_read_b64_tr_b16 a[78:79], v21 offset:2048
  v_mfma_f32_16x16x32_bf16 v[144:147], a[40:43], a[112:115], v[144:147]
  v_mfma_f32_16x16x32_bf16 v[176:179], a[44:47], a[112:115], v[176:179]
  v_mfma_f32_16x16x32_bf16 v[208:211], a[48:51], a[112:115], v[208:211]
  ds_read_b64_tr_b16 a[80:81], v18 offset:8192
  v_mfma_f32_16x16x32_bf16 v[240:243], a[52:55], a[112:115], v[240:243]
  v_mfma_f32_16x16x32_bf16 a[144:147], a[56:59], a[112:115], a[144:147]
  ds_read_b64_tr_b16 a[82:83], v18 offset:10240
  v_mfma_f32_16x16x32_bf16 a[176:179], a[60:63], a[112:115], a[176:179]
  buffer_load_dwordx4 v61, s[12:15], s47 offen offset:1024 lds
  v_mfma_f32_16x16x32_bf16 v[84:87], a[32:35], a[116:119], v[84:87]
  ds_read_b64_tr_b16 a[84:85], v19 offset:8192
  v_mfma_f32_16x16x32_bf16 v[116:119], a[36:39], a[116:119], v[116:119]
  v_mfma_f32_16x16x32_bf16 v[148:151], a[40:43], a[116:119], v[148:151]
  ds_read_b64_tr_b16 a[86:87], v19 offset:10240
  v_mfma_f32_16x16x32_bf16 v[180:183], a[44:47], a[116:119], v[180:183]
  v_mfma_f32_16x16x32_bf16 v[212:215], a[48:51], a[116:119], v[212:215]
  v_mfma_f32_16x16x32_bf16 v[244:247], a[52:55], a[116:119], v[244:247]
  ds_read_b64_tr_b16 a[88:89], v20 offset:8192
  v_mfma_f32_16x16x32_bf16 a[148:151], a[56:59], a[116:119], a[148:151]
  v_mfma_f32_16x16x32_bf16 a[180:183], a[60:63], a[116:119], a[180:183]
  buffer_load_dwordx4 v62, s[12:15], s47 offen offset:2048 lds
  v_mfma_f32_16x16x32_bf16 v[88:91], a[32:35], a[120:123], v[88:91]
  ds_read_b64_tr_b16 a[90:91], v20 offset:10240
  v_mfma_f32_16x16x32_bf16 v[120:123], a[36:39], a[120:123], v[120:123]
  ds_read_b64_tr_b16 a[92:93], v21 offset:8192
  v_mfma_f32_16x16x32_bf16 v[152:155], a[40:43], a[120:123], v[152:155]
  v_mfma_f32_16x16x32_bf16 v[184:187], a[44:47], a[120:123], v[184:187]
  ds_read_b64_tr_b16 a[94:95], v21 offset:10240
  v_mfma_f32_16x16x32_bf16 v[216:219], a[48:51], a[120:123], v[216:219]
  v_mfma_f32_16x16x32_bf16 v[248:251], a[52:55], a[120:123], v[248:251]
  v_mfma_f32_16x16x32_bf16 a[152:155], a[56:59], a[120:123], a[152:155]
  v_mfma_f32_16x16x32_bf16 a[184:187], a[60:63], a[120:123], a[184:187]
  buffer_load_dwordx4 v63, s[12:15], s47 offen offset:3072 lds
  v_mfma_f32_16x16x32_bf16 v[92:95], a[32:35], a[124:127], v[92:95]
  v_mfma_f32_16x16x32_bf16 v[124:127], a[36:39], a[124:127], v[124:127]
  v_mfma_f32_16x16x32_bf16 v[156:159], a[40:43], a[124:127], v[156:159]
  v_mfma_f32_16x16x32_bf16 v[188:191], a[44:47], a[124:127], v[188:191]
  v_mfma_f32_16x16x32_bf16 v[220:223], a[48:51], a[124:127], v[220:223]
  v_mfma_f32_16x16x32_bf16 v[252:255], a[52:55], a[124:127], v[252:255]
  v_mfma_f32_16x16x32_bf16 a[156:159], a[56:59], a[124:127], a[156:159]
  v_mfma_f32_16x16x32_bf16 a[188:191], a[60:63], a[124:127], a[188:191]
  s_waitcnt lgkmcnt(0)
  v_mfma_f32_16x16x32_bf16 v[64:67], a[0:3], a[64:67], v[64:67]
  s_mov_b32 m0, s36
  ds_read_b128 a[32:35], v17 offset:0
  v_mfma_f32_16x16x32_bf16 v[96:99], a[4:7], a[64:67], v[96:99]
  buffer_load_dwordx4 v48, s[8:11], s46 offen offset:0 lds
  v_mfma_f32_16x16x32_bf16 v[128:131], a[8:11], a[64:67], v[128:131]
  ds_read_b64_tr_b16 a[96:97], v18 offset:4096
  v_mfma_f32_16x16x32_bf16 v[160:163], a[12:15], a[64:67], v[160:163]
  v_mfma_f32_16x16x32_bf16 v[192:195], a[16:19], a[64:67], v[192:195]
  ds_read_b64_tr_b16 a[98:99], v18 offset:6144
  v_mfma_f32_16x16x32_bf16 v[224:227], a[20:23], a[64:67], v[224:227]
  v_mfma_f32_16x16x32_bf16 a[128:131], a[24:27], a[64:67], a[128:131]
  ds_read_b128 a[36:39], v17 offset:2048
  v_mfma_f32_16x16x32_bf16 a[160:163], a[28:31], a[64:67], a[160:163]
  buffer_load_dwordx4 v49, s[8:11], s46 offen offset:1024 lds
  v_mfma_f32_16x16x32_bf16 v[68:71], a[0:3], a[68:71], v[68:71]
  v_mfma_f32_16x16x32_bf16 v[100:103], a[4:7], a[68:71], v[100:103]
  ds_read_b128 a[40:43], v17 offset:4096
  v_mfma_f32_16x16x32_bf16 v[132:135], a[8:11], a[68:71], v[132:135]
  v_mfma_f32_16x16x32_bf16 v[164:167], a[12:15], a[68:71], v[164:167]
  ds_read_b128 a[44:47], v17 offset:6144
  v_mfma_f32_16x16x32_bf16 v[196:199], a[16:19], a[68:71], v[196:199]
  v_mfma_f32_16x16x32_bf16 v[228:231], a[20:23], a[68:71], v[228:231]
  ds_read_b128 a[48:51], v17 offset:8192
  v_mfma_f32_16x16x32_bf16 a[132:135], a[24:27], a[68:71], a[132:135]
  buffer_load_dwordx4 v50, s[8:11], s46 offen offset:2048 lds
  v_mfma_f32_16x16x32_bf16 a[164:167], a[28:31], a[68:71], a[164:167]
  ds_read_b128 a[52:55], v17 offset:10240
  v_mfma_f32_16x16x32_bf16 v[72:75], a[0:3], a[72:75], v[72:75]
  v_mfma_f32_16x16x32_bf16 v[104:107], a[4:7], a[72:75], v[104:107]
  v_mfma_f32_16x16x32_bf16 v[136:139], a[8:11], a[72:75], v[136:139]
  ds_read_b128 a[56:59], v17 offset:12288
  v_mfma_f32_16x16x32_bf16 v[168:171], a[12:15], a[72:75], v[168:171]
  v_mfma_f32_16x16x32_bf16 v[200:203], a[16:19], a[72:75], v[200:203]
  ds_read_b128 a[60:63], v17 offset:14336
  v_mfma_f32_16x16x32_bf16 v[232:235], a[20:23], a[72:75], v[232:235]
  buffer_load_dwordx4 v51, s[8:11], s46 offen offset:3072 lds
  v_mfma_f32_16x16x32_bf16 a[136:139], a[24:27], a[72:75], a[136:139]
  s_add_u32 m0, s36, 4096
  ds_read_b64_tr_b16 a[100:101], v19 offset:4096
  v_mfma_f32_16x16x32_bf16 a[168:171], a[28:31], a[72:75], a[168:171]
  s_add_u32 s36, s36, s38
  v_mfma_f32_16x16x32_bf16 v[76:79], a[0:3], a[76:79], v[76:79]
  s_add_u32 s37, s37, 1
  ds_read_b64_tr_b16 a[102:103], v19 offset:6144
  v_mfma_f32_16x16x32_bf16 v[108:111], a[4:7], a[76:79], v[108:111]
  s_cmp_eq_u32 s37, 3
  s_cselect_b32 s37, 0, s37
  s_cselect_b32 s38, s39, s40
  v_mfma_f32_16x16x32_bf16 v[140:143], a[8:11], a[76:79], v[140:143]
  s_add_u32 s41, s41, s43
  v_mfma_f32_16x16x32_bf16 v[172:175], a[12:15], a[76:79], v[172:175]
  s_sub_u32 s43, 0, s43
  ds_read_b64_tr_b16 a[104:105], v20 offset:4096
  v_mfma_f32_16x16x32_bf16 v[204:207], a[16:19], a[76:79], v[204:207]
  buffer_load_dwordx4 v52, s[8:11], s46 offen offset:0 lds
  v_mfma_f32_16x16x32_bf16 v[236:239], a[20:23], a[76:79], v[236:239]
  ds_read_b64_tr_b16 a[106:107], v20 offset:6144
  v_mfma_f32_16x16x32_bf16 a[140:143], a[24:27], a[76:79], a[140:143]
  v_mfma_f32_16x16x32_bf16 a[172:175], a[28:31], a[76:79], a[172:175]
  ds_read_b64_tr_b16 a[108:109], v21 offset:4096
  v_mfma_f32_16x16x32_bf16 v[80:83], a[0:3], a[80:83], v[80:83]
  v_mfma_f32_16x16x32_bf16 v[112:115], a[4:7], a[80:83], v[112:115]
  ds_read_b64_tr_b16 a[110:111], v21 offset:6144
  v_mfma_f32_16x16x32_bf16 v[144:147], a[8:11], a[80:83], v[144:147]
  v_mfma_f32_16x16x32_bf16 v[176:179], a[12:15], a[80:83], v[176:179]
  buffer_load_dwordx4 v53, s[8:11], s46 offen offset:1024 lds
  v_mfma_f32_16x16x32_bf16 v[208:211], a[16:19], a[80:83], v[208:211]
  ds_read_b64_tr_b16 a[112:113], v18 offset:12288
  v_mfma_f32_16x16x32_bf16 v[240:243], a[20:23], a[80:83], v[240:243]
  v_mfma_f32_16x16x32_bf16 a[144:147], a[24:27], a[80:83], a[144:147]
  ds_read_b64_tr_b16 a[114:115], v18 offset:14336
  v_mfma_f32_16x16x32_bf16 a[176:179], a[28:31], a[80:83], a[176:179]
  v_mfma_f32_16x16x32_bf16 v[84:87], a[0:3], a[84:87], v[84:87]
  ds_read_b64_tr_b16 a[116:117], v19 offset:12288
  v_mfma_f32_16x16x32_bf16 v[116:119], a[4:7], a[84:87], v[116:119]
  v_mfma_f32_16x16x32_bf16 v[148:151], a[8:11], a[84:87], v[148:151]
  buffer_load_dwordx4 v54, s[8:11], s46 offen offset:2048 lds
  v_mfma_f32_16x16x32_bf16 v[180:183], a[12:15], a[84:87], v[180:183]
  ds_read_b64_tr_b16 a[118:119], v19 offset:14336
  v_mfma_f32_16x16x32_bf16 v[212:215], a[16:19], a[84:87], v[212:215]
  v_mfma_f32_16x16x32_bf16 v[244:247], a[20:23], a[84:87], v[244:247]
  ds_read_b64_tr_b16 a[120:121], v20 offset:12288
  v_mfma_f32_16x16x32_bf16 a[148:151], a[24:27], a[84:87], a[148:151]
  v_mfma_f32_16x16x32_bf16 a[180:183], a[28:31], a[84:87], a[180:183]
  ds_read_b64_tr_b16 a[122:123], v20 offset:14336
  v_mfma_f32_16x16x32_bf16 v[88:91], a[0:3], a[88:91], v[88:91]
  v_mfma_f32_16x16x32_bf16 v[120:123], a[4:7], a[88:91], v[120:123]
  buffer_load_dwordx4 v55, s[8:11], s46 offen offset:3072 lds
  v_mfma_f32_16x16x32_bf16 v[152:155], a[8:11], a[88:91], v[152:155]
  s_sub_u32 s50, s50, 1
  ds_read_b64_tr_b16 a[124:125], v21 offset:12288
  v_mfma_f32_16x16x32_bf16 v[184:187], a[12:15], a[88:91], v[184:187]
  ds_read_b64_tr_b16 a[126:127], v21 offset:14336
  v_mfma_f32_16x16x32_bf16 v[216:219], a[16:19], a[88:91], v[216:219]
  s_cmp_eq_u32 s50, 0
  s_cselect_b32 s12, s72, s12
  s_cselect_b32 s13, s73, s13
  v_mfma_f32_16x16x32_bf16 v[248:251], a[20:23], a[88:91], v[248:251]
  s_lshl_b32 s47, s48, 19
  v_add_u32 v16, s38, v16
  v_add_u32 v17, s38, v17
  v_mfma_f32_16x16x32_bf16 a[152:155], a[24:27], a[88:91], a[152:155]
  s_bfe_u32 s34, 0x3020106, s49
  v_add_u32 v18, s43, v18
  v_add_u32 v19, s43, v19
  v_mfma_f32_16x16x32_bf16 a[184:187], a[28:31], a[88:91], a[184:187]
  s_add_u32 s48, s48, s34
  v_add_u32 v20, s43, v20
  v_add_u32 v21, s43, v21
  v_mfma_f32_16x16x32_bf16 v[92:95], a[0:3], a[92:95], v[92:95]
  s_add_u32 s49, s49, 8
  v_mfma_f32_16x16x32_bf16 v[124:127], a[4:7], a[92:95], v[124:127]
  s_and_b32 s49, s49, 0x8001f
  v_mfma_f32_16x16x32_bf16 v[156:159], a[8:11], a[92:95], v[156:159]
  s_and_b32 s48, s48, 7
  v_mfma_f32_16x16x32_bf16 v[188:191], a[12:15], a[92:95], v[188:191]
  s_lshl_b32 s46, s48, 7
  v_mfma_f32_16x16x32_bf16 v[220:223], a[16:19], a[92:95], v[220:223]
  v_mfma_f32_16x16x32_bf16 v[252:255], a[20:23], a[92:95], v[252:255]
  s_waitcnt vmcnt(8) lgkmcnt(0)
  s_barrier
  v_mfma_f32_16x16x32_bf16 a[156:159], a[24:27], a[92:95], a[156:159]
  s_sub_u32 s35, s35, 1
  v_mfma_f32_16x16x32_bf16 a[188:191], a[28:31], a[92:95], a[188:191]
  s_cmp_lg_u32 s35, 0
  s_cbranch_scc1 Lp1xw_loop
  v_accvgpr_read_b32 v4, a222
  v_accvgpr_read_b32 v5, a223
  v_accvgpr_read_b32 v6, a224
  v_accvgpr_read_b32 v7, a225
  v_accvgpr_read_b32 v8, a226
  v_accvgpr_read_b32 v9, a227
  v_accvgpr_read_b32 v10, a228
  v_accvgpr_read_b32 v11, a229
  s_mov_b32 s8, s64
  s_mov_b32 s9, s65
  s_mov_b32 s10, 4194304
  s_mov_b32 s11, 0x00020000
  s_mov_b32 s20, s68
  s_mov_b32 s21, s69
  s_mov_b32 s22, 8388608
  s_mov_b32 s23, 0x00020000
  s_and_b32 s4, s2, 7
  s_lshl_b32 s4, s4, 1
  s_lshr_b32 s5, s2, 6
  s_lshr_b32 s30, s2, 4
  s_add_u32 s5, s5, s30
  s_and_b32 s53, s5, 3
  s_lshl_b32 s53, s53, 3
  s_or_b32 s53, s53, 0x80000
  s_bfe_u32 s52, 0xf0f02, s53
  s_add_u32 s52, s52, s4
  s_and_b32 s52, s52, 15
  s_mov_b32 s54, s52
  s_mov_b32 s55, s53
  s_lshl_b32 s29, s52, 7
  s_lshl_b32 s28, s54, 19
  s_lshl_b32 s30, s25, 18
  s_and_b32 s31, s25, 1
  s_lshl_b32 s31, s31, 1
  s_add_u32 s31, s31, 14
  s_sub_u32 s31, s31, s25
  s_lshl_b32 s31, s31, 18
  s_or_b32 s26, s30, s29
  s_or_b32 s27, s31, s29
  s_lshl_b32 s68, s3, 12
  s_lshl_b32 s88, s3, 13
  s_add_u32 s88, s88, 98304
  v_mfma_f32_16x16x32_bf16 v[64:67], a[32:35], a[96:99], v[64:67]
  s_mov_b32 m0, s41
  ds_read_b128 a[0:3], v16 offset:0
  v_mfma_f32_16x16x32_bf16 v[96:99], a[36:39], a[96:99], v[96:99]
  buffer_load_dwordx4 v56, s[12:15], s47 offen offset:0 lds
  v_mfma_f32_16x16x32_bf16 v[128:131], a[40:43], a[96:99], v[128:131]
  ds_read_b64_tr_b16 a[64:65], v18 offset:0
  v_mfma_f32_16x16x32_bf16 v[160:163], a[44:47], a[96:99], v[160:163]
  v_mfma_f32_16x16x32_bf16 v[192:195], a[48:51], a[96:99], v[192:195]
  ds_read_b64_tr_b16 a[66:67], v18 offset:2048
  v_mfma_f32_16x16x32_bf16 v[224:227], a[52:55], a[96:99], v[224:227]
  v_mfma_f32_16x16x32_bf16 a[128:131], a[56:59], a[96:99], a[128:131]
  ds_read_b128 a[4:7], v16 offset:2048
  v_mfma_f32_16x16x32_bf16 a[160:163], a[60:63], a[96:99], a[160:163]
  buffer_load_dwordx4 v57, s[12:15], s47 offen offset:1024 lds
  v_mfma_f32_16x16x32_bf16 v[68:71], a[32:35], a[100:103], v[68:71]
  v_mfma_f32_16x16x32_bf16 v[100:103], a[36:39], a[100:103], v[100:103]
  ds_read_b128 a[8:11], v16 offset:4096
  v_mfma_f32_16x16x32_bf16 v[132:135], a[40:43], a[100:103], v[132:135]
  v_mfma_f32_16x16x32_bf16 v[164:167], a[44:47], a[100:103], v[164:167]
  ds_read_b128 a[12:15], v16 offset:6144
  v_mfma_f32_16x16x32_bf16 v[196:199], a[48:51], a[100:103], v[196:199]
  v_mfma_f32_16x16x32_bf16 v[228:231], a[52:55], a[100:103], v[228:231]
  ds_read_b128 a[16:19], v16 offset:8192
  v_mfma_f32_16x16x32_bf16 a[132:135], a[56:59], a[100:103], a[132:135]
  v_mfma_f32_16x16x32_bf16 a[164:167], a[60:63], a[100:103], a[164:167]
  buffer_load_dwordx4 v58, s[12:15], s47 offen offset:2048 lds
  v_mfma_f32_16x16x32_bf16 v[72:75], a[32:35], a[104:107], v[72:75]
  ds_read_b128 a[20:23], v16 offset:10240
  v_mfma_f32_16x16x32_bf16 v[104:107], a[36:39], a[104:107], v[104:107]
  v_mfma_f32_16x16x32_bf16 v[136:139], a[40:43], a[104:107], v[136:139]
  ds_read_b128 a[24:27], v16 offset:12288
  v_mfma_f32_16x16x32_bf16 v[168:171], a[44:47], a[104:107], v[168:171]
  v_mfma_f32_16x16x32_bf16 v[200:203], a[48:51], a[104:107], v[200:203]
  ds_read_b128 a[28:31], v16 offset:14336
  v_mfma_f32_16x16x32_bf16 v[232:235], a[52:55], a[104:107], v[232:235]
  v_mfma_f32_16x16x32_bf16 a[136:139], a[56:59], a[104:107], a[136:139]
  ds_read_b64_tr_b16 a[68:69], v19 offset:0
  v_mfma_f32_16x16x32_bf16 a[168:171], a[60:63], a[104:107], a[168:171]
  buffer_load_dwordx4 v59, s[12:15], s47 offen offset:3072 lds
  v_mfma_f32_16x16x32_bf16 v[76:79], a[32:35], a[108:111], v[76:79]
  s_add_u32 m0, s41, 4096
  ds_read_b64_tr_b16 a[70:71], v19 offset:2048
  v_mfma_f32_16x16x32_bf16 v[108:111], a[36:39], a[108:111], v[108:111]
  v_mfma_f32_16x16x32_bf16 v[140:143], a[40:43], a[108:111], v[140:143]
  v_mfma_f32_16x16x32_bf16 v[172:175], a[44:47], a[108:111], v[172:175]
  ds_read_b64_tr_b16 a[72:73], v20 offset:0
  v_mfma_f32_16x16x32_bf16 v[204:207], a[48:51], a[108:111], v[204:207]
  v_mfma_f32_16x16x32_bf16 v[236:239], a[52:55], a[108:111], v[236:239]
  ds_read_b64_tr_b16 a[74:75], v20 offset:2048
  v_mfma_f32_16x16x32_bf16 a[140:143], a[56:59], a[108:111], a[140:143]
  v_mfma_f32_16x16x32_bf16 a[172:175], a[60:63], a[108:111], a[172:175]
  buffer_load_dwordx4 v60, s[12:15], s47 offen offset:0 lds
  v_mfma_f32_16x16x32_bf16 v[80:83], a[32:35], a[112:115], v[80:83]
  ds_read_b64_tr_b16 a[76:77], v21 offset:0
  v_mfma_f32_16x16x32_bf16 v[112:115], a[36:39], a[112:115], v[112:115]
  ds_read_b64_tr_b16 a[78:79], v21 offset:2048
  v_mfma_f32_16x16x32_bf16 v[144:147], a[40:43], a[112:115], v[144:147]
  v_mfma_f32_16x16x32_bf16 v[176:179], a[44:47], a[112:115], v[176:179]
  v_mfma_f32_16x16x32_bf16 v[208:211], a[48:51], a[112:115], v[208:211]
  ds_read_b64_tr_b16 a[80:81], v18 offset:8192
  v_mfma_f32_16x16x32_bf16 v[240:243], a[52:55], a[112:115], v[240:243]
  v_mfma_f32_16x16x32_bf16 a[144:147], a[56:59], a[112:115], a[144:147]
  ds_read_b64_tr_b16 a[82:83], v18 offset:10240
  v_mfma_f32_16x16x32_bf16 a[176:179], a[60:63], a[112:115], a[176:179]
  buffer_load_dwordx4 v61, s[12:15], s47 offen offset:1024 lds
  v_mfma_f32_16x16x32_bf16 v[84:87], a[32:35], a[116:119], v[84:87]
  ds_read_b64_tr_b16 a[84:85], v19 offset:8192
  v_mfma_f32_16x16x32_bf16 v[116:119], a[36:39], a[116:119], v[116:119]
  v_mfma_f32_16x16x32_bf16 v[148:151], a[40:43], a[116:119], v[148:151]
  ds_read_b64_tr_b16 a[86:87], v19 offset:10240
  v_mfma_f32_16x16x32_bf16 v[180:183], a[44:47], a[116:119], v[180:183]
  v_mfma_f32_16x16x32_bf16 v[212:215], a[48:51], a[116:119], v[212:215]
  v_mfma_f32_16x16x32_bf16 v[244:247], a[52:55], a[116:119], v[244:247]
  ds_read_b64_tr_b16 a[88:89], v20 offset:8192
  v_mfma_f32_16x16x32_bf16 a[148:151], a[56:59], a[116:119], a[148:151]
  v_mfma_f32_16x16x32_bf16 a[180:183], a[60:63], a[116:119], a[180:183]
  buffer_load_dwordx4 v62, s[12:15], s47 offen offset:2048 lds
  v_mfma_f32_16x16x32_bf16 v[88:91], a[32:35], a[120:123], v[88:91]
  ds_read_b64_tr_b16 a[90:91], v20 offset:10240
  v_mfma_f32_16x16x32_bf16 v[120:123], a[36:39], a[120:123], v[120:123]
  ds_read_b64_tr_b16 a[92:93], v21 offset:8192
  v_mfma_f32_16x16x32_bf16 v[152:155], a[40:43], a[120:123], v[152:155]
  v_mfma_f32_16x16x32_bf16 v[184:187], a[44:47], a[120:123], v[184:187]
  ds_read_b64_tr_b16 a[94:95], v21 offset:10240
  v_mfma_f32_16x16x32_bf16 v[216:219], a[48:51], a[120:123], v[216:219]
  v_mfma_f32_16x16x32_bf16 v[248:251], a[52:55], a[120:123], v[248:251]
  v_mfma_f32_16x16x32_bf16 a[152:155], a[56:59], a[120:123], a[152:155]
  v_mfma_f32_16x16x32_bf16 a[184:187], a[60:63], a[120:123], a[184:187]
  buffer_load_dwordx4 v63, s[12:15], s47 offen offset:3072 lds
  v_mfma_f32_16x16x32_bf16 v[92:95], a[32:35], a[124:127], v[92:95]
  v_mfma_f32_16x16x32_bf16 v[124:127], a[36:39], a[124:127], v[124:127]
  v_mfma_f32_16x16x32_bf16 v[156:159], a[40:43], a[124:127], v[156:159]
  v_mfma_f32_16x16x32_bf16 v[188:191], a[44:47], a[124:127], v[188:191]
  v_mfma_f32_16x16x32_bf16 v[220:223], a[48:51], a[124:127], v[220:223]
  v_mfma_f32_16x16x32_bf16 v[252:255], a[52:55], a[124:127], v[252:255]
  v_mfma_f32_16x16x32_bf16 a[156:159], a[56:59], a[124:127], a[156:159]
  v_mfma_f32_16x16x32_bf16 a[188:191], a[60:63], a[124:127], a[188:191]
  s_waitcnt lgkmcnt(0)
  v_mfma_f32_16x16x32_bf16 v[64:67], a[0:3], a[64:67], v[64:67]
  s_mov_b32 m0, s68
  ds_read_b128 a[32:35], v17 offset:0
  v_mfma_f32_16x16x32_bf16 v[96:99], a[4:7], a[64:67], v[96:99]
  buffer_load_dwordx4 v8, s[20:23], s28 offen offset:0 lds
  v_mfma_f32_16x16x32_bf16 v[128:131], a[8:11], a[64:67], v[128:131]
  ds_read_b64_tr_b16 a[96:97], v18 offset:4096
  v_mfma_f32_16x16x32_bf16 v[160:163], a[12:15], a[64:67], v[160:163]
  v_mfma_f32_16x16x32_bf16 v[192:195], a[16:19], a[64:67], v[192:195]
  ds_read_b64_tr_b16 a[98:99], v18 offset:6144
  v_mfma_f32_16x16x32_bf16 v[224:227], a[20:23], a[64:67], v[224:227]
  v_mfma_f32_16x16x32_bf16 a[128:131], a[24:27], a[64:67], a[128:131]
  ds_read_b128 a[36:39], v17 offset:2048
  v_mfma_f32_16x16x32_bf16 a[160:163], a[28:31], a[64:67], a[160:163]
  buffer_load_dwordx4 v9, s[20:23], s28 offen offset:1024 lds
  v_mfma_f32_16x16x32_bf16 v[68:71], a[0:3], a[68:71], v[68:71]
  v_mfma_f32_16x16x32_bf16 v[100:103], a[4:7], a[68:71], v[100:103]
  ds_read_b128 a[40:43], v17 offset:4096
  v_mfma_f32_16x16x32_bf16 v[132:135], a[8:11], a[68:71], v[132:135]
  v_mfma_f32_16x16x32_bf16 v[164:167], a[12:15], a[68:71], v[164:167]
  ds_read_b128 a[44:47], v17 offset:6144
  v_mfma_f32_16x16x32_bf16 v[196:199], a[16:19], a[68:71], v[196:199]
  v_mfma_f32_16x16x32_bf16 v[228:231], a[20:23], a[68:71], v[228:231]
  ds_read_b128 a[48:51], v17 offset:8192
  v_mfma_f32_16x16x32_bf16 a[132:135], a[24:27], a[68:71], a[132:135]
  buffer_load_dwordx4 v10, s[20:23], s28 offen offset:2048 lds
  v_mfma_f32_16x16x32_bf16 a[164:167], a[28:31], a[68:71], a[164:167]
  ds_read_b128 a[52:55], v17 offset:10240
  v_mfma_f32_16x16x32_bf16 v[72:75], a[0:3], a[72:75], v[72:75]
  v_mfma_f32_16x16x32_bf16 v[104:107], a[4:7], a[72:75], v[104:107]
  v_mfma_f32_16x16x32_bf16 v[136:139], a[8:11], a[72:75], v[136:139]
  ds_read_b128 a[56:59], v17 offset:12288
  v_mfma_f32_16x16x32_bf16 v[168:171], a[12:15], a[72:75], v[168:171]
  v_mfma_f32_16x16x32_bf16 v[200:203], a[16:19], a[72:75], v[200:203]
  ds_read_b128 a[60:63], v17 offset:14336
  v_mfma_f32_16x16x32_bf16 v[232:235], a[20:23], a[72:75], v[232:235]
  buffer_load_dwordx4 v11, s[20:23], s28 offen offset:3072 lds
  v_mfma_f32_16x16x32_bf16 a[136:139], a[24:27], a[72:75], a[136:139]
  s_bfe_u32 s56, 0x302010e, s55
  s_add_u32 s54, s54, s56
  s_add_u32 s55, s55, 8
  v_mfma_f32_16x16x32_bf16 a[168:171], a[28:31], a[72:75], a[168:171]
  s_and_b32 s55, s55, 0x8001f
  s_and_b32 s54, s54, 15
  s_lshl_b32 s28, s54, 19
  v_mfma_f32_16x16x32_bf16 v[76:79], a[0:3], a[76:79], v[76:79]
  s_add_u32 m0, s68, 16384
  ds_read_b64_tr_b16 a[100:101], v19 offset:4096
  ds_read_b64_tr_b16 a[102:103], v19 offset:6144
  v_mfma_f32_16x16x32_bf16 v[108:111], a[4:7], a[76:79], v[108:111]
  s_add_u32 s36, s36, s38
  v_mfma_f32_16x16x32_bf16 v[140:143], a[8:11], a[76:79], v[140:143]
  s_add_u32 s37, s37, 1
  v_mfma_f32_16x16x32_bf16 v[172:175], a[12:15], a[76:79], v[172:175]
  ds_read_b64_tr_b16 a[104:105], v20 offset:4096
  v_mfma_f32_16x16x32_bf16 v[204:207], a[16:19], a[76:79], v[204:207]
  buffer_load_dwordx4 v8, s[20:23], s28 offen offset:0 lds
  v_mfma_f32_16x16x32_bf16 v[236:239], a[20:23], a[76:79], v[236:239]
  ds_read_b64_tr_b16 a[106:107], v20 offset:6144
  v_mfma_f32_16x16x32_bf16 a[140:143], a[24:27], a[76:79], a[140:143]
  s_cmp_eq_u32 s37, 3
  s_cselect_b32 s37, 0, s37
  s_cselect_b32 s38, s39, s40
  v_mfma_f32_16x16x32_bf16 a[172:175], a[28:31], a[76:79], a[172:175]
  s_add_u32 s41, s41, s43
  ds_read_b64_tr_b16 a[108:109], v21 offset:4096
  v_mfma_f32_16x16x32_bf16 v[80:83], a[0:3], a[80:83], v[80:83]
  s_sub_u32 s43, 0, s43
  v_mfma_f32_16x16x32_bf16 v[112:115], a[4:7], a[80:83], v[112:115]
  ds_read_b64_tr_b16 a[110:111], v21 offset:6144
  v_mfma_f32_16x16x32_bf16 v[144:147], a[8:11], a[80:83], v[144:147]
  v_mfma_f32_16x16x32_bf16 v[176:179], a[12:15], a[80:83], v[176:179]
  buffer_load_dwordx4 v9, s[20:23], s28 offen offset:1024 lds
  v_mfma_f32_16x16x32_bf16 v[208:211], a[16:19], a[80:83], v[208:211]
  ds_read_b64_tr_b16 a[112:113], v18 offset:12288
  v_mfma_f32_16x16x32_bf16 v[240:243], a[20:23], a[80:83], v[240:243]
  v_mfma_f32_16x16x32_bf16 a[144:147], a[24:27], a[80:83], a[144:147]
  ds_read_b64_tr_b16 a[114:115], v18 offset:14336
  v_mfma_f32_16x16x32_bf16 a[176:179], a[28:31], a[80:83], a[176:179]
  v_mfma_f32_16x16x32_bf16 v[84:87], a[0:3], a[84:87], v[84:87]
  ds_read_b64_tr_b16 a[116:117], v19 offset:12288
  v_mfma_f32_16x16x32_bf16 v[116:119], a[4:7], a[84:87], v[116:119]
  v_mfma_f32_16x16x32_bf16 v[148:151], a[8:11], a[84:87], v[148:151]
  buffer_load_dwordx4 v10, s[20:23], s28 offen offset:2048 lds
  v_mfma_f32_16x16x32_bf16 v[180:183], a[12:15], a[84:87], v[180:183]
  ds_read_b64_tr_b16 a[118:119], v19 offset:14336
  v_mfma_f32_16x16x32_bf16 v[212:215], a[16:19], a[84:87], v[212:215]
  v_mfma_f32_16x16x32_bf16 v[244:247], a[20:23], a[84:87], v[244:247]
  ds_read_b64_tr_b16 a[120:121], v20 offset:12288
  v_mfma_f32_16x16x32_bf16 a[148:151], a[24:27], a[84:87], a[148:151]
  v_mfma_f32_16x16x32_bf16 a[180:183], a[28:31], a[84:87], a[180:183]
  ds_read_b64_tr_b16 a[122:123], v20 offset:14336
  v_mfma_f32_16x16x32_bf16 v[88:91], a[0:3], a[88:91], v[88:91]
  v_mfma_f32_16x16x32_bf16 v[120:123], a[4:7], a[88:91], v[120:123]
  buffer_load_dwordx4 v11, s[20:23], s28 offen offset:3072 lds
  v_mfma_f32_16x16x32_bf16 v[152:155], a[8:11], a[88:91], v[152:155]
  s_bfe_u32 s56, 0x302010e, s55
  ds_read_b64_tr_b16 a[124:125], v21 offset:12288
  v_mfma_f32_16x16x32_bf16 v[184:187], a[12:15], a[88:91], v[184:187]
  s_add_u32 s54, s54, s56
  ds_read_b64_tr_b16 a[126:127], v21 offset:14336
  v_mfma_f32_16x16x32_bf16 v[216:219], a[16:19], a[88:91], v[216:219]
  s_add_u32 s55, s55, 8
  v_add_u32 v16, s38, v16
  v_add_u32 v17, s38, v17
  v_mfma_f32_16x16x32_bf16 v[248:251], a[20:23], a[88:91], v[248:251]
  s_and_b32 s55, s55, 0x8001f
  v_add_u32 v18, s43, v18
  v_add_u32 v19, s43, v19
  v_mfma_f32_16x16x32_bf16 a[152:155], a[24:27], a[88:91], a[152:155]
  s_and_b32 s54, s54, 15
  v_add_u32 v20, s43, v20
  v_add_u32 v21, s43, v21
  v_mfma_f32_16x16x32_bf16 a[184:187], a[28:31], a[88:91], a[184:187]
  s_lshl_b32 s28, s54, 19
  v_mfma_f32_16x16x32_bf16 v[92:95], a[0:3], a[92:95], v[92:95]
  v_mfma_f32_16x16x32_bf16 v[124:127], a[4:7], a[92:95], v[124:127]
  v_mfma_f32_16x16x32_bf16 v[156:159], a[8:11], a[92:95], v[156:159]
  v_mfma_f32_16x16x32_bf16 v[188:191], a[12:15], a[92:95], v[188:191]
  v_mfma_f32_16x16x32_bf16 v[220:223], a[16:19], a[92:95], v[220:223]
  v_mfma_f32_16x16x32_bf16 v[252:255], a[20:23], a[92:95], v[252:255]
  v_mfma_f32_16x16x32_bf16 a[156:159], a[24:27], a[92:95], a[156:159]
  v_mfma_f32_16x16x32_bf16 a[188:191], a[28:31], a[92:95], a[188:191]
  s_waitcnt vmcnt(8) lgkmcnt(0)
  s_barrier
  v_mfma_f32_16x16x32_bf16 v[64:67], a[32:35], a[96:99], v[64:67]
  s_mov_b32 m0, s88
  ds_read_b128 a[0:3], v16 offset:0
  v_mfma_f32_16x16x32_bf16 v[96:99], a[36:39], a[96:99], v[96:99]
  buffer_load_dwordx4 v4, s[8:11], s26 offen offset:0 lds
  v_mfma_f32_16x16x32_bf16 v[128:131], a[40:43], a[96:99], v[128:131]
  ds_read_b64_tr_b16 a[64:65], v18 offset:0
  v_mfma_f32_16x16x32_bf16 v[160:163], a[44:47], a[96:99], v[160:163]
  v_mfma_f32_16x16x32_bf16 v[192:195], a[48:51], a[96:99], v[192:195]
  ds_read_b64_tr_b16 a[66:67], v18 offset:2048
  v_mfma_f32_16x16x32_bf16 v[224:227], a[52:55], a[96:99], v[224:227]
  v_mfma_f32_16x16x32_bf16 a[128:131], a[56:59], a[96:99], a[128:131]
  ds_read_b128 a[4:7], v16 offset:2048
  v_mfma_f32_16x16x32_bf16 a[160:163], a[60:63], a[96:99], a[160:163]
  buffer_load_dwordx4 v5, s[8:11], s26 offen offset:1024 lds
  v_mfma_f32_16x16x32_bf16 v[68:71], a[32:35], a[100:103], v[68:71]
  v_mfma_f32_16x16x32_bf16 v[100:103], a[36:39], a[100:103], v[100:103]
  ds_read_b128 a[8:11], v16 offset:4096
  v_mfma_f32_16x16x32_bf16 v[132:135], a[40:43], a[100:103], v[132:135]
  v_mfma_f32_16x16x32_bf16 v[164:167], a[44:47], a[100:103], v[164:167]
  ds_read_b128 a[12:15], v16 offset:6144
  v_mfma_f32_16x16x32_bf16 v[196:199], a[48:51], a[100:103], v[196:199]
  v_mfma_f32_16x16x32_bf16 v[228:231], a[52:55], a[100:103], v[228:231]
  ds_read_b128 a[16:19], v16 offset:8192
  v_mfma_f32_16x16x32_bf16 a[132:135], a[56:59], a[100:103], a[132:135]
  v_mfma_f32_16x16x32_bf16 a[164:167], a[60:63], a[100:103], a[164:167]
  buffer_load_dwordx4 v6, s[8:11], s26 offen offset:2048 lds
  v_mfma_f32_16x16x32_bf16 v[72:75], a[32:35], a[104:107], v[72:75]
  ds_read_b128 a[20:23], v16 offset:10240
  v_mfma_f32_16x16x32_bf16 v[104:107], a[36:39], a[104:107], v[104:107]
  v_mfma_f32_16x16x32_bf16 v[136:139], a[40:43], a[104:107], v[136:139]
  ds_read_b128 a[24:27], v16 offset:12288
  v_mfma_f32_16x16x32_bf16 v[168:171], a[44:47], a[104:107], v[168:171]
  v_mfma_f32_16x16x32_bf16 v[200:203], a[48:51], a[104:107], v[200:203]
  ds_read_b128 a[28:31], v16 offset:14336
  v_mfma_f32_16x16x32_bf16 v[232:235], a[52:55], a[104:107], v[232:235]
  v_mfma_f32_16x16x32_bf16 a[136:139], a[56:59], a[104:107], a[136:139]
  ds_read_b64_tr_b16 a[68:69], v19 offset:0
  v_mfma_f32_16x16x32_bf16 a[168:171], a[60:63], a[104:107], a[168:171]
  buffer_load_dwordx4 v7, s[8:11], s26 offen offset:3072 lds
  v_mfma_f32_16x16x32_bf16 v[76:79], a[32:35], a[108:111], v[76:79]
  s_add_u32 m0, s88, 4096
  ds_read_b64_tr_b16 a[70:71], v19 offset:2048
  v_mfma_f32_16x16x32_bf16 v[108:111], a[36:39], a[108:111], v[108:111]
  v_mfma_f32_16x16x32_bf16 v[140:143], a[40:43], a[108:111], v[140:143]
  v_mfma_f32_16x16x32_bf16 v[172:175], a[44:47], a[108:111], v[172:175]
  ds_read_b64_tr_b16 a[72:73], v20 offset:0
  v_mfma_f32_16x16x32_bf16 v[204:207], a[48:51], a[108:111], v[204:207]
  v_mfma_f32_16x16x32_bf16 v[236:239], a[52:55], a[108:111], v[236:239]
  ds_read_b64_tr_b16 a[74:75], v20 offset:2048
  v_mfma_f32_16x16x32_bf16 a[140:143], a[56:59], a[108:111], a[140:143]
  v_mfma_f32_16x16x32_bf16 a[172:175], a[60:63], a[108:111], a[172:175]
  buffer_load_dwordx4 v4, s[8:11], s27 offen offset:0 lds
  v_mfma_f32_16x16x32_bf16 v[80:83], a[32:35], a[112:115], v[80:83]
  ds_read_b64_tr_b16 a[76:77], v21 offset:0
  v_mfma_f32_16x16x32_bf16 v[112:115], a[36:39], a[112:115], v[112:115]
  ds_read_b64_tr_b16 a[78:79], v21 offset:2048
  v_mfma_f32_16x16x32_bf16 v[144:147], a[40:43], a[112:115], v[144:147]
  v_mfma_f32_16x16x32_bf16 v[176:179], a[44:47], a[112:115], v[176:179]
  v_mfma_f32_16x16x32_bf16 v[208:211], a[48:51], a[112:115], v[208:211]
  ds_read_b64_tr_b16 a[80:81], v18 offset:8192
  v_mfma_f32_16x16x32_bf16 v[240:243], a[52:55], a[112:115], v[240:243]
  v_mfma_f32_16x16x32_bf16 a[144:147], a[56:59], a[112:115], a[144:147]
  ds_read_b64_tr_b16 a[82:83], v18 offset:10240
  v_mfma_f32_16x16x32_bf16 a[176:179], a[60:63], a[112:115], a[176:179]
  buffer_load_dwordx4 v5, s[8:11], s27 offen offset:1024 lds
  v_mfma_f32_16x16x32_bf16 v[84:87], a[32:35], a[116:119], v[84:87]
  ds_read_b64_tr_b16 a[84:85], v19 offset:8192
  v_mfma_f32_16x16x32_bf16 v[116:119], a[36:39], a[116:119], v[116:119]
  v_mfma_f32_16x16x32_bf16 v[148:151], a[40:43], a[116:119], v[148:151]
  ds_read_b64_tr_b16 a[86:87], v19 offset:10240
  v_mfma_f32_16x16x32_bf16 v[180:183], a[44:47], a[116:119], v[180:183]
  v_mfma_f32_16x16x32_bf16 v[212:215], a[48:51], a[116:119], v[212:215]
  v_mfma_f32_16x16x32_bf16 v[244:247], a[52:55], a[116:119], v[244:247]
  ds_read_b64_tr_b16 a[88:89], v20 offset:8192
  v_mfma_f32_16x16x32_bf16 a[148:151], a[56:59], a[116:119], a[148:151]
  v_mfma_f32_16x16x32_bf16 a[180:183], a[60:63], a[116:119], a[180:183]
  buffer_load_dwordx4 v6, s[8:11], s27 offen offset:2048 lds
  v_mfma_f32_16x16x32_bf16 v[88:91], a[32:35], a[120:123], v[88:91]
  ds_read_b64_tr_b16 a[90:91], v20 offset:10240
  v_mfma_f32_16x16x32_bf16 v[120:123], a[36:39], a[120:123], v[120:123]
  ds_read_b64_tr_b16 a[92:93], v21 offset:8192
  v_mfma_f32_16x16x32_bf16 v[152:155], a[40:43], a[120:123], v[152:155]
  v_mfma_f32_16x16x32_bf16 v[184:187], a[44:47], a[120:123], v[184:187]
  ds_read_b64_tr_b16 a[94:95], v21 offset:10240
  v_mfma_f32_16x16x32_bf16 v[216:219], a[48:51], a[120:123], v[216:219]
  v_mfma_f32_16x16x32_bf16 v[248:251], a[52:55], a[120:123], v[248:251]
  v_mfma_f32_16x16x32_bf16 a[152:155], a[56:59], a[120:123], a[152:155]
  v_mfma_f32_16x16x32_bf16 a[184:187], a[60:63], a[120:123], a[184:187]
  buffer_load_dwordx4 v7, s[8:11], s27 offen offset:3072 lds
  v_mfma_f32_16x16x32_bf16 v[92:95], a[32:35], a[124:127], v[92:95]
  s_bfe_u32 s29, 0x302010e, s53
  v_mfma_f32_16x16x32_bf16 v[124:127], a[36:39], a[124:127], v[124:127]
  s_add_u32 s52, s52, s29
  v_mfma_f32_16x16x32_bf16 v[156:159], a[40:43], a[124:127], v[156:159]
  s_add_u32 s53, s53, 8
  v_mfma_f32_16x16x32_bf16 v[188:191], a[44:47], a[124:127], v[188:191]
  s_and_b32 s53, s53, 0x8001f
  v_mfma_f32_16x16x32_bf16 v[220:223], a[48:51], a[124:127], v[220:223]
  s_and_b32 s52, s52, 15
  v_mfma_f32_16x16x32_bf16 v[252:255], a[52:55], a[124:127], v[252:255]
  s_lshl_b32 s29, s52, 7
  v_mfma_f32_16x16x32_bf16 a[156:159], a[56:59], a[124:127], a[156:159]
  s_or_b32 s26, s30, s29
  v_mfma_f32_16x16x32_bf16 a[188:191], a[60:63], a[124:127], a[188:191]
  s_or_b32 s27, s31, s29
  s_waitcnt lgkmcnt(0)
  v_mfma_f32_16x16x32_bf16 v[128:131], a[8:11], a[64:67], v[128:131]
  ds_read_b128 a[32:35], v17 offset:0
  ds_read_b64_tr_b16 a[96:97], v18 offset:4096
  v_mfma_f32_16x16x32_bf16 v[160:163], a[12:15], a[64:67], v[160:163]
  ds_read_b64_tr_b16 a[98:99], v18 offset:6144
  ds_read_b128 a[36:39], v17 offset:2048
  v_mfma_f32_16x16x32_bf16 v[132:135], a[8:11], a[68:71], v[132:135]
  ds_read_b128 a[40:43], v17 offset:4096
  ds_read_b128 a[44:47], v17 offset:6144
  v_mfma_f32_16x16x32_bf16 v[164:167], a[12:15], a[68:71], v[164:167]
  ds_read_b128 a[48:51], v17 offset:8192
  ds_read_b128 a[52:55], v17 offset:10240
  v_mfma_f32_16x16x32_bf16 v[136:139], a[8:11], a[72:75], v[136:139]
  ds_read_b128 a[56:59], v17 offset:12288
  ds_read_b128 a[60:63], v17 offset:14336
  v_mfma_f32_16x16x32_bf16 v[168:171], a[12:15], a[72:75], v[168:171]
  ds_read_b64_tr_b16 a[100:101], v19 offset:4096
  ds_read_b64_tr_b16 a[102:103], v19 offset:6144
  v_mfma_f32_16x16x32_bf16 v[140:143], a[8:11], a[76:79], v[140:143]
  ds_read_b64_tr_b16 a[104:105], v20 offset:4096
  v_mfma_f32_16x16x32_bf16 v[172:175], a[12:15], a[76:79], v[172:175]
  ds_read_b64_tr_b16 a[106:107], v20 offset:6144
  ds_read_b64_tr_b16 a[108:109], v21 offset:4096
  v_mfma_f32_16x16x32_bf16 v[144:147], a[8:11], a[80:83], v[144:147]
  ds_read_b64_tr_b16 a[110:111], v21 offset:6144
  ds_read_b64_tr_b16 a[112:113], v18 offset:12288
  v_mfma_f32_16x16x32_bf16 v[176:179], a[12:15], a[80:83], v[176:179]
  ds_read_b64_tr_b16 a[114:115], v18 offset:14336
  ds_read_b64_tr_b16 a[116:117], v19 offset:12288
  v_mfma_f32_16x16x32_bf16 v[148:151], a[8:11], a[84:87], v[148:151]
  ds_read_b64_tr_b16 a[118:119], v19 offset:14336
  ds_read_b64_tr_b16 a[120:121], v20 offset:12288
  v_mfma_f32_16x16x32_bf16 v[180:183], a[12:15], a[84:87], v[180:183]
  ds_read_b64_tr_b16 a[122:123], v20 offset:14336
  ds_read_b64_tr_b16 a[124:125], v21 offset:12288
  v_mfma_f32_16x16x32_bf16 v[152:155], a[8:11], a[88:91], v[152:155]
  ds_read_b64_tr_b16 a[126:127], v21 offset:14336
  v_mfma_f32_16x16x32_bf16 v[184:187], a[12:15], a[88:91], v[184:187]
  v_mfma_f32_16x16x32_bf16 v[156:159], a[8:11], a[92:95], v[156:159]
  v_mfma_f32_16x16x32_bf16 v[188:191], a[12:15], a[92:95], v[188:191]
  v_mfma_f32_16x16x32_bf16 v[192:195], a[16:19], a[64:67], v[192:195]
  v_mfma_f32_16x16x32_bf16 v[224:227], a[20:23], a[64:67], v[224:227]
  s_waitcnt lgkmcnt(0)
  s_barrier
  s_mov_b32 s12, s84
  s_mov_b32 s13, s85
  s_mov_b32 s14, 256
  s_mov_b32 s15, 0x00020000
  buffer_load_dwordx2 v[22:23], off, s[12:15], 0 sc1
  v_mfma_f32_16x16x32_bf16 v[128:131], a[40:43], a[96:99], v[128:131]
  s_add_u32 m0, s88, 32768
  v_mfma_f32_16x16x32_bf16 v[160:163], a[44:47], a[96:99], v[160:163]
  buffer_load_dwordx4 v4, s[8:11], s26 offen offset:0 lds
  v_mfma_f32_16x16x32_bf16 v[132:135], a[40:43], a[100:103], v[132:135]
  v_mfma_f32_16x16x32_bf16 v[164:167], a[44:47], a[100:103], v[164:167]
  v_mfma_f32_16x16x32_bf16 v[136:139], a[40:43], a[104:107], v[136:139]
  v_mfma_f32_16x16x32_bf16 v[168:171], a[44:47], a[104:107], v[168:171]
  buffer_load_dwordx4 v5, s[8:11], s26 offen offset:1024 lds
  v_cvt_pk_bf16_f32 v128, v128, v129
  v_mfma_f32_16x16x32_bf16 v[140:143], a[40:43], a[108:111], v[140:143]
  v_cvt_pk_bf16_f32 v129, v130, v131
  v_cvt_pk_bf16_f32 v130, v160, v161
  v_mfma_f32_16x16x32_bf16 v[172:175], a[44:47], a[108:111], v[172:175]
  v_cvt_pk_bf16_f32 v131, v162, v163
  v_cvt_pk_bf16_f32 v132, v132, v133
  v_mfma_f32_16x16x32_bf16 v[144:147], a[40:43], a[112:115], v[144:147]
  v_cvt_pk_bf16_f32 v133, v134, v135
  v_cvt_pk_bf16_f32 v134, v164, v165
  v_mfma_f32_16x16x32_bf16 v[176:179], a[44:47], a[112:115], v[176:179]
  v_cvt_pk_bf16_f32 v135, v166, v167
  v_mfma_f32_16x16x32_bf16 v[148:151], a[40:43], a[116:119], v[148:151]
  buffer_load_dwordx4 v6, s[8:11], s26 offen offset:2048 lds
  v_mfma_f32_16x16x32_bf16 v[180:183], a[44:47], a[116:119], v[180:183]
  s_add_u32 s60, s63, 8192
  buffer_store_dwordx4 v[128:131], v2, s[16:19], s60 offen offset:0 sc1
  v_cvt_pk_bf16_f32 v136, v136, v137
  v_mfma_f32_16x16x32_bf16 v[152:155], a[40:43], a[120:123], v[152:155]
  v_cvt_pk_bf16_f32 v137, v138, v139
  v_cvt_pk_bf16_f32 v138, v168, v169
  v_mfma_f32_16x16x32_bf16 v[184:187], a[44:47], a[120:123], v[184:187]
  v_cvt_pk_bf16_f32 v139, v170, v171
  v_cvt_pk_bf16_f32 v140, v140, v141
  v_mfma_f32_16x16x32_bf16 v[156:159], a[40:43], a[124:127], v[156:159]
  v_cvt_pk_bf16_f32 v141, v142, v143
  v_cvt_pk_bf16_f32 v142, v172, v173
  v_mfma_f32_16x16x32_bf16 v[188:191], a[44:47], a[124:127], v[188:191]
  v_cvt_pk_bf16_f32 v143, v174, v175
  v_cvt_pk_bf16_f32 v144, v144, v145
  v_mfma_f32_16x16x32_bf16 v[192:195], a[48:51], a[96:99], v[192:195]
  buffer_load_dwordx4 v7, s[8:11], s26 offen offset:3072 lds
  v_cvt_pk_bf16_f32 v145, v146, v147
  v_mfma_f32_16x16x32_bf16 v[224:227], a[52:55], a[96:99], v[224:227]
  s_add_u32 m0, s88, 36864
  v_cvt_pk_bf16_f32 v146, v176, v177
  v_cvt_pk_bf16_f32 v147, v178, v179
  v_mfma_f32_16x16x32_bf16 a[128:131], a[24:27], a[64:67], a[128:131]
  s_add_u32 s60, s63, 8192
  buffer_store_dwordx4 v[132:135], v2, s[16:19], s60 offen offset:1024 sc1
  v_cvt_pk_bf16_f32 v148, v148, v149
  v_mfma_f32_16x16x32_bf16 a[160:163], a[28:31], a[64:67], a[160:163]
  v_cvt_pk_bf16_f32 v149, v150, v151
  v_cvt_pk_bf16_f32 v150, v180, v181
  v_mfma_f32_16x16x32_bf16 a[128:131], a[56:59], a[96:99], a[128:131]
  v_cvt_pk_bf16_f32 v151, v182, v183
  v_cvt_pk_bf16_f32 v152, v152, v153
  v_mfma_f32_16x16x32_bf16 a[160:163], a[60:63], a[96:99], a[160:163]
  buffer_load_dwordx4 v4, s[8:11], s27 offen offset:0 lds
  v_cvt_pk_bf16_f32 v153, v154, v155
  v_mfma_f32_16x16x32_bf16 v[196:199], a[16:19], a[68:71], v[196:199]
  v_cvt_pk_bf16_f32 v154, v184, v185
  v_cvt_pk_bf16_f32 v155, v186, v187
  v_mfma_f32_16x16x32_bf16 v[228:231], a[20:23], a[68:71], v[228:231]
  v_cvt_pk_bf16_f32 v156, v156, v157
  v_cvt_pk_bf16_f32 v157, v158, v159
  v_mfma_f32_16x16x32_bf16 v[196:199], a[48:51], a[100:103], v[196:199]
  v_cvt_pk_bf16_f32 v158, v188, v189
  v_cvt_pk_bf16_f32 v159, v190, v191
  v_mfma_f32_16x16x32_bf16 v[228:231], a[52:55], a[100:103], v[228:231]
  v_cvt_pk_bf16_f32 v192, v192, v193
  v_cvt_pk_bf16_f32 v193, v194, v195
  v_mfma_f32_16x16x32_bf16 a[132:135], a[24:27], a[68:71], a[132:135]
  v_cvt_pk_bf16_f32 v194, v224, v225
  v_cvt_pk_bf16_f32 v195, v226, v227
  v_mfma_f32_16x16x32_bf16 a[164:167], a[28:31], a[68:71], a[164:167]
  buffer_load_dwordx4 v5, s[8:11], s27 offen offset:1024 lds
  v_mfma_f32_16x16x32_bf16 a[132:135], a[56:59], a[100:103], a[132:135]
  s_add_u32 s60, s63, 8192
  buffer_store_dwordx4 v[136:139], v2, s[16:19], s60 offen offset:2048 sc1
  v_accvgpr_read_b32 v24, a128
  v_mfma_f32_16x16x32_bf16 a[164:167], a[60:63], a[100:103], a[164:167]
  v_accvgpr_read_b32 v25, a129
  v_accvgpr_read_b32 v26, a130
  v_mfma_f32_16x16x32_bf16 v[200:203], a[16:19], a[72:75], v[200:203]
  v_accvgpr_read_b32 v27, a131
  v_accvgpr_read_b32 v28, a160
  v_mfma_f32_16x16x32_bf16 v[232:235], a[20:23], a[72:75], v[232:235]
  v_accvgpr_read_b32 v29, a161
  v_accvgpr_read_b32 v30, a162
  v_mfma_f32_16x16x32_bf16 v[200:203], a[48:51], a[104:107], v[200:203]
  buffer_load_dwordx4 v6, s[8:11], s27 offen offset:2048 lds
  v_accvgpr_read_b32 v31, a163
  v_mfma_f32_16x16x32_bf16 v[232:235], a[52:55], a[104:107], v[232:235]
  v_cvt_pk_bf16_f32 v224, v24, v25
  v_cvt_pk_bf16_f32 v225, v26, v27
  v_mfma_f32_16x16x32_bf16 a[136:139], a[24:27], a[72:75], a[136:139]
  v_cvt_pk_bf16_f32 v226, v28, v29
  v_cvt_pk_bf16_f32 v227, v30, v31
  v_mfma_f32_16x16x32_bf16 a[168:171], a[28:31], a[72:75], a[168:171]
  v_cvt_pk_bf16_f32 v196, v196, v197
  v_cvt_pk_bf16_f32 v197, v198, v199
  v_mfma_f32_16x16x32_bf16 a[136:139], a[56:59], a[104:107], a[136:139]
  v_cvt_pk_bf16_f32 v198, v228, v229
  v_cvt_pk_bf16_f32 v199, v230, v231
  v_mfma_f32_16x16x32_bf16 a[168:171], a[60:63], a[104:107], a[168:171]
  v_accvgpr_read_b32 v32, a132
  v_accvgpr_read_b32 v33, a133
  v_mfma_f32_16x16x32_bf16 v[204:207], a[16:19], a[76:79], v[204:207]
  buffer_load_dwordx4 v7, s[8:11], s27 offen offset:3072 lds
  v_accvgpr_read_b32 v34, a134
  v_mfma_f32_16x16x32_bf16 v[236:239], a[20:23], a[76:79], v[236:239]
  s_bfe_u32 s29, 0x302010e, s53
  s_add_u32 s52, s52, s29
  s_add_u32 s53, s53, 8
  v_mfma_f32_16x16x32_bf16 v[204:207], a[48:51], a[108:111], v[204:207]
  s_and_b32 s53, s53, 0x8001f
  s_and_b32 s52, s52, 15
  s_lshl_b32 s29, s52, 7
  v_mfma_f32_16x16x32_bf16 v[236:239], a[52:55], a[108:111], v[236:239]
  s_or_b32 s26, s30, s29
  s_or_b32 s27, s31, s29
  s_add_u32 m0, s68, 32768
  v_mfma_f32_16x16x32_bf16 a[140:143], a[24:27], a[76:79], a[140:143]
  v_accvgpr_read_b32 v35, a135
  v_accvgpr_read_b32 v36, a164
  v_mfma_f32_16x16x32_bf16 a[172:175], a[28:31], a[76:79], a[172:175]
  buffer_load_dwordx4 v8, s[20:23], s28 offen offset:0 lds
  v_accvgpr_read_b32 v37, a165
  v_mfma_f32_16x16x32_bf16 a[140:143], a[56:59], a[108:111], a[140:143]
  v_accvgpr_read_b32 v38, a166
  v_accvgpr_read_b32 v39, a167
  v_mfma_f32_16x16x32_bf16 a[172:175], a[60:63], a[108:111], a[172:175]
  v_cvt_pk_bf16_f32 v228, v32, v33
  v_cvt_pk_bf16_f32 v229, v34, v35
  v_mfma_f32_16x16x32_bf16 v[208:211], a[16:19], a[80:83], v[208:211]
  v_cvt_pk_bf16_f32 v230, v36, v37
  v_cvt_pk_bf16_f32 v231, v38, v39
  v_mfma_f32_16x16x32_bf16 v[240:243], a[20:23], a[80:83], v[240:243]
  s_add_u32 s60, s63, 8192
  buffer_store_dwordx4 v[140:143], v2, s[16:19], s60 offen offset:3072 sc1
  v_cvt_pk_bf16_f32 v200, v200, v201
  v_mfma_f32_16x16x32_bf16 v[208:211], a[48:51], a[112:115], v[208:211]
  v_cvt_pk_bf16_f32 v201, v202, v203
  v_cvt_pk_bf16_f32 v202, v232, v233
  v_mfma_f32_16x16x32_bf16 v[240:243], a[52:55], a[112:115], v[240:243]
  buffer_load_dwordx4 v9, s[20:23], s28 offen offset:1024 lds
  v_cvt_pk_bf16_f32 v203, v234, v235
  v_mfma_f32_16x16x32_bf16 a[144:147], a[24:27], a[80:83], a[144:147]
  v_accvgpr_read_b32 v40, a136
  v_accvgpr_read_b32 v41, a137
  v_mfma_f32_16x16x32_bf16 a[176:179], a[28:31], a[80:83], a[176:179]
  v_accvgpr_read_b32 v42, a138
  v_accvgpr_read_b32 v43, a139
  v_mfma_f32_16x16x32_bf16 a[144:147], a[56:59], a[112:115], a[144:147]
  v_accvgpr_read_b32 v44, a168
  v_accvgpr_read_b32 v45, a169
  v_mfma_f32_16x16x32_bf16 a[176:179], a[60:63], a[112:115], a[176:179]
  v_accvgpr_read_b32 v46, a170
  v_accvgpr_read_b32 v47, a171
  v_mfma_f32_16x16x32_bf16 v[212:215], a[16:19], a[84:87], v[212:215]
  buffer_load_dwordx4 v10, s[20:23], s28 offen offset:2048 lds
  v_cvt_pk_bf16_f32 v232, v40, v41
  v_mfma_f32_16x16x32_bf16 v[244:247], a[20:23], a[84:87], v[244:247]
  v_cvt_pk_bf16_f32 v233, v42, v43
  v_cvt_pk_bf16_f32 v234, v44, v45
  v_mfma_f32_16x16x32_bf16 v[212:215], a[48:51], a[116:119], v[212:215]
  v_cvt_pk_bf16_f32 v235, v46, v47
  v_cvt_pk_bf16_f32 v204, v204, v205
  v_mfma_f32_16x16x32_bf16 v[244:247], a[52:55], a[116:119], v[244:247]
  v_cvt_pk_bf16_f32 v205, v206, v207
  v_cvt_pk_bf16_f32 v206, v236, v237
  v_mfma_f32_16x16x32_bf16 a[148:151], a[24:27], a[84:87], a[148:151]
  v_cvt_pk_bf16_f32 v207, v238, v239
  v_accvgpr_read_b32 v24, a140
  v_mfma_f32_16x16x32_bf16 a[180:183], a[28:31], a[84:87], a[180:183]
  buffer_load_dwordx4 v11, s[20:23], s28 offen offset:3072 lds
  v_accvgpr_read_b32 v25, a141
  v_mfma_f32_16x16x32_bf16 a[148:151], a[56:59], a[116:119], a[148:151]
  s_bfe_u32 s56, 0x302010e, s55
  s_add_u32 s54, s54, s56
  s_add_u32 s55, s55, 8
  v_mfma_f32_16x16x32_bf16 a[180:183], a[60:63], a[116:119], a[180:183]
  s_and_b32 s55, s55, 0x8001f
  s_and_b32 s54, s54, 15
  s_lshl_b32 s28, s54, 19
  v_mfma_f32_16x16x32_bf16 v[216:219], a[16:19], a[88:91], v[216:219]
  s_add_u32 m0, s88, -32768
  v_accvgpr_read_b32 v26, a142
  v_accvgpr_read_b32 v27, a143
  v_mfma_f32_16x16x32_bf16 v[248:251], a[20:23], a[88:91], v[248:251]
  v_accvgpr_read_b32 v28, a172
  v_accvgpr_read_b32 v29, a173
  v_mfma_f32_16x16x32_bf16 v[216:219], a[48:51], a[120:123], v[216:219]
  v_accvgpr_read_b32 v30, a174
  v_accvgpr_read_b32 v31, a175
  v_mfma_f32_16x16x32_bf16 v[248:251], a[52:55], a[120:123], v[248:251]
  buffer_load_dwordx4 v4, s[8:11], s26 offen offset:0 lds
  v_cvt_pk_bf16_f32 v236, v24, v25
  v_mfma_f32_16x16x32_bf16 a[152:155], a[24:27], a[88:91], a[152:155]
  v_cvt_pk_bf16_f32 v237, v26, v27
  v_cvt_pk_bf16_f32 v238, v28, v29
  v_mfma_f32_16x16x32_bf16 a[184:187], a[28:31], a[88:91], a[184:187]
  v_cvt_pk_bf16_f32 v239, v30, v31
  v_mfma_f32_16x16x32_bf16 a[152:155], a[56:59], a[120:123], a[152:155]
  s_add_u32 s60, s63, 12288
  buffer_store_dwordx4 v[144:147], v2, s[16:19], s60 offen offset:0 sc1
  v_cvt_pk_bf16_f32 v208, v208, v209
  v_mfma_f32_16x16x32_bf16 a[184:187], a[60:63], a[120:123], a[184:187]
  v_cvt_pk_bf16_f32 v209, v210, v211
  v_cvt_pk_bf16_f32 v210, v240, v241
  v_mfma_f32_16x16x32_bf16 v[220:223], a[16:19], a[92:95], v[220:223]
  buffer_load_dwordx4 v5, s[8:11], s26 offen offset:1024 lds
  v_cvt_pk_bf16_f32 v211, v242, v243
  v_mfma_f32_16x16x32_bf16 v[252:255], a[20:23], a[92:95], v[252:255]
  v_accvgpr_read_b32 v32, a144
  v_accvgpr_read_b32 v33, a145
  v_mfma_f32_16x16x32_bf16 v[220:223], a[48:51], a[124:127], v[220:223]
  v_accvgpr_read_b32 v34, a146
  v_accvgpr_read_b32 v35, a147
  v_mfma_f32_16x16x32_bf16 v[252:255], a[52:55], a[124:127], v[252:255]
  v_accvgpr_read_b32 v36, a176
  v_accvgpr_read_b32 v37, a177
  v_mfma_f32_16x16x32_bf16 a[156:159], a[24:27], a[92:95], a[156:159]
  v_accvgpr_read_b32 v38, a178
  v_accvgpr_read_b32 v39, a179
  v_mfma_f32_16x16x32_bf16 a[188:191], a[28:31], a[92:95], a[188:191]
  v_cvt_pk_bf16_f32 v240, v32, v33
  v_cvt_pk_bf16_f32 v241, v34, v35
  v_mfma_f32_16x16x32_bf16 a[156:159], a[56:59], a[124:127], a[156:159]
  buffer_load_dwordx4 v6, s[8:11], s26 offen offset:2048 lds
  v_cvt_pk_bf16_f32 v242, v36, v37
  v_mfma_f32_16x16x32_bf16 a[188:191], a[60:63], a[124:127], a[188:191]
  v_cvt_pk_bf16_f32 v243, v38, v39
  v_cvt_pk_bf16_f32 v212, v212, v213
  v_mfma_f32_16x16x32_bf16 v[64:67], a[0:3], a[64:67], v[64:67]
  v_cvt_pk_bf16_f32 v213, v214, v215
  v_cvt_pk_bf16_f32 v214, v244, v245
  v_mfma_f32_16x16x32_bf16 v[96:99], a[4:7], a[64:67], v[96:99]
  v_cvt_pk_bf16_f32 v215, v246, v247
  v_mfma_f32_16x16x32_bf16 v[64:67], a[32:35], a[96:99], v[64:67]
  s_add_u32 s60, s63, 12288
  buffer_store_dwordx4 v[148:151], v2, s[16:19], s60 offen offset:1024 sc1
  v_accvgpr_read_b32 v40, a148
  v_mfma_f32_16x16x32_bf16 v[96:99], a[36:39], a[96:99], v[96:99]
  buffer_load_dwordx4 v7, s[8:11], s26 offen offset:3072 lds
  v_accvgpr_read_b32 v41, a149
  v_mfma_f32_16x16x32_bf16 v[68:71], a[0:3], a[68:71], v[68:71]
  s_add_u32 m0, s88, -28672
  v_accvgpr_read_b32 v42, a150
  v_accvgpr_read_b32 v43, a151
  v_mfma_f32_16x16x32_bf16 v[100:103], a[4:7], a[68:71], v[100:103]
  v_accvgpr_read_b32 v44, a180
  v_accvgpr_read_b32 v45, a181
  v_mfma_f32_16x16x32_bf16 v[68:71], a[32:35], a[100:103], v[68:71]
  v_accvgpr_read_b32 v46, a182
  v_accvgpr_read_b32 v47, a183
  v_mfma_f32_16x16x32_bf16 v[100:103], a[36:39], a[100:103], v[100:103]
  v_cvt_pk_bf16_f32 v244, v40, v41
  v_cvt_pk_bf16_f32 v245, v42, v43
  v_mfma_f32_16x16x32_bf16 v[72:75], a[0:3], a[72:75], v[72:75]
  v_cvt_pk_bf16_f32 v246, v44, v45
  v_cvt_pk_bf16_f32 v247, v46, v47
  v_mfma_f32_16x16x32_bf16 v[104:107], a[4:7], a[72:75], v[104:107]
  buffer_load_dwordx4 v4, s[8:11], s27 offen offset:0 lds
  v_cvt_pk_bf16_f32 v216, v216, v217
  v_mfma_f32_16x16x32_bf16 v[72:75], a[32:35], a[104:107], v[72:75]
  v_cvt_pk_bf16_f32 v217, v218, v219
  v_cvt_pk_bf16_f32 v218, v248, v249
  v_mfma_f32_16x16x32_bf16 v[104:107], a[36:39], a[104:107], v[104:107]
  v_cvt_pk_bf16_f32 v219, v250, v251
  v_accvgpr_read_b32 v24, a152
  v_mfma_f32_16x16x32_bf16 v[76:79], a[0:3], a[76:79], v[76:79]
  v_accvgpr_read_b32 v25, a153
  v_accvgpr_read_b32 v26, a154
  v_mfma_f32_16x16x32_bf16 v[108:111], a[4:7], a[76:79], v[108:111]
  v_accvgpr_read_b32 v27, a155
  v_accvgpr_read_b32 v28, a184
  v_mfma_f32_16x16x32_bf16 v[76:79], a[32:35], a[108:111], v[76:79]
  buffer_load_dwordx4 v5, s[8:11], s27 offen offset:1024 lds
  v_accvgpr_read_b32 v29, a185
  v_mfma_f32_16x16x32_bf16 v[108:111], a[36:39], a[108:111], v[108:111]
  v_accvgpr_read_b32 v30, a186
  v_accvgpr_read_b32 v31, a187
  v_mfma_f32_16x16x32_bf16 v[80:83], a[0:3], a[80:83], v[80:83]
  v_cvt_pk_bf16_f32 v248, v24, v25
  v_cvt_pk_bf16_f32 v249, v26, v27
  v_mfma_f32_16x16x32_bf16 v[112:115], a[4:7], a[80:83], v[112:115]
  v_cvt_pk_bf16_f32 v250, v28, v29
  v_cvt_pk_bf16_f32 v251, v30, v31
  v_mfma_f32_16x16x32_bf16 v[80:83], a[32:35], a[112:115], v[80:83]
  v_cvt_pk_bf16_f32 v220, v220, v221
  v_cvt_pk_bf16_f32 v221, v222, v223
  v_mfma_f32_16x16x32_bf16 v[112:115], a[36:39], a[112:115], v[112:115]
  v_cvt_pk_bf16_f32 v222, v252, v253
  v_cvt_pk_bf16_f32 v223, v254, v255
  v_mfma_f32_16x16x32_bf16 v[84:87], a[0:3], a[84:87], v[84:87]
  buffer_load_dwordx4 v6, s[8:11], s27 offen offset:2048 lds
  v_mfma_f32_16x16x32_bf16 v[116:119], a[4:7], a[84:87], v[116:119]
  s_add_u32 s60, s63, 12288
  buffer_store_dwordx4 v[152:155], v2, s[16:19], s60 offen offset:2048 sc1
  v_accvgpr_read_b32 v32, a156
  v_mfma_f32_16x16x32_bf16 v[84:87], a[32:35], a[116:119], v[84:87]
  v_accvgpr_read_b32 v33, a157
  v_accvgpr_read_b32 v34, a158
  v_mfma_f32_16x16x32_bf16 v[116:119], a[36:39], a[116:119], v[116:119]
  v_accvgpr_read_b32 v35, a159
  v_accvgpr_read_b32 v36, a188
  v_mfma_f32_16x16x32_bf16 v[88:91], a[0:3], a[88:91], v[88:91]
  v_accvgpr_read_b32 v37, a189
  v_accvgpr_read_b32 v38, a190
  v_mfma_f32_16x16x32_bf16 v[120:123], a[4:7], a[88:91], v[120:123]
  buffer_load_dwordx4 v7, s[8:11], s27 offen offset:3072 lds
  v_accvgpr_read_b32 v39, a191
  v_mfma_f32_16x16x32_bf16 v[88:91], a[32:35], a[120:123], v[88:91]
  s_bfe_u32 s29, 0x302010e, s53
  s_add_u32 s52, s52, s29
  s_add_u32 s53, s53, 8
  v_mfma_f32_16x16x32_bf16 v[120:123], a[36:39], a[120:123], v[120:123]
  s_and_b32 s53, s53, 0x8001f
  s_and_b32 s52, s52, 15
  s_lshl_b32 s29, s52, 7
  v_mfma_f32_16x16x32_bf16 v[92:95], a[0:3], a[92:95], v[92:95]
  s_or_b32 s26, s30, s29
  s_or_b32 s27, s31, s29
  v_cvt_pk_bf16_f32 v252, v32, v33
  v_mfma_f32_16x16x32_bf16 v[124:127], a[4:7], a[92:95], v[124:127]
  v_cvt_pk_bf16_f32 v253, v34, v35
  v_cvt_pk_bf16_f32 v254, v36, v37
  v_mfma_f32_16x16x32_bf16 v[92:95], a[32:35], a[124:127], v[92:95]
  v_cvt_pk_bf16_f32 v255, v38, v39
  v_cvt_pk_bf16_f32 v160, v64, v65
  v_mfma_f32_16x16x32_bf16 v[124:127], a[36:39], a[124:127], v[124:127]
  v_cvt_pk_bf16_f32 v161, v66, v67
  v_cvt_pk_bf16_f32 v162, v96, v97
  v_cvt_pk_bf16_f32 v163, v98, v99
  v_cvt_pk_bf16_f32 v164, v68, v69
  v_cvt_pk_bf16_f32 v165, v70, v71
  v_cvt_pk_bf16_f32 v166, v100, v101
  v_cvt_pk_bf16_f32 v167, v102, v103
  s_add_u32 s60, s63, 12288
  buffer_store_dwordx4 v[156:159], v2, s[16:19], s60 offen offset:3072 sc1
  v_cvt_pk_bf16_f32 v168, v72, v73
  v_cvt_pk_bf16_f32 v169, v74, v75
  v_cvt_pk_bf16_f32 v170, v104, v105
  v_cvt_pk_bf16_f32 v171, v106, v107
  v_cvt_pk_bf16_f32 v172, v76, v77
  v_cvt_pk_bf16_f32 v173, v78, v79
  v_cvt_pk_bf16_f32 v174, v108, v109
  v_cvt_pk_bf16_f32 v175, v110, v111
  v_cvt_pk_bf16_f32 v176, v80, v81
  v_cvt_pk_bf16_f32 v177, v82, v83
  v_cvt_pk_bf16_f32 v178, v112, v113
  v_cvt_pk_bf16_f32 v179, v114, v115
  v_cvt_pk_bf16_f32 v180, v84, v85
  v_cvt_pk_bf16_f32 v181, v86, v87
  v_cvt_pk_bf16_f32 v182, v116, v117
  v_cvt_pk_bf16_f32 v183, v118, v119
  v_cvt_pk_bf16_f32 v184, v88, v89
  v_cvt_pk_bf16_f32 v185, v90, v91
  v_cvt_pk_bf16_f32 v186, v120, v121
  v_cvt_pk_bf16_f32 v187, v122, v123
  v_cvt_pk_bf16_f32 v188, v92, v93
  v_cvt_pk_bf16_f32 v189, v94, v95
  v_cvt_pk_bf16_f32 v190, v124, v125
  v_cvt_pk_bf16_f32 v191, v126, v127
  s_lshl_b32 s34, s62, 4
  s_add_u32 s34, s34, s61
  s_lshl_b32 s34, s34, 7
  s_branch Lp3
Lp2:
  s_and_b32 s4, s2, 1
  s_lshl_b32 s4, s4, 2
  s_and_b32 s5, s59, 3
  s_add_u32 s32, s4, s5
  s_bfe_u32 s4, s2, 0x20001
  s_lshl_b32 s4, s4, 2
  s_lshr_b32 s5, s59, 2
  s_add_u32 s33, s4, s5
  s_and_b32 s4, s2, 7
  s_lshl_b32 s4, s4, 1
  s_add_u32 s5, s32, s33
  s_and_b32 s49, s5, 3
  s_lshl_b32 s49, s49, 3
  s_or_b32 s49, s49, 0x80000
  s_bfe_u32 s48, 0xf0f02, s49
  s_add_u32 s48, s48, s4
  s_and_b32 s48, s48, 15
  s_lshl_b32 s46, s48, 7
  s_lshl_b32 s36, s3, 13
  s_mul_i32 s41, s3, 6144
  s_add_u32 s41, s41, 104448
  s_mul_i32 s4, s3, 7168
  s_sub_u32 s50, 32768, s4
  v_lshrrev_b32 v240, 3, v1
  v_and_b32 v241, 6, v240
  v_and_b32 v242, 7, v1
  v_xor_b32 v241, v241, v242
  v_lshlrev_b32 v241, 4, v241
  s_lshl_b32 s4, s3, 6
  s_add_u32 s4, s4, 16
  v_add_u32 v242, s4, v240
  v_lshl_add_u32 v242, v242, 11, v241
  v_add_u32 v224, 0, v242
  v_add_u32 v225, 15360, v242
  v_add_u32 v226, 30720, v242
  v_add_u32 v227, 46080, v242
  v_add_u32 v228, 65536, v242
  v_add_u32 v229, 80896, v242
  v_add_u32 v230, 96256, v242
  v_add_u32 v231, 111616, v242
  s_lshl_b32 s4, s3, 14
  s_cmp_eq_u32 s32, 0
  s_cselect_b32 s4, 0x40000000, s4
  v_lshl_add_u32 v242, v240, 11, v241
  v_add_u32 v232, s4, v242
  v_lshrrev_b32 v242, 2, v240
  v_and_b32 v243, 3, v240
  v_lshl_add_u32 v242, v242, 3, v243
  v_mul_u32_u24 v242, 6144, v242
  v_add_u32 v242, v242, v241
  s_lshl_b32 s4, s33, 7
  v_add_u32 v242, s4, v242
  s_mul_i32 s6, s3, 6
  s_add_u32 s7, s6, 0
  s_bfe_u32 s4, s7, 0x10002
  s_lshl_b32 s4, s4, 5
  s_and_b32 s5, s7, 1
  s_lshl_b32 s5, s5, 4
  s_add_u32 s4, s4, s5
  s_bfe_u32 s5, s7, 0x10001
  s_lshl_b32 s5, s5, 2
  s_add_u32 s4, s4, s5
  s_mul_i32 s4, s4, 6144
  s_lshr_b32 s5, s7, 3
  s_lshl_b32 s5, s5, 11
  s_add_u32 s4, s4, s5
  s_add_u32 s4, s4, 2048
  v_add_u32 v233, s4, v242
  s_add_u32 s7, s6, 1
  s_bfe_u32 s4, s7, 0x10002
  s_lshl_b32 s4, s4, 5
  s_and_b32 s5, s7, 1
  s_lshl_b32 s5, s5, 4
  s_add_u32 s4, s4, s5
  s_bfe_u32 s5, s7, 0x10001
  s_lshl_b32 s5, s5, 2
  s_add_u32 s4, s4, s5
  s_mul_i32 s4, s4, 6144
  s_lshr_b32 s5, s7, 3
  s_lshl_b32 s5, s5, 11
  s_add_u32 s4, s4, s5
  s_add_u32 s4, s4, 1024
  v_add_u32 v234, s4, v242
  s_add_u32 s7, s6, 2
  s_bfe_u32 s4, s7, 0x10002
  s_lshl_b32 s4, s4, 5
  s_and_b32 s5, s7, 1
  s_lshl_b32 s5, s5, 4
  s_add_u32 s4, s4, s5
  s_bfe_u32 s5, s7, 0x10001
  s_lshl_b32 s5, s5, 2
  s_add_u32 s4, s4, s5
  s_mul_i32 s4, s4, 6144
  s_lshr_b32 s5, s7, 3
  s_lshl_b32 s5, s5, 11
  s_add_u32 s4, s4, s5
  s_add_u32 s4, s4, 0
  v_add_u32 v235, s4, v242
  s_add_u32 s7, s6, 3
  s_bfe_u32 s4, s7, 0x10002
  s_lshl_b32 s4, s4, 5
  s_and_b32 s5, s7, 1
  s_lshl_b32 s5, s5, 4
  s_add_u32 s4, s4, s5
  s_bfe_u32 s5, s7, 0x10001
  s_lshl_b32 s5, s5, 2
  s_add_u32 s4, s4, s5
  s_mul_i32 s4, s4, 6144
  s_lshr_b32 s5, s7, 3
  s_lshl_b32 s5, s5, 11
  s_add_u32 s4, s4, s5
  s_add_u32 s4, s4, 2048
  v_add_u32 v236, s4, v242
  s_add_u32 s7, s6, 4
  s_bfe_u32 s4, s7, 0x10002
  s_lshl_b32 s4, s4, 5
  s_and_b32 s5, s7, 1
  s_lshl_b32 s5, s5, 4
  s_add_u32 s4, s4, s5
  s_bfe_u32 s5, s7, 0x10001
  s_lshl_b32 s5, s5, 2
  s_add_u32 s4, s4, s5
  s_mul_i32 s4, s4, 6144
  s_lshr_b32 s5, s7, 3
  s_lshl_b32 s5, s5, 11
  s_add_u32 s4, s4, s5
  s_add_u32 s4, s4, 1024
  v_add_u32 v237, s4, v242
  s_add_u32 s7, s6, 5
  s_bfe_u32 s4, s7, 0x10002
  s_lshl_b32 s4, s4, 5
  s_and_b32 s5, s7, 1
  s_lshl_b32 s5, s5, 4
  s_add_u32 s4, s4, s5
  s_bfe_u32 s5, s7, 0x10001
  s_lshl_b32 s5, s5, 2
  s_add_u32 s4, s4, s5
  s_mul_i32 s4, s4, 6144
  s_lshr_b32 s5, s7, 3
  s_lshl_b32 s5, s5, 11
  s_add_u32 s4, s4, s5
  s_add_u32 s4, s4, 0
  v_add_u32 v238, s4, v242
  s_waitcnt lgkmcnt(0)
  s_lshl_b32 s10, s32, 19
  s_add_u32 s8, s76, s10
  s_addc_u32 s9, s77, 0
  s_sub_u32 s8, s8, 32768
  s_subb_u32 s9, s9, 0
  s_mov_b32 s10, 557056
  s_mov_b32 s11, 0x00020000
  s_sub_u32 s12, s78, 2048
  s_subb_u32 s13, s79, 0
  s_mov_b32 s14, 6293504
  s_mov_b32 s15, 0x00020000
  s_add_u32 s96, s86, 125829120
  s_addc_u32 s97, s87, 0
  s_mov_b32 s98, 262144
  s_mov_b32 s99, 0x00020000
  s_cmp_ge_u32 s3, 2
  s_cbranch_scc1 Lp2_r1
  s_and_b32 s4, s2, 7
  s_lshl_b32 s4, s4, 4
  s_add_u32 s4, s4, s59
  s_lshl_b32 s4, s4, 2
  s_add_u32 s4, s4, s3
  s_lshl_b32 s51, s4, 13
  s_add_u32 m0, s36, s50
  s_nop 0
  buffer_load_dwordx4 v232, s[8:11], s46 offen offset:0 lds
  s_mov_b32 m0, s36
  s_nop 0
  buffer_load_dwordx4 v224, s[8:11], s46 offen offset:0 lds
  buffer_load_dwordx4 v225, s[8:11], s46 offen offset:1024 lds
  buffer_load_dwordx4 v226, s[8:11], s46 offen offset:2048 lds
  buffer_load_dwordx4 v227, s[8:11], s46 offen offset:3072 lds
  s_add_u32 m0, s36, 4096
  s_nop 0
  buffer_load_dwordx4 v228, s[8:11], s46 offen offset:0 lds
  buffer_load_dwordx4 v229, s[8:11], s46 offen offset:1024 lds
  buffer_load_dwordx4 v230, s[8:11], s46 offen offset:2048 lds
  buffer_load_dwordx4 v231, s[8:11], s46 offen offset:3072 lds
  s_mul_i32 s47, s48, 393216
  s_bfe_u32 s34, 0x302010e, s49
  s_add_u32 s48, s48, s34
  s_add_u32 s49, s49, 8
  s_and_b32 s49, s49, 0x8001f
  s_and_b32 s48, s48, 15
  s_lshl_b32 s46, s48, 7
  s_mov_b32 m0, s41
  s_nop 0
  buffer_load_dwordx4 v233, s[12:15], s47 offen offset:0 lds
  buffer_load_dwordx4 v234, s[12:15], s47 offen offset:1024 lds
  buffer_load_dwordx4 v235, s[12:15], s47 offen offset:2048 lds
  s_add_u32 m0, s41, 3072
  s_nop 0
  buffer_load_dwordx4 v236, s[12:15], s47 offen offset:0 lds
  buffer_load_dwordx4 v237, s[12:15], s47 offen offset:1024 lds
  buffer_load_dwordx4 v238, s[12:15], s47 offen offset:2048 lds
  s_lshr_b32 s4, s3, 1
  s_lshl_b32 s4, s4, 14
  v_and_b32 v240, 15, v1
  v_lshlrev_b32 v240, 7, v240
  v_lshrrev_b32 v241, 4, v1
  v_and_b32 v242, 6, v1
  v_xor_b32 v241, v241, v242
  v_lshl_add_u32 v240, v241, 4, v240
  v_add_u32 v16, s4, v240
  v_xor_b32 v17, 64, v16
  v_and_b32 v240, 15, v1
  v_lshlrev_b32 v240, 7, v240
  v_lshrrev_b32 v241, 4, v1
  v_and_b32 v242, 6, v1
  v_xor_b32 v241, v241, v242
  v_lshl_add_u32 v240, v241, 4, v240
  v_add_u32 v18, 32768, v240
  v_xor_b32 v19, 64, v18
  v_lshrrev_b32 v240, 2, v1
  v_and_b32 v241, 6, v240
  v_lshlrev_b32 v240, 7, v240
  v_and_b32 v242, 1, v1
  v_lshl_add_u32 v240, v242, 3, v240
  v_add_u32 v240, 104448, v240
  v_bfe_u32 v242, v1, 1, 1
  v_xor_b32 v241, v241, v242
  v_xor_b32 v242, 0, v241
  v_lshl_add_u32 v20, v242, 4, v240
  v_xor_b32 v242, 2, v241
  v_lshl_add_u32 v21, v242, 4, v240
  s_and_b32 s4, s3, 1
  s_lshl_b32 s4, s4, 6
  v_xor_b32 v20, s4, v20
  v_xor_b32 v21, s4, v21
  s_and_b32 s24, s2, 7
  s_lshr_b32 s4, s2, 6
  s_lshl_b32 s4, s4, 3
  s_add_u32 s24, s24, s4
  s_lshr_b32 s4, s2, 3
  s_and_b32 s25, s4, 6
  s_xor_b32 s4, s4, s2
  s_bfe_u32 s4, s4, 0x10003
  s_add_u32 s25, s25, s4
  v_accvgpr_write_b32 a244, -1
  v_accvgpr_write_b32 a245, -1
  v_accvgpr_write_b32 a246, -1
  v_accvgpr_write_b32 a247, -1
  v_lshrrev_b32 v24, 3, v1
  v_and_b32 v25, 6, v24
  v_and_b32 v26, 7, v1
  v_xor_b32 v25, v25, v26
  v_lshlrev_b32 v25, 4, v25
  s_and_b32 s4, s3, 1
  s_lshl_b32 s4, s4, 16
  s_lshr_b32 s5, s3, 1
  s_lshl_b32 s5, s5, 7
  s_add_u32 s4, s4, s5
  v_lshl_add_u32 v24, v24, 11, v25
  v_add_u32 v24, s4, v24
  v_add_u32 v25, 0, v24
  v_accvgpr_write_b32 a212, v25
  v_add_u32 v25, 15360, v24
  v_accvgpr_write_b32 a213, v25
  v_add_u32 v25, 30720, v24
  v_accvgpr_write_b32 a214, v25
  v_add_u32 v25, 46080, v24
  v_accvgpr_write_b32 a215, v25
  v_accvgpr_write_b32 a236, 0
  v_mov_b32 v27, 0x3f803f80
  v_accvgpr_write_b32 a208, v27
  v_accvgpr_write_b32 a237, 0
  v_accvgpr_write_b32 a209, v27
  v_accvgpr_write_b32 a238, 0
  v_accvgpr_write_b32 a210, v27
  v_accvgpr_write_b32 a239, 0
  v_accvgpr_write_b32 a211, v27
  v_lshrrev_b32 v24, 3, v1
  v_and_b32 v25, 6, v24
  v_and_b32 v26, 7, v1
  v_xor_b32 v25, v25, v26
  v_lshlrev_b32 v25, 4, v25
  v_lshlrev_b32 v26, 2, v24
  v_add_u32 v26, s3, v26
  v_lshl_add_u32 v26, v26, 11, v25
  v_add_u32 v27, 0, v26
  v_accvgpr_write_b32 a222, v27
  v_add_u32 v27, 64512, v26
  v_accvgpr_write_b32 a223, v27
  v_add_u32 v27, 129024, v26
  v_accvgpr_write_b32 a224, v27
  v_add_u32 v27, 193536, v26
  v_accvgpr_write_b32 a225, v27
  v_lshrrev_b32 v26, 2, v24
  v_and_b32 v27, 3, v24
  v_lshl_add_u32 v26, v26, 3, v27
  s_and_b32 s4, s3, 1
  s_lshl_b32 s4, s4, 18
  s_lshr_b32 s5, s3, 1
  s_lshl_b32 s5, s5, 7
  s_add_u32 s4, s4, s5
  s_lshl_b32 s5, s24, 8
  s_add_u32 s4, s4, s5
  v_lshl_add_u32 v26, v26, 13, v25
  v_add_u32 v26, s4, v26
  v_add_u32 v27, 0, v26
  v_accvgpr_write_b32 a226, v27
  v_add_u32 v27, 130048, v26
  v_accvgpr_write_b32 a227, v27
  v_add_u32 v27, 30720, v26
  v_accvgpr_write_b32 a228, v27
  v_add_u32 v27, 160768, v26
  v_accvgpr_write_b32 a229, v27
  s_lshl_b32 s4, s3, 13
  s_add_u32 s4, s4, 98304
  v_and_b32 v24, 15, v1
  v_lshlrev_b32 v24, 7, v24
  v_lshrrev_b32 v25, 4, v1
  v_and_b32 v26, 6, v1
  v_xor_b32 v25, v25, v26
  v_lshl_add_u32 v24, v25, 4, v24
  v_add_u32 v28, s4, v24
  v_xor_b32 v29, 64, v28
  v_lshrrev_b32 v24, 2, v1
  v_and_b32 v25, 6, v24
  v_lshlrev_b32 v24, 7, v24
  v_and_b32 v26, 1, v1
  v_lshl_add_u32 v24, v26, 3, v24
  v_add_u32 v24, 0, v24
  v_bfe_u32 v26, v1, 1, 1
  v_xor_b32 v25, v25, v26
  v_xor_b32 v26, 0, v25
  v_lshl_add_u32 v30, v26, 4, v24
  v_xor_b32 v26, 2, v25
  v_lshl_add_u32 v31, v26, 4, v24
  v_xor_b32 v26, 4, v25
  v_lshl_add_u32 v32, v26, 4, v24
  v_xor_b32 v26, 6, v25
  v_lshl_add_u32 v33, v26, 4, v24
  v_accvgpr_write_b32 a230, v28
  v_accvgpr_write_b32 a231, v29
  v_accvgpr_write_b32 a232, v30
  v_accvgpr_write_b32 a233, v31
  v_accvgpr_write_b32 a234, v32
  v_accvgpr_write_b32 a235, v33
  v_and_b32 v253, 15, v1
  v_lshrrev_b32 v254, 4, v1
  v_lshlrev_b32 v254, 2, v254
  v_sub_u32 v253, v253, v254
  v_mov_b32 v254, 0xf149f2ca
  s_lshr_b32 s4, s3, 1
  s_or_b32 s4, s4, s32
  s_cselect_b64 s[6:7], 0, -1
  v_subrev_u32 v255, 0, v253
  v_and_b32 v252, 0x80000001, v255
  v_cmp_ne_u32 vcc, 0, v252
  s_nop 1
  v_cndmask_b32 v244, 0, v254, vcc
  v_add_u32 v255, 1, v255
  v_and_b32 v252, 0x80000001, v255
  v_cmp_ne_u32 vcc, 0x80000001, v252
  s_nop 1
  v_cndmask_b32 v240, 0, v254, vcc
  v_cndmask_b32 v248, v240, v254, s[6:7]
  v_subrev_u32 v255, 1, v253
  v_and_b32 v252, 0x80000001, v255
  v_cmp_ne_u32 vcc, 0, v252
  s_nop 1
  v_cndmask_b32 v245, 0, v254, vcc
  v_add_u32 v255, 1, v255
  v_and_b32 v252, 0x80000001, v255
  v_cmp_ne_u32 vcc, 0x80000001, v252
  s_nop 1
  v_cndmask_b32 v241, 0, v254, vcc
  v_cndmask_b32 v249, v241, v254, s[6:7]
  v_subrev_u32 v255, 2, v253
  v_and_b32 v252, 0x80000001, v255
  v_cmp_ne_u32 vcc, 0, v252
  s_nop 1
  v_cndmask_b32 v246, 0, v254, vcc
  v_add_u32 v255, 1, v255
  v_and_b32 v252, 0x80000001, v255
  v_cmp_ne_u32 vcc, 0x80000001, v252
  s_nop 1
  v_cndmask_b32 v242, 0, v254, vcc
  v_cndmask_b32 v250, v242, v254, s[6:7]
  v_subrev_u32 v255, 3, v253
  v_and_b32 v252, 0x80000001, v255
  v_cmp_ne_u32 vcc, 0, v252
  s_nop 1
  v_cndmask_b32 v247, 0, v254, vcc
  v_add_u32 v255, 1, v255
  v_and_b32 v252, 0x80000001, v255
  v_cmp_ne_u32 vcc, 0x80000001, v252
  s_nop 1
  v_cndmask_b32 v243, 0, v254, vcc
  v_cndmask_b32 v251, v243, v254, s[6:7]
  s_and_b32 s4, s3, 1
  s_lshl_b32 s4, s4, 12
  s_add_u32 s4, s4, 49152
  v_add_u32 v252, s4, v2
  s_lshr_b32 s5, s3, 1
  s_lshl_b32 s5, s5, 11
  v_add_u32 v253, s5, v252
  s_add_u32 s16, s86, 83886080
  s_addc_u32 s17, s87, 0
  s_mov_b32 s18, 4194304
  s_mov_b32 s19, 0x00020000
  s_lshl_b32 s57, s32, 19
  s_lshl_b32 s5, s5, 7
  s_add_u32 s57, s57, s5
  s_lshl_b32 s4, s33, 14
  s_add_u32 s57, s57, s4
  s_and_b32 s4, s3, 1
  s_lshl_b32 s4, s4, 13
  s_add_u32 s57, s57, s4
  s_add_u32 s58, s57, 4096
  s_mov_b32 s37, 0
  s_mov_b32 s39, 4294897664
  s_mov_b32 s40, 34816
  s_mov_b32 s42, 0
  s_mov_b32 s44, 4294942720
  s_mov_b32 s45, 24576
  s_mov_b32 s43, s44
  s_mov_b32 s52, s72
  s_mov_b32 s53, s73
  s_mov_b32 s54, 4194304
  s_mov_b32 s55, 0x00020000
  s_lshl_b32 s1, s51, 1
  s_mov_b32 s56, s51
  s_mov_b32 s0, 0
  s_waitcnt vmcnt(0)
  s_barrier
  ds_read_b128 a[72:75], v16 offset:0
  ds_read_b128 a[108:111], v17 offset:0
  ds_read_b64_tr_b16 a[144:145], v20 offset:0
  ds_read_b64_tr_b16 a[146:147], v20 offset:2048
  ds_read_b64_tr_b16 a[168:169], v20 offset:4096
  ds_read_b64_tr_b16 a[170:171], v20 offset:6144
  ds_read_b128 a[76:79], v16 offset:2048
  ds_read_b128 a[112:115], v17 offset:2048
  ds_read_b128 a[80:83], v16 offset:4096
  ds_read_b128 a[116:119], v17 offset:4096
  ds_read_b128 a[84:87], v16 offset:6144
  ds_read_b128 a[120:123], v17 offset:6144
  ds_read_b128 a[88:91], v16 offset:8192
  ds_read_b128 a[124:127], v17 offset:8192
  ds_read_b128 a[92:95], v16 offset:10240
  ds_read_b128 a[128:131], v17 offset:10240
  ds_read_b128 a[96:99], v16 offset:12288
  ds_read_b128 a[132:135], v17 offset:12288
  ds_read_b128 a[100:103], v16 offset:14336
  ds_read_b128 a[136:139], v17 offset:14336
  ds_read_b64_tr_b16 a[148:149], v21 offset:0
  ds_read_b64_tr_b16 a[150:151], v21 offset:2048
  ds_read_b64_tr_b16 a[172:173], v21 offset:4096
  ds_read_b64_tr_b16 a[174:175], v21 offset:6144
  ds_read_b64_tr_b16 a[152:153], v20 offset:8192
  ds_read_b64_tr_b16 a[154:155], v20 offset:10240
  ds_read_b64_tr_b16 a[176:177], v20 offset:12288
  ds_read_b64_tr_b16 a[178:179], v20 offset:14336
  ds_read_b128 a[104:107], v18 offset:0
  ds_read_b128 a[140:143], v19 offset:0
  s_waitcnt lgkmcnt(0)
  v_mfma_f32_16x16x32_bf16 v[24:27], a[144:147], a[72:75], 0
  s_add_u32 m0, s36, s50
  s_add_u32 m0, m0, 34816
  ds_read_b64_tr_b16 a[156:157], v21 offset:8192
  v_mfma_f32_16x16x32_bf16 v[24:27], a[168:171], a[108:111], v[24:27]
  buffer_load_dwordx4 v232, s[8:11], s46 offen offset:0 lds
  v_mfma_f32_16x16x32_bf16 v[28:31], a[144:147], a[76:79], 0
  s_add_u32 m0, s36, 34816
  v_mfma_f32_16x16x32_bf16 v[28:31], a[168:171], a[112:115], v[28:31]
  buffer_load_dwordx4 v224, s[8:11], s46 offen offset:0 lds
  v_mfma_f32_16x16x32_bf16 v[32:35], a[144:147], a[80:83], 0
  buffer_load_dwordx4 v225, s[8:11], s46 offen offset:1024 lds
  v_mfma_f32_16x16x32_bf16 v[32:35], a[168:171], a[116:119], v[32:35]
  buffer_load_dwordx4 v226, s[8:11], s46 offen offset:2048 lds
  v_mfma_f32_16x16x32_bf16 v[36:39], a[144:147], a[84:87], 0
  ds_read_b64_tr_b16 a[158:159], v21 offset:10240
  ds_read_b64_tr_b16 a[180:181], v21 offset:12288
  v_mfma_f32_16x16x32_bf16 v[36:39], a[168:171], a[120:123], v[36:39]
  buffer_load_dwordx4 v227, s[8:11], s46 offen offset:3072 lds
  v_mfma_f32_16x16x32_bf16 v[40:43], a[144:147], a[88:91], 0
  s_add_u32 m0, s36, 38912
  v_mfma_f32_16x16x32_bf16 v[40:43], a[168:171], a[124:127], v[40:43]
  buffer_load_dwordx4 v228, s[8:11], s46 offen offset:0 lds
  v_mfma_f32_16x16x32_bf16 v[44:47], a[144:147], a[92:95], 0
  buffer_load_dwordx4 v229, s[8:11], s46 offen offset:1024 lds
  v_mfma_f32_16x16x32_bf16 v[44:47], a[168:171], a[128:131], v[44:47]
  ds_read_b64_tr_b16 a[182:183], v21 offset:14336
  v_mfma_f32_16x16x32_bf16 v[48:51], a[144:147], a[96:99], 0
  buffer_load_dwordx4 v230, s[8:11], s46 offen offset:2048 lds
  v_mfma_f32_16x16x32_bf16 v[48:51], a[168:171], a[132:135], v[48:51]
  ds_read_b64_tr_b16 a[160:161], v20 offset:16384
  v_mfma_f32_16x16x32_bf16 v[52:55], a[144:147], a[100:103], 0
  buffer_load_dwordx4 v231, s[8:11], s46 offen offset:3072 lds
  v_mfma_f32_16x16x32_bf16 v[52:55], a[168:171], a[136:139], v[52:55]
  s_mul_i32 s47, s48, 393216
  s_bfe_u32 s34, 0x302010e, s49
  s_add_u32 s48, s48, s34
  v_mfma_f32_16x16x32_bf16 v[56:59], a[148:151], a[72:75], 0
  s_add_u32 s49, s49, 8
  s_and_b32 s49, s49, 0x8001f
  s_and_b32 s48, s48, 15
  v_mfma_f32_16x16x32_bf16 v[56:59], a[172:175], a[108:111], v[56:59]
  s_lshl_b32 s46, s48, 7
  s_add_u32 m0, s41, 24576
  ds_read_b64_tr_b16 a[162:163], v20 offset:18432
  v_mfma_f32_16x16x32_bf16 v[60:63], a[148:151], a[76:79], 0
  buffer_load_dwordx4 v233, s[12:15], s47 offen offset:0 lds
  v_mfma_f32_16x16x32_bf16 v[60:63], a[172:175], a[112:115], v[60:63]
  buffer_load_dwordx4 v234, s[12:15], s47 offen offset:1024 lds
  v_mfma_f32_16x16x32_bf16 v[64:67], a[148:151], a[80:83], 0
  buffer_load_dwordx4 v235, s[12:15], s47 offen offset:2048 lds
  v_mfma_f32_16x16x32_bf16 v[64:67], a[172:175], a[116:119], v[64:67]
  s_add_u32 m0, s41, 27648
  ds_read_b64_tr_b16 a[184:185], v20 offset:20480
  v_mfma_f32_16x16x32_bf16 v[68:71], a[148:151], a[84:87], 0
  buffer_load_dwordx4 v236, s[12:15], s47 offen offset:0 lds
  v_mfma_f32_16x16x32_bf16 v[68:71], a[172:175], a[120:123], v[68:71]
  buffer_load_dwordx4 v237, s[12:15], s47 offen offset:1024 lds
  v_mfma_f32_16x16x32_bf16 v[72:75], a[148:151], a[88:91], 0
  ds_read_b64_tr_b16 a[186:187], v20 offset:22528
  v_mfma_f32_16x16x32_bf16 v[72:75], a[172:175], a[124:127], v[72:75]
  buffer_load_dwordx4 v238, s[12:15], s47 offen offset:2048 lds
  v_mfma_f32_16x16x32_bf16 v[76:79], a[148:151], a[92:95], 0
  s_add_u32 m0, s36, s50
  s_add_u32 m0, m0, 69632
  ds_read_b64_tr_b16 a[164:165], v21 offset:16384
  v_mfma_f32_16x16x32_bf16 v[76:79], a[172:175], a[128:131], v[76:79]
  buffer_load_dwordx4 v232, s[8:11], s46 offen offset:0 lds
  v_mfma_f32_16x16x32_bf16 v[80:83], a[148:151], a[96:99], 0
  s_add_u32 m0, s36, 69632
  v_mfma_f32_16x16x32_bf16 v[80:83], a[172:175], a[132:135], v[80:83]
  buffer_load_dwordx4 v224, s[8:11], s46 offen offset:0 lds
  v_mfma_f32_16x16x32_bf16 v[84:87], a[148:151], a[100:103], 0
  buffer_load_dwordx4 v225, s[8:11], s46 offen offset:1024 lds
  v_mfma_f32_16x16x32_bf16 v[84:87], a[172:175], a[136:139], v[84:87]
  ds_read_b64_tr_b16 a[166:167], v21 offset:18432
  v_mfma_f32_16x16x32_bf16 v[88:91], a[152:155], a[72:75], 0
  buffer_load_dwordx4 v226, s[8:11], s46 offen offset:2048 lds
  v_mfma_f32_16x16x32_bf16 v[88:91], a[176:179], a[108:111], v[88:91]
  ds_read_b64_tr_b16 a[188:189], v21 offset:20480
  v_mfma_f32_16x16x32_bf16 v[92:95], a[152:155], a[76:79], 0
  buffer_load_dwordx4 v227, s[8:11], s46 offen offset:3072 lds
  v_mfma_f32_16x16x32_bf16 v[92:95], a[176:179], a[112:115], v[92:95]
  s_add_u32 m0, s36, 73728
  v_mfma_f32_16x16x32_bf16 v[96:99], a[152:155], a[80:83], 0
  buffer_load_dwordx4 v228, s[8:11], s46 offen offset:0 lds
  v_mfma_f32_16x16x32_bf16 v[96:99], a[176:179], a[116:119], v[96:99]
  buffer_load_dwordx4 v229, s[8:11], s46 offen offset:1024 lds
  v_mfma_f32_16x16x32_bf16 v[100:103], a[152:155], a[84:87], 0
  s_add_u32 s37, s37, 1
  ds_read_b64_tr_b16 a[190:191], v21 offset:22528
  v_mfma_f32_16x16x32_bf16 v[100:103], a[176:179], a[120:123], v[100:103]
  buffer_load_dwordx4 v230, s[8:11], s46 offen offset:2048 lds
  v_mfma_f32_16x16x32_bf16 v[104:107], a[152:155], a[88:91], 0
  s_cmp_eq_u32 s37, 3
  s_cselect_b32 s37, 0, s37
  s_cselect_b32 s38, s39, s40
  v_mfma_f32_16x16x32_bf16 v[104:107], a[176:179], a[124:127], v[104:107]
  buffer_load_dwordx4 v231, s[8:11], s46 offen offset:3072 lds
  v_mfma_f32_16x16x32_bf16 v[108:111], a[152:155], a[92:95], 0
  s_sub_u32 s43, 0, s43
  v_mfma_f32_16x16x32_bf16 v[108:111], a[176:179], a[128:131], v[108:111]
  s_mul_i32 s47, s48, 393216
  v_add_u32 v16, s38, v16
  v_add_u32 v17, s38, v17
  v_mfma_f32_16x16x32_bf16 v[112:115], a[152:155], a[96:99], 0
  s_bfe_u32 s34, 0x302010e, s49
  v_add_u32 v18, s38, v18
  v_add_u32 v19, s38, v19
  v_mfma_f32_16x16x32_bf16 v[112:115], a[176:179], a[132:135], v[112:115]
  s_add_u32 s48, s48, s34
  s_add_u32 s49, s49, 8
  v_add_u32 v20, s43, v20
  v_mfma_f32_16x16x32_bf16 v[116:119], a[152:155], a[100:103], 0
  s_and_b32 s49, s49, 0x8001f
  s_and_b32 s48, s48, 15
  s_lshl_b32 s46, s48, 7
  v_mfma_f32_16x16x32_bf16 v[116:119], a[176:179], a[136:139], v[116:119]
  v_add_u32 v21, s43, v21
  v_mfma_f32_16x16x32_bf16 v[216:219], a[152:155], a[104:107], 0
  v_mfma_f32_16x16x32_bf16 v[216:219], a[176:179], a[140:143], v[216:219]
  s_waitcnt vmcnt(9) lgkmcnt(0)
  s_barrier
  v_mfma_f32_16x16x32_bf16 v[120:123], a[156:159], a[72:75], 0
  buffer_load_dwordx4 a[192:195], v2, s[52:55], s51 offen offset:0
  v_mfma_f32_16x16x32_bf16 v[120:123], a[180:183], a[108:111], v[120:123]
  ds_read_b128 a[0:3], v16 offset:0
  ds_read_b128 a[36:39], v17 offset:0
  v_mfma_f32_16x16x32_bf16 v[124:127], a[156:159], a[76:79], 0
  ds_read_b64_tr_b16 a[144:145], v20 offset:0
  v_mfma_f32_16x16x32_bf16 v[124:127], a[180:183], a[112:115], v[124:127]
  v_mfma_f32_16x16x32_bf16 v[128:131], a[156:159], a[80:83], 0
  buffer_load_dwordx4 a[192:195], v2, s[52:55], s51 offen offset:1024
  v_mfma_f32_16x16x32_bf16 v[128:131], a[180:183], a[116:119], v[128:131]
  ds_read_b64_tr_b16 a[146:147], v20 offset:2048
  ds_read_b64_tr_b16 a[168:169], v20 offset:4096
  v_mfma_f32_16x16x32_bf16 v[132:135], a[156:159], a[84:87], 0
  ds_read_b64_tr_b16 a[170:171], v20 offset:6144
  v_mfma_f32_16x16x32_bf16 v[132:135], a[180:183], a[120:123], v[132:135]
  v_mfma_f32_16x16x32_bf16 v[136:139], a[156:159], a[88:91], 0
  ds_read_b128 a[4:7], v16 offset:2048
  v_mfma_f32_16x16x32_bf16 v[136:139], a[180:183], a[124:127], v[136:139]
  buffer_load_dwordx4 a[192:195], v2, s[52:55], s51 offen offset:2048
  v_mfma_f32_16x16x32_bf16 v[140:143], a[156:159], a[92:95], 0
  ds_read_b128 a[40:43], v17 offset:2048
  ds_read_b128 a[8:11], v16 offset:4096
  v_mfma_f32_16x16x32_bf16 v[140:143], a[180:183], a[128:131], v[140:143]
  v_mfma_f32_16x16x32_bf16 v[144:147], a[156:159], a[96:99], 0
  ds_read_b128 a[44:47], v17 offset:4096
  v_mfma_f32_16x16x32_bf16 v[144:147], a[180:183], a[132:135], v[144:147]
  ds_read_b128 a[12:15], v16 offset:6144
  v_mfma_f32_16x16x32_bf16 v[148:151], a[156:159], a[100:103], 0
  buffer_load_dwordx4 a[192:195], v2, s[52:55], s51 offen offset:3072
  v_mfma_f32_16x16x32_bf16 v[148:151], a[180:183], a[136:139], v[148:151]
  s_add_u32 s51, s51, 4096
  s_add_u32 s0, s0, 1
  s_cmp_eq_u32 s0, 2
  s_cselect_b32 s52, s68, s52
  s_cselect_b32 s53, s69, s53
  s_cselect_b32 s51, s1, s51
  s_cselect_b32 s54, 0, s54
  v_mfma_f32_16x16x32_bf16 v[220:223], a[156:159], a[104:107], 0
  s_cmp_eq_u32 s0, 6
  s_cselect_b32 s52, s64, s52
  s_cselect_b32 s53, s65, s53
  s_cselect_b32 s51, s56, s51
  s_cselect_b32 s54, 0, s54
  v_mfma_f32_16x16x32_bf16 v[220:223], a[180:183], a[140:143], v[220:223]
  s_cmp_eq_u32 s0, 8
  s_cselect_b32 s54, 0, s54
  s_mov_b32 m0, s41
  v_mfma_f32_16x16x32_bf16 v[152:155], a[72:75], a[160:163], 0
  ds_read_b128 a[48:51], v17 offset:6144
  ds_read_b128 a[16:19], v16 offset:8192
  v_mfma_f32_16x16x32_bf16 v[152:155], a[108:111], a[184:187], v[152:155]
  buffer_load_dwordx4 v233, s[12:15], s47 offen offset:0 lds
  v_mfma_f32_16x16x32_bf16 v[156:159], a[76:79], a[160:163], 0
  ds_read_b128 a[52:55], v17 offset:8192
  ds_read_b128 a[20:23], v16 offset:10240
  v_mfma_f32_16x16x32_bf16 v[156:159], a[112:115], a[184:187], v[156:159]
  ds_read_b128 a[56:59], v17 offset:10240
  ds_read_b128 a[24:27], v16 offset:12288
  v_mfma_f32_16x16x32_bf16 v[160:163], a[80:83], a[160:163], 0
  ds_read_b128 a[60:63], v17 offset:12288
  v_mfma_f32_16x16x32_bf16 v[160:163], a[116:119], a[184:187], v[160:163]
  v_mfma_f32_16x16x32_bf16 v[164:167], a[84:87], a[160:163], 0
  buffer_load_dwordx4 v234, s[12:15], s47 offen offset:1024 lds
  v_mfma_f32_16x16x32_bf16 v[164:167], a[120:123], a[184:187], v[164:167]
  ds_read_b128 a[28:31], v16 offset:14336
  ds_read_b128 a[64:67], v17 offset:14336
  v_mfma_f32_16x16x32_bf16 v[168:171], a[88:91], a[160:163], 0
  ds_read_b64_tr_b16 a[148:149], v21 offset:0
  v_mfma_f32_16x16x32_bf16 v[168:171], a[124:127], a[184:187], v[168:171]
  v_mfma_f32_16x16x32_bf16 v[172:175], a[92:95], a[160:163], 0
  ds_read_b64_tr_b16 a[150:151], v21 offset:2048
  v_mfma_f32_16x16x32_bf16 v[172:175], a[128:131], a[184:187], v[172:175]
  buffer_load_dwordx4 v235, s[12:15], s47 offen offset:2048 lds
  v_mfma_f32_16x16x32_bf16 v[176:179], a[96:99], a[160:163], 0
  s_add_u32 m0, s41, 3072
  ds_read_b64_tr_b16 a[172:173], v21 offset:4096
  ds_read_b64_tr_b16 a[174:175], v21 offset:6144
  v_mfma_f32_16x16x32_bf16 v[176:179], a[132:135], a[184:187], v[176:179]
  v_mfma_f32_16x16x32_bf16 v[180:183], a[100:103], a[160:163], 0
  ds_read_b64_tr_b16 a[152:153], v20 offset:8192
  v_mfma_f32_16x16x32_bf16 v[180:183], a[136:139], a[184:187], v[180:183]
  ds_read_b64_tr_b16 a[154:155], v20 offset:10240
  v_mfma_f32_16x16x32_bf16 v[184:187], a[72:75], a[164:167], 0
  buffer_load_dwordx4 v236, s[12:15], s47 offen offset:0 lds
  v_mfma_f32_16x16x32_bf16 v[184:187], a[108:111], a[188:191], v[184:187]
  ds_read_b64_tr_b16 a[176:177], v20 offset:12288
  v_mfma_f32_16x16x32_bf16 v[188:191], a[76:79], a[164:167], 0
  ds_read_b64_tr_b16 a[178:179], v20 offset:14336
  v_mfma_f32_16x16x32_bf16 v[188:191], a[112:115], a[188:191], v[188:191]
  ds_read_b128 a[32:35], v18 offset:0
  v_mfma_f32_16x16x32_bf16 v[192:195], a[80:83], a[164:167], 0
  ds_read_b128 a[68:71], v19 offset:0
  v_mfma_f32_16x16x32_bf16 v[192:195], a[116:119], a[188:191], v[192:195]
  buffer_load_dwordx4 v237, s[12:15], s47 offen offset:1024 lds
  v_mfma_f32_16x16x32_bf16 v[196:199], a[84:87], a[164:167], 0
  v_mfma_f32_16x16x32_bf16 v[196:199], a[120:123], a[188:191], v[196:199]
  v_mfma_f32_16x16x32_bf16 v[200:203], a[88:91], a[164:167], 0
  v_mfma_f32_16x16x32_bf16 v[200:203], a[124:127], a[188:191], v[200:203]
  v_mfma_f32_16x16x32_bf16 v[204:207], a[92:95], a[164:167], 0
  buffer_load_dwordx4 v238, s[12:15], s47 offen offset:2048 lds
  v_mfma_f32_16x16x32_bf16 v[204:207], a[128:131], a[188:191], v[204:207]
  v_mfma_f32_16x16x32_bf16 v[208:211], a[96:99], a[164:167], 0
  v_mfma_f32_16x16x32_bf16 v[208:211], a[132:135], a[188:191], v[208:211]
  v_mfma_f32_16x16x32_bf16 v[212:215], a[100:103], a[164:167], 0
  v_mfma_f32_16x16x32_bf16 v[212:215], a[136:139], a[188:191], v[212:215]
  s_waitcnt lgkmcnt(0)
  v_mfma_f32_16x16x32_bf16 v[24:27], a[144:147], a[0:3], v[24:27]
  s_add_u32 m0, s36, s50
  ds_read_b64_tr_b16 a[156:157], v21 offset:8192
  v_mfma_f32_16x16x32_bf16 v[24:27], a[168:171], a[36:39], v[24:27]
  buffer_load_dwordx4 v232, s[8:11], s46 offen offset:0 lds
  v_mfma_f32_16x16x32_bf16 v[28:31], a[144:147], a[4:7], v[28:31]
  s_mov_b32 m0, s36
  v_mfma_f32_16x16x32_bf16 v[28:31], a[168:171], a[40:43], v[28:31]
  ds_read_b64_tr_b16 a[158:159], v21 offset:10240
  v_mfma_f32_16x16x32_bf16 v[32:35], a[144:147], a[8:11], v[32:35]
  buffer_load_dwordx4 v224, s[8:11], s46 offen offset:0 lds
  v_mfma_f32_16x16x32_bf16 v[32:35], a[168:171], a[44:47], v[32:35]
  v_mfma_f32_16x16x32_bf16 v[36:39], a[144:147], a[12:15], v[36:39]
  ds_read_b64_tr_b16 a[180:181], v21 offset:12288
  v_mfma_f32_16x16x32_bf16 v[36:39], a[168:171], a[48:51], v[36:39]
  v_mfma_f32_16x16x32_bf16 v[40:43], a[144:147], a[16:19], v[40:43]
  v_mfma_f32_16x16x32_bf16 v[40:43], a[168:171], a[52:55], v[40:43]
  buffer_load_dwordx4 v225, s[8:11], s46 offen offset:1024 lds
  v_mfma_f32_16x16x32_bf16 v[44:47], a[144:147], a[20:23], v[44:47]
  ds_read_b64_tr_b16 a[182:183], v21 offset:14336
  v_mfma_f32_16x16x32_bf16 v[44:47], a[168:171], a[56:59], v[44:47]
  v_mfma_f32_16x16x32_bf16 v[48:51], a[144:147], a[24:27], v[48:51]
  v_mfma_f32_16x16x32_bf16 v[48:51], a[168:171], a[60:63], v[48:51]
  ds_read_b64_tr_b16 a[160:161], v20 offset:16384
  v_mfma_f32_16x16x32_bf16 v[52:55], a[144:147], a[28:31], v[52:55]
  buffer_load_dwordx4 v226, s[8:11], s46 offen offset:2048 lds
  v_mfma_f32_16x16x32_bf16 v[52:55], a[168:171], a[64:67], v[52:55]
  v_mfma_f32_16x16x32_bf16 v[56:59], a[148:151], a[0:3], v[56:59]
  ds_read_b64_tr_b16 a[162:163], v20 offset:18432
  v_mfma_f32_16x16x32_bf16 v[56:59], a[172:175], a[36:39], v[56:59]
  v_mfma_f32_16x16x32_bf16 v[60:63], a[148:151], a[4:7], v[60:63]
  v_mfma_f32_16x16x32_bf16 v[60:63], a[172:175], a[40:43], v[60:63]
  buffer_load_dwordx4 v227, s[8:11], s46 offen offset:3072 lds
  v_mfma_f32_16x16x32_bf16 v[64:67], a[148:151], a[8:11], v[64:67]
  s_add_u32 m0, s36, 4096
  ds_read_b64_tr_b16 a[184:185], v20 offset:20480
  v_mfma_f32_16x16x32_bf16 v[64:67], a[172:175], a[44:47], v[64:67]
  s_add_u32 s36, s36, s38
  v_mfma_f32_16x16x32_bf16 v[68:71], a[148:151], a[12:15], v[68:71]
  s_add_u32 s37, s37, 1
  v_mfma_f32_16x16x32_bf16 v[68:71], a[172:175], a[48:51], v[68:71]
  buffer_load_dwordx4 v228, s[8:11], s46 offen offset:0 lds
  v_mfma_f32_16x16x32_bf16 v[72:75], a[148:151], a[16:19], v[72:75]
  ds_read_b64_tr_b16 a[186:187], v20 offset:22528
  v_mfma_f32_16x16x32_bf16 v[72:75], a[172:175], a[52:55], v[72:75]
  s_cmp_eq_u32 s37, 3
  s_cselect_b32 s37, 0, s37
  s_cselect_b32 s38, s39, s40
  v_mfma_f32_16x16x32_bf16 v[76:79], a[148:151], a[20:23], v[76:79]
  s_add_u32 s41, s41, s43
  ds_read_b64_tr_b16 a[164:165], v21 offset:16384
  v_mfma_f32_16x16x32_bf16 v[76:79], a[172:175], a[56:59], v[76:79]
  s_sub_u32 s43, 0, s43
  v_mfma_f32_16x16x32_bf16 v[80:83], a[148:151], a[24:27], v[80:83]
  buffer_load_dwordx4 v229, s[8:11], s46 offen offset:1024 lds
  v_mfma_f32_16x16x32_bf16 v[80:83], a[172:175], a[60:63], v[80:83]
  v_mfma_f32_16x16x32_bf16 v[84:87], a[148:151], a[28:31], v[84:87]
  ds_read_b64_tr_b16 a[166:167], v21 offset:18432
  v_mfma_f32_16x16x32_bf16 v[84:87], a[172:175], a[64:67], v[84:87]
  v_mfma_f32_16x16x32_bf16 v[88:91], a[152:155], a[0:3], v[88:91]
  v_mfma_f32_16x16x32_bf16 v[88:91], a[176:179], a[36:39], v[88:91]
  buffer_load_dwordx4 v230, s[8:11], s46 offen offset:2048 lds
  v_mfma_f32_16x16x32_bf16 v[92:95], a[152:155], a[4:7], v[92:95]
  ds_read_b64_tr_b16 a[188:189], v21 offset:20480
  v_mfma_f32_16x16x32_bf16 v[92:95], a[176:179], a[40:43], v[92:95]
  v_mfma_f32_16x16x32_bf16 v[96:99], a[152:155], a[8:11], v[96:99]
  ds_read_b64_tr_b16 a[190:191], v21 offset:22528
  v_mfma_f32_16x16x32_bf16 v[96:99], a[176:179], a[44:47], v[96:99]
  v_add_u32 v16, s38, v16
  v_add_u32 v17, s38, v17
  v_mfma_f32_16x16x32_bf16 v[100:103], a[152:155], a[12:15], v[100:103]
  buffer_load_dwordx4 v231, s[8:11], s46 offen offset:3072 lds
  v_mfma_f32_16x16x32_bf16 v[100:103], a[176:179], a[48:51], v[100:103]
  s_mul_i32 s47, s48, 393216
  v_add_u32 v18, s38, v18
  v_add_u32 v19, s38, v19
  v_mfma_f32_16x16x32_bf16 v[104:107], a[152:155], a[16:19], v[104:107]
  s_bfe_u32 s34, 0x302010e, s49
  v_add_u32 v20, s43, v20
  v_add_u32 v21, s43, v21
  v_mfma_f32_16x16x32_bf16 v[104:107], a[176:179], a[52:55], v[104:107]
  s_add_u32 s48, s48, s34
  v_mfma_f32_16x16x32_bf16 v[108:111], a[152:155], a[20:23], v[108:111]
  s_add_u32 s49, s49, 8
  v_mfma_f32_16x16x32_bf16 v[108:111], a[176:179], a[56:59], v[108:111]
  s_and_b32 s49, s49, 0x8001f
  v_mfma_f32_16x16x32_bf16 v[112:115], a[152:155], a[24:27], v[112:115]
  s_and_b32 s48, s48, 15
  v_mfma_f32_16x16x32_bf16 v[112:115], a[176:179], a[60:63], v[112:115]
  s_lshl_b32 s46, s48, 7
  v_mfma_f32_16x16x32_bf16 v[116:119], a[152:155], a[28:31], v[116:119]
  v_mfma_f32_16x16x32_bf16 v[116:119], a[176:179], a[64:67], v[116:119]
  v_mfma_f32_16x16x32_bf16 v[216:219], a[152:155], a[32:35], v[216:219]
  v_mfma_f32_16x16x32_bf16 v[216:219], a[176:179], a[68:71], v[216:219]
  s_mov_b32 s35, 6
  s_waitcnt vmcnt(9) lgkmcnt(0)
  s_barrier
  .p2align 6
Lp2r0_loop:
  v_mfma_f32_16x16x32_bf16 v[120:123], a[156:159], a[0:3], v[120:123]
  buffer_load_dwordx4 a[192:195], v2, s[52:55], s51 offen offset:0
  v_mfma_f32_16x16x32_bf16 v[120:123], a[180:183], a[36:39], v[120:123]
  ds_read_b128 a[72:75], v16 offset:0
  ds_read_b128 a[108:111], v17 offset:0
  v_mfma_f32_16x16x32_bf16 v[124:127], a[156:159], a[4:7], v[124:127]
  ds_read_b64_tr_b16 a[144:145], v20 offset:0
  v_mfma_f32_16x16x32_bf16 v[124:127], a[180:183], a[40:43], v[124:127]
  v_mfma_f32_16x16x32_bf16 v[128:131], a[156:159], a[8:11], v[128:131]
  buffer_load_dwordx4 a[192:195], v2, s[52:55], s51 offen offset:1024
  v_mfma_f32_16x16x32_bf16 v[128:131], a[180:183], a[44:47], v[128:131]
  ds_read_b64_tr_b16 a[146:147], v20 offset:2048
  ds_read_b64_tr_b16 a[168:169], v20 offset:4096
  v_mfma_f32_16x16x32_bf16 v[132:135], a[156:159], a[12:15], v[132:135]
  ds_read_b64_tr_b16 a[170:171], v20 offset:6144
  v_mfma_f32_16x16x32_bf16 v[132:135], a[180:183], a[48:51], v[132:135]
  v_mfma_f32_16x16x32_bf16 v[136:139], a[156:159], a[16:19], v[136:139]
  ds_read_b128 a[76:79], v16 offset:2048
  v_mfma_f32_16x16x32_bf16 v[136:139], a[180:183], a[52:55], v[136:139]
  buffer_load_dwordx4 a[192:195], v2, s[52:55], s51 offen offset:2048
  v_mfma_f32_16x16x32_bf16 v[140:143], a[156:159], a[20:23], v[140:143]
  ds_read_b128 a[112:115], v17 offset:2048
  ds_read_b128 a[80:83], v16 offset:4096
  v_mfma_f32_16x16x32_bf16 v[140:143], a[180:183], a[56:59], v[140:143]
  v_mfma_f32_16x16x32_bf16 v[144:147], a[156:159], a[24:27], v[144:147]
  ds_read_b128 a[116:119], v17 offset:4096
  v_mfma_f32_16x16x32_bf16 v[144:147], a[180:183], a[60:63], v[144:147]
  ds_read_b128 a[84:87], v16 offset:6144
  v_mfma_f32_16x16x32_bf16 v[148:151], a[156:159], a[28:31], v[148:151]
  buffer_load_dwordx4 a[192:195], v2, s[52:55], s51 offen offset:3072
  v_mfma_f32_16x16x32_bf16 v[148:151], a[180:183], a[64:67], v[148:151]
  s_add_u32 s51, s51, 4096
  s_add_u32 s0, s0, 1
  s_cmp_eq_u32 s0, 2
  s_cselect_b32 s52, s68, s52
  s_cselect_b32 s53, s69, s53
  s_cselect_b32 s51, s1, s51
  s_cselect_b32 s54, 0, s54
  v_mfma_f32_16x16x32_bf16 v[220:223], a[156:159], a[32:35], v[220:223]
  s_cmp_eq_u32 s0, 6
  s_cselect_b32 s52, s64, s52
  s_cselect_b32 s53, s65, s53
  s_cselect_b32 s51, s56, s51
  s_cselect_b32 s54, 0, s54
  v_mfma_f32_16x16x32_bf16 v[220:223], a[180:183], a[68:71], v[220:223]
  s_cmp_eq_u32 s0, 8
  s_cselect_b32 s54, 0, s54
  s_mov_b32 m0, s41
  v_mfma_f32_16x16x32_bf16 v[152:155], a[0:3], a[160:163], v[152:155]
  ds_read_b128 a[120:123], v17 offset:6144
  ds_read_b128 a[88:91], v16 offset:8192
  v_mfma_f32_16x16x32_bf16 v[152:155], a[36:39], a[184:187], v[152:155]
  buffer_load_dwordx4 v233, s[12:15], s47 offen offset:0 lds
  v_mfma_f32_16x16x32_bf16 v[156:159], a[4:7], a[160:163], v[156:159]
  ds_read_b128 a[124:127], v17 offset:8192
  ds_read_b128 a[92:95], v16 offset:10240
  v_mfma_f32_16x16x32_bf16 v[156:159], a[40:43], a[184:187], v[156:159]
  ds_read_b128 a[128:131], v17 offset:10240
  ds_read_b128 a[96:99], v16 offset:12288
  v_mfma_f32_16x16x32_bf16 v[160:163], a[8:11], a[160:163], v[160:163]
  ds_read_b128 a[132:135], v17 offset:12288
  v_mfma_f32_16x16x32_bf16 v[160:163], a[44:47], a[184:187], v[160:163]
  v_mfma_f32_16x16x32_bf16 v[164:167], a[12:15], a[160:163], v[164:167]
  buffer_load_dwordx4 v234, s[12:15], s47 offen offset:1024 lds
  v_mfma_f32_16x16x32_bf16 v[164:167], a[48:51], a[184:187], v[164:167]
  ds_read_b128 a[100:103], v16 offset:14336
  ds_read_b128 a[136:139], v17 offset:14336
  v_mfma_f32_16x16x32_bf16 v[168:171], a[16:19], a[160:163], v[168:171]
  ds_read_b64_tr_b16 a[148:149], v21 offset:0
  v_mfma_f32_16x16x32_bf16 v[168:171], a[52:55], a[184:187], v[168:171]
  v_mfma_f32_16x16x32_bf16 v[172:175], a[20:23], a[160:163], v[172:175]
  ds_read_b64_tr_b16 a[150:151], v21 offset:2048
  v_mfma_f32_16x16x32_bf16 v[172:175], a[56:59], a[184:187], v[172:175]
  buffer_load_dwordx4 v235, s[12:15], s47 offen offset:2048 lds
  v_mfma_f32_16x16x32_bf16 v[176:179], a[24:27], a[160:163], v[176:179]
  s_add_u32 m0, s41, 3072
  ds_read_b64_tr_b16 a[172:173], v21 offset:4096
  ds_read_b64_tr_b16 a[174:175], v21 offset:6144
  v_mfma_f32_16x16x32_bf16 v[176:179], a[60:63], a[184:187], v[176:179]
  v_mfma_f32_16x16x32_bf16 v[180:183], a[28:31], a[160:163], v[180:183]
  ds_read_b64_tr_b16 a[152:153], v20 offset:8192
  v_mfma_f32_16x16x32_bf16 v[180:183], a[64:67], a[184:187], v[180:183]
  ds_read_b64_tr_b16 a[154:155], v20 offset:10240
  v_mfma_f32_16x16x32_bf16 v[184:187], a[0:3], a[164:167], v[184:187]
  buffer_load_dwordx4 v236, s[12:15], s47 offen offset:0 lds
  v_mfma_f32_16x16x32_bf16 v[184:187], a[36:39], a[188:191], v[184:187]
  ds_read_b64_tr_b16 a[176:177], v20 offset:12288
  v_mfma_f32_16x16x32_bf16 v[188:191], a[4:7], a[164:167], v[188:191]
  ds_read_b64_tr_b16 a[178:179], v20 offset:14336
  v_mfma_f32_16x16x32_bf16 v[188:191], a[40:43], a[188:191], v[188:191]
  ds_read_b128 a[104:107], v18 offset:0
  v_mfma_f32_16x16x32_bf16 v[192:195], a[8:11], a[164:167], v[192:195]
  ds_read_b128 a[140:143], v19 offset:0
  v_mfma_f32_16x16x32_bf16 v[192:195], a[44:47], a[188:191], v[192:195]
  buffer_load_dwordx4 v237, s[12:15], s47 offen offset:1024 lds
  v_mfma_f32_16x16x32_bf16 v[196:199], a[12:15], a[164:167], v[196:199]
  v_mfma_f32_16x16x32_bf16 v[196:199], a[48:51], a[188:191], v[196:199]
  v_mfma_f32_16x16x32_bf16 v[200:203], a[16:19], a[164:167], v[200:203]
  v_mfma_f32_16x16x32_bf16 v[200:203], a[52:55], a[188:191], v[200:203]
  v_mfma_f32_16x16x32_bf16 v[204:207], a[20:23], a[164:167], v[204:207]
  buffer_load_dwordx4 v238, s[12:15], s47 offen offset:2048 lds
  v_mfma_f32_16x16x32_bf16 v[204:207], a[56:59], a[188:191], v[204:207]
  v_mfma_f32_16x16x32_bf16 v[208:211], a[24:27], a[164:167], v[208:211]
  v_mfma_f32_16x16x32_bf16 v[208:211], a[60:63], a[188:191], v[208:211]
  v_mfma_f32_16x16x32_bf16 v[212:215], a[28:31], a[164:167], v[212:215]
  v_mfma_f32_16x16x32_bf16 v[212:215], a[64:67], a[188:191], v[212:215]
  s_waitcnt lgkmcnt(0)
  v_mfma_f32_16x16x32_bf16 v[24:27], a[144:147], a[72:75], v[24:27]
  s_add_u32 m0, s36, s50
  ds_read_b64_tr_b16 a[156:157], v21 offset:8192
  v_mfma_f32_16x16x32_bf16 v[24:27], a[168:171], a[108:111], v[24:27]
  buffer_load_dwordx4 v232, s[8:11], s46 offen offset:0 lds
  v_mfma_f32_16x16x32_bf16 v[28:31], a[144:147], a[76:79], v[28:31]
  s_mov_b32 m0, s36
  v_mfma_f32_16x16x32_bf16 v[28:31], a[168:171], a[112:115], v[28:31]
  ds_read_b64_tr_b16 a[158:159], v21 offset:10240
  v_mfma_f32_16x16x32_bf16 v[32:35], a[144:147], a[80:83], v[32:35]
  buffer_load_dwordx4 v224, s[8:11], s46 offen offset:0 lds
  v_mfma_f32_16x16x32_bf16 v[32:35], a[168:171], a[116:119], v[32:35]
  v_mfma_f32_16x16x32_bf16 v[36:39], a[144:147], a[84:87], v[36:39]
  ds_read_b64_tr_b16 a[180:181], v21 offset:12288
  v_mfma_f32_16x16x32_bf16 v[36:39], a[168:171], a[120:123], v[36:39]
  v_mfma_f32_16x16x32_bf16 v[40:43], a[144:147], a[88:91], v[40:43]
  v_mfma_f32_16x16x32_bf16 v[40:43], a[168:171], a[124:127], v[40:43]
  buffer_load_dwordx4 v225, s[8:11], s46 offen offset:1024 lds
  v_mfma_f32_16x16x32_bf16 v[44:47], a[144:147], a[92:95], v[44:47]
  ds_read_b64_tr_b16 a[182:183], v21 offset:14336
  v_mfma_f32_16x16x32_bf16 v[44:47], a[168:171], a[128:131], v[44:47]
  v_mfma_f32_16x16x32_bf16 v[48:51], a[144:147], a[96:99], v[48:51]
  v_mfma_f32_16x16x32_bf16 v[48:51], a[168:171], a[132:135], v[48:51]
  ds_read_b64_tr_b16 a[160:161], v20 offset:16384
  v_mfma_f32_16x16x32_bf16 v[52:55], a[144:147], a[100:103], v[52:55]
  buffer_load_dwordx4 v226, s[8:11], s46 offen offset:2048 lds
  v_mfma_f32_16x16x32_bf16 v[52:55], a[168:171], a[136:139], v[52:55]
  v_mfma_f32_16x16x32_bf16 v[56:59], a[148:151], a[72:75], v[56:59]
  ds_read_b64_tr_b16 a[162:163], v20 offset:18432
  v_mfma_f32_16x16x32_bf16 v[56:59], a[172:175], a[108:111], v[56:59]
  v_mfma_f32_16x16x32_bf16 v[60:63], a[148:151], a[76:79], v[60:63]
  v_mfma_f32_16x16x32_bf16 v[60:63], a[172:175], a[112:115], v[60:63]
  buffer_load_dwordx4 v227, s[8:11], s46 offen offset:3072 lds
  v_mfma_f32_16x16x32_bf16 v[64:67], a[148:151], a[80:83], v[64:67]
  s_add_u32 m0, s36, 4096
  ds_read_b64_tr_b16 a[184:185], v20 offset:20480
  v_mfma_f32_16x16x32_bf16 v[64:67], a[172:175], a[116:119], v[64:67]
  s_add_u32 s36, s36, s38
  v_mfma_f32_16x16x32_bf16 v[68:71], a[148:151], a[84:87], v[68:71]
  s_add_u32 s37, s37, 1
  v_mfma_f32_16x16x32_bf16 v[68:71], a[172:175], a[120:123], v[68:71]
  buffer_load_dwordx4 v228, s[8:11], s46 offen offset:0 lds
  v_mfma_f32_16x16x32_bf16 v[72:75], a[148:151], a[88:91], v[72:75]
  ds_read_b64_tr_b16 a[186:187], v20 offset:22528
  v_mfma_f32_16x16x32_bf16 v[72:75], a[172:175], a[124:127], v[72:75]
  s_cmp_eq_u32 s37, 3
  s_cselect_b32 s37, 0, s37
  s_cselect_b32 s38, s39, s40
  v_mfma_f32_16x16x32_bf16 v[76:79], a[148:151], a[92:95], v[76:79]
  s_add_u32 s41, s41, s43
  ds_read_b64_tr_b16 a[164:165], v21 offset:16384
  v_mfma_f32_16x16x32_bf16 v[76:79], a[172:175], a[128:131], v[76:79]
  s_sub_u32 s43, 0, s43
  v_mfma_f32_16x16x32_bf16 v[80:83], a[148:151], a[96:99], v[80:83]
  buffer_load_dwordx4 v229, s[8:11], s46 offen offset:1024 lds
  v_mfma_f32_16x16x32_bf16 v[80:83], a[172:175], a[132:135], v[80:83]
  v_mfma_f32_16x16x32_bf16 v[84:87], a[148:151], a[100:103], v[84:87]
  ds_read_b64_tr_b16 a[166:167], v21 offset:18432
  v_mfma_f32_16x16x32_bf16 v[84:87], a[172:175], a[136:139], v[84:87]
  v_mfma_f32_16x16x32_bf16 v[88:91], a[152:155], a[72:75], v[88:91]
  v_mfma_f32_16x16x32_bf16 v[88:91], a[176:179], a[108:111], v[88:91]
  buffer_load_dwordx4 v230, s[8:11], s46 offen offset:2048 lds
  v_mfma_f32_16x16x32_bf16 v[92:95], a[152:155], a[76:79], v[92:95]
  ds_read_b64_tr_b16 a[188:189], v21 offset:20480
  v_mfma_f32_16x16x32_bf16 v[92:95], a[176:179], a[112:115], v[92:95]
  v_mfma_f32_16x16x32_bf16 v[96:99], a[152:155], a[80:83], v[96:99]
  ds_read_b64_tr_b16 a[190:191], v21 offset:22528
  v_mfma_f32_16x16x32_bf16 v[96:99], a[176:179], a[116:119], v[96:99]
  v_add_u32 v16, s38, v16
  v_add_u32 v17, s38, v17
  v_mfma_f32_16x16x32_bf16 v[100:103], a[152:155], a[84:87], v[100:103]
  buffer_load_dwordx4 v231, s[8:11], s46 offen offset:3072 lds
  v_mfma_f32_16x16x32_bf16 v[100:103], a[176:179], a[120:123], v[100:103]
  s_mul_i32 s47, s48, 393216
  v_add_u32 v18, s38, v18
  v_add_u32 v19, s38, v19
  v_mfma_f32_16x16x32_bf16 v[104:107], a[152:155], a[88:91], v[104:107]
  s_bfe_u32 s34, 0x302010e, s49
  v_add_u32 v20, s43, v20
  v_add_u32 v21, s43, v21
  v_mfma_f32_16x16x32_bf16 v[104:107], a[176:179], a[124:127], v[104:107]
  s_add_u32 s48, s48, s34
  v_mfma_f32_16x16x32_bf16 v[108:111], a[152:155], a[92:95], v[108:111]
  s_add_u32 s49, s49, 8
  v_mfma_f32_16x16x32_bf16 v[108:111], a[176:179], a[128:131], v[108:111]
  s_and_b32 s49, s49, 0x8001f
  v_mfma_f32_16x16x32_bf16 v[112:115], a[152:155], a[96:99], v[112:115]
  s_and_b32 s48, s48, 15
  v_mfma_f32_16x16x32_bf16 v[112:115], a[176:179], a[132:135], v[112:115]
  s_lshl_b32 s46, s48, 7
  v_mfma_f32_16x16x32_bf16 v[116:119], a[152:155], a[100:103], v[116:119]
  v_mfma_f32_16x16x32_bf16 v[116:119], a[176:179], a[136:139], v[116:119]
  v_mfma_f32_16x16x32_bf16 v[216:219], a[152:155], a[104:107], v[216:219]
  v_mfma_f32_16x16x32_bf16 v[216:219], a[176:179], a[140:143], v[216:219]
  s_waitcnt vmcnt(9) lgkmcnt(0)
  s_barrier
  v_mfma_f32_16x16x32_bf16 v[120:123], a[156:159], a[72:75], v[120:123]
  buffer_load_dwordx4 a[192:195], v2, s[52:55], s51 offen offset:0
  v_mfma_f32_16x16x32_bf16 v[120:123], a[180:183], a[108:111], v[120:123]
  ds_read_b128 a[0:3], v16 offset:0
  ds_read_b128 a[36:39], v17 offset:0
  v_mfma_f32_16x16x32_bf16 v[124:127], a[156:159], a[76:79], v[124:127]
  ds_read_b64_tr_b16 a[144:145], v20 offset:0
  v_mfma_f32_16x16x32_bf16 v[124:127], a[180:183], a[112:115], v[124:127]
  v_mfma_f32_16x16x32_bf16 v[128:131], a[156:159], a[80:83], v[128:131]
  buffer_load_dwordx4 a[192:195], v2, s[52:55], s51 offen offset:1024
  v_mfma_f32_16x16x32_bf16 v[128:131], a[180:183], a[116:119], v[128:131]
  ds_read_b64_tr_b16 a[146:147], v20 offset:2048
  ds_read_b64_tr_b16 a[168:169], v20 offset:4096
  v_mfma_f32_16x16x32_bf16 v[132:135], a[156:159], a[84:87], v[132:135]
  ds_read_b64_tr_b16 a[170:171], v20 offset:6144
  v_mfma_f32_16x16x32_bf16 v[132:135], a[180:183], a[120:123], v[132:135]
  v_mfma_f32_16x16x32_bf16 v[136:139], a[156:159], a[88:91], v[136:139]
  ds_read_b128 a[4:7], v16 offset:2048
  v_mfma_f32_16x16x32_bf16 v[136:139], a[180:183], a[124:127], v[136:139]
  buffer_load_dwordx4 a[192:195], v2, s[52:55], s51 offen offset:2048
  v_mfma_f32_16x16x32_bf16 v[140:143], a[156:159], a[92:95], v[140:143]
  ds_read_b128 a[40:43], v17 offset:2048
  ds_read_b128 a[8:11], v16 offset:4096
  v_mfma_f32_16x16x32_bf16 v[140:143], a[180:183], a[128:131], v[140:143]
  v_mfma_f32_16x16x32_bf16 v[144:147], a[156:159], a[96:99], v[144:147]
  ds_read_b128 a[44:47], v17 offset:4096
  v_mfma_f32_16x16x32_bf16 v[144:147], a[180:183], a[132:135], v[144:147]
  ds_read_b128 a[12:15], v16 offset:6144
  v_mfma_f32_16x16x32_bf16 v[148:151], a[156:159], a[100:103], v[148:151]
  buffer_load_dwordx4 a[192:195], v2, s[52:55], s51 offen offset:3072
  v_mfma_f32_16x16x32_bf16 v[148:151], a[180:183], a[136:139], v[148:151]
  s_add_u32 s51, s51, 4096
  s_add_u32 s0, s0, 1
  s_cmp_eq_u32 s0, 2
  s_cselect_b32 s52, s68, s52
  s_cselect_b32 s53, s69, s53
  s_cselect_b32 s51, s1, s51
  s_cselect_b32 s54, 0, s54
  v_mfma_f32_16x16x32_bf16 v[220:223], a[156:159], a[104:107], v[220:223]
  s_cmp_eq_u32 s0, 6
  s_cselect_b32 s52, s64, s52
  s_cselect_b32 s53, s65, s53
  s_cselect_b32 s51, s56, s51
  s_cselect_b32 s54, 0, s54
  v_mfma_f32_16x16x32_bf16 v[220:223], a[180:183], a[140:143], v[220:223]
  s_cmp_eq_u32 s0, 8
  s_cselect_b32 s54, 0, s54
  s_mov_b32 m0, s41
  v_mfma_f32_16x16x32_bf16 v[152:155], a[72:75], a[160:163], v[152:155]
  ds_read_b128 a[48:51], v17 offset:6144
  ds_read_b128 a[16:19], v16 offset:8192
  v_mfma_f32_16x16x32_bf16 v[152:155], a[108:111], a[184:187], v[152:155]
  buffer_load_dwordx4 v233, s[12:15], s47 offen offset:0 lds
  v_mfma_f32_16x16x32_bf16 v[156:159], a[76:79], a[160:163], v[156:159]
  ds_read_b128 a[52:55], v17 offset:8192
  ds_read_b128 a[20:23], v16 offset:10240
  v_mfma_f32_16x16x32_bf16 v[156:159], a[112:115], a[184:187], v[156:159]
  ds_read_b128 a[56:59], v17 offset:10240
  ds_read_b128 a[24:27], v16 offset:12288
  v_mfma_f32_16x16x32_bf16 v[160:163], a[80:83], a[160:163], v[160:163]
  ds_read_b128 a[60:63], v17 offset:12288
  v_mfma_f32_16x16x32_bf16 v[160:163], a[116:119], a[184:187], v[160:163]
  v_mfma_f32_16x16x32_bf16 v[164:167], a[84:87], a[160:163], v[164:167]
  buffer_load_dwordx4 v234, s[12:15], s47 offen offset:1024 lds
  v_mfma_f32_16x16x32_bf16 v[164:167], a[120:123], a[184:187], v[164:167]
  ds_read_b128 a[28:31], v16 offset:14336
  ds_read_b128 a[64:67], v17 offset:14336
  v_mfma_f32_16x16x32_bf16 v[168:171], a[88:91], a[160:163], v[168:171]
  ds_read_b64_tr_b16 a[148:149], v21 offset:0
  v_mfma_f32_16x16x32_bf16 v[168:171], a[124:127], a[184:187], v[168:171]
  v_mfma_f32_16x16x32_bf16 v[172:175], a[92:95], a[160:163], v[172:175]
  ds_read_b64_tr_b16 a[150:151], v21 offset:2048
  v_mfma_f32_16x16x32_bf16 v[172:175], a[128:131], a[184:187], v[172:175]
  buffer_load_dwordx4 v235, s[12:15], s47 offen offset:2048 lds
  v_mfma_f32_16x16x32_bf16 v[176:179], a[96:99], a[160:163], v[176:179]
  s_add_u32 m0, s41, 3072
  ds_read_b64_tr_b16 a[172:173], v21 offset:4096
  ds_read_b64_tr_b16 a[174:175], v21 offset:6144
  v_mfma_f32_16x16x32_bf16 v[176:179], a[132:135], a[184:187], v[176:179]
  v_mfma_f32_16x16x32_bf16 v[180:183], a[100:103], a[160:163], v[180:183]
  ds_read_b64_tr_b16 a[152:153], v20 offset:8192
  v_mfma_f32_16x16x32_bf16 v[180:183], a[136:139], a[184:187], v[180:183]
  ds_read_b64_tr_b16 a[154:155], v20 offset:10240
  v_mfma_f32_16x16x32_bf16 v[184:187], a[72:75], a[164:167], v[184:187]
  buffer_load_dwordx4 v236, s[12:15], s47 offen offset:0 lds
  v_mfma_f32_16x16x32_bf16 v[184:187], a[108:111], a[188:191], v[184:187]
  ds_read_b64_tr_b16 a[176:177], v20 offset:12288
  v_mfma_f32_16x16x32_bf16 v[188:191], a[76:79], a[164:167], v[188:191]
  ds_read_b64_tr_b16 a[178:179], v20 offset:14336
  v_mfma_f32_16x16x32_bf16 v[188:191], a[112:115], a[188:191], v[188:191]
  ds_read_b128 a[32:35], v18 offset:0
  v_mfma_f32_16x16x32_bf16 v[192:195], a[80:83], a[164:167], v[192:195]
  ds_read_b128 a[68:71], v19 offset:0
  v_mfma_f32_16x16x32_bf16 v[192:195], a[116:119], a[188:191], v[192:195]
  buffer_load_dwordx4 v237, s[12:15], s47 offen offset:1024 lds
  v_mfma_f32_16x16x32_bf16 v[196:199], a[84:87], a[164:167], v[196:199]
  v_mfma_f32_16x16x32_bf16 v[196:199], a[120:123], a[188:191], v[196:199]
  v_mfma_f32_16x16x32_bf16 v[200:203], a[88:91], a[164:167], v[200:203]
  v_mfma_f32_16x16x32_bf16 v[200:203], a[124:127], a[188:191], v[200:203]
  v_mfma_f32_16x16x32_bf16 v[204:207], a[92:95], a[164:167], v[204:207]
  buffer_load_dwordx4 v238, s[12:15], s47 offen offset:2048 lds
  v_mfma_f32_16x16x32_bf16 v[204:207], a[128:131], a[188:191], v[204:207]
  v_mfma_f32_16x16x32_bf16 v[208:211], a[96:99], a[164:167], v[208:211]
  v_mfma_f32_16x16x32_bf16 v[208:211], a[132:135], a[188:191], v[208:211]
  v_mfma_f32_16x16x32_bf16 v[212:215], a[100:103], a[164:167], v[212:215]
  v_mfma_f32_16x16x32_bf16 v[212:215], a[136:139], a[188:191], v[212:215]
  s_waitcnt lgkmcnt(0)
  v_mfma_f32_16x16x32_bf16 v[24:27], a[144:147], a[0:3], v[24:27]
  s_add_u32 m0, s36, s50
  ds_read_b64_tr_b16 a[156:157], v21 offset:8192
  v_mfma_f32_16x16x32_bf16 v[24:27], a[168:171], a[36:39], v[24:27]
  buffer_load_dwordx4 v232, s[8:11], s46 offen offset:0 lds
  v_mfma_f32_16x16x32_bf16 v[28:31], a[144:147], a[4:7], v[28:31]
  s_mov_b32 m0, s36
  v_mfma_f32_16x16x32_bf16 v[28:31], a[168:171], a[40:43], v[28:31]
  ds_read_b64_tr_b16 a[158:159], v21 offset:10240
  v_mfma_f32_16x16x32_bf16 v[32:35], a[144:147], a[8:11], v[32:35]
  buffer_load_dwordx4 v224, s[8:11], s46 offen offset:0 lds
  v_mfma_f32_16x16x32_bf16 v[32:35], a[168:171], a[44:47], v[32:35]
  v_mfma_f32_16x16x32_bf16 v[36:39], a[144:147], a[12:15], v[36:39]
  ds_read_b64_tr_b16 a[180:181], v21 offset:12288
  v_mfma_f32_16x16x32_bf16 v[36:39], a[168:171], a[48:51], v[36:39]
  v_mfma_f32_16x16x32_bf16 v[40:43], a[144:147], a[16:19], v[40:43]
  v_mfma_f32_16x16x32_bf16 v[40:43], a[168:171], a[52:55], v[40:43]
  buffer_load_dwordx4 v225, s[8:11], s46 offen offset:1024 lds
  v_mfma_f32_16x16x32_bf16 v[44:47], a[144:147], a[20:23], v[44:47]
  ds_read_b64_tr_b16 a[182:183], v21 offset:14336
  v_mfma_f32_16x16x32_bf16 v[44:47], a[168:171], a[56:59], v[44:47]
  v_mfma_f32_16x16x32_bf16 v[48:51], a[144:147], a[24:27], v[48:51]
  v_mfma_f32_16x16x32_bf16 v[48:51], a[168:171], a[60:63], v[48:51]
  ds_read_b64_tr_b16 a[160:161], v20 offset:16384
  v_mfma_f32_16x16x32_bf16 v[52:55], a[144:147], a[28:31], v[52:55]
  buffer_load_dwordx4 v226, s[8:11], s46 offen offset:2048 lds
  v_mfma_f32_16x16x32_bf16 v[52:55], a[168:171], a[64:67], v[52:55]
  v_mfma_f32_16x16x32_bf16 v[56:59], a[148:151], a[0:3], v[56:59]
  ds_read_b64_tr_b16 a[162:163], v20 offset:18432
  v_mfma_f32_16x16x32_bf16 v[56:59], a[172:175], a[36:39], v[56:59]
  v_mfma_f32_16x16x32_bf16 v[60:63], a[148:151], a[4:7], v[60:63]
  v_mfma_f32_16x16x32_bf16 v[60:63], a[172:175], a[40:43], v[60:63]
  buffer_load_dwordx4 v227, s[8:11], s46 offen offset:3072 lds
  v_mfma_f32_16x16x32_bf16 v[64:67], a[148:151], a[8:11], v[64:67]
  s_add_u32 m0, s36, 4096
  ds_read_b64_tr_b16 a[184:185], v20 offset:20480
  v_mfma_f32_16x16x32_bf16 v[64:67], a[172:175], a[44:47], v[64:67]
  s_add_u32 s36, s36, s38
  v_mfma_f32_16x16x32_bf16 v[68:71], a[148:151], a[12:15], v[68:71]
  s_add_u32 s37, s37, 1
  v_mfma_f32_16x16x32_bf16 v[68:71], a[172:175], a[48:51], v[68:71]
  buffer_load_dwordx4 v228, s[8:11], s46 offen offset:0 lds
  v_mfma_f32_16x16x32_bf16 v[72:75], a[148:151], a[16:19], v[72:75]
  ds_read_b64_tr_b16 a[186:187], v20 offset:22528
  v_mfma_f32_16x16x32_bf16 v[72:75], a[172:175], a[52:55], v[72:75]
  s_cmp_eq_u32 s37, 3
  s_cselect_b32 s37, 0, s37
  s_cselect_b32 s38, s39, s40
  v_mfma_f32_16x16x32_bf16 v[76:79], a[148:151], a[20:23], v[76:79]
  s_add_u32 s41, s41, s43
  ds_read_b64_tr_b16 a[164:165], v21 offset:16384
  v_mfma_f32_16x16x32_bf16 v[76:79], a[172:175], a[56:59], v[76:79]
  s_sub_u32 s43, 0, s43
  v_mfma_f32_16x16x32_bf16 v[80:83], a[148:151], a[24:27], v[80:83]
  buffer_load_dwordx4 v229, s[8:11], s46 offen offset:1024 lds
  v_mfma_f32_16x16x32_bf16 v[80:83], a[172:175], a[60:63], v[80:83]
  v_mfma_f32_16x16x32_bf16 v[84:87], a[148:151], a[28:31], v[84:87]
  ds_read_b64_tr_b16 a[166:167], v21 offset:18432
  v_mfma_f32_16x16x32_bf16 v[84:87], a[172:175], a[64:67], v[84:87]
  v_mfma_f32_16x16x32_bf16 v[88:91], a[152:155], a[0:3], v[88:91]
  v_mfma_f32_16x16x32_bf16 v[88:91], a[176:179], a[36:39], v[88:91]
  buffer_load_dwordx4 v230, s[8:11], s46 offen offset:2048 lds
  v_mfma_f32_16x16x32_bf16 v[92:95], a[152:155], a[4:7], v[92:95]
  ds_read_b64_tr_b16 a[188:189], v21 offset:20480
  v_mfma_f32_16x16x32_bf16 v[92:95], a[176:179], a[40:43], v[92:95]
  v_mfma_f32_16x16x32_bf16 v[96:99], a[152:155], a[8:11], v[96:99]
  ds_read_b64_tr_b16 a[190:191], v21 offset:22528
  v_mfma_f32_16x16x32_bf16 v[96:99], a[176:179], a[44:47], v[96:99]
  v_add_u32 v16, s38, v16
  v_add_u32 v17, s38, v17
  v_mfma_f32_16x16x32_bf16 v[100:103], a[152:155], a[12:15], v[100:103]
  buffer_load_dwordx4 v231, s[8:11], s46 offen offset:3072 lds
  v_mfma_f32_16x16x32_bf16 v[100:103], a[176:179], a[48:51], v[100:103]
  s_mul_i32 s47, s48, 393216
  v_add_u32 v18, s38, v18
  v_add_u32 v19, s38, v19
  v_mfma_f32_16x16x32_bf16 v[104:107], a[152:155], a[16:19], v[104:107]
  s_bfe_u32 s34, 0x302010e, s49
  v_add_u32 v20, s43, v20
  v_add_u32 v21, s43, v21
  v_mfma_f32_16x16x32_bf16 v[104:107], a[176:179], a[52:55], v[104:107]
  s_add_u32 s48, s48, s34
  v_mfma_f32_16x16x32_bf16 v[108:111], a[152:155], a[20:23], v[108:111]
  s_add_u32 s49, s49, 8
  v_mfma_f32_16x16x32_bf16 v[108:111], a[176:179], a[56:59], v[108:111]
  s_and_b32 s49, s49, 0x8001f
  v_mfma_f32_16x16x32_bf16 v[112:115], a[152:155], a[24:27], v[112:115]
  s_and_b32 s48, s48, 15
  v_mfma_f32_16x16x32_bf16 v[112:115], a[176:179], a[60:63], v[112:115]
  s_lshl_b32 s46, s48, 7
  v_mfma_f32_16x16x32_bf16 v[116:119], a[152:155], a[28:31], v[116:119]
  v_mfma_f32_16x16x32_bf16 v[116:119], a[176:179], a[64:67], v[116:119]
  s_waitcnt vmcnt(9) lgkmcnt(0)
  s_barrier
  v_mfma_f32_16x16x32_bf16 v[216:219], a[152:155], a[32:35], v[216:219]
  s_sub_u32 s35, s35, 1
  v_mfma_f32_16x16x32_bf16 v[216:219], a[176:179], a[68:71], v[216:219]
  s_cmp_lg_u32 s35, 0
  s_cbranch_scc1 Lp2r0_loop
  v_accvgpr_read_b32 v4, a222
  v_accvgpr_read_b32 v5, a223
  v_accvgpr_read_b32 v6, a224
  v_accvgpr_read_b32 v7, a225
  v_accvgpr_read_b32 v8, a226
  v_accvgpr_read_b32 v9, a227
  v_accvgpr_read_b32 v10, a228
  v_accvgpr_read_b32 v11, a229
  s_mov_b32 s8, s64
  s_mov_b32 s9, s65
  s_mov_b32 s10, 4194304
  s_mov_b32 s11, 0x00020000
  s_mov_b32 s20, s68
  s_mov_b32 s21, s69
  s_mov_b32 s22, 8388608
  s_mov_b32 s23, 0x00020000
  s_and_b32 s4, s2, 7
  s_lshl_b32 s4, s4, 1
  s_lshr_b32 s5, s2, 6
  s_lshr_b32 s30, s2, 4
  s_add_u32 s5, s5, s30
  s_and_b32 s53, s5, 3
  s_lshl_b32 s53, s53, 3
  s_or_b32 s53, s53, 0x80000
  s_bfe_u32 s52, 0xf0f02, s53
  s_add_u32 s52, s52, s4
  s_and_b32 s52, s52, 15
  s_mov_b32 s54, s52
  s_mov_b32 s55, s53
  s_lshl_b32 s29, s52, 7
  s_lshl_b32 s28, s54, 19
  s_lshl_b32 s30, s25, 18
  s_and_b32 s31, s25, 1
  s_lshl_b32 s31, s31, 1
  s_add_u32 s31, s31, 14
  s_sub_u32 s31, s31, s25
  s_lshl_b32 s31, s31, 18
  s_or_b32 s26, s30, s29
  s_or_b32 s27, s31, s29
  s_lshl_b32 s68, s3, 12
  s_lshl_b32 s88, s3, 13
  s_add_u32 s88, s88, 98304
  v_mfma_f32_16x16x32_bf16 v[120:123], a[156:159], a[0:3], v[120:123]
  s_mov_b32 m0, s41
  ds_read_b128 a[72:75], v16 offset:0
  v_mfma_f32_16x16x32_bf16 v[120:123], a[180:183], a[36:39], v[120:123]
  buffer_load_dwordx4 v233, s[12:15], s47 offen offset:0 lds
  v_mfma_f32_16x16x32_bf16 v[124:127], a[156:159], a[4:7], v[124:127]
  ds_read_b128 a[108:111], v17 offset:0
  ds_read_b64_tr_b16 a[144:145], v20 offset:0
  v_mfma_f32_16x16x32_bf16 v[124:127], a[180:183], a[40:43], v[124:127]
  v_mfma_f32_16x16x32_bf16 v[128:131], a[156:159], a[8:11], v[128:131]
  ds_read_b64_tr_b16 a[146:147], v20 offset:2048
  v_mfma_f32_16x16x32_bf16 v[128:131], a[180:183], a[44:47], v[128:131]
  ds_read_b64_tr_b16 a[168:169], v20 offset:4096
  v_mfma_f32_16x16x32_bf16 v[132:135], a[156:159], a[12:15], v[132:135]
  ds_read_b64_tr_b16 a[170:171], v20 offset:6144
  v_mfma_f32_16x16x32_bf16 v[132:135], a[180:183], a[48:51], v[132:135]
  v_mfma_f32_16x16x32_bf16 v[136:139], a[156:159], a[16:19], v[136:139]
  ds_read_b128 a[76:79], v16 offset:2048
  v_mfma_f32_16x16x32_bf16 v[136:139], a[180:183], a[52:55], v[136:139]
  ds_read_b128 a[112:115], v17 offset:2048
  v_mfma_f32_16x16x32_bf16 v[140:143], a[156:159], a[20:23], v[140:143]
  ds_read_b128 a[80:83], v16 offset:4096
  v_mfma_f32_16x16x32_bf16 v[140:143], a[180:183], a[56:59], v[140:143]
  v_mfma_f32_16x16x32_bf16 v[144:147], a[156:159], a[24:27], v[144:147]
  ds_read_b128 a[116:119], v17 offset:4096
  v_mfma_f32_16x16x32_bf16 v[144:147], a[180:183], a[60:63], v[144:147]
  ds_read_b128 a[84:87], v16 offset:6144
  v_mfma_f32_16x16x32_bf16 v[148:151], a[156:159], a[28:31], v[148:151]
  ds_read_b128 a[120:123], v17 offset:6144
  v_mfma_f32_16x16x32_bf16 v[148:151], a[180:183], a[64:67], v[148:151]
  v_mfma_f32_16x16x32_bf16 v[220:223], a[156:159], a[32:35], v[220:223]
  buffer_load_dwordx4 v234, s[12:15], s47 offen offset:1024 lds
  v_mfma_f32_16x16x32_bf16 v[220:223], a[180:183], a[68:71], v[220:223]
  ds_read_b128 a[88:91], v16 offset:8192
  ds_read_b128 a[124:127], v17 offset:8192
  v_mfma_f32_16x16x32_bf16 v[152:155], a[0:3], a[160:163], v[152:155]
  ds_read_b128 a[92:95], v16 offset:10240
  v_mfma_f32_16x16x32_bf16 v[152:155], a[36:39], a[184:187], v[152:155]
  v_mfma_f32_16x16x32_bf16 v[156:159], a[4:7], a[160:163], v[156:159]
  ds_read_b128 a[128:131], v17 offset:10240
  v_mfma_f32_16x16x32_bf16 v[156:159], a[40:43], a[184:187], v[156:159]
  ds_read_b128 a[96:99], v16 offset:12288
  v_mfma_f32_16x16x32_bf16 v[160:163], a[8:11], a[160:163], v[160:163]
  ds_read_b128 a[132:135], v17 offset:12288
  v_mfma_f32_16x16x32_bf16 v[160:163], a[44:47], a[184:187], v[160:163]
  v_mfma_f32_16x16x32_bf16 v[164:167], a[12:15], a[160:163], v[164:167]
  ds_read_b128 a[100:103], v16 offset:14336
  v_mfma_f32_16x16x32_bf16 v[164:167], a[48:51], a[184:187], v[164:167]
  ds_read_b128 a[136:139], v17 offset:14336
  v_mfma_f32_16x16x32_bf16 v[168:171], a[16:19], a[160:163], v[168:171]
  ds_read_b64_tr_b16 a[148:149], v21 offset:0
  v_mfma_f32_16x16x32_bf16 v[168:171], a[52:55], a[184:187], v[168:171]
  v_mfma_f32_16x16x32_bf16 v[172:175], a[20:23], a[160:163], v[172:175]
  ds_read_b64_tr_b16 a[150:151], v21 offset:2048
  v_mfma_f32_16x16x32_bf16 v[172:175], a[56:59], a[184:187], v[172:175]
  ds_read_b64_tr_b16 a[172:173], v21 offset:4096
  v_mfma_f32_16x16x32_bf16 v[176:179], a[24:27], a[160:163], v[176:179]
  ds_read_b64_tr_b16 a[174:175], v21 offset:6144
  v_mfma_f32_16x16x32_bf16 v[176:179], a[60:63], a[184:187], v[176:179]
  v_mfma_f32_16x16x32_bf16 v[180:183], a[28:31], a[160:163], v[180:183]
  buffer_load_dwordx4 v235, s[12:15], s47 offen offset:2048 lds
  v_mfma_f32_16x16x32_bf16 v[180:183], a[64:67], a[184:187], v[180:183]
  ds_read_b64_tr_b16 a[152:153], v20 offset:8192
  ds_read_b64_tr_b16 a[154:155], v20 offset:10240
  v_mfma_f32_16x16x32_bf16 v[184:187], a[0:3], a[164:167], v[184:187]
  ds_read_b64_tr_b16 a[176:177], v20 offset:12288
  v_mfma_f32_16x16x32_bf16 v[184:187], a[36:39], a[188:191], v[184:187]
  v_mfma_f32_16x16x32_bf16 v[188:191], a[4:7], a[164:167], v[188:191]
  ds_read_b64_tr_b16 a[178:179], v20 offset:14336
  v_mfma_f32_16x16x32_bf16 v[188:191], a[40:43], a[188:191], v[188:191]
  ds_read_b128 a[104:107], v18 offset:0
  v_mfma_f32_16x16x32_bf16 v[192:195], a[8:11], a[164:167], v[192:195]
  ds_read_b128 a[140:143], v19 offset:0
  v_mfma_f32_16x16x32_bf16 v[192:195], a[44:47], a[188:191], v[192:195]
  v_mfma_f32_16x16x32_bf16 v[196:199], a[12:15], a[164:167], v[196:199]
  v_mfma_f32_16x16x32_bf16 v[196:199], a[48:51], a[188:191], v[196:199]
  v_mfma_f32_16x16x32_bf16 v[200:203], a[16:19], a[164:167], v[200:203]
  v_mfma_f32_16x16x32_bf16 v[200:203], a[52:55], a[188:191], v[200:203]
  v_mfma_f32_16x16x32_bf16 v[204:207], a[20:23], a[164:167], v[204:207]
  v_mfma_f32_16x16x32_bf16 v[204:207], a[56:59], a[188:191], v[204:207]
  v_mfma_f32_16x16x32_bf16 v[208:211], a[24:27], a[164:167], v[208:211]
  v_mfma_f32_16x16x32_bf16 v[208:211], a[60:63], a[188:191], v[208:211]
  v_mfma_f32_16x16x32_bf16 v[212:215], a[28:31], a[164:167], v[212:215]
  v_mfma_f32_16x16x32_bf16 v[212:215], a[64:67], a[188:191], v[212:215]
  s_waitcnt lgkmcnt(0)
  v_mfma_f32_16x16x32_bf16 v[24:27], a[144:147], a[72:75], v[24:27]
  s_add_u32 m0, s41, 3072
  ds_read_b64_tr_b16 a[156:157], v21 offset:8192
  v_mfma_f32_16x16x32_bf16 v[24:27], a[168:171], a[108:111], v[24:27]
  buffer_load_dwordx4 v236, s[12:15], s47 offen offset:0 lds
  v_mfma_f32_16x16x32_bf16 v[28:31], a[144:147], a[76:79], v[28:31]
  s_add_u32 s36, s36, s38
  v_mfma_f32_16x16x32_bf16 v[28:31], a[168:171], a[112:115], v[28:31]
  s_add_u32 s37, s37, 1
  ds_read_b64_tr_b16 a[158:159], v21 offset:10240
  v_mfma_f32_16x16x32_bf16 v[32:35], a[144:147], a[80:83], v[32:35]
  s_cmp_eq_u32 s37, 3
  s_cselect_b32 s37, 0, s37
  s_cselect_b32 s38, s39, s40
  v_mfma_f32_16x16x32_bf16 v[32:35], a[168:171], a[116:119], v[32:35]
  s_add_u32 s41, s41, s43
  v_mfma_f32_16x16x32_bf16 v[36:39], a[144:147], a[84:87], v[36:39]
  s_sub_u32 s43, 0, s43
  ds_read_b64_tr_b16 a[180:181], v21 offset:12288
  v_mfma_f32_16x16x32_bf16 v[36:39], a[168:171], a[120:123], v[36:39]
  v_mfma_f32_16x16x32_bf16 v[40:43], a[144:147], a[88:91], v[40:43]
  v_mfma_f32_16x16x32_bf16 v[40:43], a[168:171], a[124:127], v[40:43]
  v_mfma_f32_16x16x32_bf16 v[44:47], a[144:147], a[92:95], v[44:47]
  ds_read_b64_tr_b16 a[182:183], v21 offset:14336
  v_mfma_f32_16x16x32_bf16 v[44:47], a[168:171], a[128:131], v[44:47]
  v_mfma_f32_16x16x32_bf16 v[48:51], a[144:147], a[96:99], v[48:51]
  v_mfma_f32_16x16x32_bf16 v[48:51], a[168:171], a[132:135], v[48:51]
  ds_read_b64_tr_b16 a[160:161], v20 offset:16384
  v_mfma_f32_16x16x32_bf16 v[52:55], a[144:147], a[100:103], v[52:55]
  buffer_load_dwordx4 v237, s[12:15], s47 offen offset:1024 lds
  v_mfma_f32_16x16x32_bf16 v[52:55], a[168:171], a[136:139], v[52:55]
  v_mfma_f32_16x16x32_bf16 v[56:59], a[148:151], a[72:75], v[56:59]
  ds_read_b64_tr_b16 a[162:163], v20 offset:18432
  v_mfma_f32_16x16x32_bf16 v[56:59], a[172:175], a[108:111], v[56:59]
  v_mfma_f32_16x16x32_bf16 v[60:63], a[148:151], a[76:79], v[60:63]
  v_mfma_f32_16x16x32_bf16 v[60:63], a[172:175], a[112:115], v[60:63]
  v_mfma_f32_16x16x32_bf16 v[64:67], a[148:151], a[80:83], v[64:67]
  ds_read_b64_tr_b16 a[184:185], v20 offset:20480
  v_mfma_f32_16x16x32_bf16 v[64:67], a[172:175], a[116:119], v[64:67]
  v_mfma_f32_16x16x32_bf16 v[68:71], a[148:151], a[84:87], v[68:71]
  v_mfma_f32_16x16x32_bf16 v[68:71], a[172:175], a[120:123], v[68:71]
  ds_read_b64_tr_b16 a[186:187], v20 offset:22528
  v_mfma_f32_16x16x32_bf16 v[72:75], a[148:151], a[88:91], v[72:75]
  v_mfma_f32_16x16x32_bf16 v[72:75], a[172:175], a[124:127], v[72:75]
  v_mfma_f32_16x16x32_bf16 v[76:79], a[148:151], a[92:95], v[76:79]
  ds_read_b64_tr_b16 a[164:165], v21 offset:16384
  v_mfma_f32_16x16x32_bf16 v[76:79], a[172:175], a[128:131], v[76:79]
  v_mfma_f32_16x16x32_bf16 v[80:83], a[148:151], a[96:99], v[80:83]
  buffer_load_dwordx4 v238, s[12:15], s47 offen offset:2048 lds
  v_mfma_f32_16x16x32_bf16 v[80:83], a[172:175], a[132:135], v[80:83]
  v_mfma_f32_16x16x32_bf16 v[84:87], a[148:151], a[100:103], v[84:87]
  ds_read_b64_tr_b16 a[166:167], v21 offset:18432
  v_mfma_f32_16x16x32_bf16 v[84:87], a[172:175], a[136:139], v[84:87]
  v_mfma_f32_16x16x32_bf16 v[88:91], a[152:155], a[72:75], v[88:91]
  v_mfma_f32_16x16x32_bf16 v[88:91], a[176:179], a[108:111], v[88:91]
  ds_read_b64_tr_b16 a[188:189], v21 offset:20480
  v_mfma_f32_16x16x32_bf16 v[92:95], a[152:155], a[76:79], v[92:95]
  v_mfma_f32_16x16x32_bf16 v[92:95], a[176:179], a[112:115], v[92:95]
  v_mfma_f32_16x16x32_bf16 v[96:99], a[152:155], a[80:83], v[96:99]
  ds_read_b64_tr_b16 a[190:191], v21 offset:22528
  v_mfma_f32_16x16x32_bf16 v[96:99], a[176:179], a[116:119], v[96:99]
  v_add_u32 v16, s38, v16
  v_add_u32 v17, s38, v17
  v_mfma_f32_16x16x32_bf16 v[100:103], a[152:155], a[84:87], v[100:103]
  v_add_u32 v18, s38, v18
  v_add_u32 v19, s38, v19
  v_mfma_f32_16x16x32_bf16 v[100:103], a[176:179], a[120:123], v[100:103]
  v_add_u32 v20, s43, v20
  v_add_u32 v21, s43, v21
  v_mfma_f32_16x16x32_bf16 v[104:107], a[152:155], a[88:91], v[104:107]
  v_mfma_f32_16x16x32_bf16 v[104:107], a[176:179], a[124:127], v[104:107]
  v_mfma_f32_16x16x32_bf16 v[108:111], a[152:155], a[92:95], v[108:111]
  v_mfma_f32_16x16x32_bf16 v[108:111], a[176:179], a[128:131], v[108:111]
  v_mfma_f32_16x16x32_bf16 v[112:115], a[152:155], a[96:99], v[112:115]
  v_mfma_f32_16x16x32_bf16 v[112:115], a[176:179], a[132:135], v[112:115]
  v_mfma_f32_16x16x32_bf16 v[116:119], a[152:155], a[100:103], v[116:119]
  v_mfma_f32_16x16x32_bf16 v[116:119], a[176:179], a[136:139], v[116:119]
  v_mfma_f32_16x16x32_bf16 v[216:219], a[152:155], a[104:107], v[216:219]
  v_mfma_f32_16x16x32_bf16 v[216:219], a[176:179], a[140:143], v[216:219]
  s_waitcnt vmcnt(0) lgkmcnt(0)
  s_barrier
  s_mov_b32 s6, 0x3e8293ee
  s_mov_b32 s7, s6
  v_mfma_f32_16x16x32_bf16 v[120:123], a[156:159], a[72:75], v[120:123]
  ds_read_b128 a[0:3], v16 offset:0
  v_mfma_f32_16x16x32_bf16 v[120:123], a[180:183], a[108:111], v[120:123]
  ds_read_b128 a[36:39], v17 offset:0
  v_mfma_f32_16x16x32_bf16 v[124:127], a[156:159], a[76:79], v[124:127]
  ds_read_b64_tr_b16 a[144:145], v20 offset:0
  v_mfma_f32_16x16x32_bf16 v[124:127], a[180:183], a[112:115], v[124:127]
  v_mfma_f32_16x16x32_bf16 v[128:131], a[156:159], a[80:83], v[128:131]
  ds_read_b64_tr_b16 a[146:147], v20 offset:2048
  v_mfma_f32_16x16x32_bf16 v[128:131], a[180:183], a[116:119], v[128:131]
  ds_read_b64_tr_b16 a[168:169], v20 offset:4096
  v_mfma_f32_16x16x32_bf16 v[132:135], a[156:159], a[84:87], v[132:135]
  ds_read_b64_tr_b16 a[170:171], v20 offset:6144
  v_mfma_f32_16x16x32_bf16 v[132:135], a[180:183], a[120:123], v[132:135]
  v_mfma_f32_16x16x32_bf16 v[136:139], a[156:159], a[88:91], v[136:139]
  ds_read_b128 a[4:7], v16 offset:2048
  v_mfma_f32_16x16x32_bf16 v[136:139], a[180:183], a[124:127], v[136:139]
  ds_read_b128 a[40:43], v17 offset:2048
  v_mfma_f32_16x16x32_bf16 v[140:143], a[156:159], a[92:95], v[140:143]
  ds_read_b128 a[8:11], v16 offset:4096
  v_mfma_f32_16x16x32_bf16 v[140:143], a[180:183], a[128:131], v[140:143]
  v_mfma_f32_16x16x32_bf16 v[144:147], a[156:159], a[96:99], v[144:147]
  ds_read_b128 a[44:47], v17 offset:4096
  v_mfma_f32_16x16x32_bf16 v[144:147], a[180:183], a[132:135], v[144:147]
  ds_read_b128 a[12:15], v16 offset:6144
  v_mfma_f32_16x16x32_bf16 v[148:151], a[156:159], a[100:103], v[148:151]
  ds_read_b128 a[48:51], v17 offset:6144
  v_mfma_f32_16x16x32_bf16 v[148:151], a[180:183], a[136:139], v[148:151]
  v_mfma_f32_16x16x32_bf16 v[220:223], a[156:159], a[104:107], v[220:223]
  ds_read_b128 a[16:19], v16 offset:8192
  v_mfma_f32_16x16x32_bf16 v[220:223], a[180:183], a[140:143], v[220:223]
  ds_read_b128 a[52:55], v17 offset:8192
  v_mfma_f32_16x16x32_bf16 v[152:155], a[72:75], a[160:163], v[152:155]
  ds_read_b128 a[20:23], v16 offset:10240
  v_mfma_f32_16x16x32_bf16 v[152:155], a[108:111], a[184:187], v[152:155]
  v_mfma_f32_16x16x32_bf16 v[156:159], a[76:79], a[160:163], v[156:159]
  ds_read_b128 a[56:59], v17 offset:10240
  v_mfma_f32_16x16x32_bf16 v[156:159], a[112:115], a[184:187], v[156:159]
  ds_read_b128 a[24:27], v16 offset:12288
  v_mfma_f32_16x16x32_bf16 v[160:163], a[80:83], a[160:163], v[160:163]
  ds_read_b128 a[60:63], v17 offset:12288
  v_mfma_f32_16x16x32_bf16 v[160:163], a[116:119], a[184:187], v[160:163]
  v_mfma_f32_16x16x32_bf16 v[164:167], a[84:87], a[160:163], v[164:167]
  ds_read_b128 a[28:31], v16 offset:14336
  v_mfma_f32_16x16x32_bf16 v[164:167], a[120:123], a[184:187], v[164:167]
  ds_read_b128 a[64:67], v17 offset:14336
  v_mfma_f32_16x16x32_bf16 v[168:171], a[88:91], a[160:163], v[168:171]
  ds_read_b64_tr_b16 a[148:149], v21 offset:0
  v_mfma_f32_16x16x32_bf16 v[168:171], a[124:127], a[184:187], v[168:171]
  v_mfma_f32_16x16x32_bf16 v[172:175], a[92:95], a[160:163], v[172:175]
  ds_read_b64_tr_b16 a[150:151], v21 offset:2048
  v_mfma_f32_16x16x32_bf16 v[172:175], a[128:131], a[184:187], v[172:175]
  ds_read_b64_tr_b16 a[172:173], v21 offset:4096
  v_mfma_f32_16x16x32_bf16 v[176:179], a[96:99], a[160:163], v[176:179]
  ds_read_b64_tr_b16 a[174:175], v21 offset:6144
  v_mfma_f32_16x16x32_bf16 v[176:179], a[132:135], a[184:187], v[176:179]
  v_mfma_f32_16x16x32_bf16 v[180:183], a[100:103], a[160:163], v[180:183]
  ds_read_b64_tr_b16 a[152:153], v20 offset:8192
  v_mfma_f32_16x16x32_bf16 v[180:183], a[136:139], a[184:187], v[180:183]
  ds_read_b64_tr_b16 a[154:155], v20 offset:10240
  v_mfma_f32_16x16x32_bf16 v[184:187], a[72:75], a[164:167], v[184:187]
  ds_read_b64_tr_b16 a[176:177], v20 offset:12288
  v_mfma_f32_16x16x32_bf16 v[184:187], a[108:111], a[188:191], v[184:187]
  v_mfma_f32_16x16x32_bf16 v[188:191], a[76:79], a[164:167], v[188:191]
  ds_read_b64_tr_b16 a[178:179], v20 offset:14336
  v_mfma_f32_16x16x32_bf16 v[188:191], a[112:115], a[188:191], v[188:191]
  ds_read_b128 a[32:35], v18 offset:0
  v_mfma_f32_16x16x32_bf16 v[192:195], a[80:83], a[164:167], v[192:195]
  ds_read_b128 a[68:71], v19 offset:0
  v_mfma_f32_16x16x32_bf16 v[192:195], a[116:119], a[188:191], v[192:195]
  v_mfma_f32_16x16x32_bf16 v[196:199], a[84:87], a[164:167], v[196:199]
  v_mfma_f32_16x16x32_bf16 v[196:199], a[120:123], a[188:191], v[196:199]
  v_mfma_f32_16x16x32_bf16 v[200:203], a[88:91], a[164:167], v[200:203]
  v_mfma_f32_16x16x32_bf16 v[200:203], a[124:127], a[188:191], v[200:203]
  v_mfma_f32_16x16x32_bf16 v[204:207], a[92:95], a[164:167], v[204:207]
  v_mfma_f32_16x16x32_bf16 v[204:207], a[128:131], a[188:191], v[204:207]
  v_mfma_f32_16x16x32_bf16 v[208:211], a[96:99], a[164:167], v[208:211]
  v_mfma_f32_16x16x32_bf16 v[208:211], a[132:135], a[188:191], v[208:211]
  v_mfma_f32_16x16x32_bf16 v[212:215], a[100:103], a[164:167], v[212:215]
  v_mfma_f32_16x16x32_bf16 v[212:215], a[136:139], a[188:191], v[212:215]
  s_waitcnt lgkmcnt(0)
  v_mfma_f32_16x16x32_bf16 v[24:27], a[144:147], a[0:3], v[24:27]
  ds_read_b64_tr_b16 a[156:157], v21 offset:8192
  ds_read_b64_tr_b16 a[158:159], v21 offset:10240
  v_mfma_f32_16x16x32_bf16 v[24:27], a[168:171], a[36:39], v[24:27]
  ds_read_b64_tr_b16 a[180:181], v21 offset:12288
  ds_read_b64_tr_b16 a[182:183], v21 offset:14336
  v_mfma_f32_16x16x32_bf16 v[28:31], a[144:147], a[4:7], v[28:31]
  ds_read_b64_tr_b16 a[160:161], v20 offset:16384
  ds_read_b64_tr_b16 a[162:163], v20 offset:18432
  v_mfma_f32_16x16x32_bf16 v[28:31], a[168:171], a[40:43], v[28:31]
  ds_read_b64_tr_b16 a[184:185], v20 offset:20480
  v_mfma_f32_16x16x32_bf16 v[32:35], a[144:147], a[8:11], v[32:35]
  ds_read_b64_tr_b16 a[186:187], v20 offset:22528
  ds_read_b64_tr_b16 a[164:165], v21 offset:16384
  v_mfma_f32_16x16x32_bf16 v[32:35], a[168:171], a[44:47], v[32:35]
  ds_read_b64_tr_b16 a[166:167], v21 offset:18432
  ds_read_b64_tr_b16 a[188:189], v21 offset:20480
  v_mfma_f32_16x16x32_bf16 v[36:39], a[144:147], a[12:15], v[36:39]
  ds_read_b64_tr_b16 a[190:191], v21 offset:22528
  v_mfma_f32_16x16x32_bf16 v[36:39], a[168:171], a[48:51], v[36:39]
  v_mfma_f32_16x16x32_bf16 v[40:43], a[144:147], a[16:19], v[40:43]
  v_mfma_f32_16x16x32_bf16 v[40:43], a[168:171], a[52:55], v[40:43]
  v_mfma_f32_16x16x32_bf16 v[44:47], a[144:147], a[20:23], v[44:47]
  v_mfma_f32_16x16x32_bf16 v[44:47], a[168:171], a[56:59], v[44:47]
  v_mfma_f32_16x16x32_bf16 v[48:51], a[144:147], a[24:27], v[48:51]
  v_mfma_f32_16x16x32_bf16 v[48:51], a[168:171], a[60:63], v[48:51]
  v_mfma_f32_16x16x32_bf16 v[52:55], a[144:147], a[28:31], v[52:55]
  v_mfma_f32_16x16x32_bf16 v[52:55], a[168:171], a[64:67], v[52:55]
  v_mfma_f32_16x16x32_bf16 v[56:59], a[148:151], a[0:3], v[56:59]
  v_mfma_f32_16x16x32_bf16 v[56:59], a[172:175], a[36:39], v[56:59]
  v_mfma_f32_16x16x32_bf16 v[60:63], a[148:151], a[4:7], v[60:63]
  v_mfma_f32_16x16x32_bf16 v[60:63], a[172:175], a[40:43], v[60:63]
  v_mfma_f32_16x16x32_bf16 v[64:67], a[148:151], a[8:11], v[64:67]
  v_mfma_f32_16x16x32_bf16 v[64:67], a[172:175], a[44:47], v[64:67]
  v_mfma_f32_16x16x32_bf16 v[68:71], a[148:151], a[12:15], v[68:71]
  v_pk_mul_f32 v[24:25], v[24:25], s[6:7]
  v_pk_mul_f32 v[26:27], v[26:27], s[6:7]
  v_mfma_f32_16x16x32_bf16 v[68:71], a[172:175], a[48:51], v[68:71]
  v_pk_mul_f32 v[56:57], v[56:57], s[6:7]
  v_pk_mul_f32 v[58:59], v[58:59], s[6:7]
  v_mfma_f32_16x16x32_bf16 v[72:75], a[148:151], a[16:19], v[72:75]
  v_cvt_pk_bf16_f32 v24, v24, v25
  v_cvt_pk_bf16_f32 v25, v26, v27
  v_mfma_f32_16x16x32_bf16 v[72:75], a[172:175], a[52:55], v[72:75]
  v_cvt_pk_bf16_f32 v26, v56, v57
  v_cvt_pk_bf16_f32 v27, v58, v59
  v_mfma_f32_16x16x32_bf16 v[76:79], a[148:151], a[20:23], v[76:79]
  v_pk_mul_f32 v[28:29], v[28:29], s[6:7]
  v_pk_mul_f32 v[30:31], v[30:31], s[6:7]
  v_mfma_f32_16x16x32_bf16 v[76:79], a[172:175], a[56:59], v[76:79]
  v_pk_mul_f32 v[60:61], v[60:61], s[6:7]
  v_pk_mul_f32 v[62:63], v[62:63], s[6:7]
  v_mfma_f32_16x16x32_bf16 v[80:83], a[148:151], a[24:27], v[80:83]
  v_cvt_pk_bf16_f32 v28, v28, v29
  v_cvt_pk_bf16_f32 v29, v30, v31
  v_mfma_f32_16x16x32_bf16 v[80:83], a[172:175], a[60:63], v[80:83]
  v_cvt_pk_bf16_f32 v30, v60, v61
  v_cvt_pk_bf16_f32 v31, v62, v63
  v_mfma_f32_16x16x32_bf16 v[84:87], a[148:151], a[28:31], v[84:87]
  v_pk_mul_f32 v[32:33], v[32:33], s[6:7]
  v_pk_mul_f32 v[34:35], v[34:35], s[6:7]
  v_mfma_f32_16x16x32_bf16 v[84:87], a[172:175], a[64:67], v[84:87]
  v_pk_mul_f32 v[64:65], v[64:65], s[6:7]
  v_pk_mul_f32 v[66:67], v[66:67], s[6:7]
  v_mfma_f32_16x16x32_bf16 v[88:91], a[152:155], a[0:3], v[88:91]
  v_cvt_pk_bf16_f32 v32, v32, v33
  v_cvt_pk_bf16_f32 v33, v34, v35
  v_mfma_f32_16x16x32_bf16 v[88:91], a[176:179], a[36:39], v[88:91]
  v_cvt_pk_bf16_f32 v34, v64, v65
  v_cvt_pk_bf16_f32 v35, v66, v67
  v_mfma_f32_16x16x32_bf16 v[92:95], a[152:155], a[4:7], v[92:95]
  v_pk_mul_f32 v[36:37], v[36:37], s[6:7]
  v_pk_mul_f32 v[38:39], v[38:39], s[6:7]
  v_mfma_f32_16x16x32_bf16 v[92:95], a[176:179], a[40:43], v[92:95]
  v_pk_mul_f32 v[68:69], v[68:69], s[6:7]
  v_pk_mul_f32 v[70:71], v[70:71], s[6:7]
  v_mfma_f32_16x16x32_bf16 v[96:99], a[152:155], a[8:11], v[96:99]
  v_cvt_pk_bf16_f32 v36, v36, v37
  v_cvt_pk_bf16_f32 v37, v38, v39
  v_mfma_f32_16x16x32_bf16 v[96:99], a[176:179], a[44:47], v[96:99]
  v_cvt_pk_bf16_f32 v38, v68, v69
  v_cvt_pk_bf16_f32 v39, v70, v71
  v_mfma_f32_16x16x32_bf16 v[100:103], a[152:155], a[12:15], v[100:103]
  v_pk_mul_f32 v[40:41], v[40:41], s[6:7]
  v_pk_mul_f32 v[42:43], v[42:43], s[6:7]
  v_mfma_f32_16x16x32_bf16 v[100:103], a[176:179], a[48:51], v[100:103]
  v_pk_mul_f32 v[72:73], v[72:73], s[6:7]
  v_pk_mul_f32 v[74:75], v[74:75], s[6:7]
  v_mfma_f32_16x16x32_bf16 v[104:107], a[152:155], a[16:19], v[104:107]
  v_cvt_pk_bf16_f32 v40, v40, v41
  v_cvt_pk_bf16_f32 v41, v42, v43
  v_mfma_f32_16x16x32_bf16 v[104:107], a[176:179], a[52:55], v[104:107]
  v_cvt_pk_bf16_f32 v42, v72, v73
  v_cvt_pk_bf16_f32 v43, v74, v75
  v_mfma_f32_16x16x32_bf16 v[108:111], a[152:155], a[20:23], v[108:111]
  v_pk_mul_f32 v[44:45], v[44:45], s[6:7]
  v_pk_mul_f32 v[46:47], v[46:47], s[6:7]
  v_mfma_f32_16x16x32_bf16 v[108:111], a[176:179], a[56:59], v[108:111]
  v_pk_mul_f32 v[76:77], v[76:77], s[6:7]
  v_pk_mul_f32 v[78:79], v[78:79], s[6:7]
  v_mfma_f32_16x16x32_bf16 v[112:115], a[152:155], a[24:27], v[112:115]
  v_cvt_pk_bf16_f32 v44, v44, v45
  v_cvt_pk_bf16_f32 v45, v46, v47
  v_mfma_f32_16x16x32_bf16 v[112:115], a[176:179], a[60:63], v[112:115]
  v_cvt_pk_bf16_f32 v46, v76, v77
  v_cvt_pk_bf16_f32 v47, v78, v79
  v_mfma_f32_16x16x32_bf16 v[116:119], a[152:155], a[28:31], v[116:119]
  v_pk_mul_f32 v[48:49], v[48:49], s[6:7]
  v_pk_mul_f32 v[50:51], v[50:51], s[6:7]
  v_mfma_f32_16x16x32_bf16 v[116:119], a[176:179], a[64:67], v[116:119]
  v_pk_mul_f32 v[80:81], v[80:81], s[6:7]
  v_pk_mul_f32 v[82:83], v[82:83], s[6:7]
  v_mfma_f32_16x16x32_bf16 v[216:219], a[152:155], a[32:35], v[216:219]
  v_cvt_pk_bf16_f32 v48, v48, v49
  v_cvt_pk_bf16_f32 v49, v50, v51
  v_mfma_f32_16x16x32_bf16 v[216:219], a[176:179], a[68:71], v[216:219]
  v_cvt_pk_bf16_f32 v50, v80, v81
  v_cvt_pk_bf16_f32 v51, v82, v83
  s_waitcnt lgkmcnt(0)
  s_barrier
  s_mov_b32 s12, s84
  s_mov_b32 s13, s85
  s_mov_b32 s14, 256
  s_mov_b32 s15, 0x00020000
  buffer_load_dwordx2 v[22:23], off, s[12:15], 0 sc1
  v_mfma_f32_16x16x32_bf16 v[120:123], a[156:159], a[0:3], v[120:123]
  s_mov_b32 m0, s68
  v_pk_mul_f32 v[52:53], v[52:53], s[6:7]
  v_pk_mul_f32 v[54:55], v[54:55], s[6:7]
  v_mfma_f32_16x16x32_bf16 v[120:123], a[180:183], a[36:39], v[120:123]
  buffer_load_dwordx4 v8, s[20:23], s28 offen offset:0 lds
  v_pk_mul_f32 v[84:85], v[84:85], s[6:7]
  v_mfma_f32_16x16x32_bf16 v[124:127], a[156:159], a[4:7], v[124:127]
  v_pk_mul_f32 v[86:87], v[86:87], s[6:7]
  v_cvt_pk_bf16_f32 v52, v52, v53
  v_mfma_f32_16x16x32_bf16 v[124:127], a[180:183], a[40:43], v[124:127]
  buffer_load_dwordx4 v9, s[20:23], s28 offen offset:1024 lds
  v_cvt_pk_bf16_f32 v53, v54, v55
  v_mfma_f32_16x16x32_bf16 v[128:131], a[156:159], a[8:11], v[128:131]
  v_cvt_pk_bf16_f32 v54, v84, v85
  v_cvt_pk_bf16_f32 v55, v86, v87
  v_mfma_f32_16x16x32_bf16 v[128:131], a[180:183], a[44:47], v[128:131]
  v_mfma_f32_16x16x32_bf16 v[132:135], a[156:159], a[12:15], v[132:135]
  buffer_load_dwordx4 v10, s[20:23], s28 offen offset:2048 lds
  v_mfma_f32_16x16x32_bf16 v[132:135], a[180:183], a[48:51], v[132:135]
  v_mfma_f32_16x16x32_bf16 v[136:139], a[156:159], a[16:19], v[136:139]
  v_mfma_f32_16x16x32_bf16 v[136:139], a[180:183], a[52:55], v[136:139]
  buffer_load_dwordx4 v11, s[20:23], s28 offen offset:3072 lds
  v_mfma_f32_16x16x32_bf16 v[140:143], a[156:159], a[20:23], v[140:143]
  s_bfe_u32 s56, 0x302010e, s55
  s_add_u32 s54, s54, s56
  s_add_u32 s55, s55, 8
  v_mfma_f32_16x16x32_bf16 v[140:143], a[180:183], a[56:59], v[140:143]
  s_and_b32 s55, s55, 0x8001f
  s_and_b32 s54, s54, 15
  s_lshl_b32 s28, s54, 19
  v_mfma_f32_16x16x32_bf16 v[144:147], a[156:159], a[24:27], v[144:147]
  s_add_u32 m0, s68, 16384
  v_mfma_f32_16x16x32_bf16 v[144:147], a[180:183], a[60:63], v[144:147]
  buffer_load_dwordx4 v8, s[20:23], s28 offen offset:0 lds
  v_mfma_f32_16x16x32_bf16 v[148:151], a[156:159], a[28:31], v[148:151]
  v_mfma_f32_16x16x32_bf16 v[148:151], a[180:183], a[64:67], v[148:151]
  buffer_load_dwordx4 v9, s[20:23], s28 offen offset:1024 lds
  v_mfma_f32_16x16x32_bf16 v[220:223], a[156:159], a[32:35], v[220:223]
  v_mfma_f32_16x16x32_bf16 v[220:223], a[180:183], a[68:71], v[220:223]
  v_mfma_f32_16x16x32_bf16 v[152:155], a[0:3], a[160:163], v[152:155]
  buffer_load_dwordx4 v10, s[20:23], s28 offen offset:2048 lds
  v_mfma_f32_16x16x32_bf16 v[152:155], a[36:39], a[184:187], v[152:155]
  v_mfma_f32_16x16x32_bf16 v[156:159], a[4:7], a[160:163], v[156:159]
  v_mfma_f32_16x16x32_bf16 v[156:159], a[40:43], a[184:187], v[156:159]
  buffer_load_dwordx4 v11, s[20:23], s28 offen offset:3072 lds
  v_mfma_f32_16x16x32_bf16 v[160:163], a[8:11], a[160:163], v[160:163]
  s_bfe_u32 s56, 0x302010e, s55
  s_add_u32 s54, s54, s56
  s_add_u32 s55, s55, 8
  v_mfma_f32_16x16x32_bf16 v[160:163], a[44:47], a[184:187], v[160:163]
  s_and_b32 s55, s55, 0x8001f
  s_and_b32 s54, s54, 15
  s_lshl_b32 s28, s54, 19
  v_mfma_f32_16x16x32_bf16 v[164:167], a[12:15], a[160:163], v[164:167]
  s_mov_b32 m0, s88
  v_cvt_pk_bf16_f32 v216, v216, v217
  v_cvt_pk_bf16_f32 v217, v218, v219
  v_mfma_f32_16x16x32_bf16 v[164:167], a[48:51], a[184:187], v[164:167]
  buffer_load_dwordx4 v4, s[8:11], s26 offen offset:0 lds
  v_cvt_pk_bf16_f32 v218, v220, v221
  v_mfma_f32_16x16x32_bf16 v[168:171], a[16:19], a[160:163], v[168:171]
  v_cvt_pk_bf16_f32 v219, v222, v223
  v_mfma_f32_16x16x32_bf16 v[168:171], a[52:55], a[184:187], v[168:171]
  buffer_load_dwordx4 v5, s[8:11], s26 offen offset:1024 lds
  ds_write_b128 v252, v[216:219]
  v_mfma_f32_16x16x32_bf16 v[172:175], a[20:23], a[160:163], v[172:175]
  v_cvt_pk_bf16_f32 v88, v88, v89
  v_cvt_pk_bf16_f32 v89, v90, v91
  v_mfma_f32_16x16x32_bf16 v[172:175], a[56:59], a[184:187], v[172:175]
  v_cvt_pk_bf16_f32 v90, v120, v121
  v_cvt_pk_bf16_f32 v91, v122, v123
  v_mfma_f32_16x16x32_bf16 v[176:179], a[24:27], a[160:163], v[176:179]
  buffer_load_dwordx4 v6, s[8:11], s26 offen offset:2048 lds
  v_cvt_pk_bf16_f32 v92, v92, v93
  v_mfma_f32_16x16x32_bf16 v[176:179], a[60:63], a[184:187], v[176:179]
  v_cvt_pk_bf16_f32 v93, v94, v95
  v_cvt_pk_bf16_f32 v94, v124, v125
  v_mfma_f32_16x16x32_bf16 v[180:183], a[28:31], a[160:163], v[180:183]
  v_cvt_pk_bf16_f32 v95, v126, v127
  v_cvt_pk_bf16_f32 v96, v96, v97
  v_mfma_f32_16x16x32_bf16 v[180:183], a[64:67], a[184:187], v[180:183]
  buffer_load_dwordx4 v7, s[8:11], s26 offen offset:3072 lds
  v_cvt_pk_bf16_f32 v97, v98, v99
  v_mfma_f32_16x16x32_bf16 v[184:187], a[0:3], a[164:167], v[184:187]
  s_add_u32 m0, s88, 4096
  v_cvt_pk_bf16_f32 v98, v128, v129
  v_cvt_pk_bf16_f32 v99, v130, v131
  v_mfma_f32_16x16x32_bf16 v[184:187], a[36:39], a[188:191], v[184:187]
  v_cvt_pk_bf16_f32 v100, v100, v101
  v_cvt_pk_bf16_f32 v101, v102, v103
  v_mfma_f32_16x16x32_bf16 v[188:191], a[4:7], a[164:167], v[188:191]
  buffer_load_dwordx4 v4, s[8:11], s27 offen offset:0 lds
  v_cvt_pk_bf16_f32 v102, v132, v133
  v_mfma_f32_16x16x32_bf16 v[188:191], a[40:43], a[188:191], v[188:191]
  v_cvt_pk_bf16_f32 v103, v134, v135
  v_cvt_pk_bf16_f32 v104, v104, v105
  v_mfma_f32_16x16x32_bf16 v[192:195], a[8:11], a[164:167], v[192:195]
  v_cvt_pk_bf16_f32 v105, v106, v107
  v_cvt_pk_bf16_f32 v106, v136, v137
  v_mfma_f32_16x16x32_bf16 v[192:195], a[44:47], a[188:191], v[192:195]
  buffer_load_dwordx4 v5, s[8:11], s27 offen offset:1024 lds
  v_cvt_pk_bf16_f32 v107, v138, v139
  v_mfma_f32_16x16x32_bf16 v[196:199], a[12:15], a[164:167], v[196:199]
  v_cvt_pk_bf16_f32 v108, v108, v109
  v_cvt_pk_bf16_f32 v109, v110, v111
  v_mfma_f32_16x16x32_bf16 v[196:199], a[48:51], a[188:191], v[196:199]
  v_cvt_pk_bf16_f32 v110, v140, v141
  v_cvt_pk_bf16_f32 v111, v142, v143
  v_mfma_f32_16x16x32_bf16 v[200:203], a[16:19], a[164:167], v[200:203]
  buffer_load_dwordx4 v6, s[8:11], s27 offen offset:2048 lds
  v_cvt_pk_bf16_f32 v112, v112, v113
  v_mfma_f32_16x16x32_bf16 v[200:203], a[52:55], a[188:191], v[200:203]
  v_cvt_pk_bf16_f32 v113, v114, v115
  v_cvt_pk_bf16_f32 v114, v144, v145
  v_mfma_f32_16x16x32_bf16 v[204:207], a[20:23], a[164:167], v[204:207]
  v_cvt_pk_bf16_f32 v115, v146, v147
  v_cvt_pk_bf16_f32 v116, v116, v117
  v_mfma_f32_16x16x32_bf16 v[204:207], a[56:59], a[188:191], v[204:207]
  buffer_load_dwordx4 v7, s[8:11], s27 offen offset:3072 lds
  v_cvt_pk_bf16_f32 v117, v118, v119
  v_mfma_f32_16x16x32_bf16 v[208:211], a[24:27], a[164:167], v[208:211]
  s_bfe_u32 s29, 0x302010e, s53
  s_add_u32 s52, s52, s29
  s_add_u32 s53, s53, 8
  v_mfma_f32_16x16x32_bf16 v[208:211], a[60:63], a[188:191], v[208:211]
  s_and_b32 s53, s53, 0x8001f
  s_and_b32 s52, s52, 15
  s_lshl_b32 s29, s52, 7
  v_mfma_f32_16x16x32_bf16 v[212:215], a[28:31], a[164:167], v[212:215]
  s_or_b32 s26, s30, s29
  s_or_b32 s27, s31, s29
  v_cvt_pk_bf16_f32 v118, v148, v149
  v_mfma_f32_16x16x32_bf16 v[212:215], a[64:67], a[188:191], v[212:215]
  v_cvt_pk_bf16_f32 v119, v150, v151
  ds_write_b128 v252, v[116:119] offset:2048
  v_cvt_pk_bf16_f32 v72, v180, v181
  v_cvt_pk_bf16_f32 v73, v182, v183
  s_nop 3
  v_cvt_pk_bf16_f32 v136, v212, v213
  v_cvt_pk_bf16_f32 v137, v214, v215
  ds_write_b64 v252, v[72:73] offset:3072
  ds_write_b64 v252, v[136:137] offset:3080
  v_cvt_pk_bf16_f32 v70, v176, v177
  v_cvt_pk_bf16_f32 v71, v178, v179
  v_cvt_pk_bf16_f32 v134, v208, v209
  v_cvt_pk_bf16_f32 v135, v210, v211
  v_cvt_pk_bf16_f32 v68, v172, v173
  v_cvt_pk_bf16_f32 v69, v174, v175
  v_cvt_pk_bf16_f32 v132, v204, v205
  v_cvt_pk_bf16_f32 v133, v206, v207
  v_cvt_pk_bf16_f32 v66, v168, v169
  v_cvt_pk_bf16_f32 v67, v170, v171
  v_cvt_pk_bf16_f32 v130, v200, v201
  v_cvt_pk_bf16_f32 v131, v202, v203
  v_cvt_pk_bf16_f32 v64, v164, v165
  v_cvt_pk_bf16_f32 v65, v166, v167
  v_cvt_pk_bf16_f32 v128, v196, v197
  v_cvt_pk_bf16_f32 v129, v198, v199
  v_cvt_pk_bf16_f32 v62, v160, v161
  v_cvt_pk_bf16_f32 v63, v162, v163
  v_cvt_pk_bf16_f32 v126, v192, v193
  v_cvt_pk_bf16_f32 v127, v194, v195
  v_cvt_pk_bf16_f32 v60, v156, v157
  v_cvt_pk_bf16_f32 v61, v158, v159
  v_cvt_pk_bf16_f32 v124, v188, v189
  v_cvt_pk_bf16_f32 v125, v190, v191
  v_cvt_pk_bf16_f32 v58, v152, v153
  v_cvt_pk_bf16_f32 v59, v154, v155
  v_cvt_pk_bf16_f32 v122, v184, v185
  v_cvt_pk_bf16_f32 v123, v186, v187
  s_waitcnt lgkmcnt(0)
  s_barrier
  s_branch Lp2_at
Lp2_r1:
  s_and_b32 s4, s2, 7
  s_lshl_b32 s4, s4, 4
  s_add_u32 s4, s4, s59
  s_lshl_b32 s4, s4, 2
  s_add_u32 s4, s4, s3
  s_lshl_b32 s51, s4, 13
  s_mov_b32 m0, s36
  s_nop 0
  buffer_load_dwordx4 v224, s[8:11], s46 offen offset:0 lds
  buffer_load_dwordx4 v225, s[8:11], s46 offen offset:1024 lds
  buffer_load_dwordx4 v226, s[8:11], s46 offen offset:2048 lds
  buffer_load_dwordx4 v227, s[8:11], s46 offen offset:3072 lds
  s_add_u32 m0, s36, 4096
  s_nop 0
  buffer_load_dwordx4 v228, s[8:11], s46 offen offset:0 lds
  buffer_load_dwordx4 v229, s[8:11], s46 offen offset:1024 lds
  buffer_load_dwordx4 v230, s[8:11], s46 offen offset:2048 lds
  buffer_load_dwordx4 v231, s[8:11], s46 offen offset:3072 lds
  s_mul_i32 s47, s48, 393216
  s_bfe_u32 s34, 0x302010e, s49
  s_add_u32 s48, s48, s34
  s_add_u32 s49, s49, 8
  s_and_b32 s49, s49, 0x8001f
  s_and_b32 s48, s48, 15
  s_lshl_b32 s46, s48, 7
  s_mov_b32 m0, s41
  s_nop 0
  buffer_load_dwordx4 v233, s[12:15], s47 offen offset:0 lds
  buffer_load_dwordx4 v234, s[12:15], s47 offen offset:1024 lds
  buffer_load_dwordx4 v235, s[12:15], s47 offen offset:2048 lds
  s_add_u32 m0, s41, 3072
  s_nop 0
  buffer_load_dwordx4 v236, s[12:15], s47 offen offset:0 lds
  buffer_load_dwordx4 v237, s[12:15], s47 offen offset:1024 lds
  buffer_load_dwordx4 v238, s[12:15], s47 offen offset:2048 lds
  s_lshr_b32 s4, s3, 1
  s_lshl_b32 s4, s4, 14
  v_and_b32 v240, 15, v1
  v_lshlrev_b32 v240, 7, v240
  v_lshrrev_b32 v241, 4, v1
  v_and_b32 v242, 6, v1
  v_xor_b32 v241, v241, v242
  v_lshl_add_u32 v240, v241, 4, v240
  v_add_u32 v16, s4, v240
  v_xor_b32 v17, 64, v16
  v_and_b32 v240, 15, v1
  v_lshlrev_b32 v240, 7, v240
  v_lshrrev_b32 v241, 4, v1
  v_and_b32 v242, 6, v1
  v_xor_b32 v241, v241, v242
  v_lshl_add_u32 v240, v241, 4, v240
  v_add_u32 v18, 32768, v240
  v_xor_b32 v19, 64, v18
  v_lshrrev_b32 v240, 2, v1
  v_and_b32 v241, 6, v240
  v_lshlrev_b32 v240, 7, v240
  v_and_b32 v242, 1, v1
  v_lshl_add_u32 v240, v242, 3, v240
  v_add_u32 v240, 104448, v240
  v_bfe_u32 v242, v1, 1, 1
  v_xor_b32 v241, v241, v242
  v_xor_b32 v242, 0, v241
  v_lshl_add_u32 v20, v242, 4, v240
  v_xor_b32 v242, 2, v241
  v_lshl_add_u32 v21, v242, 4, v240
  s_and_b32 s4, s3, 1
  s_lshl_b32 s4, s4, 6
  v_xor_b32 v20, s4, v20
  v_xor_b32 v21, s4, v21
  s_and_b32 s24, s2, 7
  s_lshr_b32 s4, s2, 6
  s_lshl_b32 s4, s4, 3
  s_add_u32 s24, s24, s4
  s_lshr_b32 s4, s2, 3
  s_and_b32 s25, s4, 6
  s_xor_b32 s4, s4, s2
  s_bfe_u32 s4, s4, 0x10003
  s_add_u32 s25, s25, s4
  v_accvgpr_write_b32 a244, -1
  v_accvgpr_write_b32 a245, -1
  v_accvgpr_write_b32 a246, -1
  v_accvgpr_write_b32 a247, -1
  v_lshrrev_b32 v24, 3, v1
  v_and_b32 v25, 6, v24
  v_and_b32 v26, 7, v1
  v_xor_b32 v25, v25, v26
  v_lshlrev_b32 v25, 4, v25
  s_and_b32 s4, s3, 1
  s_lshl_b32 s4, s4, 16
  s_lshr_b32 s5, s3, 1
  s_lshl_b32 s5, s5, 7
  s_add_u32 s4, s4, s5
  v_lshl_add_u32 v24, v24, 11, v25
  v_add_u32 v24, s4, v24
  v_add_u32 v25, 0, v24
  v_accvgpr_write_b32 a212, v25
  v_add_u32 v25, 15360, v24
  v_accvgpr_write_b32 a213, v25
  v_add_u32 v25, 30720, v24
  v_accvgpr_write_b32 a214, v25
  v_add_u32 v25, 46080, v24
  v_accvgpr_write_b32 a215, v25
  v_accvgpr_write_b32 a236, 0
  v_mov_b32 v27, 0x3f803f80
  v_accvgpr_write_b32 a208, v27
  v_accvgpr_write_b32 a237, 0
  v_accvgpr_write_b32 a209, v27
  v_accvgpr_write_b32 a238, 0
  v_accvgpr_write_b32 a210, v27
  v_accvgpr_write_b32 a239, 0
  v_accvgpr_write_b32 a211, v27
  v_lshrrev_b32 v24, 3, v1
  v_and_b32 v25, 6, v24
  v_and_b32 v26, 7, v1
  v_xor_b32 v25, v25, v26
  v_lshlrev_b32 v25, 4, v25
  v_lshlrev_b32 v26, 2, v24
  v_add_u32 v26, s3, v26
  v_lshl_add_u32 v26, v26, 11, v25
  v_add_u32 v27, 0, v26
  v_accvgpr_write_b32 a222, v27
  v_add_u32 v27, 64512, v26
  v_accvgpr_write_b32 a223, v27
  v_add_u32 v27, 129024, v26
  v_accvgpr_write_b32 a224, v27
  v_add_u32 v27, 193536, v26
  v_accvgpr_write_b32 a225, v27
  v_lshrrev_b32 v26, 2, v24
  v_and_b32 v27, 3, v24
  v_lshl_add_u32 v26, v26, 3, v27
  s_and_b32 s4, s3, 1
  s_lshl_b32 s4, s4, 18
  s_lshr_b32 s5, s3, 1
  s_lshl_b32 s5, s5, 7
  s_add_u32 s4, s4, s5
  s_lshl_b32 s5, s24, 8
  s_add_u32 s4, s4, s5
  v_lshl_add_u32 v26, v26, 13, v25
  v_add_u32 v26, s4, v26
  v_add_u32 v27, 0, v26
  v_accvgpr_write_b32 a226, v27
  v_add_u32 v27, 130048, v26
  v_accvgpr_write_b32 a227, v27
  v_add_u32 v27, 30720, v26
  v_accvgpr_write_b32 a228, v27
  v_add_u32 v27, 160768, v26
  v_accvgpr_write_b32 a229, v27
  s_lshl_b32 s4, s3, 13
  s_add_u32 s4, s4, 98304
  v_and_b32 v24, 15, v1
  v_lshlrev_b32 v24, 7, v24
  v_lshrrev_b32 v25, 4, v1
  v_and_b32 v26, 6, v1
  v_xor_b32 v25, v25, v26
  v_lshl_add_u32 v24, v25, 4, v24
  v_add_u32 v28, s4, v24
  v_xor_b32 v29, 64, v28
  v_lshrrev_b32 v24, 2, v1
  v_and_b32 v25, 6, v24
  v_lshlrev_b32 v24, 7, v24
  v_and_b32 v26, 1, v1
  v_lshl_add_u32 v24, v26, 3, v24
  v_add_u32 v24, 0, v24
  v_bfe_u32 v26, v1, 1, 1
  v_xor_b32 v25, v25, v26
  v_xor_b32 v26, 0, v25
  v_lshl_add_u32 v30, v26, 4, v24
  v_xor_b32 v26, 2, v25
  v_lshl_add_u32 v31, v26, 4, v24
  v_xor_b32 v26, 4, v25
  v_lshl_add_u32 v32, v26, 4, v24
  v_xor_b32 v26, 6, v25
  v_lshl_add_u32 v33, v26, 4, v24
  v_accvgpr_write_b32 a230, v28
  v_accvgpr_write_b32 a231, v29
  v_accvgpr_write_b32 a232, v30
  v_accvgpr_write_b32 a233, v31
  v_accvgpr_write_b32 a234, v32
  v_accvgpr_write_b32 a235, v33
  v_and_b32 v253, 15, v1
  v_lshrrev_b32 v254, 4, v1
  v_lshlrev_b32 v254, 2, v254
  v_sub_u32 v253, v253, v254
  v_mov_b32 v254, 0xf149f2ca
  s_lshr_b32 s4, s3, 1
  s_or_b32 s4, s4, s32
  s_cselect_b64 s[6:7], 0, -1
  v_subrev_u32 v255, 0, v253
  v_and_b32 v252, 0x80000001, v255
  v_cmp_ne_u32 vcc, 0, v252
  s_nop 1
  v_cndmask_b32 v244, 0, v254, vcc
  v_add_u32 v255, 1, v255
  v_and_b32 v252, 0x80000001, v255
  v_cmp_ne_u32 vcc, 0x80000001, v252
  s_nop 1
  v_cndmask_b32 v240, 0, v254, vcc
  v_cndmask_b32 v248, v240, v254, s[6:7]
  v_subrev_u32 v255, 1, v253
  v_and_b32 v252, 0x80000001, v255
  v_cmp_ne_u32 vcc, 0, v252
  s_nop 1
  v_cndmask_b32 v245, 0, v254, vcc
  v_add_u32 v255, 1, v255
  v_and_b32 v252, 0x80000001, v255
  v_cmp_ne_u32 vcc, 0x80000001, v252
  s_nop 1
  v_cndmask_b32 v241, 0, v254, vcc
  v_cndmask_b32 v249, v241, v254, s[6:7]
  v_subrev_u32 v255, 2, v253
  v_and_b32 v252, 0x80000001, v255
  v_cmp_ne_u32 vcc, 0, v252
  s_nop 1
  v_cndmask_b32 v246, 0, v254, vcc
  v_add_u32 v255, 1, v255
  v_and_b32 v252, 0x80000001, v255
  v_cmp_ne_u32 vcc, 0x80000001, v252
  s_nop 1
  v_cndmask_b32 v242, 0, v254, vcc
  v_cndmask_b32 v250, v242, v254, s[6:7]
  v_subrev_u32 v255, 3, v253
  v_and_b32 v252, 0x80000001, v255
  v_cmp_ne_u32 vcc, 0, v252
  s_nop 1
  v_cndmask_b32 v247, 0, v254, vcc
  v_add_u32 v255, 1, v255
  v_and_b32 v252, 0x80000001, v255
  v_cmp_ne_u32 vcc, 0x80000001, v252
  s_nop 1
  v_cndmask_b32 v243, 0, v254, vcc
  v_cndmask_b32 v251, v243, v254, s[6:7]
  s_and_b32 s4, s3, 1
  s_lshl_b32 s4, s4, 12
  s_add_u32 s4, s4, 49152
  v_add_u32 v252, s4, v2
  s_lshr_b32 s5, s3, 1
  s_lshl_b32 s5, s5, 11
  v_add_u32 v253, s5, v252
  s_add_u32 s16, s86, 83886080
  s_addc_u32 s17, s87, 0
  s_mov_b32 s18, 4194304
  s_mov_b32 s19, 0x00020000
  s_lshl_b32 s57, s32, 19
  s_lshl_b32 s5, s5, 7
  s_add_u32 s57, s57, s5
  s_lshl_b32 s4, s33, 14
  s_add_u32 s57, s57, s4
  s_and_b32 s4, s3, 1
  s_lshl_b32 s4, s4, 13
  s_add_u32 s57, s57, s4
  s_add_u32 s58, s57, 4096
  s_mov_b32 s37, 0
  s_mov_b32 s39, 4294897664
  s_mov_b32 s40, 34816
  s_mov_b32 s42, 0
  s_mov_b32 s44, 4294942720
  s_mov_b32 s45, 24576
  s_mov_b32 s43, s44
  s_mov_b32 s52, s72
  s_mov_b32 s53, s73
  s_mov_b32 s54, 4194304
  s_mov_b32 s55, 0x00020000
  s_lshl_b32 s1, s51, 1
  s_mov_b32 s56, s51
  s_mov_b32 s0, 0
  s_waitcnt vmcnt(0)
  s_barrier
  ds_read_b128 a[72:75], v16 offset:0
  ds_read_b128 a[108:111], v17 offset:0
  ds_read_b64_tr_b16 a[144:145], v20 offset:0
  ds_read_b64_tr_b16 a[146:147], v20 offset:2048
  ds_read_b64_tr_b16 a[168:169], v20 offset:4096
  ds_read_b64_tr_b16 a[170:171], v20 offset:6144
  ds_read_b128 a[76:79], v16 offset:2048
  ds_read_b128 a[112:115], v17 offset:2048
  ds_read_b128 a[80:83], v16 offset:4096
  ds_read_b128 a[116:119], v17 offset:4096
  ds_read_b128 a[84:87], v16 offset:6144
  ds_read_b128 a[120:123], v17 offset:6144
  ds_read_b128 a[88:91], v16 offset:8192
  ds_read_b128 a[124:127], v17 offset:8192
  ds_read_b128 a[92:95], v16 offset:10240
  ds_read_b128 a[128:131], v17 offset:10240
  ds_read_b128 a[96:99], v16 offset:12288
  ds_read_b128 a[132:135], v17 offset:12288
  ds_read_b128 a[100:103], v16 offset:14336
  ds_read_b128 a[136:139], v17 offset:14336
  ds_read_b64_tr_b16 a[148:149], v21 offset:0
  ds_read_b64_tr_b16 a[150:151], v21 offset:2048
  ds_read_b64_tr_b16 a[172:173], v21 offset:4096
  ds_read_b64_tr_b16 a[174:175], v21 offset:6144
  ds_read_b64_tr_b16 a[152:153], v20 offset:8192
  ds_read_b64_tr_b16 a[154:155], v20 offset:10240
  ds_read_b64_tr_b16 a[176:177], v20 offset:12288
  ds_read_b64_tr_b16 a[178:179], v20 offset:14336
  ds_read_b128 a[104:107], v18 offset:0
  ds_read_b128 a[140:143], v19 offset:0
  s_waitcnt lgkmcnt(0)
  v_mfma_f32_16x16x32_bf16 v[24:27], a[144:147], a[72:75], 0
  s_add_u32 m0, s36, 34816
  ds_read_b64_tr_b16 a[156:157], v21 offset:8192
  v_mfma_f32_16x16x32_bf16 v[24:27], a[168:171], a[108:111], v[24:27]
  buffer_load_dwordx4 v224, s[8:11], s46 offen offset:0 lds
  v_mfma_f32_16x16x32_bf16 v[28:31], a[144:147], a[76:79], 0
  buffer_load_dwordx4 v225, s[8:11], s46 offen offset:1024 lds
  v_mfma_f32_16x16x32_bf16 v[28:31], a[168:171], a[112:115], v[28:31]
  buffer_load_dwordx4 v226, s[8:11], s46 offen offset:2048 lds
  v_mfma_f32_16x16x32_bf16 v[32:35], a[144:147], a[80:83], 0
  ds_read_b64_tr_b16 a[158:159], v21 offset:10240
  v_mfma_f32_16x16x32_bf16 v[32:35], a[168:171], a[116:119], v[32:35]
  buffer_load_dwordx4 v227, s[8:11], s46 offen offset:3072 lds
  v_mfma_f32_16x16x32_bf16 v[36:39], a[144:147], a[84:87], 0
  s_add_u32 m0, s36, 38912
  ds_read_b64_tr_b16 a[180:181], v21 offset:12288
  v_mfma_f32_16x16x32_bf16 v[36:39], a[168:171], a[120:123], v[36:39]
  buffer_load_dwordx4 v228, s[8:11], s46 offen offset:0 lds
  v_mfma_f32_16x16x32_bf16 v[40:43], a[144:147], a[88:91], 0
  v_mfma_f32_16x16x32_bf16 v[40:43], a[168:171], a[124:127], v[40:43]
  buffer_load_dwordx4 v229, s[8:11], s46 offen offset:1024 lds
  v_mfma_f32_16x16x32_bf16 v[44:47], a[144:147], a[92:95], 0
  ds_read_b64_tr_b16 a[182:183], v21 offset:14336
  v_mfma_f32_16x16x32_bf16 v[44:47], a[168:171], a[128:131], v[44:47]
  buffer_load_dwordx4 v230, s[8:11], s46 offen offset:2048 lds
  v_mfma_f32_16x16x32_bf16 v[48:51], a[144:147], a[96:99], 0
  ds_read_b64_tr_b16 a[160:161], v20 offset:16384
  v_mfma_f32_16x16x32_bf16 v[48:51], a[168:171], a[132:135], v[48:51]
  buffer_load_dwordx4 v231, s[8:11], s46 offen offset:3072 lds
  v_mfma_f32_16x16x32_bf16 v[52:55], a[144:147], a[100:103], 0
  s_mul_i32 s47, s48, 393216
  s_bfe_u32 s34, 0x302010e, s49
  s_add_u32 s48, s48, s34
  v_mfma_f32_16x16x32_bf16 v[52:55], a[168:171], a[136:139], v[52:55]
  s_add_u32 s49, s49, 8
  s_and_b32 s49, s49, 0x8001f
  s_and_b32 s48, s48, 15
  v_mfma_f32_16x16x32_bf16 v[56:59], a[148:151], a[72:75], 0
  s_lshl_b32 s46, s48, 7
  s_add_u32 m0, s41, 24576
  ds_read_b64_tr_b16 a[162:163], v20 offset:18432
  v_mfma_f32_16x16x32_bf16 v[56:59], a[172:175], a[108:111], v[56:59]
  buffer_load_dwordx4 v233, s[12:15], s47 offen offset:0 lds
  v_mfma_f32_16x16x32_bf16 v[60:63], a[148:151], a[76:79], 0
  buffer_load_dwordx4 v234, s[12:15], s47 offen offset:1024 lds
  v_mfma_f32_16x16x32_bf16 v[60:63], a[172:175], a[112:115], v[60:63]
  buffer_load_dwordx4 v235, s[12:15], s47 offen offset:2048 lds
  v_mfma_f32_16x16x32_bf16 v[64:67], a[148:151], a[80:83], 0
  s_add_u32 m0, s41, 27648
  ds_read_b64_tr_b16 a[184:185], v20 offset:20480
  v_mfma_f32_16x16x32_bf16 v[64:67], a[172:175], a[116:119], v[64:67]
  buffer_load_dwordx4 v236, s[12:15], s47 offen offset:0 lds
  v_mfma_f32_16x16x32_bf16 v[68:71], a[148:151], a[84:87], 0
  buffer_load_dwordx4 v237, s[12:15], s47 offen offset:1024 lds
  v_mfma_f32_16x16x32_bf16 v[68:71], a[172:175], a[120:123], v[68:71]
  ds_read_b64_tr_b16 a[186:187], v20 offset:22528
  v_mfma_f32_16x16x32_bf16 v[72:75], a[148:151], a[88:91], 0
  buffer_load_dwordx4 v238, s[12:15], s47 offen offset:2048 lds
  v_mfma_f32_16x16x32_bf16 v[72:75], a[172:175], a[124:127], v[72:75]
  s_add_u32 m0, s36, 69632
  ds_read_b64_tr_b16 a[164:165], v21 offset:16384
  v_mfma_f32_16x16x32_bf16 v[76:79], a[148:151], a[92:95], 0
  buffer_load_dwordx4 v224, s[8:11], s46 offen offset:0 lds
  v_mfma_f32_16x16x32_bf16 v[76:79], a[172:175], a[128:131], v[76:79]
  buffer_load_dwordx4 v225, s[8:11], s46 offen offset:1024 lds
  v_mfma_f32_16x16x32_bf16 v[80:83], a[148:151], a[96:99], 0
  ds_read_b64_tr_b16 a[166:167], v21 offset:18432
  v_mfma_f32_16x16x32_bf16 v[80:83], a[172:175], a[132:135], v[80:83]
  buffer_load_dwordx4 v226, s[8:11], s46 offen offset:2048 lds
  v_mfma_f32_16x16x32_bf16 v[84:87], a[148:151], a[100:103], 0
  v_mfma_f32_16x16x32_bf16 v[84:87], a[172:175], a[136:139], v[84:87]
  buffer_load_dwordx4 v227, s[8:11], s46 offen offset:3072 lds
  v_mfma_f32_16x16x32_bf16 v[88:91], a[152:155], a[72:75], 0
  s_add_u32 m0, s36, 73728
  ds_read_b64_tr_b16 a[188:189], v21 offset:20480
  v_mfma_f32_16x16x32_bf16 v[88:91], a[176:179], a[108:111], v[88:91]
  buffer_load_dwordx4 v228, s[8:11], s46 offen offset:0 lds
  v_mfma_f32_16x16x32_bf16 v[92:95], a[152:155], a[76:79], 0
  s_add_u32 s37, s37, 1
  ds_read_b64_tr_b16 a[190:191], v21 offset:22528
  v_mfma_f32_16x16x32_bf16 v[92:95], a[176:179], a[112:115], v[92:95]
  buffer_load_dwordx4 v229, s[8:11], s46 offen offset:1024 lds
  v_mfma_f32_16x16x32_bf16 v[96:99], a[152:155], a[80:83], 0
  s_cmp_eq_u32 s37, 3
  s_cselect_b32 s37, 0, s37
  s_cselect_b32 s38, s39, s40
  v_mfma_f32_16x16x32_bf16 v[96:99], a[176:179], a[116:119], v[96:99]
  buffer_load_dwordx4 v230, s[8:11], s46 offen offset:2048 lds
  v_mfma_f32_16x16x32_bf16 v[100:103], a[152:155], a[84:87], 0
  s_sub_u32 s43, 0, s43
  v_mfma_f32_16x16x32_bf16 v[100:103], a[176:179], a[120:123], v[100:103]
  buffer_load_dwordx4 v231, s[8:11], s46 offen offset:3072 lds
  v_mfma_f32_16x16x32_bf16 v[104:107], a[152:155], a[88:91], 0
  s_mul_i32 s47, s48, 393216
  v_add_u32 v16, s38, v16
  v_add_u32 v17, s38, v17
  v_mfma_f32_16x16x32_bf16 v[104:107], a[176:179], a[124:127], v[104:107]
  s_bfe_u32 s34, 0x302010e, s49
  v_add_u32 v18, s38, v18
  v_add_u32 v19, s38, v19
  v_mfma_f32_16x16x32_bf16 v[108:111], a[152:155], a[92:95], 0
  s_add_u32 s48, s48, s34
  v_add_u32 v20, s43, v20
  v_add_u32 v21, s43, v21
  v_mfma_f32_16x16x32_bf16 v[108:111], a[176:179], a[128:131], v[108:111]
  s_add_u32 s49, s49, 8
  v_mfma_f32_16x16x32_bf16 v[112:115], a[152:155], a[96:99], 0
  s_and_b32 s49, s49, 0x8001f
  s_and_b32 s48, s48, 15
  s_lshl_b32 s46, s48, 7
  v_mfma_f32_16x16x32_bf16 v[112:115], a[176:179], a[132:135], v[112:115]
  v_mfma_f32_16x16x32_bf16 v[116:119], a[152:155], a[100:103], 0
  v_mfma_f32_16x16x32_bf16 v[116:119], a[176:179], a[136:139], v[116:119]
  s_waitcnt vmcnt(8) lgkmcnt(0)
  s_barrier
  v_mfma_f32_16x16x32_bf16 v[120:123], a[156:159], a[72:75], 0
  buffer_load_dwordx4 a[192:195], v2, s[52:55], s51 offen offset:0
  v_mfma_f32_16x16x32_bf16 v[120:123], a[180:183], a[108:111], v[120:123]
  ds_read_b128 a[0:3], v16 offset:0
  ds_read_b128 a[36:39], v17 offset:0
  v_mfma_f32_16x16x32_bf16 v[124:127], a[156:159], a[76:79], 0
  ds_read_b64_tr_b16 a[144:145], v20 offset:0
  v_mfma_f32_16x16x32_bf16 v[124:127], a[180:183], a[112:115], v[124:127]
  v_mfma_f32_16x16x32_bf16 v[128:131], a[156:159], a[80:83], 0
  ds_read_b64_tr_b16 a[146:147], v20 offset:2048
  v_mfma_f32_16x16x32_bf16 v[128:131], a[180:183], a[116:119], v[128:131]
  buffer_load_dwordx4 a[192:195], v2, s[52:55], s51 offen offset:1024
  v_mfma_f32_16x16x32_bf16 v[132:135], a[156:159], a[84:87], 0
  ds_read_b64_tr_b16 a[168:169], v20 offset:4096
  v_mfma_f32_16x16x32_bf16 v[132:135], a[180:183], a[120:123], v[132:135]
  ds_read_b64_tr_b16 a[170:171], v20 offset:6144
  v_mfma_f32_16x16x32_bf16 v[136:139], a[156:159], a[88:91], 0
  ds_read_b128 a[4:7], v16 offset:2048
  v_mfma_f32_16x16x32_bf16 v[136:139], a[180:183], a[124:127], v[136:139]
  ds_read_b128 a[40:43], v17 offset:2048
  v_mfma_f32_16x16x32_bf16 v[140:143], a[156:159], a[92:95], 0
  v_mfma_f32_16x16x32_bf16 v[140:143], a[180:183], a[128:131], v[140:143]
  buffer_load_dwordx4 a[192:195], v2, s[52:55], s51 offen offset:2048
  v_mfma_f32_16x16x32_bf16 v[144:147], a[156:159], a[96:99], 0
  ds_read_b128 a[8:11], v16 offset:4096
  ds_read_b128 a[44:47], v17 offset:4096
  v_mfma_f32_16x16x32_bf16 v[144:147], a[180:183], a[132:135], v[144:147]
  v_mfma_f32_16x16x32_bf16 v[148:151], a[156:159], a[100:103], 0
  ds_read_b128 a[12:15], v16 offset:6144
  v_mfma_f32_16x16x32_bf16 v[148:151], a[180:183], a[136:139], v[148:151]
  ds_read_b128 a[48:51], v17 offset:6144
  v_mfma_f32_16x16x32_bf16 v[152:155], a[72:75], a[160:163], 0
  ds_read_b128 a[16:19], v16 offset:8192
  v_mfma_f32_16x16x32_bf16 v[152:155], a[108:111], a[184:187], v[152:155]
  buffer_load_dwordx4 a[192:195], v2, s[52:55], s51 offen offset:3072
  v_mfma_f32_16x16x32_bf16 v[156:159], a[76:79], a[160:163], 0
  s_add_u32 s51, s51, 4096
  s_add_u32 s0, s0, 1
  s_cmp_eq_u32 s0, 2
  s_cselect_b32 s52, s68, s52
  s_cselect_b32 s53, s69, s53
  s_cselect_b32 s51, s1, s51
  s_cselect_b32 s54, 0, s54
  v_mfma_f32_16x16x32_bf16 v[156:159], a[112:115], a[184:187], v[156:159]
  s_cmp_eq_u32 s0, 6
  s_cselect_b32 s52, s64, s52
  s_cselect_b32 s53, s65, s53
  s_cselect_b32 s51, s56, s51
  s_cselect_b32 s54, 0, s54
  v_mfma_f32_16x16x32_bf16 v[160:163], a[80:83], a[160:163], 0
  s_cmp_eq_u32 s0, 8
  s_cselect_b32 s54, 0, s54
  s_mov_b32 m0, s41
  v_mfma_f32_16x16x32_bf16 v[160:163], a[116:119], a[184:187], v[160:163]
  ds_read_b128 a[52:55], v17 offset:8192
  ds_read_b128 a[20:23], v16 offset:10240
  v_mfma_f32_16x16x32_bf16 v[164:167], a[84:87], a[160:163], 0
  buffer_load_dwordx4 v233, s[12:15], s47 offen offset:0 lds
  v_mfma_f32_16x16x32_bf16 v[164:167], a[120:123], a[184:187], v[164:167]
  ds_read_b128 a[56:59], v17 offset:10240
  ds_read_b128 a[24:27], v16 offset:12288
  v_mfma_f32_16x16x32_bf16 v[168:171], a[88:91], a[160:163], 0
  ds_read_b128 a[60:63], v17 offset:12288
  v_mfma_f32_16x16x32_bf16 v[168:171], a[124:127], a[184:187], v[168:171]
  ds_read_b128 a[28:31], v16 offset:14336
  v_mfma_f32_16x16x32_bf16 v[172:175], a[92:95], a[160:163], 0
  ds_read_b128 a[64:67], v17 offset:14336
  v_mfma_f32_16x16x32_bf16 v[172:175], a[128:131], a[184:187], v[172:175]
  v_mfma_f32_16x16x32_bf16 v[176:179], a[96:99], a[160:163], 0
  buffer_load_dwordx4 v234, s[12:15], s47 offen offset:1024 lds
  v_mfma_f32_16x16x32_bf16 v[176:179], a[132:135], a[184:187], v[176:179]
  ds_read_b64_tr_b16 a[148:149], v21 offset:0
  ds_read_b64_tr_b16 a[150:151], v21 offset:2048
  v_mfma_f32_16x16x32_bf16 v[180:183], a[100:103], a[160:163], 0
  ds_read_b64_tr_b16 a[172:173], v21 offset:4096
  v_mfma_f32_16x16x32_bf16 v[180:183], a[136:139], a[184:187], v[180:183]
  v_mfma_f32_16x16x32_bf16 v[216:219], a[104:107], a[160:163], 0
  ds_read_b64_tr_b16 a[174:175], v21 offset:6144
  v_mfma_f32_16x16x32_bf16 v[216:219], a[140:143], a[184:187], v[216:219]
  ds_read_b64_tr_b16 a[152:153], v20 offset:8192
  v_mfma_f32_16x16x32_bf16 v[184:187], a[72:75], a[164:167], 0
  buffer_load_dwordx4 v235, s[12:15], s47 offen offset:2048 lds
  v_mfma_f32_16x16x32_bf16 v[184:187], a[108:111], a[188:191], v[184:187]
  s_add_u32 m0, s41, 3072
  ds_read_b64_tr_b16 a[154:155], v20 offset:10240
  v_mfma_f32_16x16x32_bf16 v[188:191], a[76:79], a[164:167], 0
  ds_read_b64_tr_b16 a[176:177], v20 offset:12288
  v_mfma_f32_16x16x32_bf16 v[188:191], a[112:115], a[188:191], v[188:191]
  ds_read_b64_tr_b16 a[178:179], v20 offset:14336
  v_mfma_f32_16x16x32_bf16 v[192:195], a[80:83], a[164:167], 0
  v_mfma_f32_16x16x32_bf16 v[192:195], a[116:119], a[188:191], v[192:195]
  buffer_load_dwordx4 v236, s[12:15], s47 offen offset:0 lds
  v_mfma_f32_16x16x32_bf16 v[196:199], a[84:87], a[164:167], 0
  ds_read_b128 a[32:35], v18 offset:0
  ds_read_b128 a[68:71], v19 offset:0
  v_mfma_f32_16x16x32_bf16 v[196:199], a[120:123], a[188:191], v[196:199]
  v_mfma_f32_16x16x32_bf16 v[200:203], a[88:91], a[164:167], 0
  v_mfma_f32_16x16x32_bf16 v[200:203], a[124:127], a[188:191], v[200:203]
  v_mfma_f32_16x16x32_bf16 v[204:207], a[92:95], a[164:167], 0
  v_mfma_f32_16x16x32_bf16 v[204:207], a[128:131], a[188:191], v[204:207]
  buffer_load_dwordx4 v237, s[12:15], s47 offen offset:1024 lds
  v_mfma_f32_16x16x32_bf16 v[208:211], a[96:99], a[164:167], 0
  v_mfma_f32_16x16x32_bf16 v[208:211], a[132:135], a[188:191], v[208:211]
  v_mfma_f32_16x16x32_bf16 v[212:215], a[100:103], a[164:167], 0
  v_mfma_f32_16x16x32_bf16 v[212:215], a[136:139], a[188:191], v[212:215]
  v_mfma_f32_16x16x32_bf16 v[220:223], a[104:107], a[164:167], 0
  v_mfma_f32_16x16x32_bf16 v[220:223], a[140:143], a[188:191], v[220:223]
  s_waitcnt lgkmcnt(0)
  v_mfma_f32_16x16x32_bf16 v[24:27], a[144:147], a[0:3], v[24:27]
  buffer_load_dwordx4 v238, s[12:15], s47 offen offset:2048 lds
  v_mfma_f32_16x16x32_bf16 v[24:27], a[168:171], a[36:39], v[24:27]
  s_mov_b32 m0, s36
  ds_read_b64_tr_b16 a[156:157], v21 offset:8192
  v_mfma_f32_16x16x32_bf16 v[28:31], a[144:147], a[4:7], v[28:31]
  v_mfma_f32_16x16x32_bf16 v[28:31], a[168:171], a[40:43], v[28:31]
  ds_read_b64_tr_b16 a[158:159], v21 offset:10240
  v_mfma_f32_16x16x32_bf16 v[32:35], a[144:147], a[8:11], v[32:35]
  buffer_load_dwordx4 v224, s[8:11], s46 offen offset:0 lds
  v_mfma_f32_16x16x32_bf16 v[32:35], a[168:171], a[44:47], v[32:35]
  v_mfma_f32_16x16x32_bf16 v[36:39], a[144:147], a[12:15], v[36:39]
  ds_read_b64_tr_b16 a[180:181], v21 offset:12288
  v_mfma_f32_16x16x32_bf16 v[36:39], a[168:171], a[48:51], v[36:39]
  v_mfma_f32_16x16x32_bf16 v[40:43], a[144:147], a[16:19], v[40:43]
  v_mfma_f32_16x16x32_bf16 v[40:43], a[168:171], a[52:55], v[40:43]
  buffer_load_dwordx4 v225, s[8:11], s46 offen offset:1024 lds
  v_mfma_f32_16x16x32_bf16 v[44:47], a[144:147], a[20:23], v[44:47]
  ds_read_b64_tr_b16 a[182:183], v21 offset:14336
  v_mfma_f32_16x16x32_bf16 v[44:47], a[168:171], a[56:59], v[44:47]
  v_mfma_f32_16x16x32_bf16 v[48:51], a[144:147], a[24:27], v[48:51]
  ds_read_b64_tr_b16 a[160:161], v20 offset:16384
  v_mfma_f32_16x16x32_bf16 v[48:51], a[168:171], a[60:63], v[48:51]
  buffer_load_dwordx4 v226, s[8:11], s46 offen offset:2048 lds
  v_mfma_f32_16x16x32_bf16 v[52:55], a[144:147], a[28:31], v[52:55]
  v_mfma_f32_16x16x32_bf16 v[52:55], a[168:171], a[64:67], v[52:55]
  ds_read_b64_tr_b16 a[162:163], v20 offset:18432
  v_mfma_f32_16x16x32_bf16 v[56:59], a[148:151], a[0:3], v[56:59]
  v_mfma_f32_16x16x32_bf16 v[56:59], a[172:175], a[36:39], v[56:59]
  v_mfma_f32_16x16x32_bf16 v[60:63], a[148:151], a[4:7], v[60:63]
  buffer_load_dwordx4 v227, s[8:11], s46 offen offset:3072 lds
  v_mfma_f32_16x16x32_bf16 v[60:63], a[172:175], a[40:43], v[60:63]
  s_add_u32 m0, s36, 4096
  ds_read_b64_tr_b16 a[184:185], v20 offset:20480
  v_mfma_f32_16x16x32_bf16 v[64:67], a[148:151], a[8:11], v[64:67]
  s_add_u32 s36, s36, s38
  v_mfma_f32_16x16x32_bf16 v[64:67], a[172:175], a[44:47], v[64:67]
  s_add_u32 s37, s37, 1
  v_mfma_f32_16x16x32_bf16 v[68:71], a[148:151], a[12:15], v[68:71]
  buffer_load_dwordx4 v228, s[8:11], s46 offen offset:0 lds
  v_mfma_f32_16x16x32_bf16 v[68:71], a[172:175], a[48:51], v[68:71]
  ds_read_b64_tr_b16 a[186:187], v20 offset:22528
  v_mfma_f32_16x16x32_bf16 v[72:75], a[148:151], a[16:19], v[72:75]
  s_cmp_eq_u32 s37, 3
  s_cselect_b32 s37, 0, s37
  s_cselect_b32 s38, s39, s40
  v_mfma_f32_16x16x32_bf16 v[72:75], a[172:175], a[52:55], v[72:75]
  s_add_u32 s41, s41, s43
  ds_read_b64_tr_b16 a[164:165], v21 offset:16384
  v_mfma_f32_16x16x32_bf16 v[76:79], a[148:151], a[20:23], v[76:79]
  s_sub_u32 s43, 0, s43
  v_mfma_f32_16x16x32_bf16 v[76:79], a[172:175], a[56:59], v[76:79]
  buffer_load_dwordx4 v229, s[8:11], s46 offen offset:1024 lds
  v_mfma_f32_16x16x32_bf16 v[80:83], a[148:151], a[24:27], v[80:83]
  ds_read_b64_tr_b16 a[166:167], v21 offset:18432
  v_mfma_f32_16x16x32_bf16 v[80:83], a[172:175], a[60:63], v[80:83]
  v_mfma_f32_16x16x32_bf16 v[84:87], a[148:151], a[28:31], v[84:87]
  v_mfma_f32_16x16x32_bf16 v[84:87], a[172:175], a[64:67], v[84:87]
  buffer_load_dwordx4 v230, s[8:11], s46 offen offset:2048 lds
  v_mfma_f32_16x16x32_bf16 v[88:91], a[152:155], a[0:3], v[88:91]
  ds_read_b64_tr_b16 a[188:189], v21 offset:20480
  v_mfma_f32_16x16x32_bf16 v[88:91], a[176:179], a[36:39], v[88:91]
  v_mfma_f32_16x16x32_bf16 v[92:95], a[152:155], a[4:7], v[92:95]
  ds_read_b64_tr_b16 a[190:191], v21 offset:22528
  v_mfma_f32_16x16x32_bf16 v[92:95], a[176:179], a[40:43], v[92:95]
  v_add_u32 v16, s38, v16
  v_add_u32 v17, s38, v17
  v_mfma_f32_16x16x32_bf16 v[96:99], a[152:155], a[8:11], v[96:99]
  buffer_load_dwordx4 v231, s[8:11], s46 offen offset:3072 lds
  v_mfma_f32_16x16x32_bf16 v[96:99], a[176:179], a[44:47], v[96:99]
  s_mul_i32 s47, s48, 393216
  v_add_u32 v18, s38, v18
  v_add_u32 v19, s38, v19
  v_mfma_f32_16x16x32_bf16 v[100:103], a[152:155], a[12:15], v[100:103]
  s_bfe_u32 s34, 0x302010e, s49
  v_add_u32 v20, s43, v20
  v_add_u32 v21, s43, v21
  v_mfma_f32_16x16x32_bf16 v[100:103], a[176:179], a[48:51], v[100:103]
  s_add_u32 s48, s48, s34
  v_mfma_f32_16x16x32_bf16 v[104:107], a[152:155], a[16:19], v[104:107]
  s_add_u32 s49, s49, 8
  v_mfma_f32_16x16x32_bf16 v[104:107], a[176:179], a[52:55], v[104:107]
  s_and_b32 s49, s49, 0x8001f
  v_mfma_f32_16x16x32_bf16 v[108:111], a[152:155], a[20:23], v[108:111]
  s_and_b32 s48, s48, 15
  v_mfma_f32_16x16x32_bf16 v[108:111], a[176:179], a[56:59], v[108:111]
  s_lshl_b32 s46, s48, 7
  v_mfma_f32_16x16x32_bf16 v[112:115], a[152:155], a[24:27], v[112:115]
  v_mfma_f32_16x16x32_bf16 v[112:115], a[176:179], a[60:63], v[112:115]
  v_mfma_f32_16x16x32_bf16 v[116:119], a[152:155], a[28:31], v[116:119]
  v_mfma_f32_16x16x32_bf16 v[116:119], a[176:179], a[64:67], v[116:119]
  s_mov_b32 s35, 6
  s_waitcnt vmcnt(8) lgkmcnt(0)
  s_barrier
  .p2align 6
Lp2r1_loop:
  v_mfma_f32_16x16x32_bf16 v[120:123], a[156:159], a[0:3], v[120:123]
  buffer_load_dwordx4 a[192:195], v2, s[52:55], s51 offen offset:0
  v_mfma_f32_16x16x32_bf16 v[120:123], a[180:183], a[36:39], v[120:123]
  ds_read_b128 a[72:75], v16 offset:0
  ds_read_b128 a[108:111], v17 offset:0
  v_mfma_f32_16x16x32_bf16 v[124:127], a[156:159], a[4:7], v[124:127]
  ds_read_b64_tr_b16 a[144:145], v20 offset:0
  v_mfma_f32_16x16x32_bf16 v[124:127], a[180:183], a[40:43], v[124:127]
  v_mfma_f32_16x16x32_bf16 v[128:131], a[156:159], a[8:11], v[128:131]
  ds_read_b64_tr_b16 a[146:147], v20 offset:2048
  v_mfma_f32_16x16x32_bf16 v[128:131], a[180:183], a[44:47], v[128:131]
  buffer_load_dwordx4 a[192:195], v2, s[52:55], s51 offen offset:1024
  v_mfma_f32_16x16x32_bf16 v[132:135], a[156:159], a[12:15], v[132:135]
  ds_read_b64_tr_b16 a[168:169], v20 offset:4096
  v_mfma_f32_16x16x32_bf16 v[132:135], a[180:183], a[48:51], v[132:135]
  ds_read_b64_tr_b16 a[170:171], v20 offset:6144
  v_mfma_f32_16x16x32_bf16 v[136:139], a[156:159], a[16:19], v[136:139]
  ds_read_b128 a[76:79], v16 offset:2048
  v_mfma_f32_16x16x32_bf16 v[136:139], a[180:183], a[52:55], v[136:139]
  ds_read_b128 a[112:115], v17 offset:2048
  v_mfma_f32_16x16x32_bf16 v[140:143], a[156:159], a[20:23], v[140:143]
  v_mfma_f32_16x16x32_bf16 v[140:143], a[180:183], a[56:59], v[140:143]
  buffer_load_dwordx4 a[192:195], v2, s[52:55], s51 offen offset:2048
  v_mfma_f32_16x16x32_bf16 v[144:147], a[156:159], a[24:27], v[144:147]
  ds_read_b128 a[80:83], v16 offset:4096
  ds_read_b128 a[116:119], v17 offset:4096
  v_mfma_f32_16x16x32_bf16 v[144:147], a[180:183], a[60:63], v[144:147]
  v_mfma_f32_16x16x32_bf16 v[148:151], a[156:159], a[28:31], v[148:151]
  ds_read_b128 a[84:87], v16 offset:6144
  v_mfma_f32_16x16x32_bf16 v[148:151], a[180:183], a[64:67], v[148:151]
  ds_read_b128 a[120:123], v17 offset:6144
  v_mfma_f32_16x16x32_bf16 v[152:155], a[0:3], a[160:163], v[152:155]
  ds_read_b128 a[88:91], v16 offset:8192
  v_mfma_f32_16x16x32_bf16 v[152:155], a[36:39], a[184:187], v[152:155]
  buffer_load_dwordx4 a[192:195], v2, s[52:55], s51 offen offset:3072
  v_mfma_f32_16x16x32_bf16 v[156:159], a[4:7], a[160:163], v[156:159]
  s_add_u32 s51, s51, 4096
  s_add_u32 s0, s0, 1
  s_cmp_eq_u32 s0, 2
  s_cselect_b32 s52, s68, s52
  s_cselect_b32 s53, s69, s53
  s_cselect_b32 s51, s1, s51
  s_cselect_b32 s54, 0, s54
  v_mfma_f32_16x16x32_bf16 v[156:159], a[40:43], a[184:187], v[156:159]
  s_cmp_eq_u32 s0, 6
  s_cselect_b32 s52, s64, s52
  s_cselect_b32 s53, s65, s53
  s_cselect_b32 s51, s56, s51
  s_cselect_b32 s54, 0, s54
  v_mfma_f32_16x16x32_bf16 v[160:163], a[8:11], a[160:163], v[160:163]
  s_cmp_eq_u32 s0, 8
  s_cselect_b32 s54, 0, s54
  s_mov_b32 m0, s41
  v_mfma_f32_16x16x32_bf16 v[160:163], a[44:47], a[184:187], v[160:163]
  ds_read_b128 a[124:127], v17 offset:8192
  ds_read_b128 a[92:95], v16 offset:10240
  v_mfma_f32_16x16x32_bf16 v[164:167], a[12:15], a[160:163], v[164:167]
  buffer_load_dwordx4 v233, s[12:15], s47 offen offset:0 lds
  v_mfma_f32_16x16x32_bf16 v[164:167], a[48:51], a[184:187], v[164:167]
  ds_read_b128 a[128:131], v17 offset:10240
  ds_read_b128 a[96:99], v16 offset:12288
  v_mfma_f32_16x16x32_bf16 v[168:171], a[16:19], a[160:163], v[168:171]
  ds_read_b128 a[132:135], v17 offset:12288
  v_mfma_f32_16x16x32_bf16 v[168:171], a[52:55], a[184:187], v[168:171]
  ds_read_b128 a[100:103], v16 offset:14336
  v_mfma_f32_16x16x32_bf16 v[172:175], a[20:23], a[160:163], v[172:175]
  ds_read_b128 a[136:139], v17 offset:14336
  v_mfma_f32_16x16x32_bf16 v[172:175], a[56:59], a[184:187], v[172:175]
  v_mfma_f32_16x16x32_bf16 v[176:179], a[24:27], a[160:163], v[176:179]
  buffer_load_dwordx4 v234, s[12:15], s47 offen offset:1024 lds
  v_mfma_f32_16x16x32_bf16 v[176:179], a[60:63], a[184:187], v[176:179]
  ds_read_b64_tr_b16 a[148:149], v21 offset:0
  ds_read_b64_tr_b16 a[150:151], v21 offset:2048
  v_mfma_f32_16x16x32_bf16 v[180:183], a[28:31], a[160:163], v[180:183]
  ds_read_b64_tr_b16 a[172:173], v21 offset:4096
  v_mfma_f32_16x16x32_bf16 v[180:183], a[64:67], a[184:187], v[180:183]
  v_mfma_f32_16x16x32_bf16 v[216:219], a[32:35], a[160:163], v[216:219]
  ds_read_b64_tr_b16 a[174:175], v21 offset:6144
  v_mfma_f32_16x16x32_bf16 v[216:219], a[68:71], a[184:187], v[216:219]
  ds_read_b64_tr_b16 a[152:153], v20 offset:8192
  v_mfma_f32_16x16x32_bf16 v[184:187], a[0:3], a[164:167], v[184:187]
  buffer_load_dwordx4 v235, s[12:15], s47 offen offset:2048 lds
  v_mfma_f32_16x16x32_bf16 v[184:187], a[36:39], a[188:191], v[184:187]
  s_add_u32 m0, s41, 3072
  ds_read_b64_tr_b16 a[154:155], v20 offset:10240
  v_mfma_f32_16x16x32_bf16 v[188:191], a[4:7], a[164:167], v[188:191]
  ds_read_b64_tr_b16 a[176:177], v20 offset:12288
  v_mfma_f32_16x16x32_bf16 v[188:191], a[40:43], a[188:191], v[188:191]
  ds_read_b64_tr_b16 a[178:179], v20 offset:14336
  v_mfma_f32_16x16x32_bf16 v[192:195], a[8:11], a[164:167], v[192:195]
  v_mfma_f32_16x16x32_bf16 v[192:195], a[44:47], a[188:191], v[192:195]
  buffer_load_dwordx4 v236, s[12:15], s47 offen offset:0 lds
  v_mfma_f32_16x16x32_bf16 v[196:199], a[12:15], a[164:167], v[196:199]
  ds_read_b128 a[104:107], v18 offset:0
  ds_read_b128 a[140:143], v19 offset:0
  v_mfma_f32_16x16x32_bf16 v[196:199], a[48:51], a[188:191], v[196:199]
  v_mfma_f32_16x16x32_bf16 v[200:203], a[16:19], a[164:167], v[200:203]
  v_mfma_f32_16x16x32_bf16 v[200:203], a[52:55], a[188:191], v[200:203]
  v_mfma_f32_16x16x32_bf16 v[204:207], a[20:23], a[164:167], v[204:207]
  v_mfma_f32_16x16x32_bf16 v[204:207], a[56:59], a[188:191], v[204:207]
  buffer_load_dwordx4 v237, s[12:15], s47 offen offset:1024 lds
  v_mfma_f32_16x16x32_bf16 v[208:211], a[24:27], a[164:167], v[208:211]
  v_mfma_f32_16x16x32_bf16 v[208:211], a[60:63], a[188:191], v[208:211]
  v_mfma_f32_16x16x32_bf16 v[212:215], a[28:31], a[164:167], v[212:215]
  v_mfma_f32_16x16x32_bf16 v[212:215], a[64:67], a[188:191], v[212:215]
  v_mfma_f32_16x16x32_bf16 v[220:223], a[32:35], a[164:167], v[220:223]
  v_mfma_f32_16x16x32_bf16 v[220:223], a[68:71], a[188:191], v[220:223]
  s_waitcnt lgkmcnt(0)
  v_mfma_f32_16x16x32_bf16 v[24:27], a[144:147], a[72:75], v[24:27]
  buffer_load_dwordx4 v238, s[12:15], s47 offen offset:2048 lds
  v_mfma_f32_16x16x32_bf16 v[24:27], a[168:171], a[108:111], v[24:27]
  s_mov_b32 m0, s36
  ds_read_b64_tr_b16 a[156:157], v21 offset:8192
  v_mfma_f32_16x16x32_bf16 v[28:31], a[144:147], a[76:79], v[28:31]
  v_mfma_f32_16x16x32_bf16 v[28:31], a[168:171], a[112:115], v[28:31]
  ds_read_b64_tr_b16 a[158:159], v21 offset:10240
  v_mfma_f32_16x16x32_bf16 v[32:35], a[144:147], a[80:83], v[32:35]
  buffer_load_dwordx4 v224, s[8:11], s46 offen offset:0 lds
  v_mfma_f32_16x16x32_bf16 v[32:35], a[168:171], a[116:119], v[32:35]
  v_mfma_f32_16x16x32_bf16 v[36:39], a[144:147], a[84:87], v[36:39]
  ds_read_b64_tr_b16 a[180:181], v21 offset:12288
  v_mfma_f32_16x16x32_bf16 v[36:39], a[168:171], a[120:123], v[36:39]
  v_mfma_f32_16x16x32_bf16 v[40:43], a[144:147], a[88:91], v[40:43]
  v_mfma_f32_16x16x32_bf16 v[40:43], a[168:171], a[124:127], v[40:43]
  buffer_load_dwordx4 v225, s[8:11], s46 offen offset:1024 lds
  v_mfma_f32_16x16x32_bf16 v[44:47], a[144:147], a[92:95], v[44:47]
  ds_read_b64_tr_b16 a[182:183], v21 offset:14336
  v_mfma_f32_16x16x32_bf16 v[44:47], a[168:171], a[128:131], v[44:47]
  v_mfma_f32_16x16x32_bf16 v[48:51], a[144:147], a[96:99], v[48:51]
  ds_read_b64_tr_b16 a[160:161], v20 offset:16384
  v_mfma_f32_16x16x32_bf16 v[48:51], a[168:171], a[132:135], v[48:51]
  buffer_load_dwordx4 v226, s[8:11], s46 offen offset:2048 lds
  v_mfma_f32_16x16x32_bf16 v[52:55], a[144:147], a[100:103], v[52:55]
  v_mfma_f32_16x16x32_bf16 v[52:55], a[168:171], a[136:139], v[52:55]
  ds_read_b64_tr_b16 a[162:163], v20 offset:18432
  v_mfma_f32_16x16x32_bf16 v[56:59], a[148:151], a[72:75], v[56:59]
  v_mfma_f32_16x16x32_bf16 v[56:59], a[172:175], a[108:111], v[56:59]
  v_mfma_f32_16x16x32_bf16 v[60:63], a[148:151], a[76:79], v[60:63]
  buffer_load_dwordx4 v227, s[8:11], s46 offen offset:3072 lds
  v_mfma_f32_16x16x32_bf16 v[60:63], a[172:175], a[112:115], v[60:63]
  s_add_u32 m0, s36, 4096
  ds_read_b64_tr_b16 a[184:185], v20 offset:20480
  v_mfma_f32_16x16x32_bf16 v[64:67], a[148:151], a[80:83], v[64:67]
  s_add_u32 s36, s36, s38
  v_mfma_f32_16x16x32_bf16 v[64:67], a[172:175], a[116:119], v[64:67]
  s_add_u32 s37, s37, 1
  v_mfma_f32_16x16x32_bf16 v[68:71], a[148:151], a[84:87], v[68:71]
  buffer_load_dwordx4 v228, s[8:11], s46 offen offset:0 lds
  v_mfma_f32_16x16x32_bf16 v[68:71], a[172:175], a[120:123], v[68:71]
  ds_read_b64_tr_b16 a[186:187], v20 offset:22528
  v_mfma_f32_16x16x32_bf16 v[72:75], a[148:151], a[88:91], v[72:75]
  s_cmp_eq_u32 s37, 3
  s_cselect_b32 s37, 0, s37
  s_cselect_b32 s38, s39, s40
  v_mfma_f32_16x16x32_bf16 v[72:75], a[172:175], a[124:127], v[72:75]
  s_add_u32 s41, s41, s43
  ds_read_b64_tr_b16 a[164:165], v21 offset:16384
  v_mfma_f32_16x16x32_bf16 v[76:79], a[148:151], a[92:95], v[76:79]
  s_sub_u32 s43, 0, s43
  v_mfma_f32_16x16x32_bf16 v[76:79], a[172:175], a[128:131], v[76:79]
  buffer_load_dwordx4 v229, s[8:11], s46 offen offset:1024 lds
  v_mfma_f32_16x16x32_bf16 v[80:83], a[148:151], a[96:99], v[80:83]
  ds_read_b64_tr_b16 a[166:167], v21 offset:18432
  v_mfma_f32_16x16x32_bf16 v[80:83], a[172:175], a[132:135], v[80:83]
  v_mfma_f32_16x16x32_bf16 v[84:87], a[148:151], a[100:103], v[84:87]
  v_mfma_f32_16x16x32_bf16 v[84:87], a[172:175], a[136:139], v[84:87]
  buffer_load_dwordx4 v230, s[8:11], s46 offen offset:2048 lds
  v_mfma_f32_16x16x32_bf16 v[88:91], a[152:155], a[72:75], v[88:91]
  ds_read_b64_tr_b16 a[188:189], v21 offset:20480
  v_mfma_f32_16x16x32_bf16 v[88:91], a[176:179], a[108:111], v[88:91]
  v_mfma_f32_16x16x32_bf16 v[92:95], a[152:155], a[76:79], v[92:95]
  ds_read_b64_tr_b16 a[190:191], v21 offset:22528
  v_mfma_f32_16x16x32_bf16 v[92:95], a[176:179], a[112:115], v[92:95]
  v_add_u32 v16, s38, v16
  v_add_u32 v17, s38, v17
  v_mfma_f32_16x16x32_bf16 v[96:99], a[152:155], a[80:83], v[96:99]
  buffer_load_dwordx4 v231, s[8:11], s46 offen offset:3072 lds
  v_mfma_f32_16x16x32_bf16 v[96:99], a[176:179], a[116:119], v[96:99]
  s_mul_i32 s47, s48, 393216
  v_add_u32 v18, s38, v18
  v_add_u32 v19, s38, v19
  v_mfma_f32_16x16x32_bf16 v[100:103], a[152:155], a[84:87], v[100:103]
  s_bfe_u32 s34, 0x302010e, s49
  v_add_u32 v20, s43, v20
  v_add_u32 v21, s43, v21
  v_mfma_f32_16x16x32_bf16 v[100:103], a[176:179], a[120:123], v[100:103]
  s_add_u32 s48, s48, s34
  v_mfma_f32_16x16x32_bf16 v[104:107], a[152:155], a[88:91], v[104:107]
  s_add_u32 s49, s49, 8
  v_mfma_f32_16x16x32_bf16 v[104:107], a[176:179], a[124:127], v[104:107]
  s_and_b32 s49, s49, 0x8001f
  v_mfma_f32_16x16x32_bf16 v[108:111], a[152:155], a[92:95], v[108:111]
  s_and_b32 s48, s48, 15
  v_mfma_f32_16x16x32_bf16 v[108:111], a[176:179], a[128:131], v[108:111]
  s_lshl_b32 s46, s48, 7
  v_mfma_f32_16x16x32_bf16 v[112:115], a[152:155], a[96:99], v[112:115]
  v_mfma_f32_16x16x32_bf16 v[112:115], a[176:179], a[132:135], v[112:115]
  v_mfma_f32_16x16x32_bf16 v[116:119], a[152:155], a[100:103], v[116:119]
  v_mfma_f32_16x16x32_bf16 v[116:119], a[176:179], a[136:139], v[116:119]
  s_waitcnt vmcnt(8) lgkmcnt(0)
  s_barrier
  v_mfma_f32_16x16x32_bf16 v[120:123], a[156:159], a[72:75], v[120:123]
  buffer_load_dwordx4 a[192:195], v2, s[52:55], s51 offen offset:0
  v_mfma_f32_16x16x32_bf16 v[120:123], a[180:183], a[108:111], v[120:123]
  ds_read_b128 a[0:3], v16 offset:0
  ds_read_b128 a[36:39], v17 offset:0
  v_mfma_f32_16x16x32_bf16 v[124:127], a[156:159], a[76:79], v[124:127]
  ds_read_b64_tr_b16 a[144:145], v20 offset:0
  v_mfma_f32_16x16x32_bf16 v[124:127], a[180:183], a[112:115], v[124:127]
  v_mfma_f32_16x16x32_bf16 v[128:131], a[156:159], a[80:83], v[128:131]
  ds_read_b64_tr_b16 a[146:147], v20 offset:2048
  v_mfma_f32_16x16x32_bf16 v[128:131], a[180:183], a[116:119], v[128:131]
  buffer_load_dwordx4 a[192:195], v2, s[52:55], s51 offen offset:1024
  v_mfma_f32_16x16x32_bf16 v[132:135], a[156:159], a[84:87], v[132:135]
  ds_read_b64_tr_b16 a[168:169], v20 offset:4096
  v_mfma_f32_16x16x32_bf16 v[132:135], a[180:183], a[120:123], v[132:135]
  ds_read_b64_tr_b16 a[170:171], v20 offset:6144
  v_mfma_f32_16x16x32_bf16 v[136:139], a[156:159], a[88:91], v[136:139]
  ds_read_b128 a[4:7], v16 offset:2048
  v_mfma_f32_16x16x32_bf16 v[136:139], a[180:183], a[124:127], v[136:139]
  ds_read_b128 a[40:43], v17 offset:2048
  v_mfma_f32_16x16x32_bf16 v[140:143], a[156:159], a[92:95], v[140:143]
  v_mfma_f32_16x16x32_bf16 v[140:143], a[180:183], a[128:131], v[140:143]
  buffer_load_dwordx4 a[192:195], v2, s[52:55], s51 offen offset:2048
  v_mfma_f32_16x16x32_bf16 v[144:147], a[156:159], a[96:99], v[144:147]
  ds_read_b128 a[8:11], v16 offset:4096
  ds_read_b128 a[44:47], v17 offset:4096
  v_mfma_f32_16x16x32_bf16 v[144:147], a[180:183], a[132:135], v[144:147]
  v_mfma_f32_16x16x32_bf16 v[148:151], a[156:159], a[100:103], v[148:151]
  ds_read_b128 a[12:15], v16 offset:6144
  v_mfma_f32_16x16x32_bf16 v[148:151], a[180:183], a[136:139], v[148:151]
  ds_read_b128 a[48:51], v17 offset:6144
  v_mfma_f32_16x16x32_bf16 v[152:155], a[72:75], a[160:163], v[152:155]
  ds_read_b128 a[16:19], v16 offset:8192
  v_mfma_f32_16x16x32_bf16 v[152:155], a[108:111], a[184:187], v[152:155]
  buffer_load_dwordx4 a[192:195], v2, s[52:55], s51 offen offset:3072
  v_mfma_f32_16x16x32_bf16 v[156:159], a[76:79], a[160:163], v[156:159]
  s_add_u32 s51, s51, 4096
  s_add_u32 s0, s0, 1
  s_cmp_eq_u32 s0, 2
  s_cselect_b32 s52, s68, s52
  s_cselect_b32 s53, s69, s53
  s_cselect_b32 s51, s1, s51
  s_cselect_b32 s54, 0, s54
  v_mfma_f32_16x16x32_bf16 v[156:159], a[112:115], a[184:187], v[156:159]
  s_cmp_eq_u32 s0, 6
  s_cselect_b32 s52, s64, s52
  s_cselect_b32 s53, s65, s53
  s_cselect_b32 s51, s56, s51
  s_cselect_b32 s54, 0, s54
  v_mfma_f32_16x16x32_bf16 v[160:163], a[80:83], a[160:163], v[160:163]
  s_cmp_eq_u32 s0, 8
  s_cselect_b32 s54, 0, s54
  s_mov_b32 m0, s41
  v_mfma_f32_16x16x32_bf16 v[160:163], a[116:119], a[184:187], v[160:163]
  ds_read_b128 a[52:55], v17 offset:8192
  ds_read_b128 a[20:23], v16 offset:10240
  v_mfma_f32_16x16x32_bf16 v[164:167], a[84:87], a[160:163], v[164:167]
  buffer_load_dwordx4 v233, s[12:15], s47 offen offset:0 lds
  v_mfma_f32_16x16x32_bf16 v[164:167], a[120:123], a[184:187], v[164:167]
  ds_read_b128 a[56:59], v17 offset:10240
  ds_read_b128 a[24:27], v16 offset:12288
  v_mfma_f32_16x16x32_bf16 v[168:171], a[88:91], a[160:163], v[168:171]
  ds_read_b128 a[60:63], v17 offset:12288
  v_mfma_f32_16x16x32_bf16 v[168:171], a[124:127], a[184:187], v[168:171]
  ds_read_b128 a[28:31], v16 offset:14336
  v_mfma_f32_16x16x32_bf16 v[172:175], a[92:95], a[160:163], v[172:175]
  ds_read_b128 a[64:67], v17 offset:14336
  v_mfma_f32_16x16x32_bf16 v[172:175], a[128:131], a[184:187], v[172:175]
  v_mfma_f32_16x16x32_bf16 v[176:179], a[96:99], a[160:163], v[176:179]
  buffer_load_dwordx4 v234, s[12:15], s47 offen offset:1024 lds
  v_mfma_f32_16x16x32_bf16 v[176:179], a[132:135], a[184:187], v[176:179]
  ds_read_b64_tr_b16 a[148:149], v21 offset:0
  ds_read_b64_tr_b16 a[150:151], v21 offset:2048
  v_mfma_f32_16x16x32_bf16 v[180:183], a[100:103], a[160:163], v[180:183]
  ds_read_b64_tr_b16 a[172:173], v21 offset:4096
  v_mfma_f32_16x16x32_bf16 v[180:183], a[136:139], a[184:187], v[180:183]
  v_mfma_f32_16x16x32_bf16 v[216:219], a[104:107], a[160:163], v[216:219]
  ds_read_b64_tr_b16 a[174:175], v21 offset:6144
  v_mfma_f32_16x16x32_bf16 v[216:219], a[140:143], a[184:187], v[216:219]
  ds_read_b64_tr_b16 a[152:153], v20 offset:8192
  v_mfma_f32_16x16x32_bf16 v[184:187], a[72:75], a[164:167], v[184:187]
  buffer_load_dwordx4 v235, s[12:15], s47 offen offset:2048 lds
  v_mfma_f32_16x16x32_bf16 v[184:187], a[108:111], a[188:191], v[184:187]
  s_add_u32 m0, s41, 3072
  ds_read_b64_tr_b16 a[154:155], v20 offset:10240
  v_mfma_f32_16x16x32_bf16 v[188:191], a[76:79], a[164:167], v[188:191]
  ds_read_b64_tr_b16 a[176:177], v20 offset:12288
  v_mfma_f32_16x16x32_bf16 v[188:191], a[112:115], a[188:191], v[188:191]
  ds_read_b64_tr_b16 a[178:179], v20 offset:14336
  v_mfma_f32_16x16x32_bf16 v[192:195], a[80:83], a[164:167], v[192:195]
  v_mfma_f32_16x16x32_bf16 v[192:195], a[116:119], a[188:191], v[192:195]
  buffer_load_dwordx4 v236, s[12:15], s47 offen offset:0 lds
  v_mfma_f32_16x16x32_bf16 v[196:199], a[84:87], a[164:167], v[196:199]
  ds_read_b128 a[32:35], v18 offset:0
  ds_read_b128 a[68:71], v19 offset:0
  v_mfma_f32_16x16x32_bf16 v[196:199], a[120:123], a[188:191], v[196:199]
  v_mfma_f32_16x16x32_bf16 v[200:203], a[88:91], a[164:167], v[200:203]
  v_mfma_f32_16x16x32_bf16 v[200:203], a[124:127], a[188:191], v[200:203]
  v_mfma_f32_16x16x32_bf16 v[204:207], a[92:95], a[164:167], v[204:207]
  v_mfma_f32_16x16x32_bf16 v[204:207], a[128:131], a[188:191], v[204:207]
  buffer_load_dwordx4 v237, s[12:15], s47 offen offset:1024 lds
  v_mfma_f32_16x16x32_bf16 v[208:211], a[96:99], a[164:167], v[208:211]
  v_mfma_f32_16x16x32_bf16 v[208:211], a[132:135], a[188:191], v[208:211]
  v_mfma_f32_16x16x32_bf16 v[212:215], a[100:103], a[164:167], v[212:215]
  v_mfma_f32_16x16x32_bf16 v[212:215], a[136:139], a[188:191], v[212:215]
  v_mfma_f32_16x16x32_bf16 v[220:223], a[104:107], a[164:167], v[220:223]
  v_mfma_f32_16x16x32_bf16 v[220:223], a[140:143], a[188:191], v[220:223]
  s_waitcnt lgkmcnt(0)
  v_mfma_f32_16x16x32_bf16 v[24:27], a[144:147], a[0:3], v[24:27]
  buffer_load_dwordx4 v238, s[12:15], s47 offen offset:2048 lds
  v_mfma_f32_16x16x32_bf16 v[24:27], a[168:171], a[36:39], v[24:27]
  s_mov_b32 m0, s36
  ds_read_b64_tr_b16 a[156:157], v21 offset:8192
  v_mfma_f32_16x16x32_bf16 v[28:31], a[144:147], a[4:7], v[28:31]
  v_mfma_f32_16x16x32_bf16 v[28:31], a[168:171], a[40:43], v[28:31]
  ds_read_b64_tr_b16 a[158:159], v21 offset:10240
  v_mfma_f32_16x16x32_bf16 v[32:35], a[144:147], a[8:11], v[32:35]
  buffer_load_dwordx4 v224, s[8:11], s46 offen offset:0 lds
  v_mfma_f32_16x16x32_bf16 v[32:35], a[168:171], a[44:47], v[32:35]
  v_mfma_f32_16x16x32_bf16 v[36:39], a[144:147], a[12:15], v[36:39]
  ds_read_b64_tr_b16 a[180:181], v21 offset:12288
  v_mfma_f32_16x16x32_bf16 v[36:39], a[168:171], a[48:51], v[36:39]
  v_mfma_f32_16x16x32_bf16 v[40:43], a[144:147], a[16:19], v[40:43]
  v_mfma_f32_16x16x32_bf16 v[40:43], a[168:171], a[52:55], v[40:43]
  buffer_load_dwordx4 v225, s[8:11], s46 offen offset:1024 lds
  v_mfma_f32_16x16x32_bf16 v[44:47], a[144:147], a[20:23], v[44:47]
  ds_read_b64_tr_b16 a[182:183], v21 offset:14336
  v_mfma_f32_16x16x32_bf16 v[44:47], a[168:171], a[56:59], v[44:47]
  v_mfma_f32_16x16x32_bf16 v[48:51], a[144:147], a[24:27], v[48:51]
  ds_read_b64_tr_b16 a[160:161], v20 offset:16384
  v_mfma_f32_16x16x32_bf16 v[48:51], a[168:171], a[60:63], v[48:51]
  buffer_load_dwordx4 v226, s[8:11], s46 offen offset:2048 lds
  v_mfma_f32_16x16x32_bf16 v[52:55], a[144:147], a[28:31], v[52:55]
  v_mfma_f32_16x16x32_bf16 v[52:55], a[168:171], a[64:67], v[52:55]
  ds_read_b64_tr_b16 a[162:163], v20 offset:18432
  v_mfma_f32_16x16x32_bf16 v[56:59], a[148:151], a[0:3], v[56:59]
  v_mfma_f32_16x16x32_bf16 v[56:59], a[172:175], a[36:39], v[56:59]
  v_mfma_f32_16x16x32_bf16 v[60:63], a[148:151], a[4:7], v[60:63]
  buffer_load_dwordx4 v227, s[8:11], s46 offen offset:3072 lds
  v_mfma_f32_16x16x32_bf16 v[60:63], a[172:175], a[40:43], v[60:63]
  s_add_u32 m0, s36, 4096
  ds_read_b64_tr_b16 a[184:185], v20 offset:20480
  v_mfma_f32_16x16x32_bf16 v[64:67], a[148:151], a[8:11], v[64:67]
  s_add_u32 s36, s36, s38
  v_mfma_f32_16x16x32_bf16 v[64:67], a[172:175], a[44:47], v[64:67]
  s_add_u32 s37, s37, 1
  v_mfma_f32_16x16x32_bf16 v[68:71], a[148:151], a[12:15], v[68:71]
  buffer_load_dwordx4 v228, s[8:11], s46 offen offset:0 lds
  v_mfma_f32_16x16x32_bf16 v[68:71], a[172:175], a[48:51], v[68:71]
  ds_read_b64_tr_b16 a[186:187], v20 offset:22528
  v_mfma_f32_16x16x32_bf16 v[72:75], a[148:151], a[16:19], v[72:75]
  s_cmp_eq_u32 s37, 3
  s_cselect_b32 s37, 0, s37
  s_cselect_b32 s38, s39, s40
  v_mfma_f32_16x16x32_bf16 v[72:75], a[172:175], a[52:55], v[72:75]
  s_add_u32 s41, s41, s43
  ds_read_b64_tr_b16 a[164:165], v21 offset:16384
  v_mfma_f32_16x16x32_bf16 v[76:79], a[148:151], a[20:23], v[76:79]
  s_sub_u32 s43, 0, s43
  v_mfma_f32_16x16x32_bf16 v[76:79], a[172:175], a[56:59], v[76:79]
  buffer_load_dwordx4 v229, s[8:11], s46 offen offset:1024 lds
  v_mfma_f32_16x16x32_bf16 v[80:83], a[148:151], a[24:27], v[80:83]
  ds_read_b64_tr_b16 a[166:167], v21 offset:18432
  v_mfma_f32_16x16x32_bf16 v[80:83], a[172:175], a[60:63], v[80:83]
  v_mfma_f32_16x16x32_bf16 v[84:87], a[148:151], a[28:31], v[84:87]
  v_mfma_f32_16x16x32_bf16 v[84:87], a[172:175], a[64:67], v[84:87]
  buffer_load_dwordx4 v230, s[8:11], s46 offen offset:2048 lds
  v_mfma_f32_16x16x32_bf16 v[88:91], a[152:155], a[0:3], v[88:91]
  ds_read_b64_tr_b16 a[188:189], v21 offset:20480
  v_mfma_f32_16x16x32_bf16 v[88:91], a[176:179], a[36:39], v[88:91]
  v_mfma_f32_16x16x32_bf16 v[92:95], a[152:155], a[4:7], v[92:95]
  ds_read_b64_tr_b16 a[190:191], v21 offset:22528
  v_mfma_f32_16x16x32_bf16 v[92:95], a[176:179], a[40:43], v[92:95]
  v_add_u32 v16, s38, v16
  v_add_u32 v17, s38, v17
  v_mfma_f32_16x16x32_bf16 v[96:99], a[152:155], a[8:11], v[96:99]
  buffer_load_dwordx4 v231, s[8:11], s46 offen offset:3072 lds
  v_mfma_f32_16x16x32_bf16 v[96:99], a[176:179], a[44:47], v[96:99]
  s_mul_i32 s47, s48, 393216
  v_add_u32 v18, s38, v18
  v_add_u32 v19, s38, v19
  v_mfma_f32_16x16x32_bf16 v[100:103], a[152:155], a[12:15], v[100:103]
  s_bfe_u32 s34, 0x302010e, s49
  v_add_u32 v20, s43, v20
  v_add_u32 v21, s43, v21
  v_mfma_f32_16x16x32_bf16 v[100:103], a[176:179], a[48:51], v[100:103]
  s_add_u32 s48, s48, s34
  v_mfma_f32_16x16x32_bf16 v[104:107], a[152:155], a[16:19], v[104:107]
  s_add_u32 s49, s49, 8
  v_mfma_f32_16x16x32_bf16 v[104:107], a[176:179], a[52:55], v[104:107]
  s_and_b32 s49, s49, 0x8001f
  v_mfma_f32_16x16x32_bf16 v[108:111], a[152:155], a[20:23], v[108:111]
  s_and_b32 s48, s48, 15
  v_mfma_f32_16x16x32_bf16 v[108:111], a[176:179], a[56:59], v[108:111]
  s_lshl_b32 s46, s48, 7
  v_mfma_f32_16x16x32_bf16 v[112:115], a[152:155], a[24:27], v[112:115]
  v_mfma_f32_16x16x32_bf16 v[112:115], a[176:179], a[60:63], v[112:115]
  s_waitcnt vmcnt(8) lgkmcnt(0)
  s_barrier
  v_mfma_f32_16x16x32_bf16 v[116:119], a[152:155], a[28:31], v[116:119]
  s_sub_u32 s35, s35, 1
  v_mfma_f32_16x16x32_bf16 v[116:119], a[176:179], a[64:67], v[116:119]
  s_cmp_lg_u32 s35, 0
  s_cbranch_scc1 Lp2r1_loop
  v_accvgpr_read_b32 v4, a222
  v_accvgpr_read_b32 v5, a223
  v_accvgpr_read_b32 v6, a224
  v_accvgpr_read_b32 v7, a225
  v_accvgpr_read_b32 v8, a226
  v_accvgpr_read_b32 v9, a227
  v_accvgpr_read_b32 v10, a228
  v_accvgpr_read_b32 v11, a229
  s_mov_b32 s8, s64
  s_mov_b32 s9, s65
  s_mov_b32 s10, 4194304
  s_mov_b32 s11, 0x00020000
  s_mov_b32 s20, s68
  s_mov_b32 s21, s69
  s_mov_b32 s22, 8388608
  s_mov_b32 s23, 0x00020000
  s_and_b32 s4, s2, 7
  s_lshl_b32 s4, s4, 1
  s_lshr_b32 s5, s2, 6
  s_lshr_b32 s30, s2, 4
  s_add_u32 s5, s5, s30
  s_and_b32 s53, s5, 3
  s_lshl_b32 s53, s53, 3
  s_or_b32 s53, s53, 0x80000
  s_bfe_u32 s52, 0xf0f02, s53
  s_add_u32 s52, s52, s4
  s_and_b32 s52, s52, 15
  s_mov_b32 s54, s52
  s_mov_b32 s55, s53
  s_lshl_b32 s29, s52, 7
  s_lshl_b32 s28, s54, 19
  s_lshl_b32 s30, s25, 18
  s_and_b32 s31, s25, 1
  s_lshl_b32 s31, s31, 1
  s_add_u32 s31, s31, 14
  s_sub_u32 s31, s31, s25
  s_lshl_b32 s31, s31, 18
  s_or_b32 s26, s30, s29
  s_or_b32 s27, s31, s29
  s_lshl_b32 s68, s3, 12
  s_lshl_b32 s88, s3, 13
  s_add_u32 s88, s88, 98304
  v_mfma_f32_16x16x32_bf16 v[120:123], a[156:159], a[0:3], v[120:123]
  s_mov_b32 m0, s41
  ds_read_b128 a[72:75], v16 offset:0
  v_mfma_f32_16x16x32_bf16 v[120:123], a[180:183], a[36:39], v[120:123]
  buffer_load_dwordx4 v233, s[12:15], s47 offen offset:0 lds
  v_mfma_f32_16x16x32_bf16 v[124:127], a[156:159], a[4:7], v[124:127]
  ds_read_b128 a[108:111], v17 offset:0
  ds_read_b64_tr_b16 a[144:145], v20 offset:0
  v_mfma_f32_16x16x32_bf16 v[124:127], a[180:183], a[40:43], v[124:127]
  v_mfma_f32_16x16x32_bf16 v[128:131], a[156:159], a[8:11], v[128:131]
  ds_read_b64_tr_b16 a[146:147], v20 offset:2048
  v_mfma_f32_16x16x32_bf16 v[128:131], a[180:183], a[44:47], v[128:131]
  ds_read_b64_tr_b16 a[168:169], v20 offset:4096
  v_mfma_f32_16x16x32_bf16 v[132:135], a[156:159], a[12:15], v[132:135]
  v_mfma_f32_16x16x32_bf16 v[132:135], a[180:183], a[48:51], v[132:135]
  ds_read_b64_tr_b16 a[170:171], v20 offset:6144
  v_mfma_f32_16x16x32_bf16 v[136:139], a[156:159], a[16:19], v[136:139]
  ds_read_b128 a[76:79], v16 offset:2048
  v_mfma_f32_16x16x32_bf16 v[136:139], a[180:183], a[52:55], v[136:139]
  ds_read_b128 a[112:115], v17 offset:2048
  v_mfma_f32_16x16x32_bf16 v[140:143], a[156:159], a[20:23], v[140:143]
  v_mfma_f32_16x16x32_bf16 v[140:143], a[180:183], a[56:59], v[140:143]
  ds_read_b128 a[80:83], v16 offset:4096
  v_mfma_f32_16x16x32_bf16 v[144:147], a[156:159], a[24:27], v[144:147]
  ds_read_b128 a[116:119], v17 offset:4096
  v_mfma_f32_16x16x32_bf16 v[144:147], a[180:183], a[60:63], v[144:147]
  v_mfma_f32_16x16x32_bf16 v[148:151], a[156:159], a[28:31], v[148:151]
  ds_read_b128 a[84:87], v16 offset:6144
  v_mfma_f32_16x16x32_bf16 v[148:151], a[180:183], a[64:67], v[148:151]
  ds_read_b128 a[120:123], v17 offset:6144
  v_mfma_f32_16x16x32_bf16 v[152:155], a[0:3], a[160:163], v[152:155]
  ds_read_b128 a[88:91], v16 offset:8192
  v_mfma_f32_16x16x32_bf16 v[152:155], a[36:39], a[184:187], v[152:155]
  buffer_load_dwordx4 v234, s[12:15], s47 offen offset:1024 lds
  v_mfma_f32_16x16x32_bf16 v[156:159], a[4:7], a[160:163], v[156:159]
  ds_read_b128 a[124:127], v17 offset:8192
  v_mfma_f32_16x16x32_bf16 v[156:159], a[40:43], a[184:187], v[156:159]
  ds_read_b128 a[92:95], v16 offset:10240
  v_mfma_f32_16x16x32_bf16 v[160:163], a[8:11], a[160:163], v[160:163]
  v_mfma_f32_16x16x32_bf16 v[160:163], a[44:47], a[184:187], v[160:163]
  ds_read_b128 a[128:131], v17 offset:10240
  v_mfma_f32_16x16x32_bf16 v[164:167], a[12:15], a[160:163], v[164:167]
  ds_read_b128 a[96:99], v16 offset:12288
  v_mfma_f32_16x16x32_bf16 v[164:167], a[48:51], a[184:187], v[164:167]
  ds_read_b128 a[132:135], v17 offset:12288
  v_mfma_f32_16x16x32_bf16 v[168:171], a[16:19], a[160:163], v[168:171]
  v_mfma_f32_16x16x32_bf16 v[168:171], a[52:55], a[184:187], v[168:171]
  ds_read_b128 a[100:103], v16 offset:14336
  v_mfma_f32_16x16x32_bf16 v[172:175], a[20:23], a[160:163], v[172:175]
  ds_read_b128 a[136:139], v17 offset:14336
  v_mfma_f32_16x16x32_bf16 v[172:175], a[56:59], a[184:187], v[172:175]
  v_mfma_f32_16x16x32_bf16 v[176:179], a[24:27], a[160:163], v[176:179]
  ds_read_b64_tr_b16 a[148:149], v21 offset:0
  v_mfma_f32_16x16x32_bf16 v[176:179], a[60:63], a[184:187], v[176:179]
  ds_read_b64_tr_b16 a[150:151], v21 offset:2048
  v_mfma_f32_16x16x32_bf16 v[180:183], a[28:31], a[160:163], v[180:183]
  ds_read_b64_tr_b16 a[172:173], v21 offset:4096
  v_mfma_f32_16x16x32_bf16 v[180:183], a[64:67], a[184:187], v[180:183]
  v_mfma_f32_16x16x32_bf16 v[216:219], a[32:35], a[160:163], v[216:219]
  ds_read_b64_tr_b16 a[174:175], v21 offset:6144
  v_mfma_f32_16x16x32_bf16 v[216:219], a[68:71], a[184:187], v[216:219]
  ds_read_b64_tr_b16 a[152:153], v20 offset:8192
  v_mfma_f32_16x16x32_bf16 v[184:187], a[0:3], a[164:167], v[184:187]
  buffer_load_dwordx4 v235, s[12:15], s47 offen offset:2048 lds
  v_mfma_f32_16x16x32_bf16 v[184:187], a[36:39], a[188:191], v[184:187]
  ds_read_b64_tr_b16 a[154:155], v20 offset:10240
  v_mfma_f32_16x16x32_bf16 v[188:191], a[4:7], a[164:167], v[188:191]
  ds_read_b64_tr_b16 a[176:177], v20 offset:12288
  v_mfma_f32_16x16x32_bf16 v[188:191], a[40:43], a[188:191], v[188:191]
  ds_read_b64_tr_b16 a[178:179], v20 offset:14336
  v_mfma_f32_16x16x32_bf16 v[192:195], a[8:11], a[164:167], v[192:195]
  v_mfma_f32_16x16x32_bf16 v[192:195], a[44:47], a[188:191], v[192:195]
  ds_read_b128 a[104:107], v18 offset:0
  v_mfma_f32_16x16x32_bf16 v[196:199], a[12:15], a[164:167], v[196:199]
  ds_read_b128 a[140:143], v19 offset:0
  v_mfma_f32_16x16x32_bf16 v[196:199], a[48:51], a[188:191], v[196:199]
  v_mfma_f32_16x16x32_bf16 v[200:203], a[16:19], a[164:167], v[200:203]
  v_mfma_f32_16x16x32_bf16 v[200:203], a[52:55], a[188:191], v[200:203]
  v_mfma_f32_16x16x32_bf16 v[204:207], a[20:23], a[164:167], v[204:207]
  v_mfma_f32_16x16x32_bf16 v[204:207], a[56:59], a[188:191], v[204:207]
  v_mfma_f32_16x16x32_bf16 v[208:211], a[24:27], a[164:167], v[208:211]
  v_mfma_f32_16x16x32_bf16 v[208:211], a[60:63], a[188:191], v[208:211]
  v_mfma_f32_16x16x32_bf16 v[212:215], a[28:31], a[164:167], v[212:215]
  v_mfma_f32_16x16x32_bf16 v[212:215], a[64:67], a[188:191], v[212:215]
  v_mfma_f32_16x16x32_bf16 v[220:223], a[32:35], a[164:167], v[220:223]
  v_mfma_f32_16x16x32_bf16 v[220:223], a[68:71], a[188:191], v[220:223]
  s_waitcnt lgkmcnt(0)
  v_mfma_f32_16x16x32_bf16 v[24:27], a[144:147], a[72:75], v[24:27]
  s_add_u32 m0, s41, 3072
  ds_read_b64_tr_b16 a[156:157], v21 offset:8192
  v_mfma_f32_16x16x32_bf16 v[24:27], a[168:171], a[108:111], v[24:27]
  buffer_load_dwordx4 v236, s[12:15], s47 offen offset:0 lds
  v_mfma_f32_16x16x32_bf16 v[28:31], a[144:147], a[76:79], v[28:31]
  s_add_u32 s36, s36, s38
  v_mfma_f32_16x16x32_bf16 v[28:31], a[168:171], a[112:115], v[28:31]
  s_add_u32 s37, s37, 1
  ds_read_b64_tr_b16 a[158:159], v21 offset:10240
  v_mfma_f32_16x16x32_bf16 v[32:35], a[144:147], a[80:83], v[32:35]
  s_cmp_eq_u32 s37, 3
  s_cselect_b32 s37, 0, s37
  s_cselect_b32 s38, s39, s40
  v_mfma_f32_16x16x32_bf16 v[32:35], a[168:171], a[116:119], v[32:35]
  s_add_u32 s41, s41, s43
  v_mfma_f32_16x16x32_bf16 v[36:39], a[144:147], a[84:87], v[36:39]
  s_sub_u32 s43, 0, s43
  ds_read_b64_tr_b16 a[180:181], v21 offset:12288
  v_mfma_f32_16x16x32_bf16 v[36:39], a[168:171], a[120:123], v[36:39]
  v_mfma_f32_16x16x32_bf16 v[40:43], a[144:147], a[88:91], v[40:43]
  v_mfma_f32_16x16x32_bf16 v[40:43], a[168:171], a[124:127], v[40:43]
  ds_read_b64_tr_b16 a[182:183], v21 offset:14336
  v_mfma_f32_16x16x32_bf16 v[44:47], a[144:147], a[92:95], v[44:47]
  v_mfma_f32_16x16x32_bf16 v[44:47], a[168:171], a[128:131], v[44:47]
  v_mfma_f32_16x16x32_bf16 v[48:51], a[144:147], a[96:99], v[48:51]
  ds_read_b64_tr_b16 a[160:161], v20 offset:16384
  v_mfma_f32_16x16x32_bf16 v[48:51], a[168:171], a[132:135], v[48:51]
  buffer_load_dwordx4 v237, s[12:15], s47 offen offset:1024 lds
  v_mfma_f32_16x16x32_bf16 v[52:55], a[144:147], a[100:103], v[52:55]
  v_mfma_f32_16x16x32_bf16 v[52:55], a[168:171], a[136:139], v[52:55]
  ds_read_b64_tr_b16 a[162:163], v20 offset:18432
  v_mfma_f32_16x16x32_bf16 v[56:59], a[148:151], a[72:75], v[56:59]
  v_mfma_f32_16x16x32_bf16 v[56:59], a[172:175], a[108:111], v[56:59]
  v_mfma_f32_16x16x32_bf16 v[60:63], a[148:151], a[76:79], v[60:63]
  v_mfma_f32_16x16x32_bf16 v[60:63], a[172:175], a[112:115], v[60:63]
  ds_read_b64_tr_b16 a[184:185], v20 offset:20480
  v_mfma_f32_16x16x32_bf16 v[64:67], a[148:151], a[80:83], v[64:67]
  v_mfma_f32_16x16x32_bf16 v[64:67], a[172:175], a[116:119], v[64:67]
  v_mfma_f32_16x16x32_bf16 v[68:71], a[148:151], a[84:87], v[68:71]
  ds_read_b64_tr_b16 a[186:187], v20 offset:22528
  v_mfma_f32_16x16x32_bf16 v[68:71], a[172:175], a[120:123], v[68:71]
  v_mfma_f32_16x16x32_bf16 v[72:75], a[148:151], a[88:91], v[72:75]
  v_mfma_f32_16x16x32_bf16 v[72:75], a[172:175], a[124:127], v[72:75]
  ds_read_b64_tr_b16 a[164:165], v21 offset:16384
  v_mfma_f32_16x16x32_bf16 v[76:79], a[148:151], a[92:95], v[76:79]
  v_mfma_f32_16x16x32_bf16 v[76:79], a[172:175], a[128:131], v[76:79]
  buffer_load_dwordx4 v238, s[12:15], s47 offen offset:2048 lds
  v_mfma_f32_16x16x32_bf16 v[80:83], a[148:151], a[96:99], v[80:83]
  ds_read_b64_tr_b16 a[166:167], v21 offset:18432
  v_mfma_f32_16x16x32_bf16 v[80:83], a[172:175], a[132:135], v[80:83]
  v_mfma_f32_16x16x32_bf16 v[84:87], a[148:151], a[100:103], v[84:87]
  v_mfma_f32_16x16x32_bf16 v[84:87], a[172:175], a[136:139], v[84:87]
  ds_read_b64_tr_b16 a[188:189], v21 offset:20480
  v_mfma_f32_16x16x32_bf16 v[88:91], a[152:155], a[72:75], v[88:91]
  v_mfma_f32_16x16x32_bf16 v[88:91], a[176:179], a[108:111], v[88:91]
  v_mfma_f32_16x16x32_bf16 v[92:95], a[152:155], a[76:79], v[92:95]
  ds_read_b64_tr_b16 a[190:191], v21 offset:22528
  v_mfma_f32_16x16x32_bf16 v[92:95], a[176:179], a[112:115], v[92:95]
  v_add_u32 v16, s38, v16
  v_add_u32 v17, s38, v17
  v_mfma_f32_16x16x32_bf16 v[96:99], a[152:155], a[80:83], v[96:99]
  v_add_u32 v18, s38, v18
  v_add_u32 v19, s38, v19
  v_mfma_f32_16x16x32_bf16 v[96:99], a[176:179], a[116:119], v[96:99]
  v_add_u32 v20, s43, v20
  v_add_u32 v21, s43, v21
  v_mfma_f32_16x16x32_bf16 v[100:103], a[152:155], a[84:87], v[100:103]
  v_mfma_f32_16x16x32_bf16 v[100:103], a[176:179], a[120:123], v[100:103]
  v_mfma_f32_16x16x32_bf16 v[104:107], a[152:155], a[88:91], v[104:107]
  v_mfma_f32_16x16x32_bf16 v[104:107], a[176:179], a[124:127], v[104:107]
  v_mfma_f32_16x16x32_bf16 v[108:111], a[152:155], a[92:95], v[108:111]
  v_mfma_f32_16x16x32_bf16 v[108:111], a[176:179], a[128:131], v[108:111]
  v_mfma_f32_16x16x32_bf16 v[112:115], a[152:155], a[96:99], v[112:115]
  v_mfma_f32_16x16x32_bf16 v[112:115], a[176:179], a[132:135], v[112:115]
  v_mfma_f32_16x16x32_bf16 v[116:119], a[152:155], a[100:103], v[116:119]
  v_mfma_f32_16x16x32_bf16 v[116:119], a[176:179], a[136:139], v[116:119]
  s_waitcnt vmcnt(0) lgkmcnt(0)
  s_barrier
  s_mov_b32 s6, 0x3e8293ee
  s_mov_b32 s7, s6
  v_mfma_f32_16x16x32_bf16 v[120:123], a[156:159], a[72:75], v[120:123]
  ds_read_b128 a[0:3], v16 offset:0
  v_mfma_f32_16x16x32_bf16 v[120:123], a[180:183], a[108:111], v[120:123]
  ds_read_b128 a[36:39], v17 offset:0
  v_mfma_f32_16x16x32_bf16 v[124:127], a[156:159], a[76:79], v[124:127]
  ds_read_b64_tr_b16 a[144:145], v20 offset:0
  v_mfma_f32_16x16x32_bf16 v[124:127], a[180:183], a[112:115], v[124:127]
  v_mfma_f32_16x16x32_bf16 v[128:131], a[156:159], a[80:83], v[128:131]
  ds_read_b64_tr_b16 a[146:147], v20 offset:2048
  v_mfma_f32_16x16x32_bf16 v[128:131], a[180:183], a[116:119], v[128:131]
  ds_read_b64_tr_b16 a[168:169], v20 offset:4096
  v_mfma_f32_16x16x32_bf16 v[132:135], a[156:159], a[84:87], v[132:135]
  v_mfma_f32_16x16x32_bf16 v[132:135], a[180:183], a[120:123], v[132:135]
  ds_read_b64_tr_b16 a[170:171], v20 offset:6144
  v_mfma_f32_16x16x32_bf16 v[136:139], a[156:159], a[88:91], v[136:139]
  ds_read_b128 a[4:7], v16 offset:2048
  v_mfma_f32_16x16x32_bf16 v[136:139], a[180:183], a[124:127], v[136:139]
  ds_read_b128 a[40:43], v17 offset:2048
  v_mfma_f32_16x16x32_bf16 v[140:143], a[156:159], a[92:95], v[140:143]
  v_mfma_f32_16x16x32_bf16 v[140:143], a[180:183], a[128:131], v[140:143]
  ds_read_b128 a[8:11], v16 offset:4096
  v_mfma_f32_16x16x32_bf16 v[144:147], a[156:159], a[96:99], v[144:147]
  ds_read_b128 a[44:47], v17 offset:4096
  v_mfma_f32_16x16x32_bf16 v[144:147], a[180:183], a[132:135], v[144:147]
  v_mfma_f32_16x16x32_bf16 v[148:151], a[156:159], a[100:103], v[148:151]
  ds_read_b128 a[12:15], v16 offset:6144
  v_mfma_f32_16x16x32_bf16 v[148:151], a[180:183], a[136:139], v[148:151]
  ds_read_b128 a[48:51], v17 offset:6144
  v_mfma_f32_16x16x32_bf16 v[152:155], a[72:75], a[160:163], v[152:155]
  ds_read_b128 a[16:19], v16 offset:8192
  v_mfma_f32_16x16x32_bf16 v[152:155], a[108:111], a[184:187], v[152:155]
  v_mfma_f32_16x16x32_bf16 v[156:159], a[76:79], a[160:163], v[156:159]
  ds_read_b128 a[52:55], v17 offset:8192
  v_mfma_f32_16x16x32_bf16 v[156:159], a[112:115], a[184:187], v[156:159]
  ds_read_b128 a[20:23], v16 offset:10240
  v_mfma_f32_16x16x32_bf16 v[160:163], a[80:83], a[160:163], v[160:163]
  v_mfma_f32_16x16x32_bf16 v[160:163], a[116:119], a[184:187], v[160:163]
  ds_read_b128 a[56:59], v17 offset:10240
  v_mfma_f32_16x16x32_bf16 v[164:167], a[84:87], a[160:163], v[164:167]
  ds_read_b128 a[24:27], v16 offset:12288
  v_mfma_f32_16x16x32_bf16 v[164:167], a[120:123], a[184:187], v[164:167]
  ds_read_b128 a[60:63], v17 offset:12288
  v_mfma_f32_16x16x32_bf16 v[168:171], a[88:91], a[160:163], v[168:171]
  v_mfma_f32_16x16x32_bf16 v[168:171], a[124:127], a[184:187], v[168:171]
  ds_read_b128 a[28:31], v16 offset:14336
  v_mfma_f32_16x16x32_bf16 v[172:175], a[92:95], a[160:163], v[172:175]
  ds_read_b128 a[64:67], v17 offset:14336
  v_mfma_f32_16x16x32_bf16 v[172:175], a[128:131], a[184:187], v[172:175]
  v_mfma_f32_16x16x32_bf16 v[176:179], a[96:99], a[160:163], v[176:179]
  ds_read_b64_tr_b16 a[148:149], v21 offset:0
  v_mfma_f32_16x16x32_bf16 v[176:179], a[132:135], a[184:187], v[176:179]
  ds_read_b64_tr_b16 a[150:151], v21 offset:2048
  v_mfma_f32_16x16x32_bf16 v[180:183], a[100:103], a[160:163], v[180:183]
  ds_read_b64_tr_b16 a[172:173], v21 offset:4096
  v_mfma_f32_16x16x32_bf16 v[180:183], a[136:139], a[184:187], v[180:183]
  v_mfma_f32_16x16x32_bf16 v[216:219], a[104:107], a[160:163], v[216:219]
  ds_read_b64_tr_b16 a[174:175], v21 offset:6144
  v_mfma_f32_16x16x32_bf16 v[216:219], a[140:143], a[184:187], v[216:219]
  ds_read_b64_tr_b16 a[152:153], v20 offset:8192
  v_mfma_f32_16x16x32_bf16 v[184:187], a[72:75], a[164:167], v[184:187]
  v_mfma_f32_16x16x32_bf16 v[184:187], a[108:111], a[188:191], v[184:187]
  ds_read_b64_tr_b16 a[154:155], v20 offset:10240
  v_mfma_f32_16x16x32_bf16 v[188:191], a[76:79], a[164:167], v[188:191]
  ds_read_b64_tr_b16 a[176:177], v20 offset:12288
  v_mfma_f32_16x16x32_bf16 v[188:191], a[112:115], a[188:191], v[188:191]
  ds_read_b64_tr_b16 a[178:179], v20 offset:14336
  v_mfma_f32_16x16x32_bf16 v[192:195], a[80:83], a[164:167], v[192:195]
  v_mfma_f32_16x16x32_bf16 v[192:195], a[116:119], a[188:191], v[192:195]
  ds_read_b128 a[32:35], v18 offset:0
  v_mfma_f32_16x16x32_bf16 v[196:199], a[84:87], a[164:167], v[196:199]
  ds_read_b128 a[68:71], v19 offset:0
  v_mfma_f32_16x16x32_bf16 v[196:199], a[120:123], a[188:191], v[196:199]
  v_mfma_f32_16x16x32_bf16 v[200:203], a[88:91], a[164:167], v[200:203]
  v_mfma_f32_16x16x32_bf16 v[200:203], a[124:127], a[188:191], v[200:203]
  v_mfma_f32_16x16x32_bf16 v[204:207], a[92:95], a[164:167], v[204:207]
  v_mfma_f32_16x16x32_bf16 v[204:207], a[128:131], a[188:191], v[204:207]
  v_mfma_f32_16x16x32_bf16 v[208:211], a[96:99], a[164:167], v[208:211]
  v_mfma_f32_16x16x32_bf16 v[208:211], a[132:135], a[188:191], v[208:211]
  v_mfma_f32_16x16x32_bf16 v[212:215], a[100:103], a[164:167], v[212:215]
  v_mfma_f32_16x16x32_bf16 v[212:215], a[136:139], a[188:191], v[212:215]
  v_mfma_f32_16x16x32_bf16 v[220:223], a[104:107], a[164:167], v[220:223]
  v_mfma_f32_16x16x32_bf16 v[220:223], a[140:143], a[188:191], v[220:223]
  s_waitcnt lgkmcnt(0)
  v_mfma_f32_16x16x32_bf16 v[24:27], a[144:147], a[0:3], v[24:27]
  ds_read_b64_tr_b16 a[156:157], v21 offset:8192
  ds_read_b64_tr_b16 a[158:159], v21 offset:10240
  v_mfma_f32_16x16x32_bf16 v[24:27], a[168:171], a[36:39], v[24:27]
  ds_read_b64_tr_b16 a[180:181], v21 offset:12288
  ds_read_b64_tr_b16 a[182:183], v21 offset:14336
  v_mfma_f32_16x16x32_bf16 v[28:31], a[144:147], a[4:7], v[28:31]
  ds_read_b64_tr_b16 a[160:161], v20 offset:16384
  ds_read_b64_tr_b16 a[162:163], v20 offset:18432
  v_mfma_f32_16x16x32_bf16 v[28:31], a[168:171], a[40:43], v[28:31]
  ds_read_b64_tr_b16 a[184:185], v20 offset:20480
  v_mfma_f32_16x16x32_bf16 v[32:35], a[144:147], a[8:11], v[32:35]
  ds_read_b64_tr_b16 a[186:187], v20 offset:22528
  ds_read_b64_tr_b16 a[164:165], v21 offset:16384
  v_mfma_f32_16x16x32_bf16 v[32:35], a[168:171], a[44:47], v[32:35]
  ds_read_b64_tr_b16 a[166:167], v21 offset:18432
  ds_read_b64_tr_b16 a[188:189], v21 offset:20480
  v_mfma_f32_16x16x32_bf16 v[36:39], a[144:147], a[12:15], v[36:39]
  ds_read_b64_tr_b16 a[190:191], v21 offset:22528
  v_mfma_f32_16x16x32_bf16 v[36:39], a[168:171], a[48:51], v[36:39]
  v_mfma_f32_16x16x32_bf16 v[40:43], a[144:147], a[16:19], v[40:43]
  v_mfma_f32_16x16x32_bf16 v[40:43], a[168:171], a[52:55], v[40:43]
  v_mfma_f32_16x16x32_bf16 v[44:47], a[144:147], a[20:23], v[44:47]
  v_mfma_f32_16x16x32_bf16 v[44:47], a[168:171], a[56:59], v[44:47]
  v_mfma_f32_16x16x32_bf16 v[48:51], a[144:147], a[24:27], v[48:51]
  v_mfma_f32_16x16x32_bf16 v[48:51], a[168:171], a[60:63], v[48:51]
  v_mfma_f32_16x16x32_bf16 v[52:55], a[144:147], a[28:31], v[52:55]
  v_mfma_f32_16x16x32_bf16 v[52:55], a[168:171], a[64:67], v[52:55]
  v_mfma_f32_16x16x32_bf16 v[56:59], a[148:151], a[0:3], v[56:59]
  v_mfma_f32_16x16x32_bf16 v[56:59], a[172:175], a[36:39], v[56:59]
  v_mfma_f32_16x16x32_bf16 v[60:63], a[148:151], a[4:7], v[60:63]
  v_mfma_f32_16x16x32_bf16 v[60:63], a[172:175], a[40:43], v[60:63]
  v_mfma_f32_16x16x32_bf16 v[64:67], a[148:151], a[8:11], v[64:67]
  v_mfma_f32_16x16x32_bf16 v[64:67], a[172:175], a[44:47], v[64:67]
  v_mfma_f32_16x16x32_bf16 v[68:71], a[148:151], a[12:15], v[68:71]
  v_pk_mul_f32 v[24:25], v[24:25], s[6:7]
  v_pk_mul_f32 v[26:27], v[26:27], s[6:7]
  v_mfma_f32_16x16x32_bf16 v[68:71], a[172:175], a[48:51], v[68:71]
  v_pk_mul_f32 v[56:57], v[56:57], s[6:7]
  v_pk_mul_f32 v[58:59], v[58:59], s[6:7]
  v_mfma_f32_16x16x32_bf16 v[72:75], a[148:151], a[16:19], v[72:75]
  v_cvt_pk_bf16_f32 v24, v24, v25
  v_cvt_pk_bf16_f32 v25, v26, v27
  v_mfma_f32_16x16x32_bf16 v[72:75], a[172:175], a[52:55], v[72:75]
  v_cvt_pk_bf16_f32 v26, v56, v57
  v_cvt_pk_bf16_f32 v27, v58, v59
  v_mfma_f32_16x16x32_bf16 v[76:79], a[148:151], a[20:23], v[76:79]
  v_pk_mul_f32 v[28:29], v[28:29], s[6:7]
  v_pk_mul_f32 v[30:31], v[30:31], s[6:7]
  v_mfma_f32_16x16x32_bf16 v[76:79], a[172:175], a[56:59], v[76:79]
  v_pk_mul_f32 v[60:61], v[60:61], s[6:7]
  v_pk_mul_f32 v[62:63], v[62:63], s[6:7]
  v_mfma_f32_16x16x32_bf16 v[80:83], a[148:151], a[24:27], v[80:83]
  v_cvt_pk_bf16_f32 v28, v28, v29
  v_cvt_pk_bf16_f32 v29, v30, v31
  v_mfma_f32_16x16x32_bf16 v[80:83], a[172:175], a[60:63], v[80:83]
  v_cvt_pk_bf16_f32 v30, v60, v61
  v_cvt_pk_bf16_f32 v31, v62, v63
  v_mfma_f32_16x16x32_bf16 v[84:87], a[148:151], a[28:31], v[84:87]
  v_pk_mul_f32 v[32:33], v[32:33], s[6:7]
  v_pk_mul_f32 v[34:35], v[34:35], s[6:7]
  v_mfma_f32_16x16x32_bf16 v[84:87], a[172:175], a[64:67], v[84:87]
  v_pk_mul_f32 v[64:65], v[64:65], s[6:7]
  v_pk_mul_f32 v[66:67], v[66:67], s[6:7]
  v_mfma_f32_16x16x32_bf16 v[88:91], a[152:155], a[0:3], v[88:91]
  v_cvt_pk_bf16_f32 v32, v32, v33
  v_cvt_pk_bf16_f32 v33, v34, v35
  v_mfma_f32_16x16x32_bf16 v[88:91], a[176:179], a[36:39], v[88:91]
  v_cvt_pk_bf16_f32 v34, v64, v65
  v_cvt_pk_bf16_f32 v35, v66, v67
  v_mfma_f32_16x16x32_bf16 v[92:95], a[152:155], a[4:7], v[92:95]
  v_pk_mul_f32 v[36:37], v[36:37], s[6:7]
  v_pk_mul_f32 v[38:39], v[38:39], s[6:7]
  v_mfma_f32_16x16x32_bf16 v[92:95], a[176:179], a[40:43], v[92:95]
  v_pk_mul_f32 v[68:69], v[68:69], s[6:7]
  v_pk_mul_f32 v[70:71], v[70:71], s[6:7]
  v_mfma_f32_16x16x32_bf16 v[96:99], a[152:155], a[8:11], v[96:99]
  v_cvt_pk_bf16_f32 v36, v36, v37
  v_cvt_pk_bf16_f32 v37, v38, v39
  v_mfma_f32_16x16x32_bf16 v[96:99], a[176:179], a[44:47], v[96:99]
  v_cvt_pk_bf16_f32 v38, v68, v69
  v_cvt_pk_bf16_f32 v39, v70, v71
  v_mfma_f32_16x16x32_bf16 v[100:103], a[152:155], a[12:15], v[100:103]
  v_pk_mul_f32 v[40:41], v[40:41], s[6:7]
  v_pk_mul_f32 v[42:43], v[42:43], s[6:7]
  v_mfma_f32_16x16x32_bf16 v[100:103], a[176:179], a[48:51], v[100:103]
  v_pk_mul_f32 v[72:73], v[72:73], s[6:7]
  v_pk_mul_f32 v[74:75], v[74:75], s[6:7]
  v_mfma_f32_16x16x32_bf16 v[104:107], a[152:155], a[16:19], v[104:107]
  v_cvt_pk_bf16_f32 v40, v40, v41
  v_cvt_pk_bf16_f32 v41, v42, v43
  v_mfma_f32_16x16x32_bf16 v[104:107], a[176:179], a[52:55], v[104:107]
  v_cvt_pk_bf16_f32 v42, v72, v73
  v_cvt_pk_bf16_f32 v43, v74, v75
  v_mfma_f32_16x16x32_bf16 v[108:111], a[152:155], a[20:23], v[108:111]
  v_pk_mul_f32 v[44:45], v[44:45], s[6:7]
  v_pk_mul_f32 v[46:47], v[46:47], s[6:7]
  v_mfma_f32_16x16x32_bf16 v[108:111], a[176:179], a[56:59], v[108:111]
  v_pk_mul_f32 v[76:77], v[76:77], s[6:7]
  v_pk_mul_f32 v[78:79], v[78:79], s[6:7]
  v_mfma_f32_16x16x32_bf16 v[112:115], a[152:155], a[24:27], v[112:115]
  v_cvt_pk_bf16_f32 v44, v44, v45
  v_cvt_pk_bf16_f32 v45, v46, v47
  v_mfma_f32_16x16x32_bf16 v[112:115], a[176:179], a[60:63], v[112:115]
  v_cvt_pk_bf16_f32 v46, v76, v77
  v_cvt_pk_bf16_f32 v47, v78, v79
  v_mfma_f32_16x16x32_bf16 v[116:119], a[152:155], a[28:31], v[116:119]
  v_pk_mul_f32 v[48:49], v[48:49], s[6:7]
  v_pk_mul_f32 v[50:51], v[50:51], s[6:7]
  v_mfma_f32_16x16x32_bf16 v[116:119], a[176:179], a[64:67], v[116:119]
  v_pk_mul_f32 v[80:81], v[80:81], s[6:7]
  v_pk_mul_f32 v[82:83], v[82:83], s[6:7]
  s_waitcnt lgkmcnt(0)
  s_barrier
  s_mov_b32 s12, s84
  s_mov_b32 s13, s85
  s_mov_b32 s14, 256
  s_mov_b32 s15, 0x00020000
  buffer_load_dwordx2 v[22:23], off, s[12:15], 0 sc1
  v_mfma_f32_16x16x32_bf16 v[120:123], a[156:159], a[0:3], v[120:123]
  s_mov_b32 m0, s68
  v_cvt_pk_bf16_f32 v48, v48, v49
  v_cvt_pk_bf16_f32 v49, v50, v51
  v_mfma_f32_16x16x32_bf16 v[120:123], a[180:183], a[36:39], v[120:123]
  buffer_load_dwordx4 v8, s[20:23], s28 offen offset:0 lds
  v_cvt_pk_bf16_f32 v50, v80, v81
  v_mfma_f32_16x16x32_bf16 v[124:127], a[156:159], a[4:7], v[124:127]
  v_cvt_pk_bf16_f32 v51, v82, v83
  v_pk_mul_f32 v[52:53], v[52:53], s[6:7]
  v_mfma_f32_16x16x32_bf16 v[124:127], a[180:183], a[40:43], v[124:127]
  buffer_load_dwordx4 v9, s[20:23], s28 offen offset:1024 lds
  v_pk_mul_f32 v[54:55], v[54:55], s[6:7]
  v_mfma_f32_16x16x32_bf16 v[128:131], a[156:159], a[8:11], v[128:131]
  v_pk_mul_f32 v[84:85], v[84:85], s[6:7]
  v_pk_mul_f32 v[86:87], v[86:87], s[6:7]
  v_mfma_f32_16x16x32_bf16 v[128:131], a[180:183], a[44:47], v[128:131]
  v_cvt_pk_bf16_f32 v52, v52, v53
  v_cvt_pk_bf16_f32 v53, v54, v55
  v_mfma_f32_16x16x32_bf16 v[132:135], a[156:159], a[12:15], v[132:135]
  buffer_load_dwordx4 v10, s[20:23], s28 offen offset:2048 lds
  v_cvt_pk_bf16_f32 v54, v84, v85
  v_mfma_f32_16x16x32_bf16 v[132:135], a[180:183], a[48:51], v[132:135]
  v_cvt_pk_bf16_f32 v55, v86, v87
  v_cvt_pk_bf16_f32 v88, v88, v89
  v_mfma_f32_16x16x32_bf16 v[136:139], a[156:159], a[16:19], v[136:139]
  v_cvt_pk_bf16_f32 v89, v90, v91
  v_cvt_pk_bf16_f32 v90, v120, v121
  v_mfma_f32_16x16x32_bf16 v[136:139], a[180:183], a[52:55], v[136:139]
  buffer_load_dwordx4 v11, s[20:23], s28 offen offset:3072 lds
  v_cvt_pk_bf16_f32 v91, v122, v123
  v_mfma_f32_16x16x32_bf16 v[140:143], a[156:159], a[20:23], v[140:143]
  s_bfe_u32 s56, 0x302010e, s55
  s_add_u32 s54, s54, s56
  s_add_u32 s55, s55, 8
  v_mfma_f32_16x16x32_bf16 v[140:143], a[180:183], a[56:59], v[140:143]
  s_and_b32 s55, s55, 0x8001f
  s_and_b32 s54, s54, 15
  s_lshl_b32 s28, s54, 19
  v_mfma_f32_16x16x32_bf16 v[144:147], a[156:159], a[24:27], v[144:147]
  s_add_u32 m0, s68, 16384
  v_cvt_pk_bf16_f32 v92, v92, v93
  v_cvt_pk_bf16_f32 v93, v94, v95
  v_mfma_f32_16x16x32_bf16 v[144:147], a[180:183], a[60:63], v[144:147]
  buffer_load_dwordx4 v8, s[20:23], s28 offen offset:0 lds
  v_cvt_pk_bf16_f32 v94, v124, v125
  v_mfma_f32_16x16x32_bf16 v[148:151], a[156:159], a[28:31], v[148:151]
  v_cvt_pk_bf16_f32 v95, v126, v127
  v_cvt_pk_bf16_f32 v96, v96, v97
  v_mfma_f32_16x16x32_bf16 v[148:151], a[180:183], a[64:67], v[148:151]
  buffer_load_dwordx4 v9, s[20:23], s28 offen offset:1024 lds
  v_cvt_pk_bf16_f32 v97, v98, v99
  v_mfma_f32_16x16x32_bf16 v[152:155], a[0:3], a[160:163], v[152:155]
  v_cvt_pk_bf16_f32 v98, v128, v129
  v_cvt_pk_bf16_f32 v99, v130, v131
  v_mfma_f32_16x16x32_bf16 v[152:155], a[36:39], a[184:187], v[152:155]
  v_cvt_pk_bf16_f32 v100, v100, v101
  v_cvt_pk_bf16_f32 v101, v102, v103
  v_mfma_f32_16x16x32_bf16 v[156:159], a[4:7], a[160:163], v[156:159]
  v_cvt_pk_bf16_f32 v102, v132, v133
  v_cvt_pk_bf16_f32 v103, v134, v135
  v_mfma_f32_16x16x32_bf16 v[156:159], a[40:43], a[184:187], v[156:159]
  buffer_load_dwordx4 v10, s[20:23], s28 offen offset:2048 lds
  v_cvt_pk_bf16_f32 v104, v104, v105
  v_mfma_f32_16x16x32_bf16 v[160:163], a[8:11], a[160:163], v[160:163]
  v_cvt_pk_bf16_f32 v105, v106, v107
  v_cvt_pk_bf16_f32 v106, v136, v137
  v_mfma_f32_16x16x32_bf16 v[160:163], a[44:47], a[184:187], v[160:163]
  v_cvt_pk_bf16_f32 v107, v138, v139
  v_cvt_pk_bf16_f32 v108, v108, v109
  v_mfma_f32_16x16x32_bf16 v[164:167], a[12:15], a[160:163], v[164:167]
  buffer_load_dwordx4 v11, s[20:23], s28 offen offset:3072 lds
  v_cvt_pk_bf16_f32 v109, v110, v111
  v_mfma_f32_16x16x32_bf16 v[164:167], a[48:51], a[184:187], v[164:167]
  s_bfe_u32 s56, 0x302010e, s55
  s_add_u32 s54, s54, s56
  s_add_u32 s55, s55, 8
  v_mfma_f32_16x16x32_bf16 v[168:171], a[16:19], a[160:163], v[168:171]
  s_and_b32 s55, s55, 0x8001f
  s_and_b32 s54, s54, 15
  s_lshl_b32 s28, s54, 19
  v_mfma_f32_16x16x32_bf16 v[168:171], a[52:55], a[184:187], v[168:171]
  s_mov_b32 m0, s88
  v_cvt_pk_bf16_f32 v110, v140, v141
  v_cvt_pk_bf16_f32 v111, v142, v143
  v_mfma_f32_16x16x32_bf16 v[172:175], a[20:23], a[160:163], v[172:175]
  buffer_load_dwordx4 v4, s[8:11], s26 offen offset:0 lds
  v_cvt_pk_bf16_f32 v112, v112, v113
  v_mfma_f32_16x16x32_bf16 v[172:175], a[56:59], a[184:187], v[172:175]
  v_cvt_pk_bf16_f32 v113, v114, v115
  v_cvt_pk_bf16_f32 v114, v144, v145
  v_mfma_f32_16x16x32_bf16 v[176:179], a[24:27], a[160:163], v[176:179]
  buffer_load_dwordx4 v5, s[8:11], s26 offen offset:1024 lds
  v_cvt_pk_bf16_f32 v115, v146, v147
  v_mfma_f32_16x16x32_bf16 v[176:179], a[60:63], a[184:187], v[176:179]
  v_cvt_pk_bf16_f32 v116, v116, v117
  v_cvt_pk_bf16_f32 v117, v118, v119
  v_mfma_f32_16x16x32_bf16 v[180:183], a[28:31], a[160:163], v[180:183]
  v_cvt_pk_bf16_f32 v118, v148, v149
  v_cvt_pk_bf16_f32 v119, v150, v151
  v_mfma_f32_16x16x32_bf16 v[180:183], a[64:67], a[184:187], v[180:183]
  buffer_load_dwordx4 v6, s[8:11], s26 offen offset:2048 lds
  v_mfma_f32_16x16x32_bf16 v[216:219], a[32:35], a[160:163], v[216:219]
  v_mfma_f32_16x16x32_bf16 v[216:219], a[68:71], a[184:187], v[216:219]
  v_mfma_f32_16x16x32_bf16 v[184:187], a[0:3], a[164:167], v[184:187]
  v_mfma_f32_16x16x32_bf16 v[184:187], a[36:39], a[188:191], v[184:187]
  buffer_load_dwordx4 v7, s[8:11], s26 offen offset:3072 lds
  v_mfma_f32_16x16x32_bf16 v[188:191], a[4:7], a[164:167], v[188:191]
  s_add_u32 m0, s88, 4096
  v_mfma_f32_16x16x32_bf16 v[188:191], a[40:43], a[188:191], v[188:191]
  v_mfma_f32_16x16x32_bf16 v[192:195], a[8:11], a[164:167], v[192:195]
  buffer_load_dwordx4 v4, s[8:11], s27 offen offset:0 lds
  v_mfma_f32_16x16x32_bf16 v[192:195], a[44:47], a[188:191], v[192:195]
  v_mfma_f32_16x16x32_bf16 v[196:199], a[12:15], a[164:167], v[196:199]
  v_mfma_f32_16x16x32_bf16 v[196:199], a[48:51], a[188:191], v[196:199]
  buffer_load_dwordx4 v5, s[8:11], s27 offen offset:1024 lds
  v_mfma_f32_16x16x32_bf16 v[200:203], a[16:19], a[164:167], v[200:203]
  v_mfma_f32_16x16x32_bf16 v[200:203], a[52:55], a[188:191], v[200:203]
  v_mfma_f32_16x16x32_bf16 v[204:207], a[20:23], a[164:167], v[204:207]
  buffer_load_dwordx4 v6, s[8:11], s27 offen offset:2048 lds
  v_mfma_f32_16x16x32_bf16 v[204:207], a[56:59], a[188:191], v[204:207]
  v_mfma_f32_16x16x32_bf16 v[208:211], a[24:27], a[164:167], v[208:211]
  v_mfma_f32_16x16x32_bf16 v[208:211], a[60:63], a[188:191], v[208:211]
  buffer_load_dwordx4 v7, s[8:11], s27 offen offset:3072 lds
  v_mfma_f32_16x16x32_bf16 v[212:215], a[28:31], a[164:167], v[212:215]
  s_bfe_u32 s29, 0x302010e, s53
  s_add_u32 s52, s52, s29
  s_add_u32 s53, s53, 8
  v_mfma_f32_16x16x32_bf16 v[212:215], a[64:67], a[188:191], v[212:215]
  s_and_b32 s53, s53, 0x8001f
  s_and_b32 s52, s52, 15
  s_lshl_b32 s29, s52, 7
  v_mfma_f32_16x16x32_bf16 v[220:223], a[32:35], a[164:167], v[220:223]
  s_or_b32 s26, s30, s29
  s_or_b32 s27, s31, s29
  v_mfma_f32_16x16x32_bf16 v[220:223], a[68:71], a[188:191], v[220:223]
  v_cvt_pk_bf16_f32 v216, v216, v217
  v_cvt_pk_bf16_f32 v217, v218, v219
  s_nop 5
  v_cvt_pk_bf16_f32 v218, v220, v221
  v_cvt_pk_bf16_f32 v219, v222, v223
  ds_write_b128 v252, v[216:219] offset:1024
  v_cvt_pk_bf16_f32 v72, v180, v181
  v_cvt_pk_bf16_f32 v73, v182, v183
  v_cvt_pk_bf16_f32 v136, v212, v213
  v_cvt_pk_bf16_f32 v137, v214, v215
  v_cvt_pk_bf16_f32 v70, v176, v177
  v_cvt_pk_bf16_f32 v71, v178, v179
  v_cvt_pk_bf16_f32 v134, v208, v209
  v_cvt_pk_bf16_f32 v135, v210, v211
  v_cvt_pk_bf16_f32 v68, v172, v173
  v_cvt_pk_bf16_f32 v69, v174, v175
  v_cvt_pk_bf16_f32 v132, v204, v205
  v_cvt_pk_bf16_f32 v133, v206, v207
  v_cvt_pk_bf16_f32 v66, v168, v169
  v_cvt_pk_bf16_f32 v67, v170, v171
  v_cvt_pk_bf16_f32 v130, v200, v201
  v_cvt_pk_bf16_f32 v131, v202, v203
  v_cvt_pk_bf16_f32 v64, v164, v165
  v_cvt_pk_bf16_f32 v65, v166, v167
  v_cvt_pk_bf16_f32 v128, v196, v197
  v_cvt_pk_bf16_f32 v129, v198, v199
  v_cvt_pk_bf16_f32 v62, v160, v161
  v_cvt_pk_bf16_f32 v63, v162, v163
  v_cvt_pk_bf16_f32 v126, v192, v193
  v_cvt_pk_bf16_f32 v127, v194, v195
  v_cvt_pk_bf16_f32 v60, v156, v157
  v_cvt_pk_bf16_f32 v61, v158, v159
  v_cvt_pk_bf16_f32 v124, v188, v189
  v_cvt_pk_bf16_f32 v125, v190, v191
  v_cvt_pk_bf16_f32 v58, v152, v153
  v_cvt_pk_bf16_f32 v59, v154, v155
  v_cvt_pk_bf16_f32 v122, v184, v185
  v_cvt_pk_bf16_f32 v123, v186, v187
  s_waitcnt lgkmcnt(0)
  s_barrier
Lp2_at:
  ds_read_b128 v[76:79], v253
  ds_read_b64 v[56:57], v253 offset:1024
  ds_read_b64 v[120:121], v253 offset:1032
  v_mfma_f32_16x16x32_bf16 v[208:211], v[112:115], v[52:55], v[240:243]
  s_add_u32 m0, s88, 32768
  s_nop 0
  buffer_load_dwordx4 v4, s[8:11], s26 offen offset:0 lds
  v_mfma_f32_16x16x32_bf16 v[212:215], v[116:119], v[52:55], v[244:247]
  v_mfma_f32_16x16x32_bf16 v[200:203], v[108:111], v[48:51], v[240:243]
  v_mfma_f32_16x16x32_bf16 v[204:207], v[112:115], v[48:51], v[244:247]
  v_mfma_f32_16x16x32_bf16 v[192:195], v[104:107], v[44:47], v[240:243]
  v_mfma_f32_16x16x32_bf16 v[196:199], v[108:111], v[44:47], v[244:247]
  v_mfma_f32_16x16x32_bf16 v[184:187], v[100:103], v[40:43], v[240:243]
  v_mfma_f32_16x16x32_bf16 v[188:191], v[104:107], v[40:43], v[244:247]
  v_mfma_f32_16x16x32_bf16 v[176:179], v[96:99], v[36:39], v[240:243]
  v_mfma_f32_16x16x32_bf16 v[180:183], v[100:103], v[36:39], v[244:247]
  v_mfma_f32_16x16x32_bf16 v[168:171], v[92:95], v[32:35], v[240:243]
  v_mfma_f32_16x16x32_bf16 v[172:175], v[96:99], v[32:35], v[244:247]
  v_mfma_f32_16x16x32_bf16 v[160:163], v[88:91], v[28:31], v[240:243]
  buffer_load_dwordx4 v5, s[8:11], s26 offen offset:1024 lds
  v_mfma_f32_16x16x32_bf16 v[164:167], v[92:95], v[28:31], v[244:247]
  s_waitcnt lgkmcnt(0)
  v_mfma_f32_16x16x32_bf16 v[152:155], v[76:79], v[24:27], v[248:251]
  v_mfma_f32_16x16x32_bf16 v[156:159], v[88:91], v[24:27], v[244:247]
  v_max3_f32 v238, v208, v209, v210
  v_max3_f32 v239, v211, v212, v213
  v_max3_f32 v238, v238, v214, v215
  v_max_f32 v238, v238, v239
  v_max3_f32 v236, v200, v201, v202
  v_max3_f32 v237, v203, v204, v205
  v_max3_f32 v236, v236, v206, v207
  v_max_f32 v236, v236, v237
  v_max3_f32 v234, v192, v193, v194
  v_max3_f32 v235, v195, v196, v197
  buffer_load_dwordx4 v6, s[8:11], s26 offen offset:2048 lds
  v_max3_f32 v234, v234, v198, v199
  v_max_f32 v234, v234, v235
  v_max3_f32 v232, v184, v185, v186
  v_max3_f32 v233, v187, v188, v189
  v_max3_f32 v232, v232, v190, v191
  v_max_f32 v232, v232, v233
  v_max3_f32 v230, v176, v177, v178
  v_max3_f32 v231, v179, v180, v181
  v_max3_f32 v230, v230, v182, v183
  v_max_f32 v230, v230, v231
  v_max3_f32 v228, v168, v169, v170
  v_max3_f32 v229, v171, v172, v173
  buffer_load_dwordx4 v7, s[8:11], s26 offen offset:3072 lds
  v_max3_f32 v228, v228, v174, v175
  v_max_f32 v228, v228, v229
  v_max3_f32 v226, v160, v161, v162
  v_max3_f32 v227, v163, v164, v165
  v_max3_f32 v226, v226, v166, v167
  v_max_f32 v226, v226, v227
  v_max3_f32 v224, v152, v153, v154
  v_max3_f32 v225, v155, v156, v157
  v_max3_f32 v224, v224, v158, v159
  v_max_f32 v224, v224, v225
  v_mov_b32 v239, v238
  v_mov_b32 v237, v236
  v_mov_b32 v235, v234
  s_add_u32 m0, s88, 36864
  s_nop 0
  buffer_load_dwordx4 v4, s[8:11], s27 offen offset:0 lds
  v_mov_b32 v233, v232
  v_mov_b32 v231, v230
  v_mov_b32 v229, v228
  v_mov_b32 v227, v226
  v_mov_b32 v225, v224
  v_permlane32_swap_b32 v238, v239
  v_permlane32_swap_b32 v236, v237
  v_permlane32_swap_b32 v234, v235
  v_permlane32_swap_b32 v232, v233
  v_permlane32_swap_b32 v230, v231
  v_permlane32_swap_b32 v228, v229
  v_permlane32_swap_b32 v226, v227
  buffer_load_dwordx4 v5, s[8:11], s27 offen offset:1024 lds
  v_permlane32_swap_b32 v224, v225
  v_max_f32 v238, v238, v239
  v_max_f32 v236, v236, v237
  v_max_f32 v234, v234, v235
  v_max_f32 v232, v232, v233
  v_max_f32 v230, v230, v231
  v_max_f32 v228, v228, v229
  v_max_f32 v226, v226, v227
  v_max_f32 v224, v224, v225
  v_mov_b32 v239, v238
  v_mov_b32 v237, v236
  v_mov_b32 v235, v234
  buffer_load_dwordx4 v6, s[8:11], s27 offen offset:2048 lds
  v_mov_b32 v233, v232
  v_mov_b32 v231, v230
  v_mov_b32 v229, v228
  v_mov_b32 v227, v226
  v_mov_b32 v225, v224
  v_permlane16_swap_b32 v238, v239
  v_permlane16_swap_b32 v236, v237
  v_permlane16_swap_b32 v234, v235
  v_permlane16_swap_b32 v232, v233
  v_permlane16_swap_b32 v230, v231
  v_permlane16_swap_b32 v228, v229
  v_permlane16_swap_b32 v226, v227
  buffer_load_dwordx4 v7, s[8:11], s27 offen offset:3072 lds
  v_permlane16_swap_b32 v224, v225
  v_max_f32 v238, v238, v239
  v_max_f32 v236, v236, v237
  v_max_f32 v234, v234, v235
  v_max_f32 v232, v232, v233
  v_max_f32 v230, v230, v231
  v_max_f32 v228, v228, v229
  v_max_f32 v226, v226, v227
  v_max_f32 v224, v224, v225
  v_sub_f32 v208, v208, v238
  v_sub_f32 v209, v209, v238
  v_sub_f32 v210, v210, v238
  v_sub_f32 v211, v211, v238
  s_bfe_u32 s29, 0x302010e, s53
  s_add_u32 s52, s52, s29
  s_add_u32 s53, s53, 8
  s_and_b32 s53, s53, 0x8001f
  s_and_b32 s52, s52, 15
  s_lshl_b32 s29, s52, 7
  s_or_b32 s26, s30, s29
  s_or_b32 s27, s31, s29
  s_add_u32 m0, s68, 32768
  s_nop 0
  buffer_load_dwordx4 v8, s[20:23], s28 offen offset:0 lds
  v_sub_f32 v212, v212, v238
  v_sub_f32 v213, v213, v238
  v_sub_f32 v214, v214, v238
  v_sub_f32 v215, v215, v238
  v_exp_f32 v208, v208
  v_exp_f32 v209, v209
  v_exp_f32 v210, v210
  v_exp_f32 v211, v211
  v_exp_f32 v212, v212
  v_exp_f32 v213, v213
  v_exp_f32 v214, v214
  v_exp_f32 v215, v215
  buffer_load_dwordx4 v9, s[20:23], s28 offen offset:1024 lds
  v_sub_f32 v200, v200, v236
  v_sub_f32 v201, v201, v236
  v_sub_f32 v202, v202, v236
  v_sub_f32 v203, v203, v236
  v_sub_f32 v204, v204, v236
  v_sub_f32 v205, v205, v236
  v_sub_f32 v206, v206, v236
  v_sub_f32 v207, v207, v236
  v_exp_f32 v200, v200
  v_exp_f32 v201, v201
  v_exp_f32 v202, v202
  v_exp_f32 v203, v203
  buffer_load_dwordx4 v10, s[20:23], s28 offen offset:2048 lds
  v_exp_f32 v204, v204
  v_exp_f32 v205, v205
  v_exp_f32 v206, v206
  v_exp_f32 v207, v207
  v_cvt_pk_bf16_f32 v116, v208, v209
  v_cvt_pk_bf16_f32 v117, v210, v211
  v_cvt_pk_bf16_f32 v118, v212, v213
  v_cvt_pk_bf16_f32 v119, v214, v215
  s_nop 1
  v_mfma_f32_16x16x32_bf16 v[52:55], a[208:211], v[116:119], 0
  v_mfma_f32_16x16x32_bf16 v[208:211], v[70:73], v[116:119], 0
  v_mfma_f32_16x16x32_bf16 v[212:215], v[134:137], v[116:119], 0
  v_sub_f32 v192, v192, v234
  buffer_load_dwordx4 v11, s[20:23], s28 offen offset:3072 lds
  v_sub_f32 v193, v193, v234
  v_sub_f32 v194, v194, v234
  v_sub_f32 v195, v195, v234
  v_sub_f32 v196, v196, v234
  v_sub_f32 v197, v197, v234
  v_sub_f32 v198, v198, v234
  v_sub_f32 v199, v199, v234
  v_exp_f32 v192, v192
  v_exp_f32 v193, v193
  v_exp_f32 v194, v194
  v_exp_f32 v195, v195
  v_exp_f32 v196, v196
  v_exp_f32 v197, v197
  s_bfe_u32 s56, 0x302010e, s55
  s_add_u32 s54, s54, s56
  s_add_u32 s55, s55, 8
  s_and_b32 s55, s55, 0x8001f
  s_and_b32 s54, s54, 15
  s_lshl_b32 s28, s54, 19
  s_add_u32 m0, s88, -32768
  s_nop 0
  buffer_load_dwordx4 v4, s[8:11], s26 offen offset:0 lds
  v_exp_f32 v198, v198
  v_exp_f32 v199, v199
  v_cvt_pk_bf16_f32 v112, v200, v201
  v_cvt_pk_bf16_f32 v113, v202, v203
  v_cvt_pk_bf16_f32 v114, v204, v205
  v_cvt_pk_bf16_f32 v115, v206, v207
  s_nop 1
  v_mfma_f32_16x16x32_bf16 v[48:51], a[208:211], v[112:115], 0
  v_mfma_f32_16x16x32_bf16 v[200:203], v[68:71], v[112:115], 0
  v_mfma_f32_16x16x32_bf16 v[204:207], v[132:135], v[112:115], 0
  v_sub_f32 v184, v184, v232
  v_sub_f32 v185, v185, v232
  v_sub_f32 v186, v186, v232
  buffer_load_dwordx4 v5, s[8:11], s26 offen offset:1024 lds
  v_sub_f32 v187, v187, v232
  v_sub_f32 v188, v188, v232
  v_sub_f32 v189, v189, v232
  v_sub_f32 v190, v190, v232
  v_sub_f32 v191, v191, v232
  v_exp_f32 v184, v184
  v_exp_f32 v185, v185
  v_exp_f32 v186, v186
  v_exp_f32 v187, v187
  v_exp_f32 v188, v188
  v_exp_f32 v189, v189
  v_exp_f32 v190, v190
  buffer_load_dwordx4 v6, s[8:11], s26 offen offset:2048 lds
  v_exp_f32 v191, v191
  v_cvt_pk_bf16_f32 v108, v192, v193
  v_cvt_pk_bf16_f32 v109, v194, v195
  v_cvt_pk_bf16_f32 v110, v196, v197
  v_cvt_pk_bf16_f32 v111, v198, v199
  s_nop 1
  v_mfma_f32_16x16x32_bf16 v[44:47], a[208:211], v[108:111], 0
  v_mfma_f32_16x16x32_bf16 v[192:195], v[66:69], v[108:111], 0
  v_mfma_f32_16x16x32_bf16 v[196:199], v[130:133], v[108:111], 0
  v_sub_f32 v176, v176, v230
  v_sub_f32 v177, v177, v230
  v_sub_f32 v178, v178, v230
  v_sub_f32 v179, v179, v230
  buffer_load_dwordx4 v7, s[8:11], s26 offen offset:3072 lds
  v_sub_f32 v180, v180, v230
  v_sub_f32 v181, v181, v230
  v_sub_f32 v182, v182, v230
  v_sub_f32 v183, v183, v230
  v_exp_f32 v176, v176
  v_exp_f32 v177, v177
  v_exp_f32 v178, v178
  v_exp_f32 v179, v179
  v_exp_f32 v180, v180
  v_exp_f32 v181, v181
  v_exp_f32 v182, v182
  v_exp_f32 v183, v183
  v_cvt_pk_bf16_f32 v104, v184, v185
  s_add_u32 m0, s88, -28672
  s_nop 0
  buffer_load_dwordx4 v4, s[8:11], s27 offen offset:0 lds
  v_cvt_pk_bf16_f32 v105, v186, v187
  v_cvt_pk_bf16_f32 v106, v188, v189
  v_cvt_pk_bf16_f32 v107, v190, v191
  s_nop 1
  v_mfma_f32_16x16x32_bf16 v[40:43], a[208:211], v[104:107], 0
  v_mfma_f32_16x16x32_bf16 v[184:187], v[64:67], v[104:107], 0
  v_mfma_f32_16x16x32_bf16 v[188:191], v[128:131], v[104:107], 0
  v_sub_f32 v168, v168, v228
  v_sub_f32 v169, v169, v228
  v_sub_f32 v170, v170, v228
  v_sub_f32 v171, v171, v228
  v_sub_f32 v172, v172, v228
  v_sub_f32 v173, v173, v228
  buffer_load_dwordx4 v5, s[8:11], s27 offen offset:1024 lds
  v_sub_f32 v174, v174, v228
  v_sub_f32 v175, v175, v228
  v_exp_f32 v168, v168
  v_exp_f32 v169, v169
  v_exp_f32 v170, v170
  v_exp_f32 v171, v171
  v_exp_f32 v172, v172
  v_exp_f32 v173, v173
  v_exp_f32 v174, v174
  v_exp_f32 v175, v175
  v_cvt_pk_bf16_f32 v100, v176, v177
  v_cvt_pk_bf16_f32 v101, v178, v179
  buffer_load_dwordx4 v6, s[8:11], s27 offen offset:2048 lds
  v_cvt_pk_bf16_f32 v102, v180, v181
  v_cvt_pk_bf16_f32 v103, v182, v183
  s_nop 1
  v_mfma_f32_16x16x32_bf16 v[36:39], a[208:211], v[100:103], 0
  v_mfma_f32_16x16x32_bf16 v[176:179], v[62:65], v[100:103], 0
  v_mfma_f32_16x16x32_bf16 v[180:183], v[126:129], v[100:103], 0
  v_sub_f32 v160, v160, v226
  v_sub_f32 v161, v161, v226
  v_sub_f32 v162, v162, v226
  v_sub_f32 v163, v163, v226
  v_sub_f32 v164, v164, v226
  v_sub_f32 v165, v165, v226
  v_sub_f32 v166, v166, v226
  buffer_load_dwordx4 v7, s[8:11], s27 offen offset:3072 lds
  s_bfe_u32 s29, 0x302010e, s53
  s_add_u32 s52, s52, s29
  s_add_u32 s53, s53, 8
  s_and_b32 s53, s53, 0x8001f
  s_and_b32 s52, s52, 15
  s_lshl_b32 s29, s52, 7
  s_or_b32 s26, s30, s29
  s_or_b32 s27, s31, s29
  v_sub_f32 v167, v167, v226
  v_exp_f32 v160, v160
  v_exp_f32 v161, v161
  v_exp_f32 v162, v162
  v_exp_f32 v163, v163
  v_exp_f32 v164, v164
  v_exp_f32 v165, v165
  v_exp_f32 v166, v166
  v_exp_f32 v167, v167
  v_cvt_pk_bf16_f32 v96, v168, v169
  v_cvt_pk_bf16_f32 v97, v170, v171
  v_cvt_pk_bf16_f32 v98, v172, v173
  v_cvt_pk_bf16_f32 v99, v174, v175
  s_nop 1
  v_mfma_f32_16x16x32_bf16 v[32:35], a[208:211], v[96:99], 0
  v_mfma_f32_16x16x32_bf16 v[168:171], v[60:63], v[96:99], 0
  v_mfma_f32_16x16x32_bf16 v[172:175], v[124:127], v[96:99], 0
  v_sub_f32 v152, v152, v224
  v_sub_f32 v153, v153, v224
  v_sub_f32 v154, v154, v224
  v_sub_f32 v155, v155, v224
  v_sub_f32 v156, v156, v224
  v_sub_f32 v157, v157, v224
  v_sub_f32 v158, v158, v224
  v_sub_f32 v159, v159, v224
  v_exp_f32 v152, v152
  v_exp_f32 v153, v153
  v_exp_f32 v154, v154
  v_exp_f32 v155, v155
  v_exp_f32 v156, v156
  v_exp_f32 v157, v157
  v_exp_f32 v158, v158
  v_exp_f32 v159, v159
  v_cvt_pk_bf16_f32 v92, v160, v161
  v_cvt_pk_bf16_f32 v93, v162, v163
  v_cvt_pk_bf16_f32 v94, v164, v165
  v_cvt_pk_bf16_f32 v95, v166, v167
  s_nop 1
  v_mfma_f32_16x16x32_bf16 v[28:31], a[208:211], v[92:95], 0
  v_mfma_f32_16x16x32_bf16 v[160:163], v[58:61], v[92:95], 0
  v_mfma_f32_16x16x32_bf16 v[164:167], v[122:125], v[92:95], 0
  v_cvt_pk_bf16_f32 v88, v152, v153
  v_cvt_pk_bf16_f32 v89, v154, v155
  v_cvt_pk_bf16_f32 v90, v156, v157
  v_cvt_pk_bf16_f32 v91, v158, v159
  s_nop 1
  v_mfma_f32_16x16x32_bf16 v[24:27], a[208:211], v[88:91], 0
  v_mfma_f32_16x16x32_bf16 v[152:155], v[56:59], v[88:91], 0
  v_mfma_f32_16x16x32_bf16 v[156:159], v[120:123], v[88:91], 0
  v_rcp_f32 v52, v52
  v_rcp_f32 v48, v48
  v_rcp_f32 v44, v44
  v_rcp_f32 v40, v40
  v_rcp_f32 v36, v36
  v_rcp_f32 v32, v32
  v_rcp_f32 v28, v28
  v_rcp_f32 v24, v24
  v_mov_b32 v53, v52
  v_mov_b32 v49, v48
  v_mov_b32 v45, v44
  v_mov_b32 v41, v40
  v_mov_b32 v37, v36
  v_mov_b32 v33, v32
  v_mov_b32 v29, v28
  v_mov_b32 v25, v24
  v_pk_mul_f32 v[208:209], v[208:209], v[52:53]
  v_pk_mul_f32 v[210:211], v[210:211], v[52:53]
  v_pk_mul_f32 v[212:213], v[212:213], v[52:53]
  v_pk_mul_f32 v[214:215], v[214:215], v[52:53]
  v_cvt_pk_bf16_f32 v208, v208, v209
  v_cvt_pk_bf16_f32 v209, v210, v211
  v_cvt_pk_bf16_f32 v210, v212, v213
  v_cvt_pk_bf16_f32 v211, v214, v215
  buffer_store_dwordx4 v[208:211], v2, s[16:19], s58 offen offset:3072 sc1
  v_pk_mul_f32 v[200:201], v[200:201], v[48:49]
  v_pk_mul_f32 v[202:203], v[202:203], v[48:49]
  v_pk_mul_f32 v[204:205], v[204:205], v[48:49]
  v_pk_mul_f32 v[206:207], v[206:207], v[48:49]
  v_cvt_pk_bf16_f32 v200, v200, v201
  v_cvt_pk_bf16_f32 v201, v202, v203
  v_cvt_pk_bf16_f32 v202, v204, v205
  v_cvt_pk_bf16_f32 v203, v206, v207
  buffer_store_dwordx4 v[200:203], v2, s[16:19], s58 offen offset:2048 sc1
  v_pk_mul_f32 v[192:193], v[192:193], v[44:45]
  v_pk_mul_f32 v[194:195], v[194:195], v[44:45]
  v_pk_mul_f32 v[196:197], v[196:197], v[44:45]
  v_pk_mul_f32 v[198:199], v[198:199], v[44:45]
  v_cvt_pk_bf16_f32 v192, v192, v193
  v_cvt_pk_bf16_f32 v193, v194, v195
  v_cvt_pk_bf16_f32 v194, v196, v197
  v_cvt_pk_bf16_f32 v195, v198, v199
  buffer_store_dwordx4 v[192:195], v2, s[16:19], s58 offen offset:1024 sc1
  v_pk_mul_f32 v[184:185], v[184:185], v[40:41]
  v_pk_mul_f32 v[186:187], v[186:187], v[40:41]
  v_pk_mul_f32 v[188:189], v[188:189], v[40:41]
  v_pk_mul_f32 v[190:191], v[190:191], v[40:41]
  v_cvt_pk_bf16_f32 v184, v184, v185
  v_cvt_pk_bf16_f32 v185, v186, v187
  v_cvt_pk_bf16_f32 v186, v188, v189
  v_cvt_pk_bf16_f32 v187, v190, v191
  buffer_store_dwordx4 v[184:187], v2, s[16:19], s58 offen offset:0 sc1
  v_pk_mul_f32 v[176:177], v[176:177], v[36:37]
  v_pk_mul_f32 v[178:179], v[178:179], v[36:37]
  v_pk_mul_f32 v[180:181], v[180:181], v[36:37]
  v_pk_mul_f32 v[182:183], v[182:183], v[36:37]
  v_cvt_pk_bf16_f32 v176, v176, v177
  v_cvt_pk_bf16_f32 v177, v178, v179
  v_cvt_pk_bf16_f32 v178, v180, v181
  v_cvt_pk_bf16_f32 v179, v182, v183
  buffer_store_dwordx4 v[176:179], v2, s[16:19], s57 offen offset:3072 sc1
  v_pk_mul_f32 v[168:169], v[168:169], v[32:33]
  v_pk_mul_f32 v[170:171], v[170:171], v[32:33]
  v_pk_mul_f32 v[172:173], v[172:173], v[32:33]
  v_pk_mul_f32 v[174:175], v[174:175], v[32:33]
  v_cvt_pk_bf16_f32 v168, v168, v169
  v_cvt_pk_bf16_f32 v169, v170, v171
  v_cvt_pk_bf16_f32 v170, v172, v173
  v_cvt_pk_bf16_f32 v171, v174, v175
  buffer_store_dwordx4 v[168:171], v2, s[16:19], s57 offen offset:2048 sc1
  v_pk_mul_f32 v[160:161], v[160:161], v[28:29]
  v_pk_mul_f32 v[162:163], v[162:163], v[28:29]
  v_pk_mul_f32 v[164:165], v[164:165], v[28:29]
  v_pk_mul_f32 v[166:167], v[166:167], v[28:29]
  v_cvt_pk_bf16_f32 v160, v160, v161
  v_cvt_pk_bf16_f32 v161, v162, v163
  v_cvt_pk_bf16_f32 v162, v164, v165
  v_cvt_pk_bf16_f32 v163, v166, v167
  buffer_store_dwordx4 v[160:163], v2, s[16:19], s57 offen offset:1024 sc1
  v_pk_mul_f32 v[152:153], v[152:153], v[24:25]
  v_pk_mul_f32 v[154:155], v[154:155], v[24:25]
  v_pk_mul_f32 v[156:157], v[156:157], v[24:25]
  v_pk_mul_f32 v[158:159], v[158:159], v[24:25]
  v_cvt_pk_bf16_f32 v152, v152, v153
  v_cvt_pk_bf16_f32 v153, v154, v155
  v_cvt_pk_bf16_f32 v154, v156, v157
  v_cvt_pk_bf16_f32 v155, v158, v159
  buffer_store_dwordx4 v[152:155], v2, s[16:19], s57 offen offset:0 sc1
  s_lshl_b32 s34, s32, 4
  s_add_u32 s34, s34, s33
  s_lshl_b32 s34, s34, 7
  s_add_u32 s34, s34, 32768
  s_mov_b32 s63, 0x70000000
Lp3:
  v_accvgpr_read_b32 v16, a230
  v_accvgpr_read_b32 v17, a231
  v_accvgpr_read_b32 v18, a232
  v_accvgpr_read_b32 v19, a233
  v_accvgpr_read_b32 v20, a234
  v_accvgpr_read_b32 v21, a235
  s_mov_b32 s89, 0
  s_mov_b32 s91, 4294901760
  s_mov_b32 s92, 32768
  s_mov_b32 s89, 1
  s_mov_b32 s69, 0
  s_mov_b32 s71, 4294934528
  s_mov_b32 s72, 16384
  s_waitcnt vmcnt(28)
  s_barrier
  ds_read_b128 a[32:35], v16 offset:0
  ds_read_b128 a[48:51], v17 offset:0
  ds_read_b64_tr_b16 a[64:65], v18 offset:0
  ds_read_b64_tr_b16 a[66:67], v18 offset:2048
  ds_read_b64_tr_b16 a[96:97], v18 offset:4096
  ds_read_b64_tr_b16 a[98:99], v18 offset:6144
  ds_read_b128 a[36:39], v16 offset:2048
  ds_read_b128 a[52:55], v17 offset:2048
  ds_read_b128 a[40:43], v16 offset:4096
  ds_read_b128 a[56:59], v17 offset:4096
  ds_read_b128 a[44:47], v16 offset:6144
  ds_read_b128 a[60:63], v17 offset:6144
  ds_read_b64_tr_b16 a[68:69], v19 offset:0
  ds_read_b64_tr_b16 a[70:71], v19 offset:2048
  ds_read_b64_tr_b16 a[100:101], v19 offset:4096
  ds_read_b64_tr_b16 a[102:103], v19 offset:6144
  ds_read_b64_tr_b16 a[72:73], v20 offset:0
  ds_read_b64_tr_b16 a[74:75], v20 offset:2048
  ds_read_b64_tr_b16 a[104:105], v20 offset:4096
  ds_read_b64_tr_b16 a[106:107], v20 offset:6144
  ds_read_b64_tr_b16 a[76:77], v21 offset:0
  ds_read_b64_tr_b16 a[78:79], v21 offset:2048
  ds_read_b64_tr_b16 a[108:109], v21 offset:4096
  ds_read_b64_tr_b16 a[110:111], v21 offset:6144
  s_waitcnt lgkmcnt(0)
  v_mfma_f32_16x16x32_bf16 v[32:35], a[64:67], a[32:35], 0
  s_add_u32 s60, s63, 32768
  ds_read_b64_tr_b16 a[80:81], v18 offset:8192
  v_mfma_f32_16x16x32_bf16 v[32:35], a[96:99], a[48:51], v[32:35]
  buffer_store_dwordx4 v[192:195], v2, s[16:19], s60 offen offset:0 sc1
  v_mfma_f32_16x16x32_bf16 v[64:67], a[64:67], a[36:39], 0
  s_add_u32 s60, s63, 40960
  ds_read_b64_tr_b16 a[82:83], v18 offset:10240
  ds_read_b64_tr_b16 a[112:113], v18 offset:12288
  v_mfma_f32_16x16x32_bf16 v[64:67], a[96:99], a[52:55], v[64:67]
  buffer_store_dwordx4 v[224:227], v2, s[16:19], s60 offen offset:0 sc1
  v_mfma_f32_16x16x32_bf16 v[96:99], a[64:67], a[40:43], 0
  s_add_u32 s60, s63, 32768
  ds_read_b64_tr_b16 a[114:115], v18 offset:14336
  v_mfma_f32_16x16x32_bf16 v[96:99], a[96:99], a[56:59], v[96:99]
  s_add_u32 s89, s89, 1
  ds_read_b64_tr_b16 a[84:85], v19 offset:8192
  v_mfma_f32_16x16x32_bf16 v[128:131], a[64:67], a[44:47], 0
  buffer_store_dwordx4 v[196:199], v2, s[16:19], s60 offen offset:1024 sc1
  v_mfma_f32_16x16x32_bf16 v[128:131], a[96:99], a[60:63], v[128:131]
  s_add_u32 s60, s63, 40960
  ds_read_b64_tr_b16 a[86:87], v19 offset:10240
  v_mfma_f32_16x16x32_bf16 v[36:39], a[68:71], a[32:35], 0
  ds_read_b64_tr_b16 a[116:117], v19 offset:12288
  v_mfma_f32_16x16x32_bf16 v[36:39], a[100:103], a[48:51], v[36:39]
  buffer_store_dwordx4 v[228:231], v2, s[16:19], s60 offen offset:1024 sc1
  v_mfma_f32_16x16x32_bf16 v[68:71], a[68:71], a[36:39], 0
  s_add_u32 s60, s63, 32768
  ds_read_b64_tr_b16 a[118:119], v19 offset:14336
  v_mfma_f32_16x16x32_bf16 v[68:71], a[100:103], a[52:55], v[68:71]
  ds_read_b64_tr_b16 a[88:89], v20 offset:8192
  v_mfma_f32_16x16x32_bf16 v[100:103], a[68:71], a[40:43], 0
  buffer_store_dwordx4 v[200:203], v2, s[16:19], s60 offen offset:2048 sc1
  v_mfma_f32_16x16x32_bf16 v[100:103], a[100:103], a[56:59], v[100:103]
  s_add_u32 s60, s63, 40960
  ds_read_b64_tr_b16 a[90:91], v20 offset:10240
  ds_read_b64_tr_b16 a[120:121], v20 offset:12288
  v_mfma_f32_16x16x32_bf16 v[132:135], a[68:71], a[44:47], 0
  s_cmp_eq_u32 s89, 3
  s_cselect_b32 s89, 0, s89
  s_cselect_b32 s90, s91, s92
  v_mfma_f32_16x16x32_bf16 v[132:135], a[100:103], a[60:63], v[132:135]
  buffer_store_dwordx4 v[232:235], v2, s[16:19], s60 offen offset:2048 sc1
  v_mfma_f32_16x16x32_bf16 v[40:43], a[72:75], a[32:35], 0
  s_add_u32 s60, s63, 32768
  ds_read_b64_tr_b16 a[122:123], v20 offset:14336
  ds_read_b64_tr_b16 a[92:93], v21 offset:8192
  v_mfma_f32_16x16x32_bf16 v[40:43], a[104:107], a[48:51], v[40:43]
  s_add_u32 s69, s69, 1
  ds_read_b64_tr_b16 a[94:95], v21 offset:10240
  v_mfma_f32_16x16x32_bf16 v[72:75], a[72:75], a[36:39], 0
  buffer_store_dwordx4 v[204:207], v2, s[16:19], s60 offen offset:3072 sc1
  v_mfma_f32_16x16x32_bf16 v[72:75], a[104:107], a[52:55], v[72:75]
  s_add_u32 s60, s63, 40960
  ds_read_b64_tr_b16 a[124:125], v21 offset:12288
  v_mfma_f32_16x16x32_bf16 v[104:107], a[72:75], a[40:43], 0
  ds_read_b64_tr_b16 a[126:127], v21 offset:14336
  v_mfma_f32_16x16x32_bf16 v[104:107], a[104:107], a[56:59], v[104:107]
  buffer_store_dwordx4 v[236:239], v2, s[16:19], s60 offen offset:3072 sc1
  v_mfma_f32_16x16x32_bf16 v[136:139], a[72:75], a[44:47], 0
  s_cmp_eq_u32 s69, 3
  s_cselect_b32 s69, 0, s69
  s_cselect_b32 s70, s71, s72
  v_mfma_f32_16x16x32_bf16 v[136:139], a[104:107], a[60:63], v[136:139]
  v_add_u32 v16, s90, v16
  v_add_u32 v17, s90, v17
  v_mfma_f32_16x16x32_bf16 v[44:47], a[76:79], a[32:35], 0
  v_add_u32 v18, s70, v18
  v_add_u32 v19, s70, v19
  v_mfma_f32_16x16x32_bf16 v[44:47], a[108:111], a[48:51], v[44:47]
  v_add_u32 v20, s70, v20
  v_add_u32 v21, s70, v21
  v_mfma_f32_16x16x32_bf16 v[76:79], a[76:79], a[36:39], 0
  v_mfma_f32_16x16x32_bf16 v[76:79], a[108:111], a[52:55], v[76:79]
  v_mfma_f32_16x16x32_bf16 v[108:111], a[76:79], a[40:43], 0
  v_mfma_f32_16x16x32_bf16 v[108:111], a[108:111], a[56:59], v[108:111]
  v_mfma_f32_16x16x32_bf16 v[140:143], a[76:79], a[44:47], 0
  v_mfma_f32_16x16x32_bf16 v[140:143], a[108:111], a[60:63], v[140:143]
  s_waitcnt vmcnt(20) lgkmcnt(0)
  s_barrier
  v_mfma_f32_16x16x32_bf16 v[48:51], a[80:83], a[32:35], 0
  s_mov_b32 m0, s68
  ds_read_b128 a[0:3], v16 offset:0
  ds_read_b128 a[16:19], v17 offset:0
  v_mfma_f32_16x16x32_bf16 v[48:51], a[112:115], a[48:51], v[48:51]
  buffer_load_dwordx4 v8, s[20:23], s28 offen offset:0 lds
  v_mfma_f32_16x16x32_bf16 v[80:83], a[80:83], a[36:39], 0
  ds_read_b64_tr_b16 a[64:65], v18 offset:0
  ds_read_b64_tr_b16 a[66:67], v18 offset:2048
  v_mfma_f32_16x16x32_bf16 v[80:83], a[112:115], a[52:55], v[80:83]
  ds_read_b64_tr_b16 a[96:97], v18 offset:4096
  v_mfma_f32_16x16x32_bf16 v[112:115], a[80:83], a[40:43], 0
  ds_read_b64_tr_b16 a[98:99], v18 offset:6144
  v_mfma_f32_16x16x32_bf16 v[112:115], a[112:115], a[56:59], v[112:115]
  buffer_load_dwordx4 v9, s[20:23], s28 offen offset:1024 lds
  v_mfma_f32_16x16x32_bf16 v[144:147], a[80:83], a[44:47], 0
  ds_read_b128 a[4:7], v16 offset:2048
  ds_read_b128 a[20:23], v17 offset:2048
  v_mfma_f32_16x16x32_bf16 v[144:147], a[112:115], a[60:63], v[144:147]
  ds_read_b128 a[8:11], v16 offset:4096
  v_mfma_f32_16x16x32_bf16 v[52:55], a[84:87], a[32:35], 0
  ds_read_b128 a[24:27], v17 offset:4096
  v_mfma_f32_16x16x32_bf16 v[52:55], a[116:119], a[48:51], v[52:55]
  ds_read_b128 a[12:15], v16 offset:6144
  v_mfma_f32_16x16x32_bf16 v[84:87], a[84:87], a[36:39], 0
  buffer_load_dwordx4 v10, s[20:23], s28 offen offset:2048 lds
  v_mfma_f32_16x16x32_bf16 v[84:87], a[116:119], a[52:55], v[84:87]
  ds_read_b128 a[28:31], v17 offset:6144
  ds_read_b64_tr_b16 a[68:69], v19 offset:0
  v_mfma_f32_16x16x32_bf16 v[116:119], a[84:87], a[40:43], 0
  ds_read_b64_tr_b16 a[70:71], v19 offset:2048
  ds_read_b64_tr_b16 a[100:101], v19 offset:4096
  v_mfma_f32_16x16x32_bf16 v[116:119], a[116:119], a[56:59], v[116:119]
  ds_read_b64_tr_b16 a[102:103], v19 offset:6144
  v_mfma_f32_16x16x32_bf16 v[148:151], a[84:87], a[44:47], 0
  ds_read_b64_tr_b16 a[72:73], v20 offset:0
  v_mfma_f32_16x16x32_bf16 v[148:151], a[116:119], a[60:63], v[148:151]
  buffer_load_dwordx4 v11, s[20:23], s28 offen offset:3072 lds
  v_mfma_f32_16x16x32_bf16 v[56:59], a[88:91], a[32:35], 0
  s_bfe_u32 s56, 0x302010e, s55
  s_add_u32 s54, s54, s56
  s_add_u32 s55, s55, 8
  v_mfma_f32_16x16x32_bf16 v[56:59], a[120:123], a[48:51], v[56:59]
  s_and_b32 s55, s55, 0x8001f
  s_and_b32 s54, s54, 15
  s_lshl_b32 s28, s54, 19
  v_mfma_f32_16x16x32_bf16 v[88:91], a[88:91], a[36:39], 0
  s_mov_b32 m0, s88
  ds_read_b64_tr_b16 a[74:75], v20 offset:2048
  ds_read_b64_tr_b16 a[104:105], v20 offset:4096
  v_mfma_f32_16x16x32_bf16 v[88:91], a[120:123], a[52:55], v[88:91]
  ds_read_b64_tr_b16 a[106:107], v20 offset:6144
  ds_read_b64_tr_b16 a[76:77], v21 offset:0
  v_mfma_f32_16x16x32_bf16 v[120:123], a[88:91], a[40:43], 0
  buffer_load_dwordx4 v4, s[8:11], s26 offen offset:0 lds
  v_mfma_f32_16x16x32_bf16 v[120:123], a[120:123], a[56:59], v[120:123]
  ds_read_b64_tr_b16 a[78:79], v21 offset:2048
  ds_read_b64_tr_b16 a[108:109], v21 offset:4096
  v_mfma_f32_16x16x32_bf16 v[152:155], a[88:91], a[44:47], 0
  ds_read_b64_tr_b16 a[110:111], v21 offset:6144
  v_mfma_f32_16x16x32_bf16 v[152:155], a[120:123], a[60:63], v[152:155]
  v_mfma_f32_16x16x32_bf16 v[60:63], a[92:95], a[32:35], 0
  v_mfma_f32_16x16x32_bf16 v[60:63], a[124:127], a[48:51], v[60:63]
  buffer_load_dwordx4 v5, s[8:11], s26 offen offset:1024 lds
  v_mfma_f32_16x16x32_bf16 v[92:95], a[92:95], a[36:39], 0
  v_mfma_f32_16x16x32_bf16 v[92:95], a[124:127], a[52:55], v[92:95]
  v_mfma_f32_16x16x32_bf16 v[124:127], a[92:95], a[40:43], 0
  v_mfma_f32_16x16x32_bf16 v[124:127], a[124:127], a[56:59], v[124:127]
  v_mfma_f32_16x16x32_bf16 v[156:159], a[92:95], a[44:47], 0
  v_mfma_f32_16x16x32_bf16 v[156:159], a[124:127], a[60:63], v[156:159]
  s_waitcnt lgkmcnt(0)
  v_mfma_f32_16x16x32_bf16 v[32:35], a[64:67], a[0:3], v[32:35]
  buffer_load_dwordx4 v6, s[8:11], s26 offen offset:2048 lds
  v_mfma_f32_16x16x32_bf16 v[32:35], a[96:99], a[16:19], v[32:35]
  ds_read_b64_tr_b16 a[80:81], v18 offset:8192
  ds_read_b64_tr_b16 a[82:83], v18 offset:10240
  v_mfma_f32_16x16x32_bf16 v[64:67], a[64:67], a[4:7], v[64:67]
  ds_read_b64_tr_b16 a[112:113], v18 offset:12288
  v_mfma_f32_16x16x32_bf16 v[64:67], a[96:99], a[20:23], v[64:67]
  v_mfma_f32_16x16x32_bf16 v[96:99], a[64:67], a[8:11], v[96:99]
  buffer_load_dwordx4 v7, s[8:11], s26 offen offset:3072 lds
  v_mfma_f32_16x16x32_bf16 v[96:99], a[96:99], a[24:27], v[96:99]
  s_add_u32 m0, s88, 4096
  ds_read_b64_tr_b16 a[114:115], v18 offset:14336
  ds_read_b64_tr_b16 a[84:85], v19 offset:8192
  v_mfma_f32_16x16x32_bf16 v[128:131], a[64:67], a[12:15], v[128:131]
  s_add_u32 s88, s88, s90
  ds_read_b64_tr_b16 a[86:87], v19 offset:10240
  v_mfma_f32_16x16x32_bf16 v[128:131], a[96:99], a[28:31], v[128:131]
  s_add_u32 s89, s89, 1
  v_mfma_f32_16x16x32_bf16 v[36:39], a[68:71], a[0:3], v[36:39]
  buffer_load_dwordx4 v4, s[8:11], s27 offen offset:0 lds
  v_mfma_f32_16x16x32_bf16 v[36:39], a[100:103], a[16:19], v[36:39]
  ds_read_b64_tr_b16 a[116:117], v19 offset:12288
  ds_read_b64_tr_b16 a[118:119], v19 offset:14336
  v_mfma_f32_16x16x32_bf16 v[68:71], a[68:71], a[4:7], v[68:71]
  s_cmp_eq_u32 s89, 3
  s_cselect_b32 s89, 0, s89
  s_cselect_b32 s90, s91, s92
  v_mfma_f32_16x16x32_bf16 v[68:71], a[100:103], a[20:23], v[68:71]
  s_add_u32 s68, s68, s70
  ds_read_b64_tr_b16 a[88:89], v20 offset:8192
  v_mfma_f32_16x16x32_bf16 v[100:103], a[68:71], a[8:11], v[100:103]
  buffer_load_dwordx4 v5, s[8:11], s27 offen offset:1024 lds
  v_mfma_f32_16x16x32_bf16 v[100:103], a[100:103], a[24:27], v[100:103]
  s_add_u32 s69, s69, 1
  ds_read_b64_tr_b16 a[90:91], v20 offset:10240
  ds_read_b64_tr_b16 a[120:121], v20 offset:12288
  v_mfma_f32_16x16x32_bf16 v[132:135], a[68:71], a[12:15], v[132:135]
  s_cmp_eq_u32 s69, 3
  s_cselect_b32 s69, 0, s69
  s_cselect_b32 s70, s71, s72
  v_mfma_f32_16x16x32_bf16 v[132:135], a[100:103], a[28:31], v[132:135]
  ds_read_b64_tr_b16 a[122:123], v20 offset:14336
  v_mfma_f32_16x16x32_bf16 v[40:43], a[72:75], a[0:3], v[40:43]
  buffer_load_dwordx4 v6, s[8:11], s27 offen offset:2048 lds
  v_mfma_f32_16x16x32_bf16 v[40:43], a[104:107], a[16:19], v[40:43]
  ds_read_b64_tr_b16 a[92:93], v21 offset:8192
  ds_read_b64_tr_b16 a[94:95], v21 offset:10240
  v_mfma_f32_16x16x32_bf16 v[72:75], a[72:75], a[4:7], v[72:75]
  v_mfma_f32_16x16x32_bf16 v[72:75], a[104:107], a[20:23], v[72:75]
  ds_read_b64_tr_b16 a[124:125], v21 offset:12288
  v_mfma_f32_16x16x32_bf16 v[104:107], a[72:75], a[8:11], v[104:107]
  buffer_load_dwordx4 v7, s[8:11], s27 offen offset:3072 lds
  v_mfma_f32_16x16x32_bf16 v[104:107], a[104:107], a[24:27], v[104:107]
  s_bfe_u32 s29, 0x302010e, s53
  ds_read_b64_tr_b16 a[126:127], v21 offset:14336
  v_mfma_f32_16x16x32_bf16 v[136:139], a[72:75], a[12:15], v[136:139]
  s_add_u32 s52, s52, s29
  v_add_u32 v16, s90, v16
  v_add_u32 v17, s90, v17
  v_mfma_f32_16x16x32_bf16 v[136:139], a[104:107], a[28:31], v[136:139]
  s_add_u32 s53, s53, 8
  v_add_u32 v18, s70, v18
  v_add_u32 v19, s70, v19
  v_mfma_f32_16x16x32_bf16 v[44:47], a[76:79], a[0:3], v[44:47]
  s_and_b32 s53, s53, 0x8001f
  v_add_u32 v20, s70, v20
  v_add_u32 v21, s70, v21
  v_mfma_f32_16x16x32_bf16 v[44:47], a[108:111], a[16:19], v[44:47]
  s_and_b32 s52, s52, 15
  v_mfma_f32_16x16x32_bf16 v[76:79], a[76:79], a[4:7], v[76:79]
  s_lshl_b32 s29, s52, 7
  v_mfma_f32_16x16x32_bf16 v[76:79], a[108:111], a[20:23], v[76:79]
  s_or_b32 s26, s30, s29
  v_mfma_f32_16x16x32_bf16 v[108:111], a[76:79], a[8:11], v[108:111]
  s_or_b32 s27, s31, s29
  v_mfma_f32_16x16x32_bf16 v[108:111], a[108:111], a[24:27], v[108:111]
  v_mfma_f32_16x16x32_bf16 v[140:143], a[76:79], a[12:15], v[140:143]
  v_mfma_f32_16x16x32_bf16 v[140:143], a[108:111], a[28:31], v[140:143]
  s_waitcnt vmcnt(20) lgkmcnt(0)
  s_barrier
  v_mfma_f32_16x16x32_bf16 v[48:51], a[80:83], a[0:3], v[48:51]
  s_mov_b32 m0, s68
  ds_read_b128 a[32:35], v16 offset:0
  ds_read_b128 a[48:51], v17 offset:0
  v_mfma_f32_16x16x32_bf16 v[48:51], a[112:115], a[16:19], v[48:51]
  buffer_load_dwordx4 v8, s[20:23], s28 offen offset:0 lds
  v_mfma_f32_16x16x32_bf16 v[80:83], a[80:83], a[4:7], v[80:83]
  ds_read_b64_tr_b16 a[64:65], v18 offset:0
  ds_read_b64_tr_b16 a[66:67], v18 offset:2048
  v_mfma_f32_16x16x32_bf16 v[80:83], a[112:115], a[20:23], v[80:83]
  buffer_load_dwordx4 v9, s[20:23], s28 offen offset:1024 lds
  v_mfma_f32_16x16x32_bf16 v[112:115], a[80:83], a[8:11], v[112:115]
  ds_read_b64_tr_b16 a[96:97], v18 offset:4096
  ds_read_b64_tr_b16 a[98:99], v18 offset:6144
  v_mfma_f32_16x16x32_bf16 v[112:115], a[112:115], a[24:27], v[112:115]
  ds_read_b128 a[36:39], v16 offset:2048
  v_mfma_f32_16x16x32_bf16 v[144:147], a[80:83], a[12:15], v[144:147]
  buffer_load_dwordx4 v10, s[20:23], s28 offen offset:2048 lds
  v_mfma_f32_16x16x32_bf16 v[144:147], a[112:115], a[28:31], v[144:147]
  ds_read_b128 a[52:55], v17 offset:2048
  ds_read_b128 a[40:43], v16 offset:4096
  v_mfma_f32_16x16x32_bf16 v[52:55], a[84:87], a[0:3], v[52:55]
  ds_read_b128 a[56:59], v17 offset:4096
  v_mfma_f32_16x16x32_bf16 v[52:55], a[116:119], a[16:19], v[52:55]
  buffer_load_dwordx4 v11, s[20:23], s28 offen offset:3072 lds
  v_mfma_f32_16x16x32_bf16 v[84:87], a[84:87], a[4:7], v[84:87]
  s_bfe_u32 s56, 0x302010e, s55
  s_add_u32 s54, s54, s56
  s_add_u32 s55, s55, 8
  v_mfma_f32_16x16x32_bf16 v[84:87], a[116:119], a[20:23], v[84:87]
  s_and_b32 s55, s55, 0x8001f
  s_and_b32 s54, s54, 15
  s_lshl_b32 s28, s54, 19
  v_mfma_f32_16x16x32_bf16 v[116:119], a[84:87], a[8:11], v[116:119]
  s_mov_b32 m0, s88
  ds_read_b128 a[44:47], v16 offset:6144
  ds_read_b128 a[60:63], v17 offset:6144
  v_mfma_f32_16x16x32_bf16 v[116:119], a[116:119], a[24:27], v[116:119]
  buffer_load_dwordx4 v4, s[8:11], s26 offen offset:0 lds
  v_mfma_f32_16x16x32_bf16 v[148:151], a[84:87], a[12:15], v[148:151]
  ds_read_b64_tr_b16 a[68:69], v19 offset:0
  ds_read_b64_tr_b16 a[70:71], v19 offset:2048
  v_mfma_f32_16x16x32_bf16 v[148:151], a[116:119], a[28:31], v[148:151]
  buffer_load_dwordx4 v5, s[8:11], s26 offen offset:1024 lds
  v_mfma_f32_16x16x32_bf16 v[56:59], a[88:91], a[0:3], v[56:59]
  ds_read_b64_tr_b16 a[100:101], v19 offset:4096
  ds_read_b64_tr_b16 a[102:103], v19 offset:6144
  v_mfma_f32_16x16x32_bf16 v[56:59], a[120:123], a[16:19], v[56:59]
  ds_read_b64_tr_b16 a[72:73], v20 offset:0
  ds_read_b64_tr_b16 a[74:75], v20 offset:2048
  v_mfma_f32_16x16x32_bf16 v[88:91], a[88:91], a[4:7], v[88:91]
  buffer_load_dwordx4 v6, s[8:11], s26 offen offset:2048 lds
  v_mfma_f32_16x16x32_bf16 v[88:91], a[120:123], a[20:23], v[88:91]
  ds_read_b64_tr_b16 a[104:105], v20 offset:4096
  ds_read_b64_tr_b16 a[106:107], v20 offset:6144
  v_mfma_f32_16x16x32_bf16 v[120:123], a[88:91], a[8:11], v[120:123]
  ds_read_b64_tr_b16 a[76:77], v21 offset:0
  ds_read_b64_tr_b16 a[78:79], v21 offset:2048
  v_mfma_f32_16x16x32_bf16 v[120:123], a[120:123], a[24:27], v[120:123]
  buffer_load_dwordx4 v7, s[8:11], s26 offen offset:3072 lds
  v_mfma_f32_16x16x32_bf16 v[152:155], a[88:91], a[12:15], v[152:155]
  s_add_u32 m0, s88, 4096
  ds_read_b64_tr_b16 a[108:109], v21 offset:4096
  ds_read_b64_tr_b16 a[110:111], v21 offset:6144
  v_mfma_f32_16x16x32_bf16 v[152:155], a[120:123], a[28:31], v[152:155]
  v_mfma_f32_16x16x32_bf16 v[60:63], a[92:95], a[0:3], v[60:63]
  buffer_load_dwordx4 v4, s[8:11], s27 offen offset:0 lds
  v_mfma_f32_16x16x32_bf16 v[60:63], a[124:127], a[16:19], v[60:63]
  v_mfma_f32_16x16x32_bf16 v[92:95], a[92:95], a[4:7], v[92:95]
  v_mfma_f32_16x16x32_bf16 v[92:95], a[124:127], a[20:23], v[92:95]
  buffer_load_dwordx4 v5, s[8:11], s27 offen offset:1024 lds
  v_mfma_f32_16x16x32_bf16 v[124:127], a[92:95], a[8:11], v[124:127]
  v_mfma_f32_16x16x32_bf16 v[124:127], a[124:127], a[24:27], v[124:127]
  v_mfma_f32_16x16x32_bf16 v[156:159], a[92:95], a[12:15], v[156:159]
  v_mfma_f32_16x16x32_bf16 v[156:159], a[124:127], a[28:31], v[156:159]
  s_waitcnt lgkmcnt(0)
  v_mfma_f32_16x16x32_bf16 v[32:35], a[64:67], a[32:35], v[32:35]
  buffer_load_dwordx4 v6, s[8:11], s27 offen offset:2048 lds
  v_mfma_f32_16x16x32_bf16 v[32:35], a[96:99], a[48:51], v[32:35]
  s_add_u32 s88, s88, s90
  ds_read_b64_tr_b16 a[80:81], v18 offset:8192
  ds_read_b64_tr_b16 a[82:83], v18 offset:10240
  v_mfma_f32_16x16x32_bf16 v[64:67], a[64:67], a[36:39], v[64:67]
  buffer_load_dwordx4 v7, s[8:11], s27 offen offset:3072 lds
  v_mfma_f32_16x16x32_bf16 v[64:67], a[96:99], a[52:55], v[64:67]
  s_bfe_u32 s29, 0x302010e, s53
  s_add_u32 s52, s52, s29
  s_add_u32 s53, s53, 8
  v_mfma_f32_16x16x32_bf16 v[96:99], a[64:67], a[40:43], v[96:99]
  s_and_b32 s53, s53, 0x8001f
  s_and_b32 s52, s52, 15
  s_lshl_b32 s29, s52, 7
  v_mfma_f32_16x16x32_bf16 v[96:99], a[96:99], a[56:59], v[96:99]
  s_or_b32 s26, s30, s29
  s_or_b32 s27, s31, s29
  s_add_u32 s60, s63, 36864
  v_mfma_f32_16x16x32_bf16 v[128:131], a[64:67], a[44:47], v[128:131]
  buffer_store_dwordx4 v[208:211], v2, s[16:19], s60 offen offset:0 sc1
  v_mfma_f32_16x16x32_bf16 v[128:131], a[96:99], a[60:63], v[128:131]
  s_add_u32 s60, s63, 45056
  ds_read_b64_tr_b16 a[112:113], v18 offset:12288
  ds_read_b64_tr_b16 a[114:115], v18 offset:14336
  v_mfma_f32_16x16x32_bf16 v[36:39], a[68:71], a[32:35], v[36:39]
  buffer_store_dwordx4 v[240:243], v2, s[16:19], s60 offen offset:0 sc1
  v_mfma_f32_16x16x32_bf16 v[36:39], a[100:103], a[48:51], v[36:39]
  s_add_u32 s60, s63, 36864
  ds_read_b64_tr_b16 a[84:85], v19 offset:8192
  ds_read_b64_tr_b16 a[86:87], v19 offset:10240
  v_mfma_f32_16x16x32_bf16 v[68:71], a[68:71], a[36:39], v[68:71]
  buffer_store_dwordx4 v[212:215], v2, s[16:19], s60 offen offset:1024 sc1
  v_mfma_f32_16x16x32_bf16 v[68:71], a[100:103], a[52:55], v[68:71]
  s_add_u32 s60, s63, 45056
  ds_read_b64_tr_b16 a[116:117], v19 offset:12288
  ds_read_b64_tr_b16 a[118:119], v19 offset:14336
  v_mfma_f32_16x16x32_bf16 v[100:103], a[68:71], a[40:43], v[100:103]
  buffer_store_dwordx4 v[244:247], v2, s[16:19], s60 offen offset:1024 sc1
  v_mfma_f32_16x16x32_bf16 v[100:103], a[100:103], a[56:59], v[100:103]
  s_add_u32 s60, s63, 36864
  ds_read_b64_tr_b16 a[88:89], v20 offset:8192
  ds_read_b64_tr_b16 a[90:91], v20 offset:10240
  v_mfma_f32_16x16x32_bf16 v[132:135], a[68:71], a[44:47], v[132:135]
  s_add_u32 s89, s89, 1
  ds_read_b64_tr_b16 a[120:121], v20 offset:12288
  v_mfma_f32_16x16x32_bf16 v[132:135], a[100:103], a[60:63], v[132:135]
  buffer_store_dwordx4 v[216:219], v2, s[16:19], s60 offen offset:2048 sc1
  v_mfma_f32_16x16x32_bf16 v[40:43], a[72:75], a[32:35], v[40:43]
  s_add_u32 s60, s63, 45056
  ds_read_b64_tr_b16 a[122:123], v20 offset:14336
  ds_read_b64_tr_b16 a[92:93], v21 offset:8192
  v_mfma_f32_16x16x32_bf16 v[40:43], a[104:107], a[48:51], v[40:43]
  buffer_store_dwordx4 v[248:251], v2, s[16:19], s60 offen offset:2048 sc1
  v_mfma_f32_16x16x32_bf16 v[72:75], a[72:75], a[36:39], v[72:75]
  s_add_u32 s60, s63, 36864
  ds_read_b64_tr_b16 a[94:95], v21 offset:10240
  v_mfma_f32_16x16x32_bf16 v[72:75], a[104:107], a[52:55], v[72:75]
  ds_read_b64_tr_b16 a[124:125], v21 offset:12288
  v_mfma_f32_16x16x32_bf16 v[104:107], a[72:75], a[40:43], v[104:107]
  buffer_store_dwordx4 v[220:223], v2, s[16:19], s60 offen offset:3072 sc1
  v_mfma_f32_16x16x32_bf16 v[104:107], a[104:107], a[56:59], v[104:107]
  s_add_u32 s60, s63, 45056
  ds_read_b64_tr_b16 a[126:127], v21 offset:14336
  v_mfma_f32_16x16x32_bf16 v[136:139], a[72:75], a[44:47], v[136:139]
  buffer_store_dwordx4 v[252:255], v2, s[16:19], s60 offen offset:3072 sc1
  v_mfma_f32_16x16x32_bf16 v[136:139], a[104:107], a[60:63], v[136:139]
  s_cmp_eq_u32 s89, 3
  s_cselect_b32 s89, 0, s89
  s_cselect_b32 s90, s91, s92
  v_mfma_f32_16x16x32_bf16 v[44:47], a[76:79], a[32:35], v[44:47]
  s_add_u32 s68, s68, s70
  v_mfma_f32_16x16x32_bf16 v[44:47], a[108:111], a[48:51], v[44:47]
  s_add_u32 s69, s69, 1
  v_mfma_f32_16x16x32_bf16 v[76:79], a[76:79], a[36:39], v[76:79]
  s_cmp_eq_u32 s69, 3
  s_cselect_b32 s69, 0, s69
  s_cselect_b32 s70, s71, s72
  v_mfma_f32_16x16x32_bf16 v[76:79], a[108:111], a[52:55], v[76:79]
  v_add_u32 v16, s90, v16
  v_add_u32 v17, s90, v17
  v_mfma_f32_16x16x32_bf16 v[108:111], a[76:79], a[40:43], v[108:111]
  v_add_u32 v18, s70, v18
  v_add_u32 v19, s70, v19
  v_mfma_f32_16x16x32_bf16 v[108:111], a[108:111], a[56:59], v[108:111]
  v_add_u32 v20, s70, v20
  v_add_u32 v21, s70, v21
  v_mfma_f32_16x16x32_bf16 v[140:143], a[76:79], a[44:47], v[140:143]
  v_mfma_f32_16x16x32_bf16 v[140:143], a[108:111], a[60:63], v[140:143]
  s_waitcnt vmcnt(20) lgkmcnt(0)
  s_barrier
  v_mfma_f32_16x16x32_bf16 v[48:51], a[80:83], a[32:35], v[48:51]
  s_mov_b32 m0, s68
  ds_read_b128 a[0:3], v16 offset:0
  ds_read_b128 a[16:19], v17 offset:0
  v_mfma_f32_16x16x32_bf16 v[48:51], a[112:115], a[48:51], v[48:51]
  buffer_load_dwordx4 v8, s[20:23], s28 offen offset:0 lds
  v_mfma_f32_16x16x32_bf16 v[80:83], a[80:83], a[36:39], v[80:83]
  ds_read_b64_tr_b16 a[64:65], v18 offset:0
  ds_read_b64_tr_b16 a[66:67], v18 offset:2048
  v_mfma_f32_16x16x32_bf16 v[80:83], a[112:115], a[52:55], v[80:83]
  ds_read_b64_tr_b16 a[96:97], v18 offset:4096
  v_mfma_f32_16x16x32_bf16 v[112:115], a[80:83], a[40:43], v[112:115]
  ds_read_b64_tr_b16 a[98:99], v18 offset:6144
  v_mfma_f32_16x16x32_bf16 v[112:115], a[112:115], a[56:59], v[112:115]
  buffer_load_dwordx4 v9, s[20:23], s28 offen offset:1024 lds
  v_mfma_f32_16x16x32_bf16 v[144:147], a[80:83], a[44:47], v[144:147]
  ds_read_b128 a[4:7], v16 offset:2048
  ds_read_b128 a[20:23], v17 offset:2048
  v_mfma_f32_16x16x32_bf16 v[144:147], a[112:115], a[60:63], v[144:147]
  ds_read_b128 a[8:11], v16 offset:4096
  v_mfma_f32_16x16x32_bf16 v[52:55], a[84:87], a[32:35], v[52:55]
  ds_read_b128 a[24:27], v17 offset:4096
  v_mfma_f32_16x16x32_bf16 v[52:55], a[116:119], a[48:51], v[52:55]
  ds_read_b128 a[12:15], v16 offset:6144
  v_mfma_f32_16x16x32_bf16 v[84:87], a[84:87], a[36:39], v[84:87]
  buffer_load_dwordx4 v10, s[20:23], s28 offen offset:2048 lds
  v_mfma_f32_16x16x32_bf16 v[84:87], a[116:119], a[52:55], v[84:87]
  ds_read_b128 a[28:31], v17 offset:6144
  ds_read_b64_tr_b16 a[68:69], v19 offset:0
  v_mfma_f32_16x16x32_bf16 v[116:119], a[84:87], a[40:43], v[116:119]
  ds_read_b64_tr_b16 a[70:71], v19 offset:2048
  ds_read_b64_tr_b16 a[100:101], v19 offset:4096
  v_mfma_f32_16x16x32_bf16 v[116:119], a[116:119], a[56:59], v[116:119]
  ds_read_b64_tr_b16 a[102:103], v19 offset:6144
  v_mfma_f32_16x16x32_bf16 v[148:151], a[84:87], a[44:47], v[148:151]
  ds_read_b64_tr_b16 a[72:73], v20 offset:0
  v_mfma_f32_16x16x32_bf16 v[148:151], a[116:119], a[60:63], v[148:151]
  buffer_load_dwordx4 v11, s[20:23], s28 offen offset:3072 lds
  v_mfma_f32_16x16x32_bf16 v[56:59], a[88:91], a[32:35], v[56:59]
  s_bfe_u32 s56, 0x302010e, s55
  s_add_u32 s54, s54, s56
  s_add_u32 s55, s55, 8
  v_mfma_f32_16x16x32_bf16 v[56:59], a[120:123], a[48:51], v[56:59]
  s_and_b32 s55, s55, 0x8001f
  s_and_b32 s54, s54, 15
  s_lshl_b32 s28, s54, 19
  v_mfma_f32_16x16x32_bf16 v[88:91], a[88:91], a[36:39], v[88:91]
  s_mov_b32 m0, s88
  ds_read_b64_tr_b16 a[74:75], v20 offset:2048
  ds_read_b64_tr_b16 a[104:105], v20 offset:4096
  v_mfma_f32_16x16x32_bf16 v[88:91], a[120:123], a[52:55], v[88:91]
  ds_read_b64_tr_b16 a[106:107], v20 offset:6144
  ds_read_b64_tr_b16 a[76:77], v21 offset:0
  v_mfma_f32_16x16x32_bf16 v[120:123], a[88:91], a[40:43], v[120:123]
  buffer_load_dwordx4 v4, s[8:11], s26 offen offset:0 lds
  v_mfma_f32_16x16x32_bf16 v[120:123], a[120:123], a[56:59], v[120:123]
  ds_read_b64_tr_b16 a[78:79], v21 offset:2048
  ds_read_b64_tr_b16 a[108:109], v21 offset:4096
  v_mfma_f32_16x16x32_bf16 v[152:155], a[88:91], a[44:47], v[152:155]
  ds_read_b64_tr_b16 a[110:111], v21 offset:6144
  v_mfma_f32_16x16x32_bf16 v[152:155], a[120:123], a[60:63], v[152:155]
  v_mfma_f32_16x16x32_bf16 v[60:63], a[92:95], a[32:35], v[60:63]
  v_mfma_f32_16x16x32_bf16 v[60:63], a[124:127], a[48:51], v[60:63]
  buffer_load_dwordx4 v5, s[8:11], s26 offen offset:1024 lds
  v_mfma_f32_16x16x32_bf16 v[92:95], a[92:95], a[36:39], v[92:95]
  v_mfma_f32_16x16x32_bf16 v[92:95], a[124:127], a[52:55], v[92:95]
  v_mfma_f32_16x16x32_bf16 v[124:127], a[92:95], a[40:43], v[124:127]
  v_mfma_f32_16x16x32_bf16 v[124:127], a[124:127], a[56:59], v[124:127]
  v_mfma_f32_16x16x32_bf16 v[156:159], a[92:95], a[44:47], v[156:159]
  v_mfma_f32_16x16x32_bf16 v[156:159], a[124:127], a[60:63], v[156:159]
  s_waitcnt lgkmcnt(0)
  v_mfma_f32_16x16x32_bf16 v[32:35], a[64:67], a[0:3], v[32:35]
  buffer_load_dwordx4 v6, s[8:11], s26 offen offset:2048 lds
  v_mfma_f32_16x16x32_bf16 v[32:35], a[96:99], a[16:19], v[32:35]
  ds_read_b64_tr_b16 a[80:81], v18 offset:8192
  ds_read_b64_tr_b16 a[82:83], v18 offset:10240
  v_mfma_f32_16x16x32_bf16 v[64:67], a[64:67], a[4:7], v[64:67]
  ds_read_b64_tr_b16 a[112:113], v18 offset:12288
  v_mfma_f32_16x16x32_bf16 v[64:67], a[96:99], a[20:23], v[64:67]
  v_mfma_f32_16x16x32_bf16 v[96:99], a[64:67], a[8:11], v[96:99]
  buffer_load_dwordx4 v7, s[8:11], s26 offen offset:3072 lds
  v_mfma_f32_16x16x32_bf16 v[96:99], a[96:99], a[24:27], v[96:99]
  s_add_u32 m0, s88, 4096
  ds_read_b64_tr_b16 a[114:115], v18 offset:14336
  ds_read_b64_tr_b16 a[84:85], v19 offset:8192
  v_mfma_f32_16x16x32_bf16 v[128:131], a[64:67], a[12:15], v[128:131]
  s_add_u32 s88, s88, s90
  ds_read_b64_tr_b16 a[86:87], v19 offset:10240
  v_mfma_f32_16x16x32_bf16 v[128:131], a[96:99], a[28:31], v[128:131]
  s_add_u32 s89, s89, 1
  v_mfma_f32_16x16x32_bf16 v[36:39], a[68:71], a[0:3], v[36:39]
  buffer_load_dwordx4 v4, s[8:11], s27 offen offset:0 lds
  v_mfma_f32_16x16x32_bf16 v[36:39], a[100:103], a[16:19], v[36:39]
  ds_read_b64_tr_b16 a[116:117], v19 offset:12288
  ds_read_b64_tr_b16 a[118:119], v19 offset:14336
  v_mfma_f32_16x16x32_bf16 v[68:71], a[68:71], a[4:7], v[68:71]
  s_cmp_eq_u32 s89, 3
  s_cselect_b32 s89, 0, s89
  s_cselect_b32 s90, s91, s92
  v_mfma_f32_16x16x32_bf16 v[68:71], a[100:103], a[20:23], v[68:71]
  s_add_u32 s68, s68, s70
  ds_read_b64_tr_b16 a[88:89], v20 offset:8192
  v_mfma_f32_16x16x32_bf16 v[100:103], a[68:71], a[8:11], v[100:103]
  buffer_load_dwordx4 v5, s[8:11], s27 offen offset:1024 lds
  v_mfma_f32_16x16x32_bf16 v[100:103], a[100:103], a[24:27], v[100:103]
  s_add_u32 s69, s69, 1
  ds_read_b64_tr_b16 a[90:91], v20 offset:10240
  ds_read_b64_tr_b16 a[120:121], v20 offset:12288
  v_mfma_f32_16x16x32_bf16 v[132:135], a[68:71], a[12:15], v[132:135]
  s_cmp_eq_u32 s69, 3
  s_cselect_b32 s69, 0, s69
  s_cselect_b32 s70, s71, s72
  v_mfma_f32_16x16x32_bf16 v[132:135], a[100:103], a[28:31], v[132:135]
  ds_read_b64_tr_b16 a[122:123], v20 offset:14336
  v_mfma_f32_16x16x32_bf16 v[40:43], a[72:75], a[0:3], v[40:43]
  buffer_load_dwordx4 v6, s[8:11], s27 offen offset:2048 lds
  v_mfma_f32_16x16x32_bf16 v[40:43], a[104:107], a[16:19], v[40:43]
  ds_read_b64_tr_b16 a[92:93], v21 offset:8192
  ds_read_b64_tr_b16 a[94:95], v21 offset:10240
  v_mfma_f32_16x16x32_bf16 v[72:75], a[72:75], a[4:7], v[72:75]
  v_mfma_f32_16x16x32_bf16 v[72:75], a[104:107], a[20:23], v[72:75]
  ds_read_b64_tr_b16 a[124:125], v21 offset:12288
  v_mfma_f32_16x16x32_bf16 v[104:107], a[72:75], a[8:11], v[104:107]
  buffer_load_dwordx4 v7, s[8:11], s27 offen offset:3072 lds
  v_mfma_f32_16x16x32_bf16 v[104:107], a[104:107], a[24:27], v[104:107]
  s_bfe_u32 s29, 0x302010e, s53
  ds_read_b64_tr_b16 a[126:127], v21 offset:14336
  v_mfma_f32_16x16x32_bf16 v[136:139], a[72:75], a[12:15], v[136:139]
  s_add_u32 s52, s52, s29
  v_add_u32 v16, s90, v16
  v_add_u32 v17, s90, v17
  v_mfma_f32_16x16x32_bf16 v[136:139], a[104:107], a[28:31], v[136:139]
  s_add_u32 s53, s53, 8
  v_add_u32 v18, s70, v18
  v_add_u32 v19, s70, v19
  v_mfma_f32_16x16x32_bf16 v[44:47], a[76:79], a[0:3], v[44:47]
  s_and_b32 s53, s53, 0x8001f
  v_add_u32 v20, s70, v20
  v_add_u32 v21, s70, v21
  v_mfma_f32_16x16x32_bf16 v[44:47], a[108:111], a[16:19], v[44:47]
  s_and_b32 s52, s52, 15
  v_mfma_f32_16x16x32_bf16 v[76:79], a[76:79], a[4:7], v[76:79]
  s_lshl_b32 s29, s52, 7
  v_mfma_f32_16x16x32_bf16 v[76:79], a[108:111], a[20:23], v[76:79]
  s_or_b32 s26, s30, s29
  v_mfma_f32_16x16x32_bf16 v[108:111], a[76:79], a[8:11], v[108:111]
  s_or_b32 s27, s31, s29
  v_mfma_f32_16x16x32_bf16 v[108:111], a[108:111], a[24:27], v[108:111]
  v_mfma_f32_16x16x32_bf16 v[140:143], a[76:79], a[12:15], v[140:143]
  v_mfma_f32_16x16x32_bf16 v[140:143], a[108:111], a[28:31], v[140:143]
  s_waitcnt vmcnt(20) lgkmcnt(0)
  s_barrier
  v_mfma_f32_16x16x32_bf16 v[48:51], a[80:83], a[0:3], v[48:51]
  s_mov_b32 m0, s68
  ds_read_b128 a[32:35], v16 offset:0
  ds_read_b128 a[48:51], v17 offset:0
  v_mfma_f32_16x16x32_bf16 v[48:51], a[112:115], a[16:19], v[48:51]
  buffer_load_dwordx4 v8, s[20:23], s28 offen offset:0 lds
  v_mfma_f32_16x16x32_bf16 v[80:83], a[80:83], a[4:7], v[80:83]
  ds_read_b64_tr_b16 a[64:65], v18 offset:0
  ds_read_b64_tr_b16 a[66:67], v18 offset:2048
  v_mfma_f32_16x16x32_bf16 v[80:83], a[112:115], a[20:23], v[80:83]
  buffer_load_dwordx4 v9, s[20:23], s28 offen offset:1024 lds
  v_mfma_f32_16x16x32_bf16 v[112:115], a[80:83], a[8:11], v[112:115]
  ds_read_b64_tr_b16 a[96:97], v18 offset:4096
  ds_read_b64_tr_b16 a[98:99], v18 offset:6144
  v_mfma_f32_16x16x32_bf16 v[112:115], a[112:115], a[24:27], v[112:115]
  ds_read_b128 a[36:39], v16 offset:2048
  v_mfma_f32_16x16x32_bf16 v[144:147], a[80:83], a[12:15], v[144:147]
  buffer_load_dwordx4 v10, s[20:23], s28 offen offset:2048 lds
  v_mfma_f32_16x16x32_bf16 v[144:147], a[112:115], a[28:31], v[144:147]
  ds_read_b128 a[52:55], v17 offset:2048
  ds_read_b128 a[40:43], v16 offset:4096
  v_mfma_f32_16x16x32_bf16 v[52:55], a[84:87], a[0:3], v[52:55]
  ds_read_b128 a[56:59], v17 offset:4096
  v_mfma_f32_16x16x32_bf16 v[52:55], a[116:119], a[16:19], v[52:55]
  buffer_load_dwordx4 v11, s[20:23], s28 offen offset:3072 lds
  v_mfma_f32_16x16x32_bf16 v[84:87], a[84:87], a[4:7], v[84:87]
  s_bfe_u32 s56, 0x302010e, s55
  s_add_u32 s54, s54, s56
  s_add_u32 s55, s55, 8
  v_mfma_f32_16x16x32_bf16 v[84:87], a[116:119], a[20:23], v[84:87]
  s_and_b32 s55, s55, 0x8001f
  s_and_b32 s54, s54, 15
  s_lshl_b32 s28, s54, 19
  v_mfma_f32_16x16x32_bf16 v[116:119], a[84:87], a[8:11], v[116:119]
  s_mov_b32 m0, s88
  ds_read_b128 a[44:47], v16 offset:6144
  ds_read_b128 a[60:63], v17 offset:6144
  v_mfma_f32_16x16x32_bf16 v[116:119], a[116:119], a[24:27], v[116:119]
  buffer_load_dwordx4 v4, s[8:11], s26 offen offset:0 lds
  v_mfma_f32_16x16x32_bf16 v[148:151], a[84:87], a[12:15], v[148:151]
  ds_read_b64_tr_b16 a[68:69], v19 offset:0
  ds_read_b64_tr_b16 a[70:71], v19 offset:2048
  v_mfma_f32_16x16x32_bf16 v[148:151], a[116:119], a[28:31], v[148:151]
  buffer_load_dwordx4 v5, s[8:11], s26 offen offset:1024 lds
  v_mfma_f32_16x16x32_bf16 v[56:59], a[88:91], a[0:3], v[56:59]
  ds_read_b64_tr_b16 a[100:101], v19 offset:4096
  ds_read_b64_tr_b16 a[102:103], v19 offset:6144
  v_mfma_f32_16x16x32_bf16 v[56:59], a[120:123], a[16:19], v[56:59]
  ds_read_b64_tr_b16 a[72:73], v20 offset:0
  ds_read_b64_tr_b16 a[74:75], v20 offset:2048
  v_mfma_f32_16x16x32_bf16 v[88:91], a[88:91], a[4:7], v[88:91]
  buffer_load_dwordx4 v6, s[8:11], s26 offen offset:2048 lds
  v_mfma_f32_16x16x32_bf16 v[88:91], a[120:123], a[20:23], v[88:91]
  ds_read_b64_tr_b16 a[104:105], v20 offset:4096
  ds_read_b64_tr_b16 a[106:107], v20 offset:6144
  v_mfma_f32_16x16x32_bf16 v[120:123], a[88:91], a[8:11], v[120:123]
  ds_read_b64_tr_b16 a[76:77], v21 offset:0
  ds_read_b64_tr_b16 a[78:79], v21 offset:2048
  v_mfma_f32_16x16x32_bf16 v[120:123], a[120:123], a[24:27], v[120:123]
  buffer_load_dwordx4 v7, s[8:11], s26 offen offset:3072 lds
  v_mfma_f32_16x16x32_bf16 v[152:155], a[88:91], a[12:15], v[152:155]
  s_add_u32 m0, s88, 4096
  ds_read_b64_tr_b16 a[108:109], v21 offset:4096
  ds_read_b64_tr_b16 a[110:111], v21 offset:6144
  v_mfma_f32_16x16x32_bf16 v[152:155], a[120:123], a[28:31], v[152:155]
  v_mfma_f32_16x16x32_bf16 v[60:63], a[92:95], a[0:3], v[60:63]
  buffer_load_dwordx4 v4, s[8:11], s27 offen offset:0 lds
  v_mfma_f32_16x16x32_bf16 v[60:63], a[124:127], a[16:19], v[60:63]
  v_mfma_f32_16x16x32_bf16 v[92:95], a[92:95], a[4:7], v[92:95]
  v_mfma_f32_16x16x32_bf16 v[92:95], a[124:127], a[20:23], v[92:95]
  buffer_load_dwordx4 v5, s[8:11], s27 offen offset:1024 lds
  v_mfma_f32_16x16x32_bf16 v[124:127], a[92:95], a[8:11], v[124:127]
  v_mfma_f32_16x16x32_bf16 v[124:127], a[124:127], a[24:27], v[124:127]
  v_mfma_f32_16x16x32_bf16 v[156:159], a[92:95], a[12:15], v[156:159]
  v_mfma_f32_16x16x32_bf16 v[156:159], a[124:127], a[28:31], v[156:159]
  s_waitcnt lgkmcnt(0)
  v_mfma_f32_16x16x32_bf16 v[32:35], a[64:67], a[32:35], v[32:35]
  buffer_load_dwordx4 v6, s[8:11], s27 offen offset:2048 lds
  v_mfma_f32_16x16x32_bf16 v[32:35], a[96:99], a[48:51], v[32:35]
  s_add_u32 s88, s88, s90
  ds_read_b64_tr_b16 a[80:81], v18 offset:8192
  ds_read_b64_tr_b16 a[82:83], v18 offset:10240
  v_mfma_f32_16x16x32_bf16 v[64:67], a[64:67], a[36:39], v[64:67]
  buffer_load_dwordx4 v7, s[8:11], s27 offen offset:3072 lds
  v_mfma_f32_16x16x32_bf16 v[64:67], a[96:99], a[52:55], v[64:67]
  s_bfe_u32 s29, 0x302010e, s53
  s_add_u32 s52, s52, s29
  s_add_u32 s53, s53, 8
  v_mfma_f32_16x16x32_bf16 v[96:99], a[64:67], a[40:43], v[96:99]
  s_and_b32 s53, s53, 0x8001f
  s_and_b32 s52, s52, 15
  s_lshl_b32 s29, s52, 7
  v_mfma_f32_16x16x32_bf16 v[96:99], a[96:99], a[56:59], v[96:99]
  s_or_b32 s26, s30, s29
  s_or_b32 s27, s31, s29
  s_add_u32 s60, s63, 0
  v_mfma_f32_16x16x32_bf16 v[128:131], a[64:67], a[44:47], v[128:131]
  buffer_store_dwordx4 v[160:163], v2, s[16:19], s60 offen offset:0 sc1
  v_mfma_f32_16x16x32_bf16 v[128:131], a[96:99], a[60:63], v[128:131]
  buffer_store_dwordx4 v[164:167], v2, s[16:19], s60 offen offset:1024 sc1
  v_mfma_f32_16x16x32_bf16 v[36:39], a[68:71], a[32:35], v[36:39]
  s_add_u32 s89, s89, 1
  ds_read_b64_tr_b16 a[112:113], v18 offset:12288
  ds_read_b64_tr_b16 a[114:115], v18 offset:14336
  v_mfma_f32_16x16x32_bf16 v[36:39], a[100:103], a[48:51], v[36:39]
  ds_read_b64_tr_b16 a[84:85], v19 offset:8192
  ds_read_b64_tr_b16 a[86:87], v19 offset:10240
  v_mfma_f32_16x16x32_bf16 v[68:71], a[68:71], a[36:39], v[68:71]
  buffer_store_dwordx4 v[168:171], v2, s[16:19], s60 offen offset:2048 sc1
  v_mfma_f32_16x16x32_bf16 v[68:71], a[100:103], a[52:55], v[68:71]
  ds_read_b64_tr_b16 a[116:117], v19 offset:12288
  ds_read_b64_tr_b16 a[118:119], v19 offset:14336
  v_mfma_f32_16x16x32_bf16 v[100:103], a[68:71], a[40:43], v[100:103]
  buffer_store_dwordx4 v[172:175], v2, s[16:19], s60 offen offset:3072 sc1
  v_mfma_f32_16x16x32_bf16 v[100:103], a[100:103], a[56:59], v[100:103]
  s_add_u32 s60, s63, 4096
  ds_read_b64_tr_b16 a[88:89], v20 offset:8192
  ds_read_b64_tr_b16 a[90:91], v20 offset:10240
  v_mfma_f32_16x16x32_bf16 v[132:135], a[68:71], a[44:47], v[132:135]
  ds_read_b64_tr_b16 a[120:121], v20 offset:12288
  v_mfma_f32_16x16x32_bf16 v[132:135], a[100:103], a[60:63], v[132:135]
  buffer_store_dwordx4 v[176:179], v2, s[16:19], s60 offen offset:0 sc1
  v_mfma_f32_16x16x32_bf16 v[40:43], a[72:75], a[32:35], v[40:43]
  ds_read_b64_tr_b16 a[122:123], v20 offset:14336
  ds_read_b64_tr_b16 a[92:93], v21 offset:8192
  v_mfma_f32_16x16x32_bf16 v[40:43], a[104:107], a[48:51], v[40:43]
  buffer_store_dwordx4 v[180:183], v2, s[16:19], s60 offen offset:1024 sc1
  v_mfma_f32_16x16x32_bf16 v[72:75], a[72:75], a[36:39], v[72:75]
  ds_read_b64_tr_b16 a[94:95], v21 offset:10240
  v_mfma_f32_16x16x32_bf16 v[72:75], a[104:107], a[52:55], v[72:75]
  ds_read_b64_tr_b16 a[124:125], v21 offset:12288
  v_mfma_f32_16x16x32_bf16 v[104:107], a[72:75], a[40:43], v[104:107]
  buffer_store_dwordx4 v[184:187], v2, s[16:19], s60 offen offset:2048 sc1
  v_mfma_f32_16x16x32_bf16 v[104:107], a[104:107], a[56:59], v[104:107]
  ds_read_b64_tr_b16 a[126:127], v21 offset:14336
  v_mfma_f32_16x16x32_bf16 v[136:139], a[72:75], a[44:47], v[136:139]
  buffer_store_dwordx4 v[188:191], v2, s[16:19], s60 offen offset:3072 sc1
  v_mfma_f32_16x16x32_bf16 v[136:139], a[104:107], a[60:63], v[136:139]
  s_cmp_eq_u32 s89, 3
  s_cselect_b32 s89, 0, s89
  s_cselect_b32 s90, s91, s92
  v_mfma_f32_16x16x32_bf16 v[44:47], a[76:79], a[32:35], v[44:47]
  s_add_u32 s68, s68, s70
  v_mfma_f32_16x16x32_bf16 v[44:47], a[108:111], a[48:51], v[44:47]
  s_add_u32 s69, s69, 1
  v_mfma_f32_16x16x32_bf16 v[76:79], a[76:79], a[36:39], v[76:79]
  s_cmp_eq_u32 s69, 3
  s_cselect_b32 s69, 0, s69
  s_cselect_b32 s70, s71, s72
  v_mfma_f32_16x16x32_bf16 v[76:79], a[108:111], a[52:55], v[76:79]
  v_add_u32 v16, s90, v16
  v_add_u32 v17, s90, v17
  v_mfma_f32_16x16x32_bf16 v[108:111], a[76:79], a[40:43], v[108:111]
  v_add_u32 v18, s70, v18
  v_add_u32 v19, s70, v19
  v_mfma_f32_16x16x32_bf16 v[108:111], a[108:111], a[56:59], v[108:111]
  v_add_u32 v20, s70, v20
  v_add_u32 v21, s70, v21
  v_mfma_f32_16x16x32_bf16 v[140:143], a[76:79], a[44:47], v[140:143]
  v_mfma_f32_16x16x32_bf16 v[140:143], a[108:111], a[60:63], v[140:143]
  s_waitcnt vmcnt(20) lgkmcnt(0)
  s_barrier
  v_mfma_f32_16x16x32_bf16 v[48:51], a[80:83], a[32:35], v[48:51]
  s_mov_b32 m0, s68
  ds_read_b128 a[0:3], v16 offset:0
  ds_read_b128 a[16:19], v17 offset:0
  v_mfma_f32_16x16x32_bf16 v[48:51], a[112:115], a[48:51], v[48:51]
  buffer_load_dwordx4 v8, s[20:23], s28 offen offset:0 lds
  v_mfma_f32_16x16x32_bf16 v[80:83], a[80:83], a[36:39], v[80:83]
  ds_read_b64_tr_b16 a[64:65], v18 offset:0
  ds_read_b64_tr_b16 a[66:67], v18 offset:2048
  v_mfma_f32_16x16x32_bf16 v[80:83], a[112:115], a[52:55], v[80:83]
  ds_read_b64_tr_b16 a[96:97], v18 offset:4096
  v_mfma_f32_16x16x32_bf16 v[112:115], a[80:83], a[40:43], v[112:115]
  ds_read_b64_tr_b16 a[98:99], v18 offset:6144
  v_mfma_f32_16x16x32_bf16 v[112:115], a[112:115], a[56:59], v[112:115]
  buffer_load_dwordx4 v9, s[20:23], s28 offen offset:1024 lds
  v_mfma_f32_16x16x32_bf16 v[144:147], a[80:83], a[44:47], v[144:147]
  ds_read_b128 a[4:7], v16 offset:2048
  ds_read_b128 a[20:23], v17 offset:2048
  v_mfma_f32_16x16x32_bf16 v[144:147], a[112:115], a[60:63], v[144:147]
  ds_read_b128 a[8:11], v16 offset:4096
  v_mfma_f32_16x16x32_bf16 v[52:55], a[84:87], a[32:35], v[52:55]
  ds_read_b128 a[24:27], v17 offset:4096
  v_mfma_f32_16x16x32_bf16 v[52:55], a[116:119], a[48:51], v[52:55]
  ds_read_b128 a[12:15], v16 offset:6144
  v_mfma_f32_16x16x32_bf16 v[84:87], a[84:87], a[36:39], v[84:87]
  buffer_load_dwordx4 v10, s[20:23], s28 offen offset:2048 lds
  v_mfma_f32_16x16x32_bf16 v[84:87], a[116:119], a[52:55], v[84:87]
  ds_read_b128 a[28:31], v17 offset:6144
  ds_read_b64_tr_b16 a[68:69], v19 offset:0
  v_mfma_f32_16x16x32_bf16 v[116:119], a[84:87], a[40:43], v[116:119]
  ds_read_b64_tr_b16 a[70:71], v19 offset:2048
  ds_read_b64_tr_b16 a[100:101], v19 offset:4096
  v_mfma_f32_16x16x32_bf16 v[116:119], a[116:119], a[56:59], v[116:119]
  ds_read_b64_tr_b16 a[102:103], v19 offset:6144
  v_mfma_f32_16x16x32_bf16 v[148:151], a[84:87], a[44:47], v[148:151]
  ds_read_b64_tr_b16 a[72:73], v20 offset:0
  v_mfma_f32_16x16x32_bf16 v[148:151], a[116:119], a[60:63], v[148:151]
  buffer_load_dwordx4 v11, s[20:23], s28 offen offset:3072 lds
  v_mfma_f32_16x16x32_bf16 v[56:59], a[88:91], a[32:35], v[56:59]
  s_bfe_u32 s56, 0x302010e, s55
  s_add_u32 s54, s54, s56
  s_add_u32 s55, s55, 8
  v_mfma_f32_16x16x32_bf16 v[56:59], a[120:123], a[48:51], v[56:59]
  s_and_b32 s55, s55, 0x8001f
  s_and_b32 s54, s54, 15
  s_lshl_b32 s28, s54, 19
  v_mfma_f32_16x16x32_bf16 v[88:91], a[88:91], a[36:39], v[88:91]
  s_mov_b32 m0, s88
  ds_read_b64_tr_b16 a[74:75], v20 offset:2048
  ds_read_b64_tr_b16 a[104:105], v20 offset:4096
  v_mfma_f32_16x16x32_bf16 v[88:91], a[120:123], a[52:55], v[88:91]
  ds_read_b64_tr_b16 a[106:107], v20 offset:6144
  ds_read_b64_tr_b16 a[76:77], v21 offset:0
  v_mfma_f32_16x16x32_bf16 v[120:123], a[88:91], a[40:43], v[120:123]
  buffer_load_dwordx4 v4, s[8:11], s26 offen offset:0 lds
  v_mfma_f32_16x16x32_bf16 v[120:123], a[120:123], a[56:59], v[120:123]
  ds_read_b64_tr_b16 a[78:79], v21 offset:2048
  ds_read_b64_tr_b16 a[108:109], v21 offset:4096
  v_mfma_f32_16x16x32_bf16 v[152:155], a[88:91], a[44:47], v[152:155]
  ds_read_b64_tr_b16 a[110:111], v21 offset:6144
  v_mfma_f32_16x16x32_bf16 v[152:155], a[120:123], a[60:63], v[152:155]
  v_mfma_f32_16x16x32_bf16 v[60:63], a[92:95], a[32:35], v[60:63]
  v_mfma_f32_16x16x32_bf16 v[60:63], a[124:127], a[48:51], v[60:63]
  buffer_load_dwordx4 v5, s[8:11], s26 offen offset:1024 lds
  v_mfma_f32_16x16x32_bf16 v[92:95], a[92:95], a[36:39], v[92:95]
  v_mfma_f32_16x16x32_bf16 v[92:95], a[124:127], a[52:55], v[92:95]
  v_mfma_f32_16x16x32_bf16 v[124:127], a[92:95], a[40:43], v[124:127]
  v_mfma_f32_16x16x32_bf16 v[124:127], a[124:127], a[56:59], v[124:127]
  v_mfma_f32_16x16x32_bf16 v[156:159], a[92:95], a[44:47], v[156:159]
  v_mfma_f32_16x16x32_bf16 v[156:159], a[124:127], a[60:63], v[156:159]
  s_waitcnt lgkmcnt(0)
  v_mfma_f32_16x16x32_bf16 v[32:35], a[64:67], a[0:3], v[32:35]
  buffer_load_dwordx4 v6, s[8:11], s26 offen offset:2048 lds
  v_mfma_f32_16x16x32_bf16 v[32:35], a[96:99], a[16:19], v[32:35]
  ds_read_b64_tr_b16 a[80:81], v18 offset:8192
  ds_read_b64_tr_b16 a[82:83], v18 offset:10240
  v_mfma_f32_16x16x32_bf16 v[64:67], a[64:67], a[4:7], v[64:67]
  ds_read_b64_tr_b16 a[112:113], v18 offset:12288
  v_mfma_f32_16x16x32_bf16 v[64:67], a[96:99], a[20:23], v[64:67]
  v_mfma_f32_16x16x32_bf16 v[96:99], a[64:67], a[8:11], v[96:99]
  buffer_load_dwordx4 v7, s[8:11], s26 offen offset:3072 lds
  v_mfma_f32_16x16x32_bf16 v[96:99], a[96:99], a[24:27], v[96:99]
  s_add_u32 m0, s88, 4096
  ds_read_b64_tr_b16 a[114:115], v18 offset:14336
  ds_read_b64_tr_b16 a[84:85], v19 offset:8192
  v_mfma_f32_16x16x32_bf16 v[128:131], a[64:67], a[12:15], v[128:131]
  s_add_u32 s88, s88, s90
  ds_read_b64_tr_b16 a[86:87], v19 offset:10240
  v_mfma_f32_16x16x32_bf16 v[128:131], a[96:99], a[28:31], v[128:131]
  s_add_u32 s89, s89, 1
  v_mfma_f32_16x16x32_bf16 v[36:39], a[68:71], a[0:3], v[36:39]
  buffer_load_dwordx4 v4, s[8:11], s27 offen offset:0 lds
  v_mfma_f32_16x16x32_bf16 v[36:39], a[100:103], a[16:19], v[36:39]
  ds_read_b64_tr_b16 a[116:117], v19 offset:12288
  ds_read_b64_tr_b16 a[118:119], v19 offset:14336
  v_mfma_f32_16x16x32_bf16 v[68:71], a[68:71], a[4:7], v[68:71]
  s_cmp_eq_u32 s89, 3
  s_cselect_b32 s89, 0, s89
  s_cselect_b32 s90, s91, s92
  v_mfma_f32_16x16x32_bf16 v[68:71], a[100:103], a[20:23], v[68:71]
  s_add_u32 s68, s68, s70
  ds_read_b64_tr_b16 a[88:89], v20 offset:8192
  v_mfma_f32_16x16x32_bf16 v[100:103], a[68:71], a[8:11], v[100:103]
  buffer_load_dwordx4 v5, s[8:11], s27 offen offset:1024 lds
  v_mfma_f32_16x16x32_bf16 v[100:103], a[100:103], a[24:27], v[100:103]
  s_add_u32 s69, s69, 1
  ds_read_b64_tr_b16 a[90:91], v20 offset:10240
  ds_read_b64_tr_b16 a[120:121], v20 offset:12288
  v_mfma_f32_16x16x32_bf16 v[132:135], a[68:71], a[12:15], v[132:135]
  s_cmp_eq_u32 s69, 3
  s_cselect_b32 s69, 0, s69
  s_cselect_b32 s70, s71, s72
  v_mfma_f32_16x16x32_bf16 v[132:135], a[100:103], a[28:31], v[132:135]
  ds_read_b64_tr_b16 a[122:123], v20 offset:14336
  v_mfma_f32_16x16x32_bf16 v[40:43], a[72:75], a[0:3], v[40:43]
  buffer_load_dwordx4 v6, s[8:11], s27 offen offset:2048 lds
  v_mfma_f32_16x16x32_bf16 v[40:43], a[104:107], a[16:19], v[40:43]
  ds_read_b64_tr_b16 a[92:93], v21 offset:8192
  ds_read_b64_tr_b16 a[94:95], v21 offset:10240
  v_mfma_f32_16x16x32_bf16 v[72:75], a[72:75], a[4:7], v[72:75]
  v_mfma_f32_16x16x32_bf16 v[72:75], a[104:107], a[20:23], v[72:75]
  ds_read_b64_tr_b16 a[124:125], v21 offset:12288
  v_mfma_f32_16x16x32_bf16 v[104:107], a[72:75], a[8:11], v[104:107]
  buffer_load_dwordx4 v7, s[8:11], s27 offen offset:3072 lds
  v_mfma_f32_16x16x32_bf16 v[104:107], a[104:107], a[24:27], v[104:107]
  s_bfe_u32 s29, 0x302010e, s53
  ds_read_b64_tr_b16 a[126:127], v21 offset:14336
  v_mfma_f32_16x16x32_bf16 v[136:139], a[72:75], a[12:15], v[136:139]
  s_add_u32 s52, s52, s29
  v_add_u32 v16, s90, v16
  v_add_u32 v17, s90, v17
  v_mfma_f32_16x16x32_bf16 v[136:139], a[104:107], a[28:31], v[136:139]
  s_add_u32 s53, s53, 8
  v_add_u32 v18, s70, v18
  v_add_u32 v19, s70, v19
  v_mfma_f32_16x16x32_bf16 v[44:47], a[76:79], a[0:3], v[44:47]
  s_and_b32 s53, s53, 0x8001f
  v_add_u32 v20, s70, v20
  v_add_u32 v21, s70, v21
  v_mfma_f32_16x16x32_bf16 v[44:47], a[108:111], a[16:19], v[44:47]
  s_and_b32 s52, s52, 15
  v_mfma_f32_16x16x32_bf16 v[76:79], a[76:79], a[4:7], v[76:79]
  s_lshl_b32 s29, s52, 7
  v_mfma_f32_16x16x32_bf16 v[76:79], a[108:111], a[20:23], v[76:79]
  s_or_b32 s26, s30, s29
  v_mfma_f32_16x16x32_bf16 v[108:111], a[76:79], a[8:11], v[108:111]
  s_or_b32 s27, s31, s29
  v_mfma_f32_16x16x32_bf16 v[108:111], a[108:111], a[24:27], v[108:111]
  v_mfma_f32_16x16x32_bf16 v[140:143], a[76:79], a[12:15], v[140:143]
  v_mfma_f32_16x16x32_bf16 v[140:143], a[108:111], a[28:31], v[140:143]
  s_waitcnt vmcnt(12) lgkmcnt(0)
  s_barrier
  s_mov_b32 s5, 0x40000
Ltg_3:
  v_readfirstlane_b32 s94, v22
  v_readfirstlane_b32 s95, v23
  s_nop 0
  s_cmp_lg_u32 s95, 0
  s_cbranch_scc1 Lpolld_4
  s_sleep 4
  s_mov_b32 s12, s84
  s_mov_b32 s13, s85
  s_mov_b32 s14, 256
  s_mov_b32 s15, 0x00020000
  buffer_load_dwordx2 v[22:23], off, s[12:15], 0 sc1
  s_sub_u32 s5, s5, 1
  s_waitcnt vmcnt(0)
  s_cbranch_scc0 Ltg_3
Lpolld_4:
  v_mov_b32 v3, 0x40000000
  v_mov_b32 v22, s94
  v_cmp_eq_u32 vcc, 0, v0
  v_mov_b32 v23, s95
  s_nop 0
  v_cndmask_b32_e64 v3, v3, 0, vcc
  buffer_store_dwordx2 v[22:23], v3, s[96:99], s34 offen sc1
  v_mfma_f32_16x16x32_bf16 v[48:51], a[80:83], a[0:3], v[48:51]
  s_mov_b32 m0, s68
  ds_read_b128 a[32:35], v16 offset:0
  ds_read_b128 a[48:51], v17 offset:0
  v_mfma_f32_16x16x32_bf16 v[48:51], a[112:115], a[16:19], v[48:51]
  buffer_load_dwordx4 v8, s[20:23], s28 offen offset:0 lds
  v_mfma_f32_16x16x32_bf16 v[80:83], a[80:83], a[4:7], v[80:83]
  ds_read_b64_tr_b16 a[64:65], v18 offset:0
  ds_read_b64_tr_b16 a[66:67], v18 offset:2048
  v_mfma_f32_16x16x32_bf16 v[80:83], a[112:115], a[20:23], v[80:83]
  ds_read_b64_tr_b16 a[96:97], v18 offset:4096
  v_mfma_f32_16x16x32_bf16 v[112:115], a[80:83], a[8:11], v[112:115]
  ds_read_b64_tr_b16 a[98:99], v18 offset:6144
  v_mfma_f32_16x16x32_bf16 v[112:115], a[112:115], a[24:27], v[112:115]
  buffer_load_dwordx4 v9, s[20:23], s28 offen offset:1024 lds
  v_mfma_f32_16x16x32_bf16 v[144:147], a[80:83], a[12:15], v[144:147]
  ds_read_b128 a[36:39], v16 offset:2048
  ds_read_b128 a[52:55], v17 offset:2048
  v_mfma_f32_16x16x32_bf16 v[144:147], a[112:115], a[28:31], v[144:147]
  ds_read_b128 a[40:43], v16 offset:4096
  v_mfma_f32_16x16x32_bf16 v[52:55], a[84:87], a[0:3], v[52:55]
  ds_read_b128 a[56:59], v17 offset:4096
  v_mfma_f32_16x16x32_bf16 v[52:55], a[116:119], a[16:19], v[52:55]
  ds_read_b128 a[44:47], v16 offset:6144
  v_mfma_f32_16x16x32_bf16 v[84:87], a[84:87], a[4:7], v[84:87]
  buffer_load_dwordx4 v10, s[20:23], s28 offen offset:2048 lds
  v_mfma_f32_16x16x32_bf16 v[84:87], a[116:119], a[20:23], v[84:87]
  ds_read_b128 a[60:63], v17 offset:6144
  ds_read_b64_tr_b16 a[68:69], v19 offset:0
  v_mfma_f32_16x16x32_bf16 v[116:119], a[84:87], a[8:11], v[116:119]
  ds_read_b64_tr_b16 a[70:71], v19 offset:2048
  ds_read_b64_tr_b16 a[100:101], v19 offset:4096
  v_mfma_f32_16x16x32_bf16 v[116:119], a[116:119], a[24:27], v[116:119]
  ds_read_b64_tr_b16 a[102:103], v19 offset:6144
  v_mfma_f32_16x16x32_bf16 v[148:151], a[84:87], a[12:15], v[148:151]
  ds_read_b64_tr_b16 a[72:73], v20 offset:0
  v_mfma_f32_16x16x32_bf16 v[148:151], a[116:119], a[28:31], v[148:151]
  buffer_load_dwordx4 v11, s[20:23], s28 offen offset:3072 lds
  v_mfma_f32_16x16x32_bf16 v[56:59], a[88:91], a[0:3], v[56:59]
  s_bfe_u32 s56, 0x302010e, s55
  s_add_u32 s54, s54, s56
  s_add_u32 s55, s55, 8
  v_mfma_f32_16x16x32_bf16 v[56:59], a[120:123], a[16:19], v[56:59]
  s_and_b32 s55, s55, 0x8001f
  s_and_b32 s54, s54, 15
  s_lshl_b32 s28, s54, 19
  v_mfma_f32_16x16x32_bf16 v[88:91], a[88:91], a[4:7], v[88:91]
  s_mov_b32 m0, s88
  ds_read_b64_tr_b16 a[74:75], v20 offset:2048
  ds_read_b64_tr_b16 a[104:105], v20 offset:4096
  v_mfma_f32_16x16x32_bf16 v[88:91], a[120:123], a[20:23], v[88:91]
  ds_read_b64_tr_b16 a[106:107], v20 offset:6144
  ds_read_b64_tr_b16 a[76:77], v21 offset:0
  v_mfma_f32_16x16x32_bf16 v[120:123], a[88:91], a[8:11], v[120:123]
  buffer_load_dwordx4 v4, s[8:11], s26 offen offset:0 lds
  v_mfma_f32_16x16x32_bf16 v[120:123], a[120:123], a[24:27], v[120:123]
  ds_read_b64_tr_b16 a[78:79], v21 offset:2048
  ds_read_b64_tr_b16 a[108:109], v21 offset:4096
  v_mfma_f32_16x16x32_bf16 v[152:155], a[88:91], a[12:15], v[152:155]
  ds_read_b64_tr_b16 a[110:111], v21 offset:6144
  v_mfma_f32_16x16x32_bf16 v[152:155], a[120:123], a[28:31], v[152:155]
  v_mfma_f32_16x16x32_bf16 v[60:63], a[92:95], a[0:3], v[60:63]
  v_mfma_f32_16x16x32_bf16 v[60:63], a[124:127], a[16:19], v[60:63]
  buffer_load_dwordx4 v5, s[8:11], s26 offen offset:1024 lds
  v_mfma_f32_16x16x32_bf16 v[92:95], a[92:95], a[4:7], v[92:95]
  v_mfma_f32_16x16x32_bf16 v[92:95], a[124:127], a[20:23], v[92:95]
  v_mfma_f32_16x16x32_bf16 v[124:127], a[92:95], a[8:11], v[124:127]
  v_mfma_f32_16x16x32_bf16 v[124:127], a[124:127], a[24:27], v[124:127]
  v_mfma_f32_16x16x32_bf16 v[156:159], a[92:95], a[12:15], v[156:159]
  v_mfma_f32_16x16x32_bf16 v[156:159], a[124:127], a[28:31], v[156:159]
  s_waitcnt lgkmcnt(0)
  v_mfma_f32_16x16x32_bf16 v[32:35], a[64:67], a[32:35], v[32:35]
  buffer_load_dwordx4 v6, s[8:11], s26 offen offset:2048 lds
  v_mfma_f32_16x16x32_bf16 v[32:35], a[96:99], a[48:51], v[32:35]
  ds_read_b64_tr_b16 a[80:81], v18 offset:8192
  ds_read_b64_tr_b16 a[82:83], v18 offset:10240
  v_mfma_f32_16x16x32_bf16 v[64:67], a[64:67], a[36:39], v[64:67]
  ds_read_b64_tr_b16 a[112:113], v18 offset:12288
  v_mfma_f32_16x16x32_bf16 v[64:67], a[96:99], a[52:55], v[64:67]
  v_mfma_f32_16x16x32_bf16 v[96:99], a[64:67], a[40:43], v[96:99]
  buffer_load_dwordx4 v7, s[8:11], s26 offen offset:3072 lds
  v_mfma_f32_16x16x32_bf16 v[96:99], a[96:99], a[56:59], v[96:99]
  s_add_u32 m0, s88, 4096
  ds_read_b64_tr_b16 a[114:115], v18 offset:14336
  ds_read_b64_tr_b16 a[84:85], v19 offset:8192
  v_mfma_f32_16x16x32_bf16 v[128:131], a[64:67], a[44:47], v[128:131]
  s_add_u32 s88, s88, s90
  ds_read_b64_tr_b16 a[86:87], v19 offset:10240
  v_mfma_f32_16x16x32_bf16 v[128:131], a[96:99], a[60:63], v[128:131]
  s_add_u32 s89, s89, 1
  v_mfma_f32_16x16x32_bf16 v[36:39], a[68:71], a[32:35], v[36:39]
  buffer_load_dwordx4 v4, s[8:11], s27 offen offset:0 lds
  v_mfma_f32_16x16x32_bf16 v[36:39], a[100:103], a[48:51], v[36:39]
  ds_read_b64_tr_b16 a[116:117], v19 offset:12288
  ds_read_b64_tr_b16 a[118:119], v19 offset:14336
  v_mfma_f32_16x16x32_bf16 v[68:71], a[68:71], a[36:39], v[68:71]
  s_cmp_eq_u32 s89, 3
  s_cselect_b32 s89, 0, s89
  s_cselect_b32 s90, s91, s92
  v_mfma_f32_16x16x32_bf16 v[68:71], a[100:103], a[52:55], v[68:71]
  s_add_u32 s68, s68, s70
  ds_read_b64_tr_b16 a[88:89], v20 offset:8192
  v_mfma_f32_16x16x32_bf16 v[100:103], a[68:71], a[40:43], v[100:103]
  buffer_load_dwordx4 v5, s[8:11], s27 offen offset:1024 lds
  v_mfma_f32_16x16x32_bf16 v[100:103], a[100:103], a[56:59], v[100:103]
  s_add_u32 s69, s69, 1
  ds_read_b64_tr_b16 a[90:91], v20 offset:10240
  ds_read_b64_tr_b16 a[120:121], v20 offset:12288
  v_mfma_f32_16x16x32_bf16 v[132:135], a[68:71], a[44:47], v[132:135]
  s_cmp_eq_u32 s69, 3
  s_cselect_b32 s69, 0, s69
  s_cselect_b32 s70, s71, s72
  v_mfma_f32_16x16x32_bf16 v[132:135], a[100:103], a[60:63], v[132:135]
  ds_read_b64_tr_b16 a[122:123], v20 offset:14336
  v_mfma_f32_16x16x32_bf16 v[40:43], a[72:75], a[32:35], v[40:43]
  buffer_load_dwordx4 v6, s[8:11], s27 offen offset:2048 lds
  v_mfma_f32_16x16x32_bf16 v[40:43], a[104:107], a[48:51], v[40:43]
  ds_read_b64_tr_b16 a[92:93], v21 offset:8192
  ds_read_b64_tr_b16 a[94:95], v21 offset:10240
  v_mfma_f32_16x16x32_bf16 v[72:75], a[72:75], a[36:39], v[72:75]
  v_mfma_f32_16x16x32_bf16 v[72:75], a[104:107], a[52:55], v[72:75]
  ds_read_b64_tr_b16 a[124:125], v21 offset:12288
  v_mfma_f32_16x16x32_bf16 v[104:107], a[72:75], a[40:43], v[104:107]
  buffer_load_dwordx4 v7, s[8:11], s27 offen offset:3072 lds
  v_mfma_f32_16x16x32_bf16 v[104:107], a[104:107], a[56:59], v[104:107]
  s_bfe_u32 s29, 0x302010e, s53
  ds_read_b64_tr_b16 a[126:127], v21 offset:14336
  v_mfma_f32_16x16x32_bf16 v[136:139], a[72:75], a[44:47], v[136:139]
  s_add_u32 s52, s52, s29
  v_add_u32 v16, s90, v16
  v_add_u32 v17, s90, v17
  v_mfma_f32_16x16x32_bf16 v[136:139], a[104:107], a[60:63], v[136:139]
  s_add_u32 s53, s53, 8
  v_add_u32 v18, s70, v18
  v_add_u32 v19, s70, v19
  v_mfma_f32_16x16x32_bf16 v[44:47], a[76:79], a[32:35], v[44:47]
  s_and_b32 s53, s53, 0x8001f
  v_add_u32 v20, s70, v20
  v_add_u32 v21, s70, v21
  v_mfma_f32_16x16x32_bf16 v[44:47], a[108:111], a[48:51], v[44:47]
  s_and_b32 s52, s52, 15
  v_mfma_f32_16x16x32_bf16 v[76:79], a[76:79], a[36:39], v[76:79]
  s_lshl_b32 s29, s52, 7
  v_mfma_f32_16x16x32_bf16 v[76:79], a[108:111], a[52:55], v[76:79]
  s_or_b32 s26, s30, s29
  v_mfma_f32_16x16x32_bf16 v[108:111], a[76:79], a[40:43], v[108:111]
  s_or_b32 s27, s31, s29
  v_mfma_f32_16x16x32_bf16 v[108:111], a[108:111], a[56:59], v[108:111]
  v_mfma_f32_16x16x32_bf16 v[140:143], a[76:79], a[44:47], v[140:143]
  v_mfma_f32_16x16x32_bf16 v[140:143], a[108:111], a[60:63], v[140:143]
  s_mov_b32 s35, 3
  s_waitcnt vmcnt(12) lgkmcnt(0)
  s_barrier
  .p2align 6
Lp3_loop:
  v_mfma_f32_16x16x32_bf16 v[48:51], a[80:83], a[32:35], v[48:51]
  s_mov_b32 m0, s68
  ds_read_b128 a[0:3], v16 offset:0
  ds_read_b128 a[16:19], v17 offset:0
  v_mfma_f32_16x16x32_bf16 v[48:51], a[112:115], a[48:51], v[48:51]
  buffer_load_dwordx4 v8, s[20:23], s28 offen offset:0 lds
  v_mfma_f32_16x16x32_bf16 v[80:83], a[80:83], a[36:39], v[80:83]
  ds_read_b64_tr_b16 a[64:65], v18 offset:0
  ds_read_b64_tr_b16 a[66:67], v18 offset:2048
  v_mfma_f32_16x16x32_bf16 v[80:83], a[112:115], a[52:55], v[80:83]
  ds_read_b64_tr_b16 a[96:97], v18 offset:4096
  v_mfma_f32_16x16x32_bf16 v[112:115], a[80:83], a[40:43], v[112:115]
  ds_read_b64_tr_b16 a[98:99], v18 offset:6144
  v_mfma_f32_16x16x32_bf16 v[112:115], a[112:115], a[56:59], v[112:115]
  buffer_load_dwordx4 v9, s[20:23], s28 offen offset:1024 lds
  v_mfma_f32_16x16x32_bf16 v[144:147], a[80:83], a[44:47], v[144:147]
  ds_read_b128 a[4:7], v16 offset:2048
  ds_read_b128 a[20:23], v17 offset:2048
  v_mfma_f32_16x16x32_bf16 v[144:147], a[112:115], a[60:63], v[144:147]
  ds_read_b128 a[8:11], v16 offset:4096
  v_mfma_f32_16x16x32_bf16 v[52:55], a[84:87], a[32:35], v[52:55]
  ds_read_b128 a[24:27], v17 offset:4096
  v_mfma_f32_16x16x32_bf16 v[52:55], a[116:119], a[48:51], v[52:55]
  ds_read_b128 a[12:15], v16 offset:6144
  v_mfma_f32_16x16x32_bf16 v[84:87], a[84:87], a[36:39], v[84:87]
  buffer_load_dwordx4 v10, s[20:23], s28 offen offset:2048 lds
  v_mfma_f32_16x16x32_bf16 v[84:87], a[116:119], a[52:55], v[84:87]
  ds_read_b128 a[28:31], v17 offset:6144
  ds_read_b64_tr_b16 a[68:69], v19 offset:0
  v_mfma_f32_16x16x32_bf16 v[116:119], a[84:87], a[40:43], v[116:119]
  ds_read_b64_tr_b16 a[70:71], v19 offset:2048
  ds_read_b64_tr_b16 a[100:101], v19 offset:4096
  v_mfma_f32_16x16x32_bf16 v[116:119], a[116:119], a[56:59], v[116:119]
  ds_read_b64_tr_b16 a[102:103], v19 offset:6144
  v_mfma_f32_16x16x32_bf16 v[148:151], a[84:87], a[44:47], v[148:151]
  ds_read_b64_tr_b16 a[72:73], v20 offset:0
  v_mfma_f32_16x16x32_bf16 v[148:151], a[116:119], a[60:63], v[148:151]
  buffer_load_dwordx4 v11, s[20:23], s28 offen offset:3072 lds
  v_mfma_f32_16x16x32_bf16 v[56:59], a[88:91], a[32:35], v[56:59]
  s_bfe_u32 s56, 0x302010e, s55
  s_add_u32 s54, s54, s56
  s_add_u32 s55, s55, 8
  v_mfma_f32_16x16x32_bf16 v[56:59], a[120:123], a[48:51], v[56:59]
  s_and_b32 s55, s55, 0x8001f
  s_and_b32 s54, s54, 15
  s_lshl_b32 s28, s54, 19
  v_mfma_f32_16x16x32_bf16 v[88:91], a[88:91], a[36:39], v[88:91]
  s_mov_b32 m0, s88
  ds_read_b64_tr_b16 a[74:75], v20 offset:2048
  ds_read_b64_tr_b16 a[104:105], v20 offset:4096
  v_mfma_f32_16x16x32_bf16 v[88:91], a[120:123], a[52:55], v[88:91]
  ds_read_b64_tr_b16 a[106:107], v20 offset:6144
  ds_read_b64_tr_b16 a[76:77], v21 offset:0
  v_mfma_f32_16x16x32_bf16 v[120:123], a[88:91], a[40:43], v[120:123]
  buffer_load_dwordx4 v4, s[8:11], s26 offen offset:0 lds
  v_mfma_f32_16x16x32_bf16 v[120:123], a[120:123], a[56:59], v[120:123]
  ds_read_b64_tr_b16 a[78:79], v21 offset:2048
  ds_read_b64_tr_b16 a[108:109], v21 offset:4096
  v_mfma_f32_16x16x32_bf16 v[152:155], a[88:91], a[44:47], v[152:155]
  ds_read_b64_tr_b16 a[110:111], v21 offset:6144
  v_mfma_f32_16x16x32_bf16 v[152:155], a[120:123], a[60:63], v[152:155]
  v_mfma_f32_16x16x32_bf16 v[60:63], a[92:95], a[32:35], v[60:63]
  v_mfma_f32_16x16x32_bf16 v[60:63], a[124:127], a[48:51], v[60:63]
  buffer_load_dwordx4 v5, s[8:11], s26 offen offset:1024 lds
  v_mfma_f32_16x16x32_bf16 v[92:95], a[92:95], a[36:39], v[92:95]
  v_mfma_f32_16x16x32_bf16 v[92:95], a[124:127], a[52:55], v[92:95]
  v_mfma_f32_16x16x32_bf16 v[124:127], a[92:95], a[40:43], v[124:127]
  v_mfma_f32_16x16x32_bf16 v[124:127], a[124:127], a[56:59], v[124:127]
  v_mfma_f32_16x16x32_bf16 v[156:159], a[92:95], a[44:47], v[156:159]
  v_mfma_f32_16x16x32_bf16 v[156:159], a[124:127], a[60:63], v[156:159]
  s_waitcnt lgkmcnt(0)
  v_mfma_f32_16x16x32_bf16 v[32:35], a[64:67], a[0:3], v[32:35]
  buffer_load_dwordx4 v6, s[8:11], s26 offen offset:2048 lds
  v_mfma_f32_16x16x32_bf16 v[32:35], a[96:99], a[16:19], v[32:35]
  ds_read_b64_tr_b16 a[80:81], v18 offset:8192
  ds_read_b64_tr_b16 a[82:83], v18 offset:10240
  v_mfma_f32_16x16x32_bf16 v[64:67], a[64:67], a[4:7], v[64:67]
  ds_read_b64_tr_b16 a[112:113], v18 offset:12288
  v_mfma_f32_16x16x32_bf16 v[64:67], a[96:99], a[20:23], v[64:67]
  v_mfma_f32_16x16x32_bf16 v[96:99], a[64:67], a[8:11], v[96:99]
  buffer_load_dwordx4 v7, s[8:11], s26 offen offset:3072 lds
  v_mfma_f32_16x16x32_bf16 v[96:99], a[96:99], a[24:27], v[96:99]
  s_add_u32 m0, s88, 4096
  ds_read_b64_tr_b16 a[114:115], v18 offset:14336
  ds_read_b64_tr_b16 a[84:85], v19 offset:8192
  v_mfma_f32_16x16x32_bf16 v[128:131], a[64:67], a[12:15], v[128:131]
  s_add_u32 s88, s88, s90
  ds_read_b64_tr_b16 a[86:87], v19 offset:10240
  v_mfma_f32_16x16x32_bf16 v[128:131], a[96:99], a[28:31], v[128:131]
  s_add_u32 s89, s89, 1
  v_mfma_f32_16x16x32_bf16 v[36:39], a[68:71], a[0:3], v[36:39]
  buffer_load_dwordx4 v4, s[8:11], s27 offen offset:0 lds
  v_mfma_f32_16x16x32_bf16 v[36:39], a[100:103], a[16:19], v[36:39]
  ds_read_b64_tr_b16 a[116:117], v19 offset:12288
  ds_read_b64_tr_b16 a[118:119], v19 offset:14336
  v_mfma_f32_16x16x32_bf16 v[68:71], a[68:71], a[4:7], v[68:71]
  s_cmp_eq_u32 s89, 3
  s_cselect_b32 s89, 0, s89
  s_cselect_b32 s90, s91, s92
  v_mfma_f32_16x16x32_bf16 v[68:71], a[100:103], a[20:23], v[68:71]
  s_add_u32 s68, s68, s70
  ds_read_b64_tr_b16 a[88:89], v20 offset:8192
  v_mfma_f32_16x16x32_bf16 v[100:103], a[68:71], a[8:11], v[100:103]
  buffer_load_dwordx4 v5, s[8:11], s27 offen offset:1024 lds
  v_mfma_f32_16x16x32_bf16 v[100:103], a[100:103], a[24:27], v[100:103]
  s_add_u32 s69, s69, 1
  ds_read_b64_tr_b16 a[90:91], v20 offset:10240
  ds_read_b64_tr_b16 a[120:121], v20 offset:12288
  v_mfma_f32_16x16x32_bf16 v[132:135], a[68:71], a[12:15], v[132:135]
  s_cmp_eq_u32 s69, 3
  s_cselect_b32 s69, 0, s69
  s_cselect_b32 s70, s71, s72
  v_mfma_f32_16x16x32_bf16 v[132:135], a[100:103], a[28:31], v[132:135]
  ds_read_b64_tr_b16 a[122:123], v20 offset:14336
  v_mfma_f32_16x16x32_bf16 v[40:43], a[72:75], a[0:3], v[40:43]
  buffer_load_dwordx4 v6, s[8:11], s27 offen offset:2048 lds
  v_mfma_f32_16x16x32_bf16 v[40:43], a[104:107], a[16:19], v[40:43]
  ds_read_b64_tr_b16 a[92:93], v21 offset:8192
  ds_read_b64_tr_b16 a[94:95], v21 offset:10240
  v_mfma_f32_16x16x32_bf16 v[72:75], a[72:75], a[4:7], v[72:75]
  v_mfma_f32_16x16x32_bf16 v[72:75], a[104:107], a[20:23], v[72:75]
  ds_read_b64_tr_b16 a[124:125], v21 offset:12288
  v_mfma_f32_16x16x32_bf16 v[104:107], a[72:75], a[8:11], v[104:107]
  buffer_load_dwordx4 v7, s[8:11], s27 offen offset:3072 lds
  v_mfma_f32_16x16x32_bf16 v[104:107], a[104:107], a[24:27], v[104:107]
  s_bfe_u32 s29, 0x302010e, s53
  ds_read_b64_tr_b16 a[126:127], v21 offset:14336
  v_mfma_f32_16x16x32_bf16 v[136:139], a[72:75], a[12:15], v[136:139]
  s_add_u32 s52, s52, s29
  v_add_u32 v16, s90, v16
  v_add_u32 v17, s90, v17
  v_mfma_f32_16x16x32_bf16 v[136:139], a[104:107], a[28:31], v[136:139]
  s_add_u32 s53, s53, 8
  v_add_u32 v18, s70, v18
  v_add_u32 v19, s70, v19
  v_mfma_f32_16x16x32_bf16 v[44:47], a[76:79], a[0:3], v[44:47]
  s_and_b32 s53, s53, 0x8001f
  v_add_u32 v20, s70, v20
  v_add_u32 v21, s70, v21
  v_mfma_f32_16x16x32_bf16 v[44:47], a[108:111], a[16:19], v[44:47]
  s_and_b32 s52, s52, 15
  v_mfma_f32_16x16x32_bf16 v[76:79], a[76:79], a[4:7], v[76:79]
  s_lshl_b32 s29, s52, 7
  v_mfma_f32_16x16x32_bf16 v[76:79], a[108:111], a[20:23], v[76:79]
  s_or_b32 s26, s30, s29
  v_mfma_f32_16x16x32_bf16 v[108:111], a[76:79], a[8:11], v[108:111]
  s_or_b32 s27, s31, s29
  v_mfma_f32_16x16x32_bf16 v[108:111], a[108:111], a[24:27], v[108:111]
  v_mfma_f32_16x16x32_bf16 v[140:143], a[76:79], a[12:15], v[140:143]
  v_mfma_f32_16x16x32_bf16 v[140:143], a[108:111], a[28:31], v[140:143]
  s_waitcnt vmcnt(12) lgkmcnt(0)
  s_barrier
  v_mfma_f32_16x16x32_bf16 v[48:51], a[80:83], a[0:3], v[48:51]
  s_mov_b32 m0, s68
  ds_read_b128 a[32:35], v16 offset:0
  ds_read_b128 a[48:51], v17 offset:0
  v_mfma_f32_16x16x32_bf16 v[48:51], a[112:115], a[16:19], v[48:51]
  buffer_load_dwordx4 v8, s[20:23], s28 offen offset:0 lds
  v_mfma_f32_16x16x32_bf16 v[80:83], a[80:83], a[4:7], v[80:83]
  ds_read_b64_tr_b16 a[64:65], v18 offset:0
  ds_read_b64_tr_b16 a[66:67], v18 offset:2048
  v_mfma_f32_16x16x32_bf16 v[80:83], a[112:115], a[20:23], v[80:83]
  ds_read_b64_tr_b16 a[96:97], v18 offset:4096
  v_mfma_f32_16x16x32_bf16 v[112:115], a[80:83], a[8:11], v[112:115]
  ds_read_b64_tr_b16 a[98:99], v18 offset:6144
  v_mfma_f32_16x16x32_bf16 v[112:115], a[112:115], a[24:27], v[112:115]
  buffer_load_dwordx4 v9, s[20:23], s28 offen offset:1024 lds
  v_mfma_f32_16x16x32_bf16 v[144:147], a[80:83], a[12:15], v[144:147]
  ds_read_b128 a[36:39], v16 offset:2048
  ds_read_b128 a[52:55], v17 offset:2048
  v_mfma_f32_16x16x32_bf16 v[144:147], a[112:115], a[28:31], v[144:147]
  ds_read_b128 a[40:43], v16 offset:4096
  v_mfma_f32_16x16x32_bf16 v[52:55], a[84:87], a[0:3], v[52:55]
  ds_read_b128 a[56:59], v17 offset:4096
  v_mfma_f32_16x16x32_bf16 v[52:55], a[116:119], a[16:19], v[52:55]
  ds_read_b128 a[44:47], v16 offset:6144
  v_mfma_f32_16x16x32_bf16 v[84:87], a[84:87], a[4:7], v[84:87]
  buffer_load_dwordx4 v10, s[20:23], s28 offen offset:2048 lds
  v_mfma_f32_16x16x32_bf16 v[84:87], a[116:119], a[20:23], v[84:87]
  ds_read_b128 a[60:63], v17 offset:6144
  ds_read_b64_tr_b16 a[68:69], v19 offset:0
  v_mfma_f32_16x16x32_bf16 v[116:119], a[84:87], a[8:11], v[116:119]
  ds_read_b64_tr_b16 a[70:71], v19 offset:2048
  ds_read_b64_tr_b16 a[100:101], v19 offset:4096
  v_mfma_f32_16x16x32_bf16 v[116:119], a[116:119], a[24:27], v[116:119]
  ds_read_b64_tr_b16 a[102:103], v19 offset:6144
  v_mfma_f32_16x16x32_bf16 v[148:151], a[84:87], a[12:15], v[148:151]
  ds_read_b64_tr_b16 a[72:73], v20 offset:0
  v_mfma_f32_16x16x32_bf16 v[148:151], a[116:119], a[28:31], v[148:151]
  buffer_load_dwordx4 v11, s[20:23], s28 offen offset:3072 lds
  v_mfma_f32_16x16x32_bf16 v[56:59], a[88:91], a[0:3], v[56:59]
  s_bfe_u32 s56, 0x302010e, s55
  s_add_u32 s54, s54, s56
  s_add_u32 s55, s55, 8
  v_mfma_f32_16x16x32_bf16 v[56:59], a[120:123], a[16:19], v[56:59]
  s_and_b32 s55, s55, 0x8001f
  s_and_b32 s54, s54, 15
  s_lshl_b32 s28, s54, 19
  v_mfma_f32_16x16x32_bf16 v[88:91], a[88:91], a[4:7], v[88:91]
  s_mov_b32 m0, s88
  ds_read_b64_tr_b16 a[74:75], v20 offset:2048
  ds_read_b64_tr_b16 a[104:105], v20 offset:4096
  v_mfma_f32_16x16x32_bf16 v[88:91], a[120:123], a[20:23], v[88:91]
  ds_read_b64_tr_b16 a[106:107], v20 offset:6144
  ds_read_b64_tr_b16 a[76:77], v21 offset:0
  v_mfma_f32_16x16x32_bf16 v[120:123], a[88:91], a[8:11], v[120:123]
  buffer_load_dwordx4 v4, s[8:11], s26 offen offset:0 lds
  v_mfma_f32_16x16x32_bf16 v[120:123], a[120:123], a[24:27], v[120:123]
  ds_read_b64_tr_b16 a[78:79], v21 offset:2048
  ds_read_b64_tr_b16 a[108:109], v21 offset:4096
  v_mfma_f32_16x16x32_bf16 v[152:155], a[88:91], a[12:15], v[152:155]
  ds_read_b64_tr_b16 a[110:111], v21 offset:6144
  v_mfma_f32_16x16x32_bf16 v[152:155], a[120:123], a[28:31], v[152:155]
  v_mfma_f32_16x16x32_bf16 v[60:63], a[92:95], a[0:3], v[60:63]
  v_mfma_f32_16x16x32_bf16 v[60:63], a[124:127], a[16:19], v[60:63]
  buffer_load_dwordx4 v5, s[8:11], s26 offen offset:1024 lds
  v_mfma_f32_16x16x32_bf16 v[92:95], a[92:95], a[4:7], v[92:95]
  v_mfma_f32_16x16x32_bf16 v[92:95], a[124:127], a[20:23], v[92:95]
  v_mfma_f32_16x16x32_bf16 v[124:127], a[92:95], a[8:11], v[124:127]
  v_mfma_f32_16x16x32_bf16 v[124:127], a[124:127], a[24:27], v[124:127]
  v_mfma_f32_16x16x32_bf16 v[156:159], a[92:95], a[12:15], v[156:159]
  v_mfma_f32_16x16x32_bf16 v[156:159], a[124:127], a[28:31], v[156:159]
  s_waitcnt lgkmcnt(0)
  v_mfma_f32_16x16x32_bf16 v[32:35], a[64:67], a[32:35], v[32:35]
  buffer_load_dwordx4 v6, s[8:11], s26 offen offset:2048 lds
  v_mfma_f32_16x16x32_bf16 v[32:35], a[96:99], a[48:51], v[32:35]
  ds_read_b64_tr_b16 a[80:81], v18 offset:8192
  ds_read_b64_tr_b16 a[82:83], v18 offset:10240
  v_mfma_f32_16x16x32_bf16 v[64:67], a[64:67], a[36:39], v[64:67]
  ds_read_b64_tr_b16 a[112:113], v18 offset:12288
  v_mfma_f32_16x16x32_bf16 v[64:67], a[96:99], a[52:55], v[64:67]
  v_mfma_f32_16x16x32_bf16 v[96:99], a[64:67], a[40:43], v[96:99]
  buffer_load_dwordx4 v7, s[8:11], s26 offen offset:3072 lds
  v_mfma_f32_16x16x32_bf16 v[96:99], a[96:99], a[56:59], v[96:99]
  s_add_u32 m0, s88, 4096
  ds_read_b64_tr_b16 a[114:115], v18 offset:14336
  ds_read_b64_tr_b16 a[84:85], v19 offset:8192
  v_mfma_f32_16x16x32_bf16 v[128:131], a[64:67], a[44:47], v[128:131]
  s_add_u32 s88, s88, s90
  ds_read_b64_tr_b16 a[86:87], v19 offset:10240
  v_mfma_f32_16x16x32_bf16 v[128:131], a[96:99], a[60:63], v[128:131]
  s_add_u32 s89, s89, 1
  v_mfma_f32_16x16x32_bf16 v[36:39], a[68:71], a[32:35], v[36:39]
  buffer_load_dwordx4 v4, s[8:11], s27 offen offset:0 lds
  v_mfma_f32_16x16x32_bf16 v[36:39], a[100:103], a[48:51], v[36:39]
  ds_read_b64_tr_b16 a[116:117], v19 offset:12288
  ds_read_b64_tr_b16 a[118:119], v19 offset:14336
  v_mfma_f32_16x16x32_bf16 v[68:71], a[68:71], a[36:39], v[68:71]
  s_cmp_eq_u32 s89, 3
  s_cselect_b32 s89, 0, s89
  s_cselect_b32 s90, s91, s92
  v_mfma_f32_16x16x32_bf16 v[68:71], a[100:103], a[52:55], v[68:71]
  s_add_u32 s68, s68, s70
  ds_read_b64_tr_b16 a[88:89], v20 offset:8192
  v_mfma_f32_16x16x32_bf16 v[100:103], a[68:71], a[40:43], v[100:103]
  buffer_load_dwordx4 v5, s[8:11], s27 offen offset:1024 lds
  v_mfma_f32_16x16x32_bf16 v[100:103], a[100:103], a[56:59], v[100:103]
  s_add_u32 s69, s69, 1
  ds_read_b64_tr_b16 a[90:91], v20 offset:10240
  ds_read_b64_tr_b16 a[120:121], v20 offset:12288
  v_mfma_f32_16x16x32_bf16 v[132:135], a[68:71], a[44:47], v[132:135]
  s_cmp_eq_u32 s69, 3
  s_cselect_b32 s69, 0, s69
  s_cselect_b32 s70, s71, s72
  v_mfma_f32_16x16x32_bf16 v[132:135], a[100:103], a[60:63], v[132:135]
  ds_read_b64_tr_b16 a[122:123], v20 offset:14336
  v_mfma_f32_16x16x32_bf16 v[40:43], a[72:75], a[32:35], v[40:43]
  buffer_load_dwordx4 v6, s[8:11], s27 offen offset:2048 lds
  v_mfma_f32_16x16x32_bf16 v[40:43], a[104:107], a[48:51], v[40:43]
  ds_read_b64_tr_b16 a[92:93], v21 offset:8192
  ds_read_b64_tr_b16 a[94:95], v21 offset:10240
  v_mfma_f32_16x16x32_bf16 v[72:75], a[72:75], a[36:39], v[72:75]
  v_mfma_f32_16x16x32_bf16 v[72:75], a[104:107], a[52:55], v[72:75]
  ds_read_b64_tr_b16 a[124:125], v21 offset:12288
  v_mfma_f32_16x16x32_bf16 v[104:107], a[72:75], a[40:43], v[104:107]
  buffer_load_dwordx4 v7, s[8:11], s27 offen offset:3072 lds
  v_mfma_f32_16x16x32_bf16 v[104:107], a[104:107], a[56:59], v[104:107]
  s_bfe_u32 s29, 0x302010e, s53
  ds_read_b64_tr_b16 a[126:127], v21 offset:14336
  v_mfma_f32_16x16x32_bf16 v[136:139], a[72:75], a[44:47], v[136:139]
  s_add_u32 s52, s52, s29
  v_add_u32 v16, s90, v16
  v_add_u32 v17, s90, v17
  v_mfma_f32_16x16x32_bf16 v[136:139], a[104:107], a[60:63], v[136:139]
  s_add_u32 s53, s53, 8
  v_add_u32 v18, s70, v18
  v_add_u32 v19, s70, v19
  v_mfma_f32_16x16x32_bf16 v[44:47], a[76:79], a[32:35], v[44:47]
  s_and_b32 s53, s53, 0x8001f
  v_add_u32 v20, s70, v20
  v_add_u32 v21, s70, v21
  v_mfma_f32_16x16x32_bf16 v[44:47], a[108:111], a[48:51], v[44:47]
  s_and_b32 s52, s52, 15
  v_mfma_f32_16x16x32_bf16 v[76:79], a[76:79], a[36:39], v[76:79]
  s_lshl_b32 s29, s52, 7
  v_mfma_f32_16x16x32_bf16 v[76:79], a[108:111], a[52:55], v[76:79]
  s_or_b32 s26, s30, s29
  v_mfma_f32_16x16x32_bf16 v[108:111], a[76:79], a[40:43], v[108:111]
  s_or_b32 s27, s31, s29
  v_mfma_f32_16x16x32_bf16 v[108:111], a[108:111], a[56:59], v[108:111]
  s_waitcnt vmcnt(12) lgkmcnt(0)
  s_barrier
  v_mfma_f32_16x16x32_bf16 v[140:143], a[76:79], a[44:47], v[140:143]
  s_sub_u32 s35, s35, 1
  v_mfma_f32_16x16x32_bf16 v[140:143], a[108:111], a[60:63], v[140:143]
  s_cmp_lg_u32 s35, 0
  s_cbranch_scc1 Lp3_loop
  s_lshr_b32 s34, s24, 1
  s_lshl_b32 s34, s34, 11
  v_and_b32 v3, 7, v1
  v_lshlrev_b32 v3, 7, v3
  v_mfma_f32_16x16x32_bf16 v[48:51], a[80:83], a[32:35], v[48:51]
  buffer_load_dwordx2 v[22:23], v3, s[96:99], s34 offen sc1
  v_mfma_f32_16x16x32_bf16 v[48:51], a[112:115], a[48:51], v[48:51]
  s_mov_b32 m0, s68
  ds_read_b128 a[0:3], v16 offset:0
  ds_read_b128 a[16:19], v17 offset:0
  v_mfma_f32_16x16x32_bf16 v[80:83], a[80:83], a[36:39], v[80:83]
  ds_read_b64_tr_b16 a[64:65], v18 offset:0
  ds_read_b64_tr_b16 a[66:67], v18 offset:2048
  v_mfma_f32_16x16x32_bf16 v[80:83], a[112:115], a[52:55], v[80:83]
  ds_read_b64_tr_b16 a[96:97], v18 offset:4096
  v_mfma_f32_16x16x32_bf16 v[112:115], a[80:83], a[40:43], v[112:115]
  buffer_load_dwordx4 v8, s[20:23], s28 offen offset:0 lds
  v_mfma_f32_16x16x32_bf16 v[112:115], a[112:115], a[56:59], v[112:115]
  ds_read_b64_tr_b16 a[98:99], v18 offset:6144
  ds_read_b128 a[4:7], v16 offset:2048
  v_mfma_f32_16x16x32_bf16 v[144:147], a[80:83], a[44:47], v[144:147]
  ds_read_b128 a[20:23], v17 offset:2048
  v_mfma_f32_16x16x32_bf16 v[144:147], a[112:115], a[60:63], v[144:147]
  ds_read_b128 a[8:11], v16 offset:4096
  v_mfma_f32_16x16x32_bf16 v[52:55], a[84:87], a[32:35], v[52:55]
  buffer_load_dwordx4 v9, s[20:23], s28 offen offset:1024 lds
  v_mfma_f32_16x16x32_bf16 v[52:55], a[116:119], a[48:51], v[52:55]
  ds_read_b128 a[24:27], v17 offset:4096
  ds_read_b128 a[12:15], v16 offset:6144
  v_mfma_f32_16x16x32_bf16 v[84:87], a[84:87], a[36:39], v[84:87]
  ds_read_b128 a[28:31], v17 offset:6144
  v_mfma_f32_16x16x32_bf16 v[84:87], a[116:119], a[52:55], v[84:87]
  ds_read_b64_tr_b16 a[68:69], v19 offset:0
  ds_read_b64_tr_b16 a[70:71], v19 offset:2048
  v_mfma_f32_16x16x32_bf16 v[116:119], a[84:87], a[40:43], v[116:119]
  ds_read_b64_tr_b16 a[100:101], v19 offset:4096
  v_mfma_f32_16x16x32_bf16 v[116:119], a[116:119], a[56:59], v[116:119]
  buffer_load_dwordx4 v10, s[20:23], s28 offen offset:2048 lds
  v_mfma_f32_16x16x32_bf16 v[148:151], a[84:87], a[44:47], v[148:151]
  ds_read_b64_tr_b16 a[102:103], v19 offset:6144
  ds_read_b64_tr_b16 a[72:73], v20 offset:0
  v_mfma_f32_16x16x32_bf16 v[148:151], a[116:119], a[60:63], v[148:151]
  ds_read_b64_tr_b16 a[74:75], v20 offset:2048
  v_mfma_f32_16x16x32_bf16 v[56:59], a[88:91], a[32:35], v[56:59]
  ds_read_b64_tr_b16 a[104:105], v20 offset:4096
  v_mfma_f32_16x16x32_bf16 v[56:59], a[120:123], a[48:51], v[56:59]
  buffer_load_dwordx4 v11, s[20:23], s28 offen offset:3072 lds
  v_mfma_f32_16x16x32_bf16 v[88:91], a[88:91], a[36:39], v[88:91]
  s_bfe_u32 s56, 0x302010e, s55
  s_add_u32 s54, s54, s56
  s_add_u32 s55, s55, 8
  v_mfma_f32_16x16x32_bf16 v[88:91], a[120:123], a[52:55], v[88:91]
  s_and_b32 s55, s55, 0x8001f
  s_and_b32 s54, s54, 15
  s_lshl_b32 s28, s54, 19
  v_mfma_f32_16x16x32_bf16 v[120:123], a[88:91], a[40:43], v[120:123]
  s_mov_b32 m0, s88
  ds_read_b64_tr_b16 a[106:107], v20 offset:6144
  ds_read_b64_tr_b16 a[76:77], v21 offset:0
  v_mfma_f32_16x16x32_bf16 v[120:123], a[120:123], a[56:59], v[120:123]
  ds_read_b64_tr_b16 a[78:79], v21 offset:2048
  ds_read_b64_tr_b16 a[108:109], v21 offset:4096
  v_mfma_f32_16x16x32_bf16 v[152:155], a[88:91], a[44:47], v[152:155]
  buffer_load_dwordx4 v4, s[8:11], s26 offen offset:0 lds
  v_mfma_f32_16x16x32_bf16 v[152:155], a[120:123], a[60:63], v[152:155]
  ds_read_b64_tr_b16 a[110:111], v21 offset:6144
  v_mfma_f32_16x16x32_bf16 v[60:63], a[92:95], a[32:35], v[60:63]
  v_mfma_f32_16x16x32_bf16 v[60:63], a[124:127], a[48:51], v[60:63]
  v_mfma_f32_16x16x32_bf16 v[92:95], a[92:95], a[36:39], v[92:95]
  buffer_load_dwordx4 v5, s[8:11], s26 offen offset:1024 lds
  v_mfma_f32_16x16x32_bf16 v[92:95], a[124:127], a[52:55], v[92:95]
  v_mfma_f32_16x16x32_bf16 v[124:127], a[92:95], a[40:43], v[124:127]
  v_mfma_f32_16x16x32_bf16 v[124:127], a[124:127], a[56:59], v[124:127]
  v_mfma_f32_16x16x32_bf16 v[156:159], a[92:95], a[44:47], v[156:159]
  v_mfma_f32_16x16x32_bf16 v[156:159], a[124:127], a[60:63], v[156:159]
  s_waitcnt lgkmcnt(0)
  v_mfma_f32_16x16x32_bf16 v[32:35], a[64:67], a[0:3], v[32:35]
  buffer_load_dwordx4 v6, s[8:11], s26 offen offset:2048 lds
  v_mfma_f32_16x16x32_bf16 v[32:35], a[96:99], a[16:19], v[32:35]
  ds_read_b64_tr_b16 a[80:81], v18 offset:8192
  ds_read_b64_tr_b16 a[82:83], v18 offset:10240
  v_mfma_f32_16x16x32_bf16 v[64:67], a[64:67], a[4:7], v[64:67]
  ds_read_b64_tr_b16 a[112:113], v18 offset:12288
  v_mfma_f32_16x16x32_bf16 v[64:67], a[96:99], a[20:23], v[64:67]
  v_mfma_f32_16x16x32_bf16 v[96:99], a[64:67], a[8:11], v[96:99]
  buffer_load_dwordx4 v7, s[8:11], s26 offen offset:3072 lds
  v_mfma_f32_16x16x32_bf16 v[96:99], a[96:99], a[24:27], v[96:99]
  s_add_u32 m0, s88, 4096
  ds_read_b64_tr_b16 a[114:115], v18 offset:14336
  ds_read_b64_tr_b16 a[84:85], v19 offset:8192
  v_mfma_f32_16x16x32_bf16 v[128:131], a[64:67], a[12:15], v[128:131]
  s_add_u32 s88, s88, s90
  ds_read_b64_tr_b16 a[86:87], v19 offset:10240
  v_mfma_f32_16x16x32_bf16 v[128:131], a[96:99], a[28:31], v[128:131]
  s_add_u32 s89, s89, 1
  v_mfma_f32_16x16x32_bf16 v[36:39], a[68:71], a[0:3], v[36:39]
  buffer_load_dwordx4 v4, s[8:11], s27 offen offset:0 lds
  v_mfma_f32_16x16x32_bf16 v[36:39], a[100:103], a[16:19], v[36:39]
  ds_read_b64_tr_b16 a[116:117], v19 offset:12288
  ds_read_b64_tr_b16 a[118:119], v19 offset:14336
  v_mfma_f32_16x16x32_bf16 v[68:71], a[68:71], a[4:7], v[68:71]
  s_cmp_eq_u32 s89, 3
  s_cselect_b32 s89, 0, s89
  s_cselect_b32 s90, s91, s92
  v_mfma_f32_16x16x32_bf16 v[68:71], a[100:103], a[20:23], v[68:71]
  s_add_u32 s68, s68, s70
  ds_read_b64_tr_b16 a[88:89], v20 offset:8192
  v_mfma_f32_16x16x32_bf16 v[100:103], a[68:71], a[8:11], v[100:103]
  buffer_load_dwordx4 v5, s[8:11], s27 offen offset:1024 lds
  v_mfma_f32_16x16x32_bf16 v[100:103], a[100:103], a[24:27], v[100:103]
  s_add_u32 s69, s69, 1
  ds_read_b64_tr_b16 a[90:91], v20 offset:10240
  ds_read_b64_tr_b16 a[120:121], v20 offset:12288
  v_mfma_f32_16x16x32_bf16 v[132:135], a[68:71], a[12:15], v[132:135]
  s_cmp_eq_u32 s69, 3
  s_cselect_b32 s69, 0, s69
  s_cselect_b32 s70, s71, s72
  v_mfma_f32_16x16x32_bf16 v[132:135], a[100:103], a[28:31], v[132:135]
  ds_read_b64_tr_b16 a[122:123], v20 offset:14336
  v_mfma_f32_16x16x32_bf16 v[40:43], a[72:75], a[0:3], v[40:43]
  buffer_load_dwordx4 v6, s[8:11], s27 offen offset:2048 lds
  v_mfma_f32_16x16x32_bf16 v[40:43], a[104:107], a[16:19], v[40:43]
  ds_read_b64_tr_b16 a[92:93], v21 offset:8192
  ds_read_b64_tr_b16 a[94:95], v21 offset:10240
  v_mfma_f32_16x16x32_bf16 v[72:75], a[72:75], a[4:7], v[72:75]
  v_mfma_f32_16x16x32_bf16 v[72:75], a[104:107], a[20:23], v[72:75]
  ds_read_b64_tr_b16 a[124:125], v21 offset:12288
  v_mfma_f32_16x16x32_bf16 v[104:107], a[72:75], a[8:11], v[104:107]
  buffer_load_dwordx4 v7, s[8:11], s27 offen offset:3072 lds
  v_mfma_f32_16x16x32_bf16 v[104:107], a[104:107], a[24:27], v[104:107]
  s_bfe_u32 s29, 0x302010e, s53
  ds_read_b64_tr_b16 a[126:127], v21 offset:14336
  v_mfma_f32_16x16x32_bf16 v[136:139], a[72:75], a[12:15], v[136:139]
  s_add_u32 s52, s52, s29
  v_add_u32 v16, s90, v16
  v_add_u32 v17, s90, v17
  v_mfma_f32_16x16x32_bf16 v[136:139], a[104:107], a[28:31], v[136:139]
  s_add_u32 s53, s53, 8
  v_add_u32 v18, s70, v18
  v_add_u32 v19, s70, v19
  v_mfma_f32_16x16x32_bf16 v[44:47], a[76:79], a[0:3], v[44:47]
  s_and_b32 s53, s53, 0x8001f
  v_add_u32 v20, s70, v20
  v_add_u32 v21, s70, v21
  v_mfma_f32_16x16x32_bf16 v[44:47], a[108:111], a[16:19], v[44:47]
  s_and_b32 s52, s52, 15
  v_mfma_f32_16x16x32_bf16 v[76:79], a[76:79], a[4:7], v[76:79]
  s_lshl_b32 s29, s52, 7
  v_mfma_f32_16x16x32_bf16 v[76:79], a[108:111], a[20:23], v[76:79]
  s_or_b32 s26, s30, s29
  v_mfma_f32_16x16x32_bf16 v[108:111], a[76:79], a[8:11], v[108:111]
  s_or_b32 s27, s31, s29
  v_mfma_f32_16x16x32_bf16 v[108:111], a[108:111], a[24:27], v[108:111]
  v_mfma_f32_16x16x32_bf16 v[140:143], a[76:79], a[12:15], v[140:143]
  v_mfma_f32_16x16x32_bf16 v[140:143], a[108:111], a[28:31], v[140:143]
  s_waitcnt vmcnt(12) lgkmcnt(0)
  s_barrier
  s_mov_b32 s5, 0x40000
Lpoll_5:
  v_cmp_ne_u64 vcc, s[94:95], v[22:23]
  s_nop 0
  s_cbranch_vccz Lpolld_6
  s_sleep 4
  buffer_load_dwordx2 v[22:23], v3, s[96:99], s34 offen sc1
  s_sub_u32 s5, s5, 1
  s_waitcnt vmcnt(0)
  s_cbranch_scc0 Lpoll_5
Lpolld_6:
  s_lshl_b32 s4, s24, 20
  s_and_b32 s5, s25, 1
  s_lshl_b32 s5, s5, 1
  s_add_u32 s5, s5, 14
  s_sub_u32 s5, s5, s25
  s_add_u32 s5, s5, 1
  s_lshl_b32 s5, s5, 16
  s_add_u32 s20, s86, 16777216
  s_addc_u32 s21, s87, 0
  s_add_u32 s20, s20, s4
  s_addc_u32 s21, s21, 0
  s_mov_b32 s22, s5
  s_mov_b32 s23, 0x00020000
  s_lshl_b32 s28, s3, 12
  s_add_u32 s26, s28, 0xc000
  s_add_u32 s27, s28, 0x10000
  s_add_u32 s29, s28, 0x4000
  s_and_b32 s4, s2, 1
  s_lshl_b32 s4, s4, 3
  s_bfe_u32 s5, s2, 0x30003
  s_add_u32 s73, s4, s5
  s_bfe_u32 s4, s2, 0x10001
  s_lshl_b32 s4, s4, 2
  s_lshr_b32 s5, s2, 6
  s_add_u32 s76, s4, s5
  s_bfe_u32 s77, s2, 0x10002
  s_lshl_b32 s78, s73, 3
  s_add_u32 s78, s78, s76
  s_lshl_b32 s79, s3, 12
  v_mfma_f32_16x16x32_bf16 v[48:51], a[80:83], a[0:3], v[48:51]
  s_mov_b32 m0, s26
  ds_read_b128 a[32:35], v16 offset:0
  ds_read_b128 a[48:51], v17 offset:0
  v_mfma_f32_16x16x32_bf16 v[48:51], a[112:115], a[16:19], v[48:51]
  buffer_load_dwordx4 v2, s[20:23], s28 offen offset:0 sc1 lds
  v_mfma_f32_16x16x32_bf16 v[80:83], a[80:83], a[4:7], v[80:83]
  ds_read_b64_tr_b16 a[64:65], v18 offset:0
  ds_read_b64_tr_b16 a[66:67], v18 offset:2048
  v_mfma_f32_16x16x32_bf16 v[80:83], a[112:115], a[20:23], v[80:83]
  ds_read_b64_tr_b16 a[96:97], v18 offset:4096
  v_mfma_f32_16x16x32_bf16 v[112:115], a[80:83], a[8:11], v[112:115]
  ds_read_b64_tr_b16 a[98:99], v18 offset:6144
  v_mfma_f32_16x16x32_bf16 v[112:115], a[112:115], a[24:27], v[112:115]
  ds_read_b128 a[36:39], v16 offset:2048
  v_mfma_f32_16x16x32_bf16 v[144:147], a[80:83], a[12:15], v[144:147]
  ds_read_b128 a[52:55], v17 offset:2048
  v_mfma_f32_16x16x32_bf16 v[144:147], a[112:115], a[28:31], v[144:147]
  ds_read_b128 a[40:43], v16 offset:4096
  v_mfma_f32_16x16x32_bf16 v[52:55], a[84:87], a[0:3], v[52:55]
  ds_read_b128 a[56:59], v17 offset:4096
  v_mfma_f32_16x16x32_bf16 v[52:55], a[116:119], a[16:19], v[52:55]
  ds_read_b128 a[44:47], v16 offset:6144
  v_mfma_f32_16x16x32_bf16 v[84:87], a[84:87], a[4:7], v[84:87]
  ds_read_b128 a[60:63], v17 offset:6144
  v_mfma_f32_16x16x32_bf16 v[84:87], a[116:119], a[20:23], v[84:87]
  ds_read_b64_tr_b16 a[68:69], v19 offset:0
  ds_read_b64_tr_b16 a[70:71], v19 offset:2048
  v_mfma_f32_16x16x32_bf16 v[116:119], a[84:87], a[8:11], v[116:119]
  ds_read_b64_tr_b16 a[100:101], v19 offset:4096
  v_mfma_f32_16x16x32_bf16 v[116:119], a[116:119], a[24:27], v[116:119]
  ds_read_b64_tr_b16 a[102:103], v19 offset:6144
  v_mfma_f32_16x16x32_bf16 v[148:151], a[84:87], a[12:15], v[148:151]
  ds_read_b64_tr_b16 a[72:73], v20 offset:0
  v_mfma_f32_16x16x32_bf16 v[148:151], a[116:119], a[28:31], v[148:151]
  buffer_load_dwordx4 v2, s[20:23], s28 offen offset:1024 sc1 lds
  v_mfma_f32_16x16x32_bf16 v[56:59], a[88:91], a[0:3], v[56:59]
  ds_read_b64_tr_b16 a[74:75], v20 offset:2048
  ds_read_b64_tr_b16 a[104:105], v20 offset:4096
  v_mfma_f32_16x16x32_bf16 v[56:59], a[120:123], a[16:19], v[56:59]
  ds_read_b64_tr_b16 a[106:107], v20 offset:6144
  v_mfma_f32_16x16x32_bf16 v[88:91], a[88:91], a[4:7], v[88:91]
  ds_read_b64_tr_b16 a[76:77], v21 offset:0
  v_mfma_f32_16x16x32_bf16 v[88:91], a[120:123], a[20:23], v[88:91]
  ds_read_b64_tr_b16 a[78:79], v21 offset:2048
  v_mfma_f32_16x16x32_bf16 v[120:123], a[88:91], a[8:11], v[120:123]
  ds_read_b64_tr_b16 a[108:109], v21 offset:4096
  v_mfma_f32_16x16x32_bf16 v[120:123], a[120:123], a[24:27], v[120:123]
  ds_read_b64_tr_b16 a[110:111], v21 offset:6144
  v_mfma_f32_16x16x32_bf16 v[152:155], a[88:91], a[12:15], v[152:155]
  v_mfma_f32_16x16x32_bf16 v[152:155], a[120:123], a[28:31], v[152:155]
  v_mfma_f32_16x16x32_bf16 v[60:63], a[92:95], a[0:3], v[60:63]
  v_mfma_f32_16x16x32_bf16 v[60:63], a[124:127], a[16:19], v[60:63]
  v_mfma_f32_16x16x32_bf16 v[92:95], a[92:95], a[4:7], v[92:95]
  v_mfma_f32_16x16x32_bf16 v[92:95], a[124:127], a[20:23], v[92:95]
  v_mfma_f32_16x16x32_bf16 v[124:127], a[92:95], a[8:11], v[124:127]
  v_mfma_f32_16x16x32_bf16 v[124:127], a[124:127], a[24:27], v[124:127]
  v_mfma_f32_16x16x32_bf16 v[156:159], a[92:95], a[12:15], v[156:159]
  v_mfma_f32_16x16x32_bf16 v[156:159], a[124:127], a[28:31], v[156:159]
  s_waitcnt lgkmcnt(0)
  v_mfma_f32_16x16x32_bf16 v[32:35], a[64:67], a[32:35], v[32:35]
  buffer_load_dwordx4 v2, s[20:23], s28 offen offset:2048 sc1 lds
  v_mfma_f32_16x16x32_bf16 v[32:35], a[96:99], a[48:51], v[32:35]
  s_add_u32 s88, s88, s90
  ds_read_b64_tr_b16 a[80:81], v18 offset:8192
  ds_read_b64_tr_b16 a[82:83], v18 offset:10240
  v_mfma_f32_16x16x32_bf16 v[64:67], a[64:67], a[36:39], v[64:67]
  s_add_u32 s89, s89, 1
  ds_read_b64_tr_b16 a[112:113], v18 offset:12288
  v_mfma_f32_16x16x32_bf16 v[64:67], a[96:99], a[52:55], v[64:67]
  s_cmp_eq_u32 s89, 3
  s_cselect_b32 s89, 0, s89
  s_cselect_b32 s90, s91, s92
  v_mfma_f32_16x16x32_bf16 v[96:99], a[64:67], a[40:43], v[96:99]
  s_add_u32 s68, s68, s70
  ds_read_b64_tr_b16 a[114:115], v18 offset:14336
  v_mfma_f32_16x16x32_bf16 v[96:99], a[96:99], a[56:59], v[96:99]
  s_add_u32 s69, s69, 1
  ds_read_b64_tr_b16 a[84:85], v19 offset:8192
  v_mfma_f32_16x16x32_bf16 v[128:131], a[64:67], a[44:47], v[128:131]
  ds_read_b64_tr_b16 a[86:87], v19 offset:10240
  v_mfma_f32_16x16x32_bf16 v[128:131], a[96:99], a[60:63], v[128:131]
  s_cmp_eq_u32 s69, 3
  s_cselect_b32 s69, 0, s69
  s_cselect_b32 s70, s71, s72
  v_mfma_f32_16x16x32_bf16 v[36:39], a[68:71], a[32:35], v[36:39]
  ds_read_b64_tr_b16 a[116:117], v19 offset:12288
  v_mfma_f32_16x16x32_bf16 v[36:39], a[100:103], a[48:51], v[36:39]
  ds_read_b64_tr_b16 a[118:119], v19 offset:14336
  v_mfma_f32_16x16x32_bf16 v[68:71], a[68:71], a[36:39], v[68:71]
  v_mfma_f32_16x16x32_bf16 v[68:71], a[100:103], a[52:55], v[68:71]
  ds_read_b64_tr_b16 a[88:89], v20 offset:8192
  v_mfma_f32_16x16x32_bf16 v[100:103], a[68:71], a[40:43], v[100:103]
  buffer_load_dwordx4 v2, s[20:23], s28 offen offset:3072 sc1 lds
  v_mfma_f32_16x16x32_bf16 v[100:103], a[100:103], a[56:59], v[100:103]
  s_xor_b32 s26, s26, 0x4000
  ds_read_b64_tr_b16 a[90:91], v20 offset:10240
  ds_read_b64_tr_b16 a[120:121], v20 offset:12288
  v_mfma_f32_16x16x32_bf16 v[132:135], a[68:71], a[44:47], v[132:135]
  s_add_u32 s28, s28, 0x8000
  v_mfma_f32_16x16x32_bf16 v[132:135], a[100:103], a[60:63], v[132:135]
  ds_read_b64_tr_b16 a[122:123], v20 offset:14336
  v_mfma_f32_16x16x32_bf16 v[40:43], a[72:75], a[32:35], v[40:43]
  ds_read_b64_tr_b16 a[92:93], v21 offset:8192
  v_mfma_f32_16x16x32_bf16 v[40:43], a[104:107], a[48:51], v[40:43]
  ds_read_b64_tr_b16 a[94:95], v21 offset:10240
  v_mfma_f32_16x16x32_bf16 v[72:75], a[72:75], a[36:39], v[72:75]
  v_mfma_f32_16x16x32_bf16 v[72:75], a[104:107], a[52:55], v[72:75]
  ds_read_b64_tr_b16 a[124:125], v21 offset:12288
  v_mfma_f32_16x16x32_bf16 v[104:107], a[72:75], a[40:43], v[104:107]
  ds_read_b64_tr_b16 a[126:127], v21 offset:14336
  v_mfma_f32_16x16x32_bf16 v[104:107], a[104:107], a[56:59], v[104:107]
  v_add_u32 v16, s90, v16
  v_add_u32 v17, s90, v17
  v_mfma_f32_16x16x32_bf16 v[136:139], a[72:75], a[44:47], v[136:139]
  v_add_u32 v18, s70, v18
  v_add_u32 v19, s70, v19
  v_mfma_f32_16x16x32_bf16 v[136:139], a[104:107], a[60:63], v[136:139]
  v_add_u32 v20, s70, v20
  v_add_u32 v21, s70, v21
  v_mfma_f32_16x16x32_bf16 v[44:47], a[76:79], a[32:35], v[44:47]
  v_mfma_f32_16x16x32_bf16 v[44:47], a[108:111], a[48:51], v[44:47]
  v_mfma_f32_16x16x32_bf16 v[76:79], a[76:79], a[36:39], v[76:79]
  v_mfma_f32_16x16x32_bf16 v[76:79], a[108:111], a[52:55], v[76:79]
  v_mfma_f32_16x16x32_bf16 v[108:111], a[76:79], a[40:43], v[108:111]
  v_mfma_f32_16x16x32_bf16 v[108:111], a[108:111], a[56:59], v[108:111]
  v_mfma_f32_16x16x32_bf16 v[140:143], a[76:79], a[44:47], v[140:143]
  v_mfma_f32_16x16x32_bf16 v[140:143], a[108:111], a[60:63], v[140:143]
  s_waitcnt vmcnt(4) lgkmcnt(0)
  s_barrier
  s_mov_b32 s6, 0x3e0293ee
  s_mov_b32 s7, s6
  v_mfma_f32_16x16x32_bf16 v[48:51], a[80:83], a[32:35], v[48:51]
  s_mov_b32 m0, s26
  ds_read_b128 a[0:3], v16 offset:0
  ds_read_b128 a[16:19], v17 offset:0
  v_mfma_f32_16x16x32_bf16 v[48:51], a[112:115], a[48:51], v[48:51]
  buffer_load_dwordx4 v2, s[20:23], s28 offen offset:0 sc1 lds
  v_mfma_f32_16x16x32_bf16 v[80:83], a[80:83], a[36:39], v[80:83]
  ds_read_b64_tr_b16 a[64:65], v18 offset:0
  ds_read_b64_tr_b16 a[66:67], v18 offset:2048
  v_mfma_f32_16x16x32_bf16 v[80:83], a[112:115], a[52:55], v[80:83]
  buffer_load_dwordx4 v2, s[20:23], s28 offen offset:1024 sc1 lds
  v_mfma_f32_16x16x32_bf16 v[112:115], a[80:83], a[40:43], v[112:115]
  ds_read_b64_tr_b16 a[96:97], v18 offset:4096
  ds_read_b64_tr_b16 a[98:99], v18 offset:6144
  v_mfma_f32_16x16x32_bf16 v[112:115], a[112:115], a[56:59], v[112:115]
  ds_read_b128 a[4:7], v16 offset:2048
  v_mfma_f32_16x16x32_bf16 v[144:147], a[80:83], a[44:47], v[144:147]
  ds_read_b128 a[20:23], v17 offset:2048
  v_mfma_f32_16x16x32_bf16 v[144:147], a[112:115], a[60:63], v[144:147]
  buffer_load_dwordx4 v2, s[20:23], s28 offen offset:2048 sc1 lds
  v_mfma_f32_16x16x32_bf16 v[52:55], a[84:87], a[32:35], v[52:55]
  ds_read_b128 a[8:11], v16 offset:4096
  ds_read_b128 a[24:27], v17 offset:4096
  v_mfma_f32_16x16x32_bf16 v[52:55], a[116:119], a[48:51], v[52:55]
  ds_read_b128 a[12:15], v16 offset:6144
  v_mfma_f32_16x16x32_bf16 v[84:87], a[84:87], a[36:39], v[84:87]
  ds_read_b128 a[28:31], v17 offset:6144
  v_mfma_f32_16x16x32_bf16 v[84:87], a[116:119], a[52:55], v[84:87]
  buffer_load_dwordx4 v2, s[20:23], s28 offen offset:3072 sc1 lds
  v_mfma_f32_16x16x32_bf16 v[116:119], a[84:87], a[40:43], v[116:119]
  s_xor_b32 s26, s26, 0x8000
  s_add_u32 s28, s28, 0x8000
  s_mov_b32 m0, s27
  v_mfma_f32_16x16x32_bf16 v[116:119], a[116:119], a[56:59], v[116:119]
  ds_read_b64_tr_b16 a[68:69], v19 offset:0
  ds_read_b64_tr_b16 a[70:71], v19 offset:2048
  v_mfma_f32_16x16x32_bf16 v[148:151], a[84:87], a[44:47], v[148:151]
  ds_read_b64_tr_b16 a[100:101], v19 offset:4096
  ds_read_b64_tr_b16 a[102:103], v19 offset:6144
  v_mfma_f32_16x16x32_bf16 v[148:151], a[116:119], a[60:63], v[148:151]
  buffer_load_dwordx4 v2, s[20:23], s29 offen offset:0 sc1 lds
  v_mfma_f32_16x16x32_bf16 v[56:59], a[88:91], a[32:35], v[56:59]
  ds_read_b64_tr_b16 a[72:73], v20 offset:0
  ds_read_b64_tr_b16 a[74:75], v20 offset:2048
  v_mfma_f32_16x16x32_bf16 v[56:59], a[120:123], a[48:51], v[56:59]
  ds_read_b64_tr_b16 a[104:105], v20 offset:4096
  ds_read_b64_tr_b16 a[106:107], v20 offset:6144
  v_mfma_f32_16x16x32_bf16 v[88:91], a[88:91], a[36:39], v[88:91]
  ds_read_b64_tr_b16 a[76:77], v21 offset:0
  v_mfma_f32_16x16x32_bf16 v[88:91], a[120:123], a[52:55], v[88:91]
  buffer_load_dwordx4 v2, s[20:23], s29 offen offset:1024 sc1 lds
  v_mfma_f32_16x16x32_bf16 v[120:123], a[88:91], a[40:43], v[120:123]
  ds_read_b64_tr_b16 a[78:79], v21 offset:2048
  ds_read_b64_tr_b16 a[108:109], v21 offset:4096
  v_mfma_f32_16x16x32_bf16 v[120:123], a[120:123], a[56:59], v[120:123]
  ds_read_b64_tr_b16 a[110:111], v21 offset:6144
  v_mfma_f32_16x16x32_bf16 v[152:155], a[88:91], a[44:47], v[152:155]
  v_mfma_f32_16x16x32_bf16 v[152:155], a[120:123], a[60:63], v[152:155]
  buffer_load_dwordx4 v2, s[20:23], s29 offen offset:2048 sc1 lds
  v_mfma_f32_16x16x32_bf16 v[60:63], a[92:95], a[32:35], v[60:63]
  v_mfma_f32_16x16x32_bf16 v[60:63], a[124:127], a[48:51], v[60:63]
  v_mfma_f32_16x16x32_bf16 v[92:95], a[92:95], a[36:39], v[92:95]
  v_mfma_f32_16x16x32_bf16 v[92:95], a[124:127], a[52:55], v[92:95]
  buffer_load_dwordx4 v2, s[20:23], s29 offen offset:3072 sc1 lds
  v_mfma_f32_16x16x32_bf16 v[124:127], a[92:95], a[40:43], v[124:127]
  s_xor_b32 s27, s27, 0x4000
  v_mfma_f32_16x16x32_bf16 v[124:127], a[124:127], a[56:59], v[124:127]
  s_add_u32 s29, s29, 0x8000
  v_mfma_f32_16x16x32_bf16 v[156:159], a[92:95], a[44:47], v[156:159]
  v_mfma_f32_16x16x32_bf16 v[156:159], a[124:127], a[60:63], v[156:159]
  s_waitcnt lgkmcnt(0)
  v_mfma_f32_16x16x32_bf16 v[32:35], a[64:67], a[0:3], v[32:35]
  ds_read_b64_tr_b16 a[80:81], v18 offset:8192
  ds_read_b64_tr_b16 a[82:83], v18 offset:10240
  v_mfma_f32_16x16x32_bf16 v[32:35], a[96:99], a[16:19], v[32:35]
  ds_read_b64_tr_b16 a[112:113], v18 offset:12288
  ds_read_b64_tr_b16 a[114:115], v18 offset:14336
  v_mfma_f32_16x16x32_bf16 v[64:67], a[64:67], a[4:7], v[64:67]
  ds_read_b64_tr_b16 a[84:85], v19 offset:8192
  ds_read_b64_tr_b16 a[86:87], v19 offset:10240
  v_mfma_f32_16x16x32_bf16 v[64:67], a[96:99], a[20:23], v[64:67]
  ds_read_b64_tr_b16 a[116:117], v19 offset:12288
  ds_read_b64_tr_b16 a[118:119], v19 offset:14336
  v_mfma_f32_16x16x32_bf16 v[96:99], a[64:67], a[8:11], v[96:99]
  ds_read_b64_tr_b16 a[88:89], v20 offset:8192
  v_mfma_f32_16x16x32_bf16 v[96:99], a[96:99], a[24:27], v[96:99]
  ds_read_b64_tr_b16 a[90:91], v20 offset:10240
  ds_read_b64_tr_b16 a[120:121], v20 offset:12288
  v_mfma_f32_16x16x32_bf16 v[128:131], a[64:67], a[12:15], v[128:131]
  ds_read_b64_tr_b16 a[122:123], v20 offset:14336
  ds_read_b64_tr_b16 a[92:93], v21 offset:8192
  v_mfma_f32_16x16x32_bf16 v[128:131], a[96:99], a[28:31], v[128:131]
  ds_read_b64_tr_b16 a[94:95], v21 offset:10240
  ds_read_b64_tr_b16 a[124:125], v21 offset:12288
  v_mfma_f32_16x16x32_bf16 v[36:39], a[68:71], a[0:3], v[36:39]
  ds_read_b64_tr_b16 a[126:127], v21 offset:14336
  v_mfma_f32_16x16x32_bf16 v[36:39], a[100:103], a[16:19], v[36:39]
  v_mfma_f32_16x16x32_bf16 v[68:71], a[68:71], a[4:7], v[68:71]
  v_mfma_f32_16x16x32_bf16 v[68:71], a[100:103], a[20:23], v[68:71]
  v_mfma_f32_16x16x32_bf16 v[100:103], a[68:71], a[8:11], v[100:103]
  v_mfma_f32_16x16x32_bf16 v[100:103], a[100:103], a[24:27], v[100:103]
  v_mfma_f32_16x16x32_bf16 v[132:135], a[68:71], a[12:15], v[132:135]
  v_pk_mul_f32 v[32:33], v[32:33], s[6:7]
  v_pk_mul_f32 v[34:35], v[34:35], s[6:7]
  v_mfma_f32_16x16x32_bf16 v[132:135], a[100:103], a[28:31], v[132:135]
  v_pk_mul_f32 v[36:37], v[36:37], s[6:7]
  v_pk_mul_f32 v[38:39], v[38:39], s[6:7]
  v_mfma_f32_16x16x32_bf16 v[40:43], a[72:75], a[0:3], v[40:43]
  v_cvt_pk_bf16_f32 v32, v32, v33
  v_cvt_pk_bf16_f32 v33, v34, v35
  v_mfma_f32_16x16x32_bf16 v[40:43], a[104:107], a[16:19], v[40:43]
  v_cvt_pk_bf16_f32 v34, v36, v37
  v_cvt_pk_bf16_f32 v35, v38, v39
  v_mfma_f32_16x16x32_bf16 v[72:75], a[72:75], a[4:7], v[72:75]
  v_accvgpr_write_b32 a128, v32
  v_accvgpr_write_b32 a129, v33
  v_mfma_f32_16x16x32_bf16 v[72:75], a[104:107], a[20:23], v[72:75]
  v_accvgpr_write_b32 a130, v34
  v_accvgpr_write_b32 a131, v35
  v_mfma_f32_16x16x32_bf16 v[104:107], a[72:75], a[8:11], v[104:107]
  v_pk_mul_f32 v[64:65], v[64:65], s[6:7]
  v_pk_mul_f32 v[66:67], v[66:67], s[6:7]
  v_mfma_f32_16x16x32_bf16 v[104:107], a[104:107], a[24:27], v[104:107]
  v_pk_mul_f32 v[68:69], v[68:69], s[6:7]
  v_pk_mul_f32 v[70:71], v[70:71], s[6:7]
  v_mfma_f32_16x16x32_bf16 v[136:139], a[72:75], a[12:15], v[136:139]
  v_cvt_pk_bf16_f32 v64, v64, v65
  v_cvt_pk_bf16_f32 v65, v66, v67
  v_mfma_f32_16x16x32_bf16 v[136:139], a[104:107], a[28:31], v[136:139]
  v_cvt_pk_bf16_f32 v66, v68, v69
  v_cvt_pk_bf16_f32 v67, v70, v71
  v_mfma_f32_16x16x32_bf16 v[44:47], a[76:79], a[0:3], v[44:47]
  v_accvgpr_write_b32 a144, v64
  v_accvgpr_write_b32 a145, v65
  v_mfma_f32_16x16x32_bf16 v[44:47], a[108:111], a[16:19], v[44:47]
  v_accvgpr_write_b32 a146, v66
  v_accvgpr_write_b32 a147, v67
  v_mfma_f32_16x16x32_bf16 v[76:79], a[76:79], a[4:7], v[76:79]
  v_mfma_f32_32x32x16_bf16 v[160:175], a[236:239], a[236:239], 0
  v_pk_mul_f32 v[96:97], v[96:97], s[6:7]
  v_mfma_f32_16x16x32_bf16 v[76:79], a[108:111], a[20:23], v[76:79]
  v_pk_mul_f32 v[98:99], v[98:99], s[6:7]
  v_pk_mul_f32 v[100:101], v[100:101], s[6:7]
  v_mfma_f32_16x16x32_bf16 v[108:111], a[76:79], a[8:11], v[108:111]
  v_pk_mul_f32 v[102:103], v[102:103], s[6:7]
  v_cvt_pk_bf16_f32 v96, v96, v97
  v_mfma_f32_16x16x32_bf16 v[108:111], a[108:111], a[24:27], v[108:111]
  v_cvt_pk_bf16_f32 v97, v98, v99
  v_cvt_pk_bf16_f32 v98, v100, v101
  v_mfma_f32_16x16x32_bf16 v[140:143], a[76:79], a[12:15], v[140:143]
  v_cvt_pk_bf16_f32 v99, v102, v103
  v_accvgpr_write_b32 a160, v96
  v_mfma_f32_16x16x32_bf16 v[140:143], a[108:111], a[28:31], v[140:143]
  v_accvgpr_write_b32 a161, v97
  v_accvgpr_write_b32 a162, v98
  s_waitcnt lgkmcnt(0)
  v_mfma_f32_16x16x32_bf16 v[48:51], a[80:83], a[0:3], v[48:51]
  v_accvgpr_write_b32 a163, v99
  v_pk_mul_f32 v[128:129], v[128:129], s[6:7]
  v_mfma_f32_16x16x32_bf16 v[48:51], a[112:115], a[16:19], v[48:51]
  v_pk_mul_f32 v[130:131], v[130:131], s[6:7]
  v_pk_mul_f32 v[132:133], v[132:133], s[6:7]
  v_mfma_f32_16x16x32_bf16 v[80:83], a[80:83], a[4:7], v[80:83]
  v_pk_mul_f32 v[134:135], v[134:135], s[6:7]
  v_cvt_pk_bf16_f32 v128, v128, v129
  v_mfma_f32_16x16x32_bf16 v[80:83], a[112:115], a[20:23], v[80:83]
  v_cvt_pk_bf16_f32 v129, v130, v131
  v_cvt_pk_bf16_f32 v130, v132, v133
  v_mfma_f32_16x16x32_bf16 v[112:115], a[80:83], a[8:11], v[112:115]
  v_cvt_pk_bf16_f32 v131, v134, v135
  v_accvgpr_write_b32 a176, v128
  v_mfma_f32_16x16x32_bf16 v[112:115], a[112:115], a[24:27], v[112:115]
  v_accvgpr_write_b32 a177, v129
  v_accvgpr_write_b32 a178, v130
  v_mfma_f32_16x16x32_bf16 v[144:147], a[80:83], a[12:15], v[144:147]
  v_accvgpr_write_b32 a179, v131
  v_mfma_f32_32x32x16_bf16 v[176:191], a[236:239], a[236:239], 0
  v_mfma_f32_16x16x32_bf16 v[144:147], a[112:115], a[28:31], v[144:147]
  v_pk_mul_f32 v[40:41], v[40:41], s[6:7]
  v_pk_mul_f32 v[42:43], v[42:43], s[6:7]
  v_mfma_f32_16x16x32_bf16 v[52:55], a[84:87], a[0:3], v[52:55]
  v_pk_mul_f32 v[44:45], v[44:45], s[6:7]
  v_pk_mul_f32 v[46:47], v[46:47], s[6:7]
  v_mfma_f32_16x16x32_bf16 v[52:55], a[116:119], a[16:19], v[52:55]
  v_cvt_pk_bf16_f32 v40, v40, v41
  v_cvt_pk_bf16_f32 v41, v42, v43
  v_mfma_f32_16x16x32_bf16 v[84:87], a[84:87], a[4:7], v[84:87]
  v_cvt_pk_bf16_f32 v42, v44, v45
  v_cvt_pk_bf16_f32 v43, v46, v47
  v_mfma_f32_16x16x32_bf16 v[84:87], a[116:119], a[20:23], v[84:87]
  v_accvgpr_write_b32 a132, v40
  v_accvgpr_write_b32 a133, v41
  v_mfma_f32_16x16x32_bf16 v[116:119], a[84:87], a[8:11], v[116:119]
  v_accvgpr_write_b32 a134, v42
  v_accvgpr_write_b32 a135, v43
  v_mfma_f32_16x16x32_bf16 v[116:119], a[116:119], a[24:27], v[116:119]
  v_pk_mul_f32 v[72:73], v[72:73], s[6:7]
  v_pk_mul_f32 v[74:75], v[74:75], s[6:7]
  v_mfma_f32_16x16x32_bf16 v[148:151], a[84:87], a[12:15], v[148:151]
  v_pk_mul_f32 v[76:77], v[76:77], s[6:7]
  v_pk_mul_f32 v[78:79], v[78:79], s[6:7]
  v_mfma_f32_16x16x32_bf16 v[148:151], a[116:119], a[28:31], v[148:151]
  v_cvt_pk_bf16_f32 v72, v72, v73
  v_cvt_pk_bf16_f32 v73, v74, v75
  v_mfma_f32_16x16x32_bf16 v[56:59], a[88:91], a[0:3], v[56:59]
  v_cvt_pk_bf16_f32 v74, v76, v77
  v_cvt_pk_bf16_f32 v75, v78, v79
  v_mfma_f32_16x16x32_bf16 v[56:59], a[120:123], a[16:19], v[56:59]
  v_accvgpr_write_b32 a148, v72
  v_accvgpr_write_b32 a149, v73
  v_mfma_f32_16x16x32_bf16 v[88:91], a[88:91], a[4:7], v[88:91]
  v_accvgpr_write_b32 a150, v74
  v_accvgpr_write_b32 a151, v75
  v_mfma_f32_16x16x32_bf16 v[88:91], a[120:123], a[20:23], v[88:91]
  v_mfma_f32_32x32x16_bf16 v[192:207], a[236:239], a[236:239], 0
  v_pk_mul_f32 v[104:105], v[104:105], s[6:7]
  v_mfma_f32_16x16x32_bf16 v[120:123], a[88:91], a[8:11], v[120:123]
  v_pk_mul_f32 v[106:107], v[106:107], s[6:7]
  v_pk_mul_f32 v[108:109], v[108:109], s[6:7]
  v_mfma_f32_16x16x32_bf16 v[120:123], a[120:123], a[24:27], v[120:123]
  v_pk_mul_f32 v[110:111], v[110:111], s[6:7]
  v_cvt_pk_bf16_f32 v104, v104, v105
  v_mfma_f32_16x16x32_bf16 v[152:155], a[88:91], a[12:15], v[152:155]
  v_cvt_pk_bf16_f32 v105, v106, v107
  v_cvt_pk_bf16_f32 v106, v108, v109
  v_mfma_f32_16x16x32_bf16 v[152:155], a[120:123], a[28:31], v[152:155]
  v_cvt_pk_bf16_f32 v107, v110, v111
  v_accvgpr_write_b32 a164, v104
  v_mfma_f32_16x16x32_bf16 v[60:63], a[92:95], a[0:3], v[60:63]
  v_accvgpr_write_b32 a165, v105
  v_accvgpr_write_b32 a166, v106
  v_mfma_f32_16x16x32_bf16 v[60:63], a[124:127], a[16:19], v[60:63]
  v_accvgpr_write_b32 a167, v107
  v_pk_mul_f32 v[136:137], v[136:137], s[6:7]
  v_mfma_f32_16x16x32_bf16 v[92:95], a[92:95], a[4:7], v[92:95]
  v_pk_mul_f32 v[138:139], v[138:139], s[6:7]
  v_pk_mul_f32 v[140:141], v[140:141], s[6:7]
  v_mfma_f32_16x16x32_bf16 v[92:95], a[124:127], a[20:23], v[92:95]
  v_pk_mul_f32 v[142:143], v[142:143], s[6:7]
  v_cvt_pk_bf16_f32 v136, v136, v137
  v_mfma_f32_16x16x32_bf16 v[124:127], a[92:95], a[8:11], v[124:127]
  v_cvt_pk_bf16_f32 v137, v138, v139
  v_cvt_pk_bf16_f32 v138, v140, v141
  v_mfma_f32_16x16x32_bf16 v[124:127], a[124:127], a[24:27], v[124:127]
  v_cvt_pk_bf16_f32 v139, v142, v143
  v_accvgpr_write_b32 a180, v136
  v_mfma_f32_16x16x32_bf16 v[156:159], a[92:95], a[12:15], v[156:159]
  v_accvgpr_write_b32 a181, v137
  v_accvgpr_write_b32 a182, v138
  v_mfma_f32_16x16x32_bf16 v[156:159], a[124:127], a[28:31], v[156:159]
  v_accvgpr_write_b32 a183, v139
  v_mfma_f32_32x32x16_bf16 v[128:143], a[236:239], a[236:239], 0
  v_pk_mul_f32 v[48:49], v[48:49], s[6:7]
  v_pk_mul_f32 v[50:51], v[50:51], s[6:7]
  v_pk_mul_f32 v[52:53], v[52:53], s[6:7]
  v_pk_mul_f32 v[54:55], v[54:55], s[6:7]
  v_cvt_pk_bf16_f32 v48, v48, v49
  v_cvt_pk_bf16_f32 v49, v50, v51
  v_cvt_pk_bf16_f32 v50, v52, v53
  v_cvt_pk_bf16_f32 v51, v54, v55
  v_accvgpr_write_b32 a136, v48
  v_accvgpr_write_b32 a137, v49
  v_accvgpr_write_b32 a138, v50
  v_accvgpr_write_b32 a139, v51
  v_pk_mul_f32 v[80:81], v[80:81], s[6:7]
  v_pk_mul_f32 v[82:83], v[82:83], s[6:7]
  v_pk_mul_f32 v[84:85], v[84:85], s[6:7]
  v_pk_mul_f32 v[86:87], v[86:87], s[6:7]
  v_cvt_pk_bf16_f32 v80, v80, v81
  v_cvt_pk_bf16_f32 v81, v82, v83
  v_cvt_pk_bf16_f32 v82, v84, v85
  v_cvt_pk_bf16_f32 v83, v86, v87
  v_accvgpr_write_b32 a152, v80
  v_accvgpr_write_b32 a153, v81
  v_accvgpr_write_b32 a154, v82
  v_accvgpr_write_b32 a155, v83
  v_mfma_f32_32x32x16_bf16 v[224:239], a[236:239], a[236:239], 0
  v_pk_mul_f32 v[112:113], v[112:113], s[6:7]
  v_pk_mul_f32 v[114:115], v[114:115], s[6:7]
  v_pk_mul_f32 v[116:117], v[116:117], s[6:7]
  v_pk_mul_f32 v[118:119], v[118:119], s[6:7]
  v_cvt_pk_bf16_f32 v112, v112, v113
  v_cvt_pk_bf16_f32 v113, v114, v115
  v_cvt_pk_bf16_f32 v114, v116, v117
  v_cvt_pk_bf16_f32 v115, v118, v119
  v_accvgpr_write_b32 a168, v112
  v_accvgpr_write_b32 a169, v113
  v_accvgpr_write_b32 a170, v114
  v_accvgpr_write_b32 a171, v115
  v_pk_mul_f32 v[144:145], v[144:145], s[6:7]
  v_pk_mul_f32 v[146:147], v[146:147], s[6:7]
  v_pk_mul_f32 v[148:149], v[148:149], s[6:7]
  v_pk_mul_f32 v[150:151], v[150:151], s[6:7]
  v_cvt_pk_bf16_f32 v144, v144, v145
  v_cvt_pk_bf16_f32 v145, v146, v147
  v_cvt_pk_bf16_f32 v146, v148, v149
  v_cvt_pk_bf16_f32 v147, v150, v151
  v_accvgpr_write_b32 a184, v144
  v_accvgpr_write_b32 a185, v145
  v_accvgpr_write_b32 a186, v146
  v_accvgpr_write_b32 a187, v147
  v_mfma_f32_32x32x16_bf16 v[240:255], a[236:239], a[236:239], 0
  v_pk_mul_f32 v[56:57], v[56:57], s[6:7]
  v_pk_mul_f32 v[58:59], v[58:59], s[6:7]
  v_pk_mul_f32 v[60:61], v[60:61], s[6:7]
  v_pk_mul_f32 v[62:63], v[62:63], s[6:7]
  v_cvt_pk_bf16_f32 v56, v56, v57
  v_cvt_pk_bf16_f32 v57, v58, v59
  v_cvt_pk_bf16_f32 v58, v60, v61
  v_cvt_pk_bf16_f32 v59, v62, v63
  v_accvgpr_write_b32 a140, v56
  v_accvgpr_write_b32 a141, v57
  v_accvgpr_write_b32 a142, v58
  v_accvgpr_write_b32 a143, v59
  v_pk_mul_f32 v[88:89], v[88:89], s[6:7]
  v_pk_mul_f32 v[90:91], v[90:91], s[6:7]
  v_pk_mul_f32 v[92:93], v[92:93], s[6:7]
  v_pk_mul_f32 v[94:95], v[94:95], s[6:7]
  v_cvt_pk_bf16_f32 v88, v88, v89
  v_cvt_pk_bf16_f32 v89, v90, v91
  v_cvt_pk_bf16_f32 v90, v92, v93
  v_cvt_pk_bf16_f32 v91, v94, v95
  v_accvgpr_write_b32 a156, v88
  v_accvgpr_write_b32 a157, v89
  v_accvgpr_write_b32 a158, v90
  v_accvgpr_write_b32 a159, v91
  v_mfma_f32_32x32x16_bf16 v[208:223], a[236:239], a[236:239], 0
  v_pk_mul_f32 v[120:121], v[120:121], s[6:7]
  v_pk_mul_f32 v[122:123], v[122:123], s[6:7]
  v_pk_mul_f32 v[124:125], v[124:125], s[6:7]
  v_pk_mul_f32 v[126:127], v[126:127], s[6:7]
  v_cvt_pk_bf16_f32 v120, v120, v121
  v_cvt_pk_bf16_f32 v121, v122, v123
  v_cvt_pk_bf16_f32 v122, v124, v125
  v_cvt_pk_bf16_f32 v123, v126, v127
  v_accvgpr_write_b32 a172, v120
  v_accvgpr_write_b32 a173, v121
  v_accvgpr_write_b32 a174, v122
  v_accvgpr_write_b32 a175, v123
  v_pk_mul_f32 v[152:153], v[152:153], s[6:7]
  v_pk_mul_f32 v[154:155], v[154:155], s[6:7]
  v_pk_mul_f32 v[156:157], v[156:157], s[6:7]
  v_pk_mul_f32 v[158:159], v[158:159], s[6:7]
  v_cvt_pk_bf16_f32 v152, v152, v153
  v_cvt_pk_bf16_f32 v153, v154, v155
  v_cvt_pk_bf16_f32 v154, v156, v157
  v_cvt_pk_bf16_f32 v155, v158, v159
  v_accvgpr_write_b32 a188, v152
  v_accvgpr_write_b32 a189, v153
  v_accvgpr_write_b32 a190, v154
  v_accvgpr_write_b32 a191, v155
  v_mfma_f32_32x32x16_bf16 v[144:159], a[236:239], a[236:239], 0
  v_add_u32 v3, 0xc000, v2
  v_add_u32 v4, 0x10000, v2
  v_mov_b32 v5, 0xf149f2ca
  s_mov_b32 s89, 0
  v_mfma_f32_32x32x16_bf16 a[192:207], a[236:239], a[236:239], 0
  s_lshl_b32 s90, s78, 1
  s_add_u32 s90, s90, s77
  s_lshl_b32 s90, s90, 2
  s_add_u32 s90, s90, s3
  s_lshl_b32 s90, s90, 14
  s_add_u32 s64, s86, 100663296
  s_addc_u32 s65, s87, 0
  s_add_u32 s64, s64, s90
  s_addc_u32 s65, s65, 0
  s_mov_b32 s66, 16384
  s_mov_b32 s67, 0x00020000
  s_mov_b32 s90, 0
  s_waitcnt vmcnt(8)
  s_barrier
  ds_read_b128 a[32:35], v3 offset:0
  ds_read_b128 a[36:39], v3 offset:1024
  ds_read_b128 a[40:43], v3 offset:2048
  ds_read_b128 a[44:47], v3 offset:3072
  ds_read_b128 a[48:51], v3 offset:4096
  ds_read_b128 a[52:55], v3 offset:5120
  ds_read_b128 a[56:59], v3 offset:6144
  ds_read_b128 a[60:63], v3 offset:7168
  s_waitcnt lgkmcnt(6)
  v_mfma_f32_16x16x32_bf16 v[64:67], a[32:35], a[128:131], 0
  s_lshl_b32 s4, s2, 2
  s_add_u32 s4, s4, s3
  s_lshl_b32 s6, s4, 13
  v_mfma_f32_16x16x32_bf16 v[72:75], a[32:35], a[144:147], 0
  s_lshl_b32 s7, s4, 11
  s_mov_b32 s8, s74
  s_mov_b32 s9, s75
  v_mfma_f32_16x16x32_bf16 v[80:83], a[32:35], a[160:163], 0
  s_mov_b32 s10, 8388608
  s_mov_b32 s11, 0x00020000
  s_mov_b32 s12, s80
  v_mfma_f32_16x16x32_bf16 v[88:91], a[32:35], a[176:179], 0
  s_mov_b32 s13, s81
  s_mov_b32 s14, 2097152
  ds_read_b128 a[0:3], v3 offset:8192
  v_mfma_f32_16x16x32_bf16 v[64:67], a[36:39], a[132:135], v[64:67]
  s_mov_b32 s15, 0x00020000
  s_add_u32 s16, s86, 67108864
  s_addc_u32 s17, s87, 0
  v_mfma_f32_16x16x32_bf16 v[72:75], a[36:39], a[148:151], v[72:75]
  s_mov_b32 s18, 16777216
  s_mov_b32 s19, 0x00020000
  v_mfma_f32_16x16x32_bf16 v[80:83], a[36:39], a[164:167], v[80:83]
  v_and_b32 v6, 15, v1
  v_lshrrev_b32 v7, 4, v1
  v_mfma_f32_16x16x32_bf16 v[88:91], a[36:39], a[180:183], v[88:91]
  s_waitcnt lgkmcnt(5)
  ds_read_b128 a[4:7], v3 offset:9216
  v_sub_u32 v6, v6, v7
  v_mfma_f32_16x16x32_bf16 v[64:67], a[40:43], a[136:139], v[64:67]
  v_lshlrev_b32 v6, 2, v6
  v_add_u32 v6, s3, v6
  v_mfma_f32_16x16x32_bf16 v[72:75], a[40:43], a[152:155], v[72:75]
  v_cmp_gt_i32 s[32:33], 0, v6
  v_cmp_gt_i32 s[34:35], 1, v6
  v_mfma_f32_16x16x32_bf16 v[80:83], a[40:43], a[168:171], v[80:83]
  v_cmp_gt_i32 s[36:37], 2, v6
  v_cmp_gt_i32 s[38:39], 3, v6
  v_mfma_f32_16x16x32_bf16 v[88:91], a[40:43], a[184:187], v[88:91]
  ds_read_b128 a[8:11], v3 offset:10240
  v_cmp_gt_i32 s[40:41], 16, v6
  v_mfma_f32_16x16x32_bf16 v[64:67], a[44:47], a[140:143], v[64:67]
  v_cmp_gt_i32 s[42:43], 17, v6
  v_cmp_gt_i32 s[44:45], 18, v6
  v_mfma_f32_16x16x32_bf16 v[72:75], a[44:47], a[156:159], v[72:75]
  v_cmp_gt_i32 s[46:47], 19, v6
  v_cmp_gt_i32 s[48:49], 32, v6
  v_mfma_f32_16x16x32_bf16 v[80:83], a[44:47], a[172:175], v[80:83]
  v_cmp_gt_i32 s[50:51], 33, v6
  v_cmp_gt_i32 s[52:53], 34, v6
  v_mfma_f32_16x16x32_bf16 v[88:91], a[44:47], a[188:191], v[88:91]
  s_waitcnt lgkmcnt(5)
  ds_read_b128 a[12:15], v3 offset:11264
  v_cmp_gt_i32 s[54:55], 35, v6
  v_mfma_f32_16x16x32_bf16 v[68:71], a[48:51], a[128:131], 0
  v_cmp_gt_i32 s[56:57], 48, v6
  v_cmp_gt_i32 s[58:59], 49, v6
  v_mfma_f32_16x16x32_bf16 v[76:79], a[48:51], a[144:147], 0
  s_mov_b32 s30, 0x8000
  v_cmp_gt_i32 s[60:61], 50, v6
  v_cmp_gt_i32 s[62:63], 51, v6
  v_mfma_f32_16x16x32_bf16 v[84:87], a[48:51], a[160:163], 0
  s_mov_b32 s31, 0x4000
  v_mfma_f32_16x16x32_bf16 v[92:95], a[48:51], a[176:179], 0
  ds_read_b128 a[16:19], v3 offset:12288
  v_mfma_f32_16x16x32_bf16 v[68:71], a[52:55], a[132:135], v[68:71]
  v_mfma_f32_16x16x32_bf16 v[76:79], a[52:55], a[148:151], v[76:79]
  v_mfma_f32_16x16x32_bf16 v[84:87], a[52:55], a[164:167], v[84:87]
  v_mfma_f32_16x16x32_bf16 v[92:95], a[52:55], a[180:183], v[92:95]
  s_waitcnt lgkmcnt(5)
  ds_read_b128 a[20:23], v3 offset:13312
  v_mfma_f32_16x16x32_bf16 v[68:71], a[56:59], a[136:139], v[68:71]
  v_mfma_f32_16x16x32_bf16 v[76:79], a[56:59], a[152:155], v[76:79]
  v_mfma_f32_16x16x32_bf16 v[84:87], a[56:59], a[168:171], v[84:87]
  v_mfma_f32_16x16x32_bf16 v[92:95], a[56:59], a[184:187], v[92:95]
  ds_read_b128 a[24:27], v3 offset:14336
  v_mfma_f32_16x16x32_bf16 v[68:71], a[60:63], a[140:143], v[68:71]
  v_mfma_f32_16x16x32_bf16 v[76:79], a[60:63], a[156:159], v[76:79]
  v_mfma_f32_16x16x32_bf16 v[84:87], a[60:63], a[172:175], v[84:87]
  v_mfma_f32_16x16x32_bf16 v[92:95], a[60:63], a[188:191], v[92:95]
  ds_read_b128 a[28:31], v3 offset:15360
  s_cmp_lg_u32 s25, 0
  s_nop 0
  s_cbranch_scc1 La_nomask0
  v_cndmask_b32 v64, v64, v5, s[32:33]
  v_cndmask_b32 v65, v65, v5, s[34:35]
  v_cndmask_b32 v66, v66, v5, s[36:37]
  v_cndmask_b32 v67, v67, v5, s[38:39]
  v_cndmask_b32 v68, v68, v5, s[40:41]
  v_cndmask_b32 v69, v69, v5, s[42:43]
  v_cndmask_b32 v70, v70, v5, s[44:45]
  v_cndmask_b32 v71, v71, v5, s[46:47]
La_nomask0:
  v_max3_f32 v6, v64, v65, v66
  v_max3_f32 v7, v67, v68, v69
  v_max3_f32 v6, v6, v70, v71
  v_max_f32 v6, v6, v7
  v_max3_f32 v8, v72, v73, v74
  v_max3_f32 v9, v75, v76, v77
  v_max3_f32 v8, v8, v78, v79
  v_max_f32 v8, v8, v9
  v_max3_f32 v10, v80, v81, v82
  v_max3_f32 v11, v83, v84, v85
  v_max3_f32 v10, v10, v86, v87
  v_max_f32 v10, v10, v11
  v_max3_f32 v12, v88, v89, v90
  v_max3_f32 v13, v91, v92, v93
  v_max3_f32 v12, v12, v94, v95
  v_max_f32 v12, v12, v13
  v_mov_b32 v7, v6
  v_mov_b32 v9, v8
  v_mov_b32 v11, v10
  v_mov_b32 v13, v12
  v_permlane32_swap_b32 v6, v7
  v_permlane32_swap_b32 v8, v9
  v_permlane32_swap_b32 v10, v11
  v_permlane32_swap_b32 v12, v13
  v_max_f32 v6, v6, v7
  v_max_f32 v8, v8, v9
  v_max_f32 v10, v10, v11
  v_max_f32 v12, v12, v13
  v_mov_b32 v7, v6
  v_mov_b32 v9, v8
  v_mov_b32 v11, v10
  v_mov_b32 v13, v12
  v_permlane16_swap_b32 v6, v7
  v_permlane16_swap_b32 v8, v9
  v_permlane16_swap_b32 v10, v11
  v_permlane16_swap_b32 v12, v13
  v_max_f32 v6, v6, v7
  v_max_f32 v8, v8, v9
  v_max_f32 v10, v10, v11
  v_max_f32 v12, v12, v13
  v_sub_f32 v16, 0, v6
  v_sub_f32 v17, 0, v6
  v_sub_f32 v18, 0, v6
  v_sub_f32 v19, 0, v6
  v_sub_f32 v20, 0, v8
  v_sub_f32 v21, 0, v8
  v_sub_f32 v22, 0, v8
  v_sub_f32 v23, 0, v8
  v_sub_f32 v24, 0, v10
  v_sub_f32 v25, 0, v10
  v_sub_f32 v26, 0, v10
  v_sub_f32 v27, 0, v10
  v_sub_f32 v28, 0, v12
  v_sub_f32 v29, 0, v12
  v_sub_f32 v30, 0, v12
  v_sub_f32 v31, 0, v12
  v_pk_add_f32 v[64:65], v[64:65], v[16:17]
  v_pk_add_f32 v[66:67], v[66:67], v[16:17]
  v_pk_add_f32 v[68:69], v[68:69], v[16:17]
  v_pk_add_f32 v[70:71], v[70:71], v[16:17]
  v_pk_add_f32 v[72:73], v[72:73], v[20:21]
  v_pk_add_f32 v[74:75], v[74:75], v[20:21]
  v_pk_add_f32 v[76:77], v[76:77], v[20:21]
  v_pk_add_f32 v[78:79], v[78:79], v[20:21]
  v_pk_add_f32 v[80:81], v[80:81], v[24:25]
  v_pk_add_f32 v[82:83], v[82:83], v[24:25]
  v_pk_add_f32 v[84:85], v[84:85], v[24:25]
  v_pk_add_f32 v[86:87], v[86:87], v[24:25]
  v_pk_add_f32 v[88:89], v[88:89], v[28:29]
  v_pk_add_f32 v[90:91], v[90:91], v[28:29]
  v_pk_add_f32 v[92:93], v[92:93], v[28:29]
  v_pk_add_f32 v[94:95], v[94:95], v[28:29]
  s_lshl_b32 s88, s25, 1
  s_waitcnt vmcnt(0)
  s_barrier
  s_waitcnt lgkmcnt(4)
  v_mfma_f32_16x16x32_bf16 v[96:99], a[0:3], a[128:131], v[16:19]
  s_mov_b32 m0, s26
  v_exp_f32 v64, v64
  v_mfma_f32_16x16x32_bf16 v[96:99], a[4:7], a[132:135], v[96:99]
  buffer_load_dwordx4 v2, s[20:23], s28 offen offset:0 sc1 lds
  v_exp_f32 v65, v65
  v_mfma_f32_16x16x32_bf16 v[96:99], a[8:11], a[136:139], v[96:99]
  buffer_load_dwordx4 v2, s[20:23], s28 offen offset:1024 sc1 lds
  v_exp_f32 v66, v66
  v_mfma_f32_16x16x32_bf16 v[96:99], a[12:15], a[140:143], v[96:99]
  buffer_load_dwordx4 v2, s[20:23], s28 offen offset:2048 sc1 lds
  v_exp_f32 v67, v67
  v_mfma_f32_16x16x32_bf16 v[104:107], a[0:3], a[144:147], v[20:23]
  v_exp_f32 v68, v68
  v_cvt_pk_bf16_f32 v32, v64, v65
  v_mfma_f32_16x16x32_bf16 v[104:107], a[4:7], a[148:151], v[104:107]
  buffer_load_dwordx4 v2, s[20:23], s28 offen offset:3072 sc1 lds
  v_exp_f32 v69, v69
  v_mfma_f32_16x16x32_bf16 v[104:107], a[8:11], a[152:155], v[104:107]
  s_xor_b32 s26, s26, 0x4000
  v_exp_f32 v70, v70
  v_cvt_pk_bf16_f32 v33, v66, v67
  v_mfma_f32_16x16x32_bf16 v[104:107], a[12:15], a[156:159], v[104:107]
  s_add_u32 s28, s28, 0x8000
  v_exp_f32 v71, v71
  v_cvt_pk_bf16_f32 v34, v68, v69
  v_mfma_f32_16x16x32_bf16 v[112:115], a[0:3], a[160:163], v[24:27]
  s_mov_b32 m0, s27
  v_exp_f32 v72, v72
  v_cvt_pk_bf16_f32 v35, v70, v71
  v_mfma_f32_16x16x32_bf16 v[112:115], a[4:7], a[164:167], v[112:115]
  buffer_load_dwordx4 v2, s[20:23], s29 offen offset:0 sc1 lds
  v_exp_f32 v73, v73
  v_mfma_f32_16x16x32_bf16 v[112:115], a[8:11], a[168:171], v[112:115]
  buffer_load_dwordx4 v2, s[20:23], s29 offen offset:1024 sc1 lds
  v_exp_f32 v74, v74
  v_mfma_f32_16x16x32_bf16 v[112:115], a[12:15], a[172:175], v[112:115]
  buffer_load_dwordx4 v2, s[20:23], s29 offen offset:2048 sc1 lds
  v_exp_f32 v75, v75
  v_mfma_f32_16x16x32_bf16 v[120:123], a[0:3], a[176:179], v[28:31]
  buffer_load_dwordx4 v2, s[20:23], s29 offen offset:3072 sc1 lds
  v_exp_f32 v76, v76
  v_mfma_f32_16x16x32_bf16 v[120:123], a[4:7], a[180:183], v[120:123]
  s_xor_b32 s27, s27, 0x8000
  v_exp_f32 v77, v77
  v_cvt_pk_bf16_f32 v36, v72, v73
  v_mfma_f32_16x16x32_bf16 v[120:123], a[8:11], a[184:187], v[120:123]
  s_add_u32 s29, s29, 0x8000
  v_exp_f32 v78, v78
  v_cvt_pk_bf16_f32 v37, v74, v75
  v_mfma_f32_16x16x32_bf16 v[120:123], a[12:15], a[188:191], v[120:123]
  s_waitcnt lgkmcnt(0)
  v_exp_f32 v79, v79
  v_cvt_pk_bf16_f32 v38, v76, v77
  v_mfma_f32_16x16x32_bf16 v[100:103], a[16:19], a[128:131], v[16:19]
  s_mov_b32 m0, s26
  v_exp_f32 v80, v80
  v_cvt_pk_bf16_f32 v39, v78, v79
  v_mfma_f32_16x16x32_bf16 v[100:103], a[20:23], a[132:135], v[100:103]
  buffer_load_dwordx4 v2, s[20:23], s28 offen offset:0 sc1 lds
  v_exp_f32 v81, v81
  v_mfma_f32_16x16x32_bf16 v[100:103], a[24:27], a[136:139], v[100:103]
  buffer_load_dwordx4 v2, s[20:23], s28 offen offset:1024 sc1 lds
  v_exp_f32 v82, v82
  v_cvt_pk_bf16_f32 v40, v80, v81
  v_mfma_f32_16x16x32_bf16 v[100:103], a[28:31], a[140:143], v[100:103]
  buffer_load_dwordx4 v2, s[20:23], s28 offen offset:2048 sc1 lds
  v_exp_f32 v83, v83
  v_mfma_f32_16x16x32_bf16 v[108:111], a[16:19], a[144:147], v[20:23]
  buffer_load_dwordx4 v2, s[20:23], s28 offen offset:3072 sc1 lds
  v_exp_f32 v84, v84
  v_cvt_pk_bf16_f32 v41, v82, v83
  v_mfma_f32_16x16x32_bf16 v[108:111], a[20:23], a[148:151], v[108:111]
  s_xor_b32 s26, s26, 0x8000
  v_exp_f32 v85, v85
  v_xor_b32 v3, 0x4000, v3
  v_mfma_f32_16x16x32_bf16 v[108:111], a[24:27], a[152:155], v[108:111]
  s_add_u32 s28, s28, 0x8000
  ds_read_b128 a[32:35], v3 offset:0
  v_exp_f32 v86, v86
  v_cvt_pk_bf16_f32 v42, v84, v85
  v_mfma_f32_16x16x32_bf16 v[108:111], a[28:31], a[156:159], v[108:111]
  s_mov_b32 m0, s27
  ds_read_b128 a[36:39], v3 offset:1024
  v_exp_f32 v87, v87
  v_mfma_f32_16x16x32_bf16 v[116:119], a[16:19], a[160:163], v[24:27]
  buffer_load_dwordx4 v2, s[20:23], s29 offen offset:0 sc1 lds
  v_exp_f32 v88, v88
  v_cvt_pk_bf16_f32 v43, v86, v87
  v_mfma_f32_16x16x32_bf16 v[116:119], a[20:23], a[164:167], v[116:119]
  buffer_load_dwordx4 v2, s[20:23], s29 offen offset:1024 sc1 lds
  v_exp_f32 v89, v89
  v_mfma_f32_16x16x32_bf16 v[116:119], a[24:27], a[168:171], v[116:119]
  buffer_load_dwordx4 v2, s[20:23], s29 offen offset:2048 sc1 lds
  v_exp_f32 v90, v90
  v_cvt_pk_bf16_f32 v44, v88, v89
  v_mfma_f32_16x16x32_bf16 v[116:119], a[28:31], a[172:175], v[116:119]
  buffer_load_dwordx4 v2, s[20:23], s29 offen offset:3072 sc1 lds
  v_exp_f32 v91, v91
  v_mfma_f32_16x16x32_bf16 v[124:127], a[16:19], a[176:179], v[28:31]
  s_xor_b32 s27, s27, 0x4000
  ds_read_b128 a[40:43], v3 offset:2048
  v_exp_f32 v92, v92
  v_cvt_pk_bf16_f32 v45, v90, v91
  v_mfma_f32_16x16x32_bf16 v[124:127], a[20:23], a[180:183], v[124:127]
  s_add_u32 s29, s29, 0x8000
  ds_read_b128 a[44:47], v3 offset:3072
  v_exp_f32 v93, v93
  v_mfma_f32_16x16x32_bf16 v[124:127], a[24:27], a[184:187], v[124:127]
  ds_read_b128 a[48:51], v3 offset:4096
  v_exp_f32 v94, v94
  v_cvt_pk_bf16_f32 v46, v92, v93
  v_mfma_f32_16x16x32_bf16 v[124:127], a[28:31], a[188:191], v[124:127]
  ds_read_b128 a[52:55], v3 offset:5120
  ds_read_b128 a[56:59], v3 offset:6144
  ds_read_b128 a[60:63], v3 offset:7168
  ds_read_b128 a[0:3], v4 offset:0
  ds_read_b128 a[4:7], v4 offset:1024
  ds_read_b128 a[8:11], v4 offset:2048
  v_exp_f32 v95, v95
  s_nop 0
  v_cvt_pk_bf16_f32 v47, v94, v95
  s_cmp_eq_u32 s25, 0
  s_cbranch_scc1 La_d1
  .p2align 6
La_lo:
  s_waitcnt lgkmcnt(7)
  v_mfma_f32_16x16x32_bf16 v[64:67], a[32:35], a[128:131], v[16:19]
  v_exp_f32 v96, v96
  v_mfma_f32_16x16x32_bf16 v[64:67], a[36:39], a[132:135], v[64:67]
  buffer_store_dwordx4 a[244:247], v2, s[64:67], s90 offen offset:0 sc1
  v_mfma_f32_16x16x32_bf16 v[64:67], a[40:43], a[136:139], v[64:67]
  v_exp_f32 v97, v97
  v_mfma_f32_16x16x32_bf16 v[64:67], a[44:47], a[140:143], v[64:67]
  ds_read_b128 a[12:15], v4 offset:3072
  v_cvt_pk_bf16_f32 v48, v96, v97
  v_mfma_f32_16x16x32_bf16 v[72:75], a[32:35], a[144:147], v[20:23]
  v_exp_f32 v98, v98
  v_mfma_f32_16x16x32_bf16 v[72:75], a[36:39], a[148:151], v[72:75]
  ds_read_b128 a[16:19], v4 offset:4096
  v_mfma_f32_16x16x32_bf16 v[72:75], a[40:43], a[152:155], v[72:75]
  v_exp_f32 v99, v99
  v_mfma_f32_16x16x32_bf16 v[72:75], a[44:47], a[156:159], v[72:75]
  v_cvt_pk_bf16_f32 v49, v98, v99
  v_mfma_f32_16x16x32_bf16 v[80:83], a[32:35], a[160:163], v[24:27]
  v_exp_f32 v100, v100
  v_mfma_f32_16x16x32_bf16 v[80:83], a[36:39], a[164:167], v[80:83]
  ds_read_b128 a[20:23], v4 offset:5120
  v_mfma_f32_16x16x32_bf16 v[80:83], a[40:43], a[168:171], v[80:83]
  v_exp_f32 v101, v101
  v_mfma_f32_16x16x32_bf16 v[80:83], a[44:47], a[172:175], v[80:83]
  v_cvt_pk_bf16_f32 v50, v100, v101
  v_mfma_f32_16x16x32_bf16 v[88:91], a[32:35], a[176:179], v[28:31]
  v_exp_f32 v102, v102
  v_mfma_f32_16x16x32_bf16 v[88:91], a[36:39], a[180:183], v[88:91]
  ds_read_b128 a[24:27], v4 offset:6144
  v_mfma_f32_16x16x32_bf16 v[88:91], a[40:43], a[184:187], v[88:91]
  v_exp_f32 v103, v103
  v_mfma_f32_16x16x32_bf16 v[88:91], a[44:47], a[188:191], v[88:91]
  s_waitcnt lgkmcnt(7)
  v_cvt_pk_bf16_f32 v51, v102, v103
  v_mfma_f32_16x16x32_bf16 v[68:71], a[48:51], a[128:131], v[16:19]
  v_exp_f32 v104, v104
  v_mfma_f32_16x16x32_bf16 v[68:71], a[52:55], a[132:135], v[68:71]
  ds_read_b128 a[28:31], v4 offset:7168
  v_mfma_f32_16x16x32_bf16 v[68:71], a[56:59], a[136:139], v[68:71]
  v_exp_f32 v105, v105
  v_mfma_f32_16x16x32_bf16 v[68:71], a[60:63], a[140:143], v[68:71]
  v_cvt_pk_bf16_f32 v52, v104, v105
  v_mfma_f32_16x16x32_bf16 v[76:79], a[48:51], a[144:147], v[20:23]
  v_exp_f32 v106, v106
  v_mfma_f32_16x16x32_bf16 v[76:79], a[52:55], a[148:151], v[76:79]
  ds_read_b128 a[32:35], v3 offset:8192
  v_mfma_f32_16x16x32_bf16 v[76:79], a[56:59], a[152:155], v[76:79]
  v_exp_f32 v107, v107
  v_mfma_f32_16x16x32_bf16 v[76:79], a[60:63], a[156:159], v[76:79]
  v_cvt_pk_bf16_f32 v53, v106, v107
  v_mfma_f32_16x16x32_bf16 v[84:87], a[48:51], a[160:163], v[24:27]
  v_exp_f32 v108, v108
  v_mfma_f32_16x16x32_bf16 v[84:87], a[52:55], a[164:167], v[84:87]
  ds_read_b128 a[36:39], v3 offset:9216
  v_mfma_f32_16x16x32_bf16 v[84:87], a[56:59], a[168:171], v[84:87]
  v_exp_f32 v109, v109
  v_mfma_f32_16x16x32_bf16 v[84:87], a[60:63], a[172:175], v[84:87]
  v_cvt_pk_bf16_f32 v54, v108, v109
  v_mfma_f32_16x16x32_bf16 v[92:95], a[48:51], a[176:179], v[28:31]
  v_exp_f32 v110, v110
  v_mfma_f32_16x16x32_bf16 v[92:95], a[52:55], a[180:183], v[92:95]
  ds_read_b128 a[40:43], v3 offset:10240
  v_mfma_f32_16x16x32_bf16 v[92:95], a[56:59], a[184:187], v[92:95]
  v_exp_f32 v111, v111
  v_mfma_f32_16x16x32_bf16 v[92:95], a[60:63], a[188:191], v[92:95]
  s_waitcnt lgkmcnt(7)
  v_cvt_pk_bf16_f32 v55, v110, v111
  v_mfma_f32_16x16x32_bf16 v[128:131], a[0:3], v[32:35], v[128:131]
  buffer_store_dwordx4 a[244:247], v2, s[64:67], s90 offen offset:1024 sc1
  v_mfma_f32_16x16x32_bf16 v[160:163], a[0:3], v[36:39], v[160:163]
  s_add_u32 s90, s90, 2048
  v_exp_f32 v112, v112
  v_mfma_f32_16x16x32_bf16 v[192:195], a[0:3], v[40:43], v[192:195]
  s_sub_u32 s88, s88, 1
  ds_read_b128 a[44:47], v3 offset:11264
  v_mfma_f32_16x16x32_bf16 v[224:227], a[0:3], v[44:47], v[224:227]
  v_exp_f32 v113, v113
  v_mfma_f32_16x16x32_bf16 a[192:195], a[208:211], v[32:35], a[192:195]
  v_cvt_pk_bf16_f32 v56, v112, v113
  v_mfma_f32_16x16x32_bf16 v[132:135], a[4:7], v[32:35], v[132:135]
  v_exp_f32 v114, v114
  v_mfma_f32_16x16x32_bf16 v[164:167], a[4:7], v[36:39], v[164:167]
  ds_read_b128 a[48:51], v3 offset:12288
  v_mfma_f32_16x16x32_bf16 v[196:199], a[4:7], v[40:43], v[196:199]
  v_exp_f32 v115, v115
  v_mfma_f32_16x16x32_bf16 v[228:231], a[4:7], v[44:47], v[228:231]
  v_cvt_pk_bf16_f32 v57, v114, v115
  v_mfma_f32_16x16x32_bf16 a[196:199], a[208:211], v[36:39], a[196:199]
  v_exp_f32 v116, v116
  v_mfma_f32_16x16x32_bf16 v[136:139], a[8:11], v[32:35], v[136:139]
  ds_read_b128 a[52:55], v3 offset:13312
  v_mfma_f32_16x16x32_bf16 v[168:171], a[8:11], v[36:39], v[168:171]
  v_exp_f32 v117, v117
  v_mfma_f32_16x16x32_bf16 v[200:203], a[8:11], v[40:43], v[200:203]
  v_cvt_pk_bf16_f32 v58, v116, v117
  v_mfma_f32_16x16x32_bf16 v[232:235], a[8:11], v[44:47], v[232:235]
  v_exp_f32 v118, v118
  v_mfma_f32_16x16x32_bf16 a[200:203], a[208:211], v[40:43], a[200:203]
  v_mfma_f32_16x16x32_bf16 v[140:143], a[12:15], v[32:35], v[140:143]
  v_exp_f32 v119, v119
  v_mfma_f32_16x16x32_bf16 v[172:175], a[12:15], v[36:39], v[172:175]
  ds_read_b128 a[56:59], v3 offset:14336
  v_cvt_pk_bf16_f32 v59, v118, v119
  v_mfma_f32_16x16x32_bf16 v[204:207], a[12:15], v[40:43], v[204:207]
  v_exp_f32 v120, v120
  v_mfma_f32_16x16x32_bf16 v[236:239], a[12:15], v[44:47], v[236:239]
  v_mfma_f32_16x16x32_bf16 a[204:207], a[208:211], v[44:47], a[204:207]
  s_waitcnt lgkmcnt(7)
  v_exp_f32 v121, v121
  v_mfma_f32_16x16x32_bf16 v[144:147], a[16:19], v[32:35], v[144:147]
  ds_read_b128 a[60:63], v3 offset:15360
  v_cvt_pk_bf16_f32 v60, v120, v121
  v_mfma_f32_16x16x32_bf16 v[176:179], a[16:19], v[36:39], v[176:179]
  v_exp_f32 v122, v122
  v_mfma_f32_16x16x32_bf16 v[208:211], a[16:19], v[40:43], v[208:211]
  v_mfma_f32_16x16x32_bf16 v[240:243], a[16:19], v[44:47], v[240:243]
  v_exp_f32 v123, v123
  v_mfma_f32_16x16x32_bf16 v[148:151], a[20:23], v[32:35], v[148:151]
  ds_read_b128 a[0:3], v4 offset:8192
  v_cvt_pk_bf16_f32 v61, v122, v123
  v_mfma_f32_16x16x32_bf16 v[180:183], a[20:23], v[36:39], v[180:183]
  v_exp_f32 v124, v124
  v_mfma_f32_16x16x32_bf16 v[212:215], a[20:23], v[40:43], v[212:215]
  v_mfma_f32_16x16x32_bf16 v[244:247], a[20:23], v[44:47], v[244:247]
  v_exp_f32 v125, v125
  v_mfma_f32_16x16x32_bf16 v[152:155], a[24:27], v[32:35], v[152:155]
  ds_read_b128 a[4:7], v4 offset:9216
  v_cvt_pk_bf16_f32 v62, v124, v125
  v_mfma_f32_16x16x32_bf16 v[184:187], a[24:27], v[36:39], v[184:187]
  v_exp_f32 v126, v126
  v_mfma_f32_16x16x32_bf16 v[216:219], a[24:27], v[40:43], v[216:219]
  v_mfma_f32_16x16x32_bf16 v[248:251], a[24:27], v[44:47], v[248:251]
  v_exp_f32 v127, v127
  v_mfma_f32_16x16x32_bf16 v[156:159], a[28:31], v[32:35], v[156:159]
  ds_read_b128 a[8:11], v4 offset:10240
  v_cvt_pk_bf16_f32 v63, v126, v127
  v_mfma_f32_16x16x32_bf16 v[188:191], a[28:31], v[36:39], v[188:191]
  v_mfma_f32_16x16x32_bf16 v[220:223], a[28:31], v[40:43], v[220:223]
  s_waitcnt vmcnt(10)
  s_barrier
  v_mfma_f32_16x16x32_bf16 v[252:255], a[28:31], v[44:47], v[252:255]
  s_cmp_eq_u32 s88, 0
  s_cbranch_scc1 La_d0
  s_waitcnt lgkmcnt(7)
  v_mfma_f32_16x16x32_bf16 v[96:99], a[32:35], a[128:131], v[16:19]
  s_mov_b32 m0, s26
  v_exp_f32 v64, v64
  v_mfma_f32_16x16x32_bf16 v[96:99], a[36:39], a[132:135], v[96:99]
  buffer_load_dwordx4 v2, s[20:23], s28 offen offset:0 sc1 lds
  v_mfma_f32_16x16x32_bf16 v[96:99], a[40:43], a[136:139], v[96:99]
  v_exp_f32 v65, v65
  v_mfma_f32_16x16x32_bf16 v[96:99], a[44:47], a[140:143], v[96:99]
  ds_read_b128 a[12:15], v4 offset:11264
  v_cvt_pk_bf16_f32 v32, v64, v65
  v_mfma_f32_16x16x32_bf16 v[104:107], a[32:35], a[144:147], v[20:23]
  v_exp_f32 v66, v66
  v_mfma_f32_16x16x32_bf16 v[104:107], a[36:39], a[148:151], v[104:107]
  ds_read_b128 a[16:19], v4 offset:12288
  v_mfma_f32_16x16x32_bf16 v[104:107], a[40:43], a[152:155], v[104:107]
  v_exp_f32 v67, v67
  v_mfma_f32_16x16x32_bf16 v[104:107], a[44:47], a[156:159], v[104:107]
  v_cvt_pk_bf16_f32 v33, v66, v67
  v_mfma_f32_16x16x32_bf16 v[112:115], a[32:35], a[160:163], v[24:27]
  v_exp_f32 v68, v68
  v_mfma_f32_16x16x32_bf16 v[112:115], a[36:39], a[164:167], v[112:115]
  buffer_load_dwordx4 v2, s[20:23], s28 offen offset:1024 sc1 lds
  v_mfma_f32_16x16x32_bf16 v[112:115], a[40:43], a[168:171], v[112:115]
  v_exp_f32 v69, v69
  v_mfma_f32_16x16x32_bf16 v[112:115], a[44:47], a[172:175], v[112:115]
  ds_read_b128 a[20:23], v4 offset:13312
  v_cvt_pk_bf16_f32 v34, v68, v69
  v_mfma_f32_16x16x32_bf16 v[120:123], a[32:35], a[176:179], v[28:31]
  v_exp_f32 v70, v70
  v_mfma_f32_16x16x32_bf16 v[120:123], a[36:39], a[180:183], v[120:123]
  ds_read_b128 a[24:27], v4 offset:14336
  v_mfma_f32_16x16x32_bf16 v[120:123], a[40:43], a[184:187], v[120:123]
  v_exp_f32 v71, v71
  v_mfma_f32_16x16x32_bf16 v[120:123], a[44:47], a[188:191], v[120:123]
  s_waitcnt lgkmcnt(7)
  v_cvt_pk_bf16_f32 v35, v70, v71
  v_mfma_f32_16x16x32_bf16 v[100:103], a[48:51], a[128:131], v[16:19]
  v_exp_f32 v72, v72
  v_mfma_f32_16x16x32_bf16 v[100:103], a[52:55], a[132:135], v[100:103]
  buffer_load_dwordx4 v2, s[20:23], s28 offen offset:2048 sc1 lds
  v_mfma_f32_16x16x32_bf16 v[100:103], a[56:59], a[136:139], v[100:103]
  v_exp_f32 v73, v73
  v_mfma_f32_16x16x32_bf16 v[100:103], a[60:63], a[140:143], v[100:103]
  ds_read_b128 a[28:31], v4 offset:15360
  v_xor_b32 v3, s30, v3
  v_mfma_f32_16x16x32_bf16 v[108:111], a[48:51], a[144:147], v[20:23]
  v_exp_f32 v74, v74
  v_mfma_f32_16x16x32_bf16 v[108:111], a[52:55], a[148:151], v[108:111]
  ds_read_b128 a[32:35], v3 offset:0
  v_cvt_pk_bf16_f32 v36, v72, v73
  v_mfma_f32_16x16x32_bf16 v[108:111], a[56:59], a[152:155], v[108:111]
  v_exp_f32 v75, v75
  v_mfma_f32_16x16x32_bf16 v[108:111], a[60:63], a[156:159], v[108:111]
  v_cvt_pk_bf16_f32 v37, v74, v75
  v_mfma_f32_16x16x32_bf16 v[116:119], a[48:51], a[160:163], v[24:27]
  v_exp_f32 v76, v76
  v_mfma_f32_16x16x32_bf16 v[116:119], a[52:55], a[164:167], v[116:119]
  buffer_load_dwordx4 v2, s[20:23], s28 offen offset:3072 sc1 lds
  v_mfma_f32_16x16x32_bf16 v[116:119], a[56:59], a[168:171], v[116:119]
  s_xor_b32 s26, s26, s31
  v_exp_f32 v77, v77
  v_mfma_f32_16x16x32_bf16 v[116:119], a[60:63], a[172:175], v[116:119]
  s_add_u32 s28, s28, 0x8000
  s_mov_b32 m0, s27
  ds_read_b128 a[36:39], v3 offset:1024
  v_mfma_f32_16x16x32_bf16 v[124:127], a[48:51], a[176:179], v[28:31]
  v_exp_f32 v78, v78
  v_mfma_f32_16x16x32_bf16 v[124:127], a[52:55], a[180:183], v[124:127]
  ds_read_b128 a[40:43], v3 offset:2048
  v_cvt_pk_bf16_f32 v38, v76, v77
  v_mfma_f32_16x16x32_bf16 v[124:127], a[56:59], a[184:187], v[124:127]
  v_exp_f32 v79, v79
  v_mfma_f32_16x16x32_bf16 v[124:127], a[60:63], a[188:191], v[124:127]
  s_waitcnt lgkmcnt(7)
  v_cvt_pk_bf16_f32 v39, v78, v79
  v_mfma_f32_16x16x32_bf16 v[128:131], a[0:3], v[48:51], v[128:131]
  buffer_load_dwordx4 v2, s[20:23], s29 offen offset:0 sc1 lds
  v_mfma_f32_16x16x32_bf16 v[160:163], a[0:3], v[52:55], v[160:163]
  v_exp_f32 v80, v80
  v_mfma_f32_16x16x32_bf16 v[192:195], a[0:3], v[56:59], v[192:195]
  ds_read_b128 a[44:47], v3 offset:3072
  v_mfma_f32_16x16x32_bf16 v[224:227], a[0:3], v[60:63], v[224:227]
  v_exp_f32 v81, v81
  v_mfma_f32_16x16x32_bf16 a[192:195], a[208:211], v[48:51], a[192:195]
  v_cvt_pk_bf16_f32 v40, v80, v81
  v_mfma_f32_16x16x32_bf16 v[132:135], a[4:7], v[48:51], v[132:135]
  v_exp_f32 v82, v82
  v_mfma_f32_16x16x32_bf16 v[164:167], a[4:7], v[52:55], v[164:167]
  ds_read_b128 a[48:51], v3 offset:4096
  v_mfma_f32_16x16x32_bf16 v[196:199], a[4:7], v[56:59], v[196:199]
  v_exp_f32 v83, v83
  v_mfma_f32_16x16x32_bf16 v[228:231], a[4:7], v[60:63], v[228:231]
  buffer_load_dwordx4 v2, s[20:23], s29 offen offset:1024 sc1 lds
  v_mfma_f32_16x16x32_bf16 a[196:199], a[208:211], v[52:55], a[196:199]
  v_exp_f32 v84, v84
  v_mfma_f32_16x16x32_bf16 v[136:139], a[8:11], v[48:51], v[136:139]
  ds_read_b128 a[52:55], v3 offset:5120
  v_cvt_pk_bf16_f32 v41, v82, v83
  v_mfma_f32_16x16x32_bf16 v[168:171], a[8:11], v[52:55], v[168:171]
  v_exp_f32 v85, v85
  v_mfma_f32_16x16x32_bf16 v[200:203], a[8:11], v[56:59], v[200:203]
  v_cvt_pk_bf16_f32 v42, v84, v85
  v_mfma_f32_16x16x32_bf16 v[232:235], a[8:11], v[60:63], v[232:235]
  v_exp_f32 v86, v86
  v_mfma_f32_16x16x32_bf16 a[200:203], a[208:211], v[56:59], a[200:203]
  v_mfma_f32_16x16x32_bf16 v[140:143], a[12:15], v[48:51], v[140:143]
  v_exp_f32 v87, v87
  v_mfma_f32_16x16x32_bf16 v[172:175], a[12:15], v[52:55], v[172:175]
  buffer_load_dwordx4 v2, s[20:23], s29 offen offset:2048 sc1 lds
  v_mfma_f32_16x16x32_bf16 v[204:207], a[12:15], v[56:59], v[204:207]
  v_exp_f32 v88, v88
  v_mfma_f32_16x16x32_bf16 v[236:239], a[12:15], v[60:63], v[236:239]
  ds_read_b128 a[56:59], v3 offset:6144
  v_cvt_pk_bf16_f32 v43, v86, v87
  v_mfma_f32_16x16x32_bf16 a[204:207], a[208:211], v[60:63], a[204:207]
  s_waitcnt lgkmcnt(7)
  v_exp_f32 v89, v89
  v_mfma_f32_16x16x32_bf16 v[144:147], a[16:19], v[48:51], v[144:147]
  ds_read_b128 a[60:63], v3 offset:7168
  v_cvt_pk_bf16_f32 v44, v88, v89
  v_mfma_f32_16x16x32_bf16 v[176:179], a[16:19], v[52:55], v[176:179]
  v_exp_f32 v90, v90
  v_mfma_f32_16x16x32_bf16 v[208:211], a[16:19], v[56:59], v[208:211]
  v_mfma_f32_16x16x32_bf16 v[240:243], a[16:19], v[60:63], v[240:243]
  v_exp_f32 v91, v91
  v_mfma_f32_16x16x32_bf16 v[148:151], a[20:23], v[48:51], v[148:151]
  buffer_load_dwordx4 v2, s[20:23], s29 offen offset:3072 sc1 lds
  v_mfma_f32_16x16x32_bf16 v[180:183], a[20:23], v[52:55], v[180:183]
  s_xor_b32 s27, s27, s30
  v_exp_f32 v92, v92
  v_mfma_f32_16x16x32_bf16 v[212:215], a[20:23], v[56:59], v[212:215]
  s_add_u32 s29, s29, 0x8000
  v_xor_b32 v4, s31, v4
  v_cvt_pk_bf16_f32 v45, v90, v91
  v_mfma_f32_16x16x32_bf16 v[244:247], a[20:23], v[60:63], v[244:247]
  v_exp_f32 v93, v93
  v_mfma_f32_16x16x32_bf16 v[152:155], a[24:27], v[48:51], v[152:155]
  ds_read_b128 a[0:3], v4 offset:0
  ds_read_b128 a[4:7], v4 offset:1024
  v_mfma_f32_16x16x32_bf16 v[184:187], a[24:27], v[52:55], v[184:187]
  v_exp_f32 v94, v94
  v_mfma_f32_16x16x32_bf16 v[216:219], a[24:27], v[56:59], v[216:219]
  v_cvt_pk_bf16_f32 v46, v92, v93
  v_mfma_f32_16x16x32_bf16 v[248:251], a[24:27], v[60:63], v[248:251]
  v_exp_f32 v95, v95
  v_mfma_f32_16x16x32_bf16 v[156:159], a[28:31], v[48:51], v[156:159]
  ds_read_b128 a[8:11], v4 offset:2048
  v_cvt_pk_bf16_f32 v47, v94, v95
  v_mfma_f32_16x16x32_bf16 v[188:191], a[28:31], v[52:55], v[188:191]
  v_mfma_f32_16x16x32_bf16 v[220:223], a[28:31], v[56:59], v[220:223]
  v_mfma_f32_16x16x32_bf16 v[252:255], a[28:31], v[60:63], v[252:255]
  s_xor_b32 s30, s30, 0xc000
  s_xor_b32 s31, s31, 0xc000
  s_branch La_lo
La_d0:
  s_waitcnt lgkmcnt(7)
  v_mfma_f32_16x16x32_bf16 v[96:99], a[32:35], a[128:131], v[16:19]
  s_mov_b32 m0, s26
  ds_read_b128 a[12:15], v4 offset:11264
  v_cndmask_b32 v64, v64, v5, s[32:33]
  v_mfma_f32_16x16x32_bf16 v[96:99], a[36:39], a[132:135], v[96:99]
  v_exp_f32 v64, v64
  v_mfma_f32_16x16x32_bf16 v[96:99], a[40:43], a[136:139], v[96:99]
  v_cndmask_b32 v65, v65, v5, s[34:35]
  v_exp_f32 v65, v65
  v_mfma_f32_16x16x32_bf16 v[96:99], a[44:47], a[140:143], v[96:99]
  buffer_load_dwordx4 v2, s[20:23], s28 offen offset:0 sc1 lds
  v_mfma_f32_16x16x32_bf16 v[104:107], a[32:35], a[144:147], v[20:23]
  v_cndmask_b32 v66, v66, v5, s[36:37]
  v_exp_f32 v66, v66
  v_mfma_f32_16x16x32_bf16 v[104:107], a[36:39], a[148:151], v[104:107]
  ds_read_b128 a[16:19], v4 offset:12288
  v_cndmask_b32 v67, v67, v5, s[38:39]
  v_mfma_f32_16x16x32_bf16 v[104:107], a[40:43], a[152:155], v[104:107]
  v_exp_f32 v67, v67
  v_mfma_f32_16x16x32_bf16 v[104:107], a[44:47], a[156:159], v[104:107]
  v_cndmask_b32 v68, v68, v5, s[40:41]
  v_cndmask_b32 v69, v69, v5, s[42:43]
  v_mfma_f32_16x16x32_bf16 v[112:115], a[32:35], a[160:163], v[24:27]
  v_exp_f32 v68, v68
  v_mfma_f32_16x16x32_bf16 v[112:115], a[36:39], a[164:167], v[112:115]
  buffer_load_dwordx4 v2, s[20:23], s28 offen offset:1024 sc1 lds
  v_mfma_f32_16x16x32_bf16 v[112:115], a[40:43], a[168:171], v[112:115]
  v_exp_f32 v69, v69
  v_mfma_f32_16x16x32_bf16 v[112:115], a[44:47], a[172:175], v[112:115]
  ds_read_b128 a[20:23], v4 offset:13312
  v_cndmask_b32 v70, v70, v5, s[44:45]
  v_mfma_f32_16x16x32_bf16 v[120:123], a[32:35], a[176:179], v[28:31]
  v_exp_f32 v70, v70
  v_mfma_f32_16x16x32_bf16 v[120:123], a[36:39], a[180:183], v[120:123]
  ds_read_b128 a[24:27], v4 offset:14336
  v_cndmask_b32 v71, v71, v5, s[46:47]
  v_mfma_f32_16x16x32_bf16 v[120:123], a[40:43], a[184:187], v[120:123]
  v_exp_f32 v71, v71
  v_mfma_f32_16x16x32_bf16 v[120:123], a[44:47], a[188:191], v[120:123]
  s_waitcnt lgkmcnt(7)
  v_cvt_pk_bf16_f32 v32, v64, v65
  v_cvt_pk_bf16_f32 v33, v66, v67
  v_mfma_f32_16x16x32_bf16 v[100:103], a[48:51], a[128:131], v[16:19]
  v_exp_f32 v72, v72
  v_mfma_f32_16x16x32_bf16 v[100:103], a[52:55], a[132:135], v[100:103]
  buffer_load_dwordx4 v2, s[20:23], s28 offen offset:2048 sc1 lds
  v_mfma_f32_16x16x32_bf16 v[100:103], a[56:59], a[136:139], v[100:103]
  v_exp_f32 v73, v73
  v_mfma_f32_16x16x32_bf16 v[100:103], a[60:63], a[140:143], v[100:103]
  ds_read_b128 a[28:31], v4 offset:15360
  v_xor_b32 v3, 0x4000, v3
  v_mfma_f32_16x16x32_bf16 v[108:111], a[48:51], a[144:147], v[20:23]
  v_exp_f32 v74, v74
  v_mfma_f32_16x16x32_bf16 v[108:111], a[52:55], a[148:151], v[108:111]
  ds_read_b128 a[32:35], v3 offset:0
  v_cvt_pk_bf16_f32 v34, v68, v69
  v_mfma_f32_16x16x32_bf16 v[108:111], a[56:59], a[152:155], v[108:111]
  v_exp_f32 v75, v75
  v_mfma_f32_16x16x32_bf16 v[108:111], a[60:63], a[156:159], v[108:111]
  v_cvt_pk_bf16_f32 v35, v70, v71
  v_cvt_pk_bf16_f32 v36, v72, v73
  v_mfma_f32_16x16x32_bf16 v[116:119], a[48:51], a[160:163], v[24:27]
  v_exp_f32 v76, v76
  v_mfma_f32_16x16x32_bf16 v[116:119], a[52:55], a[164:167], v[116:119]
  buffer_load_dwordx4 v2, s[20:23], s28 offen offset:3072 sc1 lds
  v_mfma_f32_16x16x32_bf16 v[116:119], a[56:59], a[168:171], v[116:119]
  s_xor_b32 s26, s26, 0x8000
  v_exp_f32 v77, v77
  v_mfma_f32_16x16x32_bf16 v[116:119], a[60:63], a[172:175], v[116:119]
  s_add_u32 s28, s28, 0x8000
  s_mov_b32 m0, s27
  ds_read_b128 a[36:39], v3 offset:1024
  v_mfma_f32_16x16x32_bf16 v[124:127], a[48:51], a[176:179], v[28:31]
  v_exp_f32 v78, v78
  v_mfma_f32_16x16x32_bf16 v[124:127], a[52:55], a[180:183], v[124:127]
  ds_read_b128 a[40:43], v3 offset:2048
  v_cvt_pk_bf16_f32 v37, v74, v75
  v_mfma_f32_16x16x32_bf16 v[124:127], a[56:59], a[184:187], v[124:127]
  v_exp_f32 v79, v79
  v_mfma_f32_16x16x32_bf16 v[124:127], a[60:63], a[188:191], v[124:127]
  s_waitcnt lgkmcnt(7)
  v_cvt_pk_bf16_f32 v38, v76, v77
  v_cvt_pk_bf16_f32 v39, v78, v79
  v_mfma_f32_16x16x32_bf16 v[128:131], a[0:3], v[48:51], v[128:131]
  buffer_load_dwordx4 v2, s[20:23], s29 offen offset:0 sc1 lds
  v_mfma_f32_16x16x32_bf16 v[160:163], a[0:3], v[52:55], v[160:163]
  v_exp_f32 v80, v80
  v_mfma_f32_16x16x32_bf16 v[192:195], a[0:3], v[56:59], v[192:195]
  ds_read_b128 a[44:47], v3 offset:3072
  v_mfma_f32_16x16x32_bf16 v[224:227], a[0:3], v[60:63], v[224:227]
  v_exp_f32 v81, v81
  v_mfma_f32_16x16x32_bf16 a[192:195], a[208:211], v[48:51], a[192:195]
  v_cvt_pk_bf16_f32 v40, v80, v81
  v_mfma_f32_16x16x32_bf16 v[132:135], a[4:7], v[48:51], v[132:135]
  v_exp_f32 v82, v82
  v_mfma_f32_16x16x32_bf16 v[164:167], a[4:7], v[52:55], v[164:167]
  ds_read_b128 a[48:51], v3 offset:4096
  v_mfma_f32_16x16x32_bf16 v[196:199], a[4:7], v[56:59], v[196:199]
  v_exp_f32 v83, v83
  v_mfma_f32_16x16x32_bf16 v[228:231], a[4:7], v[60:63], v[228:231]
  buffer_load_dwordx4 v2, s[20:23], s29 offen offset:1024 sc1 lds
  v_mfma_f32_16x16x32_bf16 a[196:199], a[208:211], v[52:55], a[196:199]
  v_exp_f32 v84, v84
  v_mfma_f32_16x16x32_bf16 v[136:139], a[8:11], v[48:51], v[136:139]
  ds_read_b128 a[52:55], v3 offset:5120
  v_cvt_pk_bf16_f32 v41, v82, v83
  v_mfma_f32_16x16x32_bf16 v[168:171], a[8:11], v[52:55], v[168:171]
  v_exp_f32 v85, v85
  v_mfma_f32_16x16x32_bf16 v[200:203], a[8:11], v[56:59], v[200:203]
  v_cvt_pk_bf16_f32 v42, v84, v85
  v_mfma_f32_16x16x32_bf16 v[232:235], a[8:11], v[60:63], v[232:235]
  v_exp_f32 v86, v86
  v_mfma_f32_16x16x32_bf16 a[200:203], a[208:211], v[56:59], a[200:203]
  v_mfma_f32_16x16x32_bf16 v[140:143], a[12:15], v[48:51], v[140:143]
  v_exp_f32 v87, v87
  v_mfma_f32_16x16x32_bf16 v[172:175], a[12:15], v[52:55], v[172:175]
  buffer_load_dwordx4 v2, s[20:23], s29 offen offset:2048 sc1 lds
  v_mfma_f32_16x16x32_bf16 v[204:207], a[12:15], v[56:59], v[204:207]
  v_exp_f32 v88, v88
  v_mfma_f32_16x16x32_bf16 v[236:239], a[12:15], v[60:63], v[236:239]
  ds_read_b128 a[56:59], v3 offset:6144
  v_cvt_pk_bf16_f32 v43, v86, v87
  v_mfma_f32_16x16x32_bf16 a[204:207], a[208:211], v[60:63], a[204:207]
  s_waitcnt lgkmcnt(7)
  v_exp_f32 v89, v89
  v_mfma_f32_16x16x32_bf16 v[144:147], a[16:19], v[48:51], v[144:147]
  ds_read_b128 a[60:63], v3 offset:7168
  v_cvt_pk_bf16_f32 v44, v88, v89
  v_mfma_f32_16x16x32_bf16 v[176:179], a[16:19], v[52:55], v[176:179]
  v_exp_f32 v90, v90
  v_mfma_f32_16x16x32_bf16 v[208:211], a[16:19], v[56:59], v[208:211]
  v_mfma_f32_16x16x32_bf16 v[240:243], a[16:19], v[60:63], v[240:243]
  v_exp_f32 v91, v91
  v_mfma_f32_16x16x32_bf16 v[148:151], a[20:23], v[48:51], v[148:151]
  buffer_load_dwordx4 v2, s[20:23], s29 offen offset:3072 sc1 lds
  v_mfma_f32_16x16x32_bf16 v[180:183], a[20:23], v[52:55], v[180:183]
  s_xor_b32 s27, s27, 0x4000
  v_exp_f32 v92, v92
  v_mfma_f32_16x16x32_bf16 v[212:215], a[20:23], v[56:59], v[212:215]
  s_add_u32 s29, s29, 0x8000
  v_xor_b32 v4, 0x8000, v4
  v_cvt_pk_bf16_f32 v45, v90, v91
  v_mfma_f32_16x16x32_bf16 v[244:247], a[20:23], v[60:63], v[244:247]
  v_exp_f32 v93, v93
  v_mfma_f32_16x16x32_bf16 v[152:155], a[24:27], v[48:51], v[152:155]
  ds_read_b128 a[0:3], v4 offset:0
  ds_read_b128 a[4:7], v4 offset:1024
  v_mfma_f32_16x16x32_bf16 v[184:187], a[24:27], v[52:55], v[184:187]
  v_exp_f32 v94, v94
  v_mfma_f32_16x16x32_bf16 v[216:219], a[24:27], v[56:59], v[216:219]
  v_cvt_pk_bf16_f32 v46, v92, v93
  v_mfma_f32_16x16x32_bf16 v[248:251], a[24:27], v[60:63], v[248:251]
  v_exp_f32 v95, v95
  v_mfma_f32_16x16x32_bf16 v[156:159], a[28:31], v[48:51], v[156:159]
  ds_read_b128 a[8:11], v4 offset:2048
  v_cvt_pk_bf16_f32 v47, v94, v95
  v_mfma_f32_16x16x32_bf16 v[188:191], a[28:31], v[52:55], v[188:191]
  v_mfma_f32_16x16x32_bf16 v[220:223], a[28:31], v[56:59], v[220:223]
  v_mfma_f32_16x16x32_bf16 v[252:255], a[28:31], v[60:63], v[252:255]
La_d1:
  s_waitcnt lgkmcnt(7)
  v_mfma_f32_16x16x32_bf16 v[72:75], a[32:35], a[144:147], v[20:23]
  buffer_load_dwordx4 a[64:67], v2, s[8:11], s6 offen offset:0
  v_mfma_f32_16x16x32_bf16 v[72:75], a[36:39], a[148:151], v[72:75]
  v_cndmask_b32 v96, v96, v5, s[48:49]
  v_exp_f32 v96, v96
  v_mfma_f32_16x16x32_bf16 v[72:75], a[40:43], a[152:155], v[72:75]
  v_cndmask_b32 v97, v97, v5, s[50:51]
  v_exp_f32 v97, v97
  v_mfma_f32_16x16x32_bf16 v[72:75], a[44:47], a[156:159], v[72:75]
  v_cndmask_b32 v98, v98, v5, s[52:53]
  v_exp_f32 v98, v98
  v_mfma_f32_16x16x32_bf16 v[80:83], a[32:35], a[160:163], v[24:27]
  ds_read_b128 a[12:15], v4 offset:3072
  ds_read_b128 a[16:19], v4 offset:4096
  v_mfma_f32_16x16x32_bf16 v[80:83], a[36:39], a[164:167], v[80:83]
  v_cndmask_b32 v99, v99, v5, s[54:55]
  v_exp_f32 v99, v99
  v_mfma_f32_16x16x32_bf16 v[80:83], a[40:43], a[168:171], v[80:83]
  buffer_load_dwordx4 a[64:67], v2, s[8:11], s6 offen offset:1024
  v_mfma_f32_16x16x32_bf16 v[80:83], a[44:47], a[172:175], v[80:83]
  v_cndmask_b32 v100, v100, v5, s[56:57]
  v_exp_f32 v100, v100
  v_mfma_f32_16x16x32_bf16 v[88:91], a[32:35], a[176:179], v[28:31]
  ds_read_b128 a[20:23], v4 offset:5120
  v_cndmask_b32 v101, v101, v5, s[58:59]
  v_mfma_f32_16x16x32_bf16 v[88:91], a[36:39], a[180:183], v[88:91]
  v_exp_f32 v101, v101
  v_mfma_f32_16x16x32_bf16 v[88:91], a[40:43], a[184:187], v[88:91]
  v_cndmask_b32 v102, v102, v5, s[60:61]
  v_exp_f32 v102, v102
  v_mfma_f32_16x16x32_bf16 v[88:91], a[44:47], a[188:191], v[88:91]
  s_waitcnt lgkmcnt(6)
  ds_read_b128 a[24:27], v4 offset:6144
  v_cndmask_b32 v103, v103, v5, s[62:63]
  v_mfma_f32_16x16x32_bf16 v[76:79], a[48:51], a[144:147], v[20:23]
  v_exp_f32 v103, v103
  v_mfma_f32_16x16x32_bf16 v[76:79], a[52:55], a[148:151], v[76:79]
  buffer_load_dwordx4 a[64:67], v2, s[8:11], s6 offen offset:2048
  v_mfma_f32_16x16x32_bf16 v[76:79], a[56:59], a[152:155], v[76:79]
  v_exp_f32 v104, v104
  v_mfma_f32_16x16x32_bf16 v[76:79], a[60:63], a[156:159], v[76:79]
  ds_read_b128 a[28:31], v4 offset:7168
  ds_read_b128 a[32:35], v3 offset:8192
  v_mfma_f32_16x16x32_bf16 v[84:87], a[48:51], a[160:163], v[24:27]
  v_exp_f32 v105, v105
  v_mfma_f32_16x16x32_bf16 v[84:87], a[52:55], a[164:167], v[84:87]
  buffer_load_dwordx4 a[64:67], v2, s[8:11], s6 offen offset:3072
  v_mfma_f32_16x16x32_bf16 v[84:87], a[56:59], a[168:171], v[84:87]
  s_add_u32 s6, s6, 4096
  v_exp_f32 v106, v106
  v_mfma_f32_16x16x32_bf16 v[84:87], a[60:63], a[172:175], v[84:87]
  v_exp_f32 v107, v107
  v_mfma_f32_16x16x32_bf16 v[92:95], a[48:51], a[176:179], v[28:31]
  ds_read_b128 a[36:39], v3 offset:9216
  v_cvt_pk_bf16_f32 v48, v96, v97
  v_mfma_f32_16x16x32_bf16 v[92:95], a[52:55], a[180:183], v[92:95]
  v_exp_f32 v108, v108
  v_mfma_f32_16x16x32_bf16 v[92:95], a[56:59], a[184:187], v[92:95]
  buffer_load_dwordx4 a[64:67], v2, s[8:11], s6 offen offset:0
  v_mfma_f32_16x16x32_bf16 v[92:95], a[60:63], a[188:191], v[92:95]
  s_waitcnt lgkmcnt(6)
  v_exp_f32 v109, v109
  v_mfma_f32_16x16x32_bf16 v[128:131], a[0:3], v[32:35], v[128:131]
  ds_read_b128 a[40:43], v3 offset:10240
  ds_read_b128 a[44:47], v3 offset:11264
  v_mfma_f32_16x16x32_bf16 v[160:163], a[0:3], v[36:39], v[160:163]
  v_exp_f32 v110, v110
  v_mfma_f32_16x16x32_bf16 v[192:195], a[0:3], v[40:43], v[192:195]
  v_cvt_pk_bf16_f32 v49, v98, v99
  v_cvt_pk_bf16_f32 v50, v100, v101
  v_mfma_f32_16x16x32_bf16 v[224:227], a[0:3], v[44:47], v[224:227]
  v_exp_f32 v111, v111
  v_mfma_f32_16x16x32_bf16 a[192:195], a[208:211], v[32:35], a[192:195]
  buffer_load_dwordx4 a[64:67], v2, s[8:11], s6 offen offset:1024
  v_mfma_f32_16x16x32_bf16 v[132:135], a[4:7], v[32:35], v[132:135]
  v_exp_f32 v112, v112
  v_mfma_f32_16x16x32_bf16 v[164:167], a[4:7], v[36:39], v[164:167]
  v_exp_f32 v113, v113
  v_mfma_f32_16x16x32_bf16 v[196:199], a[4:7], v[40:43], v[196:199]
  ds_read_b128 a[48:51], v3 offset:12288
  v_cvt_pk_bf16_f32 v51, v102, v103
  v_mfma_f32_16x16x32_bf16 v[228:231], a[4:7], v[44:47], v[228:231]
  v_exp_f32 v114, v114
  v_mfma_f32_16x16x32_bf16 a[196:199], a[208:211], v[36:39], a[196:199]
  buffer_load_dwordx4 a[64:67], v2, s[8:11], s6 offen offset:2048
  v_mfma_f32_16x16x32_bf16 v[136:139], a[8:11], v[32:35], v[136:139]
  v_exp_f32 v115, v115
  v_mfma_f32_16x16x32_bf16 v[168:171], a[8:11], v[36:39], v[168:171]
  ds_read_b128 a[52:55], v3 offset:13312
  v_cvt_pk_bf16_f32 v52, v104, v105
  v_mfma_f32_16x16x32_bf16 v[200:203], a[8:11], v[40:43], v[200:203]
  v_exp_f32 v116, v116
  v_mfma_f32_16x16x32_bf16 v[232:235], a[8:11], v[44:47], v[232:235]
  v_cvt_pk_bf16_f32 v53, v106, v107
  v_cvt_pk_bf16_f32 v54, v108, v109
  v_mfma_f32_16x16x32_bf16 a[200:203], a[208:211], v[40:43], a[200:203]
  v_exp_f32 v117, v117
  v_mfma_f32_16x16x32_bf16 v[140:143], a[12:15], v[32:35], v[140:143]
  v_exp_f32 v118, v118
  v_mfma_f32_16x16x32_bf16 v[172:175], a[12:15], v[36:39], v[172:175]
  buffer_load_dwordx4 a[64:67], v2, s[8:11], s6 offen offset:3072
  v_mfma_f32_16x16x32_bf16 v[204:207], a[12:15], v[40:43], v[204:207]
  v_exp_f32 v119, v119
  v_mfma_f32_16x16x32_bf16 v[236:239], a[12:15], v[44:47], v[236:239]
  ds_read_b128 a[56:59], v3 offset:14336
  v_cvt_pk_bf16_f32 v55, v110, v111
  v_mfma_f32_16x16x32_bf16 a[204:207], a[208:211], v[44:47], a[204:207]
  s_waitcnt lgkmcnt(7)
  v_exp_f32 v120, v120
  v_mfma_f32_16x16x32_bf16 v[144:147], a[16:19], v[32:35], v[144:147]
  buffer_load_dwordx4 a[64:67], v2, s[12:15], s7 offen offset:0
  v_mfma_f32_16x16x32_bf16 v[176:179], a[16:19], v[36:39], v[176:179]
  v_exp_f32 v121, v121
  v_mfma_f32_16x16x32_bf16 v[208:211], a[16:19], v[40:43], v[208:211]
  ds_read_b128 a[60:63], v3 offset:15360
  v_cvt_pk_bf16_f32 v56, v112, v113
  v_mfma_f32_16x16x32_bf16 v[240:243], a[16:19], v[44:47], v[240:243]
  v_exp_f32 v122, v122
  v_mfma_f32_16x16x32_bf16 v[148:151], a[20:23], v[32:35], v[148:151]
  v_exp_f32 v123, v123
  v_mfma_f32_16x16x32_bf16 v[180:183], a[20:23], v[36:39], v[180:183]
  ds_read_b128 a[0:3], v4 offset:8192
  v_cvt_pk_bf16_f32 v57, v114, v115
  v_mfma_f32_16x16x32_bf16 v[212:215], a[20:23], v[40:43], v[212:215]
  v_exp_f32 v124, v124
  v_mfma_f32_16x16x32_bf16 v[244:247], a[20:23], v[44:47], v[244:247]
  buffer_load_dwordx4 a[64:67], v2, s[12:15], s7 offen offset:1024
  v_mfma_f32_16x16x32_bf16 v[152:155], a[24:27], v[32:35], v[152:155]
  v_exp_f32 v125, v125
  v_mfma_f32_16x16x32_bf16 v[184:187], a[24:27], v[36:39], v[184:187]
  ds_read_b128 a[4:7], v4 offset:9216
  v_cvt_pk_bf16_f32 v58, v116, v117
  v_mfma_f32_16x16x32_bf16 v[216:219], a[24:27], v[40:43], v[216:219]
  v_exp_f32 v126, v126
  v_mfma_f32_16x16x32_bf16 v[248:251], a[24:27], v[44:47], v[248:251]
  v_cvt_pk_bf16_f32 v59, v118, v119
  v_cvt_pk_bf16_f32 v60, v120, v121
  v_mfma_f32_16x16x32_bf16 v[156:159], a[28:31], v[32:35], v[156:159]
  v_exp_f32 v127, v127
  v_mfma_f32_16x16x32_bf16 v[188:191], a[28:31], v[36:39], v[188:191]
  ds_read_b128 a[8:11], v4 offset:10240
  v_cvt_pk_bf16_f32 v61, v122, v123
  v_mfma_f32_16x16x32_bf16 v[220:223], a[28:31], v[40:43], v[220:223]
  s_waitcnt vmcnt(22)
  s_barrier
  v_mfma_f32_16x16x32_bf16 v[252:255], a[28:31], v[44:47], v[252:255]
  v_cvt_pk_bf16_f32 v62, v124, v125
  v_cvt_pk_bf16_f32 v63, v126, v127
  s_waitcnt lgkmcnt(7)
  v_mfma_f32_16x16x32_bf16 v[104:107], a[32:35], a[144:147], v[20:23]
  s_mov_b32 m0, s26
  ds_read_b128 a[12:15], v4 offset:11264
  v_cndmask_b32 v72, v72, v5, s[32:33]
  v_mfma_f32_16x16x32_bf16 v[104:107], a[36:39], a[148:151], v[104:107]
  v_exp_f32 v72, v72
  v_mfma_f32_16x16x32_bf16 v[104:107], a[40:43], a[152:155], v[104:107]
  v_cndmask_b32 v73, v73, v5, s[34:35]
  v_exp_f32 v73, v73
  v_mfma_f32_16x16x32_bf16 v[104:107], a[44:47], a[156:159], v[104:107]
  buffer_load_dwordx4 v2, s[20:23], s28 offen offset:0 sc1 lds
  v_mfma_f32_16x16x32_bf16 v[112:115], a[32:35], a[160:163], v[24:27]
  v_cndmask_b32 v74, v74, v5, s[36:37]
  v_exp_f32 v74, v74
  v_mfma_f32_16x16x32_bf16 v[112:115], a[36:39], a[164:167], v[112:115]
  ds_read_b128 a[16:19], v4 offset:12288
  v_cndmask_b32 v76, v76, v5, s[40:41]
  v_mfma_f32_16x16x32_bf16 v[112:115], a[40:43], a[168:171], v[112:115]
  ds_read_b128 a[20:23], v4 offset:13312
  v_cndmask_b32 v75, v75, v5, s[38:39]
  v_mfma_f32_16x16x32_bf16 v[112:115], a[44:47], a[172:175], v[112:115]
  v_exp_f32 v75, v75
  v_mfma_f32_16x16x32_bf16 v[120:123], a[32:35], a[176:179], v[28:31]
  buffer_load_dwordx4 v2, s[20:23], s28 offen offset:1024 sc1 lds
  v_mfma_f32_16x16x32_bf16 v[120:123], a[36:39], a[180:183], v[120:123]
  v_exp_f32 v76, v76
  v_mfma_f32_16x16x32_bf16 v[120:123], a[40:43], a[184:187], v[120:123]
  ds_read_b128 a[24:27], v4 offset:14336
  v_cndmask_b32 v79, v79, v5, s[46:47]
  v_mfma_f32_16x16x32_bf16 v[120:123], a[44:47], a[188:191], v[120:123]
  s_waitcnt lgkmcnt(7)
  v_cndmask_b32 v77, v77, v5, s[42:43]
  v_cndmask_b32 v78, v78, v5, s[44:45]
  v_mfma_f32_16x16x32_bf16 v[108:111], a[48:51], a[144:147], v[20:23]
  v_exp_f32 v77, v77
  v_mfma_f32_16x16x32_bf16 v[108:111], a[52:55], a[148:151], v[108:111]
  ds_read_b128 a[28:31], v4 offset:15360
  v_xor_b32 v4, 0x4000, v4
  v_mfma_f32_16x16x32_bf16 v[108:111], a[56:59], a[152:155], v[108:111]
  v_exp_f32 v78, v78
  v_mfma_f32_16x16x32_bf16 v[108:111], a[60:63], a[156:159], v[108:111]
  buffer_load_dwordx4 v2, s[20:23], s28 offen offset:2048 sc1 lds
  v_mfma_f32_16x16x32_bf16 v[116:119], a[48:51], a[160:163], v[24:27]
  v_exp_f32 v79, v79
  v_mfma_f32_16x16x32_bf16 v[116:119], a[52:55], a[164:167], v[116:119]
  v_xor_b32 v3, 0x8000, v3
  v_cvt_pk_bf16_f32 v36, v72, v73
  v_mfma_f32_16x16x32_bf16 v[116:119], a[56:59], a[168:171], v[116:119]
  ds_read_b128 a[32:35], v3 offset:0
  ds_read_b128 a[36:39], v3 offset:1024
  v_mfma_f32_16x16x32_bf16 v[116:119], a[60:63], a[172:175], v[116:119]
  v_exp_f32 v80, v80
  v_mfma_f32_16x16x32_bf16 v[124:127], a[48:51], a[176:179], v[28:31]
  v_cvt_pk_bf16_f32 v37, v74, v75
  v_cvt_pk_bf16_f32 v38, v76, v77
  v_mfma_f32_16x16x32_bf16 v[124:127], a[52:55], a[180:183], v[124:127]
  v_exp_f32 v81, v81
  v_mfma_f32_16x16x32_bf16 v[124:127], a[56:59], a[184:187], v[124:127]
  buffer_load_dwordx4 v2, s[20:23], s28 offen offset:3072 sc1 lds
  v_mfma_f32_16x16x32_bf16 v[124:127], a[60:63], a[188:191], v[124:127]
  s_waitcnt lgkmcnt(6)
  s_xor_b32 s26, s26, 0x4000
  s_add_u32 s28, s28, 0x8000
  v_mfma_f32_16x16x32_bf16 v[128:131], a[0:3], v[48:51], v[128:131]
  s_mov_b32 m0, s27
  v_exp_f32 v82, v82
  v_mfma_f32_16x16x32_bf16 v[160:163], a[0:3], v[52:55], v[160:163]
  ds_read_b128 a[40:43], v3 offset:2048
  ds_read_b128 a[44:47], v3 offset:3072
  v_mfma_f32_16x16x32_bf16 v[192:195], a[0:3], v[56:59], v[192:195]
  v_exp_f32 v83, v83
  v_mfma_f32_16x16x32_bf16 v[224:227], a[0:3], v[60:63], v[224:227]
  v_cvt_pk_bf16_f32 v39, v78, v79
  v_cvt_pk_bf16_f32 v40, v80, v81
  v_mfma_f32_16x16x32_bf16 a[192:195], a[208:211], v[48:51], a[192:195]
  buffer_load_dwordx4 v2, s[20:23], s29 offen offset:0 sc1 lds
  v_mfma_f32_16x16x32_bf16 v[132:135], a[4:7], v[48:51], v[132:135]
  v_exp_f32 v84, v84
  v_mfma_f32_16x16x32_bf16 v[164:167], a[4:7], v[52:55], v[164:167]
  ds_read_b128 a[48:51], v3 offset:4096
  v_cvt_pk_bf16_f32 v41, v82, v83
  v_mfma_f32_16x16x32_bf16 v[196:199], a[4:7], v[56:59], v[196:199]
  v_exp_f32 v85, v85
  v_mfma_f32_16x16x32_bf16 v[228:231], a[4:7], v[60:63], v[228:231]
  v_cvt_pk_bf16_f32 v42, v84, v85
  v_mfma_f32_16x16x32_bf16 a[196:199], a[208:211], v[52:55], a[196:199]
  v_exp_f32 v86, v86
  v_mfma_f32_16x16x32_bf16 v[136:139], a[8:11], v[48:51], v[136:139]
  ds_read_b128 a[52:55], v3 offset:5120
  v_mfma_f32_16x16x32_bf16 v[168:171], a[8:11], v[52:55], v[168:171]
  buffer_load_dwordx4 v2, s[20:23], s29 offen offset:1024 sc1 lds
  v_mfma_f32_16x16x32_bf16 v[200:203], a[8:11], v[56:59], v[200:203]
  v_exp_f32 v87, v87
  v_mfma_f32_16x16x32_bf16 v[232:235], a[8:11], v[60:63], v[232:235]
  v_cvt_pk_bf16_f32 v43, v86, v87
  v_mfma_f32_16x16x32_bf16 a[200:203], a[208:211], v[56:59], a[200:203]
  v_exp_f32 v88, v88
  v_mfma_f32_16x16x32_bf16 v[140:143], a[12:15], v[48:51], v[140:143]
  ds_read_b128 a[56:59], v3 offset:6144
  v_mfma_f32_16x16x32_bf16 v[172:175], a[12:15], v[52:55], v[172:175]
  v_mfma_f32_16x16x32_bf16 v[204:207], a[12:15], v[56:59], v[204:207]
  v_exp_f32 v89, v89
  v_mfma_f32_16x16x32_bf16 v[236:239], a[12:15], v[60:63], v[236:239]
  buffer_load_dwordx4 v2, s[20:23], s29 offen offset:2048 sc1 lds
  v_mfma_f32_16x16x32_bf16 a[204:207], a[208:211], v[60:63], a[204:207]
  s_waitcnt lgkmcnt(7)
  v_exp_f32 v90, v90
  v_mfma_f32_16x16x32_bf16 v[144:147], a[16:19], v[48:51], v[144:147]
  ds_read_b128 a[60:63], v3 offset:7168
  v_cvt_pk_bf16_f32 v44, v88, v89
  v_mfma_f32_16x16x32_bf16 v[176:179], a[16:19], v[52:55], v[176:179]
  v_exp_f32 v91, v91
  v_mfma_f32_16x16x32_bf16 v[208:211], a[16:19], v[56:59], v[208:211]
  v_cvt_pk_bf16_f32 v45, v90, v91
  v_mfma_f32_16x16x32_bf16 v[240:243], a[16:19], v[60:63], v[240:243]
  v_mfma_f32_16x16x32_bf16 v[148:151], a[20:23], v[48:51], v[148:151]
  v_exp_f32 v92, v92
  v_mfma_f32_16x16x32_bf16 v[180:183], a[20:23], v[52:55], v[180:183]
  buffer_load_dwordx4 v2, s[20:23], s29 offen offset:3072 sc1 lds
  v_mfma_f32_16x16x32_bf16 v[212:215], a[20:23], v[56:59], v[212:215]
  s_xor_b32 s27, s27, 0x8000
  v_exp_f32 v93, v93
  v_mfma_f32_16x16x32_bf16 v[244:247], a[20:23], v[60:63], v[244:247]
  s_add_u32 s29, s29, 0x8000
  ds_read_b128 a[0:3], v3 offset:8192
  v_cvt_pk_bf16_f32 v46, v92, v93
  v_mfma_f32_16x16x32_bf16 v[152:155], a[24:27], v[48:51], v[152:155]
  ds_read_b128 a[4:7], v3 offset:9216
  v_mfma_f32_16x16x32_bf16 v[184:187], a[24:27], v[52:55], v[184:187]
  v_exp_f32 v94, v94
  v_mfma_f32_16x16x32_bf16 v[216:219], a[24:27], v[56:59], v[216:219]
  v_mfma_f32_16x16x32_bf16 v[248:251], a[24:27], v[60:63], v[248:251]
  v_exp_f32 v95, v95
  v_mfma_f32_16x16x32_bf16 v[156:159], a[28:31], v[48:51], v[156:159]
  ds_read_b128 a[8:11], v3 offset:10240
  v_cvt_pk_bf16_f32 v47, v94, v95
  v_mfma_f32_16x16x32_bf16 v[188:191], a[28:31], v[52:55], v[188:191]
  v_mfma_f32_16x16x32_bf16 v[220:223], a[28:31], v[56:59], v[220:223]
  s_waitcnt vmcnt(22)
  s_barrier
  v_mfma_f32_16x16x32_bf16 v[252:255], a[28:31], v[60:63], v[252:255]
  s_lshr_b32 s91, s73, 1
  s_lshl_b32 s91, s91, 11
  s_add_u32 s91, s91, 32768
  v_and_b32 v14, 15, v1
  v_lshlrev_b32 v14, 7, v14
  s_waitcnt lgkmcnt(3)
  v_mfma_f32_16x16x32_bf16 v[64:67], a[32:35], a[160:163], v[24:27]
  s_mov_b32 m0, s26
  ds_read_b128 a[12:15], v3 offset:11264
  v_cndmask_b32 v104, v104, v5, s[48:49]
  v_mfma_f32_16x16x32_bf16 v[64:67], a[36:39], a[164:167], v[64:67]
  v_exp_f32 v104, v104
  v_mfma_f32_16x16x32_bf16 v[64:67], a[40:43], a[168:171], v[64:67]
  v_cndmask_b32 v105, v105, v5, s[50:51]
  v_exp_f32 v105, v105
  v_mfma_f32_16x16x32_bf16 v[64:67], a[44:47], a[172:175], v[64:67]
  buffer_load_dwordx4 v2, s[20:23], s28 offen offset:0 sc1 lds
  v_mfma_f32_16x16x32_bf16 v[72:75], a[32:35], a[176:179], v[28:31]
  v_cndmask_b32 v106, v106, v5, s[52:53]
  v_exp_f32 v106, v106
  v_mfma_f32_16x16x32_bf16 v[72:75], a[36:39], a[180:183], v[72:75]
  ds_read_b128 a[16:19], v3 offset:12288
  ds_read_b128 a[20:23], v3 offset:13312
  v_mfma_f32_16x16x32_bf16 v[72:75], a[40:43], a[184:187], v[72:75]
  buffer_load_dwordx4 v2, s[20:23], s28 offen offset:1024 sc1 lds
  v_mfma_f32_16x16x32_bf16 v[72:75], a[44:47], a[188:191], v[72:75]
  v_cndmask_b32 v107, v107, v5, s[54:55]
  v_exp_f32 v107, v107
  v_mfma_f32_16x16x32_bf16 v[68:71], a[48:51], a[160:163], v[24:27]
  ds_read_b128 a[24:27], v3 offset:14336
  ds_read_b128 a[28:31], v3 offset:15360
  v_mfma_f32_16x16x32_bf16 v[68:71], a[52:55], a[164:167], v[68:71]
  v_cndmask_b32 v108, v108, v5, s[56:57]
  v_exp_f32 v108, v108
  v_mfma_f32_16x16x32_bf16 v[68:71], a[56:59], a[168:171], v[68:71]
  ds_read_b128 a[32:35], v4 offset:0
  v_cndmask_b32 v109, v109, v5, s[58:59]
  v_mfma_f32_16x16x32_bf16 v[68:71], a[60:63], a[172:175], v[68:71]
  v_exp_f32 v109, v109
  v_mfma_f32_16x16x32_bf16 v[76:79], a[48:51], a[176:179], v[28:31]
  ds_read_b128 a[36:39], v4 offset:1024
  v_cndmask_b32 v110, v110, v5, s[60:61]
  v_mfma_f32_16x16x32_bf16 v[76:79], a[52:55], a[180:183], v[76:79]
  buffer_load_dwordx4 v2, s[20:23], s28 offen offset:2048 sc1 lds
  v_mfma_f32_16x16x32_bf16 v[76:79], a[56:59], a[184:187], v[76:79]
  v_exp_f32 v110, v110
  v_mfma_f32_16x16x32_bf16 v[76:79], a[60:63], a[188:191], v[76:79]
  s_waitcnt lgkmcnt(2)
  ds_read_b128 a[40:43], v4 offset:2048
  v_cndmask_b32 v111, v111, v5, s[62:63]
  v_mfma_f32_16x16x32_bf16 v[80:83], a[0:3], a[160:163], v[24:27]
  v_exp_f32 v111, v111
  v_mfma_f32_16x16x32_bf16 v[80:83], a[4:7], a[164:167], v[80:83]
  ds_read_b128 a[44:47], v4 offset:3072
  v_cvt_pk_bf16_f32 v52, v104, v105
  v_mfma_f32_16x16x32_bf16 v[80:83], a[8:11], a[168:171], v[80:83]
  ds_read_b128 a[48:51], v4 offset:4096
  v_cvt_pk_bf16_f32 v53, v106, v107
  v_mfma_f32_16x16x32_bf16 v[80:83], a[12:15], a[172:175], v[80:83]
  v_exp_f32 v112, v112
  v_mfma_f32_16x16x32_bf16 v[88:91], a[0:3], a[176:179], v[28:31]
  buffer_load_dwordx4 v2, s[20:23], s28 offen offset:3072 sc1 lds
  v_mfma_f32_16x16x32_bf16 v[88:91], a[4:7], a[180:183], v[88:91]
  s_xor_b32 s26, s26, 0x8000
  v_exp_f32 v113, v113
  v_mfma_f32_16x16x32_bf16 v[88:91], a[8:11], a[184:187], v[88:91]
  s_add_u32 s28, s28, 0x8000
  s_mov_b32 m0, s27
  ds_read_b128 a[52:55], v4 offset:5120
  v_mfma_f32_16x16x32_bf16 v[88:91], a[12:15], a[188:191], v[88:91]
  v_exp_f32 v114, v114
  v_mfma_f32_16x16x32_bf16 v[84:87], a[16:19], a[160:163], v[24:27]
  ds_read_b128 a[56:59], v4 offset:6144
  ds_read_b128 a[60:63], v4 offset:7168
  v_mfma_f32_16x16x32_bf16 v[84:87], a[20:23], a[164:167], v[84:87]
  v_xor_b32 v3, 0x4000, v3
  v_cvt_pk_bf16_f32 v54, v108, v109
  v_mfma_f32_16x16x32_bf16 v[84:87], a[24:27], a[168:171], v[84:87]
  v_exp_f32 v115, v115
  v_mfma_f32_16x16x32_bf16 v[84:87], a[28:31], a[172:175], v[84:87]
  buffer_load_dwordx4 v2, s[20:23], s29 offen offset:0 sc1 lds
  v_mfma_f32_16x16x32_bf16 v[92:95], a[16:19], a[176:179], v[28:31]
  v_exp_f32 v116, v116
  v_mfma_f32_16x16x32_bf16 v[92:95], a[20:23], a[180:183], v[92:95]
  ds_read_b128 a[0:3], v3 offset:0
  ds_read_b128 a[4:7], v3 offset:1024
  v_mfma_f32_16x16x32_bf16 v[92:95], a[24:27], a[184:187], v[92:95]
  v_exp_f32 v117, v117
  v_mfma_f32_16x16x32_bf16 v[92:95], a[28:31], a[188:191], v[92:95]
  s_waitcnt lgkmcnt(6)
  ds_read_b128 a[8:11], v3 offset:2048
  v_cvt_pk_bf16_f32 v55, v110, v111
  v_mfma_f32_16x16x32_bf16 v[160:163], a[32:35], v[36:39], v[160:163]
  ds_read_b128 a[12:15], v3 offset:3072
  v_cvt_pk_bf16_f32 v56, v112, v113
  v_mfma_f32_16x16x32_bf16 v[192:195], a[32:35], v[40:43], v[192:195]
  v_exp_f32 v118, v118
  v_mfma_f32_16x16x32_bf16 v[224:227], a[32:35], v[44:47], v[224:227]
  buffer_load_dwordx4 v2, s[20:23], s29 offen offset:1024 sc1 lds
  v_mfma_f32_16x16x32_bf16 a[196:199], a[208:211], v[36:39], a[196:199]
  v_exp_f32 v119, v119
  v_mfma_f32_16x16x32_bf16 v[164:167], a[36:39], v[36:39], v[164:167]
  ds_read_b128 a[16:19], v3 offset:4096
  v_cvt_pk_bf16_f32 v57, v114, v115
  v_mfma_f32_16x16x32_bf16 v[196:199], a[36:39], v[40:43], v[196:199]
  v_cvt_pk_bf16_f32 v58, v116, v117
  v_cvt_pk_bf16_f32 v59, v118, v119
  v_mfma_f32_16x16x32_bf16 v[228:231], a[36:39], v[44:47], v[228:231]
  v_exp_f32 v120, v120
  v_mfma_f32_16x16x32_bf16 a[200:203], a[208:211], v[40:43], a[200:203]
  v_mfma_f32_16x16x32_bf16 v[168:171], a[40:43], v[36:39], v[168:171]
  v_exp_f32 v121, v121
  v_mfma_f32_16x16x32_bf16 v[200:203], a[40:43], v[40:43], v[200:203]
  buffer_load_dwordx4 v2, s[20:23], s29 offen offset:2048 sc1 lds
  v_mfma_f32_16x16x32_bf16 v[232:235], a[40:43], v[44:47], v[232:235]
  v_exp_f32 v122, v122
  v_mfma_f32_16x16x32_bf16 a[204:207], a[208:211], v[44:47], a[204:207]
  ds_read_b128 a[20:23], v3 offset:5120
  v_cvt_pk_bf16_f32 v60, v120, v121
  v_mfma_f32_16x16x32_bf16 v[172:175], a[44:47], v[36:39], v[172:175]
  ds_read_b128 a[24:27], v3 offset:6144
  v_mfma_f32_16x16x32_bf16 v[204:207], a[44:47], v[40:43], v[204:207]
  v_exp_f32 v123, v123
  v_mfma_f32_16x16x32_bf16 v[236:239], a[44:47], v[44:47], v[236:239]
  s_waitcnt lgkmcnt(7)
  v_cvt_pk_bf16_f32 v61, v122, v123
  v_mfma_f32_16x16x32_bf16 v[176:179], a[48:51], v[36:39], v[176:179]
  v_exp_f32 v124, v124
  v_mfma_f32_16x16x32_bf16 v[208:211], a[48:51], v[40:43], v[208:211]
  buffer_load_dwordx4 v2, s[20:23], s29 offen offset:3072 sc1 lds
  v_mfma_f32_16x16x32_bf16 v[240:243], a[48:51], v[44:47], v[240:243]
  s_xor_b32 s27, s27, 0x4000
  v_exp_f32 v125, v125
  v_mfma_f32_16x16x32_bf16 v[180:183], a[52:55], v[36:39], v[180:183]
  s_add_u32 s29, s29, 0x8000
  ds_read_b128 a[28:31], v3 offset:7168
  ds_read_b128 a[32:35], v3 offset:8192
  v_mfma_f32_16x16x32_bf16 v[212:215], a[52:55], v[40:43], v[212:215]
  v_cvt_pk_bf16_f32 v62, v124, v125
  v_mfma_f32_16x16x32_bf16 v[244:247], a[52:55], v[44:47], v[244:247]
  v_exp_f32 v126, v126
  v_mfma_f32_16x16x32_bf16 v[184:187], a[56:59], v[36:39], v[184:187]
  ds_read_b128 a[36:39], v3 offset:9216
  v_mfma_f32_16x16x32_bf16 v[216:219], a[56:59], v[40:43], v[216:219]
  v_exp_f32 v127, v127
  v_mfma_f32_16x16x32_bf16 v[248:251], a[56:59], v[44:47], v[248:251]
  v_cvt_pk_bf16_f32 v63, v126, v127
  v_mfma_f32_16x16x32_bf16 v[188:191], a[60:63], v[36:39], v[188:191]
  ds_read_b128 a[40:43], v3 offset:10240
  v_mfma_f32_16x16x32_bf16 v[220:223], a[60:63], v[40:43], v[220:223]
  s_waitcnt vmcnt(12)
  s_barrier
  v_mfma_f32_16x16x32_bf16 v[252:255], a[60:63], v[44:47], v[252:255]
  s_waitcnt lgkmcnt(3)
  v_mfma_f32_16x16x32_bf16 v[96:99], a[0:3], a[160:163], v[24:27]
  s_mov_b32 m0, s26
  v_exp_f32 v64, v64
  v_mfma_f32_16x16x32_bf16 v[96:99], a[4:7], a[164:167], v[96:99]
  v_exp_f32 v65, v65
  v_mfma_f32_16x16x32_bf16 v[96:99], a[8:11], a[168:171], v[96:99]
  buffer_load_dwordx4 v2, s[20:23], s28 offen offset:0 sc1 lds
  v_mfma_f32_16x16x32_bf16 v[96:99], a[12:15], a[172:175], v[96:99]
  v_exp_f32 v66, v66
  v_mfma_f32_16x16x32_bf16 v[104:107], a[0:3], a[176:179], v[28:31]
  ds_read_b128 a[44:47], v3 offset:11264
  ds_read_b128 a[48:51], v3 offset:12288
  v_mfma_f32_16x16x32_bf16 v[104:107], a[4:7], a[180:183], v[104:107]
  v_exp_f32 v67, v67
  v_mfma_f32_16x16x32_bf16 v[104:107], a[8:11], a[184:187], v[104:107]
  ds_read_b128 a[52:55], v3 offset:13312
  ds_read_b128 a[56:59], v3 offset:14336
  v_mfma_f32_16x16x32_bf16 v[104:107], a[12:15], a[188:191], v[104:107]
  v_exp_f32 v68, v68
  v_mfma_f32_16x16x32_bf16 v[100:103], a[16:19], a[160:163], v[24:27]
  v_exp_f32 v69, v69
  v_mfma_f32_16x16x32_bf16 v[100:103], a[20:23], a[164:167], v[100:103]
  ds_read_b128 a[60:63], v3 offset:15360
  v_cvt_pk_bf16_f32 v32, v64, v65
  v_mfma_f32_16x16x32_bf16 v[100:103], a[24:27], a[168:171], v[100:103]
  v_exp_f32 v70, v70
  v_mfma_f32_16x16x32_bf16 v[100:103], a[28:31], a[172:175], v[100:103]
  ds_read_b128 a[0:3], v4 offset:8192
  v_cvt_pk_bf16_f32 v33, v66, v67
  v_mfma_f32_16x16x32_bf16 v[108:111], a[16:19], a[176:179], v[28:31]
  v_exp_f32 v71, v71
  v_mfma_f32_16x16x32_bf16 v[108:111], a[20:23], a[180:183], v[108:111]
  buffer_load_dwordx4 v2, s[20:23], s28 offen offset:1024 sc1 lds
  v_mfma_f32_16x16x32_bf16 v[108:111], a[24:27], a[184:187], v[108:111]
  v_exp_f32 v72, v72
  v_mfma_f32_16x16x32_bf16 v[108:111], a[28:31], a[188:191], v[108:111]
  s_waitcnt lgkmcnt(1)
  ds_read_b128 a[4:7], v4 offset:9216
  ds_read_b128 a[8:11], v4 offset:10240
  v_mfma_f32_16x16x32_bf16 v[112:115], a[32:35], a[160:163], v[24:27]
  v_exp_f32 v73, v73
  v_mfma_f32_16x16x32_bf16 v[112:115], a[36:39], a[164:167], v[112:115]
  v_exp_f32 v74, v74
  v_mfma_f32_16x16x32_bf16 v[112:115], a[40:43], a[168:171], v[112:115]
  ds_read_b128 a[12:15], v4 offset:11264
  ds_read_b128 a[16:19], v4 offset:12288
  v_mfma_f32_16x16x32_bf16 v[112:115], a[44:47], a[172:175], v[112:115]
  v_exp_f32 v75, v75
  v_mfma_f32_16x16x32_bf16 v[120:123], a[32:35], a[176:179], v[28:31]
  ds_read_b128 a[20:23], v4 offset:13312
  v_cvt_pk_bf16_f32 v34, v68, v69
  v_mfma_f32_16x16x32_bf16 v[120:123], a[36:39], a[180:183], v[120:123]
  v_exp_f32 v76, v76
  v_mfma_f32_16x16x32_bf16 v[120:123], a[40:43], a[184:187], v[120:123]
  ds_read_b128 a[24:27], v4 offset:14336
  v_cvt_pk_bf16_f32 v35, v70, v71
  v_mfma_f32_16x16x32_bf16 v[120:123], a[44:47], a[188:191], v[120:123]
  v_exp_f32 v77, v77
  v_mfma_f32_16x16x32_bf16 v[116:119], a[48:51], a[160:163], v[24:27]
  v_exp_f32 v78, v78
  v_mfma_f32_16x16x32_bf16 v[116:119], a[52:55], a[164:167], v[116:119]
  ds_read_b128 a[28:31], v4 offset:15360
  v_xor_b32 v4, 0x8000, v4
  v_mfma_f32_16x16x32_bf16 v[116:119], a[56:59], a[168:171], v[116:119]
  v_exp_f32 v79, v79
  v_mfma_f32_16x16x32_bf16 v[116:119], a[60:63], a[172:175], v[116:119]
  buffer_load_dwordx4 v2, s[20:23], s28 offen offset:2048 sc1 lds
  v_mfma_f32_16x16x32_bf16 v[124:127], a[48:51], a[176:179], v[28:31]
  v_exp_f32 v80, v80
  v_mfma_f32_16x16x32_bf16 v[124:127], a[52:55], a[180:183], v[124:127]
  v_xor_b32 v3, 0x8000, v3
  v_cvt_pk_bf16_f32 v36, v72, v73
  v_mfma_f32_16x16x32_bf16 v[124:127], a[56:59], a[184:187], v[124:127]
  v_exp_f32 v81, v81
  v_mfma_f32_16x16x32_bf16 v[124:127], a[60:63], a[188:191], v[124:127]
  s_waitcnt lgkmcnt(4)
  ds_read_b128 a[32:35], v3 offset:0
  ds_read_b128 a[36:39], v3 offset:1024
  v_mfma_f32_16x16x32_bf16 v[160:163], a[0:3], v[52:55], v[160:163]
  v_exp_f32 v82, v82
  v_mfma_f32_16x16x32_bf16 v[192:195], a[0:3], v[56:59], v[192:195]
  v_exp_f32 v83, v83
  v_mfma_f32_16x16x32_bf16 v[224:227], a[0:3], v[60:63], v[224:227]
  ds_read_b128 a[40:43], v3 offset:2048
  ds_read_b128 a[44:47], v3 offset:3072
  v_mfma_f32_16x16x32_bf16 a[196:199], a[208:211], v[52:55], a[196:199]
  v_exp_f32 v84, v84
  v_mfma_f32_16x16x32_bf16 v[164:167], a[4:7], v[52:55], v[164:167]
  ds_read_b128 a[48:51], v3 offset:4096
  v_cvt_pk_bf16_f32 v37, v74, v75
  v_mfma_f32_16x16x32_bf16 v[196:199], a[4:7], v[56:59], v[196:199]
  v_exp_f32 v85, v85
  v_mfma_f32_16x16x32_bf16 v[228:231], a[4:7], v[60:63], v[228:231]
  v_cvt_pk_bf16_f32 v38, v76, v77
  v_cvt_pk_bf16_f32 v39, v78, v79
  v_mfma_f32_16x16x32_bf16 a[200:203], a[208:211], v[56:59], a[200:203]
  v_exp_f32 v86, v86
  v_mfma_f32_16x16x32_bf16 v[168:171], a[8:11], v[52:55], v[168:171]
  v_exp_f32 v87, v87
  v_mfma_f32_16x16x32_bf16 v[200:203], a[8:11], v[56:59], v[200:203]
  buffer_load_dwordx4 v2, s[20:23], s28 offen offset:3072 sc1 lds
  v_mfma_f32_16x16x32_bf16 v[232:235], a[8:11], v[60:63], v[232:235]
  s_xor_b32 s26, s26, 0x4000
  v_exp_f32 v88, v88
  v_mfma_f32_16x16x32_bf16 a[204:207], a[208:211], v[60:63], a[204:207]
  s_add_u32 s28, s28, 0x8000
  ds_read_b128 a[52:55], v3 offset:5120
  v_cvt_pk_bf16_f32 v40, v80, v81
  v_mfma_f32_16x16x32_bf16 v[172:175], a[12:15], v[52:55], v[172:175]
  v_exp_f32 v89, v89
  v_mfma_f32_16x16x32_bf16 v[204:207], a[12:15], v[56:59], v[204:207]
  ds_read_b128 a[56:59], v3 offset:6144
  v_cvt_pk_bf16_f32 v41, v82, v83
  v_mfma_f32_16x16x32_bf16 v[236:239], a[12:15], v[60:63], v[236:239]
  s_waitcnt lgkmcnt(7)
  v_exp_f32 v90, v90
  v_mfma_f32_16x16x32_bf16 v[176:179], a[16:19], v[52:55], v[176:179]
  ds_read_b128 a[60:63], v3 offset:7168
  v_cvt_pk_bf16_f32 v42, v84, v85
  v_mfma_f32_16x16x32_bf16 v[208:211], a[16:19], v[56:59], v[208:211]
  v_exp_f32 v91, v91
  v_mfma_f32_16x16x32_bf16 v[240:243], a[16:19], v[60:63], v[240:243]
  v_exp_f32 v92, v92
  v_mfma_f32_16x16x32_bf16 v[180:183], a[20:23], v[52:55], v[180:183]
  ds_read_b128 a[0:3], v3 offset:8192
  v_cvt_pk_bf16_f32 v43, v86, v87
  v_mfma_f32_16x16x32_bf16 v[212:215], a[20:23], v[56:59], v[212:215]
  v_exp_f32 v93, v93
  v_mfma_f32_16x16x32_bf16 v[244:247], a[20:23], v[60:63], v[244:247]
  v_cvt_pk_bf16_f32 v44, v88, v89
  v_cvt_pk_bf16_f32 v45, v90, v91
  v_mfma_f32_16x16x32_bf16 v[184:187], a[24:27], v[52:55], v[184:187]
  v_exp_f32 v94, v94
  v_mfma_f32_16x16x32_bf16 v[216:219], a[24:27], v[56:59], v[216:219]
  ds_read_b128 a[4:7], v3 offset:9216
  v_cvt_pk_bf16_f32 v46, v92, v93
  v_mfma_f32_16x16x32_bf16 v[248:251], a[24:27], v[60:63], v[248:251]
  v_exp_f32 v95, v95
  v_mfma_f32_16x16x32_bf16 v[188:191], a[28:31], v[52:55], v[188:191]
  ds_read_b128 a[8:11], v3 offset:10240
  v_cvt_pk_bf16_f32 v47, v94, v95
  v_mfma_f32_16x16x32_bf16 v[220:223], a[28:31], v[56:59], v[220:223]
  s_waitcnt vmcnt(8)
  s_barrier
  v_mfma_f32_16x16x32_bf16 v[252:255], a[28:31], v[60:63], v[252:255]
  s_lshl_b32 s4, s25, 20
  s_lshl_b32 s5, s24, 15
  s_add_u32 s4, s4, s5
  s_lshl_b32 s5, s3, 11
  s_add_u32 s4, s4, s5
  v_accvgpr_read_b32 v6, a192
  v_accvgpr_read_b32 v8, a196
  s_mov_b32 s5, 0x5f800000
  v_cmp_ngt_f32 vcc, s5, v6
  v_rcp_f32 v6, v6
  s_or_b32 s89, s89, vcc_lo
  s_or_b32 s89, s89, vcc_hi
  v_mov_b32 v7, v6
  v_cmp_ngt_f32 vcc, s5, v8
  v_rcp_f32 v8, v8
  s_or_b32 s89, s89, vcc_lo
  s_or_b32 s89, s89, vcc_hi
  v_mov_b32 v9, v8
  v_pk_mul_f32 v[128:129], v[128:129], v[6:7]
  v_pk_mul_f32 v[130:131], v[130:131], v[6:7]
  v_pk_mul_f32 v[132:133], v[132:133], v[6:7]
  v_pk_mul_f32 v[134:135], v[134:135], v[6:7]
  v_cvt_pk_bf16_f32 v128, v128, v129
  v_cvt_pk_bf16_f32 v129, v130, v131
  v_cvt_pk_bf16_f32 v130, v132, v133
  v_cvt_pk_bf16_f32 v131, v134, v135
  buffer_store_dwordx4 v[128:131], v2, s[16:19], s4 offen offset:0 sc1
  v_pk_mul_f32 v[160:161], v[160:161], v[8:9]
  v_pk_mul_f32 v[162:163], v[162:163], v[8:9]
  v_pk_mul_f32 v[164:165], v[164:165], v[8:9]
  v_pk_mul_f32 v[166:167], v[166:167], v[8:9]
  v_cvt_pk_bf16_f32 v160, v160, v161
  v_cvt_pk_bf16_f32 v161, v162, v163
  v_cvt_pk_bf16_f32 v162, v164, v165
  v_cvt_pk_bf16_f32 v163, v166, v167
  buffer_store_dwordx4 v[160:163], v2, s[16:19], s4 offen offset:1024 sc1
  s_add_u32 s4, s4, 8192
  v_pk_mul_f32 v[136:137], v[136:137], v[6:7]
  v_pk_mul_f32 v[138:139], v[138:139], v[6:7]
  v_pk_mul_f32 v[140:141], v[140:141], v[6:7]
  v_pk_mul_f32 v[142:143], v[142:143], v[6:7]
  v_cvt_pk_bf16_f32 v136, v136, v137
  v_cvt_pk_bf16_f32 v137, v138, v139
  v_cvt_pk_bf16_f32 v138, v140, v141
  v_cvt_pk_bf16_f32 v139, v142, v143
  buffer_store_dwordx4 v[136:139], v2, s[16:19], s4 offen offset:0 sc1
  v_pk_mul_f32 v[168:169], v[168:169], v[8:9]
  v_pk_mul_f32 v[170:171], v[170:171], v[8:9]
  v_pk_mul_f32 v[172:173], v[172:173], v[8:9]
  v_pk_mul_f32 v[174:175], v[174:175], v[8:9]
  v_cvt_pk_bf16_f32 v168, v168, v169
  v_cvt_pk_bf16_f32 v169, v170, v171
  v_cvt_pk_bf16_f32 v170, v172, v173
  v_cvt_pk_bf16_f32 v171, v174, v175
  buffer_store_dwordx4 v[168:171], v2, s[16:19], s4 offen offset:1024 sc1
  s_add_u32 s4, s4, 8192
  v_pk_mul_f32 v[144:145], v[144:145], v[6:7]
  v_pk_mul_f32 v[146:147], v[146:147], v[6:7]
  v_pk_mul_f32 v[148:149], v[148:149], v[6:7]
  v_pk_mul_f32 v[150:151], v[150:151], v[6:7]
  v_cvt_pk_bf16_f32 v144, v144, v145
  v_cvt_pk_bf16_f32 v145, v146, v147
  v_cvt_pk_bf16_f32 v146, v148, v149
  v_cvt_pk_bf16_f32 v147, v150, v151
  buffer_store_dwordx4 v[144:147], v2, s[16:19], s4 offen offset:0 sc1
  v_pk_mul_f32 v[176:177], v[176:177], v[8:9]
  v_pk_mul_f32 v[178:179], v[178:179], v[8:9]
  v_pk_mul_f32 v[180:181], v[180:181], v[8:9]
  v_pk_mul_f32 v[182:183], v[182:183], v[8:9]
  v_cvt_pk_bf16_f32 v176, v176, v177
  v_cvt_pk_bf16_f32 v177, v178, v179
  v_cvt_pk_bf16_f32 v178, v180, v181
  v_cvt_pk_bf16_f32 v179, v182, v183
  buffer_store_dwordx4 v[176:179], v2, s[16:19], s4 offen offset:1024 sc1
  s_add_u32 s4, s4, 8192
  v_pk_mul_f32 v[152:153], v[152:153], v[6:7]
  v_pk_mul_f32 v[154:155], v[154:155], v[6:7]
  v_pk_mul_f32 v[156:157], v[156:157], v[6:7]
  v_pk_mul_f32 v[158:159], v[158:159], v[6:7]
  v_cvt_pk_bf16_f32 v152, v152, v153
  v_cvt_pk_bf16_f32 v153, v154, v155
  v_cvt_pk_bf16_f32 v154, v156, v157
  v_cvt_pk_bf16_f32 v155, v158, v159
  buffer_store_dwordx4 v[152:155], v2, s[16:19], s4 offen offset:0 sc1
  v_pk_mul_f32 v[184:185], v[184:185], v[8:9]
  v_pk_mul_f32 v[186:187], v[186:187], v[8:9]
  v_pk_mul_f32 v[188:189], v[188:189], v[8:9]
  v_pk_mul_f32 v[190:191], v[190:191], v[8:9]
  v_cvt_pk_bf16_f32 v184, v184, v185
  v_cvt_pk_bf16_f32 v185, v186, v187
  v_cvt_pk_bf16_f32 v186, v188, v189
  v_cvt_pk_bf16_f32 v187, v190, v191
  buffer_store_dwordx4 v[184:187], v2, s[16:19], s4 offen offset:1024 sc1
  s_and_b32 s88, s25, 1
  s_lshl_b32 s88, s88, 1
  s_add_u32 s88, s88, 14
  s_sub_u32 s88, s88, s25
  s_sub_u32 s88, s88, s25
  s_sub_u32 s88, s88, 1
  .p2align 6
La_so:
  s_waitcnt lgkmcnt(3)
  v_mfma_f32_16x16x32_bf16 v[64:67], a[32:35], a[160:163], v[24:27]
  v_exp_f32 v96, v96
  v_mfma_f32_16x16x32_bf16 v[64:67], a[36:39], a[164:167], v[64:67]
  buffer_store_dwordx4 a[244:247], v2, s[64:67], s90 offen offset:0 sc1
  v_mfma_f32_16x16x32_bf16 v[64:67], a[40:43], a[168:171], v[64:67]
  v_exp_f32 v97, v97
  v_mfma_f32_16x16x32_bf16 v[64:67], a[44:47], a[172:175], v[64:67]
  ds_read_b128 a[12:15], v3 offset:11264
  ds_read_b128 a[16:19], v3 offset:12288
  v_mfma_f32_16x16x32_bf16 v[72:75], a[32:35], a[176:179], v[28:31]
  v_exp_f32 v98, v98
  v_mfma_f32_16x16x32_bf16 v[72:75], a[36:39], a[180:183], v[72:75]
  ds_read_b128 a[20:23], v3 offset:13312
  v_cvt_pk_bf16_f32 v48, v96, v97
  v_mfma_f32_16x16x32_bf16 v[72:75], a[40:43], a[184:187], v[72:75]
  v_exp_f32 v99, v99
  v_mfma_f32_16x16x32_bf16 v[72:75], a[44:47], a[188:191], v[72:75]
  buffer_store_dwordx4 a[244:247], v2, s[64:67], s90 offen offset:1024 sc1
  v_mfma_f32_16x16x32_bf16 v[68:71], a[48:51], a[160:163], v[24:27]
  s_add_u32 s90, s90, 2048
  v_exp_f32 v100, v100
  v_mfma_f32_16x16x32_bf16 v[68:71], a[52:55], a[164:167], v[68:71]
  s_mov_b32 m0, s26
  ds_read_b128 a[24:27], v3 offset:14336
  ds_read_b128 a[28:31], v3 offset:15360
  v_mfma_f32_16x16x32_bf16 v[68:71], a[56:59], a[168:171], v[68:71]
  v_exp_f32 v101, v101
  v_mfma_f32_16x16x32_bf16 v[68:71], a[60:63], a[172:175], v[68:71]
  ds_read_b128 a[32:35], v4 offset:0
  v_cvt_pk_bf16_f32 v49, v98, v99
  v_mfma_f32_16x16x32_bf16 v[76:79], a[48:51], a[176:179], v[28:31]
  v_exp_f32 v102, v102
  v_mfma_f32_16x16x32_bf16 v[76:79], a[52:55], a[180:183], v[76:79]
  buffer_load_dwordx4 v2, s[20:23], s28 offen offset:0 sc1 lds
  v_mfma_f32_16x16x32_bf16 v[76:79], a[56:59], a[184:187], v[76:79]
  v_exp_f32 v103, v103
  v_mfma_f32_16x16x32_bf16 v[76:79], a[60:63], a[188:191], v[76:79]
  s_waitcnt lgkmcnt(1)
  ds_read_b128 a[36:39], v4 offset:1024
  ds_read_b128 a[40:43], v4 offset:2048
  v_mfma_f32_16x16x32_bf16 v[80:83], a[0:3], a[160:163], v[24:27]
  v_exp_f32 v104, v104
  v_mfma_f32_16x16x32_bf16 v[80:83], a[4:7], a[164:167], v[80:83]
  ds_read_b128 a[44:47], v4 offset:3072
  v_cvt_pk_bf16_f32 v50, v100, v101
  v_mfma_f32_16x16x32_bf16 v[80:83], a[8:11], a[168:171], v[80:83]
  v_exp_f32 v105, v105
  v_mfma_f32_16x16x32_bf16 v[80:83], a[12:15], a[172:175], v[80:83]
  buffer_load_dwordx4 v2, s[20:23], s28 offen offset:1024 sc1 lds
  v_mfma_f32_16x16x32_bf16 v[88:91], a[0:3], a[176:179], v[28:31]
  v_exp_f32 v106, v106
  v_mfma_f32_16x16x32_bf16 v[88:91], a[4:7], a[180:183], v[88:91]
  ds_read_b128 a[48:51], v4 offset:4096
  ds_read_b128 a[52:55], v4 offset:5120
  v_mfma_f32_16x16x32_bf16 v[88:91], a[8:11], a[184:187], v[88:91]
  v_exp_f32 v107, v107
  v_mfma_f32_16x16x32_bf16 v[88:91], a[12:15], a[188:191], v[88:91]
  ds_read_b128 a[56:59], v4 offset:6144
  v_cvt_pk_bf16_f32 v51, v102, v103
  v_mfma_f32_16x16x32_bf16 v[84:87], a[16:19], a[160:163], v[24:27]
  v_exp_f32 v108, v108
  v_mfma_f32_16x16x32_bf16 v[84:87], a[20:23], a[164:167], v[84:87]
  buffer_load_dwordx4 v2, s[20:23], s28 offen offset:2048 sc1 lds
  v_mfma_f32_16x16x32_bf16 v[84:87], a[24:27], a[168:171], v[84:87]
  v_exp_f32 v109, v109
  v_mfma_f32_16x16x32_bf16 v[84:87], a[28:31], a[172:175], v[84:87]
  ds_read_b128 a[60:63], v4 offset:7168
  ds_read_b128 a[0:3], v4 offset:8192
  v_mfma_f32_16x16x32_bf16 v[92:95], a[16:19], a[176:179], v[28:31]
  v_exp_f32 v110, v110
  v_mfma_f32_16x16x32_bf16 v[92:95], a[20:23], a[180:183], v[92:95]
  ds_read_b128 a[4:7], v4 offset:9216
  v_cvt_pk_bf16_f32 v52, v104, v105
  v_mfma_f32_16x16x32_bf16 v[92:95], a[24:27], a[184:187], v[92:95]
  v_exp_f32 v111, v111
  v_mfma_f32_16x16x32_bf16 v[92:95], a[28:31], a[188:191], v[92:95]
  s_waitcnt lgkmcnt(2)
  ds_read_b128 a[8:11], v4 offset:10240
  v_cvt_pk_bf16_f32 v53, v106, v107
  v_mfma_f32_16x16x32_bf16 v[192:195], a[32:35], v[32:35], v[192:195]
  buffer_load_dwordx4 v2, s[20:23], s28 offen offset:3072 sc1 lds
  v_mfma_f32_16x16x32_bf16 v[224:227], a[32:35], v[36:39], v[224:227]
  s_xor_b32 s26, s26, 0x8000
  v_exp_f32 v112, v112
  v_mfma_f32_16x16x32_bf16 a[200:203], a[208:211], v[32:35], a[200:203]
  s_add_u32 s28, s28, 0x8000
  s_mov_b32 m0, s27
  ds_read_b128 a[12:15], v4 offset:11264
  v_mfma_f32_16x16x32_bf16 v[196:199], a[36:39], v[32:35], v[196:199]
  s_sub_u32 s88, s88, 1
  v_exp_f32 v113, v113
  v_mfma_f32_16x16x32_bf16 v[228:231], a[36:39], v[36:39], v[228:231]
  ds_read_b128 a[16:19], v4 offset:12288
  v_cvt_pk_bf16_f32 v54, v108, v109
  v_mfma_f32_16x16x32_bf16 a[204:207], a[208:211], v[36:39], a[204:207]
  v_exp_f32 v114, v114
  v_mfma_f32_16x16x32_bf16 v[200:203], a[40:43], v[32:35], v[200:203]
  buffer_load_dwordx4 v2, s[20:23], s29 offen offset:0 sc1 lds
  v_mfma_f32_16x16x32_bf16 v[232:235], a[40:43], v[36:39], v[232:235]
  v_exp_f32 v115, v115
  v_mfma_f32_16x16x32_bf16 v[204:207], a[44:47], v[32:35], v[204:207]
  ds_read_b128 a[20:23], v4 offset:13312
  ds_read_b128 a[24:27], v4 offset:14336
  v_mfma_f32_16x16x32_bf16 v[236:239], a[44:47], v[36:39], v[236:239]
  v_exp_f32 v116, v116
  v_mfma_f32_16x16x32_bf16 v[208:211], a[48:51], v[32:35], v[208:211]
  ds_read_b128 a[28:31], v4 offset:15360
  v_xor_b32 v4, 0x4000, v4
  v_mfma_f32_16x16x32_bf16 v[240:243], a[48:51], v[36:39], v[240:243]
  v_exp_f32 v117, v117
  v_mfma_f32_16x16x32_bf16 v[212:215], a[52:55], v[32:35], v[212:215]
  buffer_load_dwordx4 v2, s[20:23], s29 offen offset:1024 sc1 lds
  v_mfma_f32_16x16x32_bf16 v[244:247], a[52:55], v[36:39], v[244:247]
  v_exp_f32 v118, v118
  v_mfma_f32_16x16x32_bf16 v[216:219], a[56:59], v[32:35], v[216:219]
  v_xor_b32 v3, 0x4000, v3
  v_cvt_pk_bf16_f32 v55, v110, v111
  v_mfma_f32_16x16x32_bf16 v[248:251], a[56:59], v[36:39], v[248:251]
  v_exp_f32 v119, v119
  v_mfma_f32_16x16x32_bf16 v[220:223], a[60:63], v[32:35], v[220:223]
  ds_read_b128 a[32:35], v3 offset:0
  ds_read_b128 a[36:39], v3 offset:1024
  v_mfma_f32_16x16x32_bf16 v[252:255], a[60:63], v[36:39], v[252:255]
  s_waitcnt lgkmcnt(2)
  v_exp_f32 v120, v120
  v_mfma_f32_16x16x32_bf16 v[192:195], a[0:3], v[40:43], v[192:195]
  ds_read_b128 a[40:43], v3 offset:2048
  ds_read_b128 a[44:47], v3 offset:3072
  v_mfma_f32_16x16x32_bf16 v[224:227], a[0:3], v[44:47], v[224:227]
  v_exp_f32 v121, v121
  v_mfma_f32_16x16x32_bf16 a[200:203], a[208:211], v[40:43], a[200:203]
  buffer_load_dwordx4 v2, s[20:23], s29 offen offset:2048 sc1 lds
  v_mfma_f32_16x16x32_bf16 v[196:199], a[4:7], v[40:43], v[196:199]
  v_exp_f32 v122, v122
  v_mfma_f32_16x16x32_bf16 v[228:231], a[4:7], v[44:47], v[228:231]
  ds_read_b128 a[48:51], v3 offset:4096
  v_cvt_pk_bf16_f32 v56, v112, v113
  v_mfma_f32_16x16x32_bf16 a[204:207], a[208:211], v[44:47], a[204:207]
  v_exp_f32 v123, v123
  v_mfma_f32_16x16x32_bf16 v[200:203], a[8:11], v[40:43], v[200:203]
  ds_read_b128 a[52:55], v3 offset:5120
  v_cvt_pk_bf16_f32 v57, v114, v115
  v_mfma_f32_16x16x32_bf16 v[232:235], a[8:11], v[44:47], v[232:235]
  v_exp_f32 v124, v124
  v_mfma_f32_16x16x32_bf16 v[204:207], a[12:15], v[40:43], v[204:207]
  buffer_load_dwordx4 v2, s[20:23], s29 offen offset:3072 sc1 lds
  v_mfma_f32_16x16x32_bf16 v[236:239], a[12:15], v[44:47], v[236:239]
  s_xor_b32 s27, s27, 0x8000
  v_exp_f32 v125, v125
  v_mfma_f32_16x16x32_bf16 v[208:211], a[16:19], v[40:43], v[208:211]
  s_add_u32 s29, s29, 0x8000
  ds_read_b128 a[56:59], v3 offset:6144
  ds_read_b128 a[60:63], v3 offset:7168
  v_mfma_f32_16x16x32_bf16 v[240:243], a[16:19], v[44:47], v[240:243]
  v_exp_f32 v126, v126
  v_mfma_f32_16x16x32_bf16 v[212:215], a[20:23], v[40:43], v[212:215]
  ds_read_b128 a[0:3], v3 offset:8192
  v_cvt_pk_bf16_f32 v58, v116, v117
  v_mfma_f32_16x16x32_bf16 v[244:247], a[20:23], v[44:47], v[244:247]
  v_exp_f32 v127, v127
  v_mfma_f32_16x16x32_bf16 v[216:219], a[24:27], v[40:43], v[216:219]
  ds_read_b128 a[4:7], v3 offset:9216
  v_cvt_pk_bf16_f32 v59, v118, v119
  v_cvt_pk_bf16_f32 v63, v126, v127
  v_mfma_f32_16x16x32_bf16 v[248:251], a[24:27], v[44:47], v[248:251]
  v_cvt_pk_bf16_f32 v60, v120, v121
  v_cvt_pk_bf16_f32 v61, v122, v123
  v_mfma_f32_16x16x32_bf16 v[220:223], a[28:31], v[40:43], v[220:223]
  s_waitcnt vmcnt(10)
  s_barrier
  v_mfma_f32_16x16x32_bf16 v[252:255], a[28:31], v[44:47], v[252:255]
  ds_read_b128 a[8:11], v3 offset:10240
  v_cvt_pk_bf16_f32 v62, v124, v125
  s_cmp_eq_u32 s88, 0
  s_cbranch_scc1 La_e0
  s_waitcnt lgkmcnt(3)
  v_mfma_f32_16x16x32_bf16 v[96:99], a[32:35], a[160:163], v[24:27]
  s_mov_b32 m0, s26
  v_exp_f32 v64, v64
  v_mfma_f32_16x16x32_bf16 v[96:99], a[36:39], a[164:167], v[96:99]
  buffer_load_dwordx4 v2, s[20:23], s28 offen offset:0 sc1 lds
  v_mfma_f32_16x16x32_bf16 v[96:99], a[40:43], a[168:171], v[96:99]
  v_exp_f32 v65, v65
  v_mfma_f32_16x16x32_bf16 v[96:99], a[44:47], a[172:175], v[96:99]
  ds_read_b128 a[12:15], v3 offset:11264
  ds_read_b128 a[16:19], v3 offset:12288
  v_mfma_f32_16x16x32_bf16 v[104:107], a[32:35], a[176:179], v[28:31]
  v_exp_f32 v66, v66
  v_mfma_f32_16x16x32_bf16 v[104:107], a[36:39], a[180:183], v[104:107]
  ds_read_b128 a[20:23], v3 offset:13312
  v_cvt_pk_bf16_f32 v32, v64, v65
  v_mfma_f32_16x16x32_bf16 v[104:107], a[40:43], a[184:187], v[104:107]
  v_exp_f32 v67, v67
  v_mfma_f32_16x16x32_bf16 v[104:107], a[44:47], a[188:191], v[104:107]
  ds_read_b128 a[24:27], v3 offset:14336
  v_cvt_pk_bf16_f32 v33, v66, v67
  v_mfma_f32_16x16x32_bf16 v[100:103], a[48:51], a[160:163], v[24:27]
  v_exp_f32 v68, v68
  v_mfma_f32_16x16x32_bf16 v[100:103], a[52:55], a[164:167], v[100:103]
  buffer_load_dwordx4 v2, s[20:23], s28 offen offset:1024 sc1 lds
  v_mfma_f32_16x16x32_bf16 v[100:103], a[56:59], a[168:171], v[100:103]
  v_exp_f32 v69, v69
  v_mfma_f32_16x16x32_bf16 v[100:103], a[60:63], a[172:175], v[100:103]
  ds_read_b128 a[28:31], v3 offset:15360
  ds_read_b128 a[32:35], v4 offset:0
  v_mfma_f32_16x16x32_bf16 v[108:111], a[48:51], a[176:179], v[28:31]
  v_exp_f32 v70, v70
  v_mfma_f32_16x16x32_bf16 v[108:111], a[52:55], a[180:183], v[108:111]
  ds_read_b128 a[36:39], v4 offset:1024
  v_cvt_pk_bf16_f32 v34, v68, v69
  v_mfma_f32_16x16x32_bf16 v[108:111], a[56:59], a[184:187], v[108:111]
  v_exp_f32 v71, v71
  v_mfma_f32_16x16x32_bf16 v[108:111], a[60:63], a[188:191], v[108:111]
  s_waitcnt lgkmcnt(2)
  ds_read_b128 a[40:43], v4 offset:2048
  v_cvt_pk_bf16_f32 v35, v70, v71
  v_mfma_f32_16x16x32_bf16 v[112:115], a[0:3], a[160:163], v[24:27]
  v_exp_f32 v72, v72
  v_mfma_f32_16x16x32_bf16 v[112:115], a[4:7], a[164:167], v[112:115]
  buffer_load_dwordx4 v2, s[20:23], s28 offen offset:2048 sc1 lds
  v_mfma_f32_16x16x32_bf16 v[112:115], a[8:11], a[168:171], v[112:115]
  v_exp_f32 v73, v73
  v_mfma_f32_16x16x32_bf16 v[112:115], a[12:15], a[172:175], v[112:115]
  ds_read_b128 a[44:47], v4 offset:3072
  ds_read_b128 a[48:51], v4 offset:4096
  v_mfma_f32_16x16x32_bf16 v[120:123], a[0:3], a[176:179], v[28:31]
  v_exp_f32 v74, v74
  v_mfma_f32_16x16x32_bf16 v[120:123], a[4:7], a[180:183], v[120:123]
  ds_read_b128 a[52:55], v4 offset:5120
  v_cvt_pk_bf16_f32 v36, v72, v73
  v_mfma_f32_16x16x32_bf16 v[120:123], a[8:11], a[184:187], v[120:123]
  v_exp_f32 v75, v75
  v_mfma_f32_16x16x32_bf16 v[120:123], a[12:15], a[188:191], v[120:123]
  ds_read_b128 a[56:59], v4 offset:6144
  v_cvt_pk_bf16_f32 v37, v74, v75
  v_mfma_f32_16x16x32_bf16 v[116:119], a[16:19], a[160:163], v[24:27]
  v_exp_f32 v76, v76
  v_mfma_f32_16x16x32_bf16 v[116:119], a[20:23], a[164:167], v[116:119]
  buffer_load_dwordx4 v2, s[20:23], s28 offen offset:3072 sc1 lds
  v_mfma_f32_16x16x32_bf16 v[116:119], a[24:27], a[168:171], v[116:119]
  s_xor_b32 s26, s26, 0x4000
  v_exp_f32 v77, v77
  v_mfma_f32_16x16x32_bf16 v[116:119], a[28:31], a[172:175], v[116:119]
  s_add_u32 s28, s28, 0x8000
  s_mov_b32 m0, s27
  ds_read_b128 a[60:63], v4 offset:7168
  v_mfma_f32_16x16x32_bf16 v[124:127], a[16:19], a[176:179], v[28:31]
  v_exp_f32 v78, v78
  v_mfma_f32_16x16x32_bf16 v[124:127], a[20:23], a[180:183], v[124:127]
  ds_read_b128 a[0:3], v4 offset:8192
  ds_read_b128 a[4:7], v4 offset:9216
  v_mfma_f32_16x16x32_bf16 v[124:127], a[24:27], a[184:187], v[124:127]
  v_exp_f32 v79, v79
  v_mfma_f32_16x16x32_bf16 v[124:127], a[28:31], a[188:191], v[124:127]
  s_waitcnt lgkmcnt(2)
  ds_read_b128 a[8:11], v4 offset:10240
  v_cvt_pk_bf16_f32 v38, v76, v77
  v_mfma_f32_16x16x32_bf16 v[192:195], a[32:35], v[48:51], v[192:195]
  buffer_load_dwordx4 v2, s[20:23], s29 offen offset:0 sc1 lds
  v_mfma_f32_16x16x32_bf16 v[224:227], a[32:35], v[52:55], v[224:227]
  v_exp_f32 v80, v80
  v_mfma_f32_16x16x32_bf16 a[200:203], a[208:211], v[48:51], a[200:203]
  ds_read_b128 a[12:15], v4 offset:11264
  v_cvt_pk_bf16_f32 v39, v78, v79
  v_mfma_f32_16x16x32_bf16 v[196:199], a[36:39], v[48:51], v[196:199]
  v_exp_f32 v81, v81
  v_mfma_f32_16x16x32_bf16 v[228:231], a[36:39], v[52:55], v[228:231]
  ds_read_b128 a[16:19], v4 offset:12288
  v_cvt_pk_bf16_f32 v40, v80, v81
  v_mfma_f32_16x16x32_bf16 a[204:207], a[208:211], v[52:55], a[204:207]
  v_exp_f32 v82, v82
  v_mfma_f32_16x16x32_bf16 v[200:203], a[40:43], v[48:51], v[200:203]
  ds_read_b128 a[20:23], v4 offset:13312
  v_mfma_f32_16x16x32_bf16 v[232:235], a[40:43], v[52:55], v[232:235]
  v_exp_f32 v83, v83
  v_mfma_f32_16x16x32_bf16 v[204:207], a[44:47], v[48:51], v[204:207]
  buffer_load_dwordx4 v2, s[20:23], s29 offen offset:1024 sc1 lds
  v_mfma_f32_16x16x32_bf16 v[236:239], a[44:47], v[52:55], v[236:239]
  v_exp_f32 v84, v84
  v_mfma_f32_16x16x32_bf16 v[208:211], a[48:51], v[48:51], v[208:211]
  ds_read_b128 a[24:27], v4 offset:14336
  ds_read_b128 a[28:31], v4 offset:15360
  v_mfma_f32_16x16x32_bf16 v[240:243], a[48:51], v[52:55], v[240:243]
  v_exp_f32 v85, v85
  v_mfma_f32_16x16x32_bf16 v[212:215], a[52:55], v[48:51], v[212:215]
  v_xor_b32 v4, 0x8000, v4
  v_xor_b32 v3, 0x8000, v3
  v_mfma_f32_16x16x32_bf16 v[244:247], a[52:55], v[52:55], v[244:247]
  v_exp_f32 v86, v86
  v_mfma_f32_16x16x32_bf16 v[216:219], a[56:59], v[48:51], v[216:219]
  ds_read_b128 a[32:35], v3 offset:0
  ds_read_b128 a[36:39], v3 offset:1024
  v_mfma_f32_16x16x32_bf16 v[248:251], a[56:59], v[52:55], v[248:251]
  v_exp_f32 v87, v87
  v_mfma_f32_16x16x32_bf16 v[220:223], a[60:63], v[48:51], v[220:223]
  buffer_load_dwordx4 v2, s[20:23], s29 offen offset:2048 sc1 lds
  v_mfma_f32_16x16x32_bf16 v[252:255], a[60:63], v[52:55], v[252:255]
  s_waitcnt lgkmcnt(2)
  v_exp_f32 v88, v88
  v_mfma_f32_16x16x32_bf16 v[192:195], a[0:3], v[56:59], v[192:195]
  ds_read_b128 a[40:43], v3 offset:2048
  ds_read_b128 a[44:47], v3 offset:3072
  v_mfma_f32_16x16x32_bf16 v[224:227], a[0:3], v[60:63], v[224:227]
  v_exp_f32 v89, v89
  v_mfma_f32_16x16x32_bf16 a[200:203], a[208:211], v[56:59], a[200:203]
  v_cvt_pk_bf16_f32 v41, v82, v83
  v_cvt_pk_bf16_f32 v42, v84, v85
  v_mfma_f32_16x16x32_bf16 v[196:199], a[4:7], v[56:59], v[196:199]
  v_exp_f32 v90, v90
  v_mfma_f32_16x16x32_bf16 v[228:231], a[4:7], v[60:63], v[228:231]
  ds_read_b128 a[48:51], v3 offset:4096
  v_cvt_pk_bf16_f32 v43, v86, v87
  v_mfma_f32_16x16x32_bf16 a[204:207], a[208:211], v[60:63], a[204:207]
  v_exp_f32 v91, v91
  v_mfma_f32_16x16x32_bf16 v[200:203], a[8:11], v[56:59], v[200:203]
  buffer_load_dwordx4 v2, s[20:23], s29 offen offset:3072 sc1 lds
  v_mfma_f32_16x16x32_bf16 v[232:235], a[8:11], v[60:63], v[232:235]
  s_xor_b32 s27, s27, 0x4000
  v_exp_f32 v92, v92
  v_mfma_f32_16x16x32_bf16 v[204:207], a[12:15], v[56:59], v[204:207]
  s_add_u32 s29, s29, 0x8000
  ds_read_b128 a[52:55], v3 offset:5120
  ds_read_b128 a[56:59], v3 offset:6144
  v_mfma_f32_16x16x32_bf16 v[236:239], a[12:15], v[60:63], v[236:239]
  v_exp_f32 v93, v93
  v_mfma_f32_16x16x32_bf16 v[208:211], a[16:19], v[56:59], v[208:211]
  ds_read_b128 a[60:63], v3 offset:7168
  v_cvt_pk_bf16_f32 v44, v88, v89
  v_mfma_f32_16x16x32_bf16 v[240:243], a[16:19], v[60:63], v[240:243]
  v_exp_f32 v94, v94
  v_mfma_f32_16x16x32_bf16 v[212:215], a[20:23], v[56:59], v[212:215]
  ds_read_b128 a[0:3], v3 offset:8192
  v_cvt_pk_bf16_f32 v45, v90, v91
  v_mfma_f32_16x16x32_bf16 v[244:247], a[20:23], v[60:63], v[244:247]
  v_exp_f32 v95, v95
  v_mfma_f32_16x16x32_bf16 v[216:219], a[24:27], v[56:59], v[216:219]
  ds_read_b128 a[4:7], v3 offset:9216
  v_cvt_pk_bf16_f32 v46, v92, v93
  v_mfma_f32_16x16x32_bf16 v[248:251], a[24:27], v[60:63], v[248:251]
  v_cvt_pk_bf16_f32 v47, v94, v95
  v_mfma_f32_16x16x32_bf16 v[220:223], a[28:31], v[56:59], v[220:223]
  s_waitcnt vmcnt(12)
  s_barrier
  v_mfma_f32_16x16x32_bf16 v[252:255], a[28:31], v[60:63], v[252:255]
  ds_read_b128 a[8:11], v3 offset:10240
  s_branch La_so
La_e0:
  s_waitcnt lgkmcnt(7)
  v_mfma_f32_16x16x32_bf16 v[104:107], a[32:35], a[176:179], v[28:31]
  buffer_load_dwordx2 v[12:13], v14, s[96:99], s91 offen sc1
  v_mfma_f32_16x16x32_bf16 v[104:107], a[36:39], a[180:183], v[104:107]
  v_cndmask_b32 v64, v64, v5, s[32:33]
  v_exp_f32 v64, v64
  v_mfma_f32_16x16x32_bf16 v[104:107], a[40:43], a[184:187], v[104:107]
  v_cndmask_b32 v65, v65, v5, s[34:35]
  v_exp_f32 v65, v65
  v_mfma_f32_16x16x32_bf16 v[104:107], a[44:47], a[188:191], v[104:107]
  s_waitcnt lgkmcnt(3)
  v_cndmask_b32 v66, v66, v5, s[36:37]
  v_exp_f32 v66, v66
  v_mfma_f32_16x16x32_bf16 v[108:111], a[48:51], a[176:179], v[28:31]
  v_cndmask_b32 v67, v67, v5, s[38:39]
  v_exp_f32 v67, v67
  v_mfma_f32_16x16x32_bf16 v[108:111], a[52:55], a[180:183], v[108:111]
  ds_read_b128 a[12:15], v3 offset:11264
  ds_read_b128 a[16:19], v3 offset:12288
  v_mfma_f32_16x16x32_bf16 v[108:111], a[56:59], a[184:187], v[108:111]
  v_cndmask_b32 v68, v68, v5, s[40:41]
  v_exp_f32 v68, v68
  v_mfma_f32_16x16x32_bf16 v[108:111], a[60:63], a[188:191], v[108:111]
  s_waitcnt lgkmcnt(1)
  v_cndmask_b32 v69, v69, v5, s[42:43]
  v_exp_f32 v69, v69
  v_mfma_f32_16x16x32_bf16 v[120:123], a[0:3], a[176:179], v[28:31]
  ds_read_b128 a[20:23], v3 offset:13312
  ds_read_b128 a[24:27], v3 offset:14336
  ds_read_b128 a[28:31], v3 offset:15360
  v_mfma_f32_16x16x32_bf16 v[120:123], a[4:7], a[180:183], v[120:123]
  v_cndmask_b32 v70, v70, v5, s[44:45]
  v_exp_f32 v70, v70
  v_mfma_f32_16x16x32_bf16 v[120:123], a[8:11], a[184:187], v[120:123]
  v_cndmask_b32 v71, v71, v5, s[46:47]
  v_exp_f32 v71, v71
  v_mfma_f32_16x16x32_bf16 v[120:123], a[12:15], a[188:191], v[120:123]
  s_waitcnt lgkmcnt(0)
  ds_read_b128 a[32:35], v4 offset:0
  ds_read_b128 a[36:39], v4 offset:1024
  v_mfma_f32_16x16x32_bf16 v[124:127], a[16:19], a[176:179], v[28:31]
  v_exp_f32 v72, v72
  v_mfma_f32_16x16x32_bf16 v[124:127], a[20:23], a[180:183], v[124:127]
  ds_read_b128 a[40:43], v4 offset:2048
  ds_read_b128 a[44:47], v4 offset:3072
  ds_read_b128 a[48:51], v4 offset:4096
  v_mfma_f32_16x16x32_bf16 v[124:127], a[24:27], a[184:187], v[124:127]
  ds_read_b128 a[52:55], v4 offset:5120
  ds_read_b128 a[56:59], v4 offset:6144
  ds_read_b128 a[60:63], v4 offset:7168
  v_exp_f32 v73, v73
  v_mfma_f32_16x16x32_bf16 v[124:127], a[28:31], a[188:191], v[124:127]
  s_waitcnt lgkmcnt(0)
  v_exp_f32 v74, v74
  v_mfma_f32_16x16x32_bf16 v[192:195], a[32:35], v[48:51], v[192:195]
  ds_read_b128 a[0:3], v4 offset:8192
  ds_read_b128 a[4:7], v4 offset:9216
  v_mfma_f32_16x16x32_bf16 v[224:227], a[32:35], v[52:55], v[224:227]
  v_exp_f32 v75, v75
  v_mfma_f32_16x16x32_bf16 a[200:203], a[208:211], v[48:51], a[200:203]
  v_exp_f32 v76, v76
  v_mfma_f32_16x16x32_bf16 v[196:199], a[36:39], v[48:51], v[196:199]
  ds_read_b128 a[8:11], v4 offset:10240
  ds_read_b128 a[12:15], v4 offset:11264
  v_mfma_f32_16x16x32_bf16 v[228:231], a[36:39], v[52:55], v[228:231]
  v_exp_f32 v77, v77
  v_mfma_f32_16x16x32_bf16 a[204:207], a[208:211], v[52:55], a[204:207]
  v_exp_f32 v78, v78
  v_mfma_f32_16x16x32_bf16 v[200:203], a[40:43], v[48:51], v[200:203]
  ds_read_b128 a[16:19], v4 offset:12288
  ds_read_b128 a[20:23], v4 offset:13312
  v_mfma_f32_16x16x32_bf16 v[232:235], a[40:43], v[52:55], v[232:235]
  v_exp_f32 v79, v79
  v_mfma_f32_16x16x32_bf16 v[204:207], a[44:47], v[48:51], v[204:207]
  ds_read_b128 a[24:27], v4 offset:14336
  v_cvt_pk_bf16_f32 v32, v64, v65
  v_mfma_f32_16x16x32_bf16 v[236:239], a[44:47], v[52:55], v[236:239]
  v_cndmask_b32 v80, v80, v5, s[48:49]
  v_exp_f32 v80, v80
  v_mfma_f32_16x16x32_bf16 v[208:211], a[48:51], v[48:51], v[208:211]
  v_cndmask_b32 v81, v81, v5, s[50:51]
  v_exp_f32 v81, v81
  v_mfma_f32_16x16x32_bf16 v[240:243], a[48:51], v[52:55], v[240:243]
  ds_read_b128 a[28:31], v4 offset:15360
  v_xor_b32 v4, 0x8000, v4
  v_cvt_pk_bf16_f32 v40, v80, v81
  v_mfma_f32_16x16x32_bf16 v[212:215], a[52:55], v[48:51], v[212:215]
  v_cndmask_b32 v82, v82, v5, s[52:53]
  v_exp_f32 v82, v82
  v_mfma_f32_16x16x32_bf16 v[244:247], a[52:55], v[52:55], v[244:247]
  v_cndmask_b32 v83, v83, v5, s[54:55]
  v_exp_f32 v83, v83
  v_mfma_f32_16x16x32_bf16 v[216:219], a[56:59], v[48:51], v[216:219]
  ds_read_b128 a[32:35], v4 offset:0
  ds_read_b128 a[36:39], v4 offset:1024
  v_cvt_pk_bf16_f32 v41, v82, v83
  v_mfma_f32_16x16x32_bf16 v[248:251], a[56:59], v[52:55], v[248:251]
  v_cndmask_b32 v84, v84, v5, s[56:57]
  v_exp_f32 v84, v84
  v_mfma_f32_16x16x32_bf16 v[220:223], a[60:63], v[48:51], v[220:223]
  v_cndmask_b32 v85, v85, v5, s[58:59]
  v_exp_f32 v85, v85
  v_mfma_f32_16x16x32_bf16 v[252:255], a[60:63], v[52:55], v[252:255]
  s_waitcnt lgkmcnt(2)
  ds_read_b128 a[40:43], v4 offset:2048
  v_cvt_pk_bf16_f32 v33, v66, v67
  v_cvt_pk_bf16_f32 v42, v84, v85
  v_mfma_f32_16x16x32_bf16 v[192:195], a[0:3], v[56:59], v[192:195]
  v_cndmask_b32 v86, v86, v5, s[60:61]
  v_exp_f32 v86, v86
  v_mfma_f32_16x16x32_bf16 v[224:227], a[0:3], v[60:63], v[224:227]
  v_cndmask_b32 v87, v87, v5, s[62:63]
  v_exp_f32 v87, v87
  v_mfma_f32_16x16x32_bf16 a[200:203], a[208:211], v[56:59], a[200:203]
  ds_read_b128 a[44:47], v4 offset:3072
  v_cvt_pk_bf16_f32 v34, v68, v69
  v_cvt_pk_bf16_f32 v43, v86, v87
  v_mfma_f32_16x16x32_bf16 v[196:199], a[4:7], v[56:59], v[196:199]
  v_exp_f32 v88, v88
  v_mfma_f32_16x16x32_bf16 v[228:231], a[4:7], v[60:63], v[228:231]
  ds_read_b128 a[48:51], v4 offset:4096
  v_cvt_pk_bf16_f32 v35, v70, v71
  v_mfma_f32_16x16x32_bf16 a[204:207], a[208:211], v[60:63], a[204:207]
  v_exp_f32 v89, v89
  v_mfma_f32_16x16x32_bf16 v[200:203], a[8:11], v[56:59], v[200:203]
  v_exp_f32 v90, v90
  v_cvt_pk_bf16_f32 v44, v88, v89
  v_mfma_f32_16x16x32_bf16 v[232:235], a[8:11], v[60:63], v[232:235]
  ds_read_b128 a[52:55], v4 offset:5120
  v_cvt_pk_bf16_f32 v36, v72, v73
  v_mfma_f32_16x16x32_bf16 v[204:207], a[12:15], v[56:59], v[204:207]
  v_exp_f32 v91, v91
  v_mfma_f32_16x16x32_bf16 v[236:239], a[12:15], v[60:63], v[236:239]
  v_exp_f32 v92, v92
  v_cvt_pk_bf16_f32 v45, v90, v91
  v_mfma_f32_16x16x32_bf16 v[208:211], a[16:19], v[56:59], v[208:211]
  ds_read_b128 a[56:59], v4 offset:6144
  ds_read_b128 a[60:63], v4 offset:7168
  v_mfma_f32_16x16x32_bf16 v[240:243], a[16:19], v[60:63], v[240:243]
  v_exp_f32 v93, v93
  v_mfma_f32_16x16x32_bf16 v[212:215], a[20:23], v[56:59], v[212:215]
  v_exp_f32 v94, v94
  v_cvt_pk_bf16_f32 v46, v92, v93
  v_mfma_f32_16x16x32_bf16 v[244:247], a[20:23], v[60:63], v[244:247]
  ds_read_b128 a[0:3], v4 offset:8192
  v_cvt_pk_bf16_f32 v37, v74, v75
  v_mfma_f32_16x16x32_bf16 v[216:219], a[24:27], v[56:59], v[216:219]
  v_exp_f32 v95, v95
  v_mfma_f32_16x16x32_bf16 v[248:251], a[24:27], v[60:63], v[248:251]
  ds_read_b128 a[4:7], v4 offset:9216
  v_cvt_pk_bf16_f32 v38, v76, v77
  v_cvt_pk_bf16_f32 v47, v94, v95
  v_mfma_f32_16x16x32_bf16 v[220:223], a[28:31], v[56:59], v[220:223]
  s_waitcnt vmcnt(0)
  s_barrier
  v_mfma_f32_16x16x32_bf16 v[252:255], a[28:31], v[60:63], v[252:255]
  ds_read_b128 a[8:11], v4 offset:10240
  v_cvt_pk_bf16_f32 v39, v78, v79
La_e1:
  s_mov_b32 s5, 0x40000
Lpoll_7:
  v_cmp_ne_u64 vcc, s[94:95], v[12:13]
  s_nop 0
  s_cbranch_vccz Lpolld_8
  s_sleep 4
  buffer_load_dwordx2 v[12:13], v14, s[96:99], s91 offen sc1
  s_sub_u32 s5, s5, 1
  s_waitcnt vmcnt(0)
  s_cbranch_scc0 Lpoll_7
Lpolld_8:
  s_add_u32 s64, s79, 131072
  v_accvgpr_read_b32 v10, a212
  v_accvgpr_read_b32 v11, a213
  v_accvgpr_read_b32 v12, a214
  v_accvgpr_read_b32 v13, a215
  s_mov_b32 s12, s80
  s_mov_b32 s13, s81
  s_mov_b32 s14, 2097152
  s_mov_b32 s15, 0x00020000
  s_lshl_b32 s93, s77, 20
  s_lshl_b32 s72, s76, 8
  s_add_u32 s93, s93, s72
  s_add_u32 s72, s73, s76
  s_and_b32 s31, s72, 3
  s_lshl_b32 s31, s31, 3
  s_or_b32 s31, s31, 0x80000
  s_bfe_u32 s30, 0x70702, s31
  s_add_u32 s30, s30, 0
  s_and_b32 s30, s30, 7
  s_lshl_b32 s72, s30, 17
  s_add_u32 s71, s93, s72
  s_add_u32 s8, s86, 83886080
  s_addc_u32 s9, s87, 0
  s_mov_b32 s10, 4194304
  s_mov_b32 s11, 0x00020000
  s_lshl_b32 s92, s73, 1
  s_add_u32 s92, s92, s77
  s_lshl_b32 s92, s92, 17
  s_add_u32 s92, s92, s79
  s_add_u32 s72, s73, s76
  s_and_b32 s1, s72, 3
  s_lshl_b32 s1, s1, 3
  s_or_b32 s1, s1, 0x80000
  s_bfe_u32 s0, 0x70702, s1
  s_add_u32 s0, s0, 0
  s_and_b32 s0, s0, 7
  s_lshl_b32 s72, s0, 14
  s_add_u32 s70, s92, s72
  s_waitcnt lgkmcnt(3)
  v_mfma_f32_16x16x32_bf16 v[192:195], a[32:35], v[32:35], v[192:195]
  s_add_u32 m0, s79, 147456
  ds_read_b128 a[12:15], v4 offset:11264
  v_cndmask_b32 v104, v104, v5, s[32:33]
  v_mfma_f32_16x16x32_bf16 v[224:227], a[32:35], v[36:39], v[224:227]
  v_exp_f32 v104, v104
  v_mfma_f32_16x16x32_bf16 a[200:203], a[208:211], v[32:35], a[200:203]
  v_cndmask_b32 v105, v105, v5, s[34:35]
  v_exp_f32 v105, v105
  v_mfma_f32_16x16x32_bf16 v[196:199], a[36:39], v[32:35], v[196:199]
  buffer_load_dwordx4 v10, s[12:15], s71 offen offset:0 lds
  v_mfma_f32_16x16x32_bf16 v[228:231], a[36:39], v[36:39], v[228:231]
  v_cndmask_b32 v106, v106, v5, s[36:37]
  v_exp_f32 v106, v106
  v_mfma_f32_16x16x32_bf16 a[204:207], a[208:211], v[36:39], a[204:207]
  buffer_load_dwordx4 v11, s[12:15], s71 offen offset:1024 lds
  v_mfma_f32_16x16x32_bf16 v[200:203], a[40:43], v[32:35], v[200:203]
  v_cndmask_b32 v107, v107, v5, s[38:39]
  v_exp_f32 v107, v107
  v_mfma_f32_16x16x32_bf16 v[232:235], a[40:43], v[36:39], v[232:235]
  ds_read_b128 a[16:19], v4 offset:12288
  ds_read_b128 a[20:23], v4 offset:13312
  v_mfma_f32_16x16x32_bf16 v[204:207], a[44:47], v[32:35], v[204:207]
  v_cndmask_b32 v108, v108, v5, s[40:41]
  v_exp_f32 v108, v108
  v_mfma_f32_16x16x32_bf16 v[236:239], a[44:47], v[36:39], v[236:239]
  buffer_load_dwordx4 v12, s[12:15], s71 offen offset:2048 lds
  v_cvt_pk_bf16_f32 v53, v106, v107
  v_mfma_f32_16x16x32_bf16 v[208:211], a[48:51], v[32:35], v[208:211]
  v_cndmask_b32 v109, v109, v5, s[42:43]
  v_exp_f32 v109, v109
  v_mfma_f32_16x16x32_bf16 v[240:243], a[48:51], v[36:39], v[240:243]
  ds_read_b128 a[24:27], v4 offset:14336
  ds_read_b128 a[28:31], v4 offset:15360
  v_mfma_f32_16x16x32_bf16 v[212:215], a[52:55], v[32:35], v[212:215]
  v_cndmask_b32 v110, v110, v5, s[44:45]
  v_exp_f32 v110, v110
  v_mfma_f32_16x16x32_bf16 v[244:247], a[52:55], v[36:39], v[244:247]
  buffer_load_dwordx4 v13, s[12:15], s71 offen offset:3072 lds
  v_cvt_pk_bf16_f32 v54, v108, v109
  v_mfma_f32_16x16x32_bf16 v[216:219], a[56:59], v[32:35], v[216:219]
  s_bfe_u32 s72, 0x3020106, s31
  v_cndmask_b32 v111, v111, v5, s[46:47]
  v_exp_f32 v111, v111
  v_mfma_f32_16x16x32_bf16 v[248:251], a[56:59], v[36:39], v[248:251]
  s_add_u32 s30, s30, s72
  s_add_u32 s31, s31, 8
  s_and_b32 s31, s31, 0x8001f
  v_mfma_f32_16x16x32_bf16 v[220:223], a[60:63], v[32:35], v[220:223]
  s_and_b32 s30, s30, 7
  s_lshl_b32 s72, s30, 17
  s_add_u32 s71, s93, s72
  v_mfma_f32_16x16x32_bf16 v[252:255], a[60:63], v[36:39], v[252:255]
  s_waitcnt lgkmcnt(0)
  v_cndmask_b32 v120, v120, v5, s[48:49]
  v_exp_f32 v120, v120
  v_mfma_f32_16x16x32_bf16 v[192:195], a[0:3], v[40:43], v[192:195]
  s_add_u32 m0, s79, 131072
  v_xor_b32 v4, 0x4000, v4
  v_cvt_pk_bf16_f32 v52, v104, v105
  v_mfma_f32_16x16x32_bf16 v[224:227], a[0:3], v[44:47], v[224:227]
  v_cndmask_b32 v121, v121, v5, s[50:51]
  v_exp_f32 v121, v121
  v_mfma_f32_16x16x32_bf16 a[200:203], a[208:211], v[40:43], a[200:203]
  buffer_load_dwordx4 v2, s[8:11], s70 offen offset:0 sc1 lds
  v_cvt_pk_bf16_f32 v55, v110, v111
  v_mfma_f32_16x16x32_bf16 v[196:199], a[4:7], v[40:43], v[196:199]
  v_cndmask_b32 v122, v122, v5, s[52:53]
  v_exp_f32 v122, v122
  v_mfma_f32_16x16x32_bf16 v[228:231], a[4:7], v[44:47], v[228:231]
  buffer_load_dwordx4 v2, s[8:11], s70 offen offset:1024 sc1 lds
  v_cvt_pk_bf16_f32 v60, v120, v121
  v_mfma_f32_16x16x32_bf16 a[204:207], a[208:211], v[44:47], a[204:207]
  v_cndmask_b32 v123, v123, v5, s[54:55]
  v_exp_f32 v123, v123
  v_mfma_f32_16x16x32_bf16 v[200:203], a[8:11], v[40:43], v[200:203]
  buffer_load_dwordx4 v2, s[8:11], s70 offen offset:2048 sc1 lds
  v_cvt_pk_bf16_f32 v61, v122, v123
  v_mfma_f32_16x16x32_bf16 v[232:235], a[8:11], v[44:47], v[232:235]
  v_cndmask_b32 v124, v124, v5, s[56:57]
  v_exp_f32 v124, v124
  v_mfma_f32_16x16x32_bf16 v[204:207], a[12:15], v[40:43], v[204:207]
  ds_read_b128 a[32:35], v4 offset:0
  ds_read_b128 a[36:39], v4 offset:1024
  v_mfma_f32_16x16x32_bf16 v[236:239], a[12:15], v[44:47], v[236:239]
  v_cndmask_b32 v125, v125, v5, s[58:59]
  v_exp_f32 v125, v125
  v_mfma_f32_16x16x32_bf16 v[208:211], a[16:19], v[40:43], v[208:211]
  buffer_load_dwordx4 v2, s[8:11], s70 offen offset:3072 sc1 lds
  v_cvt_pk_bf16_f32 v62, v124, v125
  v_mfma_f32_16x16x32_bf16 v[240:243], a[16:19], v[44:47], v[240:243]
  s_bfe_u32 s72, 0x3020106, s1
  v_cndmask_b32 v126, v126, v5, s[60:61]
  v_exp_f32 v126, v126
  v_mfma_f32_16x16x32_bf16 v[212:215], a[20:23], v[40:43], v[212:215]
  s_add_u32 s0, s0, s72
  s_add_u32 s1, s1, 8
  s_and_b32 s1, s1, 0x8001f
  v_mfma_f32_16x16x32_bf16 v[244:247], a[20:23], v[44:47], v[244:247]
  s_and_b32 s0, s0, 7
  v_cndmask_b32 v127, v127, v5, s[62:63]
  v_exp_f32 v127, v127
  v_mfma_f32_16x16x32_bf16 v[216:219], a[24:27], v[40:43], v[216:219]
  s_lshl_b32 s72, s0, 14
  s_add_u32 s70, s92, s72
  ds_read_b128 a[40:43], v4 offset:2048
  v_cvt_pk_bf16_f32 v63, v126, v127
  v_mfma_f32_16x16x32_bf16 v[248:251], a[24:27], v[44:47], v[248:251]
  ds_read_b128 a[44:47], v4 offset:3072
  ds_read_b128 a[48:51], v4 offset:4096
  v_mfma_f32_16x16x32_bf16 v[220:223], a[28:31], v[40:43], v[220:223]
  ds_read_b128 a[52:55], v4 offset:5120
  ds_read_b128 a[56:59], v4 offset:6144
  v_mfma_f32_16x16x32_bf16 v[252:255], a[28:31], v[44:47], v[252:255]
  ds_read_b128 a[60:63], v4 offset:7168
  ds_read_b128 a[0:3], v4 offset:8192
  ds_read_b128 a[4:7], v4 offset:9216
  ds_read_b128 a[8:11], v4 offset:10240
  s_waitcnt lgkmcnt(7)
  v_mfma_f32_16x16x32_bf16 v[224:227], a[32:35], v[52:55], v[224:227]
  s_add_u32 m0, s79, 49152
  ds_read_b128 a[12:15], v4 offset:11264
  v_mfma_f32_16x16x32_bf16 a[204:207], a[208:211], v[52:55], a[204:207]
  buffer_load_dwordx4 v10, s[12:15], s71 offen offset:0 lds
  v_mfma_f32_16x16x32_bf16 v[228:231], a[36:39], v[52:55], v[228:231]
  buffer_load_dwordx4 v11, s[12:15], s71 offen offset:1024 lds
  v_mfma_f32_16x16x32_bf16 v[232:235], a[40:43], v[52:55], v[232:235]
  buffer_load_dwordx4 v12, s[12:15], s71 offen offset:2048 lds
  v_mfma_f32_16x16x32_bf16 v[236:239], a[44:47], v[52:55], v[236:239]
  s_waitcnt lgkmcnt(4)
  ds_read_b128 a[16:19], v4 offset:12288
  ds_read_b128 a[20:23], v4 offset:13312
  v_mfma_f32_16x16x32_bf16 v[240:243], a[48:51], v[52:55], v[240:243]
  buffer_load_dwordx4 v13, s[12:15], s71 offen offset:3072 lds
  ds_read_b128 a[24:27], v4 offset:14336
  v_mfma_f32_16x16x32_bf16 v[244:247], a[52:55], v[52:55], v[244:247]
  s_bfe_u32 s72, 0x3020106, s31
  s_add_u32 s30, s30, s72
  s_add_u32 s31, s31, 8
  v_mfma_f32_16x16x32_bf16 v[248:251], a[56:59], v[52:55], v[248:251]
  s_and_b32 s31, s31, 0x8001f
  s_and_b32 s30, s30, 7
  s_lshl_b32 s72, s30, 17
  v_mfma_f32_16x16x32_bf16 v[252:255], a[60:63], v[52:55], v[252:255]
  s_waitcnt lgkmcnt(3)
  s_add_u32 s71, s93, s72
  s_add_u32 m0, s79, 32768
  v_mfma_f32_16x16x32_bf16 v[224:227], a[0:3], v[60:63], v[224:227]
  buffer_load_dwordx4 v2, s[8:11], s70 offen offset:0 sc1 lds
  ds_read_b128 a[28:31], v4 offset:15360
  v_mfma_f32_16x16x32_bf16 a[204:207], a[208:211], v[60:63], a[204:207]
  buffer_load_dwordx4 v2, s[8:11], s70 offen offset:1024 sc1 lds
  v_mfma_f32_16x16x32_bf16 v[228:231], a[4:7], v[60:63], v[228:231]
  buffer_load_dwordx4 v2, s[8:11], s70 offen offset:2048 sc1 lds
  v_mfma_f32_16x16x32_bf16 v[232:235], a[8:11], v[60:63], v[232:235]
  buffer_load_dwordx4 v2, s[8:11], s70 offen offset:3072 sc1 lds
  v_mfma_f32_16x16x32_bf16 v[236:239], a[12:15], v[60:63], v[236:239]
  s_waitcnt lgkmcnt(0)
  s_bfe_u32 s72, 0x3020106, s1
  s_add_u32 s0, s0, s72
  v_mfma_f32_16x16x32_bf16 v[240:243], a[16:19], v[60:63], v[240:243]
  s_add_u32 s1, s1, 8
  s_and_b32 s1, s1, 0x8001f
  s_and_b32 s0, s0, 7
  v_mfma_f32_16x16x32_bf16 v[244:247], a[20:23], v[60:63], v[244:247]
  s_lshl_b32 s72, s0, 14
  s_add_u32 s70, s92, s72
  v_mfma_f32_16x16x32_bf16 v[248:251], a[24:27], v[60:63], v[248:251]
  v_mfma_f32_16x16x32_bf16 v[252:255], a[28:31], v[60:63], v[252:255]
  s_and_b32 s88, s25, 1
  s_lshl_b32 s88, s88, 1
  s_add_u32 s88, s88, 14
  s_sub_u32 s88, s88, s25
  s_lshl_b32 s4, s88, 20
  s_lshl_b32 s5, s24, 15
  s_add_u32 s4, s4, s5
  s_lshl_b32 s5, s3, 11
  s_add_u32 s4, s4, s5
  v_accvgpr_read_b32 v6, a200
  v_accvgpr_read_b32 v8, a204
  s_mov_b32 s5, 0x5f800000
  v_cmp_ngt_f32 vcc, s5, v6
  v_rcp_f32 v6, v6
  s_or_b32 s89, s89, vcc_lo
  s_or_b32 s89, s89, vcc_hi
  v_mov_b32 v7, v6
  v_cmp_ngt_f32 vcc, s5, v8
  v_rcp_f32 v8, v8
  s_or_b32 s89, s89, vcc_lo
  s_or_b32 s89, s89, vcc_hi
  v_mov_b32 v9, v8
  v_pk_mul_f32 v[192:193], v[192:193], v[6:7]
  v_pk_mul_f32 v[194:195], v[194:195], v[6:7]
  v_pk_mul_f32 v[196:197], v[196:197], v[6:7]
  v_pk_mul_f32 v[198:199], v[198:199], v[6:7]
  v_cvt_pk_bf16_f32 v192, v192, v193
  v_cvt_pk_bf16_f32 v193, v194, v195
  v_cvt_pk_bf16_f32 v194, v196, v197
  v_cvt_pk_bf16_f32 v195, v198, v199
  buffer_store_dwordx4 v[192:195], v2, s[16:19], s4 offen offset:0 sc1
  v_pk_mul_f32 v[224:225], v[224:225], v[8:9]
  v_pk_mul_f32 v[226:227], v[226:227], v[8:9]
  v_pk_mul_f32 v[228:229], v[228:229], v[8:9]
  v_pk_mul_f32 v[230:231], v[230:231], v[8:9]
  v_cvt_pk_bf16_f32 v224, v224, v225
  v_cvt_pk_bf16_f32 v225, v226, v227
  v_cvt_pk_bf16_f32 v226, v228, v229
  v_cvt_pk_bf16_f32 v227, v230, v231
  buffer_store_dwordx4 v[224:227], v2, s[16:19], s4 offen offset:1024 sc1
  s_add_u32 s4, s4, 8192
  v_pk_mul_f32 v[200:201], v[200:201], v[6:7]
  v_pk_mul_f32 v[202:203], v[202:203], v[6:7]
  v_pk_mul_f32 v[204:205], v[204:205], v[6:7]
  v_pk_mul_f32 v[206:207], v[206:207], v[6:7]
  v_cvt_pk_bf16_f32 v200, v200, v201
  v_cvt_pk_bf16_f32 v201, v202, v203
  v_cvt_pk_bf16_f32 v202, v204, v205
  v_cvt_pk_bf16_f32 v203, v206, v207
  buffer_store_dwordx4 v[200:203], v2, s[16:19], s4 offen offset:0 sc1
  v_pk_mul_f32 v[232:233], v[232:233], v[8:9]
  v_pk_mul_f32 v[234:235], v[234:235], v[8:9]
  v_pk_mul_f32 v[236:237], v[236:237], v[8:9]
  v_pk_mul_f32 v[238:239], v[238:239], v[8:9]
  v_cvt_pk_bf16_f32 v232, v232, v233
  v_cvt_pk_bf16_f32 v233, v234, v235
  v_cvt_pk_bf16_f32 v234, v236, v237
  v_cvt_pk_bf16_f32 v235, v238, v239
  buffer_store_dwordx4 v[232:235], v2, s[16:19], s4 offen offset:1024 sc1
  s_add_u32 s4, s4, 8192
  v_pk_mul_f32 v[208:209], v[208:209], v[6:7]
  v_pk_mul_f32 v[210:211], v[210:211], v[6:7]
  v_pk_mul_f32 v[212:213], v[212:213], v[6:7]
  v_pk_mul_f32 v[214:215], v[214:215], v[6:7]
  v_cvt_pk_bf16_f32 v208, v208, v209
  v_cvt_pk_bf16_f32 v209, v210, v211
  v_cvt_pk_bf16_f32 v210, v212, v213
  v_cvt_pk_bf16_f32 v211, v214, v215
  buffer_store_dwordx4 v[208:211], v2, s[16:19], s4 offen offset:0 sc1
  v_pk_mul_f32 v[240:241], v[240:241], v[8:9]
  v_pk_mul_f32 v[242:243], v[242:243], v[8:9]
  v_pk_mul_f32 v[244:245], v[244:245], v[8:9]
  v_pk_mul_f32 v[246:247], v[246:247], v[8:9]
  v_cvt_pk_bf16_f32 v240, v240, v241
  v_cvt_pk_bf16_f32 v241, v242, v243
  v_cvt_pk_bf16_f32 v242, v244, v245
  v_cvt_pk_bf16_f32 v243, v246, v247
  buffer_store_dwordx4 v[240:243], v2, s[16:19], s4 offen offset:1024 sc1
  s_add_u32 s4, s4, 8192
  v_pk_mul_f32 v[216:217], v[216:217], v[6:7]
  v_pk_mul_f32 v[218:219], v[218:219], v[6:7]
  v_pk_mul_f32 v[220:221], v[220:221], v[6:7]
  v_pk_mul_f32 v[222:223], v[222:223], v[6:7]
  v_cvt_pk_bf16_f32 v216, v216, v217
  v_cvt_pk_bf16_f32 v217, v218, v219
  v_cvt_pk_bf16_f32 v218, v220, v221
  v_cvt_pk_bf16_f32 v219, v222, v223
  buffer_store_dwordx4 v[216:219], v2, s[16:19], s4 offen offset:0 sc1
  v_pk_mul_f32 v[248:249], v[248:249], v[8:9]
  v_pk_mul_f32 v[250:251], v[250:251], v[8:9]
  v_pk_mul_f32 v[252:253], v[252:253], v[8:9]
  v_pk_mul_f32 v[254:255], v[254:255], v[8:9]
  v_cvt_pk_bf16_f32 v248, v248, v249
  v_cvt_pk_bf16_f32 v249, v250, v251
  v_cvt_pk_bf16_f32 v250, v252, v253
  v_cvt_pk_bf16_f32 v251, v254, v255
  buffer_store_dwordx4 v[248:251], v2, s[16:19], s4 offen offset:1024 sc1
  s_cmp_eq_u32 s89, 0
  s_cbranch_scc1 La_done
  s_waitcnt vmcnt(0)
  s_and_b32 s6, s25, 1
  s_lshl_b32 s6, s6, 1
  s_add_u32 s6, s6, 14
  s_sub_u32 s6, s6, s25
La_sl_blk:
  v_mov_b32 v192, 0
  v_mov_b32 v193, 0
  v_mov_b32 v194, 0
  v_mov_b32 v195, 0
  v_mov_b32 v196, 0
  v_mov_b32 v197, 0
  v_mov_b32 v198, 0
  v_mov_b32 v199, 0
  v_mov_b32 v200, 0
  v_mov_b32 v201, 0
  v_mov_b32 v202, 0
  v_mov_b32 v203, 0
  v_mov_b32 v204, 0
  v_mov_b32 v205, 0
  v_mov_b32 v206, 0
  v_mov_b32 v207, 0
  v_mov_b32 v208, 0
  v_mov_b32 v209, 0
  v_mov_b32 v210, 0
  v_mov_b32 v211, 0
  v_mov_b32 v212, 0
  v_mov_b32 v213, 0
  v_mov_b32 v214, 0
  v_mov_b32 v215, 0
  v_mov_b32 v216, 0
  v_mov_b32 v217, 0
  v_mov_b32 v218, 0
  v_mov_b32 v219, 0
  v_mov_b32 v220, 0
  v_mov_b32 v221, 0
  v_mov_b32 v222, 0
  v_mov_b32 v223, 0
  v_mov_b32 v224, 0
  v_mov_b32 v225, 0
  v_mov_b32 v226, 0
  v_mov_b32 v227, 0
  v_mov_b32 v228, 0
  v_mov_b32 v229, 0
  v_mov_b32 v230, 0
  v_mov_b32 v231, 0
  v_mov_b32 v232, 0
  v_mov_b32 v233, 0
  v_mov_b32 v234, 0
  v_mov_b32 v235, 0
  v_mov_b32 v236, 0
  v_mov_b32 v237, 0
  v_mov_b32 v238, 0
  v_mov_b32 v239, 0
  v_mov_b32 v240, 0
  v_mov_b32 v241, 0
  v_mov_b32 v242, 0
  v_mov_b32 v243, 0
  v_mov_b32 v244, 0
  v_mov_b32 v245, 0
  v_mov_b32 v246, 0
  v_mov_b32 v247, 0
  v_mov_b32 v248, 0
  v_mov_b32 v249, 0
  v_mov_b32 v250, 0
  v_mov_b32 v251, 0
  v_mov_b32 v252, 0
  v_mov_b32 v253, 0
  v_mov_b32 v254, 0
  v_mov_b32 v255, 0
  v_mov_b32 v24, 0
  v_mov_b32 v25, 0
  v_mov_b32 v26, 0
  v_mov_b32 v27, 0
  v_mov_b32 v28, 0
  v_mov_b32 v29, 0
  v_mov_b32 v30, 0
  v_mov_b32 v31, 0
  v_mov_b32 v16, v5
  v_mov_b32 v17, v5
  v_and_b32 v20, 15, v1
  v_lshrrev_b32 v21, 4, v1
  v_sub_u32 v20, v20, v21
  v_lshlrev_b32 v20, 2, v20
  s_lshl_b32 s4, s6, 7
  s_add_u32 s4, s4, s3
  v_add_u32 v20, s4, v20
  v_add_u32 v21, 64, v20
  s_add_u32 s7, s6, 1
  s_lshl_b32 s7, s7, 2
  s_mov_b32 s90, 0
La_sl_loop:
  s_add_u32 s4, s90, 0
  buffer_load_dwordx4 a[0:3], v2, s[20:23], s4 offen offset:0 sc1
  buffer_load_dwordx4 a[4:7], v2, s[20:23], s4 offen offset:1024 sc1
  buffer_load_dwordx4 a[8:11], v2, s[20:23], s4 offen offset:2048 sc1
  buffer_load_dwordx4 a[12:15], v2, s[20:23], s4 offen offset:3072 sc1
  s_add_u32 s4, s90, 4096
  buffer_load_dwordx4 a[16:19], v2, s[20:23], s4 offen offset:0 sc1
  buffer_load_dwordx4 a[20:23], v2, s[20:23], s4 offen offset:1024 sc1
  buffer_load_dwordx4 a[24:27], v2, s[20:23], s4 offen offset:2048 sc1
  buffer_load_dwordx4 a[28:31], v2, s[20:23], s4 offen offset:3072 sc1
  s_add_u32 s4, s90, 16384
  buffer_load_dwordx4 a[32:35], v2, s[20:23], s4 offen offset:0 sc1
  buffer_load_dwordx4 a[36:39], v2, s[20:23], s4 offen offset:1024 sc1
  buffer_load_dwordx4 a[40:43], v2, s[20:23], s4 offen offset:2048 sc1
  buffer_load_dwordx4 a[44:47], v2, s[20:23], s4 offen offset:3072 sc1
  s_add_u32 s4, s90, 20480
  buffer_load_dwordx4 a[48:51], v2, s[20:23], s4 offen offset:0 sc1
  buffer_load_dwordx4 a[52:55], v2, s[20:23], s4 offen offset:1024 sc1
  buffer_load_dwordx4 a[56:59], v2, s[20:23], s4 offen offset:2048 sc1
  buffer_load_dwordx4 a[60:63], v2, s[20:23], s4 offen offset:3072 sc1
  s_waitcnt vmcnt(0)
  v_mfma_f32_16x16x32_bf16 v[64:67], a[0:3], a[160:163], 0
  v_mfma_f32_16x16x32_bf16 v[72:75], a[0:3], a[176:179], 0
  v_mfma_f32_16x16x32_bf16 v[64:67], a[4:7], a[164:167], v[64:67]
  v_mfma_f32_16x16x32_bf16 v[72:75], a[4:7], a[180:183], v[72:75]
  v_mfma_f32_16x16x32_bf16 v[64:67], a[8:11], a[168:171], v[64:67]
  v_mfma_f32_16x16x32_bf16 v[72:75], a[8:11], a[184:187], v[72:75]
  v_mfma_f32_16x16x32_bf16 v[64:67], a[12:15], a[172:175], v[64:67]
  v_mfma_f32_16x16x32_bf16 v[72:75], a[12:15], a[188:191], v[72:75]
  v_mfma_f32_16x16x32_bf16 v[68:71], a[16:19], a[160:163], 0
  v_mfma_f32_16x16x32_bf16 v[76:79], a[16:19], a[176:179], 0
  v_mfma_f32_16x16x32_bf16 v[68:71], a[20:23], a[164:167], v[68:71]
  v_mfma_f32_16x16x32_bf16 v[76:79], a[20:23], a[180:183], v[76:79]
  v_mfma_f32_16x16x32_bf16 v[68:71], a[24:27], a[168:171], v[68:71]
  v_mfma_f32_16x16x32_bf16 v[76:79], a[24:27], a[184:187], v[76:79]
  v_mfma_f32_16x16x32_bf16 v[68:71], a[28:31], a[172:175], v[68:71]
  v_mfma_f32_16x16x32_bf16 v[76:79], a[28:31], a[188:191], v[76:79]
  v_cmp_gt_i32 vcc, 0, v20
  s_nop 1
  v_cndmask_b32 v64, v64, v5, vcc
  v_cmp_gt_i32 vcc, 1, v20
  s_nop 1
  v_cndmask_b32 v65, v65, v5, vcc
  v_cmp_gt_i32 vcc, 2, v20
  s_nop 1
  v_cndmask_b32 v66, v66, v5, vcc
  v_cmp_gt_i32 vcc, 3, v20
  s_nop 1
  v_cndmask_b32 v67, v67, v5, vcc
  v_cmp_gt_i32 vcc, 16, v20
  s_nop 1
  v_cndmask_b32 v68, v68, v5, vcc
  v_cmp_gt_i32 vcc, 17, v20
  s_nop 1
  v_cndmask_b32 v69, v69, v5, vcc
  v_cmp_gt_i32 vcc, 18, v20
  s_nop 1
  v_cndmask_b32 v70, v70, v5, vcc
  v_cmp_gt_i32 vcc, 19, v20
  s_nop 1
  v_cndmask_b32 v71, v71, v5, vcc
  v_subrev_u32 v20, 32, v20
  v_max3_f32 v6, v64, v65, v66
  v_max3_f32 v7, v67, v68, v69
  v_max3_f32 v6, v6, v70, v71
  v_max_f32 v6, v6, v7
  v_cmp_gt_i32 vcc, 0, v21
  s_nop 1
  v_cndmask_b32 v72, v72, v5, vcc
  v_cmp_gt_i32 vcc, 1, v21
  s_nop 1
  v_cndmask_b32 v73, v73, v5, vcc
  v_cmp_gt_i32 vcc, 2, v21
  s_nop 1
  v_cndmask_b32 v74, v74, v5, vcc
  v_cmp_gt_i32 vcc, 3, v21
  s_nop 1
  v_cndmask_b32 v75, v75, v5, vcc
  v_cmp_gt_i32 vcc, 16, v21
  s_nop 1
  v_cndmask_b32 v76, v76, v5, vcc
  v_cmp_gt_i32 vcc, 17, v21
  s_nop 1
  v_cndmask_b32 v77, v77, v5, vcc
  v_cmp_gt_i32 vcc, 18, v21
  s_nop 1
  v_cndmask_b32 v78, v78, v5, vcc
  v_cmp_gt_i32 vcc, 19, v21
  s_nop 1
  v_cndmask_b32 v79, v79, v5, vcc
  v_subrev_u32 v21, 32, v21
  v_max3_f32 v8, v72, v73, v74
  v_max3_f32 v9, v75, v76, v77
  v_max3_f32 v8, v8, v78, v79
  v_max_f32 v8, v8, v9
  v_mov_b32 v7, v6
  v_mov_b32 v9, v8
  s_nop 0
  v_permlane32_swap_b32 v6, v7
  v_permlane32_swap_b32 v8, v9
  v_max_f32 v6, v6, v7
  v_max_f32 v8, v8, v9
  v_mov_b32 v7, v6
  v_mov_b32 v9, v8
  s_nop 0
  v_permlane16_swap_b32 v6, v7
  v_permlane16_swap_b32 v8, v9
  v_max_f32 v6, v6, v7
  v_max_f32 v8, v8, v9
  v_max_f32 v6, v6, v16
  v_sub_f32 v7, v16, v6
  v_exp_f32 v7, v7
  v_mov_b32 v16, v6
  v_sub_f32 v64, v64, v16
  v_sub_f32 v65, v65, v16
  v_sub_f32 v66, v66, v16
  v_sub_f32 v67, v67, v16
  v_sub_f32 v68, v68, v16
  v_sub_f32 v69, v69, v16
  v_sub_f32 v70, v70, v16
  v_sub_f32 v71, v71, v16
  v_exp_f32 v64, v64
  v_exp_f32 v65, v65
  v_exp_f32 v66, v66
  v_exp_f32 v67, v67
  v_exp_f32 v68, v68
  v_exp_f32 v69, v69
  v_exp_f32 v70, v70
  v_exp_f32 v71, v71
  v_mul_f32 v24, v24, v7
  v_mul_f32 v25, v25, v7
  v_mul_f32 v26, v26, v7
  v_mul_f32 v27, v27, v7
  v_mul_f32 v192, v192, v7
  v_mul_f32 v193, v193, v7
  v_mul_f32 v194, v194, v7
  v_mul_f32 v195, v195, v7
  v_mul_f32 v196, v196, v7
  v_mul_f32 v197, v197, v7
  v_mul_f32 v198, v198, v7
  v_mul_f32 v199, v199, v7
  v_mul_f32 v200, v200, v7
  v_mul_f32 v201, v201, v7
  v_mul_f32 v202, v202, v7
  v_mul_f32 v203, v203, v7
  v_mul_f32 v204, v204, v7
  v_mul_f32 v205, v205, v7
  v_mul_f32 v206, v206, v7
  v_mul_f32 v207, v207, v7
  v_mul_f32 v208, v208, v7
  v_mul_f32 v209, v209, v7
  v_mul_f32 v210, v210, v7
  v_mul_f32 v211, v211, v7
  v_mul_f32 v212, v212, v7
  v_mul_f32 v213, v213, v7
  v_mul_f32 v214, v214, v7
  v_mul_f32 v215, v215, v7
  v_mul_f32 v216, v216, v7
  v_mul_f32 v217, v217, v7
  v_mul_f32 v218, v218, v7
  v_mul_f32 v219, v219, v7
  v_mul_f32 v220, v220, v7
  v_mul_f32 v221, v221, v7
  v_mul_f32 v222, v222, v7
  v_mul_f32 v223, v223, v7
  v_cvt_pk_bf16_f32 v32, v64, v65
  v_cvt_pk_bf16_f32 v33, v66, v67
  v_cvt_pk_bf16_f32 v34, v68, v69
  v_cvt_pk_bf16_f32 v35, v70, v71
  v_max_f32 v8, v8, v17
  v_sub_f32 v9, v17, v8
  v_exp_f32 v9, v9
  v_mov_b32 v17, v8
  v_sub_f32 v72, v72, v17
  v_sub_f32 v73, v73, v17
  v_sub_f32 v74, v74, v17
  v_sub_f32 v75, v75, v17
  v_sub_f32 v76, v76, v17
  v_sub_f32 v77, v77, v17
  v_sub_f32 v78, v78, v17
  v_sub_f32 v79, v79, v17
  v_exp_f32 v72, v72
  v_exp_f32 v73, v73
  v_exp_f32 v74, v74
  v_exp_f32 v75, v75
  v_exp_f32 v76, v76
  v_exp_f32 v77, v77
  v_exp_f32 v78, v78
  v_exp_f32 v79, v79
  v_mul_f32 v28, v28, v9
  v_mul_f32 v29, v29, v9
  v_mul_f32 v30, v30, v9
  v_mul_f32 v31, v31, v9
  v_mul_f32 v224, v224, v9
  v_mul_f32 v225, v225, v9
  v_mul_f32 v226, v226, v9
  v_mul_f32 v227, v227, v9
  v_mul_f32 v228, v228, v9
  v_mul_f32 v229, v229, v9
  v_mul_f32 v230, v230, v9
  v_mul_f32 v231, v231, v9
  v_mul_f32 v232, v232, v9
  v_mul_f32 v233, v233, v9
  v_mul_f32 v234, v234, v9
  v_mul_f32 v235, v235, v9
  v_mul_f32 v236, v236, v9
  v_mul_f32 v237, v237, v9
  v_mul_f32 v238, v238, v9
  v_mul_f32 v239, v239, v9
  v_mul_f32 v240, v240, v9
  v_mul_f32 v241, v241, v9
  v_mul_f32 v242, v242, v9
  v_mul_f32 v243, v243, v9
  v_mul_f32 v244, v244, v9
  v_mul_f32 v245, v245, v9
  v_mul_f32 v246, v246, v9
  v_mul_f32 v247, v247, v9
  v_mul_f32 v248, v248, v9
  v_mul_f32 v249, v249, v9
  v_mul_f32 v250, v250, v9
  v_mul_f32 v251, v251, v9
  v_mul_f32 v252, v252, v9
  v_mul_f32 v253, v253, v9
  v_mul_f32 v254, v254, v9
  v_mul_f32 v255, v255, v9
  v_cvt_pk_bf16_f32 v36, v72, v73
  v_cvt_pk_bf16_f32 v37, v74, v75
  v_cvt_pk_bf16_f32 v38, v76, v77
  v_cvt_pk_bf16_f32 v39, v78, v79
  v_mfma_f32_16x16x32_bf16 v[24:27], a[208:211], v[32:35], v[24:27]
  v_mfma_f32_16x16x32_bf16 v[192:195], a[32:35], v[32:35], v[192:195]
  v_mfma_f32_16x16x32_bf16 v[196:199], a[36:39], v[32:35], v[196:199]
  v_mfma_f32_16x16x32_bf16 v[200:203], a[40:43], v[32:35], v[200:203]
  v_mfma_f32_16x16x32_bf16 v[204:207], a[44:47], v[32:35], v[204:207]
  v_mfma_f32_16x16x32_bf16 v[208:211], a[48:51], v[32:35], v[208:211]
  v_mfma_f32_16x16x32_bf16 v[212:215], a[52:55], v[32:35], v[212:215]
  v_mfma_f32_16x16x32_bf16 v[216:219], a[56:59], v[32:35], v[216:219]
  v_mfma_f32_16x16x32_bf16 v[220:223], a[60:63], v[32:35], v[220:223]
  v_mfma_f32_16x16x32_bf16 v[28:31], a[208:211], v[36:39], v[28:31]
  v_mfma_f32_16x16x32_bf16 v[224:227], a[32:35], v[36:39], v[224:227]
  v_mfma_f32_16x16x32_bf16 v[228:231], a[36:39], v[36:39], v[228:231]
  v_mfma_f32_16x16x32_bf16 v[232:235], a[40:43], v[36:39], v[232:235]
  v_mfma_f32_16x16x32_bf16 v[236:239], a[44:47], v[36:39], v[236:239]
  v_mfma_f32_16x16x32_bf16 v[240:243], a[48:51], v[36:39], v[240:243]
  v_mfma_f32_16x16x32_bf16 v[244:247], a[52:55], v[36:39], v[244:247]
  v_mfma_f32_16x16x32_bf16 v[248:251], a[56:59], v[36:39], v[248:251]
  v_mfma_f32_16x16x32_bf16 v[252:255], a[60:63], v[36:39], v[252:255]
  s_add_u32 s90, s90, 8192
  s_and_b32 s4, s90, 0x4000
  s_add_u32 s90, s90, s4
  s_sub_u32 s7, s7, 1
  s_cmp_lg_u32 s7, 0
  s_cbranch_scc1 La_sl_loop
  s_lshl_b32 s4, s6, 20
  s_lshl_b32 s5, s24, 15
  s_add_u32 s4, s4, s5
  s_lshl_b32 s5, s3, 11
  s_add_u32 s4, s4, s5
  v_rcp_f32 v6, v24
  s_nop 0
  v_mov_b32 v7, v6
  v_rcp_f32 v8, v28
  s_nop 0
  v_mov_b32 v9, v8
  v_pk_mul_f32 v[192:193], v[192:193], v[6:7]
  v_pk_mul_f32 v[194:195], v[194:195], v[6:7]
  v_pk_mul_f32 v[196:197], v[196:197], v[6:7]
  v_pk_mul_f32 v[198:199], v[198:199], v[6:7]
  v_cvt_pk_bf16_f32 v192, v192, v193
  v_cvt_pk_bf16_f32 v193, v194, v195
  v_cvt_pk_bf16_f32 v194, v196, v197
  v_cvt_pk_bf16_f32 v195, v198, v199
  buffer_store_dwordx4 v[192:195], v2, s[16:19], s4 offen offset:0 sc1
  v_pk_mul_f32 v[224:225], v[224:225], v[8:9]
  v_pk_mul_f32 v[226:227], v[226:227], v[8:9]
  v_pk_mul_f32 v[228:229], v[228:229], v[8:9]
  v_pk_mul_f32 v[230:231], v[230:231], v[8:9]
  v_cvt_pk_bf16_f32 v224, v224, v225
  v_cvt_pk_bf16_f32 v225, v226, v227
  v_cvt_pk_bf16_f32 v226, v228, v229
  v_cvt_pk_bf16_f32 v227, v230, v231
  buffer_store_dwordx4 v[224:227], v2, s[16:19], s4 offen offset:1024 sc1
  s_add_u32 s4, s4, 8192
  v_pk_mul_f32 v[200:201], v[200:201], v[6:7]
  v_pk_mul_f32 v[202:203], v[202:203], v[6:7]
  v_pk_mul_f32 v[204:205], v[204:205], v[6:7]
  v_pk_mul_f32 v[206:207], v[206:207], v[6:7]
  v_cvt_pk_bf16_f32 v200, v200, v201
  v_cvt_pk_bf16_f32 v201, v202, v203
  v_cvt_pk_bf16_f32 v202, v204, v205
  v_cvt_pk_bf16_f32 v203, v206, v207
  buffer_store_dwordx4 v[200:203], v2, s[16:19], s4 offen offset:0 sc1
  v_pk_mul_f32 v[232:233], v[232:233], v[8:9]
  v_pk_mul_f32 v[234:235], v[234:235], v[8:9]
  v_pk_mul_f32 v[236:237], v[236:237], v[8:9]
  v_pk_mul_f32 v[238:239], v[238:239], v[8:9]
  v_cvt_pk_bf16_f32 v232, v232, v233
  v_cvt_pk_bf16_f32 v233, v234, v235
  v_cvt_pk_bf16_f32 v234, v236, v237
  v_cvt_pk_bf16_f32 v235, v238, v239
  buffer_store_dwordx4 v[232:235], v2, s[16:19], s4 offen offset:1024 sc1
  s_add_u32 s4, s4, 8192
  v_pk_mul_f32 v[208:209], v[208:209], v[6:7]
  v_pk_mul_f32 v[210:211], v[210:211], v[6:7]
  v_pk_mul_f32 v[212:213], v[212:213], v[6:7]
  v_pk_mul_f32 v[214:215], v[214:215], v[6:7]
  v_cvt_pk_bf16_f32 v208, v208, v209
  v_cvt_pk_bf16_f32 v209, v210, v211
  v_cvt_pk_bf16_f32 v210, v212, v213
  v_cvt_pk_bf16_f32 v211, v214, v215
  buffer_store_dwordx4 v[208:211], v2, s[16:19], s4 offen offset:0 sc1
  v_pk_mul_f32 v[240:241], v[240:241], v[8:9]
  v_pk_mul_f32 v[242:243], v[242:243], v[8:9]
  v_pk_mul_f32 v[244:245], v[244:245], v[8:9]
  v_pk_mul_f32 v[246:247], v[246:247], v[8:9]
  v_cvt_pk_bf16_f32 v240, v240, v241
  v_cvt_pk_bf16_f32 v241, v242, v243
  v_cvt_pk_bf16_f32 v242, v244, v245
  v_cvt_pk_bf16_f32 v243, v246, v247
  buffer_store_dwordx4 v[240:243], v2, s[16:19], s4 offen offset:1024 sc1
  s_add_u32 s4, s4, 8192
  v_pk_mul_f32 v[216:217], v[216:217], v[6:7]
  v_pk_mul_f32 v[218:219], v[218:219], v[6:7]
  v_pk_mul_f32 v[220:221], v[220:221], v[6:7]
  v_pk_mul_f32 v[222:223], v[222:223], v[6:7]
  v_cvt_pk_bf16_f32 v216, v216, v217
  v_cvt_pk_bf16_f32 v217, v218, v219
  v_cvt_pk_bf16_f32 v218, v220, v221
  v_cvt_pk_bf16_f32 v219, v222, v223
  buffer_store_dwordx4 v[216:219], v2, s[16:19], s4 offen offset:0 sc1
  v_pk_mul_f32 v[248:249], v[248:249], v[8:9]
  v_pk_mul_f32 v[250:251], v[250:251], v[8:9]
  v_pk_mul_f32 v[252:253], v[252:253], v[8:9]
  v_pk_mul_f32 v[254:255], v[254:255], v[8:9]
  v_cvt_pk_bf16_f32 v248, v248, v249
  v_cvt_pk_bf16_f32 v249, v250, v251
  v_cvt_pk_bf16_f32 v250, v252, v253
  v_cvt_pk_bf16_f32 v251, v254, v255
  buffer_store_dwordx4 v[248:251], v2, s[16:19], s4 offen offset:1024 sc1
  s_cmp_eq_u32 s6, s25
  s_cbranch_scc1 La_done
  v_accvgpr_read_b32 v64, a128
  v_accvgpr_read_b32 v65, a129
  v_accvgpr_read_b32 v66, a130
  v_accvgpr_read_b32 v67, a131
  v_accvgpr_read_b32 v68, a132
  v_accvgpr_read_b32 v69, a133
  v_accvgpr_read_b32 v70, a134
  v_accvgpr_read_b32 v71, a135
  v_accvgpr_read_b32 v72, a136
  v_accvgpr_read_b32 v73, a137
  v_accvgpr_read_b32 v74, a138
  v_accvgpr_read_b32 v75, a139
  v_accvgpr_read_b32 v76, a140
  v_accvgpr_read_b32 v77, a141
  v_accvgpr_read_b32 v78, a142
  v_accvgpr_read_b32 v79, a143
  v_accvgpr_read_b32 v80, a144
  v_accvgpr_read_b32 v81, a145
  v_accvgpr_read_b32 v82, a146
  v_accvgpr_read_b32 v83, a147
  v_accvgpr_read_b32 v84, a148
  v_accvgpr_read_b32 v85, a149
  v_accvgpr_read_b32 v86, a150
  v_accvgpr_read_b32 v87, a151
  v_accvgpr_read_b32 v88, a152
  v_accvgpr_read_b32 v89, a153
  v_accvgpr_read_b32 v90, a154
  v_accvgpr_read_b32 v91, a155
  v_accvgpr_read_b32 v92, a156
  v_accvgpr_read_b32 v93, a157
  v_accvgpr_read_b32 v94, a158
  v_accvgpr_read_b32 v95, a159
  v_accvgpr_write_b32 a160, v64
  v_accvgpr_write_b32 a161, v65
  v_accvgpr_write_b32 a162, v66
  v_accvgpr_write_b32 a163, v67
  v_accvgpr_write_b32 a164, v68
  v_accvgpr_write_b32 a165, v69
  v_accvgpr_write_b32 a166, v70
  v_accvgpr_write_b32 a167, v71
  v_accvgpr_write_b32 a168, v72
  v_accvgpr_write_b32 a169, v73
  v_accvgpr_write_b32 a170, v74
  v_accvgpr_write_b32 a171, v75
  v_accvgpr_write_b32 a172, v76
  v_accvgpr_write_b32 a173, v77
  v_accvgpr_write_b32 a174, v78
  v_accvgpr_write_b32 a175, v79
  v_accvgpr_write_b32 a176, v80
  v_accvgpr_write_b32 a177, v81
  v_accvgpr_write_b32 a178, v82
  v_accvgpr_write_b32 a179, v83
  v_accvgpr_write_b32 a180, v84
  v_accvgpr_write_b32 a181, v85
  v_accvgpr_write_b32 a182, v86
  v_accvgpr_write_b32 a183, v87
  v_accvgpr_write_b32 a184, v88
  v_accvgpr_write_b32 a185, v89
  v_accvgpr_write_b32 a186, v90
  v_accvgpr_write_b32 a187, v91
  v_accvgpr_write_b32 a188, v92
  v_accvgpr_write_b32 a189, v93
  v_accvgpr_write_b32 a190, v94
  v_accvgpr_write_b32 a191, v95
  s_mov_b32 s6, s25
  s_branch La_sl_blk
La_done:
  s_lshr_b32 s4, s3, 1
  s_lshl_b32 s4, s4, 12
  s_add_u32 s4, s4, 131072
  s_lshl_b32 s5, s77, 11
  s_add_u32 s4, s4, s5
  v_add_u32 v16, s4, v2
  v_xor_b32 v17, 0x800, v16
  s_and_b32 s4, s3, 1
  s_lshl_b32 s4, s4, 13
  s_add_u32 s4, s4, 131072
  v_lshrrev_b32 v24, 2, v1
  v_and_b32 v25, 6, v24
  v_lshlrev_b32 v24, 7, v24
  v_and_b32 v26, 1, v1
  v_lshl_add_u32 v24, v26, 3, v24
  v_add_u32 v24, s4, v24
  v_bfe_u32 v26, v1, 1, 1
  v_xor_b32 v25, v25, v26
  v_xor_b32 v26, 0, v25
  v_lshl_add_u32 v18, v26, 4, v24
  v_xor_b32 v26, 2, v25
  v_lshl_add_u32 v19, v26, 4, v24
  v_xor_b32 v26, 4, v25
  v_lshl_add_u32 v20, v26, 4, v24
  v_xor_b32 v26, 6, v25
  v_lshl_add_u32 v21, v26, 4, v24
  s_mov_b32 s65, 0
  s_mov_b32 s67, 4294868992
  s_mov_b32 s68, 32768
  s_mov_b32 s65, 3
  s_lshl_b32 s36, s24, 7
  s_add_u32 s36, s36, 65536
  s_and_b32 s37, s25, 1
  s_lshl_b32 s37, s37, 1
  s_add_u32 s37, s37, 14
  s_sub_u32 s37, s37, s25
  s_lshl_b32 s37, s37, 12
  s_add_u32 s37, s37, s36
  s_lshl_b32 s38, s25, 12
  s_add_u32 s36, s36, s38
  s_lshl_b32 s38, s78, 1
  s_add_u32 s38, s38, s77
  s_lshl_b32 s38, s38, 7
  s_add_u32 s38, s38, 163840
  s_lshl_b32 s91, s73, 12
  s_add_u32 s91, s91, 65536
  s_lshl_b32 s39, s78, 1
  s_add_u32 s39, s39, s77
  s_xor_b32 s39, s39, 1
  s_lshl_b32 s39, s39, 7
  s_add_u32 s39, s39, 163840
  s_sub_u32 s39, s39, s91
  v_mov_b32 v8, 0x40000000
  v_mov_b32 v6, s94
  v_cmp_eq_u32 vcc, 0, v0
  v_mov_b32 v7, s95
  s_nop 0
  v_cndmask_b32_e64 v8, v8, 0, vcc
  v_lshlrev_b32 v14, 7, v1
  v_mov_b32 v9, s39
  v_cmp_gt_u32 vcc, 32, v1
  s_nop 1
  v_cndmask_b32 v14, v9, v14, vcc
  s_waitcnt vmcnt(16)
  s_barrier
  ds_read_b128 a[96:99], v16 offset:0
  ds_read_b128 a[112:115], v16 offset:8192
  ds_read_b64_tr_b16 a[128:129], v18 offset:16384
  ds_read_b64_tr_b16 a[130:131], v18 offset:18432
  ds_read_b64_tr_b16 a[144:145], v18 offset:20480
  ds_read_b64_tr_b16 a[146:147], v18 offset:22528
  ds_read_b128 a[100:103], v16 offset:1024
  ds_read_b128 a[116:119], v16 offset:9216
  ds_read_b128 a[104:107], v17 offset:0
  ds_read_b128 a[120:123], v17 offset:8192
  ds_read_b128 a[108:111], v17 offset:1024
  ds_read_b128 a[124:127], v17 offset:9216
  ds_read_b64_tr_b16 a[132:133], v19 offset:16384
  ds_read_b64_tr_b16 a[134:135], v19 offset:18432
  ds_read_b64_tr_b16 a[148:149], v19 offset:20480
  ds_read_b64_tr_b16 a[150:151], v19 offset:22528
  s_waitcnt lgkmcnt(0)
  v_mfma_f32_16x16x32_bf16 v[32:35], a[128:131], a[96:99], 0
  s_add_u32 m0, s79, 81920
  ds_read_b64_tr_b16 a[136:137], v20 offset:16384
  ds_read_b64_tr_b16 a[138:139], v20 offset:18432
  v_mfma_f32_16x16x32_bf16 v[32:35], a[144:147], a[112:115], v[32:35]
  buffer_load_dwordx4 v10, s[12:15], s71 offen offset:0 lds
  v_mfma_f32_16x16x32_bf16 v[48:51], a[128:131], a[100:103], 0
  buffer_load_dwordx4 v11, s[12:15], s71 offen offset:1024 lds
  v_mfma_f32_16x16x32_bf16 v[48:51], a[144:147], a[116:119], v[48:51]
  buffer_load_dwordx4 v12, s[12:15], s71 offen offset:2048 lds
  v_mfma_f32_16x16x32_bf16 v[64:67], a[128:131], a[104:107], 0
  buffer_load_dwordx4 v13, s[12:15], s71 offen offset:3072 lds
  v_mfma_f32_16x16x32_bf16 v[64:67], a[144:147], a[120:123], v[64:67]
  s_bfe_u32 s72, 0x3020106, s31
  s_add_u32 s30, s30, s72
  s_add_u32 s31, s31, 8
  v_mfma_f32_16x16x32_bf16 v[80:83], a[128:131], a[108:111], 0
  s_and_b32 s31, s31, 0x8001f
  s_and_b32 s30, s30, 7
  s_lshl_b32 s72, s30, 17
  v_mfma_f32_16x16x32_bf16 v[80:83], a[144:147], a[124:127], v[80:83]
  s_add_u32 s71, s93, s72
  s_add_u32 m0, s79, 65536
  ds_read_b64_tr_b16 a[152:153], v20 offset:20480
  v_mfma_f32_16x16x32_bf16 v[36:39], a[132:135], a[96:99], 0
  buffer_load_dwordx4 v2, s[8:11], s70 offen offset:0 sc1 lds
  v_mfma_f32_16x16x32_bf16 v[36:39], a[148:151], a[112:115], v[36:39]
  buffer_load_dwordx4 v2, s[8:11], s70 offen offset:1024 sc1 lds
  v_mfma_f32_16x16x32_bf16 v[52:55], a[132:135], a[100:103], 0
  buffer_load_dwordx4 v2, s[8:11], s70 offen offset:2048 sc1 lds
  v_mfma_f32_16x16x32_bf16 v[52:55], a[148:151], a[116:119], v[52:55]
  buffer_load_dwordx4 v2, s[8:11], s70 offen offset:3072 sc1 lds
  v_mfma_f32_16x16x32_bf16 v[68:71], a[132:135], a[104:107], 0
  s_add_u32 s65, s65, 1
  ds_read_b64_tr_b16 a[154:155], v20 offset:22528
  ds_read_b64_tr_b16 a[140:141], v21 offset:16384
  v_mfma_f32_16x16x32_bf16 v[68:71], a[148:151], a[120:123], v[68:71]
  s_cmp_eq_u32 s65, 4
  s_cselect_b32 s65, 0, s65
  s_cselect_b32 s66, s67, s68
  ds_read_b64_tr_b16 a[142:143], v21 offset:18432
  ds_read_b64_tr_b16 a[156:157], v21 offset:20480
  v_mfma_f32_16x16x32_bf16 v[84:87], a[132:135], a[108:111], 0
  s_bfe_u32 s72, 0x3020106, s1
  s_add_u32 s0, s0, s72
  ds_read_b64_tr_b16 a[158:159], v21 offset:22528
  v_mfma_f32_16x16x32_bf16 v[84:87], a[148:151], a[124:127], v[84:87]
  s_add_u32 s1, s1, 8
  s_and_b32 s1, s1, 0x8001f
  s_and_b32 s0, s0, 7
  s_lshl_b32 s72, s0, 14
  s_add_u32 s70, s92, s72
  v_add_u32 v16, s66, v16
  v_add_u32 v17, s66, v17
  v_add_u32 v18, s66, v18
  v_add_u32 v19, s66, v19
  v_add_u32 v20, s66, v20
  v_add_u32 v21, s66, v21
  s_waitcnt vmcnt(8) lgkmcnt(0)
  s_barrier
  v_mfma_f32_16x16x32_bf16 v[40:43], a[136:139], a[96:99], 0
  buffer_store_dwordx2 v[6:7], v8, s[96:99], s36 offen sc1
  v_mfma_f32_16x16x32_bf16 v[40:43], a[152:155], a[112:115], v[40:43]
  buffer_store_dwordx2 v[6:7], v8, s[96:99], s37 offen sc1
  v_mfma_f32_16x16x32_bf16 v[56:59], a[136:139], a[100:103], 0
  ds_read_b128 a[64:67], v16 offset:0
  ds_read_b128 a[80:83], v16 offset:8192
  v_mfma_f32_16x16x32_bf16 v[56:59], a[152:155], a[116:119], v[56:59]
  buffer_store_dwordx2 v[6:7], v8, s[96:99], s38 offen sc1
  v_mfma_f32_16x16x32_bf16 v[72:75], a[136:139], a[104:107], 0
  s_add_u32 m0, s79, 114688
  ds_read_b64_tr_b16 a[128:129], v18 offset:16384
  ds_read_b64_tr_b16 a[130:131], v18 offset:18432
  v_mfma_f32_16x16x32_bf16 v[72:75], a[152:155], a[120:123], v[72:75]
  buffer_load_dwordx4 v10, s[12:15], s71 offen offset:0 lds
  v_mfma_f32_16x16x32_bf16 v[88:91], a[136:139], a[108:111], 0
  buffer_load_dwordx4 v11, s[12:15], s71 offen offset:1024 lds
  v_mfma_f32_16x16x32_bf16 v[88:91], a[152:155], a[124:127], v[88:91]
  buffer_load_dwordx4 v12, s[12:15], s71 offen offset:2048 lds
  v_mfma_f32_16x16x32_bf16 v[44:47], a[140:143], a[96:99], 0
  ds_read_b64_tr_b16 a[144:145], v18 offset:20480
  ds_read_b64_tr_b16 a[146:147], v18 offset:22528
  v_mfma_f32_16x16x32_bf16 v[44:47], a[156:159], a[112:115], v[44:47]
  buffer_load_dwordx4 v13, s[12:15], s71 offen offset:3072 lds
  v_mfma_f32_16x16x32_bf16 v[60:63], a[140:143], a[100:103], 0
  s_bfe_u32 s72, 0x3020106, s31
  s_add_u32 s30, s30, s72
  s_add_u32 s31, s31, 8
  v_mfma_f32_16x16x32_bf16 v[60:63], a[156:159], a[116:119], v[60:63]
  s_and_b32 s31, s31, 0x8001f
  s_and_b32 s30, s30, 7
  s_lshl_b32 s72, s30, 17
  v_mfma_f32_16x16x32_bf16 v[76:79], a[140:143], a[104:107], 0
  s_add_u32 s71, s93, s72
  s_add_u32 m0, s79, 98304
  ds_read_b128 a[68:71], v16 offset:1024
  v_mfma_f32_16x16x32_bf16 v[76:79], a[156:159], a[120:123], v[76:79]
  buffer_load_dwordx4 v2, s[8:11], s70 offen offset:0 sc1 lds
  ds_read_b128 a[84:87], v16 offset:9216
  v_mfma_f32_16x16x32_bf16 v[92:95], a[140:143], a[108:111], 0
  buffer_load_dwordx4 v2, s[8:11], s70 offen offset:1024 sc1 lds
  ds_read_b128 a[72:75], v17 offset:0
  v_mfma_f32_16x16x32_bf16 v[92:95], a[156:159], a[124:127], v[92:95]
  buffer_load_dwordx4 v2, s[8:11], s70 offen offset:2048 sc1 lds
  ds_read_b128 a[88:91], v17 offset:8192
  ds_read_b128 a[76:79], v17 offset:1024
  ds_read_b128 a[92:95], v17 offset:9216
  ds_read_b64_tr_b16 a[132:133], v19 offset:16384
  ds_read_b64_tr_b16 a[134:135], v19 offset:18432
  ds_read_b64_tr_b16 a[148:149], v19 offset:20480
  ds_read_b64_tr_b16 a[150:151], v19 offset:22528
  s_waitcnt lgkmcnt(0)
  v_mfma_f32_16x16x32_bf16 v[32:35], a[128:131], a[64:67], v[32:35]
  buffer_load_dwordx4 v2, s[8:11], s70 offen offset:3072 sc1 lds
  v_mfma_f32_16x16x32_bf16 v[32:35], a[144:147], a[80:83], v[32:35]
  s_bfe_u32 s72, 0x3020106, s1
  s_add_u32 s0, s0, s72
  s_add_u32 s1, s1, 8
  v_mfma_f32_16x16x32_bf16 v[48:51], a[128:131], a[68:71], v[48:51]
  s_and_b32 s1, s1, 0x8001f
  s_and_b32 s0, s0, 7
  s_lshl_b32 s72, s0, 14
  v_mfma_f32_16x16x32_bf16 v[48:51], a[144:147], a[84:87], v[48:51]
  s_add_u32 s70, s92, s72
  s_add_u32 m0, s64, 16384
  ds_read_b64_tr_b16 a[136:137], v20 offset:16384
  v_mfma_f32_16x16x32_bf16 v[64:67], a[128:131], a[72:75], v[64:67]
  buffer_load_dwordx4 v10, s[12:15], s71 offen offset:0 lds
  v_mfma_f32_16x16x32_bf16 v[64:67], a[144:147], a[88:91], v[64:67]
  buffer_load_dwordx4 v11, s[12:15], s71 offen offset:1024 lds
  v_mfma_f32_16x16x32_bf16 v[80:83], a[128:131], a[76:79], v[80:83]
  buffer_load_dwordx4 v12, s[12:15], s71 offen offset:2048 lds
  v_mfma_f32_16x16x32_bf16 v[80:83], a[144:147], a[92:95], v[80:83]
  buffer_load_dwordx4 v13, s[12:15], s71 offen offset:3072 lds
  v_mfma_f32_16x16x32_bf16 v[36:39], a[132:135], a[64:67], v[36:39]
  s_bfe_u32 s72, 0x3020106, s31
  s_add_u32 s30, s30, s72
  s_add_u32 s31, s31, 8
  v_mfma_f32_16x16x32_bf16 v[36:39], a[148:151], a[80:83], v[36:39]
  s_and_b32 s31, s31, 0x8001f
  s_and_b32 s30, s30, 7
  s_lshl_b32 s72, s30, 17
  v_mfma_f32_16x16x32_bf16 v[52:55], a[132:135], a[68:71], v[52:55]
  s_add_u32 s71, s93, s72
  s_mov_b32 m0, s64
  ds_read_b64_tr_b16 a[138:139], v20 offset:18432
  v_mfma_f32_16x16x32_bf16 v[52:55], a[148:151], a[84:87], v[52:55]
  buffer_load_dwordx4 v2, s[8:11], s70 offen offset:0 sc1 lds
  s_add_u32 s64, s64, s66
  s_add_u32 s65, s65, 1
  s_cmp_eq_u32 s65, 4
  s_cselect_b32 s65, 0, s65
  s_cselect_b32 s66, s67, s68
  v_mfma_f32_16x16x32_bf16 v[68:71], a[132:135], a[72:75], v[68:71]
  buffer_load_dwordx4 v2, s[8:11], s70 offen offset:1024 sc1 lds
  v_mfma_f32_16x16x32_bf16 v[68:71], a[148:151], a[88:91], v[68:71]
  buffer_load_dwordx4 v2, s[8:11], s70 offen offset:2048 sc1 lds
  v_mfma_f32_16x16x32_bf16 v[84:87], a[132:135], a[76:79], v[84:87]
  buffer_load_dwordx4 v2, s[8:11], s70 offen offset:3072 sc1 lds
  v_mfma_f32_16x16x32_bf16 v[84:87], a[148:151], a[92:95], v[84:87]
  s_bfe_u32 s72, 0x3020106, s1
  s_add_u32 s0, s0, s72
  s_add_u32 s1, s1, 8
  s_and_b32 s1, s1, 0x8001f
  s_and_b32 s0, s0, 7
  s_lshl_b32 s72, s0, 14
  s_add_u32 s70, s92, s72
  ds_read_b64_tr_b16 a[152:153], v20 offset:20480
  ds_read_b64_tr_b16 a[154:155], v20 offset:22528
  ds_read_b64_tr_b16 a[140:141], v21 offset:16384
  ds_read_b64_tr_b16 a[142:143], v21 offset:18432
  ds_read_b64_tr_b16 a[156:157], v21 offset:20480
  ds_read_b64_tr_b16 a[158:159], v21 offset:22528
  v_add_u32 v16, s66, v16
  v_add_u32 v17, s66, v17
  v_add_u32 v18, s66, v18
  v_add_u32 v19, s66, v19
  v_add_u32 v20, s66, v20
  v_add_u32 v21, s66, v21
  s_waitcnt vmcnt(19) lgkmcnt(0)
  s_barrier
  v_mfma_f32_16x16x32_bf16 v[40:43], a[136:139], a[64:67], v[40:43]
  s_add_u32 s16, s86, 100663296
  s_addc_u32 s17, s87, 0
  s_mov_b32 s18, 16777216
  v_mfma_f32_16x16x32_bf16 v[40:43], a[152:155], a[80:83], v[40:43]
  s_mov_b32 s19, 0x00020000
  s_add_u32 m0, s64, 16384
  ds_read_b128 a[96:99], v16 offset:0
  v_mfma_f32_16x16x32_bf16 v[56:59], a[136:139], a[68:71], v[56:59]
  buffer_load_dwordx4 v10, s[12:15], s71 offen offset:0 lds
  v_mfma_f32_16x16x32_bf16 v[56:59], a[152:155], a[84:87], v[56:59]
  buffer_load_dwordx4 v11, s[12:15], s71 offen offset:1024 lds
  v_mfma_f32_16x16x32_bf16 v[72:75], a[136:139], a[72:75], v[72:75]
  ds_read_b128 a[112:115], v16 offset:8192
  ds_read_b64_tr_b16 a[128:129], v18 offset:16384
  v_mfma_f32_16x16x32_bf16 v[72:75], a[152:155], a[88:91], v[72:75]
  ds_read_b64_tr_b16 a[130:131], v18 offset:18432
  ds_read_b64_tr_b16 a[144:145], v18 offset:20480
  v_mfma_f32_16x16x32_bf16 v[88:91], a[136:139], a[76:79], v[88:91]
  ds_read_b64_tr_b16 a[146:147], v18 offset:22528
  ds_read_b128 a[100:103], v16 offset:1024
  v_mfma_f32_16x16x32_bf16 v[88:91], a[152:155], a[92:95], v[88:91]
  buffer_load_dwordx4 v12, s[12:15], s71 offen offset:2048 lds
  v_mfma_f32_16x16x32_bf16 v[44:47], a[140:143], a[64:67], v[44:47]
  ds_read_b128 a[116:119], v16 offset:9216
  ds_read_b128 a[104:107], v17 offset:0
  v_mfma_f32_16x16x32_bf16 v[44:47], a[156:159], a[80:83], v[44:47]
  ds_read_b128 a[120:123], v17 offset:8192
  ds_read_b128 a[108:111], v17 offset:1024
  v_mfma_f32_16x16x32_bf16 v[60:63], a[140:143], a[68:71], v[60:63]
  ds_read_b128 a[124:127], v17 offset:9216
  ds_read_b64_tr_b16 a[132:133], v19 offset:16384
  v_mfma_f32_16x16x32_bf16 v[60:63], a[156:159], a[84:87], v[60:63]
  buffer_load_dwordx4 v13, s[12:15], s71 offen offset:3072 lds
  v_mfma_f32_16x16x32_bf16 v[76:79], a[140:143], a[72:75], v[76:79]
  s_bfe_u32 s72, 0x3020106, s31
  ds_read_b64_tr_b16 a[134:135], v19 offset:18432
  ds_read_b64_tr_b16 a[148:149], v19 offset:20480
  v_mfma_f32_16x16x32_bf16 v[76:79], a[156:159], a[88:91], v[76:79]
  s_add_u32 s30, s30, s72
  ds_read_b64_tr_b16 a[150:151], v19 offset:22528
  v_mfma_f32_16x16x32_bf16 v[92:95], a[140:143], a[76:79], v[92:95]
  s_add_u32 s31, s31, 8
  s_and_b32 s31, s31, 0x8001f
  v_mfma_f32_16x16x32_bf16 v[92:95], a[156:159], a[92:95], v[92:95]
  s_and_b32 s30, s30, 7
  s_lshl_b32 s72, s30, 17
  s_add_u32 s71, s93, s72
  s_waitcnt lgkmcnt(0)
  v_mfma_f32_16x16x32_bf16 v[32:35], a[128:131], a[96:99], v[32:35]
  s_mov_b32 m0, s64
  ds_read_b64_tr_b16 a[136:137], v20 offset:16384
  ds_read_b64_tr_b16 a[138:139], v20 offset:18432
  v_mfma_f32_16x16x32_bf16 v[32:35], a[144:147], a[112:115], v[32:35]
  buffer_load_dwordx4 v2, s[8:11], s70 offen offset:0 sc1 lds
  v_mfma_f32_16x16x32_bf16 v[48:51], a[128:131], a[100:103], v[48:51]
  buffer_load_dwordx4 v2, s[8:11], s70 offen offset:1024 sc1 lds
  v_mfma_f32_16x16x32_bf16 v[48:51], a[144:147], a[116:119], v[48:51]
  s_add_u32 s64, s64, s66
  ds_read_b64_tr_b16 a[152:153], v20 offset:20480
  ds_read_b64_tr_b16 a[154:155], v20 offset:22528
  v_mfma_f32_16x16x32_bf16 v[64:67], a[128:131], a[104:107], v[64:67]
  buffer_load_dwordx4 v2, s[8:11], s70 offen offset:2048 sc1 lds
  v_mfma_f32_16x16x32_bf16 v[64:67], a[144:147], a[120:123], v[64:67]
  s_add_u32 s65, s65, 1
  ds_read_b64_tr_b16 a[140:141], v21 offset:16384
  ds_read_b64_tr_b16 a[142:143], v21 offset:18432
  v_mfma_f32_16x16x32_bf16 v[80:83], a[128:131], a[108:111], v[80:83]
  buffer_load_dwordx4 v2, s[8:11], s70 offen offset:3072 sc1 lds
  v_mfma_f32_16x16x32_bf16 v[80:83], a[144:147], a[124:127], v[80:83]
  s_bfe_u32 s72, 0x3020106, s1
  ds_read_b64_tr_b16 a[156:157], v21 offset:20480
  ds_read_b64_tr_b16 a[158:159], v21 offset:22528
  v_mfma_f32_16x16x32_bf16 v[36:39], a[132:135], a[96:99], v[36:39]
  s_cmp_eq_u32 s65, 4
  s_cselect_b32 s65, 0, s65
  s_cselect_b32 s66, s67, s68
  v_mfma_f32_16x16x32_bf16 v[36:39], a[148:151], a[112:115], v[36:39]
  s_add_u32 s0, s0, s72
  v_add_u32 v16, s66, v16
  v_add_u32 v17, s66, v17
  v_mfma_f32_16x16x32_bf16 v[52:55], a[132:135], a[100:103], v[52:55]
  s_add_u32 s1, s1, 8
  v_add_u32 v18, s66, v18
  v_add_u32 v19, s66, v19
  v_mfma_f32_16x16x32_bf16 v[52:55], a[148:151], a[116:119], v[52:55]
  s_and_b32 s1, s1, 0x8001f
  v_add_u32 v20, s66, v20
  v_add_u32 v21, s66, v21
  v_mfma_f32_16x16x32_bf16 v[68:71], a[132:135], a[104:107], v[68:71]
  s_and_b32 s0, s0, 7
  s_lshl_b32 s72, s0, 14
  s_add_u32 s70, s92, s72
  v_mfma_f32_16x16x32_bf16 v[68:71], a[148:151], a[120:123], v[68:71]
  v_mfma_f32_16x16x32_bf16 v[84:87], a[132:135], a[108:111], v[84:87]
  v_mfma_f32_16x16x32_bf16 v[84:87], a[148:151], a[124:127], v[84:87]
  s_waitcnt vmcnt(16) lgkmcnt(0)
  s_barrier
  v_mfma_f32_16x16x32_bf16 v[40:43], a[136:139], a[96:99], v[40:43]
  s_add_u32 m0, s64, 16384
  ds_read_b128 a[64:67], v16 offset:0
  ds_read_b128 a[80:83], v16 offset:8192
  v_mfma_f32_16x16x32_bf16 v[40:43], a[152:155], a[112:115], v[40:43]
  buffer_load_dwordx4 v10, s[12:15], s71 offen offset:0 lds
  v_mfma_f32_16x16x32_bf16 v[56:59], a[136:139], a[100:103], v[56:59]
  ds_read_b64_tr_b16 a[128:129], v18 offset:16384
  ds_read_b64_tr_b16 a[130:131], v18 offset:18432
  v_mfma_f32_16x16x32_bf16 v[56:59], a[152:155], a[116:119], v[56:59]
  buffer_load_dwordx4 v11, s[12:15], s71 offen offset:1024 lds
  v_mfma_f32_16x16x32_bf16 v[72:75], a[136:139], a[104:107], v[72:75]
  ds_read_b64_tr_b16 a[144:145], v18 offset:20480
  ds_read_b64_tr_b16 a[146:147], v18 offset:22528
  v_mfma_f32_16x16x32_bf16 v[72:75], a[152:155], a[120:123], v[72:75]
  ds_read_b128 a[68:71], v16 offset:1024
  ds_read_b128 a[84:87], v16 offset:9216
  v_mfma_f32_16x16x32_bf16 v[88:91], a[136:139], a[108:111], v[88:91]
  ds_read_b128 a[72:75], v17 offset:0
  ds_read_b128 a[88:91], v17 offset:8192
  v_mfma_f32_16x16x32_bf16 v[88:91], a[152:155], a[124:127], v[88:91]
  buffer_load_dwordx4 v12, s[12:15], s71 offen offset:2048 lds
  v_mfma_f32_16x16x32_bf16 v[44:47], a[140:143], a[96:99], v[44:47]
  ds_read_b128 a[76:79], v17 offset:1024
  ds_read_b128 a[92:95], v17 offset:9216
  v_mfma_f32_16x16x32_bf16 v[44:47], a[156:159], a[112:115], v[44:47]
  ds_read_b64_tr_b16 a[132:133], v19 offset:16384
  ds_read_b64_tr_b16 a[134:135], v19 offset:18432
  v_mfma_f32_16x16x32_bf16 v[60:63], a[140:143], a[100:103], v[60:63]
  ds_read_b64_tr_b16 a[148:149], v19 offset:20480
  ds_read_b64_tr_b16 a[150:151], v19 offset:22528
  v_mfma_f32_16x16x32_bf16 v[60:63], a[156:159], a[116:119], v[60:63]
  buffer_load_dwordx4 v13, s[12:15], s71 offen offset:3072 lds
  v_mfma_f32_16x16x32_bf16 v[76:79], a[140:143], a[104:107], v[76:79]
  s_bfe_u32 s72, 0x3020106, s31
  v_mfma_f32_16x16x32_bf16 v[76:79], a[156:159], a[120:123], v[76:79]
  s_add_u32 s30, s30, s72
  v_mfma_f32_16x16x32_bf16 v[92:95], a[140:143], a[108:111], v[92:95]
  s_add_u32 s31, s31, 8
  s_and_b32 s31, s31, 0x8001f
  v_mfma_f32_16x16x32_bf16 v[92:95], a[156:159], a[124:127], v[92:95]
  s_and_b32 s30, s30, 7
  s_lshl_b32 s72, s30, 17
  s_add_u32 s71, s93, s72
  s_waitcnt lgkmcnt(0)
  v_mfma_f32_16x16x32_bf16 v[32:35], a[128:131], a[64:67], v[32:35]
  s_mov_b32 m0, s64
  ds_read_b64_tr_b16 a[136:137], v20 offset:16384
  ds_read_b64_tr_b16 a[138:139], v20 offset:18432
  v_mfma_f32_16x16x32_bf16 v[32:35], a[144:147], a[80:83], v[32:35]
  buffer_load_dwordx4 v2, s[8:11], s70 offen offset:0 sc1 lds
  v_mfma_f32_16x16x32_bf16 v[48:51], a[128:131], a[68:71], v[48:51]
  buffer_load_dwordx4 v2, s[8:11], s70 offen offset:1024 sc1 lds
  v_mfma_f32_16x16x32_bf16 v[48:51], a[144:147], a[84:87], v[48:51]
  s_add_u32 s64, s64, s66
  ds_read_b64_tr_b16 a[152:153], v20 offset:20480
  ds_read_b64_tr_b16 a[154:155], v20 offset:22528
  v_mfma_f32_16x16x32_bf16 v[64:67], a[128:131], a[72:75], v[64:67]
  buffer_load_dwordx4 v2, s[8:11], s70 offen offset:2048 sc1 lds
  v_mfma_f32_16x16x32_bf16 v[64:67], a[144:147], a[88:91], v[64:67]
  s_add_u32 s65, s65, 1
  ds_read_b64_tr_b16 a[140:141], v21 offset:16384
  ds_read_b64_tr_b16 a[142:143], v21 offset:18432
  v_mfma_f32_16x16x32_bf16 v[80:83], a[128:131], a[76:79], v[80:83]
  buffer_load_dwordx4 v2, s[8:11], s70 offen offset:3072 sc1 lds
  v_mfma_f32_16x16x32_bf16 v[80:83], a[144:147], a[92:95], v[80:83]
  s_bfe_u32 s72, 0x3020106, s1
  ds_read_b64_tr_b16 a[156:157], v21 offset:20480
  ds_read_b64_tr_b16 a[158:159], v21 offset:22528
  v_mfma_f32_16x16x32_bf16 v[36:39], a[132:135], a[64:67], v[36:39]
  s_cmp_eq_u32 s65, 4
  s_cselect_b32 s65, 0, s65
  s_cselect_b32 s66, s67, s68
  v_mfma_f32_16x16x32_bf16 v[36:39], a[148:151], a[80:83], v[36:39]
  s_add_u32 s0, s0, s72
  v_add_u32 v16, s66, v16
  v_add_u32 v17, s66, v17
  v_mfma_f32_16x16x32_bf16 v[52:55], a[132:135], a[68:71], v[52:55]
  s_add_u32 s1, s1, 8
  v_add_u32 v18, s66, v18
  v_add_u32 v19, s66, v19
  v_mfma_f32_16x16x32_bf16 v[52:55], a[148:151], a[84:87], v[52:55]
  s_and_b32 s1, s1, 0x8001f
  v_add_u32 v20, s66, v20
  v_add_u32 v21, s66, v21
  v_mfma_f32_16x16x32_bf16 v[68:71], a[132:135], a[72:75], v[68:71]
  s_and_b32 s0, s0, 7
  s_lshl_b32 s72, s0, 14
  s_add_u32 s70, s92, s72
  v_mfma_f32_16x16x32_bf16 v[68:71], a[148:151], a[88:91], v[68:71]
  v_mfma_f32_16x16x32_bf16 v[84:87], a[132:135], a[76:79], v[84:87]
  v_mfma_f32_16x16x32_bf16 v[84:87], a[148:151], a[92:95], v[84:87]
  s_waitcnt vmcnt(16) lgkmcnt(0)
  s_barrier
  v_mfma_f32_16x16x32_bf16 v[40:43], a[136:139], a[64:67], v[40:43]
  s_add_u32 m0, s64, 16384
  ds_read_b128 a[96:99], v16 offset:0
  ds_read_b128 a[112:115], v16 offset:8192
  v_mfma_f32_16x16x32_bf16 v[40:43], a[152:155], a[80:83], v[40:43]
  buffer_load_dwordx4 v10, s[12:15], s71 offen offset:0 lds
  v_mfma_f32_16x16x32_bf16 v[56:59], a[136:139], a[68:71], v[56:59]
  ds_read_b64_tr_b16 a[128:129], v18 offset:16384
  ds_read_b64_tr_b16 a[130:131], v18 offset:18432
  v_mfma_f32_16x16x32_bf16 v[56:59], a[152:155], a[84:87], v[56:59]
  buffer_load_dwordx4 v11, s[12:15], s71 offen offset:1024 lds
  v_mfma_f32_16x16x32_bf16 v[72:75], a[136:139], a[72:75], v[72:75]
  ds_read_b64_tr_b16 a[144:145], v18 offset:20480
  ds_read_b64_tr_b16 a[146:147], v18 offset:22528
  v_mfma_f32_16x16x32_bf16 v[72:75], a[152:155], a[88:91], v[72:75]
  ds_read_b128 a[100:103], v16 offset:1024
  ds_read_b128 a[116:119], v16 offset:9216
  v_mfma_f32_16x16x32_bf16 v[88:91], a[136:139], a[76:79], v[88:91]
  ds_read_b128 a[104:107], v17 offset:0
  ds_read_b128 a[120:123], v17 offset:8192
  v_mfma_f32_16x16x32_bf16 v[88:91], a[152:155], a[92:95], v[88:91]
  buffer_load_dwordx4 v12, s[12:15], s71 offen offset:2048 lds
  v_mfma_f32_16x16x32_bf16 v[44:47], a[140:143], a[64:67], v[44:47]
  ds_read_b128 a[108:111], v17 offset:1024
  ds_read_b128 a[124:127], v17 offset:9216
  v_mfma_f32_16x16x32_bf16 v[44:47], a[156:159], a[80:83], v[44:47]
  ds_read_b64_tr_b16 a[132:133], v19 offset:16384
  ds_read_b64_tr_b16 a[134:135], v19 offset:18432
  v_mfma_f32_16x16x32_bf16 v[60:63], a[140:143], a[68:71], v[60:63]
  ds_read_b64_tr_b16 a[148:149], v19 offset:20480
  ds_read_b64_tr_b16 a[150:151], v19 offset:22528
  v_mfma_f32_16x16x32_bf16 v[60:63], a[156:159], a[84:87], v[60:63]
  buffer_load_dwordx4 v13, s[12:15], s71 offen offset:3072 lds
  v_mfma_f32_16x16x32_bf16 v[76:79], a[140:143], a[72:75], v[76:79]
  s_bfe_u32 s72, 0x3020106, s31
  v_mfma_f32_16x16x32_bf16 v[76:79], a[156:159], a[88:91], v[76:79]
  s_add_u32 s30, s30, s72
  v_mfma_f32_16x16x32_bf16 v[92:95], a[140:143], a[76:79], v[92:95]
  s_add_u32 s31, s31, 8
  s_and_b32 s31, s31, 0x8001f
  v_mfma_f32_16x16x32_bf16 v[92:95], a[156:159], a[92:95], v[92:95]
  s_and_b32 s30, s30, 7
  s_lshl_b32 s72, s30, 17
  s_add_u32 s71, s93, s72
  s_waitcnt lgkmcnt(0)
  v_mfma_f32_16x16x32_bf16 v[32:35], a[128:131], a[96:99], v[32:35]
  s_mov_b32 m0, s64
  ds_read_b64_tr_b16 a[136:137], v20 offset:16384
  ds_read_b64_tr_b16 a[138:139], v20 offset:18432
  v_mfma_f32_16x16x32_bf16 v[32:35], a[144:147], a[112:115], v[32:35]
  buffer_load_dwordx4 v2, s[8:11], s70 offen offset:0 sc1 lds
  v_mfma_f32_16x16x32_bf16 v[48:51], a[128:131], a[100:103], v[48:51]
  buffer_load_dwordx4 v2, s[8:11], s70 offen offset:1024 sc1 lds
  v_mfma_f32_16x16x32_bf16 v[48:51], a[144:147], a[116:119], v[48:51]
  s_add_u32 s64, s64, s66
  ds_read_b64_tr_b16 a[152:153], v20 offset:20480
  ds_read_b64_tr_b16 a[154:155], v20 offset:22528
  v_mfma_f32_16x16x32_bf16 v[64:67], a[128:131], a[104:107], v[64:67]
  buffer_load_dwordx4 v2, s[8:11], s70 offen offset:2048 sc1 lds
  v_mfma_f32_16x16x32_bf16 v[64:67], a[144:147], a[120:123], v[64:67]
  s_add_u32 s65, s65, 1
  ds_read_b64_tr_b16 a[140:141], v21 offset:16384
  ds_read_b64_tr_b16 a[142:143], v21 offset:18432
  v_mfma_f32_16x16x32_bf16 v[80:83], a[128:131], a[108:111], v[80:83]
  buffer_load_dwordx4 v2, s[8:11], s70 offen offset:3072 sc1 lds
  v_mfma_f32_16x16x32_bf16 v[80:83], a[144:147], a[124:127], v[80:83]
  s_bfe_u32 s72, 0x3020106, s1
  ds_read_b64_tr_b16 a[156:157], v21 offset:20480
  ds_read_b64_tr_b16 a[158:159], v21 offset:22528
  v_mfma_f32_16x16x32_bf16 v[36:39], a[132:135], a[96:99], v[36:39]
  s_cmp_eq_u32 s65, 4
  s_cselect_b32 s65, 0, s65
  s_cselect_b32 s66, s67, s68
  v_mfma_f32_16x16x32_bf16 v[36:39], a[148:151], a[112:115], v[36:39]
  s_add_u32 s0, s0, s72
  v_add_u32 v16, s66, v16
  v_add_u32 v17, s66, v17
  v_mfma_f32_16x16x32_bf16 v[52:55], a[132:135], a[100:103], v[52:55]
  s_add_u32 s1, s1, 8
  v_add_u32 v18, s66, v18
  v_add_u32 v19, s66, v19
  v_mfma_f32_16x16x32_bf16 v[52:55], a[148:151], a[116:119], v[52:55]
  s_and_b32 s1, s1, 0x8001f
  v_add_u32 v20, s66, v20
  v_add_u32 v21, s66, v21
  v_mfma_f32_16x16x32_bf16 v[68:71], a[132:135], a[104:107], v[68:71]
  s_and_b32 s0, s0, 7
  s_lshl_b32 s72, s0, 14
  s_add_u32 s70, s92, s72
  v_mfma_f32_16x16x32_bf16 v[68:71], a[148:151], a[120:123], v[68:71]
  v_mfma_f32_16x16x32_bf16 v[84:87], a[132:135], a[108:111], v[84:87]
  v_mfma_f32_16x16x32_bf16 v[84:87], a[148:151], a[124:127], v[84:87]
  s_waitcnt vmcnt(16) lgkmcnt(0)
  s_barrier
  v_mfma_f32_16x16x32_bf16 v[40:43], a[136:139], a[96:99], v[40:43]
  buffer_load_dwordx2 v[6:7], v14, s[96:99], s91 offen sc1
  v_mfma_f32_16x16x32_bf16 v[40:43], a[152:155], a[112:115], v[40:43]
  s_mov_b32 s12, s74
  s_mov_b32 s13, s75
  s_mov_b32 s14, 8388608
  v_mfma_f32_16x16x32_bf16 v[56:59], a[136:139], a[100:103], v[56:59]
  s_mov_b32 s15, 0x00020000
  s_lshl_b32 s93, s77, 22
  s_lshl_b32 s72, s76, 8
  v_mfma_f32_16x16x32_bf16 v[56:59], a[152:155], a[116:119], v[56:59]
  s_add_u32 s93, s93, s72
  s_add_u32 s72, s73, s76
  s_and_b32 s31, s72, 3
  v_mfma_f32_16x16x32_bf16 v[72:75], a[136:139], a[104:107], v[72:75]
  s_lshl_b32 s31, s31, 3
  s_or_b32 s31, s31, 0x80000
  s_bfe_u32 s30, 0x1b1b02, s31
  v_mfma_f32_16x16x32_bf16 v[72:75], a[152:155], a[120:123], v[72:75]
  s_add_u32 s30, s30, 0
  s_cmp_ge_u32 s30, 28
  s_cselect_b32 s72, 28, 0
  v_mfma_f32_16x16x32_bf16 v[88:91], a[136:139], a[108:111], v[88:91]
  s_sub_u32 s30, s30, s72
  s_lshl_b32 s72, s30, 17
  s_add_u32 s71, s93, s72
  v_mfma_f32_16x16x32_bf16 v[88:91], a[152:155], a[124:127], v[88:91]
  s_add_u32 m0, s64, 16384
  ds_read_b128 a[64:67], v16 offset:0
  ds_read_b128 a[80:83], v16 offset:8192
  v_mfma_f32_16x16x32_bf16 v[44:47], a[140:143], a[96:99], v[44:47]
  buffer_load_dwordx4 v10, s[12:15], s71 offen offset:0 lds
  v_mfma_f32_16x16x32_bf16 v[44:47], a[156:159], a[112:115], v[44:47]
  ds_read_b64_tr_b16 a[128:129], v18 offset:16384
  ds_read_b64_tr_b16 a[130:131], v18 offset:18432
  v_mfma_f32_16x16x32_bf16 v[60:63], a[140:143], a[100:103], v[60:63]
  buffer_load_dwordx4 v11, s[12:15], s71 offen offset:1024 lds
  v_mfma_f32_16x16x32_bf16 v[60:63], a[156:159], a[116:119], v[60:63]
  ds_read_b64_tr_b16 a[144:145], v18 offset:20480
  ds_read_b64_tr_b16 a[146:147], v18 offset:22528
  v_mfma_f32_16x16x32_bf16 v[76:79], a[140:143], a[104:107], v[76:79]
  ds_read_b128 a[68:71], v16 offset:1024
  ds_read_b128 a[84:87], v16 offset:9216
  v_mfma_f32_16x16x32_bf16 v[76:79], a[156:159], a[120:123], v[76:79]
  ds_read_b128 a[72:75], v17 offset:0
  ds_read_b128 a[88:91], v17 offset:8192
  v_mfma_f32_16x16x32_bf16 v[92:95], a[140:143], a[108:111], v[92:95]
  ds_read_b128 a[76:79], v17 offset:1024
  ds_read_b128 a[92:95], v17 offset:9216
  v_mfma_f32_16x16x32_bf16 v[92:95], a[156:159], a[124:127], v[92:95]
  ds_read_b64_tr_b16 a[132:133], v19 offset:16384
  ds_read_b64_tr_b16 a[134:135], v19 offset:18432
  ds_read_b64_tr_b16 a[148:149], v19 offset:20480
  ds_read_b64_tr_b16 a[150:151], v19 offset:22528
  s_waitcnt lgkmcnt(0)
  v_mfma_f32_16x16x32_bf16 v[32:35], a[128:131], a[64:67], v[32:35]
  buffer_load_dwordx4 v12, s[12:15], s71 offen offset:2048 lds
  v_mfma_f32_16x16x32_bf16 v[32:35], a[144:147], a[80:83], v[32:35]
  s_add_u32 s64, s64, s66
  ds_read_b64_tr_b16 a[136:137], v20 offset:16384
  ds_read_b64_tr_b16 a[138:139], v20 offset:18432
  v_mfma_f32_16x16x32_bf16 v[48:51], a[128:131], a[68:71], v[48:51]
  s_add_u32 s65, s65, 1
  ds_read_b64_tr_b16 a[152:153], v20 offset:20480
  ds_read_b64_tr_b16 a[154:155], v20 offset:22528
  v_mfma_f32_16x16x32_bf16 v[48:51], a[144:147], a[84:87], v[48:51]
  ds_read_b64_tr_b16 a[140:141], v21 offset:16384
  ds_read_b64_tr_b16 a[142:143], v21 offset:18432
  v_mfma_f32_16x16x32_bf16 v[64:67], a[128:131], a[72:75], v[64:67]
  buffer_load_dwordx4 v13, s[12:15], s71 offen offset:3072 lds
  v_mfma_f32_16x16x32_bf16 v[64:67], a[144:147], a[88:91], v[64:67]
  s_bfe_u32 s72, 0x302011a, s31
  ds_read_b64_tr_b16 a[156:157], v21 offset:20480
  ds_read_b64_tr_b16 a[158:159], v21 offset:22528
  v_mfma_f32_16x16x32_bf16 v[80:83], a[128:131], a[76:79], v[80:83]
  s_cmp_eq_u32 s65, 4
  s_cselect_b32 s65, 0, s65
  s_cselect_b32 s66, s67, s68
  v_mfma_f32_16x16x32_bf16 v[80:83], a[144:147], a[92:95], v[80:83]
  s_add_u32 s30, s30, s72
  v_add_u32 v16, s66, v16
  v_add_u32 v17, s66, v17
  v_mfma_f32_16x16x32_bf16 v[36:39], a[132:135], a[64:67], v[36:39]
  s_add_u32 s31, s31, 8
  v_add_u32 v18, s66, v18
  v_add_u32 v19, s66, v19
  v_mfma_f32_16x16x32_bf16 v[36:39], a[148:151], a[80:83], v[36:39]
  s_and_b32 s31, s31, 0x8001f
  v_add_u32 v20, s66, v20
  v_add_u32 v21, s66, v21
  v_mfma_f32_16x16x32_bf16 v[52:55], a[132:135], a[68:71], v[52:55]
  s_cmp_ge_u32 s30, 28
  s_cselect_b32 s72, 28, 0
  v_mfma_f32_16x16x32_bf16 v[52:55], a[148:151], a[84:87], v[52:55]
  s_sub_u32 s30, s30, s72
  v_mfma_f32_16x16x32_bf16 v[68:71], a[132:135], a[72:75], v[68:71]
  s_lshl_b32 s72, s30, 17
  s_add_u32 s71, s93, s72
  v_mfma_f32_16x16x32_bf16 v[68:71], a[148:151], a[88:91], v[68:71]
  v_mfma_f32_16x16x32_bf16 v[84:87], a[132:135], a[76:79], v[84:87]
  v_mfma_f32_16x16x32_bf16 v[84:87], a[148:151], a[92:95], v[84:87]
  s_waitcnt vmcnt(4)
  v_cmp_ne_u64 vcc, s[94:95], v[6:7]
  s_nop 1
  v_cndmask_b32_e64 v8, 0, 1, vcc
  v_lshlrev_b32 v9, 2, v0
  ds_write_b32 v9, v8
  v_lshlrev_b32 v9, 4, v1
  s_waitcnt lgkmcnt(0)
  s_barrier
  ds_read_b128 v[160:163], v9
  s_waitcnt lgkmcnt(0)
  v_or3_b32 v160, v160, v161, v162
  v_or_b32 v160, v160, v163
  v_cmp_ne_u32 vcc, 0, v160
  s_nop 0
  s_cbranch_vccnz Lp6_late
  s_add_u32 s8, s86, 67108864
  s_addc_u32 s9, s87, 0
  s_mov_b32 s10, 16777216
  s_mov_b32 s11, 0x00020000
  s_lshl_b32 s92, s73, 1
  s_add_u32 s92, s92, s77
  s_lshl_b32 s92, s92, 19
  s_add_u32 s92, s92, s79
  s_add_u32 s72, s73, s76
  s_and_b32 s1, s72, 3
  s_lshl_b32 s1, s1, 3
  s_or_b32 s1, s1, 0x80000
  s_bfe_u32 s0, 0x1b1b02, s1
  s_add_u32 s0, s0, 0
  s_cmp_ge_u32 s0, 28
  s_cselect_b32 s72, 28, 0
  s_sub_u32 s0, s0, s72
  s_lshl_b32 s72, s0, 14
  s_add_u32 s70, s92, s72
  v_mfma_f32_16x16x32_bf16 v[40:43], a[136:139], a[64:67], v[40:43]
  s_add_u32 m0, s79, 131072
  ds_read_b128 a[96:99], v16 offset:0
  ds_read_b128 a[112:115], v16 offset:8192
  v_mfma_f32_16x16x32_bf16 v[40:43], a[152:155], a[80:83], v[40:43]
  buffer_load_dwordx4 v2, s[8:11], s70 offen offset:0 sc1 lds
  v_mfma_f32_16x16x32_bf16 v[56:59], a[136:139], a[68:71], v[56:59]
  buffer_load_dwordx4 v2, s[8:11], s70 offen offset:1024 sc1 lds
  v_mfma_f32_16x16x32_bf16 v[56:59], a[152:155], a[84:87], v[56:59]
  ds_read_b64_tr_b16 a[128:129], v18 offset:16384
  ds_read_b64_tr_b16 a[130:131], v18 offset:18432
  v_mfma_f32_16x16x32_bf16 v[72:75], a[136:139], a[72:75], v[72:75]
  ds_read_b64_tr_b16 a[144:145], v18 offset:20480
  ds_read_b64_tr_b16 a[146:147], v18 offset:22528
  v_mfma_f32_16x16x32_bf16 v[72:75], a[152:155], a[88:91], v[72:75]
  buffer_load_dwordx4 v2, s[8:11], s70 offen offset:2048 sc1 lds
  v_mfma_f32_16x16x32_bf16 v[88:91], a[136:139], a[76:79], v[88:91]
  ds_read_b128 a[100:103], v16 offset:1024
  ds_read_b128 a[116:119], v16 offset:9216
  v_mfma_f32_16x16x32_bf16 v[88:91], a[152:155], a[92:95], v[88:91]
  buffer_load_dwordx4 v2, s[8:11], s70 offen offset:3072 sc1 lds
  v_mfma_f32_16x16x32_bf16 v[44:47], a[140:143], a[64:67], v[44:47]
  s_bfe_u32 s72, 0x302011a, s1
  s_add_u32 s0, s0, s72
  s_add_u32 s1, s1, 8
  v_mfma_f32_16x16x32_bf16 v[44:47], a[156:159], a[80:83], v[44:47]
  s_and_b32 s1, s1, 0x8001f
  s_cmp_ge_u32 s0, 28
  s_cselect_b32 s72, 28, 0
  v_mfma_f32_16x16x32_bf16 v[60:63], a[140:143], a[68:71], v[60:63]
  s_sub_u32 s0, s0, s72
  s_lshl_b32 s72, s0, 14
  s_add_u32 s70, s92, s72
  v_mfma_f32_16x16x32_bf16 v[60:63], a[156:159], a[84:87], v[60:63]
  s_add_u32 m0, s64, 16384
  ds_read_b128 a[104:107], v17 offset:0
  ds_read_b128 a[120:123], v17 offset:8192
  v_mfma_f32_16x16x32_bf16 v[76:79], a[140:143], a[72:75], v[76:79]
  buffer_load_dwordx4 v10, s[12:15], s71 offen offset:0 lds
  v_mfma_f32_16x16x32_bf16 v[76:79], a[156:159], a[88:91], v[76:79]
  buffer_load_dwordx4 v11, s[12:15], s71 offen offset:1024 lds
  v_mfma_f32_16x16x32_bf16 v[92:95], a[140:143], a[76:79], v[92:95]
  ds_read_b128 a[108:111], v17 offset:1024
  ds_read_b128 a[124:127], v17 offset:9216
  v_mfma_f32_16x16x32_bf16 v[92:95], a[156:159], a[92:95], v[92:95]
  ds_read_b64_tr_b16 a[132:133], v19 offset:16384
  ds_read_b64_tr_b16 a[134:135], v19 offset:18432
  ds_read_b64_tr_b16 a[148:149], v19 offset:20480
  ds_read_b64_tr_b16 a[150:151], v19 offset:22528
  s_waitcnt lgkmcnt(0)
  v_mfma_f32_16x16x32_bf16 v[32:35], a[128:131], a[96:99], v[32:35]
  buffer_load_dwordx4 v12, s[12:15], s71 offen offset:2048 lds
  v_mfma_f32_16x16x32_bf16 v[32:35], a[144:147], a[112:115], v[32:35]
  buffer_load_dwordx4 v13, s[12:15], s71 offen offset:3072 lds
  v_mfma_f32_16x16x32_bf16 v[48:51], a[128:131], a[100:103], v[48:51]
  s_bfe_u32 s72, 0x302011a, s31
  s_add_u32 s30, s30, s72
  s_add_u32 s31, s31, 8
  v_mfma_f32_16x16x32_bf16 v[48:51], a[144:147], a[116:119], v[48:51]
  s_and_b32 s31, s31, 0x8001f
  s_cmp_ge_u32 s30, 28
  s_cselect_b32 s72, 28, 0
  v_mfma_f32_16x16x32_bf16 v[64:67], a[128:131], a[104:107], v[64:67]
  s_sub_u32 s30, s30, s72
  s_lshl_b32 s72, s30, 17
  s_add_u32 s71, s93, s72
  v_mfma_f32_16x16x32_bf16 v[64:67], a[144:147], a[120:123], v[64:67]
  s_mov_b32 m0, s64
  ds_read_b64_tr_b16 a[136:137], v20 offset:16384
  ds_read_b64_tr_b16 a[138:139], v20 offset:18432
  v_mfma_f32_16x16x32_bf16 v[80:83], a[128:131], a[108:111], v[80:83]
  buffer_load_dwordx4 v2, s[8:11], s70 offen offset:0 sc1 lds
  v_mfma_f32_16x16x32_bf16 v[80:83], a[144:147], a[124:127], v[80:83]
  buffer_load_dwordx4 v2, s[8:11], s70 offen offset:1024 sc1 lds
  v_mfma_f32_16x16x32_bf16 v[36:39], a[132:135], a[96:99], v[36:39]
  buffer_load_dwordx4 v2, s[8:11], s70 offen offset:2048 sc1 lds
  v_mfma_f32_16x16x32_bf16 v[36:39], a[148:151], a[112:115], v[36:39]
  buffer_load_dwordx4 v2, s[8:11], s70 offen offset:3072 sc1 lds
  v_mfma_f32_16x16x32_bf16 v[52:55], a[132:135], a[100:103], v[52:55]
  s_add_u32 s64, s64, s66
  ds_read_b64_tr_b16 a[152:153], v20 offset:20480
  ds_read_b64_tr_b16 a[154:155], v20 offset:22528
  v_mfma_f32_16x16x32_bf16 v[52:55], a[148:151], a[116:119], v[52:55]
  s_add_u32 s65, s65, 1
  ds_read_b64_tr_b16 a[140:141], v21 offset:16384
  ds_read_b64_tr_b16 a[142:143], v21 offset:18432
  v_mfma_f32_16x16x32_bf16 v[68:71], a[132:135], a[104:107], v[68:71]
  s_cmp_eq_u32 s65, 4
  s_cselect_b32 s65, 0, s65
  s_cselect_b32 s66, s67, s68
  ds_read_b64_tr_b16 a[156:157], v21 offset:20480
  ds_read_b64_tr_b16 a[158:159], v21 offset:22528
  v_mfma_f32_16x16x32_bf16 v[68:71], a[148:151], a[120:123], v[68:71]
  s_bfe_u32 s72, 0x302011a, s1
  s_add_u32 s0, s0, s72
  s_add_u32 s1, s1, 8
  v_add_u32 v16, s66, v16
  v_add_u32 v19, s66, v19
  v_mfma_f32_16x16x32_bf16 v[84:87], a[132:135], a[108:111], v[84:87]
  s_and_b32 s1, s1, 0x8001f
  s_cmp_ge_u32 s0, 28
  s_cselect_b32 s72, 28, 0
  v_add_u32 v17, s66, v17
  v_add_u32 v20, s66, v20
  v_mfma_f32_16x16x32_bf16 v[84:87], a[148:151], a[124:127], v[84:87]
  s_sub_u32 s0, s0, s72
  s_lshl_b32 s72, s0, 14
  s_add_u32 s70, s92, s72
  v_add_u32 v18, s66, v18
  v_add_u32 v21, s66, v21
  s_waitcnt vmcnt(16) lgkmcnt(0)
  s_barrier
  v_mfma_f32_16x16x32_bf16 v[40:43], a[136:139], a[96:99], v[40:43]
  s_add_u32 m0, s64, 16384
  ds_read_b128 a[64:67], v16 offset:0
  ds_read_b128 a[80:83], v16 offset:8192
  v_mfma_f32_16x16x32_bf16 v[40:43], a[152:155], a[112:115], v[40:43]
  buffer_load_dwordx4 v10, s[12:15], s71 offen offset:0 lds
  v_mfma_f32_16x16x32_bf16 v[56:59], a[136:139], a[100:103], v[56:59]
  ds_read_b64_tr_b16 a[128:129], v18 offset:16384
  ds_read_b64_tr_b16 a[130:131], v18 offset:18432
  v_mfma_f32_16x16x32_bf16 v[56:59], a[152:155], a[116:119], v[56:59]
  buffer_load_dwordx4 v11, s[12:15], s71 offen offset:1024 lds
  v_mfma_f32_16x16x32_bf16 v[72:75], a[136:139], a[104:107], v[72:75]
  ds_read_b64_tr_b16 a[144:145], v18 offset:20480
  ds_read_b64_tr_b16 a[146:147], v18 offset:22528
  v_mfma_f32_16x16x32_bf16 v[72:75], a[152:155], a[120:123], v[72:75]
  ds_read_b128 a[68:71], v16 offset:1024
  ds_read_b128 a[84:87], v16 offset:9216
  v_mfma_f32_16x16x32_bf16 v[88:91], a[136:139], a[108:111], v[88:91]
  ds_read_b128 a[72:75], v17 offset:0
  ds_read_b128 a[88:91], v17 offset:8192
  v_mfma_f32_16x16x32_bf16 v[88:91], a[152:155], a[124:127], v[88:91]
  buffer_load_dwordx4 v12, s[12:15], s71 offen offset:2048 lds
  v_mfma_f32_16x16x32_bf16 v[44:47], a[140:143], a[96:99], v[44:47]
  ds_read_b128 a[76:79], v17 offset:1024
  ds_read_b128 a[92:95], v17 offset:9216
  v_mfma_f32_16x16x32_bf16 v[44:47], a[156:159], a[112:115], v[44:47]
  ds_read_b64_tr_b16 a[132:133], v19 offset:16384
  ds_read_b64_tr_b16 a[134:135], v19 offset:18432
  v_mfma_f32_16x16x32_bf16 v[60:63], a[140:143], a[100:103], v[60:63]
  ds_read_b64_tr_b16 a[148:149], v19 offset:20480
  ds_read_b64_tr_b16 a[150:151], v19 offset:22528
  v_mfma_f32_16x16x32_bf16 v[60:63], a[156:159], a[116:119], v[60:63]
  buffer_load_dwordx4 v13, s[12:15], s71 offen offset:3072 lds
  v_mfma_f32_16x16x32_bf16 v[76:79], a[140:143], a[104:107], v[76:79]
  s_bfe_u32 s72, 0x302011a, s31
  v_mfma_f32_16x16x32_bf16 v[76:79], a[156:159], a[120:123], v[76:79]
  s_add_u32 s30, s30, s72
  v_mfma_f32_16x16x32_bf16 v[92:95], a[140:143], a[108:111], v[92:95]
  s_add_u32 s31, s31, 8
  s_and_b32 s31, s31, 0x8001f
  s_cmp_ge_u32 s30, 28
  s_cselect_b32 s72, 28, 0
  v_mfma_f32_16x16x32_bf16 v[92:95], a[156:159], a[124:127], v[92:95]
  s_sub_u32 s30, s30, s72
  s_lshl_b32 s72, s30, 17
  s_add_u32 s71, s93, s72
  s_waitcnt lgkmcnt(0)
  v_mfma_f32_16x16x32_bf16 v[32:35], a[128:131], a[64:67], v[32:35]
  s_mov_b32 m0, s64
  ds_read_b64_tr_b16 a[136:137], v20 offset:16384
  ds_read_b64_tr_b16 a[138:139], v20 offset:18432
  v_mfma_f32_16x16x32_bf16 v[32:35], a[144:147], a[80:83], v[32:35]
  buffer_load_dwordx4 v2, s[8:11], s70 offen offset:0 sc1 lds
  v_mfma_f32_16x16x32_bf16 v[48:51], a[128:131], a[68:71], v[48:51]
  buffer_load_dwordx4 v2, s[8:11], s70 offen offset:1024 sc1 lds
  v_mfma_f32_16x16x32_bf16 v[48:51], a[144:147], a[84:87], v[48:51]
  s_add_u32 s64, s64, s66
  ds_read_b64_tr_b16 a[152:153], v20 offset:20480
  ds_read_b64_tr_b16 a[154:155], v20 offset:22528
  v_mfma_f32_16x16x32_bf16 v[64:67], a[128:131], a[72:75], v[64:67]
  buffer_load_dwordx4 v2, s[8:11], s70 offen offset:2048 sc1 lds
  v_mfma_f32_16x16x32_bf16 v[64:67], a[144:147], a[88:91], v[64:67]
  s_add_u32 s65, s65, 1
  ds_read_b64_tr_b16 a[140:141], v21 offset:16384
  ds_read_b64_tr_b16 a[142:143], v21 offset:18432
  v_mfma_f32_16x16x32_bf16 v[80:83], a[128:131], a[76:79], v[80:83]
  buffer_load_dwordx4 v2, s[8:11], s70 offen offset:3072 sc1 lds
  v_mfma_f32_16x16x32_bf16 v[80:83], a[144:147], a[92:95], v[80:83]
  s_bfe_u32 s72, 0x302011a, s1
  ds_read_b64_tr_b16 a[156:157], v21 offset:20480
  ds_read_b64_tr_b16 a[158:159], v21 offset:22528
  v_mfma_f32_16x16x32_bf16 v[36:39], a[132:135], a[64:67], v[36:39]
  s_cmp_eq_u32 s65, 4
  s_cselect_b32 s65, 0, s65
  s_cselect_b32 s66, s67, s68
  v_mfma_f32_16x16x32_bf16 v[36:39], a[148:151], a[80:83], v[36:39]
  s_add_u32 s0, s0, s72
  v_add_u32 v16, s66, v16
  v_add_u32 v17, s66, v17
  v_mfma_f32_16x16x32_bf16 v[52:55], a[132:135], a[68:71], v[52:55]
  s_add_u32 s1, s1, 8
  v_add_u32 v18, s66, v18
  v_add_u32 v19, s66, v19
  v_mfma_f32_16x16x32_bf16 v[52:55], a[148:151], a[84:87], v[52:55]
  s_and_b32 s1, s1, 0x8001f
  s_cmp_ge_u32 s0, 28
  s_cselect_b32 s72, 28, 0
  v_mfma_f32_16x16x32_bf16 v[68:71], a[132:135], a[72:75], v[68:71]
  s_sub_u32 s0, s0, s72
  s_lshl_b32 s72, s0, 14
  s_add_u32 s70, s92, s72
  v_mfma_f32_16x16x32_bf16 v[68:71], a[148:151], a[88:91], v[68:71]
  v_add_u32 v20, s66, v20
  v_add_u32 v21, s66, v21
  v_mfma_f32_16x16x32_bf16 v[84:87], a[132:135], a[76:79], v[84:87]
  v_mfma_f32_16x16x32_bf16 v[84:87], a[148:151], a[92:95], v[84:87]
  s_waitcnt vmcnt(16) lgkmcnt(0)
  s_barrier
  v_mfma_f32_16x16x32_bf16 v[40:43], a[136:139], a[64:67], v[40:43]
  s_add_u32 m0, s64, 16384
  ds_read_b128 a[96:99], v16 offset:0
  ds_read_b128 a[112:115], v16 offset:8192
  v_mfma_f32_16x16x32_bf16 v[40:43], a[152:155], a[80:83], v[40:43]
  buffer_load_dwordx4 v10, s[12:15], s71 offen offset:0 lds
  v_mfma_f32_16x16x32_bf16 v[56:59], a[136:139], a[68:71], v[56:59]
  buffer_load_dwordx4 v11, s[12:15], s71 offen offset:1024 lds
  v_mfma_f32_16x16x32_bf16 v[56:59], a[152:155], a[84:87], v[56:59]
  buffer_load_dwordx4 v12, s[12:15], s71 offen offset:2048 lds
  v_mfma_f32_16x16x32_bf16 v[72:75], a[136:139], a[72:75], v[72:75]
  ds_read_b64_tr_b16 a[128:129], v18 offset:16384
  ds_read_b64_tr_b16 a[130:131], v18 offset:18432
  v_mfma_f32_16x16x32_bf16 v[72:75], a[152:155], a[88:91], v[72:75]
  buffer_load_dwordx4 v13, s[12:15], s71 offen offset:3072 lds
  v_mfma_f32_16x16x32_bf16 v[88:91], a[136:139], a[76:79], v[88:91]
  s_bfe_u32 s72, 0x302011a, s31
  s_add_u32 s30, s30, s72
  s_add_u32 s31, s31, 8
  v_mfma_f32_16x16x32_bf16 v[88:91], a[152:155], a[92:95], v[88:91]
  s_and_b32 s31, s31, 0x8001f
  s_cmp_ge_u32 s30, 28
  s_cselect_b32 s72, 28, 0
  v_mfma_f32_16x16x32_bf16 v[44:47], a[140:143], a[64:67], v[44:47]
  s_sub_u32 s30, s30, s72
  s_lshl_b32 s72, s30, 17
  s_add_u32 s71, s93, s72
  v_mfma_f32_16x16x32_bf16 v[44:47], a[156:159], a[80:83], v[44:47]
  s_mov_b32 m0, s64
  ds_read_b64_tr_b16 a[144:145], v18 offset:20480
  ds_read_b64_tr_b16 a[146:147], v18 offset:22528
  v_mfma_f32_16x16x32_bf16 v[60:63], a[140:143], a[68:71], v[60:63]
  buffer_load_dwordx4 v2, s[8:11], s70 offen offset:0 sc1 lds
  v_mfma_f32_16x16x32_bf16 v[60:63], a[156:159], a[84:87], v[60:63]
  buffer_load_dwordx4 v2, s[8:11], s70 offen offset:1024 sc1 lds
  v_mfma_f32_16x16x32_bf16 v[76:79], a[140:143], a[72:75], v[76:79]
  buffer_load_dwordx4 v2, s[8:11], s70 offen offset:2048 sc1 lds
  v_mfma_f32_16x16x32_bf16 v[76:79], a[156:159], a[88:91], v[76:79]
  buffer_load_dwordx4 v2, s[8:11], s70 offen offset:3072 sc1 lds
  v_mfma_f32_16x16x32_bf16 v[92:95], a[140:143], a[76:79], v[92:95]
  s_bfe_u32 s72, 0x302011a, s1
  ds_read_b128 a[100:103], v16 offset:1024
  ds_read_b128 a[116:119], v16 offset:9216
  v_mfma_f32_16x16x32_bf16 v[92:95], a[156:159], a[92:95], v[92:95]
  s_add_u32 s0, s0, s72
  s_add_u32 s1, s1, 8
  s_and_b32 s1, s1, 0x8001f
  s_cmp_ge_u32 s0, 28
  s_cselect_b32 s72, 28, 0
  s_sub_u32 s0, s0, s72
  s_lshl_b32 s72, s0, 14
  s_add_u32 s70, s92, s72
  ds_read_b128 a[104:107], v17 offset:0
  ds_read_b128 a[120:123], v17 offset:8192
  ds_read_b128 a[108:111], v17 offset:1024
  ds_read_b128 a[124:127], v17 offset:9216
  ds_read_b64_tr_b16 a[132:133], v19 offset:16384
  ds_read_b64_tr_b16 a[134:135], v19 offset:18432
  ds_read_b64_tr_b16 a[148:149], v19 offset:20480
  ds_read_b64_tr_b16 a[150:151], v19 offset:22528
  s_waitcnt lgkmcnt(0)
  s_lshl_b32 s6, s78, 1
  s_add_u32 s6, s6, s77
  s_xor_b32 s6, s6, 1
  s_lshl_b32 s6, s6, 2
  s_add_u32 s6, s6, s3
  s_lshl_b32 s6, s6, 14
  s_add_u32 s6, s6, 8192
  s_add_u32 s7, s6, 4096
  v_mfma_f32_16x16x32_bf16 v[96:99], a[128:131], a[96:99], 0
  s_add_u32 s64, s64, s66
  ds_read_b64_tr_b16 a[136:137], v20 offset:16384
  ds_read_b64_tr_b16 a[138:139], v20 offset:18432
  v_mfma_f32_16x16x32_bf16 v[96:99], a[144:147], a[112:115], v[96:99]
  s_add_u32 s65, s65, 1
  ds_read_b64_tr_b16 a[152:153], v20 offset:20480
  v_mfma_f32_16x16x32_bf16 v[112:115], a[128:131], a[100:103], 0
  ds_read_b64_tr_b16 a[154:155], v20 offset:22528
  v_mfma_f32_16x16x32_bf16 v[112:115], a[144:147], a[116:119], v[112:115]
  ds_read_b64_tr_b16 a[140:141], v21 offset:16384
  ds_read_b64_tr_b16 a[142:143], v21 offset:18432
  v_mfma_f32_16x16x32_bf16 v[128:131], a[128:131], a[104:107], 0
  ds_read_b64_tr_b16 a[156:157], v21 offset:20480
  v_mfma_f32_16x16x32_bf16 v[128:131], a[144:147], a[120:123], v[128:131]
  ds_read_b64_tr_b16 a[158:159], v21 offset:22528
  v_mfma_f32_16x16x32_bf16 v[144:147], a[128:131], a[108:111], 0
  s_cmp_eq_u32 s65, 4
  s_cselect_b32 s65, 0, s65
  s_cselect_b32 s66, s67, s68
  v_mfma_f32_16x16x32_bf16 v[144:147], a[144:147], a[124:127], v[144:147]
  v_add_u32 v16, s66, v16
  v_add_u32 v17, s66, v17
  v_mfma_f32_16x16x32_bf16 v[100:103], a[132:135], a[96:99], 0
  v_add_u32 v18, s66, v18
  v_add_u32 v19, s66, v19
  v_mfma_f32_16x16x32_bf16 v[100:103], a[148:151], a[112:115], v[100:103]
  v_add_u32 v20, s66, v20
  v_add_u32 v21, s66, v21
  v_mfma_f32_16x16x32_bf16 v[116:119], a[132:135], a[100:103], 0
  buffer_store_dwordx4 v[64:67], v2, s[16:19], s6 offen offset:0 sc1
  v_mfma_f32_16x16x32_bf16 v[116:119], a[148:151], a[116:119], v[116:119]
  buffer_store_dwordx4 v[68:71], v2, s[16:19], s6 offen offset:1024 sc1
  v_mfma_f32_16x16x32_bf16 v[132:135], a[132:135], a[104:107], 0
  buffer_store_dwordx4 v[72:75], v2, s[16:19], s6 offen offset:2048 sc1
  v_mfma_f32_16x16x32_bf16 v[132:135], a[148:151], a[120:123], v[132:135]
  buffer_store_dwordx4 v[76:79], v2, s[16:19], s6 offen offset:3072 sc1
  v_mfma_f32_16x16x32_bf16 v[148:151], a[132:135], a[108:111], 0
  buffer_store_dwordx4 v[80:83], v2, s[16:19], s7 offen offset:0 sc1
  v_mfma_f32_16x16x32_bf16 v[148:151], a[148:151], a[124:127], v[148:151]
  buffer_store_dwordx4 v[84:87], v2, s[16:19], s7 offen offset:1024 sc1
  buffer_store_dwordx4 v[88:91], v2, s[16:19], s7 offen offset:2048 sc1
  buffer_store_dwordx4 v[92:95], v2, s[16:19], s7 offen offset:3072 sc1
  s_branch Lp7
Lp6_late:
  v_mfma_f32_16x16x32_bf16 v[40:43], a[136:139], a[64:67], v[40:43]
  s_add_u32 m0, s64, 16384
  ds_read_b128 a[96:99], v16 offset:0
  ds_read_b128 a[112:115], v16 offset:8192
  v_mfma_f32_16x16x32_bf16 v[40:43], a[152:155], a[80:83], v[40:43]
  buffer_load_dwordx4 v10, s[12:15], s71 offen offset:0 lds
  v_mfma_f32_16x16x32_bf16 v[56:59], a[136:139], a[68:71], v[56:59]
  ds_read_b64_tr_b16 a[128:129], v18 offset:16384
  ds_read_b64_tr_b16 a[130:131], v18 offset:18432
  v_mfma_f32_16x16x32_bf16 v[56:59], a[152:155], a[84:87], v[56:59]
  ds_read_b64_tr_b16 a[144:145], v18 offset:20480
  ds_read_b64_tr_b16 a[146:147], v18 offset:22528
  v_mfma_f32_16x16x32_bf16 v[72:75], a[136:139], a[72:75], v[72:75]
  ds_read_b128 a[100:103], v16 offset:1024
  ds_read_b128 a[116:119], v16 offset:9216
  v_mfma_f32_16x16x32_bf16 v[72:75], a[152:155], a[88:91], v[72:75]
  ds_read_b128 a[104:107], v17 offset:0
  ds_read_b128 a[120:123], v17 offset:8192
  v_mfma_f32_16x16x32_bf16 v[88:91], a[136:139], a[76:79], v[88:91]
  ds_read_b128 a[108:111], v17 offset:1024
  ds_read_b128 a[124:127], v17 offset:9216
  v_mfma_f32_16x16x32_bf16 v[88:91], a[152:155], a[92:95], v[88:91]
  buffer_load_dwordx4 v11, s[12:15], s71 offen offset:1024 lds
  v_mfma_f32_16x16x32_bf16 v[44:47], a[140:143], a[64:67], v[44:47]
  ds_read_b64_tr_b16 a[132:133], v19 offset:16384
  ds_read_b64_tr_b16 a[134:135], v19 offset:18432
  v_mfma_f32_16x16x32_bf16 v[44:47], a[156:159], a[80:83], v[44:47]
  ds_read_b64_tr_b16 a[148:149], v19 offset:20480
  ds_read_b64_tr_b16 a[150:151], v19 offset:22528
  v_mfma_f32_16x16x32_bf16 v[60:63], a[140:143], a[68:71], v[60:63]
  v_mfma_f32_16x16x32_bf16 v[60:63], a[156:159], a[84:87], v[60:63]
  v_mfma_f32_16x16x32_bf16 v[76:79], a[140:143], a[72:75], v[76:79]
  v_mfma_f32_16x16x32_bf16 v[76:79], a[156:159], a[88:91], v[76:79]
  v_mfma_f32_16x16x32_bf16 v[92:95], a[140:143], a[76:79], v[92:95]
  v_mfma_f32_16x16x32_bf16 v[92:95], a[156:159], a[92:95], v[92:95]
  s_waitcnt lgkmcnt(0)
  v_mfma_f32_16x16x32_bf16 v[32:35], a[128:131], a[96:99], v[32:35]
  buffer_load_dwordx4 v12, s[12:15], s71 offen offset:2048 lds
  v_mfma_f32_16x16x32_bf16 v[32:35], a[144:147], a[112:115], v[32:35]
  s_add_u32 s64, s64, s66
  ds_read_b64_tr_b16 a[136:137], v20 offset:16384
  ds_read_b64_tr_b16 a[138:139], v20 offset:18432
  v_mfma_f32_16x16x32_bf16 v[48:51], a[128:131], a[100:103], v[48:51]
  s_add_u32 s65, s65, 1
  ds_read_b64_tr_b16 a[152:153], v20 offset:20480
  ds_read_b64_tr_b16 a[154:155], v20 offset:22528
  v_mfma_f32_16x16x32_bf16 v[48:51], a[144:147], a[116:119], v[48:51]
  ds_read_b64_tr_b16 a[140:141], v21 offset:16384
  ds_read_b64_tr_b16 a[142:143], v21 offset:18432
  v_mfma_f32_16x16x32_bf16 v[64:67], a[128:131], a[104:107], v[64:67]
  buffer_load_dwordx4 v13, s[12:15], s71 offen offset:3072 lds
  v_mfma_f32_16x16x32_bf16 v[64:67], a[144:147], a[120:123], v[64:67]
  s_bfe_u32 s72, 0x302011a, s31
  ds_read_b64_tr_b16 a[156:157], v21 offset:20480
  ds_read_b64_tr_b16 a[158:159], v21 offset:22528
  v_mfma_f32_16x16x32_bf16 v[80:83], a[128:131], a[108:111], v[80:83]
  s_cmp_eq_u32 s65, 4
  s_cselect_b32 s65, 0, s65
  s_cselect_b32 s66, s67, s68
  v_mfma_f32_16x16x32_bf16 v[80:83], a[144:147], a[124:127], v[80:83]
  s_add_u32 s30, s30, s72
  v_add_u32 v16, s66, v16
  v_add_u32 v17, s66, v17
  v_mfma_f32_16x16x32_bf16 v[36:39], a[132:135], a[96:99], v[36:39]
  s_add_u32 s31, s31, 8
  v_add_u32 v18, s66, v18
  v_add_u32 v19, s66, v19
  v_mfma_f32_16x16x32_bf16 v[36:39], a[148:151], a[112:115], v[36:39]
  s_and_b32 s31, s31, 0x8001f
  v_add_u32 v20, s66, v20
  v_add_u32 v21, s66, v21
  v_mfma_f32_16x16x32_bf16 v[52:55], a[132:135], a[100:103], v[52:55]
  s_cmp_ge_u32 s30, 28
  s_cselect_b32 s72, 28, 0
  v_mfma_f32_16x16x32_bf16 v[52:55], a[148:151], a[116:119], v[52:55]
  s_sub_u32 s30, s30, s72
  v_mfma_f32_16x16x32_bf16 v[68:71], a[132:135], a[104:107], v[68:71]
  s_lshl_b32 s72, s30, 17
  s_add_u32 s71, s93, s72
  v_mfma_f32_16x16x32_bf16 v[68:71], a[148:151], a[120:123], v[68:71]
  v_mfma_f32_16x16x32_bf16 v[84:87], a[132:135], a[108:111], v[84:87]
  v_mfma_f32_16x16x32_bf16 v[84:87], a[148:151], a[124:127], v[84:87]
  s_waitcnt vmcnt(8) lgkmcnt(0)
  s_barrier
  v_mfma_f32_16x16x32_bf16 v[40:43], a[136:139], a[96:99], v[40:43]
  s_add_u32 m0, s64, 16384
  ds_read_b128 a[64:67], v16 offset:0
  ds_read_b128 a[80:83], v16 offset:8192
  v_mfma_f32_16x16x32_bf16 v[40:43], a[152:155], a[112:115], v[40:43]
  buffer_load_dwordx4 v10, s[12:15], s71 offen offset:0 lds
  v_mfma_f32_16x16x32_bf16 v[56:59], a[136:139], a[100:103], v[56:59]
  ds_read_b64_tr_b16 a[128:129], v18 offset:16384
  ds_read_b64_tr_b16 a[130:131], v18 offset:18432
  v_mfma_f32_16x16x32_bf16 v[56:59], a[152:155], a[116:119], v[56:59]
  ds_read_b64_tr_b16 a[144:145], v18 offset:20480
  ds_read_b64_tr_b16 a[146:147], v18 offset:22528
  v_mfma_f32_16x16x32_bf16 v[72:75], a[136:139], a[104:107], v[72:75]
  ds_read_b128 a[68:71], v16 offset:1024
  ds_read_b128 a[84:87], v16 offset:9216
  v_mfma_f32_16x16x32_bf16 v[72:75], a[152:155], a[120:123], v[72:75]
  buffer_load_dwordx4 v11, s[12:15], s71 offen offset:1024 lds
  v_mfma_f32_16x16x32_bf16 v[88:91], a[136:139], a[108:111], v[88:91]
  ds_read_b128 a[72:75], v17 offset:0
  ds_read_b128 a[88:91], v17 offset:8192
  v_mfma_f32_16x16x32_bf16 v[88:91], a[152:155], a[124:127], v[88:91]
  ds_read_b128 a[76:79], v17 offset:1024
  ds_read_b128 a[92:95], v17 offset:9216
  v_mfma_f32_16x16x32_bf16 v[44:47], a[140:143], a[96:99], v[44:47]
  ds_read_b64_tr_b16 a[132:133], v19 offset:16384
  ds_read_b64_tr_b16 a[134:135], v19 offset:18432
  v_mfma_f32_16x16x32_bf16 v[44:47], a[156:159], a[112:115], v[44:47]
  ds_read_b64_tr_b16 a[148:149], v19 offset:20480
  ds_read_b64_tr_b16 a[150:151], v19 offset:22528
  v_mfma_f32_16x16x32_bf16 v[60:63], a[140:143], a[100:103], v[60:63]
  buffer_load_dwordx4 v12, s[12:15], s71 offen offset:2048 lds
  v_mfma_f32_16x16x32_bf16 v[60:63], a[156:159], a[116:119], v[60:63]
  v_mfma_f32_16x16x32_bf16 v[76:79], a[140:143], a[104:107], v[76:79]
  v_mfma_f32_16x16x32_bf16 v[76:79], a[156:159], a[120:123], v[76:79]
  v_mfma_f32_16x16x32_bf16 v[92:95], a[140:143], a[108:111], v[92:95]
  v_mfma_f32_16x16x32_bf16 v[92:95], a[156:159], a[124:127], v[92:95]
  s_waitcnt lgkmcnt(0)
  v_mfma_f32_16x16x32_bf16 v[32:35], a[128:131], a[64:67], v[32:35]
  buffer_load_dwordx4 v13, s[12:15], s71 offen offset:3072 lds
  v_mfma_f32_16x16x32_bf16 v[32:35], a[144:147], a[80:83], v[32:35]
  s_bfe_u32 s72, 0x302011a, s31
  s_add_u32 s30, s30, s72
  s_add_u32 s31, s31, 8
  v_mfma_f32_16x16x32_bf16 v[48:51], a[128:131], a[68:71], v[48:51]
  s_and_b32 s31, s31, 0x8001f
  s_cmp_ge_u32 s30, 28
  s_cselect_b32 s72, 28, 0
  v_mfma_f32_16x16x32_bf16 v[48:51], a[144:147], a[84:87], v[48:51]
  s_sub_u32 s30, s30, s72
  s_lshl_b32 s72, s30, 17
  s_add_u32 s71, s93, s72
  v_mfma_f32_16x16x32_bf16 v[64:67], a[128:131], a[72:75], v[64:67]
  buffer_load_dwordx2 v[6:7], v14, s[96:99], s91 offen sc1
  v_mfma_f32_16x16x32_bf16 v[64:67], a[144:147], a[88:91], v[64:67]
  s_add_u32 s64, s64, s66
  ds_read_b64_tr_b16 a[136:137], v20 offset:16384
  ds_read_b64_tr_b16 a[138:139], v20 offset:18432
  v_mfma_f32_16x16x32_bf16 v[80:83], a[128:131], a[76:79], v[80:83]
  s_add_u32 s65, s65, 1
  ds_read_b64_tr_b16 a[152:153], v20 offset:20480
  ds_read_b64_tr_b16 a[154:155], v20 offset:22528
  v_mfma_f32_16x16x32_bf16 v[80:83], a[144:147], a[92:95], v[80:83]
  ds_read_b64_tr_b16 a[140:141], v21 offset:16384
  ds_read_b64_tr_b16 a[142:143], v21 offset:18432
  v_mfma_f32_16x16x32_bf16 v[36:39], a[132:135], a[64:67], v[36:39]
  ds_read_b64_tr_b16 a[156:157], v21 offset:20480
  ds_read_b64_tr_b16 a[158:159], v21 offset:22528
  v_mfma_f32_16x16x32_bf16 v[36:39], a[148:151], a[80:83], v[36:39]
  s_cmp_eq_u32 s65, 4
  s_cselect_b32 s65, 0, s65
  s_cselect_b32 s66, s67, s68
  v_mfma_f32_16x16x32_bf16 v[52:55], a[132:135], a[68:71], v[52:55]
  v_add_u32 v16, s66, v16
  v_add_u32 v17, s66, v17
  v_mfma_f32_16x16x32_bf16 v[52:55], a[148:151], a[84:87], v[52:55]
  v_add_u32 v18, s66, v18
  v_add_u32 v19, s66, v19
  v_mfma_f32_16x16x32_bf16 v[68:71], a[132:135], a[72:75], v[68:71]
  v_add_u32 v20, s66, v20
  v_add_u32 v21, s66, v21
  v_mfma_f32_16x16x32_bf16 v[68:71], a[148:151], a[88:91], v[68:71]
  v_mfma_f32_16x16x32_bf16 v[84:87], a[132:135], a[76:79], v[84:87]
  v_mfma_f32_16x16x32_bf16 v[84:87], a[148:151], a[92:95], v[84:87]
  s_waitcnt vmcnt(0) lgkmcnt(0)
  s_barrier
  s_mov_b32 s5, 0x40000
Lpoll_9:
  v_cmp_ne_u64 vcc, s[94:95], v[6:7]
  s_nop 0
  s_cbranch_vccz Lpolld_10
  s_sleep 4
  buffer_load_dwordx2 v[6:7], v14, s[96:99], s91 offen sc1
  s_sub_u32 s5, s5, 1
  s_waitcnt vmcnt(0)
  s_cbranch_scc0 Lpoll_9
Lpolld_10:
  s_add_u32 s8, s86, 67108864
  s_addc_u32 s9, s87, 0
  s_mov_b32 s10, 16777216
  s_mov_b32 s11, 0x00020000
  s_lshl_b32 s92, s73, 1
  s_add_u32 s92, s92, s77
  s_lshl_b32 s92, s92, 19
  s_add_u32 s92, s92, s79
  s_add_u32 s72, s73, s76
  s_and_b32 s1, s72, 3
  s_lshl_b32 s1, s1, 3
  s_or_b32 s1, s1, 0x80000
  s_bfe_u32 s0, 0x1b1b02, s1
  s_add_u32 s0, s0, 0
  s_cmp_ge_u32 s0, 28
  s_cselect_b32 s72, 28, 0
  s_sub_u32 s0, s0, s72
  s_lshl_b32 s72, s0, 14
  s_add_u32 s70, s92, s72
  v_mfma_f32_16x16x32_bf16 v[40:43], a[136:139], a[64:67], v[40:43]
  s_add_u32 m0, s79, 131072
  v_mfma_f32_16x16x32_bf16 v[40:43], a[152:155], a[80:83], v[40:43]
  buffer_load_dwordx4 v2, s[8:11], s70 offen offset:0 sc1 lds
  v_mfma_f32_16x16x32_bf16 v[56:59], a[136:139], a[68:71], v[56:59]
  buffer_load_dwordx4 v2, s[8:11], s70 offen offset:1024 sc1 lds
  v_mfma_f32_16x16x32_bf16 v[56:59], a[152:155], a[84:87], v[56:59]
  buffer_load_dwordx4 v2, s[8:11], s70 offen offset:2048 sc1 lds
  v_mfma_f32_16x16x32_bf16 v[72:75], a[136:139], a[72:75], v[72:75]
  buffer_load_dwordx4 v2, s[8:11], s70 offen offset:3072 sc1 lds
  v_mfma_f32_16x16x32_bf16 v[72:75], a[152:155], a[88:91], v[72:75]
  s_bfe_u32 s72, 0x302011a, s1
  s_add_u32 s0, s0, s72
  s_add_u32 s1, s1, 8
  v_mfma_f32_16x16x32_bf16 v[88:91], a[136:139], a[76:79], v[88:91]
  s_and_b32 s1, s1, 0x8001f
  s_cmp_ge_u32 s0, 28
  s_cselect_b32 s72, 28, 0
  v_mfma_f32_16x16x32_bf16 v[88:91], a[152:155], a[92:95], v[88:91]
  s_sub_u32 s0, s0, s72
  s_lshl_b32 s72, s0, 14
  s_add_u32 s70, s92, s72
  v_mfma_f32_16x16x32_bf16 v[44:47], a[140:143], a[64:67], v[44:47]
  s_add_u32 m0, s79, 32768
  v_mfma_f32_16x16x32_bf16 v[44:47], a[156:159], a[80:83], v[44:47]
  buffer_load_dwordx4 v2, s[8:11], s70 offen offset:0 sc1 lds
  v_mfma_f32_16x16x32_bf16 v[60:63], a[140:143], a[68:71], v[60:63]
  buffer_load_dwordx4 v2, s[8:11], s70 offen offset:1024 sc1 lds
  v_mfma_f32_16x16x32_bf16 v[60:63], a[156:159], a[84:87], v[60:63]
  buffer_load_dwordx4 v2, s[8:11], s70 offen offset:2048 sc1 lds
  v_mfma_f32_16x16x32_bf16 v[76:79], a[140:143], a[72:75], v[76:79]
  buffer_load_dwordx4 v2, s[8:11], s70 offen offset:3072 sc1 lds
  v_mfma_f32_16x16x32_bf16 v[76:79], a[156:159], a[88:91], v[76:79]
  s_bfe_u32 s72, 0x302011a, s1
  s_add_u32 s0, s0, s72
  s_add_u32 s1, s1, 8
  v_mfma_f32_16x16x32_bf16 v[92:95], a[140:143], a[76:79], v[92:95]
  s_and_b32 s1, s1, 0x8001f
  s_cmp_ge_u32 s0, 28
  s_cselect_b32 s72, 28, 0
  v_mfma_f32_16x16x32_bf16 v[92:95], a[156:159], a[92:95], v[92:95]
  s_sub_u32 s0, s0, s72
  s_lshl_b32 s72, s0, 14
  s_add_u32 s70, s92, s72
  s_add_u32 m0, s79, 65536
  s_nop 0
  buffer_load_dwordx4 v2, s[8:11], s70 offen offset:0 sc1 lds
  buffer_load_dwordx4 v2, s[8:11], s70 offen offset:1024 sc1 lds
  buffer_load_dwordx4 v2, s[8:11], s70 offen offset:2048 sc1 lds
  buffer_load_dwordx4 v2, s[8:11], s70 offen offset:3072 sc1 lds
  s_bfe_u32 s72, 0x302011a, s1
  s_add_u32 s0, s0, s72
  s_add_u32 s1, s1, 8
  s_and_b32 s1, s1, 0x8001f
  s_cmp_ge_u32 s0, 28
  s_cselect_b32 s72, 28, 0
  s_sub_u32 s0, s0, s72
  s_lshl_b32 s72, s0, 14
  s_add_u32 s70, s92, s72
  s_add_u32 m0, s79, 114688
  s_nop 0
  buffer_load_dwordx4 v10, s[12:15], s71 offen offset:0 lds
  buffer_load_dwordx4 v11, s[12:15], s71 offen offset:1024 lds
  buffer_load_dwordx4 v12, s[12:15], s71 offen offset:2048 lds
  buffer_load_dwordx4 v13, s[12:15], s71 offen offset:3072 lds
  s_bfe_u32 s72, 0x302011a, s31
  s_add_u32 s30, s30, s72
  s_add_u32 s31, s31, 8
  s_and_b32 s31, s31, 0x8001f
  s_cmp_ge_u32 s30, 28
  s_cselect_b32 s72, 28, 0
  s_sub_u32 s30, s30, s72
  s_lshl_b32 s72, s30, 17
  s_add_u32 s71, s93, s72
  s_add_u32 m0, s79, 98304
  s_nop 0
  buffer_load_dwordx4 v2, s[8:11], s70 offen offset:0 sc1 lds
  buffer_load_dwordx4 v2, s[8:11], s70 offen offset:1024 sc1 lds
  buffer_load_dwordx4 v2, s[8:11], s70 offen offset:2048 sc1 lds
  buffer_load_dwordx4 v2, s[8:11], s70 offen offset:3072 sc1 lds
  s_bfe_u32 s72, 0x302011a, s1
  s_add_u32 s0, s0, s72
  s_add_u32 s1, s1, 8
  s_and_b32 s1, s1, 0x8001f
  s_cmp_ge_u32 s0, 28
  s_cselect_b32 s72, 28, 0
  s_sub_u32 s0, s0, s72
  s_lshl_b32 s72, s0, 14
  s_add_u32 s70, s92, s72
  s_lshl_b32 s6, s78, 1
  s_add_u32 s6, s6, s77
  s_xor_b32 s6, s6, 1
  s_lshl_b32 s6, s6, 2
  s_add_u32 s6, s6, s3
  s_lshl_b32 s6, s6, 14
  s_add_u32 s6, s6, 8192
  s_add_u32 s7, s6, 4096
  buffer_store_dwordx4 v[64:67], v2, s[16:19], s6 offen offset:0 sc1
  buffer_store_dwordx4 v[68:71], v2, s[16:19], s6 offen offset:1024 sc1
  buffer_store_dwordx4 v[72:75], v2, s[16:19], s6 offen offset:2048 sc1
  buffer_store_dwordx4 v[76:79], v2, s[16:19], s6 offen offset:3072 sc1
  buffer_store_dwordx4 v[80:83], v2, s[16:19], s7 offen offset:0 sc1
  buffer_store_dwordx4 v[84:87], v2, s[16:19], s7 offen offset:1024 sc1
  buffer_store_dwordx4 v[88:91], v2, s[16:19], s7 offen offset:2048 sc1
  buffer_store_dwordx4 v[92:95], v2, s[16:19], s7 offen offset:3072 sc1
  s_waitcnt vmcnt(24)
  s_barrier
  ds_read_b128 a[96:99], v16 offset:0
  ds_read_b128 a[112:115], v16 offset:8192
  ds_read_b64_tr_b16 a[128:129], v18 offset:16384
  ds_read_b64_tr_b16 a[130:131], v18 offset:18432
  ds_read_b64_tr_b16 a[144:145], v18 offset:20480
  ds_read_b64_tr_b16 a[146:147], v18 offset:22528
  ds_read_b128 a[100:103], v16 offset:1024
  ds_read_b128 a[116:119], v16 offset:9216
  ds_read_b128 a[104:107], v17 offset:0
  ds_read_b128 a[120:123], v17 offset:8192
  ds_read_b128 a[108:111], v17 offset:1024
  ds_read_b128 a[124:127], v17 offset:9216
  ds_read_b64_tr_b16 a[132:133], v19 offset:16384
  ds_read_b64_tr_b16 a[134:135], v19 offset:18432
  ds_read_b64_tr_b16 a[148:149], v19 offset:20480
  ds_read_b64_tr_b16 a[150:151], v19 offset:22528
  s_waitcnt lgkmcnt(0)
  v_mfma_f32_16x16x32_bf16 v[96:99], a[128:131], a[96:99], 0
  s_add_u32 s64, s64, s66
  ds_read_b64_tr_b16 a[136:137], v20 offset:16384
  ds_read_b64_tr_b16 a[138:139], v20 offset:18432
  v_mfma_f32_16x16x32_bf16 v[96:99], a[144:147], a[112:115], v[96:99]
  s_add_u32 s65, s65, 1
  ds_read_b64_tr_b16 a[152:153], v20 offset:20480
  v_mfma_f32_16x16x32_bf16 v[112:115], a[128:131], a[100:103], 0
  ds_read_b64_tr_b16 a[154:155], v20 offset:22528
  v_mfma_f32_16x16x32_bf16 v[112:115], a[144:147], a[116:119], v[112:115]
  ds_read_b64_tr_b16 a[140:141], v21 offset:16384
  ds_read_b64_tr_b16 a[142:143], v21 offset:18432
  v_mfma_f32_16x16x32_bf16 v[128:131], a[128:131], a[104:107], 0
  ds_read_b64_tr_b16 a[156:157], v21 offset:20480
  v_mfma_f32_16x16x32_bf16 v[128:131], a[144:147], a[120:123], v[128:131]
  ds_read_b64_tr_b16 a[158:159], v21 offset:22528
  v_mfma_f32_16x16x32_bf16 v[144:147], a[128:131], a[108:111], 0
  s_cmp_eq_u32 s65, 4
  s_cselect_b32 s65, 0, s65
  s_cselect_b32 s66, s67, s68
  v_mfma_f32_16x16x32_bf16 v[144:147], a[144:147], a[124:127], v[144:147]
  v_add_u32 v16, s66, v16
  v_add_u32 v17, s66, v17
  v_mfma_f32_16x16x32_bf16 v[100:103], a[132:135], a[96:99], 0
  v_add_u32 v18, s66, v18
  v_add_u32 v19, s66, v19
  v_mfma_f32_16x16x32_bf16 v[100:103], a[148:151], a[112:115], v[100:103]
  v_add_u32 v20, s66, v20
  v_add_u32 v21, s66, v21
  v_mfma_f32_16x16x32_bf16 v[116:119], a[132:135], a[100:103], 0
  v_mfma_f32_16x16x32_bf16 v[116:119], a[148:151], a[116:119], v[116:119]
  v_mfma_f32_16x16x32_bf16 v[132:135], a[132:135], a[104:107], 0
  v_mfma_f32_16x16x32_bf16 v[132:135], a[148:151], a[120:123], v[132:135]
  v_mfma_f32_16x16x32_bf16 v[148:151], a[132:135], a[108:111], 0
  v_mfma_f32_16x16x32_bf16 v[148:151], a[148:151], a[124:127], v[148:151]
Lp7:
  s_mov_b32 s69, 11
  s_waitcnt vmcnt(16) lgkmcnt(0)
  s_barrier
  v_mfma_f32_16x16x32_bf16 v[104:107], a[136:139], a[96:99], 0
  s_add_u32 m0, s64, 16384
  ds_read_b128 a[64:67], v16 offset:0
  ds_read_b128 a[80:83], v16 offset:8192
  v_mfma_f32_16x16x32_bf16 v[104:107], a[152:155], a[112:115], v[104:107]
  buffer_load_dwordx4 v10, s[12:15], s71 offen offset:0 lds
  v_mfma_f32_16x16x32_bf16 v[120:123], a[136:139], a[100:103], 0
  ds_read_b64_tr_b16 a[128:129], v18 offset:16384
  ds_read_b64_tr_b16 a[130:131], v18 offset:18432
  v_mfma_f32_16x16x32_bf16 v[120:123], a[152:155], a[116:119], v[120:123]
  buffer_load_dwordx4 v11, s[12:15], s71 offen offset:1024 lds
  v_mfma_f32_16x16x32_bf16 v[136:139], a[136:139], a[104:107], 0
  ds_read_b64_tr_b16 a[144:145], v18 offset:20480
  ds_read_b64_tr_b16 a[146:147], v18 offset:22528
  v_mfma_f32_16x16x32_bf16 v[136:139], a[152:155], a[120:123], v[136:139]
  ds_read_b128 a[68:71], v16 offset:1024
  ds_read_b128 a[84:87], v16 offset:9216
  v_mfma_f32_16x16x32_bf16 v[152:155], a[136:139], a[108:111], 0
  ds_read_b128 a[72:75], v17 offset:0
  ds_read_b128 a[88:91], v17 offset:8192
  v_mfma_f32_16x16x32_bf16 v[152:155], a[152:155], a[124:127], v[152:155]
  buffer_load_dwordx4 v12, s[12:15], s71 offen offset:2048 lds
  v_mfma_f32_16x16x32_bf16 v[108:111], a[140:143], a[96:99], 0
  ds_read_b128 a[76:79], v17 offset:1024
  ds_read_b128 a[92:95], v17 offset:9216
  v_mfma_f32_16x16x32_bf16 v[108:111], a[156:159], a[112:115], v[108:111]
  ds_read_b64_tr_b16 a[132:133], v19 offset:16384
  ds_read_b64_tr_b16 a[134:135], v19 offset:18432
  v_mfma_f32_16x16x32_bf16 v[124:127], a[140:143], a[100:103], 0
  ds_read_b64_tr_b16 a[148:149], v19 offset:20480
  ds_read_b64_tr_b16 a[150:151], v19 offset:22528
  v_mfma_f32_16x16x32_bf16 v[124:127], a[156:159], a[116:119], v[124:127]
  buffer_load_dwordx4 v13, s[12:15], s71 offen offset:3072 lds
  v_mfma_f32_16x16x32_bf16 v[140:143], a[140:143], a[104:107], 0
  s_bfe_u32 s72, 0x302011a, s31
  v_mfma_f32_16x16x32_bf16 v[140:143], a[156:159], a[120:123], v[140:143]
  s_add_u32 s30, s30, s72
  v_mfma_f32_16x16x32_bf16 v[156:159], a[140:143], a[108:111], 0
  s_add_u32 s31, s31, 8
  s_and_b32 s31, s31, 0x8001f
  s_cmp_ge_u32 s30, 28
  s_cselect_b32 s72, 28, 0
  v_mfma_f32_16x16x32_bf16 v[156:159], a[156:159], a[124:127], v[156:159]
  s_sub_u32 s30, s30, s72
  s_lshl_b32 s72, s30, 17
  s_add_u32 s71, s93, s72
  s_waitcnt lgkmcnt(0)
  v_mfma_f32_16x16x32_bf16 v[96:99], a[128:131], a[64:67], v[96:99]
  s_mov_b32 m0, s64
  ds_read_b64_tr_b16 a[136:137], v20 offset:16384
  ds_read_b64_tr_b16 a[138:139], v20 offset:18432
  v_mfma_f32_16x16x32_bf16 v[96:99], a[144:147], a[80:83], v[96:99]
  buffer_load_dwordx4 v2, s[8:11], s70 offen offset:0 sc1 lds
  v_mfma_f32_16x16x32_bf16 v[112:115], a[128:131], a[68:71], v[112:115]
  buffer_load_dwordx4 v2, s[8:11], s70 offen offset:1024 sc1 lds
  v_mfma_f32_16x16x32_bf16 v[112:115], a[144:147], a[84:87], v[112:115]
  s_add_u32 s64, s64, s66
  ds_read_b64_tr_b16 a[152:153], v20 offset:20480
  ds_read_b64_tr_b16 a[154:155], v20 offset:22528
  v_mfma_f32_16x16x32_bf16 v[128:131], a[128:131], a[72:75], v[128:131]
  buffer_load_dwordx4 v2, s[8:11], s70 offen offset:2048 sc1 lds
  v_mfma_f32_16x16x32_bf16 v[128:131], a[144:147], a[88:91], v[128:131]
  s_add_u32 s65, s65, 1
  ds_read_b64_tr_b16 a[140:141], v21 offset:16384
  ds_read_b64_tr_b16 a[142:143], v21 offset:18432
  v_mfma_f32_16x16x32_bf16 v[144:147], a[128:131], a[76:79], v[144:147]
  buffer_load_dwordx4 v2, s[8:11], s70 offen offset:3072 sc1 lds
  v_mfma_f32_16x16x32_bf16 v[144:147], a[144:147], a[92:95], v[144:147]
  s_bfe_u32 s72, 0x302011a, s1
  ds_read_b64_tr_b16 a[156:157], v21 offset:20480
  ds_read_b64_tr_b16 a[158:159], v21 offset:22528
  v_mfma_f32_16x16x32_bf16 v[100:103], a[132:135], a[64:67], v[100:103]
  s_cmp_eq_u32 s65, 4
  s_cselect_b32 s65, 0, s65
  s_cselect_b32 s66, s67, s68
  v_mfma_f32_16x16x32_bf16 v[100:103], a[148:151], a[80:83], v[100:103]
  s_add_u32 s0, s0, s72
  v_add_u32 v16, s66, v16
  v_add_u32 v17, s66, v17
  v_mfma_f32_16x16x32_bf16 v[116:119], a[132:135], a[68:71], v[116:119]
  s_add_u32 s1, s1, 8
  v_add_u32 v18, s66, v18
  v_add_u32 v19, s66, v19
  v_mfma_f32_16x16x32_bf16 v[116:119], a[148:151], a[84:87], v[116:119]
  s_and_b32 s1, s1, 0x8001f
  s_cmp_ge_u32 s0, 28
  s_cselect_b32 s72, 28, 0
  v_mfma_f32_16x16x32_bf16 v[132:135], a[132:135], a[72:75], v[132:135]
  s_sub_u32 s0, s0, s72
  s_lshl_b32 s72, s0, 14
  s_add_u32 s70, s92, s72
  v_mfma_f32_16x16x32_bf16 v[132:135], a[148:151], a[88:91], v[132:135]
  v_add_u32 v20, s66, v20
  v_add_u32 v21, s66, v21
  v_mfma_f32_16x16x32_bf16 v[148:151], a[132:135], a[76:79], v[148:151]
  v_mfma_f32_16x16x32_bf16 v[148:151], a[148:151], a[92:95], v[148:151]
  s_waitcnt vmcnt(16) lgkmcnt(0)
  s_barrier
  .p2align 6
Lp7_loop:
  v_mfma_f32_16x16x32_bf16 v[104:107], a[136:139], a[64:67], v[104:107]
  s_add_u32 m0, s64, 16384
  ds_read_b128 a[96:99], v16 offset:0
  ds_read_b128 a[112:115], v16 offset:8192
  v_mfma_f32_16x16x32_bf16 v[104:107], a[152:155], a[80:83], v[104:107]
  buffer_load_dwordx4 v10, s[12:15], s71 offen offset:0 lds
  v_mfma_f32_16x16x32_bf16 v[120:123], a[136:139], a[68:71], v[120:123]
  ds_read_b64_tr_b16 a[128:129], v18 offset:16384
  ds_read_b64_tr_b16 a[130:131], v18 offset:18432
  v_mfma_f32_16x16x32_bf16 v[120:123], a[152:155], a[84:87], v[120:123]
  buffer_load_dwordx4 v11, s[12:15], s71 offen offset:1024 lds
  v_mfma_f32_16x16x32_bf16 v[136:139], a[136:139], a[72:75], v[136:139]
  ds_read_b64_tr_b16 a[144:145], v18 offset:20480
  ds_read_b64_tr_b16 a[146:147], v18 offset:22528
  v_mfma_f32_16x16x32_bf16 v[136:139], a[152:155], a[88:91], v[136:139]
  ds_read_b128 a[100:103], v16 offset:1024
  ds_read_b128 a[116:119], v16 offset:9216
  v_mfma_f32_16x16x32_bf16 v[152:155], a[136:139], a[76:79], v[152:155]
  ds_read_b128 a[104:107], v17 offset:0
  ds_read_b128 a[120:123], v17 offset:8192
  v_mfma_f32_16x16x32_bf16 v[152:155], a[152:155], a[92:95], v[152:155]
  buffer_load_dwordx4 v12, s[12:15], s71 offen offset:2048 lds
  v_mfma_f32_16x16x32_bf16 v[108:111], a[140:143], a[64:67], v[108:111]
  ds_read_b128 a[108:111], v17 offset:1024
  ds_read_b128 a[124:127], v17 offset:9216
  v_mfma_f32_16x16x32_bf16 v[108:111], a[156:159], a[80:83], v[108:111]
  ds_read_b64_tr_b16 a[132:133], v19 offset:16384
  ds_read_b64_tr_b16 a[134:135], v19 offset:18432
  v_mfma_f32_16x16x32_bf16 v[124:127], a[140:143], a[68:71], v[124:127]
  ds_read_b64_tr_b16 a[148:149], v19 offset:20480
  ds_read_b64_tr_b16 a[150:151], v19 offset:22528
  v_mfma_f32_16x16x32_bf16 v[124:127], a[156:159], a[84:87], v[124:127]
  buffer_load_dwordx4 v13, s[12:15], s71 offen offset:3072 lds
  v_mfma_f32_16x16x32_bf16 v[140:143], a[140:143], a[72:75], v[140:143]
  s_bfe_u32 s72, 0x302011a, s31
  v_mfma_f32_16x16x32_bf16 v[140:143], a[156:159], a[88:91], v[140:143]
  s_add_u32 s30, s30, s72
  v_mfma_f32_16x16x32_bf16 v[156:159], a[140:143], a[76:79], v[156:159]
  s_add_u32 s31, s31, 8
  s_and_b32 s31, s31, 0x8001f
  s_cmp_ge_u32 s30, 28
  s_cselect_b32 s72, 28, 0
  v_mfma_f32_16x16x32_bf16 v[156:159], a[156:159], a[92:95], v[156:159]
  s_sub_u32 s30, s30, s72
  s_lshl_b32 s72, s30, 17
  s_add_u32 s71, s93, s72
  s_waitcnt lgkmcnt(0)
  v_mfma_f32_16x16x32_bf16 v[96:99], a[128:131], a[96:99], v[96:99]
  s_mov_b32 m0, s64
  ds_read_b64_tr_b16 a[136:137], v20 offset:16384
  ds_read_b64_tr_b16 a[138:139], v20 offset:18432
  v_mfma_f32_16x16x32_bf16 v[96:99], a[144:147], a[112:115], v[96:99]
  buffer_load_dwordx4 v2, s[8:11], s70 offen offset:0 sc1 lds
  v_mfma_f32_16x16x32_bf16 v[112:115], a[128:131], a[100:103], v[112:115]
  buffer_load_dwordx4 v2, s[8:11], s70 offen offset:1024 sc1 lds
  v_mfma_f32_16x16x32_bf16 v[112:115], a[144:147], a[116:119], v[112:115]
  s_add_u32 s64, s64, s66
  ds_read_b64_tr_b16 a[152:153], v20 offset:20480
  ds_read_b64_tr_b16 a[154:155], v20 offset:22528
  v_mfma_f32_16x16x32_bf16 v[128:131], a[128:131], a[104:107], v[128:131]
  buffer_load_dwordx4 v2, s[8:11], s70 offen offset:2048 sc1 lds
  v_mfma_f32_16x16x32_bf16 v[128:131], a[144:147], a[120:123], v[128:131]
  s_add_u32 s65, s65, 1
  ds_read_b64_tr_b16 a[140:141], v21 offset:16384
  ds_read_b64_tr_b16 a[142:143], v21 offset:18432
  v_mfma_f32_16x16x32_bf16 v[144:147], a[128:131], a[108:111], v[144:147]
  buffer_load_dwordx4 v2, s[8:11], s70 offen offset:3072 sc1 lds
  v_mfma_f32_16x16x32_bf16 v[144:147], a[144:147], a[124:127], v[144:147]
  s_bfe_u32 s72, 0x302011a, s1
  ds_read_b64_tr_b16 a[156:157], v21 offset:20480
  ds_read_b64_tr_b16 a[158:159], v21 offset:22528
  v_mfma_f32_16x16x32_bf16 v[100:103], a[132:135], a[96:99], v[100:103]
  s_cmp_eq_u32 s65, 4
  s_cselect_b32 s65, 0, s65
  s_cselect_b32 s66, s67, s68
  v_mfma_f32_16x16x32_bf16 v[100:103], a[148:151], a[112:115], v[100:103]
  s_add_u32 s0, s0, s72
  v_add_u32 v16, s66, v16
  v_add_u32 v17, s66, v17
  v_mfma_f32_16x16x32_bf16 v[116:119], a[132:135], a[100:103], v[116:119]
  s_add_u32 s1, s1, 8
  v_add_u32 v18, s66, v18
  v_add_u32 v19, s66, v19
  v_mfma_f32_16x16x32_bf16 v[116:119], a[148:151], a[116:119], v[116:119]
  s_and_b32 s1, s1, 0x8001f
  s_cmp_ge_u32 s0, 28
  s_cselect_b32 s72, 28, 0
  v_mfma_f32_16x16x32_bf16 v[132:135], a[132:135], a[104:107], v[132:135]
  s_sub_u32 s0, s0, s72
  s_lshl_b32 s72, s0, 14
  s_add_u32 s70, s92, s72
  v_mfma_f32_16x16x32_bf16 v[132:135], a[148:151], a[120:123], v[132:135]
  v_add_u32 v20, s66, v20
  v_add_u32 v21, s66, v21
  v_mfma_f32_16x16x32_bf16 v[148:151], a[132:135], a[108:111], v[148:151]
  v_mfma_f32_16x16x32_bf16 v[148:151], a[148:151], a[124:127], v[148:151]
  s_waitcnt vmcnt(16) lgkmcnt(0)
  s_barrier
  v_mfma_f32_16x16x32_bf16 v[104:107], a[136:139], a[96:99], v[104:107]
  s_add_u32 m0, s64, 16384
  ds_read_b128 a[64:67], v16 offset:0
  ds_read_b128 a[80:83], v16 offset:8192
  v_mfma_f32_16x16x32_bf16 v[104:107], a[152:155], a[112:115], v[104:107]
  buffer_load_dwordx4 v10, s[12:15], s71 offen offset:0 lds
  v_mfma_f32_16x16x32_bf16 v[120:123], a[136:139], a[100:103], v[120:123]
  ds_read_b64_tr_b16 a[128:129], v18 offset:16384
  ds_read_b64_tr_b16 a[130:131], v18 offset:18432
  v_mfma_f32_16x16x32_bf16 v[120:123], a[152:155], a[116:119], v[120:123]
  buffer_load_dwordx4 v11, s[12:15], s71 offen offset:1024 lds
  v_mfma_f32_16x16x32_bf16 v[136:139], a[136:139], a[104:107], v[136:139]
  ds_read_b64_tr_b16 a[144:145], v18 offset:20480
  ds_read_b64_tr_b16 a[146:147], v18 offset:22528
  v_mfma_f32_16x16x32_bf16 v[136:139], a[152:155], a[120:123], v[136:139]
  ds_read_b128 a[68:71], v16 offset:1024
  ds_read_b128 a[84:87], v16 offset:9216
  v_mfma_f32_16x16x32_bf16 v[152:155], a[136:139], a[108:111], v[152:155]
  ds_read_b128 a[72:75], v17 offset:0
  ds_read_b128 a[88:91], v17 offset:8192
  v_mfma_f32_16x16x32_bf16 v[152:155], a[152:155], a[124:127], v[152:155]
  buffer_load_dwordx4 v12, s[12:15], s71 offen offset:2048 lds
  v_mfma_f32_16x16x32_bf16 v[108:111], a[140:143], a[96:99], v[108:111]
  ds_read_b128 a[76:79], v17 offset:1024
  ds_read_b128 a[92:95], v17 offset:9216
  v_mfma_f32_16x16x32_bf16 v[108:111], a[156:159], a[112:115], v[108:111]
  ds_read_b64_tr_b16 a[132:133], v19 offset:16384
  ds_read_b64_tr_b16 a[134:135], v19 offset:18432
  v_mfma_f32_16x16x32_bf16 v[124:127], a[140:143], a[100:103], v[124:127]
  ds_read_b64_tr_b16 a[148:149], v19 offset:20480
  ds_read_b64_tr_b16 a[150:151], v19 offset:22528
  v_mfma_f32_16x16x32_bf16 v[124:127], a[156:159], a[116:119], v[124:127]
  buffer_load_dwordx4 v13, s[12:15], s71 offen offset:3072 lds
  v_mfma_f32_16x16x32_bf16 v[140:143], a[140:143], a[104:107], v[140:143]
  s_bfe_u32 s72, 0x302011a, s31
  v_mfma_f32_16x16x32_bf16 v[140:143], a[156:159], a[120:123], v[140:143]
  s_add_u32 s30, s30, s72
  v_mfma_f32_16x16x32_bf16 v[156:159], a[140:143], a[108:111], v[156:159]
  s_add_u32 s31, s31, 8
  s_and_b32 s31, s31, 0x8001f
  s_cmp_ge_u32 s30, 28
  s_cselect_b32 s72, 28, 0
  v_mfma_f32_16x16x32_bf16 v[156:159], a[156:159], a[124:127], v[156:159]
  s_sub_u32 s30, s30, s72
  s_lshl_b32 s72, s30, 17
  s_add_u32 s71, s93, s72
  s_waitcnt lgkmcnt(0)
  v_mfma_f32_16x16x32_bf16 v[96:99], a[128:131], a[64:67], v[96:99]
  s_mov_b32 m0, s64
  ds_read_b64_tr_b16 a[136:137], v20 offset:16384
  ds_read_b64_tr_b16 a[138:139], v20 offset:18432
  v_mfma_f32_16x16x32_bf16 v[96:99], a[144:147], a[80:83], v[96:99]
  buffer_load_dwordx4 v2, s[8:11], s70 offen offset:0 sc1 lds
  v_mfma_f32_16x16x32_bf16 v[112:115], a[128:131], a[68:71], v[112:115]
  buffer_load_dwordx4 v2, s[8:11], s70 offen offset:1024 sc1 lds
  v_mfma_f32_16x16x32_bf16 v[112:115], a[144:147], a[84:87], v[112:115]
  s_add_u32 s64, s64, s66
  ds_read_b64_tr_b16 a[152:153], v20 offset:20480
  ds_read_b64_tr_b16 a[154:155], v20 offset:22528
  v_mfma_f32_16x16x32_bf16 v[128:131], a[128:131], a[72:75], v[128:131]
  buffer_load_dwordx4 v2, s[8:11], s70 offen offset:2048 sc1 lds
  v_mfma_f32_16x16x32_bf16 v[128:131], a[144:147], a[88:91], v[128:131]
  s_add_u32 s65, s65, 1
  ds_read_b64_tr_b16 a[140:141], v21 offset:16384
  ds_read_b64_tr_b16 a[142:143], v21 offset:18432
  v_mfma_f32_16x16x32_bf16 v[144:147], a[128:131], a[76:79], v[144:147]
  buffer_load_dwordx4 v2, s[8:11], s70 offen offset:3072 sc1 lds
  v_mfma_f32_16x16x32_bf16 v[144:147], a[144:147], a[92:95], v[144:147]
  s_bfe_u32 s72, 0x302011a, s1
  ds_read_b64_tr_b16 a[156:157], v21 offset:20480
  ds_read_b64_tr_b16 a[158:159], v21 offset:22528
  v_mfma_f32_16x16x32_bf16 v[100:103], a[132:135], a[64:67], v[100:103]
  s_cmp_eq_u32 s65, 4
  s_cselect_b32 s65, 0, s65
  s_cselect_b32 s66, s67, s68
  v_mfma_f32_16x16x32_bf16 v[100:103], a[148:151], a[80:83], v[100:103]
  s_add_u32 s0, s0, s72
  v_add_u32 v16, s66, v16
  v_add_u32 v17, s66, v17
  v_mfma_f32_16x16x32_bf16 v[116:119], a[132:135], a[68:71], v[116:119]
  s_add_u32 s1, s1, 8
  v_add_u32 v18, s66, v18
  v_add_u32 v19, s66, v19
  v_mfma_f32_16x16x32_bf16 v[116:119], a[148:151], a[84:87], v[116:119]
  s_and_b32 s1, s1, 0x8001f
  s_cmp_ge_u32 s0, 28
  s_cselect_b32 s72, 28, 0
  v_mfma_f32_16x16x32_bf16 v[132:135], a[132:135], a[72:75], v[132:135]
  s_sub_u32 s0, s0, s72
  s_lshl_b32 s72, s0, 14
  s_add_u32 s70, s92, s72
  v_mfma_f32_16x16x32_bf16 v[132:135], a[148:151], a[88:91], v[132:135]
  s_waitcnt vmcnt(16) lgkmcnt(0)
  s_barrier
  v_add_u32 v20, s66, v20
  v_add_u32 v21, s66, v21
  v_mfma_f32_16x16x32_bf16 v[148:151], a[132:135], a[76:79], v[148:151]
  s_sub_u32 s69, s69, 1
  v_mfma_f32_16x16x32_bf16 v[148:151], a[148:151], a[92:95], v[148:151]
  s_cmp_lg_u32 s69, 0
  s_cbranch_scc1 Lp7_loop
  s_mov_b32 s20, s82
  s_mov_b32 s21, s83
  s_mov_b32 s22, 8388608
  s_mov_b32 s23, 0x00020000
  v_bfe_u32 v25, v1, 4, 1
  v_lshrrev_b32 v26, 5, v1
  v_lshl_or_b32 v25, v25, 1, v26
  v_lshlrev_b32 v25, 4, v25
  v_and_b32 v24, 15, v1
  v_lshl_add_u32 v26, v24, 14, v25
  v_lshl_add_u32 v27, v24, 12, v25
  v_mfma_f32_16x16x32_bf16 v[104:107], a[136:139], a[64:67], v[104:107]
  s_lshl_b32 s6, s78, 1
  s_add_u32 s6, s6, s77
  s_lshl_b32 s6, s6, 2
  v_mfma_f32_16x16x32_bf16 v[104:107], a[152:155], a[80:83], v[104:107]
  s_add_u32 s6, s6, s3
  s_lshl_b32 s6, s6, 14
  s_add_u32 s6, s6, 8192
  v_mfma_f32_16x16x32_bf16 v[120:123], a[136:139], a[68:71], v[120:123]
  s_add_u32 s7, s6, 4096
  ds_read_b128 a[96:99], v16 offset:0
  ds_read_b128 a[112:115], v16 offset:8192
  v_mfma_f32_16x16x32_bf16 v[120:123], a[152:155], a[84:87], v[120:123]
  buffer_load_dwordx4 v[160:163], v2, s[16:19], s6 offen offset:0 sc1
  v_mfma_f32_16x16x32_bf16 v[136:139], a[136:139], a[72:75], v[136:139]
  buffer_load_dwordx4 v[164:167], v2, s[16:19], s6 offen offset:1024 sc1
  v_mfma_f32_16x16x32_bf16 v[136:139], a[152:155], a[88:91], v[136:139]
  buffer_load_dwordx4 v[168:171], v2, s[16:19], s6 offen offset:2048 sc1
  v_mfma_f32_16x16x32_bf16 v[152:155], a[136:139], a[76:79], v[152:155]
  buffer_load_dwordx4 v[172:175], v2, s[16:19], s6 offen offset:3072 sc1
  v_mfma_f32_16x16x32_bf16 v[152:155], a[152:155], a[92:95], v[152:155]
  buffer_load_dwordx4 v[176:179], v2, s[16:19], s7 offen offset:0 sc1
  v_mfma_f32_16x16x32_bf16 v[108:111], a[140:143], a[64:67], v[108:111]
  ds_read_b64_tr_b16 a[128:129], v18 offset:16384
  ds_read_b64_tr_b16 a[130:131], v18 offset:18432
  v_mfma_f32_16x16x32_bf16 v[108:111], a[156:159], a[80:83], v[108:111]
  buffer_load_dwordx4 v[180:183], v2, s[16:19], s7 offen offset:1024 sc1
  v_mfma_f32_16x16x32_bf16 v[124:127], a[140:143], a[68:71], v[124:127]
  ds_read_b64_tr_b16 a[144:145], v18 offset:20480
  ds_read_b64_tr_b16 a[146:147], v18 offset:22528
  v_mfma_f32_16x16x32_bf16 v[124:127], a[156:159], a[84:87], v[124:127]
  buffer_load_dwordx4 v[184:187], v2, s[16:19], s7 offen offset:2048 sc1
  v_mfma_f32_16x16x32_bf16 v[140:143], a[140:143], a[72:75], v[140:143]
  ds_read_b128 a[100:103], v16 offset:1024
  ds_read_b128 a[116:119], v16 offset:9216
  v_mfma_f32_16x16x32_bf16 v[140:143], a[156:159], a[88:91], v[140:143]
  buffer_load_dwordx4 v[188:191], v2, s[16:19], s7 offen offset:3072 sc1
  v_mfma_f32_16x16x32_bf16 v[156:159], a[140:143], a[76:79], v[156:159]
  s_lshl_b32 s32, s73, 19
  ds_read_b128 a[104:107], v17 offset:0
  ds_read_b128 a[120:123], v17 offset:8192
  v_mfma_f32_16x16x32_bf16 v[156:159], a[156:159], a[92:95], v[156:159]
  s_lshl_b32 s72, s76, 8
  s_add_u32 s32, s32, s72
  s_and_b32 s72, s3, 1
  s_lshl_b32 s72, s72, 7
  s_add_u32 s32, s32, s72
  s_lshr_b32 s72, s3, 1
  s_lshl_b32 s72, s72, 1
  s_add_u32 s72, s72, s77
  s_lshl_b32 s72, s72, 17
  s_add_u32 s32, s32, s72
  s_add_u32 s32, s32, 2048
  s_add_u32 s33, s32, 65536
  s_lshl_b32 s34, s73, 19
  s_lshl_b32 s72, s76, 8
  s_add_u32 s34, s34, s72
  s_and_b32 s72, s3, 1
  s_lshl_b32 s72, s72, 7
  s_add_u32 s34, s34, s72
  s_lshr_b32 s72, s3, 1
  s_lshl_b32 s72, s72, 1
  s_add_u32 s72, s72, s77
  s_lshl_b32 s72, s72, 12
  s_add_u32 s34, s34, s72
  s_add_u32 s35, s34, 262144
  ds_read_b128 a[108:111], v17 offset:1024
  ds_read_b128 a[124:127], v17 offset:9216
  ds_read_b64_tr_b16 a[132:133], v19 offset:16384
  ds_read_b64_tr_b16 a[134:135], v19 offset:18432
  ds_read_b64_tr_b16 a[148:149], v19 offset:20480
  ds_read_b64_tr_b16 a[150:151], v19 offset:22528
  s_waitcnt lgkmcnt(0)
  v_mfma_f32_16x16x32_bf16 v[96:99], a[128:131], a[96:99], v[96:99]
  s_add_u32 m0, s64, 16384
  ds_read_b64_tr_b16 a[136:137], v20 offset:16384
  ds_read_b64_tr_b16 a[138:139], v20 offset:18432
  v_mfma_f32_16x16x32_bf16 v[96:99], a[144:147], a[112:115], v[96:99]
  buffer_load_dwordx4 v10, s[12:15], s71 offen offset:0 lds
  v_mfma_f32_16x16x32_bf16 v[112:115], a[128:131], a[100:103], v[112:115]
  buffer_load_dwordx4 v11, s[12:15], s71 offen offset:1024 lds
  v_mfma_f32_16x16x32_bf16 v[112:115], a[144:147], a[116:119], v[112:115]
  buffer_load_dwordx4 v12, s[12:15], s71 offen offset:2048 lds
  v_mfma_f32_16x16x32_bf16 v[128:131], a[128:131], a[104:107], v[128:131]
  buffer_load_dwordx4 v13, s[12:15], s71 offen offset:3072 lds
  v_mfma_f32_16x16x32_bf16 v[128:131], a[144:147], a[120:123], v[128:131]
  s_bfe_u32 s72, 0x302011a, s31
  s_add_u32 s30, s30, s72
  s_add_u32 s31, s31, 8
  v_mfma_f32_16x16x32_bf16 v[144:147], a[128:131], a[108:111], v[144:147]
  s_and_b32 s31, s31, 0x8001f
  s_cmp_ge_u32 s30, 28
  s_cselect_b32 s72, 28, 0
  v_mfma_f32_16x16x32_bf16 v[144:147], a[144:147], a[124:127], v[144:147]
  s_sub_u32 s30, s30, s72
  s_lshl_b32 s72, s30, 17
  s_add_u32 s71, s93, s72
  v_mfma_f32_16x16x32_bf16 v[100:103], a[132:135], a[96:99], v[100:103]
  s_mov_b32 m0, s64
  ds_read_b64_tr_b16 a[152:153], v20 offset:20480
  ds_read_b64_tr_b16 a[154:155], v20 offset:22528
  v_mfma_f32_16x16x32_bf16 v[100:103], a[148:151], a[112:115], v[100:103]
  buffer_load_dwordx4 v2, s[8:11], s70 offen offset:0 sc1 lds
  s_add_u32 s64, s64, s66
  s_add_u32 s65, s65, 1
  s_cmp_eq_u32 s65, 4
  s_cselect_b32 s65, 0, s65
  s_cselect_b32 s66, s67, s68
  v_mfma_f32_16x16x32_bf16 v[116:119], a[132:135], a[100:103], v[116:119]
  buffer_load_dwordx4 v2, s[8:11], s70 offen offset:1024 sc1 lds
  v_mfma_f32_16x16x32_bf16 v[116:119], a[148:151], a[116:119], v[116:119]
  buffer_load_dwordx4 v2, s[8:11], s70 offen offset:2048 sc1 lds
  v_mfma_f32_16x16x32_bf16 v[132:135], a[132:135], a[104:107], v[132:135]
  buffer_load_dwordx4 v2, s[8:11], s70 offen offset:3072 sc1 lds
  v_mfma_f32_16x16x32_bf16 v[132:135], a[148:151], a[120:123], v[132:135]
  s_bfe_u32 s72, 0x302011a, s1
  ds_read_b64_tr_b16 a[140:141], v21 offset:16384
  ds_read_b64_tr_b16 a[142:143], v21 offset:18432
  v_mfma_f32_16x16x32_bf16 v[148:151], a[132:135], a[108:111], v[148:151]
  s_add_u32 s0, s0, s72
  ds_read_b64_tr_b16 a[156:157], v21 offset:20480
  ds_read_b64_tr_b16 a[158:159], v21 offset:22528
  v_mfma_f32_16x16x32_bf16 v[148:151], a[148:151], a[124:127], v[148:151]
  s_add_u32 s1, s1, 8
  s_and_b32 s1, s1, 0x8001f
  s_cmp_ge_u32 s0, 28
  s_cselect_b32 s72, 28, 0
  s_sub_u32 s0, s0, s72
  s_lshl_b32 s72, s0, 14
  s_add_u32 s70, s92, s72
  v_add_u32 v16, s66, v16
  v_add_u32 v17, s66, v17
  v_add_u32 v18, s66, v18
  v_add_u32 v19, s66, v19
  v_add_u32 v20, s66, v20
  v_add_u32 v21, s66, v21
  s_waitcnt vmcnt(24) lgkmcnt(0)
  s_barrier
  v_mfma_f32_16x16x32_bf16 v[104:107], a[136:139], a[96:99], v[104:107]
  s_add_u32 s70, s92, 458752
  s_add_u32 s71, s93, 3670016
  s_add_u32 m0, s64, 16384
  v_mfma_f32_16x16x32_bf16 v[104:107], a[152:155], a[112:115], v[104:107]
  buffer_load_dwordx4 v10, s[12:15], s71 offen offset:0 lds
  v_mfma_f32_16x16x32_bf16 v[120:123], a[136:139], a[100:103], v[120:123]
  ds_read_b128 a[64:67], v16 offset:0
  ds_read_b128 a[80:83], v16 offset:8192
  v_mfma_f32_16x16x32_bf16 v[120:123], a[152:155], a[116:119], v[120:123]
  buffer_load_dwordx4 v11, s[12:15], s71 offen offset:1024 lds
  v_mfma_f32_16x16x32_bf16 v[136:139], a[136:139], a[104:107], v[136:139]
  ds_read_b64_tr_b16 a[128:129], v18 offset:16384
  ds_read_b64_tr_b16 a[130:131], v18 offset:18432
  v_mfma_f32_16x16x32_bf16 v[136:139], a[152:155], a[120:123], v[136:139]
  ds_read_b64_tr_b16 a[144:145], v18 offset:20480
  ds_read_b64_tr_b16 a[146:147], v18 offset:22528
  v_mfma_f32_16x16x32_bf16 v[152:155], a[136:139], a[108:111], v[152:155]
  ds_read_b128 a[68:71], v16 offset:1024
  ds_read_b128 a[84:87], v16 offset:9216
  v_mfma_f32_16x16x32_bf16 v[152:155], a[152:155], a[124:127], v[152:155]
  buffer_load_dwordx4 v12, s[12:15], s71 offen offset:2048 lds
  v_mfma_f32_16x16x32_bf16 v[108:111], a[140:143], a[96:99], v[108:111]
  ds_read_b128 a[72:75], v17 offset:0
  ds_read_b128 a[88:91], v17 offset:8192
  v_mfma_f32_16x16x32_bf16 v[108:111], a[156:159], a[112:115], v[108:111]
  ds_read_b128 a[76:79], v17 offset:1024
  ds_read_b128 a[92:95], v17 offset:9216
  v_mfma_f32_16x16x32_bf16 v[124:127], a[140:143], a[100:103], v[124:127]
  ds_read_b64_tr_b16 a[132:133], v19 offset:16384
  ds_read_b64_tr_b16 a[134:135], v19 offset:18432
  v_mfma_f32_16x16x32_bf16 v[124:127], a[156:159], a[116:119], v[124:127]
  buffer_load_dwordx4 v13, s[12:15], s71 offen offset:3072 lds
  v_mfma_f32_16x16x32_bf16 v[140:143], a[140:143], a[104:107], v[140:143]
  s_add_u32 s71, s71, 131072
  ds_read_b64_tr_b16 a[148:149], v19 offset:20480
  ds_read_b64_tr_b16 a[150:151], v19 offset:22528
  v_mfma_f32_16x16x32_bf16 v[140:143], a[156:159], a[120:123], v[140:143]
  v_mfma_f32_16x16x32_bf16 v[156:159], a[140:143], a[108:111], v[156:159]
  v_mfma_f32_16x16x32_bf16 v[156:159], a[156:159], a[124:127], v[156:159]
  s_waitcnt lgkmcnt(0)
  v_mfma_f32_16x16x32_bf16 v[96:99], a[128:131], a[64:67], v[96:99]
  s_mov_b32 m0, s64
  ds_read_b64_tr_b16 a[136:137], v20 offset:16384
  ds_read_b64_tr_b16 a[138:139], v20 offset:18432
  v_mfma_f32_16x16x32_bf16 v[96:99], a[144:147], a[80:83], v[96:99]
  buffer_load_dwordx4 v2, s[8:11], s70 offen offset:0 sc1 lds
  v_mfma_f32_16x16x32_bf16 v[112:115], a[128:131], a[68:71], v[112:115]
  buffer_load_dwordx4 v2, s[8:11], s70 offen offset:1024 sc1 lds
  v_mfma_f32_16x16x32_bf16 v[112:115], a[144:147], a[84:87], v[112:115]
  s_add_u32 s64, s64, s66
  ds_read_b64_tr_b16 a[152:153], v20 offset:20480
  ds_read_b64_tr_b16 a[154:155], v20 offset:22528
  v_mfma_f32_16x16x32_bf16 v[128:131], a[128:131], a[72:75], v[128:131]
  buffer_load_dwordx4 v2, s[8:11], s70 offen offset:2048 sc1 lds
  v_mfma_f32_16x16x32_bf16 v[128:131], a[144:147], a[88:91], v[128:131]
  s_add_u32 s65, s65, 1
  ds_read_b64_tr_b16 a[140:141], v21 offset:16384
  ds_read_b64_tr_b16 a[142:143], v21 offset:18432
  v_mfma_f32_16x16x32_bf16 v[144:147], a[128:131], a[76:79], v[144:147]
  buffer_load_dwordx4 v2, s[8:11], s70 offen offset:3072 sc1 lds
  v_mfma_f32_16x16x32_bf16 v[144:147], a[144:147], a[92:95], v[144:147]
  s_add_u32 s70, s70, 16384
  ds_read_b64_tr_b16 a[156:157], v21 offset:20480
  ds_read_b64_tr_b16 a[158:159], v21 offset:22528
  v_mfma_f32_16x16x32_bf16 v[100:103], a[132:135], a[64:67], v[100:103]
  s_cmp_eq_u32 s65, 4
  s_cselect_b32 s65, 0, s65
  s_cselect_b32 s66, s67, s68
  v_mfma_f32_16x16x32_bf16 v[100:103], a[148:151], a[80:83], v[100:103]
  v_add_u32 v16, s66, v16
  v_add_u32 v17, s66, v17
  v_mfma_f32_16x16x32_bf16 v[116:119], a[132:135], a[68:71], v[116:119]
  v_add_u32 v18, s66, v18
  v_add_u32 v19, s66, v19
  v_mfma_f32_16x16x32_bf16 v[116:119], a[148:151], a[84:87], v[116:119]
  v_add_u32 v20, s66, v20
  v_add_u32 v21, s66, v21
  v_mfma_f32_16x16x32_bf16 v[132:135], a[132:135], a[72:75], v[132:135]
  v_mfma_f32_16x16x32_bf16 v[132:135], a[148:151], a[88:91], v[132:135]
  v_mfma_f32_16x16x32_bf16 v[148:151], a[132:135], a[76:79], v[148:151]
  v_mfma_f32_16x16x32_bf16 v[148:151], a[148:151], a[92:95], v[148:151]
  s_waitcnt vmcnt(16) lgkmcnt(0)
  s_barrier
  s_mov_b32 s72, 0x40000
Lrc_11:
  v_max3_u32 v4, v160, v161, v162
  v_max3_u32 v5, v168, v169, v170
  v_max3_u32 v6, v176, v177, v178
  v_max3_u32 v7, v184, v185, v186
  v_max3_u32 v4, v4, v163, v164
  v_max3_u32 v5, v5, v171, v172
  v_max3_u32 v6, v6, v179, v180
  v_max3_u32 v7, v7, v187, v188
  v_max3_u32 v4, v4, v165, v166
  v_max3_u32 v5, v5, v173, v174
  v_max3_u32 v6, v6, v181, v182
  v_max3_u32 v7, v7, v189, v190
  v_max_u32 v4, v4, v167
  v_max_u32 v5, v5, v175
  v_max_u32 v6, v6, v183
  v_max_u32 v7, v7, v191
  v_max3_u32 v4, v4, v5, v6
  v_max_u32 v4, v4, v7
  v_cmp_eq_u32 vcc, -1, v4
  s_nop 0
  s_cbranch_vccz Lpolld_12
  buffer_load_dwordx4 v[160:163], v2, s[16:19], s6 offen offset:0 sc1
  buffer_load_dwordx4 v[164:167], v2, s[16:19], s6 offen offset:1024 sc1
  buffer_load_dwordx4 v[168:171], v2, s[16:19], s6 offen offset:2048 sc1
  buffer_load_dwordx4 v[172:175], v2, s[16:19], s6 offen offset:3072 sc1
  buffer_load_dwordx4 v[176:179], v2, s[16:19], s7 offen offset:0 sc1
  buffer_load_dwordx4 v[180:183], v2, s[16:19], s7 offen offset:1024 sc1
  buffer_load_dwordx4 v[184:187], v2, s[16:19], s7 offen offset:2048 sc1
  buffer_load_dwordx4 v[188:191], v2, s[16:19], s7 offen offset:3072 sc1
  s_sub_u32 s72, s72, 1
  s_waitcnt vmcnt(0)
  s_cbranch_scc0 Lrc_11
Lpolld_12:
  v_mfma_f32_16x16x32_bf16 v[104:107], a[136:139], a[64:67], v[104:107]
  s_add_u32 m0, s64, 16384
  ds_read_b128 a[96:99], v16 offset:0
  ds_read_b128 a[112:115], v16 offset:8192
  v_mfma_f32_16x16x32_bf16 v[104:107], a[152:155], a[80:83], v[104:107]
  buffer_load_dwordx4 v10, s[12:15], s71 offen offset:0 lds
  v_mfma_f32_16x16x32_bf16 v[120:123], a[136:139], a[68:71], v[120:123]
  ds_read_b64_tr_b16 a[128:129], v18 offset:16384
  ds_read_b64_tr_b16 a[130:131], v18 offset:18432
  v_mfma_f32_16x16x32_bf16 v[120:123], a[152:155], a[84:87], v[120:123]
  buffer_load_dwordx4 v11, s[12:15], s71 offen offset:1024 lds
  v_mfma_f32_16x16x32_bf16 v[136:139], a[136:139], a[72:75], v[136:139]
  ds_read_b64_tr_b16 a[144:145], v18 offset:20480
  ds_read_b64_tr_b16 a[146:147], v18 offset:22528
  v_mfma_f32_16x16x32_bf16 v[136:139], a[152:155], a[88:91], v[136:139]
  ds_read_b128 a[100:103], v16 offset:1024
  ds_read_b128 a[116:119], v16 offset:9216
  v_mfma_f32_16x16x32_bf16 v[152:155], a[136:139], a[76:79], v[152:155]
  ds_read_b128 a[104:107], v17 offset:0
  ds_read_b128 a[120:123], v17 offset:8192
  v_mfma_f32_16x16x32_bf16 v[152:155], a[152:155], a[92:95], v[152:155]
  buffer_load_dwordx4 v12, s[12:15], s71 offen offset:2048 lds
  v_mfma_f32_16x16x32_bf16 v[108:111], a[140:143], a[64:67], v[108:111]
  ds_read_b128 a[108:111], v17 offset:1024
  ds_read_b128 a[124:127], v17 offset:9216
  v_mfma_f32_16x16x32_bf16 v[108:111], a[156:159], a[80:83], v[108:111]
  ds_read_b64_tr_b16 a[132:133], v19 offset:16384
  ds_read_b64_tr_b16 a[134:135], v19 offset:18432
  v_mfma_f32_16x16x32_bf16 v[124:127], a[140:143], a[68:71], v[124:127]
  ds_read_b64_tr_b16 a[148:149], v19 offset:20480
  ds_read_b64_tr_b16 a[150:151], v19 offset:22528
  v_mfma_f32_16x16x32_bf16 v[124:127], a[156:159], a[84:87], v[124:127]
  buffer_load_dwordx4 v13, s[12:15], s71 offen offset:3072 lds
  v_mfma_f32_16x16x32_bf16 v[140:143], a[140:143], a[72:75], v[140:143]
  s_add_u32 s71, s71, 131072
  v_pk_add_f32 v[160:161], v[160:161], v[32:33]
  v_pk_add_f32 v[162:163], v[162:163], v[34:35]
  v_mfma_f32_16x16x32_bf16 v[140:143], a[156:159], a[88:91], v[140:143]
  v_pk_add_f32 v[164:165], v[164:165], v[36:37]
  v_pk_add_f32 v[166:167], v[166:167], v[38:39]
  v_mfma_f32_16x16x32_bf16 v[156:159], a[140:143], a[76:79], v[156:159]
  v_cvt_pk_bf16_f32 v160, v160, v161
  v_cvt_pk_bf16_f32 v161, v162, v163
  v_mfma_f32_16x16x32_bf16 v[156:159], a[156:159], a[92:95], v[156:159]
  v_cvt_pk_bf16_f32 v162, v164, v165
  v_cvt_pk_bf16_f32 v163, v166, v167
  s_nop 0
  v_permlane16_swap_b32 v160, v162
  v_permlane16_swap_b32 v161, v163
  s_waitcnt lgkmcnt(0)
  v_mfma_f32_16x16x32_bf16 v[96:99], a[128:131], a[96:99], v[96:99]
  s_mov_b32 m0, s64
  ds_read_b64_tr_b16 a[136:137], v20 offset:16384
  ds_read_b64_tr_b16 a[138:139], v20 offset:18432
  v_mfma_f32_16x16x32_bf16 v[96:99], a[144:147], a[112:115], v[96:99]
  buffer_load_dwordx4 v2, s[8:11], s70 offen offset:0 sc1 lds
  v_mfma_f32_16x16x32_bf16 v[112:115], a[128:131], a[100:103], v[112:115]
  buffer_load_dwordx4 v2, s[8:11], s70 offen offset:1024 sc1 lds
  v_mfma_f32_16x16x32_bf16 v[112:115], a[144:147], a[116:119], v[112:115]
  s_add_u32 s64, s64, s66
  ds_read_b64_tr_b16 a[152:153], v20 offset:20480
  ds_read_b64_tr_b16 a[154:155], v20 offset:22528
  v_mfma_f32_16x16x32_bf16 v[128:131], a[128:131], a[104:107], v[128:131]
  buffer_load_dwordx4 v2, s[8:11], s70 offen offset:2048 sc1 lds
  v_mfma_f32_16x16x32_bf16 v[128:131], a[144:147], a[120:123], v[128:131]
  s_add_u32 s65, s65, 1
  ds_read_b64_tr_b16 a[140:141], v21 offset:16384
  ds_read_b64_tr_b16 a[142:143], v21 offset:18432
  v_mfma_f32_16x16x32_bf16 v[144:147], a[128:131], a[108:111], v[144:147]
  buffer_load_dwordx4 v2, s[8:11], s70 offen offset:3072 sc1 lds
  v_mfma_f32_16x16x32_bf16 v[144:147], a[144:147], a[124:127], v[144:147]
  s_add_u32 s70, s70, 16384
  ds_read_b64_tr_b16 a[156:157], v21 offset:20480
  ds_read_b64_tr_b16 a[158:159], v21 offset:22528
  v_mfma_f32_16x16x32_bf16 v[100:103], a[132:135], a[96:99], v[100:103]
  s_cmp_eq_u32 s65, 4
  s_cselect_b32 s65, 0, s65
  s_cselect_b32 s66, s67, s68
  v_mfma_f32_16x16x32_bf16 v[100:103], a[148:151], a[112:115], v[100:103]
  v_add_u32 v16, s66, v16
  v_add_u32 v17, s66, v17
  v_mfma_f32_16x16x32_bf16 v[116:119], a[132:135], a[100:103], v[116:119]
  v_add_u32 v18, s66, v18
  v_add_u32 v19, s66, v19
  v_mfma_f32_16x16x32_bf16 v[116:119], a[148:151], a[116:119], v[116:119]
  v_add_u32 v20, s66, v20
  v_add_u32 v21, s66, v21
  v_mfma_f32_16x16x32_bf16 v[132:135], a[132:135], a[104:107], v[132:135]
  v_mfma_f32_16x16x32_bf16 v[132:135], a[148:151], a[120:123], v[132:135]
  v_mfma_f32_16x16x32_bf16 v[148:151], a[132:135], a[108:111], v[148:151]
  v_mfma_f32_16x16x32_bf16 v[148:151], a[148:151], a[124:127], v[148:151]
  buffer_store_dwordx4 v[160:163], v27, s[20:23], s32 offen offset:0
  s_waitcnt vmcnt(17) lgkmcnt(0)
  s_barrier
  v_mfma_f32_16x16x32_bf16 v[104:107], a[136:139], a[96:99], v[104:107]
  s_and_b32 s88, s3, 1
  s_lshl_b32 s88, s88, 12
  s_lshr_b32 s72, s3, 1
  v_mfma_f32_16x16x32_bf16 v[104:107], a[152:155], a[112:115], v[104:107]
  s_lshl_b32 s72, s72, 13
  s_add_u32 s88, s88, s72
  s_lshl_b32 s72, s77, 11
  v_mfma_f32_16x16x32_bf16 v[120:123], a[136:139], a[100:103], v[120:123]
  s_add_u32 s88, s88, s72
  s_sub_u32 s88, s88, s79
  s_add_u32 s70, s92, s88
  v_mfma_f32_16x16x32_bf16 v[120:123], a[152:155], a[116:119], v[120:123]
  s_add_u32 s70, s70, 491520
  s_add_u32 s71, s93, 3932160
  s_add_u32 m0, s64, 16384
  v_mfma_f32_16x16x32_bf16 v[136:139], a[136:139], a[104:107], v[136:139]
  buffer_load_dwordx4 v10, s[12:15], s71 offen offset:0 lds
  v_mfma_f32_16x16x32_bf16 v[136:139], a[152:155], a[120:123], v[136:139]
  buffer_load_dwordx4 v11, s[12:15], s71 offen offset:1024 lds
  v_mfma_f32_16x16x32_bf16 v[152:155], a[136:139], a[108:111], v[152:155]
  ds_read_b128 a[64:67], v16 offset:0
  ds_read_b128 a[80:83], v16 offset:8192
  v_mfma_f32_16x16x32_bf16 v[152:155], a[152:155], a[124:127], v[152:155]
  ds_read_b64_tr_b16 a[128:129], v18 offset:16384
  ds_read_b64_tr_b16 a[130:131], v18 offset:18432
  v_mfma_f32_16x16x32_bf16 v[108:111], a[140:143], a[96:99], v[108:111]
  ds_read_b64_tr_b16 a[144:145], v18 offset:20480
  ds_read_b64_tr_b16 a[146:147], v18 offset:22528
  v_mfma_f32_16x16x32_bf16 v[108:111], a[156:159], a[112:115], v[108:111]
  ds_read_b128 a[68:71], v16 offset:1024
  ds_read_b128 a[84:87], v16 offset:9216
  v_mfma_f32_16x16x32_bf16 v[124:127], a[140:143], a[100:103], v[124:127]
  buffer_load_dwordx4 v12, s[12:15], s71 offen offset:2048 lds
  v_mfma_f32_16x16x32_bf16 v[124:127], a[156:159], a[116:119], v[124:127]
  ds_read_b128 a[72:75], v17 offset:0
  ds_read_b128 a[88:91], v17 offset:8192
  v_mfma_f32_16x16x32_bf16 v[140:143], a[140:143], a[104:107], v[140:143]
  ds_read_b128 a[76:79], v17 offset:1024
  ds_read_b128 a[92:95], v17 offset:9216
  v_mfma_f32_16x16x32_bf16 v[140:143], a[156:159], a[120:123], v[140:143]
  ds_read_b64_tr_b16 a[132:133], v19 offset:16384
  ds_read_b64_tr_b16 a[134:135], v19 offset:18432
  v_mfma_f32_16x16x32_bf16 v[156:159], a[140:143], a[108:111], v[156:159]
  ds_read_b64_tr_b16 a[148:149], v19 offset:20480
  ds_read_b64_tr_b16 a[150:151], v19 offset:22528
  v_mfma_f32_16x16x32_bf16 v[156:159], a[156:159], a[124:127], v[156:159]
  v_pk_add_f32 v[168:169], v[168:169], v[40:41]
  v_pk_add_f32 v[170:171], v[170:171], v[42:43]
  v_pk_add_f32 v[172:173], v[172:173], v[44:45]
  v_pk_add_f32 v[174:175], v[174:175], v[46:47]
  v_cvt_pk_bf16_f32 v168, v168, v169
  v_cvt_pk_bf16_f32 v169, v170, v171
  v_cvt_pk_bf16_f32 v170, v172, v173
  v_cvt_pk_bf16_f32 v171, v174, v175
  s_nop 0
  v_permlane16_swap_b32 v168, v170
  v_permlane16_swap_b32 v169, v171
  s_waitcnt lgkmcnt(0)
  v_mfma_f32_16x16x32_bf16 v[96:99], a[128:131], a[64:67], v[96:99]
  buffer_load_dwordx4 v13, s[12:15], s71 offen offset:3072 lds
  v_mfma_f32_16x16x32_bf16 v[96:99], a[144:147], a[80:83], v[96:99]
  s_add_u32 s71, s71, 131072
  s_add_u32 m0, s64, s88
  ds_read_b64_tr_b16 a[136:137], v20 offset:16384
  v_mfma_f32_16x16x32_bf16 v[112:115], a[128:131], a[68:71], v[112:115]
  s_add_u32 s64, s64, s66
  ds_read_b64_tr_b16 a[138:139], v20 offset:18432
  ds_read_b64_tr_b16 a[152:153], v20 offset:20480
  v_mfma_f32_16x16x32_bf16 v[112:115], a[144:147], a[84:87], v[112:115]
  buffer_load_dwordx4 v2, s[8:11], s70 offen offset:0 sc1 lds
  v_mfma_f32_16x16x32_bf16 v[128:131], a[128:131], a[72:75], v[128:131]
  s_add_u32 s65, s65, 1
  ds_read_b64_tr_b16 a[154:155], v20 offset:22528
  ds_read_b64_tr_b16 a[140:141], v21 offset:16384
  v_mfma_f32_16x16x32_bf16 v[128:131], a[144:147], a[88:91], v[128:131]
  ds_read_b64_tr_b16 a[142:143], v21 offset:18432
  ds_read_b64_tr_b16 a[156:157], v21 offset:20480
  v_mfma_f32_16x16x32_bf16 v[144:147], a[128:131], a[76:79], v[144:147]
  buffer_load_dwordx4 v2, s[8:11], s70 offen offset:1024 sc1 lds
  v_mfma_f32_16x16x32_bf16 v[144:147], a[144:147], a[92:95], v[144:147]
  s_add_u32 s70, s70, 16384
  ds_read_b64_tr_b16 a[158:159], v21 offset:22528
  v_mfma_f32_16x16x32_bf16 v[100:103], a[132:135], a[64:67], v[100:103]
  s_cmp_eq_u32 s65, 4
  s_cselect_b32 s65, 0, s65
  s_cselect_b32 s66, s67, s68
  v_mfma_f32_16x16x32_bf16 v[100:103], a[148:151], a[80:83], v[100:103]
  v_add_u32 v16, s66, v16
  v_add_u32 v17, s66, v17
  v_mfma_f32_16x16x32_bf16 v[116:119], a[132:135], a[68:71], v[116:119]
  v_add_u32 v18, s66, v18
  v_add_u32 v19, s66, v19
  v_mfma_f32_16x16x32_bf16 v[116:119], a[148:151], a[84:87], v[116:119]
  v_add_u32 v20, s66, v20
  v_add_u32 v21, s66, v21
  v_mfma_f32_16x16x32_bf16 v[132:135], a[132:135], a[72:75], v[132:135]
  v_mfma_f32_16x16x32_bf16 v[132:135], a[148:151], a[88:91], v[132:135]
  v_mfma_f32_16x16x32_bf16 v[148:151], a[132:135], a[76:79], v[148:151]
  v_mfma_f32_16x16x32_bf16 v[148:151], a[148:151], a[92:95], v[148:151]
  buffer_store_dwordx4 v[168:171], v27, s[20:23], s32 offen offset:64
  s_waitcnt vmcnt(16) lgkmcnt(0)
  s_barrier
  v_mfma_f32_16x16x32_bf16 v[104:107], a[136:139], a[64:67], v[104:107]
  s_add_u32 m0, s64, 16384
  ds_read_b128 a[96:99], v16 offset:0
  ds_read_b128 a[112:115], v16 offset:8192
  v_mfma_f32_16x16x32_bf16 v[104:107], a[152:155], a[80:83], v[104:107]
  buffer_load_dwordx4 v10, s[12:15], s71 offen offset:0 lds
  v_mfma_f32_16x16x32_bf16 v[120:123], a[136:139], a[68:71], v[120:123]
  ds_read_b64_tr_b16 a[128:129], v18 offset:16384
  ds_read_b64_tr_b16 a[130:131], v18 offset:18432
  v_mfma_f32_16x16x32_bf16 v[120:123], a[152:155], a[84:87], v[120:123]
  ds_read_b64_tr_b16 a[144:145], v18 offset:20480
  ds_read_b64_tr_b16 a[146:147], v18 offset:22528
  v_mfma_f32_16x16x32_bf16 v[136:139], a[136:139], a[72:75], v[136:139]
  ds_read_b128 a[100:103], v16 offset:1024
  ds_read_b128 a[116:119], v16 offset:9216
  v_mfma_f32_16x16x32_bf16 v[136:139], a[152:155], a[88:91], v[136:139]
  buffer_load_dwordx4 v11, s[12:15], s71 offen offset:1024 lds
  v_mfma_f32_16x16x32_bf16 v[152:155], a[136:139], a[76:79], v[152:155]
  ds_read_b128 a[104:107], v17 offset:0
  ds_read_b128 a[120:123], v17 offset:8192
  v_mfma_f32_16x16x32_bf16 v[152:155], a[152:155], a[92:95], v[152:155]
  ds_read_b128 a[108:111], v17 offset:1024
  ds_read_b128 a[124:127], v17 offset:9216
  v_mfma_f32_16x16x32_bf16 v[108:111], a[140:143], a[64:67], v[108:111]
  ds_read_b64_tr_b16 a[132:133], v19 offset:16384
  ds_read_b64_tr_b16 a[134:135], v19 offset:18432
  v_mfma_f32_16x16x32_bf16 v[108:111], a[156:159], a[80:83], v[108:111]
  ds_read_b64_tr_b16 a[148:149], v19 offset:20480
  ds_read_b64_tr_b16 a[150:151], v19 offset:22528
  v_mfma_f32_16x16x32_bf16 v[124:127], a[140:143], a[68:71], v[124:127]
  buffer_load_dwordx4 v12, s[12:15], s71 offen offset:2048 lds
  v_mfma_f32_16x16x32_bf16 v[124:127], a[156:159], a[84:87], v[124:127]
  v_pk_add_f32 v[176:177], v[176:177], v[48:49]
  v_pk_add_f32 v[178:179], v[178:179], v[50:51]
  v_mfma_f32_16x16x32_bf16 v[140:143], a[140:143], a[72:75], v[140:143]
  v_pk_add_f32 v[180:181], v[180:181], v[52:53]
  v_pk_add_f32 v[182:183], v[182:183], v[54:55]
  v_mfma_f32_16x16x32_bf16 v[140:143], a[156:159], a[88:91], v[140:143]
  v_cvt_pk_bf16_f32 v176, v176, v177
  v_cvt_pk_bf16_f32 v177, v178, v179
  v_mfma_f32_16x16x32_bf16 v[156:159], a[140:143], a[76:79], v[156:159]
  v_cvt_pk_bf16_f32 v178, v180, v181
  v_cvt_pk_bf16_f32 v179, v182, v183
  v_mfma_f32_16x16x32_bf16 v[156:159], a[156:159], a[92:95], v[156:159]
  v_permlane16_swap_b32 v176, v178
  v_permlane16_swap_b32 v177, v179
  s_waitcnt lgkmcnt(0)
  v_mfma_f32_16x16x32_bf16 v[96:99], a[128:131], a[96:99], v[96:99]
  buffer_load_dwordx4 v13, s[12:15], s71 offen offset:3072 lds
  v_mfma_f32_16x16x32_bf16 v[96:99], a[144:147], a[112:115], v[96:99]
  s_add_u32 s71, s71, 131072
  s_add_u32 m0, s64, s88
  ds_read_b64_tr_b16 a[136:137], v20 offset:16384
  v_mfma_f32_16x16x32_bf16 v[112:115], a[128:131], a[100:103], v[112:115]
  s_add_u32 s64, s64, s66
  ds_read_b64_tr_b16 a[138:139], v20 offset:18432
  ds_read_b64_tr_b16 a[152:153], v20 offset:20480
  v_mfma_f32_16x16x32_bf16 v[112:115], a[144:147], a[116:119], v[112:115]
  buffer_load_dwordx4 v2, s[8:11], s70 offen offset:0 sc1 lds
  v_mfma_f32_16x16x32_bf16 v[128:131], a[128:131], a[104:107], v[128:131]
  s_add_u32 s65, s65, 1
  ds_read_b64_tr_b16 a[154:155], v20 offset:22528
  ds_read_b64_tr_b16 a[140:141], v21 offset:16384
  v_mfma_f32_16x16x32_bf16 v[128:131], a[144:147], a[120:123], v[128:131]
  ds_read_b64_tr_b16 a[142:143], v21 offset:18432
  ds_read_b64_tr_b16 a[156:157], v21 offset:20480
  v_mfma_f32_16x16x32_bf16 v[144:147], a[128:131], a[108:111], v[144:147]
  buffer_load_dwordx4 v2, s[8:11], s70 offen offset:1024 sc1 lds
  v_mfma_f32_16x16x32_bf16 v[144:147], a[144:147], a[124:127], v[144:147]
  s_add_u32 s70, s70, 16384
  ds_read_b64_tr_b16 a[158:159], v21 offset:22528
  v_mfma_f32_16x16x32_bf16 v[100:103], a[132:135], a[96:99], v[100:103]
  s_cmp_eq_u32 s65, 4
  s_cselect_b32 s65, 0, s65
  s_cselect_b32 s66, s67, s68
  v_mfma_f32_16x16x32_bf16 v[100:103], a[148:151], a[112:115], v[100:103]
  v_add_u32 v16, s66, v16
  v_add_u32 v17, s66, v17
  v_mfma_f32_16x16x32_bf16 v[116:119], a[132:135], a[100:103], v[116:119]
  v_add_u32 v18, s66, v18
  v_add_u32 v19, s66, v19
  v_mfma_f32_16x16x32_bf16 v[116:119], a[148:151], a[116:119], v[116:119]
  v_add_u32 v20, s66, v20
  v_add_u32 v21, s66, v21
  v_mfma_f32_16x16x32_bf16 v[132:135], a[132:135], a[104:107], v[132:135]
  v_mfma_f32_16x16x32_bf16 v[132:135], a[148:151], a[120:123], v[132:135]
  v_mfma_f32_16x16x32_bf16 v[148:151], a[132:135], a[108:111], v[148:151]
  v_mfma_f32_16x16x32_bf16 v[148:151], a[148:151], a[124:127], v[148:151]
  buffer_store_dwordx4 v[176:179], v27, s[20:23], s33 offen offset:0
  s_waitcnt vmcnt(15) lgkmcnt(0)
  s_barrier
  v_mfma_f32_16x16x32_bf16 v[104:107], a[136:139], a[96:99], v[104:107]
  s_sub_u32 s70, s70, 32768
  s_xor_b32 s70, s70, 524288
  s_sub_u32 s71, s71, 262144
  v_mfma_f32_16x16x32_bf16 v[104:107], a[152:155], a[112:115], v[104:107]
  s_xor_b32 s71, s71, 4194304
  s_add_u32 m0, s64, 16384
  ds_read_b128 a[64:67], v16 offset:0
  v_mfma_f32_16x16x32_bf16 v[120:123], a[136:139], a[100:103], v[120:123]
  buffer_load_dwordx4 v10, s[12:15], s71 offen offset:0 lds
  v_mfma_f32_16x16x32_bf16 v[120:123], a[152:155], a[116:119], v[120:123]
  ds_read_b128 a[80:83], v16 offset:8192
  ds_read_b64_tr_b16 a[128:129], v18 offset:16384
  v_mfma_f32_16x16x32_bf16 v[136:139], a[136:139], a[104:107], v[136:139]
  ds_read_b64_tr_b16 a[130:131], v18 offset:18432
  ds_read_b64_tr_b16 a[144:145], v18 offset:20480
  v_mfma_f32_16x16x32_bf16 v[136:139], a[152:155], a[120:123], v[136:139]
  buffer_load_dwordx4 v11, s[12:15], s71 offen offset:1024 lds
  v_mfma_f32_16x16x32_bf16 v[152:155], a[136:139], a[108:111], v[152:155]
  ds_read_b64_tr_b16 a[146:147], v18 offset:22528
  ds_read_b128 a[68:71], v16 offset:1024
  v_mfma_f32_16x16x32_bf16 v[152:155], a[152:155], a[124:127], v[152:155]
  ds_read_b128 a[84:87], v16 offset:9216
  ds_read_b128 a[72:75], v17 offset:0
  v_mfma_f32_16x16x32_bf16 v[108:111], a[140:143], a[96:99], v[108:111]
  ds_read_b128 a[88:91], v17 offset:8192
  ds_read_b128 a[76:79], v17 offset:1024
  v_mfma_f32_16x16x32_bf16 v[108:111], a[156:159], a[112:115], v[108:111]
  ds_read_b128 a[92:95], v17 offset:9216
  ds_read_b64_tr_b16 a[132:133], v19 offset:16384
  v_mfma_f32_16x16x32_bf16 v[124:127], a[140:143], a[100:103], v[124:127]
  buffer_load_dwordx4 v12, s[12:15], s71 offen offset:2048 lds
  v_mfma_f32_16x16x32_bf16 v[124:127], a[156:159], a[116:119], v[124:127]
  ds_read_b64_tr_b16 a[134:135], v19 offset:18432
  ds_read_b64_tr_b16 a[148:149], v19 offset:20480
  v_mfma_f32_16x16x32_bf16 v[140:143], a[140:143], a[104:107], v[140:143]
  ds_read_b64_tr_b16 a[150:151], v19 offset:22528
  v_pk_add_f32 v[184:185], v[184:185], v[56:57]
  v_mfma_f32_16x16x32_bf16 v[140:143], a[156:159], a[120:123], v[140:143]
  v_pk_add_f32 v[186:187], v[186:187], v[58:59]
  v_pk_add_f32 v[188:189], v[188:189], v[60:61]
  v_mfma_f32_16x16x32_bf16 v[156:159], a[140:143], a[108:111], v[156:159]
  v_pk_add_f32 v[190:191], v[190:191], v[62:63]
  v_cvt_pk_bf16_f32 v184, v184, v185
  v_mfma_f32_16x16x32_bf16 v[156:159], a[156:159], a[124:127], v[156:159]
  v_cvt_pk_bf16_f32 v185, v186, v187
  v_cvt_pk_bf16_f32 v186, v188, v189
  v_cvt_pk_bf16_f32 v187, v190, v191
  s_nop 0
  v_permlane16_swap_b32 v184, v186
  v_permlane16_swap_b32 v185, v187
  s_waitcnt lgkmcnt(0)
  v_mfma_f32_16x16x32_bf16 v[96:99], a[128:131], a[64:67], v[96:99]
  buffer_load_dwordx4 v13, s[12:15], s71 offen offset:3072 lds
  v_mfma_f32_16x16x32_bf16 v[96:99], a[144:147], a[80:83], v[96:99]
  s_add_u32 s71, s71, 131072
  s_add_u32 m0, s64, s88
  ds_read_b64_tr_b16 a[136:137], v20 offset:16384
  v_mfma_f32_16x16x32_bf16 v[112:115], a[128:131], a[68:71], v[112:115]
  s_add_u32 s64, s64, s66
  ds_read_b64_tr_b16 a[138:139], v20 offset:18432
  ds_read_b64_tr_b16 a[152:153], v20 offset:20480
  v_mfma_f32_16x16x32_bf16 v[112:115], a[144:147], a[84:87], v[112:115]
  buffer_load_dwordx4 v2, s[8:11], s70 offen offset:0 sc1 lds
  v_mfma_f32_16x16x32_bf16 v[128:131], a[128:131], a[72:75], v[128:131]
  s_add_u32 s65, s65, 1
  ds_read_b64_tr_b16 a[154:155], v20 offset:22528
  ds_read_b64_tr_b16 a[140:141], v21 offset:16384
  v_mfma_f32_16x16x32_bf16 v[128:131], a[144:147], a[88:91], v[128:131]
  ds_read_b64_tr_b16 a[142:143], v21 offset:18432
  ds_read_b64_tr_b16 a[156:157], v21 offset:20480
  v_mfma_f32_16x16x32_bf16 v[144:147], a[128:131], a[76:79], v[144:147]
  buffer_load_dwordx4 v2, s[8:11], s70 offen offset:1024 sc1 lds
  v_mfma_f32_16x16x32_bf16 v[144:147], a[144:147], a[92:95], v[144:147]
  s_add_u32 s70, s70, 16384
  ds_read_b64_tr_b16 a[158:159], v21 offset:22528
  v_mfma_f32_16x16x32_bf16 v[100:103], a[132:135], a[64:67], v[100:103]
  s_cmp_eq_u32 s65, 4
  s_cselect_b32 s65, 0, s65
  s_cselect_b32 s66, s67, s68
  v_mfma_f32_16x16x32_bf16 v[100:103], a[148:151], a[80:83], v[100:103]
  v_add_u32 v16, s66, v16
  v_add_u32 v17, s66, v17
  v_mfma_f32_16x16x32_bf16 v[116:119], a[132:135], a[68:71], v[116:119]
  v_add_u32 v18, s66, v18
  v_add_u32 v19, s66, v19
  v_mfma_f32_16x16x32_bf16 v[116:119], a[148:151], a[84:87], v[116:119]
  v_add_u32 v20, s66, v20
  v_add_u32 v21, s66, v21
  v_mfma_f32_16x16x32_bf16 v[132:135], a[132:135], a[72:75], v[132:135]
  v_mfma_f32_16x16x32_bf16 v[132:135], a[148:151], a[88:91], v[132:135]
  v_mfma_f32_16x16x32_bf16 v[148:151], a[132:135], a[76:79], v[148:151]
  v_mfma_f32_16x16x32_bf16 v[148:151], a[148:151], a[92:95], v[148:151]
  buffer_store_dwordx4 v[184:187], v27, s[20:23], s33 offen offset:64
  s_waitcnt vmcnt(15) lgkmcnt(0)
  s_barrier
  v_mfma_f32_16x16x32_bf16 v[104:107], a[136:139], a[64:67], v[104:107]
  s_add_u32 m0, s64, 16384
  ds_read_b128 a[96:99], v16 offset:0
  ds_read_b128 a[112:115], v16 offset:8192
  v_mfma_f32_16x16x32_bf16 v[104:107], a[152:155], a[80:83], v[104:107]
  buffer_load_dwordx4 v10, s[12:15], s71 offen offset:0 lds
  v_mfma_f32_16x16x32_bf16 v[120:123], a[136:139], a[68:71], v[120:123]
  buffer_load_dwordx4 v11, s[12:15], s71 offen offset:1024 lds
  v_mfma_f32_16x16x32_bf16 v[120:123], a[152:155], a[84:87], v[120:123]
  ds_read_b64_tr_b16 a[128:129], v18 offset:16384
  ds_read_b64_tr_b16 a[130:131], v18 offset:18432
  v_mfma_f32_16x16x32_bf16 v[136:139], a[136:139], a[72:75], v[136:139]
  ds_read_b64_tr_b16 a[144:145], v18 offset:20480
  ds_read_b64_tr_b16 a[146:147], v18 offset:22528
  v_mfma_f32_16x16x32_bf16 v[136:139], a[152:155], a[88:91], v[136:139]
  buffer_load_dwordx4 v12, s[12:15], s71 offen offset:2048 lds
  v_mfma_f32_16x16x32_bf16 v[152:155], a[136:139], a[76:79], v[152:155]
  ds_read_b128 a[100:103], v16 offset:1024
  ds_read_b128 a[116:119], v16 offset:9216
  v_mfma_f32_16x16x32_bf16 v[152:155], a[152:155], a[92:95], v[152:155]
  buffer_load_dwordx4 v13, s[12:15], s71 offen offset:3072 lds
  v_mfma_f32_16x16x32_bf16 v[108:111], a[140:143], a[64:67], v[108:111]
  s_add_u32 s71, s71, 131072
  s_add_u32 m0, s64, s88
  ds_read_b64_tr_b16 a[132:133], v19 offset:16384
  v_mfma_f32_16x16x32_bf16 v[108:111], a[156:159], a[80:83], v[108:111]
  ds_read_b64_tr_b16 a[134:135], v19 offset:18432
  ds_read_b64_tr_b16 a[148:149], v19 offset:20480
  v_mfma_f32_16x16x32_bf16 v[124:127], a[140:143], a[68:71], v[124:127]
  buffer_load_dwordx4 v2, s[8:11], s70 offen offset:0 sc1 lds
  v_mfma_f32_16x16x32_bf16 v[124:127], a[156:159], a[84:87], v[124:127]
  ds_read_b64_tr_b16 a[150:151], v19 offset:22528
  v_mfma_f32_16x16x32_bf16 v[140:143], a[140:143], a[72:75], v[140:143]
  buffer_load_dwordx4 v2, s[8:11], s70 offen offset:1024 sc1 lds
  v_mfma_f32_16x16x32_bf16 v[140:143], a[156:159], a[88:91], v[140:143]
  s_add_u32 s70, s70, 16384
  s_lshl_b32 s36, s78, 1
  v_mfma_f32_16x16x32_bf16 v[156:159], a[140:143], a[76:79], v[156:159]
  s_add_u32 s36, s36, s77
  s_xor_b32 s36, s36, 1
  s_lshl_b32 s36, s36, 2
  v_mfma_f32_16x16x32_bf16 v[156:159], a[156:159], a[92:95], v[156:159]
  s_add_u32 s36, s36, s3
  s_lshl_b32 s36, s36, 14
  s_add_u32 s37, s36, 4096
  s_waitcnt lgkmcnt(0)
  v_mfma_f32_16x16x32_bf16 v[96:99], a[128:131], a[96:99], v[96:99]
  buffer_store_dwordx4 v[128:131], v2, s[16:19], s36 offen offset:0 sc1
  ds_read_b64_tr_b16 a[136:137], v20 offset:16384
  s_add_u32 s64, s64, s66
  s_add_u32 s65, s65, 1
  s_cmp_eq_u32 s65, 4
  s_cselect_b32 s65, 0, s65
  s_cselect_b32 s66, s67, s68
  v_mfma_f32_16x16x32_bf16 v[96:99], a[144:147], a[112:115], v[96:99]
  buffer_store_dwordx4 v[132:135], v2, s[16:19], s36 offen offset:1024 sc1
  ds_read_b64_tr_b16 a[138:139], v20 offset:18432
  v_mfma_f32_16x16x32_bf16 v[112:115], a[128:131], a[100:103], v[112:115]
  buffer_store_dwordx4 v[136:139], v2, s[16:19], s36 offen offset:2048 sc1
  ds_read_b64_tr_b16 a[152:153], v20 offset:20480
  v_mfma_f32_16x16x32_bf16 v[112:115], a[144:147], a[116:119], v[112:115]
  buffer_store_dwordx4 v[140:143], v2, s[16:19], s36 offen offset:3072 sc1
  ds_read_b64_tr_b16 a[154:155], v20 offset:22528
  v_mfma_f32_16x16x32_bf16 v[100:103], a[132:135], a[96:99], v[100:103]
  buffer_store_dwordx4 v[144:147], v2, s[16:19], s37 offen offset:0 sc1
  ds_read_b64_tr_b16 a[140:141], v21 offset:16384
  v_mfma_f32_16x16x32_bf16 v[100:103], a[148:151], a[112:115], v[100:103]
  buffer_store_dwordx4 v[148:151], v2, s[16:19], s37 offen offset:1024 sc1
  ds_read_b64_tr_b16 a[142:143], v21 offset:18432
  v_mfma_f32_16x16x32_bf16 v[116:119], a[132:135], a[100:103], v[116:119]
  buffer_store_dwordx4 v[152:155], v2, s[16:19], s37 offen offset:2048 sc1
  ds_read_b64_tr_b16 a[156:157], v21 offset:20480
  v_mfma_f32_16x16x32_bf16 v[116:119], a[148:151], a[116:119], v[116:119]
  buffer_store_dwordx4 v[156:159], v2, s[16:19], s37 offen offset:3072 sc1
  ds_read_b64_tr_b16 a[158:159], v21 offset:22528
  v_add_u32 v16, s66, v16
  v_add_u32 v17, s66, v17
  v_add_u32 v18, s66, v18
  v_add_u32 v19, s66, v19
  v_add_u32 v20, s66, v20
  v_add_u32 v21, s66, v21
  s_waitcnt vmcnt(22) lgkmcnt(0)
  s_barrier
  v_mfma_f32_16x16x32_bf16 v[104:107], a[136:139], a[96:99], v[104:107]
  ds_read_b128 a[64:67], v16 offset:0
  ds_read_b128 a[80:83], v16 offset:8192
  v_mfma_f32_16x16x32_bf16 v[104:107], a[152:155], a[112:115], v[104:107]
  ds_read_b64_tr_b16 a[128:129], v18 offset:16384
  ds_read_b64_tr_b16 a[130:131], v18 offset:18432
  v_mfma_f32_16x16x32_bf16 v[120:123], a[136:139], a[100:103], v[120:123]
  ds_read_b64_tr_b16 a[144:145], v18 offset:20480
  ds_read_b64_tr_b16 a[146:147], v18 offset:22528
  v_mfma_f32_16x16x32_bf16 v[120:123], a[152:155], a[116:119], v[120:123]
  ds_read_b128 a[68:71], v16 offset:1024
  v_mfma_f32_16x16x32_bf16 v[108:111], a[140:143], a[96:99], v[108:111]
  ds_read_b128 a[84:87], v16 offset:9216
  ds_read_b64_tr_b16 a[132:133], v19 offset:16384
  v_mfma_f32_16x16x32_bf16 v[108:111], a[156:159], a[112:115], v[108:111]
  ds_read_b64_tr_b16 a[134:135], v19 offset:18432
  ds_read_b64_tr_b16 a[148:149], v19 offset:20480
  v_mfma_f32_16x16x32_bf16 v[124:127], a[140:143], a[100:103], v[124:127]
  ds_read_b64_tr_b16 a[150:151], v19 offset:22528
  v_mfma_f32_16x16x32_bf16 v[124:127], a[156:159], a[116:119], v[124:127]
  s_waitcnt lgkmcnt(0)
  v_mfma_f32_16x16x32_bf16 v[96:99], a[128:131], a[64:67], v[96:99]
  s_add_u32 s64, s64, s66
  ds_read_b64_tr_b16 a[136:137], v20 offset:16384
  ds_read_b64_tr_b16 a[138:139], v20 offset:18432
  v_mfma_f32_16x16x32_bf16 v[96:99], a[144:147], a[80:83], v[96:99]
  s_add_u32 s65, s65, 1
  ds_read_b64_tr_b16 a[152:153], v20 offset:20480
  ds_read_b64_tr_b16 a[154:155], v20 offset:22528
  v_mfma_f32_16x16x32_bf16 v[112:115], a[128:131], a[68:71], v[112:115]
  s_cmp_eq_u32 s65, 4
  s_cselect_b32 s65, 0, s65
  s_cselect_b32 s66, s67, s68
  ds_read_b64_tr_b16 a[140:141], v21 offset:16384
  v_mfma_f32_16x16x32_bf16 v[112:115], a[144:147], a[84:87], v[112:115]
  ds_read_b64_tr_b16 a[142:143], v21 offset:18432
  ds_read_b64_tr_b16 a[156:157], v21 offset:20480
  v_mfma_f32_16x16x32_bf16 v[100:103], a[132:135], a[64:67], v[100:103]
  ds_read_b64_tr_b16 a[158:159], v21 offset:22528
  v_mfma_f32_16x16x32_bf16 v[100:103], a[148:151], a[80:83], v[100:103]
  v_add_u32 v16, s66, v16
  v_add_u32 v17, s66, v17
  v_mfma_f32_16x16x32_bf16 v[116:119], a[132:135], a[68:71], v[116:119]
  v_add_u32 v18, s66, v18
  v_add_u32 v19, s66, v19
  v_mfma_f32_16x16x32_bf16 v[116:119], a[148:151], a[84:87], v[116:119]
  v_add_u32 v20, s66, v20
  v_add_u32 v21, s66, v21
  s_waitcnt vmcnt(15) lgkmcnt(0)
  s_barrier
  v_mfma_f32_16x16x32_bf16 v[104:107], a[136:139], a[64:67], v[104:107]
  ds_read_b128 a[96:99], v16 offset:0
  ds_read_b128 a[112:115], v16 offset:8192
  v_mfma_f32_16x16x32_bf16 v[104:107], a[152:155], a[80:83], v[104:107]
  ds_read_b64_tr_b16 a[128:129], v18 offset:16384
  ds_read_b64_tr_b16 a[130:131], v18 offset:18432
  v_mfma_f32_16x16x32_bf16 v[120:123], a[136:139], a[68:71], v[120:123]
  ds_read_b64_tr_b16 a[144:145], v18 offset:20480
  ds_read_b64_tr_b16 a[146:147], v18 offset:22528
  v_mfma_f32_16x16x32_bf16 v[120:123], a[152:155], a[84:87], v[120:123]
  ds_read_b128 a[100:103], v16 offset:1024
  v_mfma_f32_16x16x32_bf16 v[108:111], a[140:143], a[64:67], v[108:111]
  ds_read_b128 a[116:119], v16 offset:9216
  ds_read_b64_tr_b16 a[132:133], v19 offset:16384
  v_mfma_f32_16x16x32_bf16 v[108:111], a[156:159], a[80:83], v[108:111]
  ds_read_b64_tr_b16 a[134:135], v19 offset:18432
  ds_read_b64_tr_b16 a[148:149], v19 offset:20480
  v_mfma_f32_16x16x32_bf16 v[124:127], a[140:143], a[68:71], v[124:127]
  ds_read_b64_tr_b16 a[150:151], v19 offset:22528
  v_mfma_f32_16x16x32_bf16 v[124:127], a[156:159], a[84:87], v[124:127]
  s_waitcnt lgkmcnt(0)
  v_mfma_f32_16x16x32_bf16 v[96:99], a[128:131], a[96:99], v[96:99]
  s_add_u32 s64, s64, s66
  ds_read_b64_tr_b16 a[136:137], v20 offset:16384
  ds_read_b64_tr_b16 a[138:139], v20 offset:18432
  v_mfma_f32_16x16x32_bf16 v[96:99], a[144:147], a[112:115], v[96:99]
  s_add_u32 s65, s65, 1
  ds_read_b64_tr_b16 a[152:153], v20 offset:20480
  ds_read_b64_tr_b16 a[154:155], v20 offset:22528
  v_mfma_f32_16x16x32_bf16 v[112:115], a[128:131], a[100:103], v[112:115]
  s_cmp_eq_u32 s65, 4
  s_cselect_b32 s65, 0, s65
  s_cselect_b32 s66, s67, s68
  ds_read_b64_tr_b16 a[140:141], v21 offset:16384
  v_mfma_f32_16x16x32_bf16 v[112:115], a[144:147], a[116:119], v[112:115]
  ds_read_b64_tr_b16 a[142:143], v21 offset:18432
  ds_read_b64_tr_b16 a[156:157], v21 offset:20480
  v_mfma_f32_16x16x32_bf16 v[100:103], a[132:135], a[96:99], v[100:103]
  ds_read_b64_tr_b16 a[158:159], v21 offset:22528
  v_mfma_f32_16x16x32_bf16 v[100:103], a[148:151], a[112:115], v[100:103]
  v_add_u32 v16, s66, v16
  v_add_u32 v17, s66, v17
  v_mfma_f32_16x16x32_bf16 v[116:119], a[132:135], a[100:103], v[116:119]
  v_add_u32 v18, s66, v18
  v_add_u32 v19, s66, v19
  v_mfma_f32_16x16x32_bf16 v[116:119], a[148:151], a[116:119], v[116:119]
  v_add_u32 v20, s66, v20
  v_add_u32 v21, s66, v21
  s_waitcnt vmcnt(8) lgkmcnt(0)
  s_barrier
  v_mfma_f32_16x16x32_bf16 v[104:107], a[136:139], a[96:99], v[104:107]
  s_lshl_b32 s6, s78, 1
  s_add_u32 s6, s6, s77
  s_lshl_b32 s6, s6, 2
  v_mfma_f32_16x16x32_bf16 v[104:107], a[152:155], a[112:115], v[104:107]
  s_add_u32 s6, s6, s3
  s_lshl_b32 s6, s6, 14
  s_add_u32 s7, s6, 4096
  v_mfma_f32_16x16x32_bf16 v[120:123], a[136:139], a[100:103], v[120:123]
  buffer_load_dwordx4 v[192:195], v2, s[16:19], s6 offen offset:0 sc1
  v_mfma_f32_16x16x32_bf16 v[120:123], a[152:155], a[116:119], v[120:123]
  buffer_load_dwordx4 v[196:199], v2, s[16:19], s6 offen offset:1024 sc1
  v_mfma_f32_16x16x32_bf16 v[108:111], a[140:143], a[96:99], v[108:111]
  buffer_load_dwordx4 v[200:203], v2, s[16:19], s6 offen offset:2048 sc1
  v_mfma_f32_16x16x32_bf16 v[108:111], a[156:159], a[112:115], v[108:111]
  buffer_load_dwordx4 v[204:207], v2, s[16:19], s6 offen offset:3072 sc1
  v_mfma_f32_16x16x32_bf16 v[124:127], a[140:143], a[100:103], v[124:127]
  ds_read_b128 a[64:67], v16 offset:0
  ds_read_b128 a[80:83], v16 offset:8192
  v_mfma_f32_16x16x32_bf16 v[124:127], a[156:159], a[116:119], v[124:127]
  ds_read_b64_tr_b16 a[128:129], v18 offset:16384
  ds_read_b64_tr_b16 a[130:131], v18 offset:18432
  ds_read_b64_tr_b16 a[144:145], v18 offset:20480
  ds_read_b64_tr_b16 a[146:147], v18 offset:22528
  ds_read_b128 a[68:71], v16 offset:1024
  ds_read_b128 a[84:87], v16 offset:9216
  ds_read_b64_tr_b16 a[132:133], v19 offset:16384
  ds_read_b64_tr_b16 a[134:135], v19 offset:18432
  ds_read_b64_tr_b16 a[148:149], v19 offset:20480
  ds_read_b64_tr_b16 a[150:151], v19 offset:22528
  s_waitcnt lgkmcnt(0)
  v_mfma_f32_16x16x32_bf16 v[96:99], a[128:131], a[64:67], v[96:99]
  buffer_load_dwordx4 v[208:211], v2, s[16:19], s7 offen offset:0 sc1
  v_mfma_f32_16x16x32_bf16 v[96:99], a[144:147], a[80:83], v[96:99]
  buffer_load_dwordx4 v[212:215], v2, s[16:19], s7 offen offset:1024 sc1
  v_mfma_f32_16x16x32_bf16 v[112:115], a[128:131], a[68:71], v[112:115]
  ds_read_b64_tr_b16 a[136:137], v20 offset:16384
  ds_read_b64_tr_b16 a[138:139], v20 offset:18432
  v_mfma_f32_16x16x32_bf16 v[112:115], a[144:147], a[84:87], v[112:115]
  buffer_load_dwordx4 v[216:219], v2, s[16:19], s7 offen offset:2048 sc1
  v_mfma_f32_16x16x32_bf16 v[100:103], a[132:135], a[64:67], v[100:103]
  ds_read_b64_tr_b16 a[152:153], v20 offset:20480
  ds_read_b64_tr_b16 a[154:155], v20 offset:22528
  v_mfma_f32_16x16x32_bf16 v[100:103], a[148:151], a[80:83], v[100:103]
  buffer_load_dwordx4 v[220:223], v2, s[16:19], s7 offen offset:3072 sc1
  v_mfma_f32_16x16x32_bf16 v[116:119], a[132:135], a[68:71], v[116:119]
  ds_read_b64_tr_b16 a[140:141], v21 offset:16384
  ds_read_b64_tr_b16 a[142:143], v21 offset:18432
  v_mfma_f32_16x16x32_bf16 v[116:119], a[148:151], a[84:87], v[116:119]
  ds_read_b64_tr_b16 a[156:157], v21 offset:20480
  ds_read_b64_tr_b16 a[158:159], v21 offset:22528
  s_waitcnt lgkmcnt(0)
  v_mfma_f32_16x16x32_bf16 v[104:107], a[136:139], a[64:67], v[104:107]
  v_mfma_f32_16x16x32_bf16 v[104:107], a[152:155], a[80:83], v[104:107]
  v_mfma_f32_16x16x32_bf16 v[120:123], a[136:139], a[68:71], v[120:123]
  v_mfma_f32_16x16x32_bf16 v[120:123], a[152:155], a[84:87], v[120:123]
  v_mfma_f32_16x16x32_bf16 v[108:111], a[140:143], a[64:67], v[108:111]
  v_mfma_f32_16x16x32_bf16 v[108:111], a[156:159], a[80:83], v[108:111]
  v_mfma_f32_16x16x32_bf16 v[124:127], a[140:143], a[68:71], v[124:127]
  v_mfma_f32_16x16x32_bf16 v[124:127], a[156:159], a[84:87], v[124:127]
  s_waitcnt vmcnt(0)
  s_mov_b32 s72, 0x40000
Lrc_13:
  v_max3_u32 v4, v192, v193, v194
  v_max3_u32 v5, v200, v201, v202
  v_max3_u32 v6, v208, v209, v210
  v_max3_u32 v7, v216, v217, v218
  v_max3_u32 v4, v4, v195, v196
  v_max3_u32 v5, v5, v203, v204
  v_max3_u32 v6, v6, v211, v212
  v_max3_u32 v7, v7, v219, v220
  v_max3_u32 v4, v4, v197, v198
  v_max3_u32 v5, v5, v205, v206
  v_max3_u32 v6, v6, v213, v214
  v_max3_u32 v7, v7, v221, v222
  v_max_u32 v4, v4, v199
  v_max_u32 v5, v5, v207
  v_max_u32 v6, v6, v215
  v_max_u32 v7, v7, v223
  v_max3_u32 v4, v4, v5, v6
  v_max_u32 v4, v4, v7
  v_cmp_eq_u32 vcc, -1, v4
  s_nop 0
  s_cbranch_vccz Lpolld_14
  buffer_load_dwordx4 v[192:195], v2, s[16:19], s6 offen offset:0 sc1
  buffer_load_dwordx4 v[196:199], v2, s[16:19], s6 offen offset:1024 sc1
  buffer_load_dwordx4 v[200:203], v2, s[16:19], s6 offen offset:2048 sc1
  buffer_load_dwordx4 v[204:207], v2, s[16:19], s6 offen offset:3072 sc1
  buffer_load_dwordx4 v[208:211], v2, s[16:19], s7 offen offset:0 sc1
  buffer_load_dwordx4 v[212:215], v2, s[16:19], s7 offen offset:1024 sc1
  buffer_load_dwordx4 v[216:219], v2, s[16:19], s7 offen offset:2048 sc1
  buffer_load_dwordx4 v[220:223], v2, s[16:19], s7 offen offset:3072 sc1
  s_sub_u32 s72, s72, 1
  s_waitcnt vmcnt(0)
  s_cbranch_scc0 Lrc_13
Lpolld_14:
  v_pk_add_f32 v[192:193], v[192:193], v[96:97]
  v_pk_add_f32 v[200:201], v[200:201], v[104:105]
  v_pk_add_f32 v[208:209], v[208:209], v[112:113]
  v_pk_add_f32 v[216:217], v[216:217], v[120:121]
  v_pk_add_f32 v[194:195], v[194:195], v[98:99]
  v_pk_add_f32 v[202:203], v[202:203], v[106:107]
  v_pk_add_f32 v[210:211], v[210:211], v[114:115]
  v_pk_add_f32 v[218:219], v[218:219], v[122:123]
  v_pk_add_f32 v[196:197], v[196:197], v[100:101]
  v_pk_add_f32 v[204:205], v[204:205], v[108:109]
  v_pk_add_f32 v[212:213], v[212:213], v[116:117]
  v_pk_add_f32 v[220:221], v[220:221], v[124:125]
  v_pk_add_f32 v[198:199], v[198:199], v[102:103]
  v_pk_add_f32 v[206:207], v[206:207], v[110:111]
  v_pk_add_f32 v[214:215], v[214:215], v[118:119]
  v_pk_add_f32 v[222:223], v[222:223], v[126:127]
  v_cvt_pk_bf16_f32 v192, v192, v193
  v_cvt_pk_bf16_f32 v200, v200, v201
  v_cvt_pk_bf16_f32 v208, v208, v209
  v_cvt_pk_bf16_f32 v216, v216, v217
  v_cvt_pk_bf16_f32 v193, v194, v195
  v_cvt_pk_bf16_f32 v201, v202, v203
  v_cvt_pk_bf16_f32 v209, v210, v211
  v_cvt_pk_bf16_f32 v217, v218, v219
  v_cvt_pk_bf16_f32 v194, v196, v197
  v_cvt_pk_bf16_f32 v202, v204, v205
  v_cvt_pk_bf16_f32 v210, v212, v213
  v_cvt_pk_bf16_f32 v218, v220, v221
  v_cvt_pk_bf16_f32 v195, v198, v199
  v_cvt_pk_bf16_f32 v203, v206, v207
  v_cvt_pk_bf16_f32 v211, v214, v215
  v_cvt_pk_bf16_f32 v219, v222, v223
  v_permlane16_swap_b32 v192, v194
  v_permlane16_swap_b32 v200, v202
  v_permlane16_swap_b32 v208, v210
  v_permlane16_swap_b32 v216, v218
  v_permlane16_swap_b32 v193, v195
  v_permlane16_swap_b32 v201, v203
  v_permlane16_swap_b32 v209, v211
  v_permlane16_swap_b32 v217, v219
  buffer_store_dwordx4 v[192:195], v26, s[20:23], s34 offen offset:0
  buffer_store_dwordx4 v[200:203], v26, s[20:23], s34 offen offset:64
  buffer_store_dwordx4 v[208:211], v26, s[20:23], s35 offen offset:0
  buffer_store_dwordx4 v[216:219], v26, s[20:23], s35 offen offset:64
Lend:
  s_endpgm
.section .rodata,"a"
.p2align 6
.amdhsa_kernel concat_heads__compressed_kv_cla__sliding_local_dilated__prompt_kernel
  .amdhsa_next_free_vgpr 512
  .amdhsa_next_free_sgpr 102
  .amdhsa_accum_offset 256
  .amdhsa_group_segment_fixed_size 0
  .amdhsa_kernarg_size 96
  .amdhsa_user_sgpr_count 2
  .amdhsa_user_sgpr_kernarg_segment_ptr 1
  .amdhsa_system_sgpr_workgroup_id_x 1
.end_amdhsa_kernel
```

```asm
; @launch grid=(256,1,1) block=(256,1,1) lds=163840
.amdgcn_target "amdgcn-amd-amdhsa--gfx950"
.text
.globl concat_heads__compressed_kv_cla__sliding_local_dilated__prompt_kernel
.p2align 8
.type concat_heads__compressed_kv_cla__sliding_local_dilated__prompt_kernel,@function
concat_heads__compressed_kv_cla__sliding_local_dilated__prompt_kernel:
  s_cmp_ge_u32 s2, 256
  s_cbranch_scc1 Lend
  s_load_dwordx16 s[64:79], s[0:1], 0
  s_load_dwordx8 s[80:87], s[0:1], 64
  v_lshrrev_b32 v2, 6, v0
  v_and_b32 v1, 63, v0
  v_readfirstlane_b32 s3, v2
  v_lshlrev_b32 v2, 4, v1
  s_bfe_u32 s59, s2, 0x30003
  s_lshr_b32 s4, s2, 7
  s_lshl_b32 s4, s4, 3
  s_add_u32 s59, s59, s4
  s_lshr_b32 s4, s2, 3
  s_xor_b32 s4, s4, s2
  s_bitcmp1_b32 s4, 3
  s_cbranch_scc1 Lp2
  s_and_b32 s4, s2, 1
  s_lshl_b32 s4, s4, 2
  s_and_b32 s5, s59, 3
  s_add_u32 s61, s4, s5
  s_bfe_u32 s4, s2, 0x20001
  s_lshl_b32 s4, s4, 2
  s_lshr_b32 s5, s59, 2
  s_add_u32 s62, s4, s5
  s_lshl_b32 s4, s3, 13
  s_add_u32 s36, s4, 65536
  s_add_u32 s41, s4, 98304
  v_lshrrev_b32 v32, 3, v1
  v_and_b32 v33, 6, v32
  v_and_b32 v34, 7, v1
  v_xor_b32 v33, v33, v34
  v_lshlrev_b32 v33, 4, v33
  s_lshl_b32 s4, s61, 2
  s_add_u32 s4, s4, s3
  s_lshl_b32 s4, s4, 6
  v_add_u32 v34, s4, v32
  v_lshl_add_u32 v34, v34, 10, v33
  v_add_u32 v48, 0, v34
  v_add_u32 v49, 7168, v34
  v_add_u32 v50, 14336, v34
  v_add_u32 v51, 21504, v34
  v_add_u32 v52, 32768, v34
  v_add_u32 v53, 39936, v34
  v_add_u32 v54, 47104, v34
  v_add_u32 v55, 54272, v34
  v_lshrrev_b32 v34, 2, v32
  v_and_b32 v35, 3, v32
  v_lshl_add_u32 v34, v34, 3, v35
  s_lshl_b32 s4, s62, 2
  s_add_u32 s4, s4, s3
  s_lshl_b32 s4, s4, 7
  v_lshl_add_u32 v34, v34, 13, v33
  v_add_u32 v34, s4, v34
  v_add_u32 v56, 0, v34
  v_add_u32 v57, 130048, v34
  v_add_u32 v58, 30720, v34
  v_add_u32 v59, 160768, v34
  v_add_u32 v60, 262144, v34
  v_add_u32 v61, 392192, v34
  v_add_u32 v62, 292864, v34
  v_add_u32 v63, 422912, v34
  s_and_b32 s6, s2, 7
  s_add_u32 s4, s61, s62
  s_and_b32 s49, s4, 3
  s_lshl_b32 s49, s49, 3
  s_or_b32 s49, s49, 0x80000
  s_bfe_u32 s48, 0x70702, s49
  s_add_u32 s48, s48, s6
  s_and_b32 s48, s48, 7
  s_lshl_b32 s46, s48, 7
  s_waitcnt lgkmcnt(0)
  s_mov_b32 s8, s66
  s_mov_b32 s9, s67
  s_mov_b32 s10, 2097152
  s_mov_b32 s11, 0x00020000
  s_mov_b32 s12, s70
  s_mov_b32 s13, s71
  s_mov_b32 s14, 4194304
  s_mov_b32 s15, 0x00020000
  s_mov_b32 s50, 9
  s_add_u32 s96, s86, 125829120
  s_addc_u32 s97, s87, 0
  s_mov_b32 s98, 262144
  s_mov_b32 s99, 0x00020000
  s_or_b32 s4, s2, s3
  s_cbranch_scc1 Ltag_1
  s_mov_b32 s4, 196608
  buffer_load_dwordx2 v[22:23], off, s[96:99], s4 sc1
Ltag_1:
  s_mov_b32 m0, s36
  s_nop 0
  buffer_load_dwordx4 v48, s[8:11], s46 offen offset:0 lds
  buffer_load_dwordx4 v49, s[8:11], s46 offen offset:1024 lds
  buffer_load_dwordx4 v50, s[8:11], s46 offen offset:2048 lds
  buffer_load_dwordx4 v51, s[8:11], s46 offen offset:3072 lds
  s_add_u32 m0, s36, 4096
  s_nop 0
  buffer_load_dwordx4 v52, s[8:11], s46 offen offset:0 lds
  buffer_load_dwordx4 v53, s[8:11], s46 offen offset:1024 lds
  buffer_load_dwordx4 v54, s[8:11], s46 offen offset:2048 lds
  buffer_load_dwordx4 v55, s[8:11], s46 offen offset:3072 lds
  s_sub_u32 s50, s50, 1
  s_cmp_eq_u32 s50, 0
  s_cselect_b32 s12, s72, s12
  s_cselect_b32 s13, s73, s13
  s_lshl_b32 s47, s48, 19
  s_bfe_u32 s34, 0x3020106, s49
  s_add_u32 s48, s48, s34
  s_add_u32 s49, s49, 8
  s_and_b32 s49, s49, 0x8001f
  s_and_b32 s48, s48, 7
  s_lshl_b32 s46, s48, 7
  s_mov_b32 m0, s41
  s_nop 0
  buffer_load_dwordx4 v56, s[12:15], s47 offen offset:0 lds
  buffer_load_dwordx4 v57, s[12:15], s47 offen offset:1024 lds
  buffer_load_dwordx4 v58, s[12:15], s47 offen offset:2048 lds
  buffer_load_dwordx4 v59, s[12:15], s47 offen offset:3072 lds
  s_add_u32 m0, s41, 4096
  s_nop 0
  buffer_load_dwordx4 v60, s[12:15], s47 offen offset:0 lds
  buffer_load_dwordx4 v61, s[12:15], s47 offen offset:1024 lds
  buffer_load_dwordx4 v62, s[12:15], s47 offen offset:2048 lds
  buffer_load_dwordx4 v63, s[12:15], s47 offen offset:3072 lds
  s_lshr_b32 s4, s3, 1
  s_lshl_b32 s4, s4, 14
  s_add_u32 s4, s4, 65536
  v_and_b32 v32, 15, v1
  v_lshlrev_b32 v32, 7, v32
  v_lshrrev_b32 v33, 4, v1
  v_and_b32 v34, 6, v1
  v_xor_b32 v33, v33, v34
  v_lshl_add_u32 v32, v33, 4, v32
  v_add_u32 v16, s4, v32
  v_xor_b32 v17, 64, v16
  s_and_b32 s4, s3, 1
  s_lshl_b32 s4, s4, 14
  s_add_u32 s4, s4, 98304
  v_lshrrev_b32 v32, 2, v1
  v_and_b32 v33, 6, v32
  v_lshlrev_b32 v32, 7, v32
  v_and_b32 v34, 1, v1
  v_lshl_add_u32 v32, v34, 3, v32
  v_add_u32 v32, s4, v32
  v_bfe_u32 v34, v1, 1, 1
  v_xor_b32 v33, v33, v34
  v_xor_b32 v34, 0, v33
  v_lshl_add_u32 v18, v34, 4, v32
  v_xor_b32 v34, 2, v33
  v_lshl_add_u32 v19, v34, 4, v32
  v_xor_b32 v34, 4, v33
  v_lshl_add_u32 v20, v34, 4, v32
  v_xor_b32 v34, 6, v33
  v_lshl_add_u32 v21, v34, 4, v32
  s_and_b32 s24, s2, 7
  s_lshr_b32 s4, s2, 6
  s_lshl_b32 s4, s4, 3
  s_add_u32 s24, s24, s4
  s_lshr_b32 s4, s2, 3
  s_and_b32 s25, s4, 6
  s_xor_b32 s4, s4, s2
  s_bfe_u32 s4, s4, 0x10003
  s_add_u32 s25, s25, s4
  v_accvgpr_write_b32 a244, -1
  v_accvgpr_write_b32 a245, -1
  v_accvgpr_write_b32 a246, -1
  v_accvgpr_write_b32 a247, -1
  v_lshrrev_b32 v24, 3, v1
  v_and_b32 v25, 6, v24
  v_and_b32 v26, 7, v1
  v_xor_b32 v25, v25, v26
  v_lshlrev_b32 v25, 4, v25
  s_and_b32 s4, s3, 1
  s_lshl_b32 s4, s4, 16
  s_lshr_b32 s5, s3, 1
  s_lshl_b32 s5, s5, 7
  s_add_u32 s4, s4, s5
  v_lshl_add_u32 v24, v24, 11, v25
  v_add_u32 v24, s4, v24
  v_add_u32 v25, 0, v24
  v_accvgpr_write_b32 a212, v25
  v_add_u32 v25, 15360, v24
  v_accvgpr_write_b32 a213, v25
  v_add_u32 v25, 30720, v24
  v_accvgpr_write_b32 a214, v25
  v_add_u32 v25, 46080, v24
  v_accvgpr_write_b32 a215, v25
  v_accvgpr_write_b32 a236, 0
  v_mov_b32 v27, 0x3f803f80
  v_accvgpr_write_b32 a208, v27
  v_accvgpr_write_b32 a237, 0
  v_accvgpr_write_b32 a209, v27
  v_accvgpr_write_b32 a238, 0
  v_accvgpr_write_b32 a210, v27
  v_accvgpr_write_b32 a239, 0
  v_accvgpr_write_b32 a211, v27
  v_lshrrev_b32 v24, 3, v1
  v_and_b32 v25, 6, v24
  v_and_b32 v26, 7, v1
  v_xor_b32 v25, v25, v26
  v_lshlrev_b32 v25, 4, v25
  v_lshlrev_b32 v26, 2, v24
  v_add_u32 v26, s3, v26
  v_lshl_add_u32 v26, v26, 11, v25
  v_add_u32 v27, 0, v26
  v_accvgpr_write_b32 a222, v27
  v_add_u32 v27, 64512, v26
  v_accvgpr_write_b32 a223, v27
  v_add_u32 v27, 129024, v26
  v_accvgpr_write_b32 a224, v27
  v_add_u32 v27, 193536, v26
  v_accvgpr_write_b32 a225, v27
  v_lshrrev_b32 v26, 2, v24
  v_and_b32 v27, 3, v24
  v_lshl_add_u32 v26, v26, 3, v27
  s_and_b32 s4, s3, 1
  s_lshl_b32 s4, s4, 18
  s_lshr_b32 s5, s3, 1
  s_lshl_b32 s5, s5, 7
  s_add_u32 s4, s4, s5
  s_lshl_b32 s5, s24, 8
  s_add_u32 s4, s4, s5
  v_lshl_add_u32 v26, v26, 13, v25
  v_add_u32 v26, s4, v26
  v_add_u32 v27, 0, v26
  v_accvgpr_write_b32 a226, v27
  v_add_u32 v27, 130048, v26
  v_accvgpr_write_b32 a227, v27
  v_add_u32 v27, 30720, v26
  v_accvgpr_write_b32 a228, v27
  v_add_u32 v27, 160768, v26
  v_accvgpr_write_b32 a229, v27
  s_lshl_b32 s4, s3, 13
  s_add_u32 s4, s4, 98304
  v_and_b32 v24, 15, v1
  v_lshlrev_b32 v24, 7, v24
  v_lshrrev_b32 v25, 4, v1
  v_and_b32 v26, 6, v1
  v_xor_b32 v25, v25, v26
  v_lshl_add_u32 v24, v25, 4, v24
  v_add_u32 v28, s4, v24
  v_xor_b32 v29, 64, v28
  v_lshrrev_b32 v24, 2, v1
  v_and_b32 v25, 6, v24
  v_lshlrev_b32 v24, 7, v24
  v_and_b32 v26, 1, v1
  v_lshl_add_u32 v24, v26, 3, v24
  v_add_u32 v24, 0, v24
  v_bfe_u32 v26, v1, 1, 1
  v_xor_b32 v25, v25, v26
  v_xor_b32 v26, 0, v25
  v_lshl_add_u32 v30, v26, 4, v24
  v_xor_b32 v26, 2, v25
  v_lshl_add_u32 v31, v26, 4, v24
  v_xor_b32 v26, 4, v25
  v_lshl_add_u32 v32, v26, 4, v24
  v_xor_b32 v26, 6, v25
  v_lshl_add_u32 v33, v26, 4, v24
  v_accvgpr_write_b32 a230, v28
  v_accvgpr_write_b32 a231, v29
  v_accvgpr_write_b32 a232, v30
  v_accvgpr_write_b32 a233, v31
  v_accvgpr_write_b32 a234, v32
  v_accvgpr_write_b32 a235, v33
  s_and_b32 s4, s3, 1
  s_lshl_b32 s5, s62, 1
  s_add_u32 s4, s4, s5
  s_lshr_b32 s5, s3, 1
  s_lshl_b32 s6, s61, 1
  s_add_u32 s5, s5, s6
  s_add_u32 s16, s86, 16777216
  s_addc_u32 s17, s87, 0
  s_mov_b32 s18, 33554432
  s_mov_b32 s19, 0x00020000
  s_lshl_b32 s4, s4, 20
  s_lshl_b32 s5, s5, 16
  s_add_u32 s63, s4, s5
  s_mov_b32 s37, 0
  s_mov_b32 s39, 4294901760
  s_mov_b32 s40, 32768
  s_mov_b32 s37, 2
  s_mov_b32 s42, 0
  s_mov_b32 s44, 4294934528
  s_mov_b32 s45, 32768
  s_mov_b32 s43, s44
  s_or_b32 s4, s2, s3
  s_cbranch_scc1 Ltag_2
  s_mov_b32 s4, 196608
  s_mov_b32 s92, s84
  s_mov_b32 s93, s85
  s_mov_b32 s94, 256
  s_mov_b32 s95, 0x00020000
  s_waitcnt vmcnt(16)
  v_add_u32 v22, 1, v22
  v_or_b32 v23, 0x80000000, v23
  buffer_store_dwordx2 v[22:23], off, s[96:99], s4 sc1
  buffer_store_dwordx2 v[22:23], off, s[92:95], 0 sc1
Ltag_2:
  s_waitcnt vmcnt(0)
  s_barrier
  ds_read_b128 a[0:3], v16 offset:0
  ds_read_b64_tr_b16 a[64:65], v18 offset:0
  ds_read_b64_tr_b16 a[66:67], v18 offset:2048
  ds_read_b128 a[4:7], v16 offset:2048
  ds_read_b128 a[8:11], v16 offset:4096
  ds_read_b128 a[12:15], v16 offset:6144
  ds_read_b128 a[16:19], v16 offset:8192
  ds_read_b128 a[20:23], v16 offset:10240
  ds_read_b128 a[24:27], v16 offset:12288
  ds_read_b128 a[28:31], v16 offset:14336
  ds_read_b64_tr_b16 a[68:69], v19 offset:0
  ds_read_b64_tr_b16 a[70:71], v19 offset:2048
  ds_read_b64_tr_b16 a[72:73], v20 offset:0
  ds_read_b64_tr_b16 a[74:75], v20 offset:2048
  ds_read_b64_tr_b16 a[76:77], v21 offset:0
  ds_read_b64_tr_b16 a[78:79], v21 offset:2048
  ds_read_b64_tr_b16 a[80:81], v18 offset:8192
  ds_read_b64_tr_b16 a[82:83], v18 offset:10240
  ds_read_b64_tr_b16 a[84:85], v19 offset:8192
  ds_read_b64_tr_b16 a[86:87], v19 offset:10240
  ds_read_b64_tr_b16 a[88:89], v20 offset:8192
  ds_read_b64_tr_b16 a[90:91], v20 offset:10240
  ds_read_b64_tr_b16 a[92:93], v21 offset:8192
  ds_read_b64_tr_b16 a[94:95], v21 offset:10240
  s_waitcnt lgkmcnt(0)
  v_mfma_f32_16x16x32_bf16 v[64:67], a[64:67], a[0:3], 0
  s_add_u32 m0, s36, -65536
  ds_read_b128 a[32:35], v17 offset:0
  v_mfma_f32_16x16x32_bf16 v[96:99], a[64:67], a[4:7], 0
  buffer_load_dwordx4 v48, s[8:11], s46 offen offset:0 lds
  v_mfma_f32_16x16x32_bf16 v[128:131], a[64:67], a[8:11], 0
  buffer_load_dwordx4 v49, s[8:11], s46 offen offset:1024 lds
  v_mfma_f32_16x16x32_bf16 v[160:163], a[64:67], a[12:15], 0
  ds_read_b64_tr_b16 a[96:97], v18 offset:4096
  v_mfma_f32_16x16x32_bf16 v[192:195], a[64:67], a[16:19], 0
  buffer_load_dwordx4 v50, s[8:11], s46 offen offset:2048 lds
  v_mfma_f32_16x16x32_bf16 v[224:227], a[64:67], a[20:23], 0
  ds_read_b64_tr_b16 a[98:99], v18 offset:6144
  v_mfma_f32_16x16x32_bf16 a[128:131], a[64:67], a[24:27], 0
  ds_read_b128 a[36:39], v17 offset:2048
  v_mfma_f32_16x16x32_bf16 a[160:163], a[64:67], a[28:31], 0
  buffer_load_dwordx4 v51, s[8:11], s46 offen offset:3072 lds
  v_mfma_f32_16x16x32_bf16 v[68:71], a[68:71], a[0:3], 0
  s_add_u32 m0, s36, -61440
  v_mfma_f32_16x16x32_bf16 v[100:103], a[68:71], a[4:7], 0
  buffer_load_dwordx4 v52, s[8:11], s46 offen offset:0 lds
  v_mfma_f32_16x16x32_bf16 v[132:135], a[68:71], a[8:11], 0
  ds_read_b128 a[40:43], v17 offset:4096
  v_mfma_f32_16x16x32_bf16 v[164:167], a[68:71], a[12:15], 0
  buffer_load_dwordx4 v53, s[8:11], s46 offen offset:1024 lds
  v_mfma_f32_16x16x32_bf16 v[196:199], a[68:71], a[16:19], 0
  ds_read_b128 a[44:47], v17 offset:6144
  v_mfma_f32_16x16x32_bf16 v[228:231], a[68:71], a[20:23], 0
  ds_read_b128 a[48:51], v17 offset:8192
  v_mfma_f32_16x16x32_bf16 a[132:135], a[68:71], a[24:27], 0
  buffer_load_dwordx4 v54, s[8:11], s46 offen offset:2048 lds
  v_mfma_f32_16x16x32_bf16 a[164:167], a[68:71], a[28:31], 0
  ds_read_b128 a[52:55], v17 offset:10240
  v_mfma_f32_16x16x32_bf16 v[72:75], a[72:75], a[0:3], 0
  buffer_load_dwordx4 v55, s[8:11], s46 offen offset:3072 lds
  v_mfma_f32_16x16x32_bf16 v[104:107], a[72:75], a[4:7], 0
  s_sub_u32 s50, s50, 1
  s_cmp_eq_u32 s50, 0
  s_cselect_b32 s12, s72, s12
  s_cselect_b32 s13, s73, s13
  v_mfma_f32_16x16x32_bf16 v[136:139], a[72:75], a[8:11], 0
  s_lshl_b32 s47, s48, 19
  s_bfe_u32 s34, 0x3020106, s49
  s_add_u32 s48, s48, s34
  v_mfma_f32_16x16x32_bf16 v[168:171], a[72:75], a[12:15], 0
  s_add_u32 s49, s49, 8
  s_and_b32 s49, s49, 0x8001f
  s_and_b32 s48, s48, 7
  v_mfma_f32_16x16x32_bf16 v[200:203], a[72:75], a[16:19], 0
  s_lshl_b32 s46, s48, 7
  s_add_u32 m0, s41, 32768
  ds_read_b128 a[56:59], v17 offset:12288
  v_mfma_f32_16x16x32_bf16 v[232:235], a[72:75], a[20:23], 0
  buffer_load_dwordx4 v56, s[12:15], s47 offen offset:0 lds
  v_mfma_f32_16x16x32_bf16 a[136:139], a[72:75], a[24:27], 0
  buffer_load_dwordx4 v57, s[12:15], s47 offen offset:1024 lds
  v_mfma_f32_16x16x32_bf16 a[168:171], a[72:75], a[28:31], 0
  buffer_load_dwordx4 v58, s[12:15], s47 offen offset:2048 lds
  v_mfma_f32_16x16x32_bf16 v[76:79], a[76:79], a[0:3], 0
  ds_read_b128 a[60:63], v17 offset:14336
  ds_read_b64_tr_b16 a[100:101], v19 offset:4096
  v_mfma_f32_16x16x32_bf16 v[108:111], a[76:79], a[4:7], 0
  ds_read_b64_tr_b16 a[102:103], v19 offset:6144
  v_mfma_f32_16x16x32_bf16 v[140:143], a[76:79], a[8:11], 0
  buffer_load_dwordx4 v59, s[12:15], s47 offen offset:3072 lds
  v_mfma_f32_16x16x32_bf16 v[172:175], a[76:79], a[12:15], 0
  s_add_u32 m0, s41, 36864
  ds_read_b64_tr_b16 a[104:105], v20 offset:4096
  v_mfma_f32_16x16x32_bf16 v[204:207], a[76:79], a[16:19], 0
  buffer_load_dwordx4 v60, s[12:15], s47 offen offset:0 lds
  v_mfma_f32_16x16x32_bf16 v[236:239], a[76:79], a[20:23], 0
  ds_read_b64_tr_b16 a[106:107], v20 offset:6144
  v_mfma_f32_16x16x32_bf16 a[140:143], a[76:79], a[24:27], 0
  buffer_load_dwordx4 v61, s[12:15], s47 offen offset:1024 lds
  v_mfma_f32_16x16x32_bf16 a[172:175], a[76:79], a[28:31], 0
  ds_read_b64_tr_b16 a[108:109], v21 offset:4096
  v_mfma_f32_16x16x32_bf16 v[80:83], a[80:83], a[0:3], 0
  v_mfma_f32_16x16x32_bf16 v[112:115], a[80:83], a[4:7], 0
  buffer_load_dwordx4 v62, s[12:15], s47 offen offset:2048 lds
  v_mfma_f32_16x16x32_bf16 v[144:147], a[80:83], a[8:11], 0
  ds_read_b64_tr_b16 a[110:111], v21 offset:6144
  v_mfma_f32_16x16x32_bf16 v[176:179], a[80:83], a[12:15], 0
  buffer_load_dwordx4 v63, s[12:15], s47 offen offset:3072 lds
  v_mfma_f32_16x16x32_bf16 v[208:211], a[80:83], a[16:19], 0
  s_add_u32 m0, s36, -32768
  ds_read_b64_tr_b16 a[112:113], v18 offset:12288
  v_mfma_f32_16x16x32_bf16 v[240:243], a[80:83], a[20:23], 0
  v_mfma_f32_16x16x32_bf16 a[144:147], a[80:83], a[24:27], 0
  buffer_load_dwordx4 v48, s[8:11], s46 offen offset:0 lds
  v_mfma_f32_16x16x32_bf16 a[176:179], a[80:83], a[28:31], 0
  ds_read_b64_tr_b16 a[114:115], v18 offset:14336
  v_mfma_f32_16x16x32_bf16 v[84:87], a[84:87], a[0:3], 0
  buffer_load_dwordx4 v49, s[8:11], s46 offen offset:1024 lds
  v_mfma_f32_16x16x32_bf16 v[116:119], a[84:87], a[4:7], 0
  ds_read_b64_tr_b16 a[116:117], v19 offset:12288
  v_mfma_f32_16x16x32_bf16 v[148:151], a[84:87], a[8:11], 0
  buffer_load_dwordx4 v50, s[8:11], s46 offen offset:2048 lds
  v_mfma_f32_16x16x32_bf16 v[180:183], a[84:87], a[12:15], 0
  ds_read_b64_tr_b16 a[118:119], v19 offset:14336
  v_mfma_f32_16x16x32_bf16 v[212:215], a[84:87], a[16:19], 0
  v_mfma_f32_16x16x32_bf16 v[244:247], a[84:87], a[20:23], 0
  buffer_load_dwordx4 v51, s[8:11], s46 offen offset:3072 lds
  v_mfma_f32_16x16x32_bf16 a[148:151], a[84:87], a[24:27], 0
  s_add_u32 m0, s36, -28672
  ds_read_b64_tr_b16 a[120:121], v20 offset:12288
  v_mfma_f32_16x16x32_bf16 a[180:183], a[84:87], a[28:31], 0
  buffer_load_dwordx4 v52, s[8:11], s46 offen offset:0 lds
  v_mfma_f32_16x16x32_bf16 v[88:91], a[88:91], a[0:3], 0
  s_add_u32 s37, s37, 1
  ds_read_b64_tr_b16 a[122:123], v20 offset:14336
  v_mfma_f32_16x16x32_bf16 v[120:123], a[88:91], a[4:7], 0
  buffer_load_dwordx4 v53, s[8:11], s46 offen offset:1024 lds
  v_mfma_f32_16x16x32_bf16 v[152:155], a[88:91], a[8:11], 0
  ds_read_b64_tr_b16 a[124:125], v21 offset:12288
  v_mfma_f32_16x16x32_bf16 v[184:187], a[88:91], a[12:15], 0
  ds_read_b64_tr_b16 a[126:127], v21 offset:14336
  v_mfma_f32_16x16x32_bf16 v[216:219], a[88:91], a[16:19], 0
  buffer_load_dwordx4 v54, s[8:11], s46 offen offset:2048 lds
  v_mfma_f32_16x16x32_bf16 v[248:251], a[88:91], a[20:23], 0
  s_cmp_eq_u32 s37, 3
  s_cselect_b32 s37, 0, s37
  s_cselect_b32 s38, s39, s40
  v_mfma_f32_16x16x32_bf16 a[152:155], a[88:91], a[24:27], 0
  buffer_load_dwordx4 v55, s[8:11], s46 offen offset:3072 lds
  v_mfma_f32_16x16x32_bf16 a[184:187], a[88:91], a[28:31], 0
  s_sub_u32 s43, 0, s43
  v_mfma_f32_16x16x32_bf16 v[92:95], a[92:95], a[0:3], 0
  s_sub_u32 s50, s50, 1
  v_add_u32 v16, s38, v16
  v_add_u32 v17, s38, v17
  v_mfma_f32_16x16x32_bf16 v[124:127], a[92:95], a[4:7], 0
  s_cmp_eq_u32 s50, 0
  s_cselect_b32 s12, s72, s12
  s_cselect_b32 s13, s73, s13
  v_mfma_f32_16x16x32_bf16 v[156:159], a[92:95], a[8:11], 0
  s_lshl_b32 s47, s48, 19
  v_add_u32 v18, s43, v18
  v_add_u32 v19, s43, v19
  v_mfma_f32_16x16x32_bf16 v[188:191], a[92:95], a[12:15], 0
  s_bfe_u32 s34, 0x3020106, s49
  s_add_u32 s48, s48, s34
  s_add_u32 s49, s49, 8
  v_mfma_f32_16x16x32_bf16 v[220:223], a[92:95], a[16:19], 0
  s_and_b32 s49, s49, 0x8001f
  s_and_b32 s48, s48, 7
  s_lshl_b32 s46, s48, 7
  v_mfma_f32_16x16x32_bf16 v[252:255], a[92:95], a[20:23], 0
  v_add_u32 v20, s43, v20
  v_add_u32 v21, s43, v21
  v_mfma_f32_16x16x32_bf16 a[156:159], a[92:95], a[24:27], 0
  v_mfma_f32_16x16x32_bf16 a[188:191], a[92:95], a[28:31], 0
  s_mov_b32 s35, 6
  s_waitcnt vmcnt(8) lgkmcnt(0)
  s_barrier
  .p2align 6
Lp1wx_loop:
  v_mfma_f32_16x16x32_bf16 v[64:67], a[96:99], a[32:35], v[64:67]
  s_mov_b32 m0, s41
  ds_read_b128 a[0:3], v16 offset:0
  v_mfma_f32_16x16x32_bf16 v[96:99], a[96:99], a[36:39], v[96:99]
  buffer_load_dwordx4 v56, s[12:15], s47 offen offset:0 lds
  v_mfma_f32_16x16x32_bf16 v[128:131], a[96:99], a[40:43], v[128:131]
  ds_read_b64_tr_b16 a[64:65], v18 offset:0
  v_mfma_f32_16x16x32_bf16 v[160:163], a[96:99], a[44:47], v[160:163]
  v_mfma_f32_16x16x32_bf16 v[192:195], a[96:99], a[48:51], v[192:195]
  ds_read_b64_tr_b16 a[66:67], v18 offset:2048
  v_mfma_f32_16x16x32_bf16 v[224:227], a[96:99], a[52:55], v[224:227]
  v_mfma_f32_16x16x32_bf16 a[128:131], a[96:99], a[56:59], a[128:131]
  ds_read_b128 a[4:7], v16 offset:2048
  v_mfma_f32_16x16x32_bf16 a[160:163], a[96:99], a[60:63], a[160:163]
  buffer_load_dwordx4 v57, s[12:15], s47 offen offset:1024 lds
  v_mfma_f32_16x16x32_bf16 v[68:71], a[100:103], a[32:35], v[68:71]
  v_mfma_f32_16x16x32_bf16 v[100:103], a[100:103], a[36:39], v[100:103]
  ds_read_b128 a[8:11], v16 offset:4096
  v_mfma_f32_16x16x32_bf16 v[132:135], a[100:103], a[40:43], v[132:135]
  v_mfma_f32_16x16x32_bf16 v[164:167], a[100:103], a[44:47], v[164:167]
  ds_read_b128 a[12:15], v16 offset:6144
  v_mfma_f32_16x16x32_bf16 v[196:199], a[100:103], a[48:51], v[196:199]
  v_mfma_f32_16x16x32_bf16 v[228:231], a[100:103], a[52:55], v[228:231]
  ds_read_b128 a[16:19], v16 offset:8192
  v_mfma_f32_16x16x32_bf16 a[132:135], a[100:103], a[56:59], a[132:135]
  v_mfma_f32_16x16x32_bf16 a[164:167], a[100:103], a[60:63], a[164:167]
  buffer_load_dwordx4 v58, s[12:15], s47 offen offset:2048 lds
  v_mfma_f32_16x16x32_bf16 v[72:75], a[104:107], a[32:35], v[72:75]
  ds_read_b128 a[20:23], v16 offset:10240
  v_mfma_f32_16x16x32_bf16 v[104:107], a[104:107], a[36:39], v[104:107]
  v_mfma_f32_16x16x32_bf16 v[136:139], a[104:107], a[40:43], v[136:139]
  ds_read_b128 a[24:27], v16 offset:12288
  v_mfma_f32_16x16x32_bf16 v[168:171], a[104:107], a[44:47], v[168:171]
  v_mfma_f32_16x16x32_bf16 v[200:203], a[104:107], a[48:51], v[200:203]
  ds_read_b128 a[28:31], v16 offset:14336
  v_mfma_f32_16x16x32_bf16 v[232:235], a[104:107], a[52:55], v[232:235]
  v_mfma_f32_16x16x32_bf16 a[136:139], a[104:107], a[56:59], a[136:139]
  ds_read_b64_tr_b16 a[68:69], v19 offset:0
  v_mfma_f32_16x16x32_bf16 a[168:171], a[104:107], a[60:63], a[168:171]
  buffer_load_dwordx4 v59, s[12:15], s47 offen offset:3072 lds
  v_mfma_f32_16x16x32_bf16 v[76:79], a[108:111], a[32:35], v[76:79]
  s_add_u32 m0, s41, 4096
  ds_read_b64_tr_b16 a[70:71], v19 offset:2048
  v_mfma_f32_16x16x32_bf16 v[108:111], a[108:111], a[36:39], v[108:111]
  v_mfma_f32_16x16x32_bf16 v[140:143], a[108:111], a[40:43], v[140:143]
  v_mfma_f32_16x16x32_bf16 v[172:175], a[108:111], a[44:47], v[172:175]
  ds_read_b64_tr_b16 a[72:73], v20 offset:0
  v_mfma_f32_16x16x32_bf16 v[204:207], a[108:111], a[48:51], v[204:207]
  v_mfma_f32_16x16x32_bf16 v[236:239], a[108:111], a[52:55], v[236:239]
  ds_read_b64_tr_b16 a[74:75], v20 offset:2048
  v_mfma_f32_16x16x32_bf16 a[140:143], a[108:111], a[56:59], a[140:143]
  v_mfma_f32_16x16x32_bf16 a[172:175], a[108:111], a[60:63], a[172:175]
  buffer_load_dwordx4 v60, s[12:15], s47 offen offset:0 lds
  v_mfma_f32_16x16x32_bf16 v[80:83], a[112:115], a[32:35], v[80:83]
  ds_read_b64_tr_b16 a[76:77], v21 offset:0
  v_mfma_f32_16x16x32_bf16 v[112:115], a[112:115], a[36:39], v[112:115]
  ds_read_b64_tr_b16 a[78:79], v21 offset:2048
  v_mfma_f32_16x16x32_bf16 v[144:147], a[112:115], a[40:43], v[144:147]
  v_mfma_f32_16x16x32_bf16 v[176:179], a[112:115], a[44:47], v[176:179]
  v_mfma_f32_16x16x32_bf16 v[208:211], a[112:115], a[48:51], v[208:211]
  ds_read_b64_tr_b16 a[80:81], v18 offset:8192
  v_mfma_f32_16x16x32_bf16 v[240:243], a[112:115], a[52:55], v[240:243]
  v_mfma_f32_16x16x32_bf16 a[144:147], a[112:115], a[56:59], a[144:147]
  ds_read_b64_tr_b16 a[82:83], v18 offset:10240
  v_mfma_f32_16x16x32_bf16 a[176:179], a[112:115], a[60:63], a[176:179]
  buffer_load_dwordx4 v61, s[12:15], s47 offen offset:1024 lds
  v_mfma_f32_16x16x32_bf16 v[84:87], a[116:119], a[32:35], v[84:87]
  ds_read_b64_tr_b16 a[84:85], v19 offset:8192
  v_mfma_f32_16x16x32_bf16 v[116:119], a[116:119], a[36:39], v[116:119]
  v_mfma_f32_16x16x32_bf16 v[148:151], a[116:119], a[40:43], v[148:151]
  ds_read_b64_tr_b16 a[86:87], v19 offset:10240
  v_mfma_f32_16x16x32_bf16 v[180:183], a[116:119], a[44:47], v[180:183]
  v_mfma_f32_16x16x32_bf16 v[212:215], a[116:119], a[48:51], v[212:215]
  v_mfma_f32_16x16x32_bf16 v[244:247], a[116:119], a[52:55], v[244:247]
  ds_read_b64_tr_b16 a[88:89], v20 offset:8192
  v_mfma_f32_16x16x32_bf16 a[148:151], a[116:119], a[56:59], a[148:151]
  v_mfma_f32_16x16x32_bf16 a[180:183], a[116:119], a[60:63], a[180:183]
  buffer_load_dwordx4 v62, s[12:15], s47 offen offset:2048 lds
  v_mfma_f32_16x16x32_bf16 v[88:91], a[120:123], a[32:35], v[88:91]
  ds_read_b64_tr_b16 a[90:91], v20 offset:10240
  v_mfma_f32_16x16x32_bf16 v[120:123], a[120:123], a[36:39], v[120:123]
  ds_read_b64_tr_b16 a[92:93], v21 offset:8192
  v_mfma_f32_16x16x32_bf16 v[152:155], a[120:123], a[40:43], v[152:155]
  v_mfma_f32_16x16x32_bf16 v[184:187], a[120:123], a[44:47], v[184:187]
  ds_read_b64_tr_b16 a[94:95], v21 offset:10240
  v_mfma_f32_16x16x32_bf16 v[216:219], a[120:123], a[48:51], v[216:219]
  v_mfma_f32_16x16x32_bf16 v[248:251], a[120:123], a[52:55], v[248:251]
  v_mfma_f32_16x16x32_bf16 a[152:155], a[120:123], a[56:59], a[152:155]
  v_mfma_f32_16x16x32_bf16 a[184:187], a[120:123], a[60:63], a[184:187]
  buffer_load_dwordx4 v63, s[12:15], s47 offen offset:3072 lds
  v_mfma_f32_16x16x32_bf16 v[92:95], a[124:127], a[32:35], v[92:95]
  v_mfma_f32_16x16x32_bf16 v[124:127], a[124:127], a[36:39], v[124:127]
  v_mfma_f32_16x16x32_bf16 v[156:159], a[124:127], a[40:43], v[156:159]
  v_mfma_f32_16x16x32_bf16 v[188:191], a[124:127], a[44:47], v[188:191]
  v_mfma_f32_16x16x32_bf16 v[220:223], a[124:127], a[48:51], v[220:223]
  v_mfma_f32_16x16x32_bf16 v[252:255], a[124:127], a[52:55], v[252:255]
  v_mfma_f32_16x16x32_bf16 a[156:159], a[124:127], a[56:59], a[156:159]
  v_mfma_f32_16x16x32_bf16 a[188:191], a[124:127], a[60:63], a[188:191]
  s_waitcnt lgkmcnt(0)
  v_mfma_f32_16x16x32_bf16 v[64:67], a[64:67], a[0:3], v[64:67]
  s_mov_b32 m0, s36
  ds_read_b128 a[32:35], v17 offset:0
  v_mfma_f32_16x16x32_bf16 v[96:99], a[64:67], a[4:7], v[96:99]
  buffer_load_dwordx4 v48, s[8:11], s46 offen offset:0 lds
  v_mfma_f32_16x16x32_bf16 v[128:131], a[64:67], a[8:11], v[128:131]
  ds_read_b64_tr_b16 a[96:97], v18 offset:4096
  v_mfma_f32_16x16x32_bf16 v[160:163], a[64:67], a[12:15], v[160:163]
  v_mfma_f32_16x16x32_bf16 v[192:195], a[64:67], a[16:19], v[192:195]
  ds_read_b64_tr_b16 a[98:99], v18 offset:6144
  v_mfma_f32_16x16x32_bf16 v[224:227], a[64:67], a[20:23], v[224:227]
  v_mfma_f32_16x16x32_bf16 a[128:131], a[64:67], a[24:27], a[128:131]
  ds_read_b128 a[36:39], v17 offset:2048
  v_mfma_f32_16x16x32_bf16 a[160:163], a[64:67], a[28:31], a[160:163]
  buffer_load_dwordx4 v49, s[8:11], s46 offen offset:1024 lds
  v_mfma_f32_16x16x32_bf16 v[68:71], a[68:71], a[0:3], v[68:71]
  v_mfma_f32_16x16x32_bf16 v[100:103], a[68:71], a[4:7], v[100:103]
  ds_read_b128 a[40:43], v17 offset:4096
  v_mfma_f32_16x16x32_bf16 v[132:135], a[68:71], a[8:11], v[132:135]
  v_mfma_f32_16x16x32_bf16 v[164:167], a[68:71], a[12:15], v[164:167]
  ds_read_b128 a[44:47], v17 offset:6144
  v_mfma_f32_16x16x32_bf16 v[196:199], a[68:71], a[16:19], v[196:199]
  v_mfma_f32_16x16x32_bf16 v[228:231], a[68:71], a[20:23], v[228:231]
  ds_read_b128 a[48:51], v17 offset:8192
  v_mfma_f32_16x16x32_bf16 a[132:135], a[68:71], a[24:27], a[132:135]
  buffer_load_dwordx4 v50, s[8:11], s46 offen offset:2048 lds
  v_mfma_f32_16x16x32_bf16 a[164:167], a[68:71], a[28:31], a[164:167]
  ds_read_b128 a[52:55], v17 offset:10240
  v_mfma_f32_16x16x32_bf16 v[72:75], a[72:75], a[0:3], v[72:75]
  v_mfma_f32_16x16x32_bf16 v[104:107], a[72:75], a[4:7], v[104:107]
  v_mfma_f32_16x16x32_bf16 v[136:139], a[72:75], a[8:11], v[136:139]
  ds_read_b128 a[56:59], v17 offset:12288
  v_mfma_f32_16x16x32_bf16 v[168:171], a[72:75], a[12:15], v[168:171]
  v_mfma_f32_16x16x32_bf16 v[200:203], a[72:75], a[16:19], v[200:203]
  ds_read_b128 a[60:63], v17 offset:14336
  v_mfma_f32_16x16x32_bf16 v[232:235], a[72:75], a[20:23], v[232:235]
  buffer_load_dwordx4 v51, s[8:11], s46 offen offset:3072 lds
  v_mfma_f32_16x16x32_bf16 a[136:139], a[72:75], a[24:27], a[136:139]
  s_add_u32 m0, s36, 4096
  ds_read_b64_tr_b16 a[100:101], v19 offset:4096
  v_mfma_f32_16x16x32_bf16 a[168:171], a[72:75], a[28:31], a[168:171]
  s_add_u32 s36, s36, s38
  v_mfma_f32_16x16x32_bf16 v[76:79], a[76:79], a[0:3], v[76:79]
  s_add_u32 s37, s37, 1
  ds_read_b64_tr_b16 a[102:103], v19 offset:6144
  v_mfma_f32_16x16x32_bf16 v[108:111], a[76:79], a[4:7], v[108:111]
  s_cmp_eq_u32 s37, 3
  s_cselect_b32 s37, 0, s37
  s_cselect_b32 s38, s39, s40
  v_mfma_f32_16x16x32_bf16 v[140:143], a[76:79], a[8:11], v[140:143]
  s_add_u32 s41, s41, s43
  v_mfma_f32_16x16x32_bf16 v[172:175], a[76:79], a[12:15], v[172:175]
  s_sub_u32 s43, 0, s43
  ds_read_b64_tr_b16 a[104:105], v20 offset:4096
  v_mfma_f32_16x16x32_bf16 v[204:207], a[76:79], a[16:19], v[204:207]
  buffer_load_dwordx4 v52, s[8:11], s46 offen offset:0 lds
  v_mfma_f32_16x16x32_bf16 v[236:239], a[76:79], a[20:23], v[236:239]
  ds_read_b64_tr_b16 a[106:107], v20 offset:6144
  v_mfma_f32_16x16x32_bf16 a[140:143], a[76:79], a[24:27], a[140:143]
  v_mfma_f32_16x16x32_bf16 a[172:175], a[76:79], a[28:31], a[172:175]
  ds_read_b64_tr_b16 a[108:109], v21 offset:4096
  v_mfma_f32_16x16x32_bf16 v[80:83], a[80:83], a[0:3], v[80:83]
  v_mfma_f32_16x16x32_bf16 v[112:115], a[80:83], a[4:7], v[112:115]
  ds_read_b64_tr_b16 a[110:111], v21 offset:6144
  v_mfma_f32_16x16x32_bf16 v[144:147], a[80:83], a[8:11], v[144:147]
  v_mfma_f32_16x16x32_bf16 v[176:179], a[80:83], a[12:15], v[176:179]
  buffer_load_dwordx4 v53, s[8:11], s46 offen offset:1024 lds
  v_mfma_f32_16x16x32_bf16 v[208:211], a[80:83], a[16:19], v[208:211]
  ds_read_b64_tr_b16 a[112:113], v18 offset:12288
  v_mfma_f32_16x16x32_bf16 v[240:243], a[80:83], a[20:23], v[240:243]
  v_mfma_f32_16x16x32_bf16 a[144:147], a[80:83], a[24:27], a[144:147]
  ds_read_b64_tr_b16 a[114:115], v18 offset:14336
  v_mfma_f32_16x16x32_bf16 a[176:179], a[80:83], a[28:31], a[176:179]
  v_mfma_f32_16x16x32_bf16 v[84:87], a[84:87], a[0:3], v[84:87]
  ds_read_b64_tr_b16 a[116:117], v19 offset:12288
  v_mfma_f32_16x16x32_bf16 v[116:119], a[84:87], a[4:7], v[116:119]
  v_mfma_f32_16x16x32_bf16 v[148:151], a[84:87], a[8:11], v[148:151]
  buffer_load_dwordx4 v54, s[8:11], s46 offen offset:2048 lds
  v_mfma_f32_16x16x32_bf16 v[180:183], a[84:87], a[12:15], v[180:183]
  ds_read_b64_tr_b16 a[118:119], v19 offset:14336
  v_mfma_f32_16x16x32_bf16 v[212:215], a[84:87], a[16:19], v[212:215]
  v_mfma_f32_16x16x32_bf16 v[244:247], a[84:87], a[20:23], v[244:247]
  ds_read_b64_tr_b16 a[120:121], v20 offset:12288
  v_mfma_f32_16x16x32_bf16 a[148:151], a[84:87], a[24:27], a[148:151]
  v_mfma_f32_16x16x32_bf16 a[180:183], a[84:87], a[28:31], a[180:183]
  ds_read_b64_tr_b16 a[122:123], v20 offset:14336
  v_mfma_f32_16x16x32_bf16 v[88:91], a[88:91], a[0:3], v[88:91]
  v_mfma_f32_16x16x32_bf16 v[120:123], a[88:91], a[4:7], v[120:123]
  buffer_load_dwordx4 v55, s[8:11], s46 offen offset:3072 lds
  v_mfma_f32_16x16x32_bf16 v[152:155], a[88:91], a[8:11], v[152:155]
  s_sub_u32 s50, s50, 1
  ds_read_b64_tr_b16 a[124:125], v21 offset:12288
  v_mfma_f32_16x16x32_bf16 v[184:187], a[88:91], a[12:15], v[184:187]
  ds_read_b64_tr_b16 a[126:127], v21 offset:14336
  v_mfma_f32_16x16x32_bf16 v[216:219], a[88:91], a[16:19], v[216:219]
  s_cmp_eq_u32 s50, 0
  s_cselect_b32 s12, s72, s12
  s_cselect_b32 s13, s73, s13
  v_mfma_f32_16x16x32_bf16 v[248:251], a[88:91], a[20:23], v[248:251]
  s_lshl_b32 s47, s48, 19
  v_add_u32 v16, s38, v16
  v_add_u32 v17, s38, v17
  v_mfma_f32_16x16x32_bf16 a[152:155], a[88:91], a[24:27], a[152:155]
  s_bfe_u32 s34, 0x3020106, s49
  v_add_u32 v18, s43, v18
  v_add_u32 v19, s43, v19
  v_mfma_f32_16x16x32_bf16 a[184:187], a[88:91], a[28:31], a[184:187]
  s_add_u32 s48, s48, s34
  v_add_u32 v20, s43, v20
  v_add_u32 v21, s43, v21
  v_mfma_f32_16x16x32_bf16 v[92:95], a[92:95], a[0:3], v[92:95]
  s_add_u32 s49, s49, 8
  v_mfma_f32_16x16x32_bf16 v[124:127], a[92:95], a[4:7], v[124:127]
  s_and_b32 s49, s49, 0x8001f
  v_mfma_f32_16x16x32_bf16 v[156:159], a[92:95], a[8:11], v[156:159]
  s_and_b32 s48, s48, 7
  v_mfma_f32_16x16x32_bf16 v[188:191], a[92:95], a[12:15], v[188:191]
  s_lshl_b32 s46, s48, 7
  v_mfma_f32_16x16x32_bf16 v[220:223], a[92:95], a[16:19], v[220:223]
  v_mfma_f32_16x16x32_bf16 v[252:255], a[92:95], a[20:23], v[252:255]
  s_waitcnt vmcnt(8) lgkmcnt(0)
  s_barrier
  v_mfma_f32_16x16x32_bf16 a[156:159], a[92:95], a[24:27], a[156:159]
  s_sub_u32 s35, s35, 1
  v_mfma_f32_16x16x32_bf16 a[188:191], a[92:95], a[28:31], a[188:191]
  s_cmp_lg_u32 s35, 0
  s_cbranch_scc1 Lp1wx_loop
  v_mfma_f32_16x16x32_bf16 v[64:67], a[96:99], a[32:35], v[64:67]
  s_mov_b32 m0, s41
  ds_read_b128 a[0:3], v16 offset:0
  v_mfma_f32_16x16x32_bf16 v[96:99], a[96:99], a[36:39], v[96:99]
  buffer_load_dwordx4 v56, s[12:15], s47 offen offset:0 lds
  v_mfma_f32_16x16x32_bf16 v[128:131], a[96:99], a[40:43], v[128:131]
  ds_read_b64_tr_b16 a[64:65], v18 offset:0
  v_mfma_f32_16x16x32_bf16 v[160:163], a[96:99], a[44:47], v[160:163]
  buffer_load_dwordx4 v57, s[12:15], s47 offen offset:1024 lds
  v_mfma_f32_16x16x32_bf16 v[192:195], a[96:99], a[48:51], v[192:195]
  ds_read_b64_tr_b16 a[66:67], v18 offset:2048
  v_mfma_f32_16x16x32_bf16 v[224:227], a[96:99], a[52:55], v[224:227]
  v_mfma_f32_16x16x32_bf16 a[128:131], a[96:99], a[56:59], a[128:131]
  ds_read_b128 a[4:7], v16 offset:2048
  v_mfma_f32_16x16x32_bf16 a[160:163], a[96:99], a[60:63], a[160:163]
  buffer_load_dwordx4 v58, s[12:15], s47 offen offset:2048 lds
  v_mfma_f32_16x16x32_bf16 v[68:71], a[100:103], a[32:35], v[68:71]
  v_mfma_f32_16x16x32_bf16 v[100:103], a[100:103], a[36:39], v[100:103]
  ds_read_b128 a[8:11], v16 offset:4096
  v_mfma_f32_16x16x32_bf16 v[132:135], a[100:103], a[40:43], v[132:135]
  v_mfma_f32_16x16x32_bf16 v[164:167], a[100:103], a[44:47], v[164:167]
  buffer_load_dwordx4 v59, s[12:15], s47 offen offset:3072 lds
  v_mfma_f32_16x16x32_bf16 v[196:199], a[100:103], a[48:51], v[196:199]
  s_add_u32 m0, s41, 4096
  ds_read_b128 a[12:15], v16 offset:6144
  v_mfma_f32_16x16x32_bf16 v[228:231], a[100:103], a[52:55], v[228:231]
  ds_read_b128 a[16:19], v16 offset:8192
  v_mfma_f32_16x16x32_bf16 a[132:135], a[100:103], a[56:59], a[132:135]
  v_mfma_f32_16x16x32_bf16 a[164:167], a[100:103], a[60:63], a[164:167]
  buffer_load_dwordx4 v60, s[12:15], s47 offen offset:0 lds
  v_mfma_f32_16x16x32_bf16 v[72:75], a[104:107], a[32:35], v[72:75]
  ds_read_b128 a[20:23], v16 offset:10240
  v_mfma_f32_16x16x32_bf16 v[104:107], a[104:107], a[36:39], v[104:107]
  v_mfma_f32_16x16x32_bf16 v[136:139], a[104:107], a[40:43], v[136:139]
  ds_read_b128 a[24:27], v16 offset:12288
  v_mfma_f32_16x16x32_bf16 v[168:171], a[104:107], a[44:47], v[168:171]
  buffer_load_dwordx4 v61, s[12:15], s47 offen offset:1024 lds
  v_mfma_f32_16x16x32_bf16 v[200:203], a[104:107], a[48:51], v[200:203]
  ds_read_b128 a[28:31], v16 offset:14336
  v_mfma_f32_16x16x32_bf16 v[232:235], a[104:107], a[52:55], v[232:235]
  v_mfma_f32_16x16x32_bf16 a[136:139], a[104:107], a[56:59], a[136:139]
  ds_read_b64_tr_b16 a[68:69], v19 offset:0
  v_mfma_f32_16x16x32_bf16 a[168:171], a[104:107], a[60:63], a[168:171]
  buffer_load_dwordx4 v62, s[12:15], s47 offen offset:2048 lds
  v_mfma_f32_16x16x32_bf16 v[76:79], a[108:111], a[32:35], v[76:79]
  ds_read_b64_tr_b16 a[70:71], v19 offset:2048
  v_mfma_f32_16x16x32_bf16 v[108:111], a[108:111], a[36:39], v[108:111]
  v_mfma_f32_16x16x32_bf16 v[140:143], a[108:111], a[40:43], v[140:143]
  v_mfma_f32_16x16x32_bf16 v[172:175], a[108:111], a[44:47], v[172:175]
  buffer_load_dwordx4 v63, s[12:15], s47 offen offset:3072 lds
  v_mfma_f32_16x16x32_bf16 v[204:207], a[108:111], a[48:51], v[204:207]
  s_mov_b32 m0, s36
  ds_read_b64_tr_b16 a[72:73], v20 offset:0
  v_mfma_f32_16x16x32_bf16 v[236:239], a[108:111], a[52:55], v[236:239]
  ds_read_b64_tr_b16 a[74:75], v20 offset:2048
  v_mfma_f32_16x16x32_bf16 a[140:143], a[108:111], a[56:59], a[140:143]
  v_mfma_f32_16x16x32_bf16 a[172:175], a[108:111], a[60:63], a[172:175]
  buffer_load_dwordx4 v48, s[8:11], s46 offen offset:0 lds
  v_mfma_f32_16x16x32_bf16 v[80:83], a[112:115], a[32:35], v[80:83]
  ds_read_b64_tr_b16 a[76:77], v21 offset:0
  v_mfma_f32_16x16x32_bf16 v[112:115], a[112:115], a[36:39], v[112:115]
  ds_read_b64_tr_b16 a[78:79], v21 offset:2048
  v_mfma_f32_16x16x32_bf16 v[144:147], a[112:115], a[40:43], v[144:147]
  v_mfma_f32_16x16x32_bf16 v[176:179], a[112:115], a[44:47], v[176:179]
  buffer_load_dwordx4 v49, s[8:11], s46 offen offset:1024 lds
  v_mfma_f32_16x16x32_bf16 v[208:211], a[112:115], a[48:51], v[208:211]
  ds_read_b64_tr_b16 a[80:81], v18 offset:8192
  v_mfma_f32_16x16x32_bf16 v[240:243], a[112:115], a[52:55], v[240:243]
  v_mfma_f32_16x16x32_bf16 a[144:147], a[112:115], a[56:59], a[144:147]
  ds_read_b64_tr_b16 a[82:83], v18 offset:10240
  v_mfma_f32_16x16x32_bf16 a[176:179], a[112:115], a[60:63], a[176:179]
  buffer_load_dwordx4 v50, s[8:11], s46 offen offset:2048 lds
  v_mfma_f32_16x16x32_bf16 v[84:87], a[116:119], a[32:35], v[84:87]
  ds_read_b64_tr_b16 a[84:85], v19 offset:8192
  v_mfma_f32_16x16x32_bf16 v[116:119], a[116:119], a[36:39], v[116:119]
  v_mfma_f32_16x16x32_bf16 v[148:151], a[116:119], a[40:43], v[148:151]
  ds_read_b64_tr_b16 a[86:87], v19 offset:10240
  v_mfma_f32_16x16x32_bf16 v[180:183], a[116:119], a[44:47], v[180:183]
  buffer_load_dwordx4 v51, s[8:11], s46 offen offset:3072 lds
  v_mfma_f32_16x16x32_bf16 v[212:215], a[116:119], a[48:51], v[212:215]
  s_add_u32 m0, s36, 4096
  v_mfma_f32_16x16x32_bf16 v[244:247], a[116:119], a[52:55], v[244:247]
  ds_read_b64_tr_b16 a[88:89], v20 offset:8192
  v_mfma_f32_16x16x32_bf16 a[148:151], a[116:119], a[56:59], a[148:151]
  v_mfma_f32_16x16x32_bf16 a[180:183], a[116:119], a[60:63], a[180:183]
  buffer_load_dwordx4 v52, s[8:11], s46 offen offset:0 lds
  v_mfma_f32_16x16x32_bf16 v[88:91], a[120:123], a[32:35], v[88:91]
  ds_read_b64_tr_b16 a[90:91], v20 offset:10240
  v_mfma_f32_16x16x32_bf16 v[120:123], a[120:123], a[36:39], v[120:123]
  ds_read_b64_tr_b16 a[92:93], v21 offset:8192
  v_mfma_f32_16x16x32_bf16 v[152:155], a[120:123], a[40:43], v[152:155]
  v_mfma_f32_16x16x32_bf16 v[184:187], a[120:123], a[44:47], v[184:187]
  buffer_load_dwordx4 v53, s[8:11], s46 offen offset:1024 lds
  v_mfma_f32_16x16x32_bf16 v[216:219], a[120:123], a[48:51], v[216:219]
  ds_read_b64_tr_b16 a[94:95], v21 offset:10240
  v_mfma_f32_16x16x32_bf16 v[248:251], a[120:123], a[52:55], v[248:251]
  v_mfma_f32_16x16x32_bf16 a[152:155], a[120:123], a[56:59], a[152:155]
  v_mfma_f32_16x16x32_bf16 a[184:187], a[120:123], a[60:63], a[184:187]
  buffer_load_dwordx4 v54, s[8:11], s46 offen offset:2048 lds
  v_mfma_f32_16x16x32_bf16 v[92:95], a[124:127], a[32:35], v[92:95]
  v_mfma_f32_16x16x32_bf16 v[124:127], a[124:127], a[36:39], v[124:127]
  v_mfma_f32_16x16x32_bf16 v[156:159], a[124:127], a[40:43], v[156:159]
  v_mfma_f32_16x16x32_bf16 v[188:191], a[124:127], a[44:47], v[188:191]
  buffer_load_dwordx4 v55, s[8:11], s46 offen offset:3072 lds
  v_mfma_f32_16x16x32_bf16 v[220:223], a[124:127], a[48:51], v[220:223]
  s_sub_u32 s50, s50, 1
  v_mfma_f32_16x16x32_bf16 v[252:255], a[124:127], a[52:55], v[252:255]
  s_cmp_eq_u32 s50, 0
  s_cselect_b32 s12, s72, s12
  s_cselect_b32 s13, s73, s13
  v_mfma_f32_16x16x32_bf16 a[156:159], a[124:127], a[56:59], a[156:159]
  s_lshl_b32 s47, s48, 19
  s_bfe_u32 s34, 0x3020106, s49
  s_add_u32 s48, s48, s34
  v_mfma_f32_16x16x32_bf16 a[188:191], a[124:127], a[60:63], a[188:191]
  s_add_u32 s49, s49, 8
  s_and_b32 s49, s49, 0x8001f
  s_and_b32 s48, s48, 7
  s_lshl_b32 s46, s48, 7
  s_waitcnt lgkmcnt(0)
  v_mfma_f32_16x16x32_bf16 v[128:131], a[64:67], a[8:11], v[128:131]
  ds_read_b128 a[32:35], v17 offset:0
  ds_read_b64_tr_b16 a[96:97], v18 offset:4096
  v_mfma_f32_16x16x32_bf16 v[132:135], a[68:71], a[8:11], v[132:135]
  ds_read_b64_tr_b16 a[98:99], v18 offset:6144
  ds_read_b128 a[36:39], v17 offset:2048
  v_mfma_f32_16x16x32_bf16 a[128:131], a[64:67], a[24:27], a[128:131]
  ds_read_b128 a[40:43], v17 offset:4096
  ds_read_b128 a[44:47], v17 offset:6144
  v_mfma_f32_16x16x32_bf16 a[132:135], a[68:71], a[24:27], a[132:135]
  ds_read_b128 a[48:51], v17 offset:8192
  ds_read_b128 a[52:55], v17 offset:10240
  v_mfma_f32_16x16x32_bf16 v[136:139], a[72:75], a[8:11], v[136:139]
  ds_read_b128 a[56:59], v17 offset:12288
  ds_read_b128 a[60:63], v17 offset:14336
  v_mfma_f32_16x16x32_bf16 v[140:143], a[76:79], a[8:11], v[140:143]
  ds_read_b64_tr_b16 a[100:101], v19 offset:4096
  ds_read_b64_tr_b16 a[102:103], v19 offset:6144
  v_mfma_f32_16x16x32_bf16 a[136:139], a[72:75], a[24:27], a[136:139]
  ds_read_b64_tr_b16 a[104:105], v20 offset:4096
  v_mfma_f32_16x16x32_bf16 a[140:143], a[76:79], a[24:27], a[140:143]
  ds_read_b64_tr_b16 a[106:107], v20 offset:6144
  ds_read_b64_tr_b16 a[108:109], v21 offset:4096
  v_mfma_f32_16x16x32_bf16 v[144:147], a[80:83], a[8:11], v[144:147]
  ds_read_b64_tr_b16 a[110:111], v21 offset:6144
  ds_read_b64_tr_b16 a[112:113], v18 offset:12288
  v_mfma_f32_16x16x32_bf16 v[148:151], a[84:87], a[8:11], v[148:151]
  ds_read_b64_tr_b16 a[114:115], v18 offset:14336
  ds_read_b64_tr_b16 a[116:117], v19 offset:12288
  v_mfma_f32_16x16x32_bf16 a[144:147], a[80:83], a[24:27], a[144:147]
  ds_read_b64_tr_b16 a[118:119], v19 offset:14336
  ds_read_b64_tr_b16 a[120:121], v20 offset:12288
  v_mfma_f32_16x16x32_bf16 a[148:151], a[84:87], a[24:27], a[148:151]
  ds_read_b64_tr_b16 a[122:123], v20 offset:14336
  ds_read_b64_tr_b16 a[124:125], v21 offset:12288
  v_mfma_f32_16x16x32_bf16 v[152:155], a[88:91], a[8:11], v[152:155]
  ds_read_b64_tr_b16 a[126:127], v21 offset:14336
  v_mfma_f32_16x16x32_bf16 v[156:159], a[92:95], a[8:11], v[156:159]
  v_mfma_f32_16x16x32_bf16 a[152:155], a[88:91], a[24:27], a[152:155]
  v_mfma_f32_16x16x32_bf16 a[156:159], a[92:95], a[24:27], a[156:159]
  v_mfma_f32_16x16x32_bf16 v[160:163], a[64:67], a[12:15], v[160:163]
  v_mfma_f32_16x16x32_bf16 v[164:167], a[68:71], a[12:15], v[164:167]
  s_add_u32 s36, s36, s38
  s_add_u32 s37, s37, 1
  s_cmp_eq_u32 s37, 3
  s_cselect_b32 s37, 0, s37
  s_cselect_b32 s38, s39, s40
  v_add_u32 v16, s38, v16
  v_add_u32 v17, s38, v17
  s_add_u32 s41, s41, s43
  s_sub_u32 s43, 0, s43
  v_add_u32 v18, s43, v18
  v_add_u32 v19, s43, v19
  v_add_u32 v20, s43, v20
  v_add_u32 v21, s43, v21
  s_waitcnt vmcnt(8) lgkmcnt(0)
  s_barrier
  v_mfma_f32_16x16x32_bf16 v[128:131], a[96:99], a[40:43], v[128:131]
  s_mov_b32 m0, s41
  v_mfma_f32_16x16x32_bf16 v[132:135], a[100:103], a[40:43], v[132:135]
  buffer_load_dwordx4 v56, s[12:15], s47 offen offset:0 lds
  v_mfma_f32_16x16x32_bf16 a[128:131], a[96:99], a[56:59], a[128:131]
  v_mfma_f32_16x16x32_bf16 a[132:135], a[100:103], a[56:59], a[132:135]
  v_mfma_f32_16x16x32_bf16 v[136:139], a[104:107], a[40:43], v[136:139]
  v_mfma_f32_16x16x32_bf16 v[140:143], a[108:111], a[40:43], v[140:143]
  buffer_load_dwordx4 v57, s[12:15], s47 offen offset:1024 lds
  v_cvt_pk_bf16_f32 v128, v128, v129
  v_mfma_f32_16x16x32_bf16 a[136:139], a[104:107], a[56:59], a[136:139]
  v_cvt_pk_bf16_f32 v129, v130, v131
  v_cvt_pk_bf16_f32 v130, v132, v133
  v_mfma_f32_16x16x32_bf16 a[140:143], a[108:111], a[56:59], a[140:143]
  v_cvt_pk_bf16_f32 v131, v134, v135
  v_accvgpr_read_b32 v24, a128
  v_mfma_f32_16x16x32_bf16 v[144:147], a[112:115], a[40:43], v[144:147]
  v_accvgpr_read_b32 v25, a129
  v_accvgpr_read_b32 v26, a130
  v_mfma_f32_16x16x32_bf16 v[148:151], a[116:119], a[40:43], v[148:151]
  v_accvgpr_read_b32 v27, a131
  v_accvgpr_read_b32 v28, a132
  v_mfma_f32_16x16x32_bf16 a[144:147], a[112:115], a[56:59], a[144:147]
  v_accvgpr_read_b32 v29, a133
  v_accvgpr_read_b32 v30, a134
  v_mfma_f32_16x16x32_bf16 a[148:151], a[116:119], a[56:59], a[148:151]
  buffer_load_dwordx4 v58, s[12:15], s47 offen offset:2048 lds
  v_accvgpr_read_b32 v31, a135
  v_mfma_f32_16x16x32_bf16 v[152:155], a[120:123], a[40:43], v[152:155]
  v_cvt_pk_bf16_f32 v132, v24, v25
  v_cvt_pk_bf16_f32 v133, v26, v27
  v_mfma_f32_16x16x32_bf16 v[156:159], a[124:127], a[40:43], v[156:159]
  v_cvt_pk_bf16_f32 v134, v28, v29
  v_cvt_pk_bf16_f32 v135, v30, v31
  v_mfma_f32_16x16x32_bf16 a[152:155], a[120:123], a[56:59], a[152:155]
  s_add_u32 s60, s63, 8192
  buffer_store_dwordx4 v[128:131], v2, s[16:19], s60 offen offset:0 sc1
  v_cvt_pk_bf16_f32 v136, v136, v137
  v_mfma_f32_16x16x32_bf16 a[156:159], a[124:127], a[56:59], a[156:159]
  v_cvt_pk_bf16_f32 v137, v138, v139
  v_cvt_pk_bf16_f32 v138, v140, v141
  v_mfma_f32_16x16x32_bf16 v[160:163], a[96:99], a[44:47], v[160:163]
  v_cvt_pk_bf16_f32 v139, v142, v143
  v_mfma_f32_16x16x32_bf16 v[164:167], a[100:103], a[44:47], v[164:167]
  buffer_load_dwordx4 v59, s[12:15], s47 offen offset:3072 lds
  v_mfma_f32_16x16x32_bf16 a[160:163], a[64:67], a[28:31], a[160:163]
  s_add_u32 m0, s41, 4096
  v_mfma_f32_16x16x32_bf16 a[164:167], a[68:71], a[28:31], a[164:167]
  s_add_u32 s60, s63, 40960
  buffer_store_dwordx4 v[132:135], v2, s[16:19], s60 offen offset:0 sc1
  v_accvgpr_read_b32 v32, a136
  v_mfma_f32_16x16x32_bf16 a[160:163], a[96:99], a[60:63], a[160:163]
  v_accvgpr_read_b32 v33, a137
  v_accvgpr_read_b32 v34, a138
  v_mfma_f32_16x16x32_bf16 a[164:167], a[100:103], a[60:63], a[164:167]
  v_accvgpr_read_b32 v35, a139
  v_accvgpr_read_b32 v36, a140
  v_mfma_f32_16x16x32_bf16 v[168:171], a[72:75], a[12:15], v[168:171]
  buffer_load_dwordx4 v60, s[12:15], s47 offen offset:0 lds
  v_accvgpr_read_b32 v37, a141
  v_mfma_f32_16x16x32_bf16 v[172:175], a[76:79], a[12:15], v[172:175]
  v_accvgpr_read_b32 v38, a142
  v_accvgpr_read_b32 v39, a143
  v_mfma_f32_16x16x32_bf16 v[168:171], a[104:107], a[44:47], v[168:171]
  v_cvt_pk_bf16_f32 v140, v32, v33
  v_cvt_pk_bf16_f32 v141, v34, v35
  v_mfma_f32_16x16x32_bf16 v[172:175], a[108:111], a[44:47], v[172:175]
  v_cvt_pk_bf16_f32 v142, v36, v37
  v_cvt_pk_bf16_f32 v143, v38, v39
  v_mfma_f32_16x16x32_bf16 a[168:171], a[72:75], a[28:31], a[168:171]
  s_add_u32 s60, s63, 8192
  buffer_store_dwordx4 v[136:139], v2, s[16:19], s60 offen offset:1024 sc1
  v_cvt_pk_bf16_f32 v144, v144, v145
  v_mfma_f32_16x16x32_bf16 a[172:175], a[76:79], a[28:31], a[172:175]
  v_cvt_pk_bf16_f32 v145, v146, v147
  v_cvt_pk_bf16_f32 v146, v148, v149
  v_mfma_f32_16x16x32_bf16 a[168:171], a[104:107], a[60:63], a[168:171]
  buffer_load_dwordx4 v61, s[12:15], s47 offen offset:1024 lds
  v_cvt_pk_bf16_f32 v147, v150, v151
  v_mfma_f32_16x16x32_bf16 a[172:175], a[108:111], a[60:63], a[172:175]
  s_add_u32 s60, s63, 40960
  buffer_store_dwordx4 v[140:143], v2, s[16:19], s60 offen offset:1024 sc1
  v_accvgpr_read_b32 v40, a144
  v_mfma_f32_16x16x32_bf16 v[176:179], a[80:83], a[12:15], v[176:179]
  v_accvgpr_read_b32 v41, a145
  v_accvgpr_read_b32 v42, a146
  v_mfma_f32_16x16x32_bf16 v[180:183], a[84:87], a[12:15], v[180:183]
  v_accvgpr_read_b32 v43, a147
  v_accvgpr_read_b32 v44, a148
  v_mfma_f32_16x16x32_bf16 v[176:179], a[112:115], a[44:47], v[176:179]
  v_accvgpr_read_b32 v45, a149
  v_accvgpr_read_b32 v46, a150
  v_mfma_f32_16x16x32_bf16 v[180:183], a[116:119], a[44:47], v[180:183]
  v_accvgpr_read_b32 v47, a151
  v_cvt_pk_bf16_f32 v148, v40, v41
  v_mfma_f32_16x16x32_bf16 a[176:179], a[80:83], a[28:31], a[176:179]
  buffer_load_dwordx4 v62, s[12:15], s47 offen offset:2048 lds
  v_cvt_pk_bf16_f32 v149, v42, v43
  v_mfma_f32_16x16x32_bf16 a[180:183], a[84:87], a[28:31], a[180:183]
  v_cvt_pk_bf16_f32 v150, v44, v45
  v_cvt_pk_bf16_f32 v151, v46, v47
  v_mfma_f32_16x16x32_bf16 a[176:179], a[112:115], a[60:63], a[176:179]
  s_add_u32 s60, s63, 8192
  buffer_store_dwordx4 v[144:147], v2, s[16:19], s60 offen offset:2048 sc1
  v_cvt_pk_bf16_f32 v152, v152, v153
  v_mfma_f32_16x16x32_bf16 a[180:183], a[116:119], a[60:63], a[180:183]
  v_cvt_pk_bf16_f32 v153, v154, v155
  v_cvt_pk_bf16_f32 v154, v156, v157
  v_mfma_f32_16x16x32_bf16 v[184:187], a[88:91], a[12:15], v[184:187]
  v_cvt_pk_bf16_f32 v155, v158, v159
  v_mfma_f32_16x16x32_bf16 v[188:191], a[92:95], a[12:15], v[188:191]
  buffer_load_dwordx4 v63, s[12:15], s47 offen offset:3072 lds
  v_mfma_f32_16x16x32_bf16 v[184:187], a[120:123], a[44:47], v[184:187]
  s_mov_b32 m0, s36
  v_mfma_f32_16x16x32_bf16 v[188:191], a[124:127], a[44:47], v[188:191]
  s_add_u32 s60, s63, 40960
  buffer_store_dwordx4 v[148:151], v2, s[16:19], s60 offen offset:2048 sc1
  v_accvgpr_read_b32 v24, a152
  v_mfma_f32_16x16x32_bf16 a[184:187], a[88:91], a[28:31], a[184:187]
  v_accvgpr_read_b32 v25, a153
  v_accvgpr_read_b32 v26, a154
  v_mfma_f32_16x16x32_bf16 a[188:191], a[92:95], a[28:31], a[188:191]
  v_accvgpr_read_b32 v27, a155
  v_accvgpr_read_b32 v28, a156
  v_mfma_f32_16x16x32_bf16 a[184:187], a[120:123], a[60:63], a[184:187]
  v_accvgpr_read_b32 v29, a157
  v_accvgpr_read_b32 v30, a158
  v_mfma_f32_16x16x32_bf16 a[188:191], a[124:127], a[60:63], a[188:191]
  buffer_load_dwordx4 v48, s[8:11], s46 offen offset:0 lds
  v_accvgpr_read_b32 v31, a159
  v_mfma_f32_16x16x32_bf16 v[192:195], a[64:67], a[16:19], v[192:195]
  v_cvt_pk_bf16_f32 v156, v24, v25
  v_cvt_pk_bf16_f32 v157, v26, v27
  v_mfma_f32_16x16x32_bf16 v[196:199], a[68:71], a[16:19], v[196:199]
  v_cvt_pk_bf16_f32 v158, v28, v29
  v_cvt_pk_bf16_f32 v159, v30, v31
  v_mfma_f32_16x16x32_bf16 v[192:195], a[96:99], a[48:51], v[192:195]
  v_cvt_pk_bf16_f32 v160, v160, v161
  v_cvt_pk_bf16_f32 v161, v162, v163
  v_mfma_f32_16x16x32_bf16 v[196:199], a[100:103], a[48:51], v[196:199]
  v_cvt_pk_bf16_f32 v162, v164, v165
  v_cvt_pk_bf16_f32 v163, v166, v167
  v_mfma_f32_16x16x32_bf16 v[64:67], a[64:67], a[0:3], v[64:67]
  s_add_u32 s60, s63, 8192
  buffer_store_dwordx4 v[152:155], v2, s[16:19], s60 offen offset:3072 sc1
  v_accvgpr_read_b32 v32, a160
  v_mfma_f32_16x16x32_bf16 v[68:71], a[68:71], a[0:3], v[68:71]
  buffer_load_dwordx4 v49, s[8:11], s46 offen offset:1024 lds
  v_accvgpr_read_b32 v33, a161
  v_mfma_f32_16x16x32_bf16 v[64:67], a[96:99], a[32:35], v[64:67]
  v_accvgpr_read_b32 v34, a162
  v_accvgpr_read_b32 v35, a163
  v_mfma_f32_16x16x32_bf16 v[68:71], a[100:103], a[32:35], v[68:71]
  v_accvgpr_read_b32 v36, a164
  v_accvgpr_read_b32 v37, a165
  v_mfma_f32_16x16x32_bf16 v[200:203], a[72:75], a[16:19], v[200:203]
  v_accvgpr_read_b32 v38, a166
  v_accvgpr_read_b32 v39, a167
  v_mfma_f32_16x16x32_bf16 v[204:207], a[76:79], a[16:19], v[204:207]
  v_cvt_pk_bf16_f32 v164, v32, v33
  v_cvt_pk_bf16_f32 v165, v34, v35
  v_mfma_f32_16x16x32_bf16 v[200:203], a[104:107], a[48:51], v[200:203]
  buffer_load_dwordx4 v50, s[8:11], s46 offen offset:2048 lds
  v_cvt_pk_bf16_f32 v166, v36, v37
  v_mfma_f32_16x16x32_bf16 v[204:207], a[108:111], a[48:51], v[204:207]
  v_cvt_pk_bf16_f32 v167, v38, v39
  v_mfma_f32_16x16x32_bf16 v[72:75], a[72:75], a[0:3], v[72:75]
  s_add_u32 s60, s63, 40960
  buffer_store_dwordx4 v[156:159], v2, s[16:19], s60 offen offset:3072 sc1
  v_cvt_pk_bf16_f32 v168, v168, v169
  v_mfma_f32_16x16x32_bf16 v[76:79], a[76:79], a[0:3], v[76:79]
  v_cvt_pk_bf16_f32 v169, v170, v171
  v_cvt_pk_bf16_f32 v170, v172, v173
  v_mfma_f32_16x16x32_bf16 v[72:75], a[104:107], a[32:35], v[72:75]
  v_cvt_pk_bf16_f32 v171, v174, v175
  v_mfma_f32_16x16x32_bf16 v[76:79], a[108:111], a[32:35], v[76:79]
  s_add_u32 s60, s63, 12288
  buffer_store_dwordx4 v[160:163], v2, s[16:19], s60 offen offset:0 sc1
  v_accvgpr_read_b32 v40, a168
  v_mfma_f32_16x16x32_bf16 v[208:211], a[80:83], a[16:19], v[208:211]
  buffer_load_dwordx4 v51, s[8:11], s46 offen offset:3072 lds
  v_accvgpr_read_b32 v41, a169
  v_mfma_f32_16x16x32_bf16 v[212:215], a[84:87], a[16:19], v[212:215]
  s_add_u32 m0, s36, 4096
  v_accvgpr_read_b32 v42, a170
  v_accvgpr_read_b32 v43, a171
  v_mfma_f32_16x16x32_bf16 v[208:211], a[112:115], a[48:51], v[208:211]
  v_accvgpr_read_b32 v44, a172
  v_accvgpr_read_b32 v45, a173
  v_mfma_f32_16x16x32_bf16 v[212:215], a[116:119], a[48:51], v[212:215]
  v_accvgpr_read_b32 v46, a174
  v_accvgpr_read_b32 v47, a175
  v_mfma_f32_16x16x32_bf16 v[80:83], a[80:83], a[0:3], v[80:83]
  v_cvt_pk_bf16_f32 v172, v40, v41
  v_cvt_pk_bf16_f32 v173, v42, v43
  v_mfma_f32_16x16x32_bf16 v[84:87], a[84:87], a[0:3], v[84:87]
  v_cvt_pk_bf16_f32 v174, v44, v45
  v_cvt_pk_bf16_f32 v175, v46, v47
  v_mfma_f32_16x16x32_bf16 v[80:83], a[112:115], a[32:35], v[80:83]
  buffer_load_dwordx4 v52, s[8:11], s46 offen offset:0 lds
  v_mfma_f32_16x16x32_bf16 v[84:87], a[116:119], a[32:35], v[84:87]
  s_add_u32 s60, s63, 45056
  buffer_store_dwordx4 v[164:167], v2, s[16:19], s60 offen offset:0 sc1
  v_cvt_pk_bf16_f32 v176, v176, v177
  v_mfma_f32_16x16x32_bf16 v[216:219], a[88:91], a[16:19], v[216:219]
  v_cvt_pk_bf16_f32 v177, v178, v179
  v_cvt_pk_bf16_f32 v178, v180, v181
  v_mfma_f32_16x16x32_bf16 v[220:223], a[92:95], a[16:19], v[220:223]
  v_cvt_pk_bf16_f32 v179, v182, v183
  v_mfma_f32_16x16x32_bf16 v[216:219], a[120:123], a[48:51], v[216:219]
  s_add_u32 s60, s63, 12288
  buffer_store_dwordx4 v[168:171], v2, s[16:19], s60 offen offset:1024 sc1
  v_accvgpr_read_b32 v24, a176
  v_mfma_f32_16x16x32_bf16 v[220:223], a[124:127], a[48:51], v[220:223]
  buffer_load_dwordx4 v53, s[8:11], s46 offen offset:1024 lds
  v_accvgpr_read_b32 v25, a177
  v_mfma_f32_16x16x32_bf16 v[88:91], a[88:91], a[0:3], v[88:91]
  v_accvgpr_read_b32 v26, a178
  v_accvgpr_read_b32 v27, a179
  v_mfma_f32_16x16x32_bf16 v[92:95], a[92:95], a[0:3], v[92:95]
  v_accvgpr_read_b32 v28, a180
  v_accvgpr_read_b32 v29, a181
  v_mfma_f32_16x16x32_bf16 v[224:227], a[64:67], a[20:23], v[224:227]
  v_accvgpr_read_b32 v30, a182
  v_accvgpr_read_b32 v31, a183
  v_mfma_f32_16x16x32_bf16 v[228:231], a[68:71], a[20:23], v[228:231]
  v_cvt_pk_bf16_f32 v180, v24, v25
  v_cvt_pk_bf16_f32 v181, v26, v27
  v_mfma_f32_16x16x32_bf16 v[96:99], a[64:67], a[4:7], v[96:99]
  v_cvt_pk_bf16_f32 v182, v28, v29
  v_cvt_pk_bf16_f32 v183, v30, v31
  v_mfma_f32_16x16x32_bf16 v[100:103], a[68:71], a[4:7], v[100:103]
  buffer_load_dwordx4 v54, s[8:11], s46 offen offset:2048 lds
  v_mfma_f32_16x16x32_bf16 v[232:235], a[72:75], a[20:23], v[232:235]
  s_add_u32 s60, s63, 45056
  buffer_store_dwordx4 v[172:175], v2, s[16:19], s60 offen offset:1024 sc1
  v_cvt_pk_bf16_f32 v184, v184, v185
  v_mfma_f32_16x16x32_bf16 v[236:239], a[76:79], a[20:23], v[236:239]
  v_cvt_pk_bf16_f32 v185, v186, v187
  v_cvt_pk_bf16_f32 v186, v188, v189
  v_mfma_f32_16x16x32_bf16 v[104:107], a[72:75], a[4:7], v[104:107]
  v_cvt_pk_bf16_f32 v187, v190, v191
  v_accvgpr_read_b32 v32, a184
  v_mfma_f32_16x16x32_bf16 v[108:111], a[76:79], a[4:7], v[108:111]
  v_accvgpr_read_b32 v33, a185
  v_accvgpr_read_b32 v34, a186
  v_mfma_f32_16x16x32_bf16 v[240:243], a[80:83], a[20:23], v[240:243]
  v_accvgpr_read_b32 v35, a187
  v_accvgpr_read_b32 v36, a188
  v_mfma_f32_16x16x32_bf16 v[244:247], a[84:87], a[20:23], v[244:247]
  buffer_load_dwordx4 v55, s[8:11], s46 offen offset:3072 lds
  v_accvgpr_read_b32 v37, a189
  v_mfma_f32_16x16x32_bf16 v[112:115], a[80:83], a[4:7], v[112:115]
  s_sub_u32 s50, s50, 1
  s_cmp_eq_u32 s50, 0
  s_cselect_b32 s12, s72, s12
  s_cselect_b32 s13, s73, s13
  v_mfma_f32_16x16x32_bf16 v[116:119], a[84:87], a[4:7], v[116:119]
  s_lshl_b32 s47, s48, 19
  s_bfe_u32 s34, 0x3020106, s49
  s_add_u32 s48, s48, s34
  v_mfma_f32_16x16x32_bf16 v[248:251], a[88:91], a[20:23], v[248:251]
  s_add_u32 s49, s49, 8
  s_and_b32 s49, s49, 0x8001f
  s_and_b32 s48, s48, 7
  v_mfma_f32_16x16x32_bf16 v[252:255], a[92:95], a[20:23], v[252:255]
  s_lshl_b32 s46, s48, 7
  v_accvgpr_read_b32 v38, a190
  v_accvgpr_read_b32 v39, a191
  v_mfma_f32_16x16x32_bf16 v[120:123], a[88:91], a[4:7], v[120:123]
  v_cvt_pk_bf16_f32 v188, v32, v33
  v_cvt_pk_bf16_f32 v189, v34, v35
  v_mfma_f32_16x16x32_bf16 v[124:127], a[92:95], a[4:7], v[124:127]
  v_cvt_pk_bf16_f32 v190, v36, v37
  v_cvt_pk_bf16_f32 v191, v38, v39
  v_mfma_f32_16x16x32_bf16 v[88:91], a[120:123], a[32:35], v[88:91]
  ds_read_b128 a[0:3], v16 offset:0
  ds_read_b64_tr_b16 a[64:65], v18 offset:0
  v_mfma_f32_16x16x32_bf16 v[92:95], a[124:127], a[32:35], v[92:95]
  ds_read_b64_tr_b16 a[66:67], v18 offset:2048
  ds_read_b128 a[4:7], v16 offset:2048
  v_mfma_f32_16x16x32_bf16 v[224:227], a[96:99], a[52:55], v[224:227]
  ds_read_b128 a[8:11], v16 offset:4096
  ds_read_b128 a[12:15], v16 offset:6144
  v_mfma_f32_16x16x32_bf16 v[228:231], a[100:103], a[52:55], v[228:231]
  ds_read_b128 a[16:19], v16 offset:8192
  ds_read_b128 a[20:23], v16 offset:10240
  v_mfma_f32_16x16x32_bf16 v[96:99], a[96:99], a[36:39], v[96:99]
  ds_read_b128 a[24:27], v16 offset:12288
  ds_read_b128 a[28:31], v16 offset:14336
  v_mfma_f32_16x16x32_bf16 v[100:103], a[100:103], a[36:39], v[100:103]
  ds_read_b64_tr_b16 a[68:69], v19 offset:0
  ds_read_b64_tr_b16 a[70:71], v19 offset:2048
  v_mfma_f32_16x16x32_bf16 v[232:235], a[104:107], a[52:55], v[232:235]
  ds_read_b64_tr_b16 a[72:73], v20 offset:0
  ds_read_b64_tr_b16 a[74:75], v20 offset:2048
  v_mfma_f32_16x16x32_bf16 v[236:239], a[108:111], a[52:55], v[236:239]
  ds_read_b64_tr_b16 a[76:77], v21 offset:0
  ds_read_b64_tr_b16 a[78:79], v21 offset:2048
  v_mfma_f32_16x16x32_bf16 v[104:107], a[104:107], a[36:39], v[104:107]
  ds_read_b64_tr_b16 a[80:81], v18 offset:8192
  ds_read_b64_tr_b16 a[82:83], v18 offset:10240
  v_mfma_f32_16x16x32_bf16 v[108:111], a[108:111], a[36:39], v[108:111]
  ds_read_b64_tr_b16 a[84:85], v19 offset:8192
  ds_read_b64_tr_b16 a[86:87], v19 offset:10240
  v_mfma_f32_16x16x32_bf16 v[240:243], a[112:115], a[52:55], v[240:243]
  ds_read_b64_tr_b16 a[88:89], v20 offset:8192
  ds_read_b64_tr_b16 a[90:91], v20 offset:10240
  v_mfma_f32_16x16x32_bf16 v[244:247], a[116:119], a[52:55], v[244:247]
  ds_read_b64_tr_b16 a[92:93], v21 offset:8192
  ds_read_b64_tr_b16 a[94:95], v21 offset:10240
  v_mfma_f32_16x16x32_bf16 v[112:115], a[112:115], a[36:39], v[112:115]
  v_cvt_pk_bf16_f32 v192, v192, v193
  v_cvt_pk_bf16_f32 v193, v194, v195
  v_mfma_f32_16x16x32_bf16 v[116:119], a[116:119], a[36:39], v[116:119]
  v_cvt_pk_bf16_f32 v194, v196, v197
  v_cvt_pk_bf16_f32 v195, v198, v199
  v_mfma_f32_16x16x32_bf16 v[248:251], a[120:123], a[52:55], v[248:251]
  v_cvt_pk_bf16_f32 v196, v64, v65
  v_cvt_pk_bf16_f32 v197, v66, v67
  v_mfma_f32_16x16x32_bf16 v[252:255], a[124:127], a[52:55], v[252:255]
  v_cvt_pk_bf16_f32 v198, v68, v69
  v_cvt_pk_bf16_f32 v199, v70, v71
  v_mfma_f32_16x16x32_bf16 v[120:123], a[120:123], a[36:39], v[120:123]
  v_cvt_pk_bf16_f32 v200, v200, v201
  v_cvt_pk_bf16_f32 v201, v202, v203
  v_mfma_f32_16x16x32_bf16 v[124:127], a[124:127], a[36:39], v[124:127]
  v_cvt_pk_bf16_f32 v202, v204, v205
  v_cvt_pk_bf16_f32 v203, v206, v207
  s_waitcnt lgkmcnt(0)
  v_mfma_f32_16x16x32_bf16 a[128:131], a[24:27], a[64:67], 0
  ds_read_b128 a[32:35], v17 offset:0
  ds_read_b64_tr_b16 a[96:97], v18 offset:4096
  v_mfma_f32_16x16x32_bf16 a[132:135], a[24:27], a[68:71], 0
  ds_read_b64_tr_b16 a[98:99], v18 offset:6144
  ds_read_b128 a[36:39], v17 offset:2048
  v_mfma_f32_16x16x32_bf16 a[136:139], a[24:27], a[72:75], 0
  ds_read_b128 a[40:43], v17 offset:4096
  ds_read_b128 a[44:47], v17 offset:6144
  v_mfma_f32_16x16x32_bf16 a[140:143], a[24:27], a[76:79], 0
  ds_read_b128 a[48:51], v17 offset:8192
  ds_read_b128 a[52:55], v17 offset:10240
  v_mfma_f32_16x16x32_bf16 a[144:147], a[24:27], a[80:83], 0
  ds_read_b128 a[56:59], v17 offset:12288
  ds_read_b128 a[60:63], v17 offset:14336
  v_mfma_f32_16x16x32_bf16 a[148:151], a[24:27], a[84:87], 0
  ds_read_b64_tr_b16 a[100:101], v19 offset:4096
  ds_read_b64_tr_b16 a[102:103], v19 offset:6144
  v_mfma_f32_16x16x32_bf16 a[152:155], a[24:27], a[88:91], 0
  ds_read_b64_tr_b16 a[104:105], v20 offset:4096
  v_cvt_pk_bf16_f32 v204, v72, v73
  v_mfma_f32_16x16x32_bf16 a[156:159], a[24:27], a[92:95], 0
  ds_read_b64_tr_b16 a[106:107], v20 offset:6144
  ds_read_b64_tr_b16 a[108:109], v21 offset:4096
  v_mfma_f32_16x16x32_bf16 a[160:163], a[28:31], a[64:67], 0
  ds_read_b64_tr_b16 a[110:111], v21 offset:6144
  ds_read_b64_tr_b16 a[112:113], v18 offset:12288
  v_mfma_f32_16x16x32_bf16 a[164:167], a[28:31], a[68:71], 0
  ds_read_b64_tr_b16 a[114:115], v18 offset:14336
  ds_read_b64_tr_b16 a[116:117], v19 offset:12288
  v_mfma_f32_16x16x32_bf16 a[168:171], a[28:31], a[72:75], 0
  ds_read_b64_tr_b16 a[118:119], v19 offset:14336
  ds_read_b64_tr_b16 a[120:121], v20 offset:12288
  v_mfma_f32_16x16x32_bf16 a[172:175], a[28:31], a[76:79], 0
  ds_read_b64_tr_b16 a[122:123], v20 offset:14336
  ds_read_b64_tr_b16 a[124:125], v21 offset:12288
  v_mfma_f32_16x16x32_bf16 a[176:179], a[28:31], a[80:83], 0
  ds_read_b64_tr_b16 a[126:127], v21 offset:14336
  v_cvt_pk_bf16_f32 v205, v74, v75
  v_mfma_f32_16x16x32_bf16 a[180:183], a[28:31], a[84:87], 0
  v_cvt_pk_bf16_f32 v206, v76, v77
  v_cvt_pk_bf16_f32 v207, v78, v79
  v_mfma_f32_16x16x32_bf16 a[184:187], a[28:31], a[88:91], 0
  v_cvt_pk_bf16_f32 v208, v208, v209
  v_cvt_pk_bf16_f32 v209, v210, v211
  v_mfma_f32_16x16x32_bf16 a[188:191], a[28:31], a[92:95], 0
  v_cvt_pk_bf16_f32 v210, v212, v213
  v_cvt_pk_bf16_f32 v211, v214, v215
  v_mfma_f32_16x16x32_bf16 v[128:131], a[8:11], a[64:67], 0
  v_cvt_pk_bf16_f32 v212, v80, v81
  v_cvt_pk_bf16_f32 v213, v82, v83
  v_mfma_f32_16x16x32_bf16 v[132:135], a[8:11], a[68:71], 0
  v_cvt_pk_bf16_f32 v214, v84, v85
  v_cvt_pk_bf16_f32 v215, v86, v87
  v_mfma_f32_16x16x32_bf16 v[136:139], a[8:11], a[72:75], 0
  v_cvt_pk_bf16_f32 v216, v216, v217
  v_cvt_pk_bf16_f32 v217, v218, v219
  v_mfma_f32_16x16x32_bf16 v[140:143], a[8:11], a[76:79], 0
  s_add_u32 s36, s36, s38
  s_add_u32 s37, s37, 1
  s_cmp_eq_u32 s37, 3
  s_cselect_b32 s37, 0, s37
  s_cselect_b32 s38, s39, s40
  v_add_u32 v16, s38, v16
  v_add_u32 v17, s38, v17
  s_add_u32 s41, s41, s43
  s_sub_u32 s43, 0, s43
  v_add_u32 v18, s43, v18
  v_add_u32 v19, s43, v19
  v_add_u32 v20, s43, v20
  v_add_u32 v21, s43, v21
  s_waitcnt vmcnt(8) lgkmcnt(0)
  s_barrier
  v_mfma_f32_16x16x32_bf16 a[128:131], a[56:59], a[96:99], a[128:131]
  s_mov_b32 m0, s41
  v_cvt_pk_bf16_f32 v218, v220, v221
  v_cvt_pk_bf16_f32 v219, v222, v223
  v_mfma_f32_16x16x32_bf16 a[132:135], a[56:59], a[100:103], a[132:135]
  v_cvt_pk_bf16_f32 v220, v88, v89
  v_cvt_pk_bf16_f32 v221, v90, v91
  v_mfma_f32_16x16x32_bf16 a[136:139], a[56:59], a[104:107], a[136:139]
  v_cvt_pk_bf16_f32 v222, v92, v93
  v_cvt_pk_bf16_f32 v223, v94, v95
  v_mfma_f32_16x16x32_bf16 a[140:143], a[56:59], a[108:111], a[140:143]
  v_cvt_pk_bf16_f32 v224, v224, v225
  v_cvt_pk_bf16_f32 v225, v226, v227
  v_mfma_f32_16x16x32_bf16 a[144:147], a[56:59], a[112:115], a[144:147]
  v_cvt_pk_bf16_f32 v226, v228, v229
  v_cvt_pk_bf16_f32 v227, v230, v231
  v_mfma_f32_16x16x32_bf16 a[148:151], a[56:59], a[116:119], a[148:151]
  v_cvt_pk_bf16_f32 v228, v96, v97
  v_cvt_pk_bf16_f32 v229, v98, v99
  v_mfma_f32_16x16x32_bf16 a[152:155], a[56:59], a[120:123], a[152:155]
  v_cvt_pk_bf16_f32 v230, v100, v101
  v_cvt_pk_bf16_f32 v231, v102, v103
  v_mfma_f32_16x16x32_bf16 a[156:159], a[56:59], a[124:127], a[156:159]
  v_cvt_pk_bf16_f32 v232, v232, v233
  v_cvt_pk_bf16_f32 v233, v234, v235
  v_mfma_f32_16x16x32_bf16 a[160:163], a[60:63], a[96:99], a[160:163]
  v_cvt_pk_bf16_f32 v234, v236, v237
  v_cvt_pk_bf16_f32 v235, v238, v239
  v_mfma_f32_16x16x32_bf16 a[164:167], a[60:63], a[100:103], a[164:167]
  v_cvt_pk_bf16_f32 v236, v104, v105
  v_cvt_pk_bf16_f32 v237, v106, v107
  v_mfma_f32_16x16x32_bf16 a[168:171], a[60:63], a[104:107], a[168:171]
  v_cvt_pk_bf16_f32 v238, v108, v109
  v_cvt_pk_bf16_f32 v239, v110, v111
  v_mfma_f32_16x16x32_bf16 a[172:175], a[60:63], a[108:111], a[172:175]
  v_cvt_pk_bf16_f32 v240, v240, v241
  v_cvt_pk_bf16_f32 v241, v242, v243
  v_mfma_f32_16x16x32_bf16 a[176:179], a[60:63], a[112:115], a[176:179]
  v_cvt_pk_bf16_f32 v242, v244, v245
  v_cvt_pk_bf16_f32 v243, v246, v247
  v_mfma_f32_16x16x32_bf16 a[180:183], a[60:63], a[116:119], a[180:183]
  v_cvt_pk_bf16_f32 v244, v112, v113
  v_cvt_pk_bf16_f32 v245, v114, v115
  v_mfma_f32_16x16x32_bf16 a[184:187], a[60:63], a[120:123], a[184:187]
  v_cvt_pk_bf16_f32 v246, v116, v117
  v_cvt_pk_bf16_f32 v247, v118, v119
  v_mfma_f32_16x16x32_bf16 a[188:191], a[60:63], a[124:127], a[188:191]
  v_cvt_pk_bf16_f32 v248, v248, v249
  v_cvt_pk_bf16_f32 v249, v250, v251
  v_mfma_f32_16x16x32_bf16 v[128:131], a[40:43], a[96:99], v[128:131]
  v_cvt_pk_bf16_f32 v250, v252, v253
  v_cvt_pk_bf16_f32 v251, v254, v255
  v_mfma_f32_16x16x32_bf16 v[132:135], a[40:43], a[100:103], v[132:135]
  v_cvt_pk_bf16_f32 v252, v120, v121
  v_cvt_pk_bf16_f32 v253, v122, v123
  v_mfma_f32_16x16x32_bf16 v[136:139], a[40:43], a[104:107], v[136:139]
  v_cvt_pk_bf16_f32 v254, v124, v125
  v_cvt_pk_bf16_f32 v255, v126, v127
  v_mfma_f32_16x16x32_bf16 v[140:143], a[40:43], a[108:111], v[140:143]
  s_add_u32 s60, s63, 12288
  buffer_store_dwordx4 v[176:179], v2, s[16:19], s60 offen offset:2048 sc1
  v_mfma_f32_16x16x32_bf16 v[144:147], a[8:11], a[80:83], 0
  s_add_u32 s60, s63, 45056
  buffer_store_dwordx4 v[180:183], v2, s[16:19], s60 offen offset:2048 sc1
  v_mfma_f32_16x16x32_bf16 v[148:151], a[8:11], a[84:87], 0
  s_add_u32 s60, s63, 12288
  buffer_store_dwordx4 v[184:187], v2, s[16:19], s60 offen offset:3072 sc1
  v_mfma_f32_16x16x32_bf16 v[144:147], a[40:43], a[112:115], v[144:147]
  s_add_u32 s60, s63, 45056
  buffer_store_dwordx4 v[188:191], v2, s[16:19], s60 offen offset:3072 sc1
  v_mfma_f32_16x16x32_bf16 v[148:151], a[40:43], a[116:119], v[148:151]
  s_add_u32 s60, s63, 32768
  buffer_store_dwordx4 v[192:195], v2, s[16:19], s60 offen offset:0 sc1
  v_mfma_f32_16x16x32_bf16 v[152:155], a[8:11], a[88:91], 0
  s_add_u32 s60, s63, 0
  buffer_store_dwordx4 v[196:199], v2, s[16:19], s60 offen offset:0 sc1
  v_mfma_f32_16x16x32_bf16 v[156:159], a[8:11], a[92:95], 0
  buffer_load_dwordx4 v56, s[12:15], s47 offen offset:0 lds
  v_mfma_f32_16x16x32_bf16 v[152:155], a[40:43], a[120:123], v[152:155]
  s_add_u32 s60, s63, 32768
  buffer_store_dwordx4 v[200:203], v2, s[16:19], s60 offen offset:1024 sc1
  v_mfma_f32_16x16x32_bf16 v[156:159], a[40:43], a[124:127], v[156:159]
  buffer_load_dwordx4 v57, s[12:15], s47 offen offset:1024 lds
  v_mfma_f32_16x16x32_bf16 v[160:163], a[12:15], a[64:67], 0
  buffer_load_dwordx4 v58, s[12:15], s47 offen offset:2048 lds
  v_mfma_f32_16x16x32_bf16 v[164:167], a[12:15], a[68:71], 0
  buffer_load_dwordx4 v59, s[12:15], s47 offen offset:3072 lds
  v_mfma_f32_16x16x32_bf16 v[160:163], a[44:47], a[96:99], v[160:163]
  s_add_u32 m0, s41, 4096
  v_mfma_f32_16x16x32_bf16 v[164:167], a[44:47], a[100:103], v[164:167]
  s_add_u32 s60, s63, 0
  buffer_store_dwordx4 v[204:207], v2, s[16:19], s60 offen offset:1024 sc1
  v_mfma_f32_16x16x32_bf16 v[168:171], a[12:15], a[72:75], 0
  buffer_load_dwordx4 v60, s[12:15], s47 offen offset:0 lds
  v_mfma_f32_16x16x32_bf16 v[172:175], a[12:15], a[76:79], 0
  buffer_load_dwordx4 v61, s[12:15], s47 offen offset:1024 lds
  v_mfma_f32_16x16x32_bf16 v[168:171], a[44:47], a[104:107], v[168:171]
  buffer_load_dwordx4 v62, s[12:15], s47 offen offset:2048 lds
  v_mfma_f32_16x16x32_bf16 v[172:175], a[44:47], a[108:111], v[172:175]
  s_add_u32 s60, s63, 32768
  buffer_store_dwordx4 v[208:211], v2, s[16:19], s60 offen offset:2048 sc1
  v_mfma_f32_16x16x32_bf16 v[64:67], a[0:3], a[64:67], 0
  v_mfma_f32_16x16x32_bf16 v[68:71], a[0:3], a[68:71], 0
  v_mfma_f32_16x16x32_bf16 v[64:67], a[32:35], a[96:99], v[64:67]
  buffer_load_dwordx4 v63, s[12:15], s47 offen offset:3072 lds
  v_mfma_f32_16x16x32_bf16 v[68:71], a[32:35], a[100:103], v[68:71]
  s_add_u32 s60, s63, 0
  buffer_store_dwordx4 v[212:215], v2, s[16:19], s60 offen offset:2048 sc1
  s_mov_b32 m0, s36
  s_nop 0
  buffer_load_dwordx4 v48, s[8:11], s46 offen offset:0 lds
  buffer_load_dwordx4 v49, s[8:11], s46 offen offset:1024 lds
  buffer_load_dwordx4 v50, s[8:11], s46 offen offset:2048 lds
  buffer_load_dwordx4 v51, s[8:11], s46 offen offset:3072 lds
  v_mfma_f32_16x16x32_bf16 v[72:75], a[0:3], a[72:75], 0
  s_add_u32 m0, s36, 4096
  v_mfma_f32_16x16x32_bf16 v[76:79], a[0:3], a[76:79], 0
  v_mfma_f32_16x16x32_bf16 v[72:75], a[32:35], a[104:107], v[72:75]
  v_mfma_f32_16x16x32_bf16 v[76:79], a[32:35], a[108:111], v[76:79]
  v_mfma_f32_16x16x32_bf16 v[80:83], a[0:3], a[80:83], 0
  s_add_u32 s60, s63, 32768
  buffer_store_dwordx4 v[216:219], v2, s[16:19], s60 offen offset:3072 sc1
  v_mfma_f32_16x16x32_bf16 v[84:87], a[0:3], a[84:87], 0
  v_mfma_f32_16x16x32_bf16 v[80:83], a[32:35], a[112:115], v[80:83]
  v_mfma_f32_16x16x32_bf16 v[84:87], a[32:35], a[116:119], v[84:87]
  v_mfma_f32_16x16x32_bf16 v[88:91], a[0:3], a[88:91], 0
  s_add_u32 s60, s63, 0
  buffer_store_dwordx4 v[220:223], v2, s[16:19], s60 offen offset:3072 sc1
  v_mfma_f32_16x16x32_bf16 v[92:95], a[0:3], a[92:95], 0
  v_mfma_f32_16x16x32_bf16 v[88:91], a[32:35], a[120:123], v[88:91]
  v_mfma_f32_16x16x32_bf16 v[92:95], a[32:35], a[124:127], v[92:95]
  v_mfma_f32_16x16x32_bf16 v[96:99], a[4:7], a[64:67], 0
  s_add_u32 s60, s63, 36864
  buffer_store_dwordx4 v[224:227], v2, s[16:19], s60 offen offset:0 sc1
  v_mfma_f32_16x16x32_bf16 v[100:103], a[4:7], a[68:71], 0
  v_mfma_f32_16x16x32_bf16 v[96:99], a[36:39], a[96:99], v[96:99]
  v_mfma_f32_16x16x32_bf16 v[100:103], a[36:39], a[100:103], v[100:103]
  v_mfma_f32_16x16x32_bf16 v[104:107], a[4:7], a[72:75], 0
  s_add_u32 s60, s63, 4096
  buffer_store_dwordx4 v[228:231], v2, s[16:19], s60 offen offset:0 sc1
  v_mfma_f32_16x16x32_bf16 v[108:111], a[4:7], a[76:79], 0
  v_mfma_f32_16x16x32_bf16 v[104:107], a[36:39], a[104:107], v[104:107]
  v_mfma_f32_16x16x32_bf16 v[108:111], a[36:39], a[108:111], v[108:111]
  v_mfma_f32_16x16x32_bf16 v[112:115], a[4:7], a[80:83], 0
  v_mfma_f32_16x16x32_bf16 v[116:119], a[4:7], a[84:87], 0
  s_add_u32 s60, s63, 36864
  buffer_store_dwordx4 v[232:235], v2, s[16:19], s60 offen offset:1024 sc1
  v_mfma_f32_16x16x32_bf16 v[112:115], a[36:39], a[112:115], v[112:115]
  v_mfma_f32_16x16x32_bf16 v[116:119], a[36:39], a[116:119], v[116:119]
  v_mfma_f32_16x16x32_bf16 v[120:123], a[4:7], a[88:91], 0
  v_mfma_f32_16x16x32_bf16 v[124:127], a[4:7], a[92:95], 0
  s_add_u32 s60, s63, 4096
  buffer_store_dwordx4 v[236:239], v2, s[16:19], s60 offen offset:1024 sc1
  v_mfma_f32_16x16x32_bf16 v[120:123], a[36:39], a[120:123], v[120:123]
  buffer_load_dwordx4 v52, s[8:11], s46 offen offset:0 lds
  v_mfma_f32_16x16x32_bf16 v[124:127], a[36:39], a[124:127], v[124:127]
  v_mfma_f32_16x16x32_bf16 v[176:179], a[12:15], a[80:83], 0
  v_mfma_f32_16x16x32_bf16 v[180:183], a[12:15], a[84:87], 0
  s_add_u32 s60, s63, 36864
  buffer_store_dwordx4 v[240:243], v2, s[16:19], s60 offen offset:2048 sc1
  v_mfma_f32_16x16x32_bf16 v[176:179], a[44:47], a[112:115], v[176:179]
  v_mfma_f32_16x16x32_bf16 v[180:183], a[44:47], a[116:119], v[180:183]
  v_mfma_f32_16x16x32_bf16 v[184:187], a[12:15], a[88:91], 0
  buffer_load_dwordx4 v53, s[8:11], s46 offen offset:1024 lds
  v_mfma_f32_16x16x32_bf16 v[188:191], a[12:15], a[92:95], 0
  v_mfma_f32_16x16x32_bf16 v[192:195], a[16:19], a[64:67], 0
  s_add_u32 s60, s63, 4096
  buffer_store_dwordx4 v[244:247], v2, s[16:19], s60 offen offset:2048 sc1
  v_mfma_f32_16x16x32_bf16 v[196:199], a[16:19], a[68:71], 0
  v_mfma_f32_16x16x32_bf16 v[200:203], a[16:19], a[72:75], 0
  v_mfma_f32_16x16x32_bf16 v[204:207], a[16:19], a[76:79], 0
  buffer_load_dwordx4 v54, s[8:11], s46 offen offset:2048 lds
  v_mfma_f32_16x16x32_bf16 v[208:211], a[16:19], a[80:83], 0
  s_add_u32 s60, s63, 36864
  buffer_store_dwordx4 v[248:251], v2, s[16:19], s60 offen offset:3072 sc1
  v_mfma_f32_16x16x32_bf16 v[212:215], a[16:19], a[84:87], 0
  v_mfma_f32_16x16x32_bf16 v[216:219], a[16:19], a[88:91], 0
  v_mfma_f32_16x16x32_bf16 v[220:223], a[16:19], a[92:95], 0
  v_mfma_f32_16x16x32_bf16 v[224:227], a[20:23], a[64:67], 0
  s_add_u32 s60, s63, 4096
  buffer_store_dwordx4 v[252:255], v2, s[16:19], s60 offen offset:3072 sc1
  v_mfma_f32_16x16x32_bf16 v[228:231], a[20:23], a[68:71], 0
  buffer_load_dwordx4 v55, s[8:11], s46 offen offset:3072 lds
  v_mfma_f32_16x16x32_bf16 v[232:235], a[20:23], a[72:75], 0
  s_sub_u32 s50, s50, 1
  s_cmp_eq_u32 s50, 0
  s_cselect_b32 s12, s72, s12
  s_cselect_b32 s13, s73, s13
  v_mfma_f32_16x16x32_bf16 v[236:239], a[20:23], a[76:79], 0
  s_lshl_b32 s47, s48, 19
  s_bfe_u32 s34, 0x3020106, s49
  s_add_u32 s48, s48, s34
  v_mfma_f32_16x16x32_bf16 v[240:243], a[20:23], a[80:83], 0
  s_add_u32 s49, s49, 8
  s_and_b32 s49, s49, 0x8001f
  s_and_b32 s48, s48, 7
  v_mfma_f32_16x16x32_bf16 v[244:247], a[20:23], a[84:87], 0
  s_lshl_b32 s46, s48, 7
  v_mfma_f32_16x16x32_bf16 v[248:251], a[20:23], a[88:91], 0
  v_mfma_f32_16x16x32_bf16 v[252:255], a[20:23], a[92:95], 0
  v_mfma_f32_16x16x32_bf16 v[184:187], a[44:47], a[120:123], v[184:187]
  ds_read_b128 a[0:3], v16 offset:0
  ds_read_b64_tr_b16 a[64:65], v18 offset:0
  v_mfma_f32_16x16x32_bf16 v[188:191], a[44:47], a[124:127], v[188:191]
  ds_read_b64_tr_b16 a[66:67], v18 offset:2048
  ds_read_b128 a[4:7], v16 offset:2048
  v_mfma_f32_16x16x32_bf16 v[192:195], a[48:51], a[96:99], v[192:195]
  ds_read_b128 a[8:11], v16 offset:4096
  ds_read_b128 a[12:15], v16 offset:6144
  v_mfma_f32_16x16x32_bf16 v[196:199], a[48:51], a[100:103], v[196:199]
  ds_read_b128 a[16:19], v16 offset:8192
  ds_read_b128 a[20:23], v16 offset:10240
  v_mfma_f32_16x16x32_bf16 v[200:203], a[48:51], a[104:107], v[200:203]
  ds_read_b128 a[24:27], v16 offset:12288
  ds_read_b128 a[28:31], v16 offset:14336
  v_mfma_f32_16x16x32_bf16 v[204:207], a[48:51], a[108:111], v[204:207]
  ds_read_b64_tr_b16 a[68:69], v19 offset:0
  ds_read_b64_tr_b16 a[70:71], v19 offset:2048
  v_mfma_f32_16x16x32_bf16 v[208:211], a[48:51], a[112:115], v[208:211]
  ds_read_b64_tr_b16 a[72:73], v20 offset:0
  ds_read_b64_tr_b16 a[74:75], v20 offset:2048
  v_mfma_f32_16x16x32_bf16 v[212:215], a[48:51], a[116:119], v[212:215]
  ds_read_b64_tr_b16 a[76:77], v21 offset:0
  ds_read_b64_tr_b16 a[78:79], v21 offset:2048
  v_mfma_f32_16x16x32_bf16 v[216:219], a[48:51], a[120:123], v[216:219]
  ds_read_b64_tr_b16 a[80:81], v18 offset:8192
  ds_read_b64_tr_b16 a[82:83], v18 offset:10240
  v_mfma_f32_16x16x32_bf16 v[220:223], a[48:51], a[124:127], v[220:223]
  ds_read_b64_tr_b16 a[84:85], v19 offset:8192
  ds_read_b64_tr_b16 a[86:87], v19 offset:10240
  v_mfma_f32_16x16x32_bf16 v[224:227], a[52:55], a[96:99], v[224:227]
  ds_read_b64_tr_b16 a[88:89], v20 offset:8192
  ds_read_b64_tr_b16 a[90:91], v20 offset:10240
  v_mfma_f32_16x16x32_bf16 v[228:231], a[52:55], a[100:103], v[228:231]
  ds_read_b64_tr_b16 a[92:93], v21 offset:8192
  ds_read_b64_tr_b16 a[94:95], v21 offset:10240
  v_mfma_f32_16x16x32_bf16 v[232:235], a[52:55], a[104:107], v[232:235]
  v_mfma_f32_16x16x32_bf16 v[236:239], a[52:55], a[108:111], v[236:239]
  v_mfma_f32_16x16x32_bf16 v[240:243], a[52:55], a[112:115], v[240:243]
  v_mfma_f32_16x16x32_bf16 v[244:247], a[52:55], a[116:119], v[244:247]
  v_mfma_f32_16x16x32_bf16 v[248:251], a[52:55], a[120:123], v[248:251]
  v_mfma_f32_16x16x32_bf16 v[252:255], a[52:55], a[124:127], v[252:255]
  s_add_u32 s63, s63, 0x4000
  s_waitcnt lgkmcnt(0)
  v_mfma_f32_16x16x32_bf16 v[64:67], a[0:3], a[64:67], v[64:67]
  s_add_u32 s36, s36, s38
  ds_read_b128 a[32:35], v17 offset:0
  v_mfma_f32_16x16x32_bf16 v[96:99], a[4:7], a[64:67], v[96:99]
  s_add_u32 s37, s37, 1
  v_mfma_f32_16x16x32_bf16 v[128:131], a[8:11], a[64:67], v[128:131]
  ds_read_b64_tr_b16 a[96:97], v18 offset:4096
  v_mfma_f32_16x16x32_bf16 v[160:163], a[12:15], a[64:67], v[160:163]
  s_cmp_eq_u32 s37, 3
  s_cselect_b32 s37, 0, s37
  s_cselect_b32 s38, s39, s40
  v_mfma_f32_16x16x32_bf16 v[192:195], a[16:19], a[64:67], v[192:195]
  s_add_u32 s41, s41, s43
  ds_read_b64_tr_b16 a[98:99], v18 offset:6144
  v_mfma_f32_16x16x32_bf16 v[224:227], a[20:23], a[64:67], v[224:227]
  s_sub_u32 s43, 0, s43
  v_mfma_f32_16x16x32_bf16 a[128:131], a[24:27], a[64:67], a[128:131]
  ds_read_b128 a[36:39], v17 offset:2048
  v_mfma_f32_16x16x32_bf16 a[160:163], a[28:31], a[64:67], a[160:163]
  v_mfma_f32_16x16x32_bf16 v[68:71], a[0:3], a[68:71], v[68:71]
  v_mfma_f32_16x16x32_bf16 v[100:103], a[4:7], a[68:71], v[100:103]
  ds_read_b128 a[40:43], v17 offset:4096
  v_mfma_f32_16x16x32_bf16 v[132:135], a[8:11], a[68:71], v[132:135]
  v_mfma_f32_16x16x32_bf16 v[164:167], a[12:15], a[68:71], v[164:167]
  ds_read_b128 a[44:47], v17 offset:6144
  v_mfma_f32_16x16x32_bf16 v[196:199], a[16:19], a[68:71], v[196:199]
  v_mfma_f32_16x16x32_bf16 v[228:231], a[20:23], a[68:71], v[228:231]
  ds_read_b128 a[48:51], v17 offset:8192
  v_mfma_f32_16x16x32_bf16 a[132:135], a[24:27], a[68:71], a[132:135]
  v_mfma_f32_16x16x32_bf16 a[164:167], a[28:31], a[68:71], a[164:167]
  ds_read_b128 a[52:55], v17 offset:10240
  v_mfma_f32_16x16x32_bf16 v[72:75], a[0:3], a[72:75], v[72:75]
  v_mfma_f32_16x16x32_bf16 v[104:107], a[4:7], a[72:75], v[104:107]
  v_mfma_f32_16x16x32_bf16 v[136:139], a[8:11], a[72:75], v[136:139]
  ds_read_b128 a[56:59], v17 offset:12288
  v_mfma_f32_16x16x32_bf16 v[168:171], a[12:15], a[72:75], v[168:171]
  v_mfma_f32_16x16x32_bf16 v[200:203], a[16:19], a[72:75], v[200:203]
  ds_read_b128 a[60:63], v17 offset:14336
  v_mfma_f32_16x16x32_bf16 v[232:235], a[20:23], a[72:75], v[232:235]
  v_mfma_f32_16x16x32_bf16 a[136:139], a[24:27], a[72:75], a[136:139]
  ds_read_b64_tr_b16 a[100:101], v19 offset:4096
  v_mfma_f32_16x16x32_bf16 a[168:171], a[28:31], a[72:75], a[168:171]
  v_mfma_f32_16x16x32_bf16 v[76:79], a[0:3], a[76:79], v[76:79]
  ds_read_b64_tr_b16 a[102:103], v19 offset:6144
  v_mfma_f32_16x16x32_bf16 v[108:111], a[4:7], a[76:79], v[108:111]
  v_mfma_f32_16x16x32_bf16 v[140:143], a[8:11], a[76:79], v[140:143]
  v_mfma_f32_16x16x32_bf16 v[172:175], a[12:15], a[76:79], v[172:175]
  ds_read_b64_tr_b16 a[104:105], v20 offset:4096
  v_mfma_f32_16x16x32_bf16 v[204:207], a[16:19], a[76:79], v[204:207]
  v_mfma_f32_16x16x32_bf16 v[236:239], a[20:23], a[76:79], v[236:239]
  ds_read_b64_tr_b16 a[106:107], v20 offset:6144
  v_mfma_f32_16x16x32_bf16 a[140:143], a[24:27], a[76:79], a[140:143]
  v_mfma_f32_16x16x32_bf16 a[172:175], a[28:31], a[76:79], a[172:175]
  ds_read_b64_tr_b16 a[108:109], v21 offset:4096
  v_mfma_f32_16x16x32_bf16 v[80:83], a[0:3], a[80:83], v[80:83]
  v_mfma_f32_16x16x32_bf16 v[112:115], a[4:7], a[80:83], v[112:115]
  ds_read_b64_tr_b16 a[110:111], v21 offset:6144
  v_mfma_f32_16x16x32_bf16 v[144:147], a[8:11], a[80:83], v[144:147]
  v_mfma_f32_16x16x32_bf16 v[176:179], a[12:15], a[80:83], v[176:179]
  v_mfma_f32_16x16x32_bf16 v[208:211], a[16:19], a[80:83], v[208:211]
  ds_read_b64_tr_b16 a[112:113], v18 offset:12288
  v_mfma_f32_16x16x32_bf16 v[240:243], a[20:23], a[80:83], v[240:243]
  v_mfma_f32_16x16x32_bf16 a[144:147], a[24:27], a[80:83], a[144:147]
  ds_read_b64_tr_b16 a[114:115], v18 offset:14336
  v_mfma_f32_16x16x32_bf16 a[176:179], a[28:31], a[80:83], a[176:179]
  v_mfma_f32_16x16x32_bf16 v[84:87], a[0:3], a[84:87], v[84:87]
  ds_read_b64_tr_b16 a[116:117], v19 offset:12288
  v_mfma_f32_16x16x32_bf16 v[116:119], a[4:7], a[84:87], v[116:119]
  v_mfma_f32_16x16x32_bf16 v[148:151], a[8:11], a[84:87], v[148:151]
  ds_read_b64_tr_b16 a[118:119], v19 offset:14336
  v_mfma_f32_16x16x32_bf16 v[180:183], a[12:15], a[84:87], v[180:183]
  v_mfma_f32_16x16x32_bf16 v[212:215], a[16:19], a[84:87], v[212:215]
  v_mfma_f32_16x16x32_bf16 v[244:247], a[20:23], a[84:87], v[244:247]
  ds_read_b64_tr_b16 a[120:121], v20 offset:12288
  v_mfma_f32_16x16x32_bf16 a[148:151], a[24:27], a[84:87], a[148:151]
  v_mfma_f32_16x16x32_bf16 a[180:183], a[28:31], a[84:87], a[180:183]
  ds_read_b64_tr_b16 a[122:123], v20 offset:14336
  v_mfma_f32_16x16x32_bf16 v[88:91], a[0:3], a[88:91], v[88:91]
  v_mfma_f32_16x16x32_bf16 v[120:123], a[4:7], a[88:91], v[120:123]
  ds_read_b64_tr_b16 a[124:125], v21 offset:12288
  v_mfma_f32_16x16x32_bf16 v[152:155], a[8:11], a[88:91], v[152:155]
  v_mfma_f32_16x16x32_bf16 v[184:187], a[12:15], a[88:91], v[184:187]
  ds_read_b64_tr_b16 a[126:127], v21 offset:14336
  v_mfma_f32_16x16x32_bf16 v[216:219], a[16:19], a[88:91], v[216:219]
  v_add_u32 v16, s38, v16
  v_add_u32 v17, s38, v17
  v_mfma_f32_16x16x32_bf16 v[248:251], a[20:23], a[88:91], v[248:251]
  v_add_u32 v18, s43, v18
  v_add_u32 v19, s43, v19
  v_mfma_f32_16x16x32_bf16 a[152:155], a[24:27], a[88:91], a[152:155]
  v_add_u32 v20, s43, v20
  v_add_u32 v21, s43, v21
  v_mfma_f32_16x16x32_bf16 a[184:187], a[28:31], a[88:91], a[184:187]
  v_mfma_f32_16x16x32_bf16 v[92:95], a[0:3], a[92:95], v[92:95]
  v_mfma_f32_16x16x32_bf16 v[124:127], a[4:7], a[92:95], v[124:127]
  v_mfma_f32_16x16x32_bf16 v[156:159], a[8:11], a[92:95], v[156:159]
  v_mfma_f32_16x16x32_bf16 v[188:191], a[12:15], a[92:95], v[188:191]
  v_mfma_f32_16x16x32_bf16 v[220:223], a[16:19], a[92:95], v[220:223]
  v_mfma_f32_16x16x32_bf16 v[252:255], a[20:23], a[92:95], v[252:255]
  v_mfma_f32_16x16x32_bf16 a[156:159], a[24:27], a[92:95], a[156:159]
  v_mfma_f32_16x16x32_bf16 a[188:191], a[28:31], a[92:95], a[188:191]
  s_mov_b32 s35, 4
  s_waitcnt vmcnt(8) lgkmcnt(0)
  s_barrier
  .p2align 6
Lp1xw_loop:
  v_mfma_f32_16x16x32_bf16 v[64:67], a[32:35], a[96:99], v[64:67]
  s_mov_b32 m0, s41
  ds_read_b128 a[0:3], v16 offset:0
  v_mfma_f32_16x16x32_bf16 v[96:99], a[36:39], a[96:99], v[96:99]
  buffer_load_dwordx4 v56, s[12:15], s47 offen offset:0 lds
  v_mfma_f32_16x16x32_bf16 v[128:131], a[40:43], a[96:99], v[128:131]
  ds_read_b64_tr_b16 a[64:65], v18 offset:0
  v_mfma_f32_16x16x32_bf16 v[160:163], a[44:47], a[96:99], v[160:163]
  v_mfma_f32_16x16x32_bf16 v[192:195], a[48:51], a[96:99], v[192:195]
  ds_read_b64_tr_b16 a[66:67], v18 offset:2048
  v_mfma_f32_16x16x32_bf16 v[224:227], a[52:55], a[96:99], v[224:227]
  v_mfma_f32_16x16x32_bf16 a[128:131], a[56:59], a[96:99], a[128:131]
  ds_read_b128 a[4:7], v16 offset:2048
  v_mfma_f32_16x16x32_bf16 a[160:163], a[60:63], a[96:99], a[160:163]
  buffer_load_dwordx4 v57, s[12:15], s47 offen offset:1024 lds
  v_mfma_f32_16x16x32_bf16 v[68:71], a[32:35], a[100:103], v[68:71]
  v_mfma_f32_16x16x32_bf16 v[100:103], a[36:39], a[100:103], v[100:103]
  ds_read_b128 a[8:11], v16 offset:4096
  v_mfma_f32_16x16x32_bf16 v[132:135], a[40:43], a[100:103], v[132:135]
  v_mfma_f32_16x16x32_bf16 v[164:167], a[44:47], a[100:103], v[164:167]
  ds_read_b128 a[12:15], v16 offset:6144
  v_mfma_f32_16x16x32_bf16 v[196:199], a[48:51], a[100:103], v[196:199]
  v_mfma_f32_16x16x32_bf16 v[228:231], a[52:55], a[100:103], v[228:231]
  ds_read_b128 a[16:19], v16 offset:8192
  v_mfma_f32_16x16x32_bf16 a[132:135], a[56:59], a[100:103], a[132:135]
  v_mfma_f32_16x16x32_bf16 a[164:167], a[60:63], a[100:103], a[164:167]
  buffer_load_dwordx4 v58, s[12:15], s47 offen offset:2048 lds
  v_mfma_f32_16x16x32_bf16 v[72:75], a[32:35], a[104:107], v[72:75]
  ds_read_b128 a[20:23], v16 offset:10240
  v_mfma_f32_16x16x32_bf16 v[104:107], a[36:39], a[104:107], v[104:107]
  v_mfma_f32_16x16x32_bf16 v[136:139], a[40:43], a[104:107], v[136:139]
  ds_read_b128 a[24:27], v16 offset:12288
  v_mfma_f32_16x16x32_bf16 v[168:171], a[44:47], a[104:107], v[168:171]
  v_mfma_f32_16x16x32_bf16 v[200:203], a[48:51], a[104:107], v[200:203]
  ds_read_b128 a[28:31], v16 offset:14336
  v_mfma_f32_16x16x32_bf16 v[232:235], a[52:55], a[104:107], v[232:235]
  v_mfma_f32_16x16x32_bf16 a[136:139], a[56:59], a[104:107], a[136:139]
  ds_read_b64_tr_b16 a[68:69], v19 offset:0
  v_mfma_f32_16x16x32_bf16 a[168:171], a[60:63], a[104:107], a[168:171]
  buffer_load_dwordx4 v59, s[12:15], s47 offen offset:3072 lds
  v_mfma_f32_16x16x32_bf16 v[76:79], a[32:35], a[108:111], v[76:79]
  s_add_u32 m0, s41, 4096
  ds_read_b64_tr_b16 a[70:71], v19 offset:2048
  v_mfma_f32_16x16x32_bf16 v[108:111], a[36:39], a[108:111], v[108:111]
  v_mfma_f32_16x16x32_bf16 v[140:143], a[40:43], a[108:111], v[140:143]
  v_mfma_f32_16x16x32_bf16 v[172:175], a[44:47], a[108:111], v[172:175]
  ds_read_b64_tr_b16 a[72:73], v20 offset:0
  v_mfma_f32_16x16x32_bf16 v[204:207], a[48:51], a[108:111], v[204:207]
  v_mfma_f32_16x16x32_bf16 v[236:239], a[52:55], a[108:111], v[236:239]
  ds_read_b64_tr_b16 a[74:75], v20 offset:2048
  v_mfma_f32_16x16x32_bf16 a[140:143], a[56:59], a[108:111], a[140:143]
  v_mfma_f32_16x16x32_bf16 a[172:175], a[60:63], a[108:111], a[172:175]
  buffer_load_dwordx4 v60, s[12:15], s47 offen offset:0 lds
  v_mfma_f32_16x16x32_bf16 v[80:83], a[32:35], a[112:115], v[80:83]
  ds_read_b64_tr_b16 a[76:77], v21 offset:0
  v_mfma_f32_16x16x32_bf16 v[112:115], a[36:39], a[112:115], v[112:115]
  ds_read_b64_tr_b16 a[78:79], v21 offset:2048
  v_mfma_f32_16x16x32_bf16 v[144:147], a[40:43], a[112:115], v[144:147]
  v_mfma_f32_16x16x32_bf16 v[176:179], a[44:47], a[112:115], v[176:179]
  v_mfma_f32_16x16x32_bf16 v[208:211], a[48:51], a[112:115], v[208:211]
  ds_read_b64_tr_b16 a[80:81], v18 offset:8192
  v_mfma_f32_16x16x32_bf16 v[240:243], a[52:55], a[112:115], v[240:243]
  v_mfma_f32_16x16x32_bf16 a[144:147], a[56:59], a[112:115], a[144:147]
  ds_read_b64_tr_b16 a[82:83], v18 offset:10240
  v_mfma_f32_16x16x32_bf16 a[176:179], a[60:63], a[112:115], a[176:179]
  buffer_load_dwordx4 v61, s[12:15], s47 offen offset:1024 lds
  v_mfma_f32_16x16x32_bf16 v[84:87], a[32:35], a[116:119], v[84:87]
  ds_read_b64_tr_b16 a[84:85], v19 offset:8192
  v_mfma_f32_16x16x32_bf16 v[116:119], a[36:39], a[116:119], v[116:119]
  v_mfma_f32_16x16x32_bf16 v[148:151], a[40:43], a[116:119], v[148:151]
  ds_read_b64_tr_b16 a[86:87], v19 offset:10240
  v_mfma_f32_16x16x32_bf16 v[180:183], a[44:47], a[116:119], v[180:183]
  v_mfma_f32_16x16x32_bf16 v[212:215], a[48:51], a[116:119], v[212:215]
  v_mfma_f32_16x16x32_bf16 v[244:247], a[52:55], a[116:119], v[244:247]
  ds_read_b64_tr_b16 a[88:89], v20 offset:8192
  v_mfma_f32_16x16x32_bf16 a[148:151], a[56:59], a[116:119], a[148:151]
  v_mfma_f32_16x16x32_bf16 a[180:183], a[60:63], a[116:119], a[180:183]
  buffer_load_dwordx4 v62, s[12:15], s47 offen offset:2048 lds
  v_mfma_f32_16x16x32_bf16 v[88:91], a[32:35], a[120:123], v[88:91]
  ds_read_b64_tr_b16 a[90:91], v20 offset:10240
  v_mfma_f32_16x16x32_bf16 v[120:123], a[36:39], a[120:123], v[120:123]
  ds_read_b64_tr_b16 a[92:93], v21 offset:8192
  v_mfma_f32_16x16x32_bf16 v[152:155], a[40:43], a[120:123], v[152:155]
  v_mfma_f32_16x16x32_bf16 v[184:187], a[44:47], a[120:123], v[184:187]
  ds_read_b64_tr_b16 a[94:95], v21 offset:10240
  v_mfma_f32_16x16x32_bf16 v[216:219], a[48:51], a[120:123], v[216:219]
  v_mfma_f32_16x16x32_bf16 v[248:251], a[52:55], a[120:123], v[248:251]
  v_mfma_f32_16x16x32_bf16 a[152:155], a[56:59], a[120:123], a[152:155]
  v_mfma_f32_16x16x32_bf16 a[184:187], a[60:63], a[120:123], a[184:187]
  buffer_load_dwordx4 v63, s[12:15], s47 offen offset:3072 lds
  v_mfma_f32_16x16x32_bf16 v[92:95], a[32:35], a[124:127], v[92:95]
  v_mfma_f32_16x16x32_bf16 v[124:127], a[36:39], a[124:127], v[124:127]
  v_mfma_f32_16x16x32_bf16 v[156:159], a[40:43], a[124:127], v[156:159]
  v_mfma_f32_16x16x32_bf16 v[188:191], a[44:47], a[124:127], v[188:191]
  v_mfma_f32_16x16x32_bf16 v[220:223], a[48:51], a[124:127], v[220:223]
  v_mfma_f32_16x16x32_bf16 v[252:255], a[52:55], a[124:127], v[252:255]
  v_mfma_f32_16x16x32_bf16 a[156:159], a[56:59], a[124:127], a[156:159]
  v_mfma_f32_16x16x32_bf16 a[188:191], a[60:63], a[124:127], a[188:191]
  s_waitcnt lgkmcnt(0)
  v_mfma_f32_16x16x32_bf16 v[64:67], a[0:3], a[64:67], v[64:67]
  s_mov_b32 m0, s36
  ds_read_b128 a[32:35], v17 offset:0
  v_mfma_f32_16x16x32_bf16 v[96:99], a[4:7], a[64:67], v[96:99]
  buffer_load_dwordx4 v48, s[8:11], s46 offen offset:0 lds
  v_mfma_f32_16x16x32_bf16 v[128:131], a[8:11], a[64:67], v[128:131]
  ds_read_b64_tr_b16 a[96:97], v18 offset:4096
  v_mfma_f32_16x16x32_bf16 v[160:163], a[12:15], a[64:67], v[160:163]
  v_mfma_f32_16x16x32_bf16 v[192:195], a[16:19], a[64:67], v[192:195]
  ds_read_b64_tr_b16 a[98:99], v18 offset:6144
  v_mfma_f32_16x16x32_bf16 v[224:227], a[20:23], a[64:67], v[224:227]
  v_mfma_f32_16x16x32_bf16 a[128:131], a[24:27], a[64:67], a[128:131]
  ds_read_b128 a[36:39], v17 offset:2048
  v_mfma_f32_16x16x32_bf16 a[160:163], a[28:31], a[64:67], a[160:163]
  buffer_load_dwordx4 v49, s[8:11], s46 offen offset:1024 lds
  v_mfma_f32_16x16x32_bf16 v[68:71], a[0:3], a[68:71], v[68:71]
  v_mfma_f32_16x16x32_bf16 v[100:103], a[4:7], a[68:71], v[100:103]
  ds_read_b128 a[40:43], v17 offset:4096
  v_mfma_f32_16x16x32_bf16 v[132:135], a[8:11], a[68:71], v[132:135]
  v_mfma_f32_16x16x32_bf16 v[164:167], a[12:15], a[68:71], v[164:167]
  ds_read_b128 a[44:47], v17 offset:6144
  v_mfma_f32_16x16x32_bf16 v[196:199], a[16:19], a[68:71], v[196:199]
  v_mfma_f32_16x16x32_bf16 v[228:231], a[20:23], a[68:71], v[228:231]
  ds_read_b128 a[48:51], v17 offset:8192
  v_mfma_f32_16x16x32_bf16 a[132:135], a[24:27], a[68:71], a[132:135]
  buffer_load_dwordx4 v50, s[8:11], s46 offen offset:2048 lds
  v_mfma_f32_16x16x32_bf16 a[164:167], a[28:31], a[68:71], a[164:167]
  ds_read_b128 a[52:55], v17 offset:10240
  v_mfma_f32_16x16x32_bf16 v[72:75], a[0:3], a[72:75], v[72:75]
  v_mfma_f32_16x16x32_bf16 v[104:107], a[4:7], a[72:75], v[104:107]
  v_mfma_f32_16x16x32_bf16 v[136:139], a[8:11], a[72:75], v[136:139]
  ds_read_b128 a[56:59], v17 offset:12288
  v_mfma_f32_16x16x32_bf16 v[168:171], a[12:15], a[72:75], v[168:171]
  v_mfma_f32_16x16x32_bf16 v[200:203], a[16:19], a[72:75], v[200:203]
  ds_read_b128 a[60:63], v17 offset:14336
  v_mfma_f32_16x16x32_bf16 v[232:235], a[20:23], a[72:75], v[232:235]
  buffer_load_dwordx4 v51, s[8:11], s46 offen offset:3072 lds
  v_mfma_f32_16x16x32_bf16 a[136:139], a[24:27], a[72:75], a[136:139]
  s_add_u32 m0, s36, 4096
  ds_read_b64_tr_b16 a[100:101], v19 offset:4096
  v_mfma_f32_16x16x32_bf16 a[168:171], a[28:31], a[72:75], a[168:171]
  s_add_u32 s36, s36, s38
  v_mfma_f32_16x16x32_bf16 v[76:79], a[0:3], a[76:79], v[76:79]
  s_add_u32 s37, s37, 1
  ds_read_b64_tr_b16 a[102:103], v19 offset:6144
  v_mfma_f32_16x16x32_bf16 v[108:111], a[4:7], a[76:79], v[108:111]
  s_cmp_eq_u32 s37, 3
  s_cselect_b32 s37, 0, s37
  s_cselect_b32 s38, s39, s40
  v_mfma_f32_16x16x32_bf16 v[140:143], a[8:11], a[76:79], v[140:143]
  s_add_u32 s41, s41, s43
  v_mfma_f32_16x16x32_bf16 v[172:175], a[12:15], a[76:79], v[172:175]
  s_sub_u32 s43, 0, s43
  ds_read_b64_tr_b16 a[104:105], v20 offset:4096
  v_mfma_f32_16x16x32_bf16 v[204:207], a[16:19], a[76:79], v[204:207]
  buffer_load_dwordx4 v52, s[8:11], s46 offen offset:0 lds
  v_mfma_f32_16x16x32_bf16 v[236:239], a[20:23], a[76:79], v[236:239]
  ds_read_b64_tr_b16 a[106:107], v20 offset:6144
  v_mfma_f32_16x16x32_bf16 a[140:143], a[24:27], a[76:79], a[140:143]
  v_mfma_f32_16x16x32_bf16 a[172:175], a[28:31], a[76:79], a[172:175]
  ds_read_b64_tr_b16 a[108:109], v21 offset:4096
  v_mfma_f32_16x16x32_bf16 v[80:83], a[0:3], a[80:83], v[80:83]
  v_mfma_f32_16x16x32_bf16 v[112:115], a[4:7], a[80:83], v[112:115]
  ds_read_b64_tr_b16 a[110:111], v21 offset:6144
  v_mfma_f32_16x16x32_bf16 v[144:147], a[8:11], a[80:83], v[144:147]
  v_mfma_f32_16x16x32_bf16 v[176:179], a[12:15], a[80:83], v[176:179]
  buffer_load_dwordx4 v53, s[8:11], s46 offen offset:1024 lds
  v_mfma_f32_16x16x32_bf16 v[208:211], a[16:19], a[80:83], v[208:211]
  ds_read_b64_tr_b16 a[112:113], v18 offset:12288
  v_mfma_f32_16x16x32_bf16 v[240:243], a[20:23], a[80:83], v[240:243]
  v_mfma_f32_16x16x32_bf16 a[144:147], a[24:27], a[80:83], a[144:147]
  ds_read_b64_tr_b16 a[114:115], v18 offset:14336
  v_mfma_f32_16x16x32_bf16 a[176:179], a[28:31], a[80:83], a[176:179]
  v_mfma_f32_16x16x32_bf16 v[84:87], a[0:3], a[84:87], v[84:87]
  ds_read_b64_tr_b16 a[116:117], v19 offset:12288
  v_mfma_f32_16x16x32_bf16 v[116:119], a[4:7], a[84:87], v[116:119]
  v_mfma_f32_16x16x32_bf16 v[148:151], a[8:11], a[84:87], v[148:151]
  buffer_load_dwordx4 v54, s[8:11], s46 offen offset:2048 lds
  v_mfma_f32_16x16x32_bf16 v[180:183], a[12:15], a[84:87], v[180:183]
  ds_read_b64_tr_b16 a[118:119], v19 offset:14336
  v_mfma_f32_16x16x32_bf16 v[212:215], a[16:19], a[84:87], v[212:215]
  v_mfma_f32_16x16x32_bf16 v[244:247], a[20:23], a[84:87], v[244:247]
  ds_read_b64_tr_b16 a[120:121], v20 offset:12288
  v_mfma_f32_16x16x32_bf16 a[148:151], a[24:27], a[84:87], a[148:151]
  v_mfma_f32_16x16x32_bf16 a[180:183], a[28:31], a[84:87], a[180:183]
  ds_read_b64_tr_b16 a[122:123], v20 offset:14336
  v_mfma_f32_16x16x32_bf16 v[88:91], a[0:3], a[88:91], v[88:91]
  v_mfma_f32_16x16x32_bf16 v[120:123], a[4:7], a[88:91], v[120:123]
  buffer_load_dwordx4 v55, s[8:11], s46 offen offset:3072 lds
  v_mfma_f32_16x16x32_bf16 v[152:155], a[8:11], a[88:91], v[152:155]
  s_sub_u32 s50, s50, 1
  ds_read_b64_tr_b16 a[124:125], v21 offset:12288
  v_mfma_f32_16x16x32_bf16 v[184:187], a[12:15], a[88:91], v[184:187]
  ds_read_b64_tr_b16 a[126:127], v21 offset:14336
  v_mfma_f32_16x16x32_bf16 v[216:219], a[16:19], a[88:91], v[216:219]
  s_cmp_eq_u32 s50, 0
  s_cselect_b32 s12, s72, s12
  s_cselect_b32 s13, s73, s13
  v_mfma_f32_16x16x32_bf16 v[248:251], a[20:23], a[88:91], v[248:251]
  s_lshl_b32 s47, s48, 19
  v_add_u32 v16, s38, v16
  v_add_u32 v17, s38, v17
  v_mfma_f32_16x16x32_bf16 a[152:155], a[24:27], a[88:91], a[152:155]
  s_bfe_u32 s34, 0x3020106, s49
  v_add_u32 v18, s43, v18
  v_add_u32 v19, s43, v19
  v_mfma_f32_16x16x32_bf16 a[184:187], a[28:31], a[88:91], a[184:187]
  s_add_u32 s48, s48, s34
  v_add_u32 v20, s43, v20
  v_add_u32 v21, s43, v21
  v_mfma_f32_16x16x32_bf16 v[92:95], a[0:3], a[92:95], v[92:95]
  s_add_u32 s49, s49, 8
  v_mfma_f32_16x16x32_bf16 v[124:127], a[4:7], a[92:95], v[124:127]
  s_and_b32 s49, s49, 0x8001f
  v_mfma_f32_16x16x32_bf16 v[156:159], a[8:11], a[92:95], v[156:159]
  s_and_b32 s48, s48, 7
  v_mfma_f32_16x16x32_bf16 v[188:191], a[12:15], a[92:95], v[188:191]
  s_lshl_b32 s46, s48, 7
  v_mfma_f32_16x16x32_bf16 v[220:223], a[16:19], a[92:95], v[220:223]
  v_mfma_f32_16x16x32_bf16 v[252:255], a[20:23], a[92:95], v[252:255]
  s_waitcnt vmcnt(8) lgkmcnt(0)
  s_barrier
  v_mfma_f32_16x16x32_bf16 a[156:159], a[24:27], a[92:95], a[156:159]
  s_sub_u32 s35, s35, 1
  v_mfma_f32_16x16x32_bf16 a[188:191], a[28:31], a[92:95], a[188:191]
  s_cmp_lg_u32 s35, 0
  s_cbranch_scc1 Lp1xw_loop
  v_accvgpr_read_b32 v4, a222
  v_accvgpr_read_b32 v5, a223
  v_accvgpr_read_b32 v6, a224
  v_accvgpr_read_b32 v7, a225
  v_accvgpr_read_b32 v8, a226
  v_accvgpr_read_b32 v9, a227
  v_accvgpr_read_b32 v10, a228
  v_accvgpr_read_b32 v11, a229
  s_mov_b32 s8, s64
  s_mov_b32 s9, s65
  s_mov_b32 s10, 4194304
  s_mov_b32 s11, 0x00020000
  s_mov_b32 s20, s68
  s_mov_b32 s21, s69
  s_mov_b32 s22, 8388608
  s_mov_b32 s23, 0x00020000
  s_and_b32 s4, s2, 7
  s_lshl_b32 s4, s4, 1
  s_lshr_b32 s5, s2, 6
  s_lshr_b32 s30, s2, 4
  s_add_u32 s5, s5, s30
  s_and_b32 s53, s5, 3
  s_lshl_b32 s53, s53, 3
  s_or_b32 s53, s53, 0x80000
  s_bfe_u32 s52, 0xf0f02, s53
  s_add_u32 s52, s52, s4
  s_and_b32 s52, s52, 15
  s_mov_b32 s54, s52
  s_mov_b32 s55, s53
  s_lshl_b32 s29, s52, 7
  s_lshl_b32 s28, s54, 19
  s_lshl_b32 s30, s25, 18
  s_and_b32 s31, s25, 1
  s_lshl_b32 s31, s31, 1
  s_add_u32 s31, s31, 14
  s_sub_u32 s31, s31, s25
  s_lshl_b32 s31, s31, 18
  s_or_b32 s26, s30, s29
  s_or_b32 s27, s31, s29
  s_lshl_b32 s68, s3, 12
  s_lshl_b32 s88, s3, 13
  s_add_u32 s88, s88, 98304
  v_mfma_f32_16x16x32_bf16 v[64:67], a[32:35], a[96:99], v[64:67]
  s_mov_b32 m0, s41
  ds_read_b128 a[0:3], v16 offset:0
  v_mfma_f32_16x16x32_bf16 v[96:99], a[36:39], a[96:99], v[96:99]
  buffer_load_dwordx4 v56, s[12:15], s47 offen offset:0 lds
  v_mfma_f32_16x16x32_bf16 v[128:131], a[40:43], a[96:99], v[128:131]
  ds_read_b64_tr_b16 a[64:65], v18 offset:0
  v_mfma_f32_16x16x32_bf16 v[160:163], a[44:47], a[96:99], v[160:163]
  v_mfma_f32_16x16x32_bf16 v[192:195], a[48:51], a[96:99], v[192:195]
  ds_read_b64_tr_b16 a[66:67], v18 offset:2048
  v_mfma_f32_16x16x32_bf16 v[224:227], a[52:55], a[96:99], v[224:227]
  v_mfma_f32_16x16x32_bf16 a[128:131], a[56:59], a[96:99], a[128:131]
  ds_read_b128 a[4:7], v16 offset:2048
  v_mfma_f32_16x16x32_bf16 a[160:163], a[60:63], a[96:99], a[160:163]
  buffer_load_dwordx4 v57, s[12:15], s47 offen offset:1024 lds
  v_mfma_f32_16x16x32_bf16 v[68:71], a[32:35], a[100:103], v[68:71]
  v_mfma_f32_16x16x32_bf16 v[100:103], a[36:39], a[100:103], v[100:103]
  ds_read_b128 a[8:11], v16 offset:4096
  v_mfma_f32_16x16x32_bf16 v[132:135], a[40:43], a[100:103], v[132:135]
  v_mfma_f32_16x16x32_bf16 v[164:167], a[44:47], a[100:103], v[164:167]
  ds_read_b128 a[12:15], v16 offset:6144
  v_mfma_f32_16x16x32_bf16 v[196:199], a[48:51], a[100:103], v[196:199]
  v_mfma_f32_16x16x32_bf16 v[228:231], a[52:55], a[100:103], v[228:231]
  ds_read_b128 a[16:19], v16 offset:8192
  v_mfma_f32_16x16x32_bf16 a[132:135], a[56:59], a[100:103], a[132:135]
  v_mfma_f32_16x16x32_bf16 a[164:167], a[60:63], a[100:103], a[164:167]
  buffer_load_dwordx4 v58, s[12:15], s47 offen offset:2048 lds
  v_mfma_f32_16x16x32_bf16 v[72:75], a[32:35], a[104:107], v[72:75]
  ds_read_b128 a[20:23], v16 offset:10240
  v_mfma_f32_16x16x32_bf16 v[104:107], a[36:39], a[104:107], v[104:107]
  v_mfma_f32_16x16x32_bf16 v[136:139], a[40:43], a[104:107], v[136:139]
  ds_read_b128 a[24:27], v16 offset:12288
  v_mfma_f32_16x16x32_bf16 v[168:171], a[44:47], a[104:107], v[168:171]
  v_mfma_f32_16x16x32_bf16 v[200:203], a[48:51], a[104:107], v[200:203]
  ds_read_b128 a[28:31], v16 offset:14336
  v_mfma_f32_16x16x32_bf16 v[232:235], a[52:55], a[104:107], v[232:235]
  v_mfma_f32_16x16x32_bf16 a[136:139], a[56:59], a[104:107], a[136:139]
  ds_read_b64_tr_b16 a[68:69], v19 offset:0
  v_mfma_f32_16x16x32_bf16 a[168:171], a[60:63], a[104:107], a[168:171]
  buffer_load_dwordx4 v59, s[12:15], s47 offen offset:3072 lds
  v_mfma_f32_16x16x32_bf16 v[76:79], a[32:35], a[108:111], v[76:79]
  s_add_u32 m0, s41, 4096
  ds_read_b64_tr_b16 a[70:71], v19 offset:2048
  v_mfma_f32_16x16x32_bf16 v[108:111], a[36:39], a[108:111], v[108:111]
  v_mfma_f32_16x16x32_bf16 v[140:143], a[40:43], a[108:111], v[140:143]
  v_mfma_f32_16x16x32_bf16 v[172:175], a[44:47], a[108:111], v[172:175]
  ds_read_b64_tr_b16 a[72:73], v20 offset:0
  v_mfma_f32_16x16x32_bf16 v[204:207], a[48:51], a[108:111], v[204:207]
  v_mfma_f32_16x16x32_bf16 v[236:239], a[52:55], a[108:111], v[236:239]
  ds_read_b64_tr_b16 a[74:75], v20 offset:2048
  v_mfma_f32_16x16x32_bf16 a[140:143], a[56:59], a[108:111], a[140:143]
  v_mfma_f32_16x16x32_bf16 a[172:175], a[60:63], a[108:111], a[172:175]
  buffer_load_dwordx4 v60, s[12:15], s47 offen offset:0 lds
  v_mfma_f32_16x16x32_bf16 v[80:83], a[32:35], a[112:115], v[80:83]
  ds_read_b64_tr_b16 a[76:77], v21 offset:0
  v_mfma_f32_16x16x32_bf16 v[112:115], a[36:39], a[112:115], v[112:115]
  ds_read_b64_tr_b16 a[78:79], v21 offset:2048
  v_mfma_f32_16x16x32_bf16 v[144:147], a[40:43], a[112:115], v[144:147]
  v_mfma_f32_16x16x32_bf16 v[176:179], a[44:47], a[112:115], v[176:179]
  v_mfma_f32_16x16x32_bf16 v[208:211], a[48:51], a[112:115], v[208:211]
  ds_read_b64_tr_b16 a[80:81], v18 offset:8192
  v_mfma_f32_16x16x32_bf16 v[240:243], a[52:55], a[112:115], v[240:243]
  v_mfma_f32_16x16x32_bf16 a[144:147], a[56:59], a[112:115], a[144:147]
  ds_read_b64_tr_b16 a[82:83], v18 offset:10240
  v_mfma_f32_16x16x32_bf16 a[176:179], a[60:63], a[112:115], a[176:179]
  buffer_load_dwordx4 v61, s[12:15], s47 offen offset:1024 lds
  v_mfma_f32_16x16x32_bf16 v[84:87], a[32:35], a[116:119], v[84:87]
  ds_read_b64_tr_b16 a[84:85], v19 offset:8192
  v_mfma_f32_16x16x32_bf16 v[116:119], a[36:39], a[116:119], v[116:119]
  v_mfma_f32_16x16x32_bf16 v[148:151], a[40:43], a[116:119], v[148:151]
  ds_read_b64_tr_b16 a[86:87], v19 offset:10240
  v_mfma_f32_16x16x32_bf16 v[180:183], a[44:47], a[116:119], v[180:183]
  v_mfma_f32_16x16x32_bf16 v[212:215], a[48:51], a[116:119], v[212:215]
  v_mfma_f32_16x16x32_bf16 v[244:247], a[52:55], a[116:119], v[244:247]
  ds_read_b64_tr_b16 a[88:89], v20 offset:8192
  v_mfma_f32_16x16x32_bf16 a[148:151], a[56:59], a[116:119], a[148:151]
  v_mfma_f32_16x16x32_bf16 a[180:183], a[60:63], a[116:119], a[180:183]
  buffer_load_dwordx4 v62, s[12:15], s47 offen offset:2048 lds
  v_mfma_f32_16x16x32_bf16 v[88:91], a[32:35], a[120:123], v[88:91]
  ds_read_b64_tr_b16 a[90:91], v20 offset:10240
  v_mfma_f32_16x16x32_bf16 v[120:123], a[36:39], a[120:123], v[120:123]
  ds_read_b64_tr_b16 a[92:93], v21 offset:8192
  v_mfma_f32_16x16x32_bf16 v[152:155], a[40:43], a[120:123], v[152:155]
  v_mfma_f32_16x16x32_bf16 v[184:187], a[44:47], a[120:123], v[184:187]
  ds_read_b64_tr_b16 a[94:95], v21 offset:10240
  v_mfma_f32_16x16x32_bf16 v[216:219], a[48:51], a[120:123], v[216:219]
  v_mfma_f32_16x16x32_bf16 v[248:251], a[52:55], a[120:123], v[248:251]
  v_mfma_f32_16x16x32_bf16 a[152:155], a[56:59], a[120:123], a[152:155]
  v_mfma_f32_16x16x32_bf16 a[184:187], a[60:63], a[120:123], a[184:187]
  buffer_load_dwordx4 v63, s[12:15], s47 offen offset:3072 lds
  v_mfma_f32_16x16x32_bf16 v[92:95], a[32:35], a[124:127], v[92:95]
  v_mfma_f32_16x16x32_bf16 v[124:127], a[36:39], a[124:127], v[124:127]
  v_mfma_f32_16x16x32_bf16 v[156:159], a[40:43], a[124:127], v[156:159]
  v_mfma_f32_16x16x32_bf16 v[188:191], a[44:47], a[124:127], v[188:191]
  v_mfma_f32_16x16x32_bf16 v[220:223], a[48:51], a[124:127], v[220:223]
  v_mfma_f32_16x16x32_bf16 v[252:255], a[52:55], a[124:127], v[252:255]
  v_mfma_f32_16x16x32_bf16 a[156:159], a[56:59], a[124:127], a[156:159]
  v_mfma_f32_16x16x32_bf16 a[188:191], a[60:63], a[124:127], a[188:191]
  s_waitcnt lgkmcnt(0)
  v_mfma_f32_16x16x32_bf16 v[64:67], a[0:3], a[64:67], v[64:67]
  s_mov_b32 m0, s68
  ds_read_b128 a[32:35], v17 offset:0
  v_mfma_f32_16x16x32_bf16 v[96:99], a[4:7], a[64:67], v[96:99]
  buffer_load_dwordx4 v8, s[20:23], s28 offen offset:0 lds
  v_mfma_f32_16x16x32_bf16 v[128:131], a[8:11], a[64:67], v[128:131]
  ds_read_b64_tr_b16 a[96:97], v18 offset:4096
  v_mfma_f32_16x16x32_bf16 v[160:163], a[12:15], a[64:67], v[160:163]
  v_mfma_f32_16x16x32_bf16 v[192:195], a[16:19], a[64:67], v[192:195]
  ds_read_b64_tr_b16 a[98:99], v18 offset:6144
  v_mfma_f32_16x16x32_bf16 v[224:227], a[20:23], a[64:67], v[224:227]
  v_mfma_f32_16x16x32_bf16 a[128:131], a[24:27], a[64:67], a[128:131]
  ds_read_b128 a[36:39], v17 offset:2048
  v_mfma_f32_16x16x32_bf16 a[160:163], a[28:31], a[64:67], a[160:163]
  buffer_load_dwordx4 v9, s[20:23], s28 offen offset:1024 lds
  v_mfma_f32_16x16x32_bf16 v[68:71], a[0:3], a[68:71], v[68:71]
  v_mfma_f32_16x16x32_bf16 v[100:103], a[4:7], a[68:71], v[100:103]
  ds_read_b128 a[40:43], v17 offset:4096
  v_mfma_f32_16x16x32_bf16 v[132:135], a[8:11], a[68:71], v[132:135]
  v_mfma_f32_16x16x32_bf16 v[164:167], a[12:15], a[68:71], v[164:167]
  ds_read_b128 a[44:47], v17 offset:6144
  v_mfma_f32_16x16x32_bf16 v[196:199], a[16:19], a[68:71], v[196:199]
  v_mfma_f32_16x16x32_bf16 v[228:231], a[20:23], a[68:71], v[228:231]
  ds_read_b128 a[48:51], v17 offset:8192
  v_mfma_f32_16x16x32_bf16 a[132:135], a[24:27], a[68:71], a[132:135]
  buffer_load_dwordx4 v10, s[20:23], s28 offen offset:2048 lds
  v_mfma_f32_16x16x32_bf16 a[164:167], a[28:31], a[68:71], a[164:167]
  ds_read_b128 a[52:55], v17 offset:10240
  v_mfma_f32_16x16x32_bf16 v[72:75], a[0:3], a[72:75], v[72:75]
  v_mfma_f32_16x16x32_bf16 v[104:107], a[4:7], a[72:75], v[104:107]
  v_mfma_f32_16x16x32_bf16 v[136:139], a[8:11], a[72:75], v[136:139]
  ds_read_b128 a[56:59], v17 offset:12288
  v_mfma_f32_16x16x32_bf16 v[168:171], a[12:15], a[72:75], v[168:171]
  v_mfma_f32_16x16x32_bf16 v[200:203], a[16:19], a[72:75], v[200:203]
  ds_read_b128 a[60:63], v17 offset:14336
  v_mfma_f32_16x16x32_bf16 v[232:235], a[20:23], a[72:75], v[232:235]
  buffer_load_dwordx4 v11, s[20:23], s28 offen offset:3072 lds
  v_mfma_f32_16x16x32_bf16 a[136:139], a[24:27], a[72:75], a[136:139]
  s_bfe_u32 s56, 0x302010e, s55
  s_add_u32 s54, s54, s56
  s_add_u32 s55, s55, 8
  v_mfma_f32_16x16x32_bf16 a[168:171], a[28:31], a[72:75], a[168:171]
  s_and_b32 s55, s55, 0x8001f
  s_and_b32 s54, s54, 15
  s_lshl_b32 s28, s54, 19
  v_mfma_f32_16x16x32_bf16 v[76:79], a[0:3], a[76:79], v[76:79]
  s_add_u32 m0, s68, 16384
  ds_read_b64_tr_b16 a[100:101], v19 offset:4096
  ds_read_b64_tr_b16 a[102:103], v19 offset:6144
  v_mfma_f32_16x16x32_bf16 v[108:111], a[4:7], a[76:79], v[108:111]
  s_add_u32 s36, s36, s38
  v_mfma_f32_16x16x32_bf16 v[140:143], a[8:11], a[76:79], v[140:143]
  s_add_u32 s37, s37, 1
  v_mfma_f32_16x16x32_bf16 v[172:175], a[12:15], a[76:79], v[172:175]
  ds_read_b64_tr_b16 a[104:105], v20 offset:4096
  v_mfma_f32_16x16x32_bf16 v[204:207], a[16:19], a[76:79], v[204:207]
  buffer_load_dwordx4 v8, s[20:23], s28 offen offset:0 lds
  v_mfma_f32_16x16x32_bf16 v[236:239], a[20:23], a[76:79], v[236:239]
  ds_read_b64_tr_b16 a[106:107], v20 offset:6144
  v_mfma_f32_16x16x32_bf16 a[140:143], a[24:27], a[76:79], a[140:143]
  s_cmp_eq_u32 s37, 3
  s_cselect_b32 s37, 0, s37
  s_cselect_b32 s38, s39, s40
  v_mfma_f32_16x16x32_bf16 a[172:175], a[28:31], a[76:79], a[172:175]
  s_add_u32 s41, s41, s43
  ds_read_b64_tr_b16 a[108:109], v21 offset:4096
  v_mfma_f32_16x16x32_bf16 v[80:83], a[0:3], a[80:83], v[80:83]
  s_sub_u32 s43, 0, s43
  v_mfma_f32_16x16x32_bf16 v[112:115], a[4:7], a[80:83], v[112:115]
  ds_read_b64_tr_b16 a[110:111], v21 offset:6144
  v_mfma_f32_16x16x32_bf16 v[144:147], a[8:11], a[80:83], v[144:147]
  v_mfma_f32_16x16x32_bf16 v[176:179], a[12:15], a[80:83], v[176:179]
  buffer_load_dwordx4 v9, s[20:23], s28 offen offset:1024 lds
  v_mfma_f32_16x16x32_bf16 v[208:211], a[16:19], a[80:83], v[208:211]
  ds_read_b64_tr_b16 a[112:113], v18 offset:12288
  v_mfma_f32_16x16x32_bf16 v[240:243], a[20:23], a[80:83], v[240:243]
  v_mfma_f32_16x16x32_bf16 a[144:147], a[24:27], a[80:83], a[144:147]
  ds_read_b64_tr_b16 a[114:115], v18 offset:14336
  v_mfma_f32_16x16x32_bf16 a[176:179], a[28:31], a[80:83], a[176:179]
  v_mfma_f32_16x16x32_bf16 v[84:87], a[0:3], a[84:87], v[84:87]
  ds_read_b64_tr_b16 a[116:117], v19 offset:12288
  v_mfma_f32_16x16x32_bf16 v[116:119], a[4:7], a[84:87], v[116:119]
  v_mfma_f32_16x16x32_bf16 v[148:151], a[8:11], a[84:87], v[148:151]
  buffer_load_dwordx4 v10, s[20:23], s28 offen offset:2048 lds
  v_mfma_f32_16x16x32_bf16 v[180:183], a[12:15], a[84:87], v[180:183]
  ds_read_b64_tr_b16 a[118:119], v19 offset:14336
  v_mfma_f32_16x16x32_bf16 v[212:215], a[16:19], a[84:87], v[212:215]
  v_mfma_f32_16x16x32_bf16 v[244:247], a[20:23], a[84:87], v[244:247]
  ds_read_b64_tr_b16 a[120:121], v20 offset:12288
  v_mfma_f32_16x16x32_bf16 a[148:151], a[24:27], a[84:87], a[148:151]
  v_mfma_f32_16x16x32_bf16 a[180:183], a[28:31], a[84:87], a[180:183]
  ds_read_b64_tr_b16 a[122:123], v20 offset:14336
  v_mfma_f32_16x16x32_bf16 v[88:91], a[0:3], a[88:91], v[88:91]
  v_mfma_f32_16x16x32_bf16 v[120:123], a[4:7], a[88:91], v[120:123]
  buffer_load_dwordx4 v11, s[20:23], s28 offen offset:3072 lds
  v_mfma_f32_16x16x32_bf16 v[152:155], a[8:11], a[88:91], v[152:155]
  s_bfe_u32 s56, 0x302010e, s55
  ds_read_b64_tr_b16 a[124:125], v21 offset:12288
  v_mfma_f32_16x16x32_bf16 v[184:187], a[12:15], a[88:91], v[184:187]
  s_add_u32 s54, s54, s56
  ds_read_b64_tr_b16 a[126:127], v21 offset:14336
  v_mfma_f32_16x16x32_bf16 v[216:219], a[16:19], a[88:91], v[216:219]
  s_add_u32 s55, s55, 8
  v_add_u32 v16, s38, v16
  v_add_u32 v17, s38, v17
  v_mfma_f32_16x16x32_bf16 v[248:251], a[20:23], a[88:91], v[248:251]
  s_and_b32 s55, s55, 0x8001f
  v_add_u32 v18, s43, v18
  v_add_u32 v19, s43, v19
  v_mfma_f32_16x16x32_bf16 a[152:155], a[24:27], a[88:91], a[152:155]
  s_and_b32 s54, s54, 15
  v_add_u32 v20, s43, v20
  v_add_u32 v21, s43, v21
  v_mfma_f32_16x16x32_bf16 a[184:187], a[28:31], a[88:91], a[184:187]
  s_lshl_b32 s28, s54, 19
  v_mfma_f32_16x16x32_bf16 v[92:95], a[0:3], a[92:95], v[92:95]
  v_mfma_f32_16x16x32_bf16 v[124:127], a[4:7], a[92:95], v[124:127]
  v_mfma_f32_16x16x32_bf16 v[156:159], a[8:11], a[92:95], v[156:159]
  v_mfma_f32_16x16x32_bf16 v[188:191], a[12:15], a[92:95], v[188:191]
  v_mfma_f32_16x16x32_bf16 v[220:223], a[16:19], a[92:95], v[220:223]
  v_mfma_f32_16x16x32_bf16 v[252:255], a[20:23], a[92:95], v[252:255]
  v_mfma_f32_16x16x32_bf16 a[156:159], a[24:27], a[92:95], a[156:159]
  v_mfma_f32_16x16x32_bf16 a[188:191], a[28:31], a[92:95], a[188:191]
  s_waitcnt vmcnt(8) lgkmcnt(0)
  s_barrier
  v_mfma_f32_16x16x32_bf16 v[64:67], a[32:35], a[96:99], v[64:67]
  s_mov_b32 m0, s88
  ds_read_b128 a[0:3], v16 offset:0
  v_mfma_f32_16x16x32_bf16 v[96:99], a[36:39], a[96:99], v[96:99]
  buffer_load_dwordx4 v4, s[8:11], s26 offen offset:0 lds
  v_mfma_f32_16x16x32_bf16 v[128:131], a[40:43], a[96:99], v[128:131]
  ds_read_b64_tr_b16 a[64:65], v18 offset:0
  v_mfma_f32_16x16x32_bf16 v[160:163], a[44:47], a[96:99], v[160:163]
  v_mfma_f32_16x16x32_bf16 v[192:195], a[48:51], a[96:99], v[192:195]
  ds_read_b64_tr_b16 a[66:67], v18 offset:2048
  v_mfma_f32_16x16x32_bf16 v[224:227], a[52:55], a[96:99], v[224:227]
  v_mfma_f32_16x16x32_bf16 a[128:131], a[56:59], a[96:99], a[128:131]
  ds_read_b128 a[4:7], v16 offset:2048
  v_mfma_f32_16x16x32_bf16 a[160:163], a[60:63], a[96:99], a[160:163]
  buffer_load_dwordx4 v5, s[8:11], s26 offen offset:1024 lds
  v_mfma_f32_16x16x32_bf16 v[68:71], a[32:35], a[100:103], v[68:71]
  v_mfma_f32_16x16x32_bf16 v[100:103], a[36:39], a[100:103], v[100:103]
  ds_read_b128 a[8:11], v16 offset:4096
  v_mfma_f32_16x16x32_bf16 v[132:135], a[40:43], a[100:103], v[132:135]
  v_mfma_f32_16x16x32_bf16 v[164:167], a[44:47], a[100:103], v[164:167]
  ds_read_b128 a[12:15], v16 offset:6144
  v_mfma_f32_16x16x32_bf16 v[196:199], a[48:51], a[100:103], v[196:199]
  v_mfma_f32_16x16x32_bf16 v[228:231], a[52:55], a[100:103], v[228:231]
  ds_read_b128 a[16:19], v16 offset:8192
  v_mfma_f32_16x16x32_bf16 a[132:135], a[56:59], a[100:103], a[132:135]
  v_mfma_f32_16x16x32_bf16 a[164:167], a[60:63], a[100:103], a[164:167]
  buffer_load_dwordx4 v6, s[8:11], s26 offen offset:2048 lds
  v_mfma_f32_16x16x32_bf16 v[72:75], a[32:35], a[104:107], v[72:75]
  ds_read_b128 a[20:23], v16 offset:10240
  v_mfma_f32_16x16x32_bf16 v[104:107], a[36:39], a[104:107], v[104:107]
  v_mfma_f32_16x16x32_bf16 v[136:139], a[40:43], a[104:107], v[136:139]
  ds_read_b128 a[24:27], v16 offset:12288
  v_mfma_f32_16x16x32_bf16 v[168:171], a[44:47], a[104:107], v[168:171]
  v_mfma_f32_16x16x32_bf16 v[200:203], a[48:51], a[104:107], v[200:203]
  ds_read_b128 a[28:31], v16 offset:14336
  v_mfma_f32_16x16x32_bf16 v[232:235], a[52:55], a[104:107], v[232:235]
  v_mfma_f32_16x16x32_bf16 a[136:139], a[56:59], a[104:107], a[136:139]
  ds_read_b64_tr_b16 a[68:69], v19 offset:0
  v_mfma_f32_16x16x32_bf16 a[168:171], a[60:63], a[104:107], a[168:171]
  buffer_load_dwordx4 v7, s[8:11], s26 offen offset:3072 lds
  v_mfma_f32_16x16x32_bf16 v[76:79], a[32:35], a[108:111], v[76:79]
  s_add_u32 m0, s88, 4096
  ds_read_b64_tr_b16 a[70:71], v19 offset:2048
  v_mfma_f32_16x16x32_bf16 v[108:111], a[36:39], a[108:111], v[108:111]
  v_mfma_f32_16x16x32_bf16 v[140:143], a[40:43], a[108:111], v[140:143]
  v_mfma_f32_16x16x32_bf16 v[172:175], a[44:47], a[108:111], v[172:175]
  ds_read_b64_tr_b16 a[72:73], v20 offset:0
  v_mfma_f32_16x16x32_bf16 v[204:207], a[48:51], a[108:111], v[204:207]
  v_mfma_f32_16x16x32_bf16 v[236:239], a[52:55], a[108:111], v[236:239]
  ds_read_b64_tr_b16 a[74:75], v20 offset:2048
  v_mfma_f32_16x16x32_bf16 a[140:143], a[56:59], a[108:111], a[140:143]
  v_mfma_f32_16x16x32_bf16 a[172:175], a[60:63], a[108:111], a[172:175]
  buffer_load_dwordx4 v4, s[8:11], s27 offen offset:0 lds
  v_mfma_f32_16x16x32_bf16 v[80:83], a[32:35], a[112:115], v[80:83]
  ds_read_b64_tr_b16 a[76:77], v21 offset:0
  v_mfma_f32_16x16x32_bf16 v[112:115], a[36:39], a[112:115], v[112:115]
  ds_read_b64_tr_b16 a[78:79], v21 offset:2048
  v_mfma_f32_16x16x32_bf16 v[144:147], a[40:43], a[112:115], v[144:147]
  v_mfma_f32_16x16x32_bf16 v[176:179], a[44:47], a[112:115], v[176:179]
  v_mfma_f32_16x16x32_bf16 v[208:211], a[48:51], a[112:115], v[208:211]
  ds_read_b64_tr_b16 a[80:81], v18 offset:8192
  v_mfma_f32_16x16x32_bf16 v[240:243], a[52:55], a[112:115], v[240:243]
  v_mfma_f32_16x16x32_bf16 a[144:147], a[56:59], a[112:115], a[144:147]
  ds_read_b64_tr_b16 a[82:83], v18 offset:10240
  v_mfma_f32_16x16x32_bf16 a[176:179], a[60:63], a[112:115], a[176:179]
  buffer_load_dwordx4 v5, s[8:11], s27 offen offset:1024 lds
  v_mfma_f32_16x16x32_bf16 v[84:87], a[32:35], a[116:119], v[84:87]
  ds_read_b64_tr_b16 a[84:85], v19 offset:8192
  v_mfma_f32_16x16x32_bf16 v[116:119], a[36:39], a[116:119], v[116:119]
  v_mfma_f32_16x16x32_bf16 v[148:151], a[40:43], a[116:119], v[148:151]
  ds_read_b64_tr_b16 a[86:87], v19 offset:10240
  v_mfma_f32_16x16x32_bf16 v[180:183], a[44:47], a[116:119], v[180:183]
  v_mfma_f32_16x16x32_bf16 v[212:215], a[48:51], a[116:119], v[212:215]
  v_mfma_f32_16x16x32_bf16 v[244:247], a[52:55], a[116:119], v[244:247]
  ds_read_b64_tr_b16 a[88:89], v20 offset:8192
  v_mfma_f32_16x16x32_bf16 a[148:151], a[56:59], a[116:119], a[148:151]
  v_mfma_f32_16x16x32_bf16 a[180:183], a[60:63], a[116:119], a[180:183]
  buffer_load_dwordx4 v6, s[8:11], s27 offen offset:2048 lds
  v_mfma_f32_16x16x32_bf16 v[88:91], a[32:35], a[120:123], v[88:91]
  ds_read_b64_tr_b16 a[90:91], v20 offset:10240
  v_mfma_f32_16x16x32_bf16 v[120:123], a[36:39], a[120:123], v[120:123]
  ds_read_b64_tr_b16 a[92:93], v21 offset:8192
  v_mfma_f32_16x16x32_bf16 v[152:155], a[40:43], a[120:123], v[152:155]
  v_mfma_f32_16x16x32_bf16 v[184:187], a[44:47], a[120:123], v[184:187]
  ds_read_b64_tr_b16 a[94:95], v21 offset:10240
  v_mfma_f32_16x16x32_bf16 v[216:219], a[48:51], a[120:123], v[216:219]
  v_mfma_f32_16x16x32_bf16 v[248:251], a[52:55], a[120:123], v[248:251]
  v_mfma_f32_16x16x32_bf16 a[152:155], a[56:59], a[120:123], a[152:155]
  v_mfma_f32_16x16x32_bf16 a[184:187], a[60:63], a[120:123], a[184:187]
  buffer_load_dwordx4 v7, s[8:11], s27 offen offset:3072 lds
  v_mfma_f32_16x16x32_bf16 v[92:95], a[32:35], a[124:127], v[92:95]
  s_bfe_u32 s29, 0x302010e, s53
  v_mfma_f32_16x16x32_bf16 v[124:127], a[36:39], a[124:127], v[124:127]
  s_add_u32 s52, s52, s29
  v_mfma_f32_16x16x32_bf16 v[156:159], a[40:43], a[124:127], v[156:159]
  s_add_u32 s53, s53, 8
  v_mfma_f32_16x16x32_bf16 v[188:191], a[44:47], a[124:127], v[188:191]
  s_and_b32 s53, s53, 0x8001f
  v_mfma_f32_16x16x32_bf16 v[220:223], a[48:51], a[124:127], v[220:223]
  s_and_b32 s52, s52, 15
  v_mfma_f32_16x16x32_bf16 v[252:255], a[52:55], a[124:127], v[252:255]
  s_lshl_b32 s29, s52, 7
  v_mfma_f32_16x16x32_bf16 a[156:159], a[56:59], a[124:127], a[156:159]
  s_or_b32 s26, s30, s29
  v_mfma_f32_16x16x32_bf16 a[188:191], a[60:63], a[124:127], a[188:191]
  s_or_b32 s27, s31, s29
  s_waitcnt lgkmcnt(0)
  v_mfma_f32_16x16x32_bf16 v[128:131], a[8:11], a[64:67], v[128:131]
  ds_read_b128 a[32:35], v17 offset:0
  ds_read_b64_tr_b16 a[96:97], v18 offset:4096
  v_mfma_f32_16x16x32_bf16 v[160:163], a[12:15], a[64:67], v[160:163]
  ds_read_b64_tr_b16 a[98:99], v18 offset:6144
  ds_read_b128 a[36:39], v17 offset:2048
  v_mfma_f32_16x16x32_bf16 v[132:135], a[8:11], a[68:71], v[132:135]
  ds_read_b128 a[40:43], v17 offset:4096
  ds_read_b128 a[44:47], v17 offset:6144
  v_mfma_f32_16x16x32_bf16 v[164:167], a[12:15], a[68:71], v[164:167]
  ds_read_b128 a[48:51], v17 offset:8192
  ds_read_b128 a[52:55], v17 offset:10240
  v_mfma_f32_16x16x32_bf16 v[136:139], a[8:11], a[72:75], v[136:139]
  ds_read_b128 a[56:59], v17 offset:12288
  ds_read_b128 a[60:63], v17 offset:14336
  v_mfma_f32_16x16x32_bf16 v[168:171], a[12:15], a[72:75], v[168:171]
  ds_read_b64_tr_b16 a[100:101], v19 offset:4096
  ds_read_b64_tr_b16 a[102:103], v19 offset:6144
  v_mfma_f32_16x16x32_bf16 v[140:143], a[8:11], a[76:79], v[140:143]
  ds_read_b64_tr_b16 a[104:105], v20 offset:4096
  v_mfma_f32_16x16x32_bf16 v[172:175], a[12:15], a[76:79], v[172:175]
  ds_read_b64_tr_b16 a[106:107], v20 offset:6144
  ds_read_b64_tr_b16 a[108:109], v21 offset:4096
  v_mfma_f32_16x16x32_bf16 v[144:147], a[8:11], a[80:83], v[144:147]
  ds_read_b64_tr_b16 a[110:111], v21 offset:6144
  ds_read_b64_tr_b16 a[112:113], v18 offset:12288
  v_mfma_f32_16x16x32_bf16 v[176:179], a[12:15], a[80:83], v[176:179]
  ds_read_b64_tr_b16 a[114:115], v18 offset:14336
  ds_read_b64_tr_b16 a[116:117], v19 offset:12288
  v_mfma_f32_16x16x32_bf16 v[148:151], a[8:11], a[84:87], v[148:151]
  ds_read_b64_tr_b16 a[118:119], v19 offset:14336
  ds_read_b64_tr_b16 a[120:121], v20 offset:12288
  v_mfma_f32_16x16x32_bf16 v[180:183], a[12:15], a[84:87], v[180:183]
  ds_read_b64_tr_b16 a[122:123], v20 offset:14336
  ds_read_b64_tr_b16 a[124:125], v21 offset:12288
  v_mfma_f32_16x16x32_bf16 v[152:155], a[8:11], a[88:91], v[152:155]
  ds_read_b64_tr_b16 a[126:127], v21 offset:14336
  v_mfma_f32_16x16x32_bf16 v[184:187], a[12:15], a[88:91], v[184:187]
  v_mfma_f32_16x16x32_bf16 v[156:159], a[8:11], a[92:95], v[156:159]
  v_mfma_f32_16x16x32_bf16 v[188:191], a[12:15], a[92:95], v[188:191]
  v_mfma_f32_16x16x32_bf16 v[192:195], a[16:19], a[64:67], v[192:195]
  v_mfma_f32_16x16x32_bf16 v[224:227], a[20:23], a[64:67], v[224:227]
  s_waitcnt lgkmcnt(0)
  s_barrier
  s_mov_b32 s12, s84
  s_mov_b32 s13, s85
  s_mov_b32 s14, 256
  s_mov_b32 s15, 0x00020000
  buffer_load_dwordx2 v[22:23], off, s[12:15], 0 sc1
  v_mfma_f32_16x16x32_bf16 v[128:131], a[40:43], a[96:99], v[128:131]
  s_add_u32 m0, s88, 32768
  v_mfma_f32_16x16x32_bf16 v[160:163], a[44:47], a[96:99], v[160:163]
  buffer_load_dwordx4 v4, s[8:11], s26 offen offset:0 lds
  v_mfma_f32_16x16x32_bf16 v[132:135], a[40:43], a[100:103], v[132:135]
  v_mfma_f32_16x16x32_bf16 v[164:167], a[44:47], a[100:103], v[164:167]
  v_mfma_f32_16x16x32_bf16 v[136:139], a[40:43], a[104:107], v[136:139]
  v_mfma_f32_16x16x32_bf16 v[168:171], a[44:47], a[104:107], v[168:171]
  buffer_load_dwordx4 v5, s[8:11], s26 offen offset:1024 lds
  v_cvt_pk_bf16_f32 v128, v128, v129
  v_mfma_f32_16x16x32_bf16 v[140:143], a[40:43], a[108:111], v[140:143]
  v_cvt_pk_bf16_f32 v129, v130, v131
  v_cvt_pk_bf16_f32 v130, v160, v161
  v_mfma_f32_16x16x32_bf16 v[172:175], a[44:47], a[108:111], v[172:175]
  v_cvt_pk_bf16_f32 v131, v162, v163
  v_cvt_pk_bf16_f32 v132, v132, v133
  v_mfma_f32_16x16x32_bf16 v[144:147], a[40:43], a[112:115], v[144:147]
  v_cvt_pk_bf16_f32 v133, v134, v135
  v_cvt_pk_bf16_f32 v134, v164, v165
  v_mfma_f32_16x16x32_bf16 v[176:179], a[44:47], a[112:115], v[176:179]
  v_cvt_pk_bf16_f32 v135, v166, v167
  v_mfma_f32_16x16x32_bf16 v[148:151], a[40:43], a[116:119], v[148:151]
  buffer_load_dwordx4 v6, s[8:11], s26 offen offset:2048 lds
  v_mfma_f32_16x16x32_bf16 v[180:183], a[44:47], a[116:119], v[180:183]
  s_add_u32 s60, s63, 8192
  buffer_store_dwordx4 v[128:131], v2, s[16:19], s60 offen offset:0 sc1
  v_cvt_pk_bf16_f32 v136, v136, v137
  v_mfma_f32_16x16x32_bf16 v[152:155], a[40:43], a[120:123], v[152:155]
  v_cvt_pk_bf16_f32 v137, v138, v139
  v_cvt_pk_bf16_f32 v138, v168, v169
  v_mfma_f32_16x16x32_bf16 v[184:187], a[44:47], a[120:123], v[184:187]
  v_cvt_pk_bf16_f32 v139, v170, v171
  v_cvt_pk_bf16_f32 v140, v140, v141
  v_mfma_f32_16x16x32_bf16 v[156:159], a[40:43], a[124:127], v[156:159]
  v_cvt_pk_bf16_f32 v141, v142, v143
  v_cvt_pk_bf16_f32 v142, v172, v173
  v_mfma_f32_16x16x32_bf16 v[188:191], a[44:47], a[124:127], v[188:191]
  v_cvt_pk_bf16_f32 v143, v174, v175
  v_cvt_pk_bf16_f32 v144, v144, v145
  v_mfma_f32_16x16x32_bf16 v[192:195], a[48:51], a[96:99], v[192:195]
  buffer_load_dwordx4 v7, s[8:11], s26 offen offset:3072 lds
  v_cvt_pk_bf16_f32 v145, v146, v147
  v_mfma_f32_16x16x32_bf16 v[224:227], a[52:55], a[96:99], v[224:227]
  s_add_u32 m0, s88, 36864
  v_cvt_pk_bf16_f32 v146, v176, v177
  v_cvt_pk_bf16_f32 v147, v178, v179
  v_mfma_f32_16x16x32_bf16 a[128:131], a[24:27], a[64:67], a[128:131]
  s_add_u32 s60, s63, 8192
  buffer_store_dwordx4 v[132:135], v2, s[16:19], s60 offen offset:1024 sc1
  v_cvt_pk_bf16_f32 v148, v148, v149
  v_mfma_f32_16x16x32_bf16 a[160:163], a[28:31], a[64:67], a[160:163]
  v_cvt_pk_bf16_f32 v149, v150, v151
  v_cvt_pk_bf16_f32 v150, v180, v181
  v_mfma_f32_16x16x32_bf16 a[128:131], a[56:59], a[96:99], a[128:131]
  v_cvt_pk_bf16_f32 v151, v182, v183
  v_cvt_pk_bf16_f32 v152, v152, v153
  v_mfma_f32_16x16x32_bf16 a[160:163], a[60:63], a[96:99], a[160:163]
  buffer_load_dwordx4 v4, s[8:11], s27 offen offset:0 lds
  v_cvt_pk_bf16_f32 v153, v154, v155
  v_mfma_f32_16x16x32_bf16 v[196:199], a[16:19], a[68:71], v[196:199]
  v_cvt_pk_bf16_f32 v154, v184, v185
  v_cvt_pk_bf16_f32 v155, v186, v187
  v_mfma_f32_16x16x32_bf16 v[228:231], a[20:23], a[68:71], v[228:231]
  v_cvt_pk_bf16_f32 v156, v156, v157
  v_cvt_pk_bf16_f32 v157, v158, v159
  v_mfma_f32_16x16x32_bf16 v[196:199], a[48:51], a[100:103], v[196:199]
  v_cvt_pk_bf16_f32 v158, v188, v189
  v_cvt_pk_bf16_f32 v159, v190, v191
  v_mfma_f32_16x16x32_bf16 v[228:231], a[52:55], a[100:103], v[228:231]
  v_cvt_pk_bf16_f32 v192, v192, v193
  v_cvt_pk_bf16_f32 v193, v194, v195
  v_mfma_f32_16x16x32_bf16 a[132:135], a[24:27], a[68:71], a[132:135]
  v_cvt_pk_bf16_f32 v194, v224, v225
  v_cvt_pk_bf16_f32 v195, v226, v227
  v_mfma_f32_16x16x32_bf16 a[164:167], a[28:31], a[68:71], a[164:167]
  buffer_load_dwordx4 v5, s[8:11], s27 offen offset:1024 lds
  v_mfma_f32_16x16x32_bf16 a[132:135], a[56:59], a[100:103], a[132:135]
  s_add_u32 s60, s63, 8192
  buffer_store_dwordx4 v[136:139], v2, s[16:19], s60 offen offset:2048 sc1
  v_accvgpr_read_b32 v24, a128
  v_mfma_f32_16x16x32_bf16 a[164:167], a[60:63], a[100:103], a[164:167]
  v_accvgpr_read_b32 v25, a129
  v_accvgpr_read_b32 v26, a130
  v_mfma_f32_16x16x32_bf16 v[200:203], a[16:19], a[72:75], v[200:203]
  v_accvgpr_read_b32 v27, a131
  v_accvgpr_read_b32 v28, a160
  v_mfma_f32_16x16x32_bf16 v[232:235], a[20:23], a[72:75], v[232:235]
  v_accvgpr_read_b32 v29, a161
  v_accvgpr_read_b32 v30, a162
  v_mfma_f32_16x16x32_bf16 v[200:203], a[48:51], a[104:107], v[200:203]
  buffer_load_dwordx4 v6, s[8:11], s27 offen offset:2048 lds
  v_accvgpr_read_b32 v31, a163
  v_mfma_f32_16x16x32_bf16 v[232:235], a[52:55], a[104:107], v[232:235]
  v_cvt_pk_bf16_f32 v224, v24, v25
  v_cvt_pk_bf16_f32 v225, v26, v27
  v_mfma_f32_16x16x32_bf16 a[136:139], a[24:27], a[72:75], a[136:139]
  v_cvt_pk_bf16_f32 v226, v28, v29
  v_cvt_pk_bf16_f32 v227, v30, v31
  v_mfma_f32_16x16x32_bf16 a[168:171], a[28:31], a[72:75], a[168:171]
  v_cvt_pk_bf16_f32 v196, v196, v197
  v_cvt_pk_bf16_f32 v197, v198, v199
  v_mfma_f32_16x16x32_bf16 a[136:139], a[56:59], a[104:107], a[136:139]
  v_cvt_pk_bf16_f32 v198, v228, v229
  v_cvt_pk_bf16_f32 v199, v230, v231
  v_mfma_f32_16x16x32_bf16 a[168:171], a[60:63], a[104:107], a[168:171]
  v_accvgpr_read_b32 v32, a132
  v_accvgpr_read_b32 v33, a133
  v_mfma_f32_16x16x32_bf16 v[204:207], a[16:19], a[76:79], v[204:207]
  buffer_load_dwordx4 v7, s[8:11], s27 offen offset:3072 lds
  v_accvgpr_read_b32 v34, a134
  v_mfma_f32_16x16x32_bf16 v[236:239], a[20:23], a[76:79], v[236:239]
  s_bfe_u32 s29, 0x302010e, s53
  s_add_u32 s52, s52, s29
  s_add_u32 s53, s53, 8
  v_mfma_f32_16x16x32_bf16 v[204:207], a[48:51], a[108:111], v[204:207]
  s_and_b32 s53, s53, 0x8001f
  s_and_b32 s52, s52, 15
  s_lshl_b32 s29, s52, 7
  v_mfma_f32_16x16x32_bf16 v[236:239], a[52:55], a[108:111], v[236:239]
  s_or_b32 s26, s30, s29
  s_or_b32 s27, s31, s29
  s_add_u32 m0, s68, 32768
  v_mfma_f32_16x16x32_bf16 a[140:143], a[24:27], a[76:79], a[140:143]
  v_accvgpr_read_b32 v35, a135
  v_accvgpr_read_b32 v36, a164
  v_mfma_f32_16x16x32_bf16 a[172:175], a[28:31], a[76:79], a[172:175]
  buffer_load_dwordx4 v8, s[20:23], s28 offen offset:0 lds
  v_accvgpr_read_b32 v37, a165
  v_mfma_f32_16x16x32_bf16 a[140:143], a[56:59], a[108:111], a[140:143]
  v_accvgpr_read_b32 v38, a166
  v_accvgpr_read_b32 v39, a167
  v_mfma_f32_16x16x32_bf16 a[172:175], a[60:63], a[108:111], a[172:175]
  v_cvt_pk_bf16_f32 v228, v32, v33
  v_cvt_pk_bf16_f32 v229, v34, v35
  v_mfma_f32_16x16x32_bf16 v[208:211], a[16:19], a[80:83], v[208:211]
  v_cvt_pk_bf16_f32 v230, v36, v37
  v_cvt_pk_bf16_f32 v231, v38, v39
  v_mfma_f32_16x16x32_bf16 v[240:243], a[20:23], a[80:83], v[240:243]
  s_add_u32 s60, s63, 8192
  buffer_store_dwordx4 v[140:143], v2, s[16:19], s60 offen offset:3072 sc1
  v_cvt_pk_bf16_f32 v200, v200, v201
  v_mfma_f32_16x16x32_bf16 v[208:211], a[48:51], a[112:115], v[208:211]
  v_cvt_pk_bf16_f32 v201, v202, v203
  v_cvt_pk_bf16_f32 v202, v232, v233
  v_mfma_f32_16x16x32_bf16 v[240:243], a[52:55], a[112:115], v[240:243]
  buffer_load_dwordx4 v9, s[20:23], s28 offen offset:1024 lds
  v_cvt_pk_bf16_f32 v203, v234, v235
  v_mfma_f32_16x16x32_bf16 a[144:147], a[24:27], a[80:83], a[144:147]
  v_accvgpr_read_b32 v40, a136
  v_accvgpr_read_b32 v41, a137
  v_mfma_f32_16x16x32_bf16 a[176:179], a[28:31], a[80:83], a[176:179]
  v_accvgpr_read_b32 v42, a138
  v_accvgpr_read_b32 v43, a139
  v_mfma_f32_16x16x32_bf16 a[144:147], a[56:59], a[112:115], a[144:147]
  v_accvgpr_read_b32 v44, a168
  v_accvgpr_read_b32 v45, a169
  v_mfma_f32_16x16x32_bf16 a[176:179], a[60:63], a[112:115], a[176:179]
  v_accvgpr_read_b32 v46, a170
  v_accvgpr_read_b32 v47, a171
  v_mfma_f32_16x16x32_bf16 v[212:215], a[16:19], a[84:87], v[212:215]
  buffer_load_dwordx4 v10, s[20:23], s28 offen offset:2048 lds
  v_cvt_pk_bf16_f32 v232, v40, v41
  v_mfma_f32_16x16x32_bf16 v[244:247], a[20:23], a[84:87], v[244:247]
  v_cvt_pk_bf16_f32 v233, v42, v43
  v_cvt_pk_bf16_f32 v234, v44, v45
  v_mfma_f32_16x16x32_bf16 v[212:215], a[48:51], a[116:119], v[212:215]
  v_cvt_pk_bf16_f32 v235, v46, v47
  v_cvt_pk_bf16_f32 v204, v204, v205
  v_mfma_f32_16x16x32_bf16 v[244:247], a[52:55], a[116:119], v[244:247]
  v_cvt_pk_bf16_f32 v205, v206, v207
  v_cvt_pk_bf16_f32 v206, v236, v237
  v_mfma_f32_16x16x32_bf16 a[148:151], a[24:27], a[84:87], a[148:151]
  v_cvt_pk_bf16_f32 v207, v238, v239
  v_accvgpr_read_b32 v24, a140
  v_mfma_f32_16x16x32_bf16 a[180:183], a[28:31], a[84:87], a[180:183]
  buffer_load_dwordx4 v11, s[20:23], s28 offen offset:3072 lds
  v_accvgpr_read_b32 v25, a141
  v_mfma_f32_16x16x32_bf16 a[148:151], a[56:59], a[116:119], a[148:151]
  s_bfe_u32 s56, 0x302010e, s55
  s_add_u32 s54, s54, s56
  s_add_u32 s55, s55, 8
  v_mfma_f32_16x16x32_bf16 a[180:183], a[60:63], a[116:119], a[180:183]
  s_and_b32 s55, s55, 0x8001f
  s_and_b32 s54, s54, 15
  s_lshl_b32 s28, s54, 19
  v_mfma_f32_16x16x32_bf16 v[216:219], a[16:19], a[88:91], v[216:219]
  s_add_u32 m0, s88, -32768
  v_accvgpr_read_b32 v26, a142
  v_accvgpr_read_b32 v27, a143
  v_mfma_f32_16x16x32_bf16 v[248:251], a[20:23], a[88:91], v[248:251]
  v_accvgpr_read_b32 v28, a172
  v_accvgpr_read_b32 v29, a173
  v_mfma_f32_16x16x32_bf16 v[216:219], a[48:51], a[120:123], v[216:219]
  v_accvgpr_read_b32 v30, a174
  v_accvgpr_read_b32 v31, a175
  v_mfma_f32_16x16x32_bf16 v[248:251], a[52:55], a[120:123], v[248:251]
  buffer_load_dwordx4 v4, s[8:11], s26 offen offset:0 lds
  v_cvt_pk_bf16_f32 v236, v24, v25
  v_mfma_f32_16x16x32_bf16 a[152:155], a[24:27], a[88:91], a[152:155]
  v_cvt_pk_bf16_f32 v237, v26, v27
  v_cvt_pk_bf16_f32 v238, v28, v29
  v_mfma_f32_16x16x32_bf16 a[184:187], a[28:31], a[88:91], a[184:187]
  v_cvt_pk_bf16_f32 v239, v30, v31
  v_mfma_f32_16x16x32_bf16 a[152:155], a[56:59], a[120:123], a[152:155]
  s_add_u32 s60, s63, 12288
  buffer_store_dwordx4 v[144:147], v2, s[16:19], s60 offen offset:0 sc1
  v_cvt_pk_bf16_f32 v208, v208, v209
  v_mfma_f32_16x16x32_bf16 a[184:187], a[60:63], a[120:123], a[184:187]
  v_cvt_pk_bf16_f32 v209, v210, v211
  v_cvt_pk_bf16_f32 v210, v240, v241
  v_mfma_f32_16x16x32_bf16 v[220:223], a[16:19], a[92:95], v[220:223]
  buffer_load_dwordx4 v5, s[8:11], s26 offen offset:1024 lds
  v_cvt_pk_bf16_f32 v211, v242, v243
  v_mfma_f32_16x16x32_bf16 v[252:255], a[20:23], a[92:95], v[252:255]
  v_accvgpr_read_b32 v32, a144
  v_accvgpr_read_b32 v33, a145
  v_mfma_f32_16x16x32_bf16 v[220:223], a[48:51], a[124:127], v[220:223]
  v_accvgpr_read_b32 v34, a146
  v_accvgpr_read_b32 v35, a147
  v_mfma_f32_16x16x32_bf16 v[252:255], a[52:55], a[124:127], v[252:255]
  v_accvgpr_read_b32 v36, a176
  v_accvgpr_read_b32 v37, a177
  v_mfma_f32_16x16x32_bf16 a[156:159], a[24:27], a[92:95], a[156:159]
  v_accvgpr_read_b32 v38, a178
  v_accvgpr_read_b32 v39, a179
  v_mfma_f32_16x16x32_bf16 a[188:191], a[28:31], a[92:95], a[188:191]
  v_cvt_pk_bf16_f32 v240, v32, v33
  v_cvt_pk_bf16_f32 v241, v34, v35
  v_mfma_f32_16x16x32_bf16 a[156:159], a[56:59], a[124:127], a[156:159]
  buffer_load_dwordx4 v6, s[8:11], s26 offen offset:2048 lds
  v_cvt_pk_bf16_f32 v242, v36, v37
  v_mfma_f32_16x16x32_bf16 a[188:191], a[60:63], a[124:127], a[188:191]
  v_cvt_pk_bf16_f32 v243, v38, v39
  v_cvt_pk_bf16_f32 v212, v212, v213
  v_mfma_f32_16x16x32_bf16 v[64:67], a[0:3], a[64:67], v[64:67]
  v_cvt_pk_bf16_f32 v213, v214, v215
  v_cvt_pk_bf16_f32 v214, v244, v245
  v_mfma_f32_16x16x32_bf16 v[96:99], a[4:7], a[64:67], v[96:99]
  v_cvt_pk_bf16_f32 v215, v246, v247
  v_mfma_f32_16x16x32_bf16 v[64:67], a[32:35], a[96:99], v[64:67]
  s_add_u32 s60, s63, 12288
  buffer_store_dwordx4 v[148:151], v2, s[16:19], s60 offen offset:1024 sc1
  v_accvgpr_read_b32 v40, a148
  v_mfma_f32_16x16x32_bf16 v[96:99], a[36:39], a[96:99], v[96:99]
  buffer_load_dwordx4 v7, s[8:11], s26 offen offset:3072 lds
  v_accvgpr_read_b32 v41, a149
  v_mfma_f32_16x16x32_bf16 v[68:71], a[0:3], a[68:71], v[68:71]
  s_add_u32 m0, s88, -28672
  v_accvgpr_read_b32 v42, a150
  v_accvgpr_read_b32 v43, a151
  v_mfma_f32_16x16x32_bf16 v[100:103], a[4:7], a[68:71], v[100:103]
  v_accvgpr_read_b32 v44, a180
  v_accvgpr_read_b32 v45, a181
  v_mfma_f32_16x16x32_bf16 v[68:71], a[32:35], a[100:103], v[68:71]
  v_accvgpr_read_b32 v46, a182
  v_accvgpr_read_b32 v47, a183
  v_mfma_f32_16x16x32_bf16 v[100:103], a[36:39], a[100:103], v[100:103]
  v_cvt_pk_bf16_f32 v244, v40, v41
  v_cvt_pk_bf16_f32 v245, v42, v43
  v_mfma_f32_16x16x32_bf16 v[72:75], a[0:3], a[72:75], v[72:75]
  v_cvt_pk_bf16_f32 v246, v44, v45
  v_cvt_pk_bf16_f32 v247, v46, v47
  v_mfma_f32_16x16x32_bf16 v[104:107], a[4:7], a[72:75], v[104:107]
  buffer_load_dwordx4 v4, s[8:11], s27 offen offset:0 lds
  v_cvt_pk_bf16_f32 v216, v216, v217
  v_mfma_f32_16x16x32_bf16 v[72:75], a[32:35], a[104:107], v[72:75]
  v_cvt_pk_bf16_f32 v217, v218, v219
  v_cvt_pk_bf16_f32 v218, v248, v249
  v_mfma_f32_16x16x32_bf16 v[104:107], a[36:39], a[104:107], v[104:107]
  v_cvt_pk_bf16_f32 v219, v250, v251
  v_accvgpr_read_b32 v24, a152
  v_mfma_f32_16x16x32_bf16 v[76:79], a[0:3], a[76:79], v[76:79]
  v_accvgpr_read_b32 v25, a153
  v_accvgpr_read_b32 v26, a154
  v_mfma_f32_16x16x32_bf16 v[108:111], a[4:7], a[76:79], v[108:111]
  v_accvgpr_read_b32 v27, a155
  v_accvgpr_read_b32 v28, a184
  v_mfma_f32_16x16x32_bf16 v[76:79], a[32:35], a[108:111], v[76:79]
  buffer_load_dwordx4 v5, s[8:11], s27 offen offset:1024 lds
  v_accvgpr_read_b32 v29, a185
  v_mfma_f32_16x16x32_bf16 v[108:111], a[36:39], a[108:111], v[108:111]
  v_accvgpr_read_b32 v30, a186
  v_accvgpr_read_b32 v31, a187
  v_mfma_f32_16x16x32_bf16 v[80:83], a[0:3], a[80:83], v[80:83]
  v_cvt_pk_bf16_f32 v248, v24, v25
  v_cvt_pk_bf16_f32 v249, v26, v27
  v_mfma_f32_16x16x32_bf16 v[112:115], a[4:7], a[80:83], v[112:115]
  v_cvt_pk_bf16_f32 v250, v28, v29
  v_cvt_pk_bf16_f32 v251, v30, v31
  v_mfma_f32_16x16x32_bf16 v[80:83], a[32:35], a[112:115], v[80:83]
  v_cvt_pk_bf16_f32 v220, v220, v221
  v_cvt_pk_bf16_f32 v221, v222, v223
  v_mfma_f32_16x16x32_bf16 v[112:115], a[36:39], a[112:115], v[112:115]
  v_cvt_pk_bf16_f32 v222, v252, v253
  v_cvt_pk_bf16_f32 v223, v254, v255
  v_mfma_f32_16x16x32_bf16 v[84:87], a[0:3], a[84:87], v[84:87]
  buffer_load_dwordx4 v6, s[8:11], s27 offen offset:2048 lds
  v_mfma_f32_16x16x32_bf16 v[116:119], a[4:7], a[84:87], v[116:119]
  s_add_u32 s60, s63, 12288
  buffer_store_dwordx4 v[152:155], v2, s[16:19], s60 offen offset:2048 sc1
  v_accvgpr_read_b32 v32, a156
  v_mfma_f32_16x16x32_bf16 v[84:87], a[32:35], a[116:119], v[84:87]
  v_accvgpr_read_b32 v33, a157
  v_accvgpr_read_b32 v34, a158
  v_mfma_f32_16x16x32_bf16 v[116:119], a[36:39], a[116:119], v[116:119]
  v_accvgpr_read_b32 v35, a159
  v_accvgpr_read_b32 v36, a188
  v_mfma_f32_16x16x32_bf16 v[88:91], a[0:3], a[88:91], v[88:91]
  v_accvgpr_read_b32 v37, a189
  v_accvgpr_read_b32 v38, a190
  v_mfma_f32_16x16x32_bf16 v[120:123], a[4:7], a[88:91], v[120:123]
  buffer_load_dwordx4 v7, s[8:11], s27 offen offset:3072 lds
  v_accvgpr_read_b32 v39, a191
  v_mfma_f32_16x16x32_bf16 v[88:91], a[32:35], a[120:123], v[88:91]
  s_bfe_u32 s29, 0x302010e, s53
  s_add_u32 s52, s52, s29
  s_add_u32 s53, s53, 8
  v_mfma_f32_16x16x32_bf16 v[120:123], a[36:39], a[120:123], v[120:123]
  s_and_b32 s53, s53, 0x8001f
  s_and_b32 s52, s52, 15
  s_lshl_b32 s29, s52, 7
  v_mfma_f32_16x16x32_bf16 v[92:95], a[0:3], a[92:95], v[92:95]
  s_or_b32 s26, s30, s29
  s_or_b32 s27, s31, s29
  v_cvt_pk_bf16_f32 v252, v32, v33
  v_mfma_f32_16x16x32_bf16 v[124:127], a[4:7], a[92:95], v[124:127]
  v_cvt_pk_bf16_f32 v253, v34, v35
  v_cvt_pk_bf16_f32 v254, v36, v37
  v_mfma_f32_16x16x32_bf16 v[92:95], a[32:35], a[124:127], v[92:95]
  v_cvt_pk_bf16_f32 v255, v38, v39
  v_cvt_pk_bf16_f32 v160, v64, v65
  v_mfma_f32_16x16x32_bf16 v[124:127], a[36:39], a[124:127], v[124:127]
  v_cvt_pk_bf16_f32 v161, v66, v67
  v_cvt_pk_bf16_f32 v162, v96, v97
  v_cvt_pk_bf16_f32 v163, v98, v99
  v_cvt_pk_bf16_f32 v164, v68, v69
  v_cvt_pk_bf16_f32 v165, v70, v71
  v_cvt_pk_bf16_f32 v166, v100, v101
  v_cvt_pk_bf16_f32 v167, v102, v103
  s_add_u32 s60, s63, 12288
  buffer_store_dwordx4 v[156:159], v2, s[16:19], s60 offen offset:3072 sc1
  v_cvt_pk_bf16_f32 v168, v72, v73
  v_cvt_pk_bf16_f32 v169, v74, v75
  v_cvt_pk_bf16_f32 v170, v104, v105
  v_cvt_pk_bf16_f32 v171, v106, v107
  v_cvt_pk_bf16_f32 v172, v76, v77
  v_cvt_pk_bf16_f32 v173, v78, v79
  v_cvt_pk_bf16_f32 v174, v108, v109
  v_cvt_pk_bf16_f32 v175, v110, v111
  v_cvt_pk_bf16_f32 v176, v80, v81
  v_cvt_pk_bf16_f32 v177, v82, v83
  v_cvt_pk_bf16_f32 v178, v112, v113
  v_cvt_pk_bf16_f32 v179, v114, v115
  v_cvt_pk_bf16_f32 v180, v84, v85
  v_cvt_pk_bf16_f32 v181, v86, v87
  v_cvt_pk_bf16_f32 v182, v116, v117
  v_cvt_pk_bf16_f32 v183, v118, v119
  v_cvt_pk_bf16_f32 v184, v88, v89
  v_cvt_pk_bf16_f32 v185, v90, v91
  v_cvt_pk_bf16_f32 v186, v120, v121
  v_cvt_pk_bf16_f32 v187, v122, v123
  v_cvt_pk_bf16_f32 v188, v92, v93
  v_cvt_pk_bf16_f32 v189, v94, v95
  v_cvt_pk_bf16_f32 v190, v124, v125
  v_cvt_pk_bf16_f32 v191, v126, v127
  s_lshl_b32 s34, s62, 4
  s_add_u32 s34, s34, s61
  s_lshl_b32 s34, s34, 7
  s_branch Lp3
Lp2:
  s_and_b32 s4, s2, 1
  s_lshl_b32 s4, s4, 2
  s_and_b32 s5, s59, 3
  s_add_u32 s32, s4, s5
  s_bfe_u32 s4, s2, 0x20001
  s_lshl_b32 s4, s4, 2
  s_lshr_b32 s5, s59, 2
  s_add_u32 s33, s4, s5
  s_and_b32 s4, s2, 7
  s_lshl_b32 s4, s4, 1
  s_add_u32 s5, s32, s33
  s_and_b32 s49, s5, 3
  s_lshl_b32 s49, s49, 3
  s_or_b32 s49, s49, 0x80000
  s_bfe_u32 s48, 0xf0f02, s49
  s_add_u32 s48, s48, s4
  s_and_b32 s48, s48, 15
  s_lshl_b32 s46, s48, 7
  s_lshl_b32 s36, s3, 13
  s_mul_i32 s41, s3, 6144
  s_add_u32 s41, s41, 104448
  s_mul_i32 s4, s3, 7168
  s_sub_u32 s50, 32768, s4
  v_lshrrev_b32 v240, 3, v1
  v_and_b32 v241, 6, v240
  v_and_b32 v242, 7, v1
  v_xor_b32 v241, v241, v242
  v_lshlrev_b32 v241, 4, v241
  s_lshl_b32 s4, s3, 6
  s_add_u32 s4, s4, 16
  v_add_u32 v242, s4, v240
  v_lshl_add_u32 v242, v242, 11, v241
  v_add_u32 v224, 0, v242
  v_add_u32 v225, 15360, v242
  v_add_u32 v226, 30720, v242
  v_add_u32 v227, 46080, v242
  v_add_u32 v228, 65536, v242
  v_add_u32 v229, 80896, v242
  v_add_u32 v230, 96256, v242
  v_add_u32 v231, 111616, v242
  s_lshl_b32 s4, s3, 14
  s_cmp_eq_u32 s32, 0
  s_cselect_b32 s4, 0x40000000, s4
  v_lshl_add_u32 v242, v240, 11, v241
  v_add_u32 v232, s4, v242
  v_lshrrev_b32 v242, 2, v240
  v_and_b32 v243, 3, v240
  v_lshl_add_u32 v242, v242, 3, v243
  v_mul_u32_u24 v242, 6144, v242
  v_add_u32 v242, v242, v241
  s_lshl_b32 s4, s33, 7
  v_add_u32 v242, s4, v242
  s_mul_i32 s6, s3, 6
  s_add_u32 s7, s6, 0
  s_bfe_u32 s4, s7, 0x10002
  s_lshl_b32 s4, s4, 5
  s_and_b32 s5, s7, 1
  s_lshl_b32 s5, s5, 4
  s_add_u32 s4, s4, s5
  s_bfe_u32 s5, s7, 0x10001
  s_lshl_b32 s5, s5, 2
  s_add_u32 s4, s4, s5
  s_mul_i32 s4, s4, 6144
  s_lshr_b32 s5, s7, 3
  s_lshl_b32 s5, s5, 11
  s_add_u32 s4, s4, s5
  s_add_u32 s4, s4, 2048
  v_add_u32 v233, s4, v242
  s_add_u32 s7, s6, 1
  s_bfe_u32 s4, s7, 0x10002
  s_lshl_b32 s4, s4, 5
  s_and_b32 s5, s7, 1
  s_lshl_b32 s5, s5, 4
  s_add_u32 s4, s4, s5
  s_bfe_u32 s5, s7, 0x10001
  s_lshl_b32 s5, s5, 2
  s_add_u32 s4, s4, s5
  s_mul_i32 s4, s4, 6144
  s_lshr_b32 s5, s7, 3
  s_lshl_b32 s5, s5, 11
  s_add_u32 s4, s4, s5
  s_add_u32 s4, s4, 1024
  v_add_u32 v234, s4, v242
  s_add_u32 s7, s6, 2
  s_bfe_u32 s4, s7, 0x10002
  s_lshl_b32 s4, s4, 5
  s_and_b32 s5, s7, 1
  s_lshl_b32 s5, s5, 4
  s_add_u32 s4, s4, s5
  s_bfe_u32 s5, s7, 0x10001
  s_lshl_b32 s5, s5, 2
  s_add_u32 s4, s4, s5
  s_mul_i32 s4, s4, 6144
  s_lshr_b32 s5, s7, 3
  s_lshl_b32 s5, s5, 11
  s_add_u32 s4, s4, s5
  s_add_u32 s4, s4, 0
  v_add_u32 v235, s4, v242
  s_add_u32 s7, s6, 3
  s_bfe_u32 s4, s7, 0x10002
  s_lshl_b32 s4, s4, 5
  s_and_b32 s5, s7, 1
  s_lshl_b32 s5, s5, 4
  s_add_u32 s4, s4, s5
  s_bfe_u32 s5, s7, 0x10001
  s_lshl_b32 s5, s5, 2
  s_add_u32 s4, s4, s5
  s_mul_i32 s4, s4, 6144
  s_lshr_b32 s5, s7, 3
  s_lshl_b32 s5, s5, 11
  s_add_u32 s4, s4, s5
  s_add_u32 s4, s4, 2048
  v_add_u32 v236, s4, v242
  s_add_u32 s7, s6, 4
  s_bfe_u32 s4, s7, 0x10002
  s_lshl_b32 s4, s4, 5
  s_and_b32 s5, s7, 1
  s_lshl_b32 s5, s5, 4
  s_add_u32 s4, s4, s5
  s_bfe_u32 s5, s7, 0x10001
  s_lshl_b32 s5, s5, 2
  s_add_u32 s4, s4, s5
  s_mul_i32 s4, s4, 6144
  s_lshr_b32 s5, s7, 3
  s_lshl_b32 s5, s5, 11
  s_add_u32 s4, s4, s5
  s_add_u32 s4, s4, 1024
  v_add_u32 v237, s4, v242
  s_add_u32 s7, s6, 5
  s_bfe_u32 s4, s7, 0x10002
  s_lshl_b32 s4, s4, 5
  s_and_b32 s5, s7, 1
  s_lshl_b32 s5, s5, 4
  s_add_u32 s4, s4, s5
  s_bfe_u32 s5, s7, 0x10001
  s_lshl_b32 s5, s5, 2
  s_add_u32 s4, s4, s5
  s_mul_i32 s4, s4, 6144
  s_lshr_b32 s5, s7, 3
  s_lshl_b32 s5, s5, 11
  s_add_u32 s4, s4, s5
  s_add_u32 s4, s4, 0
  v_add_u32 v238, s4, v242
  s_waitcnt lgkmcnt(0)
  s_lshl_b32 s10, s32, 19
  s_add_u32 s8, s76, s10
  s_addc_u32 s9, s77, 0
  s_sub_u32 s8, s8, 32768
  s_subb_u32 s9, s9, 0
  s_mov_b32 s10, 557056
  s_mov_b32 s11, 0x00020000
  s_sub_u32 s12, s78, 2048
  s_subb_u32 s13, s79, 0
  s_mov_b32 s14, 6293504
  s_mov_b32 s15, 0x00020000
  s_add_u32 s96, s86, 125829120
  s_addc_u32 s97, s87, 0
  s_mov_b32 s98, 262144
  s_mov_b32 s99, 0x00020000
  s_cmp_ge_u32 s3, 2
  s_cbranch_scc1 Lp2_r1
  s_and_b32 s4, s2, 7
  s_lshl_b32 s4, s4, 4
  s_add_u32 s4, s4, s59
  s_lshl_b32 s4, s4, 2
  s_add_u32 s4, s4, s3
  s_lshl_b32 s51, s4, 13
  s_add_u32 m0, s36, s50
  s_nop 0
  buffer_load_dwordx4 v232, s[8:11], s46 offen offset:0 lds
  s_mov_b32 m0, s36
  s_nop 0
  buffer_load_dwordx4 v224, s[8:11], s46 offen offset:0 lds
  buffer_load_dwordx4 v225, s[8:11], s46 offen offset:1024 lds
  buffer_load_dwordx4 v226, s[8:11], s46 offen offset:2048 lds
  buffer_load_dwordx4 v227, s[8:11], s46 offen offset:3072 lds
  s_add_u32 m0, s36, 4096
  s_nop 0
  buffer_load_dwordx4 v228, s[8:11], s46 offen offset:0 lds
  buffer_load_dwordx4 v229, s[8:11], s46 offen offset:1024 lds
  buffer_load_dwordx4 v230, s[8:11], s46 offen offset:2048 lds
  buffer_load_dwordx4 v231, s[8:11], s46 offen offset:3072 lds
  s_mul_i32 s47, s48, 393216
  s_bfe_u32 s34, 0x302010e, s49
  s_add_u32 s48, s48, s34
  s_add_u32 s49, s49, 8
  s_and_b32 s49, s49, 0x8001f
  s_and_b32 s48, s48, 15
  s_lshl_b32 s46, s48, 7
  s_mov_b32 m0, s41
  s_nop 0
  buffer_load_dwordx4 v233, s[12:15], s47 offen offset:0 lds
  buffer_load_dwordx4 v234, s[12:15], s47 offen offset:1024 lds
  buffer_load_dwordx4 v235, s[12:15], s47 offen offset:2048 lds
  s_add_u32 m0, s41, 3072
  s_nop 0
  buffer_load_dwordx4 v236, s[12:15], s47 offen offset:0 lds
  buffer_load_dwordx4 v237, s[12:15], s47 offen offset:1024 lds
  buffer_load_dwordx4 v238, s[12:15], s47 offen offset:2048 lds
  s_lshr_b32 s4, s3, 1
  s_lshl_b32 s4, s4, 14
  v_and_b32 v240, 15, v1
  v_lshlrev_b32 v240, 7, v240
  v_lshrrev_b32 v241, 4, v1
  v_and_b32 v242, 6, v1
  v_xor_b32 v241, v241, v242
  v_lshl_add_u32 v240, v241, 4, v240
  v_add_u32 v16, s4, v240
  v_xor_b32 v17, 64, v16
  v_and_b32 v240, 15, v1
  v_lshlrev_b32 v240, 7, v240
  v_lshrrev_b32 v241, 4, v1
  v_and_b32 v242, 6, v1
  v_xor_b32 v241, v241, v242
  v_lshl_add_u32 v240, v241, 4, v240
  v_add_u32 v18, 32768, v240
  v_xor_b32 v19, 64, v18
  v_lshrrev_b32 v240, 2, v1
  v_and_b32 v241, 6, v240
  v_lshlrev_b32 v240, 7, v240
  v_and_b32 v242, 1, v1
  v_lshl_add_u32 v240, v242, 3, v240
  v_add_u32 v240, 104448, v240
  v_bfe_u32 v242, v1, 1, 1
  v_xor_b32 v241, v241, v242
  v_xor_b32 v242, 0, v241
  v_lshl_add_u32 v20, v242, 4, v240
  v_xor_b32 v242, 2, v241
  v_lshl_add_u32 v21, v242, 4, v240
  s_and_b32 s4, s3, 1
  s_lshl_b32 s4, s4, 6
  v_xor_b32 v20, s4, v20
  v_xor_b32 v21, s4, v21
  s_and_b32 s24, s2, 7
  s_lshr_b32 s4, s2, 6
  s_lshl_b32 s4, s4, 3
  s_add_u32 s24, s24, s4
  s_lshr_b32 s4, s2, 3
  s_and_b32 s25, s4, 6
  s_xor_b32 s4, s4, s2
  s_bfe_u32 s4, s4, 0x10003
  s_add_u32 s25, s25, s4
  v_accvgpr_write_b32 a244, -1
  v_accvgpr_write_b32 a245, -1
  v_accvgpr_write_b32 a246, -1
  v_accvgpr_write_b32 a247, -1
  v_lshrrev_b32 v24, 3, v1
  v_and_b32 v25, 6, v24
  v_and_b32 v26, 7, v1
  v_xor_b32 v25, v25, v26
  v_lshlrev_b32 v25, 4, v25
  s_and_b32 s4, s3, 1
  s_lshl_b32 s4, s4, 16
  s_lshr_b32 s5, s3, 1
  s_lshl_b32 s5, s5, 7
  s_add_u32 s4, s4, s5
  v_lshl_add_u32 v24, v24, 11, v25
  v_add_u32 v24, s4, v24
  v_add_u32 v25, 0, v24
  v_accvgpr_write_b32 a212, v25
  v_add_u32 v25, 15360, v24
  v_accvgpr_write_b32 a213, v25
  v_add_u32 v25, 30720, v24
  v_accvgpr_write_b32 a214, v25
  v_add_u32 v25, 46080, v24
  v_accvgpr_write_b32 a215, v25
  v_accvgpr_write_b32 a236, 0
  v_mov_b32 v27, 0x3f803f80
  v_accvgpr_write_b32 a208, v27
  v_accvgpr_write_b32 a237, 0
  v_accvgpr_write_b32 a209, v27
  v_accvgpr_write_b32 a238, 0
  v_accvgpr_write_b32 a210, v27
  v_accvgpr_write_b32 a239, 0
  v_accvgpr_write_b32 a211, v27
  v_lshrrev_b32 v24, 3, v1
  v_and_b32 v25, 6, v24
  v_and_b32 v26, 7, v1
  v_xor_b32 v25, v25, v26
  v_lshlrev_b32 v25, 4, v25
  v_lshlrev_b32 v26, 2, v24
  v_add_u32 v26, s3, v26
  v_lshl_add_u32 v26, v26, 11, v25
  v_add_u32 v27, 0, v26
  v_accvgpr_write_b32 a222, v27
  v_add_u32 v27, 64512, v26
  v_accvgpr_write_b32 a223, v27
  v_add_u32 v27, 129024, v26
  v_accvgpr_write_b32 a224, v27
  v_add_u32 v27, 193536, v26
  v_accvgpr_write_b32 a225, v27
  v_lshrrev_b32 v26, 2, v24
  v_and_b32 v27, 3, v24
  v_lshl_add_u32 v26, v26, 3, v27
  s_and_b32 s4, s3, 1
  s_lshl_b32 s4, s4, 18
  s_lshr_b32 s5, s3, 1
  s_lshl_b32 s5, s5, 7
  s_add_u32 s4, s4, s5
  s_lshl_b32 s5, s24, 8
  s_add_u32 s4, s4, s5
  v_lshl_add_u32 v26, v26, 13, v25
  v_add_u32 v26, s4, v26
  v_add_u32 v27, 0, v26
  v_accvgpr_write_b32 a226, v27
  v_add_u32 v27, 130048, v26
  v_accvgpr_write_b32 a227, v27
  v_add_u32 v27, 30720, v26
  v_accvgpr_write_b32 a228, v27
  v_add_u32 v27, 160768, v26
  v_accvgpr_write_b32 a229, v27
  s_lshl_b32 s4, s3, 13
  s_add_u32 s4, s4, 98304
  v_and_b32 v24, 15, v1
  v_lshlrev_b32 v24, 7, v24
  v_lshrrev_b32 v25, 4, v1
  v_and_b32 v26, 6, v1
  v_xor_b32 v25, v25, v26
  v_lshl_add_u32 v24, v25, 4, v24
  v_add_u32 v28, s4, v24
  v_xor_b32 v29, 64, v28
  v_lshrrev_b32 v24, 2, v1
  v_and_b32 v25, 6, v24
  v_lshlrev_b32 v24, 7, v24
  v_and_b32 v26, 1, v1
  v_lshl_add_u32 v24, v26, 3, v24
  v_add_u32 v24, 0, v24
  v_bfe_u32 v26, v1, 1, 1
  v_xor_b32 v25, v25, v26
  v_xor_b32 v26, 0, v25
  v_lshl_add_u32 v30, v26, 4, v24
  v_xor_b32 v26, 2, v25
  v_lshl_add_u32 v31, v26, 4, v24
  v_xor_b32 v26, 4, v25
  v_lshl_add_u32 v32, v26, 4, v24
  v_xor_b32 v26, 6, v25
  v_lshl_add_u32 v33, v26, 4, v24
  v_accvgpr_write_b32 a230, v28
  v_accvgpr_write_b32 a231, v29
  v_accvgpr_write_b32 a232, v30
  v_accvgpr_write_b32 a233, v31
  v_accvgpr_write_b32 a234, v32
  v_accvgpr_write_b32 a235, v33
  v_and_b32 v253, 15, v1
  v_lshrrev_b32 v254, 4, v1
  v_lshlrev_b32 v254, 2, v254
  v_sub_u32 v253, v253, v254
  v_mov_b32 v254, 0xf149f2ca
  s_lshr_b32 s4, s3, 1
  s_or_b32 s4, s4, s32
  s_cselect_b64 s[6:7], 0, -1
  v_subrev_u32 v255, 0, v253
  v_and_b32 v252, 0x80000001, v255
  v_cmp_ne_u32 vcc, 0, v252
  s_nop 1
  v_cndmask_b32 v244, 0, v254, vcc
  v_add_u32 v255, 1, v255
  v_and_b32 v252, 0x80000001, v255
  v_cmp_ne_u32 vcc, 0x80000001, v252
  s_nop 1
  v_cndmask_b32 v240, 0, v254, vcc
  v_cndmask_b32 v248, v240, v254, s[6:7]
  v_subrev_u32 v255, 1, v253
  v_and_b32 v252, 0x80000001, v255
  v_cmp_ne_u32 vcc, 0, v252
  s_nop 1
  v_cndmask_b32 v245, 0, v254, vcc
  v_add_u32 v255, 1, v255
  v_and_b32 v252, 0x80000001, v255
  v_cmp_ne_u32 vcc, 0x80000001, v252
  s_nop 1
  v_cndmask_b32 v241, 0, v254, vcc
  v_cndmask_b32 v249, v241, v254, s[6:7]
  v_subrev_u32 v255, 2, v253
  v_and_b32 v252, 0x80000001, v255
  v_cmp_ne_u32 vcc, 0, v252
  s_nop 1
  v_cndmask_b32 v246, 0, v254, vcc
  v_add_u32 v255, 1, v255
  v_and_b32 v252, 0x80000001, v255
  v_cmp_ne_u32 vcc, 0x80000001, v252
  s_nop 1
  v_cndmask_b32 v242, 0, v254, vcc
  v_cndmask_b32 v250, v242, v254, s[6:7]
  v_subrev_u32 v255, 3, v253
  v_and_b32 v252, 0x80000001, v255
  v_cmp_ne_u32 vcc, 0, v252
  s_nop 1
  v_cndmask_b32 v247, 0, v254, vcc
  v_add_u32 v255, 1, v255
  v_and_b32 v252, 0x80000001, v255
  v_cmp_ne_u32 vcc, 0x80000001, v252
  s_nop 1
  v_cndmask_b32 v243, 0, v254, vcc
  v_cndmask_b32 v251, v243, v254, s[6:7]
  s_and_b32 s4, s3, 1
  s_lshl_b32 s4, s4, 12
  s_add_u32 s4, s4, 49152
  v_add_u32 v252, s4, v2
  s_lshr_b32 s5, s3, 1
  s_lshl_b32 s5, s5, 11
  v_add_u32 v253, s5, v252
  s_add_u32 s16, s86, 83886080
  s_addc_u32 s17, s87, 0
  s_mov_b32 s18, 4194304
  s_mov_b32 s19, 0x00020000
  s_lshl_b32 s57, s32, 19
  s_lshl_b32 s5, s5, 7
  s_add_u32 s57, s57, s5
  s_lshl_b32 s4, s33, 14
  s_add_u32 s57, s57, s4
  s_and_b32 s4, s3, 1
  s_lshl_b32 s4, s4, 13
  s_add_u32 s57, s57, s4
  s_add_u32 s58, s57, 4096
  s_mov_b32 s37, 0
  s_mov_b32 s39, 4294897664
  s_mov_b32 s40, 34816
  s_mov_b32 s42, 0
  s_mov_b32 s44, 4294942720
  s_mov_b32 s45, 24576
  s_mov_b32 s43, s44
  s_mov_b32 s52, s72
  s_mov_b32 s53, s73
  s_mov_b32 s54, 4194304
  s_mov_b32 s55, 0x00020000
  s_lshl_b32 s1, s51, 1
  s_mov_b32 s56, s51
  s_mov_b32 s0, 0
  s_waitcnt vmcnt(0)
  s_barrier
  ds_read_b128 a[72:75], v16 offset:0
  ds_read_b128 a[108:111], v17 offset:0
  ds_read_b64_tr_b16 a[144:145], v20 offset:0
  ds_read_b64_tr_b16 a[146:147], v20 offset:2048
  ds_read_b64_tr_b16 a[168:169], v20 offset:4096
  ds_read_b64_tr_b16 a[170:171], v20 offset:6144
  ds_read_b128 a[76:79], v16 offset:2048
  ds_read_b128 a[112:115], v17 offset:2048
  ds_read_b128 a[80:83], v16 offset:4096
  ds_read_b128 a[116:119], v17 offset:4096
  ds_read_b128 a[84:87], v16 offset:6144
  ds_read_b128 a[120:123], v17 offset:6144
  ds_read_b128 a[88:91], v16 offset:8192
  ds_read_b128 a[124:127], v17 offset:8192
  ds_read_b128 a[92:95], v16 offset:10240
  ds_read_b128 a[128:131], v17 offset:10240
  ds_read_b128 a[96:99], v16 offset:12288
  ds_read_b128 a[132:135], v17 offset:12288
  ds_read_b128 a[100:103], v16 offset:14336
  ds_read_b128 a[136:139], v17 offset:14336
  ds_read_b64_tr_b16 a[148:149], v21 offset:0
  ds_read_b64_tr_b16 a[150:151], v21 offset:2048
  ds_read_b64_tr_b16 a[172:173], v21 offset:4096
  ds_read_b64_tr_b16 a[174:175], v21 offset:6144
  ds_read_b64_tr_b16 a[152:153], v20 offset:8192
  ds_read_b64_tr_b16 a[154:155], v20 offset:10240
  ds_read_b64_tr_b16 a[176:177], v20 offset:12288
  ds_read_b64_tr_b16 a[178:179], v20 offset:14336
  ds_read_b128 a[104:107], v18 offset:0
  ds_read_b128 a[140:143], v19 offset:0
  s_waitcnt lgkmcnt(0)
  v_mfma_f32_16x16x32_bf16 v[24:27], a[144:147], a[72:75], 0
  s_add_u32 m0, s36, s50
  s_add_u32 m0, m0, 34816
  ds_read_b64_tr_b16 a[156:157], v21 offset:8192
  v_mfma_f32_16x16x32_bf16 v[24:27], a[168:171], a[108:111], v[24:27]
  buffer_load_dwordx4 v232, s[8:11], s46 offen offset:0 lds
  v_mfma_f32_16x16x32_bf16 v[28:31], a[144:147], a[76:79], 0
  s_add_u32 m0, s36, 34816
  v_mfma_f32_16x16x32_bf16 v[28:31], a[168:171], a[112:115], v[28:31]
  buffer_load_dwordx4 v224, s[8:11], s46 offen offset:0 lds
  v_mfma_f32_16x16x32_bf16 v[32:35], a[144:147], a[80:83], 0
  buffer_load_dwordx4 v225, s[8:11], s46 offen offset:1024 lds
  v_mfma_f32_16x16x32_bf16 v[32:35], a[168:171], a[116:119], v[32:35]
  buffer_load_dwordx4 v226, s[8:11], s46 offen offset:2048 lds
  v_mfma_f32_16x16x32_bf16 v[36:39], a[144:147], a[84:87], 0
  ds_read_b64_tr_b16 a[158:159], v21 offset:10240
  ds_read_b64_tr_b16 a[180:181], v21 offset:12288
  v_mfma_f32_16x16x32_bf16 v[36:39], a[168:171], a[120:123], v[36:39]
  buffer_load_dwordx4 v227, s[8:11], s46 offen offset:3072 lds
  v_mfma_f32_16x16x32_bf16 v[40:43], a[144:147], a[88:91], 0
  s_add_u32 m0, s36, 38912
  v_mfma_f32_16x16x32_bf16 v[40:43], a[168:171], a[124:127], v[40:43]
  buffer_load_dwordx4 v228, s[8:11], s46 offen offset:0 lds
  v_mfma_f32_16x16x32_bf16 v[44:47], a[144:147], a[92:95], 0
  buffer_load_dwordx4 v229, s[8:11], s46 offen offset:1024 lds
  v_mfma_f32_16x16x32_bf16 v[44:47], a[168:171], a[128:131], v[44:47]
  ds_read_b64_tr_b16 a[182:183], v21 offset:14336
  v_mfma_f32_16x16x32_bf16 v[48:51], a[144:147], a[96:99], 0
  buffer_load_dwordx4 v230, s[8:11], s46 offen offset:2048 lds
  v_mfma_f32_16x16x32_bf16 v[48:51], a[168:171], a[132:135], v[48:51]
  ds_read_b64_tr_b16 a[160:161], v20 offset:16384
  v_mfma_f32_16x16x32_bf16 v[52:55], a[144:147], a[100:103], 0
  buffer_load_dwordx4 v231, s[8:11], s46 offen offset:3072 lds
  v_mfma_f32_16x16x32_bf16 v[52:55], a[168:171], a[136:139], v[52:55]
  s_mul_i32 s47, s48, 393216
  s_bfe_u32 s34, 0x302010e, s49
  s_add_u32 s48, s48, s34
  v_mfma_f32_16x16x32_bf16 v[56:59], a[148:151], a[72:75], 0
  s_add_u32 s49, s49, 8
  s_and_b32 s49, s49, 0x8001f
  s_and_b32 s48, s48, 15
  v_mfma_f32_16x16x32_bf16 v[56:59], a[172:175], a[108:111], v[56:59]
  s_lshl_b32 s46, s48, 7
  s_add_u32 m0, s41, 24576
  ds_read_b64_tr_b16 a[162:163], v20 offset:18432
  v_mfma_f32_16x16x32_bf16 v[60:63], a[148:151], a[76:79], 0
  buffer_load_dwordx4 v233, s[12:15], s47 offen offset:0 lds
  v_mfma_f32_16x16x32_bf16 v[60:63], a[172:175], a[112:115], v[60:63]
  buffer_load_dwordx4 v234, s[12:15], s47 offen offset:1024 lds
  v_mfma_f32_16x16x32_bf16 v[64:67], a[148:151], a[80:83], 0
  buffer_load_dwordx4 v235, s[12:15], s47 offen offset:2048 lds
  v_mfma_f32_16x16x32_bf16 v[64:67], a[172:175], a[116:119], v[64:67]
  s_add_u32 m0, s41, 27648
  ds_read_b64_tr_b16 a[184:185], v20 offset:20480
  v_mfma_f32_16x16x32_bf16 v[68:71], a[148:151], a[84:87], 0
  buffer_load_dwordx4 v236, s[12:15], s47 offen offset:0 lds
  v_mfma_f32_16x16x32_bf16 v[68:71], a[172:175], a[120:123], v[68:71]
  buffer_load_dwordx4 v237, s[12:15], s47 offen offset:1024 lds
  v_mfma_f32_16x16x32_bf16 v[72:75], a[148:151], a[88:91], 0
  ds_read_b64_tr_b16 a[186:187], v20 offset:22528
  v_mfma_f32_16x16x32_bf16 v[72:75], a[172:175], a[124:127], v[72:75]
  buffer_load_dwordx4 v238, s[12:15], s47 offen offset:2048 lds
  v_mfma_f32_16x16x32_bf16 v[76:79], a[148:151], a[92:95], 0
  s_add_u32 m0, s36, s50
  s_add_u32 m0, m0, 69632
  ds_read_b64_tr_b16 a[164:165], v21 offset:16384
  v_mfma_f32_16x16x32_bf16 v[76:79], a[172:175], a[128:131], v[76:79]
  buffer_load_dwordx4 v232, s[8:11], s46 offen offset:0 lds
  v_mfma_f32_16x16x32_bf16 v[80:83], a[148:151], a[96:99], 0
  s_add_u32 m0, s36, 69632
  v_mfma_f32_16x16x32_bf16 v[80:83], a[172:175], a[132:135], v[80:83]
  buffer_load_dwordx4 v224, s[8:11], s46 offen offset:0 lds
  v_mfma_f32_16x16x32_bf16 v[84:87], a[148:151], a[100:103], 0
  buffer_load_dwordx4 v225, s[8:11], s46 offen offset:1024 lds
  v_mfma_f32_16x16x32_bf16 v[84:87], a[172:175], a[136:139], v[84:87]
  ds_read_b64_tr_b16 a[166:167], v21 offset:18432
  v_mfma_f32_16x16x32_bf16 v[88:91], a[152:155], a[72:75], 0
  buffer_load_dwordx4 v226, s[8:11], s46 offen offset:2048 lds
  v_mfma_f32_16x16x32_bf16 v[88:91], a[176:179], a[108:111], v[88:91]
  ds_read_b64_tr_b16 a[188:189], v21 offset:20480
  v_mfma_f32_16x16x32_bf16 v[92:95], a[152:155], a[76:79], 0
  buffer_load_dwordx4 v227, s[8:11], s46 offen offset:3072 lds
  v_mfma_f32_16x16x32_bf16 v[92:95], a[176:179], a[112:115], v[92:95]
  s_add_u32 m0, s36, 73728
  v_mfma_f32_16x16x32_bf16 v[96:99], a[152:155], a[80:83], 0
  buffer_load_dwordx4 v228, s[8:11], s46 offen offset:0 lds
  v_mfma_f32_16x16x32_bf16 v[96:99], a[176:179], a[116:119], v[96:99]
  buffer_load_dwordx4 v229, s[8:11], s46 offen offset:1024 lds
  v_mfma_f32_16x16x32_bf16 v[100:103], a[152:155], a[84:87], 0
  s_add_u32 s37, s37, 1
  ds_read_b64_tr_b16 a[190:191], v21 offset:22528
  v_mfma_f32_16x16x32_bf16 v[100:103], a[176:179], a[120:123], v[100:103]
  buffer_load_dwordx4 v230, s[8:11], s46 offen offset:2048 lds
  v_mfma_f32_16x16x32_bf16 v[104:107], a[152:155], a[88:91], 0
  s_cmp_eq_u32 s37, 3
  s_cselect_b32 s37, 0, s37
  s_cselect_b32 s38, s39, s40
  v_mfma_f32_16x16x32_bf16 v[104:107], a[176:179], a[124:127], v[104:107]
  buffer_load_dwordx4 v231, s[8:11], s46 offen offset:3072 lds
  v_mfma_f32_16x16x32_bf16 v[108:111], a[152:155], a[92:95], 0
  s_sub_u32 s43, 0, s43
  v_mfma_f32_16x16x32_bf16 v[108:111], a[176:179], a[128:131], v[108:111]
  s_mul_i32 s47, s48, 393216
  v_add_u32 v16, s38, v16
  v_add_u32 v17, s38, v17
  v_mfma_f32_16x16x32_bf16 v[112:115], a[152:155], a[96:99], 0
  s_bfe_u32 s34, 0x302010e, s49
  v_add_u32 v18, s38, v18
  v_add_u32 v19, s38, v19
  v_mfma_f32_16x16x32_bf16 v[112:115], a[176:179], a[132:135], v[112:115]
  s_add_u32 s48, s48, s34
  s_add_u32 s49, s49, 8
  v_add_u32 v20, s43, v20
  v_mfma_f32_16x16x32_bf16 v[116:119], a[152:155], a[100:103], 0
  s_and_b32 s49, s49, 0x8001f
  s_and_b32 s48, s48, 15
  s_lshl_b32 s46, s48, 7
  v_mfma_f32_16x16x32_bf16 v[116:119], a[176:179], a[136:139], v[116:119]
  v_add_u32 v21, s43, v21
  v_mfma_f32_16x16x32_bf16 v[216:219], a[152:155], a[104:107], 0
  v_mfma_f32_16x16x32_bf16 v[216:219], a[176:179], a[140:143], v[216:219]
  s_waitcnt vmcnt(9) lgkmcnt(0)
  s_barrier
  v_mfma_f32_16x16x32_bf16 v[120:123], a[156:159], a[72:75], 0
  buffer_load_dwordx4 a[192:195], v2, s[52:55], s51 offen offset:0
  v_mfma_f32_16x16x32_bf16 v[120:123], a[180:183], a[108:111], v[120:123]
  ds_read_b128 a[0:3], v16 offset:0
  ds_read_b128 a[36:39], v17 offset:0
  v_mfma_f32_16x16x32_bf16 v[124:127], a[156:159], a[76:79], 0
  ds_read_b64_tr_b16 a[144:145], v20 offset:0
  v_mfma_f32_16x16x32_bf16 v[124:127], a[180:183], a[112:115], v[124:127]
  v_mfma_f32_16x16x32_bf16 v[128:131], a[156:159], a[80:83], 0
  buffer_load_dwordx4 a[192:195], v2, s[52:55], s51 offen offset:1024
  v_mfma_f32_16x16x32_bf16 v[128:131], a[180:183], a[116:119], v[128:131]
  ds_read_b64_tr_b16 a[146:147], v20 offset:2048
  ds_read_b64_tr_b16 a[168:169], v20 offset:4096
  v_mfma_f32_16x16x32_bf16 v[132:135], a[156:159], a[84:87], 0
  ds_read_b64_tr_b16 a[170:171], v20 offset:6144
  v_mfma_f32_16x16x32_bf16 v[132:135], a[180:183], a[120:123], v[132:135]
  v_mfma_f32_16x16x32_bf16 v[136:139], a[156:159], a[88:91], 0
  ds_read_b128 a[4:7], v16 offset:2048
  v_mfma_f32_16x16x32_bf16 v[136:139], a[180:183], a[124:127], v[136:139]
  buffer_load_dwordx4 a[192:195], v2, s[52:55], s51 offen offset:2048
  v_mfma_f32_16x16x32_bf16 v[140:143], a[156:159], a[92:95], 0
  ds_read_b128 a[40:43], v17 offset:2048
  ds_read_b128 a[8:11], v16 offset:4096
  v_mfma_f32_16x16x32_bf16 v[140:143], a[180:183], a[128:131], v[140:143]
  v_mfma_f32_16x16x32_bf16 v[144:147], a[156:159], a[96:99], 0
  ds_read_b128 a[44:47], v17 offset:4096
  v_mfma_f32_16x16x32_bf16 v[144:147], a[180:183], a[132:135], v[144:147]
  ds_read_b128 a[12:15], v16 offset:6144
  v_mfma_f32_16x16x32_bf16 v[148:151], a[156:159], a[100:103], 0
  buffer_load_dwordx4 a[192:195], v2, s[52:55], s51 offen offset:3072
  v_mfma_f32_16x16x32_bf16 v[148:151], a[180:183], a[136:139], v[148:151]
  s_add_u32 s51, s51, 4096
  s_add_u32 s0, s0, 1
  s_cmp_eq_u32 s0, 2
  s_cselect_b32 s52, s68, s52
  s_cselect_b32 s53, s69, s53
  s_cselect_b32 s51, s1, s51
  s_cselect_b32 s54, 0, s54
  v_mfma_f32_16x16x32_bf16 v[220:223], a[156:159], a[104:107], 0
  s_cmp_eq_u32 s0, 6
  s_cselect_b32 s52, s64, s52
  s_cselect_b32 s53, s65, s53
  s_cselect_b32 s51, s56, s51
  s_cselect_b32 s54, 0, s54
  v_mfma_f32_16x16x32_bf16 v[220:223], a[180:183], a[140:143], v[220:223]
  s_cmp_eq_u32 s0, 8
  s_cselect_b32 s54, 0, s54
  s_mov_b32 m0, s41
  v_mfma_f32_16x16x32_bf16 v[152:155], a[72:75], a[160:163], 0
  ds_read_b128 a[48:51], v17 offset:6144
  ds_read_b128 a[16:19], v16 offset:8192
  v_mfma_f32_16x16x32_bf16 v[152:155], a[108:111], a[184:187], v[152:155]
  buffer_load_dwordx4 v233, s[12:15], s47 offen offset:0 lds
  v_mfma_f32_16x16x32_bf16 v[156:159], a[76:79], a[160:163], 0
  ds_read_b128 a[52:55], v17 offset:8192
  ds_read_b128 a[20:23], v16 offset:10240
  v_mfma_f32_16x16x32_bf16 v[156:159], a[112:115], a[184:187], v[156:159]
  ds_read_b128 a[56:59], v17 offset:10240
  ds_read_b128 a[24:27], v16 offset:12288
  v_mfma_f32_16x16x32_bf16 v[160:163], a[80:83], a[160:163], 0
  ds_read_b128 a[60:63], v17 offset:12288
  v_mfma_f32_16x16x32_bf16 v[160:163], a[116:119], a[184:187], v[160:163]
  v_mfma_f32_16x16x32_bf16 v[164:167], a[84:87], a[160:163], 0
  buffer_load_dwordx4 v234, s[12:15], s47 offen offset:1024 lds
  v_mfma_f32_16x16x32_bf16 v[164:167], a[120:123], a[184:187], v[164:167]
  ds_read_b128 a[28:31], v16 offset:14336
  ds_read_b128 a[64:67], v17 offset:14336
  v_mfma_f32_16x16x32_bf16 v[168:171], a[88:91], a[160:163], 0
  ds_read_b64_tr_b16 a[148:149], v21 offset:0
  v_mfma_f32_16x16x32_bf16 v[168:171], a[124:127], a[184:187], v[168:171]
  v_mfma_f32_16x16x32_bf16 v[172:175], a[92:95], a[160:163], 0
  ds_read_b64_tr_b16 a[150:151], v21 offset:2048
  v_mfma_f32_16x16x32_bf16 v[172:175], a[128:131], a[184:187], v[172:175]
  buffer_load_dwordx4 v235, s[12:15], s47 offen offset:2048 lds
  v_mfma_f32_16x16x32_bf16 v[176:179], a[96:99], a[160:163], 0
  s_add_u32 m0, s41, 3072
  ds_read_b64_tr_b16 a[172:173], v21 offset:4096
  ds_read_b64_tr_b16 a[174:175], v21 offset:6144
  v_mfma_f32_16x16x32_bf16 v[176:179], a[132:135], a[184:187], v[176:179]
  v_mfma_f32_16x16x32_bf16 v[180:183], a[100:103], a[160:163], 0
  ds_read_b64_tr_b16 a[152:153], v20 offset:8192
  v_mfma_f32_16x16x32_bf16 v[180:183], a[136:139], a[184:187], v[180:183]
  ds_read_b64_tr_b16 a[154:155], v20 offset:10240
  v_mfma_f32_16x16x32_bf16 v[184:187], a[72:75], a[164:167], 0
  buffer_load_dwordx4 v236, s[12:15], s47 offen offset:0 lds
  v_mfma_f32_16x16x32_bf16 v[184:187], a[108:111], a[188:191], v[184:187]
  ds_read_b64_tr_b16 a[176:177], v20 offset:12288
  v_mfma_f32_16x16x32_bf16 v[188:191], a[76:79], a[164:167], 0
  ds_read_b64_tr_b16 a[178:179], v20 offset:14336
  v_mfma_f32_16x16x32_bf16 v[188:191], a[112:115], a[188:191], v[188:191]
  ds_read_b128 a[32:35], v18 offset:0
  v_mfma_f32_16x16x32_bf16 v[192:195], a[80:83], a[164:167], 0
  ds_read_b128 a[68:71], v19 offset:0
  v_mfma_f32_16x16x32_bf16 v[192:195], a[116:119], a[188:191], v[192:195]
  buffer_load_dwordx4 v237, s[12:15], s47 offen offset:1024 lds
  v_mfma_f32_16x16x32_bf16 v[196:199], a[84:87], a[164:167], 0
  v_mfma_f32_16x16x32_bf16 v[196:199], a[120:123], a[188:191], v[196:199]
  v_mfma_f32_16x16x32_bf16 v[200:203], a[88:91], a[164:167], 0
  v_mfma_f32_16x16x32_bf16 v[200:203], a[124:127], a[188:191], v[200:203]
  v_mfma_f32_16x16x32_bf16 v[204:207], a[92:95], a[164:167], 0
  buffer_load_dwordx4 v238, s[12:15], s47 offen offset:2048 lds
  v_mfma_f32_16x16x32_bf16 v[204:207], a[128:131], a[188:191], v[204:207]
  v_mfma_f32_16x16x32_bf16 v[208:211], a[96:99], a[164:167], 0
  v_mfma_f32_16x16x32_bf16 v[208:211], a[132:135], a[188:191], v[208:211]
  v_mfma_f32_16x16x32_bf16 v[212:215], a[100:103], a[164:167], 0
  v_mfma_f32_16x16x32_bf16 v[212:215], a[136:139], a[188:191], v[212:215]
  s_waitcnt lgkmcnt(0)
  v_mfma_f32_16x16x32_bf16 v[24:27], a[144:147], a[0:3], v[24:27]
  s_add_u32 m0, s36, s50
  ds_read_b64_tr_b16 a[156:157], v21 offset:8192
  v_mfma_f32_16x16x32_bf16 v[24:27], a[168:171], a[36:39], v[24:27]
  buffer_load_dwordx4 v232, s[8:11], s46 offen offset:0 lds
  v_mfma_f32_16x16x32_bf16 v[28:31], a[144:147], a[4:7], v[28:31]
  s_mov_b32 m0, s36
  v_mfma_f32_16x16x32_bf16 v[28:31], a[168:171], a[40:43], v[28:31]
  ds_read_b64_tr_b16 a[158:159], v21 offset:10240
  v_mfma_f32_16x16x32_bf16 v[32:35], a[144:147], a[8:11], v[32:35]
  buffer_load_dwordx4 v224, s[8:11], s46 offen offset:0 lds
  v_mfma_f32_16x16x32_bf16 v[32:35], a[168:171], a[44:47], v[32:35]
  v_mfma_f32_16x16x32_bf16 v[36:39], a[144:147], a[12:15], v[36:39]
  ds_read_b64_tr_b16 a[180:181], v21 offset:12288
  v_mfma_f32_16x16x32_bf16 v[36:39], a[168:171], a[48:51], v[36:39]
  v_mfma_f32_16x16x32_bf16 v[40:43], a[144:147], a[16:19], v[40:43]
  v_mfma_f32_16x16x32_bf16 v[40:43], a[168:171], a[52:55], v[40:43]
  buffer_load_dwordx4 v225, s[8:11], s46 offen offset:1024 lds
  v_mfma_f32_16x16x32_bf16 v[44:47], a[144:147], a[20:23], v[44:47]
  ds_read_b64_tr_b16 a[182:183], v21 offset:14336
  v_mfma_f32_16x16x32_bf16 v[44:47], a[168:171], a[56:59], v[44:47]
  v_mfma_f32_16x16x32_bf16 v[48:51], a[144:147], a[24:27], v[48:51]
  v_mfma_f32_16x16x32_bf16 v[48:51], a[168:171], a[60:63], v[48:51]
  ds_read_b64_tr_b16 a[160:161], v20 offset:16384
  v_mfma_f32_16x16x32_bf16 v[52:55], a[144:147], a[28:31], v[52:55]
  buffer_load_dwordx4 v226, s[8:11], s46 offen offset:2048 lds
  v_mfma_f32_16x16x32_bf16 v[52:55], a[168:171], a[64:67], v[52:55]
  v_mfma_f32_16x16x32_bf16 v[56:59], a[148:151], a[0:3], v[56:59]
  ds_read_b64_tr_b16 a[162:163], v20 offset:18432
  v_mfma_f32_16x16x32_bf16 v[56:59], a[172:175], a[36:39], v[56:59]
  v_mfma_f32_16x16x32_bf16 v[60:63], a[148:151], a[4:7], v[60:63]
  v_mfma_f32_16x16x32_bf16 v[60:63], a[172:175], a[40:43], v[60:63]
  buffer_load_dwordx4 v227, s[8:11], s46 offen offset:3072 lds
  v_mfma_f32_16x16x32_bf16 v[64:67], a[148:151], a[8:11], v[64:67]
  s_add_u32 m0, s36, 4096
  ds_read_b64_tr_b16 a[184:185], v20 offset:20480
  v_mfma_f32_16x16x32_bf16 v[64:67], a[172:175], a[44:47], v[64:67]
  s_add_u32 s36, s36, s38
  v_mfma_f32_16x16x32_bf16 v[68:71], a[148:151], a[12:15], v[68:71]
  s_add_u32 s37, s37, 1
  v_mfma_f32_16x16x32_bf16 v[68:71], a[172:175], a[48:51], v[68:71]
  buffer_load_dwordx4 v228, s[8:11], s46 offen offset:0 lds
  v_mfma_f32_16x16x32_bf16 v[72:75], a[148:151], a[16:19], v[72:75]
  ds_read_b64_tr_b16 a[186:187], v20 offset:22528
  v_mfma_f32_16x16x32_bf16 v[72:75], a[172:175], a[52:55], v[72:75]
  s_cmp_eq_u32 s37, 3
  s_cselect_b32 s37, 0, s37
  s_cselect_b32 s38, s39, s40
  v_mfma_f32_16x16x32_bf16 v[76:79], a[148:151], a[20:23], v[76:79]
  s_add_u32 s41, s41, s43
  ds_read_b64_tr_b16 a[164:165], v21 offset:16384
  v_mfma_f32_16x16x32_bf16 v[76:79], a[172:175], a[56:59], v[76:79]
  s_sub_u32 s43, 0, s43
  v_mfma_f32_16x16x32_bf16 v[80:83], a[148:151], a[24:27], v[80:83]
  buffer_load_dwordx4 v229, s[8:11], s46 offen offset:1024 lds
  v_mfma_f32_16x16x32_bf16 v[80:83], a[172:175], a[60:63], v[80:83]
  v_mfma_f32_16x16x32_bf16 v[84:87], a[148:151], a[28:31], v[84:87]
  ds_read_b64_tr_b16 a[166:167], v21 offset:18432
  v_mfma_f32_16x16x32_bf16 v[84:87], a[172:175], a[64:67], v[84:87]
  v_mfma_f32_16x16x32_bf16 v[88:91], a[152:155], a[0:3], v[88:91]
  v_mfma_f32_16x16x32_bf16 v[88:91], a[176:179], a[36:39], v[88:91]
  buffer_load_dwordx4 v230, s[8:11], s46 offen offset:2048 lds
  v_mfma_f32_16x16x32_bf16 v[92:95], a[152:155], a[4:7], v[92:95]
  ds_read_b64_tr_b16 a[188:189], v21 offset:20480
  v_mfma_f32_16x16x32_bf16 v[92:95], a[176:179], a[40:43], v[92:95]
  v_mfma_f32_16x16x32_bf16 v[96:99], a[152:155], a[8:11], v[96:99]
  ds_read_b64_tr_b16 a[190:191], v21 offset:22528
  v_mfma_f32_16x16x32_bf16 v[96:99], a[176:179], a[44:47], v[96:99]
  v_add_u32 v16, s38, v16
  v_add_u32 v17, s38, v17
  v_mfma_f32_16x16x32_bf16 v[100:103], a[152:155], a[12:15], v[100:103]
  buffer_load_dwordx4 v231, s[8:11], s46 offen offset:3072 lds
  v_mfma_f32_16x16x32_bf16 v[100:103], a[176:179], a[48:51], v[100:103]
  s_mul_i32 s47, s48, 393216
  v_add_u32 v18, s38, v18
  v_add_u32 v19, s38, v19
  v_mfma_f32_16x16x32_bf16 v[104:107], a[152:155], a[16:19], v[104:107]
  s_bfe_u32 s34, 0x302010e, s49
  v_add_u32 v20, s43, v20
  v_add_u32 v21, s43, v21
  v_mfma_f32_16x16x32_bf16 v[104:107], a[176:179], a[52:55], v[104:107]
  s_add_u32 s48, s48, s34
  v_mfma_f32_16x16x32_bf16 v[108:111], a[152:155], a[20:23], v[108:111]
  s_add_u32 s49, s49, 8
  v_mfma_f32_16x16x32_bf16 v[108:111], a[176:179], a[56:59], v[108:111]
  s_and_b32 s49, s49, 0x8001f
  v_mfma_f32_16x16x32_bf16 v[112:115], a[152:155], a[24:27], v[112:115]
  s_and_b32 s48, s48, 15
  v_mfma_f32_16x16x32_bf16 v[112:115], a[176:179], a[60:63], v[112:115]
  s_lshl_b32 s46, s48, 7
  v_mfma_f32_16x16x32_bf16 v[116:119], a[152:155], a[28:31], v[116:119]
  v_mfma_f32_16x16x32_bf16 v[116:119], a[176:179], a[64:67], v[116:119]
  v_mfma_f32_16x16x32_bf16 v[216:219], a[152:155], a[32:35], v[216:219]
  v_mfma_f32_16x16x32_bf16 v[216:219], a[176:179], a[68:71], v[216:219]
  s_mov_b32 s35, 6
  s_waitcnt vmcnt(9) lgkmcnt(0)
  s_barrier
  .p2align 6
Lp2r0_loop:
  v_mfma_f32_16x16x32_bf16 v[120:123], a[156:159], a[0:3], v[120:123]
  buffer_load_dwordx4 a[192:195], v2, s[52:55], s51 offen offset:0
  v_mfma_f32_16x16x32_bf16 v[120:123], a[180:183], a[36:39], v[120:123]
  ds_read_b128 a[72:75], v16 offset:0
  ds_read_b128 a[108:111], v17 offset:0
  v_mfma_f32_16x16x32_bf16 v[124:127], a[156:159], a[4:7], v[124:127]
  ds_read_b64_tr_b16 a[144:145], v20 offset:0
  v_mfma_f32_16x16x32_bf16 v[124:127], a[180:183], a[40:43], v[124:127]
  v_mfma_f32_16x16x32_bf16 v[128:131], a[156:159], a[8:11], v[128:131]
  buffer_load_dwordx4 a[192:195], v2, s[52:55], s51 offen offset:1024
  v_mfma_f32_16x16x32_bf16 v[128:131], a[180:183], a[44:47], v[128:131]
  ds_read_b64_tr_b16 a[146:147], v20 offset:2048
  ds_read_b64_tr_b16 a[168:169], v20 offset:4096
  v_mfma_f32_16x16x32_bf16 v[132:135], a[156:159], a[12:15], v[132:135]
  ds_read_b64_tr_b16 a[170:171], v20 offset:6144
  v_mfma_f32_16x16x32_bf16 v[132:135], a[180:183], a[48:51], v[132:135]
  v_mfma_f32_16x16x32_bf16 v[136:139], a[156:159], a[16:19], v[136:139]
  ds_read_b128 a[76:79], v16 offset:2048
  v_mfma_f32_16x16x32_bf16 v[136:139], a[180:183], a[52:55], v[136:139]
  buffer_load_dwordx4 a[192:195], v2, s[52:55], s51 offen offset:2048
  v_mfma_f32_16x16x32_bf16 v[140:143], a[156:159], a[20:23], v[140:143]
  ds_read_b128 a[112:115], v17 offset:2048
  ds_read_b128 a[80:83], v16 offset:4096
  v_mfma_f32_16x16x32_bf16 v[140:143], a[180:183], a[56:59], v[140:143]
  v_mfma_f32_16x16x32_bf16 v[144:147], a[156:159], a[24:27], v[144:147]
  ds_read_b128 a[116:119], v17 offset:4096
  v_mfma_f32_16x16x32_bf16 v[144:147], a[180:183], a[60:63], v[144:147]
  ds_read_b128 a[84:87], v16 offset:6144
  v_mfma_f32_16x16x32_bf16 v[148:151], a[156:159], a[28:31], v[148:151]
  buffer_load_dwordx4 a[192:195], v2, s[52:55], s51 offen offset:3072
  v_mfma_f32_16x16x32_bf16 v[148:151], a[180:183], a[64:67], v[148:151]
  s_add_u32 s51, s51, 4096
  s_add_u32 s0, s0, 1
  s_cmp_eq_u32 s0, 2
  s_cselect_b32 s52, s68, s52
  s_cselect_b32 s53, s69, s53
  s_cselect_b32 s51, s1, s51
  s_cselect_b32 s54, 0, s54
  v_mfma_f32_16x16x32_bf16 v[220:223], a[156:159], a[32:35], v[220:223]
  s_cmp_eq_u32 s0, 6
  s_cselect_b32 s52, s64, s52
  s_cselect_b32 s53, s65, s53
  s_cselect_b32 s51, s56, s51
  s_cselect_b32 s54, 0, s54
  v_mfma_f32_16x16x32_bf16 v[220:223], a[180:183], a[68:71], v[220:223]
  s_cmp_eq_u32 s0, 8
  s_cselect_b32 s54, 0, s54
  s_mov_b32 m0, s41
  v_mfma_f32_16x16x32_bf16 v[152:155], a[0:3], a[160:163], v[152:155]
  ds_read_b128 a[120:123], v17 offset:6144
  ds_read_b128 a[88:91], v16 offset:8192
  v_mfma_f32_16x16x32_bf16 v[152:155], a[36:39], a[184:187], v[152:155]
  buffer_load_dwordx4 v233, s[12:15], s47 offen offset:0 lds
  v_mfma_f32_16x16x32_bf16 v[156:159], a[4:7], a[160:163], v[156:159]
  ds_read_b128 a[124:127], v17 offset:8192
  ds_read_b128 a[92:95], v16 offset:10240
  v_mfma_f32_16x16x32_bf16 v[156:159], a[40:43], a[184:187], v[156:159]
  ds_read_b128 a[128:131], v17 offset:10240
  ds_read_b128 a[96:99], v16 offset:12288
  v_mfma_f32_16x16x32_bf16 v[160:163], a[8:11], a[160:163], v[160:163]
  ds_read_b128 a[132:135], v17 offset:12288
  v_mfma_f32_16x16x32_bf16 v[160:163], a[44:47], a[184:187], v[160:163]
  v_mfma_f32_16x16x32_bf16 v[164:167], a[12:15], a[160:163], v[164:167]
  buffer_load_dwordx4 v234, s[12:15], s47 offen offset:1024 lds
  v_mfma_f32_16x16x32_bf16 v[164:167], a[48:51], a[184:187], v[164:167]
  ds_read_b128 a[100:103], v16 offset:14336
  ds_read_b128 a[136:139], v17 offset:14336
  v_mfma_f32_16x16x32_bf16 v[168:171], a[16:19], a[160:163], v[168:171]
  ds_read_b64_tr_b16 a[148:149], v21 offset:0
  v_mfma_f32_16x16x32_bf16 v[168:171], a[52:55], a[184:187], v[168:171]
  v_mfma_f32_16x16x32_bf16 v[172:175], a[20:23], a[160:163], v[172:175]
  ds_read_b64_tr_b16 a[150:151], v21 offset:2048
  v_mfma_f32_16x16x32_bf16 v[172:175], a[56:59], a[184:187], v[172:175]
  buffer_load_dwordx4 v235, s[12:15], s47 offen offset:2048 lds
  v_mfma_f32_16x16x32_bf16 v[176:179], a[24:27], a[160:163], v[176:179]
  s_add_u32 m0, s41, 3072
  ds_read_b64_tr_b16 a[172:173], v21 offset:4096
  ds_read_b64_tr_b16 a[174:175], v21 offset:6144
  v_mfma_f32_16x16x32_bf16 v[176:179], a[60:63], a[184:187], v[176:179]
  v_mfma_f32_16x16x32_bf16 v[180:183], a[28:31], a[160:163], v[180:183]
  ds_read_b64_tr_b16 a[152:153], v20 offset:8192
  v_mfma_f32_16x16x32_bf16 v[180:183], a[64:67], a[184:187], v[180:183]
  ds_read_b64_tr_b16 a[154:155], v20 offset:10240
  v_mfma_f32_16x16x32_bf16 v[184:187], a[0:3], a[164:167], v[184:187]
  buffer_load_dwordx4 v236, s[12:15], s47 offen offset:0 lds
  v_mfma_f32_16x16x32_bf16 v[184:187], a[36:39], a[188:191], v[184:187]
  ds_read_b64_tr_b16 a[176:177], v20 offset:12288
  v_mfma_f32_16x16x32_bf16 v[188:191], a[4:7], a[164:167], v[188:191]
  ds_read_b64_tr_b16 a[178:179], v20 offset:14336
  v_mfma_f32_16x16x32_bf16 v[188:191], a[40:43], a[188:191], v[188:191]
  ds_read_b128 a[104:107], v18 offset:0
  v_mfma_f32_16x16x32_bf16 v[192:195], a[8:11], a[164:167], v[192:195]
  ds_read_b128 a[140:143], v19 offset:0
  v_mfma_f32_16x16x32_bf16 v[192:195], a[44:47], a[188:191], v[192:195]
  buffer_load_dwordx4 v237, s[12:15], s47 offen offset:1024 lds
  v_mfma_f32_16x16x32_bf16 v[196:199], a[12:15], a[164:167], v[196:199]
  v_mfma_f32_16x16x32_bf16 v[196:199], a[48:51], a[188:191], v[196:199]
  v_mfma_f32_16x16x32_bf16 v[200:203], a[16:19], a[164:167], v[200:203]
  v_mfma_f32_16x16x32_bf16 v[200:203], a[52:55], a[188:191], v[200:203]
  v_mfma_f32_16x16x32_bf16 v[204:207], a[20:23], a[164:167], v[204:207]
  buffer_load_dwordx4 v238, s[12:15], s47 offen offset:2048 lds
  v_mfma_f32_16x16x32_bf16 v[204:207], a[56:59], a[188:191], v[204:207]
  v_mfma_f32_16x16x32_bf16 v[208:211], a[24:27], a[164:167], v[208:211]
  v_mfma_f32_16x16x32_bf16 v[208:211], a[60:63], a[188:191], v[208:211]
  v_mfma_f32_16x16x32_bf16 v[212:215], a[28:31], a[164:167], v[212:215]
  v_mfma_f32_16x16x32_bf16 v[212:215], a[64:67], a[188:191], v[212:215]
  s_waitcnt lgkmcnt(0)
  v_mfma_f32_16x16x32_bf16 v[24:27], a[144:147], a[72:75], v[24:27]
  s_add_u32 m0, s36, s50
  ds_read_b64_tr_b16 a[156:157], v21 offset:8192
  v_mfma_f32_16x16x32_bf16 v[24:27], a[168:171], a[108:111], v[24:27]
  buffer_load_dwordx4 v232, s[8:11], s46 offen offset:0 lds
  v_mfma_f32_16x16x32_bf16 v[28:31], a[144:147], a[76:79], v[28:31]
  s_mov_b32 m0, s36
  v_mfma_f32_16x16x32_bf16 v[28:31], a[168:171], a[112:115], v[28:31]
  ds_read_b64_tr_b16 a[158:159], v21 offset:10240
  v_mfma_f32_16x16x32_bf16 v[32:35], a[144:147], a[80:83], v[32:35]
  buffer_load_dwordx4 v224, s[8:11], s46 offen offset:0 lds
  v_mfma_f32_16x16x32_bf16 v[32:35], a[168:171], a[116:119], v[32:35]
  v_mfma_f32_16x16x32_bf16 v[36:39], a[144:147], a[84:87], v[36:39]
  ds_read_b64_tr_b16 a[180:181], v21 offset:12288
  v_mfma_f32_16x16x32_bf16 v[36:39], a[168:171], a[120:123], v[36:39]
  v_mfma_f32_16x16x32_bf16 v[40:43], a[144:147], a[88:91], v[40:43]
  v_mfma_f32_16x16x32_bf16 v[40:43], a[168:171], a[124:127], v[40:43]
  buffer_load_dwordx4 v225, s[8:11], s46 offen offset:1024 lds
  v_mfma_f32_16x16x32_bf16 v[44:47], a[144:147], a[92:95], v[44:47]
  ds_read_b64_tr_b16 a[182:183], v21 offset:14336
  v_mfma_f32_16x16x32_bf16 v[44:47], a[168:171], a[128:131], v[44:47]
  v_mfma_f32_16x16x32_bf16 v[48:51], a[144:147], a[96:99], v[48:51]
  v_mfma_f32_16x16x32_bf16 v[48:51], a[168:171], a[132:135], v[48:51]
  ds_read_b64_tr_b16 a[160:161], v20 offset:16384
  v_mfma_f32_16x16x32_bf16 v[52:55], a[144:147], a[100:103], v[52:55]
  buffer_load_dwordx4 v226, s[8:11], s46 offen offset:2048 lds
  v_mfma_f32_16x16x32_bf16 v[52:55], a[168:171], a[136:139], v[52:55]
  v_mfma_f32_16x16x32_bf16 v[56:59], a[148:151], a[72:75], v[56:59]
  ds_read_b64_tr_b16 a[162:163], v20 offset:18432
  v_mfma_f32_16x16x32_bf16 v[56:59], a[172:175], a[108:111], v[56:59]
  v_mfma_f32_16x16x32_bf16 v[60:63], a[148:151], a[76:79], v[60:63]
  v_mfma_f32_16x16x32_bf16 v[60:63], a[172:175], a[112:115], v[60:63]
  buffer_load_dwordx4 v227, s[8:11], s46 offen offset:3072 lds
  v_mfma_f32_16x16x32_bf16 v[64:67], a[148:151], a[80:83], v[64:67]
  s_add_u32 m0, s36, 4096
  ds_read_b64_tr_b16 a[184:185], v20 offset:20480
  v_mfma_f32_16x16x32_bf16 v[64:67], a[172:175], a[116:119], v[64:67]
  s_add_u32 s36, s36, s38
  v_mfma_f32_16x16x32_bf16 v[68:71], a[148:151], a[84:87], v[68:71]
  s_add_u32 s37, s37, 1
  v_mfma_f32_16x16x32_bf16 v[68:71], a[172:175], a[120:123], v[68:71]
  buffer_load_dwordx4 v228, s[8:11], s46 offen offset:0 lds
  v_mfma_f32_16x16x32_bf16 v[72:75], a[148:151], a[88:91], v[72:75]
  ds_read_b64_tr_b16 a[186:187], v20 offset:22528
  v_mfma_f32_16x16x32_bf16 v[72:75], a[172:175], a[124:127], v[72:75]
  s_cmp_eq_u32 s37, 3
  s_cselect_b32 s37, 0, s37
  s_cselect_b32 s38, s39, s40
  v_mfma_f32_16x16x32_bf16 v[76:79], a[148:151], a[92:95], v[76:79]
  s_add_u32 s41, s41, s43
  ds_read_b64_tr_b16 a[164:165], v21 offset:16384
  v_mfma_f32_16x16x32_bf16 v[76:79], a[172:175], a[128:131], v[76:79]
  s_sub_u32 s43, 0, s43
  v_mfma_f32_16x16x32_bf16 v[80:83], a[148:151], a[96:99], v[80:83]
  buffer_load_dwordx4 v229, s[8:11], s46 offen offset:1024 lds
  v_mfma_f32_16x16x32_bf16 v[80:83], a[172:175], a[132:135], v[80:83]
  v_mfma_f32_16x16x32_bf16 v[84:87], a[148:151], a[100:103], v[84:87]
  ds_read_b64_tr_b16 a[166:167], v21 offset:18432
  v_mfma_f32_16x16x32_bf16 v[84:87], a[172:175], a[136:139], v[84:87]
  v_mfma_f32_16x16x32_bf16 v[88:91], a[152:155], a[72:75], v[88:91]
  v_mfma_f32_16x16x32_bf16 v[88:91], a[176:179], a[108:111], v[88:91]
  buffer_load_dwordx4 v230, s[8:11], s46 offen offset:2048 lds
  v_mfma_f32_16x16x32_bf16 v[92:95], a[152:155], a[76:79], v[92:95]
  ds_read_b64_tr_b16 a[188:189], v21 offset:20480
  v_mfma_f32_16x16x32_bf16 v[92:95], a[176:179], a[112:115], v[92:95]
  v_mfma_f32_16x16x32_bf16 v[96:99], a[152:155], a[80:83], v[96:99]
  ds_read_b64_tr_b16 a[190:191], v21 offset:22528
  v_mfma_f32_16x16x32_bf16 v[96:99], a[176:179], a[116:119], v[96:99]
  v_add_u32 v16, s38, v16
  v_add_u32 v17, s38, v17
  v_mfma_f32_16x16x32_bf16 v[100:103], a[152:155], a[84:87], v[100:103]
  buffer_load_dwordx4 v231, s[8:11], s46 offen offset:3072 lds
  v_mfma_f32_16x16x32_bf16 v[100:103], a[176:179], a[120:123], v[100:103]
  s_mul_i32 s47, s48, 393216
  v_add_u32 v18, s38, v18
  v_add_u32 v19, s38, v19
  v_mfma_f32_16x16x32_bf16 v[104:107], a[152:155], a[88:91], v[104:107]
  s_bfe_u32 s34, 0x302010e, s49
  v_add_u32 v20, s43, v20
  v_add_u32 v21, s43, v21
  v_mfma_f32_16x16x32_bf16 v[104:107], a[176:179], a[124:127], v[104:107]
  s_add_u32 s48, s48, s34
  v_mfma_f32_16x16x32_bf16 v[108:111], a[152:155], a[92:95], v[108:111]
  s_add_u32 s49, s49, 8
  v_mfma_f32_16x16x32_bf16 v[108:111], a[176:179], a[128:131], v[108:111]
  s_and_b32 s49, s49, 0x8001f
  v_mfma_f32_16x16x32_bf16 v[112:115], a[152:155], a[96:99], v[112:115]
  s_and_b32 s48, s48, 15
  v_mfma_f32_16x16x32_bf16 v[112:115], a[176:179], a[132:135], v[112:115]
  s_lshl_b32 s46, s48, 7
  v_mfma_f32_16x16x32_bf16 v[116:119], a[152:155], a[100:103], v[116:119]
  v_mfma_f32_16x16x32_bf16 v[116:119], a[176:179], a[136:139], v[116:119]
  v_mfma_f32_16x16x32_bf16 v[216:219], a[152:155], a[104:107], v[216:219]
  v_mfma_f32_16x16x32_bf16 v[216:219], a[176:179], a[140:143], v[216:219]
  s_waitcnt vmcnt(9) lgkmcnt(0)
  s_barrier
  v_mfma_f32_16x16x32_bf16 v[120:123], a[156:159], a[72:75], v[120:123]
  buffer_load_dwordx4 a[192:195], v2, s[52:55], s51 offen offset:0
  v_mfma_f32_16x16x32_bf16 v[120:123], a[180:183], a[108:111], v[120:123]
  ds_read_b128 a[0:3], v16 offset:0
  ds_read_b128 a[36:39], v17 offset:0
  v_mfma_f32_16x16x32_bf16 v[124:127], a[156:159], a[76:79], v[124:127]
  ds_read_b64_tr_b16 a[144:145], v20 offset:0
  v_mfma_f32_16x16x32_bf16 v[124:127], a[180:183], a[112:115], v[124:127]
  v_mfma_f32_16x16x32_bf16 v[128:131], a[156:159], a[80:83], v[128:131]
  buffer_load_dwordx4 a[192:195], v2, s[52:55], s51 offen offset:1024
  v_mfma_f32_16x16x32_bf16 v[128:131], a[180:183], a[116:119], v[128:131]
  ds_read_b64_tr_b16 a[146:147], v20 offset:2048
  ds_read_b64_tr_b16 a[168:169], v20 offset:4096
  v_mfma_f32_16x16x32_bf16 v[132:135], a[156:159], a[84:87], v[132:135]
  ds_read_b64_tr_b16 a[170:171], v20 offset:6144
  v_mfma_f32_16x16x32_bf16 v[132:135], a[180:183], a[120:123], v[132:135]
  v_mfma_f32_16x16x32_bf16 v[136:139], a[156:159], a[88:91], v[136:139]
  ds_read_b128 a[4:7], v16 offset:2048
  v_mfma_f32_16x16x32_bf16 v[136:139], a[180:183], a[124:127], v[136:139]
  buffer_load_dwordx4 a[192:195], v2, s[52:55], s51 offen offset:2048
  v_mfma_f32_16x16x32_bf16 v[140:143], a[156:159], a[92:95], v[140:143]
  ds_read_b128 a[40:43], v17 offset:2048
  ds_read_b128 a[8:11], v16 offset:4096
  v_mfma_f32_16x16x32_bf16 v[140:143], a[180:183], a[128:131], v[140:143]
  v_mfma_f32_16x16x32_bf16 v[144:147], a[156:159], a[96:99], v[144:147]
  ds_read_b128 a[44:47], v17 offset:4096
  v_mfma_f32_16x16x32_bf16 v[144:147], a[180:183], a[132:135], v[144:147]
  ds_read_b128 a[12:15], v16 offset:6144
  v_mfma_f32_16x16x32_bf16 v[148:151], a[156:159], a[100:103], v[148:151]
  buffer_load_dwordx4 a[192:195], v2, s[52:55], s51 offen offset:3072
  v_mfma_f32_16x16x32_bf16 v[148:151], a[180:183], a[136:139], v[148:151]
  s_add_u32 s51, s51, 4096
  s_add_u32 s0, s0, 1
  s_cmp_eq_u32 s0, 2
  s_cselect_b32 s52, s68, s52
  s_cselect_b32 s53, s69, s53
  s_cselect_b32 s51, s1, s51
  s_cselect_b32 s54, 0, s54
  v_mfma_f32_16x16x32_bf16 v[220:223], a[156:159], a[104:107], v[220:223]
  s_cmp_eq_u32 s0, 6
  s_cselect_b32 s52, s64, s52
  s_cselect_b32 s53, s65, s53
  s_cselect_b32 s51, s56, s51
  s_cselect_b32 s54, 0, s54
  v_mfma_f32_16x16x32_bf16 v[220:223], a[180:183], a[140:143], v[220:223]
  s_cmp_eq_u32 s0, 8
  s_cselect_b32 s54, 0, s54
  s_mov_b32 m0, s41
  v_mfma_f32_16x16x32_bf16 v[152:155], a[72:75], a[160:163], v[152:155]
  ds_read_b128 a[48:51], v17 offset:6144
  ds_read_b128 a[16:19], v16 offset:8192
  v_mfma_f32_16x16x32_bf16 v[152:155], a[108:111], a[184:187], v[152:155]
  buffer_load_dwordx4 v233, s[12:15], s47 offen offset:0 lds
  v_mfma_f32_16x16x32_bf16 v[156:159], a[76:79], a[160:163], v[156:159]
  ds_read_b128 a[52:55], v17 offset:8192
  ds_read_b128 a[20:23], v16 offset:10240
  v_mfma_f32_16x16x32_bf16 v[156:159], a[112:115], a[184:187], v[156:159]
  ds_read_b128 a[56:59], v17 offset:10240
  ds_read_b128 a[24:27], v16 offset:12288
  v_mfma_f32_16x16x32_bf16 v[160:163], a[80:83], a[160:163], v[160:163]
  ds_read_b128 a[60:63], v17 offset:12288
  v_mfma_f32_16x16x32_bf16 v[160:163], a[116:119], a[184:187], v[160:163]
  v_mfma_f32_16x16x32_bf16 v[164:167], a[84:87], a[160:163], v[164:167]
  buffer_load_dwordx4 v234, s[12:15], s47 offen offset:1024 lds
  v_mfma_f32_16x16x32_bf16 v[164:167], a[120:123], a[184:187], v[164:167]
  ds_read_b128 a[28:31], v16 offset:14336
  ds_read_b128 a[64:67], v17 offset:14336
  v_mfma_f32_16x16x32_bf16 v[168:171], a[88:91], a[160:163], v[168:171]
  ds_read_b64_tr_b16 a[148:149], v21 offset:0
  v_mfma_f32_16x16x32_bf16 v[168:171], a[124:127], a[184:187], v[168:171]
  v_mfma_f32_16x16x32_bf16 v[172:175], a[92:95], a[160:163], v[172:175]
  ds_read_b64_tr_b16 a[150:151], v21 offset:2048
  v_mfma_f32_16x16x32_bf16 v[172:175], a[128:131], a[184:187], v[172:175]
  buffer_load_dwordx4 v235, s[12:15], s47 offen offset:2048 lds
  v_mfma_f32_16x16x32_bf16 v[176:179], a[96:99], a[160:163], v[176:179]
  s_add_u32 m0, s41, 3072
  ds_read_b64_tr_b16 a[172:173], v21 offset:4096
  ds_read_b64_tr_b16 a[174:175], v21 offset:6144
  v_mfma_f32_16x16x32_bf16 v[176:179], a[132:135], a[184:187], v[176:179]
  v_mfma_f32_16x16x32_bf16 v[180:183], a[100:103], a[160:163], v[180:183]
  ds_read_b64_tr_b16 a[152:153], v20 offset:8192
  v_mfma_f32_16x16x32_bf16 v[180:183], a[136:139], a[184:187], v[180:183]
  ds_read_b64_tr_b16 a[154:155], v20 offset:10240
  v_mfma_f32_16x16x32_bf16 v[184:187], a[72:75], a[164:167], v[184:187]
  buffer_load_dwordx4 v236, s[12:15], s47 offen offset:0 lds
  v_mfma_f32_16x16x32_bf16 v[184:187], a[108:111], a[188:191], v[184:187]
  ds_read_b64_tr_b16 a[176:177], v20 offset:12288
  v_mfma_f32_16x16x32_bf16 v[188:191], a[76:79], a[164:167], v[188:191]
  ds_read_b64_tr_b16 a[178:179], v20 offset:14336
  v_mfma_f32_16x16x32_bf16 v[188:191], a[112:115], a[188:191], v[188:191]
  ds_read_b128 a[32:35], v18 offset:0
  v_mfma_f32_16x16x32_bf16 v[192:195], a[80:83], a[164:167], v[192:195]
  ds_read_b128 a[68:71], v19 offset:0
  v_mfma_f32_16x16x32_bf16 v[192:195], a[116:119], a[188:191], v[192:195]
  buffer_load_dwordx4 v237, s[12:15], s47 offen offset:1024 lds
  v_mfma_f32_16x16x32_bf16 v[196:199], a[84:87], a[164:167], v[196:199]
  v_mfma_f32_16x16x32_bf16 v[196:199], a[120:123], a[188:191], v[196:199]
  v_mfma_f32_16x16x32_bf16 v[200:203], a[88:91], a[164:167], v[200:203]
  v_mfma_f32_16x16x32_bf16 v[200:203], a[124:127], a[188:191], v[200:203]
  v_mfma_f32_16x16x32_bf16 v[204:207], a[92:95], a[164:167], v[204:207]
  buffer_load_dwordx4 v238, s[12:15], s47 offen offset:2048 lds
  v_mfma_f32_16x16x32_bf16 v[204:207], a[128:131], a[188:191], v[204:207]
  v_mfma_f32_16x16x32_bf16 v[208:211], a[96:99], a[164:167], v[208:211]
  v_mfma_f32_16x16x32_bf16 v[208:211], a[132:135], a[188:191], v[208:211]
  v_mfma_f32_16x16x32_bf16 v[212:215], a[100:103], a[164:167], v[212:215]
  v_mfma_f32_16x16x32_bf16 v[212:215], a[136:139], a[188:191], v[212:215]
  s_waitcnt lgkmcnt(0)
  v_mfma_f32_16x16x32_bf16 v[24:27], a[144:147], a[0:3], v[24:27]
  s_add_u32 m0, s36, s50
  ds_read_b64_tr_b16 a[156:157], v21 offset:8192
  v_mfma_f32_16x16x32_bf16 v[24:27], a[168:171], a[36:39], v[24:27]
  buffer_load_dwordx4 v232, s[8:11], s46 offen offset:0 lds
  v_mfma_f32_16x16x32_bf16 v[28:31], a[144:147], a[4:7], v[28:31]
  s_mov_b32 m0, s36
  v_mfma_f32_16x16x32_bf16 v[28:31], a[168:171], a[40:43], v[28:31]
  ds_read_b64_tr_b16 a[158:159], v21 offset:10240
  v_mfma_f32_16x16x32_bf16 v[32:35], a[144:147], a[8:11], v[32:35]
  buffer_load_dwordx4 v224, s[8:11], s46 offen offset:0 lds
  v_mfma_f32_16x16x32_bf16 v[32:35], a[168:171], a[44:47], v[32:35]
  v_mfma_f32_16x16x32_bf16 v[36:39], a[144:147], a[12:15], v[36:39]
  ds_read_b64_tr_b16 a[180:181], v21 offset:12288
  v_mfma_f32_16x16x32_bf16 v[36:39], a[168:171], a[48:51], v[36:39]
  v_mfma_f32_16x16x32_bf16 v[40:43], a[144:147], a[16:19], v[40:43]
  v_mfma_f32_16x16x32_bf16 v[40:43], a[168:171], a[52:55], v[40:43]
  buffer_load_dwordx4 v225, s[8:11], s46 offen offset:1024 lds
  v_mfma_f32_16x16x32_bf16 v[44:47], a[144:147], a[20:23], v[44:47]
  ds_read_b64_tr_b16 a[182:183], v21 offset:14336
  v_mfma_f32_16x16x32_bf16 v[44:47], a[168:171], a[56:59], v[44:47]
  v_mfma_f32_16x16x32_bf16 v[48:51], a[144:147], a[24:27], v[48:51]
  v_mfma_f32_16x16x32_bf16 v[48:51], a[168:171], a[60:63], v[48:51]
  ds_read_b64_tr_b16 a[160:161], v20 offset:16384
  v_mfma_f32_16x16x32_bf16 v[52:55], a[144:147], a[28:31], v[52:55]
  buffer_load_dwordx4 v226, s[8:11], s46 offen offset:2048 lds
  v_mfma_f32_16x16x32_bf16 v[52:55], a[168:171], a[64:67], v[52:55]
  v_mfma_f32_16x16x32_bf16 v[56:59], a[148:151], a[0:3], v[56:59]
  ds_read_b64_tr_b16 a[162:163], v20 offset:18432
  v_mfma_f32_16x16x32_bf16 v[56:59], a[172:175], a[36:39], v[56:59]
  v_mfma_f32_16x16x32_bf16 v[60:63], a[148:151], a[4:7], v[60:63]
  v_mfma_f32_16x16x32_bf16 v[60:63], a[172:175], a[40:43], v[60:63]
  buffer_load_dwordx4 v227, s[8:11], s46 offen offset:3072 lds
  v_mfma_f32_16x16x32_bf16 v[64:67], a[148:151], a[8:11], v[64:67]
  s_add_u32 m0, s36, 4096
  ds_read_b64_tr_b16 a[184:185], v20 offset:20480
  v_mfma_f32_16x16x32_bf16 v[64:67], a[172:175], a[44:47], v[64:67]
  s_add_u32 s36, s36, s38
  v_mfma_f32_16x16x32_bf16 v[68:71], a[148:151], a[12:15], v[68:71]
  s_add_u32 s37, s37, 1
  v_mfma_f32_16x16x32_bf16 v[68:71], a[172:175], a[48:51], v[68:71]
  buffer_load_dwordx4 v228, s[8:11], s46 offen offset:0 lds
  v_mfma_f32_16x16x32_bf16 v[72:75], a[148:151], a[16:19], v[72:75]
  ds_read_b64_tr_b16 a[186:187], v20 offset:22528
  v_mfma_f32_16x16x32_bf16 v[72:75], a[172:175], a[52:55], v[72:75]
  s_cmp_eq_u32 s37, 3
  s_cselect_b32 s37, 0, s37
  s_cselect_b32 s38, s39, s40
  v_mfma_f32_16x16x32_bf16 v[76:79], a[148:151], a[20:23], v[76:79]
  s_add_u32 s41, s41, s43
  ds_read_b64_tr_b16 a[164:165], v21 offset:16384
  v_mfma_f32_16x16x32_bf16 v[76:79], a[172:175], a[56:59], v[76:79]
  s_sub_u32 s43, 0, s43
  v_mfma_f32_16x16x32_bf16 v[80:83], a[148:151], a[24:27], v[80:83]
  buffer_load_dwordx4 v229, s[8:11], s46 offen offset:1024 lds
  v_mfma_f32_16x16x32_bf16 v[80:83], a[172:175], a[60:63], v[80:83]
  v_mfma_f32_16x16x32_bf16 v[84:87], a[148:151], a[28:31], v[84:87]
  ds_read_b64_tr_b16 a[166:167], v21 offset:18432
  v_mfma_f32_16x16x32_bf16 v[84:87], a[172:175], a[64:67], v[84:87]
  v_mfma_f32_16x16x32_bf16 v[88:91], a[152:155], a[0:3], v[88:91]
  v_mfma_f32_16x16x32_bf16 v[88:91], a[176:179], a[36:39], v[88:91]
  buffer_load_dwordx4 v230, s[8:11], s46 offen offset:2048 lds
  v_mfma_f32_16x16x32_bf16 v[92:95], a[152:155], a[4:7], v[92:95]
  ds_read_b64_tr_b16 a[188:189], v21 offset:20480
  v_mfma_f32_16x16x32_bf16 v[92:95], a[176:179], a[40:43], v[92:95]
  v_mfma_f32_16x16x32_bf16 v[96:99], a[152:155], a[8:11], v[96:99]
  ds_read_b64_tr_b16 a[190:191], v21 offset:22528
  v_mfma_f32_16x16x32_bf16 v[96:99], a[176:179], a[44:47], v[96:99]
  v_add_u32 v16, s38, v16
  v_add_u32 v17, s38, v17
  v_mfma_f32_16x16x32_bf16 v[100:103], a[152:155], a[12:15], v[100:103]
  buffer_load_dwordx4 v231, s[8:11], s46 offen offset:3072 lds
  v_mfma_f32_16x16x32_bf16 v[100:103], a[176:179], a[48:51], v[100:103]
  s_mul_i32 s47, s48, 393216
  v_add_u32 v18, s38, v18
  v_add_u32 v19, s38, v19
  v_mfma_f32_16x16x32_bf16 v[104:107], a[152:155], a[16:19], v[104:107]
  s_bfe_u32 s34, 0x302010e, s49
  v_add_u32 v20, s43, v20
  v_add_u32 v21, s43, v21
  v_mfma_f32_16x16x32_bf16 v[104:107], a[176:179], a[52:55], v[104:107]
  s_add_u32 s48, s48, s34
  v_mfma_f32_16x16x32_bf16 v[108:111], a[152:155], a[20:23], v[108:111]
  s_add_u32 s49, s49, 8
  v_mfma_f32_16x16x32_bf16 v[108:111], a[176:179], a[56:59], v[108:111]
  s_and_b32 s49, s49, 0x8001f
  v_mfma_f32_16x16x32_bf16 v[112:115], a[152:155], a[24:27], v[112:115]
  s_and_b32 s48, s48, 15
  v_mfma_f32_16x16x32_bf16 v[112:115], a[176:179], a[60:63], v[112:115]
  s_lshl_b32 s46, s48, 7
  v_mfma_f32_16x16x32_bf16 v[116:119], a[152:155], a[28:31], v[116:119]
  v_mfma_f32_16x16x32_bf16 v[116:119], a[176:179], a[64:67], v[116:119]
  s_waitcnt vmcnt(9) lgkmcnt(0)
  s_barrier
  v_mfma_f32_16x16x32_bf16 v[216:219], a[152:155], a[32:35], v[216:219]
  s_sub_u32 s35, s35, 1
  v_mfma_f32_16x16x32_bf16 v[216:219], a[176:179], a[68:71], v[216:219]
  s_cmp_lg_u32 s35, 0
  s_cbranch_scc1 Lp2r0_loop
  v_accvgpr_read_b32 v4, a222
  v_accvgpr_read_b32 v5, a223
  v_accvgpr_read_b32 v6, a224
  v_accvgpr_read_b32 v7, a225
  v_accvgpr_read_b32 v8, a226
  v_accvgpr_read_b32 v9, a227
  v_accvgpr_read_b32 v10, a228
  v_accvgpr_read_b32 v11, a229
  s_mov_b32 s8, s64
  s_mov_b32 s9, s65
  s_mov_b32 s10, 4194304
  s_mov_b32 s11, 0x00020000
  s_mov_b32 s20, s68
  s_mov_b32 s21, s69
  s_mov_b32 s22, 8388608
  s_mov_b32 s23, 0x00020000
  s_and_b32 s4, s2, 7
  s_lshl_b32 s4, s4, 1
  s_lshr_b32 s5, s2, 6
  s_lshr_b32 s30, s2, 4
  s_add_u32 s5, s5, s30
  s_and_b32 s53, s5, 3
  s_lshl_b32 s53, s53, 3
  s_or_b32 s53, s53, 0x80000
  s_bfe_u32 s52, 0xf0f02, s53
  s_add_u32 s52, s52, s4
  s_and_b32 s52, s52, 15
  s_mov_b32 s54, s52
  s_mov_b32 s55, s53
  s_lshl_b32 s29, s52, 7
  s_lshl_b32 s28, s54, 19
  s_lshl_b32 s30, s25, 18
  s_and_b32 s31, s25, 1
  s_lshl_b32 s31, s31, 1
  s_add_u32 s31, s31, 14
  s_sub_u32 s31, s31, s25
  s_lshl_b32 s31, s31, 18
  s_or_b32 s26, s30, s29
  s_or_b32 s27, s31, s29
  s_lshl_b32 s68, s3, 12
  s_lshl_b32 s88, s3, 13
  s_add_u32 s88, s88, 98304
  v_mfma_f32_16x16x32_bf16 v[120:123], a[156:159], a[0:3], v[120:123]
  s_mov_b32 m0, s41
  ds_read_b128 a[72:75], v16 offset:0
  v_mfma_f32_16x16x32_bf16 v[120:123], a[180:183], a[36:39], v[120:123]
  buffer_load_dwordx4 v233, s[12:15], s47 offen offset:0 lds
  v_mfma_f32_16x16x32_bf16 v[124:127], a[156:159], a[4:7], v[124:127]
  ds_read_b128 a[108:111], v17 offset:0
  ds_read_b64_tr_b16 a[144:145], v20 offset:0
  v_mfma_f32_16x16x32_bf16 v[124:127], a[180:183], a[40:43], v[124:127]
  v_mfma_f32_16x16x32_bf16 v[128:131], a[156:159], a[8:11], v[128:131]
  ds_read_b64_tr_b16 a[146:147], v20 offset:2048
  v_mfma_f32_16x16x32_bf16 v[128:131], a[180:183], a[44:47], v[128:131]
  ds_read_b64_tr_b16 a[168:169], v20 offset:4096
  v_mfma_f32_16x16x32_bf16 v[132:135], a[156:159], a[12:15], v[132:135]
  ds_read_b64_tr_b16 a[170:171], v20 offset:6144
  v_mfma_f32_16x16x32_bf16 v[132:135], a[180:183], a[48:51], v[132:135]
  v_mfma_f32_16x16x32_bf16 v[136:139], a[156:159], a[16:19], v[136:139]
  ds_read_b128 a[76:79], v16 offset:2048
  v_mfma_f32_16x16x32_bf16 v[136:139], a[180:183], a[52:55], v[136:139]
  ds_read_b128 a[112:115], v17 offset:2048
  v_mfma_f32_16x16x32_bf16 v[140:143], a[156:159], a[20:23], v[140:143]
  ds_read_b128 a[80:83], v16 offset:4096
  v_mfma_f32_16x16x32_bf16 v[140:143], a[180:183], a[56:59], v[140:143]
  v_mfma_f32_16x16x32_bf16 v[144:147], a[156:159], a[24:27], v[144:147]
  ds_read_b128 a[116:119], v17 offset:4096
  v_mfma_f32_16x16x32_bf16 v[144:147], a[180:183], a[60:63], v[144:147]
  ds_read_b128 a[84:87], v16 offset:6144
  v_mfma_f32_16x16x32_bf16 v[148:151], a[156:159], a[28:31], v[148:151]
  ds_read_b128 a[120:123], v17 offset:6144
  v_mfma_f32_16x16x32_bf16 v[148:151], a[180:183], a[64:67], v[148:151]
  v_mfma_f32_16x16x32_bf16 v[220:223], a[156:159], a[32:35], v[220:223]
  buffer_load_dwordx4 v234, s[12:15], s47 offen offset:1024 lds
  v_mfma_f32_16x16x32_bf16 v[220:223], a[180:183], a[68:71], v[220:223]
  ds_read_b128 a[88:91], v16 offset:8192
  ds_read_b128 a[124:127], v17 offset:8192
  v_mfma_f32_16x16x32_bf16 v[152:155], a[0:3], a[160:163], v[152:155]
  ds_read_b128 a[92:95], v16 offset:10240
  v_mfma_f32_16x16x32_bf16 v[152:155], a[36:39], a[184:187], v[152:155]
  v_mfma_f32_16x16x32_bf16 v[156:159], a[4:7], a[160:163], v[156:159]
  ds_read_b128 a[128:131], v17 offset:10240
  v_mfma_f32_16x16x32_bf16 v[156:159], a[40:43], a[184:187], v[156:159]
  ds_read_b128 a[96:99], v16 offset:12288
  v_mfma_f32_16x16x32_bf16 v[160:163], a[8:11], a[160:163], v[160:163]
  ds_read_b128 a[132:135], v17 offset:12288
  v_mfma_f32_16x16x32_bf16 v[160:163], a[44:47], a[184:187], v[160:163]
  v_mfma_f32_16x16x32_bf16 v[164:167], a[12:15], a[160:163], v[164:167]
  ds_read_b128 a[100:103], v16 offset:14336
  v_mfma_f32_16x16x32_bf16 v[164:167], a[48:51], a[184:187], v[164:167]
  ds_read_b128 a[136:139], v17 offset:14336
  v_mfma_f32_16x16x32_bf16 v[168:171], a[16:19], a[160:163], v[168:171]
  ds_read_b64_tr_b16 a[148:149], v21 offset:0
  v_mfma_f32_16x16x32_bf16 v[168:171], a[52:55], a[184:187], v[168:171]
  v_mfma_f32_16x16x32_bf16 v[172:175], a[20:23], a[160:163], v[172:175]
  ds_read_b64_tr_b16 a[150:151], v21 offset:2048
  v_mfma_f32_16x16x32_bf16 v[172:175], a[56:59], a[184:187], v[172:175]
  ds_read_b64_tr_b16 a[172:173], v21 offset:4096
  v_mfma_f32_16x16x32_bf16 v[176:179], a[24:27], a[160:163], v[176:179]
  ds_read_b64_tr_b16 a[174:175], v21 offset:6144
  v_mfma_f32_16x16x32_bf16 v[176:179], a[60:63], a[184:187], v[176:179]
  v_mfma_f32_16x16x32_bf16 v[180:183], a[28:31], a[160:163], v[180:183]
  buffer_load_dwordx4 v235, s[12:15], s47 offen offset:2048 lds
  v_mfma_f32_16x16x32_bf16 v[180:183], a[64:67], a[184:187], v[180:183]
  ds_read_b64_tr_b16 a[152:153], v20 offset:8192
  ds_read_b64_tr_b16 a[154:155], v20 offset:10240
  v_mfma_f32_16x16x32_bf16 v[184:187], a[0:3], a[164:167], v[184:187]
  ds_read_b64_tr_b16 a[176:177], v20 offset:12288
  v_mfma_f32_16x16x32_bf16 v[184:187], a[36:39], a[188:191], v[184:187]
  v_mfma_f32_16x16x32_bf16 v[188:191], a[4:7], a[164:167], v[188:191]
  ds_read_b64_tr_b16 a[178:179], v20 offset:14336
  v_mfma_f32_16x16x32_bf16 v[188:191], a[40:43], a[188:191], v[188:191]
  ds_read_b128 a[104:107], v18 offset:0
  v_mfma_f32_16x16x32_bf16 v[192:195], a[8:11], a[164:167], v[192:195]
  ds_read_b128 a[140:143], v19 offset:0
  v_mfma_f32_16x16x32_bf16 v[192:195], a[44:47], a[188:191], v[192:195]
  v_mfma_f32_16x16x32_bf16 v[196:199], a[12:15], a[164:167], v[196:199]
  v_mfma_f32_16x16x32_bf16 v[196:199], a[48:51], a[188:191], v[196:199]
  v_mfma_f32_16x16x32_bf16 v[200:203], a[16:19], a[164:167], v[200:203]
  v_mfma_f32_16x16x32_bf16 v[200:203], a[52:55], a[188:191], v[200:203]
  v_mfma_f32_16x16x32_bf16 v[204:207], a[20:23], a[164:167], v[204:207]
  v_mfma_f32_16x16x32_bf16 v[204:207], a[56:59], a[188:191], v[204:207]
  v_mfma_f32_16x16x32_bf16 v[208:211], a[24:27], a[164:167], v[208:211]
  v_mfma_f32_16x16x32_bf16 v[208:211], a[60:63], a[188:191], v[208:211]
  v_mfma_f32_16x16x32_bf16 v[212:215], a[28:31], a[164:167], v[212:215]
  v_mfma_f32_16x16x32_bf16 v[212:215], a[64:67], a[188:191], v[212:215]
  s_waitcnt lgkmcnt(0)
  v_mfma_f32_16x16x32_bf16 v[24:27], a[144:147], a[72:75], v[24:27]
  s_add_u32 m0, s41, 3072
  ds_read_b64_tr_b16 a[156:157], v21 offset:8192
  v_mfma_f32_16x16x32_bf16 v[24:27], a[168:171], a[108:111], v[24:27]
  buffer_load_dwordx4 v236, s[12:15], s47 offen offset:0 lds
  v_mfma_f32_16x16x32_bf16 v[28:31], a[144:147], a[76:79], v[28:31]
  s_add_u32 s36, s36, s38
  v_mfma_f32_16x16x32_bf16 v[28:31], a[168:171], a[112:115], v[28:31]
  s_add_u32 s37, s37, 1
  ds_read_b64_tr_b16 a[158:159], v21 offset:10240
  v_mfma_f32_16x16x32_bf16 v[32:35], a[144:147], a[80:83], v[32:35]
  s_cmp_eq_u32 s37, 3
  s_cselect_b32 s37, 0, s37
  s_cselect_b32 s38, s39, s40
  v_mfma_f32_16x16x32_bf16 v[32:35], a[168:171], a[116:119], v[32:35]
  s_add_u32 s41, s41, s43
  v_mfma_f32_16x16x32_bf16 v[36:39], a[144:147], a[84:87], v[36:39]
  s_sub_u32 s43, 0, s43
  ds_read_b64_tr_b16 a[180:181], v21 offset:12288
  v_mfma_f32_16x16x32_bf16 v[36:39], a[168:171], a[120:123], v[36:39]
  v_mfma_f32_16x16x32_bf16 v[40:43], a[144:147], a[88:91], v[40:43]
  v_mfma_f32_16x16x32_bf16 v[40:43], a[168:171], a[124:127], v[40:43]
  v_mfma_f32_16x16x32_bf16 v[44:47], a[144:147], a[92:95], v[44:47]
  ds_read_b64_tr_b16 a[182:183], v21 offset:14336
  v_mfma_f32_16x16x32_bf16 v[44:47], a[168:171], a[128:131], v[44:47]
  v_mfma_f32_16x16x32_bf16 v[48:51], a[144:147], a[96:99], v[48:51]
  v_mfma_f32_16x16x32_bf16 v[48:51], a[168:171], a[132:135], v[48:51]
  ds_read_b64_tr_b16 a[160:161], v20 offset:16384
  v_mfma_f32_16x16x32_bf16 v[52:55], a[144:147], a[100:103], v[52:55]
  buffer_load_dwordx4 v237, s[12:15], s47 offen offset:1024 lds
  v_mfma_f32_16x16x32_bf16 v[52:55], a[168:171], a[136:139], v[52:55]
  v_mfma_f32_16x16x32_bf16 v[56:59], a[148:151], a[72:75], v[56:59]
  ds_read_b64_tr_b16 a[162:163], v20 offset:18432
  v_mfma_f32_16x16x32_bf16 v[56:59], a[172:175], a[108:111], v[56:59]
  v_mfma_f32_16x16x32_bf16 v[60:63], a[148:151], a[76:79], v[60:63]
  v_mfma_f32_16x16x32_bf16 v[60:63], a[172:175], a[112:115], v[60:63]
  v_mfma_f32_16x16x32_bf16 v[64:67], a[148:151], a[80:83], v[64:67]
  ds_read_b64_tr_b16 a[184:185], v20 offset:20480
  v_mfma_f32_16x16x32_bf16 v[64:67], a[172:175], a[116:119], v[64:67]
  v_mfma_f32_16x16x32_bf16 v[68:71], a[148:151], a[84:87], v[68:71]
  v_mfma_f32_16x16x32_bf16 v[68:71], a[172:175], a[120:123], v[68:71]
  ds_read_b64_tr_b16 a[186:187], v20 offset:22528
  v_mfma_f32_16x16x32_bf16 v[72:75], a[148:151], a[88:91], v[72:75]
  v_mfma_f32_16x16x32_bf16 v[72:75], a[172:175], a[124:127], v[72:75]
  v_mfma_f32_16x16x32_bf16 v[76:79], a[148:151], a[92:95], v[76:79]
  ds_read_b64_tr_b16 a[164:165], v21 offset:16384
  v_mfma_f32_16x16x32_bf16 v[76:79], a[172:175], a[128:131], v[76:79]
  v_mfma_f32_16x16x32_bf16 v[80:83], a[148:151], a[96:99], v[80:83]
  buffer_load_dwordx4 v238, s[12:15], s47 offen offset:2048 lds
  v_mfma_f32_16x16x32_bf16 v[80:83], a[172:175], a[132:135], v[80:83]
  v_mfma_f32_16x16x32_bf16 v[84:87], a[148:151], a[100:103], v[84:87]
  ds_read_b64_tr_b16 a[166:167], v21 offset:18432
  v_mfma_f32_16x16x32_bf16 v[84:87], a[172:175], a[136:139], v[84:87]
  v_mfma_f32_16x16x32_bf16 v[88:91], a[152:155], a[72:75], v[88:91]
  v_mfma_f32_16x16x32_bf16 v[88:91], a[176:179], a[108:111], v[88:91]
  ds_read_b64_tr_b16 a[188:189], v21 offset:20480
  v_mfma_f32_16x16x32_bf16 v[92:95], a[152:155], a[76:79], v[92:95]
  v_mfma_f32_16x16x32_bf16 v[92:95], a[176:179], a[112:115], v[92:95]
  v_mfma_f32_16x16x32_bf16 v[96:99], a[152:155], a[80:83], v[96:99]
  ds_read_b64_tr_b16 a[190:191], v21 offset:22528
  v_mfma_f32_16x16x32_bf16 v[96:99], a[176:179], a[116:119], v[96:99]
  v_add_u32 v16, s38, v16
  v_add_u32 v17, s38, v17
  v_mfma_f32_16x16x32_bf16 v[100:103], a[152:155], a[84:87], v[100:103]
  v_add_u32 v18, s38, v18
  v_add_u32 v19, s38, v19
  v_mfma_f32_16x16x32_bf16 v[100:103], a[176:179], a[120:123], v[100:103]
  v_add_u32 v20, s43, v20
  v_add_u32 v21, s43, v21
  v_mfma_f32_16x16x32_bf16 v[104:107], a[152:155], a[88:91], v[104:107]
  v_mfma_f32_16x16x32_bf16 v[104:107], a[176:179], a[124:127], v[104:107]
  v_mfma_f32_16x16x32_bf16 v[108:111], a[152:155], a[92:95], v[108:111]
  v_mfma_f32_16x16x32_bf16 v[108:111], a[176:179], a[128:131], v[108:111]
  v_mfma_f32_16x16x32_bf16 v[112:115], a[152:155], a[96:99], v[112:115]
  v_mfma_f32_16x16x32_bf16 v[112:115], a[176:179], a[132:135], v[112:115]
  v_mfma_f32_16x16x32_bf16 v[116:119], a[152:155], a[100:103], v[116:119]
  v_mfma_f32_16x16x32_bf16 v[116:119], a[176:179], a[136:139], v[116:119]
  v_mfma_f32_16x16x32_bf16 v[216:219], a[152:155], a[104:107], v[216:219]
  v_mfma_f32_16x16x32_bf16 v[216:219], a[176:179], a[140:143], v[216:219]
  s_waitcnt vmcnt(0) lgkmcnt(0)
  s_barrier
  s_mov_b32 s6, 0x3e8293ee
  s_mov_b32 s7, s6
  v_mfma_f32_16x16x32_bf16 v[120:123], a[156:159], a[72:75], v[120:123]
  ds_read_b128 a[0:3], v16 offset:0
  v_mfma_f32_16x16x32_bf16 v[120:123], a[180:183], a[108:111], v[120:123]
  ds_read_b128 a[36:39], v17 offset:0
  v_mfma_f32_16x16x32_bf16 v[124:127], a[156:159], a[76:79], v[124:127]
  ds_read_b64_tr_b16 a[144:145], v20 offset:0
  v_mfma_f32_16x16x32_bf16 v[124:127], a[180:183], a[112:115], v[124:127]
  v_mfma_f32_16x16x32_bf16 v[128:131], a[156:159], a[80:83], v[128:131]
  ds_read_b64_tr_b16 a[146:147], v20 offset:2048
  v_mfma_f32_16x16x32_bf16 v[128:131], a[180:183], a[116:119], v[128:131]
  ds_read_b64_tr_b16 a[168:169], v20 offset:4096
  v_mfma_f32_16x16x32_bf16 v[132:135], a[156:159], a[84:87], v[132:135]
  ds_read_b64_tr_b16 a[170:171], v20 offset:6144
  v_mfma_f32_16x16x32_bf16 v[132:135], a[180:183], a[120:123], v[132:135]
  v_mfma_f32_16x16x32_bf16 v[136:139], a[156:159], a[88:91], v[136:139]
  ds_read_b128 a[4:7], v16 offset:2048
  v_mfma_f32_16x16x32_bf16 v[136:139], a[180:183], a[124:127], v[136:139]
  ds_read_b128 a[40:43], v17 offset:2048
  v_mfma_f32_16x16x32_bf16 v[140:143], a[156:159], a[92:95], v[140:143]
  ds_read_b128 a[8:11], v16 offset:4096
  v_mfma_f32_16x16x32_bf16 v[140:143], a[180:183], a[128:131], v[140:143]
  v_mfma_f32_16x16x32_bf16 v[144:147], a[156:159], a[96:99], v[144:147]
  ds_read_b128 a[44:47], v17 offset:4096
  v_mfma_f32_16x16x32_bf16 v[144:147], a[180:183], a[132:135], v[144:147]
  ds_read_b128 a[12:15], v16 offset:6144
  v_mfma_f32_16x16x32_bf16 v[148:151], a[156:159], a[100:103], v[148:151]
  ds_read_b128 a[48:51], v17 offset:6144
  v_mfma_f32_16x16x32_bf16 v[148:151], a[180:183], a[136:139], v[148:151]
  v_mfma_f32_16x16x32_bf16 v[220:223], a[156:159], a[104:107], v[220:223]
  ds_read_b128 a[16:19], v16 offset:8192
  v_mfma_f32_16x16x32_bf16 v[220:223], a[180:183], a[140:143], v[220:223]
  ds_read_b128 a[52:55], v17 offset:8192
  v_mfma_f32_16x16x32_bf16 v[152:155], a[72:75], a[160:163], v[152:155]
  ds_read_b128 a[20:23], v16 offset:10240
  v_mfma_f32_16x16x32_bf16 v[152:155], a[108:111], a[184:187], v[152:155]
  v_mfma_f32_16x16x32_bf16 v[156:159], a[76:79], a[160:163], v[156:159]
  ds_read_b128 a[56:59], v17 offset:10240
  v_mfma_f32_16x16x32_bf16 v[156:159], a[112:115], a[184:187], v[156:159]
  ds_read_b128 a[24:27], v16 offset:12288
  v_mfma_f32_16x16x32_bf16 v[160:163], a[80:83], a[160:163], v[160:163]
  ds_read_b128 a[60:63], v17 offset:12288
  v_mfma_f32_16x16x32_bf16 v[160:163], a[116:119], a[184:187], v[160:163]
  v_mfma_f32_16x16x32_bf16 v[164:167], a[84:87], a[160:163], v[164:167]
  ds_read_b128 a[28:31], v16 offset:14336
  v_mfma_f32_16x16x32_bf16 v[164:167], a[120:123], a[184:187], v[164:167]
  ds_read_b128 a[64:67], v17 offset:14336
  v_mfma_f32_16x16x32_bf16 v[168:171], a[88:91], a[160:163], v[168:171]
  ds_read_b64_tr_b16 a[148:149], v21 offset:0
  v_mfma_f32_16x16x32_bf16 v[168:171], a[124:127], a[184:187], v[168:171]
  v_mfma_f32_16x16x32_bf16 v[172:175], a[92:95], a[160:163], v[172:175]
  ds_read_b64_tr_b16 a[150:151], v21 offset:2048
  v_mfma_f32_16x16x32_bf16 v[172:175], a[128:131], a[184:187], v[172:175]
  ds_read_b64_tr_b16 a[172:173], v21 offset:4096
  v_mfma_f32_16x16x32_bf16 v[176:179], a[96:99], a[160:163], v[176:179]
  ds_read_b64_tr_b16 a[174:175], v21 offset:6144
  v_mfma_f32_16x16x32_bf16 v[176:179], a[132:135], a[184:187], v[176:179]
  v_mfma_f32_16x16x32_bf16 v[180:183], a[100:103], a[160:163], v[180:183]
  ds_read_b64_tr_b16 a[152:153], v20 offset:8192
  v_mfma_f32_16x16x32_bf16 v[180:183], a[136:139], a[184:187], v[180:183]
  ds_read_b64_tr_b16 a[154:155], v20 offset:10240
  v_mfma_f32_16x16x32_bf16 v[184:187], a[72:75], a[164:167], v[184:187]
  ds_read_b64_tr_b16 a[176:177], v20 offset:12288
  v_mfma_f32_16x16x32_bf16 v[184:187], a[108:111], a[188:191], v[184:187]
  v_mfma_f32_16x16x32_bf16 v[188:191], a[76:79], a[164:167], v[188:191]
  ds_read_b64_tr_b16 a[178:179], v20 offset:14336
  v_mfma_f32_16x16x32_bf16 v[188:191], a[112:115], a[188:191], v[188:191]
  ds_read_b128 a[32:35], v18 offset:0
  v_mfma_f32_16x16x32_bf16 v[192:195], a[80:83], a[164:167], v[192:195]
  ds_read_b128 a[68:71], v19 offset:0
  v_mfma_f32_16x16x32_bf16 v[192:195], a[116:119], a[188:191], v[192:195]
  v_mfma_f32_16x16x32_bf16 v[196:199], a[84:87], a[164:167], v[196:199]
  v_mfma_f32_16x16x32_bf16 v[196:199], a[120:123], a[188:191], v[196:199]
  v_mfma_f32_16x16x32_bf16 v[200:203], a[88:91], a[164:167], v[200:203]
  v_mfma_f32_16x16x32_bf16 v[200:203], a[124:127], a[188:191], v[200:203]
  v_mfma_f32_16x16x32_bf16 v[204:207], a[92:95], a[164:167], v[204:207]
  v_mfma_f32_16x16x32_bf16 v[204:207], a[128:131], a[188:191], v[204:207]
  v_mfma_f32_16x16x32_bf16 v[208:211], a[96:99], a[164:167], v[208:211]
  v_mfma_f32_16x16x32_bf16 v[208:211], a[132:135], a[188:191], v[208:211]
  v_mfma_f32_16x16x32_bf16 v[212:215], a[100:103], a[164:167], v[212:215]
  v_mfma_f32_16x16x32_bf16 v[212:215], a[136:139], a[188:191], v[212:215]
  s_waitcnt lgkmcnt(0)
  v_mfma_f32_16x16x32_bf16 v[24:27], a[144:147], a[0:3], v[24:27]
  ds_read_b64_tr_b16 a[156:157], v21 offset:8192
  ds_read_b64_tr_b16 a[158:159], v21 offset:10240
  v_mfma_f32_16x16x32_bf16 v[24:27], a[168:171], a[36:39], v[24:27]
  ds_read_b64_tr_b16 a[180:181], v21 offset:12288
  ds_read_b64_tr_b16 a[182:183], v21 offset:14336
  v_mfma_f32_16x16x32_bf16 v[28:31], a[144:147], a[4:7], v[28:31]
  ds_read_b64_tr_b16 a[160:161], v20 offset:16384
  ds_read_b64_tr_b16 a[162:163], v20 offset:18432
  v_mfma_f32_16x16x32_bf16 v[28:31], a[168:171], a[40:43], v[28:31]
  ds_read_b64_tr_b16 a[184:185], v20 offset:20480
  v_mfma_f32_16x16x32_bf16 v[32:35], a[144:147], a[8:11], v[32:35]
  ds_read_b64_tr_b16 a[186:187], v20 offset:22528
  ds_read_b64_tr_b16 a[164:165], v21 offset:16384
  v_mfma_f32_16x16x32_bf16 v[32:35], a[168:171], a[44:47], v[32:35]
  ds_read_b64_tr_b16 a[166:167], v21 offset:18432
  ds_read_b64_tr_b16 a[188:189], v21 offset:20480
  v_mfma_f32_16x16x32_bf16 v[36:39], a[144:147], a[12:15], v[36:39]
  ds_read_b64_tr_b16 a[190:191], v21 offset:22528
  v_mfma_f32_16x16x32_bf16 v[36:39], a[168:171], a[48:51], v[36:39]
  v_mfma_f32_16x16x32_bf16 v[40:43], a[144:147], a[16:19], v[40:43]
  v_mfma_f32_16x16x32_bf16 v[40:43], a[168:171], a[52:55], v[40:43]
  v_mfma_f32_16x16x32_bf16 v[44:47], a[144:147], a[20:23], v[44:47]
  v_mfma_f32_16x16x32_bf16 v[44:47], a[168:171], a[56:59], v[44:47]
  v_mfma_f32_16x16x32_bf16 v[48:51], a[144:147], a[24:27], v[48:51]
  v_mfma_f32_16x16x32_bf16 v[48:51], a[168:171], a[60:63], v[48:51]
  v_mfma_f32_16x16x32_bf16 v[52:55], a[144:147], a[28:31], v[52:55]
  v_mfma_f32_16x16x32_bf16 v[52:55], a[168:171], a[64:67], v[52:55]
  v_mfma_f32_16x16x32_bf16 v[56:59], a[148:151], a[0:3], v[56:59]
  v_mfma_f32_16x16x32_bf16 v[56:59], a[172:175], a[36:39], v[56:59]
  v_mfma_f32_16x16x32_bf16 v[60:63], a[148:151], a[4:7], v[60:63]
  v_mfma_f32_16x16x32_bf16 v[60:63], a[172:175], a[40:43], v[60:63]
  v_mfma_f32_16x16x32_bf16 v[64:67], a[148:151], a[8:11], v[64:67]
  v_mfma_f32_16x16x32_bf16 v[64:67], a[172:175], a[44:47], v[64:67]
  v_mfma_f32_16x16x32_bf16 v[68:71], a[148:151], a[12:15], v[68:71]
  v_pk_mul_f32 v[24:25], v[24:25], s[6:7]
  v_pk_mul_f32 v[26:27], v[26:27], s[6:7]
  v_mfma_f32_16x16x32_bf16 v[68:71], a[172:175], a[48:51], v[68:71]
  v_pk_mul_f32 v[56:57], v[56:57], s[6:7]
  v_pk_mul_f32 v[58:59], v[58:59], s[6:7]
  v_mfma_f32_16x16x32_bf16 v[72:75], a[148:151], a[16:19], v[72:75]
  v_cvt_pk_bf16_f32 v24, v24, v25
  v_cvt_pk_bf16_f32 v25, v26, v27
  v_mfma_f32_16x16x32_bf16 v[72:75], a[172:175], a[52:55], v[72:75]
  v_cvt_pk_bf16_f32 v26, v56, v57
  v_cvt_pk_bf16_f32 v27, v58, v59
  v_mfma_f32_16x16x32_bf16 v[76:79], a[148:151], a[20:23], v[76:79]
  v_pk_mul_f32 v[28:29], v[28:29], s[6:7]
  v_pk_mul_f32 v[30:31], v[30:31], s[6:7]
  v_mfma_f32_16x16x32_bf16 v[76:79], a[172:175], a[56:59], v[76:79]
  v_pk_mul_f32 v[60:61], v[60:61], s[6:7]
  v_pk_mul_f32 v[62:63], v[62:63], s[6:7]
  v_mfma_f32_16x16x32_bf16 v[80:83], a[148:151], a[24:27], v[80:83]
  v_cvt_pk_bf16_f32 v28, v28, v29
  v_cvt_pk_bf16_f32 v29, v30, v31
  v_mfma_f32_16x16x32_bf16 v[80:83], a[172:175], a[60:63], v[80:83]
  v_cvt_pk_bf16_f32 v30, v60, v61
  v_cvt_pk_bf16_f32 v31, v62, v63
  v_mfma_f32_16x16x32_bf16 v[84:87], a[148:151], a[28:31], v[84:87]
  v_pk_mul_f32 v[32:33], v[32:33], s[6:7]
  v_pk_mul_f32 v[34:35], v[34:35], s[6:7]
  v_mfma_f32_16x16x32_bf16 v[84:87], a[172:175], a[64:67], v[84:87]
  v_pk_mul_f32 v[64:65], v[64:65], s[6:7]
  v_pk_mul_f32 v[66:67], v[66:67], s[6:7]
  v_mfma_f32_16x16x32_bf16 v[88:91], a[152:155], a[0:3], v[88:91]
  v_cvt_pk_bf16_f32 v32, v32, v33
  v_cvt_pk_bf16_f32 v33, v34, v35
  v_mfma_f32_16x16x32_bf16 v[88:91], a[176:179], a[36:39], v[88:91]
  v_cvt_pk_bf16_f32 v34, v64, v65
  v_cvt_pk_bf16_f32 v35, v66, v67
  v_mfma_f32_16x16x32_bf16 v[92:95], a[152:155], a[4:7], v[92:95]
  v_pk_mul_f32 v[36:37], v[36:37], s[6:7]
  v_pk_mul_f32 v[38:39], v[38:39], s[6:7]
  v_mfma_f32_16x16x32_bf16 v[92:95], a[176:179], a[40:43], v[92:95]
  v_pk_mul_f32 v[68:69], v[68:69], s[6:7]
  v_pk_mul_f32 v[70:71], v[70:71], s[6:7]
  v_mfma_f32_16x16x32_bf16 v[96:99], a[152:155], a[8:11], v[96:99]
  v_cvt_pk_bf16_f32 v36, v36, v37
  v_cvt_pk_bf16_f32 v37, v38, v39
  v_mfma_f32_16x16x32_bf16 v[96:99], a[176:179], a[44:47], v[96:99]
  v_cvt_pk_bf16_f32 v38, v68, v69
  v_cvt_pk_bf16_f32 v39, v70, v71
  v_mfma_f32_16x16x32_bf16 v[100:103], a[152:155], a[12:15], v[100:103]
  v_pk_mul_f32 v[40:41], v[40:41], s[6:7]
  v_pk_mul_f32 v[42:43], v[42:43], s[6:7]
  v_mfma_f32_16x16x32_bf16 v[100:103], a[176:179], a[48:51], v[100:103]
  v_pk_mul_f32 v[72:73], v[72:73], s[6:7]
  v_pk_mul_f32 v[74:75], v[74:75], s[6:7]
  v_mfma_f32_16x16x32_bf16 v[104:107], a[152:155], a[16:19], v[104:107]
  v_cvt_pk_bf16_f32 v40, v40, v41
  v_cvt_pk_bf16_f32 v41, v42, v43
  v_mfma_f32_16x16x32_bf16 v[104:107], a[176:179], a[52:55], v[104:107]
  v_cvt_pk_bf16_f32 v42, v72, v73
  v_cvt_pk_bf16_f32 v43, v74, v75
  v_mfma_f32_16x16x32_bf16 v[108:111], a[152:155], a[20:23], v[108:111]
  v_pk_mul_f32 v[44:45], v[44:45], s[6:7]
  v_pk_mul_f32 v[46:47], v[46:47], s[6:7]
  v_mfma_f32_16x16x32_bf16 v[108:111], a[176:179], a[56:59], v[108:111]
  v_pk_mul_f32 v[76:77], v[76:77], s[6:7]
  v_pk_mul_f32 v[78:79], v[78:79], s[6:7]
  v_mfma_f32_16x16x32_bf16 v[112:115], a[152:155], a[24:27], v[112:115]
  v_cvt_pk_bf16_f32 v44, v44, v45
  v_cvt_pk_bf16_f32 v45, v46, v47
  v_mfma_f32_16x16x32_bf16 v[112:115], a[176:179], a[60:63], v[112:115]
  v_cvt_pk_bf16_f32 v46, v76, v77
  v_cvt_pk_bf16_f32 v47, v78, v79
  v_mfma_f32_16x16x32_bf16 v[116:119], a[152:155], a[28:31], v[116:119]
  v_pk_mul_f32 v[48:49], v[48:49], s[6:7]
  v_pk_mul_f32 v[50:51], v[50:51], s[6:7]
  v_mfma_f32_16x16x32_bf16 v[116:119], a[176:179], a[64:67], v[116:119]
  v_pk_mul_f32 v[80:81], v[80:81], s[6:7]
  v_pk_mul_f32 v[82:83], v[82:83], s[6:7]
  v_mfma_f32_16x16x32_bf16 v[216:219], a[152:155], a[32:35], v[216:219]
  v_cvt_pk_bf16_f32 v48, v48, v49
  v_cvt_pk_bf16_f32 v49, v50, v51
  v_mfma_f32_16x16x32_bf16 v[216:219], a[176:179], a[68:71], v[216:219]
  v_cvt_pk_bf16_f32 v50, v80, v81
  v_cvt_pk_bf16_f32 v51, v82, v83
  s_waitcnt lgkmcnt(0)
  s_barrier
  s_mov_b32 s12, s84
  s_mov_b32 s13, s85
  s_mov_b32 s14, 256
  s_mov_b32 s15, 0x00020000
  buffer_load_dwordx2 v[22:23], off, s[12:15], 0 sc1
  v_mfma_f32_16x16x32_bf16 v[120:123], a[156:159], a[0:3], v[120:123]
  s_mov_b32 m0, s68
  v_pk_mul_f32 v[52:53], v[52:53], s[6:7]
  v_pk_mul_f32 v[54:55], v[54:55], s[6:7]
  v_mfma_f32_16x16x32_bf16 v[120:123], a[180:183], a[36:39], v[120:123]
  buffer_load_dwordx4 v8, s[20:23], s28 offen offset:0 lds
  v_pk_mul_f32 v[84:85], v[84:85], s[6:7]
  v_mfma_f32_16x16x32_bf16 v[124:127], a[156:159], a[4:7], v[124:127]
  v_pk_mul_f32 v[86:87], v[86:87], s[6:7]
  v_cvt_pk_bf16_f32 v52, v52, v53
  v_mfma_f32_16x16x32_bf16 v[124:127], a[180:183], a[40:43], v[124:127]
  buffer_load_dwordx4 v9, s[20:23], s28 offen offset:1024 lds
  v_cvt_pk_bf16_f32 v53, v54, v55
  v_mfma_f32_16x16x32_bf16 v[128:131], a[156:159], a[8:11], v[128:131]
  v_cvt_pk_bf16_f32 v54, v84, v85
  v_cvt_pk_bf16_f32 v55, v86, v87
  v_mfma_f32_16x16x32_bf16 v[128:131], a[180:183], a[44:47], v[128:131]
  v_mfma_f32_16x16x32_bf16 v[132:135], a[156:159], a[12:15], v[132:135]
  buffer_load_dwordx4 v10, s[20:23], s28 offen offset:2048 lds
  v_mfma_f32_16x16x32_bf16 v[132:135], a[180:183], a[48:51], v[132:135]
  v_mfma_f32_16x16x32_bf16 v[136:139], a[156:159], a[16:19], v[136:139]
  v_mfma_f32_16x16x32_bf16 v[136:139], a[180:183], a[52:55], v[136:139]
  buffer_load_dwordx4 v11, s[20:23], s28 offen offset:3072 lds
  v_mfma_f32_16x16x32_bf16 v[140:143], a[156:159], a[20:23], v[140:143]
  s_bfe_u32 s56, 0x302010e, s55
  s_add_u32 s54, s54, s56
  s_add_u32 s55, s55, 8
  v_mfma_f32_16x16x32_bf16 v[140:143], a[180:183], a[56:59], v[140:143]
  s_and_b32 s55, s55, 0x8001f
  s_and_b32 s54, s54, 15
  s_lshl_b32 s28, s54, 19
  v_mfma_f32_16x16x32_bf16 v[144:147], a[156:159], a[24:27], v[144:147]
  s_add_u32 m0, s68, 16384
  v_mfma_f32_16x16x32_bf16 v[144:147], a[180:183], a[60:63], v[144:147]
  buffer_load_dwordx4 v8, s[20:23], s28 offen offset:0 lds
  v_mfma_f32_16x16x32_bf16 v[148:151], a[156:159], a[28:31], v[148:151]
  v_mfma_f32_16x16x32_bf16 v[148:151], a[180:183], a[64:67], v[148:151]
  buffer_load_dwordx4 v9, s[20:23], s28 offen offset:1024 lds
  v_mfma_f32_16x16x32_bf16 v[220:223], a[156:159], a[32:35], v[220:223]
  v_mfma_f32_16x16x32_bf16 v[220:223], a[180:183], a[68:71], v[220:223]
  v_mfma_f32_16x16x32_bf16 v[152:155], a[0:3], a[160:163], v[152:155]
  buffer_load_dwordx4 v10, s[20:23], s28 offen offset:2048 lds
  v_mfma_f32_16x16x32_bf16 v[152:155], a[36:39], a[184:187], v[152:155]
  v_mfma_f32_16x16x32_bf16 v[156:159], a[4:7], a[160:163], v[156:159]
  v_mfma_f32_16x16x32_bf16 v[156:159], a[40:43], a[184:187], v[156:159]
  buffer_load_dwordx4 v11, s[20:23], s28 offen offset:3072 lds
  v_mfma_f32_16x16x32_bf16 v[160:163], a[8:11], a[160:163], v[160:163]
  s_bfe_u32 s56, 0x302010e, s55
  s_add_u32 s54, s54, s56
  s_add_u32 s55, s55, 8
  v_mfma_f32_16x16x32_bf16 v[160:163], a[44:47], a[184:187], v[160:163]
  s_and_b32 s55, s55, 0x8001f
  s_and_b32 s54, s54, 15
  s_lshl_b32 s28, s54, 19
  v_mfma_f32_16x16x32_bf16 v[164:167], a[12:15], a[160:163], v[164:167]
  s_mov_b32 m0, s88
  v_cvt_pk_bf16_f32 v216, v216, v217
  v_cvt_pk_bf16_f32 v217, v218, v219
  v_mfma_f32_16x16x32_bf16 v[164:167], a[48:51], a[184:187], v[164:167]
  buffer_load_dwordx4 v4, s[8:11], s26 offen offset:0 lds
  v_cvt_pk_bf16_f32 v218, v220, v221
  v_mfma_f32_16x16x32_bf16 v[168:171], a[16:19], a[160:163], v[168:171]
  v_cvt_pk_bf16_f32 v219, v222, v223
  v_mfma_f32_16x16x32_bf16 v[168:171], a[52:55], a[184:187], v[168:171]
  buffer_load_dwordx4 v5, s[8:11], s26 offen offset:1024 lds
  ds_write_b128 v252, v[216:219]
  v_mfma_f32_16x16x32_bf16 v[172:175], a[20:23], a[160:163], v[172:175]
  v_cvt_pk_bf16_f32 v88, v88, v89
  v_cvt_pk_bf16_f32 v89, v90, v91
  v_mfma_f32_16x16x32_bf16 v[172:175], a[56:59], a[184:187], v[172:175]
  v_cvt_pk_bf16_f32 v90, v120, v121
  v_cvt_pk_bf16_f32 v91, v122, v123
  v_mfma_f32_16x16x32_bf16 v[176:179], a[24:27], a[160:163], v[176:179]
  buffer_load_dwordx4 v6, s[8:11], s26 offen offset:2048 lds
  v_cvt_pk_bf16_f32 v92, v92, v93
  v_mfma_f32_16x16x32_bf16 v[176:179], a[60:63], a[184:187], v[176:179]
  v_cvt_pk_bf16_f32 v93, v94, v95
  v_cvt_pk_bf16_f32 v94, v124, v125
  v_mfma_f32_16x16x32_bf16 v[180:183], a[28:31], a[160:163], v[180:183]
  v_cvt_pk_bf16_f32 v95, v126, v127
  v_cvt_pk_bf16_f32 v96, v96, v97
  v_mfma_f32_16x16x32_bf16 v[180:183], a[64:67], a[184:187], v[180:183]
  buffer_load_dwordx4 v7, s[8:11], s26 offen offset:3072 lds
  v_cvt_pk_bf16_f32 v97, v98, v99
  v_mfma_f32_16x16x32_bf16 v[184:187], a[0:3], a[164:167], v[184:187]
  s_add_u32 m0, s88, 4096
  v_cvt_pk_bf16_f32 v98, v128, v129
  v_cvt_pk_bf16_f32 v99, v130, v131
  v_mfma_f32_16x16x32_bf16 v[184:187], a[36:39], a[188:191], v[184:187]
  v_cvt_pk_bf16_f32 v100, v100, v101
  v_cvt_pk_bf16_f32 v101, v102, v103
  v_mfma_f32_16x16x32_bf16 v[188:191], a[4:7], a[164:167], v[188:191]
  buffer_load_dwordx4 v4, s[8:11], s27 offen offset:0 lds
  v_cvt_pk_bf16_f32 v102, v132, v133
  v_mfma_f32_16x16x32_bf16 v[188:191], a[40:43], a[188:191], v[188:191]
  v_cvt_pk_bf16_f32 v103, v134, v135
  v_cvt_pk_bf16_f32 v104, v104, v105
  v_mfma_f32_16x16x32_bf16 v[192:195], a[8:11], a[164:167], v[192:195]
  v_cvt_pk_bf16_f32 v105, v106, v107
  v_cvt_pk_bf16_f32 v106, v136, v137
  v_mfma_f32_16x16x32_bf16 v[192:195], a[44:47], a[188:191], v[192:195]
  buffer_load_dwordx4 v5, s[8:11], s27 offen offset:1024 lds
  v_cvt_pk_bf16_f32 v107, v138, v139
  v_mfma_f32_16x16x32_bf16 v[196:199], a[12:15], a[164:167], v[196:199]
  v_cvt_pk_bf16_f32 v108, v108, v109
  v_cvt_pk_bf16_f32 v109, v110, v111
  v_mfma_f32_16x16x32_bf16 v[196:199], a[48:51], a[188:191], v[196:199]
  v_cvt_pk_bf16_f32 v110, v140, v141
  v_cvt_pk_bf16_f32 v111, v142, v143
  v_mfma_f32_16x16x32_bf16 v[200:203], a[16:19], a[164:167], v[200:203]
  buffer_load_dwordx4 v6, s[8:11], s27 offen offset:2048 lds
  v_cvt_pk_bf16_f32 v112, v112, v113
  v_mfma_f32_16x16x32_bf16 v[200:203], a[52:55], a[188:191], v[200:203]
  v_cvt_pk_bf16_f32 v113, v114, v115
  v_cvt_pk_bf16_f32 v114, v144, v145
  v_mfma_f32_16x16x32_bf16 v[204:207], a[20:23], a[164:167], v[204:207]
  v_cvt_pk_bf16_f32 v115, v146, v147
  v_cvt_pk_bf16_f32 v116, v116, v117
  v_mfma_f32_16x16x32_bf16 v[204:207], a[56:59], a[188:191], v[204:207]
  buffer_load_dwordx4 v7, s[8:11], s27 offen offset:3072 lds
  v_cvt_pk_bf16_f32 v117, v118, v119
  v_mfma_f32_16x16x32_bf16 v[208:211], a[24:27], a[164:167], v[208:211]
  s_bfe_u32 s29, 0x302010e, s53
  s_add_u32 s52, s52, s29
  s_add_u32 s53, s53, 8
  v_mfma_f32_16x16x32_bf16 v[208:211], a[60:63], a[188:191], v[208:211]
  s_and_b32 s53, s53, 0x8001f
  s_and_b32 s52, s52, 15
  s_lshl_b32 s29, s52, 7
  v_mfma_f32_16x16x32_bf16 v[212:215], a[28:31], a[164:167], v[212:215]
  s_or_b32 s26, s30, s29
  s_or_b32 s27, s31, s29
  v_cvt_pk_bf16_f32 v118, v148, v149
  v_mfma_f32_16x16x32_bf16 v[212:215], a[64:67], a[188:191], v[212:215]
  v_cvt_pk_bf16_f32 v119, v150, v151
  ds_write_b128 v252, v[116:119] offset:2048
  v_cvt_pk_bf16_f32 v72, v180, v181
  v_cvt_pk_bf16_f32 v73, v182, v183
  s_nop 3
  v_cvt_pk_bf16_f32 v136, v212, v213
  v_cvt_pk_bf16_f32 v137, v214, v215
  ds_write_b64 v252, v[72:73] offset:3072
  ds_write_b64 v252, v[136:137] offset:3080
  v_cvt_pk_bf16_f32 v70, v176, v177
  v_cvt_pk_bf16_f32 v71, v178, v179
  v_cvt_pk_bf16_f32 v134, v208, v209
  v_cvt_pk_bf16_f32 v135, v210, v211
  v_cvt_pk_bf16_f32 v68, v172, v173
  v_cvt_pk_bf16_f32 v69, v174, v175
  v_cvt_pk_bf16_f32 v132, v204, v205
  v_cvt_pk_bf16_f32 v133, v206, v207
  v_cvt_pk_bf16_f32 v66, v168, v169
  v_cvt_pk_bf16_f32 v67, v170, v171
  v_cvt_pk_bf16_f32 v130, v200, v201
  v_cvt_pk_bf16_f32 v131, v202, v203
  v_cvt_pk_bf16_f32 v64, v164, v165
  v_cvt_pk_bf16_f32 v65, v166, v167
  v_cvt_pk_bf16_f32 v128, v196, v197
  v_cvt_pk_bf16_f32 v129, v198, v199
  v_cvt_pk_bf16_f32 v62, v160, v161
  v_cvt_pk_bf16_f32 v63, v162, v163
  v_cvt_pk_bf16_f32 v126, v192, v193
  v_cvt_pk_bf16_f32 v127, v194, v195
  v_cvt_pk_bf16_f32 v60, v156, v157
  v_cvt_pk_bf16_f32 v61, v158, v159
  v_cvt_pk_bf16_f32 v124, v188, v189
  v_cvt_pk_bf16_f32 v125, v190, v191
  v_cvt_pk_bf16_f32 v58, v152, v153
  v_cvt_pk_bf16_f32 v59, v154, v155
  v_cvt_pk_bf16_f32 v122, v184, v185
  v_cvt_pk_bf16_f32 v123, v186, v187
  s_waitcnt lgkmcnt(0)
  s_barrier
  s_branch Lp2_at
Lp2_r1:
  s_and_b32 s4, s2, 7
  s_lshl_b32 s4, s4, 4
  s_add_u32 s4, s4, s59
  s_lshl_b32 s4, s4, 2
  s_add_u32 s4, s4, s3
  s_lshl_b32 s51, s4, 13
  s_mov_b32 m0, s36
  s_nop 0
  buffer_load_dwordx4 v224, s[8:11], s46 offen offset:0 lds
  buffer_load_dwordx4 v225, s[8:11], s46 offen offset:1024 lds
  buffer_load_dwordx4 v226, s[8:11], s46 offen offset:2048 lds
  buffer_load_dwordx4 v227, s[8:11], s46 offen offset:3072 lds
  s_add_u32 m0, s36, 4096
  s_nop 0
  buffer_load_dwordx4 v228, s[8:11], s46 offen offset:0 lds
  buffer_load_dwordx4 v229, s[8:11], s46 offen offset:1024 lds
  buffer_load_dwordx4 v230, s[8:11], s46 offen offset:2048 lds
  buffer_load_dwordx4 v231, s[8:11], s46 offen offset:3072 lds
  s_mul_i32 s47, s48, 393216
  s_bfe_u32 s34, 0x302010e, s49
  s_add_u32 s48, s48, s34
  s_add_u32 s49, s49, 8
  s_and_b32 s49, s49, 0x8001f
  s_and_b32 s48, s48, 15
  s_lshl_b32 s46, s48, 7
  s_mov_b32 m0, s41
  s_nop 0
  buffer_load_dwordx4 v233, s[12:15], s47 offen offset:0 lds
  buffer_load_dwordx4 v234, s[12:15], s47 offen offset:1024 lds
  buffer_load_dwordx4 v235, s[12:15], s47 offen offset:2048 lds
  s_add_u32 m0, s41, 3072
  s_nop 0
  buffer_load_dwordx4 v236, s[12:15], s47 offen offset:0 lds
  buffer_load_dwordx4 v237, s[12:15], s47 offen offset:1024 lds
  buffer_load_dwordx4 v238, s[12:15], s47 offen offset:2048 lds
  s_lshr_b32 s4, s3, 1
  s_lshl_b32 s4, s4, 14
  v_and_b32 v240, 15, v1
  v_lshlrev_b32 v240, 7, v240
  v_lshrrev_b32 v241, 4, v1
  v_and_b32 v242, 6, v1
  v_xor_b32 v241, v241, v242
  v_lshl_add_u32 v240, v241, 4, v240
  v_add_u32 v16, s4, v240
  v_xor_b32 v17, 64, v16
  v_and_b32 v240, 15, v1
  v_lshlrev_b32 v240, 7, v240
  v_lshrrev_b32 v241, 4, v1
  v_and_b32 v242, 6, v1
  v_xor_b32 v241, v241, v242
  v_lshl_add_u32 v240, v241, 4, v240
  v_add_u32 v18, 32768, v240
  v_xor_b32 v19, 64, v18
  v_lshrrev_b32 v240, 2, v1
  v_and_b32 v241, 6, v240
  v_lshlrev_b32 v240, 7, v240
  v_and_b32 v242, 1, v1
  v_lshl_add_u32 v240, v242, 3, v240
  v_add_u32 v240, 104448, v240
  v_bfe_u32 v242, v1, 1, 1
  v_xor_b32 v241, v241, v242
  v_xor_b32 v242, 0, v241
  v_lshl_add_u32 v20, v242, 4, v240
  v_xor_b32 v242, 2, v241
  v_lshl_add_u32 v21, v242, 4, v240
  s_and_b32 s4, s3, 1
  s_lshl_b32 s4, s4, 6
  v_xor_b32 v20, s4, v20
  v_xor_b32 v21, s4, v21
  s_and_b32 s24, s2, 7
  s_lshr_b32 s4, s2, 6
  s_lshl_b32 s4, s4, 3
  s_add_u32 s24, s24, s4
  s_lshr_b32 s4, s2, 3
  s_and_b32 s25, s4, 6
  s_xor_b32 s4, s4, s2
  s_bfe_u32 s4, s4, 0x10003
  s_add_u32 s25, s25, s4
  v_accvgpr_write_b32 a244, -1
  v_accvgpr_write_b32 a245, -1
  v_accvgpr_write_b32 a246, -1
  v_accvgpr_write_b32 a247, -1
  v_lshrrev_b32 v24, 3, v1
  v_and_b32 v25, 6, v24
  v_and_b32 v26, 7, v1
  v_xor_b32 v25, v25, v26
  v_lshlrev_b32 v25, 4, v25
  s_and_b32 s4, s3, 1
  s_lshl_b32 s4, s4, 16
  s_lshr_b32 s5, s3, 1
  s_lshl_b32 s5, s5, 7
  s_add_u32 s4, s4, s5
  v_lshl_add_u32 v24, v24, 11, v25
  v_add_u32 v24, s4, v24
  v_add_u32 v25, 0, v24
  v_accvgpr_write_b32 a212, v25
  v_add_u32 v25, 15360, v24
  v_accvgpr_write_b32 a213, v25
  v_add_u32 v25, 30720, v24
  v_accvgpr_write_b32 a214, v25
  v_add_u32 v25, 46080, v24
  v_accvgpr_write_b32 a215, v25
  v_accvgpr_write_b32 a236, 0
  v_mov_b32 v27, 0x3f803f80
  v_accvgpr_write_b32 a208, v27
  v_accvgpr_write_b32 a237, 0
  v_accvgpr_write_b32 a209, v27
  v_accvgpr_write_b32 a238, 0
  v_accvgpr_write_b32 a210, v27
  v_accvgpr_write_b32 a239, 0
  v_accvgpr_write_b32 a211, v27
  v_lshrrev_b32 v24, 3, v1
  v_and_b32 v25, 6, v24
  v_and_b32 v26, 7, v1
  v_xor_b32 v25, v25, v26
  v_lshlrev_b32 v25, 4, v25
  v_lshlrev_b32 v26, 2, v24
  v_add_u32 v26, s3, v26
  v_lshl_add_u32 v26, v26, 11, v25
  v_add_u32 v27, 0, v26
  v_accvgpr_write_b32 a222, v27
  v_add_u32 v27, 64512, v26
  v_accvgpr_write_b32 a223, v27
  v_add_u32 v27, 129024, v26
  v_accvgpr_write_b32 a224, v27
  v_add_u32 v27, 193536, v26
  v_accvgpr_write_b32 a225, v27
  v_lshrrev_b32 v26, 2, v24
  v_and_b32 v27, 3, v24
  v_lshl_add_u32 v26, v26, 3, v27
  s_and_b32 s4, s3, 1
  s_lshl_b32 s4, s4, 18
  s_lshr_b32 s5, s3, 1
  s_lshl_b32 s5, s5, 7
  s_add_u32 s4, s4, s5
  s_lshl_b32 s5, s24, 8
  s_add_u32 s4, s4, s5
  v_lshl_add_u32 v26, v26, 13, v25
  v_add_u32 v26, s4, v26
  v_add_u32 v27, 0, v26
  v_accvgpr_write_b32 a226, v27
  v_add_u32 v27, 130048, v26
  v_accvgpr_write_b32 a227, v27
  v_add_u32 v27, 30720, v26
  v_accvgpr_write_b32 a228, v27
  v_add_u32 v27, 160768, v26
  v_accvgpr_write_b32 a229, v27
  s_lshl_b32 s4, s3, 13
  s_add_u32 s4, s4, 98304
  v_and_b32 v24, 15, v1
  v_lshlrev_b32 v24, 7, v24
  v_lshrrev_b32 v25, 4, v1
  v_and_b32 v26, 6, v1
  v_xor_b32 v25, v25, v26
  v_lshl_add_u32 v24, v25, 4, v24
  v_add_u32 v28, s4, v24
  v_xor_b32 v29, 64, v28
  v_lshrrev_b32 v24, 2, v1
  v_and_b32 v25, 6, v24
  v_lshlrev_b32 v24, 7, v24
  v_and_b32 v26, 1, v1
  v_lshl_add_u32 v24, v26, 3, v24
  v_add_u32 v24, 0, v24
  v_bfe_u32 v26, v1, 1, 1
  v_xor_b32 v25, v25, v26
  v_xor_b32 v26, 0, v25
  v_lshl_add_u32 v30, v26, 4, v24
  v_xor_b32 v26, 2, v25
  v_lshl_add_u32 v31, v26, 4, v24
  v_xor_b32 v26, 4, v25
  v_lshl_add_u32 v32, v26, 4, v24
  v_xor_b32 v26, 6, v25
  v_lshl_add_u32 v33, v26, 4, v24
  v_accvgpr_write_b32 a230, v28
  v_accvgpr_write_b32 a231, v29
  v_accvgpr_write_b32 a232, v30
  v_accvgpr_write_b32 a233, v31
  v_accvgpr_write_b32 a234, v32
  v_accvgpr_write_b32 a235, v33
  v_and_b32 v253, 15, v1
  v_lshrrev_b32 v254, 4, v1
  v_lshlrev_b32 v254, 2, v254
  v_sub_u32 v253, v253, v254
  v_mov_b32 v254, 0xf149f2ca
  s_lshr_b32 s4, s3, 1
  s_or_b32 s4, s4, s32
  s_cselect_b64 s[6:7], 0, -1
  v_subrev_u32 v255, 0, v253
  v_and_b32 v252, 0x80000001, v255
  v_cmp_ne_u32 vcc, 0, v252
  s_nop 1
  v_cndmask_b32 v244, 0, v254, vcc
  v_add_u32 v255, 1, v255
  v_and_b32 v252, 0x80000001, v255
  v_cmp_ne_u32 vcc, 0x80000001, v252
  s_nop 1
  v_cndmask_b32 v240, 0, v254, vcc
  v_cndmask_b32 v248, v240, v254, s[6:7]
  v_subrev_u32 v255, 1, v253
  v_and_b32 v252, 0x80000001, v255
  v_cmp_ne_u32 vcc, 0, v252
  s_nop 1
  v_cndmask_b32 v245, 0, v254, vcc
  v_add_u32 v255, 1, v255
  v_and_b32 v252, 0x80000001, v255
  v_cmp_ne_u32 vcc, 0x80000001, v252
  s_nop 1
  v_cndmask_b32 v241, 0, v254, vcc
  v_cndmask_b32 v249, v241, v254, s[6:7]
  v_subrev_u32 v255, 2, v253
  v_and_b32 v252, 0x80000001, v255
  v_cmp_ne_u32 vcc, 0, v252
  s_nop 1
  v_cndmask_b32 v246, 0, v254, vcc
  v_add_u32 v255, 1, v255
  v_and_b32 v252, 0x80000001, v255
  v_cmp_ne_u32 vcc, 0x80000001, v252
  s_nop 1
  v_cndmask_b32 v242, 0, v254, vcc
  v_cndmask_b32 v250, v242, v254, s[6:7]
  v_subrev_u32 v255, 3, v253
  v_and_b32 v252, 0x80000001, v255
  v_cmp_ne_u32 vcc, 0, v252
  s_nop 1
  v_cndmask_b32 v247, 0, v254, vcc
  v_add_u32 v255, 1, v255
  v_and_b32 v252, 0x80000001, v255
  v_cmp_ne_u32 vcc, 0x80000001, v252
  s_nop 1
  v_cndmask_b32 v243, 0, v254, vcc
  v_cndmask_b32 v251, v243, v254, s[6:7]
  s_and_b32 s4, s3, 1
  s_lshl_b32 s4, s4, 12
  s_add_u32 s4, s4, 49152
  v_add_u32 v252, s4, v2
  s_lshr_b32 s5, s3, 1
  s_lshl_b32 s5, s5, 11
  v_add_u32 v253, s5, v252
  s_add_u32 s16, s86, 83886080
  s_addc_u32 s17, s87, 0
  s_mov_b32 s18, 4194304
  s_mov_b32 s19, 0x00020000
  s_lshl_b32 s57, s32, 19
  s_lshl_b32 s5, s5, 7
  s_add_u32 s57, s57, s5
  s_lshl_b32 s4, s33, 14
  s_add_u32 s57, s57, s4
  s_and_b32 s4, s3, 1
  s_lshl_b32 s4, s4, 13
  s_add_u32 s57, s57, s4
  s_add_u32 s58, s57, 4096
  s_mov_b32 s37, 0
  s_mov_b32 s39, 4294897664
  s_mov_b32 s40, 34816
  s_mov_b32 s42, 0
  s_mov_b32 s44, 4294942720
  s_mov_b32 s45, 24576
  s_mov_b32 s43, s44
  s_mov_b32 s52, s72
  s_mov_b32 s53, s73
  s_mov_b32 s54, 4194304
  s_mov_b32 s55, 0x00020000
  s_lshl_b32 s1, s51, 1
  s_mov_b32 s56, s51
  s_mov_b32 s0, 0
  s_waitcnt vmcnt(0)
  s_barrier
  ds_read_b128 a[72:75], v16 offset:0
  ds_read_b128 a[108:111], v17 offset:0
  ds_read_b64_tr_b16 a[144:145], v20 offset:0
  ds_read_b64_tr_b16 a[146:147], v20 offset:2048
  ds_read_b64_tr_b16 a[168:169], v20 offset:4096
  ds_read_b64_tr_b16 a[170:171], v20 offset:6144
  ds_read_b128 a[76:79], v16 offset:2048
  ds_read_b128 a[112:115], v17 offset:2048
  ds_read_b128 a[80:83], v16 offset:4096
  ds_read_b128 a[116:119], v17 offset:4096
  ds_read_b128 a[84:87], v16 offset:6144
  ds_read_b128 a[120:123], v17 offset:6144
  ds_read_b128 a[88:91], v16 offset:8192
  ds_read_b128 a[124:127], v17 offset:8192
  ds_read_b128 a[92:95], v16 offset:10240
  ds_read_b128 a[128:131], v17 offset:10240
  ds_read_b128 a[96:99], v16 offset:12288
  ds_read_b128 a[132:135], v17 offset:12288
  ds_read_b128 a[100:103], v16 offset:14336
  ds_read_b128 a[136:139], v17 offset:14336
  ds_read_b64_tr_b16 a[148:149], v21 offset:0
  ds_read_b64_tr_b16 a[150:151], v21 offset:2048
  ds_read_b64_tr_b16 a[172:173], v21 offset:4096
  ds_read_b64_tr_b16 a[174:175], v21 offset:6144
  ds_read_b64_tr_b16 a[152:153], v20 offset:8192
  ds_read_b64_tr_b16 a[154:155], v20 offset:10240
  ds_read_b64_tr_b16 a[176:177], v20 offset:12288
  ds_read_b64_tr_b16 a[178:179], v20 offset:14336
  ds_read_b128 a[104:107], v18 offset:0
  ds_read_b128 a[140:143], v19 offset:0
  s_waitcnt lgkmcnt(0)
  v_mfma_f32_16x16x32_bf16 v[24:27], a[144:147], a[72:75], 0
  s_add_u32 m0, s36, 34816
  ds_read_b64_tr_b16 a[156:157], v21 offset:8192
  v_mfma_f32_16x16x32_bf16 v[24:27], a[168:171], a[108:111], v[24:27]
  buffer_load_dwordx4 v224, s[8:11], s46 offen offset:0 lds
  v_mfma_f32_16x16x32_bf16 v[28:31], a[144:147], a[76:79], 0
  buffer_load_dwordx4 v225, s[8:11], s46 offen offset:1024 lds
  v_mfma_f32_16x16x32_bf16 v[28:31], a[168:171], a[112:115], v[28:31]
  buffer_load_dwordx4 v226, s[8:11], s46 offen offset:2048 lds
  v_mfma_f32_16x16x32_bf16 v[32:35], a[144:147], a[80:83], 0
  ds_read_b64_tr_b16 a[158:159], v21 offset:10240
  v_mfma_f32_16x16x32_bf16 v[32:35], a[168:171], a[116:119], v[32:35]
  buffer_load_dwordx4 v227, s[8:11], s46 offen offset:3072 lds
  v_mfma_f32_16x16x32_bf16 v[36:39], a[144:147], a[84:87], 0
  s_add_u32 m0, s36, 38912
  ds_read_b64_tr_b16 a[180:181], v21 offset:12288
  v_mfma_f32_16x16x32_bf16 v[36:39], a[168:171], a[120:123], v[36:39]
  buffer_load_dwordx4 v228, s[8:11], s46 offen offset:0 lds
  v_mfma_f32_16x16x32_bf16 v[40:43], a[144:147], a[88:91], 0
  v_mfma_f32_16x16x32_bf16 v[40:43], a[168:171], a[124:127], v[40:43]
  buffer_load_dwordx4 v229, s[8:11], s46 offen offset:1024 lds
  v_mfma_f32_16x16x32_bf16 v[44:47], a[144:147], a[92:95], 0
  ds_read_b64_tr_b16 a[182:183], v21 offset:14336
  v_mfma_f32_16x16x32_bf16 v[44:47], a[168:171], a[128:131], v[44:47]
  buffer_load_dwordx4 v230, s[8:11], s46 offen offset:2048 lds
  v_mfma_f32_16x16x32_bf16 v[48:51], a[144:147], a[96:99], 0
  ds_read_b64_tr_b16 a[160:161], v20 offset:16384
  v_mfma_f32_16x16x32_bf16 v[48:51], a[168:171], a[132:135], v[48:51]
  buffer_load_dwordx4 v231, s[8:11], s46 offen offset:3072 lds
  v_mfma_f32_16x16x32_bf16 v[52:55], a[144:147], a[100:103], 0
  s_mul_i32 s47, s48, 393216
  s_bfe_u32 s34, 0x302010e, s49
  s_add_u32 s48, s48, s34
  v_mfma_f32_16x16x32_bf16 v[52:55], a[168:171], a[136:139], v[52:55]
  s_add_u32 s49, s49, 8
  s_and_b32 s49, s49, 0x8001f
  s_and_b32 s48, s48, 15
  v_mfma_f32_16x16x32_bf16 v[56:59], a[148:151], a[72:75], 0
  s_lshl_b32 s46, s48, 7
  s_add_u32 m0, s41, 24576
  ds_read_b64_tr_b16 a[162:163], v20 offset:18432
  v_mfma_f32_16x16x32_bf16 v[56:59], a[172:175], a[108:111], v[56:59]
  buffer_load_dwordx4 v233, s[12:15], s47 offen offset:0 lds
  v_mfma_f32_16x16x32_bf16 v[60:63], a[148:151], a[76:79], 0
  buffer_load_dwordx4 v234, s[12:15], s47 offen offset:1024 lds
  v_mfma_f32_16x16x32_bf16 v[60:63], a[172:175], a[112:115], v[60:63]
  buffer_load_dwordx4 v235, s[12:15], s47 offen offset:2048 lds
  v_mfma_f32_16x16x32_bf16 v[64:67], a[148:151], a[80:83], 0
  s_add_u32 m0, s41, 27648
  ds_read_b64_tr_b16 a[184:185], v20 offset:20480
  v_mfma_f32_16x16x32_bf16 v[64:67], a[172:175], a[116:119], v[64:67]
  buffer_load_dwordx4 v236, s[12:15], s47 offen offset:0 lds
  v_mfma_f32_16x16x32_bf16 v[68:71], a[148:151], a[84:87], 0
  buffer_load_dwordx4 v237, s[12:15], s47 offen offset:1024 lds
  v_mfma_f32_16x16x32_bf16 v[68:71], a[172:175], a[120:123], v[68:71]
  ds_read_b64_tr_b16 a[186:187], v20 offset:22528
  v_mfma_f32_16x16x32_bf16 v[72:75], a[148:151], a[88:91], 0
  buffer_load_dwordx4 v238, s[12:15], s47 offen offset:2048 lds
  v_mfma_f32_16x16x32_bf16 v[72:75], a[172:175], a[124:127], v[72:75]
  s_add_u32 m0, s36, 69632
  ds_read_b64_tr_b16 a[164:165], v21 offset:16384
  v_mfma_f32_16x16x32_bf16 v[76:79], a[148:151], a[92:95], 0
  buffer_load_dwordx4 v224, s[8:11], s46 offen offset:0 lds
  v_mfma_f32_16x16x32_bf16 v[76:79], a[172:175], a[128:131], v[76:79]
  buffer_load_dwordx4 v225, s[8:11], s46 offen offset:1024 lds
  v_mfma_f32_16x16x32_bf16 v[80:83], a[148:151], a[96:99], 0
  ds_read_b64_tr_b16 a[166:167], v21 offset:18432
  v_mfma_f32_16x16x32_bf16 v[80:83], a[172:175], a[132:135], v[80:83]
  buffer_load_dwordx4 v226, s[8:11], s46 offen offset:2048 lds
  v_mfma_f32_16x16x32_bf16 v[84:87], a[148:151], a[100:103], 0
  v_mfma_f32_16x16x32_bf16 v[84:87], a[172:175], a[136:139], v[84:87]
  buffer_load_dwordx4 v227, s[8:11], s46 offen offset:3072 lds
  v_mfma_f32_16x16x32_bf16 v[88:91], a[152:155], a[72:75], 0
  s_add_u32 m0, s36, 73728
  ds_read_b64_tr_b16 a[188:189], v21 offset:20480
  v_mfma_f32_16x16x32_bf16 v[88:91], a[176:179], a[108:111], v[88:91]
  buffer_load_dwordx4 v228, s[8:11], s46 offen offset:0 lds
  v_mfma_f32_16x16x32_bf16 v[92:95], a[152:155], a[76:79], 0
  s_add_u32 s37, s37, 1
  ds_read_b64_tr_b16 a[190:191], v21 offset:22528
  v_mfma_f32_16x16x32_bf16 v[92:95], a[176:179], a[112:115], v[92:95]
  buffer_load_dwordx4 v229, s[8:11], s46 offen offset:1024 lds
  v_mfma_f32_16x16x32_bf16 v[96:99], a[152:155], a[80:83], 0
  s_cmp_eq_u32 s37, 3
  s_cselect_b32 s37, 0, s37
  s_cselect_b32 s38, s39, s40
  v_mfma_f32_16x16x32_bf16 v[96:99], a[176:179], a[116:119], v[96:99]
  buffer_load_dwordx4 v230, s[8:11], s46 offen offset:2048 lds
  v_mfma_f32_16x16x32_bf16 v[100:103], a[152:155], a[84:87], 0
  s_sub_u32 s43, 0, s43
  v_mfma_f32_16x16x32_bf16 v[100:103], a[176:179], a[120:123], v[100:103]
  buffer_load_dwordx4 v231, s[8:11], s46 offen offset:3072 lds
  v_mfma_f32_16x16x32_bf16 v[104:107], a[152:155], a[88:91], 0
  s_mul_i32 s47, s48, 393216
  v_add_u32 v16, s38, v16
  v_add_u32 v17, s38, v17
  v_mfma_f32_16x16x32_bf16 v[104:107], a[176:179], a[124:127], v[104:107]
  s_bfe_u32 s34, 0x302010e, s49
  v_add_u32 v18, s38, v18
  v_add_u32 v19, s38, v19
  v_mfma_f32_16x16x32_bf16 v[108:111], a[152:155], a[92:95], 0
  s_add_u32 s48, s48, s34
  v_add_u32 v20, s43, v20
  v_add_u32 v21, s43, v21
  v_mfma_f32_16x16x32_bf16 v[108:111], a[176:179], a[128:131], v[108:111]
  s_add_u32 s49, s49, 8
  v_mfma_f32_16x16x32_bf16 v[112:115], a[152:155], a[96:99], 0
  s_and_b32 s49, s49, 0x8001f
  s_and_b32 s48, s48, 15
  s_lshl_b32 s46, s48, 7
  v_mfma_f32_16x16x32_bf16 v[112:115], a[176:179], a[132:135], v[112:115]
  v_mfma_f32_16x16x32_bf16 v[116:119], a[152:155], a[100:103], 0
  v_mfma_f32_16x16x32_bf16 v[116:119], a[176:179], a[136:139], v[116:119]
  s_waitcnt vmcnt(8) lgkmcnt(0)
  s_barrier
  v_mfma_f32_16x16x32_bf16 v[120:123], a[156:159], a[72:75], 0
  buffer_load_dwordx4 a[192:195], v2, s[52:55], s51 offen offset:0
  v_mfma_f32_16x16x32_bf16 v[120:123], a[180:183], a[108:111], v[120:123]
  ds_read_b128 a[0:3], v16 offset:0
  ds_read_b128 a[36:39], v17 offset:0
  v_mfma_f32_16x16x32_bf16 v[124:127], a[156:159], a[76:79], 0
  ds_read_b64_tr_b16 a[144:145], v20 offset:0
  v_mfma_f32_16x16x32_bf16 v[124:127], a[180:183], a[112:115], v[124:127]
  v_mfma_f32_16x16x32_bf16 v[128:131], a[156:159], a[80:83], 0
  ds_read_b64_tr_b16 a[146:147], v20 offset:2048
  v_mfma_f32_16x16x32_bf16 v[128:131], a[180:183], a[116:119], v[128:131]
  buffer_load_dwordx4 a[192:195], v2, s[52:55], s51 offen offset:1024
  v_mfma_f32_16x16x32_bf16 v[132:135], a[156:159], a[84:87], 0
  ds_read_b64_tr_b16 a[168:169], v20 offset:4096
  v_mfma_f32_16x16x32_bf16 v[132:135], a[180:183], a[120:123], v[132:135]
  ds_read_b64_tr_b16 a[170:171], v20 offset:6144
  v_mfma_f32_16x16x32_bf16 v[136:139], a[156:159], a[88:91], 0
  ds_read_b128 a[4:7], v16 offset:2048
  v_mfma_f32_16x16x32_bf16 v[136:139], a[180:183], a[124:127], v[136:139]
  ds_read_b128 a[40:43], v17 offset:2048
  v_mfma_f32_16x16x32_bf16 v[140:143], a[156:159], a[92:95], 0
  v_mfma_f32_16x16x32_bf16 v[140:143], a[180:183], a[128:131], v[140:143]
  buffer_load_dwordx4 a[192:195], v2, s[52:55], s51 offen offset:2048
  v_mfma_f32_16x16x32_bf16 v[144:147], a[156:159], a[96:99], 0
  ds_read_b128 a[8:11], v16 offset:4096
  ds_read_b128 a[44:47], v17 offset:4096
  v_mfma_f32_16x16x32_bf16 v[144:147], a[180:183], a[132:135], v[144:147]
  v_mfma_f32_16x16x32_bf16 v[148:151], a[156:159], a[100:103], 0
  ds_read_b128 a[12:15], v16 offset:6144
  v_mfma_f32_16x16x32_bf16 v[148:151], a[180:183], a[136:139], v[148:151]
  ds_read_b128 a[48:51], v17 offset:6144
  v_mfma_f32_16x16x32_bf16 v[152:155], a[72:75], a[160:163], 0
  ds_read_b128 a[16:19], v16 offset:8192
  v_mfma_f32_16x16x32_bf16 v[152:155], a[108:111], a[184:187], v[152:155]
  buffer_load_dwordx4 a[192:195], v2, s[52:55], s51 offen offset:3072
  v_mfma_f32_16x16x32_bf16 v[156:159], a[76:79], a[160:163], 0
  s_add_u32 s51, s51, 4096
  s_add_u32 s0, s0, 1
  s_cmp_eq_u32 s0, 2
  s_cselect_b32 s52, s68, s52
  s_cselect_b32 s53, s69, s53
  s_cselect_b32 s51, s1, s51
  s_cselect_b32 s54, 0, s54
  v_mfma_f32_16x16x32_bf16 v[156:159], a[112:115], a[184:187], v[156:159]
  s_cmp_eq_u32 s0, 6
  s_cselect_b32 s52, s64, s52
  s_cselect_b32 s53, s65, s53
  s_cselect_b32 s51, s56, s51
  s_cselect_b32 s54, 0, s54
  v_mfma_f32_16x16x32_bf16 v[160:163], a[80:83], a[160:163], 0
  s_cmp_eq_u32 s0, 8
  s_cselect_b32 s54, 0, s54
  s_mov_b32 m0, s41
  v_mfma_f32_16x16x32_bf16 v[160:163], a[116:119], a[184:187], v[160:163]
  ds_read_b128 a[52:55], v17 offset:8192
  ds_read_b128 a[20:23], v16 offset:10240
  v_mfma_f32_16x16x32_bf16 v[164:167], a[84:87], a[160:163], 0
  buffer_load_dwordx4 v233, s[12:15], s47 offen offset:0 lds
  v_mfma_f32_16x16x32_bf16 v[164:167], a[120:123], a[184:187], v[164:167]
  ds_read_b128 a[56:59], v17 offset:10240
  ds_read_b128 a[24:27], v16 offset:12288
  v_mfma_f32_16x16x32_bf16 v[168:171], a[88:91], a[160:163], 0
  ds_read_b128 a[60:63], v17 offset:12288
  v_mfma_f32_16x16x32_bf16 v[168:171], a[124:127], a[184:187], v[168:171]
  ds_read_b128 a[28:31], v16 offset:14336
  v_mfma_f32_16x16x32_bf16 v[172:175], a[92:95], a[160:163], 0
  ds_read_b128 a[64:67], v17 offset:14336
  v_mfma_f32_16x16x32_bf16 v[172:175], a[128:131], a[184:187], v[172:175]
  v_mfma_f32_16x16x32_bf16 v[176:179], a[96:99], a[160:163], 0
  buffer_load_dwordx4 v234, s[12:15], s47 offen offset:1024 lds
  v_mfma_f32_16x16x32_bf16 v[176:179], a[132:135], a[184:187], v[176:179]
  ds_read_b64_tr_b16 a[148:149], v21 offset:0
  ds_read_b64_tr_b16 a[150:151], v21 offset:2048
  v_mfma_f32_16x16x32_bf16 v[180:183], a[100:103], a[160:163], 0
  ds_read_b64_tr_b16 a[172:173], v21 offset:4096
  v_mfma_f32_16x16x32_bf16 v[180:183], a[136:139], a[184:187], v[180:183]
  v_mfma_f32_16x16x32_bf16 v[216:219], a[104:107], a[160:163], 0
  ds_read_b64_tr_b16 a[174:175], v21 offset:6144
  v_mfma_f32_16x16x32_bf16 v[216:219], a[140:143], a[184:187], v[216:219]
  ds_read_b64_tr_b16 a[152:153], v20 offset:8192
  v_mfma_f32_16x16x32_bf16 v[184:187], a[72:75], a[164:167], 0
  buffer_load_dwordx4 v235, s[12:15], s47 offen offset:2048 lds
  v_mfma_f32_16x16x32_bf16 v[184:187], a[108:111], a[188:191], v[184:187]
  s_add_u32 m0, s41, 3072
  ds_read_b64_tr_b16 a[154:155], v20 offset:10240
  v_mfma_f32_16x16x32_bf16 v[188:191], a[76:79], a[164:167], 0
  ds_read_b64_tr_b16 a[176:177], v20 offset:12288
  v_mfma_f32_16x16x32_bf16 v[188:191], a[112:115], a[188:191], v[188:191]
  ds_read_b64_tr_b16 a[178:179], v20 offset:14336
  v_mfma_f32_16x16x32_bf16 v[192:195], a[80:83], a[164:167], 0
  v_mfma_f32_16x16x32_bf16 v[192:195], a[116:119], a[188:191], v[192:195]
  buffer_load_dwordx4 v236, s[12:15], s47 offen offset:0 lds
  v_mfma_f32_16x16x32_bf16 v[196:199], a[84:87], a[164:167], 0
  ds_read_b128 a[32:35], v18 offset:0
  ds_read_b128 a[68:71], v19 offset:0
  v_mfma_f32_16x16x32_bf16 v[196:199], a[120:123], a[188:191], v[196:199]
  v_mfma_f32_16x16x32_bf16 v[200:203], a[88:91], a[164:167], 0
  v_mfma_f32_16x16x32_bf16 v[200:203], a[124:127], a[188:191], v[200:203]
  v_mfma_f32_16x16x32_bf16 v[204:207], a[92:95], a[164:167], 0
  v_mfma_f32_16x16x32_bf16 v[204:207], a[128:131], a[188:191], v[204:207]
  buffer_load_dwordx4 v237, s[12:15], s47 offen offset:1024 lds
  v_mfma_f32_16x16x32_bf16 v[208:211], a[96:99], a[164:167], 0
  v_mfma_f32_16x16x32_bf16 v[208:211], a[132:135], a[188:191], v[208:211]
  v_mfma_f32_16x16x32_bf16 v[212:215], a[100:103], a[164:167], 0
  v_mfma_f32_16x16x32_bf16 v[212:215], a[136:139], a[188:191], v[212:215]
  v_mfma_f32_16x16x32_bf16 v[220:223], a[104:107], a[164:167], 0
  v_mfma_f32_16x16x32_bf16 v[220:223], a[140:143], a[188:191], v[220:223]
  s_waitcnt lgkmcnt(0)
  v_mfma_f32_16x16x32_bf16 v[24:27], a[144:147], a[0:3], v[24:27]
  buffer_load_dwordx4 v238, s[12:15], s47 offen offset:2048 lds
  v_mfma_f32_16x16x32_bf16 v[24:27], a[168:171], a[36:39], v[24:27]
  s_mov_b32 m0, s36
  ds_read_b64_tr_b16 a[156:157], v21 offset:8192
  v_mfma_f32_16x16x32_bf16 v[28:31], a[144:147], a[4:7], v[28:31]
  v_mfma_f32_16x16x32_bf16 v[28:31], a[168:171], a[40:43], v[28:31]
  ds_read_b64_tr_b16 a[158:159], v21 offset:10240
  v_mfma_f32_16x16x32_bf16 v[32:35], a[144:147], a[8:11], v[32:35]
  buffer_load_dwordx4 v224, s[8:11], s46 offen offset:0 lds
  v_mfma_f32_16x16x32_bf16 v[32:35], a[168:171], a[44:47], v[32:35]
  v_mfma_f32_16x16x32_bf16 v[36:39], a[144:147], a[12:15], v[36:39]
  ds_read_b64_tr_b16 a[180:181], v21 offset:12288
  v_mfma_f32_16x16x32_bf16 v[36:39], a[168:171], a[48:51], v[36:39]
  v_mfma_f32_16x16x32_bf16 v[40:43], a[144:147], a[16:19], v[40:43]
  v_mfma_f32_16x16x32_bf16 v[40:43], a[168:171], a[52:55], v[40:43]
  buffer_load_dwordx4 v225, s[8:11], s46 offen offset:1024 lds
  v_mfma_f32_16x16x32_bf16 v[44:47], a[144:147], a[20:23], v[44:47]
  ds_read_b64_tr_b16 a[182:183], v21 offset:14336
  v_mfma_f32_16x16x32_bf16 v[44:47], a[168:171], a[56:59], v[44:47]
  v_mfma_f32_16x16x32_bf16 v[48:51], a[144:147], a[24:27], v[48:51]
  ds_read_b64_tr_b16 a[160:161], v20 offset:16384
  v_mfma_f32_16x16x32_bf16 v[48:51], a[168:171], a[60:63], v[48:51]
  buffer_load_dwordx4 v226, s[8:11], s46 offen offset:2048 lds
  v_mfma_f32_16x16x32_bf16 v[52:55], a[144:147], a[28:31], v[52:55]
  v_mfma_f32_16x16x32_bf16 v[52:55], a[168:171], a[64:67], v[52:55]
  ds_read_b64_tr_b16 a[162:163], v20 offset:18432
  v_mfma_f32_16x16x32_bf16 v[56:59], a[148:151], a[0:3], v[56:59]
  v_mfma_f32_16x16x32_bf16 v[56:59], a[172:175], a[36:39], v[56:59]
  v_mfma_f32_16x16x32_bf16 v[60:63], a[148:151], a[4:7], v[60:63]
  buffer_load_dwordx4 v227, s[8:11], s46 offen offset:3072 lds
  v_mfma_f32_16x16x32_bf16 v[60:63], a[172:175], a[40:43], v[60:63]
  s_add_u32 m0, s36, 4096
  ds_read_b64_tr_b16 a[184:185], v20 offset:20480
  v_mfma_f32_16x16x32_bf16 v[64:67], a[148:151], a[8:11], v[64:67]
  s_add_u32 s36, s36, s38
  v_mfma_f32_16x16x32_bf16 v[64:67], a[172:175], a[44:47], v[64:67]
  s_add_u32 s37, s37, 1
  v_mfma_f32_16x16x32_bf16 v[68:71], a[148:151], a[12:15], v[68:71]
  buffer_load_dwordx4 v228, s[8:11], s46 offen offset:0 lds
  v_mfma_f32_16x16x32_bf16 v[68:71], a[172:175], a[48:51], v[68:71]
  ds_read_b64_tr_b16 a[186:187], v20 offset:22528
  v_mfma_f32_16x16x32_bf16 v[72:75], a[148:151], a[16:19], v[72:75]
  s_cmp_eq_u32 s37, 3
  s_cselect_b32 s37, 0, s37
  s_cselect_b32 s38, s39, s40
  v_mfma_f32_16x16x32_bf16 v[72:75], a[172:175], a[52:55], v[72:75]
  s_add_u32 s41, s41, s43
  ds_read_b64_tr_b16 a[164:165], v21 offset:16384
  v_mfma_f32_16x16x32_bf16 v[76:79], a[148:151], a[20:23], v[76:79]
  s_sub_u32 s43, 0, s43
  v_mfma_f32_16x16x32_bf16 v[76:79], a[172:175], a[56:59], v[76:79]
  buffer_load_dwordx4 v229, s[8:11], s46 offen offset:1024 lds
  v_mfma_f32_16x16x32_bf16 v[80:83], a[148:151], a[24:27], v[80:83]
  ds_read_b64_tr_b16 a[166:167], v21 offset:18432
  v_mfma_f32_16x16x32_bf16 v[80:83], a[172:175], a[60:63], v[80:83]
  v_mfma_f32_16x16x32_bf16 v[84:87], a[148:151], a[28:31], v[84:87]
  v_mfma_f32_16x16x32_bf16 v[84:87], a[172:175], a[64:67], v[84:87]
  buffer_load_dwordx4 v230, s[8:11], s46 offen offset:2048 lds
  v_mfma_f32_16x16x32_bf16 v[88:91], a[152:155], a[0:3], v[88:91]
  ds_read_b64_tr_b16 a[188:189], v21 offset:20480
  v_mfma_f32_16x16x32_bf16 v[88:91], a[176:179], a[36:39], v[88:91]
  v_mfma_f32_16x16x32_bf16 v[92:95], a[152:155], a[4:7], v[92:95]
  ds_read_b64_tr_b16 a[190:191], v21 offset:22528
  v_mfma_f32_16x16x32_bf16 v[92:95], a[176:179], a[40:43], v[92:95]
  v_add_u32 v16, s38, v16
  v_add_u32 v17, s38, v17
  v_mfma_f32_16x16x32_bf16 v[96:99], a[152:155], a[8:11], v[96:99]
  buffer_load_dwordx4 v231, s[8:11], s46 offen offset:3072 lds
  v_mfma_f32_16x16x32_bf16 v[96:99], a[176:179], a[44:47], v[96:99]
  s_mul_i32 s47, s48, 393216
  v_add_u32 v18, s38, v18
  v_add_u32 v19, s38, v19
  v_mfma_f32_16x16x32_bf16 v[100:103], a[152:155], a[12:15], v[100:103]
  s_bfe_u32 s34, 0x302010e, s49
  v_add_u32 v20, s43, v20
  v_add_u32 v21, s43, v21
  v_mfma_f32_16x16x32_bf16 v[100:103], a[176:179], a[48:51], v[100:103]
  s_add_u32 s48, s48, s34
  v_mfma_f32_16x16x32_bf16 v[104:107], a[152:155], a[16:19], v[104:107]
  s_add_u32 s49, s49, 8
  v_mfma_f32_16x16x32_bf16 v[104:107], a[176:179], a[52:55], v[104:107]
  s_and_b32 s49, s49, 0x8001f
  v_mfma_f32_16x16x32_bf16 v[108:111], a[152:155], a[20:23], v[108:111]
  s_and_b32 s48, s48, 15
  v_mfma_f32_16x16x32_bf16 v[108:111], a[176:179], a[56:59], v[108:111]
  s_lshl_b32 s46, s48, 7
  v_mfma_f32_16x16x32_bf16 v[112:115], a[152:155], a[24:27], v[112:115]
  v_mfma_f32_16x16x32_bf16 v[112:115], a[176:179], a[60:63], v[112:115]
  v_mfma_f32_16x16x32_bf16 v[116:119], a[152:155], a[28:31], v[116:119]
  v_mfma_f32_16x16x32_bf16 v[116:119], a[176:179], a[64:67], v[116:119]
  s_mov_b32 s35, 6
  s_waitcnt vmcnt(8) lgkmcnt(0)
  s_barrier
  .p2align 6
Lp2r1_loop:
  v_mfma_f32_16x16x32_bf16 v[120:123], a[156:159], a[0:3], v[120:123]
  buffer_load_dwordx4 a[192:195], v2, s[52:55], s51 offen offset:0
  v_mfma_f32_16x16x32_bf16 v[120:123], a[180:183], a[36:39], v[120:123]
  ds_read_b128 a[72:75], v16 offset:0
  ds_read_b128 a[108:111], v17 offset:0
  v_mfma_f32_16x16x32_bf16 v[124:127], a[156:159], a[4:7], v[124:127]
  ds_read_b64_tr_b16 a[144:145], v20 offset:0
  v_mfma_f32_16x16x32_bf16 v[124:127], a[180:183], a[40:43], v[124:127]
  v_mfma_f32_16x16x32_bf16 v[128:131], a[156:159], a[8:11], v[128:131]
  ds_read_b64_tr_b16 a[146:147], v20 offset:2048
  v_mfma_f32_16x16x32_bf16 v[128:131], a[180:183], a[44:47], v[128:131]
  buffer_load_dwordx4 a[192:195], v2, s[52:55], s51 offen offset:1024
  v_mfma_f32_16x16x32_bf16 v[132:135], a[156:159], a[12:15], v[132:135]
  ds_read_b64_tr_b16 a[168:169], v20 offset:4096
  v_mfma_f32_16x16x32_bf16 v[132:135], a[180:183], a[48:51], v[132:135]
  ds_read_b64_tr_b16 a[170:171], v20 offset:6144
  v_mfma_f32_16x16x32_bf16 v[136:139], a[156:159], a[16:19], v[136:139]
  ds_read_b128 a[76:79], v16 offset:2048
  v_mfma_f32_16x16x32_bf16 v[136:139], a[180:183], a[52:55], v[136:139]
  ds_read_b128 a[112:115], v17 offset:2048
  v_mfma_f32_16x16x32_bf16 v[140:143], a[156:159], a[20:23], v[140:143]
  v_mfma_f32_16x16x32_bf16 v[140:143], a[180:183], a[56:59], v[140:143]
  buffer_load_dwordx4 a[192:195], v2, s[52:55], s51 offen offset:2048
  v_mfma_f32_16x16x32_bf16 v[144:147], a[156:159], a[24:27], v[144:147]
  ds_read_b128 a[80:83], v16 offset:4096
  ds_read_b128 a[116:119], v17 offset:4096
  v_mfma_f32_16x16x32_bf16 v[144:147], a[180:183], a[60:63], v[144:147]
  v_mfma_f32_16x16x32_bf16 v[148:151], a[156:159], a[28:31], v[148:151]
  ds_read_b128 a[84:87], v16 offset:6144
  v_mfma_f32_16x16x32_bf16 v[148:151], a[180:183], a[64:67], v[148:151]
  ds_read_b128 a[120:123], v17 offset:6144
  v_mfma_f32_16x16x32_bf16 v[152:155], a[0:3], a[160:163], v[152:155]
  ds_read_b128 a[88:91], v16 offset:8192
  v_mfma_f32_16x16x32_bf16 v[152:155], a[36:39], a[184:187], v[152:155]
  buffer_load_dwordx4 a[192:195], v2, s[52:55], s51 offen offset:3072
  v_mfma_f32_16x16x32_bf16 v[156:159], a[4:7], a[160:163], v[156:159]
  s_add_u32 s51, s51, 4096
  s_add_u32 s0, s0, 1
  s_cmp_eq_u32 s0, 2
  s_cselect_b32 s52, s68, s52
  s_cselect_b32 s53, s69, s53
  s_cselect_b32 s51, s1, s51
  s_cselect_b32 s54, 0, s54
  v_mfma_f32_16x16x32_bf16 v[156:159], a[40:43], a[184:187], v[156:159]
  s_cmp_eq_u32 s0, 6
  s_cselect_b32 s52, s64, s52
  s_cselect_b32 s53, s65, s53
  s_cselect_b32 s51, s56, s51
  s_cselect_b32 s54, 0, s54
  v_mfma_f32_16x16x32_bf16 v[160:163], a[8:11], a[160:163], v[160:163]
  s_cmp_eq_u32 s0, 8
  s_cselect_b32 s54, 0, s54
  s_mov_b32 m0, s41
  v_mfma_f32_16x16x32_bf16 v[160:163], a[44:47], a[184:187], v[160:163]
  ds_read_b128 a[124:127], v17 offset:8192
  ds_read_b128 a[92:95], v16 offset:10240
  v_mfma_f32_16x16x32_bf16 v[164:167], a[12:15], a[160:163], v[164:167]
  buffer_load_dwordx4 v233, s[12:15], s47 offen offset:0 lds
  v_mfma_f32_16x16x32_bf16 v[164:167], a[48:51], a[184:187], v[164:167]
  ds_read_b128 a[128:131], v17 offset:10240
  ds_read_b128 a[96:99], v16 offset:12288
  v_mfma_f32_16x16x32_bf16 v[168:171], a[16:19], a[160:163], v[168:171]
  ds_read_b128 a[132:135], v17 offset:12288
  v_mfma_f32_16x16x32_bf16 v[168:171], a[52:55], a[184:187], v[168:171]
  ds_read_b128 a[100:103], v16 offset:14336
  v_mfma_f32_16x16x32_bf16 v[172:175], a[20:23], a[160:163], v[172:175]
  ds_read_b128 a[136:139], v17 offset:14336
  v_mfma_f32_16x16x32_bf16 v[172:175], a[56:59], a[184:187], v[172:175]
  v_mfma_f32_16x16x32_bf16 v[176:179], a[24:27], a[160:163], v[176:179]
  buffer_load_dwordx4 v234, s[12:15], s47 offen offset:1024 lds
  v_mfma_f32_16x16x32_bf16 v[176:179], a[60:63], a[184:187], v[176:179]
  ds_read_b64_tr_b16 a[148:149], v21 offset:0
  ds_read_b64_tr_b16 a[150:151], v21 offset:2048
  v_mfma_f32_16x16x32_bf16 v[180:183], a[28:31], a[160:163], v[180:183]
  ds_read_b64_tr_b16 a[172:173], v21 offset:4096
  v_mfma_f32_16x16x32_bf16 v[180:183], a[64:67], a[184:187], v[180:183]
  v_mfma_f32_16x16x32_bf16 v[216:219], a[32:35], a[160:163], v[216:219]
  ds_read_b64_tr_b16 a[174:175], v21 offset:6144
  v_mfma_f32_16x16x32_bf16 v[216:219], a[68:71], a[184:187], v[216:219]
  ds_read_b64_tr_b16 a[152:153], v20 offset:8192
  v_mfma_f32_16x16x32_bf16 v[184:187], a[0:3], a[164:167], v[184:187]
  buffer_load_dwordx4 v235, s[12:15], s47 offen offset:2048 lds
  v_mfma_f32_16x16x32_bf16 v[184:187], a[36:39], a[188:191], v[184:187]
  s_add_u32 m0, s41, 3072
  ds_read_b64_tr_b16 a[154:155], v20 offset:10240
  v_mfma_f32_16x16x32_bf16 v[188:191], a[4:7], a[164:167], v[188:191]
  ds_read_b64_tr_b16 a[176:177], v20 offset:12288
  v_mfma_f32_16x16x32_bf16 v[188:191], a[40:43], a[188:191], v[188:191]
  ds_read_b64_tr_b16 a[178:179], v20 offset:14336
  v_mfma_f32_16x16x32_bf16 v[192:195], a[8:11], a[164:167], v[192:195]
  v_mfma_f32_16x16x32_bf16 v[192:195], a[44:47], a[188:191], v[192:195]
  buffer_load_dwordx4 v236, s[12:15], s47 offen offset:0 lds
  v_mfma_f32_16x16x32_bf16 v[196:199], a[12:15], a[164:167], v[196:199]
  ds_read_b128 a[104:107], v18 offset:0
  ds_read_b128 a[140:143], v19 offset:0
  v_mfma_f32_16x16x32_bf16 v[196:199], a[48:51], a[188:191], v[196:199]
  v_mfma_f32_16x16x32_bf16 v[200:203], a[16:19], a[164:167], v[200:203]
  v_mfma_f32_16x16x32_bf16 v[200:203], a[52:55], a[188:191], v[200:203]
  v_mfma_f32_16x16x32_bf16 v[204:207], a[20:23], a[164:167], v[204:207]
  v_mfma_f32_16x16x32_bf16 v[204:207], a[56:59], a[188:191], v[204:207]
  buffer_load_dwordx4 v237, s[12:15], s47 offen offset:1024 lds
  v_mfma_f32_16x16x32_bf16 v[208:211], a[24:27], a[164:167], v[208:211]
  v_mfma_f32_16x16x32_bf16 v[208:211], a[60:63], a[188:191], v[208:211]
  v_mfma_f32_16x16x32_bf16 v[212:215], a[28:31], a[164:167], v[212:215]
  v_mfma_f32_16x16x32_bf16 v[212:215], a[64:67], a[188:191], v[212:215]
  v_mfma_f32_16x16x32_bf16 v[220:223], a[32:35], a[164:167], v[220:223]
  v_mfma_f32_16x16x32_bf16 v[220:223], a[68:71], a[188:191], v[220:223]
  s_waitcnt lgkmcnt(0)
  v_mfma_f32_16x16x32_bf16 v[24:27], a[144:147], a[72:75], v[24:27]
  buffer_load_dwordx4 v238, s[12:15], s47 offen offset:2048 lds
  v_mfma_f32_16x16x32_bf16 v[24:27], a[168:171], a[108:111], v[24:27]
  s_mov_b32 m0, s36
  ds_read_b64_tr_b16 a[156:157], v21 offset:8192
  v_mfma_f32_16x16x32_bf16 v[28:31], a[144:147], a[76:79], v[28:31]
  v_mfma_f32_16x16x32_bf16 v[28:31], a[168:171], a[112:115], v[28:31]
  ds_read_b64_tr_b16 a[158:159], v21 offset:10240
  v_mfma_f32_16x16x32_bf16 v[32:35], a[144:147], a[80:83], v[32:35]
  buffer_load_dwordx4 v224, s[8:11], s46 offen offset:0 lds
  v_mfma_f32_16x16x32_bf16 v[32:35], a[168:171], a[116:119], v[32:35]
  v_mfma_f32_16x16x32_bf16 v[36:39], a[144:147], a[84:87], v[36:39]
  ds_read_b64_tr_b16 a[180:181], v21 offset:12288
  v_mfma_f32_16x16x32_bf16 v[36:39], a[168:171], a[120:123], v[36:39]
  v_mfma_f32_16x16x32_bf16 v[40:43], a[144:147], a[88:91], v[40:43]
  v_mfma_f32_16x16x32_bf16 v[40:43], a[168:171], a[124:127], v[40:43]
  buffer_load_dwordx4 v225, s[8:11], s46 offen offset:1024 lds
  v_mfma_f32_16x16x32_bf16 v[44:47], a[144:147], a[92:95], v[44:47]
  ds_read_b64_tr_b16 a[182:183], v21 offset:14336
  v_mfma_f32_16x16x32_bf16 v[44:47], a[168:171], a[128:131], v[44:47]
  v_mfma_f32_16x16x32_bf16 v[48:51], a[144:147], a[96:99], v[48:51]
  ds_read_b64_tr_b16 a[160:161], v20 offset:16384
  v_mfma_f32_16x16x32_bf16 v[48:51], a[168:171], a[132:135], v[48:51]
  buffer_load_dwordx4 v226, s[8:11], s46 offen offset:2048 lds
  v_mfma_f32_16x16x32_bf16 v[52:55], a[144:147], a[100:103], v[52:55]
  v_mfma_f32_16x16x32_bf16 v[52:55], a[168:171], a[136:139], v[52:55]
  ds_read_b64_tr_b16 a[162:163], v20 offset:18432
  v_mfma_f32_16x16x32_bf16 v[56:59], a[148:151], a[72:75], v[56:59]
  v_mfma_f32_16x16x32_bf16 v[56:59], a[172:175], a[108:111], v[56:59]
  v_mfma_f32_16x16x32_bf16 v[60:63], a[148:151], a[76:79], v[60:63]
  buffer_load_dwordx4 v227, s[8:11], s46 offen offset:3072 lds
  v_mfma_f32_16x16x32_bf16 v[60:63], a[172:175], a[112:115], v[60:63]
  s_add_u32 m0, s36, 4096
  ds_read_b64_tr_b16 a[184:185], v20 offset:20480
  v_mfma_f32_16x16x32_bf16 v[64:67], a[148:151], a[80:83], v[64:67]
  s_add_u32 s36, s36, s38
  v_mfma_f32_16x16x32_bf16 v[64:67], a[172:175], a[116:119], v[64:67]
  s_add_u32 s37, s37, 1
  v_mfma_f32_16x16x32_bf16 v[68:71], a[148:151], a[84:87], v[68:71]
  buffer_load_dwordx4 v228, s[8:11], s46 offen offset:0 lds
  v_mfma_f32_16x16x32_bf16 v[68:71], a[172:175], a[120:123], v[68:71]
  ds_read_b64_tr_b16 a[186:187], v20 offset:22528
  v_mfma_f32_16x16x32_bf16 v[72:75], a[148:151], a[88:91], v[72:75]
  s_cmp_eq_u32 s37, 3
  s_cselect_b32 s37, 0, s37
  s_cselect_b32 s38, s39, s40
  v_mfma_f32_16x16x32_bf16 v[72:75], a[172:175], a[124:127], v[72:75]
  s_add_u32 s41, s41, s43
  ds_read_b64_tr_b16 a[164:165], v21 offset:16384
  v_mfma_f32_16x16x32_bf16 v[76:79], a[148:151], a[92:95], v[76:79]
  s_sub_u32 s43, 0, s43
  v_mfma_f32_16x16x32_bf16 v[76:79], a[172:175], a[128:131], v[76:79]
  buffer_load_dwordx4 v229, s[8:11], s46 offen offset:1024 lds
  v_mfma_f32_16x16x32_bf16 v[80:83], a[148:151], a[96:99], v[80:83]
  ds_read_b64_tr_b16 a[166:167], v21 offset:18432
  v_mfma_f32_16x16x32_bf16 v[80:83], a[172:175], a[132:135], v[80:83]
  v_mfma_f32_16x16x32_bf16 v[84:87], a[148:151], a[100:103], v[84:87]
  v_mfma_f32_16x16x32_bf16 v[84:87], a[172:175], a[136:139], v[84:87]
  buffer_load_dwordx4 v230, s[8:11], s46 offen offset:2048 lds
  v_mfma_f32_16x16x32_bf16 v[88:91], a[152:155], a[72:75], v[88:91]
  ds_read_b64_tr_b16 a[188:189], v21 offset:20480
  v_mfma_f32_16x16x32_bf16 v[88:91], a[176:179], a[108:111], v[88:91]
  v_mfma_f32_16x16x32_bf16 v[92:95], a[152:155], a[76:79], v[92:95]
  ds_read_b64_tr_b16 a[190:191], v21 offset:22528
  v_mfma_f32_16x16x32_bf16 v[92:95], a[176:179], a[112:115], v[92:95]
  v_add_u32 v16, s38, v16
  v_add_u32 v17, s38, v17
  v_mfma_f32_16x16x32_bf16 v[96:99], a[152:155], a[80:83], v[96:99]
  buffer_load_dwordx4 v231, s[8:11], s46 offen offset:3072 lds
  v_mfma_f32_16x16x32_bf16 v[96:99], a[176:179], a[116:119], v[96:99]
  s_mul_i32 s47, s48, 393216
  v_add_u32 v18, s38, v18
  v_add_u32 v19, s38, v19
  v_mfma_f32_16x16x32_bf16 v[100:103], a[152:155], a[84:87], v[100:103]
  s_bfe_u32 s34, 0x302010e, s49
  v_add_u32 v20, s43, v20
  v_add_u32 v21, s43, v21
  v_mfma_f32_16x16x32_bf16 v[100:103], a[176:179], a[120:123], v[100:103]
  s_add_u32 s48, s48, s34
  v_mfma_f32_16x16x32_bf16 v[104:107], a[152:155], a[88:91], v[104:107]
  s_add_u32 s49, s49, 8
  v_mfma_f32_16x16x32_bf16 v[104:107], a[176:179], a[124:127], v[104:107]
  s_and_b32 s49, s49, 0x8001f
  v_mfma_f32_16x16x32_bf16 v[108:111], a[152:155], a[92:95], v[108:111]
  s_and_b32 s48, s48, 15
  v_mfma_f32_16x16x32_bf16 v[108:111], a[176:179], a[128:131], v[108:111]
  s_lshl_b32 s46, s48, 7
  v_mfma_f32_16x16x32_bf16 v[112:115], a[152:155], a[96:99], v[112:115]
  v_mfma_f32_16x16x32_bf16 v[112:115], a[176:179], a[132:135], v[112:115]
  v_mfma_f32_16x16x32_bf16 v[116:119], a[152:155], a[100:103], v[116:119]
  v_mfma_f32_16x16x32_bf16 v[116:119], a[176:179], a[136:139], v[116:119]
  s_waitcnt vmcnt(8) lgkmcnt(0)
  s_barrier
  v_mfma_f32_16x16x32_bf16 v[120:123], a[156:159], a[72:75], v[120:123]
  buffer_load_dwordx4 a[192:195], v2, s[52:55], s51 offen offset:0
  v_mfma_f32_16x16x32_bf16 v[120:123], a[180:183], a[108:111], v[120:123]
  ds_read_b128 a[0:3], v16 offset:0
  ds_read_b128 a[36:39], v17 offset:0
  v_mfma_f32_16x16x32_bf16 v[124:127], a[156:159], a[76:79], v[124:127]
  ds_read_b64_tr_b16 a[144:145], v20 offset:0
  v_mfma_f32_16x16x32_bf16 v[124:127], a[180:183], a[112:115], v[124:127]
  v_mfma_f32_16x16x32_bf16 v[128:131], a[156:159], a[80:83], v[128:131]
  ds_read_b64_tr_b16 a[146:147], v20 offset:2048
  v_mfma_f32_16x16x32_bf16 v[128:131], a[180:183], a[116:119], v[128:131]
  buffer_load_dwordx4 a[192:195], v2, s[52:55], s51 offen offset:1024
  v_mfma_f32_16x16x32_bf16 v[132:135], a[156:159], a[84:87], v[132:135]
  ds_read_b64_tr_b16 a[168:169], v20 offset:4096
  v_mfma_f32_16x16x32_bf16 v[132:135], a[180:183], a[120:123], v[132:135]
  ds_read_b64_tr_b16 a[170:171], v20 offset:6144
  v_mfma_f32_16x16x32_bf16 v[136:139], a[156:159], a[88:91], v[136:139]
  ds_read_b128 a[4:7], v16 offset:2048
  v_mfma_f32_16x16x32_bf16 v[136:139], a[180:183], a[124:127], v[136:139]
  ds_read_b128 a[40:43], v17 offset:2048
  v_mfma_f32_16x16x32_bf16 v[140:143], a[156:159], a[92:95], v[140:143]
  v_mfma_f32_16x16x32_bf16 v[140:143], a[180:183], a[128:131], v[140:143]
  buffer_load_dwordx4 a[192:195], v2, s[52:55], s51 offen offset:2048
  v_mfma_f32_16x16x32_bf16 v[144:147], a[156:159], a[96:99], v[144:147]
  ds_read_b128 a[8:11], v16 offset:4096
  ds_read_b128 a[44:47], v17 offset:4096
  v_mfma_f32_16x16x32_bf16 v[144:147], a[180:183], a[132:135], v[144:147]
  v_mfma_f32_16x16x32_bf16 v[148:151], a[156:159], a[100:103], v[148:151]
  ds_read_b128 a[12:15], v16 offset:6144
  v_mfma_f32_16x16x32_bf16 v[148:151], a[180:183], a[136:139], v[148:151]
  ds_read_b128 a[48:51], v17 offset:6144
  v_mfma_f32_16x16x32_bf16 v[152:155], a[72:75], a[160:163], v[152:155]
  ds_read_b128 a[16:19], v16 offset:8192
  v_mfma_f32_16x16x32_bf16 v[152:155], a[108:111], a[184:187], v[152:155]
  buffer_load_dwordx4 a[192:195], v2, s[52:55], s51 offen offset:3072
  v_mfma_f32_16x16x32_bf16 v[156:159], a[76:79], a[160:163], v[156:159]
  s_add_u32 s51, s51, 4096
  s_add_u32 s0, s0, 1
  s_cmp_eq_u32 s0, 2
  s_cselect_b32 s52, s68, s52
  s_cselect_b32 s53, s69, s53
  s_cselect_b32 s51, s1, s51
  s_cselect_b32 s54, 0, s54
  v_mfma_f32_16x16x32_bf16 v[156:159], a[112:115], a[184:187], v[156:159]
  s_cmp_eq_u32 s0, 6
  s_cselect_b32 s52, s64, s52
  s_cselect_b32 s53, s65, s53
  s_cselect_b32 s51, s56, s51
  s_cselect_b32 s54, 0, s54
  v_mfma_f32_16x16x32_bf16 v[160:163], a[80:83], a[160:163], v[160:163]
  s_cmp_eq_u32 s0, 8
  s_cselect_b32 s54, 0, s54
  s_mov_b32 m0, s41
  v_mfma_f32_16x16x32_bf16 v[160:163], a[116:119], a[184:187], v[160:163]
  ds_read_b128 a[52:55], v17 offset:8192
  ds_read_b128 a[20:23], v16 offset:10240
  v_mfma_f32_16x16x32_bf16 v[164:167], a[84:87], a[160:163], v[164:167]
  buffer_load_dwordx4 v233, s[12:15], s47 offen offset:0 lds
  v_mfma_f32_16x16x32_bf16 v[164:167], a[120:123], a[184:187], v[164:167]
  ds_read_b128 a[56:59], v17 offset:10240
  ds_read_b128 a[24:27], v16 offset:12288
  v_mfma_f32_16x16x32_bf16 v[168:171], a[88:91], a[160:163], v[168:171]
  ds_read_b128 a[60:63], v17 offset:12288
  v_mfma_f32_16x16x32_bf16 v[168:171], a[124:127], a[184:187], v[168:171]
  ds_read_b128 a[28:31], v16 offset:14336
  v_mfma_f32_16x16x32_bf16 v[172:175], a[92:95], a[160:163], v[172:175]
  ds_read_b128 a[64:67], v17 offset:14336
  v_mfma_f32_16x16x32_bf16 v[172:175], a[128:131], a[184:187], v[172:175]
  v_mfma_f32_16x16x32_bf16 v[176:179], a[96:99], a[160:163], v[176:179]
  buffer_load_dwordx4 v234, s[12:15], s47 offen offset:1024 lds
  v_mfma_f32_16x16x32_bf16 v[176:179], a[132:135], a[184:187], v[176:179]
  ds_read_b64_tr_b16 a[148:149], v21 offset:0
  ds_read_b64_tr_b16 a[150:151], v21 offset:2048
  v_mfma_f32_16x16x32_bf16 v[180:183], a[100:103], a[160:163], v[180:183]
  ds_read_b64_tr_b16 a[172:173], v21 offset:4096
  v_mfma_f32_16x16x32_bf16 v[180:183], a[136:139], a[184:187], v[180:183]
  v_mfma_f32_16x16x32_bf16 v[216:219], a[104:107], a[160:163], v[216:219]
  ds_read_b64_tr_b16 a[174:175], v21 offset:6144
  v_mfma_f32_16x16x32_bf16 v[216:219], a[140:143], a[184:187], v[216:219]
  ds_read_b64_tr_b16 a[152:153], v20 offset:8192
  v_mfma_f32_16x16x32_bf16 v[184:187], a[72:75], a[164:167], v[184:187]
  buffer_load_dwordx4 v235, s[12:15], s47 offen offset:2048 lds
  v_mfma_f32_16x16x32_bf16 v[184:187], a[108:111], a[188:191], v[184:187]
  s_add_u32 m0, s41, 3072
  ds_read_b64_tr_b16 a[154:155], v20 offset:10240
  v_mfma_f32_16x16x32_bf16 v[188:191], a[76:79], a[164:167], v[188:191]
  ds_read_b64_tr_b16 a[176:177], v20 offset:12288
  v_mfma_f32_16x16x32_bf16 v[188:191], a[112:115], a[188:191], v[188:191]
  ds_read_b64_tr_b16 a[178:179], v20 offset:14336
  v_mfma_f32_16x16x32_bf16 v[192:195], a[80:83], a[164:167], v[192:195]
  v_mfma_f32_16x16x32_bf16 v[192:195], a[116:119], a[188:191], v[192:195]
  buffer_load_dwordx4 v236, s[12:15], s47 offen offset:0 lds
  v_mfma_f32_16x16x32_bf16 v[196:199], a[84:87], a[164:167], v[196:199]
  ds_read_b128 a[32:35], v18 offset:0
  ds_read_b128 a[68:71], v19 offset:0
  v_mfma_f32_16x16x32_bf16 v[196:199], a[120:123], a[188:191], v[196:199]
  v_mfma_f32_16x16x32_bf16 v[200:203], a[88:91], a[164:167], v[200:203]
  v_mfma_f32_16x16x32_bf16 v[200:203], a[124:127], a[188:191], v[200:203]
  v_mfma_f32_16x16x32_bf16 v[204:207], a[92:95], a[164:167], v[204:207]
  v_mfma_f32_16x16x32_bf16 v[204:207], a[128:131], a[188:191], v[204:207]
  buffer_load_dwordx4 v237, s[12:15], s47 offen offset:1024 lds
  v_mfma_f32_16x16x32_bf16 v[208:211], a[96:99], a[164:167], v[208:211]
  v_mfma_f32_16x16x32_bf16 v[208:211], a[132:135], a[188:191], v[208:211]
  v_mfma_f32_16x16x32_bf16 v[212:215], a[100:103], a[164:167], v[212:215]
  v_mfma_f32_16x16x32_bf16 v[212:215], a[136:139], a[188:191], v[212:215]
  v_mfma_f32_16x16x32_bf16 v[220:223], a[104:107], a[164:167], v[220:223]
  v_mfma_f32_16x16x32_bf16 v[220:223], a[140:143], a[188:191], v[220:223]
  s_waitcnt lgkmcnt(0)
  v_mfma_f32_16x16x32_bf16 v[24:27], a[144:147], a[0:3], v[24:27]
  buffer_load_dwordx4 v238, s[12:15], s47 offen offset:2048 lds
  v_mfma_f32_16x16x32_bf16 v[24:27], a[168:171], a[36:39], v[24:27]
  s_mov_b32 m0, s36
  ds_read_b64_tr_b16 a[156:157], v21 offset:8192
  v_mfma_f32_16x16x32_bf16 v[28:31], a[144:147], a[4:7], v[28:31]
  v_mfma_f32_16x16x32_bf16 v[28:31], a[168:171], a[40:43], v[28:31]
  ds_read_b64_tr_b16 a[158:159], v21 offset:10240
  v_mfma_f32_16x16x32_bf16 v[32:35], a[144:147], a[8:11], v[32:35]
  buffer_load_dwordx4 v224, s[8:11], s46 offen offset:0 lds
  v_mfma_f32_16x16x32_bf16 v[32:35], a[168:171], a[44:47], v[32:35]
  v_mfma_f32_16x16x32_bf16 v[36:39], a[144:147], a[12:15], v[36:39]
  ds_read_b64_tr_b16 a[180:181], v21 offset:12288
  v_mfma_f32_16x16x32_bf16 v[36:39], a[168:171], a[48:51], v[36:39]
  v_mfma_f32_16x16x32_bf16 v[40:43], a[144:147], a[16:19], v[40:43]
  v_mfma_f32_16x16x32_bf16 v[40:43], a[168:171], a[52:55], v[40:43]
  buffer_load_dwordx4 v225, s[8:11], s46 offen offset:1024 lds
  v_mfma_f32_16x16x32_bf16 v[44:47], a[144:147], a[20:23], v[44:47]
  ds_read_b64_tr_b16 a[182:183], v21 offset:14336
  v_mfma_f32_16x16x32_bf16 v[44:47], a[168:171], a[56:59], v[44:47]
  v_mfma_f32_16x16x32_bf16 v[48:51], a[144:147], a[24:27], v[48:51]
  ds_read_b64_tr_b16 a[160:161], v20 offset:16384
  v_mfma_f32_16x16x32_bf16 v[48:51], a[168:171], a[60:63], v[48:51]
  buffer_load_dwordx4 v226, s[8:11], s46 offen offset:2048 lds
  v_mfma_f32_16x16x32_bf16 v[52:55], a[144:147], a[28:31], v[52:55]
  v_mfma_f32_16x16x32_bf16 v[52:55], a[168:171], a[64:67], v[52:55]
  ds_read_b64_tr_b16 a[162:163], v20 offset:18432
  v_mfma_f32_16x16x32_bf16 v[56:59], a[148:151], a[0:3], v[56:59]
  v_mfma_f32_16x16x32_bf16 v[56:59], a[172:175], a[36:39], v[56:59]
  v_mfma_f32_16x16x32_bf16 v[60:63], a[148:151], a[4:7], v[60:63]
  buffer_load_dwordx4 v227, s[8:11], s46 offen offset:3072 lds
  v_mfma_f32_16x16x32_bf16 v[60:63], a[172:175], a[40:43], v[60:63]
  s_add_u32 m0, s36, 4096
  ds_read_b64_tr_b16 a[184:185], v20 offset:20480
  v_mfma_f32_16x16x32_bf16 v[64:67], a[148:151], a[8:11], v[64:67]
  s_add_u32 s36, s36, s38
  v_mfma_f32_16x16x32_bf16 v[64:67], a[172:175], a[44:47], v[64:67]
  s_add_u32 s37, s37, 1
  v_mfma_f32_16x16x32_bf16 v[68:71], a[148:151], a[12:15], v[68:71]
  buffer_load_dwordx4 v228, s[8:11], s46 offen offset:0 lds
  v_mfma_f32_16x16x32_bf16 v[68:71], a[172:175], a[48:51], v[68:71]
  ds_read_b64_tr_b16 a[186:187], v20 offset:22528
  v_mfma_f32_16x16x32_bf16 v[72:75], a[148:151], a[16:19], v[72:75]
  s_cmp_eq_u32 s37, 3
  s_cselect_b32 s37, 0, s37
  s_cselect_b32 s38, s39, s40
  v_mfma_f32_16x16x32_bf16 v[72:75], a[172:175], a[52:55], v[72:75]
  s_add_u32 s41, s41, s43
  ds_read_b64_tr_b16 a[164:165], v21 offset:16384
  v_mfma_f32_16x16x32_bf16 v[76:79], a[148:151], a[20:23], v[76:79]
  s_sub_u32 s43, 0, s43
  v_mfma_f32_16x16x32_bf16 v[76:79], a[172:175], a[56:59], v[76:79]
  buffer_load_dwordx4 v229, s[8:11], s46 offen offset:1024 lds
  v_mfma_f32_16x16x32_bf16 v[80:83], a[148:151], a[24:27], v[80:83]
  ds_read_b64_tr_b16 a[166:167], v21 offset:18432
  v_mfma_f32_16x16x32_bf16 v[80:83], a[172:175], a[60:63], v[80:83]
  v_mfma_f32_16x16x32_bf16 v[84:87], a[148:151], a[28:31], v[84:87]
  v_mfma_f32_16x16x32_bf16 v[84:87], a[172:175], a[64:67], v[84:87]
  buffer_load_dwordx4 v230, s[8:11], s46 offen offset:2048 lds
  v_mfma_f32_16x16x32_bf16 v[88:91], a[152:155], a[0:3], v[88:91]
  ds_read_b64_tr_b16 a[188:189], v21 offset:20480
  v_mfma_f32_16x16x32_bf16 v[88:91], a[176:179], a[36:39], v[88:91]
  v_mfma_f32_16x16x32_bf16 v[92:95], a[152:155], a[4:7], v[92:95]
  ds_read_b64_tr_b16 a[190:191], v21 offset:22528
  v_mfma_f32_16x16x32_bf16 v[92:95], a[176:179], a[40:43], v[92:95]
  v_add_u32 v16, s38, v16
  v_add_u32 v17, s38, v17
  v_mfma_f32_16x16x32_bf16 v[96:99], a[152:155], a[8:11], v[96:99]
  buffer_load_dwordx4 v231, s[8:11], s46 offen offset:3072 lds
  v_mfma_f32_16x16x32_bf16 v[96:99], a[176:179], a[44:47], v[96:99]
  s_mul_i32 s47, s48, 393216
  v_add_u32 v18, s38, v18
  v_add_u32 v19, s38, v19
  v_mfma_f32_16x16x32_bf16 v[100:103], a[152:155], a[12:15], v[100:103]
  s_bfe_u32 s34, 0x302010e, s49
  v_add_u32 v20, s43, v20
  v_add_u32 v21, s43, v21
  v_mfma_f32_16x16x32_bf16 v[100:103], a[176:179], a[48:51], v[100:103]
  s_add_u32 s48, s48, s34
  v_mfma_f32_16x16x32_bf16 v[104:107], a[152:155], a[16:19], v[104:107]
  s_add_u32 s49, s49, 8
  v_mfma_f32_16x16x32_bf16 v[104:107], a[176:179], a[52:55], v[104:107]
  s_and_b32 s49, s49, 0x8001f
  v_mfma_f32_16x16x32_bf16 v[108:111], a[152:155], a[20:23], v[108:111]
  s_and_b32 s48, s48, 15
  v_mfma_f32_16x16x32_bf16 v[108:111], a[176:179], a[56:59], v[108:111]
  s_lshl_b32 s46, s48, 7
  v_mfma_f32_16x16x32_bf16 v[112:115], a[152:155], a[24:27], v[112:115]
  v_mfma_f32_16x16x32_bf16 v[112:115], a[176:179], a[60:63], v[112:115]
  s_waitcnt vmcnt(8) lgkmcnt(0)
  s_barrier
  v_mfma_f32_16x16x32_bf16 v[116:119], a[152:155], a[28:31], v[116:119]
  s_sub_u32 s35, s35, 1
  v_mfma_f32_16x16x32_bf16 v[116:119], a[176:179], a[64:67], v[116:119]
  s_cmp_lg_u32 s35, 0
  s_cbranch_scc1 Lp2r1_loop
  v_accvgpr_read_b32 v4, a222
  v_accvgpr_read_b32 v5, a223
  v_accvgpr_read_b32 v6, a224
  v_accvgpr_read_b32 v7, a225
  v_accvgpr_read_b32 v8, a226
  v_accvgpr_read_b32 v9, a227
  v_accvgpr_read_b32 v10, a228
  v_accvgpr_read_b32 v11, a229
  s_mov_b32 s8, s64
  s_mov_b32 s9, s65
  s_mov_b32 s10, 4194304
  s_mov_b32 s11, 0x00020000
  s_mov_b32 s20, s68
  s_mov_b32 s21, s69
  s_mov_b32 s22, 8388608
  s_mov_b32 s23, 0x00020000
  s_and_b32 s4, s2, 7
  s_lshl_b32 s4, s4, 1
  s_lshr_b32 s5, s2, 6
  s_lshr_b32 s30, s2, 4
  s_add_u32 s5, s5, s30
  s_and_b32 s53, s5, 3
  s_lshl_b32 s53, s53, 3
  s_or_b32 s53, s53, 0x80000
  s_bfe_u32 s52, 0xf0f02, s53
  s_add_u32 s52, s52, s4
  s_and_b32 s52, s52, 15
  s_mov_b32 s54, s52
  s_mov_b32 s55, s53
  s_lshl_b32 s29, s52, 7
  s_lshl_b32 s28, s54, 19
  s_lshl_b32 s30, s25, 18
  s_and_b32 s31, s25, 1
  s_lshl_b32 s31, s31, 1
  s_add_u32 s31, s31, 14
  s_sub_u32 s31, s31, s25
  s_lshl_b32 s31, s31, 18
  s_or_b32 s26, s30, s29
  s_or_b32 s27, s31, s29
  s_lshl_b32 s68, s3, 12
  s_lshl_b32 s88, s3, 13
  s_add_u32 s88, s88, 98304
  v_mfma_f32_16x16x32_bf16 v[120:123], a[156:159], a[0:3], v[120:123]
  s_mov_b32 m0, s41
  ds_read_b128 a[72:75], v16 offset:0
  v_mfma_f32_16x16x32_bf16 v[120:123], a[180:183], a[36:39], v[120:123]
  buffer_load_dwordx4 v233, s[12:15], s47 offen offset:0 lds
  v_mfma_f32_16x16x32_bf16 v[124:127], a[156:159], a[4:7], v[124:127]
  ds_read_b128 a[108:111], v17 offset:0
  ds_read_b64_tr_b16 a[144:145], v20 offset:0
  v_mfma_f32_16x16x32_bf16 v[124:127], a[180:183], a[40:43], v[124:127]
  v_mfma_f32_16x16x32_bf16 v[128:131], a[156:159], a[8:11], v[128:131]
  ds_read_b64_tr_b16 a[146:147], v20 offset:2048
  v_mfma_f32_16x16x32_bf16 v[128:131], a[180:183], a[44:47], v[128:131]
  ds_read_b64_tr_b16 a[168:169], v20 offset:4096
  v_mfma_f32_16x16x32_bf16 v[132:135], a[156:159], a[12:15], v[132:135]
  v_mfma_f32_16x16x32_bf16 v[132:135], a[180:183], a[48:51], v[132:135]
  ds_read_b64_tr_b16 a[170:171], v20 offset:6144
  v_mfma_f32_16x16x32_bf16 v[136:139], a[156:159], a[16:19], v[136:139]
  ds_read_b128 a[76:79], v16 offset:2048
  v_mfma_f32_16x16x32_bf16 v[136:139], a[180:183], a[52:55], v[136:139]
  ds_read_b128 a[112:115], v17 offset:2048
  v_mfma_f32_16x16x32_bf16 v[140:143], a[156:159], a[20:23], v[140:143]
  v_mfma_f32_16x16x32_bf16 v[140:143], a[180:183], a[56:59], v[140:143]
  ds_read_b128 a[80:83], v16 offset:4096
  v_mfma_f32_16x16x32_bf16 v[144:147], a[156:159], a[24:27], v[144:147]
  ds_read_b128 a[116:119], v17 offset:4096
  v_mfma_f32_16x16x32_bf16 v[144:147], a[180:183], a[60:63], v[144:147]
  v_mfma_f32_16x16x32_bf16 v[148:151], a[156:159], a[28:31], v[148:151]
  ds_read_b128 a[84:87], v16 offset:6144
  v_mfma_f32_16x16x32_bf16 v[148:151], a[180:183], a[64:67], v[148:151]
  ds_read_b128 a[120:123], v17 offset:6144
  v_mfma_f32_16x16x32_bf16 v[152:155], a[0:3], a[160:163], v[152:155]
  ds_read_b128 a[88:91], v16 offset:8192
  v_mfma_f32_16x16x32_bf16 v[152:155], a[36:39], a[184:187], v[152:155]
  buffer_load_dwordx4 v234, s[12:15], s47 offen offset:1024 lds
  v_mfma_f32_16x16x32_bf16 v[156:159], a[4:7], a[160:163], v[156:159]
  ds_read_b128 a[124:127], v17 offset:8192
  v_mfma_f32_16x16x32_bf16 v[156:159], a[40:43], a[184:187], v[156:159]
  ds_read_b128 a[92:95], v16 offset:10240
  v_mfma_f32_16x16x32_bf16 v[160:163], a[8:11], a[160:163], v[160:163]
  v_mfma_f32_16x16x32_bf16 v[160:163], a[44:47], a[184:187], v[160:163]
  ds_read_b128 a[128:131], v17 offset:10240
  v_mfma_f32_16x16x32_bf16 v[164:167], a[12:15], a[160:163], v[164:167]
  ds_read_b128 a[96:99], v16 offset:12288
  v_mfma_f32_16x16x32_bf16 v[164:167], a[48:51], a[184:187], v[164:167]
  ds_read_b128 a[132:135], v17 offset:12288
  v_mfma_f32_16x16x32_bf16 v[168:171], a[16:19], a[160:163], v[168:171]
  v_mfma_f32_16x16x32_bf16 v[168:171], a[52:55], a[184:187], v[168:171]
  ds_read_b128 a[100:103], v16 offset:14336
  v_mfma_f32_16x16x32_bf16 v[172:175], a[20:23], a[160:163], v[172:175]
  ds_read_b128 a[136:139], v17 offset:14336
  v_mfma_f32_16x16x32_bf16 v[172:175], a[56:59], a[184:187], v[172:175]
  v_mfma_f32_16x16x32_bf16 v[176:179], a[24:27], a[160:163], v[176:179]
  ds_read_b64_tr_b16 a[148:149], v21 offset:0
  v_mfma_f32_16x16x32_bf16 v[176:179], a[60:63], a[184:187], v[176:179]
  ds_read_b64_tr_b16 a[150:151], v21 offset:2048
  v_mfma_f32_16x16x32_bf16 v[180:183], a[28:31], a[160:163], v[180:183]
  ds_read_b64_tr_b16 a[172:173], v21 offset:4096
  v_mfma_f32_16x16x32_bf16 v[180:183], a[64:67], a[184:187], v[180:183]
  v_mfma_f32_16x16x32_bf16 v[216:219], a[32:35], a[160:163], v[216:219]
  ds_read_b64_tr_b16 a[174:175], v21 offset:6144
  v_mfma_f32_16x16x32_bf16 v[216:219], a[68:71], a[184:187], v[216:219]
  ds_read_b64_tr_b16 a[152:153], v20 offset:8192
  v_mfma_f32_16x16x32_bf16 v[184:187], a[0:3], a[164:167], v[184:187]
  buffer_load_dwordx4 v235, s[12:15], s47 offen offset:2048 lds
  v_mfma_f32_16x16x32_bf16 v[184:187], a[36:39], a[188:191], v[184:187]
  ds_read_b64_tr_b16 a[154:155], v20 offset:10240
  v_mfma_f32_16x16x32_bf16 v[188:191], a[4:7], a[164:167], v[188:191]
  ds_read_b64_tr_b16 a[176:177], v20 offset:12288
  v_mfma_f32_16x16x32_bf16 v[188:191], a[40:43], a[188:191], v[188:191]
  ds_read_b64_tr_b16 a[178:179], v20 offset:14336
  v_mfma_f32_16x16x32_bf16 v[192:195], a[8:11], a[164:167], v[192:195]
  v_mfma_f32_16x16x32_bf16 v[192:195], a[44:47], a[188:191], v[192:195]
  ds_read_b128 a[104:107], v18 offset:0
  v_mfma_f32_16x16x32_bf16 v[196:199], a[12:15], a[164:167], v[196:199]
  ds_read_b128 a[140:143], v19 offset:0
  v_mfma_f32_16x16x32_bf16 v[196:199], a[48:51], a[188:191], v[196:199]
  v_mfma_f32_16x16x32_bf16 v[200:203], a[16:19], a[164:167], v[200:203]
  v_mfma_f32_16x16x32_bf16 v[200:203], a[52:55], a[188:191], v[200:203]
  v_mfma_f32_16x16x32_bf16 v[204:207], a[20:23], a[164:167], v[204:207]
  v_mfma_f32_16x16x32_bf16 v[204:207], a[56:59], a[188:191], v[204:207]
  v_mfma_f32_16x16x32_bf16 v[208:211], a[24:27], a[164:167], v[208:211]
  v_mfma_f32_16x16x32_bf16 v[208:211], a[60:63], a[188:191], v[208:211]
  v_mfma_f32_16x16x32_bf16 v[212:215], a[28:31], a[164:167], v[212:215]
  v_mfma_f32_16x16x32_bf16 v[212:215], a[64:67], a[188:191], v[212:215]
  v_mfma_f32_16x16x32_bf16 v[220:223], a[32:35], a[164:167], v[220:223]
  v_mfma_f32_16x16x32_bf16 v[220:223], a[68:71], a[188:191], v[220:223]
  s_waitcnt lgkmcnt(0)
  v_mfma_f32_16x16x32_bf16 v[24:27], a[144:147], a[72:75], v[24:27]
  s_add_u32 m0, s41, 3072
  ds_read_b64_tr_b16 a[156:157], v21 offset:8192
  v_mfma_f32_16x16x32_bf16 v[24:27], a[168:171], a[108:111], v[24:27]
  buffer_load_dwordx4 v236, s[12:15], s47 offen offset:0 lds
  v_mfma_f32_16x16x32_bf16 v[28:31], a[144:147], a[76:79], v[28:31]
  s_add_u32 s36, s36, s38
  v_mfma_f32_16x16x32_bf16 v[28:31], a[168:171], a[112:115], v[28:31]
  s_add_u32 s37, s37, 1
  ds_read_b64_tr_b16 a[158:159], v21 offset:10240
  v_mfma_f32_16x16x32_bf16 v[32:35], a[144:147], a[80:83], v[32:35]
  s_cmp_eq_u32 s37, 3
  s_cselect_b32 s37, 0, s37
  s_cselect_b32 s38, s39, s40
  v_mfma_f32_16x16x32_bf16 v[32:35], a[168:171], a[116:119], v[32:35]
  s_add_u32 s41, s41, s43
  v_mfma_f32_16x16x32_bf16 v[36:39], a[144:147], a[84:87], v[36:39]
  s_sub_u32 s43, 0, s43
  ds_read_b64_tr_b16 a[180:181], v21 offset:12288
  v_mfma_f32_16x16x32_bf16 v[36:39], a[168:171], a[120:123], v[36:39]
  v_mfma_f32_16x16x32_bf16 v[40:43], a[144:147], a[88:91], v[40:43]
  v_mfma_f32_16x16x32_bf16 v[40:43], a[168:171], a[124:127], v[40:43]
  ds_read_b64_tr_b16 a[182:183], v21 offset:14336
  v_mfma_f32_16x16x32_bf16 v[44:47], a[144:147], a[92:95], v[44:47]
  v_mfma_f32_16x16x32_bf16 v[44:47], a[168:171], a[128:131], v[44:47]
  v_mfma_f32_16x16x32_bf16 v[48:51], a[144:147], a[96:99], v[48:51]
  ds_read_b64_tr_b16 a[160:161], v20 offset:16384
  v_mfma_f32_16x16x32_bf16 v[48:51], a[168:171], a[132:135], v[48:51]
  buffer_load_dwordx4 v237, s[12:15], s47 offen offset:1024 lds
  v_mfma_f32_16x16x32_bf16 v[52:55], a[144:147], a[100:103], v[52:55]
  v_mfma_f32_16x16x32_bf16 v[52:55], a[168:171], a[136:139], v[52:55]
  ds_read_b64_tr_b16 a[162:163], v20 offset:18432
  v_mfma_f32_16x16x32_bf16 v[56:59], a[148:151], a[72:75], v[56:59]
  v_mfma_f32_16x16x32_bf16 v[56:59], a[172:175], a[108:111], v[56:59]
  v_mfma_f32_16x16x32_bf16 v[60:63], a[148:151], a[76:79], v[60:63]
  v_mfma_f32_16x16x32_bf16 v[60:63], a[172:175], a[112:115], v[60:63]
  ds_read_b64_tr_b16 a[184:185], v20 offset:20480
  v_mfma_f32_16x16x32_bf16 v[64:67], a[148:151], a[80:83], v[64:67]
  v_mfma_f32_16x16x32_bf16 v[64:67], a[172:175], a[116:119], v[64:67]
  v_mfma_f32_16x16x32_bf16 v[68:71], a[148:151], a[84:87], v[68:71]
  ds_read_b64_tr_b16 a[186:187], v20 offset:22528
  v_mfma_f32_16x16x32_bf16 v[68:71], a[172:175], a[120:123], v[68:71]
  v_mfma_f32_16x16x32_bf16 v[72:75], a[148:151], a[88:91], v[72:75]
  v_mfma_f32_16x16x32_bf16 v[72:75], a[172:175], a[124:127], v[72:75]
  ds_read_b64_tr_b16 a[164:165], v21 offset:16384
  v_mfma_f32_16x16x32_bf16 v[76:79], a[148:151], a[92:95], v[76:79]
  v_mfma_f32_16x16x32_bf16 v[76:79], a[172:175], a[128:131], v[76:79]
  buffer_load_dwordx4 v238, s[12:15], s47 offen offset:2048 lds
  v_mfma_f32_16x16x32_bf16 v[80:83], a[148:151], a[96:99], v[80:83]
  ds_read_b64_tr_b16 a[166:167], v21 offset:18432
  v_mfma_f32_16x16x32_bf16 v[80:83], a[172:175], a[132:135], v[80:83]
  v_mfma_f32_16x16x32_bf16 v[84:87], a[148:151], a[100:103], v[84:87]
  v_mfma_f32_16x16x32_bf16 v[84:87], a[172:175], a[136:139], v[84:87]
  ds_read_b64_tr_b16 a[188:189], v21 offset:20480
  v_mfma_f32_16x16x32_bf16 v[88:91], a[152:155], a[72:75], v[88:91]
  v_mfma_f32_16x16x32_bf16 v[88:91], a[176:179], a[108:111], v[88:91]
  v_mfma_f32_16x16x32_bf16 v[92:95], a[152:155], a[76:79], v[92:95]
  ds_read_b64_tr_b16 a[190:191], v21 offset:22528
  v_mfma_f32_16x16x32_bf16 v[92:95], a[176:179], a[112:115], v[92:95]
  v_add_u32 v16, s38, v16
  v_add_u32 v17, s38, v17
  v_mfma_f32_16x16x32_bf16 v[96:99], a[152:155], a[80:83], v[96:99]
  v_add_u32 v18, s38, v18
  v_add_u32 v19, s38, v19
  v_mfma_f32_16x16x32_bf16 v[96:99], a[176:179], a[116:119], v[96:99]
  v_add_u32 v20, s43, v20
  v_add_u32 v21, s43, v21
  v_mfma_f32_16x16x32_bf16 v[100:103], a[152:155], a[84:87], v[100:103]
  v_mfma_f32_16x16x32_bf16 v[100:103], a[176:179], a[120:123], v[100:103]
  v_mfma_f32_16x16x32_bf16 v[104:107], a[152:155], a[88:91], v[104:107]
  v_mfma_f32_16x16x32_bf16 v[104:107], a[176:179], a[124:127], v[104:107]
  v_mfma_f32_16x16x32_bf16 v[108:111], a[152:155], a[92:95], v[108:111]
  v_mfma_f32_16x16x32_bf16 v[108:111], a[176:179], a[128:131], v[108:111]
  v_mfma_f32_16x16x32_bf16 v[112:115], a[152:155], a[96:99], v[112:115]
  v_mfma_f32_16x16x32_bf16 v[112:115], a[176:179], a[132:135], v[112:115]
  v_mfma_f32_16x16x32_bf16 v[116:119], a[152:155], a[100:103], v[116:119]
  v_mfma_f32_16x16x32_bf16 v[116:119], a[176:179], a[136:139], v[116:119]
  s_waitcnt vmcnt(0) lgkmcnt(0)
  s_barrier
  s_mov_b32 s6, 0x3e8293ee
  s_mov_b32 s7, s6
  v_mfma_f32_16x16x32_bf16 v[120:123], a[156:159], a[72:75], v[120:123]
  ds_read_b128 a[0:3], v16 offset:0
  v_mfma_f32_16x16x32_bf16 v[120:123], a[180:183], a[108:111], v[120:123]
  ds_read_b128 a[36:39], v17 offset:0
  v_mfma_f32_16x16x32_bf16 v[124:127], a[156:159], a[76:79], v[124:127]
  ds_read_b64_tr_b16 a[144:145], v20 offset:0
  v_mfma_f32_16x16x32_bf16 v[124:127], a[180:183], a[112:115], v[124:127]
  v_mfma_f32_16x16x32_bf16 v[128:131], a[156:159], a[80:83], v[128:131]
  ds_read_b64_tr_b16 a[146:147], v20 offset:2048
  v_mfma_f32_16x16x32_bf16 v[128:131], a[180:183], a[116:119], v[128:131]
  ds_read_b64_tr_b16 a[168:169], v20 offset:4096
  v_mfma_f32_16x16x32_bf16 v[132:135], a[156:159], a[84:87], v[132:135]
  v_mfma_f32_16x16x32_bf16 v[132:135], a[180:183], a[120:123], v[132:135]
  ds_read_b64_tr_b16 a[170:171], v20 offset:6144
  v_mfma_f32_16x16x32_bf16 v[136:139], a[156:159], a[88:91], v[136:139]
  ds_read_b128 a[4:7], v16 offset:2048
  v_mfma_f32_16x16x32_bf16 v[136:139], a[180:183], a[124:127], v[136:139]
  ds_read_b128 a[40:43], v17 offset:2048
  v_mfma_f32_16x16x32_bf16 v[140:143], a[156:159], a[92:95], v[140:143]
  v_mfma_f32_16x16x32_bf16 v[140:143], a[180:183], a[128:131], v[140:143]
  ds_read_b128 a[8:11], v16 offset:4096
  v_mfma_f32_16x16x32_bf16 v[144:147], a[156:159], a[96:99], v[144:147]
  ds_read_b128 a[44:47], v17 offset:4096
  v_mfma_f32_16x16x32_bf16 v[144:147], a[180:183], a[132:135], v[144:147]
  v_mfma_f32_16x16x32_bf16 v[148:151], a[156:159], a[100:103], v[148:151]
  ds_read_b128 a[12:15], v16 offset:6144
  v_mfma_f32_16x16x32_bf16 v[148:151], a[180:183], a[136:139], v[148:151]
  ds_read_b128 a[48:51], v17 offset:6144
  v_mfma_f32_16x16x32_bf16 v[152:155], a[72:75], a[160:163], v[152:155]
  ds_read_b128 a[16:19], v16 offset:8192
  v_mfma_f32_16x16x32_bf16 v[152:155], a[108:111], a[184:187], v[152:155]
  v_mfma_f32_16x16x32_bf16 v[156:159], a[76:79], a[160:163], v[156:159]
  ds_read_b128 a[52:55], v17 offset:8192
  v_mfma_f32_16x16x32_bf16 v[156:159], a[112:115], a[184:187], v[156:159]
  ds_read_b128 a[20:23], v16 offset:10240
  v_mfma_f32_16x16x32_bf16 v[160:163], a[80:83], a[160:163], v[160:163]
  v_mfma_f32_16x16x32_bf16 v[160:163], a[116:119], a[184:187], v[160:163]
  ds_read_b128 a[56:59], v17 offset:10240
  v_mfma_f32_16x16x32_bf16 v[164:167], a[84:87], a[160:163], v[164:167]
  ds_read_b128 a[24:27], v16 offset:12288
  v_mfma_f32_16x16x32_bf16 v[164:167], a[120:123], a[184:187], v[164:167]
  ds_read_b128 a[60:63], v17 offset:12288
  v_mfma_f32_16x16x32_bf16 v[168:171], a[88:91], a[160:163], v[168:171]
  v_mfma_f32_16x16x32_bf16 v[168:171], a[124:127], a[184:187], v[168:171]
  ds_read_b128 a[28:31], v16 offset:14336
  v_mfma_f32_16x16x32_bf16 v[172:175], a[92:95], a[160:163], v[172:175]
  ds_read_b128 a[64:67], v17 offset:14336
  v_mfma_f32_16x16x32_bf16 v[172:175], a[128:131], a[184:187], v[172:175]
  v_mfma_f32_16x16x32_bf16 v[176:179], a[96:99], a[160:163], v[176:179]
  ds_read_b64_tr_b16 a[148:149], v21 offset:0
  v_mfma_f32_16x16x32_bf16 v[176:179], a[132:135], a[184:187], v[176:179]
  ds_read_b64_tr_b16 a[150:151], v21 offset:2048
  v_mfma_f32_16x16x32_bf16 v[180:183], a[100:103], a[160:163], v[180:183]
  ds_read_b64_tr_b16 a[172:173], v21 offset:4096
  v_mfma_f32_16x16x32_bf16 v[180:183], a[136:139], a[184:187], v[180:183]
  v_mfma_f32_16x16x32_bf16 v[216:219], a[104:107], a[160:163], v[216:219]
  ds_read_b64_tr_b16 a[174:175], v21 offset:6144
  v_mfma_f32_16x16x32_bf16 v[216:219], a[140:143], a[184:187], v[216:219]
  ds_read_b64_tr_b16 a[152:153], v20 offset:8192
  v_mfma_f32_16x16x32_bf16 v[184:187], a[72:75], a[164:167], v[184:187]
  v_mfma_f32_16x16x32_bf16 v[184:187], a[108:111], a[188:191], v[184:187]
  ds_read_b64_tr_b16 a[154:155], v20 offset:10240
  v_mfma_f32_16x16x32_bf16 v[188:191], a[76:79], a[164:167], v[188:191]
  ds_read_b64_tr_b16 a[176:177], v20 offset:12288
  v_mfma_f32_16x16x32_bf16 v[188:191], a[112:115], a[188:191], v[188:191]
  ds_read_b64_tr_b16 a[178:179], v20 offset:14336
  v_mfma_f32_16x16x32_bf16 v[192:195], a[80:83], a[164:167], v[192:195]
  v_mfma_f32_16x16x32_bf16 v[192:195], a[116:119], a[188:191], v[192:195]
  ds_read_b128 a[32:35], v18 offset:0
  v_mfma_f32_16x16x32_bf16 v[196:199], a[84:87], a[164:167], v[196:199]
  ds_read_b128 a[68:71], v19 offset:0
  v_mfma_f32_16x16x32_bf16 v[196:199], a[120:123], a[188:191], v[196:199]
  v_mfma_f32_16x16x32_bf16 v[200:203], a[88:91], a[164:167], v[200:203]
  v_mfma_f32_16x16x32_bf16 v[200:203], a[124:127], a[188:191], v[200:203]
  v_mfma_f32_16x16x32_bf16 v[204:207], a[92:95], a[164:167], v[204:207]
  v_mfma_f32_16x16x32_bf16 v[204:207], a[128:131], a[188:191], v[204:207]
  v_mfma_f32_16x16x32_bf16 v[208:211], a[96:99], a[164:167], v[208:211]
  v_mfma_f32_16x16x32_bf16 v[208:211], a[132:135], a[188:191], v[208:211]
  v_mfma_f32_16x16x32_bf16 v[212:215], a[100:103], a[164:167], v[212:215]
  v_mfma_f32_16x16x32_bf16 v[212:215], a[136:139], a[188:191], v[212:215]
  v_mfma_f32_16x16x32_bf16 v[220:223], a[104:107], a[164:167], v[220:223]
  v_mfma_f32_16x16x32_bf16 v[220:223], a[140:143], a[188:191], v[220:223]
  s_waitcnt lgkmcnt(0)
  v_mfma_f32_16x16x32_bf16 v[24:27], a[144:147], a[0:3], v[24:27]
  ds_read_b64_tr_b16 a[156:157], v21 offset:8192
  ds_read_b64_tr_b16 a[158:159], v21 offset:10240
  v_mfma_f32_16x16x32_bf16 v[24:27], a[168:171], a[36:39], v[24:27]
  ds_read_b64_tr_b16 a[180:181], v21 offset:12288
  ds_read_b64_tr_b16 a[182:183], v21 offset:14336
  v_mfma_f32_16x16x32_bf16 v[28:31], a[144:147], a[4:7], v[28:31]
  ds_read_b64_tr_b16 a[160:161], v20 offset:16384
  ds_read_b64_tr_b16 a[162:163], v20 offset:18432
  v_mfma_f32_16x16x32_bf16 v[28:31], a[168:171], a[40:43], v[28:31]
  ds_read_b64_tr_b16 a[184:185], v20 offset:20480
  v_mfma_f32_16x16x32_bf16 v[32:35], a[144:147], a[8:11], v[32:35]
  ds_read_b64_tr_b16 a[186:187], v20 offset:22528
  ds_read_b64_tr_b16 a[164:165], v21 offset:16384
  v_mfma_f32_16x16x32_bf16 v[32:35], a[168:171], a[44:47], v[32:35]
  ds_read_b64_tr_b16 a[166:167], v21 offset:18432
  ds_read_b64_tr_b16 a[188:189], v21 offset:20480
  v_mfma_f32_16x16x32_bf16 v[36:39], a[144:147], a[12:15], v[36:39]
  ds_read_b64_tr_b16 a[190:191], v21 offset:22528
  v_mfma_f32_16x16x32_bf16 v[36:39], a[168:171], a[48:51], v[36:39]
  v_mfma_f32_16x16x32_bf16 v[40:43], a[144:147], a[16:19], v[40:43]
  v_mfma_f32_16x16x32_bf16 v[40:43], a[168:171], a[52:55], v[40:43]
  v_mfma_f32_16x16x32_bf16 v[44:47], a[144:147], a[20:23], v[44:47]
  v_mfma_f32_16x16x32_bf16 v[44:47], a[168:171], a[56:59], v[44:47]
  v_mfma_f32_16x16x32_bf16 v[48:51], a[144:147], a[24:27], v[48:51]
  v_mfma_f32_16x16x32_bf16 v[48:51], a[168:171], a[60:63], v[48:51]
  v_mfma_f32_16x16x32_bf16 v[52:55], a[144:147], a[28:31], v[52:55]
  v_mfma_f32_16x16x32_bf16 v[52:55], a[168:171], a[64:67], v[52:55]
  v_mfma_f32_16x16x32_bf16 v[56:59], a[148:151], a[0:3], v[56:59]
  v_mfma_f32_16x16x32_bf16 v[56:59], a[172:175], a[36:39], v[56:59]
  v_mfma_f32_16x16x32_bf16 v[60:63], a[148:151], a[4:7], v[60:63]
  v_mfma_f32_16x16x32_bf16 v[60:63], a[172:175], a[40:43], v[60:63]
  v_mfma_f32_16x16x32_bf16 v[64:67], a[148:151], a[8:11], v[64:67]
  v_mfma_f32_16x16x32_bf16 v[64:67], a[172:175], a[44:47], v[64:67]
  v_mfma_f32_16x16x32_bf16 v[68:71], a[148:151], a[12:15], v[68:71]
  v_pk_mul_f32 v[24:25], v[24:25], s[6:7]
  v_pk_mul_f32 v[26:27], v[26:27], s[6:7]
  v_mfma_f32_16x16x32_bf16 v[68:71], a[172:175], a[48:51], v[68:71]
  v_pk_mul_f32 v[56:57], v[56:57], s[6:7]
  v_pk_mul_f32 v[58:59], v[58:59], s[6:7]
  v_mfma_f32_16x16x32_bf16 v[72:75], a[148:151], a[16:19], v[72:75]
  v_cvt_pk_bf16_f32 v24, v24, v25
  v_cvt_pk_bf16_f32 v25, v26, v27
  v_mfma_f32_16x16x32_bf16 v[72:75], a[172:175], a[52:55], v[72:75]
  v_cvt_pk_bf16_f32 v26, v56, v57
  v_cvt_pk_bf16_f32 v27, v58, v59
  v_mfma_f32_16x16x32_bf16 v[76:79], a[148:151], a[20:23], v[76:79]
  v_pk_mul_f32 v[28:29], v[28:29], s[6:7]
  v_pk_mul_f32 v[30:31], v[30:31], s[6:7]
  v_mfma_f32_16x16x32_bf16 v[76:79], a[172:175], a[56:59], v[76:79]
  v_pk_mul_f32 v[60:61], v[60:61], s[6:7]
  v_pk_mul_f32 v[62:63], v[62:63], s[6:7]
  v_mfma_f32_16x16x32_bf16 v[80:83], a[148:151], a[24:27], v[80:83]
  v_cvt_pk_bf16_f32 v28, v28, v29
  v_cvt_pk_bf16_f32 v29, v30, v31
  v_mfma_f32_16x16x32_bf16 v[80:83], a[172:175], a[60:63], v[80:83]
  v_cvt_pk_bf16_f32 v30, v60, v61
  v_cvt_pk_bf16_f32 v31, v62, v63
  v_mfma_f32_16x16x32_bf16 v[84:87], a[148:151], a[28:31], v[84:87]
  v_pk_mul_f32 v[32:33], v[32:33], s[6:7]
  v_pk_mul_f32 v[34:35], v[34:35], s[6:7]
  v_mfma_f32_16x16x32_bf16 v[84:87], a[172:175], a[64:67], v[84:87]
  v_pk_mul_f32 v[64:65], v[64:65], s[6:7]
  v_pk_mul_f32 v[66:67], v[66:67], s[6:7]
  v_mfma_f32_16x16x32_bf16 v[88:91], a[152:155], a[0:3], v[88:91]
  v_cvt_pk_bf16_f32 v32, v32, v33
  v_cvt_pk_bf16_f32 v33, v34, v35
  v_mfma_f32_16x16x32_bf16 v[88:91], a[176:179], a[36:39], v[88:91]
  v_cvt_pk_bf16_f32 v34, v64, v65
  v_cvt_pk_bf16_f32 v35, v66, v67
  v_mfma_f32_16x16x32_bf16 v[92:95], a[152:155], a[4:7], v[92:95]
  v_pk_mul_f32 v[36:37], v[36:37], s[6:7]
  v_pk_mul_f32 v[38:39], v[38:39], s[6:7]
  v_mfma_f32_16x16x32_bf16 v[92:95], a[176:179], a[40:43], v[92:95]
  v_pk_mul_f32 v[68:69], v[68:69], s[6:7]
  v_pk_mul_f32 v[70:71], v[70:71], s[6:7]
  v_mfma_f32_16x16x32_bf16 v[96:99], a[152:155], a[8:11], v[96:99]
  v_cvt_pk_bf16_f32 v36, v36, v37
  v_cvt_pk_bf16_f32 v37, v38, v39
  v_mfma_f32_16x16x32_bf16 v[96:99], a[176:179], a[44:47], v[96:99]
  v_cvt_pk_bf16_f32 v38, v68, v69
  v_cvt_pk_bf16_f32 v39, v70, v71
  v_mfma_f32_16x16x32_bf16 v[100:103], a[152:155], a[12:15], v[100:103]
  v_pk_mul_f32 v[40:41], v[40:41], s[6:7]
  v_pk_mul_f32 v[42:43], v[42:43], s[6:7]
  v_mfma_f32_16x16x32_bf16 v[100:103], a[176:179], a[48:51], v[100:103]
  v_pk_mul_f32 v[72:73], v[72:73], s[6:7]
  v_pk_mul_f32 v[74:75], v[74:75], s[6:7]
  v_mfma_f32_16x16x32_bf16 v[104:107], a[152:155], a[16:19], v[104:107]
  v_cvt_pk_bf16_f32 v40, v40, v41
  v_cvt_pk_bf16_f32 v41, v42, v43
  v_mfma_f32_16x16x32_bf16 v[104:107], a[176:179], a[52:55], v[104:107]
  v_cvt_pk_bf16_f32 v42, v72, v73
  v_cvt_pk_bf16_f32 v43, v74, v75
  v_mfma_f32_16x16x32_bf16 v[108:111], a[152:155], a[20:23], v[108:111]
  v_pk_mul_f32 v[44:45], v[44:45], s[6:7]
  v_pk_mul_f32 v[46:47], v[46:47], s[6:7]
  v_mfma_f32_16x16x32_bf16 v[108:111], a[176:179], a[56:59], v[108:111]
  v_pk_mul_f32 v[76:77], v[76:77], s[6:7]
  v_pk_mul_f32 v[78:79], v[78:79], s[6:7]
  v_mfma_f32_16x16x32_bf16 v[112:115], a[152:155], a[24:27], v[112:115]
  v_cvt_pk_bf16_f32 v44, v44, v45
  v_cvt_pk_bf16_f32 v45, v46, v47
  v_mfma_f32_16x16x32_bf16 v[112:115], a[176:179], a[60:63], v[112:115]
  v_cvt_pk_bf16_f32 v46, v76, v77
  v_cvt_pk_bf16_f32 v47, v78, v79
  v_mfma_f32_16x16x32_bf16 v[116:119], a[152:155], a[28:31], v[116:119]
  v_pk_mul_f32 v[48:49], v[48:49], s[6:7]
  v_pk_mul_f32 v[50:51], v[50:51], s[6:7]
  v_mfma_f32_16x16x32_bf16 v[116:119], a[176:179], a[64:67], v[116:119]
  v_pk_mul_f32 v[80:81], v[80:81], s[6:7]
  v_pk_mul_f32 v[82:83], v[82:83], s[6:7]
  s_waitcnt lgkmcnt(0)
  s_barrier
  s_mov_b32 s12, s84
  s_mov_b32 s13, s85
  s_mov_b32 s14, 256
  s_mov_b32 s15, 0x00020000
  buffer_load_dwordx2 v[22:23], off, s[12:15], 0 sc1
  v_mfma_f32_16x16x32_bf16 v[120:123], a[156:159], a[0:3], v[120:123]
  s_mov_b32 m0, s68
  v_cvt_pk_bf16_f32 v48, v48, v49
  v_cvt_pk_bf16_f32 v49, v50, v51
  v_mfma_f32_16x16x32_bf16 v[120:123], a[180:183], a[36:39], v[120:123]
  buffer_load_dwordx4 v8, s[20:23], s28 offen offset:0 lds
  v_cvt_pk_bf16_f32 v50, v80, v81
  v_mfma_f32_16x16x32_bf16 v[124:127], a[156:159], a[4:7], v[124:127]
  v_cvt_pk_bf16_f32 v51, v82, v83
  v_pk_mul_f32 v[52:53], v[52:53], s[6:7]
  v_mfma_f32_16x16x32_bf16 v[124:127], a[180:183], a[40:43], v[124:127]
  buffer_load_dwordx4 v9, s[20:23], s28 offen offset:1024 lds
  v_pk_mul_f32 v[54:55], v[54:55], s[6:7]
  v_mfma_f32_16x16x32_bf16 v[128:131], a[156:159], a[8:11], v[128:131]
  v_pk_mul_f32 v[84:85], v[84:85], s[6:7]
  v_pk_mul_f32 v[86:87], v[86:87], s[6:7]
  v_mfma_f32_16x16x32_bf16 v[128:131], a[180:183], a[44:47], v[128:131]
  v_cvt_pk_bf16_f32 v52, v52, v53
  v_cvt_pk_bf16_f32 v53, v54, v55
  v_mfma_f32_16x16x32_bf16 v[132:135], a[156:159], a[12:15], v[132:135]
  buffer_load_dwordx4 v10, s[20:23], s28 offen offset:2048 lds
  v_cvt_pk_bf16_f32 v54, v84, v85
  v_mfma_f32_16x16x32_bf16 v[132:135], a[180:183], a[48:51], v[132:135]
  v_cvt_pk_bf16_f32 v55, v86, v87
  v_cvt_pk_bf16_f32 v88, v88, v89
  v_mfma_f32_16x16x32_bf16 v[136:139], a[156:159], a[16:19], v[136:139]
  v_cvt_pk_bf16_f32 v89, v90, v91
  v_cvt_pk_bf16_f32 v90, v120, v121
  v_mfma_f32_16x16x32_bf16 v[136:139], a[180:183], a[52:55], v[136:139]
  buffer_load_dwordx4 v11, s[20:23], s28 offen offset:3072 lds
  v_cvt_pk_bf16_f32 v91, v122, v123
  v_mfma_f32_16x16x32_bf16 v[140:143], a[156:159], a[20:23], v[140:143]
  s_bfe_u32 s56, 0x302010e, s55
  s_add_u32 s54, s54, s56
  s_add_u32 s55, s55, 8
  v_mfma_f32_16x16x32_bf16 v[140:143], a[180:183], a[56:59], v[140:143]
  s_and_b32 s55, s55, 0x8001f
  s_and_b32 s54, s54, 15
  s_lshl_b32 s28, s54, 19
  v_mfma_f32_16x16x32_bf16 v[144:147], a[156:159], a[24:27], v[144:147]
  s_add_u32 m0, s68, 16384
  v_cvt_pk_bf16_f32 v92, v92, v93
  v_cvt_pk_bf16_f32 v93, v94, v95
  v_mfma_f32_16x16x32_bf16 v[144:147], a[180:183], a[60:63], v[144:147]
  buffer_load_dwordx4 v8, s[20:23], s28 offen offset:0 lds
  v_cvt_pk_bf16_f32 v94, v124, v125
  v_mfma_f32_16x16x32_bf16 v[148:151], a[156:159], a[28:31], v[148:151]
  v_cvt_pk_bf16_f32 v95, v126, v127
  v_cvt_pk_bf16_f32 v96, v96, v97
  v_mfma_f32_16x16x32_bf16 v[148:151], a[180:183], a[64:67], v[148:151]
  buffer_load_dwordx4 v9, s[20:23], s28 offen offset:1024 lds
  v_cvt_pk_bf16_f32 v97, v98, v99
  v_mfma_f32_16x16x32_bf16 v[152:155], a[0:3], a[160:163], v[152:155]
  v_cvt_pk_bf16_f32 v98, v128, v129
  v_cvt_pk_bf16_f32 v99, v130, v131
  v_mfma_f32_16x16x32_bf16 v[152:155], a[36:39], a[184:187], v[152:155]
  v_cvt_pk_bf16_f32 v100, v100, v101
  v_cvt_pk_bf16_f32 v101, v102, v103
  v_mfma_f32_16x16x32_bf16 v[156:159], a[4:7], a[160:163], v[156:159]
  v_cvt_pk_bf16_f32 v102, v132, v133
  v_cvt_pk_bf16_f32 v103, v134, v135
  v_mfma_f32_16x16x32_bf16 v[156:159], a[40:43], a[184:187], v[156:159]
  buffer_load_dwordx4 v10, s[20:23], s28 offen offset:2048 lds
  v_cvt_pk_bf16_f32 v104, v104, v105
  v_mfma_f32_16x16x32_bf16 v[160:163], a[8:11], a[160:163], v[160:163]
  v_cvt_pk_bf16_f32 v105, v106, v107
  v_cvt_pk_bf16_f32 v106, v136, v137
  v_mfma_f32_16x16x32_bf16 v[160:163], a[44:47], a[184:187], v[160:163]
  v_cvt_pk_bf16_f32 v107, v138, v139
  v_cvt_pk_bf16_f32 v108, v108, v109
  v_mfma_f32_16x16x32_bf16 v[164:167], a[12:15], a[160:163], v[164:167]
  buffer_load_dwordx4 v11, s[20:23], s28 offen offset:3072 lds
  v_cvt_pk_bf16_f32 v109, v110, v111
  v_mfma_f32_16x16x32_bf16 v[164:167], a[48:51], a[184:187], v[164:167]
  s_bfe_u32 s56, 0x302010e, s55
  s_add_u32 s54, s54, s56
  s_add_u32 s55, s55, 8
  v_mfma_f32_16x16x32_bf16 v[168:171], a[16:19], a[160:163], v[168:171]
  s_and_b32 s55, s55, 0x8001f
  s_and_b32 s54, s54, 15
  s_lshl_b32 s28, s54, 19
  v_mfma_f32_16x16x32_bf16 v[168:171], a[52:55], a[184:187], v[168:171]
  s_mov_b32 m0, s88
  v_cvt_pk_bf16_f32 v110, v140, v141
  v_cvt_pk_bf16_f32 v111, v142, v143
  v_mfma_f32_16x16x32_bf16 v[172:175], a[20:23], a[160:163], v[172:175]
  buffer_load_dwordx4 v4, s[8:11], s26 offen offset:0 lds
  v_cvt_pk_bf16_f32 v112, v112, v113
  v_mfma_f32_16x16x32_bf16 v[172:175], a[56:59], a[184:187], v[172:175]
  v_cvt_pk_bf16_f32 v113, v114, v115
  v_cvt_pk_bf16_f32 v114, v144, v145
  v_mfma_f32_16x16x32_bf16 v[176:179], a[24:27], a[160:163], v[176:179]
  buffer_load_dwordx4 v5, s[8:11], s26 offen offset:1024 lds
  v_cvt_pk_bf16_f32 v115, v146, v147
  v_mfma_f32_16x16x32_bf16 v[176:179], a[60:63], a[184:187], v[176:179]
  v_cvt_pk_bf16_f32 v116, v116, v117
  v_cvt_pk_bf16_f32 v117, v118, v119
  v_mfma_f32_16x16x32_bf16 v[180:183], a[28:31], a[160:163], v[180:183]
  v_cvt_pk_bf16_f32 v118, v148, v149
  v_cvt_pk_bf16_f32 v119, v150, v151
  v_mfma_f32_16x16x32_bf16 v[180:183], a[64:67], a[184:187], v[180:183]
  buffer_load_dwordx4 v6, s[8:11], s26 offen offset:2048 lds
  v_mfma_f32_16x16x32_bf16 v[216:219], a[32:35], a[160:163], v[216:219]
  v_mfma_f32_16x16x32_bf16 v[216:219], a[68:71], a[184:187], v[216:219]
  v_mfma_f32_16x16x32_bf16 v[184:187], a[0:3], a[164:167], v[184:187]
  v_mfma_f32_16x16x32_bf16 v[184:187], a[36:39], a[188:191], v[184:187]
  buffer_load_dwordx4 v7, s[8:11], s26 offen offset:3072 lds
  v_mfma_f32_16x16x32_bf16 v[188:191], a[4:7], a[164:167], v[188:191]
  s_add_u32 m0, s88, 4096
  v_mfma_f32_16x16x32_bf16 v[188:191], a[40:43], a[188:191], v[188:191]
  v_mfma_f32_16x16x32_bf16 v[192:195], a[8:11], a[164:167], v[192:195]
  buffer_load_dwordx4 v4, s[8:11], s27 offen offset:0 lds
  v_mfma_f32_16x16x32_bf16 v[192:195], a[44:47], a[188:191], v[192:195]
  v_mfma_f32_16x16x32_bf16 v[196:199], a[12:15], a[164:167], v[196:199]
  v_mfma_f32_16x16x32_bf16 v[196:199], a[48:51], a[188:191], v[196:199]
  buffer_load_dwordx4 v5, s[8:11], s27 offen offset:1024 lds
  v_mfma_f32_16x16x32_bf16 v[200:203], a[16:19], a[164:167], v[200:203]
  v_mfma_f32_16x16x32_bf16 v[200:203], a[52:55], a[188:191], v[200:203]
  v_mfma_f32_16x16x32_bf16 v[204:207], a[20:23], a[164:167], v[204:207]
  buffer_load_dwordx4 v6, s[8:11], s27 offen offset:2048 lds
  v_mfma_f32_16x16x32_bf16 v[204:207], a[56:59], a[188:191], v[204:207]
  v_mfma_f32_16x16x32_bf16 v[208:211], a[24:27], a[164:167], v[208:211]
  v_mfma_f32_16x16x32_bf16 v[208:211], a[60:63], a[188:191], v[208:211]
  buffer_load_dwordx4 v7, s[8:11], s27 offen offset:3072 lds
  v_mfma_f32_16x16x32_bf16 v[212:215], a[28:31], a[164:167], v[212:215]
  s_bfe_u32 s29, 0x302010e, s53
  s_add_u32 s52, s52, s29
  s_add_u32 s53, s53, 8
  v_mfma_f32_16x16x32_bf16 v[212:215], a[64:67], a[188:191], v[212:215]
  s_and_b32 s53, s53, 0x8001f
  s_and_b32 s52, s52, 15
  s_lshl_b32 s29, s52, 7
  v_mfma_f32_16x16x32_bf16 v[220:223], a[32:35], a[164:167], v[220:223]
  s_or_b32 s26, s30, s29
  s_or_b32 s27, s31, s29
  v_mfma_f32_16x16x32_bf16 v[220:223], a[68:71], a[188:191], v[220:223]
  v_cvt_pk_bf16_f32 v216, v216, v217
  v_cvt_pk_bf16_f32 v217, v218, v219
  s_nop 5
  v_cvt_pk_bf16_f32 v218, v220, v221
  v_cvt_pk_bf16_f32 v219, v222, v223
  ds_write_b128 v252, v[216:219] offset:1024
  v_cvt_pk_bf16_f32 v72, v180, v181
  v_cvt_pk_bf16_f32 v73, v182, v183
  v_cvt_pk_bf16_f32 v136, v212, v213
  v_cvt_pk_bf16_f32 v137, v214, v215
  v_cvt_pk_bf16_f32 v70, v176, v177
  v_cvt_pk_bf16_f32 v71, v178, v179
  v_cvt_pk_bf16_f32 v134, v208, v209
  v_cvt_pk_bf16_f32 v135, v210, v211
  v_cvt_pk_bf16_f32 v68, v172, v173
  v_cvt_pk_bf16_f32 v69, v174, v175
  v_cvt_pk_bf16_f32 v132, v204, v205
  v_cvt_pk_bf16_f32 v133, v206, v207
  v_cvt_pk_bf16_f32 v66, v168, v169
  v_cvt_pk_bf16_f32 v67, v170, v171
  v_cvt_pk_bf16_f32 v130, v200, v201
  v_cvt_pk_bf16_f32 v131, v202, v203
  v_cvt_pk_bf16_f32 v64, v164, v165
  v_cvt_pk_bf16_f32 v65, v166, v167
  v_cvt_pk_bf16_f32 v128, v196, v197
  v_cvt_pk_bf16_f32 v129, v198, v199
  v_cvt_pk_bf16_f32 v62, v160, v161
  v_cvt_pk_bf16_f32 v63, v162, v163
  v_cvt_pk_bf16_f32 v126, v192, v193
  v_cvt_pk_bf16_f32 v127, v194, v195
  v_cvt_pk_bf16_f32 v60, v156, v157
  v_cvt_pk_bf16_f32 v61, v158, v159
  v_cvt_pk_bf16_f32 v124, v188, v189
  v_cvt_pk_bf16_f32 v125, v190, v191
  v_cvt_pk_bf16_f32 v58, v152, v153
  v_cvt_pk_bf16_f32 v59, v154, v155
  v_cvt_pk_bf16_f32 v122, v184, v185
  v_cvt_pk_bf16_f32 v123, v186, v187
  s_waitcnt lgkmcnt(0)
  s_barrier
Lp2_at:
  ds_read_b128 v[76:79], v253
  ds_read_b64 v[56:57], v253 offset:1024
  ds_read_b64 v[120:121], v253 offset:1032
  v_mfma_f32_16x16x32_bf16 v[208:211], v[112:115], v[52:55], v[240:243]
  s_add_u32 m0, s88, 32768
  s_nop 0
  buffer_load_dwordx4 v4, s[8:11], s26 offen offset:0 lds
  v_mfma_f32_16x16x32_bf16 v[212:215], v[116:119], v[52:55], v[244:247]
  v_mfma_f32_16x16x32_bf16 v[200:203], v[108:111], v[48:51], v[240:243]
  v_mfma_f32_16x16x32_bf16 v[204:207], v[112:115], v[48:51], v[244:247]
  v_mfma_f32_16x16x32_bf16 v[192:195], v[104:107], v[44:47], v[240:243]
  v_mfma_f32_16x16x32_bf16 v[196:199], v[108:111], v[44:47], v[244:247]
  v_mfma_f32_16x16x32_bf16 v[184:187], v[100:103], v[40:43], v[240:243]
  v_mfma_f32_16x16x32_bf16 v[188:191], v[104:107], v[40:43], v[244:247]
  v_mfma_f32_16x16x32_bf16 v[176:179], v[96:99], v[36:39], v[240:243]
  v_mfma_f32_16x16x32_bf16 v[180:183], v[100:103], v[36:39], v[244:247]
  v_mfma_f32_16x16x32_bf16 v[168:171], v[92:95], v[32:35], v[240:243]
  v_mfma_f32_16x16x32_bf16 v[172:175], v[96:99], v[32:35], v[244:247]
  v_mfma_f32_16x16x32_bf16 v[160:163], v[88:91], v[28:31], v[240:243]
  buffer_load_dwordx4 v5, s[8:11], s26 offen offset:1024 lds
  v_mfma_f32_16x16x32_bf16 v[164:167], v[92:95], v[28:31], v[244:247]
  s_waitcnt lgkmcnt(0)
  v_mfma_f32_16x16x32_bf16 v[152:155], v[76:79], v[24:27], v[248:251]
  v_mfma_f32_16x16x32_bf16 v[156:159], v[88:91], v[24:27], v[244:247]
  v_max3_f32 v238, v208, v209, v210
  v_max3_f32 v239, v211, v212, v213
  v_max3_f32 v238, v238, v214, v215
  v_max_f32 v238, v238, v239
  v_max3_f32 v236, v200, v201, v202
  v_max3_f32 v237, v203, v204, v205
  v_max3_f32 v236, v236, v206, v207
  v_max_f32 v236, v236, v237
  v_max3_f32 v234, v192, v193, v194
  v_max3_f32 v235, v195, v196, v197
  buffer_load_dwordx4 v6, s[8:11], s26 offen offset:2048 lds
  v_max3_f32 v234, v234, v198, v199
  v_max_f32 v234, v234, v235
  v_max3_f32 v232, v184, v185, v186
  v_max3_f32 v233, v187, v188, v189
  v_max3_f32 v232, v232, v190, v191
  v_max_f32 v232, v232, v233
  v_max3_f32 v230, v176, v177, v178
  v_max3_f32 v231, v179, v180, v181
  v_max3_f32 v230, v230, v182, v183
  v_max_f32 v230, v230, v231
  v_max3_f32 v228, v168, v169, v170
  v_max3_f32 v229, v171, v172, v173
  buffer_load_dwordx4 v7, s[8:11], s26 offen offset:3072 lds
  v_max3_f32 v228, v228, v174, v175
  v_max_f32 v228, v228, v229
  v_max3_f32 v226, v160, v161, v162
  v_max3_f32 v227, v163, v164, v165
  v_max3_f32 v226, v226, v166, v167
  v_max_f32 v226, v226, v227
  v_max3_f32 v224, v152, v153, v154
  v_max3_f32 v225, v155, v156, v157
  v_max3_f32 v224, v224, v158, v159
  v_max_f32 v224, v224, v225
  v_mov_b32 v239, v238
  v_mov_b32 v237, v236
  v_mov_b32 v235, v234
  s_add_u32 m0, s88, 36864
  s_nop 0
  buffer_load_dwordx4 v4, s[8:11], s27 offen offset:0 lds
  v_mov_b32 v233, v232
  v_mov_b32 v231, v230
  v_mov_b32 v229, v228
  v_mov_b32 v227, v226
  v_mov_b32 v225, v224
  v_permlane32_swap_b32 v238, v239
  v_permlane32_swap_b32 v236, v237
  v_permlane32_swap_b32 v234, v235
  v_permlane32_swap_b32 v232, v233
  v_permlane32_swap_b32 v230, v231
  v_permlane32_swap_b32 v228, v229
  v_permlane32_swap_b32 v226, v227
  buffer_load_dwordx4 v5, s[8:11], s27 offen offset:1024 lds
  v_permlane32_swap_b32 v224, v225
  v_max_f32 v238, v238, v239
  v_max_f32 v236, v236, v237
  v_max_f32 v234, v234, v235
  v_max_f32 v232, v232, v233
  v_max_f32 v230, v230, v231
  v_max_f32 v228, v228, v229
  v_max_f32 v226, v226, v227
  v_max_f32 v224, v224, v225
  v_mov_b32 v239, v238
  v_mov_b32 v237, v236
  v_mov_b32 v235, v234
  buffer_load_dwordx4 v6, s[8:11], s27 offen offset:2048 lds
  v_mov_b32 v233, v232
  v_mov_b32 v231, v230
  v_mov_b32 v229, v228
  v_mov_b32 v227, v226
  v_mov_b32 v225, v224
  v_permlane16_swap_b32 v238, v239
  v_permlane16_swap_b32 v236, v237
  v_permlane16_swap_b32 v234, v235
  v_permlane16_swap_b32 v232, v233
  v_permlane16_swap_b32 v230, v231
  v_permlane16_swap_b32 v228, v229
  v_permlane16_swap_b32 v226, v227
  buffer_load_dwordx4 v7, s[8:11], s27 offen offset:3072 lds
  v_permlane16_swap_b32 v224, v225
  v_max_f32 v238, v238, v239
  v_max_f32 v236, v236, v237
  v_max_f32 v234, v234, v235
  v_max_f32 v232, v232, v233
  v_max_f32 v230, v230, v231
  v_max_f32 v228, v228, v229
  v_max_f32 v226, v226, v227
  v_max_f32 v224, v224, v225
  v_sub_f32 v208, v208, v238
  v_sub_f32 v209, v209, v238
  v_sub_f32 v210, v210, v238
  v_sub_f32 v211, v211, v238
  s_bfe_u32 s29, 0x302010e, s53
  s_add_u32 s52, s52, s29
  s_add_u32 s53, s53, 8
  s_and_b32 s53, s53, 0x8001f
  s_and_b32 s52, s52, 15
  s_lshl_b32 s29, s52, 7
  s_or_b32 s26, s30, s29
  s_or_b32 s27, s31, s29
  s_add_u32 m0, s68, 32768
  s_nop 0
  buffer_load_dwordx4 v8, s[20:23], s28 offen offset:0 lds
  v_sub_f32 v212, v212, v238
  v_sub_f32 v213, v213, v238
  v_sub_f32 v214, v214, v238
  v_sub_f32 v215, v215, v238
  v_exp_f32 v208, v208
  v_exp_f32 v209, v209
  v_exp_f32 v210, v210
  v_exp_f32 v211, v211
  v_exp_f32 v212, v212
  v_exp_f32 v213, v213
  v_exp_f32 v214, v214
  v_exp_f32 v215, v215
  buffer_load_dwordx4 v9, s[20:23], s28 offen offset:1024 lds
  v_sub_f32 v200, v200, v236
  v_sub_f32 v201, v201, v236
  v_sub_f32 v202, v202, v236
  v_sub_f32 v203, v203, v236
  v_sub_f32 v204, v204, v236
  v_sub_f32 v205, v205, v236
  v_sub_f32 v206, v206, v236
  v_sub_f32 v207, v207, v236
  v_exp_f32 v200, v200
  v_exp_f32 v201, v201
  v_exp_f32 v202, v202
  v_exp_f32 v203, v203
  buffer_load_dwordx4 v10, s[20:23], s28 offen offset:2048 lds
  v_exp_f32 v204, v204
  v_exp_f32 v205, v205
  v_exp_f32 v206, v206
  v_exp_f32 v207, v207
  v_cvt_pk_bf16_f32 v116, v208, v209
  v_cvt_pk_bf16_f32 v117, v210, v211
  v_cvt_pk_bf16_f32 v118, v212, v213
  v_cvt_pk_bf16_f32 v119, v214, v215
  s_nop 1
  v_mfma_f32_16x16x32_bf16 v[52:55], a[208:211], v[116:119], 0
  v_mfma_f32_16x16x32_bf16 v[208:211], v[70:73], v[116:119], 0
  v_mfma_f32_16x16x32_bf16 v[212:215], v[134:137], v[116:119], 0
  v_sub_f32 v192, v192, v234
  buffer_load_dwordx4 v11, s[20:23], s28 offen offset:3072 lds
  v_sub_f32 v193, v193, v234
  v_sub_f32 v194, v194, v234
  v_sub_f32 v195, v195, v234
  v_sub_f32 v196, v196, v234
  v_sub_f32 v197, v197, v234
  v_sub_f32 v198, v198, v234
  v_sub_f32 v199, v199, v234
  v_exp_f32 v192, v192
  v_exp_f32 v193, v193
  v_exp_f32 v194, v194
  v_exp_f32 v195, v195
  v_exp_f32 v196, v196
  v_exp_f32 v197, v197
  s_bfe_u32 s56, 0x302010e, s55
  s_add_u32 s54, s54, s56
  s_add_u32 s55, s55, 8
  s_and_b32 s55, s55, 0x8001f
  s_and_b32 s54, s54, 15
  s_lshl_b32 s28, s54, 19
  s_add_u32 m0, s88, -32768
  s_nop 0
  buffer_load_dwordx4 v4, s[8:11], s26 offen offset:0 lds
  v_exp_f32 v198, v198
  v_exp_f32 v199, v199
  v_cvt_pk_bf16_f32 v112, v200, v201
  v_cvt_pk_bf16_f32 v113, v202, v203
  v_cvt_pk_bf16_f32 v114, v204, v205
  v_cvt_pk_bf16_f32 v115, v206, v207
  s_nop 1
  v_mfma_f32_16x16x32_bf16 v[48:51], a[208:211], v[112:115], 0
  v_mfma_f32_16x16x32_bf16 v[200:203], v[68:71], v[112:115], 0
  v_mfma_f32_16x16x32_bf16 v[204:207], v[132:135], v[112:115], 0
  v_sub_f32 v184, v184, v232
  v_sub_f32 v185, v185, v232
  v_sub_f32 v186, v186, v232
  buffer_load_dwordx4 v5, s[8:11], s26 offen offset:1024 lds
  v_sub_f32 v187, v187, v232
  v_sub_f32 v188, v188, v232
  v_sub_f32 v189, v189, v232
  v_sub_f32 v190, v190, v232
  v_sub_f32 v191, v191, v232
  v_exp_f32 v184, v184
  v_exp_f32 v185, v185
  v_exp_f32 v186, v186
  v_exp_f32 v187, v187
  v_exp_f32 v188, v188
  v_exp_f32 v189, v189
  v_exp_f32 v190, v190
  buffer_load_dwordx4 v6, s[8:11], s26 offen offset:2048 lds
  v_exp_f32 v191, v191
  v_cvt_pk_bf16_f32 v108, v192, v193
  v_cvt_pk_bf16_f32 v109, v194, v195
  v_cvt_pk_bf16_f32 v110, v196, v197
  v_cvt_pk_bf16_f32 v111, v198, v199
  s_nop 1
  v_mfma_f32_16x16x32_bf16 v[44:47], a[208:211], v[108:111], 0
  v_mfma_f32_16x16x32_bf16 v[192:195], v[66:69], v[108:111], 0
  v_mfma_f32_16x16x32_bf16 v[196:199], v[130:133], v[108:111], 0
  v_sub_f32 v176, v176, v230
  v_sub_f32 v177, v177, v230
  v_sub_f32 v178, v178, v230
  v_sub_f32 v179, v179, v230
  buffer_load_dwordx4 v7, s[8:11], s26 offen offset:3072 lds
  v_sub_f32 v180, v180, v230
  v_sub_f32 v181, v181, v230
  v_sub_f32 v182, v182, v230
  v_sub_f32 v183, v183, v230
  v_exp_f32 v176, v176
  v_exp_f32 v177, v177
  v_exp_f32 v178, v178
  v_exp_f32 v179, v179
  v_exp_f32 v180, v180
  v_exp_f32 v181, v181
  v_exp_f32 v182, v182
  v_exp_f32 v183, v183
  v_cvt_pk_bf16_f32 v104, v184, v185
  s_add_u32 m0, s88, -28672
  s_nop 0
  buffer_load_dwordx4 v4, s[8:11], s27 offen offset:0 lds
  v_cvt_pk_bf16_f32 v105, v186, v187
  v_cvt_pk_bf16_f32 v106, v188, v189
  v_cvt_pk_bf16_f32 v107, v190, v191
  s_nop 1
  v_mfma_f32_16x16x32_bf16 v[40:43], a[208:211], v[104:107], 0
  v_mfma_f32_16x16x32_bf16 v[184:187], v[64:67], v[104:107], 0
  v_mfma_f32_16x16x32_bf16 v[188:191], v[128:131], v[104:107], 0
  v_sub_f32 v168, v168, v228
  v_sub_f32 v169, v169, v228
  v_sub_f32 v170, v170, v228
  v_sub_f32 v171, v171, v228
  v_sub_f32 v172, v172, v228
  v_sub_f32 v173, v173, v228
  buffer_load_dwordx4 v5, s[8:11], s27 offen offset:1024 lds
  v_sub_f32 v174, v174, v228
  v_sub_f32 v175, v175, v228
  v_exp_f32 v168, v168
  v_exp_f32 v169, v169
  v_exp_f32 v170, v170
  v_exp_f32 v171, v171
  v_exp_f32 v172, v172
  v_exp_f32 v173, v173
  v_exp_f32 v174, v174
  v_exp_f32 v175, v175
  v_cvt_pk_bf16_f32 v100, v176, v177
  v_cvt_pk_bf16_f32 v101, v178, v179
  buffer_load_dwordx4 v6, s[8:11], s27 offen offset:2048 lds
  v_cvt_pk_bf16_f32 v102, v180, v181
  v_cvt_pk_bf16_f32 v103, v182, v183
  s_nop 1
  v_mfma_f32_16x16x32_bf16 v[36:39], a[208:211], v[100:103], 0
  v_mfma_f32_16x16x32_bf16 v[176:179], v[62:65], v[100:103], 0
  v_mfma_f32_16x16x32_bf16 v[180:183], v[126:129], v[100:103], 0
  v_sub_f32 v160, v160, v226
  v_sub_f32 v161, v161, v226
  v_sub_f32 v162, v162, v226
  v_sub_f32 v163, v163, v226
  v_sub_f32 v164, v164, v226
  v_sub_f32 v165, v165, v226
  v_sub_f32 v166, v166, v226
  buffer_load_dwordx4 v7, s[8:11], s27 offen offset:3072 lds
  s_bfe_u32 s29, 0x302010e, s53
  s_add_u32 s52, s52, s29
  s_add_u32 s53, s53, 8
  s_and_b32 s53, s53, 0x8001f
  s_and_b32 s52, s52, 15
  s_lshl_b32 s29, s52, 7
  s_or_b32 s26, s30, s29
  s_or_b32 s27, s31, s29
  v_sub_f32 v167, v167, v226
  v_exp_f32 v160, v160
  v_exp_f32 v161, v161
  v_exp_f32 v162, v162
  v_exp_f32 v163, v163
  v_exp_f32 v164, v164
  v_exp_f32 v165, v165
  v_exp_f32 v166, v166
  v_exp_f32 v167, v167
  v_cvt_pk_bf16_f32 v96, v168, v169
  v_cvt_pk_bf16_f32 v97, v170, v171
  v_cvt_pk_bf16_f32 v98, v172, v173
  v_cvt_pk_bf16_f32 v99, v174, v175
  s_nop 1
  v_mfma_f32_16x16x32_bf16 v[32:35], a[208:211], v[96:99], 0
  v_mfma_f32_16x16x32_bf16 v[168:171], v[60:63], v[96:99], 0
  v_mfma_f32_16x16x32_bf16 v[172:175], v[124:127], v[96:99], 0
  v_sub_f32 v152, v152, v224
  v_sub_f32 v153, v153, v224
  v_sub_f32 v154, v154, v224
  v_sub_f32 v155, v155, v224
  v_sub_f32 v156, v156, v224
  v_sub_f32 v157, v157, v224
  v_sub_f32 v158, v158, v224
  v_sub_f32 v159, v159, v224
  v_exp_f32 v152, v152
  v_exp_f32 v153, v153
  v_exp_f32 v154, v154
  v_exp_f32 v155, v155
  v_exp_f32 v156, v156
  v_exp_f32 v157, v157
  v_exp_f32 v158, v158
  v_exp_f32 v159, v159
  v_cvt_pk_bf16_f32 v92, v160, v161
  v_cvt_pk_bf16_f32 v93, v162, v163
  v_cvt_pk_bf16_f32 v94, v164, v165
  v_cvt_pk_bf16_f32 v95, v166, v167
  s_nop 1
  v_mfma_f32_16x16x32_bf16 v[28:31], a[208:211], v[92:95], 0
  v_mfma_f32_16x16x32_bf16 v[160:163], v[58:61], v[92:95], 0
  v_mfma_f32_16x16x32_bf16 v[164:167], v[122:125], v[92:95], 0
  v_cvt_pk_bf16_f32 v88, v152, v153
  v_cvt_pk_bf16_f32 v89, v154, v155
  v_cvt_pk_bf16_f32 v90, v156, v157
  v_cvt_pk_bf16_f32 v91, v158, v159
  s_nop 1
  v_mfma_f32_16x16x32_bf16 v[24:27], a[208:211], v[88:91], 0
  v_mfma_f32_16x16x32_bf16 v[152:155], v[56:59], v[88:91], 0
  v_mfma_f32_16x16x32_bf16 v[156:159], v[120:123], v[88:91], 0
  v_rcp_f32 v52, v52
  v_rcp_f32 v48, v48
  v_rcp_f32 v44, v44
  v_rcp_f32 v40, v40
  v_rcp_f32 v36, v36
  v_rcp_f32 v32, v32
  v_rcp_f32 v28, v28
  v_rcp_f32 v24, v24
  v_mov_b32 v53, v52
  v_mov_b32 v49, v48
  v_mov_b32 v45, v44
  v_mov_b32 v41, v40
  v_mov_b32 v37, v36
  v_mov_b32 v33, v32
  v_mov_b32 v29, v28
  v_mov_b32 v25, v24
  v_pk_mul_f32 v[208:209], v[208:209], v[52:53]
  v_pk_mul_f32 v[210:211], v[210:211], v[52:53]
  v_pk_mul_f32 v[212:213], v[212:213], v[52:53]
  v_pk_mul_f32 v[214:215], v[214:215], v[52:53]
  v_cvt_pk_bf16_f32 v208, v208, v209
  v_cvt_pk_bf16_f32 v209, v210, v211
  v_cvt_pk_bf16_f32 v210, v212, v213
  v_cvt_pk_bf16_f32 v211, v214, v215
  buffer_store_dwordx4 v[208:211], v2, s[16:19], s58 offen offset:3072 sc1
  v_pk_mul_f32 v[200:201], v[200:201], v[48:49]
  v_pk_mul_f32 v[202:203], v[202:203], v[48:49]
  v_pk_mul_f32 v[204:205], v[204:205], v[48:49]
  v_pk_mul_f32 v[206:207], v[206:207], v[48:49]
  v_cvt_pk_bf16_f32 v200, v200, v201
  v_cvt_pk_bf16_f32 v201, v202, v203
  v_cvt_pk_bf16_f32 v202, v204, v205
  v_cvt_pk_bf16_f32 v203, v206, v207
  buffer_store_dwordx4 v[200:203], v2, s[16:19], s58 offen offset:2048 sc1
  v_pk_mul_f32 v[192:193], v[192:193], v[44:45]
  v_pk_mul_f32 v[194:195], v[194:195], v[44:45]
  v_pk_mul_f32 v[196:197], v[196:197], v[44:45]
  v_pk_mul_f32 v[198:199], v[198:199], v[44:45]
  v_cvt_pk_bf16_f32 v192, v192, v193
  v_cvt_pk_bf16_f32 v193, v194, v195
  v_cvt_pk_bf16_f32 v194, v196, v197
  v_cvt_pk_bf16_f32 v195, v198, v199
  buffer_store_dwordx4 v[192:195], v2, s[16:19], s58 offen offset:1024 sc1
  v_pk_mul_f32 v[184:185], v[184:185], v[40:41]
  v_pk_mul_f32 v[186:187], v[186:187], v[40:41]
  v_pk_mul_f32 v[188:189], v[188:189], v[40:41]
  v_pk_mul_f32 v[190:191], v[190:191], v[40:41]
  v_cvt_pk_bf16_f32 v184, v184, v185
  v_cvt_pk_bf16_f32 v185, v186, v187
  v_cvt_pk_bf16_f32 v186, v188, v189
  v_cvt_pk_bf16_f32 v187, v190, v191
  buffer_store_dwordx4 v[184:187], v2, s[16:19], s58 offen offset:0 sc1
  v_pk_mul_f32 v[176:177], v[176:177], v[36:37]
  v_pk_mul_f32 v[178:179], v[178:179], v[36:37]
  v_pk_mul_f32 v[180:181], v[180:181], v[36:37]
  v_pk_mul_f32 v[182:183], v[182:183], v[36:37]
  v_cvt_pk_bf16_f32 v176, v176, v177
  v_cvt_pk_bf16_f32 v177, v178, v179
  v_cvt_pk_bf16_f32 v178, v180, v181
  v_cvt_pk_bf16_f32 v179, v182, v183
  buffer_store_dwordx4 v[176:179], v2, s[16:19], s57 offen offset:3072 sc1
  v_pk_mul_f32 v[168:169], v[168:169], v[32:33]
  v_pk_mul_f32 v[170:171], v[170:171], v[32:33]
  v_pk_mul_f32 v[172:173], v[172:173], v[32:33]
  v_pk_mul_f32 v[174:175], v[174:175], v[32:33]
  v_cvt_pk_bf16_f32 v168, v168, v169
  v_cvt_pk_bf16_f32 v169, v170, v171
  v_cvt_pk_bf16_f32 v170, v172, v173
  v_cvt_pk_bf16_f32 v171, v174, v175
  buffer_store_dwordx4 v[168:171], v2, s[16:19], s57 offen offset:2048 sc1
  v_pk_mul_f32 v[160:161], v[160:161], v[28:29]
  v_pk_mul_f32 v[162:163], v[162:163], v[28:29]
  v_pk_mul_f32 v[164:165], v[164:165], v[28:29]
  v_pk_mul_f32 v[166:167], v[166:167], v[28:29]
  v_cvt_pk_bf16_f32 v160, v160, v161
  v_cvt_pk_bf16_f32 v161, v162, v163
  v_cvt_pk_bf16_f32 v162, v164, v165
  v_cvt_pk_bf16_f32 v163, v166, v167
  buffer_store_dwordx4 v[160:163], v2, s[16:19], s57 offen offset:1024 sc1
  v_pk_mul_f32 v[152:153], v[152:153], v[24:25]
  v_pk_mul_f32 v[154:155], v[154:155], v[24:25]
  v_pk_mul_f32 v[156:157], v[156:157], v[24:25]
  v_pk_mul_f32 v[158:159], v[158:159], v[24:25]
  v_cvt_pk_bf16_f32 v152, v152, v153
  v_cvt_pk_bf16_f32 v153, v154, v155
  v_cvt_pk_bf16_f32 v154, v156, v157
  v_cvt_pk_bf16_f32 v155, v158, v159
  buffer_store_dwordx4 v[152:155], v2, s[16:19], s57 offen offset:0 sc1
  s_lshl_b32 s34, s32, 4
  s_add_u32 s34, s34, s33
  s_lshl_b32 s34, s34, 7
  s_add_u32 s34, s34, 32768
  s_mov_b32 s63, 0x70000000
Lp3:
  v_accvgpr_read_b32 v16, a230
  v_accvgpr_read_b32 v17, a231
  v_accvgpr_read_b32 v18, a232
  v_accvgpr_read_b32 v19, a233
  v_accvgpr_read_b32 v20, a234
  v_accvgpr_read_b32 v21, a235
  s_mov_b32 s89, 0
  s_mov_b32 s91, 4294901760
  s_mov_b32 s92, 32768
  s_mov_b32 s89, 1
  s_mov_b32 s69, 0
  s_mov_b32 s71, 4294934528
  s_mov_b32 s72, 16384
  s_waitcnt vmcnt(28)
  s_barrier
  ds_read_b128 a[32:35], v16 offset:0
  ds_read_b128 a[48:51], v17 offset:0
  ds_read_b64_tr_b16 a[64:65], v18 offset:0
  ds_read_b64_tr_b16 a[66:67], v18 offset:2048
  ds_read_b64_tr_b16 a[96:97], v18 offset:4096
  ds_read_b64_tr_b16 a[98:99], v18 offset:6144
  ds_read_b128 a[36:39], v16 offset:2048
  ds_read_b128 a[52:55], v17 offset:2048
  ds_read_b128 a[40:43], v16 offset:4096
  ds_read_b128 a[56:59], v17 offset:4096
  ds_read_b128 a[44:47], v16 offset:6144
  ds_read_b128 a[60:63], v17 offset:6144
  ds_read_b64_tr_b16 a[68:69], v19 offset:0
  ds_read_b64_tr_b16 a[70:71], v19 offset:2048
  ds_read_b64_tr_b16 a[100:101], v19 offset:4096
  ds_read_b64_tr_b16 a[102:103], v19 offset:6144
  ds_read_b64_tr_b16 a[72:73], v20 offset:0
  ds_read_b64_tr_b16 a[74:75], v20 offset:2048
  ds_read_b64_tr_b16 a[104:105], v20 offset:4096
  ds_read_b64_tr_b16 a[106:107], v20 offset:6144
  ds_read_b64_tr_b16 a[76:77], v21 offset:0
  ds_read_b64_tr_b16 a[78:79], v21 offset:2048
  ds_read_b64_tr_b16 a[108:109], v21 offset:4096
  ds_read_b64_tr_b16 a[110:111], v21 offset:6144
  s_waitcnt lgkmcnt(0)
  v_mfma_f32_16x16x32_bf16 v[32:35], a[64:67], a[32:35], 0
  s_add_u32 s60, s63, 32768
  ds_read_b64_tr_b16 a[80:81], v18 offset:8192
  v_mfma_f32_16x16x32_bf16 v[32:35], a[96:99], a[48:51], v[32:35]
  buffer_store_dwordx4 v[192:195], v2, s[16:19], s60 offen offset:0 sc1
  v_mfma_f32_16x16x32_bf16 v[64:67], a[64:67], a[36:39], 0
  s_add_u32 s60, s63, 40960
  ds_read_b64_tr_b16 a[82:83], v18 offset:10240
  ds_read_b64_tr_b16 a[112:113], v18 offset:12288
  v_mfma_f32_16x16x32_bf16 v[64:67], a[96:99], a[52:55], v[64:67]
  buffer_store_dwordx4 v[224:227], v2, s[16:19], s60 offen offset:0 sc1
  v_mfma_f32_16x16x32_bf16 v[96:99], a[64:67], a[40:43], 0
  s_add_u32 s60, s63, 32768
  ds_read_b64_tr_b16 a[114:115], v18 offset:14336
  v_mfma_f32_16x16x32_bf16 v[96:99], a[96:99], a[56:59], v[96:99]
  s_add_u32 s89, s89, 1
  ds_read_b64_tr_b16 a[84:85], v19 offset:8192
  v_mfma_f32_16x16x32_bf16 v[128:131], a[64:67], a[44:47], 0
  buffer_store_dwordx4 v[196:199], v2, s[16:19], s60 offen offset:1024 sc1
  v_mfma_f32_16x16x32_bf16 v[128:131], a[96:99], a[60:63], v[128:131]
  s_add_u32 s60, s63, 40960
  ds_read_b64_tr_b16 a[86:87], v19 offset:10240
  v_mfma_f32_16x16x32_bf16 v[36:39], a[68:71], a[32:35], 0
  ds_read_b64_tr_b16 a[116:117], v19 offset:12288
  v_mfma_f32_16x16x32_bf16 v[36:39], a[100:103], a[48:51], v[36:39]
  buffer_store_dwordx4 v[228:231], v2, s[16:19], s60 offen offset:1024 sc1
  v_mfma_f32_16x16x32_bf16 v[68:71], a[68:71], a[36:39], 0
  s_add_u32 s60, s63, 32768
  ds_read_b64_tr_b16 a[118:119], v19 offset:14336
  v_mfma_f32_16x16x32_bf16 v[68:71], a[100:103], a[52:55], v[68:71]
  ds_read_b64_tr_b16 a[88:89], v20 offset:8192
  v_mfma_f32_16x16x32_bf16 v[100:103], a[68:71], a[40:43], 0
  buffer_store_dwordx4 v[200:203], v2, s[16:19], s60 offen offset:2048 sc1
  v_mfma_f32_16x16x32_bf16 v[100:103], a[100:103], a[56:59], v[100:103]
  s_add_u32 s60, s63, 40960
  ds_read_b64_tr_b16 a[90:91], v20 offset:10240
  ds_read_b64_tr_b16 a[120:121], v20 offset:12288
  v_mfma_f32_16x16x32_bf16 v[132:135], a[68:71], a[44:47], 0
  s_cmp_eq_u32 s89, 3
  s_cselect_b32 s89, 0, s89
  s_cselect_b32 s90, s91, s92
  v_mfma_f32_16x16x32_bf16 v[132:135], a[100:103], a[60:63], v[132:135]
  buffer_store_dwordx4 v[232:235], v2, s[16:19], s60 offen offset:2048 sc1
  v_mfma_f32_16x16x32_bf16 v[40:43], a[72:75], a[32:35], 0
  s_add_u32 s60, s63, 32768
  ds_read_b64_tr_b16 a[122:123], v20 offset:14336
  ds_read_b64_tr_b16 a[92:93], v21 offset:8192
  v_mfma_f32_16x16x32_bf16 v[40:43], a[104:107], a[48:51], v[40:43]
  s_add_u32 s69, s69, 1
  ds_read_b64_tr_b16 a[94:95], v21 offset:10240
  v_mfma_f32_16x16x32_bf16 v[72:75], a[72:75], a[36:39], 0
  buffer_store_dwordx4 v[204:207], v2, s[16:19], s60 offen offset:3072 sc1
  v_mfma_f32_16x16x32_bf16 v[72:75], a[104:107], a[52:55], v[72:75]
  s_add_u32 s60, s63, 40960
  ds_read_b64_tr_b16 a[124:125], v21 offset:12288
  v_mfma_f32_16x16x32_bf16 v[104:107], a[72:75], a[40:43], 0
  ds_read_b64_tr_b16 a[126:127], v21 offset:14336
  v_mfma_f32_16x16x32_bf16 v[104:107], a[104:107], a[56:59], v[104:107]
  buffer_store_dwordx4 v[236:239], v2, s[16:19], s60 offen offset:3072 sc1
  v_mfma_f32_16x16x32_bf16 v[136:139], a[72:75], a[44:47], 0
  s_cmp_eq_u32 s69, 3
  s_cselect_b32 s69, 0, s69
  s_cselect_b32 s70, s71, s72
  v_mfma_f32_16x16x32_bf16 v[136:139], a[104:107], a[60:63], v[136:139]
  v_add_u32 v16, s90, v16
  v_add_u32 v17, s90, v17
  v_mfma_f32_16x16x32_bf16 v[44:47], a[76:79], a[32:35], 0
  v_add_u32 v18, s70, v18
  v_add_u32 v19, s70, v19
  v_mfma_f32_16x16x32_bf16 v[44:47], a[108:111], a[48:51], v[44:47]
  v_add_u32 v20, s70, v20
  v_add_u32 v21, s70, v21
  v_mfma_f32_16x16x32_bf16 v[76:79], a[76:79], a[36:39], 0
  v_mfma_f32_16x16x32_bf16 v[76:79], a[108:111], a[52:55], v[76:79]
  v_mfma_f32_16x16x32_bf16 v[108:111], a[76:79], a[40:43], 0
  v_mfma_f32_16x16x32_bf16 v[108:111], a[108:111], a[56:59], v[108:111]
  v_mfma_f32_16x16x32_bf16 v[140:143], a[76:79], a[44:47], 0
  v_mfma_f32_16x16x32_bf16 v[140:143], a[108:111], a[60:63], v[140:143]
  s_waitcnt vmcnt(20) lgkmcnt(0)
  s_barrier
  v_mfma_f32_16x16x32_bf16 v[48:51], a[80:83], a[32:35], 0
  s_mov_b32 m0, s68
  ds_read_b128 a[0:3], v16 offset:0
  ds_read_b128 a[16:19], v17 offset:0
  v_mfma_f32_16x16x32_bf16 v[48:51], a[112:115], a[48:51], v[48:51]
  buffer_load_dwordx4 v8, s[20:23], s28 offen offset:0 lds
  v_mfma_f32_16x16x32_bf16 v[80:83], a[80:83], a[36:39], 0
  ds_read_b64_tr_b16 a[64:65], v18 offset:0
  ds_read_b64_tr_b16 a[66:67], v18 offset:2048
  v_mfma_f32_16x16x32_bf16 v[80:83], a[112:115], a[52:55], v[80:83]
  ds_read_b64_tr_b16 a[96:97], v18 offset:4096
  v_mfma_f32_16x16x32_bf16 v[112:115], a[80:83], a[40:43], 0
  ds_read_b64_tr_b16 a[98:99], v18 offset:6144
  v_mfma_f32_16x16x32_bf16 v[112:115], a[112:115], a[56:59], v[112:115]
  buffer_load_dwordx4 v9, s[20:23], s28 offen offset:1024 lds
  v_mfma_f32_16x16x32_bf16 v[144:147], a[80:83], a[44:47], 0
  ds_read_b128 a[4:7], v16 offset:2048
  ds_read_b128 a[20:23], v17 offset:2048
  v_mfma_f32_16x16x32_bf16 v[144:147], a[112:115], a[60:63], v[144:147]
  ds_read_b128 a[8:11], v16 offset:4096
  v_mfma_f32_16x16x32_bf16 v[52:55], a[84:87], a[32:35], 0
  ds_read_b128 a[24:27], v17 offset:4096
  v_mfma_f32_16x16x32_bf16 v[52:55], a[116:119], a[48:51], v[52:55]
  ds_read_b128 a[12:15], v16 offset:6144
  v_mfma_f32_16x16x32_bf16 v[84:87], a[84:87], a[36:39], 0
  buffer_load_dwordx4 v10, s[20:23], s28 offen offset:2048 lds
  v_mfma_f32_16x16x32_bf16 v[84:87], a[116:119], a[52:55], v[84:87]
  ds_read_b128 a[28:31], v17 offset:6144
  ds_read_b64_tr_b16 a[68:69], v19 offset:0
  v_mfma_f32_16x16x32_bf16 v[116:119], a[84:87], a[40:43], 0
  ds_read_b64_tr_b16 a[70:71], v19 offset:2048
  ds_read_b64_tr_b16 a[100:101], v19 offset:4096
  v_mfma_f32_16x16x32_bf16 v[116:119], a[116:119], a[56:59], v[116:119]
  ds_read_b64_tr_b16 a[102:103], v19 offset:6144
  v_mfma_f32_16x16x32_bf16 v[148:151], a[84:87], a[44:47], 0
  ds_read_b64_tr_b16 a[72:73], v20 offset:0
  v_mfma_f32_16x16x32_bf16 v[148:151], a[116:119], a[60:63], v[148:151]
  buffer_load_dwordx4 v11, s[20:23], s28 offen offset:3072 lds
  v_mfma_f32_16x16x32_bf16 v[56:59], a[88:91], a[32:35], 0
  s_bfe_u32 s56, 0x302010e, s55
  s_add_u32 s54, s54, s56
  s_add_u32 s55, s55, 8
  v_mfma_f32_16x16x32_bf16 v[56:59], a[120:123], a[48:51], v[56:59]
  s_and_b32 s55, s55, 0x8001f
  s_and_b32 s54, s54, 15
  s_lshl_b32 s28, s54, 19
  v_mfma_f32_16x16x32_bf16 v[88:91], a[88:91], a[36:39], 0
  s_mov_b32 m0, s88
  ds_read_b64_tr_b16 a[74:75], v20 offset:2048
  ds_read_b64_tr_b16 a[104:105], v20 offset:4096
  v_mfma_f32_16x16x32_bf16 v[88:91], a[120:123], a[52:55], v[88:91]
  ds_read_b64_tr_b16 a[106:107], v20 offset:6144
  ds_read_b64_tr_b16 a[76:77], v21 offset:0
  v_mfma_f32_16x16x32_bf16 v[120:123], a[88:91], a[40:43], 0
  buffer_load_dwordx4 v4, s[8:11], s26 offen offset:0 lds
  v_mfma_f32_16x16x32_bf16 v[120:123], a[120:123], a[56:59], v[120:123]
  ds_read_b64_tr_b16 a[78:79], v21 offset:2048
  ds_read_b64_tr_b16 a[108:109], v21 offset:4096
  v_mfma_f32_16x16x32_bf16 v[152:155], a[88:91], a[44:47], 0
  ds_read_b64_tr_b16 a[110:111], v21 offset:6144
  v_mfma_f32_16x16x32_bf16 v[152:155], a[120:123], a[60:63], v[152:155]
  v_mfma_f32_16x16x32_bf16 v[60:63], a[92:95], a[32:35], 0
  v_mfma_f32_16x16x32_bf16 v[60:63], a[124:127], a[48:51], v[60:63]
  buffer_load_dwordx4 v5, s[8:11], s26 offen offset:1024 lds
  v_mfma_f32_16x16x32_bf16 v[92:95], a[92:95], a[36:39], 0
  v_mfma_f32_16x16x32_bf16 v[92:95], a[124:127], a[52:55], v[92:95]
  v_mfma_f32_16x16x32_bf16 v[124:127], a[92:95], a[40:43], 0
  v_mfma_f32_16x16x32_bf16 v[124:127], a[124:127], a[56:59], v[124:127]
  v_mfma_f32_16x16x32_bf16 v[156:159], a[92:95], a[44:47], 0
  v_mfma_f32_16x16x32_bf16 v[156:159], a[124:127], a[60:63], v[156:159]
  s_waitcnt lgkmcnt(0)
  v_mfma_f32_16x16x32_bf16 v[32:35], a[64:67], a[0:3], v[32:35]
  buffer_load_dwordx4 v6, s[8:11], s26 offen offset:2048 lds
  v_mfma_f32_16x16x32_bf16 v[32:35], a[96:99], a[16:19], v[32:35]
  ds_read_b64_tr_b16 a[80:81], v18 offset:8192
  ds_read_b64_tr_b16 a[82:83], v18 offset:10240
  v_mfma_f32_16x16x32_bf16 v[64:67], a[64:67], a[4:7], v[64:67]
  ds_read_b64_tr_b16 a[112:113], v18 offset:12288
  v_mfma_f32_16x16x32_bf16 v[64:67], a[96:99], a[20:23], v[64:67]
  v_mfma_f32_16x16x32_bf16 v[96:99], a[64:67], a[8:11], v[96:99]
  buffer_load_dwordx4 v7, s[8:11], s26 offen offset:3072 lds
  v_mfma_f32_16x16x32_bf16 v[96:99], a[96:99], a[24:27], v[96:99]
  s_add_u32 m0, s88, 4096
  ds_read_b64_tr_b16 a[114:115], v18 offset:14336
  ds_read_b64_tr_b16 a[84:85], v19 offset:8192
  v_mfma_f32_16x16x32_bf16 v[128:131], a[64:67], a[12:15], v[128:131]
  s_add_u32 s88, s88, s90
  ds_read_b64_tr_b16 a[86:87], v19 offset:10240
  v_mfma_f32_16x16x32_bf16 v[128:131], a[96:99], a[28:31], v[128:131]
  s_add_u32 s89, s89, 1
  v_mfma_f32_16x16x32_bf16 v[36:39], a[68:71], a[0:3], v[36:39]
  buffer_load_dwordx4 v4, s[8:11], s27 offen offset:0 lds
  v_mfma_f32_16x16x32_bf16 v[36:39], a[100:103], a[16:19], v[36:39]
  ds_read_b64_tr_b16 a[116:117], v19 offset:12288
  ds_read_b64_tr_b16 a[118:119], v19 offset:14336
  v_mfma_f32_16x16x32_bf16 v[68:71], a[68:71], a[4:7], v[68:71]
  s_cmp_eq_u32 s89, 3
  s_cselect_b32 s89, 0, s89
  s_cselect_b32 s90, s91, s92
  v_mfma_f32_16x16x32_bf16 v[68:71], a[100:103], a[20:23], v[68:71]
  s_add_u32 s68, s68, s70
  ds_read_b64_tr_b16 a[88:89], v20 offset:8192
  v_mfma_f32_16x16x32_bf16 v[100:103], a[68:71], a[8:11], v[100:103]
  buffer_load_dwordx4 v5, s[8:11], s27 offen offset:1024 lds
  v_mfma_f32_16x16x32_bf16 v[100:103], a[100:103], a[24:27], v[100:103]
  s_add_u32 s69, s69, 1
  ds_read_b64_tr_b16 a[90:91], v20 offset:10240
  ds_read_b64_tr_b16 a[120:121], v20 offset:12288
  v_mfma_f32_16x16x32_bf16 v[132:135], a[68:71], a[12:15], v[132:135]
  s_cmp_eq_u32 s69, 3
  s_cselect_b32 s69, 0, s69
  s_cselect_b32 s70, s71, s72
  v_mfma_f32_16x16x32_bf16 v[132:135], a[100:103], a[28:31], v[132:135]
  ds_read_b64_tr_b16 a[122:123], v20 offset:14336
  v_mfma_f32_16x16x32_bf16 v[40:43], a[72:75], a[0:3], v[40:43]
  buffer_load_dwordx4 v6, s[8:11], s27 offen offset:2048 lds
  v_mfma_f32_16x16x32_bf16 v[40:43], a[104:107], a[16:19], v[40:43]
  ds_read_b64_tr_b16 a[92:93], v21 offset:8192
  ds_read_b64_tr_b16 a[94:95], v21 offset:10240
  v_mfma_f32_16x16x32_bf16 v[72:75], a[72:75], a[4:7], v[72:75]
  v_mfma_f32_16x16x32_bf16 v[72:75], a[104:107], a[20:23], v[72:75]
  ds_read_b64_tr_b16 a[124:125], v21 offset:12288
  v_mfma_f32_16x16x32_bf16 v[104:107], a[72:75], a[8:11], v[104:107]
  buffer_load_dwordx4 v7, s[8:11], s27 offen offset:3072 lds
  v_mfma_f32_16x16x32_bf16 v[104:107], a[104:107], a[24:27], v[104:107]
  s_bfe_u32 s29, 0x302010e, s53
  ds_read_b64_tr_b16 a[126:127], v21 offset:14336
  v_mfma_f32_16x16x32_bf16 v[136:139], a[72:75], a[12:15], v[136:139]
  s_add_u32 s52, s52, s29
  v_add_u32 v16, s90, v16
  v_add_u32 v17, s90, v17
  v_mfma_f32_16x16x32_bf16 v[136:139], a[104:107], a[28:31], v[136:139]
  s_add_u32 s53, s53, 8
  v_add_u32 v18, s70, v18
  v_add_u32 v19, s70, v19
  v_mfma_f32_16x16x32_bf16 v[44:47], a[76:79], a[0:3], v[44:47]
  s_and_b32 s53, s53, 0x8001f
  v_add_u32 v20, s70, v20
  v_add_u32 v21, s70, v21
  v_mfma_f32_16x16x32_bf16 v[44:47], a[108:111], a[16:19], v[44:47]
  s_and_b32 s52, s52, 15
  v_mfma_f32_16x16x32_bf16 v[76:79], a[76:79], a[4:7], v[76:79]
  s_lshl_b32 s29, s52, 7
  v_mfma_f32_16x16x32_bf16 v[76:79], a[108:111], a[20:23], v[76:79]
  s_or_b32 s26, s30, s29
  v_mfma_f32_16x16x32_bf16 v[108:111], a[76:79], a[8:11], v[108:111]
  s_or_b32 s27, s31, s29
  v_mfma_f32_16x16x32_bf16 v[108:111], a[108:111], a[24:27], v[108:111]
  v_mfma_f32_16x16x32_bf16 v[140:143], a[76:79], a[12:15], v[140:143]
  v_mfma_f32_16x16x32_bf16 v[140:143], a[108:111], a[28:31], v[140:143]
  s_waitcnt vmcnt(20) lgkmcnt(0)
  s_barrier
  v_mfma_f32_16x16x32_bf16 v[48:51], a[80:83], a[0:3], v[48:51]
  s_mov_b32 m0, s68
  ds_read_b128 a[32:35], v16 offset:0
  ds_read_b128 a[48:51], v17 offset:0
  v_mfma_f32_16x16x32_bf16 v[48:51], a[112:115], a[16:19], v[48:51]
  buffer_load_dwordx4 v8, s[20:23], s28 offen offset:0 lds
  v_mfma_f32_16x16x32_bf16 v[80:83], a[80:83], a[4:7], v[80:83]
  ds_read_b64_tr_b16 a[64:65], v18 offset:0
  ds_read_b64_tr_b16 a[66:67], v18 offset:2048
  v_mfma_f32_16x16x32_bf16 v[80:83], a[112:115], a[20:23], v[80:83]
  buffer_load_dwordx4 v9, s[20:23], s28 offen offset:1024 lds
  v_mfma_f32_16x16x32_bf16 v[112:115], a[80:83], a[8:11], v[112:115]
  ds_read_b64_tr_b16 a[96:97], v18 offset:4096
  ds_read_b64_tr_b16 a[98:99], v18 offset:6144
  v_mfma_f32_16x16x32_bf16 v[112:115], a[112:115], a[24:27], v[112:115]
  ds_read_b128 a[36:39], v16 offset:2048
  v_mfma_f32_16x16x32_bf16 v[144:147], a[80:83], a[12:15], v[144:147]
  buffer_load_dwordx4 v10, s[20:23], s28 offen offset:2048 lds
  v_mfma_f32_16x16x32_bf16 v[144:147], a[112:115], a[28:31], v[144:147]
  ds_read_b128 a[52:55], v17 offset:2048
  ds_read_b128 a[40:43], v16 offset:4096
  v_mfma_f32_16x16x32_bf16 v[52:55], a[84:87], a[0:3], v[52:55]
  ds_read_b128 a[56:59], v17 offset:4096
  v_mfma_f32_16x16x32_bf16 v[52:55], a[116:119], a[16:19], v[52:55]
  buffer_load_dwordx4 v11, s[20:23], s28 offen offset:3072 lds
  v_mfma_f32_16x16x32_bf16 v[84:87], a[84:87], a[4:7], v[84:87]
  s_bfe_u32 s56, 0x302010e, s55
  s_add_u32 s54, s54, s56
  s_add_u32 s55, s55, 8
  v_mfma_f32_16x16x32_bf16 v[84:87], a[116:119], a[20:23], v[84:87]
  s_and_b32 s55, s55, 0x8001f
  s_and_b32 s54, s54, 15
  s_lshl_b32 s28, s54, 19
  v_mfma_f32_16x16x32_bf16 v[116:119], a[84:87], a[8:11], v[116:119]
  s_mov_b32 m0, s88
  ds_read_b128 a[44:47], v16 offset:6144
  ds_read_b128 a[60:63], v17 offset:6144
  v_mfma_f32_16x16x32_bf16 v[116:119], a[116:119], a[24:27], v[116:119]
  buffer_load_dwordx4 v4, s[8:11], s26 offen offset:0 lds
  v_mfma_f32_16x16x32_bf16 v[148:151], a[84:87], a[12:15], v[148:151]
  ds_read_b64_tr_b16 a[68:69], v19 offset:0
  ds_read_b64_tr_b16 a[70:71], v19 offset:2048
  v_mfma_f32_16x16x32_bf16 v[148:151], a[116:119], a[28:31], v[148:151]
  buffer_load_dwordx4 v5, s[8:11], s26 offen offset:1024 lds
  v_mfma_f32_16x16x32_bf16 v[56:59], a[88:91], a[0:3], v[56:59]
  ds_read_b64_tr_b16 a[100:101], v19 offset:4096
  ds_read_b64_tr_b16 a[102:103], v19 offset:6144
  v_mfma_f32_16x16x32_bf16 v[56:59], a[120:123], a[16:19], v[56:59]
  ds_read_b64_tr_b16 a[72:73], v20 offset:0
  ds_read_b64_tr_b16 a[74:75], v20 offset:2048
  v_mfma_f32_16x16x32_bf16 v[88:91], a[88:91], a[4:7], v[88:91]
  buffer_load_dwordx4 v6, s[8:11], s26 offen offset:2048 lds
  v_mfma_f32_16x16x32_bf16 v[88:91], a[120:123], a[20:23], v[88:91]
  ds_read_b64_tr_b16 a[104:105], v20 offset:4096
  ds_read_b64_tr_b16 a[106:107], v20 offset:6144
  v_mfma_f32_16x16x32_bf16 v[120:123], a[88:91], a[8:11], v[120:123]
  ds_read_b64_tr_b16 a[76:77], v21 offset:0
  ds_read_b64_tr_b16 a[78:79], v21 offset:2048
  v_mfma_f32_16x16x32_bf16 v[120:123], a[120:123], a[24:27], v[120:123]
  buffer_load_dwordx4 v7, s[8:11], s26 offen offset:3072 lds
  v_mfma_f32_16x16x32_bf16 v[152:155], a[88:91], a[12:15], v[152:155]
  s_add_u32 m0, s88, 4096
  ds_read_b64_tr_b16 a[108:109], v21 offset:4096
  ds_read_b64_tr_b16 a[110:111], v21 offset:6144
  v_mfma_f32_16x16x32_bf16 v[152:155], a[120:123], a[28:31], v[152:155]
  v_mfma_f32_16x16x32_bf16 v[60:63], a[92:95], a[0:3], v[60:63]
  buffer_load_dwordx4 v4, s[8:11], s27 offen offset:0 lds
  v_mfma_f32_16x16x32_bf16 v[60:63], a[124:127], a[16:19], v[60:63]
  v_mfma_f32_16x16x32_bf16 v[92:95], a[92:95], a[4:7], v[92:95]
  v_mfma_f32_16x16x32_bf16 v[92:95], a[124:127], a[20:23], v[92:95]
  buffer_load_dwordx4 v5, s[8:11], s27 offen offset:1024 lds
  v_mfma_f32_16x16x32_bf16 v[124:127], a[92:95], a[8:11], v[124:127]
  v_mfma_f32_16x16x32_bf16 v[124:127], a[124:127], a[24:27], v[124:127]
  v_mfma_f32_16x16x32_bf16 v[156:159], a[92:95], a[12:15], v[156:159]
  v_mfma_f32_16x16x32_bf16 v[156:159], a[124:127], a[28:31], v[156:159]
  s_waitcnt lgkmcnt(0)
  v_mfma_f32_16x16x32_bf16 v[32:35], a[64:67], a[32:35], v[32:35]
  buffer_load_dwordx4 v6, s[8:11], s27 offen offset:2048 lds
  v_mfma_f32_16x16x32_bf16 v[32:35], a[96:99], a[48:51], v[32:35]
  s_add_u32 s88, s88, s90
  ds_read_b64_tr_b16 a[80:81], v18 offset:8192
  ds_read_b64_tr_b16 a[82:83], v18 offset:10240
  v_mfma_f32_16x16x32_bf16 v[64:67], a[64:67], a[36:39], v[64:67]
  buffer_load_dwordx4 v7, s[8:11], s27 offen offset:3072 lds
  v_mfma_f32_16x16x32_bf16 v[64:67], a[96:99], a[52:55], v[64:67]
  s_bfe_u32 s29, 0x302010e, s53
  s_add_u32 s52, s52, s29
  s_add_u32 s53, s53, 8
  v_mfma_f32_16x16x32_bf16 v[96:99], a[64:67], a[40:43], v[96:99]
  s_and_b32 s53, s53, 0x8001f
  s_and_b32 s52, s52, 15
  s_lshl_b32 s29, s52, 7
  v_mfma_f32_16x16x32_bf16 v[96:99], a[96:99], a[56:59], v[96:99]
  s_or_b32 s26, s30, s29
  s_or_b32 s27, s31, s29
  s_add_u32 s60, s63, 36864
  v_mfma_f32_16x16x32_bf16 v[128:131], a[64:67], a[44:47], v[128:131]
  buffer_store_dwordx4 v[208:211], v2, s[16:19], s60 offen offset:0 sc1
  v_mfma_f32_16x16x32_bf16 v[128:131], a[96:99], a[60:63], v[128:131]
  s_add_u32 s60, s63, 45056
  ds_read_b64_tr_b16 a[112:113], v18 offset:12288
  ds_read_b64_tr_b16 a[114:115], v18 offset:14336
  v_mfma_f32_16x16x32_bf16 v[36:39], a[68:71], a[32:35], v[36:39]
  buffer_store_dwordx4 v[240:243], v2, s[16:19], s60 offen offset:0 sc1
  v_mfma_f32_16x16x32_bf16 v[36:39], a[100:103], a[48:51], v[36:39]
  s_add_u32 s60, s63, 36864
  ds_read_b64_tr_b16 a[84:85], v19 offset:8192
  ds_read_b64_tr_b16 a[86:87], v19 offset:10240
  v_mfma_f32_16x16x32_bf16 v[68:71], a[68:71], a[36:39], v[68:71]
  buffer_store_dwordx4 v[212:215], v2, s[16:19], s60 offen offset:1024 sc1
  v_mfma_f32_16x16x32_bf16 v[68:71], a[100:103], a[52:55], v[68:71]
  s_add_u32 s60, s63, 45056
  ds_read_b64_tr_b16 a[116:117], v19 offset:12288
  ds_read_b64_tr_b16 a[118:119], v19 offset:14336
  v_mfma_f32_16x16x32_bf16 v[100:103], a[68:71], a[40:43], v[100:103]
  buffer_store_dwordx4 v[244:247], v2, s[16:19], s60 offen offset:1024 sc1
  v_mfma_f32_16x16x32_bf16 v[100:103], a[100:103], a[56:59], v[100:103]
  s_add_u32 s60, s63, 36864
  ds_read_b64_tr_b16 a[88:89], v20 offset:8192
  ds_read_b64_tr_b16 a[90:91], v20 offset:10240
  v_mfma_f32_16x16x32_bf16 v[132:135], a[68:71], a[44:47], v[132:135]
  s_add_u32 s89, s89, 1
  ds_read_b64_tr_b16 a[120:121], v20 offset:12288
  v_mfma_f32_16x16x32_bf16 v[132:135], a[100:103], a[60:63], v[132:135]
  buffer_store_dwordx4 v[216:219], v2, s[16:19], s60 offen offset:2048 sc1
  v_mfma_f32_16x16x32_bf16 v[40:43], a[72:75], a[32:35], v[40:43]
  s_add_u32 s60, s63, 45056
  ds_read_b64_tr_b16 a[122:123], v20 offset:14336
  ds_read_b64_tr_b16 a[92:93], v21 offset:8192
  v_mfma_f32_16x16x32_bf16 v[40:43], a[104:107], a[48:51], v[40:43]
  buffer_store_dwordx4 v[248:251], v2, s[16:19], s60 offen offset:2048 sc1
  v_mfma_f32_16x16x32_bf16 v[72:75], a[72:75], a[36:39], v[72:75]
  s_add_u32 s60, s63, 36864
  ds_read_b64_tr_b16 a[94:95], v21 offset:10240
  v_mfma_f32_16x16x32_bf16 v[72:75], a[104:107], a[52:55], v[72:75]
  ds_read_b64_tr_b16 a[124:125], v21 offset:12288
  v_mfma_f32_16x16x32_bf16 v[104:107], a[72:75], a[40:43], v[104:107]
  buffer_store_dwordx4 v[220:223], v2, s[16:19], s60 offen offset:3072 sc1
  v_mfma_f32_16x16x32_bf16 v[104:107], a[104:107], a[56:59], v[104:107]
  s_add_u32 s60, s63, 45056
  ds_read_b64_tr_b16 a[126:127], v21 offset:14336
  v_mfma_f32_16x16x32_bf16 v[136:139], a[72:75], a[44:47], v[136:139]
  buffer_store_dwordx4 v[252:255], v2, s[16:19], s60 offen offset:3072 sc1
  v_mfma_f32_16x16x32_bf16 v[136:139], a[104:107], a[60:63], v[136:139]
  s_cmp_eq_u32 s89, 3
  s_cselect_b32 s89, 0, s89
  s_cselect_b32 s90, s91, s92
  v_mfma_f32_16x16x32_bf16 v[44:47], a[76:79], a[32:35], v[44:47]
  s_add_u32 s68, s68, s70
  v_mfma_f32_16x16x32_bf16 v[44:47], a[108:111], a[48:51], v[44:47]
  s_add_u32 s69, s69, 1
  v_mfma_f32_16x16x32_bf16 v[76:79], a[76:79], a[36:39], v[76:79]
  s_cmp_eq_u32 s69, 3
  s_cselect_b32 s69, 0, s69
  s_cselect_b32 s70, s71, s72
  v_mfma_f32_16x16x32_bf16 v[76:79], a[108:111], a[52:55], v[76:79]
  v_add_u32 v16, s90, v16
  v_add_u32 v17, s90, v17
  v_mfma_f32_16x16x32_bf16 v[108:111], a[76:79], a[40:43], v[108:111]
  v_add_u32 v18, s70, v18
  v_add_u32 v19, s70, v19
  v_mfma_f32_16x16x32_bf16 v[108:111], a[108:111], a[56:59], v[108:111]
  v_add_u32 v20, s70, v20
  v_add_u32 v21, s70, v21
  v_mfma_f32_16x16x32_bf16 v[140:143], a[76:79], a[44:47], v[140:143]
  v_mfma_f32_16x16x32_bf16 v[140:143], a[108:111], a[60:63], v[140:143]
  s_waitcnt vmcnt(20) lgkmcnt(0)
  s_barrier
  v_mfma_f32_16x16x32_bf16 v[48:51], a[80:83], a[32:35], v[48:51]
  s_mov_b32 m0, s68
  ds_read_b128 a[0:3], v16 offset:0
  ds_read_b128 a[16:19], v17 offset:0
  v_mfma_f32_16x16x32_bf16 v[48:51], a[112:115], a[48:51], v[48:51]
  buffer_load_dwordx4 v8, s[20:23], s28 offen offset:0 lds
  v_mfma_f32_16x16x32_bf16 v[80:83], a[80:83], a[36:39], v[80:83]
  ds_read_b64_tr_b16 a[64:65], v18 offset:0
  ds_read_b64_tr_b16 a[66:67], v18 offset:2048
  v_mfma_f32_16x16x32_bf16 v[80:83], a[112:115], a[52:55], v[80:83]
  ds_read_b64_tr_b16 a[96:97], v18 offset:4096
  v_mfma_f32_16x16x32_bf16 v[112:115], a[80:83], a[40:43], v[112:115]
  ds_read_b64_tr_b16 a[98:99], v18 offset:6144
  v_mfma_f32_16x16x32_bf16 v[112:115], a[112:115], a[56:59], v[112:115]
  buffer_load_dwordx4 v9, s[20:23], s28 offen offset:1024 lds
  v_mfma_f32_16x16x32_bf16 v[144:147], a[80:83], a[44:47], v[144:147]
  ds_read_b128 a[4:7], v16 offset:2048
  ds_read_b128 a[20:23], v17 offset:2048
  v_mfma_f32_16x16x32_bf16 v[144:147], a[112:115], a[60:63], v[144:147]
  ds_read_b128 a[8:11], v16 offset:4096
  v_mfma_f32_16x16x32_bf16 v[52:55], a[84:87], a[32:35], v[52:55]
  ds_read_b128 a[24:27], v17 offset:4096
  v_mfma_f32_16x16x32_bf16 v[52:55], a[116:119], a[48:51], v[52:55]
  ds_read_b128 a[12:15], v16 offset:6144
  v_mfma_f32_16x16x32_bf16 v[84:87], a[84:87], a[36:39], v[84:87]
  buffer_load_dwordx4 v10, s[20:23], s28 offen offset:2048 lds
  v_mfma_f32_16x16x32_bf16 v[84:87], a[116:119], a[52:55], v[84:87]
  ds_read_b128 a[28:31], v17 offset:6144
  ds_read_b64_tr_b16 a[68:69], v19 offset:0
  v_mfma_f32_16x16x32_bf16 v[116:119], a[84:87], a[40:43], v[116:119]
  ds_read_b64_tr_b16 a[70:71], v19 offset:2048
  ds_read_b64_tr_b16 a[100:101], v19 offset:4096
  v_mfma_f32_16x16x32_bf16 v[116:119], a[116:119], a[56:59], v[116:119]
  ds_read_b64_tr_b16 a[102:103], v19 offset:6144
  v_mfma_f32_16x16x32_bf16 v[148:151], a[84:87], a[44:47], v[148:151]
  ds_read_b64_tr_b16 a[72:73], v20 offset:0
  v_mfma_f32_16x16x32_bf16 v[148:151], a[116:119], a[60:63], v[148:151]
  buffer_load_dwordx4 v11, s[20:23], s28 offen offset:3072 lds
  v_mfma_f32_16x16x32_bf16 v[56:59], a[88:91], a[32:35], v[56:59]
  s_bfe_u32 s56, 0x302010e, s55
  s_add_u32 s54, s54, s56
  s_add_u32 s55, s55, 8
  v_mfma_f32_16x16x32_bf16 v[56:59], a[120:123], a[48:51], v[56:59]
  s_and_b32 s55, s55, 0x8001f
  s_and_b32 s54, s54, 15
  s_lshl_b32 s28, s54, 19
  v_mfma_f32_16x16x32_bf16 v[88:91], a[88:91], a[36:39], v[88:91]
  s_mov_b32 m0, s88
  ds_read_b64_tr_b16 a[74:75], v20 offset:2048
  ds_read_b64_tr_b16 a[104:105], v20 offset:4096
  v_mfma_f32_16x16x32_bf16 v[88:91], a[120:123], a[52:55], v[88:91]
  ds_read_b64_tr_b16 a[106:107], v20 offset:6144
  ds_read_b64_tr_b16 a[76:77], v21 offset:0
  v_mfma_f32_16x16x32_bf16 v[120:123], a[88:91], a[40:43], v[120:123]
  buffer_load_dwordx4 v4, s[8:11], s26 offen offset:0 lds
  v_mfma_f32_16x16x32_bf16 v[120:123], a[120:123], a[56:59], v[120:123]
  ds_read_b64_tr_b16 a[78:79], v21 offset:2048
  ds_read_b64_tr_b16 a[108:109], v21 offset:4096
  v_mfma_f32_16x16x32_bf16 v[152:155], a[88:91], a[44:47], v[152:155]
  ds_read_b64_tr_b16 a[110:111], v21 offset:6144
  v_mfma_f32_16x16x32_bf16 v[152:155], a[120:123], a[60:63], v[152:155]
  v_mfma_f32_16x16x32_bf16 v[60:63], a[92:95], a[32:35], v[60:63]
  v_mfma_f32_16x16x32_bf16 v[60:63], a[124:127], a[48:51], v[60:63]
  buffer_load_dwordx4 v5, s[8:11], s26 offen offset:1024 lds
  v_mfma_f32_16x16x32_bf16 v[92:95], a[92:95], a[36:39], v[92:95]
  v_mfma_f32_16x16x32_bf16 v[92:95], a[124:127], a[52:55], v[92:95]
  v_mfma_f32_16x16x32_bf16 v[124:127], a[92:95], a[40:43], v[124:127]
  v_mfma_f32_16x16x32_bf16 v[124:127], a[124:127], a[56:59], v[124:127]
  v_mfma_f32_16x16x32_bf16 v[156:159], a[92:95], a[44:47], v[156:159]
  v_mfma_f32_16x16x32_bf16 v[156:159], a[124:127], a[60:63], v[156:159]
  s_waitcnt lgkmcnt(0)
  v_mfma_f32_16x16x32_bf16 v[32:35], a[64:67], a[0:3], v[32:35]
  buffer_load_dwordx4 v6, s[8:11], s26 offen offset:2048 lds
  v_mfma_f32_16x16x32_bf16 v[32:35], a[96:99], a[16:19], v[32:35]
  ds_read_b64_tr_b16 a[80:81], v18 offset:8192
  ds_read_b64_tr_b16 a[82:83], v18 offset:10240
  v_mfma_f32_16x16x32_bf16 v[64:67], a[64:67], a[4:7], v[64:67]
  ds_read_b64_tr_b16 a[112:113], v18 offset:12288
  v_mfma_f32_16x16x32_bf16 v[64:67], a[96:99], a[20:23], v[64:67]
  v_mfma_f32_16x16x32_bf16 v[96:99], a[64:67], a[8:11], v[96:99]
  buffer_load_dwordx4 v7, s[8:11], s26 offen offset:3072 lds
  v_mfma_f32_16x16x32_bf16 v[96:99], a[96:99], a[24:27], v[96:99]
  s_add_u32 m0, s88, 4096
  ds_read_b64_tr_b16 a[114:115], v18 offset:14336
  ds_read_b64_tr_b16 a[84:85], v19 offset:8192
  v_mfma_f32_16x16x32_bf16 v[128:131], a[64:67], a[12:15], v[128:131]
  s_add_u32 s88, s88, s90
  ds_read_b64_tr_b16 a[86:87], v19 offset:10240
  v_mfma_f32_16x16x32_bf16 v[128:131], a[96:99], a[28:31], v[128:131]
  s_add_u32 s89, s89, 1
  v_mfma_f32_16x16x32_bf16 v[36:39], a[68:71], a[0:3], v[36:39]
  buffer_load_dwordx4 v4, s[8:11], s27 offen offset:0 lds
  v_mfma_f32_16x16x32_bf16 v[36:39], a[100:103], a[16:19], v[36:39]
  ds_read_b64_tr_b16 a[116:117], v19 offset:12288
  ds_read_b64_tr_b16 a[118:119], v19 offset:14336
  v_mfma_f32_16x16x32_bf16 v[68:71], a[68:71], a[4:7], v[68:71]
  s_cmp_eq_u32 s89, 3
  s_cselect_b32 s89, 0, s89
  s_cselect_b32 s90, s91, s92
  v_mfma_f32_16x16x32_bf16 v[68:71], a[100:103], a[20:23], v[68:71]
  s_add_u32 s68, s68, s70
  ds_read_b64_tr_b16 a[88:89], v20 offset:8192
  v_mfma_f32_16x16x32_bf16 v[100:103], a[68:71], a[8:11], v[100:103]
  buffer_load_dwordx4 v5, s[8:11], s27 offen offset:1024 lds
  v_mfma_f32_16x16x32_bf16 v[100:103], a[100:103], a[24:27], v[100:103]
  s_add_u32 s69, s69, 1
  ds_read_b64_tr_b16 a[90:91], v20 offset:10240
  ds_read_b64_tr_b16 a[120:121], v20 offset:12288
  v_mfma_f32_16x16x32_bf16 v[132:135], a[68:71], a[12:15], v[132:135]
  s_cmp_eq_u32 s69, 3
  s_cselect_b32 s69, 0, s69
  s_cselect_b32 s70, s71, s72
  v_mfma_f32_16x16x32_bf16 v[132:135], a[100:103], a[28:31], v[132:135]
  ds_read_b64_tr_b16 a[122:123], v20 offset:14336
  v_mfma_f32_16x16x32_bf16 v[40:43], a[72:75], a[0:3], v[40:43]
  buffer_load_dwordx4 v6, s[8:11], s27 offen offset:2048 lds
  v_mfma_f32_16x16x32_bf16 v[40:43], a[104:107], a[16:19], v[40:43]
  ds_read_b64_tr_b16 a[92:93], v21 offset:8192
  ds_read_b64_tr_b16 a[94:95], v21 offset:10240
  v_mfma_f32_16x16x32_bf16 v[72:75], a[72:75], a[4:7], v[72:75]
  v_mfma_f32_16x16x32_bf16 v[72:75], a[104:107], a[20:23], v[72:75]
  ds_read_b64_tr_b16 a[124:125], v21 offset:12288
  v_mfma_f32_16x16x32_bf16 v[104:107], a[72:75], a[8:11], v[104:107]
  buffer_load_dwordx4 v7, s[8:11], s27 offen offset:3072 lds
  v_mfma_f32_16x16x32_bf16 v[104:107], a[104:107], a[24:27], v[104:107]
  s_bfe_u32 s29, 0x302010e, s53
  ds_read_b64_tr_b16 a[126:127], v21 offset:14336
  v_mfma_f32_16x16x32_bf16 v[136:139], a[72:75], a[12:15], v[136:139]
  s_add_u32 s52, s52, s29
  v_add_u32 v16, s90, v16
  v_add_u32 v17, s90, v17
  v_mfma_f32_16x16x32_bf16 v[136:139], a[104:107], a[28:31], v[136:139]
  s_add_u32 s53, s53, 8
  v_add_u32 v18, s70, v18
  v_add_u32 v19, s70, v19
  v_mfma_f32_16x16x32_bf16 v[44:47], a[76:79], a[0:3], v[44:47]
  s_and_b32 s53, s53, 0x8001f
  v_add_u32 v20, s70, v20
  v_add_u32 v21, s70, v21
  v_mfma_f32_16x16x32_bf16 v[44:47], a[108:111], a[16:19], v[44:47]
  s_and_b32 s52, s52, 15
  v_mfma_f32_16x16x32_bf16 v[76:79], a[76:79], a[4:7], v[76:79]
  s_lshl_b32 s29, s52, 7
  v_mfma_f32_16x16x32_bf16 v[76:79], a[108:111], a[20:23], v[76:79]
  s_or_b32 s26, s30, s29
  v_mfma_f32_16x16x32_bf16 v[108:111], a[76:79], a[8:11], v[108:111]
  s_or_b32 s27, s31, s29
  v_mfma_f32_16x16x32_bf16 v[108:111], a[108:111], a[24:27], v[108:111]
  v_mfma_f32_16x16x32_bf16 v[140:143], a[76:79], a[12:15], v[140:143]
  v_mfma_f32_16x16x32_bf16 v[140:143], a[108:111], a[28:31], v[140:143]
  s_waitcnt vmcnt(20) lgkmcnt(0)
  s_barrier
  v_mfma_f32_16x16x32_bf16 v[48:51], a[80:83], a[0:3], v[48:51]
  s_mov_b32 m0, s68
  ds_read_b128 a[32:35], v16 offset:0
  ds_read_b128 a[48:51], v17 offset:0
  v_mfma_f32_16x16x32_bf16 v[48:51], a[112:115], a[16:19], v[48:51]
  buffer_load_dwordx4 v8, s[20:23], s28 offen offset:0 lds
  v_mfma_f32_16x16x32_bf16 v[80:83], a[80:83], a[4:7], v[80:83]
  ds_read_b64_tr_b16 a[64:65], v18 offset:0
  ds_read_b64_tr_b16 a[66:67], v18 offset:2048
  v_mfma_f32_16x16x32_bf16 v[80:83], a[112:115], a[20:23], v[80:83]
  buffer_load_dwordx4 v9, s[20:23], s28 offen offset:1024 lds
  v_mfma_f32_16x16x32_bf16 v[112:115], a[80:83], a[8:11], v[112:115]
  ds_read_b64_tr_b16 a[96:97], v18 offset:4096
  ds_read_b64_tr_b16 a[98:99], v18 offset:6144
  v_mfma_f32_16x16x32_bf16 v[112:115], a[112:115], a[24:27], v[112:115]
  ds_read_b128 a[36:39], v16 offset:2048
  v_mfma_f32_16x16x32_bf16 v[144:147], a[80:83], a[12:15], v[144:147]
  buffer_load_dwordx4 v10, s[20:23], s28 offen offset:2048 lds
  v_mfma_f32_16x16x32_bf16 v[144:147], a[112:115], a[28:31], v[144:147]
  ds_read_b128 a[52:55], v17 offset:2048
  ds_read_b128 a[40:43], v16 offset:4096
  v_mfma_f32_16x16x32_bf16 v[52:55], a[84:87], a[0:3], v[52:55]
  ds_read_b128 a[56:59], v17 offset:4096
  v_mfma_f32_16x16x32_bf16 v[52:55], a[116:119], a[16:19], v[52:55]
  buffer_load_dwordx4 v11, s[20:23], s28 offen offset:3072 lds
  v_mfma_f32_16x16x32_bf16 v[84:87], a[84:87], a[4:7], v[84:87]
  s_bfe_u32 s56, 0x302010e, s55
  s_add_u32 s54, s54, s56
  s_add_u32 s55, s55, 8
  v_mfma_f32_16x16x32_bf16 v[84:87], a[116:119], a[20:23], v[84:87]
  s_and_b32 s55, s55, 0x8001f
  s_and_b32 s54, s54, 15
  s_lshl_b32 s28, s54, 19
  v_mfma_f32_16x16x32_bf16 v[116:119], a[84:87], a[8:11], v[116:119]
  s_mov_b32 m0, s88
  ds_read_b128 a[44:47], v16 offset:6144
  ds_read_b128 a[60:63], v17 offset:6144
  v_mfma_f32_16x16x32_bf16 v[116:119], a[116:119], a[24:27], v[116:119]
  buffer_load_dwordx4 v4, s[8:11], s26 offen offset:0 lds
  v_mfma_f32_16x16x32_bf16 v[148:151], a[84:87], a[12:15], v[148:151]
  ds_read_b64_tr_b16 a[68:69], v19 offset:0
  ds_read_b64_tr_b16 a[70:71], v19 offset:2048
  v_mfma_f32_16x16x32_bf16 v[148:151], a[116:119], a[28:31], v[148:151]
  buffer_load_dwordx4 v5, s[8:11], s26 offen offset:1024 lds
  v_mfma_f32_16x16x32_bf16 v[56:59], a[88:91], a[0:3], v[56:59]
  ds_read_b64_tr_b16 a[100:101], v19 offset:4096
  ds_read_b64_tr_b16 a[102:103], v19 offset:6144
  v_mfma_f32_16x16x32_bf16 v[56:59], a[120:123], a[16:19], v[56:59]
  ds_read_b64_tr_b16 a[72:73], v20 offset:0
  ds_read_b64_tr_b16 a[74:75], v20 offset:2048
  v_mfma_f32_16x16x32_bf16 v[88:91], a[88:91], a[4:7], v[88:91]
  buffer_load_dwordx4 v6, s[8:11], s26 offen offset:2048 lds
  v_mfma_f32_16x16x32_bf16 v[88:91], a[120:123], a[20:23], v[88:91]
  ds_read_b64_tr_b16 a[104:105], v20 offset:4096
  ds_read_b64_tr_b16 a[106:107], v20 offset:6144
  v_mfma_f32_16x16x32_bf16 v[120:123], a[88:91], a[8:11], v[120:123]
  ds_read_b64_tr_b16 a[76:77], v21 offset:0
  ds_read_b64_tr_b16 a[78:79], v21 offset:2048
  v_mfma_f32_16x16x32_bf16 v[120:123], a[120:123], a[24:27], v[120:123]
  buffer_load_dwordx4 v7, s[8:11], s26 offen offset:3072 lds
  v_mfma_f32_16x16x32_bf16 v[152:155], a[88:91], a[12:15], v[152:155]
  s_add_u32 m0, s88, 4096
  ds_read_b64_tr_b16 a[108:109], v21 offset:4096
  ds_read_b64_tr_b16 a[110:111], v21 offset:6144
  v_mfma_f32_16x16x32_bf16 v[152:155], a[120:123], a[28:31], v[152:155]
  v_mfma_f32_16x16x32_bf16 v[60:63], a[92:95], a[0:3], v[60:63]
  buffer_load_dwordx4 v4, s[8:11], s27 offen offset:0 lds
  v_mfma_f32_16x16x32_bf16 v[60:63], a[124:127], a[16:19], v[60:63]
  v_mfma_f32_16x16x32_bf16 v[92:95], a[92:95], a[4:7], v[92:95]
  v_mfma_f32_16x16x32_bf16 v[92:95], a[124:127], a[20:23], v[92:95]
  buffer_load_dwordx4 v5, s[8:11], s27 offen offset:1024 lds
  v_mfma_f32_16x16x32_bf16 v[124:127], a[92:95], a[8:11], v[124:127]
  v_mfma_f32_16x16x32_bf16 v[124:127], a[124:127], a[24:27], v[124:127]
  v_mfma_f32_16x16x32_bf16 v[156:159], a[92:95], a[12:15], v[156:159]
  v_mfma_f32_16x16x32_bf16 v[156:159], a[124:127], a[28:31], v[156:159]
  s_waitcnt lgkmcnt(0)
  v_mfma_f32_16x16x32_bf16 v[32:35], a[64:67], a[32:35], v[32:35]
  buffer_load_dwordx4 v6, s[8:11], s27 offen offset:2048 lds
  v_mfma_f32_16x16x32_bf16 v[32:35], a[96:99], a[48:51], v[32:35]
  s_add_u32 s88, s88, s90
  ds_read_b64_tr_b16 a[80:81], v18 offset:8192
  ds_read_b64_tr_b16 a[82:83], v18 offset:10240
  v_mfma_f32_16x16x32_bf16 v[64:67], a[64:67], a[36:39], v[64:67]
  buffer_load_dwordx4 v7, s[8:11], s27 offen offset:3072 lds
  v_mfma_f32_16x16x32_bf16 v[64:67], a[96:99], a[52:55], v[64:67]
  s_bfe_u32 s29, 0x302010e, s53
  s_add_u32 s52, s52, s29
  s_add_u32 s53, s53, 8
  v_mfma_f32_16x16x32_bf16 v[96:99], a[64:67], a[40:43], v[96:99]
  s_and_b32 s53, s53, 0x8001f
  s_and_b32 s52, s52, 15
  s_lshl_b32 s29, s52, 7
  v_mfma_f32_16x16x32_bf16 v[96:99], a[96:99], a[56:59], v[96:99]
  s_or_b32 s26, s30, s29
  s_or_b32 s27, s31, s29
  s_add_u32 s60, s63, 0
  v_mfma_f32_16x16x32_bf16 v[128:131], a[64:67], a[44:47], v[128:131]
  buffer_store_dwordx4 v[160:163], v2, s[16:19], s60 offen offset:0 sc1
  v_mfma_f32_16x16x32_bf16 v[128:131], a[96:99], a[60:63], v[128:131]
  buffer_store_dwordx4 v[164:167], v2, s[16:19], s60 offen offset:1024 sc1
  v_mfma_f32_16x16x32_bf16 v[36:39], a[68:71], a[32:35], v[36:39]
  s_add_u32 s89, s89, 1
  ds_read_b64_tr_b16 a[112:113], v18 offset:12288
  ds_read_b64_tr_b16 a[114:115], v18 offset:14336
  v_mfma_f32_16x16x32_bf16 v[36:39], a[100:103], a[48:51], v[36:39]
  ds_read_b64_tr_b16 a[84:85], v19 offset:8192
  ds_read_b64_tr_b16 a[86:87], v19 offset:10240
  v_mfma_f32_16x16x32_bf16 v[68:71], a[68:71], a[36:39], v[68:71]
  buffer_store_dwordx4 v[168:171], v2, s[16:19], s60 offen offset:2048 sc1
  v_mfma_f32_16x16x32_bf16 v[68:71], a[100:103], a[52:55], v[68:71]
  ds_read_b64_tr_b16 a[116:117], v19 offset:12288
  ds_read_b64_tr_b16 a[118:119], v19 offset:14336
  v_mfma_f32_16x16x32_bf16 v[100:103], a[68:71], a[40:43], v[100:103]
  buffer_store_dwordx4 v[172:175], v2, s[16:19], s60 offen offset:3072 sc1
  v_mfma_f32_16x16x32_bf16 v[100:103], a[100:103], a[56:59], v[100:103]
  s_add_u32 s60, s63, 4096
  ds_read_b64_tr_b16 a[88:89], v20 offset:8192
  ds_read_b64_tr_b16 a[90:91], v20 offset:10240
  v_mfma_f32_16x16x32_bf16 v[132:135], a[68:71], a[44:47], v[132:135]
  ds_read_b64_tr_b16 a[120:121], v20 offset:12288
  v_mfma_f32_16x16x32_bf16 v[132:135], a[100:103], a[60:63], v[132:135]
  buffer_store_dwordx4 v[176:179], v2, s[16:19], s60 offen offset:0 sc1
  v_mfma_f32_16x16x32_bf16 v[40:43], a[72:75], a[32:35], v[40:43]
  ds_read_b64_tr_b16 a[122:123], v20 offset:14336
  ds_read_b64_tr_b16 a[92:93], v21 offset:8192
  v_mfma_f32_16x16x32_bf16 v[40:43], a[104:107], a[48:51], v[40:43]
  buffer_store_dwordx4 v[180:183], v2, s[16:19], s60 offen offset:1024 sc1
  v_mfma_f32_16x16x32_bf16 v[72:75], a[72:75], a[36:39], v[72:75]
  ds_read_b64_tr_b16 a[94:95], v21 offset:10240
  v_mfma_f32_16x16x32_bf16 v[72:75], a[104:107], a[52:55], v[72:75]
  ds_read_b64_tr_b16 a[124:125], v21 offset:12288
  v_mfma_f32_16x16x32_bf16 v[104:107], a[72:75], a[40:43], v[104:107]
  buffer_store_dwordx4 v[184:187], v2, s[16:19], s60 offen offset:2048 sc1
  v_mfma_f32_16x16x32_bf16 v[104:107], a[104:107], a[56:59], v[104:107]
  ds_read_b64_tr_b16 a[126:127], v21 offset:14336
  v_mfma_f32_16x16x32_bf16 v[136:139], a[72:75], a[44:47], v[136:139]
  buffer_store_dwordx4 v[188:191], v2, s[16:19], s60 offen offset:3072 sc1
  v_mfma_f32_16x16x32_bf16 v[136:139], a[104:107], a[60:63], v[136:139]
  s_cmp_eq_u32 s89, 3
  s_cselect_b32 s89, 0, s89
  s_cselect_b32 s90, s91, s92
  v_mfma_f32_16x16x32_bf16 v[44:47], a[76:79], a[32:35], v[44:47]
  s_add_u32 s68, s68, s70
  v_mfma_f32_16x16x32_bf16 v[44:47], a[108:111], a[48:51], v[44:47]
  s_add_u32 s69, s69, 1
  v_mfma_f32_16x16x32_bf16 v[76:79], a[76:79], a[36:39], v[76:79]
  s_cmp_eq_u32 s69, 3
  s_cselect_b32 s69, 0, s69
  s_cselect_b32 s70, s71, s72
  v_mfma_f32_16x16x32_bf16 v[76:79], a[108:111], a[52:55], v[76:79]
  v_add_u32 v16, s90, v16
  v_add_u32 v17, s90, v17
  v_mfma_f32_16x16x32_bf16 v[108:111], a[76:79], a[40:43], v[108:111]
  v_add_u32 v18, s70, v18
  v_add_u32 v19, s70, v19
  v_mfma_f32_16x16x32_bf16 v[108:111], a[108:111], a[56:59], v[108:111]
  v_add_u32 v20, s70, v20
  v_add_u32 v21, s70, v21
  v_mfma_f32_16x16x32_bf16 v[140:143], a[76:79], a[44:47], v[140:143]
  v_mfma_f32_16x16x32_bf16 v[140:143], a[108:111], a[60:63], v[140:143]
  s_waitcnt vmcnt(20) lgkmcnt(0)
  s_barrier
  v_mfma_f32_16x16x32_bf16 v[48:51], a[80:83], a[32:35], v[48:51]
  s_mov_b32 m0, s68
  ds_read_b128 a[0:3], v16 offset:0
  ds_read_b128 a[16:19], v17 offset:0
  v_mfma_f32_16x16x32_bf16 v[48:51], a[112:115], a[48:51], v[48:51]
  buffer_load_dwordx4 v8, s[20:23], s28 offen offset:0 lds
  v_mfma_f32_16x16x32_bf16 v[80:83], a[80:83], a[36:39], v[80:83]
  ds_read_b64_tr_b16 a[64:65], v18 offset:0
  ds_read_b64_tr_b16 a[66:67], v18 offset:2048
  v_mfma_f32_16x16x32_bf16 v[80:83], a[112:115], a[52:55], v[80:83]
  ds_read_b64_tr_b16 a[96:97], v18 offset:4096
  v_mfma_f32_16x16x32_bf16 v[112:115], a[80:83], a[40:43], v[112:115]
  ds_read_b64_tr_b16 a[98:99], v18 offset:6144
  v_mfma_f32_16x16x32_bf16 v[112:115], a[112:115], a[56:59], v[112:115]
  buffer_load_dwordx4 v9, s[20:23], s28 offen offset:1024 lds
  v_mfma_f32_16x16x32_bf16 v[144:147], a[80:83], a[44:47], v[144:147]
  ds_read_b128 a[4:7], v16 offset:2048
  ds_read_b128 a[20:23], v17 offset:2048
  v_mfma_f32_16x16x32_bf16 v[144:147], a[112:115], a[60:63], v[144:147]
  ds_read_b128 a[8:11], v16 offset:4096
  v_mfma_f32_16x16x32_bf16 v[52:55], a[84:87], a[32:35], v[52:55]
  ds_read_b128 a[24:27], v17 offset:4096
  v_mfma_f32_16x16x32_bf16 v[52:55], a[116:119], a[48:51], v[52:55]
  ds_read_b128 a[12:15], v16 offset:6144
  v_mfma_f32_16x16x32_bf16 v[84:87], a[84:87], a[36:39], v[84:87]
  buffer_load_dwordx4 v10, s[20:23], s28 offen offset:2048 lds
  v_mfma_f32_16x16x32_bf16 v[84:87], a[116:119], a[52:55], v[84:87]
  ds_read_b128 a[28:31], v17 offset:6144
  ds_read_b64_tr_b16 a[68:69], v19 offset:0
  v_mfma_f32_16x16x32_bf16 v[116:119], a[84:87], a[40:43], v[116:119]
  ds_read_b64_tr_b16 a[70:71], v19 offset:2048
  ds_read_b64_tr_b16 a[100:101], v19 offset:4096
  v_mfma_f32_16x16x32_bf16 v[116:119], a[116:119], a[56:59], v[116:119]
  ds_read_b64_tr_b16 a[102:103], v19 offset:6144
  v_mfma_f32_16x16x32_bf16 v[148:151], a[84:87], a[44:47], v[148:151]
  ds_read_b64_tr_b16 a[72:73], v20 offset:0
  v_mfma_f32_16x16x32_bf16 v[148:151], a[116:119], a[60:63], v[148:151]
  buffer_load_dwordx4 v11, s[20:23], s28 offen offset:3072 lds
  v_mfma_f32_16x16x32_bf16 v[56:59], a[88:91], a[32:35], v[56:59]
  s_bfe_u32 s56, 0x302010e, s55
  s_add_u32 s54, s54, s56
  s_add_u32 s55, s55, 8
  v_mfma_f32_16x16x32_bf16 v[56:59], a[120:123], a[48:51], v[56:59]
  s_and_b32 s55, s55, 0x8001f
  s_and_b32 s54, s54, 15
  s_lshl_b32 s28, s54, 19
  v_mfma_f32_16x16x32_bf16 v[88:91], a[88:91], a[36:39], v[88:91]
  s_mov_b32 m0, s88
  ds_read_b64_tr_b16 a[74:75], v20 offset:2048
  ds_read_b64_tr_b16 a[104:105], v20 offset:4096
  v_mfma_f32_16x16x32_bf16 v[88:91], a[120:123], a[52:55], v[88:91]
  ds_read_b64_tr_b16 a[106:107], v20 offset:6144
  ds_read_b64_tr_b16 a[76:77], v21 offset:0
  v_mfma_f32_16x16x32_bf16 v[120:123], a[88:91], a[40:43], v[120:123]
  buffer_load_dwordx4 v4, s[8:11], s26 offen offset:0 lds
  v_mfma_f32_16x16x32_bf16 v[120:123], a[120:123], a[56:59], v[120:123]
  ds_read_b64_tr_b16 a[78:79], v21 offset:2048
  ds_read_b64_tr_b16 a[108:109], v21 offset:4096
  v_mfma_f32_16x16x32_bf16 v[152:155], a[88:91], a[44:47], v[152:155]
  ds_read_b64_tr_b16 a[110:111], v21 offset:6144
  v_mfma_f32_16x16x32_bf16 v[152:155], a[120:123], a[60:63], v[152:155]
  v_mfma_f32_16x16x32_bf16 v[60:63], a[92:95], a[32:35], v[60:63]
  v_mfma_f32_16x16x32_bf16 v[60:63], a[124:127], a[48:51], v[60:63]
  buffer_load_dwordx4 v5, s[8:11], s26 offen offset:1024 lds
  v_mfma_f32_16x16x32_bf16 v[92:95], a[92:95], a[36:39], v[92:95]
  v_mfma_f32_16x16x32_bf16 v[92:95], a[124:127], a[52:55], v[92:95]
  v_mfma_f32_16x16x32_bf16 v[124:127], a[92:95], a[40:43], v[124:127]
  v_mfma_f32_16x16x32_bf16 v[124:127], a[124:127], a[56:59], v[124:127]
  v_mfma_f32_16x16x32_bf16 v[156:159], a[92:95], a[44:47], v[156:159]
  v_mfma_f32_16x16x32_bf16 v[156:159], a[124:127], a[60:63], v[156:159]
  s_waitcnt lgkmcnt(0)
  v_mfma_f32_16x16x32_bf16 v[32:35], a[64:67], a[0:3], v[32:35]
  buffer_load_dwordx4 v6, s[8:11], s26 offen offset:2048 lds
  v_mfma_f32_16x16x32_bf16 v[32:35], a[96:99], a[16:19], v[32:35]
  ds_read_b64_tr_b16 a[80:81], v18 offset:8192
  ds_read_b64_tr_b16 a[82:83], v18 offset:10240
  v_mfma_f32_16x16x32_bf16 v[64:67], a[64:67], a[4:7], v[64:67]
  ds_read_b64_tr_b16 a[112:113], v18 offset:12288
  v_mfma_f32_16x16x32_bf16 v[64:67], a[96:99], a[20:23], v[64:67]
  v_mfma_f32_16x16x32_bf16 v[96:99], a[64:67], a[8:11], v[96:99]
  buffer_load_dwordx4 v7, s[8:11], s26 offen offset:3072 lds
  v_mfma_f32_16x16x32_bf16 v[96:99], a[96:99], a[24:27], v[96:99]
  s_add_u32 m0, s88, 4096
  ds_read_b64_tr_b16 a[114:115], v18 offset:14336
  ds_read_b64_tr_b16 a[84:85], v19 offset:8192
  v_mfma_f32_16x16x32_bf16 v[128:131], a[64:67], a[12:15], v[128:131]
  s_add_u32 s88, s88, s90
  ds_read_b64_tr_b16 a[86:87], v19 offset:10240
  v_mfma_f32_16x16x32_bf16 v[128:131], a[96:99], a[28:31], v[128:131]
  s_add_u32 s89, s89, 1
  v_mfma_f32_16x16x32_bf16 v[36:39], a[68:71], a[0:3], v[36:39]
  buffer_load_dwordx4 v4, s[8:11], s27 offen offset:0 lds
  v_mfma_f32_16x16x32_bf16 v[36:39], a[100:103], a[16:19], v[36:39]
  ds_read_b64_tr_b16 a[116:117], v19 offset:12288
  ds_read_b64_tr_b16 a[118:119], v19 offset:14336
  v_mfma_f32_16x16x32_bf16 v[68:71], a[68:71], a[4:7], v[68:71]
  s_cmp_eq_u32 s89, 3
  s_cselect_b32 s89, 0, s89
  s_cselect_b32 s90, s91, s92
  v_mfma_f32_16x16x32_bf16 v[68:71], a[100:103], a[20:23], v[68:71]
  s_add_u32 s68, s68, s70
  ds_read_b64_tr_b16 a[88:89], v20 offset:8192
  v_mfma_f32_16x16x32_bf16 v[100:103], a[68:71], a[8:11], v[100:103]
  buffer_load_dwordx4 v5, s[8:11], s27 offen offset:1024 lds
  v_mfma_f32_16x16x32_bf16 v[100:103], a[100:103], a[24:27], v[100:103]
  s_add_u32 s69, s69, 1
  ds_read_b64_tr_b16 a[90:91], v20 offset:10240
  ds_read_b64_tr_b16 a[120:121], v20 offset:12288
  v_mfma_f32_16x16x32_bf16 v[132:135], a[68:71], a[12:15], v[132:135]
  s_cmp_eq_u32 s69, 3
  s_cselect_b32 s69, 0, s69
  s_cselect_b32 s70, s71, s72
  v_mfma_f32_16x16x32_bf16 v[132:135], a[100:103], a[28:31], v[132:135]
  ds_read_b64_tr_b16 a[122:123], v20 offset:14336
  v_mfma_f32_16x16x32_bf16 v[40:43], a[72:75], a[0:3], v[40:43]
  buffer_load_dwordx4 v6, s[8:11], s27 offen offset:2048 lds
  v_mfma_f32_16x16x32_bf16 v[40:43], a[104:107], a[16:19], v[40:43]
  ds_read_b64_tr_b16 a[92:93], v21 offset:8192
  ds_read_b64_tr_b16 a[94:95], v21 offset:10240
  v_mfma_f32_16x16x32_bf16 v[72:75], a[72:75], a[4:7], v[72:75]
  v_mfma_f32_16x16x32_bf16 v[72:75], a[104:107], a[20:23], v[72:75]
  ds_read_b64_tr_b16 a[124:125], v21 offset:12288
  v_mfma_f32_16x16x32_bf16 v[104:107], a[72:75], a[8:11], v[104:107]
  buffer_load_dwordx4 v7, s[8:11], s27 offen offset:3072 lds
  v_mfma_f32_16x16x32_bf16 v[104:107], a[104:107], a[24:27], v[104:107]
  s_bfe_u32 s29, 0x302010e, s53
  ds_read_b64_tr_b16 a[126:127], v21 offset:14336
  v_mfma_f32_16x16x32_bf16 v[136:139], a[72:75], a[12:15], v[136:139]
  s_add_u32 s52, s52, s29
  v_add_u32 v16, s90, v16
  v_add_u32 v17, s90, v17
  v_mfma_f32_16x16x32_bf16 v[136:139], a[104:107], a[28:31], v[136:139]
  s_add_u32 s53, s53, 8
  v_add_u32 v18, s70, v18
  v_add_u32 v19, s70, v19
  v_mfma_f32_16x16x32_bf16 v[44:47], a[76:79], a[0:3], v[44:47]
  s_and_b32 s53, s53, 0x8001f
  v_add_u32 v20, s70, v20
  v_add_u32 v21, s70, v21
  v_mfma_f32_16x16x32_bf16 v[44:47], a[108:111], a[16:19], v[44:47]
  s_and_b32 s52, s52, 15
  v_mfma_f32_16x16x32_bf16 v[76:79], a[76:79], a[4:7], v[76:79]
  s_lshl_b32 s29, s52, 7
  v_mfma_f32_16x16x32_bf16 v[76:79], a[108:111], a[20:23], v[76:79]
  s_or_b32 s26, s30, s29
  v_mfma_f32_16x16x32_bf16 v[108:111], a[76:79], a[8:11], v[108:111]
  s_or_b32 s27, s31, s29
  v_mfma_f32_16x16x32_bf16 v[108:111], a[108:111], a[24:27], v[108:111]
  v_mfma_f32_16x16x32_bf16 v[140:143], a[76:79], a[12:15], v[140:143]
  v_mfma_f32_16x16x32_bf16 v[140:143], a[108:111], a[28:31], v[140:143]
  s_waitcnt vmcnt(12) lgkmcnt(0)
  s_barrier
  s_mov_b32 s5, 0x40000
Ltg_3:
  v_readfirstlane_b32 s94, v22
  v_readfirstlane_b32 s95, v23
  s_nop 0
  s_cmp_lg_u32 s95, 0
  s_cbranch_scc1 Lpolld_4
  s_sleep 4
  s_mov_b32 s12, s84
  s_mov_b32 s13, s85
  s_mov_b32 s14, 256
  s_mov_b32 s15, 0x00020000
  buffer_load_dwordx2 v[22:23], off, s[12:15], 0 sc1
  s_sub_u32 s5, s5, 1
  s_waitcnt vmcnt(0)
  s_cbranch_scc0 Ltg_3
Lpolld_4:
  v_mov_b32 v3, 0x40000000
  v_mov_b32 v22, s94
  v_cmp_eq_u32 vcc, 0, v0
  v_mov_b32 v23, s95
  s_nop 0
  v_cndmask_b32_e64 v3, v3, 0, vcc
  buffer_store_dwordx2 v[22:23], v3, s[96:99], s34 offen sc1
  v_mfma_f32_16x16x32_bf16 v[48:51], a[80:83], a[0:3], v[48:51]
  s_mov_b32 m0, s68
  ds_read_b128 a[32:35], v16 offset:0
  ds_read_b128 a[48:51], v17 offset:0
  v_mfma_f32_16x16x32_bf16 v[48:51], a[112:115], a[16:19], v[48:51]
  buffer_load_dwordx4 v8, s[20:23], s28 offen offset:0 lds
  v_mfma_f32_16x16x32_bf16 v[80:83], a[80:83], a[4:7], v[80:83]
  ds_read_b64_tr_b16 a[64:65], v18 offset:0
  ds_read_b64_tr_b16 a[66:67], v18 offset:2048
  v_mfma_f32_16x16x32_bf16 v[80:83], a[112:115], a[20:23], v[80:83]
  ds_read_b64_tr_b16 a[96:97], v18 offset:4096
  v_mfma_f32_16x16x32_bf16 v[112:115], a[80:83], a[8:11], v[112:115]
  ds_read_b64_tr_b16 a[98:99], v18 offset:6144
  v_mfma_f32_16x16x32_bf16 v[112:115], a[112:115], a[24:27], v[112:115]
  buffer_load_dwordx4 v9, s[20:23], s28 offen offset:1024 lds
  v_mfma_f32_16x16x32_bf16 v[144:147], a[80:83], a[12:15], v[144:147]
  ds_read_b128 a[36:39], v16 offset:2048
  ds_read_b128 a[52:55], v17 offset:2048
  v_mfma_f32_16x16x32_bf16 v[144:147], a[112:115], a[28:31], v[144:147]
  ds_read_b128 a[40:43], v16 offset:4096
  v_mfma_f32_16x16x32_bf16 v[52:55], a[84:87], a[0:3], v[52:55]
  ds_read_b128 a[56:59], v17 offset:4096
  v_mfma_f32_16x16x32_bf16 v[52:55], a[116:119], a[16:19], v[52:55]
  ds_read_b128 a[44:47], v16 offset:6144
  v_mfma_f32_16x16x32_bf16 v[84:87], a[84:87], a[4:7], v[84:87]
  buffer_load_dwordx4 v10, s[20:23], s28 offen offset:2048 lds
  v_mfma_f32_16x16x32_bf16 v[84:87], a[116:119], a[20:23], v[84:87]
  ds_read_b128 a[60:63], v17 offset:6144
  ds_read_b64_tr_b16 a[68:69], v19 offset:0
  v_mfma_f32_16x16x32_bf16 v[116:119], a[84:87], a[8:11], v[116:119]
  ds_read_b64_tr_b16 a[70:71], v19 offset:2048
  ds_read_b64_tr_b16 a[100:101], v19 offset:4096
  v_mfma_f32_16x16x32_bf16 v[116:119], a[116:119], a[24:27], v[116:119]
  ds_read_b64_tr_b16 a[102:103], v19 offset:6144
  v_mfma_f32_16x16x32_bf16 v[148:151], a[84:87], a[12:15], v[148:151]
  ds_read_b64_tr_b16 a[72:73], v20 offset:0
  v_mfma_f32_16x16x32_bf16 v[148:151], a[116:119], a[28:31], v[148:151]
  buffer_load_dwordx4 v11, s[20:23], s28 offen offset:3072 lds
  v_mfma_f32_16x16x32_bf16 v[56:59], a[88:91], a[0:3], v[56:59]
  s_bfe_u32 s56, 0x302010e, s55
  s_add_u32 s54, s54, s56
  s_add_u32 s55, s55, 8
  v_mfma_f32_16x16x32_bf16 v[56:59], a[120:123], a[16:19], v[56:59]
  s_and_b32 s55, s55, 0x8001f
  s_and_b32 s54, s54, 15
  s_lshl_b32 s28, s54, 19
  v_mfma_f32_16x16x32_bf16 v[88:91], a[88:91], a[4:7], v[88:91]
  s_mov_b32 m0, s88
  ds_read_b64_tr_b16 a[74:75], v20 offset:2048
  ds_read_b64_tr_b16 a[104:105], v20 offset:4096
  v_mfma_f32_16x16x32_bf16 v[88:91], a[120:123], a[20:23], v[88:91]
  ds_read_b64_tr_b16 a[106:107], v20 offset:6144
  ds_read_b64_tr_b16 a[76:77], v21 offset:0
  v_mfma_f32_16x16x32_bf16 v[120:123], a[88:91], a[8:11], v[120:123]
  buffer_load_dwordx4 v4, s[8:11], s26 offen offset:0 lds
  v_mfma_f32_16x16x32_bf16 v[120:123], a[120:123], a[24:27], v[120:123]
  ds_read_b64_tr_b16 a[78:79], v21 offset:2048
  ds_read_b64_tr_b16 a[108:109], v21 offset:4096
  v_mfma_f32_16x16x32_bf16 v[152:155], a[88:91], a[12:15], v[152:155]
  ds_read_b64_tr_b16 a[110:111], v21 offset:6144
  v_mfma_f32_16x16x32_bf16 v[152:155], a[120:123], a[28:31], v[152:155]
  v_mfma_f32_16x16x32_bf16 v[60:63], a[92:95], a[0:3], v[60:63]
  v_mfma_f32_16x16x32_bf16 v[60:63], a[124:127], a[16:19], v[60:63]
  buffer_load_dwordx4 v5, s[8:11], s26 offen offset:1024 lds
  v_mfma_f32_16x16x32_bf16 v[92:95], a[92:95], a[4:7], v[92:95]
  v_mfma_f32_16x16x32_bf16 v[92:95], a[124:127], a[20:23], v[92:95]
  v_mfma_f32_16x16x32_bf16 v[124:127], a[92:95], a[8:11], v[124:127]
  v_mfma_f32_16x16x32_bf16 v[124:127], a[124:127], a[24:27], v[124:127]
  v_mfma_f32_16x16x32_bf16 v[156:159], a[92:95], a[12:15], v[156:159]
  v_mfma_f32_16x16x32_bf16 v[156:159], a[124:127], a[28:31], v[156:159]
  s_waitcnt lgkmcnt(0)
  v_mfma_f32_16x16x32_bf16 v[32:35], a[64:67], a[32:35], v[32:35]
  buffer_load_dwordx4 v6, s[8:11], s26 offen offset:2048 lds
  v_mfma_f32_16x16x32_bf16 v[32:35], a[96:99], a[48:51], v[32:35]
  ds_read_b64_tr_b16 a[80:81], v18 offset:8192
  ds_read_b64_tr_b16 a[82:83], v18 offset:10240
  v_mfma_f32_16x16x32_bf16 v[64:67], a[64:67], a[36:39], v[64:67]
  ds_read_b64_tr_b16 a[112:113], v18 offset:12288
  v_mfma_f32_16x16x32_bf16 v[64:67], a[96:99], a[52:55], v[64:67]
  v_mfma_f32_16x16x32_bf16 v[96:99], a[64:67], a[40:43], v[96:99]
  buffer_load_dwordx4 v7, s[8:11], s26 offen offset:3072 lds
  v_mfma_f32_16x16x32_bf16 v[96:99], a[96:99], a[56:59], v[96:99]
  s_add_u32 m0, s88, 4096
  ds_read_b64_tr_b16 a[114:115], v18 offset:14336
  ds_read_b64_tr_b16 a[84:85], v19 offset:8192
  v_mfma_f32_16x16x32_bf16 v[128:131], a[64:67], a[44:47], v[128:131]
  s_add_u32 s88, s88, s90
  ds_read_b64_tr_b16 a[86:87], v19 offset:10240
  v_mfma_f32_16x16x32_bf16 v[128:131], a[96:99], a[60:63], v[128:131]
  s_add_u32 s89, s89, 1
  v_mfma_f32_16x16x32_bf16 v[36:39], a[68:71], a[32:35], v[36:39]
  buffer_load_dwordx4 v4, s[8:11], s27 offen offset:0 lds
  v_mfma_f32_16x16x32_bf16 v[36:39], a[100:103], a[48:51], v[36:39]
  ds_read_b64_tr_b16 a[116:117], v19 offset:12288
  ds_read_b64_tr_b16 a[118:119], v19 offset:14336
  v_mfma_f32_16x16x32_bf16 v[68:71], a[68:71], a[36:39], v[68:71]
  s_cmp_eq_u32 s89, 3
  s_cselect_b32 s89, 0, s89
  s_cselect_b32 s90, s91, s92
  v_mfma_f32_16x16x32_bf16 v[68:71], a[100:103], a[52:55], v[68:71]
  s_add_u32 s68, s68, s70
  ds_read_b64_tr_b16 a[88:89], v20 offset:8192
  v_mfma_f32_16x16x32_bf16 v[100:103], a[68:71], a[40:43], v[100:103]
  buffer_load_dwordx4 v5, s[8:11], s27 offen offset:1024 lds
  v_mfma_f32_16x16x32_bf16 v[100:103], a[100:103], a[56:59], v[100:103]
  s_add_u32 s69, s69, 1
  ds_read_b64_tr_b16 a[90:91], v20 offset:10240
  ds_read_b64_tr_b16 a[120:121], v20 offset:12288
  v_mfma_f32_16x16x32_bf16 v[132:135], a[68:71], a[44:47], v[132:135]
  s_cmp_eq_u32 s69, 3
  s_cselect_b32 s69, 0, s69
  s_cselect_b32 s70, s71, s72
  v_mfma_f32_16x16x32_bf16 v[132:135], a[100:103], a[60:63], v[132:135]
  ds_read_b64_tr_b16 a[122:123], v20 offset:14336
  v_mfma_f32_16x16x32_bf16 v[40:43], a[72:75], a[32:35], v[40:43]
  buffer_load_dwordx4 v6, s[8:11], s27 offen offset:2048 lds
  v_mfma_f32_16x16x32_bf16 v[40:43], a[104:107], a[48:51], v[40:43]
  ds_read_b64_tr_b16 a[92:93], v21 offset:8192
  ds_read_b64_tr_b16 a[94:95], v21 offset:10240
  v_mfma_f32_16x16x32_bf16 v[72:75], a[72:75], a[36:39], v[72:75]
  v_mfma_f32_16x16x32_bf16 v[72:75], a[104:107], a[52:55], v[72:75]
  ds_read_b64_tr_b16 a[124:125], v21 offset:12288
  v_mfma_f32_16x16x32_bf16 v[104:107], a[72:75], a[40:43], v[104:107]
  buffer_load_dwordx4 v7, s[8:11], s27 offen offset:3072 lds
  v_mfma_f32_16x16x32_bf16 v[104:107], a[104:107], a[56:59], v[104:107]
  s_bfe_u32 s29, 0x302010e, s53
  ds_read_b64_tr_b16 a[126:127], v21 offset:14336
  v_mfma_f32_16x16x32_bf16 v[136:139], a[72:75], a[44:47], v[136:139]
  s_add_u32 s52, s52, s29
  v_add_u32 v16, s90, v16
  v_add_u32 v17, s90, v17
  v_mfma_f32_16x16x32_bf16 v[136:139], a[104:107], a[60:63], v[136:139]
  s_add_u32 s53, s53, 8
  v_add_u32 v18, s70, v18
  v_add_u32 v19, s70, v19
  v_mfma_f32_16x16x32_bf16 v[44:47], a[76:79], a[32:35], v[44:47]
  s_and_b32 s53, s53, 0x8001f
  v_add_u32 v20, s70, v20
  v_add_u32 v21, s70, v21
  v_mfma_f32_16x16x32_bf16 v[44:47], a[108:111], a[48:51], v[44:47]
  s_and_b32 s52, s52, 15
  v_mfma_f32_16x16x32_bf16 v[76:79], a[76:79], a[36:39], v[76:79]
  s_lshl_b32 s29, s52, 7
  v_mfma_f32_16x16x32_bf16 v[76:79], a[108:111], a[52:55], v[76:79]
  s_or_b32 s26, s30, s29
  v_mfma_f32_16x16x32_bf16 v[108:111], a[76:79], a[40:43], v[108:111]
  s_or_b32 s27, s31, s29
  v_mfma_f32_16x16x32_bf16 v[108:111], a[108:111], a[56:59], v[108:111]
  v_mfma_f32_16x16x32_bf16 v[140:143], a[76:79], a[44:47], v[140:143]
  v_mfma_f32_16x16x32_bf16 v[140:143], a[108:111], a[60:63], v[140:143]
  s_mov_b32 s35, 3
  s_waitcnt vmcnt(12) lgkmcnt(0)
  s_barrier
  .p2align 6
Lp3_loop:
  v_mfma_f32_16x16x32_bf16 v[48:51], a[80:83], a[32:35], v[48:51]
  s_mov_b32 m0, s68
  ds_read_b128 a[0:3], v16 offset:0
  ds_read_b128 a[16:19], v17 offset:0
  v_mfma_f32_16x16x32_bf16 v[48:51], a[112:115], a[48:51], v[48:51]
  buffer_load_dwordx4 v8, s[20:23], s28 offen offset:0 lds
  v_mfma_f32_16x16x32_bf16 v[80:83], a[80:83], a[36:39], v[80:83]
  ds_read_b64_tr_b16 a[64:65], v18 offset:0
  ds_read_b64_tr_b16 a[66:67], v18 offset:2048
  v_mfma_f32_16x16x32_bf16 v[80:83], a[112:115], a[52:55], v[80:83]
  ds_read_b64_tr_b16 a[96:97], v18 offset:4096
  v_mfma_f32_16x16x32_bf16 v[112:115], a[80:83], a[40:43], v[112:115]
  ds_read_b64_tr_b16 a[98:99], v18 offset:6144
  v_mfma_f32_16x16x32_bf16 v[112:115], a[112:115], a[56:59], v[112:115]
  buffer_load_dwordx4 v9, s[20:23], s28 offen offset:1024 lds
  v_mfma_f32_16x16x32_bf16 v[144:147], a[80:83], a[44:47], v[144:147]
  ds_read_b128 a[4:7], v16 offset:2048
  ds_read_b128 a[20:23], v17 offset:2048
  v_mfma_f32_16x16x32_bf16 v[144:147], a[112:115], a[60:63], v[144:147]
  ds_read_b128 a[8:11], v16 offset:4096
  v_mfma_f32_16x16x32_bf16 v[52:55], a[84:87], a[32:35], v[52:55]
  ds_read_b128 a[24:27], v17 offset:4096
  v_mfma_f32_16x16x32_bf16 v[52:55], a[116:119], a[48:51], v[52:55]
  ds_read_b128 a[12:15], v16 offset:6144
  v_mfma_f32_16x16x32_bf16 v[84:87], a[84:87], a[36:39], v[84:87]
  buffer_load_dwordx4 v10, s[20:23], s28 offen offset:2048 lds
  v_mfma_f32_16x16x32_bf16 v[84:87], a[116:119], a[52:55], v[84:87]
  ds_read_b128 a[28:31], v17 offset:6144
  ds_read_b64_tr_b16 a[68:69], v19 offset:0
  v_mfma_f32_16x16x32_bf16 v[116:119], a[84:87], a[40:43], v[116:119]
  ds_read_b64_tr_b16 a[70:71], v19 offset:2048
  ds_read_b64_tr_b16 a[100:101], v19 offset:4096
  v_mfma_f32_16x16x32_bf16 v[116:119], a[116:119], a[56:59], v[116:119]
  ds_read_b64_tr_b16 a[102:103], v19 offset:6144
  v_mfma_f32_16x16x32_bf16 v[148:151], a[84:87], a[44:47], v[148:151]
  ds_read_b64_tr_b16 a[72:73], v20 offset:0
  v_mfma_f32_16x16x32_bf16 v[148:151], a[116:119], a[60:63], v[148:151]
  buffer_load_dwordx4 v11, s[20:23], s28 offen offset:3072 lds
  v_mfma_f32_16x16x32_bf16 v[56:59], a[88:91], a[32:35], v[56:59]
  s_bfe_u32 s56, 0x302010e, s55
  s_add_u32 s54, s54, s56
  s_add_u32 s55, s55, 8
  v_mfma_f32_16x16x32_bf16 v[56:59], a[120:123], a[48:51], v[56:59]
  s_and_b32 s55, s55, 0x8001f
  s_and_b32 s54, s54, 15
  s_lshl_b32 s28, s54, 19
  v_mfma_f32_16x16x32_bf16 v[88:91], a[88:91], a[36:39], v[88:91]
  s_mov_b32 m0, s88
  ds_read_b64_tr_b16 a[74:75], v20 offset:2048
  ds_read_b64_tr_b16 a[104:105], v20 offset:4096
  v_mfma_f32_16x16x32_bf16 v[88:91], a[120:123], a[52:55], v[88:91]
  ds_read_b64_tr_b16 a[106:107], v20 offset:6144
  ds_read_b64_tr_b16 a[76:77], v21 offset:0
  v_mfma_f32_16x16x32_bf16 v[120:123], a[88:91], a[40:43], v[120:123]
  buffer_load_dwordx4 v4, s[8:11], s26 offen offset:0 lds
  v_mfma_f32_16x16x32_bf16 v[120:123], a[120:123], a[56:59], v[120:123]
  ds_read_b64_tr_b16 a[78:79], v21 offset:2048
  ds_read_b64_tr_b16 a[108:109], v21 offset:4096
  v_mfma_f32_16x16x32_bf16 v[152:155], a[88:91], a[44:47], v[152:155]
  ds_read_b64_tr_b16 a[110:111], v21 offset:6144
  v_mfma_f32_16x16x32_bf16 v[152:155], a[120:123], a[60:63], v[152:155]
  v_mfma_f32_16x16x32_bf16 v[60:63], a[92:95], a[32:35], v[60:63]
  v_mfma_f32_16x16x32_bf16 v[60:63], a[124:127], a[48:51], v[60:63]
  buffer_load_dwordx4 v5, s[8:11], s26 offen offset:1024 lds
  v_mfma_f32_16x16x32_bf16 v[92:95], a[92:95], a[36:39], v[92:95]
  v_mfma_f32_16x16x32_bf16 v[92:95], a[124:127], a[52:55], v[92:95]
  v_mfma_f32_16x16x32_bf16 v[124:127], a[92:95], a[40:43], v[124:127]
  v_mfma_f32_16x16x32_bf16 v[124:127], a[124:127], a[56:59], v[124:127]
  v_mfma_f32_16x16x32_bf16 v[156:159], a[92:95], a[44:47], v[156:159]
  v_mfma_f32_16x16x32_bf16 v[156:159], a[124:127], a[60:63], v[156:159]
  s_waitcnt lgkmcnt(0)
  v_mfma_f32_16x16x32_bf16 v[32:35], a[64:67], a[0:3], v[32:35]
  buffer_load_dwordx4 v6, s[8:11], s26 offen offset:2048 lds
  v_mfma_f32_16x16x32_bf16 v[32:35], a[96:99], a[16:19], v[32:35]
  ds_read_b64_tr_b16 a[80:81], v18 offset:8192
  ds_read_b64_tr_b16 a[82:83], v18 offset:10240
  v_mfma_f32_16x16x32_bf16 v[64:67], a[64:67], a[4:7], v[64:67]
  ds_read_b64_tr_b16 a[112:113], v18 offset:12288
  v_mfma_f32_16x16x32_bf16 v[64:67], a[96:99], a[20:23], v[64:67]
  v_mfma_f32_16x16x32_bf16 v[96:99], a[64:67], a[8:11], v[96:99]
  buffer_load_dwordx4 v7, s[8:11], s26 offen offset:3072 lds
  v_mfma_f32_16x16x32_bf16 v[96:99], a[96:99], a[24:27], v[96:99]
  s_add_u32 m0, s88, 4096
  ds_read_b64_tr_b16 a[114:115], v18 offset:14336
  ds_read_b64_tr_b16 a[84:85], v19 offset:8192
  v_mfma_f32_16x16x32_bf16 v[128:131], a[64:67], a[12:15], v[128:131]
  s_add_u32 s88, s88, s90
  ds_read_b64_tr_b16 a[86:87], v19 offset:10240
  v_mfma_f32_16x16x32_bf16 v[128:131], a[96:99], a[28:31], v[128:131]
  s_add_u32 s89, s89, 1
  v_mfma_f32_16x16x32_bf16 v[36:39], a[68:71], a[0:3], v[36:39]
  buffer_load_dwordx4 v4, s[8:11], s27 offen offset:0 lds
  v_mfma_f32_16x16x32_bf16 v[36:39], a[100:103], a[16:19], v[36:39]
  ds_read_b64_tr_b16 a[116:117], v19 offset:12288
  ds_read_b64_tr_b16 a[118:119], v19 offset:14336
  v_mfma_f32_16x16x32_bf16 v[68:71], a[68:71], a[4:7], v[68:71]
  s_cmp_eq_u32 s89, 3
  s_cselect_b32 s89, 0, s89
  s_cselect_b32 s90, s91, s92
  v_mfma_f32_16x16x32_bf16 v[68:71], a[100:103], a[20:23], v[68:71]
  s_add_u32 s68, s68, s70
  ds_read_b64_tr_b16 a[88:89], v20 offset:8192
  v_mfma_f32_16x16x32_bf16 v[100:103], a[68:71], a[8:11], v[100:103]
  buffer_load_dwordx4 v5, s[8:11], s27 offen offset:1024 lds
  v_mfma_f32_16x16x32_bf16 v[100:103], a[100:103], a[24:27], v[100:103]
  s_add_u32 s69, s69, 1
  ds_read_b64_tr_b16 a[90:91], v20 offset:10240
  ds_read_b64_tr_b16 a[120:121], v20 offset:12288
  v_mfma_f32_16x16x32_bf16 v[132:135], a[68:71], a[12:15], v[132:135]
  s_cmp_eq_u32 s69, 3
  s_cselect_b32 s69, 0, s69
  s_cselect_b32 s70, s71, s72
  v_mfma_f32_16x16x32_bf16 v[132:135], a[100:103], a[28:31], v[132:135]
  ds_read_b64_tr_b16 a[122:123], v20 offset:14336
  v_mfma_f32_16x16x32_bf16 v[40:43], a[72:75], a[0:3], v[40:43]
  buffer_load_dwordx4 v6, s[8:11], s27 offen offset:2048 lds
  v_mfma_f32_16x16x32_bf16 v[40:43], a[104:107], a[16:19], v[40:43]
  ds_read_b64_tr_b16 a[92:93], v21 offset:8192
  ds_read_b64_tr_b16 a[94:95], v21 offset:10240
  v_mfma_f32_16x16x32_bf16 v[72:75], a[72:75], a[4:7], v[72:75]
  v_mfma_f32_16x16x32_bf16 v[72:75], a[104:107], a[20:23], v[72:75]
  ds_read_b64_tr_b16 a[124:125], v21 offset:12288
  v_mfma_f32_16x16x32_bf16 v[104:107], a[72:75], a[8:11], v[104:107]
  buffer_load_dwordx4 v7, s[8:11], s27 offen offset:3072 lds
  v_mfma_f32_16x16x32_bf16 v[104:107], a[104:107], a[24:27], v[104:107]
  s_bfe_u32 s29, 0x302010e, s53
  ds_read_b64_tr_b16 a[126:127], v21 offset:14336
  v_mfma_f32_16x16x32_bf16 v[136:139], a[72:75], a[12:15], v[136:139]
  s_add_u32 s52, s52, s29
  v_add_u32 v16, s90, v16
  v_add_u32 v17, s90, v17
  v_mfma_f32_16x16x32_bf16 v[136:139], a[104:107], a[28:31], v[136:139]
  s_add_u32 s53, s53, 8
  v_add_u32 v18, s70, v18
  v_add_u32 v19, s70, v19
  v_mfma_f32_16x16x32_bf16 v[44:47], a[76:79], a[0:3], v[44:47]
  s_and_b32 s53, s53, 0x8001f
  v_add_u32 v20, s70, v20
  v_add_u32 v21, s70, v21
  v_mfma_f32_16x16x32_bf16 v[44:47], a[108:111], a[16:19], v[44:47]
  s_and_b32 s52, s52, 15
  v_mfma_f32_16x16x32_bf16 v[76:79], a[76:79], a[4:7], v[76:79]
  s_lshl_b32 s29, s52, 7
  v_mfma_f32_16x16x32_bf16 v[76:79], a[108:111], a[20:23], v[76:79]
  s_or_b32 s26, s30, s29
  v_mfma_f32_16x16x32_bf16 v[108:111], a[76:79], a[8:11], v[108:111]
  s_or_b32 s27, s31, s29
  v_mfma_f32_16x16x32_bf16 v[108:111], a[108:111], a[24:27], v[108:111]
  v_mfma_f32_16x16x32_bf16 v[140:143], a[76:79], a[12:15], v[140:143]
  v_mfma_f32_16x16x32_bf16 v[140:143], a[108:111], a[28:31], v[140:143]
  s_waitcnt vmcnt(12) lgkmcnt(0)
  s_barrier
  v_mfma_f32_16x16x32_bf16 v[48:51], a[80:83], a[0:3], v[48:51]
  s_mov_b32 m0, s68
  ds_read_b128 a[32:35], v16 offset:0
  ds_read_b128 a[48:51], v17 offset:0
  v_mfma_f32_16x16x32_bf16 v[48:51], a[112:115], a[16:19], v[48:51]
  buffer_load_dwordx4 v8, s[20:23], s28 offen offset:0 lds
  v_mfma_f32_16x16x32_bf16 v[80:83], a[80:83], a[4:7], v[80:83]
  ds_read_b64_tr_b16 a[64:65], v18 offset:0
  ds_read_b64_tr_b16 a[66:67], v18 offset:2048
  v_mfma_f32_16x16x32_bf16 v[80:83], a[112:115], a[20:23], v[80:83]
  ds_read_b64_tr_b16 a[96:97], v18 offset:4096
  v_mfma_f32_16x16x32_bf16 v[112:115], a[80:83], a[8:11], v[112:115]
  ds_read_b64_tr_b16 a[98:99], v18 offset:6144
  v_mfma_f32_16x16x32_bf16 v[112:115], a[112:115], a[24:27], v[112:115]
  buffer_load_dwordx4 v9, s[20:23], s28 offen offset:1024 lds
  v_mfma_f32_16x16x32_bf16 v[144:147], a[80:83], a[12:15], v[144:147]
  ds_read_b128 a[36:39], v16 offset:2048
  ds_read_b128 a[52:55], v17 offset:2048
  v_mfma_f32_16x16x32_bf16 v[144:147], a[112:115], a[28:31], v[144:147]
  ds_read_b128 a[40:43], v16 offset:4096
  v_mfma_f32_16x16x32_bf16 v[52:55], a[84:87], a[0:3], v[52:55]
  ds_read_b128 a[56:59], v17 offset:4096
  v_mfma_f32_16x16x32_bf16 v[52:55], a[116:119], a[16:19], v[52:55]
  ds_read_b128 a[44:47], v16 offset:6144
  v_mfma_f32_16x16x32_bf16 v[84:87], a[84:87], a[4:7], v[84:87]
  buffer_load_dwordx4 v10, s[20:23], s28 offen offset:2048 lds
  v_mfma_f32_16x16x32_bf16 v[84:87], a[116:119], a[20:23], v[84:87]
  ds_read_b128 a[60:63], v17 offset:6144
  ds_read_b64_tr_b16 a[68:69], v19 offset:0
  v_mfma_f32_16x16x32_bf16 v[116:119], a[84:87], a[8:11], v[116:119]
  ds_read_b64_tr_b16 a[70:71], v19 offset:2048
  ds_read_b64_tr_b16 a[100:101], v19 offset:4096
  v_mfma_f32_16x16x32_bf16 v[116:119], a[116:119], a[24:27], v[116:119]
  ds_read_b64_tr_b16 a[102:103], v19 offset:6144
  v_mfma_f32_16x16x32_bf16 v[148:151], a[84:87], a[12:15], v[148:151]
  ds_read_b64_tr_b16 a[72:73], v20 offset:0
  v_mfma_f32_16x16x32_bf16 v[148:151], a[116:119], a[28:31], v[148:151]
  buffer_load_dwordx4 v11, s[20:23], s28 offen offset:3072 lds
  v_mfma_f32_16x16x32_bf16 v[56:59], a[88:91], a[0:3], v[56:59]
  s_bfe_u32 s56, 0x302010e, s55
  s_add_u32 s54, s54, s56
  s_add_u32 s55, s55, 8
  v_mfma_f32_16x16x32_bf16 v[56:59], a[120:123], a[16:19], v[56:59]
  s_and_b32 s55, s55, 0x8001f
  s_and_b32 s54, s54, 15
  s_lshl_b32 s28, s54, 19
  v_mfma_f32_16x16x32_bf16 v[88:91], a[88:91], a[4:7], v[88:91]
  s_mov_b32 m0, s88
  ds_read_b64_tr_b16 a[74:75], v20 offset:2048
  ds_read_b64_tr_b16 a[104:105], v20 offset:4096
  v_mfma_f32_16x16x32_bf16 v[88:91], a[120:123], a[20:23], v[88:91]
  ds_read_b64_tr_b16 a[106:107], v20 offset:6144
  ds_read_b64_tr_b16 a[76:77], v21 offset:0
  v_mfma_f32_16x16x32_bf16 v[120:123], a[88:91], a[8:11], v[120:123]
  buffer_load_dwordx4 v4, s[8:11], s26 offen offset:0 lds
  v_mfma_f32_16x16x32_bf16 v[120:123], a[120:123], a[24:27], v[120:123]
  ds_read_b64_tr_b16 a[78:79], v21 offset:2048
  ds_read_b64_tr_b16 a[108:109], v21 offset:4096
  v_mfma_f32_16x16x32_bf16 v[152:155], a[88:91], a[12:15], v[152:155]
  ds_read_b64_tr_b16 a[110:111], v21 offset:6144
  v_mfma_f32_16x16x32_bf16 v[152:155], a[120:123], a[28:31], v[152:155]
  v_mfma_f32_16x16x32_bf16 v[60:63], a[92:95], a[0:3], v[60:63]
  v_mfma_f32_16x16x32_bf16 v[60:63], a[124:127], a[16:19], v[60:63]
  buffer_load_dwordx4 v5, s[8:11], s26 offen offset:1024 lds
  v_mfma_f32_16x16x32_bf16 v[92:95], a[92:95], a[4:7], v[92:95]
  v_mfma_f32_16x16x32_bf16 v[92:95], a[124:127], a[20:23], v[92:95]
  v_mfma_f32_16x16x32_bf16 v[124:127], a[92:95], a[8:11], v[124:127]
  v_mfma_f32_16x16x32_bf16 v[124:127], a[124:127], a[24:27], v[124:127]
  v_mfma_f32_16x16x32_bf16 v[156:159], a[92:95], a[12:15], v[156:159]
  v_mfma_f32_16x16x32_bf16 v[156:159], a[124:127], a[28:31], v[156:159]
  s_waitcnt lgkmcnt(0)
  v_mfma_f32_16x16x32_bf16 v[32:35], a[64:67], a[32:35], v[32:35]
  buffer_load_dwordx4 v6, s[8:11], s26 offen offset:2048 lds
  v_mfma_f32_16x16x32_bf16 v[32:35], a[96:99], a[48:51], v[32:35]
  ds_read_b64_tr_b16 a[80:81], v18 offset:8192
  ds_read_b64_tr_b16 a[82:83], v18 offset:10240
  v_mfma_f32_16x16x32_bf16 v[64:67], a[64:67], a[36:39], v[64:67]
  ds_read_b64_tr_b16 a[112:113], v18 offset:12288
  v_mfma_f32_16x16x32_bf16 v[64:67], a[96:99], a[52:55], v[64:67]
  v_mfma_f32_16x16x32_bf16 v[96:99], a[64:67], a[40:43], v[96:99]
  buffer_load_dwordx4 v7, s[8:11], s26 offen offset:3072 lds
  v_mfma_f32_16x16x32_bf16 v[96:99], a[96:99], a[56:59], v[96:99]
  s_add_u32 m0, s88, 4096
  ds_read_b64_tr_b16 a[114:115], v18 offset:14336
  ds_read_b64_tr_b16 a[84:85], v19 offset:8192
  v_mfma_f32_16x16x32_bf16 v[128:131], a[64:67], a[44:47], v[128:131]
  s_add_u32 s88, s88, s90
  ds_read_b64_tr_b16 a[86:87], v19 offset:10240
  v_mfma_f32_16x16x32_bf16 v[128:131], a[96:99], a[60:63], v[128:131]
  s_add_u32 s89, s89, 1
  v_mfma_f32_16x16x32_bf16 v[36:39], a[68:71], a[32:35], v[36:39]
  buffer_load_dwordx4 v4, s[8:11], s27 offen offset:0 lds
  v_mfma_f32_16x16x32_bf16 v[36:39], a[100:103], a[48:51], v[36:39]
  ds_read_b64_tr_b16 a[116:117], v19 offset:12288
  ds_read_b64_tr_b16 a[118:119], v19 offset:14336
  v_mfma_f32_16x16x32_bf16 v[68:71], a[68:71], a[36:39], v[68:71]
  s_cmp_eq_u32 s89, 3
  s_cselect_b32 s89, 0, s89
  s_cselect_b32 s90, s91, s92
  v_mfma_f32_16x16x32_bf16 v[68:71], a[100:103], a[52:55], v[68:71]
  s_add_u32 s68, s68, s70
  ds_read_b64_tr_b16 a[88:89], v20 offset:8192
  v_mfma_f32_16x16x32_bf16 v[100:103], a[68:71], a[40:43], v[100:103]
  buffer_load_dwordx4 v5, s[8:11], s27 offen offset:1024 lds
  v_mfma_f32_16x16x32_bf16 v[100:103], a[100:103], a[56:59], v[100:103]
  s_add_u32 s69, s69, 1
  ds_read_b64_tr_b16 a[90:91], v20 offset:10240
  ds_read_b64_tr_b16 a[120:121], v20 offset:12288
  v_mfma_f32_16x16x32_bf16 v[132:135], a[68:71], a[44:47], v[132:135]
  s_cmp_eq_u32 s69, 3
  s_cselect_b32 s69, 0, s69
  s_cselect_b32 s70, s71, s72
  v_mfma_f32_16x16x32_bf16 v[132:135], a[100:103], a[60:63], v[132:135]
  ds_read_b64_tr_b16 a[122:123], v20 offset:14336
  v_mfma_f32_16x16x32_bf16 v[40:43], a[72:75], a[32:35], v[40:43]
  buffer_load_dwordx4 v6, s[8:11], s27 offen offset:2048 lds
  v_mfma_f32_16x16x32_bf16 v[40:43], a[104:107], a[48:51], v[40:43]
  ds_read_b64_tr_b16 a[92:93], v21 offset:8192
  ds_read_b64_tr_b16 a[94:95], v21 offset:10240
  v_mfma_f32_16x16x32_bf16 v[72:75], a[72:75], a[36:39], v[72:75]
  v_mfma_f32_16x16x32_bf16 v[72:75], a[104:107], a[52:55], v[72:75]
  ds_read_b64_tr_b16 a[124:125], v21 offset:12288
  v_mfma_f32_16x16x32_bf16 v[104:107], a[72:75], a[40:43], v[104:107]
  buffer_load_dwordx4 v7, s[8:11], s27 offen offset:3072 lds
  v_mfma_f32_16x16x32_bf16 v[104:107], a[104:107], a[56:59], v[104:107]
  s_bfe_u32 s29, 0x302010e, s53
  ds_read_b64_tr_b16 a[126:127], v21 offset:14336
  v_mfma_f32_16x16x32_bf16 v[136:139], a[72:75], a[44:47], v[136:139]
  s_add_u32 s52, s52, s29
  v_add_u32 v16, s90, v16
  v_add_u32 v17, s90, v17
  v_mfma_f32_16x16x32_bf16 v[136:139], a[104:107], a[60:63], v[136:139]
  s_add_u32 s53, s53, 8
  v_add_u32 v18, s70, v18
  v_add_u32 v19, s70, v19
  v_mfma_f32_16x16x32_bf16 v[44:47], a[76:79], a[32:35], v[44:47]
  s_and_b32 s53, s53, 0x8001f
  v_add_u32 v20, s70, v20
  v_add_u32 v21, s70, v21
  v_mfma_f32_16x16x32_bf16 v[44:47], a[108:111], a[48:51], v[44:47]
  s_and_b32 s52, s52, 15
  v_mfma_f32_16x16x32_bf16 v[76:79], a[76:79], a[36:39], v[76:79]
  s_lshl_b32 s29, s52, 7
  v_mfma_f32_16x16x32_bf16 v[76:79], a[108:111], a[52:55], v[76:79]
  s_or_b32 s26, s30, s29
  v_mfma_f32_16x16x32_bf16 v[108:111], a[76:79], a[40:43], v[108:111]
  s_or_b32 s27, s31, s29
  v_mfma_f32_16x16x32_bf16 v[108:111], a[108:111], a[56:59], v[108:111]
  s_waitcnt vmcnt(12) lgkmcnt(0)
  s_barrier
  v_mfma_f32_16x16x32_bf16 v[140:143], a[76:79], a[44:47], v[140:143]
  s_sub_u32 s35, s35, 1
  v_mfma_f32_16x16x32_bf16 v[140:143], a[108:111], a[60:63], v[140:143]
  s_cmp_lg_u32 s35, 0
  s_cbranch_scc1 Lp3_loop
  s_lshr_b32 s34, s24, 1
  s_lshl_b32 s34, s34, 11
  v_and_b32 v3, 7, v1
  v_lshlrev_b32 v3, 7, v3
  v_mfma_f32_16x16x32_bf16 v[48:51], a[80:83], a[32:35], v[48:51]
  buffer_load_dwordx2 v[22:23], v3, s[96:99], s34 offen sc1
  v_mfma_f32_16x16x32_bf16 v[48:51], a[112:115], a[48:51], v[48:51]
  s_mov_b32 m0, s68
  ds_read_b128 a[0:3], v16 offset:0
  ds_read_b128 a[16:19], v17 offset:0
  v_mfma_f32_16x16x32_bf16 v[80:83], a[80:83], a[36:39], v[80:83]
  ds_read_b64_tr_b16 a[64:65], v18 offset:0
  ds_read_b64_tr_b16 a[66:67], v18 offset:2048
  v_mfma_f32_16x16x32_bf16 v[80:83], a[112:115], a[52:55], v[80:83]
  ds_read_b64_tr_b16 a[96:97], v18 offset:4096
  v_mfma_f32_16x16x32_bf16 v[112:115], a[80:83], a[40:43], v[112:115]
  buffer_load_dwordx4 v8, s[20:23], s28 offen offset:0 lds
  v_mfma_f32_16x16x32_bf16 v[112:115], a[112:115], a[56:59], v[112:115]
  ds_read_b64_tr_b16 a[98:99], v18 offset:6144
  ds_read_b128 a[4:7], v16 offset:2048
  v_mfma_f32_16x16x32_bf16 v[144:147], a[80:83], a[44:47], v[144:147]
  ds_read_b128 a[20:23], v17 offset:2048
  v_mfma_f32_16x16x32_bf16 v[144:147], a[112:115], a[60:63], v[144:147]
  ds_read_b128 a[8:11], v16 offset:4096
  v_mfma_f32_16x16x32_bf16 v[52:55], a[84:87], a[32:35], v[52:55]
  buffer_load_dwordx4 v9, s[20:23], s28 offen offset:1024 lds
  v_mfma_f32_16x16x32_bf16 v[52:55], a[116:119], a[48:51], v[52:55]
  ds_read_b128 a[24:27], v17 offset:4096
  ds_read_b128 a[12:15], v16 offset:6144
  v_mfma_f32_16x16x32_bf16 v[84:87], a[84:87], a[36:39], v[84:87]
  ds_read_b128 a[28:31], v17 offset:6144
  v_mfma_f32_16x16x32_bf16 v[84:87], a[116:119], a[52:55], v[84:87]
  ds_read_b64_tr_b16 a[68:69], v19 offset:0
  ds_read_b64_tr_b16 a[70:71], v19 offset:2048
  v_mfma_f32_16x16x32_bf16 v[116:119], a[84:87], a[40:43], v[116:119]
  ds_read_b64_tr_b16 a[100:101], v19 offset:4096
  v_mfma_f32_16x16x32_bf16 v[116:119], a[116:119], a[56:59], v[116:119]
  buffer_load_dwordx4 v10, s[20:23], s28 offen offset:2048 lds
  v_mfma_f32_16x16x32_bf16 v[148:151], a[84:87], a[44:47], v[148:151]
  ds_read_b64_tr_b16 a[102:103], v19 offset:6144
  ds_read_b64_tr_b16 a[72:73], v20 offset:0
  v_mfma_f32_16x16x32_bf16 v[148:151], a[116:119], a[60:63], v[148:151]
  ds_read_b64_tr_b16 a[74:75], v20 offset:2048
  v_mfma_f32_16x16x32_bf16 v[56:59], a[88:91], a[32:35], v[56:59]
  ds_read_b64_tr_b16 a[104:105], v20 offset:4096
  v_mfma_f32_16x16x32_bf16 v[56:59], a[120:123], a[48:51], v[56:59]
  buffer_load_dwordx4 v11, s[20:23], s28 offen offset:3072 lds
  v_mfma_f32_16x16x32_bf16 v[88:91], a[88:91], a[36:39], v[88:91]
  s_bfe_u32 s56, 0x302010e, s55
  s_add_u32 s54, s54, s56
  s_add_u32 s55, s55, 8
  v_mfma_f32_16x16x32_bf16 v[88:91], a[120:123], a[52:55], v[88:91]
  s_and_b32 s55, s55, 0x8001f
  s_and_b32 s54, s54, 15
  s_lshl_b32 s28, s54, 19
  v_mfma_f32_16x16x32_bf16 v[120:123], a[88:91], a[40:43], v[120:123]
  s_mov_b32 m0, s88
  ds_read_b64_tr_b16 a[106:107], v20 offset:6144
  ds_read_b64_tr_b16 a[76:77], v21 offset:0
  v_mfma_f32_16x16x32_bf16 v[120:123], a[120:123], a[56:59], v[120:123]
  ds_read_b64_tr_b16 a[78:79], v21 offset:2048
  ds_read_b64_tr_b16 a[108:109], v21 offset:4096
  v_mfma_f32_16x16x32_bf16 v[152:155], a[88:91], a[44:47], v[152:155]
  buffer_load_dwordx4 v4, s[8:11], s26 offen offset:0 lds
  v_mfma_f32_16x16x32_bf16 v[152:155], a[120:123], a[60:63], v[152:155]
  ds_read_b64_tr_b16 a[110:111], v21 offset:6144
  v_mfma_f32_16x16x32_bf16 v[60:63], a[92:95], a[32:35], v[60:63]
  v_mfma_f32_16x16x32_bf16 v[60:63], a[124:127], a[48:51], v[60:63]
  v_mfma_f32_16x16x32_bf16 v[92:95], a[92:95], a[36:39], v[92:95]
  buffer_load_dwordx4 v5, s[8:11], s26 offen offset:1024 lds
  v_mfma_f32_16x16x32_bf16 v[92:95], a[124:127], a[52:55], v[92:95]
  v_mfma_f32_16x16x32_bf16 v[124:127], a[92:95], a[40:43], v[124:127]
  v_mfma_f32_16x16x32_bf16 v[124:127], a[124:127], a[56:59], v[124:127]
  v_mfma_f32_16x16x32_bf16 v[156:159], a[92:95], a[44:47], v[156:159]
  v_mfma_f32_16x16x32_bf16 v[156:159], a[124:127], a[60:63], v[156:159]
  s_waitcnt lgkmcnt(0)
  v_mfma_f32_16x16x32_bf16 v[32:35], a[64:67], a[0:3], v[32:35]
  buffer_load_dwordx4 v6, s[8:11], s26 offen offset:2048 lds
  v_mfma_f32_16x16x32_bf16 v[32:35], a[96:99], a[16:19], v[32:35]
  ds_read_b64_tr_b16 a[80:81], v18 offset:8192
  ds_read_b64_tr_b16 a[82:83], v18 offset:10240
  v_mfma_f32_16x16x32_bf16 v[64:67], a[64:67], a[4:7], v[64:67]
  ds_read_b64_tr_b16 a[112:113], v18 offset:12288
  v_mfma_f32_16x16x32_bf16 v[64:67], a[96:99], a[20:23], v[64:67]
  v_mfma_f32_16x16x32_bf16 v[96:99], a[64:67], a[8:11], v[96:99]
  buffer_load_dwordx4 v7, s[8:11], s26 offen offset:3072 lds
  v_mfma_f32_16x16x32_bf16 v[96:99], a[96:99], a[24:27], v[96:99]
  s_add_u32 m0, s88, 4096
  ds_read_b64_tr_b16 a[114:115], v18 offset:14336
  ds_read_b64_tr_b16 a[84:85], v19 offset:8192
  v_mfma_f32_16x16x32_bf16 v[128:131], a[64:67], a[12:15], v[128:131]
  s_add_u32 s88, s88, s90
  ds_read_b64_tr_b16 a[86:87], v19 offset:10240
  v_mfma_f32_16x16x32_bf16 v[128:131], a[96:99], a[28:31], v[128:131]
  s_add_u32 s89, s89, 1
  v_mfma_f32_16x16x32_bf16 v[36:39], a[68:71], a[0:3], v[36:39]
  buffer_load_dwordx4 v4, s[8:11], s27 offen offset:0 lds
  v_mfma_f32_16x16x32_bf16 v[36:39], a[100:103], a[16:19], v[36:39]
  ds_read_b64_tr_b16 a[116:117], v19 offset:12288
  ds_read_b64_tr_b16 a[118:119], v19 offset:14336
  v_mfma_f32_16x16x32_bf16 v[68:71], a[68:71], a[4:7], v[68:71]
  s_cmp_eq_u32 s89, 3
  s_cselect_b32 s89, 0, s89
  s_cselect_b32 s90, s91, s92
  v_mfma_f32_16x16x32_bf16 v[68:71], a[100:103], a[20:23], v[68:71]
  s_add_u32 s68, s68, s70
  ds_read_b64_tr_b16 a[88:89], v20 offset:8192
  v_mfma_f32_16x16x32_bf16 v[100:103], a[68:71], a[8:11], v[100:103]
  buffer_load_dwordx4 v5, s[8:11], s27 offen offset:1024 lds
  v_mfma_f32_16x16x32_bf16 v[100:103], a[100:103], a[24:27], v[100:103]
  s_add_u32 s69, s69, 1
  ds_read_b64_tr_b16 a[90:91], v20 offset:10240
  ds_read_b64_tr_b16 a[120:121], v20 offset:12288
  v_mfma_f32_16x16x32_bf16 v[132:135], a[68:71], a[12:15], v[132:135]
  s_cmp_eq_u32 s69, 3
  s_cselect_b32 s69, 0, s69
  s_cselect_b32 s70, s71, s72
  v_mfma_f32_16x16x32_bf16 v[132:135], a[100:103], a[28:31], v[132:135]
  ds_read_b64_tr_b16 a[122:123], v20 offset:14336
  v_mfma_f32_16x16x32_bf16 v[40:43], a[72:75], a[0:3], v[40:43]
  buffer_load_dwordx4 v6, s[8:11], s27 offen offset:2048 lds
  v_mfma_f32_16x16x32_bf16 v[40:43], a[104:107], a[16:19], v[40:43]
  ds_read_b64_tr_b16 a[92:93], v21 offset:8192
  ds_read_b64_tr_b16 a[94:95], v21 offset:10240
  v_mfma_f32_16x16x32_bf16 v[72:75], a[72:75], a[4:7], v[72:75]
  v_mfma_f32_16x16x32_bf16 v[72:75], a[104:107], a[20:23], v[72:75]
  ds_read_b64_tr_b16 a[124:125], v21 offset:12288
  v_mfma_f32_16x16x32_bf16 v[104:107], a[72:75], a[8:11], v[104:107]
  buffer_load_dwordx4 v7, s[8:11], s27 offen offset:3072 lds
  v_mfma_f32_16x16x32_bf16 v[104:107], a[104:107], a[24:27], v[104:107]
  s_bfe_u32 s29, 0x302010e, s53
  ds_read_b64_tr_b16 a[126:127], v21 offset:14336
  v_mfma_f32_16x16x32_bf16 v[136:139], a[72:75], a[12:15], v[136:139]
  s_add_u32 s52, s52, s29
  v_add_u32 v16, s90, v16
  v_add_u32 v17, s90, v17
  v_mfma_f32_16x16x32_bf16 v[136:139], a[104:107], a[28:31], v[136:139]
  s_add_u32 s53, s53, 8
  v_add_u32 v18, s70, v18
  v_add_u32 v19, s70, v19
  v_mfma_f32_16x16x32_bf16 v[44:47], a[76:79], a[0:3], v[44:47]
  s_and_b32 s53, s53, 0x8001f
  v_add_u32 v20, s70, v20
  v_add_u32 v21, s70, v21
  v_mfma_f32_16x16x32_bf16 v[44:47], a[108:111], a[16:19], v[44:47]
  s_and_b32 s52, s52, 15
  v_mfma_f32_16x16x32_bf16 v[76:79], a[76:79], a[4:7], v[76:79]
  s_lshl_b32 s29, s52, 7
  v_mfma_f32_16x16x32_bf16 v[76:79], a[108:111], a[20:23], v[76:79]
  s_or_b32 s26, s30, s29
  v_mfma_f32_16x16x32_bf16 v[108:111], a[76:79], a[8:11], v[108:111]
  s_or_b32 s27, s31, s29
  v_mfma_f32_16x16x32_bf16 v[108:111], a[108:111], a[24:27], v[108:111]
  v_mfma_f32_16x16x32_bf16 v[140:143], a[76:79], a[12:15], v[140:143]
  v_mfma_f32_16x16x32_bf16 v[140:143], a[108:111], a[28:31], v[140:143]
  s_waitcnt vmcnt(12) lgkmcnt(0)
  s_barrier
  s_mov_b32 s5, 0x40000
Lpoll_5:
  v_cmp_ne_u64 vcc, s[94:95], v[22:23]
  s_nop 0
  s_cbranch_vccz Lpolld_6
  s_sleep 4
  buffer_load_dwordx2 v[22:23], v3, s[96:99], s34 offen sc1
  s_sub_u32 s5, s5, 1
  s_waitcnt vmcnt(0)
  s_cbranch_scc0 Lpoll_5
Lpolld_6:
  s_lshl_b32 s4, s24, 20
  s_and_b32 s5, s25, 1
  s_lshl_b32 s5, s5, 1
  s_add_u32 s5, s5, 14
  s_sub_u32 s5, s5, s25
  s_add_u32 s5, s5, 1
  s_lshl_b32 s5, s5, 16
  s_add_u32 s20, s86, 16777216
  s_addc_u32 s21, s87, 0
  s_add_u32 s20, s20, s4
  s_addc_u32 s21, s21, 0
  s_mov_b32 s22, s5
  s_mov_b32 s23, 0x00020000
  s_lshl_b32 s28, s3, 12
  s_add_u32 s26, s28, 0xc000
  s_add_u32 s27, s28, 0x10000
  s_add_u32 s29, s28, 0x4000
  s_and_b32 s4, s2, 1
  s_lshl_b32 s4, s4, 3
  s_bfe_u32 s5, s2, 0x30003
  s_add_u32 s73, s4, s5
  s_bfe_u32 s4, s2, 0x10001
  s_lshl_b32 s4, s4, 2
  s_lshr_b32 s5, s2, 6
  s_add_u32 s76, s4, s5
  s_bfe_u32 s77, s2, 0x10002
  s_lshl_b32 s78, s73, 3
  s_add_u32 s78, s78, s76
  s_lshl_b32 s79, s3, 12
  v_mfma_f32_16x16x32_bf16 v[48:51], a[80:83], a[0:3], v[48:51]
  s_mov_b32 m0, s26
  ds_read_b128 a[32:35], v16 offset:0
  ds_read_b128 a[48:51], v17 offset:0
  v_mfma_f32_16x16x32_bf16 v[48:51], a[112:115], a[16:19], v[48:51]
  buffer_load_dwordx4 v2, s[20:23], s28 offen offset:0 sc1 lds
  v_mfma_f32_16x16x32_bf16 v[80:83], a[80:83], a[4:7], v[80:83]
  ds_read_b64_tr_b16 a[64:65], v18 offset:0
  ds_read_b64_tr_b16 a[66:67], v18 offset:2048
  v_mfma_f32_16x16x32_bf16 v[80:83], a[112:115], a[20:23], v[80:83]
  ds_read_b64_tr_b16 a[96:97], v18 offset:4096
  v_mfma_f32_16x16x32_bf16 v[112:115], a[80:83], a[8:11], v[112:115]
  ds_read_b64_tr_b16 a[98:99], v18 offset:6144
  v_mfma_f32_16x16x32_bf16 v[112:115], a[112:115], a[24:27], v[112:115]
  ds_read_b128 a[36:39], v16 offset:2048
  v_mfma_f32_16x16x32_bf16 v[144:147], a[80:83], a[12:15], v[144:147]
  ds_read_b128 a[52:55], v17 offset:2048
  v_mfma_f32_16x16x32_bf16 v[144:147], a[112:115], a[28:31], v[144:147]
  ds_read_b128 a[40:43], v16 offset:4096
  v_mfma_f32_16x16x32_bf16 v[52:55], a[84:87], a[0:3], v[52:55]
  ds_read_b128 a[56:59], v17 offset:4096
  v_mfma_f32_16x16x32_bf16 v[52:55], a[116:119], a[16:19], v[52:55]
  ds_read_b128 a[44:47], v16 offset:6144
  v_mfma_f32_16x16x32_bf16 v[84:87], a[84:87], a[4:7], v[84:87]
  ds_read_b128 a[60:63], v17 offset:6144
  v_mfma_f32_16x16x32_bf16 v[84:87], a[116:119], a[20:23], v[84:87]
  ds_read_b64_tr_b16 a[68:69], v19 offset:0
  ds_read_b64_tr_b16 a[70:71], v19 offset:2048
  v_mfma_f32_16x16x32_bf16 v[116:119], a[84:87], a[8:11], v[116:119]
  ds_read_b64_tr_b16 a[100:101], v19 offset:4096
  v_mfma_f32_16x16x32_bf16 v[116:119], a[116:119], a[24:27], v[116:119]
  ds_read_b64_tr_b16 a[102:103], v19 offset:6144
  v_mfma_f32_16x16x32_bf16 v[148:151], a[84:87], a[12:15], v[148:151]
  ds_read_b64_tr_b16 a[72:73], v20 offset:0
  v_mfma_f32_16x16x32_bf16 v[148:151], a[116:119], a[28:31], v[148:151]
  buffer_load_dwordx4 v2, s[20:23], s28 offen offset:1024 sc1 lds
  v_mfma_f32_16x16x32_bf16 v[56:59], a[88:91], a[0:3], v[56:59]
  ds_read_b64_tr_b16 a[74:75], v20 offset:2048
  ds_read_b64_tr_b16 a[104:105], v20 offset:4096
  v_mfma_f32_16x16x32_bf16 v[56:59], a[120:123], a[16:19], v[56:59]
  ds_read_b64_tr_b16 a[106:107], v20 offset:6144
  v_mfma_f32_16x16x32_bf16 v[88:91], a[88:91], a[4:7], v[88:91]
  ds_read_b64_tr_b16 a[76:77], v21 offset:0
  v_mfma_f32_16x16x32_bf16 v[88:91], a[120:123], a[20:23], v[88:91]
  ds_read_b64_tr_b16 a[78:79], v21 offset:2048
  v_mfma_f32_16x16x32_bf16 v[120:123], a[88:91], a[8:11], v[120:123]
  ds_read_b64_tr_b16 a[108:109], v21 offset:4096
  v_mfma_f32_16x16x32_bf16 v[120:123], a[120:123], a[24:27], v[120:123]
  ds_read_b64_tr_b16 a[110:111], v21 offset:6144
  v_mfma_f32_16x16x32_bf16 v[152:155], a[88:91], a[12:15], v[152:155]
  v_mfma_f32_16x16x32_bf16 v[152:155], a[120:123], a[28:31], v[152:155]
  v_mfma_f32_16x16x32_bf16 v[60:63], a[92:95], a[0:3], v[60:63]
  v_mfma_f32_16x16x32_bf16 v[60:63], a[124:127], a[16:19], v[60:63]
  v_mfma_f32_16x16x32_bf16 v[92:95], a[92:95], a[4:7], v[92:95]
  v_mfma_f32_16x16x32_bf16 v[92:95], a[124:127], a[20:23], v[92:95]
  v_mfma_f32_16x16x32_bf16 v[124:127], a[92:95], a[8:11], v[124:127]
  v_mfma_f32_16x16x32_bf16 v[124:127], a[124:127], a[24:27], v[124:127]
  v_mfma_f32_16x16x32_bf16 v[156:159], a[92:95], a[12:15], v[156:159]
  v_mfma_f32_16x16x32_bf16 v[156:159], a[124:127], a[28:31], v[156:159]
  s_waitcnt lgkmcnt(0)
  v_mfma_f32_16x16x32_bf16 v[32:35], a[64:67], a[32:35], v[32:35]
  buffer_load_dwordx4 v2, s[20:23], s28 offen offset:2048 sc1 lds
  v_mfma_f32_16x16x32_bf16 v[32:35], a[96:99], a[48:51], v[32:35]
  s_add_u32 s88, s88, s90
  ds_read_b64_tr_b16 a[80:81], v18 offset:8192
  ds_read_b64_tr_b16 a[82:83], v18 offset:10240
  v_mfma_f32_16x16x32_bf16 v[64:67], a[64:67], a[36:39], v[64:67]
  s_add_u32 s89, s89, 1
  ds_read_b64_tr_b16 a[112:113], v18 offset:12288
  v_mfma_f32_16x16x32_bf16 v[64:67], a[96:99], a[52:55], v[64:67]
  s_cmp_eq_u32 s89, 3
  s_cselect_b32 s89, 0, s89
  s_cselect_b32 s90, s91, s92
  v_mfma_f32_16x16x32_bf16 v[96:99], a[64:67], a[40:43], v[96:99]
  s_add_u32 s68, s68, s70
  ds_read_b64_tr_b16 a[114:115], v18 offset:14336
  v_mfma_f32_16x16x32_bf16 v[96:99], a[96:99], a[56:59], v[96:99]
  s_add_u32 s69, s69, 1
  ds_read_b64_tr_b16 a[84:85], v19 offset:8192
  v_mfma_f32_16x16x32_bf16 v[128:131], a[64:67], a[44:47], v[128:131]
  ds_read_b64_tr_b16 a[86:87], v19 offset:10240
  v_mfma_f32_16x16x32_bf16 v[128:131], a[96:99], a[60:63], v[128:131]
  s_cmp_eq_u32 s69, 3
  s_cselect_b32 s69, 0, s69
  s_cselect_b32 s70, s71, s72
  v_mfma_f32_16x16x32_bf16 v[36:39], a[68:71], a[32:35], v[36:39]
  ds_read_b64_tr_b16 a[116:117], v19 offset:12288
  v_mfma_f32_16x16x32_bf16 v[36:39], a[100:103], a[48:51], v[36:39]
  ds_read_b64_tr_b16 a[118:119], v19 offset:14336
  v_mfma_f32_16x16x32_bf16 v[68:71], a[68:71], a[36:39], v[68:71]
  v_mfma_f32_16x16x32_bf16 v[68:71], a[100:103], a[52:55], v[68:71]
  ds_read_b64_tr_b16 a[88:89], v20 offset:8192
  v_mfma_f32_16x16x32_bf16 v[100:103], a[68:71], a[40:43], v[100:103]
  buffer_load_dwordx4 v2, s[20:23], s28 offen offset:3072 sc1 lds
  v_mfma_f32_16x16x32_bf16 v[100:103], a[100:103], a[56:59], v[100:103]
  s_xor_b32 s26, s26, 0x4000
  ds_read_b64_tr_b16 a[90:91], v20 offset:10240
  ds_read_b64_tr_b16 a[120:121], v20 offset:12288
  v_mfma_f32_16x16x32_bf16 v[132:135], a[68:71], a[44:47], v[132:135]
  s_add_u32 s28, s28, 0x8000
  v_mfma_f32_16x16x32_bf16 v[132:135], a[100:103], a[60:63], v[132:135]
  ds_read_b64_tr_b16 a[122:123], v20 offset:14336
  v_mfma_f32_16x16x32_bf16 v[40:43], a[72:75], a[32:35], v[40:43]
  ds_read_b64_tr_b16 a[92:93], v21 offset:8192
  v_mfma_f32_16x16x32_bf16 v[40:43], a[104:107], a[48:51], v[40:43]
  ds_read_b64_tr_b16 a[94:95], v21 offset:10240
  v_mfma_f32_16x16x32_bf16 v[72:75], a[72:75], a[36:39], v[72:75]
  v_mfma_f32_16x16x32_bf16 v[72:75], a[104:107], a[52:55], v[72:75]
  ds_read_b64_tr_b16 a[124:125], v21 offset:12288
  v_mfma_f32_16x16x32_bf16 v[104:107], a[72:75], a[40:43], v[104:107]
  ds_read_b64_tr_b16 a[126:127], v21 offset:14336
  v_mfma_f32_16x16x32_bf16 v[104:107], a[104:107], a[56:59], v[104:107]
  v_add_u32 v16, s90, v16
  v_add_u32 v17, s90, v17
  v_mfma_f32_16x16x32_bf16 v[136:139], a[72:75], a[44:47], v[136:139]
  v_add_u32 v18, s70, v18
  v_add_u32 v19, s70, v19
  v_mfma_f32_16x16x32_bf16 v[136:139], a[104:107], a[60:63], v[136:139]
  v_add_u32 v20, s70, v20
  v_add_u32 v21, s70, v21
  v_mfma_f32_16x16x32_bf16 v[44:47], a[76:79], a[32:35], v[44:47]
  v_mfma_f32_16x16x32_bf16 v[44:47], a[108:111], a[48:51], v[44:47]
  v_mfma_f32_16x16x32_bf16 v[76:79], a[76:79], a[36:39], v[76:79]
  v_mfma_f32_16x16x32_bf16 v[76:79], a[108:111], a[52:55], v[76:79]
  v_mfma_f32_16x16x32_bf16 v[108:111], a[76:79], a[40:43], v[108:111]
  v_mfma_f32_16x16x32_bf16 v[108:111], a[108:111], a[56:59], v[108:111]
  v_mfma_f32_16x16x32_bf16 v[140:143], a[76:79], a[44:47], v[140:143]
  v_mfma_f32_16x16x32_bf16 v[140:143], a[108:111], a[60:63], v[140:143]
  s_waitcnt vmcnt(4) lgkmcnt(0)
  s_barrier
  s_mov_b32 s6, 0x3e0293ee
  s_mov_b32 s7, s6
  v_mfma_f32_16x16x32_bf16 v[48:51], a[80:83], a[32:35], v[48:51]
  s_mov_b32 m0, s26
  ds_read_b128 a[0:3], v16 offset:0
  ds_read_b128 a[16:19], v17 offset:0
  v_mfma_f32_16x16x32_bf16 v[48:51], a[112:115], a[48:51], v[48:51]
  buffer_load_dwordx4 v2, s[20:23], s28 offen offset:0 sc1 lds
  v_mfma_f32_16x16x32_bf16 v[80:83], a[80:83], a[36:39], v[80:83]
  ds_read_b64_tr_b16 a[64:65], v18 offset:0
  ds_read_b64_tr_b16 a[66:67], v18 offset:2048
  v_mfma_f32_16x16x32_bf16 v[80:83], a[112:115], a[52:55], v[80:83]
  buffer_load_dwordx4 v2, s[20:23], s28 offen offset:1024 sc1 lds
  v_mfma_f32_16x16x32_bf16 v[112:115], a[80:83], a[40:43], v[112:115]
  ds_read_b64_tr_b16 a[96:97], v18 offset:4096
  ds_read_b64_tr_b16 a[98:99], v18 offset:6144
  v_mfma_f32_16x16x32_bf16 v[112:115], a[112:115], a[56:59], v[112:115]
  ds_read_b128 a[4:7], v16 offset:2048
  v_mfma_f32_16x16x32_bf16 v[144:147], a[80:83], a[44:47], v[144:147]
  ds_read_b128 a[20:23], v17 offset:2048
  v_mfma_f32_16x16x32_bf16 v[144:147], a[112:115], a[60:63], v[144:147]
  buffer_load_dwordx4 v2, s[20:23], s28 offen offset:2048 sc1 lds
  v_mfma_f32_16x16x32_bf16 v[52:55], a[84:87], a[32:35], v[52:55]
  ds_read_b128 a[8:11], v16 offset:4096
  ds_read_b128 a[24:27], v17 offset:4096
  v_mfma_f32_16x16x32_bf16 v[52:55], a[116:119], a[48:51], v[52:55]
  ds_read_b128 a[12:15], v16 offset:6144
  v_mfma_f32_16x16x32_bf16 v[84:87], a[84:87], a[36:39], v[84:87]
  ds_read_b128 a[28:31], v17 offset:6144
  v_mfma_f32_16x16x32_bf16 v[84:87], a[116:119], a[52:55], v[84:87]
  buffer_load_dwordx4 v2, s[20:23], s28 offen offset:3072 sc1 lds
  v_mfma_f32_16x16x32_bf16 v[116:119], a[84:87], a[40:43], v[116:119]
  s_xor_b32 s26, s26, 0x8000
  s_add_u32 s28, s28, 0x8000
  s_mov_b32 m0, s27
  v_mfma_f32_16x16x32_bf16 v[116:119], a[116:119], a[56:59], v[116:119]
  ds_read_b64_tr_b16 a[68:69], v19 offset:0
  ds_read_b64_tr_b16 a[70:71], v19 offset:2048
  v_mfma_f32_16x16x32_bf16 v[148:151], a[84:87], a[44:47], v[148:151]
  ds_read_b64_tr_b16 a[100:101], v19 offset:4096
  ds_read_b64_tr_b16 a[102:103], v19 offset:6144
  v_mfma_f32_16x16x32_bf16 v[148:151], a[116:119], a[60:63], v[148:151]
  buffer_load_dwordx4 v2, s[20:23], s29 offen offset:0 sc1 lds
  v_mfma_f32_16x16x32_bf16 v[56:59], a[88:91], a[32:35], v[56:59]
  ds_read_b64_tr_b16 a[72:73], v20 offset:0
  ds_read_b64_tr_b16 a[74:75], v20 offset:2048
  v_mfma_f32_16x16x32_bf16 v[56:59], a[120:123], a[48:51], v[56:59]
  ds_read_b64_tr_b16 a[104:105], v20 offset:4096
  ds_read_b64_tr_b16 a[106:107], v20 offset:6144
  v_mfma_f32_16x16x32_bf16 v[88:91], a[88:91], a[36:39], v[88:91]
  ds_read_b64_tr_b16 a[76:77], v21 offset:0
  v_mfma_f32_16x16x32_bf16 v[88:91], a[120:123], a[52:55], v[88:91]
  buffer_load_dwordx4 v2, s[20:23], s29 offen offset:1024 sc1 lds
  v_mfma_f32_16x16x32_bf16 v[120:123], a[88:91], a[40:43], v[120:123]
  ds_read_b64_tr_b16 a[78:79], v21 offset:2048
  ds_read_b64_tr_b16 a[108:109], v21 offset:4096
  v_mfma_f32_16x16x32_bf16 v[120:123], a[120:123], a[56:59], v[120:123]
  ds_read_b64_tr_b16 a[110:111], v21 offset:6144
  v_mfma_f32_16x16x32_bf16 v[152:155], a[88:91], a[44:47], v[152:155]
  v_mfma_f32_16x16x32_bf16 v[152:155], a[120:123], a[60:63], v[152:155]
  buffer_load_dwordx4 v2, s[20:23], s29 offen offset:2048 sc1 lds
  v_mfma_f32_16x16x32_bf16 v[60:63], a[92:95], a[32:35], v[60:63]
  v_mfma_f32_16x16x32_bf16 v[60:63], a[124:127], a[48:51], v[60:63]
  v_mfma_f32_16x16x32_bf16 v[92:95], a[92:95], a[36:39], v[92:95]
  v_mfma_f32_16x16x32_bf16 v[92:95], a[124:127], a[52:55], v[92:95]
  buffer_load_dwordx4 v2, s[20:23], s29 offen offset:3072 sc1 lds
  v_mfma_f32_16x16x32_bf16 v[124:127], a[92:95], a[40:43], v[124:127]
  s_xor_b32 s27, s27, 0x4000
  v_mfma_f32_16x16x32_bf16 v[124:127], a[124:127], a[56:59], v[124:127]
  s_add_u32 s29, s29, 0x8000
  v_mfma_f32_16x16x32_bf16 v[156:159], a[92:95], a[44:47], v[156:159]
  v_mfma_f32_16x16x32_bf16 v[156:159], a[124:127], a[60:63], v[156:159]
  s_waitcnt lgkmcnt(0)
  v_mfma_f32_16x16x32_bf16 v[32:35], a[64:67], a[0:3], v[32:35]
  ds_read_b64_tr_b16 a[80:81], v18 offset:8192
  ds_read_b64_tr_b16 a[82:83], v18 offset:10240
  v_mfma_f32_16x16x32_bf16 v[32:35], a[96:99], a[16:19], v[32:35]
  ds_read_b64_tr_b16 a[112:113], v18 offset:12288
  ds_read_b64_tr_b16 a[114:115], v18 offset:14336
  v_mfma_f32_16x16x32_bf16 v[64:67], a[64:67], a[4:7], v[64:67]
  ds_read_b64_tr_b16 a[84:85], v19 offset:8192
  ds_read_b64_tr_b16 a[86:87], v19 offset:10240
  v_mfma_f32_16x16x32_bf16 v[64:67], a[96:99], a[20:23], v[64:67]
  ds_read_b64_tr_b16 a[116:117], v19 offset:12288
  ds_read_b64_tr_b16 a[118:119], v19 offset:14336
  v_mfma_f32_16x16x32_bf16 v[96:99], a[64:67], a[8:11], v[96:99]
  ds_read_b64_tr_b16 a[88:89], v20 offset:8192
  v_mfma_f32_16x16x32_bf16 v[96:99], a[96:99], a[24:27], v[96:99]
  ds_read_b64_tr_b16 a[90:91], v20 offset:10240
  ds_read_b64_tr_b16 a[120:121], v20 offset:12288
  v_mfma_f32_16x16x32_bf16 v[128:131], a[64:67], a[12:15], v[128:131]
  ds_read_b64_tr_b16 a[122:123], v20 offset:14336
  ds_read_b64_tr_b16 a[92:93], v21 offset:8192
  v_mfma_f32_16x16x32_bf16 v[128:131], a[96:99], a[28:31], v[128:131]
  ds_read_b64_tr_b16 a[94:95], v21 offset:10240
  ds_read_b64_tr_b16 a[124:125], v21 offset:12288
  v_mfma_f32_16x16x32_bf16 v[36:39], a[68:71], a[0:3], v[36:39]
  ds_read_b64_tr_b16 a[126:127], v21 offset:14336
  v_mfma_f32_16x16x32_bf16 v[36:39], a[100:103], a[16:19], v[36:39]
  v_mfma_f32_16x16x32_bf16 v[68:71], a[68:71], a[4:7], v[68:71]
  v_mfma_f32_16x16x32_bf16 v[68:71], a[100:103], a[20:23], v[68:71]
  v_mfma_f32_16x16x32_bf16 v[100:103], a[68:71], a[8:11], v[100:103]
  v_mfma_f32_16x16x32_bf16 v[100:103], a[100:103], a[24:27], v[100:103]
  v_mfma_f32_16x16x32_bf16 v[132:135], a[68:71], a[12:15], v[132:135]
  v_pk_mul_f32 v[32:33], v[32:33], s[6:7]
  v_pk_mul_f32 v[34:35], v[34:35], s[6:7]
  v_mfma_f32_16x16x32_bf16 v[132:135], a[100:103], a[28:31], v[132:135]
  v_pk_mul_f32 v[36:37], v[36:37], s[6:7]
  v_pk_mul_f32 v[38:39], v[38:39], s[6:7]
  v_mfma_f32_16x16x32_bf16 v[40:43], a[72:75], a[0:3], v[40:43]
  v_cvt_pk_bf16_f32 v32, v32, v33
  v_cvt_pk_bf16_f32 v33, v34, v35
  v_mfma_f32_16x16x32_bf16 v[40:43], a[104:107], a[16:19], v[40:43]
  v_cvt_pk_bf16_f32 v34, v36, v37
  v_cvt_pk_bf16_f32 v35, v38, v39
  v_mfma_f32_16x16x32_bf16 v[72:75], a[72:75], a[4:7], v[72:75]
  v_accvgpr_write_b32 a128, v32
  v_accvgpr_write_b32 a129, v33
  v_mfma_f32_16x16x32_bf16 v[72:75], a[104:107], a[20:23], v[72:75]
  v_accvgpr_write_b32 a130, v34
  v_accvgpr_write_b32 a131, v35
  v_mfma_f32_16x16x32_bf16 v[104:107], a[72:75], a[8:11], v[104:107]
  v_pk_mul_f32 v[64:65], v[64:65], s[6:7]
  v_pk_mul_f32 v[66:67], v[66:67], s[6:7]
  v_mfma_f32_16x16x32_bf16 v[104:107], a[104:107], a[24:27], v[104:107]
  v_pk_mul_f32 v[68:69], v[68:69], s[6:7]
  v_pk_mul_f32 v[70:71], v[70:71], s[6:7]
  v_mfma_f32_16x16x32_bf16 v[136:139], a[72:75], a[12:15], v[136:139]
  v_cvt_pk_bf16_f32 v64, v64, v65
  v_cvt_pk_bf16_f32 v65, v66, v67
  v_mfma_f32_16x16x32_bf16 v[136:139], a[104:107], a[28:31], v[136:139]
  v_cvt_pk_bf16_f32 v66, v68, v69
  v_cvt_pk_bf16_f32 v67, v70, v71
  v_mfma_f32_16x16x32_bf16 v[44:47], a[76:79], a[0:3], v[44:47]
  v_accvgpr_write_b32 a144, v64
  v_accvgpr_write_b32 a145, v65
  v_mfma_f32_16x16x32_bf16 v[44:47], a[108:111], a[16:19], v[44:47]
  v_accvgpr_write_b32 a146, v66
  v_accvgpr_write_b32 a147, v67
  v_mfma_f32_16x16x32_bf16 v[76:79], a[76:79], a[4:7], v[76:79]
  v_mfma_f32_32x32x16_bf16 v[160:175], a[236:239], a[236:239], 0
  v_pk_mul_f32 v[96:97], v[96:97], s[6:7]
  v_mfma_f32_16x16x32_bf16 v[76:79], a[108:111], a[20:23], v[76:79]
  v_pk_mul_f32 v[98:99], v[98:99], s[6:7]
  v_pk_mul_f32 v[100:101], v[100:101], s[6:7]
  v_mfma_f32_16x16x32_bf16 v[108:111], a[76:79], a[8:11], v[108:111]
  v_pk_mul_f32 v[102:103], v[102:103], s[6:7]
  v_cvt_pk_bf16_f32 v96, v96, v97
  v_mfma_f32_16x16x32_bf16 v[108:111], a[108:111], a[24:27], v[108:111]
  v_cvt_pk_bf16_f32 v97, v98, v99
  v_cvt_pk_bf16_f32 v98, v100, v101
  v_mfma_f32_16x16x32_bf16 v[140:143], a[76:79], a[12:15], v[140:143]
  v_cvt_pk_bf16_f32 v99, v102, v103
  v_accvgpr_write_b32 a160, v96
  v_mfma_f32_16x16x32_bf16 v[140:143], a[108:111], a[28:31], v[140:143]
  v_accvgpr_write_b32 a161, v97
  v_accvgpr_write_b32 a162, v98
  s_waitcnt lgkmcnt(0)
  v_mfma_f32_16x16x32_bf16 v[48:51], a[80:83], a[0:3], v[48:51]
  v_accvgpr_write_b32 a163, v99
  v_pk_mul_f32 v[128:129], v[128:129], s[6:7]
  v_mfma_f32_16x16x32_bf16 v[48:51], a[112:115], a[16:19], v[48:51]
  v_pk_mul_f32 v[130:131], v[130:131], s[6:7]
  v_pk_mul_f32 v[132:133], v[132:133], s[6:7]
  v_mfma_f32_16x16x32_bf16 v[80:83], a[80:83], a[4:7], v[80:83]
  v_pk_mul_f32 v[134:135], v[134:135], s[6:7]
  v_cvt_pk_bf16_f32 v128, v128, v129
  v_mfma_f32_16x16x32_bf16 v[80:83], a[112:115], a[20:23], v[80:83]
  v_cvt_pk_bf16_f32 v129, v130, v131
  v_cvt_pk_bf16_f32 v130, v132, v133
  v_mfma_f32_16x16x32_bf16 v[112:115], a[80:83], a[8:11], v[112:115]
  v_cvt_pk_bf16_f32 v131, v134, v135
  v_accvgpr_write_b32 a176, v128
  v_mfma_f32_16x16x32_bf16 v[112:115], a[112:115], a[24:27], v[112:115]
  v_accvgpr_write_b32 a177, v129
  v_accvgpr_write_b32 a178, v130
  v_mfma_f32_16x16x32_bf16 v[144:147], a[80:83], a[12:15], v[144:147]
  v_accvgpr_write_b32 a179, v131
  v_mfma_f32_32x32x16_bf16 v[176:191], a[236:239], a[236:239], 0
  v_mfma_f32_16x16x32_bf16 v[144:147], a[112:115], a[28:31], v[144:147]
  v_pk_mul_f32 v[40:41], v[40:41], s[6:7]
  v_pk_mul_f32 v[42:43], v[42:43], s[6:7]
  v_mfma_f32_16x16x32_bf16 v[52:55], a[84:87], a[0:3], v[52:55]
  v_pk_mul_f32 v[44:45], v[44:45], s[6:7]
  v_pk_mul_f32 v[46:47], v[46:47], s[6:7]
  v_mfma_f32_16x16x32_bf16 v[52:55], a[116:119], a[16:19], v[52:55]
  v_cvt_pk_bf16_f32 v40, v40, v41
  v_cvt_pk_bf16_f32 v41, v42, v43
  v_mfma_f32_16x16x32_bf16 v[84:87], a[84:87], a[4:7], v[84:87]
  v_cvt_pk_bf16_f32 v42, v44, v45
  v_cvt_pk_bf16_f32 v43, v46, v47
  v_mfma_f32_16x16x32_bf16 v[84:87], a[116:119], a[20:23], v[84:87]
  v_accvgpr_write_b32 a132, v40
  v_accvgpr_write_b32 a133, v41
  v_mfma_f32_16x16x32_bf16 v[116:119], a[84:87], a[8:11], v[116:119]
  v_accvgpr_write_b32 a134, v42
  v_accvgpr_write_b32 a135, v43
  v_mfma_f32_16x16x32_bf16 v[116:119], a[116:119], a[24:27], v[116:119]
  v_pk_mul_f32 v[72:73], v[72:73], s[6:7]
  v_pk_mul_f32 v[74:75], v[74:75], s[6:7]
  v_mfma_f32_16x16x32_bf16 v[148:151], a[84:87], a[12:15], v[148:151]
  v_pk_mul_f32 v[76:77], v[76:77], s[6:7]
  v_pk_mul_f32 v[78:79], v[78:79], s[6:7]
  v_mfma_f32_16x16x32_bf16 v[148:151], a[116:119], a[28:31], v[148:151]
  v_cvt_pk_bf16_f32 v72, v72, v73
  v_cvt_pk_bf16_f32 v73, v74, v75
  v_mfma_f32_16x16x32_bf16 v[56:59], a[88:91], a[0:3], v[56:59]
  v_cvt_pk_bf16_f32 v74, v76, v77
  v_cvt_pk_bf16_f32 v75, v78, v79
  v_mfma_f32_16x16x32_bf16 v[56:59], a[120:123], a[16:19], v[56:59]
  v_accvgpr_write_b32 a148, v72
  v_accvgpr_write_b32 a149, v73
  v_mfma_f32_16x16x32_bf16 v[88:91], a[88:91], a[4:7], v[88:91]
  v_accvgpr_write_b32 a150, v74
  v_accvgpr_write_b32 a151, v75
  v_mfma_f32_16x16x32_bf16 v[88:91], a[120:123], a[20:23], v[88:91]
  v_mfma_f32_32x32x16_bf16 v[192:207], a[236:239], a[236:239], 0
  v_pk_mul_f32 v[104:105], v[104:105], s[6:7]
  v_mfma_f32_16x16x32_bf16 v[120:123], a[88:91], a[8:11], v[120:123]
  v_pk_mul_f32 v[106:107], v[106:107], s[6:7]
  v_pk_mul_f32 v[108:109], v[108:109], s[6:7]
  v_mfma_f32_16x16x32_bf16 v[120:123], a[120:123], a[24:27], v[120:123]
  v_pk_mul_f32 v[110:111], v[110:111], s[6:7]
  v_cvt_pk_bf16_f32 v104, v104, v105
  v_mfma_f32_16x16x32_bf16 v[152:155], a[88:91], a[12:15], v[152:155]
  v_cvt_pk_bf16_f32 v105, v106, v107
  v_cvt_pk_bf16_f32 v106, v108, v109
  v_mfma_f32_16x16x32_bf16 v[152:155], a[120:123], a[28:31], v[152:155]
  v_cvt_pk_bf16_f32 v107, v110, v111
  v_accvgpr_write_b32 a164, v104
  v_mfma_f32_16x16x32_bf16 v[60:63], a[92:95], a[0:3], v[60:63]
  v_accvgpr_write_b32 a165, v105
  v_accvgpr_write_b32 a166, v106
  v_mfma_f32_16x16x32_bf16 v[60:63], a[124:127], a[16:19], v[60:63]
  v_accvgpr_write_b32 a167, v107
  v_pk_mul_f32 v[136:137], v[136:137], s[6:7]
  v_mfma_f32_16x16x32_bf16 v[92:95], a[92:95], a[4:7], v[92:95]
  v_pk_mul_f32 v[138:139], v[138:139], s[6:7]
  v_pk_mul_f32 v[140:141], v[140:141], s[6:7]
  v_mfma_f32_16x16x32_bf16 v[92:95], a[124:127], a[20:23], v[92:95]
  v_pk_mul_f32 v[142:143], v[142:143], s[6:7]
  v_cvt_pk_bf16_f32 v136, v136, v137
  v_mfma_f32_16x16x32_bf16 v[124:127], a[92:95], a[8:11], v[124:127]
  v_cvt_pk_bf16_f32 v137, v138, v139
  v_cvt_pk_bf16_f32 v138, v140, v141
  v_mfma_f32_16x16x32_bf16 v[124:127], a[124:127], a[24:27], v[124:127]
  v_cvt_pk_bf16_f32 v139, v142, v143
  v_accvgpr_write_b32 a180, v136
  v_mfma_f32_16x16x32_bf16 v[156:159], a[92:95], a[12:15], v[156:159]
  v_accvgpr_write_b32 a181, v137
  v_accvgpr_write_b32 a182, v138
  v_mfma_f32_16x16x32_bf16 v[156:159], a[124:127], a[28:31], v[156:159]
  v_accvgpr_write_b32 a183, v139
  v_mfma_f32_32x32x16_bf16 v[128:143], a[236:239], a[236:239], 0
  v_pk_mul_f32 v[48:49], v[48:49], s[6:7]
  v_pk_mul_f32 v[50:51], v[50:51], s[6:7]
  v_pk_mul_f32 v[52:53], v[52:53], s[6:7]
  v_pk_mul_f32 v[54:55], v[54:55], s[6:7]
  v_cvt_pk_bf16_f32 v48, v48, v49
  v_cvt_pk_bf16_f32 v49, v50, v51
  v_cvt_pk_bf16_f32 v50, v52, v53
  v_cvt_pk_bf16_f32 v51, v54, v55
  v_accvgpr_write_b32 a136, v48
  v_accvgpr_write_b32 a137, v49
  v_accvgpr_write_b32 a138, v50
  v_accvgpr_write_b32 a139, v51
  v_pk_mul_f32 v[80:81], v[80:81], s[6:7]
  v_pk_mul_f32 v[82:83], v[82:83], s[6:7]
  v_pk_mul_f32 v[84:85], v[84:85], s[6:7]
  v_pk_mul_f32 v[86:87], v[86:87], s[6:7]
  v_cvt_pk_bf16_f32 v80, v80, v81
  v_cvt_pk_bf16_f32 v81, v82, v83
  v_cvt_pk_bf16_f32 v82, v84, v85
  v_cvt_pk_bf16_f32 v83, v86, v87
  v_accvgpr_write_b32 a152, v80
  v_accvgpr_write_b32 a153, v81
  v_accvgpr_write_b32 a154, v82
  v_accvgpr_write_b32 a155, v83
  v_mfma_f32_32x32x16_bf16 v[224:239], a[236:239], a[236:239], 0
  v_pk_mul_f32 v[112:113], v[112:113], s[6:7]
  v_pk_mul_f32 v[114:115], v[114:115], s[6:7]
  v_pk_mul_f32 v[116:117], v[116:117], s[6:7]
  v_pk_mul_f32 v[118:119], v[118:119], s[6:7]
  v_cvt_pk_bf16_f32 v112, v112, v113
  v_cvt_pk_bf16_f32 v113, v114, v115
  v_cvt_pk_bf16_f32 v114, v116, v117
  v_cvt_pk_bf16_f32 v115, v118, v119
  v_accvgpr_write_b32 a168, v112
  v_accvgpr_write_b32 a169, v113
  v_accvgpr_write_b32 a170, v114
  v_accvgpr_write_b32 a171, v115
  v_pk_mul_f32 v[144:145], v[144:145], s[6:7]
  v_pk_mul_f32 v[146:147], v[146:147], s[6:7]
  v_pk_mul_f32 v[148:149], v[148:149], s[6:7]
  v_pk_mul_f32 v[150:151], v[150:151], s[6:7]
  v_cvt_pk_bf16_f32 v144, v144, v145
  v_cvt_pk_bf16_f32 v145, v146, v147
  v_cvt_pk_bf16_f32 v146, v148, v149
  v_cvt_pk_bf16_f32 v147, v150, v151
  v_accvgpr_write_b32 a184, v144
  v_accvgpr_write_b32 a185, v145
  v_accvgpr_write_b32 a186, v146
  v_accvgpr_write_b32 a187, v147
  v_mfma_f32_32x32x16_bf16 v[240:255], a[236:239], a[236:239], 0
  v_pk_mul_f32 v[56:57], v[56:57], s[6:7]
  v_pk_mul_f32 v[58:59], v[58:59], s[6:7]
  v_pk_mul_f32 v[60:61], v[60:61], s[6:7]
  v_pk_mul_f32 v[62:63], v[62:63], s[6:7]
  v_cvt_pk_bf16_f32 v56, v56, v57
  v_cvt_pk_bf16_f32 v57, v58, v59
  v_cvt_pk_bf16_f32 v58, v60, v61
  v_cvt_pk_bf16_f32 v59, v62, v63
  v_accvgpr_write_b32 a140, v56
  v_accvgpr_write_b32 a141, v57
  v_accvgpr_write_b32 a142, v58
  v_accvgpr_write_b32 a143, v59
  v_pk_mul_f32 v[88:89], v[88:89], s[6:7]
  v_pk_mul_f32 v[90:91], v[90:91], s[6:7]
  v_pk_mul_f32 v[92:93], v[92:93], s[6:7]
  v_pk_mul_f32 v[94:95], v[94:95], s[6:7]
  v_cvt_pk_bf16_f32 v88, v88, v89
  v_cvt_pk_bf16_f32 v89, v90, v91
  v_cvt_pk_bf16_f32 v90, v92, v93
  v_cvt_pk_bf16_f32 v91, v94, v95
  v_accvgpr_write_b32 a156, v88
  v_accvgpr_write_b32 a157, v89
  v_accvgpr_write_b32 a158, v90
  v_accvgpr_write_b32 a159, v91
  v_mfma_f32_32x32x16_bf16 v[208:223], a[236:239], a[236:239], 0
  v_pk_mul_f32 v[120:121], v[120:121], s[6:7]
  v_pk_mul_f32 v[122:123], v[122:123], s[6:7]
  v_pk_mul_f32 v[124:125], v[124:125], s[6:7]
  v_pk_mul_f32 v[126:127], v[126:127], s[6:7]
  v_cvt_pk_bf16_f32 v120, v120, v121
  v_cvt_pk_bf16_f32 v121, v122, v123
  v_cvt_pk_bf16_f32 v122, v124, v125
  v_cvt_pk_bf16_f32 v123, v126, v127
  v_accvgpr_write_b32 a172, v120
  v_accvgpr_write_b32 a173, v121
  v_accvgpr_write_b32 a174, v122
  v_accvgpr_write_b32 a175, v123
  v_pk_mul_f32 v[152:153], v[152:153], s[6:7]
  v_pk_mul_f32 v[154:155], v[154:155], s[6:7]
  v_pk_mul_f32 v[156:157], v[156:157], s[6:7]
  v_pk_mul_f32 v[158:159], v[158:159], s[6:7]
  v_cvt_pk_bf16_f32 v152, v152, v153
  v_cvt_pk_bf16_f32 v153, v154, v155
  v_cvt_pk_bf16_f32 v154, v156, v157
  v_cvt_pk_bf16_f32 v155, v158, v159
  v_accvgpr_write_b32 a188, v152
  v_accvgpr_write_b32 a189, v153
  v_accvgpr_write_b32 a190, v154
  v_accvgpr_write_b32 a191, v155
  v_mfma_f32_32x32x16_bf16 v[144:159], a[236:239], a[236:239], 0
  v_add_u32 v3, 0xc000, v2
  v_add_u32 v4, 0x10000, v2
  v_mov_b32 v5, 0xf149f2ca
  s_mov_b32 s89, 0
  v_mfma_f32_32x32x16_bf16 a[192:207], a[236:239], a[236:239], 0
  s_lshl_b32 s90, s78, 1
  s_add_u32 s90, s90, s77
  s_lshl_b32 s90, s90, 2
  s_add_u32 s90, s90, s3
  s_lshl_b32 s90, s90, 14
  s_add_u32 s64, s86, 100663296
  s_addc_u32 s65, s87, 0
  s_add_u32 s64, s64, s90
  s_addc_u32 s65, s65, 0
  s_mov_b32 s66, 8192
  s_mov_b32 s67, 0x00020000
  s_mov_b32 s90, 0
  s_waitcnt vmcnt(8)
  s_barrier
  ds_read_b128 a[32:35], v3 offset:0
  ds_read_b128 a[36:39], v3 offset:1024
  ds_read_b128 a[40:43], v3 offset:2048
  ds_read_b128 a[44:47], v3 offset:3072
  ds_read_b128 a[48:51], v3 offset:4096
  ds_read_b128 a[52:55], v3 offset:5120
  ds_read_b128 a[56:59], v3 offset:6144
  ds_read_b128 a[60:63], v3 offset:7168
  s_waitcnt lgkmcnt(6)
  v_mfma_f32_16x16x32_bf16 v[64:67], a[32:35], a[128:131], 0
  s_lshl_b32 s4, s2, 2
  s_add_u32 s4, s4, s3
  s_lshl_b32 s6, s4, 13
  v_mfma_f32_16x16x32_bf16 v[72:75], a[32:35], a[144:147], 0
  s_lshl_b32 s7, s4, 11
  s_mov_b32 s8, s74
  s_mov_b32 s9, s75
  v_mfma_f32_16x16x32_bf16 v[80:83], a[32:35], a[160:163], 0
  s_mov_b32 s10, 8388608
  s_mov_b32 s11, 0x00020000
  s_mov_b32 s12, s80
  v_mfma_f32_16x16x32_bf16 v[88:91], a[32:35], a[176:179], 0
  s_mov_b32 s13, s81
  s_mov_b32 s14, 2097152
  ds_read_b128 a[0:3], v3 offset:8192
  v_mfma_f32_16x16x32_bf16 v[64:67], a[36:39], a[132:135], v[64:67]
  s_mov_b32 s15, 0x00020000
  s_add_u32 s16, s86, 67108864
  s_addc_u32 s17, s87, 0
  v_mfma_f32_16x16x32_bf16 v[72:75], a[36:39], a[148:151], v[72:75]
  s_mov_b32 s18, 16777216
  s_mov_b32 s19, 0x00020000
  v_mfma_f32_16x16x32_bf16 v[80:83], a[36:39], a[164:167], v[80:83]
  v_and_b32 v6, 15, v1
  v_lshrrev_b32 v7, 4, v1
  v_mfma_f32_16x16x32_bf16 v[88:91], a[36:39], a[180:183], v[88:91]
  s_waitcnt lgkmcnt(5)
  ds_read_b128 a[4:7], v3 offset:9216
  v_sub_u32 v6, v6, v7
  v_mfma_f32_16x16x32_bf16 v[64:67], a[40:43], a[136:139], v[64:67]
  v_lshlrev_b32 v6, 2, v6
  v_add_u32 v6, s3, v6
  v_mfma_f32_16x16x32_bf16 v[72:75], a[40:43], a[152:155], v[72:75]
  v_cmp_gt_i32 s[32:33], 0, v6
  v_cmp_gt_i32 s[34:35], 1, v6
  v_mfma_f32_16x16x32_bf16 v[80:83], a[40:43], a[168:171], v[80:83]
  v_cmp_gt_i32 s[36:37], 2, v6
  v_cmp_gt_i32 s[38:39], 3, v6
  v_mfma_f32_16x16x32_bf16 v[88:91], a[40:43], a[184:187], v[88:91]
  ds_read_b128 a[8:11], v3 offset:10240
  v_cmp_gt_i32 s[40:41], 16, v6
  v_mfma_f32_16x16x32_bf16 v[64:67], a[44:47], a[140:143], v[64:67]
  v_cmp_gt_i32 s[42:43], 17, v6
  v_cmp_gt_i32 s[44:45], 18, v6
  v_mfma_f32_16x16x32_bf16 v[72:75], a[44:47], a[156:159], v[72:75]
  v_cmp_gt_i32 s[46:47], 19, v6
  v_cmp_gt_i32 s[48:49], 32, v6
  v_mfma_f32_16x16x32_bf16 v[80:83], a[44:47], a[172:175], v[80:83]
  v_cmp_gt_i32 s[50:51], 33, v6
  v_cmp_gt_i32 s[52:53], 34, v6
  v_mfma_f32_16x16x32_bf16 v[88:91], a[44:47], a[188:191], v[88:91]
  s_waitcnt lgkmcnt(5)
  ds_read_b128 a[12:15], v3 offset:11264
  v_cmp_gt_i32 s[54:55], 35, v6
  v_mfma_f32_16x16x32_bf16 v[68:71], a[48:51], a[128:131], 0
  v_cmp_gt_i32 s[56:57], 48, v6
  v_cmp_gt_i32 s[58:59], 49, v6
  v_mfma_f32_16x16x32_bf16 v[76:79], a[48:51], a[144:147], 0
  s_mov_b32 s30, 0x8000
  v_cmp_gt_i32 s[60:61], 50, v6
  v_cmp_gt_i32 s[62:63], 51, v6
  v_mfma_f32_16x16x32_bf16 v[84:87], a[48:51], a[160:163], 0
  s_mov_b32 s31, 0x4000
  v_mfma_f32_16x16x32_bf16 v[92:95], a[48:51], a[176:179], 0
  ds_read_b128 a[16:19], v3 offset:12288
  v_mfma_f32_16x16x32_bf16 v[68:71], a[52:55], a[132:135], v[68:71]
  v_mfma_f32_16x16x32_bf16 v[76:79], a[52:55], a[148:151], v[76:79]
  v_mfma_f32_16x16x32_bf16 v[84:87], a[52:55], a[164:167], v[84:87]
  v_mfma_f32_16x16x32_bf16 v[92:95], a[52:55], a[180:183], v[92:95]
  s_waitcnt lgkmcnt(5)
  ds_read_b128 a[20:23], v3 offset:13312
  v_mfma_f32_16x16x32_bf16 v[68:71], a[56:59], a[136:139], v[68:71]
  v_mfma_f32_16x16x32_bf16 v[76:79], a[56:59], a[152:155], v[76:79]
  v_mfma_f32_16x16x32_bf16 v[84:87], a[56:59], a[168:171], v[84:87]
  v_mfma_f32_16x16x32_bf16 v[92:95], a[56:59], a[184:187], v[92:95]
  ds_read_b128 a[24:27], v3 offset:14336
  v_mfma_f32_16x16x32_bf16 v[68:71], a[60:63], a[140:143], v[68:71]
  v_mfma_f32_16x16x32_bf16 v[76:79], a[60:63], a[156:159], v[76:79]
  v_mfma_f32_16x16x32_bf16 v[84:87], a[60:63], a[172:175], v[84:87]
  v_mfma_f32_16x16x32_bf16 v[92:95], a[60:63], a[188:191], v[92:95]
  ds_read_b128 a[28:31], v3 offset:15360
  s_cmp_lg_u32 s25, 0
  s_nop 0
  s_cbranch_scc1 La_nomask0
  v_cndmask_b32 v64, v64, v5, s[32:33]
  v_cndmask_b32 v65, v65, v5, s[34:35]
  v_cndmask_b32 v66, v66, v5, s[36:37]
  v_cndmask_b32 v67, v67, v5, s[38:39]
  v_cndmask_b32 v68, v68, v5, s[40:41]
  v_cndmask_b32 v69, v69, v5, s[42:43]
  v_cndmask_b32 v70, v70, v5, s[44:45]
  v_cndmask_b32 v71, v71, v5, s[46:47]
La_nomask0:
  v_max3_f32 v6, v64, v65, v66
  v_max3_f32 v7, v67, v68, v69
  v_max3_f32 v6, v6, v70, v71
  v_max_f32 v6, v6, v7
  v_max3_f32 v8, v72, v73, v74
  v_max3_f32 v9, v75, v76, v77
  v_max3_f32 v8, v8, v78, v79
  v_max_f32 v8, v8, v9
  v_max3_f32 v10, v80, v81, v82
  v_max3_f32 v11, v83, v84, v85
  v_max3_f32 v10, v10, v86, v87
  v_max_f32 v10, v10, v11
  v_max3_f32 v12, v88, v89, v90
  v_max3_f32 v13, v91, v92, v93
  v_max3_f32 v12, v12, v94, v95
  v_max_f32 v12, v12, v13
  v_mov_b32 v7, v6
  v_mov_b32 v9, v8
  v_mov_b32 v11, v10
  v_mov_b32 v13, v12
  v_permlane32_swap_b32 v6, v7
  v_permlane32_swap_b32 v8, v9
  v_permlane32_swap_b32 v10, v11
  v_permlane32_swap_b32 v12, v13
  v_max_f32 v6, v6, v7
  v_max_f32 v8, v8, v9
  v_max_f32 v10, v10, v11
  v_max_f32 v12, v12, v13
  v_mov_b32 v7, v6
  v_mov_b32 v9, v8
  v_mov_b32 v11, v10
  v_mov_b32 v13, v12
  v_permlane16_swap_b32 v6, v7
  v_permlane16_swap_b32 v8, v9
  v_permlane16_swap_b32 v10, v11
  v_permlane16_swap_b32 v12, v13
  v_max_f32 v6, v6, v7
  v_max_f32 v8, v8, v9
  v_max_f32 v10, v10, v11
  v_max_f32 v12, v12, v13
  v_sub_f32 v16, 0, v6
  v_sub_f32 v17, 0, v6
  v_sub_f32 v18, 0, v6
  v_sub_f32 v19, 0, v6
  v_sub_f32 v20, 0, v8
  v_sub_f32 v21, 0, v8
  v_sub_f32 v22, 0, v8
  v_sub_f32 v23, 0, v8
  v_sub_f32 v24, 0, v10
  v_sub_f32 v25, 0, v10
  v_sub_f32 v26, 0, v10
  v_sub_f32 v27, 0, v10
  v_sub_f32 v28, 0, v12
  v_sub_f32 v29, 0, v12
  v_sub_f32 v30, 0, v12
  v_sub_f32 v31, 0, v12
  v_pk_add_f32 v[64:65], v[64:65], v[16:17]
  v_pk_add_f32 v[66:67], v[66:67], v[16:17]
  v_pk_add_f32 v[68:69], v[68:69], v[16:17]
  v_pk_add_f32 v[70:71], v[70:71], v[16:17]
  v_pk_add_f32 v[72:73], v[72:73], v[20:21]
  v_pk_add_f32 v[74:75], v[74:75], v[20:21]
  v_pk_add_f32 v[76:77], v[76:77], v[20:21]
  v_pk_add_f32 v[78:79], v[78:79], v[20:21]
  v_pk_add_f32 v[80:81], v[80:81], v[24:25]
  v_pk_add_f32 v[82:83], v[82:83], v[24:25]
  v_pk_add_f32 v[84:85], v[84:85], v[24:25]
  v_pk_add_f32 v[86:87], v[86:87], v[24:25]
  v_pk_add_f32 v[88:89], v[88:89], v[28:29]
  v_pk_add_f32 v[90:91], v[90:91], v[28:29]
  v_pk_add_f32 v[92:93], v[92:93], v[28:29]
  v_pk_add_f32 v[94:95], v[94:95], v[28:29]
  s_lshl_b32 s88, s25, 1
  s_waitcnt vmcnt(0)
  s_barrier
  s_waitcnt lgkmcnt(4)
  v_mfma_f32_16x16x32_bf16 v[96:99], a[0:3], a[128:131], v[16:19]
  s_mov_b32 m0, s26
  v_exp_f32 v64, v64
  v_mfma_f32_16x16x32_bf16 v[96:99], a[4:7], a[132:135], v[96:99]
  buffer_load_dwordx4 v2, s[20:23], s28 offen offset:0 sc1 lds
  v_exp_f32 v65, v65
  v_mfma_f32_16x16x32_bf16 v[96:99], a[8:11], a[136:139], v[96:99]
  buffer_load_dwordx4 v2, s[20:23], s28 offen offset:1024 sc1 lds
  v_exp_f32 v66, v66
  v_mfma_f32_16x16x32_bf16 v[96:99], a[12:15], a[140:143], v[96:99]
  buffer_load_dwordx4 v2, s[20:23], s28 offen offset:2048 sc1 lds
  v_exp_f32 v67, v67
  v_mfma_f32_16x16x32_bf16 v[104:107], a[0:3], a[144:147], v[20:23]
  v_exp_f32 v68, v68
  v_cvt_pk_bf16_f32 v32, v64, v65
  v_mfma_f32_16x16x32_bf16 v[104:107], a[4:7], a[148:151], v[104:107]
  buffer_load_dwordx4 v2, s[20:23], s28 offen offset:3072 sc1 lds
  v_exp_f32 v69, v69
  v_mfma_f32_16x16x32_bf16 v[104:107], a[8:11], a[152:155], v[104:107]
  s_xor_b32 s26, s26, 0x4000
  v_exp_f32 v70, v70
  v_cvt_pk_bf16_f32 v33, v66, v67
  v_mfma_f32_16x16x32_bf16 v[104:107], a[12:15], a[156:159], v[104:107]
  s_add_u32 s28, s28, 0x8000
  v_exp_f32 v71, v71
  v_cvt_pk_bf16_f32 v34, v68, v69
  v_mfma_f32_16x16x32_bf16 v[112:115], a[0:3], a[160:163], v[24:27]
  s_mov_b32 m0, s27
  v_exp_f32 v72, v72
  v_cvt_pk_bf16_f32 v35, v70, v71
  v_mfma_f32_16x16x32_bf16 v[112:115], a[4:7], a[164:167], v[112:115]
  buffer_load_dwordx4 v2, s[20:23], s29 offen offset:0 sc1 lds
  v_exp_f32 v73, v73
  v_mfma_f32_16x16x32_bf16 v[112:115], a[8:11], a[168:171], v[112:115]
  buffer_load_dwordx4 v2, s[20:23], s29 offen offset:1024 sc1 lds
  v_exp_f32 v74, v74
  v_mfma_f32_16x16x32_bf16 v[112:115], a[12:15], a[172:175], v[112:115]
  buffer_load_dwordx4 v2, s[20:23], s29 offen offset:2048 sc1 lds
  v_exp_f32 v75, v75
  v_mfma_f32_16x16x32_bf16 v[120:123], a[0:3], a[176:179], v[28:31]
  buffer_load_dwordx4 v2, s[20:23], s29 offen offset:3072 sc1 lds
  v_exp_f32 v76, v76
  v_mfma_f32_16x16x32_bf16 v[120:123], a[4:7], a[180:183], v[120:123]
  s_xor_b32 s27, s27, 0x8000
  v_exp_f32 v77, v77
  v_cvt_pk_bf16_f32 v36, v72, v73
  v_mfma_f32_16x16x32_bf16 v[120:123], a[8:11], a[184:187], v[120:123]
  s_add_u32 s29, s29, 0x8000
  v_exp_f32 v78, v78
  v_cvt_pk_bf16_f32 v37, v74, v75
  v_mfma_f32_16x16x32_bf16 v[120:123], a[12:15], a[188:191], v[120:123]
  s_waitcnt lgkmcnt(0)
  v_exp_f32 v79, v79
  v_cvt_pk_bf16_f32 v38, v76, v77
  v_mfma_f32_16x16x32_bf16 v[100:103], a[16:19], a[128:131], v[16:19]
  s_mov_b32 m0, s26
  v_exp_f32 v80, v80
  v_cvt_pk_bf16_f32 v39, v78, v79
  v_mfma_f32_16x16x32_bf16 v[100:103], a[20:23], a[132:135], v[100:103]
  buffer_load_dwordx4 v2, s[20:23], s28 offen offset:0 sc1 lds
  v_exp_f32 v81, v81
  v_mfma_f32_16x16x32_bf16 v[100:103], a[24:27], a[136:139], v[100:103]
  buffer_load_dwordx4 v2, s[20:23], s28 offen offset:1024 sc1 lds
  v_exp_f32 v82, v82
  v_cvt_pk_bf16_f32 v40, v80, v81
  v_mfma_f32_16x16x32_bf16 v[100:103], a[28:31], a[140:143], v[100:103]
  buffer_load_dwordx4 v2, s[20:23], s28 offen offset:2048 sc1 lds
  v_exp_f32 v83, v83
  v_mfma_f32_16x16x32_bf16 v[108:111], a[16:19], a[144:147], v[20:23]
  buffer_load_dwordx4 v2, s[20:23], s28 offen offset:3072 sc1 lds
  v_exp_f32 v84, v84
  v_cvt_pk_bf16_f32 v41, v82, v83
  v_mfma_f32_16x16x32_bf16 v[108:111], a[20:23], a[148:151], v[108:111]
  s_xor_b32 s26, s26, 0x8000
  v_exp_f32 v85, v85
  v_xor_b32 v3, 0x4000, v3
  v_mfma_f32_16x16x32_bf16 v[108:111], a[24:27], a[152:155], v[108:111]
  s_add_u32 s28, s28, 0x8000
  ds_read_b128 a[32:35], v3 offset:0
  v_exp_f32 v86, v86
  v_cvt_pk_bf16_f32 v42, v84, v85
  v_mfma_f32_16x16x32_bf16 v[108:111], a[28:31], a[156:159], v[108:111]
  s_mov_b32 m0, s27
  ds_read_b128 a[36:39], v3 offset:1024
  v_exp_f32 v87, v87
  v_mfma_f32_16x16x32_bf16 v[116:119], a[16:19], a[160:163], v[24:27]
  buffer_load_dwordx4 v2, s[20:23], s29 offen offset:0 sc1 lds
  v_exp_f32 v88, v88
  v_cvt_pk_bf16_f32 v43, v86, v87
  v_mfma_f32_16x16x32_bf16 v[116:119], a[20:23], a[164:167], v[116:119]
  buffer_load_dwordx4 v2, s[20:23], s29 offen offset:1024 sc1 lds
  v_exp_f32 v89, v89
  v_mfma_f32_16x16x32_bf16 v[116:119], a[24:27], a[168:171], v[116:119]
  buffer_load_dwordx4 v2, s[20:23], s29 offen offset:2048 sc1 lds
  v_exp_f32 v90, v90
  v_cvt_pk_bf16_f32 v44, v88, v89
  v_mfma_f32_16x16x32_bf16 v[116:119], a[28:31], a[172:175], v[116:119]
  buffer_load_dwordx4 v2, s[20:23], s29 offen offset:3072 sc1 lds
  v_exp_f32 v91, v91
  v_mfma_f32_16x16x32_bf16 v[124:127], a[16:19], a[176:179], v[28:31]
  s_xor_b32 s27, s27, 0x4000
  ds_read_b128 a[40:43], v3 offset:2048
  v_exp_f32 v92, v92
  v_cvt_pk_bf16_f32 v45, v90, v91
  v_mfma_f32_16x16x32_bf16 v[124:127], a[20:23], a[180:183], v[124:127]
  s_add_u32 s29, s29, 0x8000
  ds_read_b128 a[44:47], v3 offset:3072
  v_exp_f32 v93, v93
  v_mfma_f32_16x16x32_bf16 v[124:127], a[24:27], a[184:187], v[124:127]
  ds_read_b128 a[48:51], v3 offset:4096
  v_exp_f32 v94, v94
  v_cvt_pk_bf16_f32 v46, v92, v93
  v_mfma_f32_16x16x32_bf16 v[124:127], a[28:31], a[188:191], v[124:127]
  ds_read_b128 a[52:55], v3 offset:5120
  ds_read_b128 a[56:59], v3 offset:6144
  ds_read_b128 a[60:63], v3 offset:7168
  ds_read_b128 a[0:3], v4 offset:0
  ds_read_b128 a[4:7], v4 offset:1024
  ds_read_b128 a[8:11], v4 offset:2048
  v_exp_f32 v95, v95
  s_nop 0
  v_cvt_pk_bf16_f32 v47, v94, v95
  s_cmp_eq_u32 s25, 0
  s_cbranch_scc1 La_d1
  .p2align 6
La_lo:
  s_waitcnt lgkmcnt(7)
  v_mfma_f32_16x16x32_bf16 v[64:67], a[32:35], a[128:131], v[16:19]
  v_exp_f32 v96, v96
  v_mfma_f32_16x16x32_bf16 v[64:67], a[36:39], a[132:135], v[64:67]
  buffer_store_dwordx4 a[244:247], v2, s[64:67], s90 offen offset:0 sc1
  v_mfma_f32_16x16x32_bf16 v[64:67], a[40:43], a[136:139], v[64:67]
  v_exp_f32 v97, v97
  v_mfma_f32_16x16x32_bf16 v[64:67], a[44:47], a[140:143], v[64:67]
  ds_read_b128 a[12:15], v4 offset:3072
  v_cvt_pk_bf16_f32 v48, v96, v97
  v_mfma_f32_16x16x32_bf16 v[72:75], a[32:35], a[144:147], v[20:23]
  v_exp_f32 v98, v98
  v_mfma_f32_16x16x32_bf16 v[72:75], a[36:39], a[148:151], v[72:75]
  ds_read_b128 a[16:19], v4 offset:4096
  v_mfma_f32_16x16x32_bf16 v[72:75], a[40:43], a[152:155], v[72:75]
  v_exp_f32 v99, v99
  v_mfma_f32_16x16x32_bf16 v[72:75], a[44:47], a[156:159], v[72:75]
  v_cvt_pk_bf16_f32 v49, v98, v99
  v_mfma_f32_16x16x32_bf16 v[80:83], a[32:35], a[160:163], v[24:27]
  v_exp_f32 v100, v100
  v_mfma_f32_16x16x32_bf16 v[80:83], a[36:39], a[164:167], v[80:83]
  ds_read_b128 a[20:23], v4 offset:5120
  v_mfma_f32_16x16x32_bf16 v[80:83], a[40:43], a[168:171], v[80:83]
  v_exp_f32 v101, v101
  v_mfma_f32_16x16x32_bf16 v[80:83], a[44:47], a[172:175], v[80:83]
  v_cvt_pk_bf16_f32 v50, v100, v101
  v_mfma_f32_16x16x32_bf16 v[88:91], a[32:35], a[176:179], v[28:31]
  v_exp_f32 v102, v102
  v_mfma_f32_16x16x32_bf16 v[88:91], a[36:39], a[180:183], v[88:91]
  ds_read_b128 a[24:27], v4 offset:6144
  v_mfma_f32_16x16x32_bf16 v[88:91], a[40:43], a[184:187], v[88:91]
  v_exp_f32 v103, v103
  v_mfma_f32_16x16x32_bf16 v[88:91], a[44:47], a[188:191], v[88:91]
  s_waitcnt lgkmcnt(7)
  v_cvt_pk_bf16_f32 v51, v102, v103
  v_mfma_f32_16x16x32_bf16 v[68:71], a[48:51], a[128:131], v[16:19]
  v_exp_f32 v104, v104
  v_mfma_f32_16x16x32_bf16 v[68:71], a[52:55], a[132:135], v[68:71]
  ds_read_b128 a[28:31], v4 offset:7168
  v_mfma_f32_16x16x32_bf16 v[68:71], a[56:59], a[136:139], v[68:71]
  v_exp_f32 v105, v105
  v_mfma_f32_16x16x32_bf16 v[68:71], a[60:63], a[140:143], v[68:71]
  v_cvt_pk_bf16_f32 v52, v104, v105
  v_mfma_f32_16x16x32_bf16 v[76:79], a[48:51], a[144:147], v[20:23]
  v_exp_f32 v106, v106
  v_mfma_f32_16x16x32_bf16 v[76:79], a[52:55], a[148:151], v[76:79]
  ds_read_b128 a[32:35], v3 offset:8192
  v_mfma_f32_16x16x32_bf16 v[76:79], a[56:59], a[152:155], v[76:79]
  v_exp_f32 v107, v107
  v_mfma_f32_16x16x32_bf16 v[76:79], a[60:63], a[156:159], v[76:79]
  v_cvt_pk_bf16_f32 v53, v106, v107
  v_mfma_f32_16x16x32_bf16 v[84:87], a[48:51], a[160:163], v[24:27]
  v_exp_f32 v108, v108
  v_mfma_f32_16x16x32_bf16 v[84:87], a[52:55], a[164:167], v[84:87]
  ds_read_b128 a[36:39], v3 offset:9216
  v_mfma_f32_16x16x32_bf16 v[84:87], a[56:59], a[168:171], v[84:87]
  v_exp_f32 v109, v109
  v_mfma_f32_16x16x32_bf16 v[84:87], a[60:63], a[172:175], v[84:87]
  v_cvt_pk_bf16_f32 v54, v108, v109
  v_mfma_f32_16x16x32_bf16 v[92:95], a[48:51], a[176:179], v[28:31]
  v_exp_f32 v110, v110
  v_mfma_f32_16x16x32_bf16 v[92:95], a[52:55], a[180:183], v[92:95]
  ds_read_b128 a[40:43], v3 offset:10240
  v_mfma_f32_16x16x32_bf16 v[92:95], a[56:59], a[184:187], v[92:95]
  v_exp_f32 v111, v111
  v_mfma_f32_16x16x32_bf16 v[92:95], a[60:63], a[188:191], v[92:95]
  s_waitcnt lgkmcnt(7)
  v_cvt_pk_bf16_f32 v55, v110, v111
  v_mfma_f32_16x16x32_bf16 v[128:131], a[0:3], v[32:35], v[128:131]
  buffer_store_dwordx4 a[244:247], v2, s[64:67], s90 offen offset:1024 sc1
  v_mfma_f32_16x16x32_bf16 v[160:163], a[0:3], v[36:39], v[160:163]
  s_add_u32 s90, s90, 2048
  v_exp_f32 v112, v112
  v_mfma_f32_16x16x32_bf16 v[192:195], a[0:3], v[40:43], v[192:195]
  s_sub_u32 s88, s88, 1
  ds_read_b128 a[44:47], v3 offset:11264
  v_mfma_f32_16x16x32_bf16 v[224:227], a[0:3], v[44:47], v[224:227]
  v_exp_f32 v113, v113
  v_mfma_f32_16x16x32_bf16 a[192:195], a[208:211], v[32:35], a[192:195]
  v_cvt_pk_bf16_f32 v56, v112, v113
  v_mfma_f32_16x16x32_bf16 v[132:135], a[4:7], v[32:35], v[132:135]
  v_exp_f32 v114, v114
  v_mfma_f32_16x16x32_bf16 v[164:167], a[4:7], v[36:39], v[164:167]
  ds_read_b128 a[48:51], v3 offset:12288
  v_mfma_f32_16x16x32_bf16 v[196:199], a[4:7], v[40:43], v[196:199]
  v_exp_f32 v115, v115
  v_mfma_f32_16x16x32_bf16 v[228:231], a[4:7], v[44:47], v[228:231]
  v_cvt_pk_bf16_f32 v57, v114, v115
  v_mfma_f32_16x16x32_bf16 a[196:199], a[208:211], v[36:39], a[196:199]
  v_exp_f32 v116, v116
  v_mfma_f32_16x16x32_bf16 v[136:139], a[8:11], v[32:35], v[136:139]
  ds_read_b128 a[52:55], v3 offset:13312
  v_mfma_f32_16x16x32_bf16 v[168:171], a[8:11], v[36:39], v[168:171]
  v_exp_f32 v117, v117
  v_mfma_f32_16x16x32_bf16 v[200:203], a[8:11], v[40:43], v[200:203]
  v_cvt_pk_bf16_f32 v58, v116, v117
  v_mfma_f32_16x16x32_bf16 v[232:235], a[8:11], v[44:47], v[232:235]
  v_exp_f32 v118, v118
  v_mfma_f32_16x16x32_bf16 a[200:203], a[208:211], v[40:43], a[200:203]
  v_mfma_f32_16x16x32_bf16 v[140:143], a[12:15], v[32:35], v[140:143]
  v_exp_f32 v119, v119
  v_mfma_f32_16x16x32_bf16 v[172:175], a[12:15], v[36:39], v[172:175]
  ds_read_b128 a[56:59], v3 offset:14336
  v_cvt_pk_bf16_f32 v59, v118, v119
  v_mfma_f32_16x16x32_bf16 v[204:207], a[12:15], v[40:43], v[204:207]
  v_exp_f32 v120, v120
  v_mfma_f32_16x16x32_bf16 v[236:239], a[12:15], v[44:47], v[236:239]
  v_mfma_f32_16x16x32_bf16 a[204:207], a[208:211], v[44:47], a[204:207]
  s_waitcnt lgkmcnt(7)
  v_exp_f32 v121, v121
  v_mfma_f32_16x16x32_bf16 v[144:147], a[16:19], v[32:35], v[144:147]
  ds_read_b128 a[60:63], v3 offset:15360
  v_cvt_pk_bf16_f32 v60, v120, v121
  v_mfma_f32_16x16x32_bf16 v[176:179], a[16:19], v[36:39], v[176:179]
  v_exp_f32 v122, v122
  v_mfma_f32_16x16x32_bf16 v[208:211], a[16:19], v[40:43], v[208:211]
  v_mfma_f32_16x16x32_bf16 v[240:243], a[16:19], v[44:47], v[240:243]
  v_exp_f32 v123, v123
  v_mfma_f32_16x16x32_bf16 v[148:151], a[20:23], v[32:35], v[148:151]
  ds_read_b128 a[0:3], v4 offset:8192
  v_cvt_pk_bf16_f32 v61, v122, v123
  v_mfma_f32_16x16x32_bf16 v[180:183], a[20:23], v[36:39], v[180:183]
  v_exp_f32 v124, v124
  v_mfma_f32_16x16x32_bf16 v[212:215], a[20:23], v[40:43], v[212:215]
  v_mfma_f32_16x16x32_bf16 v[244:247], a[20:23], v[44:47], v[244:247]
  v_exp_f32 v125, v125
  v_mfma_f32_16x16x32_bf16 v[152:155], a[24:27], v[32:35], v[152:155]
  ds_read_b128 a[4:7], v4 offset:9216
  v_cvt_pk_bf16_f32 v62, v124, v125
  v_mfma_f32_16x16x32_bf16 v[184:187], a[24:27], v[36:39], v[184:187]
  v_exp_f32 v126, v126
  v_mfma_f32_16x16x32_bf16 v[216:219], a[24:27], v[40:43], v[216:219]
  v_mfma_f32_16x16x32_bf16 v[248:251], a[24:27], v[44:47], v[248:251]
  v_exp_f32 v127, v127
  v_mfma_f32_16x16x32_bf16 v[156:159], a[28:31], v[32:35], v[156:159]
  ds_read_b128 a[8:11], v4 offset:10240
  v_cvt_pk_bf16_f32 v63, v126, v127
  v_mfma_f32_16x16x32_bf16 v[188:191], a[28:31], v[36:39], v[188:191]
  v_mfma_f32_16x16x32_bf16 v[220:223], a[28:31], v[40:43], v[220:223]
  s_waitcnt vmcnt(10)
  s_barrier
  v_mfma_f32_16x16x32_bf16 v[252:255], a[28:31], v[44:47], v[252:255]
  s_cmp_eq_u32 s88, 0
  s_cbranch_scc1 La_d0
  s_waitcnt lgkmcnt(7)
  v_mfma_f32_16x16x32_bf16 v[96:99], a[32:35], a[128:131], v[16:19]
  s_mov_b32 m0, s26
  v_exp_f32 v64, v64
  v_mfma_f32_16x16x32_bf16 v[96:99], a[36:39], a[132:135], v[96:99]
  buffer_load_dwordx4 v2, s[20:23], s28 offen offset:0 sc1 lds
  v_mfma_f32_16x16x32_bf16 v[96:99], a[40:43], a[136:139], v[96:99]
  v_exp_f32 v65, v65
  v_mfma_f32_16x16x32_bf16 v[96:99], a[44:47], a[140:143], v[96:99]
  ds_read_b128 a[12:15], v4 offset:11264
  v_cvt_pk_bf16_f32 v32, v64, v65
  v_mfma_f32_16x16x32_bf16 v[104:107], a[32:35], a[144:147], v[20:23]
  v_exp_f32 v66, v66
  v_mfma_f32_16x16x32_bf16 v[104:107], a[36:39], a[148:151], v[104:107]
  ds_read_b128 a[16:19], v4 offset:12288
  v_mfma_f32_16x16x32_bf16 v[104:107], a[40:43], a[152:155], v[104:107]
  v_exp_f32 v67, v67
  v_mfma_f32_16x16x32_bf16 v[104:107], a[44:47], a[156:159], v[104:107]
  v_cvt_pk_bf16_f32 v33, v66, v67
  v_mfma_f32_16x16x32_bf16 v[112:115], a[32:35], a[160:163], v[24:27]
  v_exp_f32 v68, v68
  v_mfma_f32_16x16x32_bf16 v[112:115], a[36:39], a[164:167], v[112:115]
  buffer_load_dwordx4 v2, s[20:23], s28 offen offset:1024 sc1 lds
  v_mfma_f32_16x16x32_bf16 v[112:115], a[40:43], a[168:171], v[112:115]
  v_exp_f32 v69, v69
  v_mfma_f32_16x16x32_bf16 v[112:115], a[44:47], a[172:175], v[112:115]
  ds_read_b128 a[20:23], v4 offset:13312
  v_cvt_pk_bf16_f32 v34, v68, v69
  v_mfma_f32_16x16x32_bf16 v[120:123], a[32:35], a[176:179], v[28:31]
  v_exp_f32 v70, v70
  v_mfma_f32_16x16x32_bf16 v[120:123], a[36:39], a[180:183], v[120:123]
  ds_read_b128 a[24:27], v4 offset:14336
  v_mfma_f32_16x16x32_bf16 v[120:123], a[40:43], a[184:187], v[120:123]
  v_exp_f32 v71, v71
  v_mfma_f32_16x16x32_bf16 v[120:123], a[44:47], a[188:191], v[120:123]
  s_waitcnt lgkmcnt(7)
  v_cvt_pk_bf16_f32 v35, v70, v71
  v_mfma_f32_16x16x32_bf16 v[100:103], a[48:51], a[128:131], v[16:19]
  v_exp_f32 v72, v72
  v_mfma_f32_16x16x32_bf16 v[100:103], a[52:55], a[132:135], v[100:103]
  buffer_load_dwordx4 v2, s[20:23], s28 offen offset:2048 sc1 lds
  v_mfma_f32_16x16x32_bf16 v[100:103], a[56:59], a[136:139], v[100:103]
  v_exp_f32 v73, v73
  v_mfma_f32_16x16x32_bf16 v[100:103], a[60:63], a[140:143], v[100:103]
  ds_read_b128 a[28:31], v4 offset:15360
  v_xor_b32 v3, s30, v3
  v_mfma_f32_16x16x32_bf16 v[108:111], a[48:51], a[144:147], v[20:23]
  v_exp_f32 v74, v74
  v_mfma_f32_16x16x32_bf16 v[108:111], a[52:55], a[148:151], v[108:111]
  ds_read_b128 a[32:35], v3 offset:0
  v_cvt_pk_bf16_f32 v36, v72, v73
  v_mfma_f32_16x16x32_bf16 v[108:111], a[56:59], a[152:155], v[108:111]
  v_exp_f32 v75, v75
  v_mfma_f32_16x16x32_bf16 v[108:111], a[60:63], a[156:159], v[108:111]
  v_cvt_pk_bf16_f32 v37, v74, v75
  v_mfma_f32_16x16x32_bf16 v[116:119], a[48:51], a[160:163], v[24:27]
  v_exp_f32 v76, v76
  v_mfma_f32_16x16x32_bf16 v[116:119], a[52:55], a[164:167], v[116:119]
  buffer_load_dwordx4 v2, s[20:23], s28 offen offset:3072 sc1 lds
  v_mfma_f32_16x16x32_bf16 v[116:119], a[56:59], a[168:171], v[116:119]
  s_xor_b32 s26, s26, s31
  v_exp_f32 v77, v77
  v_mfma_f32_16x16x32_bf16 v[116:119], a[60:63], a[172:175], v[116:119]
  s_add_u32 s28, s28, 0x8000
  s_mov_b32 m0, s27
  ds_read_b128 a[36:39], v3 offset:1024
  v_mfma_f32_16x16x32_bf16 v[124:127], a[48:51], a[176:179], v[28:31]
  v_exp_f32 v78, v78
  v_mfma_f32_16x16x32_bf16 v[124:127], a[52:55], a[180:183], v[124:127]
  ds_read_b128 a[40:43], v3 offset:2048
  v_cvt_pk_bf16_f32 v38, v76, v77
  v_mfma_f32_16x16x32_bf16 v[124:127], a[56:59], a[184:187], v[124:127]
  v_exp_f32 v79, v79
  v_mfma_f32_16x16x32_bf16 v[124:127], a[60:63], a[188:191], v[124:127]
  s_waitcnt lgkmcnt(7)
  v_cvt_pk_bf16_f32 v39, v78, v79
  v_mfma_f32_16x16x32_bf16 v[128:131], a[0:3], v[48:51], v[128:131]
  buffer_load_dwordx4 v2, s[20:23], s29 offen offset:0 sc1 lds
  v_mfma_f32_16x16x32_bf16 v[160:163], a[0:3], v[52:55], v[160:163]
  v_exp_f32 v80, v80
  v_mfma_f32_16x16x32_bf16 v[192:195], a[0:3], v[56:59], v[192:195]
  ds_read_b128 a[44:47], v3 offset:3072
  v_mfma_f32_16x16x32_bf16 v[224:227], a[0:3], v[60:63], v[224:227]
  v_exp_f32 v81, v81
  v_mfma_f32_16x16x32_bf16 a[192:195], a[208:211], v[48:51], a[192:195]
  v_cvt_pk_bf16_f32 v40, v80, v81
  v_mfma_f32_16x16x32_bf16 v[132:135], a[4:7], v[48:51], v[132:135]
  v_exp_f32 v82, v82
  v_mfma_f32_16x16x32_bf16 v[164:167], a[4:7], v[52:55], v[164:167]
  ds_read_b128 a[48:51], v3 offset:4096
  v_mfma_f32_16x16x32_bf16 v[196:199], a[4:7], v[56:59], v[196:199]
  v_exp_f32 v83, v83
  v_mfma_f32_16x16x32_bf16 v[228:231], a[4:7], v[60:63], v[228:231]
  buffer_load_dwordx4 v2, s[20:23], s29 offen offset:1024 sc1 lds
  v_mfma_f32_16x16x32_bf16 a[196:199], a[208:211], v[52:55], a[196:199]
  v_exp_f32 v84, v84
  v_mfma_f32_16x16x32_bf16 v[136:139], a[8:11], v[48:51], v[136:139]
  ds_read_b128 a[52:55], v3 offset:5120
  v_cvt_pk_bf16_f32 v41, v82, v83
  v_mfma_f32_16x16x32_bf16 v[168:171], a[8:11], v[52:55], v[168:171]
  v_exp_f32 v85, v85
  v_mfma_f32_16x16x32_bf16 v[200:203], a[8:11], v[56:59], v[200:203]
  v_cvt_pk_bf16_f32 v42, v84, v85
  v_mfma_f32_16x16x32_bf16 v[232:235], a[8:11], v[60:63], v[232:235]
  v_exp_f32 v86, v86
  v_mfma_f32_16x16x32_bf16 a[200:203], a[208:211], v[56:59], a[200:203]
  v_mfma_f32_16x16x32_bf16 v[140:143], a[12:15], v[48:51], v[140:143]
  v_exp_f32 v87, v87
  v_mfma_f32_16x16x32_bf16 v[172:175], a[12:15], v[52:55], v[172:175]
  buffer_load_dwordx4 v2, s[20:23], s29 offen offset:2048 sc1 lds
  v_mfma_f32_16x16x32_bf16 v[204:207], a[12:15], v[56:59], v[204:207]
  v_exp_f32 v88, v88
  v_mfma_f32_16x16x32_bf16 v[236:239], a[12:15], v[60:63], v[236:239]
  ds_read_b128 a[56:59], v3 offset:6144
  v_cvt_pk_bf16_f32 v43, v86, v87
  v_mfma_f32_16x16x32_bf16 a[204:207], a[208:211], v[60:63], a[204:207]
  s_waitcnt lgkmcnt(7)
  v_exp_f32 v89, v89
  v_mfma_f32_16x16x32_bf16 v[144:147], a[16:19], v[48:51], v[144:147]
  ds_read_b128 a[60:63], v3 offset:7168
  v_cvt_pk_bf16_f32 v44, v88, v89
  v_mfma_f32_16x16x32_bf16 v[176:179], a[16:19], v[52:55], v[176:179]
  v_exp_f32 v90, v90
  v_mfma_f32_16x16x32_bf16 v[208:211], a[16:19], v[56:59], v[208:211]
  v_mfma_f32_16x16x32_bf16 v[240:243], a[16:19], v[60:63], v[240:243]
  v_exp_f32 v91, v91
  v_mfma_f32_16x16x32_bf16 v[148:151], a[20:23], v[48:51], v[148:151]
  buffer_load_dwordx4 v2, s[20:23], s29 offen offset:3072 sc1 lds
  v_mfma_f32_16x16x32_bf16 v[180:183], a[20:23], v[52:55], v[180:183]
  s_xor_b32 s27, s27, s30
  v_exp_f32 v92, v92
  v_mfma_f32_16x16x32_bf16 v[212:215], a[20:23], v[56:59], v[212:215]
  s_add_u32 s29, s29, 0x8000
  v_xor_b32 v4, s31, v4
  v_cvt_pk_bf16_f32 v45, v90, v91
  v_mfma_f32_16x16x32_bf16 v[244:247], a[20:23], v[60:63], v[244:247]
  v_exp_f32 v93, v93
  v_mfma_f32_16x16x32_bf16 v[152:155], a[24:27], v[48:51], v[152:155]
  ds_read_b128 a[0:3], v4 offset:0
  ds_read_b128 a[4:7], v4 offset:1024
  v_mfma_f32_16x16x32_bf16 v[184:187], a[24:27], v[52:55], v[184:187]
  v_exp_f32 v94, v94
  v_mfma_f32_16x16x32_bf16 v[216:219], a[24:27], v[56:59], v[216:219]
  v_cvt_pk_bf16_f32 v46, v92, v93
  v_mfma_f32_16x16x32_bf16 v[248:251], a[24:27], v[60:63], v[248:251]
  v_exp_f32 v95, v95
  v_mfma_f32_16x16x32_bf16 v[156:159], a[28:31], v[48:51], v[156:159]
  ds_read_b128 a[8:11], v4 offset:2048
  v_cvt_pk_bf16_f32 v47, v94, v95
  v_mfma_f32_16x16x32_bf16 v[188:191], a[28:31], v[52:55], v[188:191]
  v_mfma_f32_16x16x32_bf16 v[220:223], a[28:31], v[56:59], v[220:223]
  v_mfma_f32_16x16x32_bf16 v[252:255], a[28:31], v[60:63], v[252:255]
  s_xor_b32 s30, s30, 0xc000
  s_xor_b32 s31, s31, 0xc000
  s_branch La_lo
La_d0:
  s_waitcnt lgkmcnt(7)
  v_mfma_f32_16x16x32_bf16 v[96:99], a[32:35], a[128:131], v[16:19]
  s_mov_b32 m0, s26
  ds_read_b128 a[12:15], v4 offset:11264
  v_cndmask_b32 v64, v64, v5, s[32:33]
  v_mfma_f32_16x16x32_bf16 v[96:99], a[36:39], a[132:135], v[96:99]
  v_exp_f32 v64, v64
  v_mfma_f32_16x16x32_bf16 v[96:99], a[40:43], a[136:139], v[96:99]
  v_cndmask_b32 v65, v65, v5, s[34:35]
  v_exp_f32 v65, v65
  v_mfma_f32_16x16x32_bf16 v[96:99], a[44:47], a[140:143], v[96:99]
  buffer_load_dwordx4 v2, s[20:23], s28 offen offset:0 sc1 lds
  v_mfma_f32_16x16x32_bf16 v[104:107], a[32:35], a[144:147], v[20:23]
  v_cndmask_b32 v66, v66, v5, s[36:37]
  v_exp_f32 v66, v66
  v_mfma_f32_16x16x32_bf16 v[104:107], a[36:39], a[148:151], v[104:107]
  ds_read_b128 a[16:19], v4 offset:12288
  v_cndmask_b32 v67, v67, v5, s[38:39]
  v_mfma_f32_16x16x32_bf16 v[104:107], a[40:43], a[152:155], v[104:107]
  v_exp_f32 v67, v67
  v_mfma_f32_16x16x32_bf16 v[104:107], a[44:47], a[156:159], v[104:107]
  v_cndmask_b32 v68, v68, v5, s[40:41]
  v_cndmask_b32 v69, v69, v5, s[42:43]
  v_mfma_f32_16x16x32_bf16 v[112:115], a[32:35], a[160:163], v[24:27]
  v_exp_f32 v68, v68
  v_mfma_f32_16x16x32_bf16 v[112:115], a[36:39], a[164:167], v[112:115]
  buffer_load_dwordx4 v2, s[20:23], s28 offen offset:1024 sc1 lds
  v_mfma_f32_16x16x32_bf16 v[112:115], a[40:43], a[168:171], v[112:115]
  v_exp_f32 v69, v69
  v_mfma_f32_16x16x32_bf16 v[112:115], a[44:47], a[172:175], v[112:115]
  ds_read_b128 a[20:23], v4 offset:13312
  v_cndmask_b32 v70, v70, v5, s[44:45]
  v_mfma_f32_16x16x32_bf16 v[120:123], a[32:35], a[176:179], v[28:31]
  v_exp_f32 v70, v70
  v_mfma_f32_16x16x32_bf16 v[120:123], a[36:39], a[180:183], v[120:123]
  ds_read_b128 a[24:27], v4 offset:14336
  v_cndmask_b32 v71, v71, v5, s[46:47]
  v_mfma_f32_16x16x32_bf16 v[120:123], a[40:43], a[184:187], v[120:123]
  v_exp_f32 v71, v71
  v_mfma_f32_16x16x32_bf16 v[120:123], a[44:47], a[188:191], v[120:123]
  s_waitcnt lgkmcnt(7)
  v_cvt_pk_bf16_f32 v32, v64, v65
  v_cvt_pk_bf16_f32 v33, v66, v67
  v_mfma_f32_16x16x32_bf16 v[100:103], a[48:51], a[128:131], v[16:19]
  v_exp_f32 v72, v72
  v_mfma_f32_16x16x32_bf16 v[100:103], a[52:55], a[132:135], v[100:103]
  buffer_load_dwordx4 v2, s[20:23], s28 offen offset:2048 sc1 lds
  v_mfma_f32_16x16x32_bf16 v[100:103], a[56:59], a[136:139], v[100:103]
  v_exp_f32 v73, v73
  v_mfma_f32_16x16x32_bf16 v[100:103], a[60:63], a[140:143], v[100:103]
  ds_read_b128 a[28:31], v4 offset:15360
  v_xor_b32 v3, 0x4000, v3
  v_mfma_f32_16x16x32_bf16 v[108:111], a[48:51], a[144:147], v[20:23]
  v_exp_f32 v74, v74
  v_mfma_f32_16x16x32_bf16 v[108:111], a[52:55], a[148:151], v[108:111]
  ds_read_b128 a[32:35], v3 offset:0
  v_cvt_pk_bf16_f32 v34, v68, v69
  v_mfma_f32_16x16x32_bf16 v[108:111], a[56:59], a[152:155], v[108:111]
  v_exp_f32 v75, v75
  v_mfma_f32_16x16x32_bf16 v[108:111], a[60:63], a[156:159], v[108:111]
  v_cvt_pk_bf16_f32 v35, v70, v71
  v_cvt_pk_bf16_f32 v36, v72, v73
  v_mfma_f32_16x16x32_bf16 v[116:119], a[48:51], a[160:163], v[24:27]
  v_exp_f32 v76, v76
  v_mfma_f32_16x16x32_bf16 v[116:119], a[52:55], a[164:167], v[116:119]
  buffer_load_dwordx4 v2, s[20:23], s28 offen offset:3072 sc1 lds
  v_mfma_f32_16x16x32_bf16 v[116:119], a[56:59], a[168:171], v[116:119]
  s_xor_b32 s26, s26, 0x8000
  v_exp_f32 v77, v77
  v_mfma_f32_16x16x32_bf16 v[116:119], a[60:63], a[172:175], v[116:119]
  s_add_u32 s28, s28, 0x8000
  s_mov_b32 m0, s27
  ds_read_b128 a[36:39], v3 offset:1024
  v_mfma_f32_16x16x32_bf16 v[124:127], a[48:51], a[176:179], v[28:31]
  v_exp_f32 v78, v78
  v_mfma_f32_16x16x32_bf16 v[124:127], a[52:55], a[180:183], v[124:127]
  ds_read_b128 a[40:43], v3 offset:2048
  v_cvt_pk_bf16_f32 v37, v74, v75
  v_mfma_f32_16x16x32_bf16 v[124:127], a[56:59], a[184:187], v[124:127]
  v_exp_f32 v79, v79
  v_mfma_f32_16x16x32_bf16 v[124:127], a[60:63], a[188:191], v[124:127]
  s_waitcnt lgkmcnt(7)
  v_cvt_pk_bf16_f32 v38, v76, v77
  v_cvt_pk_bf16_f32 v39, v78, v79
  v_mfma_f32_16x16x32_bf16 v[128:131], a[0:3], v[48:51], v[128:131]
  buffer_load_dwordx4 v2, s[20:23], s29 offen offset:0 sc1 lds
  v_mfma_f32_16x16x32_bf16 v[160:163], a[0:3], v[52:55], v[160:163]
  v_exp_f32 v80, v80
  v_mfma_f32_16x16x32_bf16 v[192:195], a[0:3], v[56:59], v[192:195]
  ds_read_b128 a[44:47], v3 offset:3072
  v_mfma_f32_16x16x32_bf16 v[224:227], a[0:3], v[60:63], v[224:227]
  v_exp_f32 v81, v81
  v_mfma_f32_16x16x32_bf16 a[192:195], a[208:211], v[48:51], a[192:195]
  v_cvt_pk_bf16_f32 v40, v80, v81
  v_mfma_f32_16x16x32_bf16 v[132:135], a[4:7], v[48:51], v[132:135]
  v_exp_f32 v82, v82
  v_mfma_f32_16x16x32_bf16 v[164:167], a[4:7], v[52:55], v[164:167]
  ds_read_b128 a[48:51], v3 offset:4096
  v_mfma_f32_16x16x32_bf16 v[196:199], a[4:7], v[56:59], v[196:199]
  v_exp_f32 v83, v83
  v_mfma_f32_16x16x32_bf16 v[228:231], a[4:7], v[60:63], v[228:231]
  buffer_load_dwordx4 v2, s[20:23], s29 offen offset:1024 sc1 lds
  v_mfma_f32_16x16x32_bf16 a[196:199], a[208:211], v[52:55], a[196:199]
  v_exp_f32 v84, v84
  v_mfma_f32_16x16x32_bf16 v[136:139], a[8:11], v[48:51], v[136:139]
  ds_read_b128 a[52:55], v3 offset:5120
  v_cvt_pk_bf16_f32 v41, v82, v83
  v_mfma_f32_16x16x32_bf16 v[168:171], a[8:11], v[52:55], v[168:171]
  v_exp_f32 v85, v85
  v_mfma_f32_16x16x32_bf16 v[200:203], a[8:11], v[56:59], v[200:203]
  v_cvt_pk_bf16_f32 v42, v84, v85
  v_mfma_f32_16x16x32_bf16 v[232:235], a[8:11], v[60:63], v[232:235]
  v_exp_f32 v86, v86
  v_mfma_f32_16x16x32_bf16 a[200:203], a[208:211], v[56:59], a[200:203]
  v_mfma_f32_16x16x32_bf16 v[140:143], a[12:15], v[48:51], v[140:143]
  v_exp_f32 v87, v87
  v_mfma_f32_16x16x32_bf16 v[172:175], a[12:15], v[52:55], v[172:175]
  buffer_load_dwordx4 v2, s[20:23], s29 offen offset:2048 sc1 lds
  v_mfma_f32_16x16x32_bf16 v[204:207], a[12:15], v[56:59], v[204:207]
  v_exp_f32 v88, v88
  v_mfma_f32_16x16x32_bf16 v[236:239], a[12:15], v[60:63], v[236:239]
  ds_read_b128 a[56:59], v3 offset:6144
  v_cvt_pk_bf16_f32 v43, v86, v87
  v_mfma_f32_16x16x32_bf16 a[204:207], a[208:211], v[60:63], a[204:207]
  s_waitcnt lgkmcnt(7)
  v_exp_f32 v89, v89
  v_mfma_f32_16x16x32_bf16 v[144:147], a[16:19], v[48:51], v[144:147]
  ds_read_b128 a[60:63], v3 offset:7168
  v_cvt_pk_bf16_f32 v44, v88, v89
  v_mfma_f32_16x16x32_bf16 v[176:179], a[16:19], v[52:55], v[176:179]
  v_exp_f32 v90, v90
  v_mfma_f32_16x16x32_bf16 v[208:211], a[16:19], v[56:59], v[208:211]
  v_mfma_f32_16x16x32_bf16 v[240:243], a[16:19], v[60:63], v[240:243]
  v_exp_f32 v91, v91
  v_mfma_f32_16x16x32_bf16 v[148:151], a[20:23], v[48:51], v[148:151]
  buffer_load_dwordx4 v2, s[20:23], s29 offen offset:3072 sc1 lds
  v_mfma_f32_16x16x32_bf16 v[180:183], a[20:23], v[52:55], v[180:183]
  s_xor_b32 s27, s27, 0x4000
  v_exp_f32 v92, v92
  v_mfma_f32_16x16x32_bf16 v[212:215], a[20:23], v[56:59], v[212:215]
  s_add_u32 s29, s29, 0x8000
  v_xor_b32 v4, 0x8000, v4
  v_cvt_pk_bf16_f32 v45, v90, v91
  v_mfma_f32_16x16x32_bf16 v[244:247], a[20:23], v[60:63], v[244:247]
  v_exp_f32 v93, v93
  v_mfma_f32_16x16x32_bf16 v[152:155], a[24:27], v[48:51], v[152:155]
  ds_read_b128 a[0:3], v4 offset:0
  ds_read_b128 a[4:7], v4 offset:1024
  v_mfma_f32_16x16x32_bf16 v[184:187], a[24:27], v[52:55], v[184:187]
  v_exp_f32 v94, v94
  v_mfma_f32_16x16x32_bf16 v[216:219], a[24:27], v[56:59], v[216:219]
  v_cvt_pk_bf16_f32 v46, v92, v93
  v_mfma_f32_16x16x32_bf16 v[248:251], a[24:27], v[60:63], v[248:251]
  v_exp_f32 v95, v95
  v_mfma_f32_16x16x32_bf16 v[156:159], a[28:31], v[48:51], v[156:159]
  ds_read_b128 a[8:11], v4 offset:2048
  v_cvt_pk_bf16_f32 v47, v94, v95
  v_mfma_f32_16x16x32_bf16 v[188:191], a[28:31], v[52:55], v[188:191]
  v_mfma_f32_16x16x32_bf16 v[220:223], a[28:31], v[56:59], v[220:223]
  v_mfma_f32_16x16x32_bf16 v[252:255], a[28:31], v[60:63], v[252:255]
La_d1:
  s_waitcnt lgkmcnt(7)
  v_mfma_f32_16x16x32_bf16 v[72:75], a[32:35], a[144:147], v[20:23]
  buffer_load_dwordx4 a[64:67], v2, s[8:11], s6 offen offset:0
  v_mfma_f32_16x16x32_bf16 v[72:75], a[36:39], a[148:151], v[72:75]
  v_cndmask_b32 v96, v96, v5, s[48:49]
  v_exp_f32 v96, v96
  v_mfma_f32_16x16x32_bf16 v[72:75], a[40:43], a[152:155], v[72:75]
  v_cndmask_b32 v97, v97, v5, s[50:51]
  v_exp_f32 v97, v97
  v_mfma_f32_16x16x32_bf16 v[72:75], a[44:47], a[156:159], v[72:75]
  v_cndmask_b32 v98, v98, v5, s[52:53]
  v_exp_f32 v98, v98
  v_mfma_f32_16x16x32_bf16 v[80:83], a[32:35], a[160:163], v[24:27]
  ds_read_b128 a[12:15], v4 offset:3072
  ds_read_b128 a[16:19], v4 offset:4096
  v_mfma_f32_16x16x32_bf16 v[80:83], a[36:39], a[164:167], v[80:83]
  v_cndmask_b32 v99, v99, v5, s[54:55]
  v_exp_f32 v99, v99
  v_mfma_f32_16x16x32_bf16 v[80:83], a[40:43], a[168:171], v[80:83]
  buffer_load_dwordx4 a[64:67], v2, s[8:11], s6 offen offset:1024
  v_mfma_f32_16x16x32_bf16 v[80:83], a[44:47], a[172:175], v[80:83]
  v_cndmask_b32 v100, v100, v5, s[56:57]
  v_exp_f32 v100, v100
  v_mfma_f32_16x16x32_bf16 v[88:91], a[32:35], a[176:179], v[28:31]
  ds_read_b128 a[20:23], v4 offset:5120
  v_cndmask_b32 v101, v101, v5, s[58:59]
  v_mfma_f32_16x16x32_bf16 v[88:91], a[36:39], a[180:183], v[88:91]
  v_exp_f32 v101, v101
  v_mfma_f32_16x16x32_bf16 v[88:91], a[40:43], a[184:187], v[88:91]
  v_cndmask_b32 v102, v102, v5, s[60:61]
  v_exp_f32 v102, v102
  v_mfma_f32_16x16x32_bf16 v[88:91], a[44:47], a[188:191], v[88:91]
  s_waitcnt lgkmcnt(6)
  ds_read_b128 a[24:27], v4 offset:6144
  v_cndmask_b32 v103, v103, v5, s[62:63]
  v_mfma_f32_16x16x32_bf16 v[76:79], a[48:51], a[144:147], v[20:23]
  v_exp_f32 v103, v103
  v_mfma_f32_16x16x32_bf16 v[76:79], a[52:55], a[148:151], v[76:79]
  buffer_load_dwordx4 a[64:67], v2, s[8:11], s6 offen offset:2048
  v_mfma_f32_16x16x32_bf16 v[76:79], a[56:59], a[152:155], v[76:79]
  v_exp_f32 v104, v104
  v_mfma_f32_16x16x32_bf16 v[76:79], a[60:63], a[156:159], v[76:79]
  ds_read_b128 a[28:31], v4 offset:7168
  ds_read_b128 a[32:35], v3 offset:8192
  v_mfma_f32_16x16x32_bf16 v[84:87], a[48:51], a[160:163], v[24:27]
  v_exp_f32 v105, v105
  v_mfma_f32_16x16x32_bf16 v[84:87], a[52:55], a[164:167], v[84:87]
  buffer_load_dwordx4 a[64:67], v2, s[8:11], s6 offen offset:3072
  v_mfma_f32_16x16x32_bf16 v[84:87], a[56:59], a[168:171], v[84:87]
  s_add_u32 s6, s6, 4096
  v_exp_f32 v106, v106
  v_mfma_f32_16x16x32_bf16 v[84:87], a[60:63], a[172:175], v[84:87]
  v_exp_f32 v107, v107
  v_mfma_f32_16x16x32_bf16 v[92:95], a[48:51], a[176:179], v[28:31]
  ds_read_b128 a[36:39], v3 offset:9216
  v_cvt_pk_bf16_f32 v48, v96, v97
  v_mfma_f32_16x16x32_bf16 v[92:95], a[52:55], a[180:183], v[92:95]
  v_exp_f32 v108, v108
  v_mfma_f32_16x16x32_bf16 v[92:95], a[56:59], a[184:187], v[92:95]
  buffer_load_dwordx4 a[64:67], v2, s[8:11], s6 offen offset:0
  v_mfma_f32_16x16x32_bf16 v[92:95], a[60:63], a[188:191], v[92:95]
  s_waitcnt lgkmcnt(6)
  v_exp_f32 v109, v109
  v_mfma_f32_16x16x32_bf16 v[128:131], a[0:3], v[32:35], v[128:131]
  ds_read_b128 a[40:43], v3 offset:10240
  ds_read_b128 a[44:47], v3 offset:11264
  v_mfma_f32_16x16x32_bf16 v[160:163], a[0:3], v[36:39], v[160:163]
  v_exp_f32 v110, v110
  v_mfma_f32_16x16x32_bf16 v[192:195], a[0:3], v[40:43], v[192:195]
  v_cvt_pk_bf16_f32 v49, v98, v99
  v_cvt_pk_bf16_f32 v50, v100, v101
  v_mfma_f32_16x16x32_bf16 v[224:227], a[0:3], v[44:47], v[224:227]
  v_exp_f32 v111, v111
  v_mfma_f32_16x16x32_bf16 a[192:195], a[208:211], v[32:35], a[192:195]
  buffer_load_dwordx4 a[64:67], v2, s[8:11], s6 offen offset:1024
  v_mfma_f32_16x16x32_bf16 v[132:135], a[4:7], v[32:35], v[132:135]
  v_exp_f32 v112, v112
  v_mfma_f32_16x16x32_bf16 v[164:167], a[4:7], v[36:39], v[164:167]
  v_exp_f32 v113, v113
  v_mfma_f32_16x16x32_bf16 v[196:199], a[4:7], v[40:43], v[196:199]
  ds_read_b128 a[48:51], v3 offset:12288
  v_cvt_pk_bf16_f32 v51, v102, v103
  v_mfma_f32_16x16x32_bf16 v[228:231], a[4:7], v[44:47], v[228:231]
  v_exp_f32 v114, v114
  v_mfma_f32_16x16x32_bf16 a[196:199], a[208:211], v[36:39], a[196:199]
  buffer_load_dwordx4 a[64:67], v2, s[8:11], s6 offen offset:2048
  v_mfma_f32_16x16x32_bf16 v[136:139], a[8:11], v[32:35], v[136:139]
  v_exp_f32 v115, v115
  v_mfma_f32_16x16x32_bf16 v[168:171], a[8:11], v[36:39], v[168:171]
  ds_read_b128 a[52:55], v3 offset:13312
  v_cvt_pk_bf16_f32 v52, v104, v105
  v_mfma_f32_16x16x32_bf16 v[200:203], a[8:11], v[40:43], v[200:203]
  v_exp_f32 v116, v116
  v_mfma_f32_16x16x32_bf16 v[232:235], a[8:11], v[44:47], v[232:235]
  v_cvt_pk_bf16_f32 v53, v106, v107
  v_cvt_pk_bf16_f32 v54, v108, v109
  v_mfma_f32_16x16x32_bf16 a[200:203], a[208:211], v[40:43], a[200:203]
  v_exp_f32 v117, v117
  v_mfma_f32_16x16x32_bf16 v[140:143], a[12:15], v[32:35], v[140:143]
  v_exp_f32 v118, v118
  v_mfma_f32_16x16x32_bf16 v[172:175], a[12:15], v[36:39], v[172:175]
  buffer_load_dwordx4 a[64:67], v2, s[8:11], s6 offen offset:3072
  v_mfma_f32_16x16x32_bf16 v[204:207], a[12:15], v[40:43], v[204:207]
  v_exp_f32 v119, v119
  v_mfma_f32_16x16x32_bf16 v[236:239], a[12:15], v[44:47], v[236:239]
  ds_read_b128 a[56:59], v3 offset:14336
  v_cvt_pk_bf16_f32 v55, v110, v111
  v_mfma_f32_16x16x32_bf16 a[204:207], a[208:211], v[44:47], a[204:207]
  s_waitcnt lgkmcnt(7)
  v_exp_f32 v120, v120
  v_mfma_f32_16x16x32_bf16 v[144:147], a[16:19], v[32:35], v[144:147]
  buffer_load_dwordx4 a[64:67], v2, s[12:15], s7 offen offset:0
  v_mfma_f32_16x16x32_bf16 v[176:179], a[16:19], v[36:39], v[176:179]
  v_exp_f32 v121, v121
  v_mfma_f32_16x16x32_bf16 v[208:211], a[16:19], v[40:43], v[208:211]
  ds_read_b128 a[60:63], v3 offset:15360
  v_cvt_pk_bf16_f32 v56, v112, v113
  v_mfma_f32_16x16x32_bf16 v[240:243], a[16:19], v[44:47], v[240:243]
  v_exp_f32 v122, v122
  v_mfma_f32_16x16x32_bf16 v[148:151], a[20:23], v[32:35], v[148:151]
  v_exp_f32 v123, v123
  v_mfma_f32_16x16x32_bf16 v[180:183], a[20:23], v[36:39], v[180:183]
  ds_read_b128 a[0:3], v4 offset:8192
  v_cvt_pk_bf16_f32 v57, v114, v115
  v_mfma_f32_16x16x32_bf16 v[212:215], a[20:23], v[40:43], v[212:215]
  v_exp_f32 v124, v124
  v_mfma_f32_16x16x32_bf16 v[244:247], a[20:23], v[44:47], v[244:247]
  buffer_load_dwordx4 a[64:67], v2, s[12:15], s7 offen offset:1024
  v_mfma_f32_16x16x32_bf16 v[152:155], a[24:27], v[32:35], v[152:155]
  v_exp_f32 v125, v125
  v_mfma_f32_16x16x32_bf16 v[184:187], a[24:27], v[36:39], v[184:187]
  ds_read_b128 a[4:7], v4 offset:9216
  v_cvt_pk_bf16_f32 v58, v116, v117
  v_mfma_f32_16x16x32_bf16 v[216:219], a[24:27], v[40:43], v[216:219]
  v_exp_f32 v126, v126
  v_mfma_f32_16x16x32_bf16 v[248:251], a[24:27], v[44:47], v[248:251]
  v_cvt_pk_bf16_f32 v59, v118, v119
  v_cvt_pk_bf16_f32 v60, v120, v121
  v_mfma_f32_16x16x32_bf16 v[156:159], a[28:31], v[32:35], v[156:159]
  v_exp_f32 v127, v127
  v_mfma_f32_16x16x32_bf16 v[188:191], a[28:31], v[36:39], v[188:191]
  ds_read_b128 a[8:11], v4 offset:10240
  v_cvt_pk_bf16_f32 v61, v122, v123
  v_mfma_f32_16x16x32_bf16 v[220:223], a[28:31], v[40:43], v[220:223]
  s_waitcnt vmcnt(22)
  s_barrier
  v_mfma_f32_16x16x32_bf16 v[252:255], a[28:31], v[44:47], v[252:255]
  v_cvt_pk_bf16_f32 v62, v124, v125
  v_cvt_pk_bf16_f32 v63, v126, v127
  s_waitcnt lgkmcnt(7)
  v_mfma_f32_16x16x32_bf16 v[104:107], a[32:35], a[144:147], v[20:23]
  s_mov_b32 m0, s26
  ds_read_b128 a[12:15], v4 offset:11264
  v_cndmask_b32 v72, v72, v5, s[32:33]
  v_mfma_f32_16x16x32_bf16 v[104:107], a[36:39], a[148:151], v[104:107]
  v_exp_f32 v72, v72
  v_mfma_f32_16x16x32_bf16 v[104:107], a[40:43], a[152:155], v[104:107]
  v_cndmask_b32 v73, v73, v5, s[34:35]
  v_exp_f32 v73, v73
  v_mfma_f32_16x16x32_bf16 v[104:107], a[44:47], a[156:159], v[104:107]
  buffer_load_dwordx4 v2, s[20:23], s28 offen offset:0 sc1 lds
  v_mfma_f32_16x16x32_bf16 v[112:115], a[32:35], a[160:163], v[24:27]
  v_cndmask_b32 v74, v74, v5, s[36:37]
  v_exp_f32 v74, v74
  v_mfma_f32_16x16x32_bf16 v[112:115], a[36:39], a[164:167], v[112:115]
  ds_read_b128 a[16:19], v4 offset:12288
  v_cndmask_b32 v76, v76, v5, s[40:41]
  v_mfma_f32_16x16x32_bf16 v[112:115], a[40:43], a[168:171], v[112:115]
  ds_read_b128 a[20:23], v4 offset:13312
  v_cndmask_b32 v75, v75, v5, s[38:39]
  v_mfma_f32_16x16x32_bf16 v[112:115], a[44:47], a[172:175], v[112:115]
  v_exp_f32 v75, v75
  v_mfma_f32_16x16x32_bf16 v[120:123], a[32:35], a[176:179], v[28:31]
  buffer_load_dwordx4 v2, s[20:23], s28 offen offset:1024 sc1 lds
  v_mfma_f32_16x16x32_bf16 v[120:123], a[36:39], a[180:183], v[120:123]
  v_exp_f32 v76, v76
  v_mfma_f32_16x16x32_bf16 v[120:123], a[40:43], a[184:187], v[120:123]
  ds_read_b128 a[24:27], v4 offset:14336
  v_cndmask_b32 v79, v79, v5, s[46:47]
  v_mfma_f32_16x16x32_bf16 v[120:123], a[44:47], a[188:191], v[120:123]
  s_waitcnt lgkmcnt(7)
  v_cndmask_b32 v77, v77, v5, s[42:43]
  v_cndmask_b32 v78, v78, v5, s[44:45]
  v_mfma_f32_16x16x32_bf16 v[108:111], a[48:51], a[144:147], v[20:23]
  v_exp_f32 v77, v77
  v_mfma_f32_16x16x32_bf16 v[108:111], a[52:55], a[148:151], v[108:111]
  ds_read_b128 a[28:31], v4 offset:15360
  v_xor_b32 v4, 0x4000, v4
  v_mfma_f32_16x16x32_bf16 v[108:111], a[56:59], a[152:155], v[108:111]
  v_exp_f32 v78, v78
  v_mfma_f32_16x16x32_bf16 v[108:111], a[60:63], a[156:159], v[108:111]
  buffer_load_dwordx4 v2, s[20:23], s28 offen offset:2048 sc1 lds
  v_mfma_f32_16x16x32_bf16 v[116:119], a[48:51], a[160:163], v[24:27]
  v_exp_f32 v79, v79
  v_mfma_f32_16x16x32_bf16 v[116:119], a[52:55], a[164:167], v[116:119]
  v_xor_b32 v3, 0x8000, v3
  v_cvt_pk_bf16_f32 v36, v72, v73
  v_mfma_f32_16x16x32_bf16 v[116:119], a[56:59], a[168:171], v[116:119]
  ds_read_b128 a[32:35], v3 offset:0
  ds_read_b128 a[36:39], v3 offset:1024
  v_mfma_f32_16x16x32_bf16 v[116:119], a[60:63], a[172:175], v[116:119]
  v_exp_f32 v80, v80
  v_mfma_f32_16x16x32_bf16 v[124:127], a[48:51], a[176:179], v[28:31]
  v_cvt_pk_bf16_f32 v37, v74, v75
  v_cvt_pk_bf16_f32 v38, v76, v77
  v_mfma_f32_16x16x32_bf16 v[124:127], a[52:55], a[180:183], v[124:127]
  v_exp_f32 v81, v81
  v_mfma_f32_16x16x32_bf16 v[124:127], a[56:59], a[184:187], v[124:127]
  buffer_load_dwordx4 v2, s[20:23], s28 offen offset:3072 sc1 lds
  v_mfma_f32_16x16x32_bf16 v[124:127], a[60:63], a[188:191], v[124:127]
  s_waitcnt lgkmcnt(6)
  s_xor_b32 s26, s26, 0x4000
  s_add_u32 s28, s28, 0x8000
  v_mfma_f32_16x16x32_bf16 v[128:131], a[0:3], v[48:51], v[128:131]
  s_mov_b32 m0, s27
  v_exp_f32 v82, v82
  v_mfma_f32_16x16x32_bf16 v[160:163], a[0:3], v[52:55], v[160:163]
  ds_read_b128 a[40:43], v3 offset:2048
  ds_read_b128 a[44:47], v3 offset:3072
  v_mfma_f32_16x16x32_bf16 v[192:195], a[0:3], v[56:59], v[192:195]
  v_exp_f32 v83, v83
  v_mfma_f32_16x16x32_bf16 v[224:227], a[0:3], v[60:63], v[224:227]
  v_cvt_pk_bf16_f32 v39, v78, v79
  v_cvt_pk_bf16_f32 v40, v80, v81
  v_mfma_f32_16x16x32_bf16 a[192:195], a[208:211], v[48:51], a[192:195]
  buffer_load_dwordx4 v2, s[20:23], s29 offen offset:0 sc1 lds
  v_mfma_f32_16x16x32_bf16 v[132:135], a[4:7], v[48:51], v[132:135]
  v_exp_f32 v84, v84
  v_mfma_f32_16x16x32_bf16 v[164:167], a[4:7], v[52:55], v[164:167]
  ds_read_b128 a[48:51], v3 offset:4096
  v_cvt_pk_bf16_f32 v41, v82, v83
  v_mfma_f32_16x16x32_bf16 v[196:199], a[4:7], v[56:59], v[196:199]
  v_exp_f32 v85, v85
  v_mfma_f32_16x16x32_bf16 v[228:231], a[4:7], v[60:63], v[228:231]
  v_cvt_pk_bf16_f32 v42, v84, v85
  v_mfma_f32_16x16x32_bf16 a[196:199], a[208:211], v[52:55], a[196:199]
  v_exp_f32 v86, v86
  v_mfma_f32_16x16x32_bf16 v[136:139], a[8:11], v[48:51], v[136:139]
  ds_read_b128 a[52:55], v3 offset:5120
  v_mfma_f32_16x16x32_bf16 v[168:171], a[8:11], v[52:55], v[168:171]
  buffer_load_dwordx4 v2, s[20:23], s29 offen offset:1024 sc1 lds
  v_mfma_f32_16x16x32_bf16 v[200:203], a[8:11], v[56:59], v[200:203]
  v_exp_f32 v87, v87
  v_mfma_f32_16x16x32_bf16 v[232:235], a[8:11], v[60:63], v[232:235]
  v_cvt_pk_bf16_f32 v43, v86, v87
  v_mfma_f32_16x16x32_bf16 a[200:203], a[208:211], v[56:59], a[200:203]
  v_exp_f32 v88, v88
  v_mfma_f32_16x16x32_bf16 v[140:143], a[12:15], v[48:51], v[140:143]
  ds_read_b128 a[56:59], v3 offset:6144
  v_mfma_f32_16x16x32_bf16 v[172:175], a[12:15], v[52:55], v[172:175]
  v_mfma_f32_16x16x32_bf16 v[204:207], a[12:15], v[56:59], v[204:207]
  v_exp_f32 v89, v89
  v_mfma_f32_16x16x32_bf16 v[236:239], a[12:15], v[60:63], v[236:239]
  buffer_load_dwordx4 v2, s[20:23], s29 offen offset:2048 sc1 lds
  v_mfma_f32_16x16x32_bf16 a[204:207], a[208:211], v[60:63], a[204:207]
  s_waitcnt lgkmcnt(7)
  v_exp_f32 v90, v90
  v_mfma_f32_16x16x32_bf16 v[144:147], a[16:19], v[48:51], v[144:147]
  ds_read_b128 a[60:63], v3 offset:7168
  v_cvt_pk_bf16_f32 v44, v88, v89
  v_mfma_f32_16x16x32_bf16 v[176:179], a[16:19], v[52:55], v[176:179]
  v_exp_f32 v91, v91
  v_mfma_f32_16x16x32_bf16 v[208:211], a[16:19], v[56:59], v[208:211]
  v_cvt_pk_bf16_f32 v45, v90, v91
  v_mfma_f32_16x16x32_bf16 v[240:243], a[16:19], v[60:63], v[240:243]
  v_mfma_f32_16x16x32_bf16 v[148:151], a[20:23], v[48:51], v[148:151]
  v_exp_f32 v92, v92
  v_mfma_f32_16x16x32_bf16 v[180:183], a[20:23], v[52:55], v[180:183]
  buffer_load_dwordx4 v2, s[20:23], s29 offen offset:3072 sc1 lds
  v_mfma_f32_16x16x32_bf16 v[212:215], a[20:23], v[56:59], v[212:215]
  s_xor_b32 s27, s27, 0x8000
  v_exp_f32 v93, v93
  v_mfma_f32_16x16x32_bf16 v[244:247], a[20:23], v[60:63], v[244:247]
  s_add_u32 s29, s29, 0x8000
  ds_read_b128 a[0:3], v3 offset:8192
  v_cvt_pk_bf16_f32 v46, v92, v93
  v_mfma_f32_16x16x32_bf16 v[152:155], a[24:27], v[48:51], v[152:155]
  ds_read_b128 a[4:7], v3 offset:9216
  v_mfma_f32_16x16x32_bf16 v[184:187], a[24:27], v[52:55], v[184:187]
  v_exp_f32 v94, v94
  v_mfma_f32_16x16x32_bf16 v[216:219], a[24:27], v[56:59], v[216:219]
  v_mfma_f32_16x16x32_bf16 v[248:251], a[24:27], v[60:63], v[248:251]
  v_exp_f32 v95, v95
  v_mfma_f32_16x16x32_bf16 v[156:159], a[28:31], v[48:51], v[156:159]
  ds_read_b128 a[8:11], v3 offset:10240
  v_cvt_pk_bf16_f32 v47, v94, v95
  v_mfma_f32_16x16x32_bf16 v[188:191], a[28:31], v[52:55], v[188:191]
  v_mfma_f32_16x16x32_bf16 v[220:223], a[28:31], v[56:59], v[220:223]
  s_waitcnt vmcnt(22)
  s_barrier
  v_mfma_f32_16x16x32_bf16 v[252:255], a[28:31], v[60:63], v[252:255]
  s_lshr_b32 s91, s73, 1
  s_lshl_b32 s91, s91, 11
  s_add_u32 s91, s91, 32768
  v_and_b32 v14, 15, v1
  v_lshlrev_b32 v14, 7, v14
  s_waitcnt lgkmcnt(3)
  v_mfma_f32_16x16x32_bf16 v[64:67], a[32:35], a[160:163], v[24:27]
  s_mov_b32 m0, s26
  ds_read_b128 a[12:15], v3 offset:11264
  v_cndmask_b32 v104, v104, v5, s[48:49]
  v_mfma_f32_16x16x32_bf16 v[64:67], a[36:39], a[164:167], v[64:67]
  v_exp_f32 v104, v104
  v_mfma_f32_16x16x32_bf16 v[64:67], a[40:43], a[168:171], v[64:67]
  v_cndmask_b32 v105, v105, v5, s[50:51]
  v_exp_f32 v105, v105
  v_mfma_f32_16x16x32_bf16 v[64:67], a[44:47], a[172:175], v[64:67]
  buffer_load_dwordx4 v2, s[20:23], s28 offen offset:0 sc1 lds
  v_mfma_f32_16x16x32_bf16 v[72:75], a[32:35], a[176:179], v[28:31]
  v_cndmask_b32 v106, v106, v5, s[52:53]
  v_exp_f32 v106, v106
  v_mfma_f32_16x16x32_bf16 v[72:75], a[36:39], a[180:183], v[72:75]
  ds_read_b128 a[16:19], v3 offset:12288
  ds_read_b128 a[20:23], v3 offset:13312
  v_mfma_f32_16x16x32_bf16 v[72:75], a[40:43], a[184:187], v[72:75]
  buffer_load_dwordx4 v2, s[20:23], s28 offen offset:1024 sc1 lds
  v_mfma_f32_16x16x32_bf16 v[72:75], a[44:47], a[188:191], v[72:75]
  v_cndmask_b32 v107, v107, v5, s[54:55]
  v_exp_f32 v107, v107
  v_mfma_f32_16x16x32_bf16 v[68:71], a[48:51], a[160:163], v[24:27]
  ds_read_b128 a[24:27], v3 offset:14336
  ds_read_b128 a[28:31], v3 offset:15360
  v_mfma_f32_16x16x32_bf16 v[68:71], a[52:55], a[164:167], v[68:71]
  v_cndmask_b32 v108, v108, v5, s[56:57]
  v_exp_f32 v108, v108
  v_mfma_f32_16x16x32_bf16 v[68:71], a[56:59], a[168:171], v[68:71]
  ds_read_b128 a[32:35], v4 offset:0
  v_cndmask_b32 v109, v109, v5, s[58:59]
  v_mfma_f32_16x16x32_bf16 v[68:71], a[60:63], a[172:175], v[68:71]
  v_exp_f32 v109, v109
  v_mfma_f32_16x16x32_bf16 v[76:79], a[48:51], a[176:179], v[28:31]
  ds_read_b128 a[36:39], v4 offset:1024
  v_cndmask_b32 v110, v110, v5, s[60:61]
  v_mfma_f32_16x16x32_bf16 v[76:79], a[52:55], a[180:183], v[76:79]
  buffer_load_dwordx4 v2, s[20:23], s28 offen offset:2048 sc1 lds
  v_mfma_f32_16x16x32_bf16 v[76:79], a[56:59], a[184:187], v[76:79]
  v_exp_f32 v110, v110
  v_mfma_f32_16x16x32_bf16 v[76:79], a[60:63], a[188:191], v[76:79]
  s_waitcnt lgkmcnt(2)
  ds_read_b128 a[40:43], v4 offset:2048
  v_cndmask_b32 v111, v111, v5, s[62:63]
  v_mfma_f32_16x16x32_bf16 v[80:83], a[0:3], a[160:163], v[24:27]
  v_exp_f32 v111, v111
  v_mfma_f32_16x16x32_bf16 v[80:83], a[4:7], a[164:167], v[80:83]
  ds_read_b128 a[44:47], v4 offset:3072
  v_cvt_pk_bf16_f32 v52, v104, v105
  v_mfma_f32_16x16x32_bf16 v[80:83], a[8:11], a[168:171], v[80:83]
  ds_read_b128 a[48:51], v4 offset:4096
  v_cvt_pk_bf16_f32 v53, v106, v107
  v_mfma_f32_16x16x32_bf16 v[80:83], a[12:15], a[172:175], v[80:83]
  v_exp_f32 v112, v112
  v_mfma_f32_16x16x32_bf16 v[88:91], a[0:3], a[176:179], v[28:31]
  buffer_load_dwordx4 v2, s[20:23], s28 offen offset:3072 sc1 lds
  v_mfma_f32_16x16x32_bf16 v[88:91], a[4:7], a[180:183], v[88:91]
  s_xor_b32 s26, s26, 0x8000
  v_exp_f32 v113, v113
  v_mfma_f32_16x16x32_bf16 v[88:91], a[8:11], a[184:187], v[88:91]
  s_add_u32 s28, s28, 0x8000
  s_mov_b32 m0, s27
  ds_read_b128 a[52:55], v4 offset:5120
  v_mfma_f32_16x16x32_bf16 v[88:91], a[12:15], a[188:191], v[88:91]
  v_exp_f32 v114, v114
  v_mfma_f32_16x16x32_bf16 v[84:87], a[16:19], a[160:163], v[24:27]
  ds_read_b128 a[56:59], v4 offset:6144
  ds_read_b128 a[60:63], v4 offset:7168
  v_mfma_f32_16x16x32_bf16 v[84:87], a[20:23], a[164:167], v[84:87]
  v_xor_b32 v3, 0x4000, v3
  v_cvt_pk_bf16_f32 v54, v108, v109
  v_mfma_f32_16x16x32_bf16 v[84:87], a[24:27], a[168:171], v[84:87]
  v_exp_f32 v115, v115
  v_mfma_f32_16x16x32_bf16 v[84:87], a[28:31], a[172:175], v[84:87]
  buffer_load_dwordx4 v2, s[20:23], s29 offen offset:0 sc1 lds
  v_mfma_f32_16x16x32_bf16 v[92:95], a[16:19], a[176:179], v[28:31]
  v_exp_f32 v116, v116
  v_mfma_f32_16x16x32_bf16 v[92:95], a[20:23], a[180:183], v[92:95]
  ds_read_b128 a[0:3], v3 offset:0
  ds_read_b128 a[4:7], v3 offset:1024
  v_mfma_f32_16x16x32_bf16 v[92:95], a[24:27], a[184:187], v[92:95]
  v_exp_f32 v117, v117
  v_mfma_f32_16x16x32_bf16 v[92:95], a[28:31], a[188:191], v[92:95]
  s_waitcnt lgkmcnt(6)
  ds_read_b128 a[8:11], v3 offset:2048
  v_cvt_pk_bf16_f32 v55, v110, v111
  v_mfma_f32_16x16x32_bf16 v[160:163], a[32:35], v[36:39], v[160:163]
  ds_read_b128 a[12:15], v3 offset:3072
  v_cvt_pk_bf16_f32 v56, v112, v113
  v_mfma_f32_16x16x32_bf16 v[192:195], a[32:35], v[40:43], v[192:195]
  v_exp_f32 v118, v118
  v_mfma_f32_16x16x32_bf16 v[224:227], a[32:35], v[44:47], v[224:227]
  buffer_load_dwordx4 v2, s[20:23], s29 offen offset:1024 sc1 lds
  v_mfma_f32_16x16x32_bf16 a[196:199], a[208:211], v[36:39], a[196:199]
  v_exp_f32 v119, v119
  v_mfma_f32_16x16x32_bf16 v[164:167], a[36:39], v[36:39], v[164:167]
  ds_read_b128 a[16:19], v3 offset:4096
  v_cvt_pk_bf16_f32 v57, v114, v115
  v_mfma_f32_16x16x32_bf16 v[196:199], a[36:39], v[40:43], v[196:199]
  v_cvt_pk_bf16_f32 v58, v116, v117
  v_cvt_pk_bf16_f32 v59, v118, v119
  v_mfma_f32_16x16x32_bf16 v[228:231], a[36:39], v[44:47], v[228:231]
  v_exp_f32 v120, v120
  v_mfma_f32_16x16x32_bf16 a[200:203], a[208:211], v[40:43], a[200:203]
  v_mfma_f32_16x16x32_bf16 v[168:171], a[40:43], v[36:39], v[168:171]
  v_exp_f32 v121, v121
  v_mfma_f32_16x16x32_bf16 v[200:203], a[40:43], v[40:43], v[200:203]
  buffer_load_dwordx4 v2, s[20:23], s29 offen offset:2048 sc1 lds
  v_mfma_f32_16x16x32_bf16 v[232:235], a[40:43], v[44:47], v[232:235]
  v_exp_f32 v122, v122
  v_mfma_f32_16x16x32_bf16 a[204:207], a[208:211], v[44:47], a[204:207]
  ds_read_b128 a[20:23], v3 offset:5120
  v_cvt_pk_bf16_f32 v60, v120, v121
  v_mfma_f32_16x16x32_bf16 v[172:175], a[44:47], v[36:39], v[172:175]
  ds_read_b128 a[24:27], v3 offset:6144
  v_mfma_f32_16x16x32_bf16 v[204:207], a[44:47], v[40:43], v[204:207]
  v_exp_f32 v123, v123
  v_mfma_f32_16x16x32_bf16 v[236:239], a[44:47], v[44:47], v[236:239]
  s_waitcnt lgkmcnt(7)
  v_cvt_pk_bf16_f32 v61, v122, v123
  v_mfma_f32_16x16x32_bf16 v[176:179], a[48:51], v[36:39], v[176:179]
  v_exp_f32 v124, v124
  v_mfma_f32_16x16x32_bf16 v[208:211], a[48:51], v[40:43], v[208:211]
  buffer_load_dwordx4 v2, s[20:23], s29 offen offset:3072 sc1 lds
  v_mfma_f32_16x16x32_bf16 v[240:243], a[48:51], v[44:47], v[240:243]
  s_xor_b32 s27, s27, 0x4000
  v_exp_f32 v125, v125
  v_mfma_f32_16x16x32_bf16 v[180:183], a[52:55], v[36:39], v[180:183]
  s_add_u32 s29, s29, 0x8000
  ds_read_b128 a[28:31], v3 offset:7168
  ds_read_b128 a[32:35], v3 offset:8192
  v_mfma_f32_16x16x32_bf16 v[212:215], a[52:55], v[40:43], v[212:215]
  v_cvt_pk_bf16_f32 v62, v124, v125
  v_mfma_f32_16x16x32_bf16 v[244:247], a[52:55], v[44:47], v[244:247]
  v_exp_f32 v126, v126
  v_mfma_f32_16x16x32_bf16 v[184:187], a[56:59], v[36:39], v[184:187]
  ds_read_b128 a[36:39], v3 offset:9216
  v_mfma_f32_16x16x32_bf16 v[216:219], a[56:59], v[40:43], v[216:219]
  v_exp_f32 v127, v127
  v_mfma_f32_16x16x32_bf16 v[248:251], a[56:59], v[44:47], v[248:251]
  v_cvt_pk_bf16_f32 v63, v126, v127
  v_mfma_f32_16x16x32_bf16 v[188:191], a[60:63], v[36:39], v[188:191]
  ds_read_b128 a[40:43], v3 offset:10240
  v_mfma_f32_16x16x32_bf16 v[220:223], a[60:63], v[40:43], v[220:223]
  s_waitcnt vmcnt(12)
  s_barrier
  v_mfma_f32_16x16x32_bf16 v[252:255], a[60:63], v[44:47], v[252:255]
  s_waitcnt lgkmcnt(3)
  v_mfma_f32_16x16x32_bf16 v[96:99], a[0:3], a[160:163], v[24:27]
  s_mov_b32 m0, s26
  v_exp_f32 v64, v64
  v_mfma_f32_16x16x32_bf16 v[96:99], a[4:7], a[164:167], v[96:99]
  v_exp_f32 v65, v65
  v_mfma_f32_16x16x32_bf16 v[96:99], a[8:11], a[168:171], v[96:99]
  buffer_load_dwordx4 v2, s[20:23], s28 offen offset:0 sc1 lds
  v_mfma_f32_16x16x32_bf16 v[96:99], a[12:15], a[172:175], v[96:99]
  v_exp_f32 v66, v66
  v_mfma_f32_16x16x32_bf16 v[104:107], a[0:3], a[176:179], v[28:31]
  ds_read_b128 a[44:47], v3 offset:11264
  ds_read_b128 a[48:51], v3 offset:12288
  v_mfma_f32_16x16x32_bf16 v[104:107], a[4:7], a[180:183], v[104:107]
  v_exp_f32 v67, v67
  v_mfma_f32_16x16x32_bf16 v[104:107], a[8:11], a[184:187], v[104:107]
  ds_read_b128 a[52:55], v3 offset:13312
  ds_read_b128 a[56:59], v3 offset:14336
  v_mfma_f32_16x16x32_bf16 v[104:107], a[12:15], a[188:191], v[104:107]
  v_exp_f32 v68, v68
  v_mfma_f32_16x16x32_bf16 v[100:103], a[16:19], a[160:163], v[24:27]
  v_exp_f32 v69, v69
  v_mfma_f32_16x16x32_bf16 v[100:103], a[20:23], a[164:167], v[100:103]
  ds_read_b128 a[60:63], v3 offset:15360
  v_cvt_pk_bf16_f32 v32, v64, v65
  v_mfma_f32_16x16x32_bf16 v[100:103], a[24:27], a[168:171], v[100:103]
  v_exp_f32 v70, v70
  v_mfma_f32_16x16x32_bf16 v[100:103], a[28:31], a[172:175], v[100:103]
  ds_read_b128 a[0:3], v4 offset:8192
  v_cvt_pk_bf16_f32 v33, v66, v67
  v_mfma_f32_16x16x32_bf16 v[108:111], a[16:19], a[176:179], v[28:31]
  v_exp_f32 v71, v71
  v_mfma_f32_16x16x32_bf16 v[108:111], a[20:23], a[180:183], v[108:111]
  buffer_load_dwordx4 v2, s[20:23], s28 offen offset:1024 sc1 lds
  v_mfma_f32_16x16x32_bf16 v[108:111], a[24:27], a[184:187], v[108:111]
  v_exp_f32 v72, v72
  v_mfma_f32_16x16x32_bf16 v[108:111], a[28:31], a[188:191], v[108:111]
  s_waitcnt lgkmcnt(1)
  ds_read_b128 a[4:7], v4 offset:9216
  ds_read_b128 a[8:11], v4 offset:10240
  v_mfma_f32_16x16x32_bf16 v[112:115], a[32:35], a[160:163], v[24:27]
  v_exp_f32 v73, v73
  v_mfma_f32_16x16x32_bf16 v[112:115], a[36:39], a[164:167], v[112:115]
  v_exp_f32 v74, v74
  v_mfma_f32_16x16x32_bf16 v[112:115], a[40:43], a[168:171], v[112:115]
  ds_read_b128 a[12:15], v4 offset:11264
  ds_read_b128 a[16:19], v4 offset:12288
  v_mfma_f32_16x16x32_bf16 v[112:115], a[44:47], a[172:175], v[112:115]
  v_exp_f32 v75, v75
  v_mfma_f32_16x16x32_bf16 v[120:123], a[32:35], a[176:179], v[28:31]
  ds_read_b128 a[20:23], v4 offset:13312
  v_cvt_pk_bf16_f32 v34, v68, v69
  v_mfma_f32_16x16x32_bf16 v[120:123], a[36:39], a[180:183], v[120:123]
  v_exp_f32 v76, v76
  v_mfma_f32_16x16x32_bf16 v[120:123], a[40:43], a[184:187], v[120:123]
  ds_read_b128 a[24:27], v4 offset:14336
  v_cvt_pk_bf16_f32 v35, v70, v71
  v_mfma_f32_16x16x32_bf16 v[120:123], a[44:47], a[188:191], v[120:123]
  v_exp_f32 v77, v77
  v_mfma_f32_16x16x32_bf16 v[116:119], a[48:51], a[160:163], v[24:27]
  v_exp_f32 v78, v78
  v_mfma_f32_16x16x32_bf16 v[116:119], a[52:55], a[164:167], v[116:119]
  ds_read_b128 a[28:31], v4 offset:15360
  v_xor_b32 v4, 0x8000, v4
  v_mfma_f32_16x16x32_bf16 v[116:119], a[56:59], a[168:171], v[116:119]
  v_exp_f32 v79, v79
  v_mfma_f32_16x16x32_bf16 v[116:119], a[60:63], a[172:175], v[116:119]
  buffer_load_dwordx4 v2, s[20:23], s28 offen offset:2048 sc1 lds
  v_mfma_f32_16x16x32_bf16 v[124:127], a[48:51], a[176:179], v[28:31]
  v_exp_f32 v80, v80
  v_mfma_f32_16x16x32_bf16 v[124:127], a[52:55], a[180:183], v[124:127]
  v_xor_b32 v3, 0x8000, v3
  v_cvt_pk_bf16_f32 v36, v72, v73
  v_mfma_f32_16x16x32_bf16 v[124:127], a[56:59], a[184:187], v[124:127]
  v_exp_f32 v81, v81
  v_mfma_f32_16x16x32_bf16 v[124:127], a[60:63], a[188:191], v[124:127]
  s_waitcnt lgkmcnt(4)
  ds_read_b128 a[32:35], v3 offset:0
  ds_read_b128 a[36:39], v3 offset:1024
  v_mfma_f32_16x16x32_bf16 v[160:163], a[0:3], v[52:55], v[160:163]
  v_exp_f32 v82, v82
  v_mfma_f32_16x16x32_bf16 v[192:195], a[0:3], v[56:59], v[192:195]
  v_exp_f32 v83, v83
  v_mfma_f32_16x16x32_bf16 v[224:227], a[0:3], v[60:63], v[224:227]
  ds_read_b128 a[40:43], v3 offset:2048
  ds_read_b128 a[44:47], v3 offset:3072
  v_mfma_f32_16x16x32_bf16 a[196:199], a[208:211], v[52:55], a[196:199]
  v_exp_f32 v84, v84
  v_mfma_f32_16x16x32_bf16 v[164:167], a[4:7], v[52:55], v[164:167]
  ds_read_b128 a[48:51], v3 offset:4096
  v_cvt_pk_bf16_f32 v37, v74, v75
  v_mfma_f32_16x16x32_bf16 v[196:199], a[4:7], v[56:59], v[196:199]
  v_exp_f32 v85, v85
  v_mfma_f32_16x16x32_bf16 v[228:231], a[4:7], v[60:63], v[228:231]
  v_cvt_pk_bf16_f32 v38, v76, v77
  v_cvt_pk_bf16_f32 v39, v78, v79
  v_mfma_f32_16x16x32_bf16 a[200:203], a[208:211], v[56:59], a[200:203]
  v_exp_f32 v86, v86
  v_mfma_f32_16x16x32_bf16 v[168:171], a[8:11], v[52:55], v[168:171]
  v_exp_f32 v87, v87
  v_mfma_f32_16x16x32_bf16 v[200:203], a[8:11], v[56:59], v[200:203]
  buffer_load_dwordx4 v2, s[20:23], s28 offen offset:3072 sc1 lds
  v_mfma_f32_16x16x32_bf16 v[232:235], a[8:11], v[60:63], v[232:235]
  s_xor_b32 s26, s26, 0x4000
  v_exp_f32 v88, v88
  v_mfma_f32_16x16x32_bf16 a[204:207], a[208:211], v[60:63], a[204:207]
  s_add_u32 s28, s28, 0x8000
  ds_read_b128 a[52:55], v3 offset:5120
  v_cvt_pk_bf16_f32 v40, v80, v81
  v_mfma_f32_16x16x32_bf16 v[172:175], a[12:15], v[52:55], v[172:175]
  v_exp_f32 v89, v89
  v_mfma_f32_16x16x32_bf16 v[204:207], a[12:15], v[56:59], v[204:207]
  ds_read_b128 a[56:59], v3 offset:6144
  v_cvt_pk_bf16_f32 v41, v82, v83
  v_mfma_f32_16x16x32_bf16 v[236:239], a[12:15], v[60:63], v[236:239]
  s_waitcnt lgkmcnt(7)
  v_exp_f32 v90, v90
  v_mfma_f32_16x16x32_bf16 v[176:179], a[16:19], v[52:55], v[176:179]
  ds_read_b128 a[60:63], v3 offset:7168
  v_cvt_pk_bf16_f32 v42, v84, v85
  v_mfma_f32_16x16x32_bf16 v[208:211], a[16:19], v[56:59], v[208:211]
  v_exp_f32 v91, v91
  v_mfma_f32_16x16x32_bf16 v[240:243], a[16:19], v[60:63], v[240:243]
  v_exp_f32 v92, v92
  v_mfma_f32_16x16x32_bf16 v[180:183], a[20:23], v[52:55], v[180:183]
  ds_read_b128 a[0:3], v3 offset:8192
  v_cvt_pk_bf16_f32 v43, v86, v87
  v_mfma_f32_16x16x32_bf16 v[212:215], a[20:23], v[56:59], v[212:215]
  v_exp_f32 v93, v93
  v_mfma_f32_16x16x32_bf16 v[244:247], a[20:23], v[60:63], v[244:247]
  v_cvt_pk_bf16_f32 v44, v88, v89
  v_cvt_pk_bf16_f32 v45, v90, v91
  v_mfma_f32_16x16x32_bf16 v[184:187], a[24:27], v[52:55], v[184:187]
  v_exp_f32 v94, v94
  v_mfma_f32_16x16x32_bf16 v[216:219], a[24:27], v[56:59], v[216:219]
  ds_read_b128 a[4:7], v3 offset:9216
  v_cvt_pk_bf16_f32 v46, v92, v93
  v_mfma_f32_16x16x32_bf16 v[248:251], a[24:27], v[60:63], v[248:251]
  v_exp_f32 v95, v95
  v_mfma_f32_16x16x32_bf16 v[188:191], a[28:31], v[52:55], v[188:191]
  ds_read_b128 a[8:11], v3 offset:10240
  v_cvt_pk_bf16_f32 v47, v94, v95
  v_mfma_f32_16x16x32_bf16 v[220:223], a[28:31], v[56:59], v[220:223]
  s_waitcnt vmcnt(8)
  s_barrier
  v_mfma_f32_16x16x32_bf16 v[252:255], a[28:31], v[60:63], v[252:255]
  s_lshl_b32 s4, s25, 20
  s_lshl_b32 s5, s24, 15
  s_add_u32 s4, s4, s5
  s_lshl_b32 s5, s3, 11
  s_add_u32 s4, s4, s5
  v_accvgpr_read_b32 v6, a192
  v_accvgpr_read_b32 v8, a196
  s_mov_b32 s5, 0x5f800000
  v_cmp_ngt_f32 vcc, s5, v6
  v_rcp_f32 v6, v6
  s_or_b32 s89, s89, vcc_lo
  s_or_b32 s89, s89, vcc_hi
  v_mov_b32 v7, v6
  v_cmp_ngt_f32 vcc, s5, v8
  v_rcp_f32 v8, v8
  s_or_b32 s89, s89, vcc_lo
  s_or_b32 s89, s89, vcc_hi
  v_mov_b32 v9, v8
  v_pk_mul_f32 v[128:129], v[128:129], v[6:7]
  v_pk_mul_f32 v[130:131], v[130:131], v[6:7]
  v_pk_mul_f32 v[132:133], v[132:133], v[6:7]
  v_pk_mul_f32 v[134:135], v[134:135], v[6:7]
  v_cvt_pk_bf16_f32 v128, v128, v129
  v_cvt_pk_bf16_f32 v129, v130, v131
  v_cvt_pk_bf16_f32 v130, v132, v133
  v_cvt_pk_bf16_f32 v131, v134, v135
  buffer_store_dwordx4 v[128:131], v2, s[16:19], s4 offen offset:0 sc1
  v_pk_mul_f32 v[160:161], v[160:161], v[8:9]
  v_pk_mul_f32 v[162:163], v[162:163], v[8:9]
  v_pk_mul_f32 v[164:165], v[164:165], v[8:9]
  v_pk_mul_f32 v[166:167], v[166:167], v[8:9]
  v_cvt_pk_bf16_f32 v160, v160, v161
  v_cvt_pk_bf16_f32 v161, v162, v163
  v_cvt_pk_bf16_f32 v162, v164, v165
  v_cvt_pk_bf16_f32 v163, v166, v167
  buffer_store_dwordx4 v[160:163], v2, s[16:19], s4 offen offset:1024 sc1
  s_add_u32 s4, s4, 8192
  v_pk_mul_f32 v[136:137], v[136:137], v[6:7]
  v_pk_mul_f32 v[138:139], v[138:139], v[6:7]
  v_pk_mul_f32 v[140:141], v[140:141], v[6:7]
  v_pk_mul_f32 v[142:143], v[142:143], v[6:7]
  v_cvt_pk_bf16_f32 v136, v136, v137
  v_cvt_pk_bf16_f32 v137, v138, v139
  v_cvt_pk_bf16_f32 v138, v140, v141
  v_cvt_pk_bf16_f32 v139, v142, v143
  buffer_store_dwordx4 v[136:139], v2, s[16:19], s4 offen offset:0 sc1
  v_pk_mul_f32 v[168:169], v[168:169], v[8:9]
  v_pk_mul_f32 v[170:171], v[170:171], v[8:9]
  v_pk_mul_f32 v[172:173], v[172:173], v[8:9]
  v_pk_mul_f32 v[174:175], v[174:175], v[8:9]
  v_cvt_pk_bf16_f32 v168, v168, v169
  v_cvt_pk_bf16_f32 v169, v170, v171
  v_cvt_pk_bf16_f32 v170, v172, v173
  v_cvt_pk_bf16_f32 v171, v174, v175
  buffer_store_dwordx4 v[168:171], v2, s[16:19], s4 offen offset:1024 sc1
  s_add_u32 s4, s4, 8192
  v_pk_mul_f32 v[144:145], v[144:145], v[6:7]
  v_pk_mul_f32 v[146:147], v[146:147], v[6:7]
  v_pk_mul_f32 v[148:149], v[148:149], v[6:7]
  v_pk_mul_f32 v[150:151], v[150:151], v[6:7]
  v_cvt_pk_bf16_f32 v144, v144, v145
  v_cvt_pk_bf16_f32 v145, v146, v147
  v_cvt_pk_bf16_f32 v146, v148, v149
  v_cvt_pk_bf16_f32 v147, v150, v151
  buffer_store_dwordx4 v[144:147], v2, s[16:19], s4 offen offset:0 sc1
  v_pk_mul_f32 v[176:177], v[176:177], v[8:9]
  v_pk_mul_f32 v[178:179], v[178:179], v[8:9]
  v_pk_mul_f32 v[180:181], v[180:181], v[8:9]
  v_pk_mul_f32 v[182:183], v[182:183], v[8:9]
  v_cvt_pk_bf16_f32 v176, v176, v177
  v_cvt_pk_bf16_f32 v177, v178, v179
  v_cvt_pk_bf16_f32 v178, v180, v181
  v_cvt_pk_bf16_f32 v179, v182, v183
  buffer_store_dwordx4 v[176:179], v2, s[16:19], s4 offen offset:1024 sc1
  s_add_u32 s4, s4, 8192
  v_pk_mul_f32 v[152:153], v[152:153], v[6:7]
  v_pk_mul_f32 v[154:155], v[154:155], v[6:7]
  v_pk_mul_f32 v[156:157], v[156:157], v[6:7]
  v_pk_mul_f32 v[158:159], v[158:159], v[6:7]
  v_cvt_pk_bf16_f32 v152, v152, v153
  v_cvt_pk_bf16_f32 v153, v154, v155
  v_cvt_pk_bf16_f32 v154, v156, v157
  v_cvt_pk_bf16_f32 v155, v158, v159
  buffer_store_dwordx4 v[152:155], v2, s[16:19], s4 offen offset:0 sc1
  v_pk_mul_f32 v[184:185], v[184:185], v[8:9]
  v_pk_mul_f32 v[186:187], v[186:187], v[8:9]
  v_pk_mul_f32 v[188:189], v[188:189], v[8:9]
  v_pk_mul_f32 v[190:191], v[190:191], v[8:9]
  v_cvt_pk_bf16_f32 v184, v184, v185
  v_cvt_pk_bf16_f32 v185, v186, v187
  v_cvt_pk_bf16_f32 v186, v188, v189
  v_cvt_pk_bf16_f32 v187, v190, v191
  buffer_store_dwordx4 v[184:187], v2, s[16:19], s4 offen offset:1024 sc1
  s_and_b32 s88, s25, 1
  s_lshl_b32 s88, s88, 1
  s_add_u32 s88, s88, 14
  s_sub_u32 s88, s88, s25
  s_sub_u32 s88, s88, s25
  s_sub_u32 s88, s88, 1
  .p2align 6
La_so:
  s_waitcnt lgkmcnt(3)
  v_mfma_f32_16x16x32_bf16 v[64:67], a[32:35], a[160:163], v[24:27]
  v_exp_f32 v96, v96
  v_mfma_f32_16x16x32_bf16 v[64:67], a[36:39], a[164:167], v[64:67]
  buffer_store_dwordx4 a[244:247], v2, s[64:67], s90 offen offset:0 sc1
  v_mfma_f32_16x16x32_bf16 v[64:67], a[40:43], a[168:171], v[64:67]
  v_exp_f32 v97, v97
  v_mfma_f32_16x16x32_bf16 v[64:67], a[44:47], a[172:175], v[64:67]
  ds_read_b128 a[12:15], v3 offset:11264
  ds_read_b128 a[16:19], v3 offset:12288
  v_mfma_f32_16x16x32_bf16 v[72:75], a[32:35], a[176:179], v[28:31]
  v_exp_f32 v98, v98
  v_mfma_f32_16x16x32_bf16 v[72:75], a[36:39], a[180:183], v[72:75]
  ds_read_b128 a[20:23], v3 offset:13312
  v_cvt_pk_bf16_f32 v48, v96, v97
  v_mfma_f32_16x16x32_bf16 v[72:75], a[40:43], a[184:187], v[72:75]
  v_exp_f32 v99, v99
  v_mfma_f32_16x16x32_bf16 v[72:75], a[44:47], a[188:191], v[72:75]
  buffer_store_dwordx4 a[244:247], v2, s[64:67], s90 offen offset:1024 sc1
  v_mfma_f32_16x16x32_bf16 v[68:71], a[48:51], a[160:163], v[24:27]
  s_add_u32 s90, s90, 2048
  v_exp_f32 v100, v100
  v_mfma_f32_16x16x32_bf16 v[68:71], a[52:55], a[164:167], v[68:71]
  s_mov_b32 m0, s26
  ds_read_b128 a[24:27], v3 offset:14336
  ds_read_b128 a[28:31], v3 offset:15360
  v_mfma_f32_16x16x32_bf16 v[68:71], a[56:59], a[168:171], v[68:71]
  v_exp_f32 v101, v101
  v_mfma_f32_16x16x32_bf16 v[68:71], a[60:63], a[172:175], v[68:71]
  ds_read_b128 a[32:35], v4 offset:0
  v_cvt_pk_bf16_f32 v49, v98, v99
  v_mfma_f32_16x16x32_bf16 v[76:79], a[48:51], a[176:179], v[28:31]
  v_exp_f32 v102, v102
  v_mfma_f32_16x16x32_bf16 v[76:79], a[52:55], a[180:183], v[76:79]
  buffer_load_dwordx4 v2, s[20:23], s28 offen offset:0 sc1 lds
  v_mfma_f32_16x16x32_bf16 v[76:79], a[56:59], a[184:187], v[76:79]
  v_exp_f32 v103, v103
  v_mfma_f32_16x16x32_bf16 v[76:79], a[60:63], a[188:191], v[76:79]
  s_waitcnt lgkmcnt(1)
  ds_read_b128 a[36:39], v4 offset:1024
  ds_read_b128 a[40:43], v4 offset:2048
  v_mfma_f32_16x16x32_bf16 v[80:83], a[0:3], a[160:163], v[24:27]
  v_exp_f32 v104, v104
  v_mfma_f32_16x16x32_bf16 v[80:83], a[4:7], a[164:167], v[80:83]
  ds_read_b128 a[44:47], v4 offset:3072
  v_cvt_pk_bf16_f32 v50, v100, v101
  v_mfma_f32_16x16x32_bf16 v[80:83], a[8:11], a[168:171], v[80:83]
  v_exp_f32 v105, v105
  v_mfma_f32_16x16x32_bf16 v[80:83], a[12:15], a[172:175], v[80:83]
  buffer_load_dwordx4 v2, s[20:23], s28 offen offset:1024 sc1 lds
  v_mfma_f32_16x16x32_bf16 v[88:91], a[0:3], a[176:179], v[28:31]
  v_exp_f32 v106, v106
  v_mfma_f32_16x16x32_bf16 v[88:91], a[4:7], a[180:183], v[88:91]
  ds_read_b128 a[48:51], v4 offset:4096
  ds_read_b128 a[52:55], v4 offset:5120
  v_mfma_f32_16x16x32_bf16 v[88:91], a[8:11], a[184:187], v[88:91]
  v_exp_f32 v107, v107
  v_mfma_f32_16x16x32_bf16 v[88:91], a[12:15], a[188:191], v[88:91]
  ds_read_b128 a[56:59], v4 offset:6144
  v_cvt_pk_bf16_f32 v51, v102, v103
  v_mfma_f32_16x16x32_bf16 v[84:87], a[16:19], a[160:163], v[24:27]
  v_exp_f32 v108, v108
  v_mfma_f32_16x16x32_bf16 v[84:87], a[20:23], a[164:167], v[84:87]
  buffer_load_dwordx4 v2, s[20:23], s28 offen offset:2048 sc1 lds
  v_mfma_f32_16x16x32_bf16 v[84:87], a[24:27], a[168:171], v[84:87]
  v_exp_f32 v109, v109
  v_mfma_f32_16x16x32_bf16 v[84:87], a[28:31], a[172:175], v[84:87]
  ds_read_b128 a[60:63], v4 offset:7168
  ds_read_b128 a[0:3], v4 offset:8192
  v_mfma_f32_16x16x32_bf16 v[92:95], a[16:19], a[176:179], v[28:31]
  v_exp_f32 v110, v110
  v_mfma_f32_16x16x32_bf16 v[92:95], a[20:23], a[180:183], v[92:95]
  ds_read_b128 a[4:7], v4 offset:9216
  v_cvt_pk_bf16_f32 v52, v104, v105
  v_mfma_f32_16x16x32_bf16 v[92:95], a[24:27], a[184:187], v[92:95]
  v_exp_f32 v111, v111
  v_mfma_f32_16x16x32_bf16 v[92:95], a[28:31], a[188:191], v[92:95]
  s_waitcnt lgkmcnt(2)
  ds_read_b128 a[8:11], v4 offset:10240
  v_cvt_pk_bf16_f32 v53, v106, v107
  v_mfma_f32_16x16x32_bf16 v[192:195], a[32:35], v[32:35], v[192:195]
  buffer_load_dwordx4 v2, s[20:23], s28 offen offset:3072 sc1 lds
  v_mfma_f32_16x16x32_bf16 v[224:227], a[32:35], v[36:39], v[224:227]
  s_xor_b32 s26, s26, 0x8000
  v_exp_f32 v112, v112
  v_mfma_f32_16x16x32_bf16 a[200:203], a[208:211], v[32:35], a[200:203]
  s_add_u32 s28, s28, 0x8000
  s_mov_b32 m0, s27
  ds_read_b128 a[12:15], v4 offset:11264
  v_mfma_f32_16x16x32_bf16 v[196:199], a[36:39], v[32:35], v[196:199]
  s_sub_u32 s88, s88, 1
  v_exp_f32 v113, v113
  v_mfma_f32_16x16x32_bf16 v[228:231], a[36:39], v[36:39], v[228:231]
  ds_read_b128 a[16:19], v4 offset:12288
  v_cvt_pk_bf16_f32 v54, v108, v109
  v_mfma_f32_16x16x32_bf16 a[204:207], a[208:211], v[36:39], a[204:207]
  v_exp_f32 v114, v114
  v_mfma_f32_16x16x32_bf16 v[200:203], a[40:43], v[32:35], v[200:203]
  buffer_load_dwordx4 v2, s[20:23], s29 offen offset:0 sc1 lds
  v_mfma_f32_16x16x32_bf16 v[232:235], a[40:43], v[36:39], v[232:235]
  v_exp_f32 v115, v115
  v_mfma_f32_16x16x32_bf16 v[204:207], a[44:47], v[32:35], v[204:207]
  ds_read_b128 a[20:23], v4 offset:13312
  ds_read_b128 a[24:27], v4 offset:14336
  v_mfma_f32_16x16x32_bf16 v[236:239], a[44:47], v[36:39], v[236:239]
  v_exp_f32 v116, v116
  v_mfma_f32_16x16x32_bf16 v[208:211], a[48:51], v[32:35], v[208:211]
  ds_read_b128 a[28:31], v4 offset:15360
  v_xor_b32 v4, 0x4000, v4
  v_mfma_f32_16x16x32_bf16 v[240:243], a[48:51], v[36:39], v[240:243]
  v_exp_f32 v117, v117
  v_mfma_f32_16x16x32_bf16 v[212:215], a[52:55], v[32:35], v[212:215]
  buffer_load_dwordx4 v2, s[20:23], s29 offen offset:1024 sc1 lds
  v_mfma_f32_16x16x32_bf16 v[244:247], a[52:55], v[36:39], v[244:247]
  v_exp_f32 v118, v118
  v_mfma_f32_16x16x32_bf16 v[216:219], a[56:59], v[32:35], v[216:219]
  v_xor_b32 v3, 0x4000, v3
  v_cvt_pk_bf16_f32 v55, v110, v111
  v_mfma_f32_16x16x32_bf16 v[248:251], a[56:59], v[36:39], v[248:251]
  v_exp_f32 v119, v119
  v_mfma_f32_16x16x32_bf16 v[220:223], a[60:63], v[32:35], v[220:223]
  ds_read_b128 a[32:35], v3 offset:0
  ds_read_b128 a[36:39], v3 offset:1024
  v_mfma_f32_16x16x32_bf16 v[252:255], a[60:63], v[36:39], v[252:255]
  s_waitcnt lgkmcnt(2)
  v_exp_f32 v120, v120
  v_mfma_f32_16x16x32_bf16 v[192:195], a[0:3], v[40:43], v[192:195]
  ds_read_b128 a[40:43], v3 offset:2048
  ds_read_b128 a[44:47], v3 offset:3072
  v_mfma_f32_16x16x32_bf16 v[224:227], a[0:3], v[44:47], v[224:227]
  v_exp_f32 v121, v121
  v_mfma_f32_16x16x32_bf16 a[200:203], a[208:211], v[40:43], a[200:203]
  buffer_load_dwordx4 v2, s[20:23], s29 offen offset:2048 sc1 lds
  v_mfma_f32_16x16x32_bf16 v[196:199], a[4:7], v[40:43], v[196:199]
  v_exp_f32 v122, v122
  v_mfma_f32_16x16x32_bf16 v[228:231], a[4:7], v[44:47], v[228:231]
  ds_read_b128 a[48:51], v3 offset:4096
  v_cvt_pk_bf16_f32 v56, v112, v113
  v_mfma_f32_16x16x32_bf16 a[204:207], a[208:211], v[44:47], a[204:207]
  v_exp_f32 v123, v123
  v_mfma_f32_16x16x32_bf16 v[200:203], a[8:11], v[40:43], v[200:203]
  ds_read_b128 a[52:55], v3 offset:5120
  v_cvt_pk_bf16_f32 v57, v114, v115
  v_mfma_f32_16x16x32_bf16 v[232:235], a[8:11], v[44:47], v[232:235]
  v_exp_f32 v124, v124
  v_mfma_f32_16x16x32_bf16 v[204:207], a[12:15], v[40:43], v[204:207]
  buffer_load_dwordx4 v2, s[20:23], s29 offen offset:3072 sc1 lds
  v_mfma_f32_16x16x32_bf16 v[236:239], a[12:15], v[44:47], v[236:239]
  s_xor_b32 s27, s27, 0x8000
  v_exp_f32 v125, v125
  v_mfma_f32_16x16x32_bf16 v[208:211], a[16:19], v[40:43], v[208:211]
  s_add_u32 s29, s29, 0x8000
  ds_read_b128 a[56:59], v3 offset:6144
  ds_read_b128 a[60:63], v3 offset:7168
  v_mfma_f32_16x16x32_bf16 v[240:243], a[16:19], v[44:47], v[240:243]
  v_exp_f32 v126, v126
  v_mfma_f32_16x16x32_bf16 v[212:215], a[20:23], v[40:43], v[212:215]
  ds_read_b128 a[0:3], v3 offset:8192
  v_cvt_pk_bf16_f32 v58, v116, v117
  v_mfma_f32_16x16x32_bf16 v[244:247], a[20:23], v[44:47], v[244:247]
  v_exp_f32 v127, v127
  v_mfma_f32_16x16x32_bf16 v[216:219], a[24:27], v[40:43], v[216:219]
  ds_read_b128 a[4:7], v3 offset:9216
  v_cvt_pk_bf16_f32 v59, v118, v119
  v_cvt_pk_bf16_f32 v63, v126, v127
  v_mfma_f32_16x16x32_bf16 v[248:251], a[24:27], v[44:47], v[248:251]
  v_cvt_pk_bf16_f32 v60, v120, v121
  v_cvt_pk_bf16_f32 v61, v122, v123
  v_mfma_f32_16x16x32_bf16 v[220:223], a[28:31], v[40:43], v[220:223]
  s_waitcnt vmcnt(10)
  s_barrier
  v_mfma_f32_16x16x32_bf16 v[252:255], a[28:31], v[44:47], v[252:255]
  ds_read_b128 a[8:11], v3 offset:10240
  v_cvt_pk_bf16_f32 v62, v124, v125
  s_cmp_eq_u32 s88, 0
  s_cbranch_scc1 La_e0
  s_waitcnt lgkmcnt(3)
  v_mfma_f32_16x16x32_bf16 v[96:99], a[32:35], a[160:163], v[24:27]
  s_mov_b32 m0, s26
  v_exp_f32 v64, v64
  v_mfma_f32_16x16x32_bf16 v[96:99], a[36:39], a[164:167], v[96:99]
  buffer_load_dwordx4 v2, s[20:23], s28 offen offset:0 sc1 lds
  v_mfma_f32_16x16x32_bf16 v[96:99], a[40:43], a[168:171], v[96:99]
  v_exp_f32 v65, v65
  v_mfma_f32_16x16x32_bf16 v[96:99], a[44:47], a[172:175], v[96:99]
  ds_read_b128 a[12:15], v3 offset:11264
  ds_read_b128 a[16:19], v3 offset:12288
  v_mfma_f32_16x16x32_bf16 v[104:107], a[32:35], a[176:179], v[28:31]
  v_exp_f32 v66, v66
  v_mfma_f32_16x16x32_bf16 v[104:107], a[36:39], a[180:183], v[104:107]
  ds_read_b128 a[20:23], v3 offset:13312
  v_cvt_pk_bf16_f32 v32, v64, v65
  v_mfma_f32_16x16x32_bf16 v[104:107], a[40:43], a[184:187], v[104:107]
  v_exp_f32 v67, v67
  v_mfma_f32_16x16x32_bf16 v[104:107], a[44:47], a[188:191], v[104:107]
  ds_read_b128 a[24:27], v3 offset:14336
  v_cvt_pk_bf16_f32 v33, v66, v67
  v_mfma_f32_16x16x32_bf16 v[100:103], a[48:51], a[160:163], v[24:27]
  v_exp_f32 v68, v68
  v_mfma_f32_16x16x32_bf16 v[100:103], a[52:55], a[164:167], v[100:103]
  buffer_load_dwordx4 v2, s[20:23], s28 offen offset:1024 sc1 lds
  v_mfma_f32_16x16x32_bf16 v[100:103], a[56:59], a[168:171], v[100:103]
  v_exp_f32 v69, v69
  v_mfma_f32_16x16x32_bf16 v[100:103], a[60:63], a[172:175], v[100:103]
  ds_read_b128 a[28:31], v3 offset:15360
  ds_read_b128 a[32:35], v4 offset:0
  v_mfma_f32_16x16x32_bf16 v[108:111], a[48:51], a[176:179], v[28:31]
  v_exp_f32 v70, v70
  v_mfma_f32_16x16x32_bf16 v[108:111], a[52:55], a[180:183], v[108:111]
  ds_read_b128 a[36:39], v4 offset:1024
  v_cvt_pk_bf16_f32 v34, v68, v69
  v_mfma_f32_16x16x32_bf16 v[108:111], a[56:59], a[184:187], v[108:111]
  v_exp_f32 v71, v71
  v_mfma_f32_16x16x32_bf16 v[108:111], a[60:63], a[188:191], v[108:111]
  s_waitcnt lgkmcnt(2)
  ds_read_b128 a[40:43], v4 offset:2048
  v_cvt_pk_bf16_f32 v35, v70, v71
  v_mfma_f32_16x16x32_bf16 v[112:115], a[0:3], a[160:163], v[24:27]
  v_exp_f32 v72, v72
  v_mfma_f32_16x16x32_bf16 v[112:115], a[4:7], a[164:167], v[112:115]
  buffer_load_dwordx4 v2, s[20:23], s28 offen offset:2048 sc1 lds
  v_mfma_f32_16x16x32_bf16 v[112:115], a[8:11], a[168:171], v[112:115]
  v_exp_f32 v73, v73
  v_mfma_f32_16x16x32_bf16 v[112:115], a[12:15], a[172:175], v[112:115]
  ds_read_b128 a[44:47], v4 offset:3072
  ds_read_b128 a[48:51], v4 offset:4096
  v_mfma_f32_16x16x32_bf16 v[120:123], a[0:3], a[176:179], v[28:31]
  v_exp_f32 v74, v74
  v_mfma_f32_16x16x32_bf16 v[120:123], a[4:7], a[180:183], v[120:123]
  ds_read_b128 a[52:55], v4 offset:5120
  v_cvt_pk_bf16_f32 v36, v72, v73
  v_mfma_f32_16x16x32_bf16 v[120:123], a[8:11], a[184:187], v[120:123]
  v_exp_f32 v75, v75
  v_mfma_f32_16x16x32_bf16 v[120:123], a[12:15], a[188:191], v[120:123]
  ds_read_b128 a[56:59], v4 offset:6144
  v_cvt_pk_bf16_f32 v37, v74, v75
  v_mfma_f32_16x16x32_bf16 v[116:119], a[16:19], a[160:163], v[24:27]
  v_exp_f32 v76, v76
  v_mfma_f32_16x16x32_bf16 v[116:119], a[20:23], a[164:167], v[116:119]
  buffer_load_dwordx4 v2, s[20:23], s28 offen offset:3072 sc1 lds
  v_mfma_f32_16x16x32_bf16 v[116:119], a[24:27], a[168:171], v[116:119]
  s_xor_b32 s26, s26, 0x4000
  v_exp_f32 v77, v77
  v_mfma_f32_16x16x32_bf16 v[116:119], a[28:31], a[172:175], v[116:119]
  s_add_u32 s28, s28, 0x8000
  s_mov_b32 m0, s27
  ds_read_b128 a[60:63], v4 offset:7168
  v_mfma_f32_16x16x32_bf16 v[124:127], a[16:19], a[176:179], v[28:31]
  v_exp_f32 v78, v78
  v_mfma_f32_16x16x32_bf16 v[124:127], a[20:23], a[180:183], v[124:127]
  ds_read_b128 a[0:3], v4 offset:8192
  ds_read_b128 a[4:7], v4 offset:9216
  v_mfma_f32_16x16x32_bf16 v[124:127], a[24:27], a[184:187], v[124:127]
  v_exp_f32 v79, v79
  v_mfma_f32_16x16x32_bf16 v[124:127], a[28:31], a[188:191], v[124:127]
  s_waitcnt lgkmcnt(2)
  ds_read_b128 a[8:11], v4 offset:10240
  v_cvt_pk_bf16_f32 v38, v76, v77
  v_mfma_f32_16x16x32_bf16 v[192:195], a[32:35], v[48:51], v[192:195]
  buffer_load_dwordx4 v2, s[20:23], s29 offen offset:0 sc1 lds
  v_mfma_f32_16x16x32_bf16 v[224:227], a[32:35], v[52:55], v[224:227]
  v_exp_f32 v80, v80
  v_mfma_f32_16x16x32_bf16 a[200:203], a[208:211], v[48:51], a[200:203]
  ds_read_b128 a[12:15], v4 offset:11264
  v_cvt_pk_bf16_f32 v39, v78, v79
  v_mfma_f32_16x16x32_bf16 v[196:199], a[36:39], v[48:51], v[196:199]
  v_exp_f32 v81, v81
  v_mfma_f32_16x16x32_bf16 v[228:231], a[36:39], v[52:55], v[228:231]
  ds_read_b128 a[16:19], v4 offset:12288
  v_cvt_pk_bf16_f32 v40, v80, v81
  v_mfma_f32_16x16x32_bf16 a[204:207], a[208:211], v[52:55], a[204:207]
  v_exp_f32 v82, v82
  v_mfma_f32_16x16x32_bf16 v[200:203], a[40:43], v[48:51], v[200:203]
  ds_read_b128 a[20:23], v4 offset:13312
  v_mfma_f32_16x16x32_bf16 v[232:235], a[40:43], v[52:55], v[232:235]
  v_exp_f32 v83, v83
  v_mfma_f32_16x16x32_bf16 v[204:207], a[44:47], v[48:51], v[204:207]
  buffer_load_dwordx4 v2, s[20:23], s29 offen offset:1024 sc1 lds
  v_mfma_f32_16x16x32_bf16 v[236:239], a[44:47], v[52:55], v[236:239]
  v_exp_f32 v84, v84
  v_mfma_f32_16x16x32_bf16 v[208:211], a[48:51], v[48:51], v[208:211]
  ds_read_b128 a[24:27], v4 offset:14336
  ds_read_b128 a[28:31], v4 offset:15360
  v_mfma_f32_16x16x32_bf16 v[240:243], a[48:51], v[52:55], v[240:243]
  v_exp_f32 v85, v85
  v_mfma_f32_16x16x32_bf16 v[212:215], a[52:55], v[48:51], v[212:215]
  v_xor_b32 v4, 0x8000, v4
  v_xor_b32 v3, 0x8000, v3
  v_mfma_f32_16x16x32_bf16 v[244:247], a[52:55], v[52:55], v[244:247]
  v_exp_f32 v86, v86
  v_mfma_f32_16x16x32_bf16 v[216:219], a[56:59], v[48:51], v[216:219]
  ds_read_b128 a[32:35], v3 offset:0
  ds_read_b128 a[36:39], v3 offset:1024
  v_mfma_f32_16x16x32_bf16 v[248:251], a[56:59], v[52:55], v[248:251]
  v_exp_f32 v87, v87
  v_mfma_f32_16x16x32_bf16 v[220:223], a[60:63], v[48:51], v[220:223]
  buffer_load_dwordx4 v2, s[20:23], s29 offen offset:2048 sc1 lds
  v_mfma_f32_16x16x32_bf16 v[252:255], a[60:63], v[52:55], v[252:255]
  s_waitcnt lgkmcnt(2)
  v_exp_f32 v88, v88
  v_mfma_f32_16x16x32_bf16 v[192:195], a[0:3], v[56:59], v[192:195]
  ds_read_b128 a[40:43], v3 offset:2048
  ds_read_b128 a[44:47], v3 offset:3072
  v_mfma_f32_16x16x32_bf16 v[224:227], a[0:3], v[60:63], v[224:227]
  v_exp_f32 v89, v89
  v_mfma_f32_16x16x32_bf16 a[200:203], a[208:211], v[56:59], a[200:203]
  v_cvt_pk_bf16_f32 v41, v82, v83
  v_cvt_pk_bf16_f32 v42, v84, v85
  v_mfma_f32_16x16x32_bf16 v[196:199], a[4:7], v[56:59], v[196:199]
  v_exp_f32 v90, v90
  v_mfma_f32_16x16x32_bf16 v[228:231], a[4:7], v[60:63], v[228:231]
  ds_read_b128 a[48:51], v3 offset:4096
  v_cvt_pk_bf16_f32 v43, v86, v87
  v_mfma_f32_16x16x32_bf16 a[204:207], a[208:211], v[60:63], a[204:207]
  v_exp_f32 v91, v91
  v_mfma_f32_16x16x32_bf16 v[200:203], a[8:11], v[56:59], v[200:203]
  buffer_load_dwordx4 v2, s[20:23], s29 offen offset:3072 sc1 lds
  v_mfma_f32_16x16x32_bf16 v[232:235], a[8:11], v[60:63], v[232:235]
  s_xor_b32 s27, s27, 0x4000
  v_exp_f32 v92, v92
  v_mfma_f32_16x16x32_bf16 v[204:207], a[12:15], v[56:59], v[204:207]
  s_add_u32 s29, s29, 0x8000
  ds_read_b128 a[52:55], v3 offset:5120
  ds_read_b128 a[56:59], v3 offset:6144
  v_mfma_f32_16x16x32_bf16 v[236:239], a[12:15], v[60:63], v[236:239]
  v_exp_f32 v93, v93
  v_mfma_f32_16x16x32_bf16 v[208:211], a[16:19], v[56:59], v[208:211]
  ds_read_b128 a[60:63], v3 offset:7168
  v_cvt_pk_bf16_f32 v44, v88, v89
  v_mfma_f32_16x16x32_bf16 v[240:243], a[16:19], v[60:63], v[240:243]
  v_exp_f32 v94, v94
  v_mfma_f32_16x16x32_bf16 v[212:215], a[20:23], v[56:59], v[212:215]
  ds_read_b128 a[0:3], v3 offset:8192
  v_cvt_pk_bf16_f32 v45, v90, v91
  v_mfma_f32_16x16x32_bf16 v[244:247], a[20:23], v[60:63], v[244:247]
  v_exp_f32 v95, v95
  v_mfma_f32_16x16x32_bf16 v[216:219], a[24:27], v[56:59], v[216:219]
  ds_read_b128 a[4:7], v3 offset:9216
  v_cvt_pk_bf16_f32 v46, v92, v93
  v_mfma_f32_16x16x32_bf16 v[248:251], a[24:27], v[60:63], v[248:251]
  v_cvt_pk_bf16_f32 v47, v94, v95
  v_mfma_f32_16x16x32_bf16 v[220:223], a[28:31], v[56:59], v[220:223]
  s_waitcnt vmcnt(12)
  s_barrier
  v_mfma_f32_16x16x32_bf16 v[252:255], a[28:31], v[60:63], v[252:255]
  ds_read_b128 a[8:11], v3 offset:10240
  s_branch La_so
La_e0:
  s_waitcnt lgkmcnt(7)
  v_mfma_f32_16x16x32_bf16 v[104:107], a[32:35], a[176:179], v[28:31]
  buffer_load_dwordx2 v[12:13], v14, s[96:99], s91 offen sc1
  v_mfma_f32_16x16x32_bf16 v[104:107], a[36:39], a[180:183], v[104:107]
  v_cndmask_b32 v64, v64, v5, s[32:33]
  v_exp_f32 v64, v64
  v_mfma_f32_16x16x32_bf16 v[104:107], a[40:43], a[184:187], v[104:107]
  v_cndmask_b32 v65, v65, v5, s[34:35]
  v_exp_f32 v65, v65
  v_mfma_f32_16x16x32_bf16 v[104:107], a[44:47], a[188:191], v[104:107]
  s_waitcnt lgkmcnt(3)
  v_cndmask_b32 v66, v66, v5, s[36:37]
  v_exp_f32 v66, v66
  v_mfma_f32_16x16x32_bf16 v[108:111], a[48:51], a[176:179], v[28:31]
  v_cndmask_b32 v67, v67, v5, s[38:39]
  v_exp_f32 v67, v67
  v_mfma_f32_16x16x32_bf16 v[108:111], a[52:55], a[180:183], v[108:111]
  ds_read_b128 a[12:15], v3 offset:11264
  ds_read_b128 a[16:19], v3 offset:12288
  v_mfma_f32_16x16x32_bf16 v[108:111], a[56:59], a[184:187], v[108:111]
  v_cndmask_b32 v68, v68, v5, s[40:41]
  v_exp_f32 v68, v68
  v_mfma_f32_16x16x32_bf16 v[108:111], a[60:63], a[188:191], v[108:111]
  s_waitcnt lgkmcnt(1)
  v_cndmask_b32 v69, v69, v5, s[42:43]
  v_exp_f32 v69, v69
  v_mfma_f32_16x16x32_bf16 v[120:123], a[0:3], a[176:179], v[28:31]
  ds_read_b128 a[20:23], v3 offset:13312
  ds_read_b128 a[24:27], v3 offset:14336
  ds_read_b128 a[28:31], v3 offset:15360
  v_mfma_f32_16x16x32_bf16 v[120:123], a[4:7], a[180:183], v[120:123]
  v_cndmask_b32 v70, v70, v5, s[44:45]
  v_exp_f32 v70, v70
  v_mfma_f32_16x16x32_bf16 v[120:123], a[8:11], a[184:187], v[120:123]
  v_cndmask_b32 v71, v71, v5, s[46:47]
  v_exp_f32 v71, v71
  v_mfma_f32_16x16x32_bf16 v[120:123], a[12:15], a[188:191], v[120:123]
  s_waitcnt lgkmcnt(0)
  ds_read_b128 a[32:35], v4 offset:0
  ds_read_b128 a[36:39], v4 offset:1024
  v_mfma_f32_16x16x32_bf16 v[124:127], a[16:19], a[176:179], v[28:31]
  v_exp_f32 v72, v72
  v_mfma_f32_16x16x32_bf16 v[124:127], a[20:23], a[180:183], v[124:127]
  ds_read_b128 a[40:43], v4 offset:2048
  ds_read_b128 a[44:47], v4 offset:3072
  ds_read_b128 a[48:51], v4 offset:4096
  v_mfma_f32_16x16x32_bf16 v[124:127], a[24:27], a[184:187], v[124:127]
  ds_read_b128 a[52:55], v4 offset:5120
  ds_read_b128 a[56:59], v4 offset:6144
  ds_read_b128 a[60:63], v4 offset:7168
  v_exp_f32 v73, v73
  v_mfma_f32_16x16x32_bf16 v[124:127], a[28:31], a[188:191], v[124:127]
  s_waitcnt lgkmcnt(0)
  v_exp_f32 v74, v74
  v_mfma_f32_16x16x32_bf16 v[192:195], a[32:35], v[48:51], v[192:195]
  ds_read_b128 a[0:3], v4 offset:8192
  ds_read_b128 a[4:7], v4 offset:9216
  v_mfma_f32_16x16x32_bf16 v[224:227], a[32:35], v[52:55], v[224:227]
  v_exp_f32 v75, v75
  v_mfma_f32_16x16x32_bf16 a[200:203], a[208:211], v[48:51], a[200:203]
  v_exp_f32 v76, v76
  v_mfma_f32_16x16x32_bf16 v[196:199], a[36:39], v[48:51], v[196:199]
  ds_read_b128 a[8:11], v4 offset:10240
  ds_read_b128 a[12:15], v4 offset:11264
  v_mfma_f32_16x16x32_bf16 v[228:231], a[36:39], v[52:55], v[228:231]
  v_exp_f32 v77, v77
  v_mfma_f32_16x16x32_bf16 a[204:207], a[208:211], v[52:55], a[204:207]
  v_exp_f32 v78, v78
  v_mfma_f32_16x16x32_bf16 v[200:203], a[40:43], v[48:51], v[200:203]
  ds_read_b128 a[16:19], v4 offset:12288
  ds_read_b128 a[20:23], v4 offset:13312
  v_mfma_f32_16x16x32_bf16 v[232:235], a[40:43], v[52:55], v[232:235]
  v_exp_f32 v79, v79
  v_mfma_f32_16x16x32_bf16 v[204:207], a[44:47], v[48:51], v[204:207]
  ds_read_b128 a[24:27], v4 offset:14336
  v_cvt_pk_bf16_f32 v32, v64, v65
  v_mfma_f32_16x16x32_bf16 v[236:239], a[44:47], v[52:55], v[236:239]
  v_cndmask_b32 v80, v80, v5, s[48:49]
  v_exp_f32 v80, v80
  v_mfma_f32_16x16x32_bf16 v[208:211], a[48:51], v[48:51], v[208:211]
  v_cndmask_b32 v81, v81, v5, s[50:51]
  v_exp_f32 v81, v81
  v_mfma_f32_16x16x32_bf16 v[240:243], a[48:51], v[52:55], v[240:243]
  ds_read_b128 a[28:31], v4 offset:15360
  v_xor_b32 v4, 0x8000, v4
  v_cvt_pk_bf16_f32 v40, v80, v81
  v_mfma_f32_16x16x32_bf16 v[212:215], a[52:55], v[48:51], v[212:215]
  v_cndmask_b32 v82, v82, v5, s[52:53]
  v_exp_f32 v82, v82
  v_mfma_f32_16x16x32_bf16 v[244:247], a[52:55], v[52:55], v[244:247]
  v_cndmask_b32 v83, v83, v5, s[54:55]
  v_exp_f32 v83, v83
  v_mfma_f32_16x16x32_bf16 v[216:219], a[56:59], v[48:51], v[216:219]
  ds_read_b128 a[32:35], v4 offset:0
  ds_read_b128 a[36:39], v4 offset:1024
  v_cvt_pk_bf16_f32 v41, v82, v83
  v_mfma_f32_16x16x32_bf16 v[248:251], a[56:59], v[52:55], v[248:251]
  v_cndmask_b32 v84, v84, v5, s[56:57]
  v_exp_f32 v84, v84
  v_mfma_f32_16x16x32_bf16 v[220:223], a[60:63], v[48:51], v[220:223]
  v_cndmask_b32 v85, v85, v5, s[58:59]
  v_exp_f32 v85, v85
  v_mfma_f32_16x16x32_bf16 v[252:255], a[60:63], v[52:55], v[252:255]
  s_waitcnt lgkmcnt(2)
  ds_read_b128 a[40:43], v4 offset:2048
  v_cvt_pk_bf16_f32 v33, v66, v67
  v_cvt_pk_bf16_f32 v42, v84, v85
  v_mfma_f32_16x16x32_bf16 v[192:195], a[0:3], v[56:59], v[192:195]
  v_cndmask_b32 v86, v86, v5, s[60:61]
  v_exp_f32 v86, v86
  v_mfma_f32_16x16x32_bf16 v[224:227], a[0:3], v[60:63], v[224:227]
  v_cndmask_b32 v87, v87, v5, s[62:63]
  v_exp_f32 v87, v87
  v_mfma_f32_16x16x32_bf16 a[200:203], a[208:211], v[56:59], a[200:203]
  ds_read_b128 a[44:47], v4 offset:3072
  v_cvt_pk_bf16_f32 v34, v68, v69
  v_cvt_pk_bf16_f32 v43, v86, v87
  v_mfma_f32_16x16x32_bf16 v[196:199], a[4:7], v[56:59], v[196:199]
  v_exp_f32 v88, v88
  v_mfma_f32_16x16x32_bf16 v[228:231], a[4:7], v[60:63], v[228:231]
  ds_read_b128 a[48:51], v4 offset:4096
  v_cvt_pk_bf16_f32 v35, v70, v71
  v_mfma_f32_16x16x32_bf16 a[204:207], a[208:211], v[60:63], a[204:207]
  v_exp_f32 v89, v89
  v_mfma_f32_16x16x32_bf16 v[200:203], a[8:11], v[56:59], v[200:203]
  v_exp_f32 v90, v90
  v_cvt_pk_bf16_f32 v44, v88, v89
  v_mfma_f32_16x16x32_bf16 v[232:235], a[8:11], v[60:63], v[232:235]
  ds_read_b128 a[52:55], v4 offset:5120
  v_cvt_pk_bf16_f32 v36, v72, v73
  v_mfma_f32_16x16x32_bf16 v[204:207], a[12:15], v[56:59], v[204:207]
  v_exp_f32 v91, v91
  v_mfma_f32_16x16x32_bf16 v[236:239], a[12:15], v[60:63], v[236:239]
  v_exp_f32 v92, v92
  v_cvt_pk_bf16_f32 v45, v90, v91
  v_mfma_f32_16x16x32_bf16 v[208:211], a[16:19], v[56:59], v[208:211]
  ds_read_b128 a[56:59], v4 offset:6144
  ds_read_b128 a[60:63], v4 offset:7168
  v_mfma_f32_16x16x32_bf16 v[240:243], a[16:19], v[60:63], v[240:243]
  v_exp_f32 v93, v93
  v_mfma_f32_16x16x32_bf16 v[212:215], a[20:23], v[56:59], v[212:215]
  v_exp_f32 v94, v94
  v_cvt_pk_bf16_f32 v46, v92, v93
  v_mfma_f32_16x16x32_bf16 v[244:247], a[20:23], v[60:63], v[244:247]
  ds_read_b128 a[0:3], v4 offset:8192
  v_cvt_pk_bf16_f32 v37, v74, v75
  v_mfma_f32_16x16x32_bf16 v[216:219], a[24:27], v[56:59], v[216:219]
  v_exp_f32 v95, v95
  v_mfma_f32_16x16x32_bf16 v[248:251], a[24:27], v[60:63], v[248:251]
  ds_read_b128 a[4:7], v4 offset:9216
  v_cvt_pk_bf16_f32 v38, v76, v77
  v_cvt_pk_bf16_f32 v47, v94, v95
  v_mfma_f32_16x16x32_bf16 v[220:223], a[28:31], v[56:59], v[220:223]
  s_waitcnt vmcnt(0)
  s_barrier
  v_mfma_f32_16x16x32_bf16 v[252:255], a[28:31], v[60:63], v[252:255]
  ds_read_b128 a[8:11], v4 offset:10240
  v_cvt_pk_bf16_f32 v39, v78, v79
La_e1:
  s_mov_b32 s5, 0x40000
Lpoll_7:
  v_cmp_ne_u64 vcc, s[94:95], v[12:13]
  s_nop 0
  s_cbranch_vccz Lpolld_8
  s_sleep 4
  buffer_load_dwordx2 v[12:13], v14, s[96:99], s91 offen sc1
  s_sub_u32 s5, s5, 1
  s_waitcnt vmcnt(0)
  s_cbranch_scc0 Lpoll_7
Lpolld_8:
  s_add_u32 s64, s79, 131072
  v_accvgpr_read_b32 v10, a212
  v_accvgpr_read_b32 v11, a213
  v_accvgpr_read_b32 v12, a214
  v_accvgpr_read_b32 v13, a215
  s_mov_b32 s12, s80
  s_mov_b32 s13, s81
  s_mov_b32 s14, 2097152
  s_mov_b32 s15, 0x00020000
  s_lshl_b32 s93, s77, 20
  s_lshl_b32 s72, s76, 8
  s_add_u32 s93, s93, s72
  s_add_u32 s72, s73, s76
  s_and_b32 s31, s72, 3
  s_lshl_b32 s31, s31, 3
  s_or_b32 s31, s31, 0x80000
  s_bfe_u32 s30, 0x70702, s31
  s_add_u32 s30, s30, 0
  s_and_b32 s30, s30, 7
  s_lshl_b32 s72, s30, 17
  s_add_u32 s71, s93, s72
  s_add_u32 s8, s86, 83886080
  s_addc_u32 s9, s87, 0
  s_mov_b32 s10, 4194304
  s_mov_b32 s11, 0x00020000
  s_lshl_b32 s92, s73, 1
  s_add_u32 s92, s92, s77
  s_lshl_b32 s92, s92, 17
  s_add_u32 s92, s92, s79
  s_add_u32 s72, s73, s76
  s_and_b32 s1, s72, 3
  s_lshl_b32 s1, s1, 3
  s_or_b32 s1, s1, 0x80000
  s_bfe_u32 s0, 0x70702, s1
  s_add_u32 s0, s0, 0
  s_and_b32 s0, s0, 7
  s_lshl_b32 s72, s0, 14
  s_add_u32 s70, s92, s72
  s_waitcnt lgkmcnt(3)
  v_mfma_f32_16x16x32_bf16 v[192:195], a[32:35], v[32:35], v[192:195]
  s_add_u32 m0, s79, 147456
  ds_read_b128 a[12:15], v4 offset:11264
  v_cndmask_b32 v104, v104, v5, s[32:33]
  v_mfma_f32_16x16x32_bf16 v[224:227], a[32:35], v[36:39], v[224:227]
  v_exp_f32 v104, v104
  v_mfma_f32_16x16x32_bf16 a[200:203], a[208:211], v[32:35], a[200:203]
  v_cndmask_b32 v105, v105, v5, s[34:35]
  v_exp_f32 v105, v105
  v_mfma_f32_16x16x32_bf16 v[196:199], a[36:39], v[32:35], v[196:199]
  buffer_load_dwordx4 v10, s[12:15], s71 offen offset:0 lds
  v_mfma_f32_16x16x32_bf16 v[228:231], a[36:39], v[36:39], v[228:231]
  v_cndmask_b32 v106, v106, v5, s[36:37]
  v_exp_f32 v106, v106
  v_mfma_f32_16x16x32_bf16 a[204:207], a[208:211], v[36:39], a[204:207]
  buffer_load_dwordx4 v11, s[12:15], s71 offen offset:1024 lds
  v_mfma_f32_16x16x32_bf16 v[200:203], a[40:43], v[32:35], v[200:203]
  v_cndmask_b32 v107, v107, v5, s[38:39]
  v_exp_f32 v107, v107
  v_mfma_f32_16x16x32_bf16 v[232:235], a[40:43], v[36:39], v[232:235]
  ds_read_b128 a[16:19], v4 offset:12288
  ds_read_b128 a[20:23], v4 offset:13312
  v_mfma_f32_16x16x32_bf16 v[204:207], a[44:47], v[32:35], v[204:207]
  v_cndmask_b32 v108, v108, v5, s[40:41]
  v_exp_f32 v108, v108
  v_mfma_f32_16x16x32_bf16 v[236:239], a[44:47], v[36:39], v[236:239]
  buffer_load_dwordx4 v12, s[12:15], s71 offen offset:2048 lds
  v_cvt_pk_bf16_f32 v53, v106, v107
  v_mfma_f32_16x16x32_bf16 v[208:211], a[48:51], v[32:35], v[208:211]
  v_cndmask_b32 v109, v109, v5, s[42:43]
  v_exp_f32 v109, v109
  v_mfma_f32_16x16x32_bf16 v[240:243], a[48:51], v[36:39], v[240:243]
  ds_read_b128 a[24:27], v4 offset:14336
  ds_read_b128 a[28:31], v4 offset:15360
  v_mfma_f32_16x16x32_bf16 v[212:215], a[52:55], v[32:35], v[212:215]
  v_cndmask_b32 v110, v110, v5, s[44:45]
  v_exp_f32 v110, v110
  v_mfma_f32_16x16x32_bf16 v[244:247], a[52:55], v[36:39], v[244:247]
  buffer_load_dwordx4 v13, s[12:15], s71 offen offset:3072 lds
  v_cvt_pk_bf16_f32 v54, v108, v109
  v_mfma_f32_16x16x32_bf16 v[216:219], a[56:59], v[32:35], v[216:219]
  s_bfe_u32 s72, 0x3020106, s31
  v_cndmask_b32 v111, v111, v5, s[46:47]
  v_exp_f32 v111, v111
  v_mfma_f32_16x16x32_bf16 v[248:251], a[56:59], v[36:39], v[248:251]
  s_add_u32 s30, s30, s72
  s_add_u32 s31, s31, 8
  s_and_b32 s31, s31, 0x8001f
  v_mfma_f32_16x16x32_bf16 v[220:223], a[60:63], v[32:35], v[220:223]
  s_and_b32 s30, s30, 7
  s_lshl_b32 s72, s30, 17
  s_add_u32 s71, s93, s72
  v_mfma_f32_16x16x32_bf16 v[252:255], a[60:63], v[36:39], v[252:255]
  s_waitcnt lgkmcnt(0)
  v_cndmask_b32 v120, v120, v5, s[48:49]
  v_exp_f32 v120, v120
  v_mfma_f32_16x16x32_bf16 v[192:195], a[0:3], v[40:43], v[192:195]
  s_add_u32 m0, s79, 131072
  v_xor_b32 v4, 0x4000, v4
  v_cvt_pk_bf16_f32 v52, v104, v105
  v_mfma_f32_16x16x32_bf16 v[224:227], a[0:3], v[44:47], v[224:227]
  v_cndmask_b32 v121, v121, v5, s[50:51]
  v_exp_f32 v121, v121
  v_mfma_f32_16x16x32_bf16 a[200:203], a[208:211], v[40:43], a[200:203]
  buffer_load_dwordx4 v2, s[8:11], s70 offen offset:0 sc1 lds
  v_cvt_pk_bf16_f32 v55, v110, v111
  v_mfma_f32_16x16x32_bf16 v[196:199], a[4:7], v[40:43], v[196:199]
  v_cndmask_b32 v122, v122, v5, s[52:53]
  v_exp_f32 v122, v122
  v_mfma_f32_16x16x32_bf16 v[228:231], a[4:7], v[44:47], v[228:231]
  buffer_load_dwordx4 v2, s[8:11], s70 offen offset:1024 sc1 lds
  v_cvt_pk_bf16_f32 v60, v120, v121
  v_mfma_f32_16x16x32_bf16 a[204:207], a[208:211], v[44:47], a[204:207]
  v_cndmask_b32 v123, v123, v5, s[54:55]
  v_exp_f32 v123, v123
  v_mfma_f32_16x16x32_bf16 v[200:203], a[8:11], v[40:43], v[200:203]
  buffer_load_dwordx4 v2, s[8:11], s70 offen offset:2048 sc1 lds
  v_cvt_pk_bf16_f32 v61, v122, v123
  v_mfma_f32_16x16x32_bf16 v[232:235], a[8:11], v[44:47], v[232:235]
  v_cndmask_b32 v124, v124, v5, s[56:57]
  v_exp_f32 v124, v124
  v_mfma_f32_16x16x32_bf16 v[204:207], a[12:15], v[40:43], v[204:207]
  ds_read_b128 a[32:35], v4 offset:0
  ds_read_b128 a[36:39], v4 offset:1024
  v_mfma_f32_16x16x32_bf16 v[236:239], a[12:15], v[44:47], v[236:239]
  v_cndmask_b32 v125, v125, v5, s[58:59]
  v_exp_f32 v125, v125
  v_mfma_f32_16x16x32_bf16 v[208:211], a[16:19], v[40:43], v[208:211]
  buffer_load_dwordx4 v2, s[8:11], s70 offen offset:3072 sc1 lds
  v_cvt_pk_bf16_f32 v62, v124, v125
  v_mfma_f32_16x16x32_bf16 v[240:243], a[16:19], v[44:47], v[240:243]
  s_bfe_u32 s72, 0x3020106, s1
  v_cndmask_b32 v126, v126, v5, s[60:61]
  v_exp_f32 v126, v126
  v_mfma_f32_16x16x32_bf16 v[212:215], a[20:23], v[40:43], v[212:215]
  s_add_u32 s0, s0, s72
  s_add_u32 s1, s1, 8
  s_and_b32 s1, s1, 0x8001f
  v_mfma_f32_16x16x32_bf16 v[244:247], a[20:23], v[44:47], v[244:247]
  s_and_b32 s0, s0, 7
  v_cndmask_b32 v127, v127, v5, s[62:63]
  v_exp_f32 v127, v127
  v_mfma_f32_16x16x32_bf16 v[216:219], a[24:27], v[40:43], v[216:219]
  s_lshl_b32 s72, s0, 14
  s_add_u32 s70, s92, s72
  ds_read_b128 a[40:43], v4 offset:2048
  v_cvt_pk_bf16_f32 v63, v126, v127
  v_mfma_f32_16x16x32_bf16 v[248:251], a[24:27], v[44:47], v[248:251]
  ds_read_b128 a[44:47], v4 offset:3072
  ds_read_b128 a[48:51], v4 offset:4096
  v_mfma_f32_16x16x32_bf16 v[220:223], a[28:31], v[40:43], v[220:223]
  ds_read_b128 a[52:55], v4 offset:5120
  ds_read_b128 a[56:59], v4 offset:6144
  v_mfma_f32_16x16x32_bf16 v[252:255], a[28:31], v[44:47], v[252:255]
  ds_read_b128 a[60:63], v4 offset:7168
  ds_read_b128 a[0:3], v4 offset:8192
  ds_read_b128 a[4:7], v4 offset:9216
  ds_read_b128 a[8:11], v4 offset:10240
  s_waitcnt lgkmcnt(7)
  v_mfma_f32_16x16x32_bf16 v[224:227], a[32:35], v[52:55], v[224:227]
  s_add_u32 m0, s79, 49152
  ds_read_b128 a[12:15], v4 offset:11264
  v_mfma_f32_16x16x32_bf16 a[204:207], a[208:211], v[52:55], a[204:207]
  buffer_load_dwordx4 v10, s[12:15], s71 offen offset:0 lds
  v_mfma_f32_16x16x32_bf16 v[228:231], a[36:39], v[52:55], v[228:231]
  buffer_load_dwordx4 v11, s[12:15], s71 offen offset:1024 lds
  v_mfma_f32_16x16x32_bf16 v[232:235], a[40:43], v[52:55], v[232:235]
  buffer_load_dwordx4 v12, s[12:15], s71 offen offset:2048 lds
  v_mfma_f32_16x16x32_bf16 v[236:239], a[44:47], v[52:55], v[236:239]
  s_waitcnt lgkmcnt(4)
  ds_read_b128 a[16:19], v4 offset:12288
  ds_read_b128 a[20:23], v4 offset:13312
  v_mfma_f32_16x16x32_bf16 v[240:243], a[48:51], v[52:55], v[240:243]
  buffer_load_dwordx4 v13, s[12:15], s71 offen offset:3072 lds
  ds_read_b128 a[24:27], v4 offset:14336
  v_mfma_f32_16x16x32_bf16 v[244:247], a[52:55], v[52:55], v[244:247]
  s_bfe_u32 s72, 0x3020106, s31
  s_add_u32 s30, s30, s72
  s_add_u32 s31, s31, 8
  v_mfma_f32_16x16x32_bf16 v[248:251], a[56:59], v[52:55], v[248:251]
  s_and_b32 s31, s31, 0x8001f
  s_and_b32 s30, s30, 7
  s_lshl_b32 s72, s30, 17
  v_mfma_f32_16x16x32_bf16 v[252:255], a[60:63], v[52:55], v[252:255]
  s_waitcnt lgkmcnt(3)
  s_add_u32 s71, s93, s72
  s_add_u32 m0, s79, 32768
  v_mfma_f32_16x16x32_bf16 v[224:227], a[0:3], v[60:63], v[224:227]
  buffer_load_dwordx4 v2, s[8:11], s70 offen offset:0 sc1 lds
  ds_read_b128 a[28:31], v4 offset:15360
  v_mfma_f32_16x16x32_bf16 a[204:207], a[208:211], v[60:63], a[204:207]
  buffer_load_dwordx4 v2, s[8:11], s70 offen offset:1024 sc1 lds
  v_mfma_f32_16x16x32_bf16 v[228:231], a[4:7], v[60:63], v[228:231]
  buffer_load_dwordx4 v2, s[8:11], s70 offen offset:2048 sc1 lds
  v_mfma_f32_16x16x32_bf16 v[232:235], a[8:11], v[60:63], v[232:235]
  buffer_load_dwordx4 v2, s[8:11], s70 offen offset:3072 sc1 lds
  v_mfma_f32_16x16x32_bf16 v[236:239], a[12:15], v[60:63], v[236:239]
  s_waitcnt lgkmcnt(0)
  s_bfe_u32 s72, 0x3020106, s1
  s_add_u32 s0, s0, s72
  v_mfma_f32_16x16x32_bf16 v[240:243], a[16:19], v[60:63], v[240:243]
  s_add_u32 s1, s1, 8
  s_and_b32 s1, s1, 0x8001f
  s_and_b32 s0, s0, 7
  v_mfma_f32_16x16x32_bf16 v[244:247], a[20:23], v[60:63], v[244:247]
  s_lshl_b32 s72, s0, 14
  s_add_u32 s70, s92, s72
  v_mfma_f32_16x16x32_bf16 v[248:251], a[24:27], v[60:63], v[248:251]
  v_mfma_f32_16x16x32_bf16 v[252:255], a[28:31], v[60:63], v[252:255]
  s_and_b32 s88, s25, 1
  s_lshl_b32 s88, s88, 1
  s_add_u32 s88, s88, 14
  s_sub_u32 s88, s88, s25
  s_lshl_b32 s4, s88, 20
  s_lshl_b32 s5, s24, 15
  s_add_u32 s4, s4, s5
  s_lshl_b32 s5, s3, 11
  s_add_u32 s4, s4, s5
  v_accvgpr_read_b32 v6, a200
  v_accvgpr_read_b32 v8, a204
  s_mov_b32 s5, 0x5f800000
  v_cmp_ngt_f32 vcc, s5, v6
  v_rcp_f32 v6, v6
  s_or_b32 s89, s89, vcc_lo
  s_or_b32 s89, s89, vcc_hi
  v_mov_b32 v7, v6
  v_cmp_ngt_f32 vcc, s5, v8
  v_rcp_f32 v8, v8
  s_or_b32 s89, s89, vcc_lo
  s_or_b32 s89, s89, vcc_hi
  v_mov_b32 v9, v8
  v_pk_mul_f32 v[192:193], v[192:193], v[6:7]
  v_pk_mul_f32 v[194:195], v[194:195], v[6:7]
  v_pk_mul_f32 v[196:197], v[196:197], v[6:7]
  v_pk_mul_f32 v[198:199], v[198:199], v[6:7]
  v_cvt_pk_bf16_f32 v192, v192, v193
  v_cvt_pk_bf16_f32 v193, v194, v195
  v_cvt_pk_bf16_f32 v194, v196, v197
  v_cvt_pk_bf16_f32 v195, v198, v199
  buffer_store_dwordx4 v[192:195], v2, s[16:19], s4 offen offset:0 sc1
  v_pk_mul_f32 v[224:225], v[224:225], v[8:9]
  v_pk_mul_f32 v[226:227], v[226:227], v[8:9]
  v_pk_mul_f32 v[228:229], v[228:229], v[8:9]
  v_pk_mul_f32 v[230:231], v[230:231], v[8:9]
  v_cvt_pk_bf16_f32 v224, v224, v225
  v_cvt_pk_bf16_f32 v225, v226, v227
  v_cvt_pk_bf16_f32 v226, v228, v229
  v_cvt_pk_bf16_f32 v227, v230, v231
  buffer_store_dwordx4 v[224:227], v2, s[16:19], s4 offen offset:1024 sc1
  s_add_u32 s4, s4, 8192
  v_pk_mul_f32 v[200:201], v[200:201], v[6:7]
  v_pk_mul_f32 v[202:203], v[202:203], v[6:7]
  v_pk_mul_f32 v[204:205], v[204:205], v[6:7]
  v_pk_mul_f32 v[206:207], v[206:207], v[6:7]
  v_cvt_pk_bf16_f32 v200, v200, v201
  v_cvt_pk_bf16_f32 v201, v202, v203
  v_cvt_pk_bf16_f32 v202, v204, v205
  v_cvt_pk_bf16_f32 v203, v206, v207
  buffer_store_dwordx4 v[200:203], v2, s[16:19], s4 offen offset:0 sc1
  v_pk_mul_f32 v[232:233], v[232:233], v[8:9]
  v_pk_mul_f32 v[234:235], v[234:235], v[8:9]
  v_pk_mul_f32 v[236:237], v[236:237], v[8:9]
  v_pk_mul_f32 v[238:239], v[238:239], v[8:9]
  v_cvt_pk_bf16_f32 v232, v232, v233
  v_cvt_pk_bf16_f32 v233, v234, v235
  v_cvt_pk_bf16_f32 v234, v236, v237
  v_cvt_pk_bf16_f32 v235, v238, v239
  buffer_store_dwordx4 v[232:235], v2, s[16:19], s4 offen offset:1024 sc1
  s_add_u32 s4, s4, 8192
  v_pk_mul_f32 v[208:209], v[208:209], v[6:7]
  v_pk_mul_f32 v[210:211], v[210:211], v[6:7]
  v_pk_mul_f32 v[212:213], v[212:213], v[6:7]
  v_pk_mul_f32 v[214:215], v[214:215], v[6:7]
  v_cvt_pk_bf16_f32 v208, v208, v209
  v_cvt_pk_bf16_f32 v209, v210, v211
  v_cvt_pk_bf16_f32 v210, v212, v213
  v_cvt_pk_bf16_f32 v211, v214, v215
  buffer_store_dwordx4 v[208:211], v2, s[16:19], s4 offen offset:0 sc1
  v_pk_mul_f32 v[240:241], v[240:241], v[8:9]
  v_pk_mul_f32 v[242:243], v[242:243], v[8:9]
  v_pk_mul_f32 v[244:245], v[244:245], v[8:9]
  v_pk_mul_f32 v[246:247], v[246:247], v[8:9]
  v_cvt_pk_bf16_f32 v240, v240, v241
  v_cvt_pk_bf16_f32 v241, v242, v243
  v_cvt_pk_bf16_f32 v242, v244, v245
  v_cvt_pk_bf16_f32 v243, v246, v247
  buffer_store_dwordx4 v[240:243], v2, s[16:19], s4 offen offset:1024 sc1
  s_add_u32 s4, s4, 8192
  v_pk_mul_f32 v[216:217], v[216:217], v[6:7]
  v_pk_mul_f32 v[218:219], v[218:219], v[6:7]
  v_pk_mul_f32 v[220:221], v[220:221], v[6:7]
  v_pk_mul_f32 v[222:223], v[222:223], v[6:7]
  v_cvt_pk_bf16_f32 v216, v216, v217
  v_cvt_pk_bf16_f32 v217, v218, v219
  v_cvt_pk_bf16_f32 v218, v220, v221
  v_cvt_pk_bf16_f32 v219, v222, v223
  buffer_store_dwordx4 v[216:219], v2, s[16:19], s4 offen offset:0 sc1
  v_pk_mul_f32 v[248:249], v[248:249], v[8:9]
  v_pk_mul_f32 v[250:251], v[250:251], v[8:9]
  v_pk_mul_f32 v[252:253], v[252:253], v[8:9]
  v_pk_mul_f32 v[254:255], v[254:255], v[8:9]
  v_cvt_pk_bf16_f32 v248, v248, v249
  v_cvt_pk_bf16_f32 v249, v250, v251
  v_cvt_pk_bf16_f32 v250, v252, v253
  v_cvt_pk_bf16_f32 v251, v254, v255
  buffer_store_dwordx4 v[248:251], v2, s[16:19], s4 offen offset:1024 sc1
  s_cmp_eq_u32 s89, 0
  s_cbranch_scc1 La_done
  s_waitcnt vmcnt(0)
  s_and_b32 s6, s25, 1
  s_lshl_b32 s6, s6, 1
  s_add_u32 s6, s6, 14
  s_sub_u32 s6, s6, s25
La_sl_blk:
  v_mov_b32 v192, 0
  v_mov_b32 v193, 0
  v_mov_b32 v194, 0
  v_mov_b32 v195, 0
  v_mov_b32 v196, 0
  v_mov_b32 v197, 0
  v_mov_b32 v198, 0
  v_mov_b32 v199, 0
  v_mov_b32 v200, 0
  v_mov_b32 v201, 0
  v_mov_b32 v202, 0
  v_mov_b32 v203, 0
  v_mov_b32 v204, 0
  v_mov_b32 v205, 0
  v_mov_b32 v206, 0
  v_mov_b32 v207, 0
  v_mov_b32 v208, 0
  v_mov_b32 v209, 0
  v_mov_b32 v210, 0
  v_mov_b32 v211, 0
  v_mov_b32 v212, 0
  v_mov_b32 v213, 0
  v_mov_b32 v214, 0
  v_mov_b32 v215, 0
  v_mov_b32 v216, 0
  v_mov_b32 v217, 0
  v_mov_b32 v218, 0
  v_mov_b32 v219, 0
  v_mov_b32 v220, 0
  v_mov_b32 v221, 0
  v_mov_b32 v222, 0
  v_mov_b32 v223, 0
  v_mov_b32 v224, 0
  v_mov_b32 v225, 0
  v_mov_b32 v226, 0
  v_mov_b32 v227, 0
  v_mov_b32 v228, 0
  v_mov_b32 v229, 0
  v_mov_b32 v230, 0
  v_mov_b32 v231, 0
  v_mov_b32 v232, 0
  v_mov_b32 v233, 0
  v_mov_b32 v234, 0
  v_mov_b32 v235, 0
  v_mov_b32 v236, 0
  v_mov_b32 v237, 0
  v_mov_b32 v238, 0
  v_mov_b32 v239, 0
  v_mov_b32 v240, 0
  v_mov_b32 v241, 0
  v_mov_b32 v242, 0
  v_mov_b32 v243, 0
  v_mov_b32 v244, 0
  v_mov_b32 v245, 0
  v_mov_b32 v246, 0
  v_mov_b32 v247, 0
  v_mov_b32 v248, 0
  v_mov_b32 v249, 0
  v_mov_b32 v250, 0
  v_mov_b32 v251, 0
  v_mov_b32 v252, 0
  v_mov_b32 v253, 0
  v_mov_b32 v254, 0
  v_mov_b32 v255, 0
  v_mov_b32 v24, 0
  v_mov_b32 v25, 0
  v_mov_b32 v26, 0
  v_mov_b32 v27, 0
  v_mov_b32 v28, 0
  v_mov_b32 v29, 0
  v_mov_b32 v30, 0
  v_mov_b32 v31, 0
  v_mov_b32 v16, v5
  v_mov_b32 v17, v5
  v_and_b32 v20, 15, v1
  v_lshrrev_b32 v21, 4, v1
  v_sub_u32 v20, v20, v21
  v_lshlrev_b32 v20, 2, v20
  s_lshl_b32 s4, s6, 7
  s_add_u32 s4, s4, s3
  v_add_u32 v20, s4, v20
  v_add_u32 v21, 64, v20
  s_add_u32 s7, s6, 1
  s_lshl_b32 s7, s7, 2
  s_mov_b32 s90, 0
La_sl_loop:
  s_add_u32 s4, s90, 0
  buffer_load_dwordx4 a[0:3], v2, s[20:23], s4 offen offset:0 sc1
  buffer_load_dwordx4 a[4:7], v2, s[20:23], s4 offen offset:1024 sc1
  buffer_load_dwordx4 a[8:11], v2, s[20:23], s4 offen offset:2048 sc1
  buffer_load_dwordx4 a[12:15], v2, s[20:23], s4 offen offset:3072 sc1
  s_add_u32 s4, s90, 4096
  buffer_load_dwordx4 a[16:19], v2, s[20:23], s4 offen offset:0 sc1
  buffer_load_dwordx4 a[20:23], v2, s[20:23], s4 offen offset:1024 sc1
  buffer_load_dwordx4 a[24:27], v2, s[20:23], s4 offen offset:2048 sc1
  buffer_load_dwordx4 a[28:31], v2, s[20:23], s4 offen offset:3072 sc1
  s_add_u32 s4, s90, 16384
  buffer_load_dwordx4 a[32:35], v2, s[20:23], s4 offen offset:0 sc1
  buffer_load_dwordx4 a[36:39], v2, s[20:23], s4 offen offset:1024 sc1
  buffer_load_dwordx4 a[40:43], v2, s[20:23], s4 offen offset:2048 sc1
  buffer_load_dwordx4 a[44:47], v2, s[20:23], s4 offen offset:3072 sc1
  s_add_u32 s4, s90, 20480
  buffer_load_dwordx4 a[48:51], v2, s[20:23], s4 offen offset:0 sc1
  buffer_load_dwordx4 a[52:55], v2, s[20:23], s4 offen offset:1024 sc1
  buffer_load_dwordx4 a[56:59], v2, s[20:23], s4 offen offset:2048 sc1
  buffer_load_dwordx4 a[60:63], v2, s[20:23], s4 offen offset:3072 sc1
  s_waitcnt vmcnt(0)
  v_mfma_f32_16x16x32_bf16 v[64:67], a[0:3], a[160:163], 0
  v_mfma_f32_16x16x32_bf16 v[72:75], a[0:3], a[176:179], 0
  v_mfma_f32_16x16x32_bf16 v[64:67], a[4:7], a[164:167], v[64:67]
  v_mfma_f32_16x16x32_bf16 v[72:75], a[4:7], a[180:183], v[72:75]
  v_mfma_f32_16x16x32_bf16 v[64:67], a[8:11], a[168:171], v[64:67]
  v_mfma_f32_16x16x32_bf16 v[72:75], a[8:11], a[184:187], v[72:75]
  v_mfma_f32_16x16x32_bf16 v[64:67], a[12:15], a[172:175], v[64:67]
  v_mfma_f32_16x16x32_bf16 v[72:75], a[12:15], a[188:191], v[72:75]
  v_mfma_f32_16x16x32_bf16 v[68:71], a[16:19], a[160:163], 0
  v_mfma_f32_16x16x32_bf16 v[76:79], a[16:19], a[176:179], 0
  v_mfma_f32_16x16x32_bf16 v[68:71], a[20:23], a[164:167], v[68:71]
  v_mfma_f32_16x16x32_bf16 v[76:79], a[20:23], a[180:183], v[76:79]
  v_mfma_f32_16x16x32_bf16 v[68:71], a[24:27], a[168:171], v[68:71]
  v_mfma_f32_16x16x32_bf16 v[76:79], a[24:27], a[184:187], v[76:79]
  v_mfma_f32_16x16x32_bf16 v[68:71], a[28:31], a[172:175], v[68:71]
  v_mfma_f32_16x16x32_bf16 v[76:79], a[28:31], a[188:191], v[76:79]
  v_cmp_gt_i32 vcc, 0, v20
  s_nop 1
  v_cndmask_b32 v64, v64, v5, vcc
  v_cmp_gt_i32 vcc, 1, v20
  s_nop 1
  v_cndmask_b32 v65, v65, v5, vcc
  v_cmp_gt_i32 vcc, 2, v20
  s_nop 1
  v_cndmask_b32 v66, v66, v5, vcc
  v_cmp_gt_i32 vcc, 3, v20
  s_nop 1
  v_cndmask_b32 v67, v67, v5, vcc
  v_cmp_gt_i32 vcc, 16, v20
  s_nop 1
  v_cndmask_b32 v68, v68, v5, vcc
  v_cmp_gt_i32 vcc, 17, v20
  s_nop 1
  v_cndmask_b32 v69, v69, v5, vcc
  v_cmp_gt_i32 vcc, 18, v20
  s_nop 1
  v_cndmask_b32 v70, v70, v5, vcc
  v_cmp_gt_i32 vcc, 19, v20
  s_nop 1
  v_cndmask_b32 v71, v71, v5, vcc
  v_subrev_u32 v20, 32, v20
  v_max3_f32 v6, v64, v65, v66
  v_max3_f32 v7, v67, v68, v69
  v_max3_f32 v6, v6, v70, v71
  v_max_f32 v6, v6, v7
  v_cmp_gt_i32 vcc, 0, v21
  s_nop 1
  v_cndmask_b32 v72, v72, v5, vcc
  v_cmp_gt_i32 vcc, 1, v21
  s_nop 1
  v_cndmask_b32 v73, v73, v5, vcc
  v_cmp_gt_i32 vcc, 2, v21
  s_nop 1
  v_cndmask_b32 v74, v74, v5, vcc
  v_cmp_gt_i32 vcc, 3, v21
  s_nop 1
  v_cndmask_b32 v75, v75, v5, vcc
  v_cmp_gt_i32 vcc, 16, v21
  s_nop 1
  v_cndmask_b32 v76, v76, v5, vcc
  v_cmp_gt_i32 vcc, 17, v21
  s_nop 1
  v_cndmask_b32 v77, v77, v5, vcc
  v_cmp_gt_i32 vcc, 18, v21
  s_nop 1
  v_cndmask_b32 v78, v78, v5, vcc
  v_cmp_gt_i32 vcc, 19, v21
  s_nop 1
  v_cndmask_b32 v79, v79, v5, vcc
  v_subrev_u32 v21, 32, v21
  v_max3_f32 v8, v72, v73, v74
  v_max3_f32 v9, v75, v76, v77
  v_max3_f32 v8, v8, v78, v79
  v_max_f32 v8, v8, v9
  v_mov_b32 v7, v6
  v_mov_b32 v9, v8
  s_nop 0
  v_permlane32_swap_b32 v6, v7
  v_permlane32_swap_b32 v8, v9
  v_max_f32 v6, v6, v7
  v_max_f32 v8, v8, v9
  v_mov_b32 v7, v6
  v_mov_b32 v9, v8
  s_nop 0
  v_permlane16_swap_b32 v6, v7
  v_permlane16_swap_b32 v8, v9
  v_max_f32 v6, v6, v7
  v_max_f32 v8, v8, v9
  v_max_f32 v6, v6, v16
  v_sub_f32 v7, v16, v6
  v_exp_f32 v7, v7
  v_mov_b32 v16, v6
  v_sub_f32 v64, v64, v16
  v_sub_f32 v65, v65, v16
  v_sub_f32 v66, v66, v16
  v_sub_f32 v67, v67, v16
  v_sub_f32 v68, v68, v16
  v_sub_f32 v69, v69, v16
  v_sub_f32 v70, v70, v16
  v_sub_f32 v71, v71, v16
  v_exp_f32 v64, v64
  v_exp_f32 v65, v65
  v_exp_f32 v66, v66
  v_exp_f32 v67, v67
  v_exp_f32 v68, v68
  v_exp_f32 v69, v69
  v_exp_f32 v70, v70
  v_exp_f32 v71, v71
  v_mul_f32 v24, v24, v7
  v_mul_f32 v25, v25, v7
  v_mul_f32 v26, v26, v7
  v_mul_f32 v27, v27, v7
  v_mul_f32 v192, v192, v7
  v_mul_f32 v193, v193, v7
  v_mul_f32 v194, v194, v7
  v_mul_f32 v195, v195, v7
  v_mul_f32 v196, v196, v7
  v_mul_f32 v197, v197, v7
  v_mul_f32 v198, v198, v7
  v_mul_f32 v199, v199, v7
  v_mul_f32 v200, v200, v7
  v_mul_f32 v201, v201, v7
  v_mul_f32 v202, v202, v7
  v_mul_f32 v203, v203, v7
  v_mul_f32 v204, v204, v7
  v_mul_f32 v205, v205, v7
  v_mul_f32 v206, v206, v7
  v_mul_f32 v207, v207, v7
  v_mul_f32 v208, v208, v7
  v_mul_f32 v209, v209, v7
  v_mul_f32 v210, v210, v7
  v_mul_f32 v211, v211, v7
  v_mul_f32 v212, v212, v7
  v_mul_f32 v213, v213, v7
  v_mul_f32 v214, v214, v7
  v_mul_f32 v215, v215, v7
  v_mul_f32 v216, v216, v7
  v_mul_f32 v217, v217, v7
  v_mul_f32 v218, v218, v7
  v_mul_f32 v219, v219, v7
  v_mul_f32 v220, v220, v7
  v_mul_f32 v221, v221, v7
  v_mul_f32 v222, v222, v7
  v_mul_f32 v223, v223, v7
  v_cvt_pk_bf16_f32 v32, v64, v65
  v_cvt_pk_bf16_f32 v33, v66, v67
  v_cvt_pk_bf16_f32 v34, v68, v69
  v_cvt_pk_bf16_f32 v35, v70, v71
  v_max_f32 v8, v8, v17
  v_sub_f32 v9, v17, v8
  v_exp_f32 v9, v9
  v_mov_b32 v17, v8
  v_sub_f32 v72, v72, v17
  v_sub_f32 v73, v73, v17
  v_sub_f32 v74, v74, v17
  v_sub_f32 v75, v75, v17
  v_sub_f32 v76, v76, v17
  v_sub_f32 v77, v77, v17
  v_sub_f32 v78, v78, v17
  v_sub_f32 v79, v79, v17
  v_exp_f32 v72, v72
  v_exp_f32 v73, v73
  v_exp_f32 v74, v74
  v_exp_f32 v75, v75
  v_exp_f32 v76, v76
  v_exp_f32 v77, v77
  v_exp_f32 v78, v78
  v_exp_f32 v79, v79
  v_mul_f32 v28, v28, v9
  v_mul_f32 v29, v29, v9
  v_mul_f32 v30, v30, v9
  v_mul_f32 v31, v31, v9
  v_mul_f32 v224, v224, v9
  v_mul_f32 v225, v225, v9
  v_mul_f32 v226, v226, v9
  v_mul_f32 v227, v227, v9
  v_mul_f32 v228, v228, v9
  v_mul_f32 v229, v229, v9
  v_mul_f32 v230, v230, v9
  v_mul_f32 v231, v231, v9
  v_mul_f32 v232, v232, v9
  v_mul_f32 v233, v233, v9
  v_mul_f32 v234, v234, v9
  v_mul_f32 v235, v235, v9
  v_mul_f32 v236, v236, v9
  v_mul_f32 v237, v237, v9
  v_mul_f32 v238, v238, v9
  v_mul_f32 v239, v239, v9
  v_mul_f32 v240, v240, v9
  v_mul_f32 v241, v241, v9
  v_mul_f32 v242, v242, v9
  v_mul_f32 v243, v243, v9
  v_mul_f32 v244, v244, v9
  v_mul_f32 v245, v245, v9
  v_mul_f32 v246, v246, v9
  v_mul_f32 v247, v247, v9
  v_mul_f32 v248, v248, v9
  v_mul_f32 v249, v249, v9
  v_mul_f32 v250, v250, v9
  v_mul_f32 v251, v251, v9
  v_mul_f32 v252, v252, v9
  v_mul_f32 v253, v253, v9
  v_mul_f32 v254, v254, v9
  v_mul_f32 v255, v255, v9
  v_cvt_pk_bf16_f32 v36, v72, v73
  v_cvt_pk_bf16_f32 v37, v74, v75
  v_cvt_pk_bf16_f32 v38, v76, v77
  v_cvt_pk_bf16_f32 v39, v78, v79
  v_mfma_f32_16x16x32_bf16 v[24:27], a[208:211], v[32:35], v[24:27]
  v_mfma_f32_16x16x32_bf16 v[192:195], a[32:35], v[32:35], v[192:195]
  v_mfma_f32_16x16x32_bf16 v[196:199], a[36:39], v[32:35], v[196:199]
  v_mfma_f32_16x16x32_bf16 v[200:203], a[40:43], v[32:35], v[200:203]
  v_mfma_f32_16x16x32_bf16 v[204:207], a[44:47], v[32:35], v[204:207]
  v_mfma_f32_16x16x32_bf16 v[208:211], a[48:51], v[32:35], v[208:211]
  v_mfma_f32_16x16x32_bf16 v[212:215], a[52:55], v[32:35], v[212:215]
  v_mfma_f32_16x16x32_bf16 v[216:219], a[56:59], v[32:35], v[216:219]
  v_mfma_f32_16x16x32_bf16 v[220:223], a[60:63], v[32:35], v[220:223]
  v_mfma_f32_16x16x32_bf16 v[28:31], a[208:211], v[36:39], v[28:31]
  v_mfma_f32_16x16x32_bf16 v[224:227], a[32:35], v[36:39], v[224:227]
  v_mfma_f32_16x16x32_bf16 v[228:231], a[36:39], v[36:39], v[228:231]
  v_mfma_f32_16x16x32_bf16 v[232:235], a[40:43], v[36:39], v[232:235]
  v_mfma_f32_16x16x32_bf16 v[236:239], a[44:47], v[36:39], v[236:239]
  v_mfma_f32_16x16x32_bf16 v[240:243], a[48:51], v[36:39], v[240:243]
  v_mfma_f32_16x16x32_bf16 v[244:247], a[52:55], v[36:39], v[244:247]
  v_mfma_f32_16x16x32_bf16 v[248:251], a[56:59], v[36:39], v[248:251]
  v_mfma_f32_16x16x32_bf16 v[252:255], a[60:63], v[36:39], v[252:255]
  s_add_u32 s90, s90, 8192
  s_and_b32 s4, s90, 0x4000
  s_add_u32 s90, s90, s4
  s_sub_u32 s7, s7, 1
  s_cmp_lg_u32 s7, 0
  s_cbranch_scc1 La_sl_loop
  s_lshl_b32 s4, s6, 20
  s_lshl_b32 s5, s24, 15
  s_add_u32 s4, s4, s5
  s_lshl_b32 s5, s3, 11
  s_add_u32 s4, s4, s5
  v_rcp_f32 v6, v24
  s_nop 0
  v_mov_b32 v7, v6
  v_rcp_f32 v8, v28
  s_nop 0
  v_mov_b32 v9, v8
  v_pk_mul_f32 v[192:193], v[192:193], v[6:7]
  v_pk_mul_f32 v[194:195], v[194:195], v[6:7]
  v_pk_mul_f32 v[196:197], v[196:197], v[6:7]
  v_pk_mul_f32 v[198:199], v[198:199], v[6:7]
  v_cvt_pk_bf16_f32 v192, v192, v193
  v_cvt_pk_bf16_f32 v193, v194, v195
  v_cvt_pk_bf16_f32 v194, v196, v197
  v_cvt_pk_bf16_f32 v195, v198, v199
  buffer_store_dwordx4 v[192:195], v2, s[16:19], s4 offen offset:0 sc1
  v_pk_mul_f32 v[224:225], v[224:225], v[8:9]
  v_pk_mul_f32 v[226:227], v[226:227], v[8:9]
  v_pk_mul_f32 v[228:229], v[228:229], v[8:9]
  v_pk_mul_f32 v[230:231], v[230:231], v[8:9]
  v_cvt_pk_bf16_f32 v224, v224, v225
  v_cvt_pk_bf16_f32 v225, v226, v227
  v_cvt_pk_bf16_f32 v226, v228, v229
  v_cvt_pk_bf16_f32 v227, v230, v231
  buffer_store_dwordx4 v[224:227], v2, s[16:19], s4 offen offset:1024 sc1
  s_add_u32 s4, s4, 8192
  v_pk_mul_f32 v[200:201], v[200:201], v[6:7]
  v_pk_mul_f32 v[202:203], v[202:203], v[6:7]
  v_pk_mul_f32 v[204:205], v[204:205], v[6:7]
  v_pk_mul_f32 v[206:207], v[206:207], v[6:7]
  v_cvt_pk_bf16_f32 v200, v200, v201
  v_cvt_pk_bf16_f32 v201, v202, v203
  v_cvt_pk_bf16_f32 v202, v204, v205
  v_cvt_pk_bf16_f32 v203, v206, v207
  buffer_store_dwordx4 v[200:203], v2, s[16:19], s4 offen offset:0 sc1
  v_pk_mul_f32 v[232:233], v[232:233], v[8:9]
  v_pk_mul_f32 v[234:235], v[234:235], v[8:9]
  v_pk_mul_f32 v[236:237], v[236:237], v[8:9]
  v_pk_mul_f32 v[238:239], v[238:239], v[8:9]
  v_cvt_pk_bf16_f32 v232, v232, v233
  v_cvt_pk_bf16_f32 v233, v234, v235
  v_cvt_pk_bf16_f32 v234, v236, v237
  v_cvt_pk_bf16_f32 v235, v238, v239
  buffer_store_dwordx4 v[232:235], v2, s[16:19], s4 offen offset:1024 sc1
  s_add_u32 s4, s4, 8192
  v_pk_mul_f32 v[208:209], v[208:209], v[6:7]
  v_pk_mul_f32 v[210:211], v[210:211], v[6:7]
  v_pk_mul_f32 v[212:213], v[212:213], v[6:7]
  v_pk_mul_f32 v[214:215], v[214:215], v[6:7]
  v_cvt_pk_bf16_f32 v208, v208, v209
  v_cvt_pk_bf16_f32 v209, v210, v211
  v_cvt_pk_bf16_f32 v210, v212, v213
  v_cvt_pk_bf16_f32 v211, v214, v215
  buffer_store_dwordx4 v[208:211], v2, s[16:19], s4 offen offset:0 sc1
  v_pk_mul_f32 v[240:241], v[240:241], v[8:9]
  v_pk_mul_f32 v[242:243], v[242:243], v[8:9]
  v_pk_mul_f32 v[244:245], v[244:245], v[8:9]
  v_pk_mul_f32 v[246:247], v[246:247], v[8:9]
  v_cvt_pk_bf16_f32 v240, v240, v241
  v_cvt_pk_bf16_f32 v241, v242, v243
  v_cvt_pk_bf16_f32 v242, v244, v245
  v_cvt_pk_bf16_f32 v243, v246, v247
  buffer_store_dwordx4 v[240:243], v2, s[16:19], s4 offen offset:1024 sc1
  s_add_u32 s4, s4, 8192
  v_pk_mul_f32 v[216:217], v[216:217], v[6:7]
  v_pk_mul_f32 v[218:219], v[218:219], v[6:7]
  v_pk_mul_f32 v[220:221], v[220:221], v[6:7]
  v_pk_mul_f32 v[222:223], v[222:223], v[6:7]
  v_cvt_pk_bf16_f32 v216, v216, v217
  v_cvt_pk_bf16_f32 v217, v218, v219
  v_cvt_pk_bf16_f32 v218, v220, v221
  v_cvt_pk_bf16_f32 v219, v222, v223
  buffer_store_dwordx4 v[216:219], v2, s[16:19], s4 offen offset:0 sc1
  v_pk_mul_f32 v[248:249], v[248:249], v[8:9]
  v_pk_mul_f32 v[250:251], v[250:251], v[8:9]
  v_pk_mul_f32 v[252:253], v[252:253], v[8:9]
  v_pk_mul_f32 v[254:255], v[254:255], v[8:9]
  v_cvt_pk_bf16_f32 v248, v248, v249
  v_cvt_pk_bf16_f32 v249, v250, v251
  v_cvt_pk_bf16_f32 v250, v252, v253
  v_cvt_pk_bf16_f32 v251, v254, v255
  buffer_store_dwordx4 v[248:251], v2, s[16:19], s4 offen offset:1024 sc1
  s_cmp_eq_u32 s6, s25
  s_cbranch_scc1 La_done
  v_accvgpr_read_b32 v64, a128
  v_accvgpr_read_b32 v65, a129
  v_accvgpr_read_b32 v66, a130
  v_accvgpr_read_b32 v67, a131
  v_accvgpr_read_b32 v68, a132
  v_accvgpr_read_b32 v69, a133
  v_accvgpr_read_b32 v70, a134
  v_accvgpr_read_b32 v71, a135
  v_accvgpr_read_b32 v72, a136
  v_accvgpr_read_b32 v73, a137
  v_accvgpr_read_b32 v74, a138
  v_accvgpr_read_b32 v75, a139
  v_accvgpr_read_b32 v76, a140
  v_accvgpr_read_b32 v77, a141
  v_accvgpr_read_b32 v78, a142
  v_accvgpr_read_b32 v79, a143
  v_accvgpr_read_b32 v80, a144
  v_accvgpr_read_b32 v81, a145
  v_accvgpr_read_b32 v82, a146
  v_accvgpr_read_b32 v83, a147
  v_accvgpr_read_b32 v84, a148
  v_accvgpr_read_b32 v85, a149
  v_accvgpr_read_b32 v86, a150
  v_accvgpr_read_b32 v87, a151
  v_accvgpr_read_b32 v88, a152
  v_accvgpr_read_b32 v89, a153
  v_accvgpr_read_b32 v90, a154
  v_accvgpr_read_b32 v91, a155
  v_accvgpr_read_b32 v92, a156
  v_accvgpr_read_b32 v93, a157
  v_accvgpr_read_b32 v94, a158
  v_accvgpr_read_b32 v95, a159
  v_accvgpr_write_b32 a160, v64
  v_accvgpr_write_b32 a161, v65
  v_accvgpr_write_b32 a162, v66
  v_accvgpr_write_b32 a163, v67
  v_accvgpr_write_b32 a164, v68
  v_accvgpr_write_b32 a165, v69
  v_accvgpr_write_b32 a166, v70
  v_accvgpr_write_b32 a167, v71
  v_accvgpr_write_b32 a168, v72
  v_accvgpr_write_b32 a169, v73
  v_accvgpr_write_b32 a170, v74
  v_accvgpr_write_b32 a171, v75
  v_accvgpr_write_b32 a172, v76
  v_accvgpr_write_b32 a173, v77
  v_accvgpr_write_b32 a174, v78
  v_accvgpr_write_b32 a175, v79
  v_accvgpr_write_b32 a176, v80
  v_accvgpr_write_b32 a177, v81
  v_accvgpr_write_b32 a178, v82
  v_accvgpr_write_b32 a179, v83
  v_accvgpr_write_b32 a180, v84
  v_accvgpr_write_b32 a181, v85
  v_accvgpr_write_b32 a182, v86
  v_accvgpr_write_b32 a183, v87
  v_accvgpr_write_b32 a184, v88
  v_accvgpr_write_b32 a185, v89
  v_accvgpr_write_b32 a186, v90
  v_accvgpr_write_b32 a187, v91
  v_accvgpr_write_b32 a188, v92
  v_accvgpr_write_b32 a189, v93
  v_accvgpr_write_b32 a190, v94
  v_accvgpr_write_b32 a191, v95
  s_mov_b32 s6, s25
  s_branch La_sl_blk
La_done:
  s_lshr_b32 s4, s3, 1
  s_lshl_b32 s4, s4, 12
  s_add_u32 s4, s4, 131072
  s_lshl_b32 s5, s77, 11
  s_add_u32 s4, s4, s5
  v_add_u32 v16, s4, v2
  v_xor_b32 v17, 0x800, v16
  s_and_b32 s4, s3, 1
  s_lshl_b32 s4, s4, 13
  s_add_u32 s4, s4, 131072
  v_lshrrev_b32 v24, 2, v1
  v_and_b32 v25, 6, v24
  v_lshlrev_b32 v24, 7, v24
  v_and_b32 v26, 1, v1
  v_lshl_add_u32 v24, v26, 3, v24
  v_add_u32 v24, s4, v24
  v_bfe_u32 v26, v1, 1, 1
  v_xor_b32 v25, v25, v26
  v_xor_b32 v26, 0, v25
  v_lshl_add_u32 v18, v26, 4, v24
  v_xor_b32 v26, 2, v25
  v_lshl_add_u32 v19, v26, 4, v24
  v_xor_b32 v26, 4, v25
  v_lshl_add_u32 v20, v26, 4, v24
  v_xor_b32 v26, 6, v25
  v_lshl_add_u32 v21, v26, 4, v24
  s_mov_b32 s65, 0
  s_mov_b32 s67, 4294868992
  s_mov_b32 s68, 32768
  s_mov_b32 s65, 3
  s_lshl_b32 s36, s24, 7
  s_add_u32 s36, s36, 65536
  s_and_b32 s37, s25, 1
  s_lshl_b32 s37, s37, 1
  s_add_u32 s37, s37, 14
  s_sub_u32 s37, s37, s25
  s_lshl_b32 s37, s37, 12
  s_add_u32 s37, s37, s36
  s_lshl_b32 s38, s25, 12
  s_add_u32 s36, s36, s38
  s_lshl_b32 s38, s78, 1
  s_add_u32 s38, s38, s77
  s_lshl_b32 s38, s38, 7
  s_add_u32 s38, s38, 163840
  s_lshl_b32 s91, s73, 12
  s_add_u32 s91, s91, 65536
  s_lshl_b32 s39, s78, 1
  s_add_u32 s39, s39, s77
  s_xor_b32 s39, s39, 1
  s_lshl_b32 s39, s39, 7
  s_add_u32 s39, s39, 163840
  s_sub_u32 s39, s39, s91
  v_mov_b32 v8, 0x40000000
  v_mov_b32 v6, s94
  v_cmp_eq_u32 vcc, 0, v0
  v_mov_b32 v7, s95
  s_nop 0
  v_cndmask_b32_e64 v8, v8, 0, vcc
  v_lshlrev_b32 v14, 7, v1
  v_mov_b32 v9, s39
  v_cmp_gt_u32 vcc, 32, v1
  s_nop 1
  v_cndmask_b32 v14, v9, v14, vcc
  s_waitcnt vmcnt(16)
  s_barrier
  ds_read_b128 a[96:99], v16 offset:0
  ds_read_b128 a[112:115], v16 offset:8192
  ds_read_b64_tr_b16 a[128:129], v18 offset:16384
  ds_read_b64_tr_b16 a[130:131], v18 offset:18432
  ds_read_b64_tr_b16 a[144:145], v18 offset:20480
  ds_read_b64_tr_b16 a[146:147], v18 offset:22528
  ds_read_b128 a[100:103], v16 offset:1024
  ds_read_b128 a[116:119], v16 offset:9216
  ds_read_b128 a[104:107], v17 offset:0
  ds_read_b128 a[120:123], v17 offset:8192
  ds_read_b128 a[108:111], v17 offset:1024
  ds_read_b128 a[124:127], v17 offset:9216
  ds_read_b64_tr_b16 a[132:133], v19 offset:16384
  ds_read_b64_tr_b16 a[134:135], v19 offset:18432
  ds_read_b64_tr_b16 a[148:149], v19 offset:20480
  ds_read_b64_tr_b16 a[150:151], v19 offset:22528
  s_waitcnt lgkmcnt(0)
  v_mfma_f32_16x16x32_bf16 v[32:35], a[128:131], a[96:99], 0
  s_add_u32 m0, s79, 81920
  ds_read_b64_tr_b16 a[136:137], v20 offset:16384
  ds_read_b64_tr_b16 a[138:139], v20 offset:18432
  v_mfma_f32_16x16x32_bf16 v[32:35], a[144:147], a[112:115], v[32:35]
  buffer_load_dwordx4 v10, s[12:15], s71 offen offset:0 lds
  v_mfma_f32_16x16x32_bf16 v[48:51], a[128:131], a[100:103], 0
  buffer_load_dwordx4 v11, s[12:15], s71 offen offset:1024 lds
  v_mfma_f32_16x16x32_bf16 v[48:51], a[144:147], a[116:119], v[48:51]
  buffer_load_dwordx4 v12, s[12:15], s71 offen offset:2048 lds
  v_mfma_f32_16x16x32_bf16 v[64:67], a[128:131], a[104:107], 0
  buffer_load_dwordx4 v13, s[12:15], s71 offen offset:3072 lds
  v_mfma_f32_16x16x32_bf16 v[64:67], a[144:147], a[120:123], v[64:67]
  s_bfe_u32 s72, 0x3020106, s31
  s_add_u32 s30, s30, s72
  s_add_u32 s31, s31, 8
  v_mfma_f32_16x16x32_bf16 v[80:83], a[128:131], a[108:111], 0
  s_and_b32 s31, s31, 0x8001f
  s_and_b32 s30, s30, 7
  s_lshl_b32 s72, s30, 17
  v_mfma_f32_16x16x32_bf16 v[80:83], a[144:147], a[124:127], v[80:83]
  s_add_u32 s71, s93, s72
  s_add_u32 m0, s79, 65536
  ds_read_b64_tr_b16 a[152:153], v20 offset:20480
  v_mfma_f32_16x16x32_bf16 v[36:39], a[132:135], a[96:99], 0
  buffer_load_dwordx4 v2, s[8:11], s70 offen offset:0 sc1 lds
  v_mfma_f32_16x16x32_bf16 v[36:39], a[148:151], a[112:115], v[36:39]
  buffer_load_dwordx4 v2, s[8:11], s70 offen offset:1024 sc1 lds
  v_mfma_f32_16x16x32_bf16 v[52:55], a[132:135], a[100:103], 0
  buffer_load_dwordx4 v2, s[8:11], s70 offen offset:2048 sc1 lds
  v_mfma_f32_16x16x32_bf16 v[52:55], a[148:151], a[116:119], v[52:55]
  buffer_load_dwordx4 v2, s[8:11], s70 offen offset:3072 sc1 lds
  v_mfma_f32_16x16x32_bf16 v[68:71], a[132:135], a[104:107], 0
  s_add_u32 s65, s65, 1
  ds_read_b64_tr_b16 a[154:155], v20 offset:22528
  ds_read_b64_tr_b16 a[140:141], v21 offset:16384
  v_mfma_f32_16x16x32_bf16 v[68:71], a[148:151], a[120:123], v[68:71]
  s_cmp_eq_u32 s65, 4
  s_cselect_b32 s65, 0, s65
  s_cselect_b32 s66, s67, s68
  ds_read_b64_tr_b16 a[142:143], v21 offset:18432
  ds_read_b64_tr_b16 a[156:157], v21 offset:20480
  v_mfma_f32_16x16x32_bf16 v[84:87], a[132:135], a[108:111], 0
  s_bfe_u32 s72, 0x3020106, s1
  s_add_u32 s0, s0, s72
  ds_read_b64_tr_b16 a[158:159], v21 offset:22528
  v_mfma_f32_16x16x32_bf16 v[84:87], a[148:151], a[124:127], v[84:87]
  s_add_u32 s1, s1, 8
  s_and_b32 s1, s1, 0x8001f
  s_and_b32 s0, s0, 7
  s_lshl_b32 s72, s0, 14
  s_add_u32 s70, s92, s72
  v_add_u32 v16, s66, v16
  v_add_u32 v17, s66, v17
  v_add_u32 v18, s66, v18
  v_add_u32 v19, s66, v19
  v_add_u32 v20, s66, v20
  v_add_u32 v21, s66, v21
  s_waitcnt vmcnt(8) lgkmcnt(0)
  s_barrier
  v_mfma_f32_16x16x32_bf16 v[40:43], a[136:139], a[96:99], 0
  buffer_store_dwordx2 v[6:7], v8, s[96:99], s36 offen sc1
  v_mfma_f32_16x16x32_bf16 v[40:43], a[152:155], a[112:115], v[40:43]
  buffer_store_dwordx2 v[6:7], v8, s[96:99], s37 offen sc1
  v_mfma_f32_16x16x32_bf16 v[56:59], a[136:139], a[100:103], 0
  ds_read_b128 a[64:67], v16 offset:0
  ds_read_b128 a[80:83], v16 offset:8192
  v_mfma_f32_16x16x32_bf16 v[56:59], a[152:155], a[116:119], v[56:59]
  buffer_store_dwordx2 v[6:7], v8, s[96:99], s38 offen sc1
  v_mfma_f32_16x16x32_bf16 v[72:75], a[136:139], a[104:107], 0
  s_add_u32 m0, s79, 114688
  ds_read_b64_tr_b16 a[128:129], v18 offset:16384
  ds_read_b64_tr_b16 a[130:131], v18 offset:18432
  v_mfma_f32_16x16x32_bf16 v[72:75], a[152:155], a[120:123], v[72:75]
  buffer_load_dwordx4 v10, s[12:15], s71 offen offset:0 lds
  v_mfma_f32_16x16x32_bf16 v[88:91], a[136:139], a[108:111], 0
  buffer_load_dwordx4 v11, s[12:15], s71 offen offset:1024 lds
  v_mfma_f32_16x16x32_bf16 v[88:91], a[152:155], a[124:127], v[88:91]
  buffer_load_dwordx4 v12, s[12:15], s71 offen offset:2048 lds
  v_mfma_f32_16x16x32_bf16 v[44:47], a[140:143], a[96:99], 0
  ds_read_b64_tr_b16 a[144:145], v18 offset:20480
  ds_read_b64_tr_b16 a[146:147], v18 offset:22528
  v_mfma_f32_16x16x32_bf16 v[44:47], a[156:159], a[112:115], v[44:47]
  buffer_load_dwordx4 v13, s[12:15], s71 offen offset:3072 lds
  v_mfma_f32_16x16x32_bf16 v[60:63], a[140:143], a[100:103], 0
  s_bfe_u32 s72, 0x3020106, s31
  s_add_u32 s30, s30, s72
  s_add_u32 s31, s31, 8
  v_mfma_f32_16x16x32_bf16 v[60:63], a[156:159], a[116:119], v[60:63]
  s_and_b32 s31, s31, 0x8001f
  s_and_b32 s30, s30, 7
  s_lshl_b32 s72, s30, 17
  v_mfma_f32_16x16x32_bf16 v[76:79], a[140:143], a[104:107], 0
  s_add_u32 s71, s93, s72
  s_add_u32 m0, s79, 98304
  ds_read_b128 a[68:71], v16 offset:1024
  v_mfma_f32_16x16x32_bf16 v[76:79], a[156:159], a[120:123], v[76:79]
  buffer_load_dwordx4 v2, s[8:11], s70 offen offset:0 sc1 lds
  ds_read_b128 a[84:87], v16 offset:9216
  v_mfma_f32_16x16x32_bf16 v[92:95], a[140:143], a[108:111], 0
  buffer_load_dwordx4 v2, s[8:11], s70 offen offset:1024 sc1 lds
  ds_read_b128 a[72:75], v17 offset:0
  v_mfma_f32_16x16x32_bf16 v[92:95], a[156:159], a[124:127], v[92:95]
  buffer_load_dwordx4 v2, s[8:11], s70 offen offset:2048 sc1 lds
  ds_read_b128 a[88:91], v17 offset:8192
  ds_read_b128 a[76:79], v17 offset:1024
  ds_read_b128 a[92:95], v17 offset:9216
  ds_read_b64_tr_b16 a[132:133], v19 offset:16384
  ds_read_b64_tr_b16 a[134:135], v19 offset:18432
  ds_read_b64_tr_b16 a[148:149], v19 offset:20480
  ds_read_b64_tr_b16 a[150:151], v19 offset:22528
  s_waitcnt lgkmcnt(0)
  v_mfma_f32_16x16x32_bf16 v[32:35], a[128:131], a[64:67], v[32:35]
  buffer_load_dwordx4 v2, s[8:11], s70 offen offset:3072 sc1 lds
  v_mfma_f32_16x16x32_bf16 v[32:35], a[144:147], a[80:83], v[32:35]
  s_bfe_u32 s72, 0x3020106, s1
  s_add_u32 s0, s0, s72
  s_add_u32 s1, s1, 8
  v_mfma_f32_16x16x32_bf16 v[48:51], a[128:131], a[68:71], v[48:51]
  s_and_b32 s1, s1, 0x8001f
  s_and_b32 s0, s0, 7
  s_lshl_b32 s72, s0, 14
  v_mfma_f32_16x16x32_bf16 v[48:51], a[144:147], a[84:87], v[48:51]
  s_add_u32 s70, s92, s72
  s_add_u32 m0, s64, 16384
  ds_read_b64_tr_b16 a[136:137], v20 offset:16384
  v_mfma_f32_16x16x32_bf16 v[64:67], a[128:131], a[72:75], v[64:67]
  buffer_load_dwordx4 v10, s[12:15], s71 offen offset:0 lds
  v_mfma_f32_16x16x32_bf16 v[64:67], a[144:147], a[88:91], v[64:67]
  buffer_load_dwordx4 v11, s[12:15], s71 offen offset:1024 lds
  v_mfma_f32_16x16x32_bf16 v[80:83], a[128:131], a[76:79], v[80:83]
  buffer_load_dwordx4 v12, s[12:15], s71 offen offset:2048 lds
  v_mfma_f32_16x16x32_bf16 v[80:83], a[144:147], a[92:95], v[80:83]
  buffer_load_dwordx4 v13, s[12:15], s71 offen offset:3072 lds
  v_mfma_f32_16x16x32_bf16 v[36:39], a[132:135], a[64:67], v[36:39]
  s_bfe_u32 s72, 0x3020106, s31
  s_add_u32 s30, s30, s72
  s_add_u32 s31, s31, 8
  v_mfma_f32_16x16x32_bf16 v[36:39], a[148:151], a[80:83], v[36:39]
  s_and_b32 s31, s31, 0x8001f
  s_and_b32 s30, s30, 7
  s_lshl_b32 s72, s30, 17
  v_mfma_f32_16x16x32_bf16 v[52:55], a[132:135], a[68:71], v[52:55]
  s_add_u32 s71, s93, s72
  s_mov_b32 m0, s64
  ds_read_b64_tr_b16 a[138:139], v20 offset:18432
  v_mfma_f32_16x16x32_bf16 v[52:55], a[148:151], a[84:87], v[52:55]
  buffer_load_dwordx4 v2, s[8:11], s70 offen offset:0 sc1 lds
  s_add_u32 s64, s64, s66
  s_add_u32 s65, s65, 1
  s_cmp_eq_u32 s65, 4
  s_cselect_b32 s65, 0, s65
  s_cselect_b32 s66, s67, s68
  v_mfma_f32_16x16x32_bf16 v[68:71], a[132:135], a[72:75], v[68:71]
  buffer_load_dwordx4 v2, s[8:11], s70 offen offset:1024 sc1 lds
  v_mfma_f32_16x16x32_bf16 v[68:71], a[148:151], a[88:91], v[68:71]
  buffer_load_dwordx4 v2, s[8:11], s70 offen offset:2048 sc1 lds
  v_mfma_f32_16x16x32_bf16 v[84:87], a[132:135], a[76:79], v[84:87]
  buffer_load_dwordx4 v2, s[8:11], s70 offen offset:3072 sc1 lds
  v_mfma_f32_16x16x32_bf16 v[84:87], a[148:151], a[92:95], v[84:87]
  s_bfe_u32 s72, 0x3020106, s1
  s_add_u32 s0, s0, s72
  s_add_u32 s1, s1, 8
  s_and_b32 s1, s1, 0x8001f
  s_and_b32 s0, s0, 7
  s_lshl_b32 s72, s0, 14
  s_add_u32 s70, s92, s72
  ds_read_b64_tr_b16 a[152:153], v20 offset:20480
  ds_read_b64_tr_b16 a[154:155], v20 offset:22528
  ds_read_b64_tr_b16 a[140:141], v21 offset:16384
  ds_read_b64_tr_b16 a[142:143], v21 offset:18432
  ds_read_b64_tr_b16 a[156:157], v21 offset:20480
  ds_read_b64_tr_b16 a[158:159], v21 offset:22528
  v_add_u32 v16, s66, v16
  v_add_u32 v17, s66, v17
  v_add_u32 v18, s66, v18
  v_add_u32 v19, s66, v19
  v_add_u32 v20, s66, v20
  v_add_u32 v21, s66, v21
  s_waitcnt vmcnt(19) lgkmcnt(0)
  s_barrier
  v_mfma_f32_16x16x32_bf16 v[40:43], a[136:139], a[64:67], v[40:43]
  s_add_u32 s16, s86, 100663296
  s_addc_u32 s17, s87, 0
  s_mov_b32 s18, 16777216
  v_mfma_f32_16x16x32_bf16 v[40:43], a[152:155], a[80:83], v[40:43]
  s_mov_b32 s19, 0x00020000
  s_add_u32 m0, s64, 16384
  ds_read_b128 a[96:99], v16 offset:0
  v_mfma_f32_16x16x32_bf16 v[56:59], a[136:139], a[68:71], v[56:59]
  buffer_load_dwordx4 v10, s[12:15], s71 offen offset:0 lds
  v_mfma_f32_16x16x32_bf16 v[56:59], a[152:155], a[84:87], v[56:59]
  buffer_load_dwordx4 v11, s[12:15], s71 offen offset:1024 lds
  v_mfma_f32_16x16x32_bf16 v[72:75], a[136:139], a[72:75], v[72:75]
  ds_read_b128 a[112:115], v16 offset:8192
  ds_read_b64_tr_b16 a[128:129], v18 offset:16384
  v_mfma_f32_16x16x32_bf16 v[72:75], a[152:155], a[88:91], v[72:75]
  ds_read_b64_tr_b16 a[130:131], v18 offset:18432
  ds_read_b64_tr_b16 a[144:145], v18 offset:20480
  v_mfma_f32_16x16x32_bf16 v[88:91], a[136:139], a[76:79], v[88:91]
  ds_read_b64_tr_b16 a[146:147], v18 offset:22528
  ds_read_b128 a[100:103], v16 offset:1024
  v_mfma_f32_16x16x32_bf16 v[88:91], a[152:155], a[92:95], v[88:91]
  buffer_load_dwordx4 v12, s[12:15], s71 offen offset:2048 lds
  v_mfma_f32_16x16x32_bf16 v[44:47], a[140:143], a[64:67], v[44:47]
  ds_read_b128 a[116:119], v16 offset:9216
  ds_read_b128 a[104:107], v17 offset:0
  v_mfma_f32_16x16x32_bf16 v[44:47], a[156:159], a[80:83], v[44:47]
  ds_read_b128 a[120:123], v17 offset:8192
  ds_read_b128 a[108:111], v17 offset:1024
  v_mfma_f32_16x16x32_bf16 v[60:63], a[140:143], a[68:71], v[60:63]
  ds_read_b128 a[124:127], v17 offset:9216
  ds_read_b64_tr_b16 a[132:133], v19 offset:16384
  v_mfma_f32_16x16x32_bf16 v[60:63], a[156:159], a[84:87], v[60:63]
  buffer_load_dwordx4 v13, s[12:15], s71 offen offset:3072 lds
  v_mfma_f32_16x16x32_bf16 v[76:79], a[140:143], a[72:75], v[76:79]
  s_bfe_u32 s72, 0x3020106, s31
  ds_read_b64_tr_b16 a[134:135], v19 offset:18432
  ds_read_b64_tr_b16 a[148:149], v19 offset:20480
  v_mfma_f32_16x16x32_bf16 v[76:79], a[156:159], a[88:91], v[76:79]
  s_add_u32 s30, s30, s72
  ds_read_b64_tr_b16 a[150:151], v19 offset:22528
  v_mfma_f32_16x16x32_bf16 v[92:95], a[140:143], a[76:79], v[92:95]
  s_add_u32 s31, s31, 8
  s_and_b32 s31, s31, 0x8001f
  v_mfma_f32_16x16x32_bf16 v[92:95], a[156:159], a[92:95], v[92:95]
  s_and_b32 s30, s30, 7
  s_lshl_b32 s72, s30, 17
  s_add_u32 s71, s93, s72
  s_waitcnt lgkmcnt(0)
  v_mfma_f32_16x16x32_bf16 v[32:35], a[128:131], a[96:99], v[32:35]
  s_mov_b32 m0, s64
  ds_read_b64_tr_b16 a[136:137], v20 offset:16384
  ds_read_b64_tr_b16 a[138:139], v20 offset:18432
  v_mfma_f32_16x16x32_bf16 v[32:35], a[144:147], a[112:115], v[32:35]
  buffer_load_dwordx4 v2, s[8:11], s70 offen offset:0 sc1 lds
  v_mfma_f32_16x16x32_bf16 v[48:51], a[128:131], a[100:103], v[48:51]
  buffer_load_dwordx4 v2, s[8:11], s70 offen offset:1024 sc1 lds
  v_mfma_f32_16x16x32_bf16 v[48:51], a[144:147], a[116:119], v[48:51]
  s_add_u32 s64, s64, s66
  ds_read_b64_tr_b16 a[152:153], v20 offset:20480
  ds_read_b64_tr_b16 a[154:155], v20 offset:22528
  v_mfma_f32_16x16x32_bf16 v[64:67], a[128:131], a[104:107], v[64:67]
  buffer_load_dwordx4 v2, s[8:11], s70 offen offset:2048 sc1 lds
  v_mfma_f32_16x16x32_bf16 v[64:67], a[144:147], a[120:123], v[64:67]
  s_add_u32 s65, s65, 1
  ds_read_b64_tr_b16 a[140:141], v21 offset:16384
  ds_read_b64_tr_b16 a[142:143], v21 offset:18432
  v_mfma_f32_16x16x32_bf16 v[80:83], a[128:131], a[108:111], v[80:83]
  buffer_load_dwordx4 v2, s[8:11], s70 offen offset:3072 sc1 lds
  v_mfma_f32_16x16x32_bf16 v[80:83], a[144:147], a[124:127], v[80:83]
  s_bfe_u32 s72, 0x3020106, s1
  ds_read_b64_tr_b16 a[156:157], v21 offset:20480
  ds_read_b64_tr_b16 a[158:159], v21 offset:22528
  v_mfma_f32_16x16x32_bf16 v[36:39], a[132:135], a[96:99], v[36:39]
  s_cmp_eq_u32 s65, 4
  s_cselect_b32 s65, 0, s65
  s_cselect_b32 s66, s67, s68
  v_mfma_f32_16x16x32_bf16 v[36:39], a[148:151], a[112:115], v[36:39]
  s_add_u32 s0, s0, s72
  v_add_u32 v16, s66, v16
  v_add_u32 v17, s66, v17
  v_mfma_f32_16x16x32_bf16 v[52:55], a[132:135], a[100:103], v[52:55]
  s_add_u32 s1, s1, 8
  v_add_u32 v18, s66, v18
  v_add_u32 v19, s66, v19
  v_mfma_f32_16x16x32_bf16 v[52:55], a[148:151], a[116:119], v[52:55]
  s_and_b32 s1, s1, 0x8001f
  v_add_u32 v20, s66, v20
  v_add_u32 v21, s66, v21
  v_mfma_f32_16x16x32_bf16 v[68:71], a[132:135], a[104:107], v[68:71]
  s_and_b32 s0, s0, 7
  s_lshl_b32 s72, s0, 14
  s_add_u32 s70, s92, s72
  v_mfma_f32_16x16x32_bf16 v[68:71], a[148:151], a[120:123], v[68:71]
  v_mfma_f32_16x16x32_bf16 v[84:87], a[132:135], a[108:111], v[84:87]
  v_mfma_f32_16x16x32_bf16 v[84:87], a[148:151], a[124:127], v[84:87]
  s_waitcnt vmcnt(16) lgkmcnt(0)
  s_barrier
  v_mfma_f32_16x16x32_bf16 v[40:43], a[136:139], a[96:99], v[40:43]
  s_add_u32 m0, s64, 16384
  ds_read_b128 a[64:67], v16 offset:0
  ds_read_b128 a[80:83], v16 offset:8192
  v_mfma_f32_16x16x32_bf16 v[40:43], a[152:155], a[112:115], v[40:43]
  buffer_load_dwordx4 v10, s[12:15], s71 offen offset:0 lds
  v_mfma_f32_16x16x32_bf16 v[56:59], a[136:139], a[100:103], v[56:59]
  ds_read_b64_tr_b16 a[128:129], v18 offset:16384
  ds_read_b64_tr_b16 a[130:131], v18 offset:18432
  v_mfma_f32_16x16x32_bf16 v[56:59], a[152:155], a[116:119], v[56:59]
  buffer_load_dwordx4 v11, s[12:15], s71 offen offset:1024 lds
  v_mfma_f32_16x16x32_bf16 v[72:75], a[136:139], a[104:107], v[72:75]
  ds_read_b64_tr_b16 a[144:145], v18 offset:20480
  ds_read_b64_tr_b16 a[146:147], v18 offset:22528
  v_mfma_f32_16x16x32_bf16 v[72:75], a[152:155], a[120:123], v[72:75]
  ds_read_b128 a[68:71], v16 offset:1024
  ds_read_b128 a[84:87], v16 offset:9216
  v_mfma_f32_16x16x32_bf16 v[88:91], a[136:139], a[108:111], v[88:91]
  ds_read_b128 a[72:75], v17 offset:0
  ds_read_b128 a[88:91], v17 offset:8192
  v_mfma_f32_16x16x32_bf16 v[88:91], a[152:155], a[124:127], v[88:91]
  buffer_load_dwordx4 v12, s[12:15], s71 offen offset:2048 lds
  v_mfma_f32_16x16x32_bf16 v[44:47], a[140:143], a[96:99], v[44:47]
  ds_read_b128 a[76:79], v17 offset:1024
  ds_read_b128 a[92:95], v17 offset:9216
  v_mfma_f32_16x16x32_bf16 v[44:47], a[156:159], a[112:115], v[44:47]
  ds_read_b64_tr_b16 a[132:133], v19 offset:16384
  ds_read_b64_tr_b16 a[134:135], v19 offset:18432
  v_mfma_f32_16x16x32_bf16 v[60:63], a[140:143], a[100:103], v[60:63]
  ds_read_b64_tr_b16 a[148:149], v19 offset:20480
  ds_read_b64_tr_b16 a[150:151], v19 offset:22528
  v_mfma_f32_16x16x32_bf16 v[60:63], a[156:159], a[116:119], v[60:63]
  buffer_load_dwordx4 v13, s[12:15], s71 offen offset:3072 lds
  v_mfma_f32_16x16x32_bf16 v[76:79], a[140:143], a[104:107], v[76:79]
  s_bfe_u32 s72, 0x3020106, s31
  v_mfma_f32_16x16x32_bf16 v[76:79], a[156:159], a[120:123], v[76:79]
  s_add_u32 s30, s30, s72
  v_mfma_f32_16x16x32_bf16 v[92:95], a[140:143], a[108:111], v[92:95]
  s_add_u32 s31, s31, 8
  s_and_b32 s31, s31, 0x8001f
  v_mfma_f32_16x16x32_bf16 v[92:95], a[156:159], a[124:127], v[92:95]
  s_and_b32 s30, s30, 7
  s_lshl_b32 s72, s30, 17
  s_add_u32 s71, s93, s72
  s_waitcnt lgkmcnt(0)
  v_mfma_f32_16x16x32_bf16 v[32:35], a[128:131], a[64:67], v[32:35]
  s_mov_b32 m0, s64
  ds_read_b64_tr_b16 a[136:137], v20 offset:16384
  ds_read_b64_tr_b16 a[138:139], v20 offset:18432
  v_mfma_f32_16x16x32_bf16 v[32:35], a[144:147], a[80:83], v[32:35]
  buffer_load_dwordx4 v2, s[8:11], s70 offen offset:0 sc1 lds
  v_mfma_f32_16x16x32_bf16 v[48:51], a[128:131], a[68:71], v[48:51]
  buffer_load_dwordx4 v2, s[8:11], s70 offen offset:1024 sc1 lds
  v_mfma_f32_16x16x32_bf16 v[48:51], a[144:147], a[84:87], v[48:51]
  s_add_u32 s64, s64, s66
  ds_read_b64_tr_b16 a[152:153], v20 offset:20480
  ds_read_b64_tr_b16 a[154:155], v20 offset:22528
  v_mfma_f32_16x16x32_bf16 v[64:67], a[128:131], a[72:75], v[64:67]
  buffer_load_dwordx4 v2, s[8:11], s70 offen offset:2048 sc1 lds
  v_mfma_f32_16x16x32_bf16 v[64:67], a[144:147], a[88:91], v[64:67]
  s_add_u32 s65, s65, 1
  ds_read_b64_tr_b16 a[140:141], v21 offset:16384
  ds_read_b64_tr_b16 a[142:143], v21 offset:18432
  v_mfma_f32_16x16x32_bf16 v[80:83], a[128:131], a[76:79], v[80:83]
  buffer_load_dwordx4 v2, s[8:11], s70 offen offset:3072 sc1 lds
  v_mfma_f32_16x16x32_bf16 v[80:83], a[144:147], a[92:95], v[80:83]
  s_bfe_u32 s72, 0x3020106, s1
  ds_read_b64_tr_b16 a[156:157], v21 offset:20480
  ds_read_b64_tr_b16 a[158:159], v21 offset:22528
  v_mfma_f32_16x16x32_bf16 v[36:39], a[132:135], a[64:67], v[36:39]
  s_cmp_eq_u32 s65, 4
  s_cselect_b32 s65, 0, s65
  s_cselect_b32 s66, s67, s68
  v_mfma_f32_16x16x32_bf16 v[36:39], a[148:151], a[80:83], v[36:39]
  s_add_u32 s0, s0, s72
  v_add_u32 v16, s66, v16
  v_add_u32 v17, s66, v17
  v_mfma_f32_16x16x32_bf16 v[52:55], a[132:135], a[68:71], v[52:55]
  s_add_u32 s1, s1, 8
  v_add_u32 v18, s66, v18
  v_add_u32 v19, s66, v19
  v_mfma_f32_16x16x32_bf16 v[52:55], a[148:151], a[84:87], v[52:55]
  s_and_b32 s1, s1, 0x8001f
  v_add_u32 v20, s66, v20
  v_add_u32 v21, s66, v21
  v_mfma_f32_16x16x32_bf16 v[68:71], a[132:135], a[72:75], v[68:71]
  s_and_b32 s0, s0, 7
  s_lshl_b32 s72, s0, 14
  s_add_u32 s70, s92, s72
  v_mfma_f32_16x16x32_bf16 v[68:71], a[148:151], a[88:91], v[68:71]
  v_mfma_f32_16x16x32_bf16 v[84:87], a[132:135], a[76:79], v[84:87]
  v_mfma_f32_16x16x32_bf16 v[84:87], a[148:151], a[92:95], v[84:87]
  s_waitcnt vmcnt(16) lgkmcnt(0)
  s_barrier
  v_mfma_f32_16x16x32_bf16 v[40:43], a[136:139], a[64:67], v[40:43]
  s_add_u32 m0, s64, 16384
  ds_read_b128 a[96:99], v16 offset:0
  ds_read_b128 a[112:115], v16 offset:8192
  v_mfma_f32_16x16x32_bf16 v[40:43], a[152:155], a[80:83], v[40:43]
  buffer_load_dwordx4 v10, s[12:15], s71 offen offset:0 lds
  v_mfma_f32_16x16x32_bf16 v[56:59], a[136:139], a[68:71], v[56:59]
  ds_read_b64_tr_b16 a[128:129], v18 offset:16384
  ds_read_b64_tr_b16 a[130:131], v18 offset:18432
  v_mfma_f32_16x16x32_bf16 v[56:59], a[152:155], a[84:87], v[56:59]
  buffer_load_dwordx4 v11, s[12:15], s71 offen offset:1024 lds
  v_mfma_f32_16x16x32_bf16 v[72:75], a[136:139], a[72:75], v[72:75]
  ds_read_b64_tr_b16 a[144:145], v18 offset:20480
  ds_read_b64_tr_b16 a[146:147], v18 offset:22528
  v_mfma_f32_16x16x32_bf16 v[72:75], a[152:155], a[88:91], v[72:75]
  ds_read_b128 a[100:103], v16 offset:1024
  ds_read_b128 a[116:119], v16 offset:9216
  v_mfma_f32_16x16x32_bf16 v[88:91], a[136:139], a[76:79], v[88:91]
  ds_read_b128 a[104:107], v17 offset:0
  ds_read_b128 a[120:123], v17 offset:8192
  v_mfma_f32_16x16x32_bf16 v[88:91], a[152:155], a[92:95], v[88:91]
  buffer_load_dwordx4 v12, s[12:15], s71 offen offset:2048 lds
  v_mfma_f32_16x16x32_bf16 v[44:47], a[140:143], a[64:67], v[44:47]
  ds_read_b128 a[108:111], v17 offset:1024
  ds_read_b128 a[124:127], v17 offset:9216
  v_mfma_f32_16x16x32_bf16 v[44:47], a[156:159], a[80:83], v[44:47]
  ds_read_b64_tr_b16 a[132:133], v19 offset:16384
  ds_read_b64_tr_b16 a[134:135], v19 offset:18432
  v_mfma_f32_16x16x32_bf16 v[60:63], a[140:143], a[68:71], v[60:63]
  ds_read_b64_tr_b16 a[148:149], v19 offset:20480
  ds_read_b64_tr_b16 a[150:151], v19 offset:22528
  v_mfma_f32_16x16x32_bf16 v[60:63], a[156:159], a[84:87], v[60:63]
  buffer_load_dwordx4 v13, s[12:15], s71 offen offset:3072 lds
  v_mfma_f32_16x16x32_bf16 v[76:79], a[140:143], a[72:75], v[76:79]
  s_bfe_u32 s72, 0x3020106, s31
  v_mfma_f32_16x16x32_bf16 v[76:79], a[156:159], a[88:91], v[76:79]
  s_add_u32 s30, s30, s72
  v_mfma_f32_16x16x32_bf16 v[92:95], a[140:143], a[76:79], v[92:95]
  s_add_u32 s31, s31, 8
  s_and_b32 s31, s31, 0x8001f
  v_mfma_f32_16x16x32_bf16 v[92:95], a[156:159], a[92:95], v[92:95]
  s_and_b32 s30, s30, 7
  s_lshl_b32 s72, s30, 17
  s_add_u32 s71, s93, s72
  s_waitcnt lgkmcnt(0)
  v_mfma_f32_16x16x32_bf16 v[32:35], a[128:131], a[96:99], v[32:35]
  s_mov_b32 m0, s64
  ds_read_b64_tr_b16 a[136:137], v20 offset:16384
  ds_read_b64_tr_b16 a[138:139], v20 offset:18432
  v_mfma_f32_16x16x32_bf16 v[32:35], a[144:147], a[112:115], v[32:35]
  buffer_load_dwordx4 v2, s[8:11], s70 offen offset:0 sc1 lds
  v_mfma_f32_16x16x32_bf16 v[48:51], a[128:131], a[100:103], v[48:51]
  buffer_load_dwordx4 v2, s[8:11], s70 offen offset:1024 sc1 lds
  v_mfma_f32_16x16x32_bf16 v[48:51], a[144:147], a[116:119], v[48:51]
  s_add_u32 s64, s64, s66
  ds_read_b64_tr_b16 a[152:153], v20 offset:20480
  ds_read_b64_tr_b16 a[154:155], v20 offset:22528
  v_mfma_f32_16x16x32_bf16 v[64:67], a[128:131], a[104:107], v[64:67]
  buffer_load_dwordx4 v2, s[8:11], s70 offen offset:2048 sc1 lds
  v_mfma_f32_16x16x32_bf16 v[64:67], a[144:147], a[120:123], v[64:67]
  s_add_u32 s65, s65, 1
  ds_read_b64_tr_b16 a[140:141], v21 offset:16384
  ds_read_b64_tr_b16 a[142:143], v21 offset:18432
  v_mfma_f32_16x16x32_bf16 v[80:83], a[128:131], a[108:111], v[80:83]
  buffer_load_dwordx4 v2, s[8:11], s70 offen offset:3072 sc1 lds
  v_mfma_f32_16x16x32_bf16 v[80:83], a[144:147], a[124:127], v[80:83]
  s_bfe_u32 s72, 0x3020106, s1
  ds_read_b64_tr_b16 a[156:157], v21 offset:20480
  ds_read_b64_tr_b16 a[158:159], v21 offset:22528
  v_mfma_f32_16x16x32_bf16 v[36:39], a[132:135], a[96:99], v[36:39]
  s_cmp_eq_u32 s65, 4
  s_cselect_b32 s65, 0, s65
  s_cselect_b32 s66, s67, s68
  v_mfma_f32_16x16x32_bf16 v[36:39], a[148:151], a[112:115], v[36:39]
  s_add_u32 s0, s0, s72
  v_add_u32 v16, s66, v16
  v_add_u32 v17, s66, v17
  v_mfma_f32_16x16x32_bf16 v[52:55], a[132:135], a[100:103], v[52:55]
  s_add_u32 s1, s1, 8
  v_add_u32 v18, s66, v18
  v_add_u32 v19, s66, v19
  v_mfma_f32_16x16x32_bf16 v[52:55], a[148:151], a[116:119], v[52:55]
  s_and_b32 s1, s1, 0x8001f
  v_add_u32 v20, s66, v20
  v_add_u32 v21, s66, v21
  v_mfma_f32_16x16x32_bf16 v[68:71], a[132:135], a[104:107], v[68:71]
  s_and_b32 s0, s0, 7
  s_lshl_b32 s72, s0, 14
  s_add_u32 s70, s92, s72
  v_mfma_f32_16x16x32_bf16 v[68:71], a[148:151], a[120:123], v[68:71]
  v_mfma_f32_16x16x32_bf16 v[84:87], a[132:135], a[108:111], v[84:87]
  v_mfma_f32_16x16x32_bf16 v[84:87], a[148:151], a[124:127], v[84:87]
  s_waitcnt vmcnt(16) lgkmcnt(0)
  s_barrier
  v_mfma_f32_16x16x32_bf16 v[40:43], a[136:139], a[96:99], v[40:43]
  buffer_load_dwordx2 v[6:7], v14, s[96:99], s91 offen sc1
  v_mfma_f32_16x16x32_bf16 v[40:43], a[152:155], a[112:115], v[40:43]
  s_mov_b32 s12, s74
  s_mov_b32 s13, s75
  s_mov_b32 s14, 8388608
  v_mfma_f32_16x16x32_bf16 v[56:59], a[136:139], a[100:103], v[56:59]
  s_mov_b32 s15, 0x00020000
  s_lshl_b32 s93, s77, 22
  s_lshl_b32 s72, s76, 8
  v_mfma_f32_16x16x32_bf16 v[56:59], a[152:155], a[116:119], v[56:59]
  s_add_u32 s93, s93, s72
  s_add_u32 s72, s73, s76
  s_and_b32 s31, s72, 3
  v_mfma_f32_16x16x32_bf16 v[72:75], a[136:139], a[104:107], v[72:75]
  s_lshl_b32 s31, s31, 3
  s_or_b32 s31, s31, 0x80000
  s_bfe_u32 s30, 0x1b1b02, s31
  v_mfma_f32_16x16x32_bf16 v[72:75], a[152:155], a[120:123], v[72:75]
  s_add_u32 s30, s30, 0
  s_cmp_ge_u32 s30, 28
  s_cselect_b32 s72, 28, 0
  v_mfma_f32_16x16x32_bf16 v[88:91], a[136:139], a[108:111], v[88:91]
  s_sub_u32 s30, s30, s72
  s_lshl_b32 s72, s30, 17
  s_add_u32 s71, s93, s72
  v_mfma_f32_16x16x32_bf16 v[88:91], a[152:155], a[124:127], v[88:91]
  s_add_u32 m0, s64, 16384
  ds_read_b128 a[64:67], v16 offset:0
  ds_read_b128 a[80:83], v16 offset:8192
  v_mfma_f32_16x16x32_bf16 v[44:47], a[140:143], a[96:99], v[44:47]
  buffer_load_dwordx4 v10, s[12:15], s71 offen offset:0 lds
  v_mfma_f32_16x16x32_bf16 v[44:47], a[156:159], a[112:115], v[44:47]
  ds_read_b64_tr_b16 a[128:129], v18 offset:16384
  ds_read_b64_tr_b16 a[130:131], v18 offset:18432
  v_mfma_f32_16x16x32_bf16 v[60:63], a[140:143], a[100:103], v[60:63]
  buffer_load_dwordx4 v11, s[12:15], s71 offen offset:1024 lds
  v_mfma_f32_16x16x32_bf16 v[60:63], a[156:159], a[116:119], v[60:63]
  ds_read_b64_tr_b16 a[144:145], v18 offset:20480
  ds_read_b64_tr_b16 a[146:147], v18 offset:22528
  v_mfma_f32_16x16x32_bf16 v[76:79], a[140:143], a[104:107], v[76:79]
  ds_read_b128 a[68:71], v16 offset:1024
  ds_read_b128 a[84:87], v16 offset:9216
  v_mfma_f32_16x16x32_bf16 v[76:79], a[156:159], a[120:123], v[76:79]
  ds_read_b128 a[72:75], v17 offset:0
  ds_read_b128 a[88:91], v17 offset:8192
  v_mfma_f32_16x16x32_bf16 v[92:95], a[140:143], a[108:111], v[92:95]
  ds_read_b128 a[76:79], v17 offset:1024
  ds_read_b128 a[92:95], v17 offset:9216
  v_mfma_f32_16x16x32_bf16 v[92:95], a[156:159], a[124:127], v[92:95]
  ds_read_b64_tr_b16 a[132:133], v19 offset:16384
  ds_read_b64_tr_b16 a[134:135], v19 offset:18432
  ds_read_b64_tr_b16 a[148:149], v19 offset:20480
  ds_read_b64_tr_b16 a[150:151], v19 offset:22528
  s_waitcnt lgkmcnt(0)
  v_mfma_f32_16x16x32_bf16 v[32:35], a[128:131], a[64:67], v[32:35]
  buffer_load_dwordx4 v12, s[12:15], s71 offen offset:2048 lds
  v_mfma_f32_16x16x32_bf16 v[32:35], a[144:147], a[80:83], v[32:35]
  s_add_u32 s64, s64, s66
  ds_read_b64_tr_b16 a[136:137], v20 offset:16384
  ds_read_b64_tr_b16 a[138:139], v20 offset:18432
  v_mfma_f32_16x16x32_bf16 v[48:51], a[128:131], a[68:71], v[48:51]
  s_add_u32 s65, s65, 1
  ds_read_b64_tr_b16 a[152:153], v20 offset:20480
  ds_read_b64_tr_b16 a[154:155], v20 offset:22528
  v_mfma_f32_16x16x32_bf16 v[48:51], a[144:147], a[84:87], v[48:51]
  ds_read_b64_tr_b16 a[140:141], v21 offset:16384
  ds_read_b64_tr_b16 a[142:143], v21 offset:18432
  v_mfma_f32_16x16x32_bf16 v[64:67], a[128:131], a[72:75], v[64:67]
  buffer_load_dwordx4 v13, s[12:15], s71 offen offset:3072 lds
  v_mfma_f32_16x16x32_bf16 v[64:67], a[144:147], a[88:91], v[64:67]
  s_bfe_u32 s72, 0x302011a, s31
  ds_read_b64_tr_b16 a[156:157], v21 offset:20480
  ds_read_b64_tr_b16 a[158:159], v21 offset:22528
  v_mfma_f32_16x16x32_bf16 v[80:83], a[128:131], a[76:79], v[80:83]
  s_cmp_eq_u32 s65, 4
  s_cselect_b32 s65, 0, s65
  s_cselect_b32 s66, s67, s68
  v_mfma_f32_16x16x32_bf16 v[80:83], a[144:147], a[92:95], v[80:83]
  s_add_u32 s30, s30, s72
  v_add_u32 v16, s66, v16
  v_add_u32 v17, s66, v17
  v_mfma_f32_16x16x32_bf16 v[36:39], a[132:135], a[64:67], v[36:39]
  s_add_u32 s31, s31, 8
  v_add_u32 v18, s66, v18
  v_add_u32 v19, s66, v19
  v_mfma_f32_16x16x32_bf16 v[36:39], a[148:151], a[80:83], v[36:39]
  s_and_b32 s31, s31, 0x8001f
  v_add_u32 v20, s66, v20
  v_add_u32 v21, s66, v21
  v_mfma_f32_16x16x32_bf16 v[52:55], a[132:135], a[68:71], v[52:55]
  s_cmp_ge_u32 s30, 28
  s_cselect_b32 s72, 28, 0
  v_mfma_f32_16x16x32_bf16 v[52:55], a[148:151], a[84:87], v[52:55]
  s_sub_u32 s30, s30, s72
  v_mfma_f32_16x16x32_bf16 v[68:71], a[132:135], a[72:75], v[68:71]
  s_lshl_b32 s72, s30, 17
  s_add_u32 s71, s93, s72
  v_mfma_f32_16x16x32_bf16 v[68:71], a[148:151], a[88:91], v[68:71]
  v_mfma_f32_16x16x32_bf16 v[84:87], a[132:135], a[76:79], v[84:87]
  v_mfma_f32_16x16x32_bf16 v[84:87], a[148:151], a[92:95], v[84:87]
  s_waitcnt vmcnt(4)
  v_cmp_ne_u64 vcc, s[94:95], v[6:7]
  s_nop 1
  v_cndmask_b32_e64 v8, 0, 1, vcc
  v_lshlrev_b32 v9, 2, v0
  ds_write_b32 v9, v8
  v_lshlrev_b32 v9, 4, v1
  s_waitcnt lgkmcnt(0)
  s_barrier
  ds_read_b128 v[160:163], v9
  s_waitcnt lgkmcnt(0)
  v_or3_b32 v160, v160, v161, v162
  v_or_b32 v160, v160, v163
  v_cmp_ne_u32 vcc, 0, v160
  s_nop 0
  s_cbranch_vccnz Lp6_late
  s_add_u32 s8, s86, 67108864
  s_addc_u32 s9, s87, 0
  s_mov_b32 s10, 16777216
  s_mov_b32 s11, 0x00020000
  s_lshl_b32 s92, s73, 1
  s_add_u32 s92, s92, s77
  s_lshl_b32 s92, s92, 19
  s_add_u32 s92, s92, s79
  s_add_u32 s72, s73, s76
  s_and_b32 s1, s72, 3
  s_lshl_b32 s1, s1, 3
  s_or_b32 s1, s1, 0x80000
  s_bfe_u32 s0, 0x1b1b02, s1
  s_add_u32 s0, s0, 0
  s_cmp_ge_u32 s0, 28
  s_cselect_b32 s72, 28, 0
  s_sub_u32 s0, s0, s72
  s_lshl_b32 s72, s0, 14
  s_add_u32 s70, s92, s72
  v_mfma_f32_16x16x32_bf16 v[40:43], a[136:139], a[64:67], v[40:43]
  s_add_u32 m0, s79, 131072
  ds_read_b128 a[96:99], v16 offset:0
  ds_read_b128 a[112:115], v16 offset:8192
  v_mfma_f32_16x16x32_bf16 v[40:43], a[152:155], a[80:83], v[40:43]
  buffer_load_dwordx4 v2, s[8:11], s70 offen offset:0 sc1 lds
  v_mfma_f32_16x16x32_bf16 v[56:59], a[136:139], a[68:71], v[56:59]
  buffer_load_dwordx4 v2, s[8:11], s70 offen offset:1024 sc1 lds
  v_mfma_f32_16x16x32_bf16 v[56:59], a[152:155], a[84:87], v[56:59]
  ds_read_b64_tr_b16 a[128:129], v18 offset:16384
  ds_read_b64_tr_b16 a[130:131], v18 offset:18432
  v_mfma_f32_16x16x32_bf16 v[72:75], a[136:139], a[72:75], v[72:75]
  ds_read_b64_tr_b16 a[144:145], v18 offset:20480
  ds_read_b64_tr_b16 a[146:147], v18 offset:22528
  v_mfma_f32_16x16x32_bf16 v[72:75], a[152:155], a[88:91], v[72:75]
  buffer_load_dwordx4 v2, s[8:11], s70 offen offset:2048 sc1 lds
  v_mfma_f32_16x16x32_bf16 v[88:91], a[136:139], a[76:79], v[88:91]
  ds_read_b128 a[100:103], v16 offset:1024
  ds_read_b128 a[116:119], v16 offset:9216
  v_mfma_f32_16x16x32_bf16 v[88:91], a[152:155], a[92:95], v[88:91]
  buffer_load_dwordx4 v2, s[8:11], s70 offen offset:3072 sc1 lds
  v_mfma_f32_16x16x32_bf16 v[44:47], a[140:143], a[64:67], v[44:47]
  s_bfe_u32 s72, 0x302011a, s1
  s_add_u32 s0, s0, s72
  s_add_u32 s1, s1, 8
  v_mfma_f32_16x16x32_bf16 v[44:47], a[156:159], a[80:83], v[44:47]
  s_and_b32 s1, s1, 0x8001f
  s_cmp_ge_u32 s0, 28
  s_cselect_b32 s72, 28, 0
  v_mfma_f32_16x16x32_bf16 v[60:63], a[140:143], a[68:71], v[60:63]
  s_sub_u32 s0, s0, s72
  s_lshl_b32 s72, s0, 14
  s_add_u32 s70, s92, s72
  v_mfma_f32_16x16x32_bf16 v[60:63], a[156:159], a[84:87], v[60:63]
  s_add_u32 m0, s64, 16384
  ds_read_b128 a[104:107], v17 offset:0
  ds_read_b128 a[120:123], v17 offset:8192
  v_mfma_f32_16x16x32_bf16 v[76:79], a[140:143], a[72:75], v[76:79]
  buffer_load_dwordx4 v10, s[12:15], s71 offen offset:0 lds
  v_mfma_f32_16x16x32_bf16 v[76:79], a[156:159], a[88:91], v[76:79]
  buffer_load_dwordx4 v11, s[12:15], s71 offen offset:1024 lds
  v_mfma_f32_16x16x32_bf16 v[92:95], a[140:143], a[76:79], v[92:95]
  ds_read_b128 a[108:111], v17 offset:1024
  ds_read_b128 a[124:127], v17 offset:9216
  v_mfma_f32_16x16x32_bf16 v[92:95], a[156:159], a[92:95], v[92:95]
  ds_read_b64_tr_b16 a[132:133], v19 offset:16384
  ds_read_b64_tr_b16 a[134:135], v19 offset:18432
  ds_read_b64_tr_b16 a[148:149], v19 offset:20480
  ds_read_b64_tr_b16 a[150:151], v19 offset:22528
  s_waitcnt lgkmcnt(0)
  v_mfma_f32_16x16x32_bf16 v[32:35], a[128:131], a[96:99], v[32:35]
  buffer_load_dwordx4 v12, s[12:15], s71 offen offset:2048 lds
  v_mfma_f32_16x16x32_bf16 v[32:35], a[144:147], a[112:115], v[32:35]
  buffer_load_dwordx4 v13, s[12:15], s71 offen offset:3072 lds
  v_mfma_f32_16x16x32_bf16 v[48:51], a[128:131], a[100:103], v[48:51]
  s_bfe_u32 s72, 0x302011a, s31
  s_add_u32 s30, s30, s72
  s_add_u32 s31, s31, 8
  v_mfma_f32_16x16x32_bf16 v[48:51], a[144:147], a[116:119], v[48:51]
  s_and_b32 s31, s31, 0x8001f
  s_cmp_ge_u32 s30, 28
  s_cselect_b32 s72, 28, 0
  v_mfma_f32_16x16x32_bf16 v[64:67], a[128:131], a[104:107], v[64:67]
  s_sub_u32 s30, s30, s72
  s_lshl_b32 s72, s30, 17
  s_add_u32 s71, s93, s72
  v_mfma_f32_16x16x32_bf16 v[64:67], a[144:147], a[120:123], v[64:67]
  s_mov_b32 m0, s64
  ds_read_b64_tr_b16 a[136:137], v20 offset:16384
  ds_read_b64_tr_b16 a[138:139], v20 offset:18432
  v_mfma_f32_16x16x32_bf16 v[80:83], a[128:131], a[108:111], v[80:83]
  buffer_load_dwordx4 v2, s[8:11], s70 offen offset:0 sc1 lds
  v_mfma_f32_16x16x32_bf16 v[80:83], a[144:147], a[124:127], v[80:83]
  buffer_load_dwordx4 v2, s[8:11], s70 offen offset:1024 sc1 lds
  v_mfma_f32_16x16x32_bf16 v[36:39], a[132:135], a[96:99], v[36:39]
  buffer_load_dwordx4 v2, s[8:11], s70 offen offset:2048 sc1 lds
  v_mfma_f32_16x16x32_bf16 v[36:39], a[148:151], a[112:115], v[36:39]
  buffer_load_dwordx4 v2, s[8:11], s70 offen offset:3072 sc1 lds
  v_mfma_f32_16x16x32_bf16 v[52:55], a[132:135], a[100:103], v[52:55]
  s_add_u32 s64, s64, s66
  ds_read_b64_tr_b16 a[152:153], v20 offset:20480
  ds_read_b64_tr_b16 a[154:155], v20 offset:22528
  v_mfma_f32_16x16x32_bf16 v[52:55], a[148:151], a[116:119], v[52:55]
  s_add_u32 s65, s65, 1
  ds_read_b64_tr_b16 a[140:141], v21 offset:16384
  ds_read_b64_tr_b16 a[142:143], v21 offset:18432
  v_mfma_f32_16x16x32_bf16 v[68:71], a[132:135], a[104:107], v[68:71]
  s_cmp_eq_u32 s65, 4
  s_cselect_b32 s65, 0, s65
  s_cselect_b32 s66, s67, s68
  ds_read_b64_tr_b16 a[156:157], v21 offset:20480
  ds_read_b64_tr_b16 a[158:159], v21 offset:22528
  v_mfma_f32_16x16x32_bf16 v[68:71], a[148:151], a[120:123], v[68:71]
  s_bfe_u32 s72, 0x302011a, s1
  s_add_u32 s0, s0, s72
  s_add_u32 s1, s1, 8
  v_add_u32 v16, s66, v16
  v_add_u32 v19, s66, v19
  v_mfma_f32_16x16x32_bf16 v[84:87], a[132:135], a[108:111], v[84:87]
  s_and_b32 s1, s1, 0x8001f
  s_cmp_ge_u32 s0, 28
  s_cselect_b32 s72, 28, 0
  v_add_u32 v17, s66, v17
  v_add_u32 v20, s66, v20
  v_mfma_f32_16x16x32_bf16 v[84:87], a[148:151], a[124:127], v[84:87]
  s_sub_u32 s0, s0, s72
  s_lshl_b32 s72, s0, 14
  s_add_u32 s70, s92, s72
  v_add_u32 v18, s66, v18
  v_add_u32 v21, s66, v21
  s_waitcnt vmcnt(16) lgkmcnt(0)
  s_barrier
  v_mfma_f32_16x16x32_bf16 v[40:43], a[136:139], a[96:99], v[40:43]
  s_add_u32 m0, s64, 16384
  ds_read_b128 a[64:67], v16 offset:0
  ds_read_b128 a[80:83], v16 offset:8192
  v_mfma_f32_16x16x32_bf16 v[40:43], a[152:155], a[112:115], v[40:43]
  buffer_load_dwordx4 v10, s[12:15], s71 offen offset:0 lds
  v_mfma_f32_16x16x32_bf16 v[56:59], a[136:139], a[100:103], v[56:59]
  ds_read_b64_tr_b16 a[128:129], v18 offset:16384
  ds_read_b64_tr_b16 a[130:131], v18 offset:18432
  v_mfma_f32_16x16x32_bf16 v[56:59], a[152:155], a[116:119], v[56:59]
  buffer_load_dwordx4 v11, s[12:15], s71 offen offset:1024 lds
  v_mfma_f32_16x16x32_bf16 v[72:75], a[136:139], a[104:107], v[72:75]
  ds_read_b64_tr_b16 a[144:145], v18 offset:20480
  ds_read_b64_tr_b16 a[146:147], v18 offset:22528
  v_mfma_f32_16x16x32_bf16 v[72:75], a[152:155], a[120:123], v[72:75]
  ds_read_b128 a[68:71], v16 offset:1024
  ds_read_b128 a[84:87], v16 offset:9216
  v_mfma_f32_16x16x32_bf16 v[88:91], a[136:139], a[108:111], v[88:91]
  ds_read_b128 a[72:75], v17 offset:0
  ds_read_b128 a[88:91], v17 offset:8192
  v_mfma_f32_16x16x32_bf16 v[88:91], a[152:155], a[124:127], v[88:91]
  buffer_load_dwordx4 v12, s[12:15], s71 offen offset:2048 lds
  v_mfma_f32_16x16x32_bf16 v[44:47], a[140:143], a[96:99], v[44:47]
  ds_read_b128 a[76:79], v17 offset:1024
  ds_read_b128 a[92:95], v17 offset:9216
  v_mfma_f32_16x16x32_bf16 v[44:47], a[156:159], a[112:115], v[44:47]
  ds_read_b64_tr_b16 a[132:133], v19 offset:16384
  ds_read_b64_tr_b16 a[134:135], v19 offset:18432
  v_mfma_f32_16x16x32_bf16 v[60:63], a[140:143], a[100:103], v[60:63]
  ds_read_b64_tr_b16 a[148:149], v19 offset:20480
  ds_read_b64_tr_b16 a[150:151], v19 offset:22528
  v_mfma_f32_16x16x32_bf16 v[60:63], a[156:159], a[116:119], v[60:63]
  buffer_load_dwordx4 v13, s[12:15], s71 offen offset:3072 lds
  v_mfma_f32_16x16x32_bf16 v[76:79], a[140:143], a[104:107], v[76:79]
  s_bfe_u32 s72, 0x302011a, s31
  v_mfma_f32_16x16x32_bf16 v[76:79], a[156:159], a[120:123], v[76:79]
  s_add_u32 s30, s30, s72
  v_mfma_f32_16x16x32_bf16 v[92:95], a[140:143], a[108:111], v[92:95]
  s_add_u32 s31, s31, 8
  s_and_b32 s31, s31, 0x8001f
  s_cmp_ge_u32 s30, 28
  s_cselect_b32 s72, 28, 0
  v_mfma_f32_16x16x32_bf16 v[92:95], a[156:159], a[124:127], v[92:95]
  s_sub_u32 s30, s30, s72
  s_lshl_b32 s72, s30, 17
  s_add_u32 s71, s93, s72
  s_waitcnt lgkmcnt(0)
  v_mfma_f32_16x16x32_bf16 v[32:35], a[128:131], a[64:67], v[32:35]
  s_mov_b32 m0, s64
  ds_read_b64_tr_b16 a[136:137], v20 offset:16384
  ds_read_b64_tr_b16 a[138:139], v20 offset:18432
  v_mfma_f32_16x16x32_bf16 v[32:35], a[144:147], a[80:83], v[32:35]
  buffer_load_dwordx4 v2, s[8:11], s70 offen offset:0 sc1 lds
  v_mfma_f32_16x16x32_bf16 v[48:51], a[128:131], a[68:71], v[48:51]
  buffer_load_dwordx4 v2, s[8:11], s70 offen offset:1024 sc1 lds
  v_mfma_f32_16x16x32_bf16 v[48:51], a[144:147], a[84:87], v[48:51]
  s_add_u32 s64, s64, s66
  ds_read_b64_tr_b16 a[152:153], v20 offset:20480
  ds_read_b64_tr_b16 a[154:155], v20 offset:22528
  v_mfma_f32_16x16x32_bf16 v[64:67], a[128:131], a[72:75], v[64:67]
  buffer_load_dwordx4 v2, s[8:11], s70 offen offset:2048 sc1 lds
  v_mfma_f32_16x16x32_bf16 v[64:67], a[144:147], a[88:91], v[64:67]
  s_add_u32 s65, s65, 1
  ds_read_b64_tr_b16 a[140:141], v21 offset:16384
  ds_read_b64_tr_b16 a[142:143], v21 offset:18432
  v_mfma_f32_16x16x32_bf16 v[80:83], a[128:131], a[76:79], v[80:83]
  buffer_load_dwordx4 v2, s[8:11], s70 offen offset:3072 sc1 lds
  v_mfma_f32_16x16x32_bf16 v[80:83], a[144:147], a[92:95], v[80:83]
  s_bfe_u32 s72, 0x302011a, s1
  ds_read_b64_tr_b16 a[156:157], v21 offset:20480
  ds_read_b64_tr_b16 a[158:159], v21 offset:22528
  v_mfma_f32_16x16x32_bf16 v[36:39], a[132:135], a[64:67], v[36:39]
  s_cmp_eq_u32 s65, 4
  s_cselect_b32 s65, 0, s65
  s_cselect_b32 s66, s67, s68
  v_mfma_f32_16x16x32_bf16 v[36:39], a[148:151], a[80:83], v[36:39]
  s_add_u32 s0, s0, s72
  v_add_u32 v16, s66, v16
  v_add_u32 v17, s66, v17
  v_mfma_f32_16x16x32_bf16 v[52:55], a[132:135], a[68:71], v[52:55]
  s_add_u32 s1, s1, 8
  v_add_u32 v18, s66, v18
  v_add_u32 v19, s66, v19
  v_mfma_f32_16x16x32_bf16 v[52:55], a[148:151], a[84:87], v[52:55]
  s_and_b32 s1, s1, 0x8001f
  s_cmp_ge_u32 s0, 28
  s_cselect_b32 s72, 28, 0
  v_mfma_f32_16x16x32_bf16 v[68:71], a[132:135], a[72:75], v[68:71]
  s_sub_u32 s0, s0, s72
  s_lshl_b32 s72, s0, 14
  s_add_u32 s70, s92, s72
  v_mfma_f32_16x16x32_bf16 v[68:71], a[148:151], a[88:91], v[68:71]
  v_add_u32 v20, s66, v20
  v_add_u32 v21, s66, v21
  v_mfma_f32_16x16x32_bf16 v[84:87], a[132:135], a[76:79], v[84:87]
  v_mfma_f32_16x16x32_bf16 v[84:87], a[148:151], a[92:95], v[84:87]
  s_waitcnt vmcnt(16) lgkmcnt(0)
  s_barrier
  v_mfma_f32_16x16x32_bf16 v[40:43], a[136:139], a[64:67], v[40:43]
  s_add_u32 m0, s64, 16384
  ds_read_b128 a[96:99], v16 offset:0
  ds_read_b128 a[112:115], v16 offset:8192
  v_mfma_f32_16x16x32_bf16 v[40:43], a[152:155], a[80:83], v[40:43]
  buffer_load_dwordx4 v10, s[12:15], s71 offen offset:0 lds
  v_mfma_f32_16x16x32_bf16 v[56:59], a[136:139], a[68:71], v[56:59]
  buffer_load_dwordx4 v11, s[12:15], s71 offen offset:1024 lds
  v_mfma_f32_16x16x32_bf16 v[56:59], a[152:155], a[84:87], v[56:59]
  buffer_load_dwordx4 v12, s[12:15], s71 offen offset:2048 lds
  v_mfma_f32_16x16x32_bf16 v[72:75], a[136:139], a[72:75], v[72:75]
  ds_read_b64_tr_b16 a[128:129], v18 offset:16384
  ds_read_b64_tr_b16 a[130:131], v18 offset:18432
  v_mfma_f32_16x16x32_bf16 v[72:75], a[152:155], a[88:91], v[72:75]
  buffer_load_dwordx4 v13, s[12:15], s71 offen offset:3072 lds
  v_mfma_f32_16x16x32_bf16 v[88:91], a[136:139], a[76:79], v[88:91]
  s_bfe_u32 s72, 0x302011a, s31
  s_add_u32 s30, s30, s72
  s_add_u32 s31, s31, 8
  v_mfma_f32_16x16x32_bf16 v[88:91], a[152:155], a[92:95], v[88:91]
  s_and_b32 s31, s31, 0x8001f
  s_cmp_ge_u32 s30, 28
  s_cselect_b32 s72, 28, 0
  v_mfma_f32_16x16x32_bf16 v[44:47], a[140:143], a[64:67], v[44:47]
  s_sub_u32 s30, s30, s72
  s_lshl_b32 s72, s30, 17
  s_add_u32 s71, s93, s72
  v_mfma_f32_16x16x32_bf16 v[44:47], a[156:159], a[80:83], v[44:47]
  s_mov_b32 m0, s64
  ds_read_b64_tr_b16 a[144:145], v18 offset:20480
  ds_read_b64_tr_b16 a[146:147], v18 offset:22528
  v_mfma_f32_16x16x32_bf16 v[60:63], a[140:143], a[68:71], v[60:63]
  buffer_load_dwordx4 v2, s[8:11], s70 offen offset:0 sc1 lds
  v_mfma_f32_16x16x32_bf16 v[60:63], a[156:159], a[84:87], v[60:63]
  buffer_load_dwordx4 v2, s[8:11], s70 offen offset:1024 sc1 lds
  v_mfma_f32_16x16x32_bf16 v[76:79], a[140:143], a[72:75], v[76:79]
  buffer_load_dwordx4 v2, s[8:11], s70 offen offset:2048 sc1 lds
  v_mfma_f32_16x16x32_bf16 v[76:79], a[156:159], a[88:91], v[76:79]
  buffer_load_dwordx4 v2, s[8:11], s70 offen offset:3072 sc1 lds
  v_mfma_f32_16x16x32_bf16 v[92:95], a[140:143], a[76:79], v[92:95]
  s_bfe_u32 s72, 0x302011a, s1
  ds_read_b128 a[100:103], v16 offset:1024
  ds_read_b128 a[116:119], v16 offset:9216
  v_mfma_f32_16x16x32_bf16 v[92:95], a[156:159], a[92:95], v[92:95]
  s_add_u32 s0, s0, s72
  s_add_u32 s1, s1, 8
  s_and_b32 s1, s1, 0x8001f
  s_cmp_ge_u32 s0, 28
  s_cselect_b32 s72, 28, 0
  s_sub_u32 s0, s0, s72
  s_lshl_b32 s72, s0, 14
  s_add_u32 s70, s92, s72
  ds_read_b128 a[104:107], v17 offset:0
  ds_read_b128 a[120:123], v17 offset:8192
  ds_read_b128 a[108:111], v17 offset:1024
  ds_read_b128 a[124:127], v17 offset:9216
  ds_read_b64_tr_b16 a[132:133], v19 offset:16384
  ds_read_b64_tr_b16 a[134:135], v19 offset:18432
  ds_read_b64_tr_b16 a[148:149], v19 offset:20480
  ds_read_b64_tr_b16 a[150:151], v19 offset:22528
  s_waitcnt lgkmcnt(0)
  s_lshl_b32 s6, s78, 1
  s_add_u32 s6, s6, s77
  s_xor_b32 s6, s6, 1
  s_lshl_b32 s6, s6, 2
  s_add_u32 s6, s6, s3
  s_lshl_b32 s6, s6, 14
  s_add_u32 s6, s6, 4096
  s_add_u32 s7, s6, 4096
  v_cvt_pk_bf16_f32 v64, v64, v65
  v_cvt_pk_bf16_f32 v65, v66, v67
  v_cvt_pk_bf16_f32 v66, v68, v69
  v_cvt_pk_bf16_f32 v67, v70, v71
  v_cvt_pk_bf16_f32 v68, v72, v73
  v_cvt_pk_bf16_f32 v69, v74, v75
  v_cvt_pk_bf16_f32 v70, v76, v77
  v_cvt_pk_bf16_f32 v71, v78, v79
  v_cvt_pk_bf16_f32 v72, v80, v81
  v_cvt_pk_bf16_f32 v73, v82, v83
  v_cvt_pk_bf16_f32 v74, v84, v85
  v_cvt_pk_bf16_f32 v75, v86, v87
  v_cvt_pk_bf16_f32 v76, v88, v89
  v_cvt_pk_bf16_f32 v77, v90, v91
  v_cvt_pk_bf16_f32 v78, v92, v93
  v_cvt_pk_bf16_f32 v79, v94, v95
  v_mfma_f32_16x16x32_bf16 v[96:99], a[128:131], a[96:99], 0
  s_add_u32 s64, s64, s66
  ds_read_b64_tr_b16 a[136:137], v20 offset:16384
  ds_read_b64_tr_b16 a[138:139], v20 offset:18432
  v_mfma_f32_16x16x32_bf16 v[96:99], a[144:147], a[112:115], v[96:99]
  s_add_u32 s65, s65, 1
  ds_read_b64_tr_b16 a[152:153], v20 offset:20480
  v_mfma_f32_16x16x32_bf16 v[112:115], a[128:131], a[100:103], 0
  ds_read_b64_tr_b16 a[154:155], v20 offset:22528
  v_mfma_f32_16x16x32_bf16 v[112:115], a[144:147], a[116:119], v[112:115]
  ds_read_b64_tr_b16 a[140:141], v21 offset:16384
  ds_read_b64_tr_b16 a[142:143], v21 offset:18432
  v_mfma_f32_16x16x32_bf16 v[128:131], a[128:131], a[104:107], 0
  ds_read_b64_tr_b16 a[156:157], v21 offset:20480
  v_mfma_f32_16x16x32_bf16 v[128:131], a[144:147], a[120:123], v[128:131]
  ds_read_b64_tr_b16 a[158:159], v21 offset:22528
  v_mfma_f32_16x16x32_bf16 v[144:147], a[128:131], a[108:111], 0
  s_cmp_eq_u32 s65, 4
  s_cselect_b32 s65, 0, s65
  s_cselect_b32 s66, s67, s68
  v_mfma_f32_16x16x32_bf16 v[144:147], a[144:147], a[124:127], v[144:147]
  v_add_u32 v16, s66, v16
  v_add_u32 v17, s66, v17
  v_mfma_f32_16x16x32_bf16 v[100:103], a[132:135], a[96:99], 0
  v_add_u32 v18, s66, v18
  v_add_u32 v19, s66, v19
  v_mfma_f32_16x16x32_bf16 v[100:103], a[148:151], a[112:115], v[100:103]
  v_add_u32 v20, s66, v20
  v_add_u32 v21, s66, v21
  v_mfma_f32_16x16x32_bf16 v[116:119], a[132:135], a[100:103], 0
  buffer_store_dwordx4 v[64:67], v2, s[16:19], s6 offen offset:0 sc1
  v_mfma_f32_16x16x32_bf16 v[116:119], a[148:151], a[116:119], v[116:119]
  buffer_store_dwordx4 v[68:71], v2, s[16:19], s6 offen offset:1024 sc1
  v_mfma_f32_16x16x32_bf16 v[132:135], a[132:135], a[104:107], 0
  buffer_store_dwordx4 v[72:75], v2, s[16:19], s6 offen offset:2048 sc1
  v_mfma_f32_16x16x32_bf16 v[132:135], a[148:151], a[120:123], v[132:135]
  buffer_store_dwordx4 v[76:79], v2, s[16:19], s6 offen offset:3072 sc1
  v_mfma_f32_16x16x32_bf16 v[148:151], a[132:135], a[108:111], 0
  v_mfma_f32_16x16x32_bf16 v[148:151], a[148:151], a[124:127], v[148:151]
  s_branch Lp7
Lp6_late:
  v_mfma_f32_16x16x32_bf16 v[40:43], a[136:139], a[64:67], v[40:43]
  s_add_u32 m0, s64, 16384
  ds_read_b128 a[96:99], v16 offset:0
  ds_read_b128 a[112:115], v16 offset:8192
  v_mfma_f32_16x16x32_bf16 v[40:43], a[152:155], a[80:83], v[40:43]
  buffer_load_dwordx4 v10, s[12:15], s71 offen offset:0 lds
  v_mfma_f32_16x16x32_bf16 v[56:59], a[136:139], a[68:71], v[56:59]
  ds_read_b64_tr_b16 a[128:129], v18 offset:16384
  ds_read_b64_tr_b16 a[130:131], v18 offset:18432
  v_mfma_f32_16x16x32_bf16 v[56:59], a[152:155], a[84:87], v[56:59]
  ds_read_b64_tr_b16 a[144:145], v18 offset:20480
  ds_read_b64_tr_b16 a[146:147], v18 offset:22528
  v_mfma_f32_16x16x32_bf16 v[72:75], a[136:139], a[72:75], v[72:75]
  ds_read_b128 a[100:103], v16 offset:1024
  ds_read_b128 a[116:119], v16 offset:9216
  v_mfma_f32_16x16x32_bf16 v[72:75], a[152:155], a[88:91], v[72:75]
  ds_read_b128 a[104:107], v17 offset:0
  ds_read_b128 a[120:123], v17 offset:8192
  v_mfma_f32_16x16x32_bf16 v[88:91], a[136:139], a[76:79], v[88:91]
  ds_read_b128 a[108:111], v17 offset:1024
  ds_read_b128 a[124:127], v17 offset:9216
  v_mfma_f32_16x16x32_bf16 v[88:91], a[152:155], a[92:95], v[88:91]
  buffer_load_dwordx4 v11, s[12:15], s71 offen offset:1024 lds
  v_mfma_f32_16x16x32_bf16 v[44:47], a[140:143], a[64:67], v[44:47]
  ds_read_b64_tr_b16 a[132:133], v19 offset:16384
  ds_read_b64_tr_b16 a[134:135], v19 offset:18432
  v_mfma_f32_16x16x32_bf16 v[44:47], a[156:159], a[80:83], v[44:47]
  ds_read_b64_tr_b16 a[148:149], v19 offset:20480
  ds_read_b64_tr_b16 a[150:151], v19 offset:22528
  v_mfma_f32_16x16x32_bf16 v[60:63], a[140:143], a[68:71], v[60:63]
  v_mfma_f32_16x16x32_bf16 v[60:63], a[156:159], a[84:87], v[60:63]
  v_mfma_f32_16x16x32_bf16 v[76:79], a[140:143], a[72:75], v[76:79]
  v_mfma_f32_16x16x32_bf16 v[76:79], a[156:159], a[88:91], v[76:79]
  v_mfma_f32_16x16x32_bf16 v[92:95], a[140:143], a[76:79], v[92:95]
  v_mfma_f32_16x16x32_bf16 v[92:95], a[156:159], a[92:95], v[92:95]
  s_waitcnt lgkmcnt(0)
  v_mfma_f32_16x16x32_bf16 v[32:35], a[128:131], a[96:99], v[32:35]
  buffer_load_dwordx4 v12, s[12:15], s71 offen offset:2048 lds
  v_mfma_f32_16x16x32_bf16 v[32:35], a[144:147], a[112:115], v[32:35]
  s_add_u32 s64, s64, s66
  ds_read_b64_tr_b16 a[136:137], v20 offset:16384
  ds_read_b64_tr_b16 a[138:139], v20 offset:18432
  v_mfma_f32_16x16x32_bf16 v[48:51], a[128:131], a[100:103], v[48:51]
  s_add_u32 s65, s65, 1
  ds_read_b64_tr_b16 a[152:153], v20 offset:20480
  ds_read_b64_tr_b16 a[154:155], v20 offset:22528
  v_mfma_f32_16x16x32_bf16 v[48:51], a[144:147], a[116:119], v[48:51]
  ds_read_b64_tr_b16 a[140:141], v21 offset:16384
  ds_read_b64_tr_b16 a[142:143], v21 offset:18432
  v_mfma_f32_16x16x32_bf16 v[64:67], a[128:131], a[104:107], v[64:67]
  buffer_load_dwordx4 v13, s[12:15], s71 offen offset:3072 lds
  v_mfma_f32_16x16x32_bf16 v[64:67], a[144:147], a[120:123], v[64:67]
  s_bfe_u32 s72, 0x302011a, s31
  ds_read_b64_tr_b16 a[156:157], v21 offset:20480
  ds_read_b64_tr_b16 a[158:159], v21 offset:22528
  v_mfma_f32_16x16x32_bf16 v[80:83], a[128:131], a[108:111], v[80:83]
  s_cmp_eq_u32 s65, 4
  s_cselect_b32 s65, 0, s65
  s_cselect_b32 s66, s67, s68
  v_mfma_f32_16x16x32_bf16 v[80:83], a[144:147], a[124:127], v[80:83]
  s_add_u32 s30, s30, s72
  v_add_u32 v16, s66, v16
  v_add_u32 v17, s66, v17
  v_mfma_f32_16x16x32_bf16 v[36:39], a[132:135], a[96:99], v[36:39]
  s_add_u32 s31, s31, 8
  v_add_u32 v18, s66, v18
  v_add_u32 v19, s66, v19
  v_mfma_f32_16x16x32_bf16 v[36:39], a[148:151], a[112:115], v[36:39]
  s_and_b32 s31, s31, 0x8001f
  v_add_u32 v20, s66, v20
  v_add_u32 v21, s66, v21
  v_mfma_f32_16x16x32_bf16 v[52:55], a[132:135], a[100:103], v[52:55]
  s_cmp_ge_u32 s30, 28
  s_cselect_b32 s72, 28, 0
  v_mfma_f32_16x16x32_bf16 v[52:55], a[148:151], a[116:119], v[52:55]
  s_sub_u32 s30, s30, s72
  v_mfma_f32_16x16x32_bf16 v[68:71], a[132:135], a[104:107], v[68:71]
  s_lshl_b32 s72, s30, 17
  s_add_u32 s71, s93, s72
  v_mfma_f32_16x16x32_bf16 v[68:71], a[148:151], a[120:123], v[68:71]
  v_mfma_f32_16x16x32_bf16 v[84:87], a[132:135], a[108:111], v[84:87]
  v_mfma_f32_16x16x32_bf16 v[84:87], a[148:151], a[124:127], v[84:87]
  s_waitcnt vmcnt(8) lgkmcnt(0)
  s_barrier
  v_mfma_f32_16x16x32_bf16 v[40:43], a[136:139], a[96:99], v[40:43]
  s_add_u32 m0, s64, 16384
  ds_read_b128 a[64:67], v16 offset:0
  ds_read_b128 a[80:83], v16 offset:8192
  v_mfma_f32_16x16x32_bf16 v[40:43], a[152:155], a[112:115], v[40:43]
  buffer_load_dwordx4 v10, s[12:15], s71 offen offset:0 lds
  v_mfma_f32_16x16x32_bf16 v[56:59], a[136:139], a[100:103], v[56:59]
  ds_read_b64_tr_b16 a[128:129], v18 offset:16384
  ds_read_b64_tr_b16 a[130:131], v18 offset:18432
  v_mfma_f32_16x16x32_bf16 v[56:59], a[152:155], a[116:119], v[56:59]
  ds_read_b64_tr_b16 a[144:145], v18 offset:20480
  ds_read_b64_tr_b16 a[146:147], v18 offset:22528
  v_mfma_f32_16x16x32_bf16 v[72:75], a[136:139], a[104:107], v[72:75]
  ds_read_b128 a[68:71], v16 offset:1024
  ds_read_b128 a[84:87], v16 offset:9216
  v_mfma_f32_16x16x32_bf16 v[72:75], a[152:155], a[120:123], v[72:75]
  buffer_load_dwordx4 v11, s[12:15], s71 offen offset:1024 lds
  v_mfma_f32_16x16x32_bf16 v[88:91], a[136:139], a[108:111], v[88:91]
  ds_read_b128 a[72:75], v17 offset:0
  ds_read_b128 a[88:91], v17 offset:8192
  v_mfma_f32_16x16x32_bf16 v[88:91], a[152:155], a[124:127], v[88:91]
  ds_read_b128 a[76:79], v17 offset:1024
  ds_read_b128 a[92:95], v17 offset:9216
  v_mfma_f32_16x16x32_bf16 v[44:47], a[140:143], a[96:99], v[44:47]
  ds_read_b64_tr_b16 a[132:133], v19 offset:16384
  ds_read_b64_tr_b16 a[134:135], v19 offset:18432
  v_mfma_f32_16x16x32_bf16 v[44:47], a[156:159], a[112:115], v[44:47]
  ds_read_b64_tr_b16 a[148:149], v19 offset:20480
  ds_read_b64_tr_b16 a[150:151], v19 offset:22528
  v_mfma_f32_16x16x32_bf16 v[60:63], a[140:143], a[100:103], v[60:63]
  buffer_load_dwordx4 v12, s[12:15], s71 offen offset:2048 lds
  v_mfma_f32_16x16x32_bf16 v[60:63], a[156:159], a[116:119], v[60:63]
  v_mfma_f32_16x16x32_bf16 v[76:79], a[140:143], a[104:107], v[76:79]
  v_mfma_f32_16x16x32_bf16 v[76:79], a[156:159], a[120:123], v[76:79]
  v_mfma_f32_16x16x32_bf16 v[92:95], a[140:143], a[108:111], v[92:95]
  v_mfma_f32_16x16x32_bf16 v[92:95], a[156:159], a[124:127], v[92:95]
  s_waitcnt lgkmcnt(0)
  v_mfma_f32_16x16x32_bf16 v[32:35], a[128:131], a[64:67], v[32:35]
  buffer_load_dwordx4 v13, s[12:15], s71 offen offset:3072 lds
  v_mfma_f32_16x16x32_bf16 v[32:35], a[144:147], a[80:83], v[32:35]
  s_bfe_u32 s72, 0x302011a, s31
  s_add_u32 s30, s30, s72
  s_add_u32 s31, s31, 8
  v_mfma_f32_16x16x32_bf16 v[48:51], a[128:131], a[68:71], v[48:51]
  s_and_b32 s31, s31, 0x8001f
  s_cmp_ge_u32 s30, 28
  s_cselect_b32 s72, 28, 0
  v_mfma_f32_16x16x32_bf16 v[48:51], a[144:147], a[84:87], v[48:51]
  s_sub_u32 s30, s30, s72
  s_lshl_b32 s72, s30, 17
  s_add_u32 s71, s93, s72
  v_mfma_f32_16x16x32_bf16 v[64:67], a[128:131], a[72:75], v[64:67]
  buffer_load_dwordx2 v[6:7], v14, s[96:99], s91 offen sc1
  v_mfma_f32_16x16x32_bf16 v[64:67], a[144:147], a[88:91], v[64:67]
  s_add_u32 s64, s64, s66
  ds_read_b64_tr_b16 a[136:137], v20 offset:16384
  ds_read_b64_tr_b16 a[138:139], v20 offset:18432
  v_mfma_f32_16x16x32_bf16 v[80:83], a[128:131], a[76:79], v[80:83]
  s_add_u32 s65, s65, 1
  ds_read_b64_tr_b16 a[152:153], v20 offset:20480
  ds_read_b64_tr_b16 a[154:155], v20 offset:22528
  v_mfma_f32_16x16x32_bf16 v[80:83], a[144:147], a[92:95], v[80:83]
  ds_read_b64_tr_b16 a[140:141], v21 offset:16384
  ds_read_b64_tr_b16 a[142:143], v21 offset:18432
  v_mfma_f32_16x16x32_bf16 v[36:39], a[132:135], a[64:67], v[36:39]
  ds_read_b64_tr_b16 a[156:157], v21 offset:20480
  ds_read_b64_tr_b16 a[158:159], v21 offset:22528
  v_mfma_f32_16x16x32_bf16 v[36:39], a[148:151], a[80:83], v[36:39]
  s_cmp_eq_u32 s65, 4
  s_cselect_b32 s65, 0, s65
  s_cselect_b32 s66, s67, s68
  v_mfma_f32_16x16x32_bf16 v[52:55], a[132:135], a[68:71], v[52:55]
  v_add_u32 v16, s66, v16
  v_add_u32 v17, s66, v17
  v_mfma_f32_16x16x32_bf16 v[52:55], a[148:151], a[84:87], v[52:55]
  v_add_u32 v18, s66, v18
  v_add_u32 v19, s66, v19
  v_mfma_f32_16x16x32_bf16 v[68:71], a[132:135], a[72:75], v[68:71]
  v_add_u32 v20, s66, v20
  v_add_u32 v21, s66, v21
  v_mfma_f32_16x16x32_bf16 v[68:71], a[148:151], a[88:91], v[68:71]
  v_mfma_f32_16x16x32_bf16 v[84:87], a[132:135], a[76:79], v[84:87]
  v_mfma_f32_16x16x32_bf16 v[84:87], a[148:151], a[92:95], v[84:87]
  s_waitcnt vmcnt(0) lgkmcnt(0)
  s_barrier
  s_mov_b32 s5, 0x40000
Lpoll_9:
  v_cmp_ne_u64 vcc, s[94:95], v[6:7]
  s_nop 0
  s_cbranch_vccz Lpolld_10
  s_sleep 4
  buffer_load_dwordx2 v[6:7], v14, s[96:99], s91 offen sc1
  s_sub_u32 s5, s5, 1
  s_waitcnt vmcnt(0)
  s_cbranch_scc0 Lpoll_9
Lpolld_10:
  s_add_u32 s8, s86, 67108864
  s_addc_u32 s9, s87, 0
  s_mov_b32 s10, 16777216
  s_mov_b32 s11, 0x00020000
  s_lshl_b32 s92, s73, 1
  s_add_u32 s92, s92, s77
  s_lshl_b32 s92, s92, 19
  s_add_u32 s92, s92, s79
  s_add_u32 s72, s73, s76
  s_and_b32 s1, s72, 3
  s_lshl_b32 s1, s1, 3
  s_or_b32 s1, s1, 0x80000
  s_bfe_u32 s0, 0x1b1b02, s1
  s_add_u32 s0, s0, 0
  s_cmp_ge_u32 s0, 28
  s_cselect_b32 s72, 28, 0
  s_sub_u32 s0, s0, s72
  s_lshl_b32 s72, s0, 14
  s_add_u32 s70, s92, s72
  v_mfma_f32_16x16x32_bf16 v[40:43], a[136:139], a[64:67], v[40:43]
  s_add_u32 m0, s79, 131072
  v_mfma_f32_16x16x32_bf16 v[40:43], a[152:155], a[80:83], v[40:43]
  buffer_load_dwordx4 v2, s[8:11], s70 offen offset:0 sc1 lds
  v_mfma_f32_16x16x32_bf16 v[56:59], a[136:139], a[68:71], v[56:59]
  buffer_load_dwordx4 v2, s[8:11], s70 offen offset:1024 sc1 lds
  v_mfma_f32_16x16x32_bf16 v[56:59], a[152:155], a[84:87], v[56:59]
  buffer_load_dwordx4 v2, s[8:11], s70 offen offset:2048 sc1 lds
  v_mfma_f32_16x16x32_bf16 v[72:75], a[136:139], a[72:75], v[72:75]
  buffer_load_dwordx4 v2, s[8:11], s70 offen offset:3072 sc1 lds
  v_mfma_f32_16x16x32_bf16 v[72:75], a[152:155], a[88:91], v[72:75]
  s_bfe_u32 s72, 0x302011a, s1
  s_add_u32 s0, s0, s72
  s_add_u32 s1, s1, 8
  v_mfma_f32_16x16x32_bf16 v[88:91], a[136:139], a[76:79], v[88:91]
  s_and_b32 s1, s1, 0x8001f
  s_cmp_ge_u32 s0, 28
  s_cselect_b32 s72, 28, 0
  v_mfma_f32_16x16x32_bf16 v[88:91], a[152:155], a[92:95], v[88:91]
  s_sub_u32 s0, s0, s72
  s_lshl_b32 s72, s0, 14
  s_add_u32 s70, s92, s72
  v_mfma_f32_16x16x32_bf16 v[44:47], a[140:143], a[64:67], v[44:47]
  s_add_u32 m0, s79, 32768
  v_mfma_f32_16x16x32_bf16 v[44:47], a[156:159], a[80:83], v[44:47]
  buffer_load_dwordx4 v2, s[8:11], s70 offen offset:0 sc1 lds
  v_mfma_f32_16x16x32_bf16 v[60:63], a[140:143], a[68:71], v[60:63]
  buffer_load_dwordx4 v2, s[8:11], s70 offen offset:1024 sc1 lds
  v_mfma_f32_16x16x32_bf16 v[60:63], a[156:159], a[84:87], v[60:63]
  buffer_load_dwordx4 v2, s[8:11], s70 offen offset:2048 sc1 lds
  v_mfma_f32_16x16x32_bf16 v[76:79], a[140:143], a[72:75], v[76:79]
  buffer_load_dwordx4 v2, s[8:11], s70 offen offset:3072 sc1 lds
  v_mfma_f32_16x16x32_bf16 v[76:79], a[156:159], a[88:91], v[76:79]
  s_bfe_u32 s72, 0x302011a, s1
  s_add_u32 s0, s0, s72
  s_add_u32 s1, s1, 8
  v_mfma_f32_16x16x32_bf16 v[92:95], a[140:143], a[76:79], v[92:95]
  s_and_b32 s1, s1, 0x8001f
  s_cmp_ge_u32 s0, 28
  s_cselect_b32 s72, 28, 0
  v_mfma_f32_16x16x32_bf16 v[92:95], a[156:159], a[92:95], v[92:95]
  s_sub_u32 s0, s0, s72
  s_lshl_b32 s72, s0, 14
  s_add_u32 s70, s92, s72
  s_add_u32 m0, s79, 65536
  s_nop 0
  buffer_load_dwordx4 v2, s[8:11], s70 offen offset:0 sc1 lds
  buffer_load_dwordx4 v2, s[8:11], s70 offen offset:1024 sc1 lds
  buffer_load_dwordx4 v2, s[8:11], s70 offen offset:2048 sc1 lds
  buffer_load_dwordx4 v2, s[8:11], s70 offen offset:3072 sc1 lds
  s_bfe_u32 s72, 0x302011a, s1
  s_add_u32 s0, s0, s72
  s_add_u32 s1, s1, 8
  s_and_b32 s1, s1, 0x8001f
  s_cmp_ge_u32 s0, 28
  s_cselect_b32 s72, 28, 0
  s_sub_u32 s0, s0, s72
  s_lshl_b32 s72, s0, 14
  s_add_u32 s70, s92, s72
  s_add_u32 m0, s79, 114688
  s_nop 0
  buffer_load_dwordx4 v10, s[12:15], s71 offen offset:0 lds
  buffer_load_dwordx4 v11, s[12:15], s71 offen offset:1024 lds
  buffer_load_dwordx4 v12, s[12:15], s71 offen offset:2048 lds
  buffer_load_dwordx4 v13, s[12:15], s71 offen offset:3072 lds
  s_bfe_u32 s72, 0x302011a, s31
  s_add_u32 s30, s30, s72
  s_add_u32 s31, s31, 8
  s_and_b32 s31, s31, 0x8001f
  s_cmp_ge_u32 s30, 28
  s_cselect_b32 s72, 28, 0
  s_sub_u32 s30, s30, s72
  s_lshl_b32 s72, s30, 17
  s_add_u32 s71, s93, s72
  s_add_u32 m0, s79, 98304
  s_nop 0
  buffer_load_dwordx4 v2, s[8:11], s70 offen offset:0 sc1 lds
  buffer_load_dwordx4 v2, s[8:11], s70 offen offset:1024 sc1 lds
  buffer_load_dwordx4 v2, s[8:11], s70 offen offset:2048 sc1 lds
  buffer_load_dwordx4 v2, s[8:11], s70 offen offset:3072 sc1 lds
  s_bfe_u32 s72, 0x302011a, s1
  s_add_u32 s0, s0, s72
  s_add_u32 s1, s1, 8
  s_and_b32 s1, s1, 0x8001f
  s_cmp_ge_u32 s0, 28
  s_cselect_b32 s72, 28, 0
  s_sub_u32 s0, s0, s72
  s_lshl_b32 s72, s0, 14
  s_add_u32 s70, s92, s72
  v_cvt_pk_bf16_f32 v64, v64, v65
  v_cvt_pk_bf16_f32 v65, v66, v67
  v_cvt_pk_bf16_f32 v66, v68, v69
  v_cvt_pk_bf16_f32 v67, v70, v71
  v_cvt_pk_bf16_f32 v68, v72, v73
  v_cvt_pk_bf16_f32 v69, v74, v75
  v_cvt_pk_bf16_f32 v70, v76, v77
  v_cvt_pk_bf16_f32 v71, v78, v79
  v_cvt_pk_bf16_f32 v72, v80, v81
  v_cvt_pk_bf16_f32 v73, v82, v83
  v_cvt_pk_bf16_f32 v74, v84, v85
  v_cvt_pk_bf16_f32 v75, v86, v87
  v_cvt_pk_bf16_f32 v76, v88, v89
  v_cvt_pk_bf16_f32 v77, v90, v91
  v_cvt_pk_bf16_f32 v78, v92, v93
  v_cvt_pk_bf16_f32 v79, v94, v95
  s_lshl_b32 s6, s78, 1
  s_add_u32 s6, s6, s77
  s_xor_b32 s6, s6, 1
  s_lshl_b32 s6, s6, 2
  s_add_u32 s6, s6, s3
  s_lshl_b32 s6, s6, 14
  s_add_u32 s6, s6, 4096
  s_add_u32 s7, s6, 4096
  buffer_store_dwordx4 v[64:67], v2, s[16:19], s6 offen offset:0 sc1
  buffer_store_dwordx4 v[68:71], v2, s[16:19], s6 offen offset:1024 sc1
  buffer_store_dwordx4 v[72:75], v2, s[16:19], s6 offen offset:2048 sc1
  buffer_store_dwordx4 v[76:79], v2, s[16:19], s6 offen offset:3072 sc1
  s_waitcnt vmcnt(20)
  s_barrier
  ds_read_b128 a[96:99], v16 offset:0
  ds_read_b128 a[112:115], v16 offset:8192
  ds_read_b64_tr_b16 a[128:129], v18 offset:16384
  ds_read_b64_tr_b16 a[130:131], v18 offset:18432
  ds_read_b64_tr_b16 a[144:145], v18 offset:20480
  ds_read_b64_tr_b16 a[146:147], v18 offset:22528
  ds_read_b128 a[100:103], v16 offset:1024
  ds_read_b128 a[116:119], v16 offset:9216
  ds_read_b128 a[104:107], v17 offset:0
  ds_read_b128 a[120:123], v17 offset:8192
  ds_read_b128 a[108:111], v17 offset:1024
  ds_read_b128 a[124:127], v17 offset:9216
  ds_read_b64_tr_b16 a[132:133], v19 offset:16384
  ds_read_b64_tr_b16 a[134:135], v19 offset:18432
  ds_read_b64_tr_b16 a[148:149], v19 offset:20480
  ds_read_b64_tr_b16 a[150:151], v19 offset:22528
  s_waitcnt lgkmcnt(0)
  v_mfma_f32_16x16x32_bf16 v[96:99], a[128:131], a[96:99], 0
  s_add_u32 s64, s64, s66
  ds_read_b64_tr_b16 a[136:137], v20 offset:16384
  ds_read_b64_tr_b16 a[138:139], v20 offset:18432
  v_mfma_f32_16x16x32_bf16 v[96:99], a[144:147], a[112:115], v[96:99]
  s_add_u32 s65, s65, 1
  ds_read_b64_tr_b16 a[152:153], v20 offset:20480
  v_mfma_f32_16x16x32_bf16 v[112:115], a[128:131], a[100:103], 0
  ds_read_b64_tr_b16 a[154:155], v20 offset:22528
  v_mfma_f32_16x16x32_bf16 v[112:115], a[144:147], a[116:119], v[112:115]
  ds_read_b64_tr_b16 a[140:141], v21 offset:16384
  ds_read_b64_tr_b16 a[142:143], v21 offset:18432
  v_mfma_f32_16x16x32_bf16 v[128:131], a[128:131], a[104:107], 0
  ds_read_b64_tr_b16 a[156:157], v21 offset:20480
  v_mfma_f32_16x16x32_bf16 v[128:131], a[144:147], a[120:123], v[128:131]
  ds_read_b64_tr_b16 a[158:159], v21 offset:22528
  v_mfma_f32_16x16x32_bf16 v[144:147], a[128:131], a[108:111], 0
  s_cmp_eq_u32 s65, 4
  s_cselect_b32 s65, 0, s65
  s_cselect_b32 s66, s67, s68
  v_mfma_f32_16x16x32_bf16 v[144:147], a[144:147], a[124:127], v[144:147]
  v_add_u32 v16, s66, v16
  v_add_u32 v17, s66, v17
  v_mfma_f32_16x16x32_bf16 v[100:103], a[132:135], a[96:99], 0
  v_add_u32 v18, s66, v18
  v_add_u32 v19, s66, v19
  v_mfma_f32_16x16x32_bf16 v[100:103], a[148:151], a[112:115], v[100:103]
  v_add_u32 v20, s66, v20
  v_add_u32 v21, s66, v21
  v_mfma_f32_16x16x32_bf16 v[116:119], a[132:135], a[100:103], 0
  v_mfma_f32_16x16x32_bf16 v[116:119], a[148:151], a[116:119], v[116:119]
  v_mfma_f32_16x16x32_bf16 v[132:135], a[132:135], a[104:107], 0
  v_mfma_f32_16x16x32_bf16 v[132:135], a[148:151], a[120:123], v[132:135]
  v_mfma_f32_16x16x32_bf16 v[148:151], a[132:135], a[108:111], 0
  v_mfma_f32_16x16x32_bf16 v[148:151], a[148:151], a[124:127], v[148:151]
Lp7:
  s_mov_b32 s69, 11
  s_waitcnt vmcnt(16) lgkmcnt(0)
  s_barrier
  v_mfma_f32_16x16x32_bf16 v[104:107], a[136:139], a[96:99], 0
  s_add_u32 m0, s64, 16384
  ds_read_b128 a[64:67], v16 offset:0
  ds_read_b128 a[80:83], v16 offset:8192
  v_mfma_f32_16x16x32_bf16 v[104:107], a[152:155], a[112:115], v[104:107]
  buffer_load_dwordx4 v10, s[12:15], s71 offen offset:0 lds
  v_mfma_f32_16x16x32_bf16 v[120:123], a[136:139], a[100:103], 0
  ds_read_b64_tr_b16 a[128:129], v18 offset:16384
  ds_read_b64_tr_b16 a[130:131], v18 offset:18432
  v_mfma_f32_16x16x32_bf16 v[120:123], a[152:155], a[116:119], v[120:123]
  buffer_load_dwordx4 v11, s[12:15], s71 offen offset:1024 lds
  v_mfma_f32_16x16x32_bf16 v[136:139], a[136:139], a[104:107], 0
  ds_read_b64_tr_b16 a[144:145], v18 offset:20480
  ds_read_b64_tr_b16 a[146:147], v18 offset:22528
  v_mfma_f32_16x16x32_bf16 v[136:139], a[152:155], a[120:123], v[136:139]
  ds_read_b128 a[68:71], v16 offset:1024
  ds_read_b128 a[84:87], v16 offset:9216
  v_mfma_f32_16x16x32_bf16 v[152:155], a[136:139], a[108:111], 0
  ds_read_b128 a[72:75], v17 offset:0
  ds_read_b128 a[88:91], v17 offset:8192
  v_mfma_f32_16x16x32_bf16 v[152:155], a[152:155], a[124:127], v[152:155]
  buffer_load_dwordx4 v12, s[12:15], s71 offen offset:2048 lds
  v_mfma_f32_16x16x32_bf16 v[108:111], a[140:143], a[96:99], 0
  ds_read_b128 a[76:79], v17 offset:1024
  ds_read_b128 a[92:95], v17 offset:9216
  v_mfma_f32_16x16x32_bf16 v[108:111], a[156:159], a[112:115], v[108:111]
  ds_read_b64_tr_b16 a[132:133], v19 offset:16384
  ds_read_b64_tr_b16 a[134:135], v19 offset:18432
  v_mfma_f32_16x16x32_bf16 v[124:127], a[140:143], a[100:103], 0
  ds_read_b64_tr_b16 a[148:149], v19 offset:20480
  ds_read_b64_tr_b16 a[150:151], v19 offset:22528
  v_mfma_f32_16x16x32_bf16 v[124:127], a[156:159], a[116:119], v[124:127]
  buffer_load_dwordx4 v13, s[12:15], s71 offen offset:3072 lds
  v_mfma_f32_16x16x32_bf16 v[140:143], a[140:143], a[104:107], 0
  s_bfe_u32 s72, 0x302011a, s31
  v_mfma_f32_16x16x32_bf16 v[140:143], a[156:159], a[120:123], v[140:143]
  s_add_u32 s30, s30, s72
  v_mfma_f32_16x16x32_bf16 v[156:159], a[140:143], a[108:111], 0
  s_add_u32 s31, s31, 8
  s_and_b32 s31, s31, 0x8001f
  s_cmp_ge_u32 s30, 28
  s_cselect_b32 s72, 28, 0
  v_mfma_f32_16x16x32_bf16 v[156:159], a[156:159], a[124:127], v[156:159]
  s_sub_u32 s30, s30, s72
  s_lshl_b32 s72, s30, 17
  s_add_u32 s71, s93, s72
  s_waitcnt lgkmcnt(0)
  v_mfma_f32_16x16x32_bf16 v[96:99], a[128:131], a[64:67], v[96:99]
  s_mov_b32 m0, s64
  ds_read_b64_tr_b16 a[136:137], v20 offset:16384
  ds_read_b64_tr_b16 a[138:139], v20 offset:18432
  v_mfma_f32_16x16x32_bf16 v[96:99], a[144:147], a[80:83], v[96:99]
  buffer_load_dwordx4 v2, s[8:11], s70 offen offset:0 sc1 lds
  v_mfma_f32_16x16x32_bf16 v[112:115], a[128:131], a[68:71], v[112:115]
  buffer_load_dwordx4 v2, s[8:11], s70 offen offset:1024 sc1 lds
  v_mfma_f32_16x16x32_bf16 v[112:115], a[144:147], a[84:87], v[112:115]
  s_add_u32 s64, s64, s66
  ds_read_b64_tr_b16 a[152:153], v20 offset:20480
  ds_read_b64_tr_b16 a[154:155], v20 offset:22528
  v_mfma_f32_16x16x32_bf16 v[128:131], a[128:131], a[72:75], v[128:131]
  buffer_load_dwordx4 v2, s[8:11], s70 offen offset:2048 sc1 lds
  v_mfma_f32_16x16x32_bf16 v[128:131], a[144:147], a[88:91], v[128:131]
  s_add_u32 s65, s65, 1
  ds_read_b64_tr_b16 a[140:141], v21 offset:16384
  ds_read_b64_tr_b16 a[142:143], v21 offset:18432
  v_mfma_f32_16x16x32_bf16 v[144:147], a[128:131], a[76:79], v[144:147]
  buffer_load_dwordx4 v2, s[8:11], s70 offen offset:3072 sc1 lds
  v_mfma_f32_16x16x32_bf16 v[144:147], a[144:147], a[92:95], v[144:147]
  s_bfe_u32 s72, 0x302011a, s1
  ds_read_b64_tr_b16 a[156:157], v21 offset:20480
  ds_read_b64_tr_b16 a[158:159], v21 offset:22528
  v_mfma_f32_16x16x32_bf16 v[100:103], a[132:135], a[64:67], v[100:103]
  s_cmp_eq_u32 s65, 4
  s_cselect_b32 s65, 0, s65
  s_cselect_b32 s66, s67, s68
  v_mfma_f32_16x16x32_bf16 v[100:103], a[148:151], a[80:83], v[100:103]
  s_add_u32 s0, s0, s72
  v_add_u32 v16, s66, v16
  v_add_u32 v17, s66, v17
  v_mfma_f32_16x16x32_bf16 v[116:119], a[132:135], a[68:71], v[116:119]
  s_add_u32 s1, s1, 8
  v_add_u32 v18, s66, v18
  v_add_u32 v19, s66, v19
  v_mfma_f32_16x16x32_bf16 v[116:119], a[148:151], a[84:87], v[116:119]
  s_and_b32 s1, s1, 0x8001f
  s_cmp_ge_u32 s0, 28
  s_cselect_b32 s72, 28, 0
  v_mfma_f32_16x16x32_bf16 v[132:135], a[132:135], a[72:75], v[132:135]
  s_sub_u32 s0, s0, s72
  s_lshl_b32 s72, s0, 14
  s_add_u32 s70, s92, s72
  v_mfma_f32_16x16x32_bf16 v[132:135], a[148:151], a[88:91], v[132:135]
  v_add_u32 v20, s66, v20
  v_add_u32 v21, s66, v21
  v_mfma_f32_16x16x32_bf16 v[148:151], a[132:135], a[76:79], v[148:151]
  v_mfma_f32_16x16x32_bf16 v[148:151], a[148:151], a[92:95], v[148:151]
  s_waitcnt vmcnt(16) lgkmcnt(0)
  s_barrier
  .p2align 6
Lp7_loop:
  v_mfma_f32_16x16x32_bf16 v[104:107], a[136:139], a[64:67], v[104:107]
  s_add_u32 m0, s64, 16384
  ds_read_b128 a[96:99], v16 offset:0
  ds_read_b128 a[112:115], v16 offset:8192
  v_mfma_f32_16x16x32_bf16 v[104:107], a[152:155], a[80:83], v[104:107]
  buffer_load_dwordx4 v10, s[12:15], s71 offen offset:0 lds
  v_mfma_f32_16x16x32_bf16 v[120:123], a[136:139], a[68:71], v[120:123]
  ds_read_b64_tr_b16 a[128:129], v18 offset:16384
  ds_read_b64_tr_b16 a[130:131], v18 offset:18432
  v_mfma_f32_16x16x32_bf16 v[120:123], a[152:155], a[84:87], v[120:123]
  buffer_load_dwordx4 v11, s[12:15], s71 offen offset:1024 lds
  v_mfma_f32_16x16x32_bf16 v[136:139], a[136:139], a[72:75], v[136:139]
  ds_read_b64_tr_b16 a[144:145], v18 offset:20480
  ds_read_b64_tr_b16 a[146:147], v18 offset:22528
  v_mfma_f32_16x16x32_bf16 v[136:139], a[152:155], a[88:91], v[136:139]
  ds_read_b128 a[100:103], v16 offset:1024
  ds_read_b128 a[116:119], v16 offset:9216
  v_mfma_f32_16x16x32_bf16 v[152:155], a[136:139], a[76:79], v[152:155]
  ds_read_b128 a[104:107], v17 offset:0
  ds_read_b128 a[120:123], v17 offset:8192
  v_mfma_f32_16x16x32_bf16 v[152:155], a[152:155], a[92:95], v[152:155]
  buffer_load_dwordx4 v12, s[12:15], s71 offen offset:2048 lds
  v_mfma_f32_16x16x32_bf16 v[108:111], a[140:143], a[64:67], v[108:111]
  ds_read_b128 a[108:111], v17 offset:1024
  ds_read_b128 a[124:127], v17 offset:9216
  v_mfma_f32_16x16x32_bf16 v[108:111], a[156:159], a[80:83], v[108:111]
  ds_read_b64_tr_b16 a[132:133], v19 offset:16384
  ds_read_b64_tr_b16 a[134:135], v19 offset:18432
  v_mfma_f32_16x16x32_bf16 v[124:127], a[140:143], a[68:71], v[124:127]
  ds_read_b64_tr_b16 a[148:149], v19 offset:20480
  ds_read_b64_tr_b16 a[150:151], v19 offset:22528
  v_mfma_f32_16x16x32_bf16 v[124:127], a[156:159], a[84:87], v[124:127]
  buffer_load_dwordx4 v13, s[12:15], s71 offen offset:3072 lds
  v_mfma_f32_16x16x32_bf16 v[140:143], a[140:143], a[72:75], v[140:143]
  s_bfe_u32 s72, 0x302011a, s31
  v_mfma_f32_16x16x32_bf16 v[140:143], a[156:159], a[88:91], v[140:143]
  s_add_u32 s30, s30, s72
  v_mfma_f32_16x16x32_bf16 v[156:159], a[140:143], a[76:79], v[156:159]
  s_add_u32 s31, s31, 8
  s_and_b32 s31, s31, 0x8001f
  s_cmp_ge_u32 s30, 28
  s_cselect_b32 s72, 28, 0
  v_mfma_f32_16x16x32_bf16 v[156:159], a[156:159], a[92:95], v[156:159]
  s_sub_u32 s30, s30, s72
  s_lshl_b32 s72, s30, 17
  s_add_u32 s71, s93, s72
  s_waitcnt lgkmcnt(0)
  v_mfma_f32_16x16x32_bf16 v[96:99], a[128:131], a[96:99], v[96:99]
  s_mov_b32 m0, s64
  ds_read_b64_tr_b16 a[136:137], v20 offset:16384
  ds_read_b64_tr_b16 a[138:139], v20 offset:18432
  v_mfma_f32_16x16x32_bf16 v[96:99], a[144:147], a[112:115], v[96:99]
  buffer_load_dwordx4 v2, s[8:11], s70 offen offset:0 sc1 lds
  v_mfma_f32_16x16x32_bf16 v[112:115], a[128:131], a[100:103], v[112:115]
  buffer_load_dwordx4 v2, s[8:11], s70 offen offset:1024 sc1 lds
  v_mfma_f32_16x16x32_bf16 v[112:115], a[144:147], a[116:119], v[112:115]
  s_add_u32 s64, s64, s66
  ds_read_b64_tr_b16 a[152:153], v20 offset:20480
  ds_read_b64_tr_b16 a[154:155], v20 offset:22528
  v_mfma_f32_16x16x32_bf16 v[128:131], a[128:131], a[104:107], v[128:131]
  buffer_load_dwordx4 v2, s[8:11], s70 offen offset:2048 sc1 lds
  v_mfma_f32_16x16x32_bf16 v[128:131], a[144:147], a[120:123], v[128:131]
  s_add_u32 s65, s65, 1
  ds_read_b64_tr_b16 a[140:141], v21 offset:16384
  ds_read_b64_tr_b16 a[142:143], v21 offset:18432
  v_mfma_f32_16x16x32_bf16 v[144:147], a[128:131], a[108:111], v[144:147]
  buffer_load_dwordx4 v2, s[8:11], s70 offen offset:3072 sc1 lds
  v_mfma_f32_16x16x32_bf16 v[144:147], a[144:147], a[124:127], v[144:147]
  s_bfe_u32 s72, 0x302011a, s1
  ds_read_b64_tr_b16 a[156:157], v21 offset:20480
  ds_read_b64_tr_b16 a[158:159], v21 offset:22528
  v_mfma_f32_16x16x32_bf16 v[100:103], a[132:135], a[96:99], v[100:103]
  s_cmp_eq_u32 s65, 4
  s_cselect_b32 s65, 0, s65
  s_cselect_b32 s66, s67, s68
  v_mfma_f32_16x16x32_bf16 v[100:103], a[148:151], a[112:115], v[100:103]
  s_add_u32 s0, s0, s72
  v_add_u32 v16, s66, v16
  v_add_u32 v17, s66, v17
  v_mfma_f32_16x16x32_bf16 v[116:119], a[132:135], a[100:103], v[116:119]
  s_add_u32 s1, s1, 8
  v_add_u32 v18, s66, v18
  v_add_u32 v19, s66, v19
  v_mfma_f32_16x16x32_bf16 v[116:119], a[148:151], a[116:119], v[116:119]
  s_and_b32 s1, s1, 0x8001f
  s_cmp_ge_u32 s0, 28
  s_cselect_b32 s72, 28, 0
  v_mfma_f32_16x16x32_bf16 v[132:135], a[132:135], a[104:107], v[132:135]
  s_sub_u32 s0, s0, s72
  s_lshl_b32 s72, s0, 14
  s_add_u32 s70, s92, s72
  v_mfma_f32_16x16x32_bf16 v[132:135], a[148:151], a[120:123], v[132:135]
  v_add_u32 v20, s66, v20
  v_add_u32 v21, s66, v21
  v_mfma_f32_16x16x32_bf16 v[148:151], a[132:135], a[108:111], v[148:151]
  v_mfma_f32_16x16x32_bf16 v[148:151], a[148:151], a[124:127], v[148:151]
  s_waitcnt vmcnt(16) lgkmcnt(0)
  s_barrier
  v_mfma_f32_16x16x32_bf16 v[104:107], a[136:139], a[96:99], v[104:107]
  s_add_u32 m0, s64, 16384
  ds_read_b128 a[64:67], v16 offset:0
  ds_read_b128 a[80:83], v16 offset:8192
  v_mfma_f32_16x16x32_bf16 v[104:107], a[152:155], a[112:115], v[104:107]
  buffer_load_dwordx4 v10, s[12:15], s71 offen offset:0 lds
  v_mfma_f32_16x16x32_bf16 v[120:123], a[136:139], a[100:103], v[120:123]
  ds_read_b64_tr_b16 a[128:129], v18 offset:16384
  ds_read_b64_tr_b16 a[130:131], v18 offset:18432
  v_mfma_f32_16x16x32_bf16 v[120:123], a[152:155], a[116:119], v[120:123]
  buffer_load_dwordx4 v11, s[12:15], s71 offen offset:1024 lds
  v_mfma_f32_16x16x32_bf16 v[136:139], a[136:139], a[104:107], v[136:139]
  ds_read_b64_tr_b16 a[144:145], v18 offset:20480
  ds_read_b64_tr_b16 a[146:147], v18 offset:22528
  v_mfma_f32_16x16x32_bf16 v[136:139], a[152:155], a[120:123], v[136:139]
  ds_read_b128 a[68:71], v16 offset:1024
  ds_read_b128 a[84:87], v16 offset:9216
  v_mfma_f32_16x16x32_bf16 v[152:155], a[136:139], a[108:111], v[152:155]
  ds_read_b128 a[72:75], v17 offset:0
  ds_read_b128 a[88:91], v17 offset:8192
  v_mfma_f32_16x16x32_bf16 v[152:155], a[152:155], a[124:127], v[152:155]
  buffer_load_dwordx4 v12, s[12:15], s71 offen offset:2048 lds
  v_mfma_f32_16x16x32_bf16 v[108:111], a[140:143], a[96:99], v[108:111]
  ds_read_b128 a[76:79], v17 offset:1024
  ds_read_b128 a[92:95], v17 offset:9216
  v_mfma_f32_16x16x32_bf16 v[108:111], a[156:159], a[112:115], v[108:111]
  ds_read_b64_tr_b16 a[132:133], v19 offset:16384
  ds_read_b64_tr_b16 a[134:135], v19 offset:18432
  v_mfma_f32_16x16x32_bf16 v[124:127], a[140:143], a[100:103], v[124:127]
  ds_read_b64_tr_b16 a[148:149], v19 offset:20480
  ds_read_b64_tr_b16 a[150:151], v19 offset:22528
  v_mfma_f32_16x16x32_bf16 v[124:127], a[156:159], a[116:119], v[124:127]
  buffer_load_dwordx4 v13, s[12:15], s71 offen offset:3072 lds
  v_mfma_f32_16x16x32_bf16 v[140:143], a[140:143], a[104:107], v[140:143]
  s_bfe_u32 s72, 0x302011a, s31
  v_mfma_f32_16x16x32_bf16 v[140:143], a[156:159], a[120:123], v[140:143]
  s_add_u32 s30, s30, s72
  v_mfma_f32_16x16x32_bf16 v[156:159], a[140:143], a[108:111], v[156:159]
  s_add_u32 s31, s31, 8
  s_and_b32 s31, s31, 0x8001f
  s_cmp_ge_u32 s30, 28
  s_cselect_b32 s72, 28, 0
  v_mfma_f32_16x16x32_bf16 v[156:159], a[156:159], a[124:127], v[156:159]
  s_sub_u32 s30, s30, s72
  s_lshl_b32 s72, s30, 17
  s_add_u32 s71, s93, s72
  s_waitcnt lgkmcnt(0)
  v_mfma_f32_16x16x32_bf16 v[96:99], a[128:131], a[64:67], v[96:99]
  s_mov_b32 m0, s64
  ds_read_b64_tr_b16 a[136:137], v20 offset:16384
  ds_read_b64_tr_b16 a[138:139], v20 offset:18432
  v_mfma_f32_16x16x32_bf16 v[96:99], a[144:147], a[80:83], v[96:99]
  buffer_load_dwordx4 v2, s[8:11], s70 offen offset:0 sc1 lds
  v_mfma_f32_16x16x32_bf16 v[112:115], a[128:131], a[68:71], v[112:115]
  buffer_load_dwordx4 v2, s[8:11], s70 offen offset:1024 sc1 lds
  v_mfma_f32_16x16x32_bf16 v[112:115], a[144:147], a[84:87], v[112:115]
  s_add_u32 s64, s64, s66
  ds_read_b64_tr_b16 a[152:153], v20 offset:20480
  ds_read_b64_tr_b16 a[154:155], v20 offset:22528
  v_mfma_f32_16x16x32_bf16 v[128:131], a[128:131], a[72:75], v[128:131]
  buffer_load_dwordx4 v2, s[8:11], s70 offen offset:2048 sc1 lds
  v_mfma_f32_16x16x32_bf16 v[128:131], a[144:147], a[88:91], v[128:131]
  s_add_u32 s65, s65, 1
  ds_read_b64_tr_b16 a[140:141], v21 offset:16384
  ds_read_b64_tr_b16 a[142:143], v21 offset:18432
  v_mfma_f32_16x16x32_bf16 v[144:147], a[128:131], a[76:79], v[144:147]
  buffer_load_dwordx4 v2, s[8:11], s70 offen offset:3072 sc1 lds
  v_mfma_f32_16x16x32_bf16 v[144:147], a[144:147], a[92:95], v[144:147]
  s_bfe_u32 s72, 0x302011a, s1
  ds_read_b64_tr_b16 a[156:157], v21 offset:20480
  ds_read_b64_tr_b16 a[158:159], v21 offset:22528
  v_mfma_f32_16x16x32_bf16 v[100:103], a[132:135], a[64:67], v[100:103]
  s_cmp_eq_u32 s65, 4
  s_cselect_b32 s65, 0, s65
  s_cselect_b32 s66, s67, s68
  v_mfma_f32_16x16x32_bf16 v[100:103], a[148:151], a[80:83], v[100:103]
  s_add_u32 s0, s0, s72
  v_add_u32 v16, s66, v16
  v_add_u32 v17, s66, v17
  v_mfma_f32_16x16x32_bf16 v[116:119], a[132:135], a[68:71], v[116:119]
  s_add_u32 s1, s1, 8
  v_add_u32 v18, s66, v18
  v_add_u32 v19, s66, v19
  v_mfma_f32_16x16x32_bf16 v[116:119], a[148:151], a[84:87], v[116:119]
  s_and_b32 s1, s1, 0x8001f
  s_cmp_ge_u32 s0, 28
  s_cselect_b32 s72, 28, 0
  v_mfma_f32_16x16x32_bf16 v[132:135], a[132:135], a[72:75], v[132:135]
  s_sub_u32 s0, s0, s72
  s_lshl_b32 s72, s0, 14
  s_add_u32 s70, s92, s72
  v_mfma_f32_16x16x32_bf16 v[132:135], a[148:151], a[88:91], v[132:135]
  s_waitcnt vmcnt(16) lgkmcnt(0)
  s_barrier
  v_add_u32 v20, s66, v20
  v_add_u32 v21, s66, v21
  v_mfma_f32_16x16x32_bf16 v[148:151], a[132:135], a[76:79], v[148:151]
  s_sub_u32 s69, s69, 1
  v_mfma_f32_16x16x32_bf16 v[148:151], a[148:151], a[92:95], v[148:151]
  s_cmp_lg_u32 s69, 0
  s_cbranch_scc1 Lp7_loop
  s_mov_b32 s20, s82
  s_mov_b32 s21, s83
  s_mov_b32 s22, 8388608
  s_mov_b32 s23, 0x00020000
  v_bfe_u32 v25, v1, 4, 1
  v_lshrrev_b32 v26, 5, v1
  v_lshl_or_b32 v25, v25, 1, v26
  v_lshlrev_b32 v25, 4, v25
  v_and_b32 v24, 15, v1
  v_lshl_add_u32 v26, v24, 14, v25
  v_lshl_add_u32 v27, v24, 12, v25
  v_mfma_f32_16x16x32_bf16 v[104:107], a[136:139], a[64:67], v[104:107]
  s_lshl_b32 s6, s78, 1
  s_add_u32 s6, s6, s77
  s_lshl_b32 s6, s6, 2
  v_mfma_f32_16x16x32_bf16 v[104:107], a[152:155], a[80:83], v[104:107]
  s_add_u32 s6, s6, s3
  s_lshl_b32 s6, s6, 14
  s_add_u32 s6, s6, 4096
  v_mfma_f32_16x16x32_bf16 v[120:123], a[136:139], a[68:71], v[120:123]
  s_add_u32 s7, s6, 4096
  ds_read_b128 a[96:99], v16 offset:0
  ds_read_b128 a[112:115], v16 offset:8192
  v_mfma_f32_16x16x32_bf16 v[120:123], a[152:155], a[84:87], v[120:123]
  buffer_load_dwordx4 v[176:179], v2, s[16:19], s6 offen offset:0 sc1
  v_mfma_f32_16x16x32_bf16 v[136:139], a[136:139], a[72:75], v[136:139]
  buffer_load_dwordx4 v[180:183], v2, s[16:19], s6 offen offset:1024 sc1
  v_mfma_f32_16x16x32_bf16 v[136:139], a[152:155], a[88:91], v[136:139]
  buffer_load_dwordx4 v[184:187], v2, s[16:19], s6 offen offset:2048 sc1
  v_mfma_f32_16x16x32_bf16 v[152:155], a[136:139], a[76:79], v[152:155]
  ds_read_b64_tr_b16 a[128:129], v18 offset:16384
  ds_read_b64_tr_b16 a[130:131], v18 offset:18432
  v_mfma_f32_16x16x32_bf16 v[152:155], a[152:155], a[92:95], v[152:155]
  buffer_load_dwordx4 v[188:191], v2, s[16:19], s6 offen offset:3072 sc1
  ds_read_b64_tr_b16 a[144:145], v18 offset:20480
  ds_read_b64_tr_b16 a[146:147], v18 offset:22528
  v_mfma_f32_16x16x32_bf16 v[108:111], a[140:143], a[64:67], v[108:111]
  s_lshl_b32 s32, s73, 19
  s_lshl_b32 s72, s76, 8
  s_add_u32 s32, s32, s72
  ds_read_b128 a[100:103], v16 offset:1024
  v_mfma_f32_16x16x32_bf16 v[108:111], a[156:159], a[80:83], v[108:111]
  s_and_b32 s72, s3, 1
  s_lshl_b32 s72, s72, 7
  s_add_u32 s32, s32, s72
  ds_read_b128 a[116:119], v16 offset:9216
  v_mfma_f32_16x16x32_bf16 v[124:127], a[140:143], a[68:71], v[124:127]
  s_lshr_b32 s72, s3, 1
  s_lshl_b32 s72, s72, 1
  s_add_u32 s72, s72, s77
  ds_read_b128 a[104:107], v17 offset:0
  v_mfma_f32_16x16x32_bf16 v[124:127], a[156:159], a[84:87], v[124:127]
  s_lshl_b32 s72, s72, 17
  s_add_u32 s32, s32, s72
  s_add_u32 s32, s32, 2048
  ds_read_b128 a[120:123], v17 offset:8192
  v_mfma_f32_16x16x32_bf16 v[140:143], a[140:143], a[72:75], v[140:143]
  s_add_u32 s33, s32, 65536
  s_lshl_b32 s34, s73, 19
  s_lshl_b32 s72, s76, 8
  ds_read_b128 a[108:111], v17 offset:1024
  v_mfma_f32_16x16x32_bf16 v[140:143], a[156:159], a[88:91], v[140:143]
  s_add_u32 s34, s34, s72
  s_and_b32 s72, s3, 1
  s_lshl_b32 s72, s72, 7
  ds_read_b128 a[124:127], v17 offset:9216
  v_mfma_f32_16x16x32_bf16 v[156:159], a[140:143], a[76:79], v[156:159]
  s_add_u32 s34, s34, s72
  s_lshr_b32 s72, s3, 1
  s_lshl_b32 s72, s72, 1
  ds_read_b64_tr_b16 a[132:133], v19 offset:16384
  ds_read_b64_tr_b16 a[134:135], v19 offset:18432
  ds_read_b64_tr_b16 a[148:149], v19 offset:20480
  v_mfma_f32_16x16x32_bf16 v[156:159], a[156:159], a[92:95], v[156:159]
  s_add_u32 s72, s72, s77
  s_lshl_b32 s72, s72, 12
  s_add_u32 s34, s34, s72
  s_add_u32 s35, s34, 262144
  s_add_u32 m0, s64, 16384
  ds_read_b64_tr_b16 a[150:151], v19 offset:22528
  s_nop 0
  buffer_load_dwordx4 v10, s[12:15], s71 offen offset:0 lds
  buffer_load_dwordx4 v11, s[12:15], s71 offen offset:1024 lds
  s_waitcnt lgkmcnt(0)
  v_mfma_f32_16x16x32_bf16 v[96:99], a[128:131], a[96:99], v[96:99]
  buffer_load_dwordx4 v12, s[12:15], s71 offen offset:2048 lds
  v_mfma_f32_16x16x32_bf16 v[96:99], a[144:147], a[112:115], v[96:99]
  buffer_load_dwordx4 v13, s[12:15], s71 offen offset:3072 lds
  v_mfma_f32_16x16x32_bf16 v[112:115], a[128:131], a[100:103], v[112:115]
  s_bfe_u32 s72, 0x302011a, s31
  s_add_u32 s30, s30, s72
  s_add_u32 s31, s31, 8
  v_mfma_f32_16x16x32_bf16 v[112:115], a[144:147], a[116:119], v[112:115]
  s_and_b32 s31, s31, 0x8001f
  s_cmp_ge_u32 s30, 28
  s_cselect_b32 s72, 28, 0
  v_mfma_f32_16x16x32_bf16 v[128:131], a[128:131], a[104:107], v[128:131]
  s_sub_u32 s30, s30, s72
  s_lshl_b32 s72, s30, 17
  s_add_u32 s71, s93, s72
  v_mfma_f32_16x16x32_bf16 v[128:131], a[144:147], a[120:123], v[128:131]
  s_mov_b32 m0, s64
  ds_read_b64_tr_b16 a[136:137], v20 offset:16384
  ds_read_b64_tr_b16 a[138:139], v20 offset:18432
  v_mfma_f32_16x16x32_bf16 v[144:147], a[128:131], a[108:111], v[144:147]
  buffer_load_dwordx4 v2, s[8:11], s70 offen offset:0 sc1 lds
  v_mfma_f32_16x16x32_bf16 v[144:147], a[144:147], a[124:127], v[144:147]
  buffer_load_dwordx4 v2, s[8:11], s70 offen offset:1024 sc1 lds
  v_mfma_f32_16x16x32_bf16 v[100:103], a[132:135], a[96:99], v[100:103]
  buffer_load_dwordx4 v2, s[8:11], s70 offen offset:2048 sc1 lds
  v_mfma_f32_16x16x32_bf16 v[100:103], a[148:151], a[112:115], v[100:103]
  buffer_load_dwordx4 v2, s[8:11], s70 offen offset:3072 sc1 lds
  v_mfma_f32_16x16x32_bf16 v[116:119], a[132:135], a[100:103], v[116:119]
  s_add_u32 s64, s64, s66
  ds_read_b64_tr_b16 a[152:153], v20 offset:20480
  ds_read_b64_tr_b16 a[154:155], v20 offset:22528
  v_mfma_f32_16x16x32_bf16 v[116:119], a[148:151], a[116:119], v[116:119]
  s_add_u32 s65, s65, 1
  ds_read_b64_tr_b16 a[140:141], v21 offset:16384
  ds_read_b64_tr_b16 a[142:143], v21 offset:18432
  v_mfma_f32_16x16x32_bf16 v[132:135], a[132:135], a[104:107], v[132:135]
  s_cmp_eq_u32 s65, 4
  s_cselect_b32 s65, 0, s65
  s_cselect_b32 s66, s67, s68
  ds_read_b64_tr_b16 a[156:157], v21 offset:20480
  ds_read_b64_tr_b16 a[158:159], v21 offset:22528
  v_mfma_f32_16x16x32_bf16 v[132:135], a[148:151], a[120:123], v[132:135]
  s_bfe_u32 s72, 0x302011a, s1
  s_add_u32 s0, s0, s72
  s_add_u32 s1, s1, 8
  v_add_u32 v16, s66, v16
  v_add_u32 v19, s66, v19
  v_mfma_f32_16x16x32_bf16 v[148:151], a[132:135], a[108:111], v[148:151]
  s_and_b32 s1, s1, 0x8001f
  s_cmp_ge_u32 s0, 28
  s_cselect_b32 s72, 28, 0
  v_add_u32 v17, s66, v17
  v_add_u32 v20, s66, v20
  v_mfma_f32_16x16x32_bf16 v[148:151], a[148:151], a[124:127], v[148:151]
  s_sub_u32 s0, s0, s72
  s_lshl_b32 s72, s0, 14
  s_add_u32 s70, s92, s72
  v_add_u32 v18, s66, v18
  v_add_u32 v21, s66, v21
  s_waitcnt vmcnt(20) lgkmcnt(0)
  s_barrier
  v_mfma_f32_16x16x32_bf16 v[104:107], a[136:139], a[96:99], v[104:107]
  s_add_u32 s70, s92, 458752
  s_add_u32 s71, s93, 3670016
  s_add_u32 m0, s64, 16384
  v_mfma_f32_16x16x32_bf16 v[104:107], a[152:155], a[112:115], v[104:107]
  buffer_load_dwordx4 v10, s[12:15], s71 offen offset:0 lds
  v_mfma_f32_16x16x32_bf16 v[120:123], a[136:139], a[100:103], v[120:123]
  ds_read_b128 a[64:67], v16 offset:0
  ds_read_b128 a[80:83], v16 offset:8192
  v_mfma_f32_16x16x32_bf16 v[120:123], a[152:155], a[116:119], v[120:123]
  buffer_load_dwordx4 v11, s[12:15], s71 offen offset:1024 lds
  v_mfma_f32_16x16x32_bf16 v[136:139], a[136:139], a[104:107], v[136:139]
  ds_read_b64_tr_b16 a[128:129], v18 offset:16384
  ds_read_b64_tr_b16 a[130:131], v18 offset:18432
  v_mfma_f32_16x16x32_bf16 v[136:139], a[152:155], a[120:123], v[136:139]
  ds_read_b64_tr_b16 a[144:145], v18 offset:20480
  ds_read_b64_tr_b16 a[146:147], v18 offset:22528
  v_mfma_f32_16x16x32_bf16 v[152:155], a[136:139], a[108:111], v[152:155]
  ds_read_b128 a[68:71], v16 offset:1024
  ds_read_b128 a[84:87], v16 offset:9216
  v_mfma_f32_16x16x32_bf16 v[152:155], a[152:155], a[124:127], v[152:155]
  buffer_load_dwordx4 v12, s[12:15], s71 offen offset:2048 lds
  v_mfma_f32_16x16x32_bf16 v[108:111], a[140:143], a[96:99], v[108:111]
  ds_read_b128 a[72:75], v17 offset:0
  ds_read_b128 a[88:91], v17 offset:8192
  v_mfma_f32_16x16x32_bf16 v[108:111], a[156:159], a[112:115], v[108:111]
  ds_read_b128 a[76:79], v17 offset:1024
  ds_read_b128 a[92:95], v17 offset:9216
  v_mfma_f32_16x16x32_bf16 v[124:127], a[140:143], a[100:103], v[124:127]
  ds_read_b64_tr_b16 a[132:133], v19 offset:16384
  ds_read_b64_tr_b16 a[134:135], v19 offset:18432
  v_mfma_f32_16x16x32_bf16 v[124:127], a[156:159], a[116:119], v[124:127]
  buffer_load_dwordx4 v13, s[12:15], s71 offen offset:3072 lds
  v_mfma_f32_16x16x32_bf16 v[140:143], a[140:143], a[104:107], v[140:143]
  s_add_u32 s71, s71, 131072
  ds_read_b64_tr_b16 a[148:149], v19 offset:20480
  ds_read_b64_tr_b16 a[150:151], v19 offset:22528
  v_mfma_f32_16x16x32_bf16 v[140:143], a[156:159], a[120:123], v[140:143]
  v_mfma_f32_16x16x32_bf16 v[156:159], a[140:143], a[108:111], v[156:159]
  v_mfma_f32_16x16x32_bf16 v[156:159], a[156:159], a[124:127], v[156:159]
  s_waitcnt lgkmcnt(0)
  v_mfma_f32_16x16x32_bf16 v[96:99], a[128:131], a[64:67], v[96:99]
  s_mov_b32 m0, s64
  ds_read_b64_tr_b16 a[136:137], v20 offset:16384
  ds_read_b64_tr_b16 a[138:139], v20 offset:18432
  v_mfma_f32_16x16x32_bf16 v[96:99], a[144:147], a[80:83], v[96:99]
  buffer_load_dwordx4 v2, s[8:11], s70 offen offset:0 sc1 lds
  v_mfma_f32_16x16x32_bf16 v[112:115], a[128:131], a[68:71], v[112:115]
  buffer_load_dwordx4 v2, s[8:11], s70 offen offset:1024 sc1 lds
  v_mfma_f32_16x16x32_bf16 v[112:115], a[144:147], a[84:87], v[112:115]
  s_add_u32 s64, s64, s66
  ds_read_b64_tr_b16 a[152:153], v20 offset:20480
  ds_read_b64_tr_b16 a[154:155], v20 offset:22528
  v_mfma_f32_16x16x32_bf16 v[128:131], a[128:131], a[72:75], v[128:131]
  buffer_load_dwordx4 v2, s[8:11], s70 offen offset:2048 sc1 lds
  v_mfma_f32_16x16x32_bf16 v[128:131], a[144:147], a[88:91], v[128:131]
  s_add_u32 s65, s65, 1
  ds_read_b64_tr_b16 a[140:141], v21 offset:16384
  ds_read_b64_tr_b16 a[142:143], v21 offset:18432
  v_mfma_f32_16x16x32_bf16 v[144:147], a[128:131], a[76:79], v[144:147]
  buffer_load_dwordx4 v2, s[8:11], s70 offen offset:3072 sc1 lds
  v_mfma_f32_16x16x32_bf16 v[144:147], a[144:147], a[92:95], v[144:147]
  s_add_u32 s70, s70, 16384
  ds_read_b64_tr_b16 a[156:157], v21 offset:20480
  ds_read_b64_tr_b16 a[158:159], v21 offset:22528
  v_mfma_f32_16x16x32_bf16 v[100:103], a[132:135], a[64:67], v[100:103]
  s_cmp_eq_u32 s65, 4
  s_cselect_b32 s65, 0, s65
  s_cselect_b32 s66, s67, s68
  v_mfma_f32_16x16x32_bf16 v[100:103], a[148:151], a[80:83], v[100:103]
  v_add_u32 v16, s66, v16
  v_add_u32 v17, s66, v17
  v_mfma_f32_16x16x32_bf16 v[116:119], a[132:135], a[68:71], v[116:119]
  v_add_u32 v18, s66, v18
  v_add_u32 v19, s66, v19
  v_mfma_f32_16x16x32_bf16 v[116:119], a[148:151], a[84:87], v[116:119]
  v_add_u32 v20, s66, v20
  v_add_u32 v21, s66, v21
  v_mfma_f32_16x16x32_bf16 v[132:135], a[132:135], a[72:75], v[132:135]
  v_mfma_f32_16x16x32_bf16 v[132:135], a[148:151], a[88:91], v[132:135]
  v_mfma_f32_16x16x32_bf16 v[148:151], a[132:135], a[76:79], v[148:151]
  v_mfma_f32_16x16x32_bf16 v[148:151], a[148:151], a[92:95], v[148:151]
  s_waitcnt vmcnt(16) lgkmcnt(0)
  s_barrier
  s_mov_b32 s72, 0x40000
Lrc_11:
  v_max3_u32 v6, v176, v177, v178
  v_max3_u32 v7, v184, v185, v186
  v_max3_u32 v6, v6, v179, v180
  v_max3_u32 v7, v7, v187, v188
  v_max3_u32 v6, v6, v181, v182
  v_max3_u32 v7, v7, v189, v190
  v_max_u32 v6, v6, v183
  v_max_u32 v7, v7, v191
  v_max_u32 v4, v6, v7
  v_cmp_eq_u32 vcc, -1, v4
  s_nop 0
  s_cbranch_vccz Lpolld_12
  buffer_load_dwordx4 v[176:179], v2, s[16:19], s6 offen offset:0 sc1
  buffer_load_dwordx4 v[180:183], v2, s[16:19], s6 offen offset:1024 sc1
  buffer_load_dwordx4 v[184:187], v2, s[16:19], s6 offen offset:2048 sc1
  buffer_load_dwordx4 v[188:191], v2, s[16:19], s6 offen offset:3072 sc1
  s_sub_u32 s72, s72, 1
  s_waitcnt vmcnt(0)
  s_cbranch_scc0 Lrc_11
Lpolld_12:
  v_mfma_f32_16x16x32_bf16 v[104:107], a[136:139], a[64:67], v[104:107]
  s_add_u32 m0, s64, 16384
  ds_read_b128 a[96:99], v16 offset:0
  ds_read_b128 a[112:115], v16 offset:8192
  v_mfma_f32_16x16x32_bf16 v[104:107], a[152:155], a[80:83], v[104:107]
  buffer_load_dwordx4 v10, s[12:15], s71 offen offset:0 lds
  v_mfma_f32_16x16x32_bf16 v[120:123], a[136:139], a[68:71], v[120:123]
  ds_read_b64_tr_b16 a[128:129], v18 offset:16384
  ds_read_b64_tr_b16 a[130:131], v18 offset:18432
  v_mfma_f32_16x16x32_bf16 v[120:123], a[152:155], a[84:87], v[120:123]
  buffer_load_dwordx4 v11, s[12:15], s71 offen offset:1024 lds
  v_mfma_f32_16x16x32_bf16 v[136:139], a[136:139], a[72:75], v[136:139]
  ds_read_b64_tr_b16 a[144:145], v18 offset:20480
  ds_read_b64_tr_b16 a[146:147], v18 offset:22528
  v_mfma_f32_16x16x32_bf16 v[136:139], a[152:155], a[88:91], v[136:139]
  ds_read_b128 a[100:103], v16 offset:1024
  ds_read_b128 a[116:119], v16 offset:9216
  v_mfma_f32_16x16x32_bf16 v[152:155], a[136:139], a[76:79], v[152:155]
  ds_read_b128 a[104:107], v17 offset:0
  ds_read_b128 a[120:123], v17 offset:8192
  v_mfma_f32_16x16x32_bf16 v[152:155], a[152:155], a[92:95], v[152:155]
  buffer_load_dwordx4 v12, s[12:15], s71 offen offset:2048 lds
  v_mfma_f32_16x16x32_bf16 v[108:111], a[140:143], a[64:67], v[108:111]
  ds_read_b128 a[108:111], v17 offset:1024
  ds_read_b128 a[124:127], v17 offset:9216
  v_mfma_f32_16x16x32_bf16 v[108:111], a[156:159], a[80:83], v[108:111]
  ds_read_b64_tr_b16 a[132:133], v19 offset:16384
  ds_read_b64_tr_b16 a[134:135], v19 offset:18432
  v_mfma_f32_16x16x32_bf16 v[124:127], a[140:143], a[68:71], v[124:127]
  ds_read_b64_tr_b16 a[148:149], v19 offset:20480
  ds_read_b64_tr_b16 a[150:151], v19 offset:22528
  v_mfma_f32_16x16x32_bf16 v[124:127], a[156:159], a[84:87], v[124:127]
  buffer_load_dwordx4 v13, s[12:15], s71 offen offset:3072 lds
  v_mfma_f32_16x16x32_bf16 v[140:143], a[140:143], a[72:75], v[140:143]
  s_add_u32 s71, s71, 131072
  v_lshlrev_b32 v64, 16, v176
  v_and_b32 v65, 0xffff0000, v176
  v_mfma_f32_16x16x32_bf16 v[140:143], a[156:159], a[88:91], v[140:143]
  v_lshlrev_b32 v66, 16, v177
  v_and_b32 v67, 0xffff0000, v177
  v_mfma_f32_16x16x32_bf16 v[156:159], a[140:143], a[76:79], v[156:159]
  v_lshlrev_b32 v68, 16, v178
  v_and_b32 v69, 0xffff0000, v178
  v_mfma_f32_16x16x32_bf16 v[156:159], a[156:159], a[92:95], v[156:159]
  v_lshlrev_b32 v70, 16, v179
  v_and_b32 v71, 0xffff0000, v179
  v_pk_add_f32 v[64:65], v[64:65], v[32:33]
  v_pk_add_f32 v[66:67], v[66:67], v[34:35]
  v_pk_add_f32 v[68:69], v[68:69], v[36:37]
  v_pk_add_f32 v[70:71], v[70:71], v[38:39]
  v_cvt_pk_bf16_f32 v64, v64, v65
  v_cvt_pk_bf16_f32 v65, v66, v67
  v_cvt_pk_bf16_f32 v66, v68, v69
  v_cvt_pk_bf16_f32 v67, v70, v71
  s_nop 0
  v_permlane16_swap_b32 v64, v66
  v_permlane16_swap_b32 v65, v67
  s_waitcnt lgkmcnt(0)
  v_mfma_f32_16x16x32_bf16 v[96:99], a[128:131], a[96:99], v[96:99]
  s_mov_b32 m0, s64
  ds_read_b64_tr_b16 a[136:137], v20 offset:16384
  ds_read_b64_tr_b16 a[138:139], v20 offset:18432
  v_mfma_f32_16x16x32_bf16 v[96:99], a[144:147], a[112:115], v[96:99]
  buffer_load_dwordx4 v2, s[8:11], s70 offen offset:0 sc1 lds
  v_mfma_f32_16x16x32_bf16 v[112:115], a[128:131], a[100:103], v[112:115]
  buffer_load_dwordx4 v2, s[8:11], s70 offen offset:1024 sc1 lds
  v_mfma_f32_16x16x32_bf16 v[112:115], a[144:147], a[116:119], v[112:115]
  s_add_u32 s64, s64, s66
  ds_read_b64_tr_b16 a[152:153], v20 offset:20480
  ds_read_b64_tr_b16 a[154:155], v20 offset:22528
  v_mfma_f32_16x16x32_bf16 v[128:131], a[128:131], a[104:107], v[128:131]
  buffer_load_dwordx4 v2, s[8:11], s70 offen offset:2048 sc1 lds
  v_mfma_f32_16x16x32_bf16 v[128:131], a[144:147], a[120:123], v[128:131]
  s_add_u32 s65, s65, 1
  ds_read_b64_tr_b16 a[140:141], v21 offset:16384
  ds_read_b64_tr_b16 a[142:143], v21 offset:18432
  v_mfma_f32_16x16x32_bf16 v[144:147], a[128:131], a[108:111], v[144:147]
  buffer_load_dwordx4 v2, s[8:11], s70 offen offset:3072 sc1 lds
  v_mfma_f32_16x16x32_bf16 v[144:147], a[144:147], a[124:127], v[144:147]
  s_add_u32 s70, s70, 16384
  ds_read_b64_tr_b16 a[156:157], v21 offset:20480
  ds_read_b64_tr_b16 a[158:159], v21 offset:22528
  v_mfma_f32_16x16x32_bf16 v[100:103], a[132:135], a[96:99], v[100:103]
  s_cmp_eq_u32 s65, 4
  s_cselect_b32 s65, 0, s65
  s_cselect_b32 s66, s67, s68
  v_mfma_f32_16x16x32_bf16 v[100:103], a[148:151], a[112:115], v[100:103]
  v_add_u32 v16, s66, v16
  v_add_u32 v17, s66, v17
  v_mfma_f32_16x16x32_bf16 v[116:119], a[132:135], a[100:103], v[116:119]
  v_add_u32 v18, s66, v18
  v_add_u32 v19, s66, v19
  v_mfma_f32_16x16x32_bf16 v[116:119], a[148:151], a[116:119], v[116:119]
  v_add_u32 v20, s66, v20
  v_add_u32 v21, s66, v21
  v_mfma_f32_16x16x32_bf16 v[132:135], a[132:135], a[104:107], v[132:135]
  v_mfma_f32_16x16x32_bf16 v[132:135], a[148:151], a[120:123], v[132:135]
  v_mfma_f32_16x16x32_bf16 v[148:151], a[132:135], a[108:111], v[148:151]
  v_mfma_f32_16x16x32_bf16 v[148:151], a[148:151], a[124:127], v[148:151]
  buffer_store_dwordx4 v[64:67], v27, s[20:23], s32 offen offset:0
  s_waitcnt vmcnt(17) lgkmcnt(0)
  s_barrier
  v_mfma_f32_16x16x32_bf16 v[104:107], a[136:139], a[96:99], v[104:107]
  s_and_b32 s88, s3, 1
  s_lshl_b32 s88, s88, 12
  s_lshr_b32 s72, s3, 1
  v_mfma_f32_16x16x32_bf16 v[104:107], a[152:155], a[112:115], v[104:107]
  s_lshl_b32 s72, s72, 13
  s_add_u32 s88, s88, s72
  s_lshl_b32 s72, s77, 11
  v_mfma_f32_16x16x32_bf16 v[120:123], a[136:139], a[100:103], v[120:123]
  s_add_u32 s88, s88, s72
  s_sub_u32 s88, s88, s79
  s_add_u32 s70, s92, s88
  v_mfma_f32_16x16x32_bf16 v[120:123], a[152:155], a[116:119], v[120:123]
  s_add_u32 s70, s70, 491520
  s_add_u32 s71, s93, 3932160
  s_add_u32 m0, s64, 16384
  v_mfma_f32_16x16x32_bf16 v[136:139], a[136:139], a[104:107], v[136:139]
  buffer_load_dwordx4 v10, s[12:15], s71 offen offset:0 lds
  v_mfma_f32_16x16x32_bf16 v[136:139], a[152:155], a[120:123], v[136:139]
  buffer_load_dwordx4 v11, s[12:15], s71 offen offset:1024 lds
  v_mfma_f32_16x16x32_bf16 v[152:155], a[136:139], a[108:111], v[152:155]
  ds_read_b128 a[64:67], v16 offset:0
  ds_read_b128 a[80:83], v16 offset:8192
  v_mfma_f32_16x16x32_bf16 v[152:155], a[152:155], a[124:127], v[152:155]
  ds_read_b64_tr_b16 a[128:129], v18 offset:16384
  ds_read_b64_tr_b16 a[130:131], v18 offset:18432
  v_mfma_f32_16x16x32_bf16 v[108:111], a[140:143], a[96:99], v[108:111]
  ds_read_b64_tr_b16 a[144:145], v18 offset:20480
  ds_read_b64_tr_b16 a[146:147], v18 offset:22528
  v_mfma_f32_16x16x32_bf16 v[108:111], a[156:159], a[112:115], v[108:111]
  ds_read_b128 a[68:71], v16 offset:1024
  ds_read_b128 a[84:87], v16 offset:9216
  v_mfma_f32_16x16x32_bf16 v[124:127], a[140:143], a[100:103], v[124:127]
  buffer_load_dwordx4 v12, s[12:15], s71 offen offset:2048 lds
  v_mfma_f32_16x16x32_bf16 v[124:127], a[156:159], a[116:119], v[124:127]
  ds_read_b128 a[72:75], v17 offset:0
  ds_read_b128 a[88:91], v17 offset:8192
  v_mfma_f32_16x16x32_bf16 v[140:143], a[140:143], a[104:107], v[140:143]
  ds_read_b128 a[76:79], v17 offset:1024
  ds_read_b128 a[92:95], v17 offset:9216
  v_mfma_f32_16x16x32_bf16 v[140:143], a[156:159], a[120:123], v[140:143]
  ds_read_b64_tr_b16 a[132:133], v19 offset:16384
  ds_read_b64_tr_b16 a[134:135], v19 offset:18432
  v_mfma_f32_16x16x32_bf16 v[156:159], a[140:143], a[108:111], v[156:159]
  ds_read_b64_tr_b16 a[148:149], v19 offset:20480
  ds_read_b64_tr_b16 a[150:151], v19 offset:22528
  v_mfma_f32_16x16x32_bf16 v[156:159], a[156:159], a[124:127], v[156:159]
  v_lshlrev_b32 v72, 16, v180
  v_and_b32 v73, 0xffff0000, v180
  v_lshlrev_b32 v74, 16, v181
  v_and_b32 v75, 0xffff0000, v181
  v_lshlrev_b32 v76, 16, v182
  v_and_b32 v77, 0xffff0000, v182
  v_lshlrev_b32 v78, 16, v183
  v_and_b32 v79, 0xffff0000, v183
  v_pk_add_f32 v[72:73], v[72:73], v[40:41]
  v_pk_add_f32 v[74:75], v[74:75], v[42:43]
  v_pk_add_f32 v[76:77], v[76:77], v[44:45]
  v_pk_add_f32 v[78:79], v[78:79], v[46:47]
  v_cvt_pk_bf16_f32 v72, v72, v73
  v_cvt_pk_bf16_f32 v73, v74, v75
  v_cvt_pk_bf16_f32 v74, v76, v77
  v_cvt_pk_bf16_f32 v75, v78, v79
  s_nop 0
  v_permlane16_swap_b32 v72, v74
  v_permlane16_swap_b32 v73, v75
  s_waitcnt lgkmcnt(0)
  v_mfma_f32_16x16x32_bf16 v[96:99], a[128:131], a[64:67], v[96:99]
  buffer_load_dwordx4 v13, s[12:15], s71 offen offset:3072 lds
  v_mfma_f32_16x16x32_bf16 v[96:99], a[144:147], a[80:83], v[96:99]
  s_add_u32 s71, s71, 131072
  s_add_u32 m0, s64, s88
  ds_read_b64_tr_b16 a[136:137], v20 offset:16384
  v_mfma_f32_16x16x32_bf16 v[112:115], a[128:131], a[68:71], v[112:115]
  s_add_u32 s64, s64, s66
  ds_read_b64_tr_b16 a[138:139], v20 offset:18432
  ds_read_b64_tr_b16 a[152:153], v20 offset:20480
  v_mfma_f32_16x16x32_bf16 v[112:115], a[144:147], a[84:87], v[112:115]
  buffer_load_dwordx4 v2, s[8:11], s70 offen offset:0 sc1 lds
  v_mfma_f32_16x16x32_bf16 v[128:131], a[128:131], a[72:75], v[128:131]
  s_add_u32 s65, s65, 1
  ds_read_b64_tr_b16 a[154:155], v20 offset:22528
  ds_read_b64_tr_b16 a[140:141], v21 offset:16384
  v_mfma_f32_16x16x32_bf16 v[128:131], a[144:147], a[88:91], v[128:131]
  ds_read_b64_tr_b16 a[142:143], v21 offset:18432
  ds_read_b64_tr_b16 a[156:157], v21 offset:20480
  v_mfma_f32_16x16x32_bf16 v[144:147], a[128:131], a[76:79], v[144:147]
  buffer_load_dwordx4 v2, s[8:11], s70 offen offset:1024 sc1 lds
  v_mfma_f32_16x16x32_bf16 v[144:147], a[144:147], a[92:95], v[144:147]
  s_add_u32 s70, s70, 16384
  ds_read_b64_tr_b16 a[158:159], v21 offset:22528
  v_mfma_f32_16x16x32_bf16 v[100:103], a[132:135], a[64:67], v[100:103]
  s_cmp_eq_u32 s65, 4
  s_cselect_b32 s65, 0, s65
  s_cselect_b32 s66, s67, s68
  v_mfma_f32_16x16x32_bf16 v[100:103], a[148:151], a[80:83], v[100:103]
  v_add_u32 v16, s66, v16
  v_add_u32 v17, s66, v17
  v_mfma_f32_16x16x32_bf16 v[116:119], a[132:135], a[68:71], v[116:119]
  v_add_u32 v18, s66, v18
  v_add_u32 v19, s66, v19
  v_mfma_f32_16x16x32_bf16 v[116:119], a[148:151], a[84:87], v[116:119]
  v_add_u32 v20, s66, v20
  v_add_u32 v21, s66, v21
  v_mfma_f32_16x16x32_bf16 v[132:135], a[132:135], a[72:75], v[132:135]
  v_mfma_f32_16x16x32_bf16 v[132:135], a[148:151], a[88:91], v[132:135]
  v_mfma_f32_16x16x32_bf16 v[148:151], a[132:135], a[76:79], v[148:151]
  v_mfma_f32_16x16x32_bf16 v[148:151], a[148:151], a[92:95], v[148:151]
  buffer_store_dwordx4 v[72:75], v27, s[20:23], s32 offen offset:64
  s_waitcnt vmcnt(16) lgkmcnt(0)
  s_barrier
  v_mfma_f32_16x16x32_bf16 v[104:107], a[136:139], a[64:67], v[104:107]
  s_add_u32 m0, s64, 16384
  ds_read_b128 a[96:99], v16 offset:0
  ds_read_b128 a[112:115], v16 offset:8192
  v_mfma_f32_16x16x32_bf16 v[104:107], a[152:155], a[80:83], v[104:107]
  buffer_load_dwordx4 v10, s[12:15], s71 offen offset:0 lds
  v_mfma_f32_16x16x32_bf16 v[120:123], a[136:139], a[68:71], v[120:123]
  ds_read_b64_tr_b16 a[128:129], v18 offset:16384
  ds_read_b64_tr_b16 a[130:131], v18 offset:18432
  v_mfma_f32_16x16x32_bf16 v[120:123], a[152:155], a[84:87], v[120:123]
  ds_read_b64_tr_b16 a[144:145], v18 offset:20480
  ds_read_b64_tr_b16 a[146:147], v18 offset:22528
  v_mfma_f32_16x16x32_bf16 v[136:139], a[136:139], a[72:75], v[136:139]
  ds_read_b128 a[100:103], v16 offset:1024
  ds_read_b128 a[116:119], v16 offset:9216
  v_mfma_f32_16x16x32_bf16 v[136:139], a[152:155], a[88:91], v[136:139]
  buffer_load_dwordx4 v11, s[12:15], s71 offen offset:1024 lds
  v_mfma_f32_16x16x32_bf16 v[152:155], a[136:139], a[76:79], v[152:155]
  ds_read_b128 a[104:107], v17 offset:0
  ds_read_b128 a[120:123], v17 offset:8192
  v_mfma_f32_16x16x32_bf16 v[152:155], a[152:155], a[92:95], v[152:155]
  ds_read_b128 a[108:111], v17 offset:1024
  ds_read_b128 a[124:127], v17 offset:9216
  v_mfma_f32_16x16x32_bf16 v[108:111], a[140:143], a[64:67], v[108:111]
  ds_read_b64_tr_b16 a[132:133], v19 offset:16384
  ds_read_b64_tr_b16 a[134:135], v19 offset:18432
  v_mfma_f32_16x16x32_bf16 v[108:111], a[156:159], a[80:83], v[108:111]
  ds_read_b64_tr_b16 a[148:149], v19 offset:20480
  ds_read_b64_tr_b16 a[150:151], v19 offset:22528
  v_mfma_f32_16x16x32_bf16 v[124:127], a[140:143], a[68:71], v[124:127]
  buffer_load_dwordx4 v12, s[12:15], s71 offen offset:2048 lds
  v_mfma_f32_16x16x32_bf16 v[124:127], a[156:159], a[84:87], v[124:127]
  v_lshlrev_b32 v80, 16, v184
  v_and_b32 v81, 0xffff0000, v184
  v_mfma_f32_16x16x32_bf16 v[140:143], a[140:143], a[72:75], v[140:143]
  v_lshlrev_b32 v82, 16, v185
  v_and_b32 v83, 0xffff0000, v185
  v_mfma_f32_16x16x32_bf16 v[140:143], a[156:159], a[88:91], v[140:143]
  v_lshlrev_b32 v84, 16, v186
  v_and_b32 v85, 0xffff0000, v186
  v_mfma_f32_16x16x32_bf16 v[156:159], a[140:143], a[76:79], v[156:159]
  v_lshlrev_b32 v86, 16, v187
  v_and_b32 v87, 0xffff0000, v187
  v_mfma_f32_16x16x32_bf16 v[156:159], a[156:159], a[92:95], v[156:159]
  v_pk_add_f32 v[80:81], v[80:81], v[48:49]
  v_pk_add_f32 v[82:83], v[82:83], v[50:51]
  v_pk_add_f32 v[84:85], v[84:85], v[52:53]
  v_pk_add_f32 v[86:87], v[86:87], v[54:55]
  v_cvt_pk_bf16_f32 v80, v80, v81
  v_cvt_pk_bf16_f32 v81, v82, v83
  v_cvt_pk_bf16_f32 v82, v84, v85
  v_cvt_pk_bf16_f32 v83, v86, v87
  s_nop 0
  v_permlane16_swap_b32 v80, v82
  v_permlane16_swap_b32 v81, v83
  s_waitcnt lgkmcnt(0)
  v_mfma_f32_16x16x32_bf16 v[96:99], a[128:131], a[96:99], v[96:99]
  buffer_load_dwordx4 v13, s[12:15], s71 offen offset:3072 lds
  v_mfma_f32_16x16x32_bf16 v[96:99], a[144:147], a[112:115], v[96:99]
  s_add_u32 s71, s71, 131072
  s_add_u32 m0, s64, s88
  ds_read_b64_tr_b16 a[136:137], v20 offset:16384
  v_mfma_f32_16x16x32_bf16 v[112:115], a[128:131], a[100:103], v[112:115]
  s_add_u32 s64, s64, s66
  ds_read_b64_tr_b16 a[138:139], v20 offset:18432
  ds_read_b64_tr_b16 a[152:153], v20 offset:20480
  v_mfma_f32_16x16x32_bf16 v[112:115], a[144:147], a[116:119], v[112:115]
  buffer_load_dwordx4 v2, s[8:11], s70 offen offset:0 sc1 lds
  v_mfma_f32_16x16x32_bf16 v[128:131], a[128:131], a[104:107], v[128:131]
  s_add_u32 s65, s65, 1
  ds_read_b64_tr_b16 a[154:155], v20 offset:22528
  ds_read_b64_tr_b16 a[140:141], v21 offset:16384
  v_mfma_f32_16x16x32_bf16 v[128:131], a[144:147], a[120:123], v[128:131]
  ds_read_b64_tr_b16 a[142:143], v21 offset:18432
  ds_read_b64_tr_b16 a[156:157], v21 offset:20480
  v_mfma_f32_16x16x32_bf16 v[144:147], a[128:131], a[108:111], v[144:147]
  buffer_load_dwordx4 v2, s[8:11], s70 offen offset:1024 sc1 lds
  v_mfma_f32_16x16x32_bf16 v[144:147], a[144:147], a[124:127], v[144:147]
  s_add_u32 s70, s70, 16384
  ds_read_b64_tr_b16 a[158:159], v21 offset:22528
  v_mfma_f32_16x16x32_bf16 v[100:103], a[132:135], a[96:99], v[100:103]
  s_cmp_eq_u32 s65, 4
  s_cselect_b32 s65, 0, s65
  s_cselect_b32 s66, s67, s68
  v_mfma_f32_16x16x32_bf16 v[100:103], a[148:151], a[112:115], v[100:103]
  v_add_u32 v16, s66, v16
  v_add_u32 v17, s66, v17
  v_mfma_f32_16x16x32_bf16 v[116:119], a[132:135], a[100:103], v[116:119]
  v_add_u32 v18, s66, v18
  v_add_u32 v19, s66, v19
  v_mfma_f32_16x16x32_bf16 v[116:119], a[148:151], a[116:119], v[116:119]
  v_add_u32 v20, s66, v20
  v_add_u32 v21, s66, v21
  v_mfma_f32_16x16x32_bf16 v[132:135], a[132:135], a[104:107], v[132:135]
  v_mfma_f32_16x16x32_bf16 v[132:135], a[148:151], a[120:123], v[132:135]
  v_mfma_f32_16x16x32_bf16 v[148:151], a[132:135], a[108:111], v[148:151]
  v_mfma_f32_16x16x32_bf16 v[148:151], a[148:151], a[124:127], v[148:151]
  buffer_store_dwordx4 v[80:83], v27, s[20:23], s33 offen offset:0
  s_waitcnt vmcnt(15) lgkmcnt(0)
  s_barrier
  v_mfma_f32_16x16x32_bf16 v[104:107], a[136:139], a[96:99], v[104:107]
  s_sub_u32 s70, s70, 32768
  s_xor_b32 s70, s70, 524288
  s_sub_u32 s71, s71, 262144
  v_mfma_f32_16x16x32_bf16 v[104:107], a[152:155], a[112:115], v[104:107]
  s_xor_b32 s71, s71, 4194304
  s_add_u32 m0, s64, 16384
  ds_read_b128 a[64:67], v16 offset:0
  v_mfma_f32_16x16x32_bf16 v[120:123], a[136:139], a[100:103], v[120:123]
  buffer_load_dwordx4 v10, s[12:15], s71 offen offset:0 lds
  v_mfma_f32_16x16x32_bf16 v[120:123], a[152:155], a[116:119], v[120:123]
  ds_read_b128 a[80:83], v16 offset:8192
  ds_read_b64_tr_b16 a[128:129], v18 offset:16384
  v_mfma_f32_16x16x32_bf16 v[136:139], a[136:139], a[104:107], v[136:139]
  ds_read_b64_tr_b16 a[130:131], v18 offset:18432
  ds_read_b64_tr_b16 a[144:145], v18 offset:20480
  v_mfma_f32_16x16x32_bf16 v[136:139], a[152:155], a[120:123], v[136:139]
  buffer_load_dwordx4 v11, s[12:15], s71 offen offset:1024 lds
  v_mfma_f32_16x16x32_bf16 v[152:155], a[136:139], a[108:111], v[152:155]
  ds_read_b64_tr_b16 a[146:147], v18 offset:22528
  ds_read_b128 a[68:71], v16 offset:1024
  v_mfma_f32_16x16x32_bf16 v[152:155], a[152:155], a[124:127], v[152:155]
  ds_read_b128 a[84:87], v16 offset:9216
  ds_read_b128 a[72:75], v17 offset:0
  v_mfma_f32_16x16x32_bf16 v[108:111], a[140:143], a[96:99], v[108:111]
  ds_read_b128 a[88:91], v17 offset:8192
  ds_read_b128 a[76:79], v17 offset:1024
  v_mfma_f32_16x16x32_bf16 v[108:111], a[156:159], a[112:115], v[108:111]
  ds_read_b128 a[92:95], v17 offset:9216
  ds_read_b64_tr_b16 a[132:133], v19 offset:16384
  v_mfma_f32_16x16x32_bf16 v[124:127], a[140:143], a[100:103], v[124:127]
  buffer_load_dwordx4 v12, s[12:15], s71 offen offset:2048 lds
  v_mfma_f32_16x16x32_bf16 v[124:127], a[156:159], a[116:119], v[124:127]
  ds_read_b64_tr_b16 a[134:135], v19 offset:18432
  ds_read_b64_tr_b16 a[148:149], v19 offset:20480
  v_mfma_f32_16x16x32_bf16 v[140:143], a[140:143], a[104:107], v[140:143]
  ds_read_b64_tr_b16 a[150:151], v19 offset:22528
  v_lshlrev_b32 v88, 16, v188
  v_mfma_f32_16x16x32_bf16 v[140:143], a[156:159], a[120:123], v[140:143]
  v_and_b32 v89, 0xffff0000, v188
  v_lshlrev_b32 v90, 16, v189
  v_mfma_f32_16x16x32_bf16 v[156:159], a[140:143], a[108:111], v[156:159]
  v_and_b32 v91, 0xffff0000, v189
  v_lshlrev_b32 v92, 16, v190
  v_mfma_f32_16x16x32_bf16 v[156:159], a[156:159], a[124:127], v[156:159]
  v_and_b32 v93, 0xffff0000, v190
  v_lshlrev_b32 v94, 16, v191
  v_and_b32 v95, 0xffff0000, v191
  v_pk_add_f32 v[88:89], v[88:89], v[56:57]
  v_pk_add_f32 v[90:91], v[90:91], v[58:59]
  v_pk_add_f32 v[92:93], v[92:93], v[60:61]
  v_pk_add_f32 v[94:95], v[94:95], v[62:63]
  v_cvt_pk_bf16_f32 v88, v88, v89
  v_cvt_pk_bf16_f32 v89, v90, v91
  v_cvt_pk_bf16_f32 v90, v92, v93
  v_cvt_pk_bf16_f32 v91, v94, v95
  s_nop 0
  v_permlane16_swap_b32 v88, v90
  v_permlane16_swap_b32 v89, v91
  s_waitcnt lgkmcnt(0)
  v_mfma_f32_16x16x32_bf16 v[96:99], a[128:131], a[64:67], v[96:99]
  buffer_load_dwordx4 v13, s[12:15], s71 offen offset:3072 lds
  v_mfma_f32_16x16x32_bf16 v[96:99], a[144:147], a[80:83], v[96:99]
  s_add_u32 s71, s71, 131072
  s_add_u32 m0, s64, s88
  ds_read_b64_tr_b16 a[136:137], v20 offset:16384
  v_mfma_f32_16x16x32_bf16 v[112:115], a[128:131], a[68:71], v[112:115]
  s_add_u32 s64, s64, s66
  ds_read_b64_tr_b16 a[138:139], v20 offset:18432
  ds_read_b64_tr_b16 a[152:153], v20 offset:20480
  v_mfma_f32_16x16x32_bf16 v[112:115], a[144:147], a[84:87], v[112:115]
  buffer_load_dwordx4 v2, s[8:11], s70 offen offset:0 sc1 lds
  v_mfma_f32_16x16x32_bf16 v[128:131], a[128:131], a[72:75], v[128:131]
  s_add_u32 s65, s65, 1
  ds_read_b64_tr_b16 a[154:155], v20 offset:22528
  ds_read_b64_tr_b16 a[140:141], v21 offset:16384
  v_mfma_f32_16x16x32_bf16 v[128:131], a[144:147], a[88:91], v[128:131]
  ds_read_b64_tr_b16 a[142:143], v21 offset:18432
  ds_read_b64_tr_b16 a[156:157], v21 offset:20480
  v_mfma_f32_16x16x32_bf16 v[144:147], a[128:131], a[76:79], v[144:147]
  buffer_load_dwordx4 v2, s[8:11], s70 offen offset:1024 sc1 lds
  v_mfma_f32_16x16x32_bf16 v[144:147], a[144:147], a[92:95], v[144:147]
  s_add_u32 s70, s70, 16384
  ds_read_b64_tr_b16 a[158:159], v21 offset:22528
  v_mfma_f32_16x16x32_bf16 v[100:103], a[132:135], a[64:67], v[100:103]
  s_cmp_eq_u32 s65, 4
  s_cselect_b32 s65, 0, s65
  s_cselect_b32 s66, s67, s68
  v_mfma_f32_16x16x32_bf16 v[100:103], a[148:151], a[80:83], v[100:103]
  v_add_u32 v16, s66, v16
  v_add_u32 v17, s66, v17
  v_mfma_f32_16x16x32_bf16 v[116:119], a[132:135], a[68:71], v[116:119]
  v_add_u32 v18, s66, v18
  v_add_u32 v19, s66, v19
  v_mfma_f32_16x16x32_bf16 v[116:119], a[148:151], a[84:87], v[116:119]
  v_add_u32 v20, s66, v20
  v_add_u32 v21, s66, v21
  v_mfma_f32_16x16x32_bf16 v[132:135], a[132:135], a[72:75], v[132:135]
  v_mfma_f32_16x16x32_bf16 v[132:135], a[148:151], a[88:91], v[132:135]
  v_mfma_f32_16x16x32_bf16 v[148:151], a[132:135], a[76:79], v[148:151]
  v_mfma_f32_16x16x32_bf16 v[148:151], a[148:151], a[92:95], v[148:151]
  buffer_store_dwordx4 v[88:91], v27, s[20:23], s33 offen offset:64
  s_waitcnt vmcnt(15) lgkmcnt(0)
  s_barrier
  v_mfma_f32_16x16x32_bf16 v[104:107], a[136:139], a[64:67], v[104:107]
  s_add_u32 m0, s64, 16384
  ds_read_b128 a[96:99], v16 offset:0
  ds_read_b128 a[112:115], v16 offset:8192
  v_mfma_f32_16x16x32_bf16 v[104:107], a[152:155], a[80:83], v[104:107]
  buffer_load_dwordx4 v10, s[12:15], s71 offen offset:0 lds
  v_mfma_f32_16x16x32_bf16 v[120:123], a[136:139], a[68:71], v[120:123]
  buffer_load_dwordx4 v11, s[12:15], s71 offen offset:1024 lds
  v_mfma_f32_16x16x32_bf16 v[120:123], a[152:155], a[84:87], v[120:123]
  ds_read_b64_tr_b16 a[128:129], v18 offset:16384
  ds_read_b64_tr_b16 a[130:131], v18 offset:18432
  v_mfma_f32_16x16x32_bf16 v[136:139], a[136:139], a[72:75], v[136:139]
  ds_read_b64_tr_b16 a[144:145], v18 offset:20480
  ds_read_b64_tr_b16 a[146:147], v18 offset:22528
  v_mfma_f32_16x16x32_bf16 v[136:139], a[152:155], a[88:91], v[136:139]
  buffer_load_dwordx4 v12, s[12:15], s71 offen offset:2048 lds
  v_mfma_f32_16x16x32_bf16 v[152:155], a[136:139], a[76:79], v[152:155]
  ds_read_b128 a[100:103], v16 offset:1024
  ds_read_b128 a[116:119], v16 offset:9216
  v_mfma_f32_16x16x32_bf16 v[152:155], a[152:155], a[92:95], v[152:155]
  buffer_load_dwordx4 v13, s[12:15], s71 offen offset:3072 lds
  v_mfma_f32_16x16x32_bf16 v[108:111], a[140:143], a[64:67], v[108:111]
  s_add_u32 s71, s71, 131072
  s_add_u32 m0, s64, s88
  ds_read_b64_tr_b16 a[132:133], v19 offset:16384
  v_mfma_f32_16x16x32_bf16 v[108:111], a[156:159], a[80:83], v[108:111]
  ds_read_b64_tr_b16 a[134:135], v19 offset:18432
  ds_read_b64_tr_b16 a[148:149], v19 offset:20480
  v_mfma_f32_16x16x32_bf16 v[124:127], a[140:143], a[68:71], v[124:127]
  buffer_load_dwordx4 v2, s[8:11], s70 offen offset:0 sc1 lds
  v_mfma_f32_16x16x32_bf16 v[124:127], a[156:159], a[84:87], v[124:127]
  ds_read_b64_tr_b16 a[150:151], v19 offset:22528
  v_mfma_f32_16x16x32_bf16 v[140:143], a[140:143], a[72:75], v[140:143]
  buffer_load_dwordx4 v2, s[8:11], s70 offen offset:1024 sc1 lds
  v_mfma_f32_16x16x32_bf16 v[140:143], a[156:159], a[88:91], v[140:143]
  s_add_u32 s70, s70, 16384
  s_lshl_b32 s36, s78, 1
  v_mfma_f32_16x16x32_bf16 v[156:159], a[140:143], a[76:79], v[156:159]
  s_add_u32 s36, s36, s77
  s_xor_b32 s36, s36, 1
  s_lshl_b32 s36, s36, 2
  v_mfma_f32_16x16x32_bf16 v[156:159], a[156:159], a[92:95], v[156:159]
  s_add_u32 s36, s36, s3
  s_lshl_b32 s36, s36, 14
  s_add_u32 s37, s36, 4096
  s_waitcnt lgkmcnt(0)
  v_cvt_pk_bf16_f32 v128, v128, v129
  v_cvt_pk_bf16_f32 v129, v130, v131
  v_cvt_pk_bf16_f32 v130, v132, v133
  v_cvt_pk_bf16_f32 v131, v134, v135
  v_cvt_pk_bf16_f32 v132, v136, v137
  v_cvt_pk_bf16_f32 v133, v138, v139
  v_cvt_pk_bf16_f32 v134, v140, v141
  v_cvt_pk_bf16_f32 v135, v142, v143
  v_cvt_pk_bf16_f32 v136, v144, v145
  v_cvt_pk_bf16_f32 v137, v146, v147
  v_cvt_pk_bf16_f32 v138, v148, v149
  v_cvt_pk_bf16_f32 v139, v150, v151
  v_cvt_pk_bf16_f32 v140, v152, v153
  v_cvt_pk_bf16_f32 v141, v154, v155
  v_cvt_pk_bf16_f32 v142, v156, v157
  v_cvt_pk_bf16_f32 v143, v158, v159
  v_mfma_f32_16x16x32_bf16 v[96:99], a[128:131], a[96:99], v[96:99]
  buffer_store_dwordx4 v[128:131], v2, s[16:19], s36 offen offset:0 sc1
  v_mfma_f32_16x16x32_bf16 v[96:99], a[144:147], a[112:115], v[96:99]
  buffer_store_dwordx4 v[132:135], v2, s[16:19], s36 offen offset:1024 sc1
  v_mfma_f32_16x16x32_bf16 v[112:115], a[128:131], a[100:103], v[112:115]
  s_add_u32 s64, s64, s66
  ds_read_b64_tr_b16 a[136:137], v20 offset:16384
  ds_read_b64_tr_b16 a[138:139], v20 offset:18432
  v_mfma_f32_16x16x32_bf16 v[112:115], a[144:147], a[116:119], v[112:115]
  buffer_store_dwordx4 v[136:139], v2, s[16:19], s36 offen offset:2048 sc1
  v_mfma_f32_16x16x32_bf16 v[100:103], a[132:135], a[96:99], v[100:103]
  s_add_u32 s65, s65, 1
  ds_read_b64_tr_b16 a[152:153], v20 offset:20480
  ds_read_b64_tr_b16 a[154:155], v20 offset:22528
  v_mfma_f32_16x16x32_bf16 v[100:103], a[148:151], a[112:115], v[100:103]
  buffer_store_dwordx4 v[140:143], v2, s[16:19], s36 offen offset:3072 sc1
  v_mfma_f32_16x16x32_bf16 v[116:119], a[132:135], a[100:103], v[116:119]
  s_cmp_eq_u32 s65, 4
  s_cselect_b32 s65, 0, s65
  s_cselect_b32 s66, s67, s68
  ds_read_b64_tr_b16 a[140:141], v21 offset:16384
  ds_read_b64_tr_b16 a[142:143], v21 offset:18432
  v_mfma_f32_16x16x32_bf16 v[116:119], a[148:151], a[116:119], v[116:119]
  ds_read_b64_tr_b16 a[156:157], v21 offset:20480
  ds_read_b64_tr_b16 a[158:159], v21 offset:22528
  v_add_u32 v16, s66, v16
  v_add_u32 v17, s66, v17
  v_add_u32 v18, s66, v18
  v_add_u32 v19, s66, v19
  v_add_u32 v20, s66, v20
  v_add_u32 v21, s66, v21
  s_waitcnt vmcnt(18) lgkmcnt(0)
  s_barrier
  v_mfma_f32_16x16x32_bf16 v[104:107], a[136:139], a[96:99], v[104:107]
  ds_read_b128 a[64:67], v16 offset:0
  ds_read_b128 a[80:83], v16 offset:8192
  v_mfma_f32_16x16x32_bf16 v[104:107], a[152:155], a[112:115], v[104:107]
  ds_read_b64_tr_b16 a[128:129], v18 offset:16384
  ds_read_b64_tr_b16 a[130:131], v18 offset:18432
  v_mfma_f32_16x16x32_bf16 v[120:123], a[136:139], a[100:103], v[120:123]
  ds_read_b64_tr_b16 a[144:145], v18 offset:20480
  ds_read_b64_tr_b16 a[146:147], v18 offset:22528
  v_mfma_f32_16x16x32_bf16 v[120:123], a[152:155], a[116:119], v[120:123]
  ds_read_b128 a[68:71], v16 offset:1024
  v_mfma_f32_16x16x32_bf16 v[108:111], a[140:143], a[96:99], v[108:111]
  ds_read_b128 a[84:87], v16 offset:9216
  ds_read_b64_tr_b16 a[132:133], v19 offset:16384
  v_mfma_f32_16x16x32_bf16 v[108:111], a[156:159], a[112:115], v[108:111]
  ds_read_b64_tr_b16 a[134:135], v19 offset:18432
  ds_read_b64_tr_b16 a[148:149], v19 offset:20480
  v_mfma_f32_16x16x32_bf16 v[124:127], a[140:143], a[100:103], v[124:127]
  ds_read_b64_tr_b16 a[150:151], v19 offset:22528
  v_mfma_f32_16x16x32_bf16 v[124:127], a[156:159], a[116:119], v[124:127]
  s_waitcnt lgkmcnt(0)
  v_mfma_f32_16x16x32_bf16 v[96:99], a[128:131], a[64:67], v[96:99]
  s_add_u32 s64, s64, s66
  ds_read_b64_tr_b16 a[136:137], v20 offset:16384
  ds_read_b64_tr_b16 a[138:139], v20 offset:18432
  v_mfma_f32_16x16x32_bf16 v[96:99], a[144:147], a[80:83], v[96:99]
  s_add_u32 s65, s65, 1
  ds_read_b64_tr_b16 a[152:153], v20 offset:20480
  ds_read_b64_tr_b16 a[154:155], v20 offset:22528
  v_mfma_f32_16x16x32_bf16 v[112:115], a[128:131], a[68:71], v[112:115]
  s_cmp_eq_u32 s65, 4
  s_cselect_b32 s65, 0, s65
  s_cselect_b32 s66, s67, s68
  ds_read_b64_tr_b16 a[140:141], v21 offset:16384
  v_mfma_f32_16x16x32_bf16 v[112:115], a[144:147], a[84:87], v[112:115]
  ds_read_b64_tr_b16 a[142:143], v21 offset:18432
  ds_read_b64_tr_b16 a[156:157], v21 offset:20480
  v_mfma_f32_16x16x32_bf16 v[100:103], a[132:135], a[64:67], v[100:103]
  ds_read_b64_tr_b16 a[158:159], v21 offset:22528
  v_mfma_f32_16x16x32_bf16 v[100:103], a[148:151], a[80:83], v[100:103]
  v_add_u32 v16, s66, v16
  v_add_u32 v17, s66, v17
  v_mfma_f32_16x16x32_bf16 v[116:119], a[132:135], a[68:71], v[116:119]
  v_add_u32 v18, s66, v18
  v_add_u32 v19, s66, v19
  v_mfma_f32_16x16x32_bf16 v[116:119], a[148:151], a[84:87], v[116:119]
  v_add_u32 v20, s66, v20
  v_add_u32 v21, s66, v21
  s_waitcnt vmcnt(11) lgkmcnt(0)
  s_barrier
  v_mfma_f32_16x16x32_bf16 v[104:107], a[136:139], a[64:67], v[104:107]
  ds_read_b128 a[96:99], v16 offset:0
  ds_read_b128 a[112:115], v16 offset:8192
  v_mfma_f32_16x16x32_bf16 v[104:107], a[152:155], a[80:83], v[104:107]
  ds_read_b64_tr_b16 a[128:129], v18 offset:16384
  ds_read_b64_tr_b16 a[130:131], v18 offset:18432
  v_mfma_f32_16x16x32_bf16 v[120:123], a[136:139], a[68:71], v[120:123]
  ds_read_b64_tr_b16 a[144:145], v18 offset:20480
  ds_read_b64_tr_b16 a[146:147], v18 offset:22528
  v_mfma_f32_16x16x32_bf16 v[120:123], a[152:155], a[84:87], v[120:123]
  ds_read_b128 a[100:103], v16 offset:1024
  v_mfma_f32_16x16x32_bf16 v[108:111], a[140:143], a[64:67], v[108:111]
  ds_read_b128 a[116:119], v16 offset:9216
  ds_read_b64_tr_b16 a[132:133], v19 offset:16384
  v_mfma_f32_16x16x32_bf16 v[108:111], a[156:159], a[80:83], v[108:111]
  ds_read_b64_tr_b16 a[134:135], v19 offset:18432
  ds_read_b64_tr_b16 a[148:149], v19 offset:20480
  v_mfma_f32_16x16x32_bf16 v[124:127], a[140:143], a[68:71], v[124:127]
  ds_read_b64_tr_b16 a[150:151], v19 offset:22528
  v_mfma_f32_16x16x32_bf16 v[124:127], a[156:159], a[84:87], v[124:127]
  s_waitcnt lgkmcnt(0)
  v_mfma_f32_16x16x32_bf16 v[96:99], a[128:131], a[96:99], v[96:99]
  s_add_u32 s64, s64, s66
  ds_read_b64_tr_b16 a[136:137], v20 offset:16384
  ds_read_b64_tr_b16 a[138:139], v20 offset:18432
  v_mfma_f32_16x16x32_bf16 v[96:99], a[144:147], a[112:115], v[96:99]
  s_add_u32 s65, s65, 1
  ds_read_b64_tr_b16 a[152:153], v20 offset:20480
  ds_read_b64_tr_b16 a[154:155], v20 offset:22528
  v_mfma_f32_16x16x32_bf16 v[112:115], a[128:131], a[100:103], v[112:115]
  s_cmp_eq_u32 s65, 4
  s_cselect_b32 s65, 0, s65
  s_cselect_b32 s66, s67, s68
  ds_read_b64_tr_b16 a[140:141], v21 offset:16384
  v_mfma_f32_16x16x32_bf16 v[112:115], a[144:147], a[116:119], v[112:115]
  ds_read_b64_tr_b16 a[142:143], v21 offset:18432
  ds_read_b64_tr_b16 a[156:157], v21 offset:20480
  v_mfma_f32_16x16x32_bf16 v[100:103], a[132:135], a[96:99], v[100:103]
  ds_read_b64_tr_b16 a[158:159], v21 offset:22528
  v_mfma_f32_16x16x32_bf16 v[100:103], a[148:151], a[112:115], v[100:103]
  v_add_u32 v16, s66, v16
  v_add_u32 v17, s66, v17
  v_mfma_f32_16x16x32_bf16 v[116:119], a[132:135], a[100:103], v[116:119]
  v_add_u32 v18, s66, v18
  v_add_u32 v19, s66, v19
  v_mfma_f32_16x16x32_bf16 v[116:119], a[148:151], a[116:119], v[116:119]
  v_add_u32 v20, s66, v20
  v_add_u32 v21, s66, v21
  s_waitcnt vmcnt(4) lgkmcnt(0)
  s_barrier
  v_mfma_f32_16x16x32_bf16 v[104:107], a[136:139], a[96:99], v[104:107]
  s_lshl_b32 s6, s78, 1
  s_add_u32 s6, s6, s77
  s_lshl_b32 s6, s6, 2
  v_mfma_f32_16x16x32_bf16 v[104:107], a[152:155], a[112:115], v[104:107]
  s_add_u32 s6, s6, s3
  s_lshl_b32 s6, s6, 14
  s_add_u32 s7, s6, 4096
  v_mfma_f32_16x16x32_bf16 v[120:123], a[136:139], a[100:103], v[120:123]
  buffer_load_dwordx4 v[208:211], v2, s[16:19], s6 offen offset:0 sc1
  v_mfma_f32_16x16x32_bf16 v[120:123], a[152:155], a[116:119], v[120:123]
  buffer_load_dwordx4 v[212:215], v2, s[16:19], s6 offen offset:1024 sc1
  v_mfma_f32_16x16x32_bf16 v[108:111], a[140:143], a[96:99], v[108:111]
  ds_read_b128 a[64:67], v16 offset:0
  ds_read_b128 a[80:83], v16 offset:8192
  v_mfma_f32_16x16x32_bf16 v[108:111], a[156:159], a[112:115], v[108:111]
  ds_read_b64_tr_b16 a[128:129], v18 offset:16384
  ds_read_b64_tr_b16 a[130:131], v18 offset:18432
  v_mfma_f32_16x16x32_bf16 v[124:127], a[140:143], a[100:103], v[124:127]
  ds_read_b64_tr_b16 a[144:145], v18 offset:20480
  ds_read_b64_tr_b16 a[146:147], v18 offset:22528
  v_mfma_f32_16x16x32_bf16 v[124:127], a[156:159], a[116:119], v[124:127]
  ds_read_b128 a[68:71], v16 offset:1024
  ds_read_b128 a[84:87], v16 offset:9216
  ds_read_b64_tr_b16 a[132:133], v19 offset:16384
  ds_read_b64_tr_b16 a[134:135], v19 offset:18432
  ds_read_b64_tr_b16 a[148:149], v19 offset:20480
  ds_read_b64_tr_b16 a[150:151], v19 offset:22528
  s_waitcnt lgkmcnt(0)
  v_mfma_f32_16x16x32_bf16 v[96:99], a[128:131], a[64:67], v[96:99]
  buffer_load_dwordx4 v[216:219], v2, s[16:19], s6 offen offset:2048 sc1
  v_mfma_f32_16x16x32_bf16 v[96:99], a[144:147], a[80:83], v[96:99]
  ds_read_b64_tr_b16 a[136:137], v20 offset:16384
  ds_read_b64_tr_b16 a[138:139], v20 offset:18432
  v_mfma_f32_16x16x32_bf16 v[112:115], a[128:131], a[68:71], v[112:115]
  ds_read_b64_tr_b16 a[152:153], v20 offset:20480
  ds_read_b64_tr_b16 a[154:155], v20 offset:22528
  v_mfma_f32_16x16x32_bf16 v[112:115], a[144:147], a[84:87], v[112:115]
  buffer_load_dwordx4 v[220:223], v2, s[16:19], s6 offen offset:3072 sc1
  v_mfma_f32_16x16x32_bf16 v[100:103], a[132:135], a[64:67], v[100:103]
  ds_read_b64_tr_b16 a[140:141], v21 offset:16384
  ds_read_b64_tr_b16 a[142:143], v21 offset:18432
  v_mfma_f32_16x16x32_bf16 v[100:103], a[148:151], a[80:83], v[100:103]
  ds_read_b64_tr_b16 a[156:157], v21 offset:20480
  ds_read_b64_tr_b16 a[158:159], v21 offset:22528
  v_mfma_f32_16x16x32_bf16 v[116:119], a[132:135], a[68:71], v[116:119]
  v_mfma_f32_16x16x32_bf16 v[116:119], a[148:151], a[84:87], v[116:119]
  s_waitcnt lgkmcnt(0)
  v_mfma_f32_16x16x32_bf16 v[104:107], a[136:139], a[64:67], v[104:107]
  v_mfma_f32_16x16x32_bf16 v[104:107], a[152:155], a[80:83], v[104:107]
  v_mfma_f32_16x16x32_bf16 v[120:123], a[136:139], a[68:71], v[120:123]
  v_mfma_f32_16x16x32_bf16 v[120:123], a[152:155], a[84:87], v[120:123]
  v_mfma_f32_16x16x32_bf16 v[108:111], a[140:143], a[64:67], v[108:111]
  v_mfma_f32_16x16x32_bf16 v[108:111], a[156:159], a[80:83], v[108:111]
  v_mfma_f32_16x16x32_bf16 v[124:127], a[140:143], a[68:71], v[124:127]
  v_mfma_f32_16x16x32_bf16 v[124:127], a[156:159], a[84:87], v[124:127]
  s_waitcnt vmcnt(0)
  s_mov_b32 s72, 0x40000
Lrc_13:
  v_max3_u32 v6, v208, v209, v210
  v_max3_u32 v7, v216, v217, v218
  v_max3_u32 v6, v6, v211, v212
  v_max3_u32 v7, v7, v219, v220
  v_max3_u32 v6, v6, v213, v214
  v_max3_u32 v7, v7, v221, v222
  v_max_u32 v6, v6, v215
  v_max_u32 v7, v7, v223
  v_max_u32 v4, v6, v7
  v_cmp_eq_u32 vcc, -1, v4
  s_nop 0
  s_cbranch_vccz Lpolld_14
  buffer_load_dwordx4 v[208:211], v2, s[16:19], s6 offen offset:0 sc1
  buffer_load_dwordx4 v[212:215], v2, s[16:19], s6 offen offset:1024 sc1
  buffer_load_dwordx4 v[216:219], v2, s[16:19], s6 offen offset:2048 sc1
  buffer_load_dwordx4 v[220:223], v2, s[16:19], s6 offen offset:3072 sc1
  s_sub_u32 s72, s72, 1
  s_waitcnt vmcnt(0)
  s_cbranch_scc0 Lrc_13
Lpolld_14:
  v_lshlrev_b32 v128, 16, v208
  v_lshlrev_b32 v136, 16, v212
  v_lshlrev_b32 v144, 16, v216
  v_lshlrev_b32 v152, 16, v220
  v_and_b32 v129, 0xffff0000, v208
  v_and_b32 v137, 0xffff0000, v212
  v_and_b32 v145, 0xffff0000, v216
  v_and_b32 v153, 0xffff0000, v220
  v_lshlrev_b32 v130, 16, v209
  v_lshlrev_b32 v138, 16, v213
  v_lshlrev_b32 v146, 16, v217
  v_lshlrev_b32 v154, 16, v221
  v_and_b32 v131, 0xffff0000, v209
  v_and_b32 v139, 0xffff0000, v213
  v_and_b32 v147, 0xffff0000, v217
  v_and_b32 v155, 0xffff0000, v221
  v_lshlrev_b32 v132, 16, v210
  v_lshlrev_b32 v140, 16, v214
  v_lshlrev_b32 v148, 16, v218
  v_lshlrev_b32 v156, 16, v222
  v_and_b32 v133, 0xffff0000, v210
  v_and_b32 v141, 0xffff0000, v214
  v_and_b32 v149, 0xffff0000, v218
  v_and_b32 v157, 0xffff0000, v222
  v_lshlrev_b32 v134, 16, v211
  v_lshlrev_b32 v142, 16, v215
  v_lshlrev_b32 v150, 16, v219
  v_lshlrev_b32 v158, 16, v223
  v_and_b32 v135, 0xffff0000, v211
  v_and_b32 v143, 0xffff0000, v215
  v_and_b32 v151, 0xffff0000, v219
  v_and_b32 v159, 0xffff0000, v223
  v_pk_add_f32 v[128:129], v[128:129], v[96:97]
  v_pk_add_f32 v[136:137], v[136:137], v[104:105]
  v_pk_add_f32 v[144:145], v[144:145], v[112:113]
  v_pk_add_f32 v[152:153], v[152:153], v[120:121]
  v_pk_add_f32 v[130:131], v[130:131], v[98:99]
  v_pk_add_f32 v[138:139], v[138:139], v[106:107]
  v_pk_add_f32 v[146:147], v[146:147], v[114:115]
  v_pk_add_f32 v[154:155], v[154:155], v[122:123]
  v_pk_add_f32 v[132:133], v[132:133], v[100:101]
  v_pk_add_f32 v[140:141], v[140:141], v[108:109]
  v_pk_add_f32 v[148:149], v[148:149], v[116:117]
  v_pk_add_f32 v[156:157], v[156:157], v[124:125]
  v_pk_add_f32 v[134:135], v[134:135], v[102:103]
  v_pk_add_f32 v[142:143], v[142:143], v[110:111]
  v_pk_add_f32 v[150:151], v[150:151], v[118:119]
  v_pk_add_f32 v[158:159], v[158:159], v[126:127]
  v_cvt_pk_bf16_f32 v128, v128, v129
  v_cvt_pk_bf16_f32 v136, v136, v137
  v_cvt_pk_bf16_f32 v144, v144, v145
  v_cvt_pk_bf16_f32 v152, v152, v153
  v_cvt_pk_bf16_f32 v129, v130, v131
  v_cvt_pk_bf16_f32 v137, v138, v139
  v_cvt_pk_bf16_f32 v145, v146, v147
  v_cvt_pk_bf16_f32 v153, v154, v155
  v_cvt_pk_bf16_f32 v130, v132, v133
  v_cvt_pk_bf16_f32 v138, v140, v141
  v_cvt_pk_bf16_f32 v146, v148, v149
  v_cvt_pk_bf16_f32 v154, v156, v157
  v_cvt_pk_bf16_f32 v131, v134, v135
  v_cvt_pk_bf16_f32 v139, v142, v143
  v_cvt_pk_bf16_f32 v147, v150, v151
  v_cvt_pk_bf16_f32 v155, v158, v159
  v_permlane16_swap_b32 v128, v130
  v_permlane16_swap_b32 v136, v138
  v_permlane16_swap_b32 v144, v146
  v_permlane16_swap_b32 v152, v154
  v_permlane16_swap_b32 v129, v131
  v_permlane16_swap_b32 v137, v139
  v_permlane16_swap_b32 v145, v147
  v_permlane16_swap_b32 v153, v155
  buffer_store_dwordx4 v[128:131], v26, s[20:23], s34 offen offset:0
  buffer_store_dwordx4 v[136:139], v26, s[20:23], s34 offen offset:64
  buffer_store_dwordx4 v[144:147], v26, s[20:23], s35 offen offset:0
  buffer_store_dwordx4 v[152:155], v26, s[20:23], s35 offen offset:64
Lend:
  s_endpgm
.section .rodata,"a"
.p2align 6
.amdhsa_kernel concat_heads__compressed_kv_cla__sliding_local_dilated__prompt_kernel
  .amdhsa_next_free_vgpr 512
  .amdhsa_next_free_sgpr 102
  .amdhsa_accum_offset 256
  .amdhsa_group_segment_fixed_size 0
  .amdhsa_kernarg_size 96
  .amdhsa_user_sgpr_count 2
  .amdhsa_user_sgpr_kernarg_segment_ptr 1
  .amdhsa_system_sgpr_workgroup_id_x 1
.end_amdhsa_kernel
```
